```python
import torch

def _softmax(x, axis=-1):
    return torch.softmax(x, dim=axis)
def _gelu(x):
    return torch.nn.functional.gelu(x, approximate="tanh")
def _silu(x):
    return torch.nn.functional.silu(x)
def _sigmoid(x):
    return torch.sigmoid(x)
def _layernorm(x, axis=-1, eps=1e-5):
    m = x.mean(dim=axis, keepdim=True)
    v = x.var(dim=axis, keepdim=True, unbiased=False)
    return (x - m) / torch.sqrt(v + eps)
def _scatter_add(tgt, idx, src, axis=0):
    return tgt.clone().index_add_(axis, idx, src)
def _segment_sum(src, seg, n):
    out = torch.zeros((n,) + src.shape[1:], dtype=src.dtype)
    return out.index_add_(0, seg, src)
def _pad(x, pw):
    flat = tuple(v for pair in reversed(pw) for v in pair)
    return torch.nn.functional.pad(x, flat)

kernel_name = 'gather_scatter__molecular_angular_gemnet__graph'

def setup_inputs():

    _w = (lambda a: (lambda t: t.to(torch.bfloat16) if t.is_floating_point() else t)(torch.as_tensor(a)))
    N, deg, De, L = 10000, 64, 4, 1
    E = N * deg
    T = E * deg
    NR = 8
    dist = torch.rand(E).to(float)
    angle = (torch.rand(T) * torch.pi).to(float)
    centers = torch.linspace(0.0, 1.0, NR).to(float)
    ang_freq = torch.arange(1, L + 1).to(float)
    return {
        "m": _w((lambda *s: torch.randn(*s, dtype=torch.bfloat16) * 0.05)(E, De)),
        "idx_in": _w((lambda lo, hi, *s: torch.randint(lo, hi, s))(0, E, T).to(torch.int64)),
        "idx_out": _w((lambda lo, hi, *s: torch.randint(lo, hi, s))(0, E, T).to(torch.int64)),
        "dist": _w(dist),
        "angle": _w(angle),
        "centers": _w(centers),
        "ang_freq": _w(ang_freq),
        "w_rbf": _w((lambda *s: torch.randn(*s, dtype=torch.bfloat16) * 0.2)(NR, De)),
        "w_sbf": _w((lambda *s: torch.randn(*s, dtype=torch.bfloat16) * 0.2)(NR * L, De)),
        "w_down": _w((lambda *s: torch.randn(*s, dtype=torch.bfloat16) * 0.2)(De, De)),
        "w_up": _w((lambda *s: torch.randn(*s, dtype=torch.bfloat16) * 0.2)(De, De)),
    }

def reference(m, idx_in, idx_out, dist, angle, centers, ang_freq, w_rbf, w_sbf, w_down, w_up):
    E, De = m.shape[0], m.shape[1]
    NR = centers.shape[0]
    L = ang_freq.shape[0]
    rbf = torch.exp(-10.0 * (dist[:, None] - centers[None, :]) ** 2)
    cbf = torch.cos(ang_freq[None, :] * angle[:, None])
    rbf_t = rbf[idx_out]
    sbf = torch.reshape(rbf_t[:, :, None] * cbf[:, None, :], (-1, NR * L))
    x = (m[idx_in] @ w_down) * (sbf @ w_sbf)
    agg = _segment_sum(x, idx_out, E)
    return m + (agg @ w_up) * (rbf @ w_rbf)
```

```asm
; @launch kernel=zero_kernel grid=(2500,1,1) block=(256,1,1) lds=0
; @launch kernel=atom_kernel grid=(160000,1,1) block=(256,1,1) lds=0
; @launch kernel=epi_kernel grid=(2500,1,1) block=(256,1,1) lds=0
.amdgcn_target "amdgcn-amd-amdhsa--gfx950"
.text
.globl zero_kernel
.p2align 8
.type zero_kernel,@function
zero_kernel:
    s_load_dwordx2 s[4:5], s[0:1], 104
    s_waitcnt lgkmcnt(0)
    s_mov_b32 s6, 10240000
    s_mov_b32 s7, 0x00020000
    s_lshl_b32 s3, s2, 8
    v_add_u32 v1, s3, v0
    v_lshlrev_b32 v1, 4, v1
    v_mov_b32 v4, 0
    v_mov_b32 v5, 0
    v_mov_b32 v6, 0
    v_mov_b32 v7, 0
    buffer_store_dwordx4 v[4:7], v1, s[4:7], 0 offen
    s_endpgm
.globl atom_kernel
.p2align 8
.type atom_kernel,@function
atom_kernel:
    s_load_dwordx2 s[4:5], s[0:1], 104
    s_load_dwordx2 s[8:9], s[0:1], 8
    s_load_dwordx2 s[12:13], s[0:1], 16
    s_load_dwordx2 s[16:17], s[0:1], 32
    s_load_dwordx2 s[20:21], s[0:1], 0
    s_waitcnt lgkmcnt(0)
    s_mov_b32 s6, 10240000
    s_mov_b32 s7, 0x00020000
    s_mov_b32 s10, 163840000
    s_mov_b32 s11, 0x00020000
    s_mov_b32 s14, 163840000
    s_mov_b32 s15, 0x00020000
    s_mov_b32 s18, 81920000
    s_mov_b32 s19, 0x00020000
    s_mov_b32 s22, 5120000
    s_mov_b32 s23, 0x00020000
    s_cmp_ge_u32 s2, 160000
    s_cbranch_scc1 L_atom_end
    s_lshl_b32 s3, s2, 8
    v_add_u32 v1, s3, v0
    v_lshlrev_b32 v2, 2, v1
    v_lshlrev_b32 v3, 1, v1
    buffer_load_dword v4, v2, s[8:11], 0 offen
    buffer_load_dword v5, v2, s[12:15], 0 offen
    buffer_load_ushort v6, v3, s[16:19], 0 offen
    s_waitcnt vmcnt(0)
    v_lshlrev_b32 v4, 3, v4
    buffer_load_dwordx2 v[8:9], v4, s[20:23], 0 offen
    v_lshlrev_b32 v5, 4, v5
    v_lshlrev_b32 v6, 16, v6
    v_mul_f32 v6, 0.15915494, v6
    v_fract_f32 v6, v6
    v_cos_f32 v6, v6
    s_waitcnt vmcnt(0)
    v_lshlrev_b32 v10, 16, v8
    v_and_b32 v11, 0xffff0000, v8
    v_lshlrev_b32 v12, 16, v9
    v_and_b32 v13, 0xffff0000, v9
    v_mul_f32 v10, v6, v10
    v_mul_f32 v11, v6, v11
    v_mul_f32 v12, v6, v12
    v_mul_f32 v13, v6, v13
    buffer_atomic_add_f32 v10, v5, s[4:7], 0 offen
    buffer_atomic_add_f32 v11, v5, s[4:7], 0 offen offset:4
    buffer_atomic_add_f32 v12, v5, s[4:7], 0 offen offset:8
    buffer_atomic_add_f32 v13, v5, s[4:7], 0 offen offset:12
L_atom_end:
    s_endpgm
.globl epi_kernel
.p2align 8
.type epi_kernel,@function
epi_kernel:
    s_load_dwordx2 s[4:5], s[0:1], 104
    s_load_dwordx2 s[8:9], s[0:1], 0
    s_load_dwordx2 s[12:13], s[0:1], 24
    s_load_dwordx2 s[16:17], s[0:1], 88
    s_load_dwordx2 s[20:21], s[0:1], 40
    s_load_dwordx4 s[24:27], s[0:1], 56
    s_load_dwordx4 s[28:31], s[0:1], 72
    s_waitcnt lgkmcnt(0)
    s_mov_b32 s6, 10240000
    s_mov_b32 s7, 0x00020000
    s_mov_b32 s10, 5120000
    s_mov_b32 s11, 0x00020000
    s_mov_b32 s14, 1280000
    s_mov_b32 s15, 0x00020000
    s_mov_b32 s18, 5120000
    s_mov_b32 s19, 0x00020000
    s_load_dwordx4 s[32:35], s[20:21], 0
    s_load_dwordx16 s[36:51], s[24:25], 0
    s_load_dwordx16 s[52:67], s[26:27], 0
    s_load_dwordx8 s[68:75], s[28:29], 0
    s_load_dwordx8 s[76:83], s[30:31], 0
    s_lshl_b32 s3, s2, 8
    v_add_u32 v1, s3, v0
    v_lshlrev_b32 v2, 4, v1
    v_lshlrev_b32 v3, 3, v1
    v_lshlrev_b32 v1, 1, v1
    buffer_load_dwordx4 v[4:7], v2, s[4:7], 0 offen
    buffer_load_dwordx2 v[8:9], v3, s[8:11], 0 offen
    buffer_load_ushort v10, v1, s[12:15], 0 offen
    s_waitcnt lgkmcnt(0)
    s_waitcnt vmcnt(0)
    v_lshlrev_b32 v10, 16, v10
    s_lshl_b32 s84, s32, 16
    v_subrev_f32 v16, s84, v10
    s_and_b32 s84, s32, 0xffff0000
    v_subrev_f32 v17, s84, v10
    s_lshl_b32 s84, s33, 16
    v_subrev_f32 v18, s84, v10
    s_and_b32 s84, s33, 0xffff0000
    v_subrev_f32 v19, s84, v10
    s_lshl_b32 s84, s34, 16
    v_subrev_f32 v20, s84, v10
    s_and_b32 s84, s34, 0xffff0000
    v_subrev_f32 v21, s84, v10
    s_lshl_b32 s84, s35, 16
    v_subrev_f32 v22, s84, v10
    s_and_b32 s84, s35, 0xffff0000
    v_subrev_f32 v23, s84, v10
    v_cvt_pk_bf16_f32 v11, v16, v17
    v_lshlrev_b32 v16, 16, v11
    v_and_b32 v17, 0xffff0000, v11
    v_cvt_pk_bf16_f32 v11, v18, v19
    v_lshlrev_b32 v18, 16, v11
    v_and_b32 v19, 0xffff0000, v11
    v_cvt_pk_bf16_f32 v11, v20, v21
    v_lshlrev_b32 v20, 16, v11
    v_and_b32 v21, 0xffff0000, v11
    v_cvt_pk_bf16_f32 v11, v22, v23
    v_lshlrev_b32 v22, 16, v11
    v_and_b32 v23, 0xffff0000, v11
    v_mul_f32 v16, v16, v16
    v_mul_f32 v17, v17, v17
    v_mul_f32 v18, v18, v18
    v_mul_f32 v19, v19, v19
    v_mul_f32 v20, v20, v20
    v_mul_f32 v21, v21, v21
    v_mul_f32 v22, v22, v22
    v_mul_f32 v23, v23, v23
    v_cvt_pk_bf16_f32 v11, v16, v17
    v_lshlrev_b32 v16, 16, v11
    v_and_b32 v17, 0xffff0000, v11
    v_cvt_pk_bf16_f32 v11, v18, v19
    v_lshlrev_b32 v18, 16, v11
    v_and_b32 v19, 0xffff0000, v11
    v_cvt_pk_bf16_f32 v11, v20, v21
    v_lshlrev_b32 v20, 16, v11
    v_and_b32 v21, 0xffff0000, v11
    v_cvt_pk_bf16_f32 v11, v22, v23
    v_lshlrev_b32 v22, 16, v11
    v_and_b32 v23, 0xffff0000, v11
    v_mul_f32 v16, 0xc1200000, v16
    v_mul_f32 v17, 0xc1200000, v17
    v_mul_f32 v18, 0xc1200000, v18
    v_mul_f32 v19, 0xc1200000, v19
    v_mul_f32 v20, 0xc1200000, v20
    v_mul_f32 v21, 0xc1200000, v21
    v_mul_f32 v22, 0xc1200000, v22
    v_mul_f32 v23, 0xc1200000, v23
    v_cvt_pk_bf16_f32 v11, v16, v17
    v_lshlrev_b32 v16, 16, v11
    v_and_b32 v17, 0xffff0000, v11
    v_cvt_pk_bf16_f32 v11, v18, v19
    v_lshlrev_b32 v18, 16, v11
    v_and_b32 v19, 0xffff0000, v11
    v_cvt_pk_bf16_f32 v11, v20, v21
    v_lshlrev_b32 v20, 16, v11
    v_and_b32 v21, 0xffff0000, v11
    v_cvt_pk_bf16_f32 v11, v22, v23
    v_lshlrev_b32 v22, 16, v11
    v_and_b32 v23, 0xffff0000, v11
    v_mul_f32 v16, 0x3fb8aa3b, v16
    v_mul_f32 v17, 0x3fb8aa3b, v17
    v_mul_f32 v18, 0x3fb8aa3b, v18
    v_mul_f32 v19, 0x3fb8aa3b, v19
    v_mul_f32 v20, 0x3fb8aa3b, v20
    v_mul_f32 v21, 0x3fb8aa3b, v21
    v_mul_f32 v22, 0x3fb8aa3b, v22
    v_mul_f32 v23, 0x3fb8aa3b, v23
    v_exp_f32 v16, v16
    v_exp_f32 v17, v17
    v_exp_f32 v18, v18
    v_exp_f32 v19, v19
    v_exp_f32 v20, v20
    v_exp_f32 v21, v21
    v_exp_f32 v22, v22
    v_exp_f32 v23, v23
    s_nop 0
    v_cvt_pk_bf16_f32 v11, v16, v17
    v_lshlrev_b32 v16, 16, v11
    v_and_b32 v17, 0xffff0000, v11
    v_cvt_pk_bf16_f32 v11, v18, v19
    v_lshlrev_b32 v18, 16, v11
    v_and_b32 v19, 0xffff0000, v11
    v_cvt_pk_bf16_f32 v11, v20, v21
    v_lshlrev_b32 v20, 16, v11
    v_and_b32 v21, 0xffff0000, v11
    v_cvt_pk_bf16_f32 v11, v22, v23
    v_lshlrev_b32 v22, 16, v11
    v_and_b32 v23, 0xffff0000, v11
    s_lshl_b32 s84, s36, 16
    v_mul_f32 v24, s84, v16
    s_lshl_b32 s84, s38, 16
    v_fmac_f32 v24, s84, v17
    s_lshl_b32 s84, s40, 16
    v_fmac_f32 v24, s84, v18
    s_lshl_b32 s84, s42, 16
    v_fmac_f32 v24, s84, v19
    s_lshl_b32 s84, s44, 16
    v_fmac_f32 v24, s84, v20
    s_lshl_b32 s84, s46, 16
    v_fmac_f32 v24, s84, v21
    s_lshl_b32 s84, s48, 16
    v_fmac_f32 v24, s84, v22
    s_lshl_b32 s84, s50, 16
    v_fmac_f32 v24, s84, v23
    s_and_b32 s84, s36, 0xffff0000
    v_mul_f32 v25, s84, v16
    s_and_b32 s84, s38, 0xffff0000
    v_fmac_f32 v25, s84, v17
    s_and_b32 s84, s40, 0xffff0000
    v_fmac_f32 v25, s84, v18
    s_and_b32 s84, s42, 0xffff0000
    v_fmac_f32 v25, s84, v19
    s_and_b32 s84, s44, 0xffff0000
    v_fmac_f32 v25, s84, v20
    s_and_b32 s84, s46, 0xffff0000
    v_fmac_f32 v25, s84, v21
    s_and_b32 s84, s48, 0xffff0000
    v_fmac_f32 v25, s84, v22
    s_and_b32 s84, s50, 0xffff0000
    v_fmac_f32 v25, s84, v23
    s_lshl_b32 s84, s37, 16
    v_mul_f32 v26, s84, v16
    s_lshl_b32 s84, s39, 16
    v_fmac_f32 v26, s84, v17
    s_lshl_b32 s84, s41, 16
    v_fmac_f32 v26, s84, v18
    s_lshl_b32 s84, s43, 16
    v_fmac_f32 v26, s84, v19
    s_lshl_b32 s84, s45, 16
    v_fmac_f32 v26, s84, v20
    s_lshl_b32 s84, s47, 16
    v_fmac_f32 v26, s84, v21
    s_lshl_b32 s84, s49, 16
    v_fmac_f32 v26, s84, v22
    s_lshl_b32 s84, s51, 16
    v_fmac_f32 v26, s84, v23
    s_and_b32 s84, s37, 0xffff0000
    v_mul_f32 v27, s84, v16
    s_and_b32 s84, s39, 0xffff0000
    v_fmac_f32 v27, s84, v17
    s_and_b32 s84, s41, 0xffff0000
    v_fmac_f32 v27, s84, v18
    s_and_b32 s84, s43, 0xffff0000
    v_fmac_f32 v27, s84, v19
    s_and_b32 s84, s45, 0xffff0000
    v_fmac_f32 v27, s84, v20
    s_and_b32 s84, s47, 0xffff0000
    v_fmac_f32 v27, s84, v21
    s_and_b32 s84, s49, 0xffff0000
    v_fmac_f32 v27, s84, v22
    s_and_b32 s84, s51, 0xffff0000
    v_fmac_f32 v27, s84, v23
    s_lshl_b32 s84, s52, 16
    v_mul_f32 v28, s84, v16
    s_lshl_b32 s84, s54, 16
    v_fmac_f32 v28, s84, v17
    s_lshl_b32 s84, s56, 16
    v_fmac_f32 v28, s84, v18
    s_lshl_b32 s84, s58, 16
    v_fmac_f32 v28, s84, v19
    s_lshl_b32 s84, s60, 16
    v_fmac_f32 v28, s84, v20
    s_lshl_b32 s84, s62, 16
    v_fmac_f32 v28, s84, v21
    s_lshl_b32 s84, s64, 16
    v_fmac_f32 v28, s84, v22
    s_lshl_b32 s84, s66, 16
    v_fmac_f32 v28, s84, v23
    s_and_b32 s84, s52, 0xffff0000
    v_mul_f32 v29, s84, v16
    s_and_b32 s84, s54, 0xffff0000
    v_fmac_f32 v29, s84, v17
    s_and_b32 s84, s56, 0xffff0000
    v_fmac_f32 v29, s84, v18
    s_and_b32 s84, s58, 0xffff0000
    v_fmac_f32 v29, s84, v19
    s_and_b32 s84, s60, 0xffff0000
    v_fmac_f32 v29, s84, v20
    s_and_b32 s84, s62, 0xffff0000
    v_fmac_f32 v29, s84, v21
    s_and_b32 s84, s64, 0xffff0000
    v_fmac_f32 v29, s84, v22
    s_and_b32 s84, s66, 0xffff0000
    v_fmac_f32 v29, s84, v23
    s_lshl_b32 s84, s53, 16
    v_mul_f32 v30, s84, v16
    s_lshl_b32 s84, s55, 16
    v_fmac_f32 v30, s84, v17
    s_lshl_b32 s84, s57, 16
    v_fmac_f32 v30, s84, v18
    s_lshl_b32 s84, s59, 16
    v_fmac_f32 v30, s84, v19
    s_lshl_b32 s84, s61, 16
    v_fmac_f32 v30, s84, v20
    s_lshl_b32 s84, s63, 16
    v_fmac_f32 v30, s84, v21
    s_lshl_b32 s84, s65, 16
    v_fmac_f32 v30, s84, v22
    s_lshl_b32 s84, s67, 16
    v_fmac_f32 v30, s84, v23
    s_and_b32 s84, s53, 0xffff0000
    v_mul_f32 v31, s84, v16
    s_and_b32 s84, s55, 0xffff0000
    v_fmac_f32 v31, s84, v17
    s_and_b32 s84, s57, 0xffff0000
    v_fmac_f32 v31, s84, v18
    s_and_b32 s84, s59, 0xffff0000
    v_fmac_f32 v31, s84, v19
    s_and_b32 s84, s61, 0xffff0000
    v_fmac_f32 v31, s84, v20
    s_and_b32 s84, s63, 0xffff0000
    v_fmac_f32 v31, s84, v21
    s_and_b32 s84, s65, 0xffff0000
    v_fmac_f32 v31, s84, v22
    s_and_b32 s84, s67, 0xffff0000
    v_fmac_f32 v31, s84, v23
    s_lshl_b32 s84, s68, 16
    v_mul_f32 v32, s84, v4
    s_lshl_b32 s84, s70, 16
    v_fmac_f32 v32, s84, v5
    s_lshl_b32 s84, s72, 16
    v_fmac_f32 v32, s84, v6
    s_lshl_b32 s84, s74, 16
    v_fmac_f32 v32, s84, v7
    s_and_b32 s84, s68, 0xffff0000
    v_mul_f32 v33, s84, v4
    s_and_b32 s84, s70, 0xffff0000
    v_fmac_f32 v33, s84, v5
    s_and_b32 s84, s72, 0xffff0000
    v_fmac_f32 v33, s84, v6
    s_and_b32 s84, s74, 0xffff0000
    v_fmac_f32 v33, s84, v7
    s_lshl_b32 s84, s69, 16
    v_mul_f32 v34, s84, v4
    s_lshl_b32 s84, s71, 16
    v_fmac_f32 v34, s84, v5
    s_lshl_b32 s84, s73, 16
    v_fmac_f32 v34, s84, v6
    s_lshl_b32 s84, s75, 16
    v_fmac_f32 v34, s84, v7
    s_and_b32 s84, s69, 0xffff0000
    v_mul_f32 v35, s84, v4
    s_and_b32 s84, s71, 0xffff0000
    v_fmac_f32 v35, s84, v5
    s_and_b32 s84, s73, 0xffff0000
    v_fmac_f32 v35, s84, v6
    s_and_b32 s84, s75, 0xffff0000
    v_fmac_f32 v35, s84, v7
    v_mul_f32 v32, v32, v28
    v_mul_f32 v33, v33, v29
    v_mul_f32 v34, v34, v30
    v_mul_f32 v35, v35, v31
    s_lshl_b32 s84, s76, 16
    v_mul_f32 v36, s84, v32
    s_lshl_b32 s84, s78, 16
    v_fmac_f32 v36, s84, v33
    s_lshl_b32 s84, s80, 16
    v_fmac_f32 v36, s84, v34
    s_lshl_b32 s84, s82, 16
    v_fmac_f32 v36, s84, v35
    s_and_b32 s84, s76, 0xffff0000
    v_mul_f32 v37, s84, v32
    s_and_b32 s84, s78, 0xffff0000
    v_fmac_f32 v37, s84, v33
    s_and_b32 s84, s80, 0xffff0000
    v_fmac_f32 v37, s84, v34
    s_and_b32 s84, s82, 0xffff0000
    v_fmac_f32 v37, s84, v35
    s_lshl_b32 s84, s77, 16
    v_mul_f32 v38, s84, v32
    s_lshl_b32 s84, s79, 16
    v_fmac_f32 v38, s84, v33
    s_lshl_b32 s84, s81, 16
    v_fmac_f32 v38, s84, v34
    s_lshl_b32 s84, s83, 16
    v_fmac_f32 v38, s84, v35
    s_and_b32 s84, s77, 0xffff0000
    v_mul_f32 v39, s84, v32
    s_and_b32 s84, s79, 0xffff0000
    v_fmac_f32 v39, s84, v33
    s_and_b32 s84, s81, 0xffff0000
    v_fmac_f32 v39, s84, v34
    s_and_b32 s84, s83, 0xffff0000
    v_fmac_f32 v39, s84, v35
    v_lshlrev_b32 v12, 16, v8
    v_and_b32 v13, 0xffff0000, v8
    v_lshlrev_b32 v14, 16, v9
    v_and_b32 v15, 0xffff0000, v9
    v_fmac_f32 v12, v36, v24
    v_fmac_f32 v13, v37, v25
    v_fmac_f32 v14, v38, v26
    v_fmac_f32 v15, v39, v27
    v_cvt_pk_bf16_f32 v8, v12, v13
    v_cvt_pk_bf16_f32 v9, v14, v15
    buffer_store_dwordx2 v[8:9], v3, s[16:19], 0 offen
    s_endpgm
.section .rodata,"a"
.p2align 6
.amdhsa_kernel zero_kernel
  .amdhsa_next_free_vgpr 8
  .amdhsa_next_free_sgpr 96
  .amdhsa_accum_offset 8
  .amdhsa_group_segment_fixed_size 0
  .amdhsa_kernarg_size 112
  .amdhsa_user_sgpr_count 2
  .amdhsa_user_sgpr_kernarg_segment_ptr 1
  .amdhsa_system_sgpr_workgroup_id_x 1
  .amdhsa_float_denorm_mode_32 0
.end_amdhsa_kernel
.p2align 6
.amdhsa_kernel atom_kernel
  .amdhsa_next_free_vgpr 16
  .amdhsa_next_free_sgpr 96
  .amdhsa_accum_offset 16
  .amdhsa_group_segment_fixed_size 0
  .amdhsa_kernarg_size 112
  .amdhsa_user_sgpr_count 2
  .amdhsa_user_sgpr_kernarg_segment_ptr 1
  .amdhsa_system_sgpr_workgroup_id_x 1
  .amdhsa_float_denorm_mode_32 0
.end_amdhsa_kernel
.p2align 6
.amdhsa_kernel epi_kernel
  .amdhsa_next_free_vgpr 40
  .amdhsa_next_free_sgpr 96
  .amdhsa_accum_offset 40
  .amdhsa_group_segment_fixed_size 0
  .amdhsa_kernarg_size 112
  .amdhsa_user_sgpr_count 2
  .amdhsa_user_sgpr_kernarg_segment_ptr 1
  .amdhsa_system_sgpr_workgroup_id_x 1
  .amdhsa_float_denorm_mode_32 0
.end_amdhsa_kernel
```

```asm
; @launch kernel=p1_kernel grid=(256,1,1) block=(1024,1,1) lds=163840
; @launch kernel=p2_kernel grid=(256,1,1) block=(1024,1,1) lds=163840
; @launch kernel=p3_kernel grid=(1250,1,1) block=(256,1,1) lds=0
.amdgcn_target "amdgcn-amd-amdhsa--gfx950"
.text
.globl p1_kernel
.p2align 8
.type p1_kernel,@function
p1_kernel:
    s_cmp_ge_u32 s2, 256
    s_cbranch_scc1 L_p1_end
    s_load_dwordx2 s[4:5], s[0:1], 104
    s_load_dwordx2 s[8:9], s[0:1], 8
    s_load_dwordx2 s[12:13], s[0:1], 16
    s_load_dwordx2 s[16:17], s[0:1], 32
    s_load_dwordx2 s[28:29], s[0:1], 0
    s_load_dwordx2 s[6:7], s[0:1], 48
    v_lshlrev_b32 v1, 4, v0
    v_lshlrev_b32 v2, 3, v0
    v_mul_u32_u24 v3, 12, v0
    v_lshrrev_b32 v6, 6, v0
    v_mov_b32 v4, 1
    v_mov_b32 v5, 0
    v_readfirstlane_b32 s39, v6
    v_cmp_gt_u32 vcc, 784, v0
    s_mov_b32 s32, s2
    s_mul_i32 s33, s2, 160000
    s_mul_i32 s34, s2, 80000
    s_mov_b64 s[44:45], vcc
    v_mov_b32 v6, 0x7f000000
    v_cndmask_b32 v17, v6, v5, vcc
    s_waitcnt lgkmcnt(0)
    s_load_dword s3, s[6:7], 0
    s_mov_b32 s10, 163840000
    s_mov_b32 s11, 0x00020000
    s_mov_b32 s14, 163840000
    s_mov_b32 s15, 0x00020000
    s_mov_b32 s18, 81920000
    s_mov_b32 s19, 0x00020000
    s_mul_i32 s36, s2, 20000
    s_add_u32 s30, s36, 20000
    s_mov_b32 s31, 0x00020000
    s_add_u32 s35, s36, 16384
    buffer_load_dwordx4 v[48:51], v1, s[28:31], s36 offen
    buffer_load_dwordx4 v[52:55], v1, s[28:31], s35 offen
    s_add_u32 s35, s33, 0
    buffer_load_dwordx4 v[18:21], v1, s[8:11], s35 offen nt
    s_add_u32 s35, s33, 0
    buffer_load_dwordx4 v[22:25], v1, s[12:15], s35 offen nt
    s_add_u32 s35, s34, 0
    buffer_load_dwordx2 v[26:27], v2, s[16:19], s35 offen nt
    s_add_u32 s35, s33, 16384
    buffer_load_dwordx4 v[28:31], v1, s[8:11], s35 offen nt
    s_add_u32 s35, s33, 16384
    buffer_load_dwordx4 v[32:35], v1, s[12:15], s35 offen nt
    s_add_u32 s35, s34, 8192
    buffer_load_dwordx2 v[36:37], v2, s[16:19], s35 offen nt
    s_add_u32 s35, s33, 32768
    buffer_load_dwordx4 v[38:41], v1, s[8:11], s35 offen nt
    s_add_u32 s35, s33, 32768
    buffer_load_dwordx4 v[42:45], v1, s[12:15], s35 offen nt
    s_add_u32 s35, s34, 16384
    buffer_load_dwordx2 v[46:47], v2, s[16:19], s35 offen nt
    s_mov_b32 s20, s4
    s_mov_b32 s21, s5
    s_mov_b32 s22, 0
    s_mov_b32 s23, 0x00020000
    s_add_u32 s24, s4, 245768192
    s_addc_u32 s25, s5, 0
    s_mov_b32 s26, 8523776
    s_mov_b32 s27, 0x00020000
    s_mov_b32 s37, 4294957296
    s_mov_b32 s38, 262400
    s_mov_b32 s41, 0xffff
    s_mov_b32 s43, 0x05040100
    s_mov_b32 s40, 0
    v_mov_b32 v8, 0
    v_mov_b32 v9, 0
    v_mov_b32 v10, 0
    v_mov_b32 v11, 0
    ds_write_b128 v1, v[8:11] offset:0
    s_waitcnt lgkmcnt(0)
    s_lshl_b32 s3, s3, 16
    v_mov_b32 v16, s3
    v_mul_f32 v16, 0.15915494, v16
    s_waitcnt vmcnt(9)
    v_mov_b32 v12, 0x3f803f80
    v_and_b32 v48, 0x7fff7fff, v48
    v_and_b32 v49, 0x7fff7fff, v49
    v_and_b32 v50, 0x7fff7fff, v50
    v_and_b32 v51, 0x7fff7fff, v51
    v_and_b32 v52, 0x7fff7fff, v52
    v_and_b32 v53, 0x7fff7fff, v53
    v_and_b32 v54, 0x7fff7fff, v54
    v_and_b32 v55, 0x7fff7fff, v55
    v_pk_max_u16 v8, v8, v48
    v_dot2c_f32_bf16 v9, v48, v12
    v_pk_max_u16 v8, v8, v49
    v_dot2c_f32_bf16 v9, v49, v12
    v_pk_max_u16 v8, v8, v50
    v_dot2c_f32_bf16 v9, v50, v12
    v_pk_max_u16 v8, v8, v51
    v_dot2c_f32_bf16 v9, v51, v12
    v_pk_max_u16 v8, v8, v52
    v_dot2c_f32_bf16 v9, v52, v12
    v_pk_max_u16 v8, v8, v53
    v_dot2c_f32_bf16 v9, v53, v12
    v_pk_max_u16 v8, v8, v54
    v_dot2c_f32_bf16 v9, v54, v12
    v_pk_max_u16 v8, v8, v55
    v_dot2c_f32_bf16 v9, v55, v12
    v_lshrrev_b32 v10, 16, v8
    v_and_b32 v8, 0xffff, v8
    v_max_u32 v8, v8, v10
    s_nop 0
    s_nop 1
    v_max_u32_dpp v8, v8, v8 row_shr:1 row_mask:0xf bank_mask:0xf bound_ctrl:0
    s_nop 1
    v_max_u32_dpp v8, v8, v8 row_shr:2 row_mask:0xf bank_mask:0xf bound_ctrl:0
    s_nop 1
    v_max_u32_dpp v8, v8, v8 row_shr:4 row_mask:0xf bank_mask:0xf bound_ctrl:0
    s_nop 1
    v_max_u32_dpp v8, v8, v8 row_shr:8 row_mask:0xf bank_mask:0xf bound_ctrl:0
    s_nop 1
    v_max_u32_dpp v8, v8, v8 row_bcast:15 row_mask:0xa bank_mask:0xf
    s_nop 1
    v_max_u32_dpp v8, v8, v8 row_bcast:31 row_mask:0xc bank_mask:0xf
    s_nop 1
    v_add_f32_dpp v9, v9, v9 row_shr:1 row_mask:0xf bank_mask:0xf bound_ctrl:0
    s_nop 1
    v_add_f32_dpp v9, v9, v9 row_shr:2 row_mask:0xf bank_mask:0xf bound_ctrl:0
    s_nop 1
    v_add_f32_dpp v9, v9, v9 row_shr:4 row_mask:0xf bank_mask:0xf bound_ctrl:0
    s_nop 1
    v_add_f32_dpp v9, v9, v9 row_shr:8 row_mask:0xf bank_mask:0xf bound_ctrl:0
    s_nop 1
    v_add_f32_dpp v9, v9, v9 row_bcast:15 row_mask:0xa bank_mask:0xf
    s_nop 1
    v_add_f32_dpp v9, v9, v9 row_bcast:31 row_mask:0xc bank_mask:0xf
    s_lshl_b32 s35, s39, 4
    s_add_u32 s35, s35, 160064
    v_mov_b32 v10, s35
    s_mov_b32 exec_lo, 0
    s_brev_b32 exec_hi, 1
    ds_write_b64 v10, v[8:9]
    s_mov_b64 exec, -1
    s_waitcnt lgkmcnt(0)
    s_barrier
L_p1_loop:
    s_mov_b32 s36, 221184
    buffer_store_dwordx3 v[120:122], v3, s[20:23], s36 offen sc1
    s_mov_b32 s36, 233472
    buffer_store_dwordx3 v[124:126], v3, s[20:23], s36 offen sc1
    s_nop 0
    v_or_b32 v8, v1, v17
    v_or_b32 v9, v2, v17
    s_add_u32 s35, s33, 147456
    buffer_load_dwordx4 v[120:123], v8, s[8:11], s35 offen nt
    s_add_u32 s35, s33, 147456
    buffer_load_dwordx4 v[124:127], v8, s[12:15], s35 offen nt
    s_add_u32 s35, s34, 73728
    buffer_load_dwordx2 v[6:7], v9, s[16:19], s35 offen nt
    s_mov_b32 s36, 0
    buffer_store_dwordx3 v[48:50], v3, s[20:23], s36 offen sc1
    s_mov_b32 s36, 12288
    buffer_store_dwordx3 v[52:54], v3, s[20:23], s36 offen sc1
    s_waitcnt vmcnt(13)
    s_nop 0
    v_lshl_add_u32 v48, v22, 16, v18
    v_lshl_add_u32 v49, v23, 16, v19
    v_lshl_add_u32 v52, v24, 16, v20
    v_lshl_add_u32 v53, v25, 16, v21
    v_mul_hi_u32_u24 v18, 429497, v18
    v_mul_hi_u32_u24 v22, 429497, v22
    v_mul_hi_u32_u24 v19, 429497, v19
    v_mul_hi_u32_u24 v23, 429497, v23
    v_mul_hi_u32_u24 v20, 429497, v20
    v_mul_hi_u32_u24 v24, 429497, v24
    v_mul_hi_u32_u24 v21, 429497, v21
    v_mul_hi_u32_u24 v25, 429497, v25
    v_lshl_or_b32 v18, v22, 16, v18
    v_lshl_or_b32 v19, v23, 16, v19
    v_lshl_or_b32 v20, v24, 16, v20
    v_lshl_or_b32 v21, v25, 16, v21
    v_dot2_u32_u16 v22, v18, s38, 0
    v_dot2_u32_u16 v23, v19, s38, 0
    v_dot2_u32_u16 v24, v20, s38, 0
    v_dot2_u32_u16 v25, v21, s38, 0
    v_mad_i32_i24 v48, v18, s37, v48
    v_mad_i32_i24 v49, v19, s37, v49
    v_mad_i32_i24 v52, v20, s37, v52
    v_mad_i32_i24 v53, v21, s37, v53
    ds_add_u32 v22, v4 offset:0
    ds_add_u32 v23, v4 offset:0
    ds_add_u32 v24, v4 offset:0
    ds_add_u32 v25, v4 offset:0
    v_lshlrev_b32 v18, 16, v26
    v_lshlrev_b32 v20, 16, v27
    v_and_b32 v19, 0xffff0000, v26
    v_and_b32 v21, 0xffff0000, v27
    v_mul_f32 v18, v16, v18
    v_mul_f32 v19, v16, v19
    v_mul_f32 v20, v16, v20
    v_mul_f32 v21, v16, v21
    v_fract_f32 v18, v18
    v_fract_f32 v19, v19
    v_fract_f32 v20, v20
    v_fract_f32 v21, v21
    v_cos_f32 v18, v18
    v_cos_f32 v19, v19
    v_cos_f32 v20, v20
    v_cos_f32 v21, v21
    v_cvt_pk_bf16_f32 v18, 0, v18
    v_cvt_pk_bf16_f32 v19, 0, v19
    v_cvt_pk_bf16_f32 v20, 0, v20
    v_cvt_pk_bf16_f32 v21, 0, v21
    v_or_b32 v50, v18, v22
    v_or_b32 v51, v19, v23
    v_or_b32 v54, v20, v24
    v_or_b32 v55, v21, v25
    v_or3_b32 v5, v50, v51, v5
    v_or3_b32 v5, v54, v55, v5
    s_add_u32 s35, s33, 49152
    buffer_load_dwordx4 v[18:21], v1, s[8:11], s35 offen nt
    s_add_u32 s35, s33, 49152
    buffer_load_dwordx4 v[22:25], v1, s[12:15], s35 offen nt
    s_add_u32 s35, s34, 24576
    buffer_load_dwordx2 v[26:27], v2, s[16:19], s35 offen nt
    s_mov_b32 s36, 24576
    buffer_store_dwordx3 v[56:58], v3, s[20:23], s36 offen sc1
    s_mov_b32 s36, 36864
    buffer_store_dwordx3 v[60:62], v3, s[20:23], s36 offen sc1
    s_waitcnt vmcnt(15)
    s_nop 0
    v_lshl_add_u32 v56, v32, 16, v28
    v_lshl_add_u32 v57, v33, 16, v29
    v_lshl_add_u32 v60, v34, 16, v30
    v_lshl_add_u32 v61, v35, 16, v31
    v_mul_hi_u32_u24 v28, 429497, v28
    v_mul_hi_u32_u24 v32, 429497, v32
    v_mul_hi_u32_u24 v29, 429497, v29
    v_mul_hi_u32_u24 v33, 429497, v33
    v_mul_hi_u32_u24 v30, 429497, v30
    v_mul_hi_u32_u24 v34, 429497, v34
    v_mul_hi_u32_u24 v31, 429497, v31
    v_mul_hi_u32_u24 v35, 429497, v35
    v_lshl_or_b32 v28, v32, 16, v28
    v_lshl_or_b32 v29, v33, 16, v29
    v_lshl_or_b32 v30, v34, 16, v30
    v_lshl_or_b32 v31, v35, 16, v31
    v_dot2_u32_u16 v32, v28, s38, 0
    v_dot2_u32_u16 v33, v29, s38, 0
    v_dot2_u32_u16 v34, v30, s38, 0
    v_dot2_u32_u16 v35, v31, s38, 0
    v_mad_i32_i24 v56, v28, s37, v56
    v_mad_i32_i24 v57, v29, s37, v57
    v_mad_i32_i24 v60, v30, s37, v60
    v_mad_i32_i24 v61, v31, s37, v61
    ds_add_u32 v32, v4 offset:0
    ds_add_u32 v33, v4 offset:0
    ds_add_u32 v34, v4 offset:0
    ds_add_u32 v35, v4 offset:0
    v_lshlrev_b32 v28, 16, v36
    v_lshlrev_b32 v30, 16, v37
    v_and_b32 v29, 0xffff0000, v36
    v_and_b32 v31, 0xffff0000, v37
    v_mul_f32 v28, v16, v28
    v_mul_f32 v29, v16, v29
    v_mul_f32 v30, v16, v30
    v_mul_f32 v31, v16, v31
    v_fract_f32 v28, v28
    v_fract_f32 v29, v29
    v_fract_f32 v30, v30
    v_fract_f32 v31, v31
    v_cos_f32 v28, v28
    v_cos_f32 v29, v29
    v_cos_f32 v30, v30
    v_cos_f32 v31, v31
    v_cvt_pk_bf16_f32 v28, 0, v28
    v_cvt_pk_bf16_f32 v29, 0, v29
    v_cvt_pk_bf16_f32 v30, 0, v30
    v_cvt_pk_bf16_f32 v31, 0, v31
    v_or_b32 v58, v28, v32
    v_or_b32 v59, v29, v33
    v_or_b32 v62, v30, v34
    v_or_b32 v63, v31, v35
    v_or3_b32 v5, v58, v59, v5
    v_or3_b32 v5, v62, v63, v5
    s_add_u32 s35, s33, 65536
    buffer_load_dwordx4 v[28:31], v1, s[8:11], s35 offen nt
    s_add_u32 s35, s33, 65536
    buffer_load_dwordx4 v[32:35], v1, s[12:15], s35 offen nt
    s_add_u32 s35, s34, 32768
    buffer_load_dwordx2 v[36:37], v2, s[16:19], s35 offen nt
    s_mov_b32 s36, 49152
    buffer_store_dwordx3 v[64:66], v3, s[20:23], s36 offen sc1
    s_mov_b32 s36, 61440
    buffer_store_dwordx3 v[68:70], v3, s[20:23], s36 offen sc1
    s_waitcnt vmcnt(17)
    s_nop 0
    v_lshl_add_u32 v64, v42, 16, v38
    v_lshl_add_u32 v65, v43, 16, v39
    v_lshl_add_u32 v68, v44, 16, v40
    v_lshl_add_u32 v69, v45, 16, v41
    v_mul_hi_u32_u24 v38, 429497, v38
    v_mul_hi_u32_u24 v42, 429497, v42
    v_mul_hi_u32_u24 v39, 429497, v39
    v_mul_hi_u32_u24 v43, 429497, v43
    v_mul_hi_u32_u24 v40, 429497, v40
    v_mul_hi_u32_u24 v44, 429497, v44
    v_mul_hi_u32_u24 v41, 429497, v41
    v_mul_hi_u32_u24 v45, 429497, v45
    v_lshl_or_b32 v38, v42, 16, v38
    v_lshl_or_b32 v39, v43, 16, v39
    v_lshl_or_b32 v40, v44, 16, v40
    v_lshl_or_b32 v41, v45, 16, v41
    v_dot2_u32_u16 v42, v38, s38, 0
    v_dot2_u32_u16 v43, v39, s38, 0
    v_dot2_u32_u16 v44, v40, s38, 0
    v_dot2_u32_u16 v45, v41, s38, 0
    v_mad_i32_i24 v64, v38, s37, v64
    v_mad_i32_i24 v65, v39, s37, v65
    v_mad_i32_i24 v68, v40, s37, v68
    v_mad_i32_i24 v69, v41, s37, v69
    ds_add_u32 v42, v4 offset:0
    ds_add_u32 v43, v4 offset:0
    ds_add_u32 v44, v4 offset:0
    ds_add_u32 v45, v4 offset:0
    v_lshlrev_b32 v38, 16, v46
    v_lshlrev_b32 v40, 16, v47
    v_and_b32 v39, 0xffff0000, v46
    v_and_b32 v41, 0xffff0000, v47
    v_mul_f32 v38, v16, v38
    v_mul_f32 v39, v16, v39
    v_mul_f32 v40, v16, v40
    v_mul_f32 v41, v16, v41
    v_fract_f32 v38, v38
    v_fract_f32 v39, v39
    v_fract_f32 v40, v40
    v_fract_f32 v41, v41
    v_cos_f32 v38, v38
    v_cos_f32 v39, v39
    v_cos_f32 v40, v40
    v_cos_f32 v41, v41
    v_cvt_pk_bf16_f32 v38, 0, v38
    v_cvt_pk_bf16_f32 v39, 0, v39
    v_cvt_pk_bf16_f32 v40, 0, v40
    v_cvt_pk_bf16_f32 v41, 0, v41
    v_or_b32 v66, v38, v42
    v_or_b32 v67, v39, v43
    v_or_b32 v70, v40, v44
    v_or_b32 v71, v41, v45
    v_or3_b32 v5, v66, v67, v5
    v_or3_b32 v5, v70, v71, v5
    s_add_u32 s35, s33, 81920
    buffer_load_dwordx4 v[38:41], v1, s[8:11], s35 offen nt
    s_add_u32 s35, s33, 81920
    buffer_load_dwordx4 v[42:45], v1, s[12:15], s35 offen nt
    s_add_u32 s35, s34, 40960
    buffer_load_dwordx2 v[46:47], v2, s[16:19], s35 offen nt
    s_mov_b32 s36, 73728
    buffer_store_dwordx3 v[72:74], v3, s[20:23], s36 offen sc1
    s_mov_b32 s36, 86016
    buffer_store_dwordx3 v[76:78], v3, s[20:23], s36 offen sc1
    s_waitcnt vmcnt(12)
    s_nop 0
    v_lshl_add_u32 v72, v22, 16, v18
    v_lshl_add_u32 v73, v23, 16, v19
    v_lshl_add_u32 v76, v24, 16, v20
    v_lshl_add_u32 v77, v25, 16, v21
    v_mul_hi_u32_u24 v18, 429497, v18
    v_mul_hi_u32_u24 v22, 429497, v22
    v_mul_hi_u32_u24 v19, 429497, v19
    v_mul_hi_u32_u24 v23, 429497, v23
    v_mul_hi_u32_u24 v20, 429497, v20
    v_mul_hi_u32_u24 v24, 429497, v24
    v_mul_hi_u32_u24 v21, 429497, v21
    v_mul_hi_u32_u24 v25, 429497, v25
    v_lshl_or_b32 v18, v22, 16, v18
    v_lshl_or_b32 v19, v23, 16, v19
    v_lshl_or_b32 v20, v24, 16, v20
    v_lshl_or_b32 v21, v25, 16, v21
    v_dot2_u32_u16 v22, v18, s38, 0
    v_dot2_u32_u16 v23, v19, s38, 0
    v_dot2_u32_u16 v24, v20, s38, 0
    v_dot2_u32_u16 v25, v21, s38, 0
    v_mad_i32_i24 v72, v18, s37, v72
    v_mad_i32_i24 v73, v19, s37, v73
    v_mad_i32_i24 v76, v20, s37, v76
    v_mad_i32_i24 v77, v21, s37, v77
    ds_add_u32 v22, v4 offset:0
    ds_add_u32 v23, v4 offset:0
    ds_add_u32 v24, v4 offset:0
    ds_add_u32 v25, v4 offset:0
    v_lshlrev_b32 v18, 16, v26
    v_lshlrev_b32 v20, 16, v27
    v_and_b32 v19, 0xffff0000, v26
    v_and_b32 v21, 0xffff0000, v27
    v_mul_f32 v18, v16, v18
    v_mul_f32 v19, v16, v19
    v_mul_f32 v20, v16, v20
    v_mul_f32 v21, v16, v21
    v_fract_f32 v18, v18
    v_fract_f32 v19, v19
    v_fract_f32 v20, v20
    v_fract_f32 v21, v21
    v_cos_f32 v18, v18
    v_cos_f32 v19, v19
    v_cos_f32 v20, v20
    v_cos_f32 v21, v21
    v_cvt_pk_bf16_f32 v18, 0, v18
    v_cvt_pk_bf16_f32 v19, 0, v19
    v_cvt_pk_bf16_f32 v20, 0, v20
    v_cvt_pk_bf16_f32 v21, 0, v21
    v_or_b32 v74, v18, v22
    v_or_b32 v75, v19, v23
    v_or_b32 v78, v20, v24
    v_or_b32 v79, v21, v25
    v_or3_b32 v5, v74, v75, v5
    v_or3_b32 v5, v78, v79, v5
    s_add_u32 s35, s33, 98304
    buffer_load_dwordx4 v[18:21], v1, s[8:11], s35 offen nt
    s_add_u32 s35, s33, 98304
    buffer_load_dwordx4 v[22:25], v1, s[12:15], s35 offen nt
    s_add_u32 s35, s34, 49152
    buffer_load_dwordx2 v[26:27], v2, s[16:19], s35 offen nt
    s_mov_b32 s36, 98304
    buffer_store_dwordx3 v[80:82], v3, s[20:23], s36 offen sc1
    s_mov_b32 s36, 110592
    buffer_store_dwordx3 v[84:86], v3, s[20:23], s36 offen sc1
    s_waitcnt vmcnt(12)
    s_nop 0
    v_lshl_add_u32 v80, v32, 16, v28
    v_lshl_add_u32 v81, v33, 16, v29
    v_lshl_add_u32 v84, v34, 16, v30
    v_lshl_add_u32 v85, v35, 16, v31
    v_mul_hi_u32_u24 v28, 429497, v28
    v_mul_hi_u32_u24 v32, 429497, v32
    v_mul_hi_u32_u24 v29, 429497, v29
    v_mul_hi_u32_u24 v33, 429497, v33
    v_mul_hi_u32_u24 v30, 429497, v30
    v_mul_hi_u32_u24 v34, 429497, v34
    v_mul_hi_u32_u24 v31, 429497, v31
    v_mul_hi_u32_u24 v35, 429497, v35
    v_lshl_or_b32 v28, v32, 16, v28
    v_lshl_or_b32 v29, v33, 16, v29
    v_lshl_or_b32 v30, v34, 16, v30
    v_lshl_or_b32 v31, v35, 16, v31
    v_dot2_u32_u16 v32, v28, s38, 0
    v_dot2_u32_u16 v33, v29, s38, 0
    v_dot2_u32_u16 v34, v30, s38, 0
    v_dot2_u32_u16 v35, v31, s38, 0
    v_mad_i32_i24 v80, v28, s37, v80
    v_mad_i32_i24 v81, v29, s37, v81
    v_mad_i32_i24 v84, v30, s37, v84
    v_mad_i32_i24 v85, v31, s37, v85
    ds_add_u32 v32, v4 offset:0
    ds_add_u32 v33, v4 offset:0
    ds_add_u32 v34, v4 offset:0
    ds_add_u32 v35, v4 offset:0
    v_lshlrev_b32 v28, 16, v36
    v_lshlrev_b32 v30, 16, v37
    v_and_b32 v29, 0xffff0000, v36
    v_and_b32 v31, 0xffff0000, v37
    v_mul_f32 v28, v16, v28
    v_mul_f32 v29, v16, v29
    v_mul_f32 v30, v16, v30
    v_mul_f32 v31, v16, v31
    v_fract_f32 v28, v28
    v_fract_f32 v29, v29
    v_fract_f32 v30, v30
    v_fract_f32 v31, v31
    v_cos_f32 v28, v28
    v_cos_f32 v29, v29
    v_cos_f32 v30, v30
    v_cos_f32 v31, v31
    v_cvt_pk_bf16_f32 v28, 0, v28
    v_cvt_pk_bf16_f32 v29, 0, v29
    v_cvt_pk_bf16_f32 v30, 0, v30
    v_cvt_pk_bf16_f32 v31, 0, v31
    v_or_b32 v82, v28, v32
    v_or_b32 v83, v29, v33
    v_or_b32 v86, v30, v34
    v_or_b32 v87, v31, v35
    v_or3_b32 v5, v82, v83, v5
    v_or3_b32 v5, v86, v87, v5
    s_add_u32 s35, s33, 114688
    buffer_load_dwordx4 v[28:31], v1, s[8:11], s35 offen nt
    s_add_u32 s35, s33, 114688
    buffer_load_dwordx4 v[32:35], v1, s[12:15], s35 offen nt
    s_add_u32 s35, s34, 57344
    buffer_load_dwordx2 v[36:37], v2, s[16:19], s35 offen nt
    s_mov_b32 s36, 122880
    buffer_store_dwordx3 v[88:90], v3, s[20:23], s36 offen sc1
    s_mov_b32 s36, 135168
    buffer_store_dwordx3 v[92:94], v3, s[20:23], s36 offen sc1
    s_waitcnt vmcnt(12)
    s_nop 0
    v_lshl_add_u32 v88, v42, 16, v38
    v_lshl_add_u32 v89, v43, 16, v39
    v_lshl_add_u32 v92, v44, 16, v40
    v_lshl_add_u32 v93, v45, 16, v41
    v_mul_hi_u32_u24 v38, 429497, v38
    v_mul_hi_u32_u24 v42, 429497, v42
    v_mul_hi_u32_u24 v39, 429497, v39
    v_mul_hi_u32_u24 v43, 429497, v43
    v_mul_hi_u32_u24 v40, 429497, v40
    v_mul_hi_u32_u24 v44, 429497, v44
    v_mul_hi_u32_u24 v41, 429497, v41
    v_mul_hi_u32_u24 v45, 429497, v45
    v_lshl_or_b32 v38, v42, 16, v38
    v_lshl_or_b32 v39, v43, 16, v39
    v_lshl_or_b32 v40, v44, 16, v40
    v_lshl_or_b32 v41, v45, 16, v41
    v_dot2_u32_u16 v42, v38, s38, 0
    v_dot2_u32_u16 v43, v39, s38, 0
    v_dot2_u32_u16 v44, v40, s38, 0
    v_dot2_u32_u16 v45, v41, s38, 0
    v_mad_i32_i24 v88, v38, s37, v88
    v_mad_i32_i24 v89, v39, s37, v89
    v_mad_i32_i24 v92, v40, s37, v92
    v_mad_i32_i24 v93, v41, s37, v93
    ds_add_u32 v42, v4 offset:0
    ds_add_u32 v43, v4 offset:0
    ds_add_u32 v44, v4 offset:0
    ds_add_u32 v45, v4 offset:0
    v_lshlrev_b32 v38, 16, v46
    v_lshlrev_b32 v40, 16, v47
    v_and_b32 v39, 0xffff0000, v46
    v_and_b32 v41, 0xffff0000, v47
    v_mul_f32 v38, v16, v38
    v_mul_f32 v39, v16, v39
    v_mul_f32 v40, v16, v40
    v_mul_f32 v41, v16, v41
    v_fract_f32 v38, v38
    v_fract_f32 v39, v39
    v_fract_f32 v40, v40
    v_fract_f32 v41, v41
    v_cos_f32 v38, v38
    v_cos_f32 v39, v39
    v_cos_f32 v40, v40
    v_cos_f32 v41, v41
    v_cvt_pk_bf16_f32 v38, 0, v38
    v_cvt_pk_bf16_f32 v39, 0, v39
    v_cvt_pk_bf16_f32 v40, 0, v40
    v_cvt_pk_bf16_f32 v41, 0, v41
    v_or_b32 v90, v38, v42
    v_or_b32 v91, v39, v43
    v_or_b32 v94, v40, v44
    v_or_b32 v95, v41, v45
    v_or3_b32 v5, v90, v91, v5
    v_or3_b32 v5, v94, v95, v5
    s_add_u32 s35, s33, 131072
    buffer_load_dwordx4 v[38:41], v1, s[8:11], s35 offen nt
    s_add_u32 s35, s33, 131072
    buffer_load_dwordx4 v[42:45], v1, s[12:15], s35 offen nt
    s_add_u32 s35, s34, 65536
    buffer_load_dwordx2 v[46:47], v2, s[16:19], s35 offen nt
    s_mov_b32 s36, 147456
    buffer_store_dwordx3 v[96:98], v3, s[20:23], s36 offen sc1
    s_mov_b32 s36, 159744
    buffer_store_dwordx3 v[100:102], v3, s[20:23], s36 offen sc1
    s_waitcnt vmcnt(12)
    s_nop 0
    v_lshl_add_u32 v96, v22, 16, v18
    v_lshl_add_u32 v97, v23, 16, v19
    v_lshl_add_u32 v100, v24, 16, v20
    v_lshl_add_u32 v101, v25, 16, v21
    v_mul_hi_u32_u24 v18, 429497, v18
    v_mul_hi_u32_u24 v22, 429497, v22
    v_mul_hi_u32_u24 v19, 429497, v19
    v_mul_hi_u32_u24 v23, 429497, v23
    v_mul_hi_u32_u24 v20, 429497, v20
    v_mul_hi_u32_u24 v24, 429497, v24
    v_mul_hi_u32_u24 v21, 429497, v21
    v_mul_hi_u32_u24 v25, 429497, v25
    v_lshl_or_b32 v18, v22, 16, v18
    v_lshl_or_b32 v19, v23, 16, v19
    v_lshl_or_b32 v20, v24, 16, v20
    v_lshl_or_b32 v21, v25, 16, v21
    v_dot2_u32_u16 v22, v18, s38, 0
    v_dot2_u32_u16 v23, v19, s38, 0
    v_dot2_u32_u16 v24, v20, s38, 0
    v_dot2_u32_u16 v25, v21, s38, 0
    v_mad_i32_i24 v96, v18, s37, v96
    v_mad_i32_i24 v97, v19, s37, v97
    v_mad_i32_i24 v100, v20, s37, v100
    v_mad_i32_i24 v101, v21, s37, v101
    ds_add_u32 v22, v4 offset:0
    ds_add_u32 v23, v4 offset:0
    ds_add_u32 v24, v4 offset:0
    ds_add_u32 v25, v4 offset:0
    v_lshlrev_b32 v18, 16, v26
    v_lshlrev_b32 v20, 16, v27
    v_and_b32 v19, 0xffff0000, v26
    v_and_b32 v21, 0xffff0000, v27
    v_mul_f32 v18, v16, v18
    v_mul_f32 v19, v16, v19
    v_mul_f32 v20, v16, v20
    v_mul_f32 v21, v16, v21
    v_fract_f32 v18, v18
    v_fract_f32 v19, v19
    v_fract_f32 v20, v20
    v_fract_f32 v21, v21
    v_cos_f32 v18, v18
    v_cos_f32 v19, v19
    v_cos_f32 v20, v20
    v_cos_f32 v21, v21
    v_cvt_pk_bf16_f32 v18, 0, v18
    v_cvt_pk_bf16_f32 v19, 0, v19
    v_cvt_pk_bf16_f32 v20, 0, v20
    v_cvt_pk_bf16_f32 v21, 0, v21
    v_or_b32 v98, v18, v22
    v_or_b32 v99, v19, v23
    v_or_b32 v102, v20, v24
    v_or_b32 v103, v21, v25
    v_or3_b32 v5, v98, v99, v5
    v_or3_b32 v5, v102, v103, v5
    s_mov_b32 s36, 172032
    buffer_store_dwordx3 v[104:106], v3, s[20:23], s36 offen sc1
    s_mov_b32 s36, 184320
    buffer_store_dwordx3 v[108:110], v3, s[20:23], s36 offen sc1
    s_waitcnt vmcnt(9)
    s_nop 0
    v_lshl_add_u32 v104, v32, 16, v28
    v_lshl_add_u32 v105, v33, 16, v29
    v_lshl_add_u32 v108, v34, 16, v30
    v_lshl_add_u32 v109, v35, 16, v31
    v_mul_hi_u32_u24 v28, 429497, v28
    v_mul_hi_u32_u24 v32, 429497, v32
    v_mul_hi_u32_u24 v29, 429497, v29
    v_mul_hi_u32_u24 v33, 429497, v33
    v_mul_hi_u32_u24 v30, 429497, v30
    v_mul_hi_u32_u24 v34, 429497, v34
    v_mul_hi_u32_u24 v31, 429497, v31
    v_mul_hi_u32_u24 v35, 429497, v35
    v_lshl_or_b32 v28, v32, 16, v28
    v_lshl_or_b32 v29, v33, 16, v29
    v_lshl_or_b32 v30, v34, 16, v30
    v_lshl_or_b32 v31, v35, 16, v31
    v_dot2_u32_u16 v32, v28, s38, 0
    v_dot2_u32_u16 v33, v29, s38, 0
    v_dot2_u32_u16 v34, v30, s38, 0
    v_dot2_u32_u16 v35, v31, s38, 0
    v_mad_i32_i24 v104, v28, s37, v104
    v_mad_i32_i24 v105, v29, s37, v105
    v_mad_i32_i24 v108, v30, s37, v108
    v_mad_i32_i24 v109, v31, s37, v109
    ds_add_u32 v32, v4 offset:0
    ds_add_u32 v33, v4 offset:0
    ds_add_u32 v34, v4 offset:0
    ds_add_u32 v35, v4 offset:0
    v_lshlrev_b32 v28, 16, v36
    v_lshlrev_b32 v30, 16, v37
    v_and_b32 v29, 0xffff0000, v36
    v_and_b32 v31, 0xffff0000, v37
    v_mul_f32 v28, v16, v28
    v_mul_f32 v29, v16, v29
    v_mul_f32 v30, v16, v30
    v_mul_f32 v31, v16, v31
    v_fract_f32 v28, v28
    v_fract_f32 v29, v29
    v_fract_f32 v30, v30
    v_fract_f32 v31, v31
    v_cos_f32 v28, v28
    v_cos_f32 v29, v29
    v_cos_f32 v30, v30
    v_cos_f32 v31, v31
    v_cvt_pk_bf16_f32 v28, 0, v28
    v_cvt_pk_bf16_f32 v29, 0, v29
    v_cvt_pk_bf16_f32 v30, 0, v30
    v_cvt_pk_bf16_f32 v31, 0, v31
    v_or_b32 v106, v28, v32
    v_or_b32 v107, v29, v33
    v_or_b32 v110, v30, v34
    v_or_b32 v111, v31, v35
    v_or3_b32 v5, v106, v107, v5
    v_or3_b32 v5, v110, v111, v5
    s_mov_b32 s36, 196608
    buffer_store_dwordx3 v[112:114], v3, s[20:23], s36 offen sc1
    s_mov_b32 s36, 208896
    buffer_store_dwordx3 v[116:118], v3, s[20:23], s36 offen sc1
    s_waitcnt vmcnt(6)
    s_nop 0
    v_lshl_add_u32 v112, v42, 16, v38
    v_lshl_add_u32 v113, v43, 16, v39
    v_lshl_add_u32 v116, v44, 16, v40
    v_lshl_add_u32 v117, v45, 16, v41
    v_mul_hi_u32_u24 v38, 429497, v38
    v_mul_hi_u32_u24 v42, 429497, v42
    v_mul_hi_u32_u24 v39, 429497, v39
    v_mul_hi_u32_u24 v43, 429497, v43
    v_mul_hi_u32_u24 v40, 429497, v40
    v_mul_hi_u32_u24 v44, 429497, v44
    v_mul_hi_u32_u24 v41, 429497, v41
    v_mul_hi_u32_u24 v45, 429497, v45
    v_lshl_or_b32 v38, v42, 16, v38
    v_lshl_or_b32 v39, v43, 16, v39
    v_lshl_or_b32 v40, v44, 16, v40
    v_lshl_or_b32 v41, v45, 16, v41
    v_dot2_u32_u16 v42, v38, s38, 0
    v_dot2_u32_u16 v43, v39, s38, 0
    v_dot2_u32_u16 v44, v40, s38, 0
    v_dot2_u32_u16 v45, v41, s38, 0
    v_mad_i32_i24 v112, v38, s37, v112
    v_mad_i32_i24 v113, v39, s37, v113
    v_mad_i32_i24 v116, v40, s37, v116
    v_mad_i32_i24 v117, v41, s37, v117
    ds_add_u32 v42, v4 offset:0
    ds_add_u32 v43, v4 offset:0
    ds_add_u32 v44, v4 offset:0
    ds_add_u32 v45, v4 offset:0
    v_lshlrev_b32 v38, 16, v46
    v_lshlrev_b32 v40, 16, v47
    v_and_b32 v39, 0xffff0000, v46
    v_and_b32 v41, 0xffff0000, v47
    v_mul_f32 v38, v16, v38
    v_mul_f32 v39, v16, v39
    v_mul_f32 v40, v16, v40
    v_mul_f32 v41, v16, v41
    v_fract_f32 v38, v38
    v_fract_f32 v39, v39
    v_fract_f32 v40, v40
    v_fract_f32 v41, v41
    v_cos_f32 v38, v38
    v_cos_f32 v39, v39
    v_cos_f32 v40, v40
    v_cos_f32 v41, v41
    v_cvt_pk_bf16_f32 v38, 0, v38
    v_cvt_pk_bf16_f32 v39, 0, v39
    v_cvt_pk_bf16_f32 v40, 0, v40
    v_cvt_pk_bf16_f32 v41, 0, v41
    v_or_b32 v114, v38, v42
    v_or_b32 v115, v39, v43
    v_or_b32 v118, v40, v44
    v_or_b32 v119, v41, v45
    v_or3_b32 v5, v114, v115, v5
    v_or3_b32 v5, v118, v119, v5
    s_mov_b64 exec, s[44:45]
    v_lshl_add_u32 v8, v124, 16, v120
    v_lshl_add_u32 v9, v125, 16, v121
    v_lshl_add_u32 v10, v126, 16, v122
    v_lshl_add_u32 v11, v127, 16, v123
    v_mul_hi_u32_u24 v120, 429497, v120
    v_mul_hi_u32_u24 v124, 429497, v124
    v_mul_hi_u32_u24 v121, 429497, v121
    v_mul_hi_u32_u24 v125, 429497, v125
    v_mul_hi_u32_u24 v122, 429497, v122
    v_mul_hi_u32_u24 v126, 429497, v126
    v_mul_hi_u32_u24 v123, 429497, v123
    v_mul_hi_u32_u24 v127, 429497, v127
    v_lshl_or_b32 v120, v124, 16, v120
    v_lshl_or_b32 v121, v125, 16, v121
    v_lshl_or_b32 v122, v126, 16, v122
    v_lshl_or_b32 v123, v127, 16, v123
    v_dot2_u32_u16 v124, v120, s38, 0
    v_dot2_u32_u16 v125, v121, s38, 0
    v_dot2_u32_u16 v126, v122, s38, 0
    v_dot2_u32_u16 v127, v123, s38, 0
    v_mad_i32_i24 v8, v120, s37, v8
    v_mad_i32_i24 v9, v121, s37, v9
    v_mad_i32_i24 v10, v122, s37, v10
    v_mad_i32_i24 v11, v123, s37, v11
    ds_add_u32 v124, v4 offset:0
    ds_add_u32 v125, v4 offset:0
    ds_add_u32 v126, v4 offset:0
    ds_add_u32 v127, v4 offset:0
    v_lshlrev_b32 v120, 16, v6
    v_lshlrev_b32 v122, 16, v7
    v_and_b32 v121, 0xffff0000, v6
    v_and_b32 v123, 0xffff0000, v7
    v_mul_f32 v120, v16, v120
    v_mul_f32 v121, v16, v121
    v_mul_f32 v122, v16, v122
    v_mul_f32 v123, v16, v123
    v_fract_f32 v120, v120
    v_fract_f32 v121, v121
    v_fract_f32 v122, v122
    v_fract_f32 v123, v123
    v_cos_f32 v120, v120
    v_cos_f32 v121, v121
    v_cos_f32 v122, v122
    v_cos_f32 v123, v123
    v_cvt_pk_bf16_f32 v120, 0, v120
    v_cvt_pk_bf16_f32 v121, 0, v121
    v_cvt_pk_bf16_f32 v122, 0, v122
    v_cvt_pk_bf16_f32 v123, 0, v123
    v_or_b32 v122, v122, v126
    v_or_b32 v123, v123, v127
    v_or_b32 v126, v120, v124
    v_or_b32 v127, v121, v125
    v_or3_b32 v5, v126, v127, v5
    v_or3_b32 v5, v122, v123, v5
    v_mov_b32 v120, v10
    v_mov_b32 v121, v11
    v_mov_b32 v124, v8
    v_mov_b32 v125, v9
    s_mov_b64 exec, -1
    s_and_b32 s35, s32, 15
    s_lshl_b32 s35, s35, 6
    s_lshr_b32 s36, s32, 4
    s_add_u32 s35, s35, s36
    s_mul_i32 s42, s35, 8320
    s_mul_i32 s35, s35, 240000
    s_add_u32 s35, s35, 8192
    s_add_u32 s20, s4, s35
    s_addc_u32 s21, s5, 0
    s_mov_b32 s22, 240000
    s_waitcnt lgkmcnt(0)
    s_barrier
    ds_read_b128 v[8:11], v1 offset:0
    s_add_u32 s35, s33, 40960000
    buffer_load_dwordx4 v[18:21], v1, s[8:11], s35 offen nt
    s_lshl_b32 s35, s39, 2
    s_add_u32 s35, s35, 160000
    v_mov_b32 v7, s35
    v_and_b32 v14, 15, v0
    v_lshlrev_b32 v14, 2, v14
    v_add_u32 v14, 160000, v14
    s_waitcnt lgkmcnt(0)
    v_add_u32 v9, v8, v9
    v_add_u32 v10, v9, v10
    v_add_u32 v11, v10, v11
    v_mov_b32 v6, v11
    s_nop 1
    v_add_u32_dpp v6, v6, v6 row_shr:1 row_mask:0xf bank_mask:0xf bound_ctrl:0
    s_nop 1
    v_add_u32_dpp v6, v6, v6 row_shr:2 row_mask:0xf bank_mask:0xf bound_ctrl:0
    s_nop 1
    v_add_u32_dpp v6, v6, v6 row_shr:4 row_mask:0xf bank_mask:0xf bound_ctrl:0
    s_nop 1
    v_add_u32_dpp v6, v6, v6 row_shr:8 row_mask:0xf bank_mask:0xf bound_ctrl:0
    s_nop 1
    v_add_u32_dpp v6, v6, v6 row_bcast:15 row_mask:0xa bank_mask:0xf
    s_nop 1
    v_add_u32_dpp v6, v6, v6 row_bcast:31 row_mask:0xc bank_mask:0xf
    s_mov_b32 exec_lo, 0
    s_brev_b32 exec_hi, 1
    ds_write_b32 v7, v6
    s_mov_b64 exec, -1
    v_sub_u32 v6, v6, v11
    s_waitcnt lgkmcnt(0)
    s_barrier
    ds_read_b32 v7, v14
    s_waitcnt lgkmcnt(0)
    v_mov_b32 v15, v7
    s_nop 1
    v_add_u32_dpp v7, v7, v7 row_shr:1 row_mask:0xf bank_mask:0xf bound_ctrl:0
    s_nop 1
    v_add_u32_dpp v7, v7, v7 row_shr:2 row_mask:0xf bank_mask:0xf bound_ctrl:0
    s_nop 1
    v_add_u32_dpp v7, v7, v7 row_shr:4 row_mask:0xf bank_mask:0xf bound_ctrl:0
    s_nop 1
    v_add_u32_dpp v7, v7, v7 row_shr:8 row_mask:0xf bank_mask:0xf bound_ctrl:0
    v_sub_u32 v7, v7, v15
    s_nop 0
    v_readlane_b32 s35, v7, s39
    s_nop 1
    v_add_u32 v12, s35, v6
    v_add_u32 v13, v12, v8
    v_add_u32 v14, v12, v9
    v_add_u32 v15, v12, v10
    ds_write_b128 v1, v[12:15] offset:0
    ds_write_b128 v1, v[12:15] offset:16384
    v_mov_b32 v6, 32768
    v_mov_b32 v7, 40000
    s_mov_b64 exec, 1
    ds_write_b32 v6, v7
    s_mov_b64 exec, -1
    s_waitcnt lgkmcnt(0)
    s_barrier
    s_add_u32 s35, s33, 40960000
    buffer_load_dwordx4 v[22:25], v1, s[12:15], s35 offen nt
    v_and_b32 v6, 63, v0
    s_lshl_b32 s35, s39, 10
    v_lshl_add_u32 v7, v6, 2, s35
    v_lshl_add_u32 v12, v6, 8, s35
    ds_read_b32 v8, v7 offset:16384
    ds_read_b32 v9, v7 offset:16640
    ds_read_b32 v10, v7 offset:16896
    ds_read_b32 v11, v7 offset:17152
    s_mov_b64 exec, 15
    ds_read_b32 v12, v12 offset:16640
    s_mov_b64 exec, -1
    s_lshr_b32 s35, s39, 2
    s_mul_i32 s35, s35, 2080
    s_and_b32 s36, s39, 3
    s_lshl_b32 s36, s36, 3
    s_add_u32 s35, s35, s36
    v_lshl_add_u32 v7, v6, 5, s35
    v_lshl_add_u32 v13, v6, 1, s35
    s_waitcnt lgkmcnt(1)
    v_perm_b32 v8, v9, v8, s43
    v_perm_b32 v9, v11, v10, s43
    buffer_store_dwordx2 v[8:9], v7, s[24:27], s42 offen
    s_waitcnt lgkmcnt(0)
    s_mov_b64 exec, 15
    buffer_store_short v12, v13, s[24:27], s42 offen offset:2048
    s_mov_b64 exec, -1
    s_nop 0
    v_and_b32 v6, 0xffff, v50
    v_and_b32 v7, 0xffff, v51
    v_and_b32 v8, 0xffff, v54
    v_and_b32 v9, 0xffff, v55
    v_and_b32 v10, 0xffff, v58
    ds_add_rtn_u32 v6, v6, v4 offset:0
    ds_add_rtn_u32 v7, v7, v4 offset:0
    ds_add_rtn_u32 v8, v8, v4 offset:0
    ds_add_rtn_u32 v9, v9, v4 offset:0
    ds_add_rtn_u32 v10, v10, v4 offset:0
    v_and_b32 v11, 0xffff, v59
    v_and_b32 v12, 0xffff, v62
    v_and_b32 v13, 0xffff, v63
    v_and_b32 v14, 0xffff, v66
    v_and_b32 v15, 0xffff, v67
    ds_add_rtn_u32 v11, v11, v4 offset:0
    ds_add_rtn_u32 v12, v12, v4 offset:0
    ds_add_rtn_u32 v13, v13, v4 offset:0
    ds_add_rtn_u32 v14, v14, v4 offset:0
    ds_add_rtn_u32 v15, v15, v4 offset:0
    s_waitcnt lgkmcnt(5)
    v_bfi_b32 v50, s41, v6, v50
    v_bfi_b32 v51, s41, v7, v51
    v_bfi_b32 v54, s41, v8, v54
    v_bfi_b32 v55, s41, v9, v55
    v_bfi_b32 v58, s41, v10, v58
    v_and_b32 v6, 0xffff, v70
    v_and_b32 v7, 0xffff, v71
    v_and_b32 v8, 0xffff, v74
    v_and_b32 v9, 0xffff, v75
    v_and_b32 v10, 0xffff, v78
    ds_add_rtn_u32 v6, v6, v4 offset:0
    ds_add_rtn_u32 v7, v7, v4 offset:0
    ds_add_rtn_u32 v8, v8, v4 offset:0
    ds_add_rtn_u32 v9, v9, v4 offset:0
    ds_add_rtn_u32 v10, v10, v4 offset:0
    s_waitcnt lgkmcnt(5)
    v_bfi_b32 v59, s41, v11, v59
    v_bfi_b32 v62, s41, v12, v62
    v_bfi_b32 v63, s41, v13, v63
    v_bfi_b32 v66, s41, v14, v66
    v_bfi_b32 v67, s41, v15, v67
    v_and_b32 v11, 0xffff, v79
    v_and_b32 v12, 0xffff, v82
    v_and_b32 v13, 0xffff, v83
    v_and_b32 v14, 0xffff, v86
    v_and_b32 v15, 0xffff, v87
    ds_add_rtn_u32 v11, v11, v4 offset:0
    ds_add_rtn_u32 v12, v12, v4 offset:0
    ds_add_rtn_u32 v13, v13, v4 offset:0
    ds_add_rtn_u32 v14, v14, v4 offset:0
    ds_add_rtn_u32 v15, v15, v4 offset:0
    s_waitcnt lgkmcnt(5)
    v_bfi_b32 v70, s41, v6, v70
    v_bfi_b32 v71, s41, v7, v71
    v_bfi_b32 v74, s41, v8, v74
    v_bfi_b32 v75, s41, v9, v75
    v_bfi_b32 v78, s41, v10, v78
    s_add_u32 s35, s34, 20480000
    buffer_load_dwordx2 v[26:27], v2, s[16:19], s35 offen nt
    v_and_b32 v6, 0xffff, v90
    v_and_b32 v7, 0xffff, v91
    v_and_b32 v8, 0xffff, v94
    v_and_b32 v9, 0xffff, v95
    v_and_b32 v10, 0xffff, v98
    ds_add_rtn_u32 v6, v6, v4 offset:0
    ds_add_rtn_u32 v7, v7, v4 offset:0
    ds_add_rtn_u32 v8, v8, v4 offset:0
    ds_add_rtn_u32 v9, v9, v4 offset:0
    ds_add_rtn_u32 v10, v10, v4 offset:0
    s_waitcnt lgkmcnt(5)
    v_bfi_b32 v79, s41, v11, v79
    v_bfi_b32 v82, s41, v12, v82
    v_bfi_b32 v83, s41, v13, v83
    v_bfi_b32 v86, s41, v14, v86
    v_bfi_b32 v87, s41, v15, v87
    v_and_b32 v11, 0xffff, v99
    v_and_b32 v12, 0xffff, v102
    v_and_b32 v13, 0xffff, v103
    v_and_b32 v14, 0xffff, v106
    v_and_b32 v15, 0xffff, v107
    ds_add_rtn_u32 v11, v11, v4 offset:0
    ds_add_rtn_u32 v12, v12, v4 offset:0
    ds_add_rtn_u32 v13, v13, v4 offset:0
    ds_add_rtn_u32 v14, v14, v4 offset:0
    ds_add_rtn_u32 v15, v15, v4 offset:0
    s_waitcnt lgkmcnt(5)
    v_bfi_b32 v90, s41, v6, v90
    v_bfi_b32 v91, s41, v7, v91
    v_bfi_b32 v94, s41, v8, v94
    v_bfi_b32 v95, s41, v9, v95
    v_bfi_b32 v98, s41, v10, v98
    v_and_b32 v6, 0xffff, v110
    v_and_b32 v7, 0xffff, v111
    v_and_b32 v8, 0xffff, v114
    v_and_b32 v9, 0xffff, v115
    v_and_b32 v10, 0xffff, v118
    ds_add_rtn_u32 v6, v6, v4 offset:0
    ds_add_rtn_u32 v7, v7, v4 offset:0
    ds_add_rtn_u32 v8, v8, v4 offset:0
    ds_add_rtn_u32 v9, v9, v4 offset:0
    ds_add_rtn_u32 v10, v10, v4 offset:0
    s_waitcnt lgkmcnt(5)
    v_bfi_b32 v99, s41, v11, v99
    v_bfi_b32 v102, s41, v12, v102
    v_bfi_b32 v103, s41, v13, v103
    v_bfi_b32 v106, s41, v14, v106
    v_bfi_b32 v107, s41, v15, v107
    s_add_u32 s35, s33, 40976384
    buffer_load_dwordx4 v[28:31], v1, s[8:11], s35 offen nt
    v_and_b32 v11, 0xffff, v119
    ds_add_rtn_u32 v11, v11, v4 offset:0
    s_waitcnt lgkmcnt(1)
    v_bfi_b32 v110, s41, v6, v110
    v_bfi_b32 v111, s41, v7, v111
    v_bfi_b32 v114, s41, v8, v114
    v_bfi_b32 v115, s41, v9, v115
    v_bfi_b32 v118, s41, v10, v118
    s_mov_b64 exec, s[44:45]
    v_and_b32 v6, 0xffff, v122
    v_and_b32 v7, 0xffff, v123
    v_and_b32 v8, 0xffff, v126
    v_and_b32 v9, 0xffff, v127
    ds_add_rtn_u32 v6, v6, v4 offset:0
    ds_add_rtn_u32 v7, v7, v4 offset:0
    ds_add_rtn_u32 v8, v8, v4 offset:0
    ds_add_rtn_u32 v9, v9, v4 offset:0
    s_mov_b64 exec, -1
    s_waitcnt lgkmcnt(4)
    v_bfi_b32 v119, s41, v11, v119
    s_waitcnt lgkmcnt(0)
    v_bfi_b32 v122, s41, v6, v122
    v_bfi_b32 v123, s41, v7, v123
    v_bfi_b32 v126, s41, v8, v126
    v_bfi_b32 v127, s41, v9, v127
    s_barrier
    v_lshlrev_b32_sdwa v6, 2, v50 dst_sel:DWORD dst_unused:UNUSED_PAD src0_sel:DWORD src1_sel:WORD_0
    ds_write_b32 v6, v48 offset:0
    v_lshlrev_b32_sdwa v7, 2, v51 dst_sel:DWORD dst_unused:UNUSED_PAD src0_sel:DWORD src1_sel:WORD_0
    ds_write_b32 v7, v49 offset:0
    v_lshlrev_b32_sdwa v8, 2, v54 dst_sel:DWORD dst_unused:UNUSED_PAD src0_sel:DWORD src1_sel:WORD_0
    ds_write_b32 v8, v52 offset:0
    v_lshlrev_b32_sdwa v9, 2, v55 dst_sel:DWORD dst_unused:UNUSED_PAD src0_sel:DWORD src1_sel:WORD_0
    ds_write_b32 v9, v53 offset:0
    v_lshlrev_b32_sdwa v10, 2, v58 dst_sel:DWORD dst_unused:UNUSED_PAD src0_sel:DWORD src1_sel:WORD_0
    ds_write_b32 v10, v56 offset:0
    v_lshlrev_b32_sdwa v11, 2, v59 dst_sel:DWORD dst_unused:UNUSED_PAD src0_sel:DWORD src1_sel:WORD_0
    ds_write_b32 v11, v57 offset:0
    s_add_u32 s35, s33, 40976384
    buffer_load_dwordx4 v[32:35], v1, s[12:15], s35 offen nt
    v_lshlrev_b32_sdwa v12, 2, v62 dst_sel:DWORD dst_unused:UNUSED_PAD src0_sel:DWORD src1_sel:WORD_0
    ds_write_b32 v12, v60 offset:0
    v_lshlrev_b32_sdwa v13, 2, v63 dst_sel:DWORD dst_unused:UNUSED_PAD src0_sel:DWORD src1_sel:WORD_0
    ds_write_b32 v13, v61 offset:0
    v_lshlrev_b32_sdwa v6, 2, v66 dst_sel:DWORD dst_unused:UNUSED_PAD src0_sel:DWORD src1_sel:WORD_0
    ds_write_b32 v6, v64 offset:0
    v_lshlrev_b32_sdwa v7, 2, v67 dst_sel:DWORD dst_unused:UNUSED_PAD src0_sel:DWORD src1_sel:WORD_0
    ds_write_b32 v7, v65 offset:0
    v_lshlrev_b32_sdwa v8, 2, v70 dst_sel:DWORD dst_unused:UNUSED_PAD src0_sel:DWORD src1_sel:WORD_0
    ds_write_b32 v8, v68 offset:0
    v_lshlrev_b32_sdwa v9, 2, v71 dst_sel:DWORD dst_unused:UNUSED_PAD src0_sel:DWORD src1_sel:WORD_0
    ds_write_b32 v9, v69 offset:0
    v_lshlrev_b32_sdwa v10, 2, v74 dst_sel:DWORD dst_unused:UNUSED_PAD src0_sel:DWORD src1_sel:WORD_0
    ds_write_b32 v10, v72 offset:0
    v_lshlrev_b32_sdwa v11, 2, v75 dst_sel:DWORD dst_unused:UNUSED_PAD src0_sel:DWORD src1_sel:WORD_0
    ds_write_b32 v11, v73 offset:0
    v_lshlrev_b32_sdwa v12, 2, v78 dst_sel:DWORD dst_unused:UNUSED_PAD src0_sel:DWORD src1_sel:WORD_0
    ds_write_b32 v12, v76 offset:0
    v_lshlrev_b32_sdwa v13, 2, v79 dst_sel:DWORD dst_unused:UNUSED_PAD src0_sel:DWORD src1_sel:WORD_0
    ds_write_b32 v13, v77 offset:0
    v_lshlrev_b32_sdwa v6, 2, v82 dst_sel:DWORD dst_unused:UNUSED_PAD src0_sel:DWORD src1_sel:WORD_0
    ds_write_b32 v6, v80 offset:0
    v_lshlrev_b32_sdwa v7, 2, v83 dst_sel:DWORD dst_unused:UNUSED_PAD src0_sel:DWORD src1_sel:WORD_0
    ds_write_b32 v7, v81 offset:0
    v_lshlrev_b32_sdwa v8, 2, v86 dst_sel:DWORD dst_unused:UNUSED_PAD src0_sel:DWORD src1_sel:WORD_0
    ds_write_b32 v8, v84 offset:0
    v_lshlrev_b32_sdwa v9, 2, v87 dst_sel:DWORD dst_unused:UNUSED_PAD src0_sel:DWORD src1_sel:WORD_0
    ds_write_b32 v9, v85 offset:0
    v_lshlrev_b32_sdwa v10, 2, v90 dst_sel:DWORD dst_unused:UNUSED_PAD src0_sel:DWORD src1_sel:WORD_0
    ds_write_b32 v10, v88 offset:0
    v_lshlrev_b32_sdwa v11, 2, v91 dst_sel:DWORD dst_unused:UNUSED_PAD src0_sel:DWORD src1_sel:WORD_0
    ds_write_b32 v11, v89 offset:0
    v_lshlrev_b32_sdwa v12, 2, v94 dst_sel:DWORD dst_unused:UNUSED_PAD src0_sel:DWORD src1_sel:WORD_0
    ds_write_b32 v12, v92 offset:0
    s_add_u32 s35, s34, 20488192
    buffer_load_dwordx2 v[36:37], v2, s[16:19], s35 offen nt
    v_lshlrev_b32_sdwa v13, 2, v95 dst_sel:DWORD dst_unused:UNUSED_PAD src0_sel:DWORD src1_sel:WORD_0
    ds_write_b32 v13, v93 offset:0
    v_lshlrev_b32_sdwa v6, 2, v98 dst_sel:DWORD dst_unused:UNUSED_PAD src0_sel:DWORD src1_sel:WORD_0
    ds_write_b32 v6, v96 offset:0
    v_lshlrev_b32_sdwa v7, 2, v99 dst_sel:DWORD dst_unused:UNUSED_PAD src0_sel:DWORD src1_sel:WORD_0
    ds_write_b32 v7, v97 offset:0
    v_lshlrev_b32_sdwa v8, 2, v102 dst_sel:DWORD dst_unused:UNUSED_PAD src0_sel:DWORD src1_sel:WORD_0
    ds_write_b32 v8, v100 offset:0
    v_lshlrev_b32_sdwa v9, 2, v103 dst_sel:DWORD dst_unused:UNUSED_PAD src0_sel:DWORD src1_sel:WORD_0
    ds_write_b32 v9, v101 offset:0
    v_lshlrev_b32_sdwa v10, 2, v106 dst_sel:DWORD dst_unused:UNUSED_PAD src0_sel:DWORD src1_sel:WORD_0
    ds_write_b32 v10, v104 offset:0
    v_lshlrev_b32_sdwa v11, 2, v107 dst_sel:DWORD dst_unused:UNUSED_PAD src0_sel:DWORD src1_sel:WORD_0
    ds_write_b32 v11, v105 offset:0
    v_lshlrev_b32_sdwa v12, 2, v110 dst_sel:DWORD dst_unused:UNUSED_PAD src0_sel:DWORD src1_sel:WORD_0
    ds_write_b32 v12, v108 offset:0
    v_lshlrev_b32_sdwa v13, 2, v111 dst_sel:DWORD dst_unused:UNUSED_PAD src0_sel:DWORD src1_sel:WORD_0
    ds_write_b32 v13, v109 offset:0
    v_lshlrev_b32_sdwa v6, 2, v114 dst_sel:DWORD dst_unused:UNUSED_PAD src0_sel:DWORD src1_sel:WORD_0
    ds_write_b32 v6, v112 offset:0
    v_lshlrev_b32_sdwa v7, 2, v115 dst_sel:DWORD dst_unused:UNUSED_PAD src0_sel:DWORD src1_sel:WORD_0
    ds_write_b32 v7, v113 offset:0
    v_lshlrev_b32_sdwa v8, 2, v118 dst_sel:DWORD dst_unused:UNUSED_PAD src0_sel:DWORD src1_sel:WORD_0
    ds_write_b32 v8, v116 offset:0
    v_lshlrev_b32_sdwa v9, 2, v119 dst_sel:DWORD dst_unused:UNUSED_PAD src0_sel:DWORD src1_sel:WORD_0
    ds_write_b32 v9, v117 offset:0
    s_mov_b64 exec, s[44:45]
    v_lshlrev_b32_sdwa v10, 2, v122 dst_sel:DWORD dst_unused:UNUSED_PAD src0_sel:DWORD src1_sel:WORD_0
    ds_write_b32 v10, v120 offset:0
    v_lshlrev_b32_sdwa v11, 2, v123 dst_sel:DWORD dst_unused:UNUSED_PAD src0_sel:DWORD src1_sel:WORD_0
    ds_write_b32 v11, v121 offset:0
    v_lshlrev_b32_sdwa v12, 2, v126 dst_sel:DWORD dst_unused:UNUSED_PAD src0_sel:DWORD src1_sel:WORD_0
    ds_write_b32 v12, v124 offset:0
    v_lshlrev_b32_sdwa v13, 2, v127 dst_sel:DWORD dst_unused:UNUSED_PAD src0_sel:DWORD src1_sel:WORD_0
    ds_write_b32 v13, v125 offset:0
    s_mov_b64 exec, -1
    v_add_u32 v6, 65536, v2
    v_add_u32 v7, 131072, v2
    s_waitcnt lgkmcnt(0)
    s_barrier
    ds_read_b64 v[48:49], v2 offset:0
    ds_read_b64 v[52:53], v2 offset:8192
    ds_read_b64 v[56:57], v2 offset:16384
    ds_read_b64 v[60:61], v2 offset:24576
    ds_read_b64 v[64:65], v2 offset:32768
    ds_read_b64 v[68:69], v2 offset:40960
    ds_read_b64 v[72:73], v2 offset:49152
    ds_read_b64 v[76:77], v2 offset:57344
    ds_read_b64 v[80:81], v6 offset:0
    ds_read_b64 v[84:85], v6 offset:8192
    ds_read_b64 v[88:89], v6 offset:16384
    ds_read_b64 v[92:93], v6 offset:24576
    ds_read_b64 v[96:97], v6 offset:32768
    ds_read_b64 v[100:101], v6 offset:40960
    ds_read_b64 v[104:105], v6 offset:49152
    ds_read_b64 v[108:109], v6 offset:57344
    ds_read_b64 v[112:113], v7 offset:0
    ds_read_b64 v[116:117], v7 offset:8192
    ds_read_b64 v[120:121], v7 offset:16384
    ds_read_b64 v[124:125], v7 offset:24576
    s_add_u32 s35, s33, 40992768
    buffer_load_dwordx4 v[38:41], v1, s[8:11], s35 offen nt
    v_mov_b32 v12, 0
    v_mov_b32 v13, 0
    v_mov_b32 v14, 0
    v_mov_b32 v15, 0
    s_waitcnt lgkmcnt(0)
    s_barrier
    ds_write_b128 v1, v[12:15] offset:0
    v_lshlrev_b32_sdwa v6, 1, v50 dst_sel:DWORD dst_unused:UNUSED_PAD src0_sel:DWORD src1_sel:WORD_0
    ds_write_b16_d16_hi v6, v50 offset:16384
    v_lshlrev_b32_sdwa v7, 1, v51 dst_sel:DWORD dst_unused:UNUSED_PAD src0_sel:DWORD src1_sel:WORD_0
    ds_write_b16_d16_hi v7, v51 offset:16384
    v_lshlrev_b32_sdwa v8, 1, v54 dst_sel:DWORD dst_unused:UNUSED_PAD src0_sel:DWORD src1_sel:WORD_0
    ds_write_b16_d16_hi v8, v54 offset:16384
    v_lshlrev_b32_sdwa v9, 1, v55 dst_sel:DWORD dst_unused:UNUSED_PAD src0_sel:DWORD src1_sel:WORD_0
    ds_write_b16_d16_hi v9, v55 offset:16384
    v_lshlrev_b32_sdwa v10, 1, v58 dst_sel:DWORD dst_unused:UNUSED_PAD src0_sel:DWORD src1_sel:WORD_0
    ds_write_b16_d16_hi v10, v58 offset:16384
    v_lshlrev_b32_sdwa v11, 1, v59 dst_sel:DWORD dst_unused:UNUSED_PAD src0_sel:DWORD src1_sel:WORD_0
    ds_write_b16_d16_hi v11, v59 offset:16384
    s_add_u32 s35, s33, 40992768
    buffer_load_dwordx4 v[42:45], v1, s[12:15], s35 offen nt
    v_lshlrev_b32_sdwa v6, 1, v62 dst_sel:DWORD dst_unused:UNUSED_PAD src0_sel:DWORD src1_sel:WORD_0
    ds_write_b16_d16_hi v6, v62 offset:16384
    v_lshlrev_b32_sdwa v7, 1, v63 dst_sel:DWORD dst_unused:UNUSED_PAD src0_sel:DWORD src1_sel:WORD_0
    ds_write_b16_d16_hi v7, v63 offset:16384
    v_lshlrev_b32_sdwa v8, 1, v66 dst_sel:DWORD dst_unused:UNUSED_PAD src0_sel:DWORD src1_sel:WORD_0
    ds_write_b16_d16_hi v8, v66 offset:16384
    v_lshlrev_b32_sdwa v9, 1, v67 dst_sel:DWORD dst_unused:UNUSED_PAD src0_sel:DWORD src1_sel:WORD_0
    ds_write_b16_d16_hi v9, v67 offset:16384
    v_lshlrev_b32_sdwa v10, 1, v70 dst_sel:DWORD dst_unused:UNUSED_PAD src0_sel:DWORD src1_sel:WORD_0
    ds_write_b16_d16_hi v10, v70 offset:16384
    v_lshlrev_b32_sdwa v11, 1, v71 dst_sel:DWORD dst_unused:UNUSED_PAD src0_sel:DWORD src1_sel:WORD_0
    ds_write_b16_d16_hi v11, v71 offset:16384
    v_lshlrev_b32_sdwa v6, 1, v74 dst_sel:DWORD dst_unused:UNUSED_PAD src0_sel:DWORD src1_sel:WORD_0
    ds_write_b16_d16_hi v6, v74 offset:16384
    v_lshlrev_b32_sdwa v7, 1, v75 dst_sel:DWORD dst_unused:UNUSED_PAD src0_sel:DWORD src1_sel:WORD_0
    ds_write_b16_d16_hi v7, v75 offset:16384
    v_lshlrev_b32_sdwa v8, 1, v78 dst_sel:DWORD dst_unused:UNUSED_PAD src0_sel:DWORD src1_sel:WORD_0
    ds_write_b16_d16_hi v8, v78 offset:16384
    v_lshlrev_b32_sdwa v9, 1, v79 dst_sel:DWORD dst_unused:UNUSED_PAD src0_sel:DWORD src1_sel:WORD_0
    ds_write_b16_d16_hi v9, v79 offset:16384
    v_lshlrev_b32_sdwa v10, 1, v82 dst_sel:DWORD dst_unused:UNUSED_PAD src0_sel:DWORD src1_sel:WORD_0
    ds_write_b16_d16_hi v10, v82 offset:16384
    v_lshlrev_b32_sdwa v11, 1, v83 dst_sel:DWORD dst_unused:UNUSED_PAD src0_sel:DWORD src1_sel:WORD_0
    ds_write_b16_d16_hi v11, v83 offset:16384
    v_lshlrev_b32_sdwa v6, 1, v86 dst_sel:DWORD dst_unused:UNUSED_PAD src0_sel:DWORD src1_sel:WORD_0
    ds_write_b16_d16_hi v6, v86 offset:16384
    v_lshlrev_b32_sdwa v7, 1, v87 dst_sel:DWORD dst_unused:UNUSED_PAD src0_sel:DWORD src1_sel:WORD_0
    ds_write_b16_d16_hi v7, v87 offset:16384
    v_lshlrev_b32_sdwa v8, 1, v90 dst_sel:DWORD dst_unused:UNUSED_PAD src0_sel:DWORD src1_sel:WORD_0
    ds_write_b16_d16_hi v8, v90 offset:16384
    v_lshlrev_b32_sdwa v9, 1, v91 dst_sel:DWORD dst_unused:UNUSED_PAD src0_sel:DWORD src1_sel:WORD_0
    ds_write_b16_d16_hi v9, v91 offset:16384
    v_lshlrev_b32_sdwa v10, 1, v94 dst_sel:DWORD dst_unused:UNUSED_PAD src0_sel:DWORD src1_sel:WORD_0
    ds_write_b16_d16_hi v10, v94 offset:16384
    s_add_u32 s35, s34, 20496384
    buffer_load_dwordx2 v[46:47], v2, s[16:19], s35 offen nt
    v_lshlrev_b32_sdwa v11, 1, v95 dst_sel:DWORD dst_unused:UNUSED_PAD src0_sel:DWORD src1_sel:WORD_0
    ds_write_b16_d16_hi v11, v95 offset:16384
    v_lshlrev_b32_sdwa v6, 1, v98 dst_sel:DWORD dst_unused:UNUSED_PAD src0_sel:DWORD src1_sel:WORD_0
    ds_write_b16_d16_hi v6, v98 offset:16384
    v_lshlrev_b32_sdwa v7, 1, v99 dst_sel:DWORD dst_unused:UNUSED_PAD src0_sel:DWORD src1_sel:WORD_0
    ds_write_b16_d16_hi v7, v99 offset:16384
    v_lshlrev_b32_sdwa v8, 1, v102 dst_sel:DWORD dst_unused:UNUSED_PAD src0_sel:DWORD src1_sel:WORD_0
    ds_write_b16_d16_hi v8, v102 offset:16384
    v_lshlrev_b32_sdwa v9, 1, v103 dst_sel:DWORD dst_unused:UNUSED_PAD src0_sel:DWORD src1_sel:WORD_0
    ds_write_b16_d16_hi v9, v103 offset:16384
    v_lshlrev_b32_sdwa v10, 1, v106 dst_sel:DWORD dst_unused:UNUSED_PAD src0_sel:DWORD src1_sel:WORD_0
    ds_write_b16_d16_hi v10, v106 offset:16384
    v_lshlrev_b32_sdwa v11, 1, v107 dst_sel:DWORD dst_unused:UNUSED_PAD src0_sel:DWORD src1_sel:WORD_0
    ds_write_b16_d16_hi v11, v107 offset:16384
    v_lshlrev_b32_sdwa v6, 1, v110 dst_sel:DWORD dst_unused:UNUSED_PAD src0_sel:DWORD src1_sel:WORD_0
    ds_write_b16_d16_hi v6, v110 offset:16384
    v_lshlrev_b32_sdwa v7, 1, v111 dst_sel:DWORD dst_unused:UNUSED_PAD src0_sel:DWORD src1_sel:WORD_0
    ds_write_b16_d16_hi v7, v111 offset:16384
    v_lshlrev_b32_sdwa v8, 1, v114 dst_sel:DWORD dst_unused:UNUSED_PAD src0_sel:DWORD src1_sel:WORD_0
    ds_write_b16_d16_hi v8, v114 offset:16384
    v_lshlrev_b32_sdwa v9, 1, v115 dst_sel:DWORD dst_unused:UNUSED_PAD src0_sel:DWORD src1_sel:WORD_0
    ds_write_b16_d16_hi v9, v115 offset:16384
    v_lshlrev_b32_sdwa v10, 1, v118 dst_sel:DWORD dst_unused:UNUSED_PAD src0_sel:DWORD src1_sel:WORD_0
    ds_write_b16_d16_hi v10, v118 offset:16384
    v_lshlrev_b32_sdwa v11, 1, v119 dst_sel:DWORD dst_unused:UNUSED_PAD src0_sel:DWORD src1_sel:WORD_0
    ds_write_b16_d16_hi v11, v119 offset:16384
    s_mov_b64 exec, s[44:45]
    v_lshlrev_b32_sdwa v6, 1, v122 dst_sel:DWORD dst_unused:UNUSED_PAD src0_sel:DWORD src1_sel:WORD_0
    ds_write_b16_d16_hi v6, v122 offset:16384
    v_lshlrev_b32_sdwa v7, 1, v123 dst_sel:DWORD dst_unused:UNUSED_PAD src0_sel:DWORD src1_sel:WORD_0
    ds_write_b16_d16_hi v7, v123 offset:16384
    v_lshlrev_b32_sdwa v8, 1, v126 dst_sel:DWORD dst_unused:UNUSED_PAD src0_sel:DWORD src1_sel:WORD_0
    ds_write_b16_d16_hi v8, v126 offset:16384
    v_lshlrev_b32_sdwa v9, 1, v127 dst_sel:DWORD dst_unused:UNUSED_PAD src0_sel:DWORD src1_sel:WORD_0
    ds_write_b16_d16_hi v9, v127 offset:16384
    s_mov_b64 exec, -1
    v_lshlrev_b32 v6, 2, v0
    v_add_u32 v7, 40960, v6
    s_waitcnt lgkmcnt(0)
    s_barrier
    ds_read_b32 v122, v7 offset:49152
    ds_read_b32 v126, v7 offset:53248
    ds_read_b32 v50, v6 offset:16384
    ds_read_b32 v54, v6 offset:20480
    ds_read_b32 v58, v6 offset:24576
    ds_read_b32 v62, v6 offset:28672
    ds_read_b32 v66, v6 offset:32768
    ds_read_b32 v70, v6 offset:36864
    ds_read_b32 v74, v6 offset:40960
    ds_read_b32 v78, v6 offset:45056
    ds_read_b32 v82, v6 offset:49152
    ds_read_b32 v86, v6 offset:53248
    ds_read_b32 v90, v7 offset:16384
    ds_read_b32 v94, v7 offset:20480
    ds_read_b32 v98, v7 offset:24576
    ds_read_b32 v102, v7 offset:28672
    ds_read_b32 v106, v7 offset:32768
    ds_read_b32 v110, v7 offset:36864
    ds_read_b32 v114, v7 offset:40960
    ds_read_b32 v118, v7 offset:45056
    s_add_u32 s32, s32, 256
    s_add_u32 s33, s33, 40960000
    s_add_u32 s34, s34, 20480000
    s_add_u32 s40, s40, 1
    s_cmp_lt_u32 s40, 4
    s_waitcnt lgkmcnt(0)
    s_cbranch_scc1 L_p1_loop
    s_mov_b32 s36, 0
    buffer_store_dwordx3 v[48:50], v3, s[20:23], s36 offen sc1
    s_mov_b32 s36, 12288
    buffer_store_dwordx3 v[52:54], v3, s[20:23], s36 offen sc1
    s_mov_b32 s36, 24576
    buffer_store_dwordx3 v[56:58], v3, s[20:23], s36 offen sc1
    s_mov_b32 s36, 36864
    buffer_store_dwordx3 v[60:62], v3, s[20:23], s36 offen sc1
    s_mov_b32 s36, 49152
    buffer_store_dwordx3 v[64:66], v3, s[20:23], s36 offen sc1
    s_mov_b32 s36, 61440
    buffer_store_dwordx3 v[68:70], v3, s[20:23], s36 offen sc1
    s_mov_b32 s36, 73728
    buffer_store_dwordx3 v[72:74], v3, s[20:23], s36 offen sc1
    s_mov_b32 s36, 86016
    buffer_store_dwordx3 v[76:78], v3, s[20:23], s36 offen sc1
    s_mov_b32 s36, 98304
    buffer_store_dwordx3 v[80:82], v3, s[20:23], s36 offen sc1
    s_mov_b32 s36, 110592
    buffer_store_dwordx3 v[84:86], v3, s[20:23], s36 offen sc1
    s_mov_b32 s36, 122880
    buffer_store_dwordx3 v[88:90], v3, s[20:23], s36 offen sc1
    s_mov_b32 s36, 135168
    buffer_store_dwordx3 v[92:94], v3, s[20:23], s36 offen sc1
    s_mov_b32 s36, 147456
    buffer_store_dwordx3 v[96:98], v3, s[20:23], s36 offen sc1
    s_mov_b32 s36, 159744
    buffer_store_dwordx3 v[100:102], v3, s[20:23], s36 offen sc1
    s_mov_b32 s36, 172032
    buffer_store_dwordx3 v[104:106], v3, s[20:23], s36 offen sc1
    s_mov_b32 s36, 184320
    buffer_store_dwordx3 v[108:110], v3, s[20:23], s36 offen sc1
    s_mov_b32 s36, 196608
    buffer_store_dwordx3 v[112:114], v3, s[20:23], s36 offen sc1
    s_mov_b32 s36, 208896
    buffer_store_dwordx3 v[116:118], v3, s[20:23], s36 offen sc1
    s_mov_b32 s36, 221184
    buffer_store_dwordx3 v[120:122], v3, s[20:23], s36 offen sc1
    s_mov_b32 s36, 233472
    buffer_store_dwordx3 v[124:126], v3, s[20:23], s36 offen sc1
    v_and_b32 v6, 0x40000000, v5
    v_cmp_ne_u32 vcc, 0, v6
    s_lshl_b32 s35, s39, 4
    s_add_u32 s35, s35, 160072
    v_mov_b32 v10, s35
    s_cmp_lg_u64 vcc, 0
    s_cselect_b32 s36, 1, 0
    v_mov_b32 v11, s36
    ds_write_b32 v10, v11
    s_waitcnt lgkmcnt(0)
    s_barrier
    s_cmp_lg_u32 s39, 0
    s_cbranch_scc1 L_p1_end
    v_and_b32 v6, 15, v0
    v_lshlrev_b32 v6, 4, v6
    v_add_u32 v6, 160064, v6
    ds_read_b128 v[8:11], v6
    s_waitcnt lgkmcnt(0)
    s_nop 1
    v_max_u32_dpp v8, v8, v8 row_shr:1 row_mask:0xf bank_mask:0xf bound_ctrl:0
    s_nop 1
    v_max_u32_dpp v8, v8, v8 row_shr:2 row_mask:0xf bank_mask:0xf bound_ctrl:0
    s_nop 1
    v_max_u32_dpp v8, v8, v8 row_shr:4 row_mask:0xf bank_mask:0xf bound_ctrl:0
    s_nop 1
    v_max_u32_dpp v8, v8, v8 row_shr:8 row_mask:0xf bank_mask:0xf bound_ctrl:0
    s_nop 1
    v_add_f32_dpp v9, v9, v9 row_shr:1 row_mask:0xf bank_mask:0xf bound_ctrl:0
    s_nop 1
    v_add_f32_dpp v9, v9, v9 row_shr:2 row_mask:0xf bank_mask:0xf bound_ctrl:0
    s_nop 1
    v_add_f32_dpp v9, v9, v9 row_shr:4 row_mask:0xf bank_mask:0xf bound_ctrl:0
    s_nop 1
    v_add_f32_dpp v9, v9, v9 row_shr:8 row_mask:0xf bank_mask:0xf bound_ctrl:0
    s_nop 1
    v_or_b32_dpp v10, v10, v10 row_shr:1 row_mask:0xf bank_mask:0xf bound_ctrl:0
    s_nop 1
    v_or_b32_dpp v10, v10, v10 row_shr:2 row_mask:0xf bank_mask:0xf bound_ctrl:0
    s_nop 1
    v_or_b32_dpp v10, v10, v10 row_shr:4 row_mask:0xf bank_mask:0xf bound_ctrl:0
    s_nop 1
    v_or_b32_dpp v10, v10, v10 row_shr:8 row_mask:0xf bank_mask:0xf bound_ctrl:0
    s_lshl_b32 s35, s2, 4
    s_add_u32 s35, s35, 8519680
    v_mov_b32 v6, 0
    v_mov_b32 v11, 0
    s_mov_b64 exec, 0x8000
    buffer_store_dwordx4 v[8:11], v6, s[24:27], s35 offen
L_p1_end:
    s_endpgm
.globl p2_kernel
.p2align 8
.type p2_kernel,@function
p2_kernel:
    s_cmp_ge_u32 s2, 256
    s_cbranch_scc1 L_p2_end
    s_load_dwordx2 s[4:5], s[0:1], 104
    s_load_dwordx2 s[8:9], s[0:1], 0
    s_and_b32 s14, s2, 7
    s_lshr_b32 s101, s2, 3
    s_and_b32 s3, s14, 1
    s_lshl_b32 s3, s3, 5
    s_add_u32 s3, s3, s101
    s_lshr_b32 s12, s14, 1
    v_lshrrev_b32 v112, 6, v0
    v_lshlrev_b32 v1, 4, v0
    v_and_b32 v113, 63, v0
    v_readfirstlane_b32 s13, v112
    v_mul_u32_u24 v114, 8320, v0
    v_lshlrev_b32 v115, 6, v113
    s_mul_i32 s14, s12, 65
    s_add_u32 s14, s14, s3
    s_lshl_b32 s14, s14, 5
    s_add_u32 s14, s14, 245768192
    s_mov_b32 s15, 254287872
    s_mul_i32 s22, s12, 1280000
    s_mov_b32 s2, 0
    s_waitcnt lgkmcnt(0)
    s_mov_b32 s6, 655360000
    s_mov_b32 s7, 0x00020000
    s_add_u32 s10, s22, 1280000
    s_mov_b32 s11, 0x00020000
    buffer_load_dwordx4 v[64:67], v114, s[4:7], s14 offen offset:0
    buffer_load_dwordx4 v[68:71], v114, s[4:7], s14 offen offset:16
    buffer_load_dwordx4 v[72:75], v114, s[4:7], s14 offen offset:32
    buffer_load_dwordx4 v[76:79], v114, s[4:7], s14 offen offset:48
    buffer_load_dwordx3 v[36:38], v115, s[4:7], s15 offen offset:0
    buffer_load_dwordx3 v[40:42], v115, s[4:7], s15 offen offset:16
    buffer_load_dwordx3 v[44:46], v115, s[4:7], s15 offen offset:32
    buffer_load_dwordx3 v[48:50], v115, s[4:7], s15 offen offset:48
    s_add_u32 s14, s22, 0
    buffer_load_dwordx4 v[88:91], v1, s[8:11], s14 offen
    s_add_u32 s14, s22, 16384
    buffer_load_dwordx4 v[92:95], v1, s[8:11], s14 offen
    s_add_u32 s14, s22, 32768
    buffer_load_dwordx4 v[96:99], v1, s[8:11], s14 offen
    s_add_u32 s14, s22, 49152
    buffer_load_dwordx4 v[100:103], v1, s[8:11], s14 offen
    s_add_u32 s14, s22, 65536
    buffer_load_dwordx4 v[104:107], v1, s[8:11], s14 offen
    s_and_b32 s14, s101, 3
    s_lshl_b32 s14, s14, 8
    s_lshr_b32 s15, s101, 2
    s_lshl_b32 s15, s15, 14
    s_add_u32 s14, s14, s15
    s_add_u32 s14, s14, s22
    s_add_u32 s14, s14, 80000
    s_mov_b64 exec, 0x101
    buffer_load_dword v125, v1, s[8:11], s14 offen
    s_mov_b64 exec, -1
    v_mul_u32_u24 v2, 12, v113
    v_add_u32 v2, 2816, v2
    v_add_u32 v3, 80000, v1
    v_add_u32 v124, 145536, v1
    v_add_u32 v117, 65536, v1
    v_mov_b32 v116, 0x7f000000
    v_cmp_gt_u32 vcc, 904, v0
    s_mul_i32 s19, s13, 240
    s_add_u32 s19, s19, 160000
    v_cndmask_b32 v124, v116, v124, vcc
    v_cndmask_b32 v117, v116, v117, vcc
    v_lshl_add_u32 v6, v113, 2, s19
    v_lshl_add_u32 v126, v113, 1, s19
    v_cmp_gt_u32 vcc, 42, v113
    s_mul_i32 s27, s13, 15360000
    s_mov_b32 s23, 240000
    v_cndmask_b32 v6, v116, v6, vcc
    v_lshrrev_b32 v118, 1, v113
    v_subrev_u32 v119, 28, v113
    v_cmp_gt_u32 vcc, 28, v113
    s_mov_b32 s17, 0x05040100
    s_mov_b32 s18, 80000
    v_cndmask_b32 v5, v119, v118, vcc
    v_lshlrev_b32 v5, 5, v5
    s_mov_b64 exec, 0x5555555
    v_mov_b32 v5, -64
    s_mov_b64 exec, -1
    s_mov_b32 s20, 3221209088
    s_mov_b32 s21, 3221209087
    v_mov_b32 v4, 0
    v_mov_b32 v108, 1073758208
    v_mov_b32 v109, 1073758208
    v_mov_b32 v110, 1073758208
    v_mov_b32 v111, 1073758208
    ds_write_b128 v1, v[108:111] offset:0
    ds_write_b128 v1, v[108:111] offset:16384
    ds_write_b128 v1, v[108:111] offset:32768
    ds_write_b128 v1, v[108:111] offset:49152
    ds_write_b128 v117, v[108:111]
    s_waitcnt vmcnt(10)
    v_mov_b32 v11, v64
    v_mov_b32 v15, v65
    v_mov_b32 v19, v66
    v_mov_b32 v23, v67
    v_mov_b32 v27, v68
    v_mov_b32 v31, v69
    v_mov_b32 v35, v70
    v_mov_b32 v39, v71
    v_mov_b32 v43, v72
    v_mov_b32 v47, v73
    v_mov_b32 v51, v74
    v_mov_b32 v55, v75
    v_mov_b32 v59, v76
    v_mov_b32 v63, v77
    v_mov_b32 v122, v78
    v_mov_b32 v123, v79
    v_lshrrev_b32_sdwa v112, 1, v11 dst_sel:DWORD dst_unused:UNUSED_PAD src0_sel:DWORD src1_sel:WORD_0
    v_add_u32_sdwa v113, 1, v43 dst_sel:DWORD dst_unused:UNUSED_PAD src0_sel:DWORD src1_sel:WORD_0
    v_lshrrev_b32 v113, 1, v113
    v_sub_u32 v113, v113, v112
    v_cmp_eq_u32 vcc, 0, v113
    v_max_u32 v113, 1, v113
    v_mov_b32 v114, v113
    v_and_b32_sdwa v115, 1, v11 dst_sel:DWORD dst_unused:UNUSED_PAD src0_sel:DWORD src1_sel:WORD_0
    v_and_b32_sdwa v116, 1, v43 dst_sel:DWORD dst_unused:UNUSED_PAD src0_sel:DWORD src1_sel:WORD_0
    v_add_u32_dpp v114, v114, v114 row_shr:1 row_mask:0xf bank_mask:0xf bound_ctrl:0
    v_cndmask_b32 v115, v115, v113, vcc
    v_cndmask_b32 v116, v116, v113, vcc
    v_add_u32_dpp v114, v114, v114 row_shr:2 row_mask:0xf bank_mask:0xf bound_ctrl:0
    v_add_u32 v112, 448, v112
    s_nop 0
    v_add_u32_dpp v114, v114, v114 row_shr:4 row_mask:0xf bank_mask:0xf bound_ctrl:0
    s_nop 1
    v_add_u32_dpp v114, v114, v114 row_shr:8 row_mask:0xf bank_mask:0xf bound_ctrl:0
    s_nop 1
    v_add_u32_dpp v114, v114, v114 row_bcast:15 row_mask:0xa bank_mask:0xf
    s_nop 1
    v_add_u32_dpp v114, v114, v114 row_bcast:31 row_mask:0xc bank_mask:0xf
    s_nop 0
    v_readlane_b32 s28, v114, 63
    v_sub_u32 v113, v114, v113
    v_add_u32 v114, -1, v114
    v_sub_u32 v112, v112, v113
    s_cmp_gt_u32 s28, 448
    s_cselect_b32 s28, 0, s28
    s_cselect_b32 s2, 1, s2
    s_cselect_b64 vcc, 0, -1
    v_sub_u32 v117, s28, v5
    v_med3_i32 v117, v117, 0, 32
    v_lshlrev_b64 v[118:119], v117, -1
    v_lshlrev_b32 v115, v113, v115
    v_lshrrev_b32 v113, 5, v113
    ds_write_b32 v6, v118
    v_lshl_add_u32 v113, v113, 2, s19
    v_lshlrev_b32 v119, v114, v116
    v_lshlrev_b32_e64 v118, v114, 1
    v_lshrrev_b32 v114, 5, v114
    v_lshl_add_u32 v114, v114, 3, s19
    s_mov_b64 exec, vcc
    ds_or_b32 v113, v115 offset:112
    ds_or_b64 v114, v[118:119]
    s_mov_b64 exec, -1
    ds_read_b32 v7, v6
    ds_write_b16 v126, v112
    s_waitcnt lgkmcnt(1)
    v_readlane_b32 s30, v7, 0
    v_readlane_b32 s31, v7, 2
    v_readlane_b32 s32, v7, 4
    v_readlane_b32 s33, v7, 6
    v_readlane_b32 s34, v7, 8
    v_readlane_b32 s35, v7, 10
    v_readlane_b32 s36, v7, 12
    v_readlane_b32 s37, v7, 14
    v_readlane_b32 s38, v7, 16
    v_readlane_b32 s39, v7, 18
    v_readlane_b32 s40, v7, 20
    v_readlane_b32 s41, v7, 22
    s_mov_b32 s25, s19
    s_mov_b32 s26, s27
    s_nop 0
    v_mbcnt_lo_u32_b32 v8, s30, 0
    v_mbcnt_hi_u32_b32 v8, s31, v8
    s_bcnt1_i32_b64 s14, s[30:31]
    v_lshl_add_u32 v9, v8, 1, s25
    ds_read_u16 v9, v9
    v_mad_u32_u24 v8, v8, s23, v2
    s_mov_b32 s30, s26
    s_lshl1_add_u32 s25, s14, s25
    s_mul_i32 s14, s14, s23
    s_add_u32 s26, s26, s14
    s_add_u32 s26, s26, 768
    v_readlane_b32 s44, v7, 28
    v_readlane_b32 s45, v7, 29
    v_readlane_b32 s46, v7, 1
    v_readlane_b32 s47, v7, 3
    v_mbcnt_lo_u32_b32 v12, s32, 0
    v_mbcnt_hi_u32_b32 v12, s33, v12
    s_bcnt1_i32_b64 s14, s[32:33]
    v_lshl_add_u32 v13, v12, 1, s25
    ds_read_u16 v13, v13
    v_mad_u32_u24 v12, v12, s23, v2
    s_mov_b32 s32, s26
    s_lshl1_add_u32 s25, s14, s25
    s_mul_i32 s14, s14, s23
    s_add_u32 s26, s26, s14
    s_add_u32 s26, s26, 768
    v_readlane_b32 s48, v7, 30
    v_readlane_b32 s49, v7, 31
    v_readlane_b32 s50, v7, 5
    v_readlane_b32 s51, v7, 7
    v_mbcnt_lo_u32_b32 v16, s34, 0
    v_mbcnt_hi_u32_b32 v16, s35, v16
    s_bcnt1_i32_b64 s14, s[34:35]
    v_lshl_add_u32 v17, v16, 1, s25
    ds_read_u16 v17, v17
    v_mad_u32_u24 v16, v16, s23, v2
    s_mov_b32 s34, s26
    s_lshl1_add_u32 s25, s14, s25
    s_mul_i32 s14, s14, s23
    s_add_u32 s26, s26, s14
    s_add_u32 s26, s26, 768
    v_readlane_b32 s52, v7, 32
    v_readlane_b32 s53, v7, 33
    v_readlane_b32 s54, v7, 9
    v_readlane_b32 s55, v7, 11
    v_mbcnt_lo_u32_b32 v20, s36, 0
    v_mbcnt_hi_u32_b32 v20, s37, v20
    s_bcnt1_i32_b64 s14, s[36:37]
    v_lshl_add_u32 v21, v20, 1, s25
    ds_read_u16 v21, v21
    v_mad_u32_u24 v20, v20, s23, v2
    s_mov_b32 s36, s26
    s_lshl1_add_u32 s25, s14, s25
    s_mul_i32 s14, s14, s23
    s_add_u32 s26, s26, s14
    s_add_u32 s26, s26, 768
    v_readlane_b32 s56, v7, 34
    v_readlane_b32 s57, v7, 35
    v_readlane_b32 s58, v7, 13
    v_readlane_b32 s59, v7, 15
    v_mbcnt_lo_u32_b32 v24, s38, 0
    v_mbcnt_hi_u32_b32 v24, s39, v24
    s_bcnt1_i32_b64 s14, s[38:39]
    v_lshl_add_u32 v25, v24, 1, s25
    ds_read_u16 v25, v25
    v_mad_u32_u24 v24, v24, s23, v2
    s_mov_b32 s38, s26
    s_lshl1_add_u32 s25, s14, s25
    s_mul_i32 s14, s14, s23
    s_add_u32 s26, s26, s14
    s_add_u32 s26, s26, 768
    v_readlane_b32 s60, v7, 36
    v_readlane_b32 s61, v7, 37
    v_readlane_b32 s62, v7, 17
    v_readlane_b32 s63, v7, 19
    v_mbcnt_lo_u32_b32 v28, s40, 0
    v_mbcnt_hi_u32_b32 v28, s41, v28
    s_bcnt1_i32_b64 s14, s[40:41]
    v_lshl_add_u32 v29, v28, 1, s25
    ds_read_u16 v29, v29
    v_mad_u32_u24 v28, v28, s23, v2
    s_mov_b32 s40, s26
    s_lshl1_add_u32 s25, s14, s25
    s_mul_i32 s14, s14, s23
    s_add_u32 s26, s26, s14
    s_add_u32 s26, s26, 768
    v_readlane_b32 s64, v7, 38
    v_readlane_b32 s65, v7, 39
    v_readlane_b32 s66, v7, 21
    v_readlane_b32 s67, v7, 23
    s_waitcnt lgkmcnt(5)
    v_mad_u32_u24 v8, v9, 12, v8
    s_nand_b64 exec, s[44:45], s[46:47]
    buffer_load_dwordx3 v[8:10], v8, s[4:7], s30 offen
    s_mov_b64 exec, -1
    s_waitcnt lgkmcnt(4)
    v_mad_u32_u24 v12, v13, 12, v12
    s_nand_b64 exec, s[48:49], s[50:51]
    buffer_load_dwordx3 v[12:14], v12, s[4:7], s32 offen
    s_mov_b64 exec, -1
    s_waitcnt lgkmcnt(3)
    v_mad_u32_u24 v16, v17, 12, v16
    s_nand_b64 exec, s[52:53], s[54:55]
    buffer_load_dwordx3 v[16:18], v16, s[4:7], s34 offen
    s_mov_b64 exec, -1
    s_waitcnt lgkmcnt(2)
    v_mad_u32_u24 v20, v21, 12, v20
    s_nand_b64 exec, s[56:57], s[58:59]
    buffer_load_dwordx3 v[20:22], v20, s[4:7], s36 offen
    s_mov_b64 exec, -1
    s_waitcnt lgkmcnt(1)
    v_mad_u32_u24 v24, v25, 12, v24
    s_nand_b64 exec, s[60:61], s[62:63]
    buffer_load_dwordx3 v[24:26], v24, s[4:7], s38 offen
    s_mov_b64 exec, -1
    s_waitcnt lgkmcnt(0)
    v_mad_u32_u24 v28, v29, 12, v28
    s_nand_b64 exec, s[64:65], s[66:67]
    buffer_load_dwordx3 v[28:30], v28, s[4:7], s40 offen
    s_mov_b64 exec, -1
    s_cmp_le_u32 s28, 384
    s_cbranch_scc1 L_p2_kernel_norare_1
    v_readlane_b32 s42, v7, 24
    v_readlane_b32 s43, v7, 26
    s_nop 1
    v_mbcnt_lo_u32_b32 v32, s42, 0
    v_mbcnt_hi_u32_b32 v32, s43, v32
    s_bcnt1_i32_b64 s14, s[42:43]
    v_lshl_add_u32 v33, v32, 1, s25
    ds_read_u16 v33, v33
    v_mad_u32_u24 v32, v32, s23, v2
    s_mov_b32 s42, s26
    s_lshl1_add_u32 s25, s14, s25
    s_mul_i32 s14, s14, s23
    s_add_u32 s26, s26, s14
    s_add_u32 s26, s26, 768
    v_readlane_b32 s68, v7, 40
    v_readlane_b32 s69, v7, 41
    v_readlane_b32 s70, v7, 25
    v_readlane_b32 s71, v7, 27
    s_waitcnt lgkmcnt(0)
    v_mad_u32_u24 v32, v33, 12, v32
    s_nand_b64 exec, s[68:69], s[70:71]
    buffer_load_dwordx3 v[32:34], v32, s[4:7], s42 offen
    s_mov_b64 exec, -1
L_p2_kernel_norare_1:
    s_waitcnt vmcnt(12)
    v_max3_u32 v36, v36, v40, v44
    v_add_f32 v37, v37, v41
    v_or3_b32 v38, v38, v42, v46
    v_add_f32 v45, v45, v49
    v_max_u32 v36, v36, v48
    v_or_b32 v38, v38, v50
    v_add_f32 v37, v37, v45
    v_cmp_ne_u32 vcc, 0, v38
    s_nop 1
    v_max_u32_dpp v36, v36, v36 row_shr:1 row_mask:0xf bank_mask:0xf bound_ctrl:0
    s_nop 1
    v_max_u32_dpp v36, v36, v36 row_shr:2 row_mask:0xf bank_mask:0xf bound_ctrl:0
    s_nop 1
    v_max_u32_dpp v36, v36, v36 row_shr:4 row_mask:0xf bank_mask:0xf bound_ctrl:0
    s_nop 1
    v_max_u32_dpp v36, v36, v36 row_shr:8 row_mask:0xf bank_mask:0xf bound_ctrl:0
    s_nop 1
    v_max_u32_dpp v36, v36, v36 row_bcast:15 row_mask:0xa bank_mask:0xf
    s_nop 1
    v_max_u32_dpp v36, v36, v36 row_bcast:31 row_mask:0xc bank_mask:0xf
    s_nop 1
    v_add_f32_dpp v37, v37, v37 row_shr:1 row_mask:0xf bank_mask:0xf bound_ctrl:0
    s_nop 1
    v_add_f32_dpp v37, v37, v37 row_shr:2 row_mask:0xf bank_mask:0xf bound_ctrl:0
    s_nop 1
    v_add_f32_dpp v37, v37, v37 row_shr:4 row_mask:0xf bank_mask:0xf bound_ctrl:0
    s_nop 1
    v_add_f32_dpp v37, v37, v37 row_shr:8 row_mask:0xf bank_mask:0xf bound_ctrl:0
    s_nop 1
    v_add_f32_dpp v37, v37, v37 row_bcast:15 row_mask:0xa bank_mask:0xf
    s_nop 1
    v_add_f32_dpp v37, v37, v37 row_bcast:31 row_mask:0xc bank_mask:0xf
    s_cmp_lg_u64 vcc, 0
    s_cselect_b32 s2, 1, s2
    v_lshlrev_b32 v36, 16, v36
    v_mul_f32 v38, 936490775, v37
    v_mul_f32 v37, 928531664, v37
    v_cmp_nle_f32 vcc, v36, v38
    v_max_u32 v36, v36, v37
    s_nop 0
    v_readlane_b32 s14, v36, 63
    s_bitcmp1_b32 vcc_hi, 31
    s_cselect_b32 s2, 1, s2
    s_lshr_b32 s14, s14, 23
    s_add_u32 s14, s14, 1
    s_cmp_lt_u32 s14, 40
    s_cselect_b32 s2, 1, s2
    s_cmp_gt_u32 s14, 230
    s_cselect_b32 s2, 1, s2
    s_sub_u32 s100, s14, 14
    s_lshl_b32 s100, s100, 23
    s_add_u32 s16, s100, 197148672
    s_waitcnt vmcnt(7)
    ds_write_b128 v3, v[88:91] offset:0
    ds_write_b128 v3, v[92:95] offset:16384
    ds_write_b128 v3, v[96:99] offset:32768
    ds_write_b128 v3, v[100:103] offset:49152
    ds_write_b128 v124, v[104:107]
    s_add_u32 s22, s22, 80000
    s_add_u32 s14, s22, 0
    buffer_load_dwordx4 v[88:91], v1, s[8:11], s14 offen
    s_add_u32 s14, s22, 16384
    buffer_load_dwordx4 v[92:95], v1, s[8:11], s14 offen
    s_add_u32 s14, s22, 32768
    buffer_load_dwordx4 v[96:99], v1, s[8:11], s14 offen
    s_add_u32 s14, s22, 49152
    buffer_load_dwordx4 v[100:103], v1, s[8:11], s14 offen
    s_add_u32 s14, s22, 65536
    buffer_load_dwordx4 v[104:107], v1, s[8:11], s14 offen
    v_lshrrev_b32_sdwa v112, 1, v11 dst_sel:DWORD dst_unused:UNUSED_PAD src0_sel:DWORD src1_sel:WORD_1
    v_add_u32_sdwa v113, 1, v43 dst_sel:DWORD dst_unused:UNUSED_PAD src0_sel:DWORD src1_sel:WORD_1
    v_lshrrev_b32 v113, 1, v113
    v_sub_u32 v113, v113, v112
    v_cmp_eq_u32 vcc, 0, v113
    v_max_u32 v113, 1, v113
    v_mov_b32 v114, v113
    v_and_b32_sdwa v115, 1, v11 dst_sel:DWORD dst_unused:UNUSED_PAD src0_sel:DWORD src1_sel:WORD_1
    v_and_b32_sdwa v116, 1, v43 dst_sel:DWORD dst_unused:UNUSED_PAD src0_sel:DWORD src1_sel:WORD_1
    v_add_u32_dpp v114, v114, v114 row_shr:1 row_mask:0xf bank_mask:0xf bound_ctrl:0
    v_cndmask_b32 v115, v115, v113, vcc
    v_cndmask_b32 v116, v116, v113, vcc
    v_add_u32_dpp v114, v114, v114 row_shr:2 row_mask:0xf bank_mask:0xf bound_ctrl:0
    v_add_u32 v112, 448, v112
    s_nop 0
    v_add_u32_dpp v114, v114, v114 row_shr:4 row_mask:0xf bank_mask:0xf bound_ctrl:0
    s_nop 1
    v_add_u32_dpp v114, v114, v114 row_shr:8 row_mask:0xf bank_mask:0xf bound_ctrl:0
    s_nop 1
    v_add_u32_dpp v114, v114, v114 row_bcast:15 row_mask:0xa bank_mask:0xf
    s_nop 1
    v_add_u32_dpp v114, v114, v114 row_bcast:31 row_mask:0xc bank_mask:0xf
    s_nop 0
    v_readlane_b32 s29, v114, 63
    v_sub_u32 v113, v114, v113
    v_add_u32 v114, -1, v114
    v_sub_u32 v112, v112, v113
    s_cmp_gt_u32 s29, 448
    s_cselect_b32 s29, 0, s29
    s_cselect_b32 s2, 1, s2
    s_cselect_b64 vcc, 0, -1
    v_sub_u32 v117, s29, v5
    v_med3_i32 v117, v117, 0, 32
    v_lshlrev_b64 v[118:119], v117, -1
    v_lshlrev_b32 v115, v113, v115
    v_lshrrev_b32 v113, 5, v113
    ds_write_b32 v6, v118
    v_lshl_add_u32 v113, v113, 2, s19
    v_lshlrev_b32 v119, v114, v116
    v_lshlrev_b32_e64 v118, v114, 1
    v_lshrrev_b32 v114, 5, v114
    v_lshl_add_u32 v114, v114, 3, s19
    s_mov_b64 exec, vcc
    ds_or_b32 v113, v115 offset:112
    ds_or_b64 v114, v[118:119]
    s_mov_b64 exec, -1
    ds_read_b32 v7, v6
    ds_write_b16 v126, v112
    s_mov_b32 s24, 0
    s_waitcnt lgkmcnt(5)
    s_barrier
L_p2_loop:
    s_cmp_le_u32 s28, 384
    s_cbranch_scc1 L_p2_kernel_norare2_2
    s_waitcnt vmcnt(0)
    v_mad_u32_u16 v64, v32, 8, s18
    v_mad_u32_u16 v66, v33, 8, s18
    ds_read_b64 v[64:65], v64
    ds_read_b64 v[66:67], v66
    v_and_b32 v112, 0xffff, v34
    v_lshrrev_b32 v114, 16, v34
    v_lshlrev_b32 v113, 16, v34
    v_and_b32 v34, 0xffff0000, v34
    v_lshlrev_b32_sdwa v32, 3, v32 dst_sel:DWORD dst_unused:UNUSED_PAD src0_sel:DWORD src1_sel:WORD_1
    v_lshlrev_b32_sdwa v33, 3, v33 dst_sel:DWORD dst_unused:UNUSED_PAD src0_sel:DWORD src1_sel:WORD_1
    s_waitcnt lgkmcnt(0)
    v_dot2_f32_bf16 v115, v64, v112, s16
    v_dot2_f32_bf16 v64, v64, v113, s16
    v_dot2_f32_bf16 v116, v65, v112, s16
    v_dot2_f32_bf16 v65, v65, v113, s16
    v_dot2_f32_bf16 v117, v66, v114, s16
    v_dot2_f32_bf16 v66, v66, v34, s16
    v_dot2_f32_bf16 v118, v67, v114, s16
    v_dot2_f32_bf16 v67, v67, v34, s16
    v_perm_b32 v64, v64, v115, s17
    v_perm_b32 v65, v65, v116, s17
    v_perm_b32 v66, v66, v117, s17
    v_perm_b32 v67, v67, v118, s17
    v_lshl_add_u64 v[64:65], v[64:65], 0, s[20:21]
    v_lshl_add_u64 v[66:67], v[66:67], 0, s[20:21]
    v_or3_b32 v4, v108, v109, v4
    v_or3_b32 v4, v110, v111, v4
    s_not_b64 exec, s[68:69]
    ds_add_rtn_u64 v[108:109], v32, v[64:65]
    s_not_b64 exec, s[70:71]
    ds_add_rtn_u64 v[110:111], v33, v[66:67]
    s_mov_b64 exec, -1
    s_waitcnt lgkmcnt(0)
L_p2_kernel_norare2_2:
    s_waitcnt lgkmcnt(1)
    v_readlane_b32 s30, v7, 0
    v_readlane_b32 s31, v7, 2
    v_readlane_b32 s32, v7, 4
    v_readlane_b32 s33, v7, 6
    v_readlane_b32 s34, v7, 8
    v_readlane_b32 s35, v7, 10
    v_readlane_b32 s36, v7, 12
    v_readlane_b32 s37, v7, 14
    v_readlane_b32 s38, v7, 16
    v_readlane_b32 s39, v7, 18
    v_readlane_b32 s40, v7, 20
    v_readlane_b32 s41, v7, 22
    s_mov_b32 s25, s19
    s_mov_b32 s26, s27
    s_and_b32 s14, s101, 3
    s_lshl_b32 s14, s14, 8
    s_lshr_b32 s15, s101, 2
    s_lshl_b32 s15, s15, 14
    s_add_u32 s14, s14, s15
    s_add_u32 s14, s14, s22
    s_add_u32 s14, s14, 80000
    s_mov_b64 exec, 0x101
    buffer_load_dword v125, v1, s[8:11], s14 offen
    s_mov_b64 exec, -1
    s_waitcnt vmcnt(11)
    v_mad_u32_u16 v64, v8, 8, s18
    v_mad_u32_u16 v66, v9, 8, s18
    ds_read_b64 v[64:65], v64
    ds_read_b64 v[66:67], v66
    v_mbcnt_lo_u32_b32 v36, s30, 0
    v_mbcnt_hi_u32_b32 v36, s31, v36
    s_bcnt1_i32_b64 s14, s[30:31]
    v_lshl_add_u32 v37, v36, 1, s25
    ds_read_u16 v37, v37
    v_mad_u32_u24 v36, v36, s23, v2
    s_mov_b32 s30, s26
    s_lshl1_add_u32 s25, s14, s25
    s_mul_i32 s14, s14, s23
    s_add_u32 s26, s26, s14
    s_add_u32 s26, s26, 768
    v_readlane_b32 s72, v7, 28
    v_readlane_b32 s73, v7, 29
    v_readlane_b32 s74, v7, 1
    v_readlane_b32 s75, v7, 3
    s_waitcnt vmcnt(10)
    v_mad_u32_u16 v68, v12, 8, s18
    v_mad_u32_u16 v70, v13, 8, s18
    ds_read_b64 v[68:69], v68
    ds_read_b64 v[70:71], v70
    v_mbcnt_lo_u32_b32 v40, s32, 0
    v_mbcnt_hi_u32_b32 v40, s33, v40
    s_bcnt1_i32_b64 s14, s[32:33]
    v_lshl_add_u32 v41, v40, 1, s25
    ds_read_u16 v41, v41
    v_mad_u32_u24 v40, v40, s23, v2
    s_mov_b32 s32, s26
    s_lshl1_add_u32 s25, s14, s25
    s_mul_i32 s14, s14, s23
    s_add_u32 s26, s26, s14
    s_add_u32 s26, s26, 768
    v_readlane_b32 s76, v7, 30
    v_readlane_b32 s77, v7, 31
    v_readlane_b32 s78, v7, 5
    v_readlane_b32 s79, v7, 7
    s_waitcnt vmcnt(9)
    v_mad_u32_u16 v72, v16, 8, s18
    v_mad_u32_u16 v74, v17, 8, s18
    ds_read_b64 v[72:73], v72
    ds_read_b64 v[74:75], v74
    v_mbcnt_lo_u32_b32 v44, s34, 0
    v_mbcnt_hi_u32_b32 v44, s35, v44
    s_bcnt1_i32_b64 s14, s[34:35]
    v_lshl_add_u32 v45, v44, 1, s25
    ds_read_u16 v45, v45
    v_mad_u32_u24 v44, v44, s23, v2
    s_mov_b32 s34, s26
    s_lshl1_add_u32 s25, s14, s25
    s_mul_i32 s14, s14, s23
    s_add_u32 s26, s26, s14
    s_add_u32 s26, s26, 768
    v_readlane_b32 s80, v7, 32
    v_readlane_b32 s81, v7, 33
    v_readlane_b32 s82, v7, 9
    v_readlane_b32 s83, v7, 11
    s_waitcnt vmcnt(8)
    v_mad_u32_u16 v76, v20, 8, s18
    v_mad_u32_u16 v78, v21, 8, s18
    ds_read_b64 v[76:77], v76
    ds_read_b64 v[78:79], v78
    v_mbcnt_lo_u32_b32 v48, s36, 0
    v_mbcnt_hi_u32_b32 v48, s37, v48
    s_bcnt1_i32_b64 s14, s[36:37]
    v_lshl_add_u32 v49, v48, 1, s25
    ds_read_u16 v49, v49
    v_mad_u32_u24 v48, v48, s23, v2
    s_mov_b32 s36, s26
    s_lshl1_add_u32 s25, s14, s25
    s_mul_i32 s14, s14, s23
    s_add_u32 s26, s26, s14
    s_add_u32 s26, s26, 768
    v_readlane_b32 s84, v7, 34
    v_readlane_b32 s85, v7, 35
    v_readlane_b32 s86, v7, 13
    v_readlane_b32 s87, v7, 15
    s_waitcnt vmcnt(7)
    v_mad_u32_u16 v80, v24, 8, s18
    v_mad_u32_u16 v82, v25, 8, s18
    ds_read_b64 v[80:81], v80
    ds_read_b64 v[82:83], v82
    v_mbcnt_lo_u32_b32 v52, s38, 0
    v_mbcnt_hi_u32_b32 v52, s39, v52
    s_bcnt1_i32_b64 s14, s[38:39]
    v_lshl_add_u32 v53, v52, 1, s25
    ds_read_u16 v53, v53
    v_mad_u32_u24 v52, v52, s23, v2
    s_mov_b32 s38, s26
    s_lshl1_add_u32 s25, s14, s25
    s_mul_i32 s14, s14, s23
    s_add_u32 s26, s26, s14
    s_add_u32 s26, s26, 768
    v_readlane_b32 s88, v7, 36
    v_readlane_b32 s89, v7, 37
    v_readlane_b32 s90, v7, 17
    v_readlane_b32 s91, v7, 19
    s_waitcnt vmcnt(6)
    v_mad_u32_u16 v84, v28, 8, s18
    v_mad_u32_u16 v86, v29, 8, s18
    ds_read_b64 v[84:85], v84
    ds_read_b64 v[86:87], v86
    v_mbcnt_lo_u32_b32 v56, s40, 0
    v_mbcnt_hi_u32_b32 v56, s41, v56
    s_bcnt1_i32_b64 s14, s[40:41]
    v_lshl_add_u32 v57, v56, 1, s25
    ds_read_u16 v57, v57
    v_mad_u32_u24 v56, v56, s23, v2
    s_mov_b32 s40, s26
    s_lshl1_add_u32 s25, s14, s25
    s_mul_i32 s14, s14, s23
    s_add_u32 s26, s26, s14
    s_add_u32 s26, s26, 768
    v_readlane_b32 s92, v7, 38
    v_readlane_b32 s93, v7, 39
    v_readlane_b32 s94, v7, 21
    v_readlane_b32 s95, v7, 23
    s_waitcnt lgkmcnt(15)
    v_mad_u32_u24 v36, v37, 12, v36
    s_nand_b64 exec, s[72:73], s[74:75]
    buffer_load_dwordx3 v[36:38], v36, s[4:7], s30 offen
    s_mov_b64 exec, -1
    s_waitcnt lgkmcnt(12)
    v_mad_u32_u24 v40, v41, 12, v40
    s_nand_b64 exec, s[76:77], s[78:79]
    buffer_load_dwordx3 v[40:42], v40, s[4:7], s32 offen
    s_mov_b64 exec, -1
    v_and_b32 v112, 0xffff, v10
    v_lshrrev_b32 v114, 16, v10
    v_lshlrev_b32 v113, 16, v10
    v_and_b32 v10, 0xffff0000, v10
    v_lshlrev_b32_sdwa v8, 3, v8 dst_sel:DWORD dst_unused:UNUSED_PAD src0_sel:DWORD src1_sel:WORD_1
    v_lshlrev_b32_sdwa v9, 3, v9 dst_sel:DWORD dst_unused:UNUSED_PAD src0_sel:DWORD src1_sel:WORD_1
    v_dot2_f32_bf16 v115, v64, v112, s16
    v_dot2_f32_bf16 v64, v64, v113, s16
    v_dot2_f32_bf16 v116, v65, v112, s16
    v_dot2_f32_bf16 v65, v65, v113, s16
    v_dot2_f32_bf16 v117, v66, v114, s16
    v_dot2_f32_bf16 v66, v66, v10, s16
    v_dot2_f32_bf16 v118, v67, v114, s16
    v_dot2_f32_bf16 v67, v67, v10, s16
    v_perm_b32 v64, v64, v115, s17
    v_perm_b32 v65, v65, v116, s17
    v_perm_b32 v66, v66, v117, s17
    v_perm_b32 v67, v67, v118, s17
    v_lshl_add_u64 v[64:65], v[64:65], 0, s[20:21]
    v_lshl_add_u64 v[66:67], v[66:67], 0, s[20:21]
    v_or3_b32 v4, v108, v109, v4
    v_or3_b32 v4, v110, v111, v4
    s_not_b64 exec, s[44:45]
    ds_add_rtn_u64 v[108:109], v8, v[64:65]
    s_not_b64 exec, s[46:47]
    ds_add_rtn_u64 v[110:111], v9, v[66:67]
    s_mov_b64 exec, -1
    s_waitcnt lgkmcnt(11)
    v_mad_u32_u24 v44, v45, 12, v44
    s_nand_b64 exec, s[80:81], s[82:83]
    buffer_load_dwordx3 v[44:46], v44, s[4:7], s34 offen
    s_mov_b64 exec, -1
    s_waitcnt lgkmcnt(8)
    v_mad_u32_u24 v48, v49, 12, v48
    s_nand_b64 exec, s[84:85], s[86:87]
    buffer_load_dwordx3 v[48:50], v48, s[4:7], s36 offen
    s_mov_b64 exec, -1
    v_and_b32 v112, 0xffff, v14
    v_lshrrev_b32 v114, 16, v14
    v_lshlrev_b32 v113, 16, v14
    v_and_b32 v14, 0xffff0000, v14
    v_lshlrev_b32_sdwa v12, 3, v12 dst_sel:DWORD dst_unused:UNUSED_PAD src0_sel:DWORD src1_sel:WORD_1
    v_lshlrev_b32_sdwa v13, 3, v13 dst_sel:DWORD dst_unused:UNUSED_PAD src0_sel:DWORD src1_sel:WORD_1
    v_dot2_f32_bf16 v115, v68, v112, s16
    v_dot2_f32_bf16 v68, v68, v113, s16
    v_dot2_f32_bf16 v116, v69, v112, s16
    v_dot2_f32_bf16 v69, v69, v113, s16
    v_dot2_f32_bf16 v117, v70, v114, s16
    v_dot2_f32_bf16 v70, v70, v14, s16
    v_dot2_f32_bf16 v118, v71, v114, s16
    v_dot2_f32_bf16 v71, v71, v14, s16
    v_perm_b32 v68, v68, v115, s17
    v_perm_b32 v69, v69, v116, s17
    v_perm_b32 v70, v70, v117, s17
    v_perm_b32 v71, v71, v118, s17
    v_lshl_add_u64 v[68:69], v[68:69], 0, s[20:21]
    v_lshl_add_u64 v[70:71], v[70:71], 0, s[20:21]
    s_waitcnt lgkmcnt(0)
    v_or3_b32 v4, v108, v109, v4
    v_or3_b32 v4, v110, v111, v4
    s_not_b64 exec, s[48:49]
    ds_add_rtn_u64 v[108:109], v12, v[68:69]
    s_not_b64 exec, s[50:51]
    ds_add_rtn_u64 v[110:111], v13, v[70:71]
    s_mov_b64 exec, -1
    v_mad_u32_u24 v52, v53, 12, v52
    s_nand_b64 exec, s[88:89], s[90:91]
    buffer_load_dwordx3 v[52:54], v52, s[4:7], s38 offen
    s_mov_b64 exec, -1
    v_mad_u32_u24 v56, v57, 12, v56
    s_nand_b64 exec, s[92:93], s[94:95]
    buffer_load_dwordx3 v[56:58], v56, s[4:7], s40 offen
    s_mov_b64 exec, -1
    v_and_b32 v112, 0xffff, v18
    v_lshrrev_b32 v114, 16, v18
    v_lshlrev_b32 v113, 16, v18
    v_and_b32 v18, 0xffff0000, v18
    v_lshlrev_b32_sdwa v16, 3, v16 dst_sel:DWORD dst_unused:UNUSED_PAD src0_sel:DWORD src1_sel:WORD_1
    v_lshlrev_b32_sdwa v17, 3, v17 dst_sel:DWORD dst_unused:UNUSED_PAD src0_sel:DWORD src1_sel:WORD_1
    v_dot2_f32_bf16 v115, v72, v112, s16
    v_dot2_f32_bf16 v72, v72, v113, s16
    v_dot2_f32_bf16 v116, v73, v112, s16
    v_dot2_f32_bf16 v73, v73, v113, s16
    v_dot2_f32_bf16 v117, v74, v114, s16
    v_dot2_f32_bf16 v74, v74, v18, s16
    v_dot2_f32_bf16 v118, v75, v114, s16
    v_dot2_f32_bf16 v75, v75, v18, s16
    v_perm_b32 v72, v72, v115, s17
    v_perm_b32 v73, v73, v116, s17
    v_perm_b32 v74, v74, v117, s17
    v_perm_b32 v75, v75, v118, s17
    v_lshl_add_u64 v[72:73], v[72:73], 0, s[20:21]
    v_lshl_add_u64 v[74:75], v[74:75], 0, s[20:21]
    s_waitcnt lgkmcnt(0)
    v_or3_b32 v4, v108, v109, v4
    v_or3_b32 v4, v110, v111, v4
    s_not_b64 exec, s[52:53]
    ds_add_rtn_u64 v[108:109], v16, v[72:73]
    s_not_b64 exec, s[54:55]
    ds_add_rtn_u64 v[110:111], v17, v[74:75]
    s_mov_b64 exec, -1
    s_cmp_le_u32 s29, 384
    s_cbranch_scc1 L_p2_kernel_norare_3
    v_readlane_b32 s42, v7, 24
    v_readlane_b32 s43, v7, 26
    s_nop 1
    v_mbcnt_lo_u32_b32 v60, s42, 0
    v_mbcnt_hi_u32_b32 v60, s43, v60
    s_bcnt1_i32_b64 s14, s[42:43]
    v_lshl_add_u32 v61, v60, 1, s25
    ds_read_u16 v61, v61
    v_mad_u32_u24 v60, v60, s23, v2
    s_mov_b32 s42, s26
    s_lshl1_add_u32 s25, s14, s25
    s_mul_i32 s14, s14, s23
    s_add_u32 s26, s26, s14
    s_add_u32 s26, s26, 768
    v_readlane_b32 s96, v7, 40
    v_readlane_b32 s97, v7, 41
    v_readlane_b32 s98, v7, 25
    v_readlane_b32 s99, v7, 27
    s_waitcnt lgkmcnt(0)
    v_mad_u32_u24 v60, v61, 12, v60
    s_nand_b64 exec, s[96:97], s[98:99]
    buffer_load_dwordx3 v[60:62], v60, s[4:7], s42 offen
    s_mov_b64 exec, -1
L_p2_kernel_norare_3:
    s_barrier
    s_waitcnt vmcnt(7)
    ds_write_b128 v3, v[88:91] offset:0
    ds_write_b128 v3, v[92:95] offset:16384
    ds_write_b128 v3, v[96:99] offset:32768
    ds_write_b128 v3, v[100:103] offset:49152
    ds_write_b128 v124, v[104:107]
    s_add_u32 s22, s22, 80000
    v_and_b32 v112, 0xffff, v22
    v_lshrrev_b32 v114, 16, v22
    v_lshlrev_b32 v113, 16, v22
    v_and_b32 v22, 0xffff0000, v22
    v_lshlrev_b32_sdwa v20, 3, v20 dst_sel:DWORD dst_unused:UNUSED_PAD src0_sel:DWORD src1_sel:WORD_1
    v_lshlrev_b32_sdwa v21, 3, v21 dst_sel:DWORD dst_unused:UNUSED_PAD src0_sel:DWORD src1_sel:WORD_1
    v_dot2_f32_bf16 v115, v76, v112, s16
    v_dot2_f32_bf16 v76, v76, v113, s16
    v_dot2_f32_bf16 v116, v77, v112, s16
    v_dot2_f32_bf16 v77, v77, v113, s16
    v_dot2_f32_bf16 v117, v78, v114, s16
    v_dot2_f32_bf16 v78, v78, v22, s16
    v_dot2_f32_bf16 v118, v79, v114, s16
    v_dot2_f32_bf16 v79, v79, v22, s16
    v_perm_b32 v76, v76, v115, s17
    v_perm_b32 v77, v77, v116, s17
    v_perm_b32 v78, v78, v117, s17
    v_perm_b32 v79, v79, v118, s17
    v_lshl_add_u64 v[76:77], v[76:77], 0, s[20:21]
    v_lshl_add_u64 v[78:79], v[78:79], 0, s[20:21]
    s_waitcnt lgkmcnt(5)
    v_or3_b32 v4, v108, v109, v4
    v_or3_b32 v4, v110, v111, v4
    s_not_b64 exec, s[56:57]
    ds_add_rtn_u64 v[108:109], v20, v[76:77]
    s_not_b64 exec, s[58:59]
    ds_add_rtn_u64 v[110:111], v21, v[78:79]
    s_mov_b64 exec, -1
    s_add_u32 s14, s22, 0
    buffer_load_dwordx4 v[88:91], v1, s[8:11], s14 offen
    s_add_u32 s14, s22, 16384
    buffer_load_dwordx4 v[92:95], v1, s[8:11], s14 offen
    v_and_b32 v112, 0xffff, v26
    v_lshrrev_b32 v114, 16, v26
    v_lshlrev_b32 v113, 16, v26
    v_and_b32 v26, 0xffff0000, v26
    v_lshlrev_b32_sdwa v24, 3, v24 dst_sel:DWORD dst_unused:UNUSED_PAD src0_sel:DWORD src1_sel:WORD_1
    v_lshlrev_b32_sdwa v25, 3, v25 dst_sel:DWORD dst_unused:UNUSED_PAD src0_sel:DWORD src1_sel:WORD_1
    v_dot2_f32_bf16 v115, v80, v112, s16
    v_dot2_f32_bf16 v80, v80, v113, s16
    v_dot2_f32_bf16 v116, v81, v112, s16
    v_dot2_f32_bf16 v81, v81, v113, s16
    v_dot2_f32_bf16 v117, v82, v114, s16
    v_dot2_f32_bf16 v82, v82, v26, s16
    v_dot2_f32_bf16 v118, v83, v114, s16
    v_dot2_f32_bf16 v83, v83, v26, s16
    v_perm_b32 v80, v80, v115, s17
    v_perm_b32 v81, v81, v116, s17
    v_perm_b32 v82, v82, v117, s17
    v_perm_b32 v83, v83, v118, s17
    v_lshl_add_u64 v[80:81], v[80:81], 0, s[20:21]
    v_lshl_add_u64 v[82:83], v[82:83], 0, s[20:21]
    s_waitcnt lgkmcnt(0)
    v_or3_b32 v4, v108, v109, v4
    v_or3_b32 v4, v110, v111, v4
    s_not_b64 exec, s[60:61]
    ds_add_rtn_u64 v[108:109], v24, v[80:81]
    s_not_b64 exec, s[62:63]
    ds_add_rtn_u64 v[110:111], v25, v[82:83]
    s_mov_b64 exec, -1
    s_add_u32 s14, s22, 32768
    buffer_load_dwordx4 v[96:99], v1, s[8:11], s14 offen
    s_add_u32 s14, s22, 49152
    buffer_load_dwordx4 v[100:103], v1, s[8:11], s14 offen
    v_and_b32 v112, 0xffff, v30
    v_lshrrev_b32 v114, 16, v30
    v_lshlrev_b32 v113, 16, v30
    v_and_b32 v30, 0xffff0000, v30
    v_lshlrev_b32_sdwa v28, 3, v28 dst_sel:DWORD dst_unused:UNUSED_PAD src0_sel:DWORD src1_sel:WORD_1
    v_lshlrev_b32_sdwa v29, 3, v29 dst_sel:DWORD dst_unused:UNUSED_PAD src0_sel:DWORD src1_sel:WORD_1
    v_dot2_f32_bf16 v115, v84, v112, s16
    v_dot2_f32_bf16 v84, v84, v113, s16
    v_dot2_f32_bf16 v116, v85, v112, s16
    v_dot2_f32_bf16 v85, v85, v113, s16
    v_dot2_f32_bf16 v117, v86, v114, s16
    v_dot2_f32_bf16 v86, v86, v30, s16
    v_dot2_f32_bf16 v118, v87, v114, s16
    v_dot2_f32_bf16 v87, v87, v30, s16
    v_perm_b32 v84, v84, v115, s17
    v_perm_b32 v85, v85, v116, s17
    v_perm_b32 v86, v86, v117, s17
    v_perm_b32 v87, v87, v118, s17
    v_lshl_add_u64 v[84:85], v[84:85], 0, s[20:21]
    v_lshl_add_u64 v[86:87], v[86:87], 0, s[20:21]
    s_waitcnt lgkmcnt(0)
    v_or3_b32 v4, v108, v109, v4
    v_or3_b32 v4, v110, v111, v4
    s_not_b64 exec, s[64:65]
    ds_add_rtn_u64 v[108:109], v28, v[84:85]
    s_not_b64 exec, s[66:67]
    ds_add_rtn_u64 v[110:111], v29, v[86:87]
    s_mov_b64 exec, -1
    s_add_u32 s14, s22, 65536
    buffer_load_dwordx4 v[104:107], v1, s[8:11], s14 offen
    v_mov_b32 v11, v15
    v_mov_b32 v43, v47
    v_mov_b32 v15, v19
    v_mov_b32 v47, v51
    v_mov_b32 v19, v23
    v_mov_b32 v51, v55
    v_mov_b32 v23, v27
    v_mov_b32 v55, v59
    v_mov_b32 v27, v31
    v_mov_b32 v59, v63
    v_mov_b32 v31, v35
    v_mov_b32 v63, v122
    v_mov_b32 v35, v39
    v_mov_b32 v122, v123
    v_mov_b32 v39, 0
    v_mov_b32 v123, 0
    v_lshrrev_b32_sdwa v112, 1, v11 dst_sel:DWORD dst_unused:UNUSED_PAD src0_sel:DWORD src1_sel:WORD_0
    v_add_u32_sdwa v113, 1, v43 dst_sel:DWORD dst_unused:UNUSED_PAD src0_sel:DWORD src1_sel:WORD_0
    v_lshrrev_b32 v113, 1, v113
    v_sub_u32 v113, v113, v112
    v_cmp_eq_u32 vcc, 0, v113
    v_max_u32 v113, 1, v113
    v_mov_b32 v114, v113
    v_and_b32_sdwa v115, 1, v11 dst_sel:DWORD dst_unused:UNUSED_PAD src0_sel:DWORD src1_sel:WORD_0
    v_and_b32_sdwa v116, 1, v43 dst_sel:DWORD dst_unused:UNUSED_PAD src0_sel:DWORD src1_sel:WORD_0
    v_add_u32_dpp v114, v114, v114 row_shr:1 row_mask:0xf bank_mask:0xf bound_ctrl:0
    v_cndmask_b32 v115, v115, v113, vcc
    v_cndmask_b32 v116, v116, v113, vcc
    v_add_u32_dpp v114, v114, v114 row_shr:2 row_mask:0xf bank_mask:0xf bound_ctrl:0
    v_add_u32 v112, 448, v112
    s_nop 0
    v_add_u32_dpp v114, v114, v114 row_shr:4 row_mask:0xf bank_mask:0xf bound_ctrl:0
    s_nop 1
    v_add_u32_dpp v114, v114, v114 row_shr:8 row_mask:0xf bank_mask:0xf bound_ctrl:0
    s_nop 1
    v_add_u32_dpp v114, v114, v114 row_bcast:15 row_mask:0xa bank_mask:0xf
    s_nop 1
    v_add_u32_dpp v114, v114, v114 row_bcast:31 row_mask:0xc bank_mask:0xf
    s_nop 0
    v_readlane_b32 s28, v114, 63
    v_sub_u32 v113, v114, v113
    v_add_u32 v114, -1, v114
    v_sub_u32 v112, v112, v113
    s_cmp_gt_u32 s28, 448
    s_cselect_b32 s28, 0, s28
    s_cselect_b32 s2, 1, s2
    s_cselect_b64 vcc, 0, -1
    v_sub_u32 v117, s28, v5
    v_med3_i32 v117, v117, 0, 32
    v_lshlrev_b64 v[118:119], v117, -1
    v_lshlrev_b32 v115, v113, v115
    v_lshrrev_b32 v113, 5, v113
    ds_write_b32 v6, v118
    v_lshl_add_u32 v113, v113, 2, s19
    v_lshlrev_b32 v119, v114, v116
    v_lshlrev_b32_e64 v118, v114, 1
    v_lshrrev_b32 v114, 5, v114
    v_lshl_add_u32 v114, v114, 3, s19
    s_mov_b64 exec, vcc
    ds_or_b32 v113, v115 offset:112
    ds_or_b64 v114, v[118:119]
    s_mov_b64 exec, -1
    ds_read_b32 v7, v6
    ds_write_b16 v126, v112
    s_barrier
    s_cmp_le_u32 s29, 384
    s_cbranch_scc1 L_p2_kernel_norare2_4
    s_waitcnt vmcnt(0)
    v_mad_u32_u16 v64, v60, 8, s18
    v_mad_u32_u16 v66, v61, 8, s18
    ds_read_b64 v[64:65], v64
    ds_read_b64 v[66:67], v66
    v_and_b32 v112, 0xffff, v62
    v_lshrrev_b32 v114, 16, v62
    v_lshlrev_b32 v113, 16, v62
    v_and_b32 v62, 0xffff0000, v62
    v_lshlrev_b32_sdwa v60, 3, v60 dst_sel:DWORD dst_unused:UNUSED_PAD src0_sel:DWORD src1_sel:WORD_1
    v_lshlrev_b32_sdwa v61, 3, v61 dst_sel:DWORD dst_unused:UNUSED_PAD src0_sel:DWORD src1_sel:WORD_1
    s_waitcnt lgkmcnt(0)
    v_dot2_f32_bf16 v115, v64, v112, s16
    v_dot2_f32_bf16 v64, v64, v113, s16
    v_dot2_f32_bf16 v116, v65, v112, s16
    v_dot2_f32_bf16 v65, v65, v113, s16
    v_dot2_f32_bf16 v117, v66, v114, s16
    v_dot2_f32_bf16 v66, v66, v62, s16
    v_dot2_f32_bf16 v118, v67, v114, s16
    v_dot2_f32_bf16 v67, v67, v62, s16
    v_perm_b32 v64, v64, v115, s17
    v_perm_b32 v65, v65, v116, s17
    v_perm_b32 v66, v66, v117, s17
    v_perm_b32 v67, v67, v118, s17
    v_lshl_add_u64 v[64:65], v[64:65], 0, s[20:21]
    v_lshl_add_u64 v[66:67], v[66:67], 0, s[20:21]
    v_or3_b32 v4, v108, v109, v4
    v_or3_b32 v4, v110, v111, v4
    s_not_b64 exec, s[96:97]
    ds_add_rtn_u64 v[108:109], v60, v[64:65]
    s_not_b64 exec, s[98:99]
    ds_add_rtn_u64 v[110:111], v61, v[66:67]
    s_mov_b64 exec, -1
    s_waitcnt lgkmcnt(0)
L_p2_kernel_norare2_4:
    s_waitcnt lgkmcnt(1)
    v_readlane_b32 s30, v7, 0
    v_readlane_b32 s31, v7, 2
    v_readlane_b32 s32, v7, 4
    v_readlane_b32 s33, v7, 6
    v_readlane_b32 s34, v7, 8
    v_readlane_b32 s35, v7, 10
    v_readlane_b32 s36, v7, 12
    v_readlane_b32 s37, v7, 14
    v_readlane_b32 s38, v7, 16
    v_readlane_b32 s39, v7, 18
    v_readlane_b32 s40, v7, 20
    v_readlane_b32 s41, v7, 22
    s_mov_b32 s25, s19
    s_mov_b32 s26, s27
    s_and_b32 s14, s101, 3
    s_lshl_b32 s14, s14, 8
    s_lshr_b32 s15, s101, 2
    s_lshl_b32 s15, s15, 14
    s_add_u32 s14, s14, s15
    s_add_u32 s14, s14, s22
    s_add_u32 s14, s14, 80000
    s_mov_b64 exec, 0x101
    buffer_load_dword v125, v1, s[8:11], s14 offen
    s_mov_b64 exec, -1
    s_waitcnt vmcnt(11)
    v_mad_u32_u16 v64, v36, 8, s18
    v_mad_u32_u16 v66, v37, 8, s18
    ds_read_b64 v[64:65], v64
    ds_read_b64 v[66:67], v66
    v_mbcnt_lo_u32_b32 v8, s30, 0
    v_mbcnt_hi_u32_b32 v8, s31, v8
    s_bcnt1_i32_b64 s14, s[30:31]
    v_lshl_add_u32 v9, v8, 1, s25
    ds_read_u16 v9, v9
    v_mad_u32_u24 v8, v8, s23, v2
    s_mov_b32 s30, s26
    s_lshl1_add_u32 s25, s14, s25
    s_mul_i32 s14, s14, s23
    s_add_u32 s26, s26, s14
    s_add_u32 s26, s26, 768
    v_readlane_b32 s44, v7, 28
    v_readlane_b32 s45, v7, 29
    v_readlane_b32 s46, v7, 1
    v_readlane_b32 s47, v7, 3
    s_waitcnt vmcnt(10)
    v_mad_u32_u16 v68, v40, 8, s18
    v_mad_u32_u16 v70, v41, 8, s18
    ds_read_b64 v[68:69], v68
    ds_read_b64 v[70:71], v70
    v_mbcnt_lo_u32_b32 v12, s32, 0
    v_mbcnt_hi_u32_b32 v12, s33, v12
    s_bcnt1_i32_b64 s14, s[32:33]
    v_lshl_add_u32 v13, v12, 1, s25
    ds_read_u16 v13, v13
    v_mad_u32_u24 v12, v12, s23, v2
    s_mov_b32 s32, s26
    s_lshl1_add_u32 s25, s14, s25
    s_mul_i32 s14, s14, s23
    s_add_u32 s26, s26, s14
    s_add_u32 s26, s26, 768
    v_readlane_b32 s48, v7, 30
    v_readlane_b32 s49, v7, 31
    v_readlane_b32 s50, v7, 5
    v_readlane_b32 s51, v7, 7
    s_waitcnt vmcnt(9)
    v_mad_u32_u16 v72, v44, 8, s18
    v_mad_u32_u16 v74, v45, 8, s18
    ds_read_b64 v[72:73], v72
    ds_read_b64 v[74:75], v74
    v_mbcnt_lo_u32_b32 v16, s34, 0
    v_mbcnt_hi_u32_b32 v16, s35, v16
    s_bcnt1_i32_b64 s14, s[34:35]
    v_lshl_add_u32 v17, v16, 1, s25
    ds_read_u16 v17, v17
    v_mad_u32_u24 v16, v16, s23, v2
    s_mov_b32 s34, s26
    s_lshl1_add_u32 s25, s14, s25
    s_mul_i32 s14, s14, s23
    s_add_u32 s26, s26, s14
    s_add_u32 s26, s26, 768
    v_readlane_b32 s52, v7, 32
    v_readlane_b32 s53, v7, 33
    v_readlane_b32 s54, v7, 9
    v_readlane_b32 s55, v7, 11
    s_waitcnt vmcnt(8)
    v_mad_u32_u16 v76, v48, 8, s18
    v_mad_u32_u16 v78, v49, 8, s18
    ds_read_b64 v[76:77], v76
    ds_read_b64 v[78:79], v78
    v_mbcnt_lo_u32_b32 v20, s36, 0
    v_mbcnt_hi_u32_b32 v20, s37, v20
    s_bcnt1_i32_b64 s14, s[36:37]
    v_lshl_add_u32 v21, v20, 1, s25
    ds_read_u16 v21, v21
    v_mad_u32_u24 v20, v20, s23, v2
    s_mov_b32 s36, s26
    s_lshl1_add_u32 s25, s14, s25
    s_mul_i32 s14, s14, s23
    s_add_u32 s26, s26, s14
    s_add_u32 s26, s26, 768
    v_readlane_b32 s56, v7, 34
    v_readlane_b32 s57, v7, 35
    v_readlane_b32 s58, v7, 13
    v_readlane_b32 s59, v7, 15
    s_waitcnt vmcnt(7)
    v_mad_u32_u16 v80, v52, 8, s18
    v_mad_u32_u16 v82, v53, 8, s18
    ds_read_b64 v[80:81], v80
    ds_read_b64 v[82:83], v82
    v_mbcnt_lo_u32_b32 v24, s38, 0
    v_mbcnt_hi_u32_b32 v24, s39, v24
    s_bcnt1_i32_b64 s14, s[38:39]
    v_lshl_add_u32 v25, v24, 1, s25
    ds_read_u16 v25, v25
    v_mad_u32_u24 v24, v24, s23, v2
    s_mov_b32 s38, s26
    s_lshl1_add_u32 s25, s14, s25
    s_mul_i32 s14, s14, s23
    s_add_u32 s26, s26, s14
    s_add_u32 s26, s26, 768
    v_readlane_b32 s60, v7, 36
    v_readlane_b32 s61, v7, 37
    v_readlane_b32 s62, v7, 17
    v_readlane_b32 s63, v7, 19
    s_waitcnt vmcnt(6)
    v_mad_u32_u16 v84, v56, 8, s18
    v_mad_u32_u16 v86, v57, 8, s18
    ds_read_b64 v[84:85], v84
    ds_read_b64 v[86:87], v86
    v_mbcnt_lo_u32_b32 v28, s40, 0
    v_mbcnt_hi_u32_b32 v28, s41, v28
    s_bcnt1_i32_b64 s14, s[40:41]
    v_lshl_add_u32 v29, v28, 1, s25
    ds_read_u16 v29, v29
    v_mad_u32_u24 v28, v28, s23, v2
    s_mov_b32 s40, s26
    s_lshl1_add_u32 s25, s14, s25
    s_mul_i32 s14, s14, s23
    s_add_u32 s26, s26, s14
    s_add_u32 s26, s26, 768
    v_readlane_b32 s64, v7, 38
    v_readlane_b32 s65, v7, 39
    v_readlane_b32 s66, v7, 21
    v_readlane_b32 s67, v7, 23
    s_waitcnt lgkmcnt(15)
    v_mad_u32_u24 v8, v9, 12, v8
    s_nand_b64 exec, s[44:45], s[46:47]
    buffer_load_dwordx3 v[8:10], v8, s[4:7], s30 offen
    s_mov_b64 exec, -1
    s_waitcnt lgkmcnt(12)
    v_mad_u32_u24 v12, v13, 12, v12
    s_nand_b64 exec, s[48:49], s[50:51]
    buffer_load_dwordx3 v[12:14], v12, s[4:7], s32 offen
    s_mov_b64 exec, -1
    v_and_b32 v112, 0xffff, v38
    v_lshrrev_b32 v114, 16, v38
    v_lshlrev_b32 v113, 16, v38
    v_and_b32 v38, 0xffff0000, v38
    v_lshlrev_b32_sdwa v36, 3, v36 dst_sel:DWORD dst_unused:UNUSED_PAD src0_sel:DWORD src1_sel:WORD_1
    v_lshlrev_b32_sdwa v37, 3, v37 dst_sel:DWORD dst_unused:UNUSED_PAD src0_sel:DWORD src1_sel:WORD_1
    v_dot2_f32_bf16 v115, v64, v112, s16
    v_dot2_f32_bf16 v64, v64, v113, s16
    v_dot2_f32_bf16 v116, v65, v112, s16
    v_dot2_f32_bf16 v65, v65, v113, s16
    v_dot2_f32_bf16 v117, v66, v114, s16
    v_dot2_f32_bf16 v66, v66, v38, s16
    v_dot2_f32_bf16 v118, v67, v114, s16
    v_dot2_f32_bf16 v67, v67, v38, s16
    v_perm_b32 v64, v64, v115, s17
    v_perm_b32 v65, v65, v116, s17
    v_perm_b32 v66, v66, v117, s17
    v_perm_b32 v67, v67, v118, s17
    v_lshl_add_u64 v[64:65], v[64:65], 0, s[20:21]
    v_lshl_add_u64 v[66:67], v[66:67], 0, s[20:21]
    v_or3_b32 v4, v108, v109, v4
    v_or3_b32 v4, v110, v111, v4
    s_not_b64 exec, s[72:73]
    ds_add_rtn_u64 v[108:109], v36, v[64:65]
    s_not_b64 exec, s[74:75]
    ds_add_rtn_u64 v[110:111], v37, v[66:67]
    s_mov_b64 exec, -1
    s_waitcnt lgkmcnt(11)
    v_mad_u32_u24 v16, v17, 12, v16
    s_nand_b64 exec, s[52:53], s[54:55]
    buffer_load_dwordx3 v[16:18], v16, s[4:7], s34 offen
    s_mov_b64 exec, -1
    s_waitcnt lgkmcnt(8)
    v_mad_u32_u24 v20, v21, 12, v20
    s_nand_b64 exec, s[56:57], s[58:59]
    buffer_load_dwordx3 v[20:22], v20, s[4:7], s36 offen
    s_mov_b64 exec, -1
    v_and_b32 v112, 0xffff, v42
    v_lshrrev_b32 v114, 16, v42
    v_lshlrev_b32 v113, 16, v42
    v_and_b32 v42, 0xffff0000, v42
    v_lshlrev_b32_sdwa v40, 3, v40 dst_sel:DWORD dst_unused:UNUSED_PAD src0_sel:DWORD src1_sel:WORD_1
    v_lshlrev_b32_sdwa v41, 3, v41 dst_sel:DWORD dst_unused:UNUSED_PAD src0_sel:DWORD src1_sel:WORD_1
    v_dot2_f32_bf16 v115, v68, v112, s16
    v_dot2_f32_bf16 v68, v68, v113, s16
    v_dot2_f32_bf16 v116, v69, v112, s16
    v_dot2_f32_bf16 v69, v69, v113, s16
    v_dot2_f32_bf16 v117, v70, v114, s16
    v_dot2_f32_bf16 v70, v70, v42, s16
    v_dot2_f32_bf16 v118, v71, v114, s16
    v_dot2_f32_bf16 v71, v71, v42, s16
    v_perm_b32 v68, v68, v115, s17
    v_perm_b32 v69, v69, v116, s17
    v_perm_b32 v70, v70, v117, s17
    v_perm_b32 v71, v71, v118, s17
    v_lshl_add_u64 v[68:69], v[68:69], 0, s[20:21]
    v_lshl_add_u64 v[70:71], v[70:71], 0, s[20:21]
    s_waitcnt lgkmcnt(0)
    v_or3_b32 v4, v108, v109, v4
    v_or3_b32 v4, v110, v111, v4
    s_not_b64 exec, s[76:77]
    ds_add_rtn_u64 v[108:109], v40, v[68:69]
    s_not_b64 exec, s[78:79]
    ds_add_rtn_u64 v[110:111], v41, v[70:71]
    s_mov_b64 exec, -1
    v_mad_u32_u24 v24, v25, 12, v24
    s_nand_b64 exec, s[60:61], s[62:63]
    buffer_load_dwordx3 v[24:26], v24, s[4:7], s38 offen
    s_mov_b64 exec, -1
    v_mad_u32_u24 v28, v29, 12, v28
    s_nand_b64 exec, s[64:65], s[66:67]
    buffer_load_dwordx3 v[28:30], v28, s[4:7], s40 offen
    s_mov_b64 exec, -1
    v_and_b32 v112, 0xffff, v46
    v_lshrrev_b32 v114, 16, v46
    v_lshlrev_b32 v113, 16, v46
    v_and_b32 v46, 0xffff0000, v46
    v_lshlrev_b32_sdwa v44, 3, v44 dst_sel:DWORD dst_unused:UNUSED_PAD src0_sel:DWORD src1_sel:WORD_1
    v_lshlrev_b32_sdwa v45, 3, v45 dst_sel:DWORD dst_unused:UNUSED_PAD src0_sel:DWORD src1_sel:WORD_1
    v_dot2_f32_bf16 v115, v72, v112, s16
    v_dot2_f32_bf16 v72, v72, v113, s16
    v_dot2_f32_bf16 v116, v73, v112, s16
    v_dot2_f32_bf16 v73, v73, v113, s16
    v_dot2_f32_bf16 v117, v74, v114, s16
    v_dot2_f32_bf16 v74, v74, v46, s16
    v_dot2_f32_bf16 v118, v75, v114, s16
    v_dot2_f32_bf16 v75, v75, v46, s16
    v_perm_b32 v72, v72, v115, s17
    v_perm_b32 v73, v73, v116, s17
    v_perm_b32 v74, v74, v117, s17
    v_perm_b32 v75, v75, v118, s17
    v_lshl_add_u64 v[72:73], v[72:73], 0, s[20:21]
    v_lshl_add_u64 v[74:75], v[74:75], 0, s[20:21]
    s_waitcnt lgkmcnt(0)
    v_or3_b32 v4, v108, v109, v4
    v_or3_b32 v4, v110, v111, v4
    s_not_b64 exec, s[80:81]
    ds_add_rtn_u64 v[108:109], v44, v[72:73]
    s_not_b64 exec, s[82:83]
    ds_add_rtn_u64 v[110:111], v45, v[74:75]
    s_mov_b64 exec, -1
    s_cmp_le_u32 s28, 384
    s_cbranch_scc1 L_p2_kernel_norare_5
    v_readlane_b32 s42, v7, 24
    v_readlane_b32 s43, v7, 26
    s_nop 1
    v_mbcnt_lo_u32_b32 v32, s42, 0
    v_mbcnt_hi_u32_b32 v32, s43, v32
    s_bcnt1_i32_b64 s14, s[42:43]
    v_lshl_add_u32 v33, v32, 1, s25
    ds_read_u16 v33, v33
    v_mad_u32_u24 v32, v32, s23, v2
    s_mov_b32 s42, s26
    s_lshl1_add_u32 s25, s14, s25
    s_mul_i32 s14, s14, s23
    s_add_u32 s26, s26, s14
    s_add_u32 s26, s26, 768
    v_readlane_b32 s68, v7, 40
    v_readlane_b32 s69, v7, 41
    v_readlane_b32 s70, v7, 25
    v_readlane_b32 s71, v7, 27
    s_waitcnt lgkmcnt(0)
    v_mad_u32_u24 v32, v33, 12, v32
    s_nand_b64 exec, s[68:69], s[70:71]
    buffer_load_dwordx3 v[32:34], v32, s[4:7], s42 offen
    s_mov_b64 exec, -1
L_p2_kernel_norare_5:
    s_barrier
    s_waitcnt vmcnt(7)
    ds_write_b128 v3, v[88:91] offset:0
    ds_write_b128 v3, v[92:95] offset:16384
    ds_write_b128 v3, v[96:99] offset:32768
    ds_write_b128 v3, v[100:103] offset:49152
    ds_write_b128 v124, v[104:107]
    s_add_u32 s22, s22, 80000
    v_and_b32 v112, 0xffff, v50
    v_lshrrev_b32 v114, 16, v50
    v_lshlrev_b32 v113, 16, v50
    v_and_b32 v50, 0xffff0000, v50
    v_lshlrev_b32_sdwa v48, 3, v48 dst_sel:DWORD dst_unused:UNUSED_PAD src0_sel:DWORD src1_sel:WORD_1
    v_lshlrev_b32_sdwa v49, 3, v49 dst_sel:DWORD dst_unused:UNUSED_PAD src0_sel:DWORD src1_sel:WORD_1
    v_dot2_f32_bf16 v115, v76, v112, s16
    v_dot2_f32_bf16 v76, v76, v113, s16
    v_dot2_f32_bf16 v116, v77, v112, s16
    v_dot2_f32_bf16 v77, v77, v113, s16
    v_dot2_f32_bf16 v117, v78, v114, s16
    v_dot2_f32_bf16 v78, v78, v50, s16
    v_dot2_f32_bf16 v118, v79, v114, s16
    v_dot2_f32_bf16 v79, v79, v50, s16
    v_perm_b32 v76, v76, v115, s17
    v_perm_b32 v77, v77, v116, s17
    v_perm_b32 v78, v78, v117, s17
    v_perm_b32 v79, v79, v118, s17
    v_lshl_add_u64 v[76:77], v[76:77], 0, s[20:21]
    v_lshl_add_u64 v[78:79], v[78:79], 0, s[20:21]
    s_waitcnt lgkmcnt(5)
    v_or3_b32 v4, v108, v109, v4
    v_or3_b32 v4, v110, v111, v4
    s_not_b64 exec, s[84:85]
    ds_add_rtn_u64 v[108:109], v48, v[76:77]
    s_not_b64 exec, s[86:87]
    ds_add_rtn_u64 v[110:111], v49, v[78:79]
    s_mov_b64 exec, -1
    s_add_u32 s14, s22, 0
    buffer_load_dwordx4 v[88:91], v1, s[8:11], s14 offen
    s_add_u32 s14, s22, 16384
    buffer_load_dwordx4 v[92:95], v1, s[8:11], s14 offen
    v_and_b32 v112, 0xffff, v54
    v_lshrrev_b32 v114, 16, v54
    v_lshlrev_b32 v113, 16, v54
    v_and_b32 v54, 0xffff0000, v54
    v_lshlrev_b32_sdwa v52, 3, v52 dst_sel:DWORD dst_unused:UNUSED_PAD src0_sel:DWORD src1_sel:WORD_1
    v_lshlrev_b32_sdwa v53, 3, v53 dst_sel:DWORD dst_unused:UNUSED_PAD src0_sel:DWORD src1_sel:WORD_1
    v_dot2_f32_bf16 v115, v80, v112, s16
    v_dot2_f32_bf16 v80, v80, v113, s16
    v_dot2_f32_bf16 v116, v81, v112, s16
    v_dot2_f32_bf16 v81, v81, v113, s16
    v_dot2_f32_bf16 v117, v82, v114, s16
    v_dot2_f32_bf16 v82, v82, v54, s16
    v_dot2_f32_bf16 v118, v83, v114, s16
    v_dot2_f32_bf16 v83, v83, v54, s16
    v_perm_b32 v80, v80, v115, s17
    v_perm_b32 v81, v81, v116, s17
    v_perm_b32 v82, v82, v117, s17
    v_perm_b32 v83, v83, v118, s17
    v_lshl_add_u64 v[80:81], v[80:81], 0, s[20:21]
    v_lshl_add_u64 v[82:83], v[82:83], 0, s[20:21]
    s_waitcnt lgkmcnt(0)
    v_or3_b32 v4, v108, v109, v4
    v_or3_b32 v4, v110, v111, v4
    s_not_b64 exec, s[88:89]
    ds_add_rtn_u64 v[108:109], v52, v[80:81]
    s_not_b64 exec, s[90:91]
    ds_add_rtn_u64 v[110:111], v53, v[82:83]
    s_mov_b64 exec, -1
    s_add_u32 s14, s22, 32768
    buffer_load_dwordx4 v[96:99], v1, s[8:11], s14 offen
    s_add_u32 s14, s22, 49152
    buffer_load_dwordx4 v[100:103], v1, s[8:11], s14 offen
    v_and_b32 v112, 0xffff, v58
    v_lshrrev_b32 v114, 16, v58
    v_lshlrev_b32 v113, 16, v58
    v_and_b32 v58, 0xffff0000, v58
    v_lshlrev_b32_sdwa v56, 3, v56 dst_sel:DWORD dst_unused:UNUSED_PAD src0_sel:DWORD src1_sel:WORD_1
    v_lshlrev_b32_sdwa v57, 3, v57 dst_sel:DWORD dst_unused:UNUSED_PAD src0_sel:DWORD src1_sel:WORD_1
    v_dot2_f32_bf16 v115, v84, v112, s16
    v_dot2_f32_bf16 v84, v84, v113, s16
    v_dot2_f32_bf16 v116, v85, v112, s16
    v_dot2_f32_bf16 v85, v85, v113, s16
    v_dot2_f32_bf16 v117, v86, v114, s16
    v_dot2_f32_bf16 v86, v86, v58, s16
    v_dot2_f32_bf16 v118, v87, v114, s16
    v_dot2_f32_bf16 v87, v87, v58, s16
    v_perm_b32 v84, v84, v115, s17
    v_perm_b32 v85, v85, v116, s17
    v_perm_b32 v86, v86, v117, s17
    v_perm_b32 v87, v87, v118, s17
    v_lshl_add_u64 v[84:85], v[84:85], 0, s[20:21]
    v_lshl_add_u64 v[86:87], v[86:87], 0, s[20:21]
    s_waitcnt lgkmcnt(0)
    v_or3_b32 v4, v108, v109, v4
    v_or3_b32 v4, v110, v111, v4
    s_not_b64 exec, s[92:93]
    ds_add_rtn_u64 v[108:109], v56, v[84:85]
    s_not_b64 exec, s[94:95]
    ds_add_rtn_u64 v[110:111], v57, v[86:87]
    s_mov_b64 exec, -1
    s_add_u32 s14, s22, 65536
    buffer_load_dwordx4 v[104:107], v1, s[8:11], s14 offen
    v_lshrrev_b32_sdwa v112, 1, v11 dst_sel:DWORD dst_unused:UNUSED_PAD src0_sel:DWORD src1_sel:WORD_1
    v_add_u32_sdwa v113, 1, v43 dst_sel:DWORD dst_unused:UNUSED_PAD src0_sel:DWORD src1_sel:WORD_1
    v_lshrrev_b32 v113, 1, v113
    v_sub_u32 v113, v113, v112
    v_cmp_eq_u32 vcc, 0, v113
    v_max_u32 v113, 1, v113
    v_mov_b32 v114, v113
    v_and_b32_sdwa v115, 1, v11 dst_sel:DWORD dst_unused:UNUSED_PAD src0_sel:DWORD src1_sel:WORD_1
    v_and_b32_sdwa v116, 1, v43 dst_sel:DWORD dst_unused:UNUSED_PAD src0_sel:DWORD src1_sel:WORD_1
    v_add_u32_dpp v114, v114, v114 row_shr:1 row_mask:0xf bank_mask:0xf bound_ctrl:0
    v_cndmask_b32 v115, v115, v113, vcc
    v_cndmask_b32 v116, v116, v113, vcc
    v_add_u32_dpp v114, v114, v114 row_shr:2 row_mask:0xf bank_mask:0xf bound_ctrl:0
    v_add_u32 v112, 448, v112
    s_nop 0
    v_add_u32_dpp v114, v114, v114 row_shr:4 row_mask:0xf bank_mask:0xf bound_ctrl:0
    s_nop 1
    v_add_u32_dpp v114, v114, v114 row_shr:8 row_mask:0xf bank_mask:0xf bound_ctrl:0
    s_nop 1
    v_add_u32_dpp v114, v114, v114 row_bcast:15 row_mask:0xa bank_mask:0xf
    s_nop 1
    v_add_u32_dpp v114, v114, v114 row_bcast:31 row_mask:0xc bank_mask:0xf
    s_nop 0
    v_readlane_b32 s29, v114, 63
    v_sub_u32 v113, v114, v113
    v_add_u32 v114, -1, v114
    v_sub_u32 v112, v112, v113
    s_cmp_gt_u32 s29, 448
    s_cselect_b32 s29, 0, s29
    s_cselect_b32 s2, 1, s2
    s_cselect_b64 vcc, 0, -1
    v_sub_u32 v117, s29, v5
    v_med3_i32 v117, v117, 0, 32
    v_lshlrev_b64 v[118:119], v117, -1
    v_lshlrev_b32 v115, v113, v115
    v_lshrrev_b32 v113, 5, v113
    ds_write_b32 v6, v118
    v_lshl_add_u32 v113, v113, 2, s19
    v_lshlrev_b32 v119, v114, v116
    v_lshlrev_b32_e64 v118, v114, 1
    v_lshrrev_b32 v114, 5, v114
    v_lshl_add_u32 v114, v114, 3, s19
    s_mov_b64 exec, vcc
    ds_or_b32 v113, v115 offset:112
    ds_or_b64 v114, v[118:119]
    s_mov_b64 exec, -1
    ds_read_b32 v7, v6
    ds_write_b16 v126, v112
    s_add_u32 s24, s24, 1
    s_cmp_lt_u32 s24, 8
    s_barrier
    s_cbranch_scc1 L_p2_loop
    s_waitcnt lgkmcnt(5)
    v_or3_b32 v4, v108, v109, v4
    v_or3_b32 v4, v110, v111, v4
    s_waitcnt vmcnt(0) lgkmcnt(0)
    s_barrier
    v_subrev_u32 v112, 80000, v124
    ds_read_b128 v[88:91], v1 offset:0
    ds_read_b128 v[92:95], v1 offset:16384
    ds_read_b128 v[96:99], v1 offset:32768
    ds_read_b128 v[100:103], v1 offset:49152
    ds_read_b128 v[104:107], v112
    s_mul_i32 s14, s12, 5120000
    s_mul_i32 s15, s3, 80000
    s_add_u32 s26, s14, s15
    s_add_u32 s26, s26, 254296064
    s_waitcnt lgkmcnt(4)
    s_add_u32 s14, s26, 0
    buffer_store_dwordx4 v[88:91], v1, s[4:7], s14 offen
    v_or3_b32 v4, v88, v89, v4
    v_or3_b32 v4, v90, v91, v4
    s_waitcnt lgkmcnt(3)
    s_add_u32 s14, s26, 16384
    buffer_store_dwordx4 v[92:95], v1, s[4:7], s14 offen
    v_or3_b32 v4, v92, v93, v4
    v_or3_b32 v4, v94, v95, v4
    s_waitcnt lgkmcnt(2)
    s_add_u32 s14, s26, 32768
    buffer_store_dwordx4 v[96:99], v1, s[4:7], s14 offen
    v_or3_b32 v4, v96, v97, v4
    v_or3_b32 v4, v98, v99, v4
    s_waitcnt lgkmcnt(1)
    s_add_u32 s14, s26, 49152
    buffer_store_dwordx4 v[100:103], v1, s[4:7], s14 offen
    v_or3_b32 v4, v100, v101, v4
    v_or3_b32 v4, v102, v103, v4
    s_waitcnt lgkmcnt(0)
    buffer_store_dwordx4 v[104:107], v112, s[4:7], s26 offen
    v_or3_b32 v4, v104, v105, v4
    v_or3_b32 v4, v106, v107, v4
    v_and_b32 v4, 0x80008000, v4
    v_cmp_ne_u32 vcc, 0, v4
    v_mov_b32 v113, s19
    v_and_b32 v115, 15, v0
    v_mul_u32_u24 v115, 240, v115
    v_add_u32 v115, 160000, v115
    s_cmp_lg_u64 vcc, 0
    s_cselect_b32 s2, 1, s2
    v_mov_b32 v114, s2
    s_mov_b64 exec, 1
    ds_write_b32 v113, v114
    s_mov_b64 exec, -1
    s_waitcnt lgkmcnt(0)
    s_barrier
    ds_read_b32 v114, v115
    s_lshl_b32 s14, s3, 4
    s_lshl_b32 s15, s12, 2
    s_add_u32 s25, s14, s15
    s_add_u32 s25, s25, 254291968
    s_waitcnt lgkmcnt(0)
    v_cmp_ne_u32 vcc, 0, v114
    v_mov_b32 v113, 0
    s_nop 1
    s_cmp_lg_u64 vcc, 0
    s_cselect_b32 s14, 0, s100
    v_mov_b32 v114, s14
    s_mov_b64 exec, 1
    buffer_store_dword v114, v113, s[4:7], s25 offen
    s_mov_b64 exec, -1
    s_cbranch_scc0 L_p2_end
    s_barrier
    v_mov_b32 v8, 0
    v_mov_b32 v9, 0
    v_mov_b32 v10, 0
    v_mov_b32 v11, 0
    v_mov_b32 v12, v1
    ds_write_b128 v12, v[8:11]
    v_add_u32 v12, 16384, v12
    ds_write_b128 v12, v[8:11]
    v_add_u32 v12, 16384, v12
    ds_write_b128 v12, v[8:11]
    v_add_u32 v12, 16384, v12
    ds_write_b128 v12, v[8:11]
    v_add_u32 v12, 16384, v12
    ds_write_b128 v12, v[8:11]
    v_add_u32 v12, 16384, v12
    ds_write_b128 v12, v[8:11]
    v_add_u32 v12, 16384, v12
    ds_write_b128 v12, v[8:11]
    v_add_u32 v12, 16384, v12
    ds_write_b128 v12, v[8:11]
    v_add_u32 v12, 16384, v12
    ds_write_b128 v12, v[8:11]
    v_add_u32 v12, 16384, v12
    ds_write_b128 v12, v[8:11]
    v_add_u32 v12, 16384, v12
    v_mul_u32_u24 v13, 8320, v0
    v_mul_lo_u32 v14, v0, s23
    v_add_u32 v14, 8192, v14
    s_mul_i32 s25, s12, 65
    s_add_u32 s25, s25, s3
    s_lshl_b32 s25, s25, 5
    s_add_u32 s25, s25, 245768192
    s_mul_i32 s22, s12, 1280000
    s_mov_b32 s24, 0
    s_waitcnt lgkmcnt(0)
    s_barrier
L_p2_sstep:
    buffer_load_ushort v15, v13, s[4:7], s25 offen
    buffer_load_ushort v16, v13, s[4:7], s25 offen offset:32
    s_waitcnt vmcnt(0)
L_p2_srec:
    v_cmp_lt_u32 vcc, v15, v16
    s_nop 1
    s_and_b64 exec, exec, vcc
    s_cbranch_execz L_p2_sdone
    v_lshrrev_b32 v17, 1, v15
    v_and_b32 v18, 1, v15
    v_mad_u32_u24 v17, v17, 12, v14
    v_lshl_add_u32 v19, v18, 2, v17
    v_lshl_add_u32 v17, v18, 1, v17
    buffer_load_dword v20, v19, s[4:7], 0 offen
    buffer_load_ushort v21, v17, s[4:7], 0 offen offset:8
    v_add_u32 v15, 1, v15
    s_waitcnt vmcnt(0)
    v_lshlrev_b32_sdwa v19, 3, v20 dst_sel:DWORD dst_unused:UNUSED_PAD src0_sel:DWORD src1_sel:WORD_0
    buffer_load_dwordx2 v[22:23], v19, s[8:11], s22 offen
    v_lshlrev_b32_sdwa v20, 4, v20 dst_sel:DWORD dst_unused:UNUSED_PAD src0_sel:DWORD src1_sel:WORD_1
    v_lshlrev_b32 v21, 16, v21
    s_waitcnt vmcnt(0)
    v_lshlrev_b32 v24, 16, v22
    v_and_b32 v25, 0xffff0000, v22
    v_lshlrev_b32 v26, 16, v23
    v_and_b32 v27, 0xffff0000, v23
    v_mul_f32 v24, v21, v24
    v_mul_f32 v25, v21, v25
    v_mul_f32 v26, v21, v26
    v_mul_f32 v27, v21, v27
    ds_add_f32 v20, v24
    ds_add_f32 v20, v25 offset:4
    ds_add_f32 v20, v26 offset:8
    ds_add_f32 v20, v27 offset:12
    s_branch L_p2_srec
L_p2_sdone:
    s_mov_b64 exec, -1
    s_add_u32 s25, s25, 2
    s_add_u32 s22, s22, 80000
    s_add_u32 s24, s24, 1
    s_cmp_lt_u32 s24, 16
    s_cbranch_scc1 L_p2_sstep
    s_waitcnt lgkmcnt(0)
    s_barrier
    s_mul_i32 s14, s12, 10240000
    s_mul_i32 s15, s3, 160000
    s_add_u32 s26, s14, s15
    s_add_u32 s26, s26, 274776064
    v_mov_b32 v12, v1
    s_mov_b32 s24, 0
L_p2_sout:
    v_cmp_gt_u32 vcc, 160000, v12
    ds_read_b128 v[8:11], v12
    s_nop 0
    s_and_b64 exec, exec, vcc
    s_cbranch_execz L_p2_end
    s_waitcnt lgkmcnt(0)
    buffer_store_dwordx4 v[8:11], v12, s[4:7], s26 offen
    s_waitcnt vmcnt(0)
    v_add_u32 v12, 16384, v12
    s_branch L_p2_sout
L_p2_end:
    s_endpgm
.globl p3_kernel
.p2align 8
.type p3_kernel,@function
p3_kernel:
    s_cmp_ge_u32 s2, 1250
    s_cbranch_scc1 L_p3_end
    s_load_dwordx2 s[4:5], s[0:1], 104
    s_load_dwordx2 s[8:9], s[0:1], 0
    s_load_dwordx2 s[12:13], s[0:1], 24
    s_load_dwordx2 s[16:17], s[0:1], 88
    s_load_dwordx2 s[20:21], s[0:1], 40
    s_load_dwordx4 s[24:27], s[0:1], 56
    s_load_dwordx4 s[28:31], s[0:1], 72
    s_lshl_b32 s3, s2, 8
    v_add_u32 v0, s3, v0
    v_lshlrev_b32 v1, 4, v0
    v_lshlrev_b32 v2, 2, v0
    v_mul_hi_u32_u24 v3, 858994, v0
    v_lshlrev_b32 v3, 4, v3
    s_waitcnt lgkmcnt(0)
    s_mov_b32 s6, 655360000
    s_mov_b32 s7, 0x00020000
    s_mov_b32 s10, 5120000
    s_mov_b32 s11, 0x00020000
    s_mov_b32 s14, 1280000
    s_mov_b32 s15, 0x00020000
    s_mov_b32 s18, 5120000
    s_mov_b32 s19, 0x00020000
    s_load_dwordx4 s[96:99], s[20:21], 0
    s_load_dwordx16 s[32:47], s[24:25], 0
    s_load_dwordx16 s[48:63], s[26:27], 0
    s_load_dwordx8 s[64:71], s[28:29], 0
    s_load_dwordx8 s[80:87], s[30:31], 0
    buffer_load_dword v4, v2, s[12:15], 0 offen
    s_mov_b32 s3, 254291968
    buffer_load_dwordx4 v[8:11], v3, s[4:7], s3 offen
    s_mov_b32 s3, 254296064
    buffer_load_dwordx4 v[12:15], v1, s[4:7], s3 offen
    s_mov_b32 s3, 259416064
    buffer_load_dwordx4 v[16:19], v1, s[4:7], s3 offen
    s_mov_b32 s3, 264536064
    buffer_load_dwordx4 v[20:23], v1, s[4:7], s3 offen
    s_mov_b32 s3, 269656064
    buffer_load_dwordx4 v[24:27], v1, s[4:7], s3 offen
    buffer_load_dwordx4 v[28:31], v1, s[8:11], 0 offen
    s_waitcnt lgkmcnt(0)
    s_pack_ll_b32_b16 s20, s32, s34
    s_pack_hh_b32_b16 s21, s32, s34
    s_pack_ll_b32_b16 s22, s33, s35
    s_pack_hh_b32_b16 s35, s33, s35
    s_mov_b32 s32, s20
    s_mov_b32 s33, s21
    s_mov_b32 s34, s22
    s_pack_ll_b32_b16 s20, s36, s38
    s_pack_hh_b32_b16 s21, s36, s38
    s_pack_ll_b32_b16 s22, s37, s39
    s_pack_hh_b32_b16 s39, s37, s39
    s_mov_b32 s36, s20
    s_mov_b32 s37, s21
    s_mov_b32 s38, s22
    s_pack_ll_b32_b16 s20, s40, s42
    s_pack_hh_b32_b16 s21, s40, s42
    s_pack_ll_b32_b16 s22, s41, s43
    s_pack_hh_b32_b16 s43, s41, s43
    s_mov_b32 s40, s20
    s_mov_b32 s41, s21
    s_mov_b32 s42, s22
    s_pack_ll_b32_b16 s20, s44, s46
    s_pack_hh_b32_b16 s21, s44, s46
    s_pack_ll_b32_b16 s22, s45, s47
    s_pack_hh_b32_b16 s47, s45, s47
    s_mov_b32 s44, s20
    s_mov_b32 s45, s21
    s_mov_b32 s46, s22
    s_pack_ll_b32_b16 s20, s48, s50
    s_pack_hh_b32_b16 s21, s48, s50
    s_pack_ll_b32_b16 s22, s49, s51
    s_pack_hh_b32_b16 s51, s49, s51
    s_mov_b32 s48, s20
    s_mov_b32 s49, s21
    s_mov_b32 s50, s22
    s_pack_ll_b32_b16 s20, s52, s54
    s_pack_hh_b32_b16 s21, s52, s54
    s_pack_ll_b32_b16 s22, s53, s55
    s_pack_hh_b32_b16 s55, s53, s55
    s_mov_b32 s52, s20
    s_mov_b32 s53, s21
    s_mov_b32 s54, s22
    s_pack_ll_b32_b16 s20, s56, s58
    s_pack_hh_b32_b16 s21, s56, s58
    s_pack_ll_b32_b16 s22, s57, s59
    s_pack_hh_b32_b16 s59, s57, s59
    s_mov_b32 s56, s20
    s_mov_b32 s57, s21
    s_mov_b32 s58, s22
    s_pack_ll_b32_b16 s20, s60, s62
    s_pack_hh_b32_b16 s21, s60, s62
    s_pack_ll_b32_b16 s22, s61, s63
    s_pack_hh_b32_b16 s63, s61, s63
    s_mov_b32 s60, s20
    s_mov_b32 s61, s21
    s_mov_b32 s62, s22
    s_and_b32 s79, s71, 0xffff0000
    s_lshl_b32 s78, s71, 16
    s_and_b32 s77, s70, 0xffff0000
    s_lshl_b32 s76, s70, 16
    s_and_b32 s75, s69, 0xffff0000
    s_lshl_b32 s74, s69, 16
    s_and_b32 s73, s68, 0xffff0000
    s_lshl_b32 s72, s68, 16
    s_and_b32 s71, s67, 0xffff0000
    s_lshl_b32 s70, s67, 16
    s_and_b32 s69, s66, 0xffff0000
    s_lshl_b32 s68, s66, 16
    s_and_b32 s67, s65, 0xffff0000
    s_lshl_b32 s66, s65, 16
    s_and_b32 s65, s64, 0xffff0000
    s_lshl_b32 s64, s64, 16
    s_and_b32 s95, s87, 0xffff0000
    s_lshl_b32 s94, s87, 16
    s_and_b32 s93, s86, 0xffff0000
    s_lshl_b32 s92, s86, 16
    s_and_b32 s91, s85, 0xffff0000
    s_lshl_b32 s90, s85, 16
    s_and_b32 s89, s84, 0xffff0000
    s_lshl_b32 s88, s84, 16
    s_and_b32 s87, s83, 0xffff0000
    s_lshl_b32 s86, s83, 16
    s_and_b32 s85, s82, 0xffff0000
    s_lshl_b32 s84, s82, 16
    s_and_b32 s83, s81, 0xffff0000
    s_lshl_b32 s82, s81, 16
    s_and_b32 s81, s80, 0xffff0000
    s_lshl_b32 s80, s80, 16
    s_lshl_b32 s20, s96, 16
    s_and_b32 s21, s96, 0xffff0000
    s_lshl_b32 s22, s97, 16
    s_and_b32 s23, s97, 0xffff0000
    s_lshl_b32 s24, s98, 16
    s_and_b32 s25, s98, 0xffff0000
    s_lshl_b32 s26, s99, 16
    s_and_b32 s27, s99, 0xffff0000
    s_waitcnt vmcnt(6)
    v_and_b32 v5, 0xffff0000, v4
    v_lshlrev_b32 v4, 16, v4
    v_subrev_f32 v32, s20, v4
    v_subrev_f32 v33, s21, v4
    v_subrev_f32 v34, s22, v4
    v_subrev_f32 v35, s23, v4
    v_subrev_f32 v36, s24, v4
    v_subrev_f32 v37, s25, v4
    v_subrev_f32 v38, s26, v4
    v_subrev_f32 v39, s27, v4
    v_cvt_pk_bf16_f32 v6, v32, v33
    v_lshlrev_b32 v32, 16, v6
    v_and_b32 v33, 0xffff0000, v6
    v_cvt_pk_bf16_f32 v6, v34, v35
    v_lshlrev_b32 v34, 16, v6
    v_and_b32 v35, 0xffff0000, v6
    v_cvt_pk_bf16_f32 v6, v36, v37
    v_lshlrev_b32 v36, 16, v6
    v_and_b32 v37, 0xffff0000, v6
    v_cvt_pk_bf16_f32 v6, v38, v39
    v_lshlrev_b32 v38, 16, v6
    v_and_b32 v39, 0xffff0000, v6
    v_mul_f32 v32, v32, v32
    v_mul_f32 v33, v33, v33
    v_mul_f32 v34, v34, v34
    v_mul_f32 v35, v35, v35
    v_mul_f32 v36, v36, v36
    v_mul_f32 v37, v37, v37
    v_mul_f32 v38, v38, v38
    v_mul_f32 v39, v39, v39
    v_cvt_pk_bf16_f32 v6, v32, v33
    v_lshlrev_b32 v32, 16, v6
    v_and_b32 v33, 0xffff0000, v6
    v_cvt_pk_bf16_f32 v6, v34, v35
    v_lshlrev_b32 v34, 16, v6
    v_and_b32 v35, 0xffff0000, v6
    v_cvt_pk_bf16_f32 v6, v36, v37
    v_lshlrev_b32 v36, 16, v6
    v_and_b32 v37, 0xffff0000, v6
    v_cvt_pk_bf16_f32 v6, v38, v39
    v_lshlrev_b32 v38, 16, v6
    v_and_b32 v39, 0xffff0000, v6
    v_mul_f32 v32, 0xc1200000, v32
    v_mul_f32 v33, 0xc1200000, v33
    v_mul_f32 v34, 0xc1200000, v34
    v_mul_f32 v35, 0xc1200000, v35
    v_mul_f32 v36, 0xc1200000, v36
    v_mul_f32 v37, 0xc1200000, v37
    v_mul_f32 v38, 0xc1200000, v38
    v_mul_f32 v39, 0xc1200000, v39
    v_cvt_pk_bf16_f32 v6, v32, v33
    v_lshlrev_b32 v32, 16, v6
    v_and_b32 v33, 0xffff0000, v6
    v_cvt_pk_bf16_f32 v6, v34, v35
    v_lshlrev_b32 v34, 16, v6
    v_and_b32 v35, 0xffff0000, v6
    v_cvt_pk_bf16_f32 v6, v36, v37
    v_lshlrev_b32 v36, 16, v6
    v_and_b32 v37, 0xffff0000, v6
    v_cvt_pk_bf16_f32 v6, v38, v39
    v_lshlrev_b32 v38, 16, v6
    v_and_b32 v39, 0xffff0000, v6
    v_mul_f32 v32, 0x3fb8aa3b, v32
    v_mul_f32 v33, 0x3fb8aa3b, v33
    v_mul_f32 v34, 0x3fb8aa3b, v34
    v_mul_f32 v35, 0x3fb8aa3b, v35
    v_mul_f32 v36, 0x3fb8aa3b, v36
    v_mul_f32 v37, 0x3fb8aa3b, v37
    v_mul_f32 v38, 0x3fb8aa3b, v38
    v_mul_f32 v39, 0x3fb8aa3b, v39
    v_exp_f32 v32, v32
    v_exp_f32 v33, v33
    v_exp_f32 v34, v34
    v_exp_f32 v35, v35
    v_exp_f32 v36, v36
    v_exp_f32 v37, v37
    v_exp_f32 v38, v38
    v_exp_f32 v39, v39
    v_cvt_pk_bf16_f32 v40, v32, v33
    v_cvt_pk_bf16_f32 v41, v34, v35
    v_cvt_pk_bf16_f32 v42, v36, v37
    v_cvt_pk_bf16_f32 v43, v38, v39
    v_dot2_f32_bf16 v44, v40, s32, 0
    v_dot2_f32_bf16 v45, v40, s33, 0
    v_dot2_f32_bf16 v46, v40, s34, 0
    v_dot2_f32_bf16 v47, v40, s35, 0
    v_dot2_f32_bf16 v48, v40, s48, 0
    v_dot2_f32_bf16 v49, v40, s49, 0
    v_dot2_f32_bf16 v50, v40, s50, 0
    v_dot2_f32_bf16 v51, v40, s51, 0
    v_dot2_f32_bf16 v44, v41, s36, v44
    v_dot2_f32_bf16 v45, v41, s37, v45
    v_dot2_f32_bf16 v46, v41, s38, v46
    v_dot2_f32_bf16 v47, v41, s39, v47
    v_dot2_f32_bf16 v48, v41, s52, v48
    v_dot2_f32_bf16 v49, v41, s53, v49
    v_dot2_f32_bf16 v50, v41, s54, v50
    v_dot2_f32_bf16 v51, v41, s55, v51
    v_dot2_f32_bf16 v44, v42, s40, v44
    v_dot2_f32_bf16 v45, v42, s41, v45
    v_dot2_f32_bf16 v46, v42, s42, v46
    v_dot2_f32_bf16 v47, v42, s43, v47
    v_dot2_f32_bf16 v48, v42, s56, v48
    v_dot2_f32_bf16 v49, v42, s57, v49
    v_dot2_f32_bf16 v50, v42, s58, v50
    v_dot2_f32_bf16 v51, v42, s59, v51
    v_dot2_f32_bf16 v44, v43, s44, v44
    v_dot2_f32_bf16 v45, v43, s45, v45
    v_dot2_f32_bf16 v46, v43, s46, v46
    v_dot2_f32_bf16 v47, v43, s47, v47
    v_dot2_f32_bf16 v48, v43, s60, v48
    v_dot2_f32_bf16 v49, v43, s61, v49
    v_dot2_f32_bf16 v50, v43, s62, v50
    v_dot2_f32_bf16 v51, v43, s63, v51
    v_subrev_f32 v32, s20, v5
    v_subrev_f32 v33, s21, v5
    v_subrev_f32 v34, s22, v5
    v_subrev_f32 v35, s23, v5
    v_subrev_f32 v36, s24, v5
    v_subrev_f32 v37, s25, v5
    v_subrev_f32 v38, s26, v5
    v_subrev_f32 v39, s27, v5
    v_cvt_pk_bf16_f32 v6, v32, v33
    v_lshlrev_b32 v32, 16, v6
    v_and_b32 v33, 0xffff0000, v6
    v_cvt_pk_bf16_f32 v6, v34, v35
    v_lshlrev_b32 v34, 16, v6
    v_and_b32 v35, 0xffff0000, v6
    v_cvt_pk_bf16_f32 v6, v36, v37
    v_lshlrev_b32 v36, 16, v6
    v_and_b32 v37, 0xffff0000, v6
    v_cvt_pk_bf16_f32 v6, v38, v39
    v_lshlrev_b32 v38, 16, v6
    v_and_b32 v39, 0xffff0000, v6
    v_mul_f32 v32, v32, v32
    v_mul_f32 v33, v33, v33
    v_mul_f32 v34, v34, v34
    v_mul_f32 v35, v35, v35
    v_mul_f32 v36, v36, v36
    v_mul_f32 v37, v37, v37
    v_mul_f32 v38, v38, v38
    v_mul_f32 v39, v39, v39
    v_cvt_pk_bf16_f32 v6, v32, v33
    v_lshlrev_b32 v32, 16, v6
    v_and_b32 v33, 0xffff0000, v6
    v_cvt_pk_bf16_f32 v6, v34, v35
    v_lshlrev_b32 v34, 16, v6
    v_and_b32 v35, 0xffff0000, v6
    v_cvt_pk_bf16_f32 v6, v36, v37
    v_lshlrev_b32 v36, 16, v6
    v_and_b32 v37, 0xffff0000, v6
    v_cvt_pk_bf16_f32 v6, v38, v39
    v_lshlrev_b32 v38, 16, v6
    v_and_b32 v39, 0xffff0000, v6
    v_mul_f32 v32, 0xc1200000, v32
    v_mul_f32 v33, 0xc1200000, v33
    v_mul_f32 v34, 0xc1200000, v34
    v_mul_f32 v35, 0xc1200000, v35
    v_mul_f32 v36, 0xc1200000, v36
    v_mul_f32 v37, 0xc1200000, v37
    v_mul_f32 v38, 0xc1200000, v38
    v_mul_f32 v39, 0xc1200000, v39
    v_cvt_pk_bf16_f32 v6, v32, v33
    v_lshlrev_b32 v32, 16, v6
    v_and_b32 v33, 0xffff0000, v6
    v_cvt_pk_bf16_f32 v6, v34, v35
    v_lshlrev_b32 v34, 16, v6
    v_and_b32 v35, 0xffff0000, v6
    v_cvt_pk_bf16_f32 v6, v36, v37
    v_lshlrev_b32 v36, 16, v6
    v_and_b32 v37, 0xffff0000, v6
    v_cvt_pk_bf16_f32 v6, v38, v39
    v_lshlrev_b32 v38, 16, v6
    v_and_b32 v39, 0xffff0000, v6
    v_mul_f32 v32, 0x3fb8aa3b, v32
    v_mul_f32 v33, 0x3fb8aa3b, v33
    v_mul_f32 v34, 0x3fb8aa3b, v34
    v_mul_f32 v35, 0x3fb8aa3b, v35
    v_mul_f32 v36, 0x3fb8aa3b, v36
    v_mul_f32 v37, 0x3fb8aa3b, v37
    v_mul_f32 v38, 0x3fb8aa3b, v38
    v_mul_f32 v39, 0x3fb8aa3b, v39
    v_exp_f32 v32, v32
    v_exp_f32 v33, v33
    v_exp_f32 v34, v34
    v_exp_f32 v35, v35
    v_exp_f32 v36, v36
    v_exp_f32 v37, v37
    v_exp_f32 v38, v38
    v_exp_f32 v39, v39
    v_cvt_pk_bf16_f32 v40, v32, v33
    v_cvt_pk_bf16_f32 v41, v34, v35
    v_cvt_pk_bf16_f32 v42, v36, v37
    v_cvt_pk_bf16_f32 v43, v38, v39
    v_dot2_f32_bf16 v52, v40, s32, 0
    v_dot2_f32_bf16 v53, v40, s33, 0
    v_dot2_f32_bf16 v54, v40, s34, 0
    v_dot2_f32_bf16 v55, v40, s35, 0
    v_dot2_f32_bf16 v56, v40, s48, 0
    v_dot2_f32_bf16 v57, v40, s49, 0
    v_dot2_f32_bf16 v58, v40, s50, 0
    v_dot2_f32_bf16 v59, v40, s51, 0
    v_dot2_f32_bf16 v52, v41, s36, v52
    v_dot2_f32_bf16 v53, v41, s37, v53
    v_dot2_f32_bf16 v54, v41, s38, v54
    v_dot2_f32_bf16 v55, v41, s39, v55
    v_dot2_f32_bf16 v56, v41, s52, v56
    v_dot2_f32_bf16 v57, v41, s53, v57
    v_dot2_f32_bf16 v58, v41, s54, v58
    v_dot2_f32_bf16 v59, v41, s55, v59
    v_dot2_f32_bf16 v52, v42, s40, v52
    v_dot2_f32_bf16 v53, v42, s41, v53
    v_dot2_f32_bf16 v54, v42, s42, v54
    v_dot2_f32_bf16 v55, v42, s43, v55
    v_dot2_f32_bf16 v56, v42, s56, v56
    v_dot2_f32_bf16 v57, v42, s57, v57
    v_dot2_f32_bf16 v58, v42, s58, v58
    v_dot2_f32_bf16 v59, v42, s59, v59
    v_dot2_f32_bf16 v52, v43, s44, v52
    v_dot2_f32_bf16 v53, v43, s45, v53
    v_dot2_f32_bf16 v54, v43, s46, v54
    v_dot2_f32_bf16 v55, v43, s47, v55
    v_dot2_f32_bf16 v56, v43, s60, v56
    v_dot2_f32_bf16 v57, v43, s61, v57
    v_dot2_f32_bf16 v58, v43, s62, v58
    v_dot2_f32_bf16 v59, v43, s63, v59
    s_waitcnt vmcnt(1)
    v_cvt_f32_u32_sdwa v40, v12 dst_sel:DWORD dst_unused:UNUSED_PAD src0_sel:WORD_0
    v_add_f32 v40, 3330277376, v40
    v_mul_f32 v32, v8, v40
    v_cvt_f32_u32_sdwa v41, v12 dst_sel:DWORD dst_unused:UNUSED_PAD src0_sel:WORD_1
    v_add_f32 v41, 3330277376, v41
    v_mul_f32 v33, v8, v41
    v_cvt_f32_u32_sdwa v42, v13 dst_sel:DWORD dst_unused:UNUSED_PAD src0_sel:WORD_0
    v_add_f32 v42, 3330277376, v42
    v_mul_f32 v34, v8, v42
    v_cvt_f32_u32_sdwa v43, v13 dst_sel:DWORD dst_unused:UNUSED_PAD src0_sel:WORD_1
    v_add_f32 v43, 3330277376, v43
    v_mul_f32 v35, v8, v43
    v_cvt_f32_u32_sdwa v40, v14 dst_sel:DWORD dst_unused:UNUSED_PAD src0_sel:WORD_0
    v_add_f32 v40, 3330277376, v40
    v_mul_f32 v36, v8, v40
    v_cvt_f32_u32_sdwa v41, v14 dst_sel:DWORD dst_unused:UNUSED_PAD src0_sel:WORD_1
    v_add_f32 v41, 3330277376, v41
    v_mul_f32 v37, v8, v41
    v_cvt_f32_u32_sdwa v42, v15 dst_sel:DWORD dst_unused:UNUSED_PAD src0_sel:WORD_0
    v_add_f32 v42, 3330277376, v42
    v_mul_f32 v38, v8, v42
    v_cvt_f32_u32_sdwa v43, v15 dst_sel:DWORD dst_unused:UNUSED_PAD src0_sel:WORD_1
    v_add_f32 v43, 3330277376, v43
    v_mul_f32 v39, v8, v43
    v_cvt_f32_u32_sdwa v40, v16 dst_sel:DWORD dst_unused:UNUSED_PAD src0_sel:WORD_0
    v_add_f32 v40, 3330277376, v40
    v_fmac_f32 v32, v9, v40
    v_cvt_f32_u32_sdwa v41, v16 dst_sel:DWORD dst_unused:UNUSED_PAD src0_sel:WORD_1
    v_add_f32 v41, 3330277376, v41
    v_fmac_f32 v33, v9, v41
    v_cvt_f32_u32_sdwa v42, v17 dst_sel:DWORD dst_unused:UNUSED_PAD src0_sel:WORD_0
    v_add_f32 v42, 3330277376, v42
    v_fmac_f32 v34, v9, v42
    v_cvt_f32_u32_sdwa v43, v17 dst_sel:DWORD dst_unused:UNUSED_PAD src0_sel:WORD_1
    v_add_f32 v43, 3330277376, v43
    v_fmac_f32 v35, v9, v43
    v_cvt_f32_u32_sdwa v40, v18 dst_sel:DWORD dst_unused:UNUSED_PAD src0_sel:WORD_0
    v_add_f32 v40, 3330277376, v40
    v_fmac_f32 v36, v9, v40
    v_cvt_f32_u32_sdwa v41, v18 dst_sel:DWORD dst_unused:UNUSED_PAD src0_sel:WORD_1
    v_add_f32 v41, 3330277376, v41
    v_fmac_f32 v37, v9, v41
    v_cvt_f32_u32_sdwa v42, v19 dst_sel:DWORD dst_unused:UNUSED_PAD src0_sel:WORD_0
    v_add_f32 v42, 3330277376, v42
    v_fmac_f32 v38, v9, v42
    v_cvt_f32_u32_sdwa v43, v19 dst_sel:DWORD dst_unused:UNUSED_PAD src0_sel:WORD_1
    v_add_f32 v43, 3330277376, v43
    v_fmac_f32 v39, v9, v43
    v_cvt_f32_u32_sdwa v40, v20 dst_sel:DWORD dst_unused:UNUSED_PAD src0_sel:WORD_0
    v_add_f32 v40, 3330277376, v40
    v_fmac_f32 v32, v10, v40
    v_cvt_f32_u32_sdwa v41, v20 dst_sel:DWORD dst_unused:UNUSED_PAD src0_sel:WORD_1
    v_add_f32 v41, 3330277376, v41
    v_fmac_f32 v33, v10, v41
    v_cvt_f32_u32_sdwa v42, v21 dst_sel:DWORD dst_unused:UNUSED_PAD src0_sel:WORD_0
    v_add_f32 v42, 3330277376, v42
    v_fmac_f32 v34, v10, v42
    v_cvt_f32_u32_sdwa v43, v21 dst_sel:DWORD dst_unused:UNUSED_PAD src0_sel:WORD_1
    v_add_f32 v43, 3330277376, v43
    v_fmac_f32 v35, v10, v43
    v_cvt_f32_u32_sdwa v40, v22 dst_sel:DWORD dst_unused:UNUSED_PAD src0_sel:WORD_0
    v_add_f32 v40, 3330277376, v40
    v_fmac_f32 v36, v10, v40
    v_cvt_f32_u32_sdwa v41, v22 dst_sel:DWORD dst_unused:UNUSED_PAD src0_sel:WORD_1
    v_add_f32 v41, 3330277376, v41
    v_fmac_f32 v37, v10, v41
    v_cvt_f32_u32_sdwa v42, v23 dst_sel:DWORD dst_unused:UNUSED_PAD src0_sel:WORD_0
    v_add_f32 v42, 3330277376, v42
    v_fmac_f32 v38, v10, v42
    v_cvt_f32_u32_sdwa v43, v23 dst_sel:DWORD dst_unused:UNUSED_PAD src0_sel:WORD_1
    v_add_f32 v43, 3330277376, v43
    v_fmac_f32 v39, v10, v43
    v_cvt_f32_u32_sdwa v40, v24 dst_sel:DWORD dst_unused:UNUSED_PAD src0_sel:WORD_0
    v_add_f32 v40, 3330277376, v40
    v_fmac_f32 v32, v11, v40
    v_cvt_f32_u32_sdwa v41, v24 dst_sel:DWORD dst_unused:UNUSED_PAD src0_sel:WORD_1
    v_add_f32 v41, 3330277376, v41
    v_fmac_f32 v33, v11, v41
    v_cvt_f32_u32_sdwa v42, v25 dst_sel:DWORD dst_unused:UNUSED_PAD src0_sel:WORD_0
    v_add_f32 v42, 3330277376, v42
    v_fmac_f32 v34, v11, v42
    v_cvt_f32_u32_sdwa v43, v25 dst_sel:DWORD dst_unused:UNUSED_PAD src0_sel:WORD_1
    v_add_f32 v43, 3330277376, v43
    v_fmac_f32 v35, v11, v43
    v_cvt_f32_u32_sdwa v40, v26 dst_sel:DWORD dst_unused:UNUSED_PAD src0_sel:WORD_0
    v_add_f32 v40, 3330277376, v40
    v_fmac_f32 v36, v11, v40
    v_cvt_f32_u32_sdwa v41, v26 dst_sel:DWORD dst_unused:UNUSED_PAD src0_sel:WORD_1
    v_add_f32 v41, 3330277376, v41
    v_fmac_f32 v37, v11, v41
    v_cvt_f32_u32_sdwa v42, v27 dst_sel:DWORD dst_unused:UNUSED_PAD src0_sel:WORD_0
    v_add_f32 v42, 3330277376, v42
    v_fmac_f32 v38, v11, v42
    v_cvt_f32_u32_sdwa v43, v27 dst_sel:DWORD dst_unused:UNUSED_PAD src0_sel:WORD_1
    v_add_f32 v43, 3330277376, v43
    v_fmac_f32 v39, v11, v43
    v_min_u32 v6, v8, v9
    v_min3_u32 v6, v6, v10, v11
    v_cmp_eq_u32 vcc, 0, v6
    s_nop 1
    s_cbranch_vccz L_p3_fast
    v_lshlrev_b32 v7, 5, v0
    v_cmp_eq_u32 vcc, 0, v8
    s_nop 1
    s_and_b64 exec, exec, vcc
    s_cbranch_execz L_p3_kernel_q_1
    s_mov_b32 s3, 274776064
    buffer_load_dwordx4 v[12:15], v7, s[4:7], s3 offen
    buffer_load_dwordx4 v[16:19], v7, s[4:7], s3 offen offset:16
    s_waitcnt vmcnt(0)
    v_add_f32 v32, v32, v12
    v_add_f32 v33, v33, v13
    v_add_f32 v34, v34, v14
    v_add_f32 v35, v35, v15
    v_add_f32 v36, v36, v16
    v_add_f32 v37, v37, v17
    v_add_f32 v38, v38, v18
    v_add_f32 v39, v39, v19
L_p3_kernel_q_1:
    s_mov_b64 exec, -1
    v_cmp_eq_u32 vcc, 0, v9
    s_nop 1
    s_and_b64 exec, exec, vcc
    s_cbranch_execz L_p3_kernel_q_2
    s_mov_b32 s3, 285016064
    buffer_load_dwordx4 v[12:15], v7, s[4:7], s3 offen
    buffer_load_dwordx4 v[16:19], v7, s[4:7], s3 offen offset:16
    s_waitcnt vmcnt(0)
    v_add_f32 v32, v32, v12
    v_add_f32 v33, v33, v13
    v_add_f32 v34, v34, v14
    v_add_f32 v35, v35, v15
    v_add_f32 v36, v36, v16
    v_add_f32 v37, v37, v17
    v_add_f32 v38, v38, v18
    v_add_f32 v39, v39, v19
L_p3_kernel_q_2:
    s_mov_b64 exec, -1
    v_cmp_eq_u32 vcc, 0, v10
    s_nop 1
    s_and_b64 exec, exec, vcc
    s_cbranch_execz L_p3_kernel_q_3
    s_mov_b32 s3, 295256064
    buffer_load_dwordx4 v[12:15], v7, s[4:7], s3 offen
    buffer_load_dwordx4 v[16:19], v7, s[4:7], s3 offen offset:16
    s_waitcnt vmcnt(0)
    v_add_f32 v32, v32, v12
    v_add_f32 v33, v33, v13
    v_add_f32 v34, v34, v14
    v_add_f32 v35, v35, v15
    v_add_f32 v36, v36, v16
    v_add_f32 v37, v37, v17
    v_add_f32 v38, v38, v18
    v_add_f32 v39, v39, v19
L_p3_kernel_q_3:
    s_mov_b64 exec, -1
    v_cmp_eq_u32 vcc, 0, v11
    s_nop 1
    s_and_b64 exec, exec, vcc
    s_cbranch_execz L_p3_kernel_q_4
    s_mov_b32 s3, 305496064
    buffer_load_dwordx4 v[12:15], v7, s[4:7], s3 offen
    buffer_load_dwordx4 v[16:19], v7, s[4:7], s3 offen offset:16
    s_waitcnt vmcnt(0)
    v_add_f32 v32, v32, v12
    v_add_f32 v33, v33, v13
    v_add_f32 v34, v34, v14
    v_add_f32 v35, v35, v15
    v_add_f32 v36, v36, v16
    v_add_f32 v37, v37, v17
    v_add_f32 v38, v38, v18
    v_add_f32 v39, v39, v19
L_p3_kernel_q_4:
    s_mov_b64 exec, -1
L_p3_fast:
    s_waitcnt vmcnt(0)
    v_mul_f32 v12, s64, v32
    v_mul_f32 v13, s65, v32
    v_mul_f32 v14, s66, v32
    v_mul_f32 v15, s67, v32
    v_fmac_f32 v12, s68, v33
    v_fmac_f32 v13, s69, v33
    v_fmac_f32 v14, s70, v33
    v_fmac_f32 v15, s71, v33
    v_fmac_f32 v12, s72, v34
    v_fmac_f32 v13, s73, v34
    v_fmac_f32 v14, s74, v34
    v_fmac_f32 v15, s75, v34
    v_fmac_f32 v12, s76, v35
    v_fmac_f32 v13, s77, v35
    v_fmac_f32 v14, s78, v35
    v_fmac_f32 v15, s79, v35
    v_mul_f32 v12, v12, v48
    v_mul_f32 v13, v13, v49
    v_mul_f32 v14, v14, v50
    v_mul_f32 v15, v15, v51
    v_mul_f32 v16, s80, v12
    v_mul_f32 v17, s81, v12
    v_mul_f32 v18, s82, v12
    v_mul_f32 v19, s83, v12
    v_fmac_f32 v16, s84, v13
    v_fmac_f32 v17, s85, v13
    v_fmac_f32 v18, s86, v13
    v_fmac_f32 v19, s87, v13
    v_fmac_f32 v16, s88, v14
    v_fmac_f32 v17, s89, v14
    v_fmac_f32 v18, s90, v14
    v_fmac_f32 v19, s91, v14
    v_fmac_f32 v16, s92, v15
    v_fmac_f32 v17, s93, v15
    v_fmac_f32 v18, s94, v15
    v_fmac_f32 v19, s95, v15
    v_lshlrev_b32 v20, 16, v28
    v_and_b32 v21, 0xffff0000, v28
    v_lshlrev_b32 v22, 16, v29
    v_and_b32 v23, 0xffff0000, v29
    v_fmac_f32 v20, v16, v44
    v_fmac_f32 v21, v17, v45
    v_fmac_f32 v22, v18, v46
    v_fmac_f32 v23, v19, v47
    v_cvt_pk_bf16_f32 v28, v20, v21
    v_cvt_pk_bf16_f32 v29, v22, v23
    v_mul_f32 v12, s64, v36
    v_mul_f32 v13, s65, v36
    v_mul_f32 v14, s66, v36
    v_mul_f32 v15, s67, v36
    v_fmac_f32 v12, s68, v37
    v_fmac_f32 v13, s69, v37
    v_fmac_f32 v14, s70, v37
    v_fmac_f32 v15, s71, v37
    v_fmac_f32 v12, s72, v38
    v_fmac_f32 v13, s73, v38
    v_fmac_f32 v14, s74, v38
    v_fmac_f32 v15, s75, v38
    v_fmac_f32 v12, s76, v39
    v_fmac_f32 v13, s77, v39
    v_fmac_f32 v14, s78, v39
    v_fmac_f32 v15, s79, v39
    v_mul_f32 v12, v12, v56
    v_mul_f32 v13, v13, v57
    v_mul_f32 v14, v14, v58
    v_mul_f32 v15, v15, v59
    v_mul_f32 v16, s80, v12
    v_mul_f32 v17, s81, v12
    v_mul_f32 v18, s82, v12
    v_mul_f32 v19, s83, v12
    v_fmac_f32 v16, s84, v13
    v_fmac_f32 v17, s85, v13
    v_fmac_f32 v18, s86, v13
    v_fmac_f32 v19, s87, v13
    v_fmac_f32 v16, s88, v14
    v_fmac_f32 v17, s89, v14
    v_fmac_f32 v18, s90, v14
    v_fmac_f32 v19, s91, v14
    v_fmac_f32 v16, s92, v15
    v_fmac_f32 v17, s93, v15
    v_fmac_f32 v18, s94, v15
    v_fmac_f32 v19, s95, v15
    v_lshlrev_b32 v20, 16, v30
    v_and_b32 v21, 0xffff0000, v30
    v_lshlrev_b32 v22, 16, v31
    v_and_b32 v23, 0xffff0000, v31
    v_fmac_f32 v20, v16, v52
    v_fmac_f32 v21, v17, v53
    v_fmac_f32 v22, v18, v54
    v_fmac_f32 v23, v19, v55
    v_cvt_pk_bf16_f32 v30, v20, v21
    v_cvt_pk_bf16_f32 v31, v22, v23
    buffer_store_dwordx4 v[28:31], v1, s[16:19], 0 offen
L_p3_end:
    s_endpgm
.section .rodata,"a"
.p2align 6
.amdhsa_kernel p1_kernel
  .amdhsa_next_free_vgpr 128
  .amdhsa_next_free_sgpr 96
  .amdhsa_accum_offset 128
  .amdhsa_group_segment_fixed_size 0
  .amdhsa_kernarg_size 112
  .amdhsa_user_sgpr_count 2
  .amdhsa_user_sgpr_kernarg_segment_ptr 1
  .amdhsa_system_sgpr_workgroup_id_x 1
  .amdhsa_float_denorm_mode_32 0
.end_amdhsa_kernel
.p2align 6
.amdhsa_kernel p2_kernel
  .amdhsa_next_free_vgpr 128
  .amdhsa_next_free_sgpr 102
  .amdhsa_accum_offset 128
  .amdhsa_group_segment_fixed_size 0
  .amdhsa_kernarg_size 112
  .amdhsa_user_sgpr_count 2
  .amdhsa_user_sgpr_kernarg_segment_ptr 1
  .amdhsa_system_sgpr_workgroup_id_x 1
  .amdhsa_float_denorm_mode_32 0
.end_amdhsa_kernel
.p2align 6
.amdhsa_kernel p3_kernel
  .amdhsa_next_free_vgpr 64
  .amdhsa_next_free_sgpr 102
  .amdhsa_accum_offset 64
  .amdhsa_group_segment_fixed_size 0
  .amdhsa_kernarg_size 112
  .amdhsa_user_sgpr_count 2
  .amdhsa_user_sgpr_kernarg_segment_ptr 1
  .amdhsa_system_sgpr_workgroup_id_x 1
  .amdhsa_float_denorm_mode_32 0
.end_amdhsa_kernel
```

```asm
; @launch kernel=p1_kernel grid=(256,1,1) block=(1024,1,1) lds=163840
; @launch kernel=p2_kernel grid=(256,1,1) block=(1024,1,1) lds=163840
; @launch kernel=p3_kernel grid=(1250,1,1) block=(256,1,1) lds=0
.amdgcn_target "amdgcn-amd-amdhsa--gfx950"
.text
.globl p1_kernel
.p2align 8
.type p1_kernel,@function
p1_kernel:
    s_cmp_ge_u32 s2, 256
    s_cbranch_scc1 L_p1_end
    s_load_dwordx2 s[4:5], s[0:1], 104
    s_load_dwordx2 s[8:9], s[0:1], 8
    s_load_dwordx2 s[12:13], s[0:1], 16
    s_load_dwordx2 s[16:17], s[0:1], 32
    s_load_dwordx2 s[28:29], s[0:1], 0
    s_load_dwordx2 s[6:7], s[0:1], 48
    v_lshlrev_b32 v1, 4, v0
    v_lshlrev_b32 v2, 3, v0
    v_mul_u32_u24 v3, 12, v0
    v_lshrrev_b32 v6, 6, v0
    v_mov_b32 v4, 1
    v_mov_b32 v5, 0
    v_readfirstlane_b32 s39, v6
    v_cmp_gt_u32 vcc, 784, v0
    s_mov_b32 s32, s2
    s_mul_i32 s33, s2, 160000
    s_mul_i32 s34, s2, 80000
    s_mov_b64 s[44:45], vcc
    v_mov_b32 v6, 0x7f000000
    v_cndmask_b32 v17, v6, v5, vcc
    s_waitcnt lgkmcnt(0)
    s_load_dword s3, s[6:7], 0
    s_mov_b32 s10, 163840000
    s_mov_b32 s11, 0x00020000
    s_mov_b32 s14, 163840000
    s_mov_b32 s15, 0x00020000
    s_mov_b32 s18, 81920000
    s_mov_b32 s19, 0x00020000
    s_mul_i32 s36, s2, 20000
    s_add_u32 s30, s36, 20000
    s_mov_b32 s31, 0x00020000
    s_add_u32 s35, s36, 16384
    buffer_load_dwordx4 v[48:51], v1, s[28:31], s36 offen nt
    buffer_load_dwordx4 v[52:55], v1, s[28:31], s35 offen nt
    s_add_u32 s35, s33, 0
    buffer_load_dwordx4 v[18:21], v1, s[8:11], s35 offen nt
    s_add_u32 s35, s33, 0
    buffer_load_dwordx4 v[22:25], v1, s[12:15], s35 offen nt
    s_add_u32 s35, s34, 0
    buffer_load_dwordx2 v[26:27], v2, s[16:19], s35 offen nt
    s_add_u32 s35, s33, 16384
    buffer_load_dwordx4 v[28:31], v1, s[8:11], s35 offen nt
    s_add_u32 s35, s33, 16384
    buffer_load_dwordx4 v[32:35], v1, s[12:15], s35 offen nt
    s_add_u32 s35, s34, 8192
    buffer_load_dwordx2 v[36:37], v2, s[16:19], s35 offen nt
    s_add_u32 s35, s33, 32768
    buffer_load_dwordx4 v[38:41], v1, s[8:11], s35 offen nt
    s_add_u32 s35, s33, 32768
    buffer_load_dwordx4 v[42:45], v1, s[12:15], s35 offen nt
    s_add_u32 s35, s34, 16384
    buffer_load_dwordx2 v[46:47], v2, s[16:19], s35 offen nt
    s_mov_b32 s20, s4
    s_mov_b32 s21, s5
    s_mov_b32 s22, 0
    s_mov_b32 s23, 0x00020000
    s_add_u32 s24, s4, 246292480
    s_addc_u32 s25, s5, 0
    s_mov_b32 s26, 8557056
    s_mov_b32 s27, 0x00020000
    s_mov_b32 s37, 1492179184
    s_mov_b32 s55, 0
    s_mov_b32 s38, 262400
    s_mov_b32 s41, 0xffff
    s_mov_b32 s43, 0x05040100
    s_mov_b32 s40, 0
    v_mov_b32 v8, 0
    v_mov_b32 v9, 0
    v_mov_b32 v10, 0
    v_mov_b32 v11, 0
    ds_write_b128 v1, v[8:11] offset:0
    s_waitcnt lgkmcnt(0)
    s_lshl_b32 s3, s3, 16
    v_mov_b32 v16, s3
    v_mul_f32 v16, 0.15915494, v16
    s_waitcnt vmcnt(9)
    s_add_u32 s28, s4, 254853632
    s_addc_u32 s29, s5, 0
    s_mul_i32 s36, s2, 20000
    s_add_u32 s35, s36, 16384
    buffer_store_dwordx4 v[48:51], v1, s[28:31], s36 offen
    buffer_store_dwordx4 v[52:55], v1, s[28:31], s35 offen
    s_nop 0
    v_mov_b32 v12, 0x3f803f80
    v_and_b32 v48, 0x7fff7fff, v48
    v_and_b32 v49, 0x7fff7fff, v49
    v_and_b32 v50, 0x7fff7fff, v50
    v_and_b32 v51, 0x7fff7fff, v51
    v_and_b32 v52, 0x7fff7fff, v52
    v_and_b32 v53, 0x7fff7fff, v53
    v_and_b32 v54, 0x7fff7fff, v54
    v_and_b32 v55, 0x7fff7fff, v55
    v_pk_max_u16 v8, v8, v48
    v_dot2c_f32_bf16 v9, v48, v12
    v_pk_max_u16 v8, v8, v49
    v_dot2c_f32_bf16 v9, v49, v12
    v_pk_max_u16 v8, v8, v50
    v_dot2c_f32_bf16 v9, v50, v12
    v_pk_max_u16 v8, v8, v51
    v_dot2c_f32_bf16 v9, v51, v12
    v_pk_max_u16 v8, v8, v52
    v_dot2c_f32_bf16 v9, v52, v12
    v_pk_max_u16 v8, v8, v53
    v_dot2c_f32_bf16 v9, v53, v12
    v_pk_max_u16 v8, v8, v54
    v_dot2c_f32_bf16 v9, v54, v12
    v_pk_max_u16 v8, v8, v55
    v_dot2c_f32_bf16 v9, v55, v12
    v_lshrrev_b32 v10, 16, v8
    v_and_b32 v8, 0xffff, v8
    v_max_u32 v8, v8, v10
    s_nop 0
    s_nop 1
    v_max_u32_dpp v8, v8, v8 row_shr:1 row_mask:0xf bank_mask:0xf bound_ctrl:0
    s_nop 1
    v_max_u32_dpp v8, v8, v8 row_shr:2 row_mask:0xf bank_mask:0xf bound_ctrl:0
    s_nop 1
    v_max_u32_dpp v8, v8, v8 row_shr:4 row_mask:0xf bank_mask:0xf bound_ctrl:0
    s_nop 1
    v_max_u32_dpp v8, v8, v8 row_shr:8 row_mask:0xf bank_mask:0xf bound_ctrl:0
    s_nop 1
    v_max_u32_dpp v8, v8, v8 row_bcast:15 row_mask:0xa bank_mask:0xf
    s_nop 1
    v_max_u32_dpp v8, v8, v8 row_bcast:31 row_mask:0xc bank_mask:0xf
    s_nop 1
    v_add_f32_dpp v9, v9, v9 row_shr:1 row_mask:0xf bank_mask:0xf bound_ctrl:0
    s_nop 1
    v_add_f32_dpp v9, v9, v9 row_shr:2 row_mask:0xf bank_mask:0xf bound_ctrl:0
    s_nop 1
    v_add_f32_dpp v9, v9, v9 row_shr:4 row_mask:0xf bank_mask:0xf bound_ctrl:0
    s_nop 1
    v_add_f32_dpp v9, v9, v9 row_shr:8 row_mask:0xf bank_mask:0xf bound_ctrl:0
    s_nop 1
    v_add_f32_dpp v9, v9, v9 row_bcast:15 row_mask:0xa bank_mask:0xf
    s_nop 1
    v_add_f32_dpp v9, v9, v9 row_bcast:31 row_mask:0xc bank_mask:0xf
    s_lshl_b32 s35, s39, 4
    s_add_u32 s35, s35, 160320
    v_mov_b32 v10, s35
    s_mov_b32 exec_lo, 0
    s_brev_b32 exec_hi, 1
    ds_write_b64 v10, v[8:9]
    s_mov_b64 exec, -1
    s_waitcnt lgkmcnt(0)
    s_barrier
L_p1_loop:
    s_mov_b32 s36, 221184
    buffer_store_dwordx3 v[120:122], v3, s[20:23], s36 offen sc1
    s_mov_b32 s36, 233472
    buffer_store_dwordx3 v[124:126], v3, s[20:23], s36 offen sc1
    s_nop 0
    v_or_b32 v8, v1, v17
    v_or_b32 v9, v2, v17
    s_add_u32 s35, s33, 147456
    buffer_load_dwordx4 v[120:123], v8, s[8:11], s35 offen nt
    s_add_u32 s35, s33, 147456
    buffer_load_dwordx4 v[124:127], v8, s[12:15], s35 offen nt
    s_add_u32 s35, s34, 73728
    buffer_load_dwordx2 v[6:7], v9, s[16:19], s35 offen nt
    s_mov_b32 s36, 0
    buffer_store_dwordx3 v[48:50], v3, s[20:23], s36 offen sc1
    s_mov_b32 s36, 12288
    buffer_store_dwordx3 v[52:54], v3, s[20:23], s36 offen sc1
    s_waitcnt vmcnt(13)
    s_nop 0
    v_perm_b32 v48, v22, v18, s43
    v_perm_b32 v49, v23, v19, s43
    v_perm_b32 v52, v24, v20, s43
    v_perm_b32 v53, v25, v21, s43
    v_mul_hi_u32_u24 v18, 429497, v18
    v_mul_hi_u32_u24 v22, 429497, v22
    v_mul_hi_u32_u24 v19, 429497, v19
    v_mul_hi_u32_u24 v23, 429497, v23
    v_mul_hi_u32_u24 v20, 429497, v20
    v_mul_hi_u32_u24 v24, 429497, v24
    v_mul_hi_u32_u24 v21, 429497, v21
    v_mul_hi_u32_u24 v25, 429497, v25
    v_lshl_or_b32 v18, v22, 16, v18
    v_lshl_or_b32 v19, v23, 16, v19
    v_lshl_or_b32 v20, v24, 16, v20
    v_lshl_or_b32 v21, v25, 16, v21
    v_dot2_u32_u16 v22, v18, s38, 0
    v_dot2_u32_u16 v23, v19, s38, 0
    v_dot2_u32_u16 v24, v20, s38, 0
    v_dot2_u32_u16 v25, v21, s38, 0
    v_pk_mad_u16 v48, v18, s37, v48
    v_pk_mad_u16 v49, v19, s37, v49
    v_pk_mad_u16 v52, v20, s37, v52
    v_pk_mad_u16 v53, v21, s37, v53
    ds_add_u32 v22, v4 offset:0
    ds_add_u32 v23, v4 offset:0
    ds_add_u32 v24, v4 offset:0
    ds_add_u32 v25, v4 offset:0
    v_or_b32 v48, 0x40000000, v48
    v_or_b32 v49, 0x40000000, v49
    v_or_b32 v52, 0x40000000, v52
    v_or_b32 v53, 0x40000000, v53
    v_lshlrev_b32 v18, 16, v26
    v_lshlrev_b32 v20, 16, v27
    v_and_b32 v19, 0xffff0000, v26
    v_and_b32 v21, 0xffff0000, v27
    v_mul_f32 v18, v16, v18
    v_mul_f32 v19, v16, v19
    v_mul_f32 v20, v16, v20
    v_mul_f32 v21, v16, v21
    v_fract_f32 v18, v18
    v_fract_f32 v19, v19
    v_fract_f32 v20, v20
    v_fract_f32 v21, v21
    v_cos_f32 v18, v18
    v_cos_f32 v19, v19
    v_cos_f32 v20, v20
    v_cos_f32 v21, v21
    v_cvt_pk_bf16_f32 v18, 0, v18
    v_cvt_pk_bf16_f32 v19, 0, v19
    v_cvt_pk_bf16_f32 v20, 0, v20
    v_cvt_pk_bf16_f32 v21, 0, v21
    v_or_b32 v50, v18, v22
    v_or_b32 v51, v19, v23
    v_or_b32 v54, v20, v24
    v_or_b32 v55, v21, v25
    v_or3_b32 v5, v50, v51, v5
    v_or3_b32 v5, v54, v55, v5
    s_add_u32 s35, s33, 49152
    buffer_load_dwordx4 v[18:21], v1, s[8:11], s35 offen nt
    s_add_u32 s35, s33, 49152
    buffer_load_dwordx4 v[22:25], v1, s[12:15], s35 offen nt
    s_add_u32 s35, s34, 24576
    buffer_load_dwordx2 v[26:27], v2, s[16:19], s35 offen nt
    s_mov_b32 s36, 24576
    buffer_store_dwordx3 v[56:58], v3, s[20:23], s36 offen sc1
    s_mov_b32 s36, 36864
    buffer_store_dwordx3 v[60:62], v3, s[20:23], s36 offen sc1
    s_waitcnt vmcnt(15)
    s_nop 0
    v_perm_b32 v56, v32, v28, s43
    v_perm_b32 v57, v33, v29, s43
    v_perm_b32 v60, v34, v30, s43
    v_perm_b32 v61, v35, v31, s43
    v_mul_hi_u32_u24 v28, 429497, v28
    v_mul_hi_u32_u24 v32, 429497, v32
    v_mul_hi_u32_u24 v29, 429497, v29
    v_mul_hi_u32_u24 v33, 429497, v33
    v_mul_hi_u32_u24 v30, 429497, v30
    v_mul_hi_u32_u24 v34, 429497, v34
    v_mul_hi_u32_u24 v31, 429497, v31
    v_mul_hi_u32_u24 v35, 429497, v35
    v_lshl_or_b32 v28, v32, 16, v28
    v_lshl_or_b32 v29, v33, 16, v29
    v_lshl_or_b32 v30, v34, 16, v30
    v_lshl_or_b32 v31, v35, 16, v31
    v_dot2_u32_u16 v32, v28, s38, 0
    v_dot2_u32_u16 v33, v29, s38, 0
    v_dot2_u32_u16 v34, v30, s38, 0
    v_dot2_u32_u16 v35, v31, s38, 0
    v_pk_mad_u16 v56, v28, s37, v56
    v_pk_mad_u16 v57, v29, s37, v57
    v_pk_mad_u16 v60, v30, s37, v60
    v_pk_mad_u16 v61, v31, s37, v61
    ds_add_u32 v32, v4 offset:0
    ds_add_u32 v33, v4 offset:0
    ds_add_u32 v34, v4 offset:0
    ds_add_u32 v35, v4 offset:0
    v_or_b32 v56, 0x40000000, v56
    v_or_b32 v57, 0x40000000, v57
    v_or_b32 v60, 0x40000000, v60
    v_or_b32 v61, 0x40000000, v61
    v_lshlrev_b32 v28, 16, v36
    v_lshlrev_b32 v30, 16, v37
    v_and_b32 v29, 0xffff0000, v36
    v_and_b32 v31, 0xffff0000, v37
    v_mul_f32 v28, v16, v28
    v_mul_f32 v29, v16, v29
    v_mul_f32 v30, v16, v30
    v_mul_f32 v31, v16, v31
    v_fract_f32 v28, v28
    v_fract_f32 v29, v29
    v_fract_f32 v30, v30
    v_fract_f32 v31, v31
    v_cos_f32 v28, v28
    v_cos_f32 v29, v29
    v_cos_f32 v30, v30
    v_cos_f32 v31, v31
    v_cvt_pk_bf16_f32 v28, 0, v28
    v_cvt_pk_bf16_f32 v29, 0, v29
    v_cvt_pk_bf16_f32 v30, 0, v30
    v_cvt_pk_bf16_f32 v31, 0, v31
    v_or_b32 v58, v28, v32
    v_or_b32 v59, v29, v33
    v_or_b32 v62, v30, v34
    v_or_b32 v63, v31, v35
    v_or3_b32 v5, v58, v59, v5
    v_or3_b32 v5, v62, v63, v5
    s_add_u32 s35, s33, 65536
    buffer_load_dwordx4 v[28:31], v1, s[8:11], s35 offen nt
    s_add_u32 s35, s33, 65536
    buffer_load_dwordx4 v[32:35], v1, s[12:15], s35 offen nt
    s_add_u32 s35, s34, 32768
    buffer_load_dwordx2 v[36:37], v2, s[16:19], s35 offen nt
    s_mov_b32 s36, 49152
    buffer_store_dwordx3 v[64:66], v3, s[20:23], s36 offen sc1
    s_mov_b32 s36, 61440
    buffer_store_dwordx3 v[68:70], v3, s[20:23], s36 offen sc1
    s_waitcnt vmcnt(17)
    s_nop 0
    v_perm_b32 v64, v42, v38, s43
    v_perm_b32 v65, v43, v39, s43
    v_perm_b32 v68, v44, v40, s43
    v_perm_b32 v69, v45, v41, s43
    v_mul_hi_u32_u24 v38, 429497, v38
    v_mul_hi_u32_u24 v42, 429497, v42
    v_mul_hi_u32_u24 v39, 429497, v39
    v_mul_hi_u32_u24 v43, 429497, v43
    v_mul_hi_u32_u24 v40, 429497, v40
    v_mul_hi_u32_u24 v44, 429497, v44
    v_mul_hi_u32_u24 v41, 429497, v41
    v_mul_hi_u32_u24 v45, 429497, v45
    v_lshl_or_b32 v38, v42, 16, v38
    v_lshl_or_b32 v39, v43, 16, v39
    v_lshl_or_b32 v40, v44, 16, v40
    v_lshl_or_b32 v41, v45, 16, v41
    v_dot2_u32_u16 v42, v38, s38, 0
    v_dot2_u32_u16 v43, v39, s38, 0
    v_dot2_u32_u16 v44, v40, s38, 0
    v_dot2_u32_u16 v45, v41, s38, 0
    v_pk_mad_u16 v64, v38, s37, v64
    v_pk_mad_u16 v65, v39, s37, v65
    v_pk_mad_u16 v68, v40, s37, v68
    v_pk_mad_u16 v69, v41, s37, v69
    ds_add_u32 v42, v4 offset:0
    ds_add_u32 v43, v4 offset:0
    ds_add_u32 v44, v4 offset:0
    ds_add_u32 v45, v4 offset:0
    v_or_b32 v64, 0x40000000, v64
    v_or_b32 v65, 0x40000000, v65
    v_or_b32 v68, 0x40000000, v68
    v_or_b32 v69, 0x40000000, v69
    v_lshlrev_b32 v38, 16, v46
    v_lshlrev_b32 v40, 16, v47
    v_and_b32 v39, 0xffff0000, v46
    v_and_b32 v41, 0xffff0000, v47
    v_mul_f32 v38, v16, v38
    v_mul_f32 v39, v16, v39
    v_mul_f32 v40, v16, v40
    v_mul_f32 v41, v16, v41
    v_fract_f32 v38, v38
    v_fract_f32 v39, v39
    v_fract_f32 v40, v40
    v_fract_f32 v41, v41
    v_cos_f32 v38, v38
    v_cos_f32 v39, v39
    v_cos_f32 v40, v40
    v_cos_f32 v41, v41
    v_cvt_pk_bf16_f32 v38, 0, v38
    v_cvt_pk_bf16_f32 v39, 0, v39
    v_cvt_pk_bf16_f32 v40, 0, v40
    v_cvt_pk_bf16_f32 v41, 0, v41
    v_or_b32 v66, v38, v42
    v_or_b32 v67, v39, v43
    v_or_b32 v70, v40, v44
    v_or_b32 v71, v41, v45
    v_or3_b32 v5, v66, v67, v5
    v_or3_b32 v5, v70, v71, v5
    s_add_u32 s35, s33, 81920
    buffer_load_dwordx4 v[38:41], v1, s[8:11], s35 offen nt
    s_add_u32 s35, s33, 81920
    buffer_load_dwordx4 v[42:45], v1, s[12:15], s35 offen nt
    s_add_u32 s35, s34, 40960
    buffer_load_dwordx2 v[46:47], v2, s[16:19], s35 offen nt
    s_mov_b32 s36, 73728
    buffer_store_dwordx3 v[72:74], v3, s[20:23], s36 offen sc1
    s_mov_b32 s36, 86016
    buffer_store_dwordx3 v[76:78], v3, s[20:23], s36 offen sc1
    s_waitcnt vmcnt(12)
    s_nop 0
    v_perm_b32 v72, v22, v18, s43
    v_perm_b32 v73, v23, v19, s43
    v_perm_b32 v76, v24, v20, s43
    v_perm_b32 v77, v25, v21, s43
    v_mul_hi_u32_u24 v18, 429497, v18
    v_mul_hi_u32_u24 v22, 429497, v22
    v_mul_hi_u32_u24 v19, 429497, v19
    v_mul_hi_u32_u24 v23, 429497, v23
    v_mul_hi_u32_u24 v20, 429497, v20
    v_mul_hi_u32_u24 v24, 429497, v24
    v_mul_hi_u32_u24 v21, 429497, v21
    v_mul_hi_u32_u24 v25, 429497, v25
    v_lshl_or_b32 v18, v22, 16, v18
    v_lshl_or_b32 v19, v23, 16, v19
    v_lshl_or_b32 v20, v24, 16, v20
    v_lshl_or_b32 v21, v25, 16, v21
    v_dot2_u32_u16 v22, v18, s38, 0
    v_dot2_u32_u16 v23, v19, s38, 0
    v_dot2_u32_u16 v24, v20, s38, 0
    v_dot2_u32_u16 v25, v21, s38, 0
    v_pk_mad_u16 v72, v18, s37, v72
    v_pk_mad_u16 v73, v19, s37, v73
    v_pk_mad_u16 v76, v20, s37, v76
    v_pk_mad_u16 v77, v21, s37, v77
    ds_add_u32 v22, v4 offset:0
    ds_add_u32 v23, v4 offset:0
    ds_add_u32 v24, v4 offset:0
    ds_add_u32 v25, v4 offset:0
    v_or_b32 v72, 0x40000000, v72
    v_or_b32 v73, 0x40000000, v73
    v_or_b32 v76, 0x40000000, v76
    v_or_b32 v77, 0x40000000, v77
    v_lshlrev_b32 v18, 16, v26
    v_lshlrev_b32 v20, 16, v27
    v_and_b32 v19, 0xffff0000, v26
    v_and_b32 v21, 0xffff0000, v27
    v_mul_f32 v18, v16, v18
    v_mul_f32 v19, v16, v19
    v_mul_f32 v20, v16, v20
    v_mul_f32 v21, v16, v21
    v_fract_f32 v18, v18
    v_fract_f32 v19, v19
    v_fract_f32 v20, v20
    v_fract_f32 v21, v21
    v_cos_f32 v18, v18
    v_cos_f32 v19, v19
    v_cos_f32 v20, v20
    v_cos_f32 v21, v21
    v_cvt_pk_bf16_f32 v18, 0, v18
    v_cvt_pk_bf16_f32 v19, 0, v19
    v_cvt_pk_bf16_f32 v20, 0, v20
    v_cvt_pk_bf16_f32 v21, 0, v21
    v_or_b32 v74, v18, v22
    v_or_b32 v75, v19, v23
    v_or_b32 v78, v20, v24
    v_or_b32 v79, v21, v25
    v_or3_b32 v5, v74, v75, v5
    v_or3_b32 v5, v78, v79, v5
    s_add_u32 s35, s33, 98304
    buffer_load_dwordx4 v[18:21], v1, s[8:11], s35 offen nt
    s_add_u32 s35, s33, 98304
    buffer_load_dwordx4 v[22:25], v1, s[12:15], s35 offen nt
    s_add_u32 s35, s34, 49152
    buffer_load_dwordx2 v[26:27], v2, s[16:19], s35 offen nt
    s_mov_b32 s36, 98304
    buffer_store_dwordx3 v[80:82], v3, s[20:23], s36 offen sc1
    s_mov_b32 s36, 110592
    buffer_store_dwordx3 v[84:86], v3, s[20:23], s36 offen sc1
    s_waitcnt vmcnt(12)
    s_nop 0
    v_perm_b32 v80, v32, v28, s43
    v_perm_b32 v81, v33, v29, s43
    v_perm_b32 v84, v34, v30, s43
    v_perm_b32 v85, v35, v31, s43
    v_mul_hi_u32_u24 v28, 429497, v28
    v_mul_hi_u32_u24 v32, 429497, v32
    v_mul_hi_u32_u24 v29, 429497, v29
    v_mul_hi_u32_u24 v33, 429497, v33
    v_mul_hi_u32_u24 v30, 429497, v30
    v_mul_hi_u32_u24 v34, 429497, v34
    v_mul_hi_u32_u24 v31, 429497, v31
    v_mul_hi_u32_u24 v35, 429497, v35
    v_lshl_or_b32 v28, v32, 16, v28
    v_lshl_or_b32 v29, v33, 16, v29
    v_lshl_or_b32 v30, v34, 16, v30
    v_lshl_or_b32 v31, v35, 16, v31
    v_dot2_u32_u16 v32, v28, s38, 0
    v_dot2_u32_u16 v33, v29, s38, 0
    v_dot2_u32_u16 v34, v30, s38, 0
    v_dot2_u32_u16 v35, v31, s38, 0
    v_pk_mad_u16 v80, v28, s37, v80
    v_pk_mad_u16 v81, v29, s37, v81
    v_pk_mad_u16 v84, v30, s37, v84
    v_pk_mad_u16 v85, v31, s37, v85
    ds_add_u32 v32, v4 offset:0
    ds_add_u32 v33, v4 offset:0
    ds_add_u32 v34, v4 offset:0
    ds_add_u32 v35, v4 offset:0
    v_or_b32 v80, 0x40000000, v80
    v_or_b32 v81, 0x40000000, v81
    v_or_b32 v84, 0x40000000, v84
    v_or_b32 v85, 0x40000000, v85
    v_lshlrev_b32 v28, 16, v36
    v_lshlrev_b32 v30, 16, v37
    v_and_b32 v29, 0xffff0000, v36
    v_and_b32 v31, 0xffff0000, v37
    v_mul_f32 v28, v16, v28
    v_mul_f32 v29, v16, v29
    v_mul_f32 v30, v16, v30
    v_mul_f32 v31, v16, v31
    v_fract_f32 v28, v28
    v_fract_f32 v29, v29
    v_fract_f32 v30, v30
    v_fract_f32 v31, v31
    v_cos_f32 v28, v28
    v_cos_f32 v29, v29
    v_cos_f32 v30, v30
    v_cos_f32 v31, v31
    v_cvt_pk_bf16_f32 v28, 0, v28
    v_cvt_pk_bf16_f32 v29, 0, v29
    v_cvt_pk_bf16_f32 v30, 0, v30
    v_cvt_pk_bf16_f32 v31, 0, v31
    v_or_b32 v82, v28, v32
    v_or_b32 v83, v29, v33
    v_or_b32 v86, v30, v34
    v_or_b32 v87, v31, v35
    v_or3_b32 v5, v82, v83, v5
    v_or3_b32 v5, v86, v87, v5
    s_add_u32 s35, s33, 114688
    buffer_load_dwordx4 v[28:31], v1, s[8:11], s35 offen nt
    s_add_u32 s35, s33, 114688
    buffer_load_dwordx4 v[32:35], v1, s[12:15], s35 offen nt
    s_add_u32 s35, s34, 57344
    buffer_load_dwordx2 v[36:37], v2, s[16:19], s35 offen nt
    s_mov_b32 s36, 122880
    buffer_store_dwordx3 v[88:90], v3, s[20:23], s36 offen sc1
    s_mov_b32 s36, 135168
    buffer_store_dwordx3 v[92:94], v3, s[20:23], s36 offen sc1
    s_waitcnt vmcnt(12)
    s_nop 0
    v_perm_b32 v88, v42, v38, s43
    v_perm_b32 v89, v43, v39, s43
    v_perm_b32 v92, v44, v40, s43
    v_perm_b32 v93, v45, v41, s43
    v_mul_hi_u32_u24 v38, 429497, v38
    v_mul_hi_u32_u24 v42, 429497, v42
    v_mul_hi_u32_u24 v39, 429497, v39
    v_mul_hi_u32_u24 v43, 429497, v43
    v_mul_hi_u32_u24 v40, 429497, v40
    v_mul_hi_u32_u24 v44, 429497, v44
    v_mul_hi_u32_u24 v41, 429497, v41
    v_mul_hi_u32_u24 v45, 429497, v45
    v_lshl_or_b32 v38, v42, 16, v38
    v_lshl_or_b32 v39, v43, 16, v39
    v_lshl_or_b32 v40, v44, 16, v40
    v_lshl_or_b32 v41, v45, 16, v41
    v_dot2_u32_u16 v42, v38, s38, 0
    v_dot2_u32_u16 v43, v39, s38, 0
    v_dot2_u32_u16 v44, v40, s38, 0
    v_dot2_u32_u16 v45, v41, s38, 0
    v_pk_mad_u16 v88, v38, s37, v88
    v_pk_mad_u16 v89, v39, s37, v89
    v_pk_mad_u16 v92, v40, s37, v92
    v_pk_mad_u16 v93, v41, s37, v93
    ds_add_u32 v42, v4 offset:0
    ds_add_u32 v43, v4 offset:0
    ds_add_u32 v44, v4 offset:0
    ds_add_u32 v45, v4 offset:0
    v_or_b32 v88, 0x40000000, v88
    v_or_b32 v89, 0x40000000, v89
    v_or_b32 v92, 0x40000000, v92
    v_or_b32 v93, 0x40000000, v93
    v_lshlrev_b32 v38, 16, v46
    v_lshlrev_b32 v40, 16, v47
    v_and_b32 v39, 0xffff0000, v46
    v_and_b32 v41, 0xffff0000, v47
    v_mul_f32 v38, v16, v38
    v_mul_f32 v39, v16, v39
    v_mul_f32 v40, v16, v40
    v_mul_f32 v41, v16, v41
    v_fract_f32 v38, v38
    v_fract_f32 v39, v39
    v_fract_f32 v40, v40
    v_fract_f32 v41, v41
    v_cos_f32 v38, v38
    v_cos_f32 v39, v39
    v_cos_f32 v40, v40
    v_cos_f32 v41, v41
    v_cvt_pk_bf16_f32 v38, 0, v38
    v_cvt_pk_bf16_f32 v39, 0, v39
    v_cvt_pk_bf16_f32 v40, 0, v40
    v_cvt_pk_bf16_f32 v41, 0, v41
    v_or_b32 v90, v38, v42
    v_or_b32 v91, v39, v43
    v_or_b32 v94, v40, v44
    v_or_b32 v95, v41, v45
    v_or3_b32 v5, v90, v91, v5
    v_or3_b32 v5, v94, v95, v5
    s_add_u32 s35, s33, 131072
    buffer_load_dwordx4 v[38:41], v1, s[8:11], s35 offen nt
    s_add_u32 s35, s33, 131072
    buffer_load_dwordx4 v[42:45], v1, s[12:15], s35 offen nt
    s_add_u32 s35, s34, 65536
    buffer_load_dwordx2 v[46:47], v2, s[16:19], s35 offen nt
    s_mov_b32 s36, 147456
    buffer_store_dwordx3 v[96:98], v3, s[20:23], s36 offen sc1
    s_mov_b32 s36, 159744
    buffer_store_dwordx3 v[100:102], v3, s[20:23], s36 offen sc1
    s_waitcnt vmcnt(12)
    s_nop 0
    v_perm_b32 v96, v22, v18, s43
    v_perm_b32 v97, v23, v19, s43
    v_perm_b32 v100, v24, v20, s43
    v_perm_b32 v101, v25, v21, s43
    v_mul_hi_u32_u24 v18, 429497, v18
    v_mul_hi_u32_u24 v22, 429497, v22
    v_mul_hi_u32_u24 v19, 429497, v19
    v_mul_hi_u32_u24 v23, 429497, v23
    v_mul_hi_u32_u24 v20, 429497, v20
    v_mul_hi_u32_u24 v24, 429497, v24
    v_mul_hi_u32_u24 v21, 429497, v21
    v_mul_hi_u32_u24 v25, 429497, v25
    v_lshl_or_b32 v18, v22, 16, v18
    v_lshl_or_b32 v19, v23, 16, v19
    v_lshl_or_b32 v20, v24, 16, v20
    v_lshl_or_b32 v21, v25, 16, v21
    v_dot2_u32_u16 v22, v18, s38, 0
    v_dot2_u32_u16 v23, v19, s38, 0
    v_dot2_u32_u16 v24, v20, s38, 0
    v_dot2_u32_u16 v25, v21, s38, 0
    v_pk_mad_u16 v96, v18, s37, v96
    v_pk_mad_u16 v97, v19, s37, v97
    v_pk_mad_u16 v100, v20, s37, v100
    v_pk_mad_u16 v101, v21, s37, v101
    ds_add_u32 v22, v4 offset:0
    ds_add_u32 v23, v4 offset:0
    ds_add_u32 v24, v4 offset:0
    ds_add_u32 v25, v4 offset:0
    v_or_b32 v96, 0x40000000, v96
    v_or_b32 v97, 0x40000000, v97
    v_or_b32 v100, 0x40000000, v100
    v_or_b32 v101, 0x40000000, v101
    v_lshlrev_b32 v18, 16, v26
    v_lshlrev_b32 v20, 16, v27
    v_and_b32 v19, 0xffff0000, v26
    v_and_b32 v21, 0xffff0000, v27
    v_mul_f32 v18, v16, v18
    v_mul_f32 v19, v16, v19
    v_mul_f32 v20, v16, v20
    v_mul_f32 v21, v16, v21
    v_fract_f32 v18, v18
    v_fract_f32 v19, v19
    v_fract_f32 v20, v20
    v_fract_f32 v21, v21
    v_cos_f32 v18, v18
    v_cos_f32 v19, v19
    v_cos_f32 v20, v20
    v_cos_f32 v21, v21
    v_cvt_pk_bf16_f32 v18, 0, v18
    v_cvt_pk_bf16_f32 v19, 0, v19
    v_cvt_pk_bf16_f32 v20, 0, v20
    v_cvt_pk_bf16_f32 v21, 0, v21
    v_or_b32 v98, v18, v22
    v_or_b32 v99, v19, v23
    v_or_b32 v102, v20, v24
    v_or_b32 v103, v21, v25
    v_or3_b32 v5, v98, v99, v5
    v_or3_b32 v5, v102, v103, v5
    s_mov_b32 s36, 172032
    buffer_store_dwordx3 v[104:106], v3, s[20:23], s36 offen sc1
    s_mov_b32 s36, 184320
    buffer_store_dwordx3 v[108:110], v3, s[20:23], s36 offen sc1
    s_waitcnt vmcnt(9)
    s_nop 0
    v_perm_b32 v104, v32, v28, s43
    v_perm_b32 v105, v33, v29, s43
    v_perm_b32 v108, v34, v30, s43
    v_perm_b32 v109, v35, v31, s43
    v_mul_hi_u32_u24 v28, 429497, v28
    v_mul_hi_u32_u24 v32, 429497, v32
    v_mul_hi_u32_u24 v29, 429497, v29
    v_mul_hi_u32_u24 v33, 429497, v33
    v_mul_hi_u32_u24 v30, 429497, v30
    v_mul_hi_u32_u24 v34, 429497, v34
    v_mul_hi_u32_u24 v31, 429497, v31
    v_mul_hi_u32_u24 v35, 429497, v35
    v_lshl_or_b32 v28, v32, 16, v28
    v_lshl_or_b32 v29, v33, 16, v29
    v_lshl_or_b32 v30, v34, 16, v30
    v_lshl_or_b32 v31, v35, 16, v31
    v_dot2_u32_u16 v32, v28, s38, 0
    v_dot2_u32_u16 v33, v29, s38, 0
    v_dot2_u32_u16 v34, v30, s38, 0
    v_dot2_u32_u16 v35, v31, s38, 0
    v_pk_mad_u16 v104, v28, s37, v104
    v_pk_mad_u16 v105, v29, s37, v105
    v_pk_mad_u16 v108, v30, s37, v108
    v_pk_mad_u16 v109, v31, s37, v109
    ds_add_u32 v32, v4 offset:0
    ds_add_u32 v33, v4 offset:0
    ds_add_u32 v34, v4 offset:0
    ds_add_u32 v35, v4 offset:0
    v_or_b32 v104, 0x40000000, v104
    v_or_b32 v105, 0x40000000, v105
    v_or_b32 v108, 0x40000000, v108
    v_or_b32 v109, 0x40000000, v109
    v_lshlrev_b32 v28, 16, v36
    v_lshlrev_b32 v30, 16, v37
    v_and_b32 v29, 0xffff0000, v36
    v_and_b32 v31, 0xffff0000, v37
    v_mul_f32 v28, v16, v28
    v_mul_f32 v29, v16, v29
    v_mul_f32 v30, v16, v30
    v_mul_f32 v31, v16, v31
    v_fract_f32 v28, v28
    v_fract_f32 v29, v29
    v_fract_f32 v30, v30
    v_fract_f32 v31, v31
    v_cos_f32 v28, v28
    v_cos_f32 v29, v29
    v_cos_f32 v30, v30
    v_cos_f32 v31, v31
    v_cvt_pk_bf16_f32 v28, 0, v28
    v_cvt_pk_bf16_f32 v29, 0, v29
    v_cvt_pk_bf16_f32 v30, 0, v30
    v_cvt_pk_bf16_f32 v31, 0, v31
    v_or_b32 v106, v28, v32
    v_or_b32 v107, v29, v33
    v_or_b32 v110, v30, v34
    v_or_b32 v111, v31, v35
    v_or3_b32 v5, v106, v107, v5
    v_or3_b32 v5, v110, v111, v5
    s_mov_b32 s36, 196608
    buffer_store_dwordx3 v[112:114], v3, s[20:23], s36 offen sc1
    s_mov_b32 s36, 208896
    buffer_store_dwordx3 v[116:118], v3, s[20:23], s36 offen sc1
    s_waitcnt vmcnt(6)
    s_nop 0
    v_perm_b32 v112, v42, v38, s43
    v_perm_b32 v113, v43, v39, s43
    v_perm_b32 v116, v44, v40, s43
    v_perm_b32 v117, v45, v41, s43
    v_mul_hi_u32_u24 v38, 429497, v38
    v_mul_hi_u32_u24 v42, 429497, v42
    v_mul_hi_u32_u24 v39, 429497, v39
    v_mul_hi_u32_u24 v43, 429497, v43
    v_mul_hi_u32_u24 v40, 429497, v40
    v_mul_hi_u32_u24 v44, 429497, v44
    v_mul_hi_u32_u24 v41, 429497, v41
    v_mul_hi_u32_u24 v45, 429497, v45
    v_lshl_or_b32 v38, v42, 16, v38
    v_lshl_or_b32 v39, v43, 16, v39
    v_lshl_or_b32 v40, v44, 16, v40
    v_lshl_or_b32 v41, v45, 16, v41
    v_dot2_u32_u16 v42, v38, s38, 0
    v_dot2_u32_u16 v43, v39, s38, 0
    v_dot2_u32_u16 v44, v40, s38, 0
    v_dot2_u32_u16 v45, v41, s38, 0
    v_pk_mad_u16 v112, v38, s37, v112
    v_pk_mad_u16 v113, v39, s37, v113
    v_pk_mad_u16 v116, v40, s37, v116
    v_pk_mad_u16 v117, v41, s37, v117
    ds_add_u32 v42, v4 offset:0
    ds_add_u32 v43, v4 offset:0
    ds_add_u32 v44, v4 offset:0
    ds_add_u32 v45, v4 offset:0
    v_or_b32 v112, 0x40000000, v112
    v_or_b32 v113, 0x40000000, v113
    v_or_b32 v116, 0x40000000, v116
    v_or_b32 v117, 0x40000000, v117
    v_lshlrev_b32 v38, 16, v46
    v_lshlrev_b32 v40, 16, v47
    v_and_b32 v39, 0xffff0000, v46
    v_and_b32 v41, 0xffff0000, v47
    v_mul_f32 v38, v16, v38
    v_mul_f32 v39, v16, v39
    v_mul_f32 v40, v16, v40
    v_mul_f32 v41, v16, v41
    v_fract_f32 v38, v38
    v_fract_f32 v39, v39
    v_fract_f32 v40, v40
    v_fract_f32 v41, v41
    v_cos_f32 v38, v38
    v_cos_f32 v39, v39
    v_cos_f32 v40, v40
    v_cos_f32 v41, v41
    v_cvt_pk_bf16_f32 v38, 0, v38
    v_cvt_pk_bf16_f32 v39, 0, v39
    v_cvt_pk_bf16_f32 v40, 0, v40
    v_cvt_pk_bf16_f32 v41, 0, v41
    v_or_b32 v114, v38, v42
    v_or_b32 v115, v39, v43
    v_or_b32 v118, v40, v44
    v_or_b32 v119, v41, v45
    v_or3_b32 v5, v114, v115, v5
    v_or3_b32 v5, v118, v119, v5
    s_mov_b64 exec, s[44:45]
    v_perm_b32 v8, v124, v120, s43
    v_perm_b32 v9, v125, v121, s43
    v_perm_b32 v10, v126, v122, s43
    v_perm_b32 v11, v127, v123, s43
    v_mul_hi_u32_u24 v120, 429497, v120
    v_mul_hi_u32_u24 v124, 429497, v124
    v_mul_hi_u32_u24 v121, 429497, v121
    v_mul_hi_u32_u24 v125, 429497, v125
    v_mul_hi_u32_u24 v122, 429497, v122
    v_mul_hi_u32_u24 v126, 429497, v126
    v_mul_hi_u32_u24 v123, 429497, v123
    v_mul_hi_u32_u24 v127, 429497, v127
    v_lshl_or_b32 v120, v124, 16, v120
    v_lshl_or_b32 v121, v125, 16, v121
    v_lshl_or_b32 v122, v126, 16, v122
    v_lshl_or_b32 v123, v127, 16, v123
    v_dot2_u32_u16 v124, v120, s38, 0
    v_dot2_u32_u16 v125, v121, s38, 0
    v_dot2_u32_u16 v126, v122, s38, 0
    v_dot2_u32_u16 v127, v123, s38, 0
    v_pk_mad_u16 v8, v120, s37, v8
    v_pk_mad_u16 v9, v121, s37, v9
    v_pk_mad_u16 v10, v122, s37, v10
    v_pk_mad_u16 v11, v123, s37, v11
    ds_add_u32 v124, v4 offset:0
    ds_add_u32 v125, v4 offset:0
    ds_add_u32 v126, v4 offset:0
    ds_add_u32 v127, v4 offset:0
    v_or_b32 v8, 0x40000000, v8
    v_or_b32 v9, 0x40000000, v9
    v_or_b32 v10, 0x40000000, v10
    v_or_b32 v11, 0x40000000, v11
    v_lshlrev_b32 v120, 16, v6
    v_lshlrev_b32 v122, 16, v7
    v_and_b32 v121, 0xffff0000, v6
    v_and_b32 v123, 0xffff0000, v7
    v_mul_f32 v120, v16, v120
    v_mul_f32 v121, v16, v121
    v_mul_f32 v122, v16, v122
    v_mul_f32 v123, v16, v123
    v_fract_f32 v120, v120
    v_fract_f32 v121, v121
    v_fract_f32 v122, v122
    v_fract_f32 v123, v123
    v_cos_f32 v120, v120
    v_cos_f32 v121, v121
    v_cos_f32 v122, v122
    v_cos_f32 v123, v123
    v_cvt_pk_bf16_f32 v120, 0, v120
    v_cvt_pk_bf16_f32 v121, 0, v121
    v_cvt_pk_bf16_f32 v122, 0, v122
    v_cvt_pk_bf16_f32 v123, 0, v123
    v_or_b32 v122, v122, v126
    v_or_b32 v123, v123, v127
    v_or_b32 v126, v120, v124
    v_or_b32 v127, v121, v125
    v_or3_b32 v5, v126, v127, v5
    v_or3_b32 v5, v122, v123, v5
    v_mov_b32 v120, v10
    v_mov_b32 v121, v11
    v_mov_b32 v124, v8
    v_mov_b32 v125, v9
    s_mov_b64 exec, -1
    s_and_b32 s35, s32, 15
    s_lshl_b32 s35, s35, 6
    s_lshr_b32 s36, s32, 4
    s_add_u32 s35, s35, s36
    s_lshl_b32 s42, s35, 5
    s_mul_i32 s35, s35, 240512
    s_add_u32 s35, s35, 8192
    s_add_u32 s20, s4, s35
    s_addc_u32 s21, s5, 0
    s_waitcnt lgkmcnt(0)
    s_barrier
    ds_read_b128 v[8:11], v1 offset:0
    s_add_u32 s35, s33, 40960000
    buffer_load_dwordx4 v[18:21], v1, s[8:11], s35 offen nt
    s_lshl_b32 s35, s39, 2
    s_add_u32 s35, s35, 160256
    v_mov_b32 v7, s35
    v_and_b32 v14, 15, v0
    v_lshlrev_b32 v14, 2, v14
    v_add_u32 v14, 160256, v14
    s_waitcnt lgkmcnt(0)
    v_cmp_eq_u32 s[56:57], 0, v8
    v_max_u32 v12, 1, v8
    v_lshl_or_b32 v8, v8, 16, v12
    v_cmp_eq_u32 s[58:59], 0, v9
    v_max_u32 v12, 1, v9
    v_lshl_or_b32 v9, v9, 16, v12
    v_cmp_eq_u32 s[60:61], 0, v10
    v_max_u32 v12, 1, v10
    v_lshl_or_b32 v10, v10, 16, v12
    v_cmp_eq_u32 s[62:63], 0, v11
    v_max_u32 v12, 1, v11
    v_lshl_or_b32 v11, v11, 16, v12
    v_add_u32 v9, v8, v9
    v_add_u32 v10, v9, v10
    v_add_u32 v11, v10, v11
    v_mov_b32 v6, v11
    s_nop 1
    v_add_u32_dpp v6, v6, v6 row_shr:1 row_mask:0xf bank_mask:0xf bound_ctrl:0
    s_nop 1
    v_add_u32_dpp v6, v6, v6 row_shr:2 row_mask:0xf bank_mask:0xf bound_ctrl:0
    s_nop 1
    v_add_u32_dpp v6, v6, v6 row_shr:4 row_mask:0xf bank_mask:0xf bound_ctrl:0
    s_nop 1
    v_add_u32_dpp v6, v6, v6 row_shr:8 row_mask:0xf bank_mask:0xf bound_ctrl:0
    s_nop 1
    v_add_u32_dpp v6, v6, v6 row_bcast:15 row_mask:0xa bank_mask:0xf
    s_nop 1
    v_add_u32_dpp v6, v6, v6 row_bcast:31 row_mask:0xc bank_mask:0xf
    s_mov_b32 exec_lo, 0
    s_brev_b32 exec_hi, 1
    ds_write_b32 v7, v6
    s_mov_b64 exec, -1
    v_sub_u32 v6, v6, v11
    s_or_b64 s[46:47], s[56:57], s[58:59]
    s_or_b64 vcc, s[60:61], s[62:63]
    s_or_b64 s[46:47], s[46:47], vcc
    s_waitcnt lgkmcnt(0)
    s_barrier
    ds_read_b32 v7, v14
    s_waitcnt lgkmcnt(0)
    v_mov_b32 v15, v7
    s_nop 1
    v_add_u32_dpp v7, v7, v7 row_shr:1 row_mask:0xf bank_mask:0xf bound_ctrl:0
    s_nop 1
    v_add_u32_dpp v7, v7, v7 row_shr:2 row_mask:0xf bank_mask:0xf bound_ctrl:0
    s_nop 1
    v_add_u32_dpp v7, v7, v7 row_shr:4 row_mask:0xf bank_mask:0xf bound_ctrl:0
    s_nop 1
    v_add_u32_dpp v7, v7, v7 row_shr:8 row_mask:0xf bank_mask:0xf bound_ctrl:0
    s_nop 0
    v_readlane_b32 s54, v7, 15
    v_sub_u32 v7, v7, v15
    s_nop 0
    v_readlane_b32 s35, v7, s39
    s_and_b32 s54, s54, 0xffff
    s_cmp_ge_u32 s54, 40064
    s_cselect_b32 s36, 16, 0
    s_cselect_b32 s54, 40000, s54
    s_cselect_b32 s55, 1, s55
    s_cselect_b64 s[46:47], 0, s[46:47]
    v_add_u32 v12, s35, v6
    v_add_u32 v13, v12, v8
    v_add_u32 v14, v12, v9
    v_add_u32 v15, v12, v10
    v_bfe_u32 v12, v12, s36, 16
    v_bfe_u32 v13, v13, s36, 16
    v_bfe_u32 v14, v14, s36, 16
    v_bfe_u32 v15, v15, s36, 16
    ds_write_b128 v1, v[12:15] offset:0
    ds_write_b128 v1, v[12:15] offset:16384
    v_mov_b32 v6, 32768
    v_mov_b32 v7, s54
    s_mov_b64 exec, 1
    ds_write_b32 v6, v7
    s_mov_b64 exec, -1
    s_add_u32 s35, s54, 1
    s_lshr_b32 s35, s35, 1
    s_mul_i32 s35, s35, 12
    s_min_u32 s22, s35, 240512
    v_perm_b32 v15, v15, v14, s43
    v_perm_b32 v14, v13, v12, s43
    s_waitcnt lgkmcnt(0)
    s_barrier
    s_add_u32 s35, s33, 40960000
    buffer_load_dwordx4 v[22:25], v1, s[12:15], s35 offen nt
    v_and_b32 v6, 63, v0
    s_lshl_b32 s35, s39, 10
    v_lshl_add_u32 v7, v6, 2, s35
    v_lshl_add_u32 v12, v6, 8, s35
    ds_read_b32 v8, v7 offset:16384
    ds_read_b32 v9, v7 offset:16640
    ds_read_b32 v10, v7 offset:16896
    ds_read_b32 v11, v7 offset:17152
    s_mov_b64 exec, 15
    ds_read_b32 v12, v12 offset:16640
    s_mov_b64 exec, -1
    s_lshr_b32 s35, s39, 2
    s_mul_i32 s35, s35, 2138240
    s_and_b32 s36, s39, 3
    s_lshl_b32 s36, s36, 3
    s_add_u32 s35, s35, s36
    s_add_u32 s35, s35, s42
    s_add_u32 s36, s35, 2105344
    v_mul_u32_u24 v7, 32896, v6
    v_lshlrev_b32 v13, 1, v6
    s_waitcnt lgkmcnt(1)
    v_perm_b32 v8, v9, v8, s43
    v_perm_b32 v9, v11, v10, s43
    buffer_store_dwordx2 v[8:9], v7, s[24:27], s35 offen
    s_waitcnt lgkmcnt(0)
    s_mov_b64 exec, 15
    buffer_store_short v12, v13, s[24:27], s36 offen
    s_mov_b64 exec, -1
    s_nop 0
    v_and_b32 v6, 0xffff, v50
    v_and_b32 v7, 0xffff, v51
    v_and_b32 v8, 0xffff, v54
    v_and_b32 v9, 0xffff, v55
    ds_add_rtn_u32 v6, v6, v4 offset:0
    ds_add_rtn_u32 v7, v7, v4 offset:0
    ds_add_rtn_u32 v8, v8, v4 offset:0
    ds_add_rtn_u32 v9, v9, v4 offset:0
    v_and_b32 v10, 0xffff, v58
    v_and_b32 v11, 0xffff, v59
    v_and_b32 v12, 0xffff, v62
    v_and_b32 v13, 0xffff, v63
    ds_add_rtn_u32 v10, v10, v4 offset:0
    ds_add_rtn_u32 v11, v11, v4 offset:0
    ds_add_rtn_u32 v12, v12, v4 offset:0
    ds_add_rtn_u32 v13, v13, v4 offset:0
    s_waitcnt lgkmcnt(4)
    v_bfi_b32 v50, s41, v6, v50
    v_bfi_b32 v51, s41, v7, v51
    v_bfi_b32 v54, s41, v8, v54
    v_bfi_b32 v55, s41, v9, v55
    v_and_b32 v6, 0xffff, v66
    v_and_b32 v7, 0xffff, v67
    v_and_b32 v8, 0xffff, v70
    v_and_b32 v9, 0xffff, v71
    ds_add_rtn_u32 v6, v6, v4 offset:0
    ds_add_rtn_u32 v7, v7, v4 offset:0
    ds_add_rtn_u32 v8, v8, v4 offset:0
    ds_add_rtn_u32 v9, v9, v4 offset:0
    s_waitcnt lgkmcnt(4)
    v_bfi_b32 v58, s41, v10, v58
    v_bfi_b32 v59, s41, v11, v59
    v_bfi_b32 v62, s41, v12, v62
    v_bfi_b32 v63, s41, v13, v63
    v_and_b32 v10, 0xffff, v74
    v_and_b32 v11, 0xffff, v75
    v_and_b32 v12, 0xffff, v78
    v_and_b32 v13, 0xffff, v79
    ds_add_rtn_u32 v10, v10, v4 offset:0
    ds_add_rtn_u32 v11, v11, v4 offset:0
    ds_add_rtn_u32 v12, v12, v4 offset:0
    ds_add_rtn_u32 v13, v13, v4 offset:0
    s_waitcnt lgkmcnt(4)
    v_bfi_b32 v66, s41, v6, v66
    v_bfi_b32 v67, s41, v7, v67
    v_bfi_b32 v70, s41, v8, v70
    v_bfi_b32 v71, s41, v9, v71
    s_add_u32 s35, s34, 20480000
    buffer_load_dwordx2 v[26:27], v2, s[16:19], s35 offen nt
    v_and_b32 v6, 0xffff, v82
    v_and_b32 v7, 0xffff, v83
    v_and_b32 v8, 0xffff, v86
    v_and_b32 v9, 0xffff, v87
    ds_add_rtn_u32 v6, v6, v4 offset:0
    ds_add_rtn_u32 v7, v7, v4 offset:0
    ds_add_rtn_u32 v8, v8, v4 offset:0
    ds_add_rtn_u32 v9, v9, v4 offset:0
    s_waitcnt lgkmcnt(4)
    v_bfi_b32 v74, s41, v10, v74
    v_bfi_b32 v75, s41, v11, v75
    v_bfi_b32 v78, s41, v12, v78
    v_bfi_b32 v79, s41, v13, v79
    v_and_b32 v10, 0xffff, v90
    v_and_b32 v11, 0xffff, v91
    v_and_b32 v12, 0xffff, v94
    v_and_b32 v13, 0xffff, v95
    ds_add_rtn_u32 v10, v10, v4 offset:0
    ds_add_rtn_u32 v11, v11, v4 offset:0
    ds_add_rtn_u32 v12, v12, v4 offset:0
    ds_add_rtn_u32 v13, v13, v4 offset:0
    s_waitcnt lgkmcnt(4)
    v_bfi_b32 v82, s41, v6, v82
    v_bfi_b32 v83, s41, v7, v83
    v_bfi_b32 v86, s41, v8, v86
    v_bfi_b32 v87, s41, v9, v87
    v_and_b32 v6, 0xffff, v98
    v_and_b32 v7, 0xffff, v99
    v_and_b32 v8, 0xffff, v102
    v_and_b32 v9, 0xffff, v103
    ds_add_rtn_u32 v6, v6, v4 offset:0
    ds_add_rtn_u32 v7, v7, v4 offset:0
    ds_add_rtn_u32 v8, v8, v4 offset:0
    ds_add_rtn_u32 v9, v9, v4 offset:0
    s_waitcnt lgkmcnt(4)
    v_bfi_b32 v90, s41, v10, v90
    v_bfi_b32 v91, s41, v11, v91
    v_bfi_b32 v94, s41, v12, v94
    v_bfi_b32 v95, s41, v13, v95
    v_and_b32 v10, 0xffff, v106
    v_and_b32 v11, 0xffff, v107
    v_and_b32 v12, 0xffff, v110
    v_and_b32 v13, 0xffff, v111
    ds_add_rtn_u32 v10, v10, v4 offset:0
    ds_add_rtn_u32 v11, v11, v4 offset:0
    ds_add_rtn_u32 v12, v12, v4 offset:0
    ds_add_rtn_u32 v13, v13, v4 offset:0
    s_waitcnt lgkmcnt(4)
    v_bfi_b32 v98, s41, v6, v98
    v_bfi_b32 v99, s41, v7, v99
    v_bfi_b32 v102, s41, v8, v102
    v_bfi_b32 v103, s41, v9, v103
    s_add_u32 s35, s33, 40976384
    buffer_load_dwordx4 v[28:31], v1, s[8:11], s35 offen nt
    v_and_b32 v6, 0xffff, v114
    v_and_b32 v7, 0xffff, v115
    v_and_b32 v8, 0xffff, v118
    v_and_b32 v9, 0xffff, v119
    ds_add_rtn_u32 v6, v6, v4 offset:0
    ds_add_rtn_u32 v7, v7, v4 offset:0
    ds_add_rtn_u32 v8, v8, v4 offset:0
    ds_add_rtn_u32 v9, v9, v4 offset:0
    s_waitcnt lgkmcnt(4)
    v_bfi_b32 v106, s41, v10, v106
    v_bfi_b32 v107, s41, v11, v107
    v_bfi_b32 v110, s41, v12, v110
    v_bfi_b32 v111, s41, v13, v111
    s_mov_b64 exec, s[44:45]
    v_and_b32 v10, 0xffff, v122
    v_and_b32 v11, 0xffff, v123
    v_and_b32 v12, 0xffff, v126
    v_and_b32 v13, 0xffff, v127
    ds_add_rtn_u32 v10, v10, v4 offset:0
    ds_add_rtn_u32 v11, v11, v4 offset:0
    ds_add_rtn_u32 v12, v12, v4 offset:0
    ds_add_rtn_u32 v13, v13, v4 offset:0
    s_mov_b64 exec, -1
    s_waitcnt lgkmcnt(4)
    v_bfi_b32 v114, s41, v6, v114
    v_bfi_b32 v115, s41, v7, v115
    v_bfi_b32 v118, s41, v8, v118
    v_bfi_b32 v119, s41, v9, v119
    s_waitcnt lgkmcnt(0)
    v_bfi_b32 v122, s41, v10, v122
    v_bfi_b32 v123, s41, v11, v123
    v_bfi_b32 v126, s41, v12, v126
    v_bfi_b32 v127, s41, v13, v127
    s_barrier
    s_lshl_b32 s35, s54, 2
    v_mov_b32 v6, s35
    v_mov_b32 v7, 0
    s_mov_b64 exec, 1
    ds_write_b32 v6, v7
    s_cmp_eq_u64 s[46:47], 0
    s_cbranch_scc1 L_p1_kernel_nonull_1
    s_mov_b64 exec, s[56:57]
    v_lshlrev_b32_sdwa v6, 2, v14 dst_sel:DWORD dst_unused:UNUSED_PAD src0_sel:DWORD src1_sel:WORD_0
    ds_write_b32 v6, v7
    s_mov_b64 exec, s[58:59]
    v_lshlrev_b32_sdwa v6, 2, v14 dst_sel:DWORD dst_unused:UNUSED_PAD src0_sel:DWORD src1_sel:WORD_1
    ds_write_b32 v6, v7
    s_mov_b64 exec, s[60:61]
    v_lshlrev_b32_sdwa v6, 2, v15 dst_sel:DWORD dst_unused:UNUSED_PAD src0_sel:DWORD src1_sel:WORD_0
    ds_write_b32 v6, v7
    s_mov_b64 exec, s[62:63]
    v_lshlrev_b32_sdwa v6, 2, v15 dst_sel:DWORD dst_unused:UNUSED_PAD src0_sel:DWORD src1_sel:WORD_1
    ds_write_b32 v6, v7
L_p1_kernel_nonull_1:
    s_mov_b64 exec, -1
    v_lshlrev_b32_sdwa v6, 2, v50 dst_sel:DWORD dst_unused:UNUSED_PAD src0_sel:DWORD src1_sel:WORD_0
    ds_write_b32 v6, v48 offset:0
    v_lshlrev_b32_sdwa v7, 2, v51 dst_sel:DWORD dst_unused:UNUSED_PAD src0_sel:DWORD src1_sel:WORD_0
    ds_write_b32 v7, v49 offset:0
    v_lshlrev_b32_sdwa v8, 2, v54 dst_sel:DWORD dst_unused:UNUSED_PAD src0_sel:DWORD src1_sel:WORD_0
    ds_write_b32 v8, v52 offset:0
    v_lshlrev_b32_sdwa v9, 2, v55 dst_sel:DWORD dst_unused:UNUSED_PAD src0_sel:DWORD src1_sel:WORD_0
    ds_write_b32 v9, v53 offset:0
    v_lshlrev_b32_sdwa v10, 2, v58 dst_sel:DWORD dst_unused:UNUSED_PAD src0_sel:DWORD src1_sel:WORD_0
    ds_write_b32 v10, v56 offset:0
    v_lshlrev_b32_sdwa v11, 2, v59 dst_sel:DWORD dst_unused:UNUSED_PAD src0_sel:DWORD src1_sel:WORD_0
    ds_write_b32 v11, v57 offset:0
    s_add_u32 s35, s33, 40976384
    buffer_load_dwordx4 v[32:35], v1, s[12:15], s35 offen nt
    v_lshlrev_b32_sdwa v12, 2, v62 dst_sel:DWORD dst_unused:UNUSED_PAD src0_sel:DWORD src1_sel:WORD_0
    ds_write_b32 v12, v60 offset:0
    v_lshlrev_b32_sdwa v13, 2, v63 dst_sel:DWORD dst_unused:UNUSED_PAD src0_sel:DWORD src1_sel:WORD_0
    ds_write_b32 v13, v61 offset:0
    v_lshlrev_b32_sdwa v6, 2, v66 dst_sel:DWORD dst_unused:UNUSED_PAD src0_sel:DWORD src1_sel:WORD_0
    ds_write_b32 v6, v64 offset:0
    v_lshlrev_b32_sdwa v7, 2, v67 dst_sel:DWORD dst_unused:UNUSED_PAD src0_sel:DWORD src1_sel:WORD_0
    ds_write_b32 v7, v65 offset:0
    v_lshlrev_b32_sdwa v8, 2, v70 dst_sel:DWORD dst_unused:UNUSED_PAD src0_sel:DWORD src1_sel:WORD_0
    ds_write_b32 v8, v68 offset:0
    v_lshlrev_b32_sdwa v9, 2, v71 dst_sel:DWORD dst_unused:UNUSED_PAD src0_sel:DWORD src1_sel:WORD_0
    ds_write_b32 v9, v69 offset:0
    v_lshlrev_b32_sdwa v10, 2, v74 dst_sel:DWORD dst_unused:UNUSED_PAD src0_sel:DWORD src1_sel:WORD_0
    ds_write_b32 v10, v72 offset:0
    v_lshlrev_b32_sdwa v11, 2, v75 dst_sel:DWORD dst_unused:UNUSED_PAD src0_sel:DWORD src1_sel:WORD_0
    ds_write_b32 v11, v73 offset:0
    v_lshlrev_b32_sdwa v12, 2, v78 dst_sel:DWORD dst_unused:UNUSED_PAD src0_sel:DWORD src1_sel:WORD_0
    ds_write_b32 v12, v76 offset:0
    v_lshlrev_b32_sdwa v13, 2, v79 dst_sel:DWORD dst_unused:UNUSED_PAD src0_sel:DWORD src1_sel:WORD_0
    ds_write_b32 v13, v77 offset:0
    v_lshlrev_b32_sdwa v6, 2, v82 dst_sel:DWORD dst_unused:UNUSED_PAD src0_sel:DWORD src1_sel:WORD_0
    ds_write_b32 v6, v80 offset:0
    v_lshlrev_b32_sdwa v7, 2, v83 dst_sel:DWORD dst_unused:UNUSED_PAD src0_sel:DWORD src1_sel:WORD_0
    ds_write_b32 v7, v81 offset:0
    v_lshlrev_b32_sdwa v8, 2, v86 dst_sel:DWORD dst_unused:UNUSED_PAD src0_sel:DWORD src1_sel:WORD_0
    ds_write_b32 v8, v84 offset:0
    v_lshlrev_b32_sdwa v9, 2, v87 dst_sel:DWORD dst_unused:UNUSED_PAD src0_sel:DWORD src1_sel:WORD_0
    ds_write_b32 v9, v85 offset:0
    v_lshlrev_b32_sdwa v10, 2, v90 dst_sel:DWORD dst_unused:UNUSED_PAD src0_sel:DWORD src1_sel:WORD_0
    ds_write_b32 v10, v88 offset:0
    v_lshlrev_b32_sdwa v11, 2, v91 dst_sel:DWORD dst_unused:UNUSED_PAD src0_sel:DWORD src1_sel:WORD_0
    ds_write_b32 v11, v89 offset:0
    v_lshlrev_b32_sdwa v12, 2, v94 dst_sel:DWORD dst_unused:UNUSED_PAD src0_sel:DWORD src1_sel:WORD_0
    ds_write_b32 v12, v92 offset:0
    s_add_u32 s35, s34, 20488192
    buffer_load_dwordx2 v[36:37], v2, s[16:19], s35 offen nt
    v_lshlrev_b32_sdwa v13, 2, v95 dst_sel:DWORD dst_unused:UNUSED_PAD src0_sel:DWORD src1_sel:WORD_0
    ds_write_b32 v13, v93 offset:0
    v_lshlrev_b32_sdwa v6, 2, v98 dst_sel:DWORD dst_unused:UNUSED_PAD src0_sel:DWORD src1_sel:WORD_0
    ds_write_b32 v6, v96 offset:0
    v_lshlrev_b32_sdwa v7, 2, v99 dst_sel:DWORD dst_unused:UNUSED_PAD src0_sel:DWORD src1_sel:WORD_0
    ds_write_b32 v7, v97 offset:0
    v_lshlrev_b32_sdwa v8, 2, v102 dst_sel:DWORD dst_unused:UNUSED_PAD src0_sel:DWORD src1_sel:WORD_0
    ds_write_b32 v8, v100 offset:0
    v_lshlrev_b32_sdwa v9, 2, v103 dst_sel:DWORD dst_unused:UNUSED_PAD src0_sel:DWORD src1_sel:WORD_0
    ds_write_b32 v9, v101 offset:0
    v_lshlrev_b32_sdwa v10, 2, v106 dst_sel:DWORD dst_unused:UNUSED_PAD src0_sel:DWORD src1_sel:WORD_0
    ds_write_b32 v10, v104 offset:0
    v_lshlrev_b32_sdwa v11, 2, v107 dst_sel:DWORD dst_unused:UNUSED_PAD src0_sel:DWORD src1_sel:WORD_0
    ds_write_b32 v11, v105 offset:0
    v_lshlrev_b32_sdwa v12, 2, v110 dst_sel:DWORD dst_unused:UNUSED_PAD src0_sel:DWORD src1_sel:WORD_0
    ds_write_b32 v12, v108 offset:0
    v_lshlrev_b32_sdwa v13, 2, v111 dst_sel:DWORD dst_unused:UNUSED_PAD src0_sel:DWORD src1_sel:WORD_0
    ds_write_b32 v13, v109 offset:0
    v_lshlrev_b32_sdwa v6, 2, v114 dst_sel:DWORD dst_unused:UNUSED_PAD src0_sel:DWORD src1_sel:WORD_0
    ds_write_b32 v6, v112 offset:0
    v_lshlrev_b32_sdwa v7, 2, v115 dst_sel:DWORD dst_unused:UNUSED_PAD src0_sel:DWORD src1_sel:WORD_0
    ds_write_b32 v7, v113 offset:0
    v_lshlrev_b32_sdwa v8, 2, v118 dst_sel:DWORD dst_unused:UNUSED_PAD src0_sel:DWORD src1_sel:WORD_0
    ds_write_b32 v8, v116 offset:0
    v_lshlrev_b32_sdwa v9, 2, v119 dst_sel:DWORD dst_unused:UNUSED_PAD src0_sel:DWORD src1_sel:WORD_0
    ds_write_b32 v9, v117 offset:0
    s_mov_b64 exec, s[44:45]
    v_lshlrev_b32_sdwa v10, 2, v122 dst_sel:DWORD dst_unused:UNUSED_PAD src0_sel:DWORD src1_sel:WORD_0
    ds_write_b32 v10, v120 offset:0
    v_lshlrev_b32_sdwa v11, 2, v123 dst_sel:DWORD dst_unused:UNUSED_PAD src0_sel:DWORD src1_sel:WORD_0
    ds_write_b32 v11, v121 offset:0
    v_lshlrev_b32_sdwa v12, 2, v126 dst_sel:DWORD dst_unused:UNUSED_PAD src0_sel:DWORD src1_sel:WORD_0
    ds_write_b32 v12, v124 offset:0
    v_lshlrev_b32_sdwa v13, 2, v127 dst_sel:DWORD dst_unused:UNUSED_PAD src0_sel:DWORD src1_sel:WORD_0
    ds_write_b32 v13, v125 offset:0
    s_mov_b64 exec, -1
    v_add_u32 v6, 65536, v2
    v_add_u32 v7, 131072, v2
    s_waitcnt lgkmcnt(0)
    s_barrier
    ds_read_b64 v[48:49], v2 offset:0
    ds_read_b64 v[52:53], v2 offset:8192
    ds_read_b64 v[56:57], v2 offset:16384
    ds_read_b64 v[60:61], v2 offset:24576
    ds_read_b64 v[64:65], v2 offset:32768
    ds_read_b64 v[68:69], v2 offset:40960
    ds_read_b64 v[72:73], v2 offset:49152
    ds_read_b64 v[76:77], v2 offset:57344
    ds_read_b64 v[80:81], v6 offset:0
    ds_read_b64 v[84:85], v6 offset:8192
    ds_read_b64 v[88:89], v6 offset:16384
    ds_read_b64 v[92:93], v6 offset:24576
    ds_read_b64 v[96:97], v6 offset:32768
    ds_read_b64 v[100:101], v6 offset:40960
    ds_read_b64 v[104:105], v6 offset:49152
    ds_read_b64 v[108:109], v6 offset:57344
    ds_read_b64 v[112:113], v7 offset:0
    ds_read_b64 v[116:117], v7 offset:8192
    ds_read_b64 v[120:121], v7 offset:16384
    ds_read_b64 v[124:125], v7 offset:24576
    s_add_u32 s35, s33, 40992768
    buffer_load_dwordx4 v[38:41], v1, s[8:11], s35 offen nt
    v_mov_b32 v12, 0
    v_mov_b32 v13, 0
    v_mov_b32 v14, 0
    v_mov_b32 v15, 0
    s_waitcnt lgkmcnt(0)
    s_barrier
    ds_write_b128 v1, v[12:15] offset:0
    v_lshlrev_b32_sdwa v6, 1, v50 dst_sel:DWORD dst_unused:UNUSED_PAD src0_sel:DWORD src1_sel:WORD_0
    ds_write_b16_d16_hi v6, v50 offset:16384
    v_lshlrev_b32_sdwa v7, 1, v51 dst_sel:DWORD dst_unused:UNUSED_PAD src0_sel:DWORD src1_sel:WORD_0
    ds_write_b16_d16_hi v7, v51 offset:16384
    v_lshlrev_b32_sdwa v8, 1, v54 dst_sel:DWORD dst_unused:UNUSED_PAD src0_sel:DWORD src1_sel:WORD_0
    ds_write_b16_d16_hi v8, v54 offset:16384
    v_lshlrev_b32_sdwa v9, 1, v55 dst_sel:DWORD dst_unused:UNUSED_PAD src0_sel:DWORD src1_sel:WORD_0
    ds_write_b16_d16_hi v9, v55 offset:16384
    v_lshlrev_b32_sdwa v10, 1, v58 dst_sel:DWORD dst_unused:UNUSED_PAD src0_sel:DWORD src1_sel:WORD_0
    ds_write_b16_d16_hi v10, v58 offset:16384
    v_lshlrev_b32_sdwa v11, 1, v59 dst_sel:DWORD dst_unused:UNUSED_PAD src0_sel:DWORD src1_sel:WORD_0
    ds_write_b16_d16_hi v11, v59 offset:16384
    s_add_u32 s35, s33, 40992768
    buffer_load_dwordx4 v[42:45], v1, s[12:15], s35 offen nt
    v_lshlrev_b32_sdwa v6, 1, v62 dst_sel:DWORD dst_unused:UNUSED_PAD src0_sel:DWORD src1_sel:WORD_0
    ds_write_b16_d16_hi v6, v62 offset:16384
    v_lshlrev_b32_sdwa v7, 1, v63 dst_sel:DWORD dst_unused:UNUSED_PAD src0_sel:DWORD src1_sel:WORD_0
    ds_write_b16_d16_hi v7, v63 offset:16384
    v_lshlrev_b32_sdwa v8, 1, v66 dst_sel:DWORD dst_unused:UNUSED_PAD src0_sel:DWORD src1_sel:WORD_0
    ds_write_b16_d16_hi v8, v66 offset:16384
    v_lshlrev_b32_sdwa v9, 1, v67 dst_sel:DWORD dst_unused:UNUSED_PAD src0_sel:DWORD src1_sel:WORD_0
    ds_write_b16_d16_hi v9, v67 offset:16384
    v_lshlrev_b32_sdwa v10, 1, v70 dst_sel:DWORD dst_unused:UNUSED_PAD src0_sel:DWORD src1_sel:WORD_0
    ds_write_b16_d16_hi v10, v70 offset:16384
    v_lshlrev_b32_sdwa v11, 1, v71 dst_sel:DWORD dst_unused:UNUSED_PAD src0_sel:DWORD src1_sel:WORD_0
    ds_write_b16_d16_hi v11, v71 offset:16384
    v_lshlrev_b32_sdwa v6, 1, v74 dst_sel:DWORD dst_unused:UNUSED_PAD src0_sel:DWORD src1_sel:WORD_0
    ds_write_b16_d16_hi v6, v74 offset:16384
    v_lshlrev_b32_sdwa v7, 1, v75 dst_sel:DWORD dst_unused:UNUSED_PAD src0_sel:DWORD src1_sel:WORD_0
    ds_write_b16_d16_hi v7, v75 offset:16384
    v_lshlrev_b32_sdwa v8, 1, v78 dst_sel:DWORD dst_unused:UNUSED_PAD src0_sel:DWORD src1_sel:WORD_0
    ds_write_b16_d16_hi v8, v78 offset:16384
    v_lshlrev_b32_sdwa v9, 1, v79 dst_sel:DWORD dst_unused:UNUSED_PAD src0_sel:DWORD src1_sel:WORD_0
    ds_write_b16_d16_hi v9, v79 offset:16384
    v_lshlrev_b32_sdwa v10, 1, v82 dst_sel:DWORD dst_unused:UNUSED_PAD src0_sel:DWORD src1_sel:WORD_0
    ds_write_b16_d16_hi v10, v82 offset:16384
    v_lshlrev_b32_sdwa v11, 1, v83 dst_sel:DWORD dst_unused:UNUSED_PAD src0_sel:DWORD src1_sel:WORD_0
    ds_write_b16_d16_hi v11, v83 offset:16384
    v_lshlrev_b32_sdwa v6, 1, v86 dst_sel:DWORD dst_unused:UNUSED_PAD src0_sel:DWORD src1_sel:WORD_0
    ds_write_b16_d16_hi v6, v86 offset:16384
    v_lshlrev_b32_sdwa v7, 1, v87 dst_sel:DWORD dst_unused:UNUSED_PAD src0_sel:DWORD src1_sel:WORD_0
    ds_write_b16_d16_hi v7, v87 offset:16384
    v_lshlrev_b32_sdwa v8, 1, v90 dst_sel:DWORD dst_unused:UNUSED_PAD src0_sel:DWORD src1_sel:WORD_0
    ds_write_b16_d16_hi v8, v90 offset:16384
    v_lshlrev_b32_sdwa v9, 1, v91 dst_sel:DWORD dst_unused:UNUSED_PAD src0_sel:DWORD src1_sel:WORD_0
    ds_write_b16_d16_hi v9, v91 offset:16384
    v_lshlrev_b32_sdwa v10, 1, v94 dst_sel:DWORD dst_unused:UNUSED_PAD src0_sel:DWORD src1_sel:WORD_0
    ds_write_b16_d16_hi v10, v94 offset:16384
    s_add_u32 s35, s34, 20496384
    buffer_load_dwordx2 v[46:47], v2, s[16:19], s35 offen nt
    v_lshlrev_b32_sdwa v11, 1, v95 dst_sel:DWORD dst_unused:UNUSED_PAD src0_sel:DWORD src1_sel:WORD_0
    ds_write_b16_d16_hi v11, v95 offset:16384
    v_lshlrev_b32_sdwa v6, 1, v98 dst_sel:DWORD dst_unused:UNUSED_PAD src0_sel:DWORD src1_sel:WORD_0
    ds_write_b16_d16_hi v6, v98 offset:16384
    v_lshlrev_b32_sdwa v7, 1, v99 dst_sel:DWORD dst_unused:UNUSED_PAD src0_sel:DWORD src1_sel:WORD_0
    ds_write_b16_d16_hi v7, v99 offset:16384
    v_lshlrev_b32_sdwa v8, 1, v102 dst_sel:DWORD dst_unused:UNUSED_PAD src0_sel:DWORD src1_sel:WORD_0
    ds_write_b16_d16_hi v8, v102 offset:16384
    v_lshlrev_b32_sdwa v9, 1, v103 dst_sel:DWORD dst_unused:UNUSED_PAD src0_sel:DWORD src1_sel:WORD_0
    ds_write_b16_d16_hi v9, v103 offset:16384
    v_lshlrev_b32_sdwa v10, 1, v106 dst_sel:DWORD dst_unused:UNUSED_PAD src0_sel:DWORD src1_sel:WORD_0
    ds_write_b16_d16_hi v10, v106 offset:16384
    v_lshlrev_b32_sdwa v11, 1, v107 dst_sel:DWORD dst_unused:UNUSED_PAD src0_sel:DWORD src1_sel:WORD_0
    ds_write_b16_d16_hi v11, v107 offset:16384
    v_lshlrev_b32_sdwa v6, 1, v110 dst_sel:DWORD dst_unused:UNUSED_PAD src0_sel:DWORD src1_sel:WORD_0
    ds_write_b16_d16_hi v6, v110 offset:16384
    v_lshlrev_b32_sdwa v7, 1, v111 dst_sel:DWORD dst_unused:UNUSED_PAD src0_sel:DWORD src1_sel:WORD_0
    ds_write_b16_d16_hi v7, v111 offset:16384
    v_lshlrev_b32_sdwa v8, 1, v114 dst_sel:DWORD dst_unused:UNUSED_PAD src0_sel:DWORD src1_sel:WORD_0
    ds_write_b16_d16_hi v8, v114 offset:16384
    v_lshlrev_b32_sdwa v9, 1, v115 dst_sel:DWORD dst_unused:UNUSED_PAD src0_sel:DWORD src1_sel:WORD_0
    ds_write_b16_d16_hi v9, v115 offset:16384
    v_lshlrev_b32_sdwa v10, 1, v118 dst_sel:DWORD dst_unused:UNUSED_PAD src0_sel:DWORD src1_sel:WORD_0
    ds_write_b16_d16_hi v10, v118 offset:16384
    v_lshlrev_b32_sdwa v11, 1, v119 dst_sel:DWORD dst_unused:UNUSED_PAD src0_sel:DWORD src1_sel:WORD_0
    ds_write_b16_d16_hi v11, v119 offset:16384
    s_mov_b64 exec, s[44:45]
    v_lshlrev_b32_sdwa v6, 1, v122 dst_sel:DWORD dst_unused:UNUSED_PAD src0_sel:DWORD src1_sel:WORD_0
    ds_write_b16_d16_hi v6, v122 offset:16384
    v_lshlrev_b32_sdwa v7, 1, v123 dst_sel:DWORD dst_unused:UNUSED_PAD src0_sel:DWORD src1_sel:WORD_0
    ds_write_b16_d16_hi v7, v123 offset:16384
    v_lshlrev_b32_sdwa v8, 1, v126 dst_sel:DWORD dst_unused:UNUSED_PAD src0_sel:DWORD src1_sel:WORD_0
    ds_write_b16_d16_hi v8, v126 offset:16384
    v_lshlrev_b32_sdwa v9, 1, v127 dst_sel:DWORD dst_unused:UNUSED_PAD src0_sel:DWORD src1_sel:WORD_0
    ds_write_b16_d16_hi v9, v127 offset:16384
    s_mov_b64 exec, -1
    v_lshlrev_b32 v6, 2, v0
    v_add_u32 v7, 40960, v6
    s_waitcnt lgkmcnt(0)
    s_barrier
    ds_read_b32 v122, v7 offset:49152
    ds_read_b32 v126, v7 offset:53248
    ds_read_b32 v50, v6 offset:16384
    ds_read_b32 v54, v6 offset:20480
    ds_read_b32 v58, v6 offset:24576
    ds_read_b32 v62, v6 offset:28672
    ds_read_b32 v66, v6 offset:32768
    ds_read_b32 v70, v6 offset:36864
    ds_read_b32 v74, v6 offset:40960
    ds_read_b32 v78, v6 offset:45056
    ds_read_b32 v82, v6 offset:49152
    ds_read_b32 v86, v6 offset:53248
    ds_read_b32 v90, v7 offset:16384
    ds_read_b32 v94, v7 offset:20480
    ds_read_b32 v98, v7 offset:24576
    ds_read_b32 v102, v7 offset:28672
    ds_read_b32 v106, v7 offset:32768
    ds_read_b32 v110, v7 offset:36864
    ds_read_b32 v114, v7 offset:40960
    ds_read_b32 v118, v7 offset:45056
    s_add_u32 s32, s32, 256
    s_add_u32 s33, s33, 40960000
    s_add_u32 s34, s34, 20480000
    s_add_u32 s40, s40, 1
    s_cmp_lt_u32 s40, 4
    s_waitcnt lgkmcnt(0)
    s_cbranch_scc1 L_p1_loop
    s_mov_b32 s36, 0
    buffer_store_dwordx3 v[48:50], v3, s[20:23], s36 offen sc1
    s_mov_b32 s36, 12288
    buffer_store_dwordx3 v[52:54], v3, s[20:23], s36 offen sc1
    s_mov_b32 s36, 24576
    buffer_store_dwordx3 v[56:58], v3, s[20:23], s36 offen sc1
    s_mov_b32 s36, 36864
    buffer_store_dwordx3 v[60:62], v3, s[20:23], s36 offen sc1
    s_mov_b32 s36, 49152
    buffer_store_dwordx3 v[64:66], v3, s[20:23], s36 offen sc1
    s_mov_b32 s36, 61440
    buffer_store_dwordx3 v[68:70], v3, s[20:23], s36 offen sc1
    s_mov_b32 s36, 73728
    buffer_store_dwordx3 v[72:74], v3, s[20:23], s36 offen sc1
    s_mov_b32 s36, 86016
    buffer_store_dwordx3 v[76:78], v3, s[20:23], s36 offen sc1
    s_mov_b32 s36, 98304
    buffer_store_dwordx3 v[80:82], v3, s[20:23], s36 offen sc1
    s_mov_b32 s36, 110592
    buffer_store_dwordx3 v[84:86], v3, s[20:23], s36 offen sc1
    s_mov_b32 s36, 122880
    buffer_store_dwordx3 v[88:90], v3, s[20:23], s36 offen sc1
    s_mov_b32 s36, 135168
    buffer_store_dwordx3 v[92:94], v3, s[20:23], s36 offen sc1
    s_mov_b32 s36, 147456
    buffer_store_dwordx3 v[96:98], v3, s[20:23], s36 offen sc1
    s_mov_b32 s36, 159744
    buffer_store_dwordx3 v[100:102], v3, s[20:23], s36 offen sc1
    s_mov_b32 s36, 172032
    buffer_store_dwordx3 v[104:106], v3, s[20:23], s36 offen sc1
    s_mov_b32 s36, 184320
    buffer_store_dwordx3 v[108:110], v3, s[20:23], s36 offen sc1
    s_mov_b32 s36, 196608
    buffer_store_dwordx3 v[112:114], v3, s[20:23], s36 offen sc1
    s_mov_b32 s36, 208896
    buffer_store_dwordx3 v[116:118], v3, s[20:23], s36 offen sc1
    s_mov_b32 s36, 221184
    buffer_store_dwordx3 v[120:122], v3, s[20:23], s36 offen sc1
    s_mov_b32 s36, 233472
    buffer_store_dwordx3 v[124:126], v3, s[20:23], s36 offen sc1
    v_and_b32 v6, 0x40000000, v5
    v_cmp_ne_u32 vcc, 0, v6
    s_lshl_b32 s35, s39, 4
    s_add_u32 s35, s35, 160328
    v_mov_b32 v10, s35
    s_cmp_lg_u64 vcc, 0
    s_cselect_b32 s36, 1, s55
    v_mov_b32 v11, s36
    ds_write_b32 v10, v11
    s_waitcnt lgkmcnt(0)
    s_barrier
    s_cmp_lg_u32 s39, 0
    s_cbranch_scc1 L_p1_end
    v_and_b32 v6, 15, v0
    v_lshlrev_b32 v6, 4, v6
    v_add_u32 v6, 160320, v6
    ds_read_b128 v[8:11], v6
    s_waitcnt lgkmcnt(0)
    s_nop 1
    v_max_u32_dpp v8, v8, v8 row_shr:1 row_mask:0xf bank_mask:0xf bound_ctrl:0
    s_nop 1
    v_max_u32_dpp v8, v8, v8 row_shr:2 row_mask:0xf bank_mask:0xf bound_ctrl:0
    s_nop 1
    v_max_u32_dpp v8, v8, v8 row_shr:4 row_mask:0xf bank_mask:0xf bound_ctrl:0
    s_nop 1
    v_max_u32_dpp v8, v8, v8 row_shr:8 row_mask:0xf bank_mask:0xf bound_ctrl:0
    s_nop 1
    v_add_f32_dpp v9, v9, v9 row_shr:1 row_mask:0xf bank_mask:0xf bound_ctrl:0
    s_nop 1
    v_add_f32_dpp v9, v9, v9 row_shr:2 row_mask:0xf bank_mask:0xf bound_ctrl:0
    s_nop 1
    v_add_f32_dpp v9, v9, v9 row_shr:4 row_mask:0xf bank_mask:0xf bound_ctrl:0
    s_nop 1
    v_add_f32_dpp v9, v9, v9 row_shr:8 row_mask:0xf bank_mask:0xf bound_ctrl:0
    s_nop 1
    v_or_b32_dpp v10, v10, v10 row_shr:1 row_mask:0xf bank_mask:0xf bound_ctrl:0
    s_nop 1
    v_or_b32_dpp v10, v10, v10 row_shr:2 row_mask:0xf bank_mask:0xf bound_ctrl:0
    s_nop 1
    v_or_b32_dpp v10, v10, v10 row_shr:4 row_mask:0xf bank_mask:0xf bound_ctrl:0
    s_nop 1
    v_or_b32_dpp v10, v10, v10 row_shr:8 row_mask:0xf bank_mask:0xf bound_ctrl:0
    s_lshl_b32 s35, s2, 4
    s_add_u32 s35, s35, 8552960
    v_mov_b32 v6, 0
    v_mov_b32 v11, 0
    s_mov_b64 exec, 0x8000
    buffer_store_dwordx4 v[8:11], v6, s[24:27], s35 offen
L_p1_end:
    s_endpgm
.globl p2_kernel
.p2align 8
.type p2_kernel,@function
p2_kernel:
    s_cmp_ge_u32 s2, 256
    s_cbranch_scc1 L_p2_end
    s_load_dwordx2 s[4:5], s[0:1], 104
    s_load_dwordx2 s[8:9], s[0:1], 0
    s_and_b32 s14, s2, 7
    s_lshr_b32 s49, s2, 3
    s_and_b32 s3, s14, 1
    s_lshl_b32 s3, s3, 5
    s_add_u32 s3, s3, s49
    s_lshr_b32 s12, s14, 1
    v_lshrrev_b32 v112, 6, v0
    v_lshlrev_b32 v1, 4, v0
    v_and_b32 v113, 63, v0
    v_readfirstlane_b32 s13, v112
    v_lshlrev_b32 v114, 5, v0
    v_lshlrev_b32 v115, 6, v113
    s_mul_i32 s14, s12, 65
    s_add_u32 s14, s14, s3
    s_mul_i32 s14, s14, 32896
    s_add_u32 s14, s14, 246292480
    s_add_u32 s25, s14, 32896
    s_mov_b32 s15, 254845440
    s_mul_i32 s22, s12, 1280000
    s_mov_b32 s2, 0
    s_waitcnt lgkmcnt(0)
    s_mov_b32 s6, 655360000
    s_mov_b32 s7, 0x00020000
    s_add_u32 s8, s4, 254853632
    s_addc_u32 s9, s5, 0
    s_add_u32 s10, s22, 1280000
    s_mov_b32 s11, 0x00020000
    buffer_load_dwordx4 v[64:67], v114, s[4:7], s14 offen offset:0
    buffer_load_dwordx4 v[68:71], v114, s[4:7], s14 offen offset:16
    buffer_load_dwordx4 v[72:75], v114, s[4:7], s25 offen offset:0
    buffer_load_dwordx4 v[76:79], v114, s[4:7], s25 offen offset:16
    buffer_load_dwordx3 v[36:38], v115, s[4:7], s15 offen offset:0
    buffer_load_dwordx3 v[40:42], v115, s[4:7], s15 offen offset:16
    buffer_load_dwordx3 v[44:46], v115, s[4:7], s15 offen offset:32
    buffer_load_dwordx3 v[48:50], v115, s[4:7], s15 offen offset:48
    s_and_b32 s14, s49, 3
    s_lshl_b32 s14, s14, 8
    s_lshr_b32 s15, s49, 2
    s_lshl_b32 s15, s15, 14
    s_add_u32 s51, s14, s15
    s_add_u32 s14, s51, s22
    s_add_u32 s14, s14, 0
    s_mov_b64 exec, 0x101
    buffer_load_dword v125, v1, s[8:11], s14 offen
    s_mov_b64 exec, -1
    s_add_u32 s14, s51, s22
    s_add_u32 s14, s14, 80000
    s_mov_b64 exec, 0x101
    buffer_load_dword v125, v1, s[8:11], s14 offen
    s_mov_b64 exec, -1
    v_mul_u32_u24 v2, 12, v113
    v_add_u32 v2, 2816, v2
    v_add_u32 v3, 80000, v1
    v_add_u32 v124, 145536, v1
    v_add_u32 v117, 65536, v1
    v_mov_b32 v116, 0x7f000000
    v_cmp_gt_u32 vcc, 904, v0
    s_mul_i32 s19, s13, 240
    s_add_u32 s19, s19, 160000
    v_cndmask_b32 v124, v116, v124, vcc
    v_cndmask_b32 v117, v116, v117, vcc
    v_lshl_add_u32 v6, v113, 2, s19
    v_lshl_add_u32 v126, v113, 1, s19
    v_cmp_gt_u32 vcc, 14, v113
    s_mul_i32 s27, s13, 15392768
    s_mov_b32 s23, 240512
    v_cndmask_b32 v6, v116, v6, vcc
    s_mov_b32 s44, s4
    s_mov_b32 s45, s5
    s_add_u32 s46, s27, 15400960
    s_mov_b32 s47, 0x00020000
    s_mov_b32 s17, 0x05040100
    s_mov_b32 s18, 80000
    s_and_b32 s50, s3, 1
    s_lshl_b32 s50, s50, 18
    s_sub_u32 s50, 4294836224, s50
    s_mov_b32 s20, 3221209088
    s_mov_b32 s21, 3221209087
    v_mov_b32 v4, 0
    v_mov_b32 v5, 0
    v_mov_b32 v118, 448
    ds_write_b32 v6, v5 offset:160
    ds_write_b16 v126, v118 offset:2
    v_mov_b32 v108, 1073758208
    v_mov_b32 v109, 1073758208
    v_mov_b32 v110, 1073758208
    v_mov_b32 v111, 1073758208
    ds_write_b128 v1, v[108:111] offset:0
    ds_write_b128 v1, v[108:111] offset:16384
    ds_write_b128 v1, v[108:111] offset:32768
    ds_write_b128 v1, v[108:111] offset:49152
    ds_write_b128 v117, v[108:111]
    s_waitcnt vmcnt(6)
    v_mov_b32 v11, v64
    v_mov_b32 v15, v65
    v_mov_b32 v19, v66
    v_mov_b32 v23, v67
    v_mov_b32 v27, v68
    v_mov_b32 v31, v69
    v_mov_b32 v35, v70
    v_mov_b32 v39, v71
    v_mov_b32 v43, v72
    v_mov_b32 v47, v73
    v_mov_b32 v51, v74
    v_mov_b32 v55, v75
    v_mov_b32 v59, v76
    v_mov_b32 v63, v77
    v_mov_b32 v122, v78
    v_mov_b32 v123, v79
    s_add_u32 s14, s22, 0
    buffer_load_dwordx4 v[88:91], v1, s[8:11], s14 offen
    s_add_u32 s14, s22, 16384
    buffer_load_dwordx4 v[92:95], v1, s[8:11], s14 offen
    s_add_u32 s14, s22, 32768
    buffer_load_dwordx4 v[96:99], v1, s[8:11], s14 offen
    s_add_u32 s14, s22, 49152
    buffer_load_dwordx4 v[100:103], v1, s[8:11], s14 offen
    s_add_u32 s14, s22, 65536
    buffer_load_dwordx4 v[104:107], v1, s[8:11], s14 offen
    v_add_u32_sdwa v113, 1, v43 dst_sel:DWORD dst_unused:UNUSED_PAD src0_sel:DWORD src1_sel:WORD_0
    v_lshrrev_b32_sdwa v112, 1, v11 dst_sel:DWORD dst_unused:UNUSED_PAD src0_sel:DWORD src1_sel:WORD_0
    v_lshrrev_b32 v113, 1, v113
    v_sub_u32 v114, v113, v112
    v_add_u32 v113, 448, v113
    s_nop 0
    v_add_u32_dpp v114, v114, v114 row_shr:1 row_mask:0xf bank_mask:0xf bound_ctrl:0
    s_nop 1
    v_add_u32_dpp v114, v114, v114 row_shr:2 row_mask:0xf bank_mask:0xf bound_ctrl:0
    s_nop 1
    v_add_u32_dpp v114, v114, v114 row_shr:4 row_mask:0xf bank_mask:0xf bound_ctrl:0
    s_nop 1
    v_add_u32_dpp v114, v114, v114 row_shr:8 row_mask:0xf bank_mask:0xf bound_ctrl:0
    s_nop 1
    v_add_u32_dpp v114, v114, v114 row_bcast:15 row_mask:0xa bank_mask:0xf
    s_nop 1
    v_add_u32_dpp v114, v114, v114 row_bcast:31 row_mask:0xc bank_mask:0xf
    v_sub_u32 v113, v113, v114
    v_readlane_b32 s56, v114, 63
    v_add_u32 v114, -1, v114
    ds_write_b16 v126, v113
    v_lshlrev_b32_e64 v115, v114, 1
    v_lshrrev_b32 v114, 5, v114
    v_lshl_add_u32 v114, v114, 2, s19
    s_cmp_gt_u32 s56, 448
    s_cselect_b32 s2, 1, s2
    s_cselect_b64 exec, 0, -1
    ds_or_b32 v114, v115 offset:160
    s_mov_b64 exec, -1
    ds_wrxchg_rtn_b32 v7, v6, v5 offset:160
    s_waitcnt lgkmcnt(0)
    v_readlane_b32 s30, v7, 0
    v_readlane_b32 s31, v7, 1
    v_readlane_b32 s32, v7, 2
    v_readlane_b32 s33, v7, 3
    v_readlane_b32 s34, v7, 4
    v_readlane_b32 s35, v7, 5
    v_readlane_b32 s36, v7, 6
    v_readlane_b32 s37, v7, 7
    v_readlane_b32 s38, v7, 8
    v_readlane_b32 s39, v7, 9
    v_readlane_b32 s40, v7, 10
    v_readlane_b32 s41, v7, 11
    s_mov_b32 s25, s19
    s_mov_b32 s26, s27
    s_mov_b32 s28, s56
    v_mbcnt_lo_u32_b32 v8, s30, 0
    v_mbcnt_hi_u32_b32 v8, s31, v8
    s_bcnt1_i32_b64 s14, s[30:31]
    v_lshl_add_u32 v9, v8, 1, s25
    ds_read_u16 v9, v9
    v_mad_u32_u24 v8, v8, s23, v2
    s_mov_b32 s30, s26
    s_lshl1_add_u32 s25, s14, s25
    s_mul_i32 s14, s14, s23
    s_add_u32 s26, s26, s14
    v_mbcnt_lo_u32_b32 v12, s32, 0
    v_mbcnt_hi_u32_b32 v12, s33, v12
    s_bcnt1_i32_b64 s14, s[32:33]
    v_lshl_add_u32 v13, v12, 1, s25
    ds_read_u16 v13, v13
    v_mad_u32_u24 v12, v12, s23, v2
    s_mov_b32 s32, s26
    s_lshl1_add_u32 s25, s14, s25
    s_mul_i32 s14, s14, s23
    s_add_u32 s26, s26, s14
    v_mbcnt_lo_u32_b32 v16, s34, 0
    v_mbcnt_hi_u32_b32 v16, s35, v16
    s_bcnt1_i32_b64 s14, s[34:35]
    v_lshl_add_u32 v17, v16, 1, s25
    ds_read_u16 v17, v17
    v_mad_u32_u24 v16, v16, s23, v2
    s_mov_b32 s34, s26
    s_lshl1_add_u32 s25, s14, s25
    s_mul_i32 s14, s14, s23
    s_add_u32 s26, s26, s14
    v_mbcnt_lo_u32_b32 v20, s36, 0
    v_mbcnt_hi_u32_b32 v20, s37, v20
    s_bcnt1_i32_b64 s14, s[36:37]
    v_lshl_add_u32 v21, v20, 1, s25
    ds_read_u16 v21, v21
    v_mad_u32_u24 v20, v20, s23, v2
    s_mov_b32 s36, s26
    s_lshl1_add_u32 s25, s14, s25
    s_mul_i32 s14, s14, s23
    s_add_u32 s26, s26, s14
    v_mbcnt_lo_u32_b32 v24, s38, 0
    v_mbcnt_hi_u32_b32 v24, s39, v24
    s_bcnt1_i32_b64 s14, s[38:39]
    v_lshl_add_u32 v25, v24, 1, s25
    ds_read_u16 v25, v25
    v_mad_u32_u24 v24, v24, s23, v2
    s_mov_b32 s38, s26
    s_lshl1_add_u32 s25, s14, s25
    s_mul_i32 s14, s14, s23
    s_add_u32 s26, s26, s14
    v_mbcnt_lo_u32_b32 v28, s40, 0
    v_mbcnt_hi_u32_b32 v28, s41, v28
    s_bcnt1_i32_b64 s14, s[40:41]
    v_lshl_add_u32 v29, v28, 1, s25
    ds_read_u16 v29, v29
    v_mad_u32_u24 v28, v28, s23, v2
    s_mov_b32 s40, s26
    s_lshl1_add_u32 s25, s14, s25
    s_mul_i32 s14, s14, s23
    s_add_u32 s26, s26, s14
    s_waitcnt lgkmcnt(5)
    v_mad_u32_u24 v8, v9, 12, v8
    buffer_load_dwordx3 v[8:10], v8, s[44:47], s30 offen offset:0
    s_waitcnt lgkmcnt(4)
    v_mad_u32_u24 v12, v13, 12, v12
    buffer_load_dwordx3 v[12:14], v12, s[44:47], s32 offen offset:768
    s_waitcnt lgkmcnt(3)
    v_mad_u32_u24 v16, v17, 12, v16
    buffer_load_dwordx3 v[16:18], v16, s[44:47], s34 offen offset:1536
    s_waitcnt lgkmcnt(2)
    v_mad_u32_u24 v20, v21, 12, v20
    buffer_load_dwordx3 v[20:22], v20, s[44:47], s36 offen offset:2304
    s_waitcnt lgkmcnt(1)
    v_mad_u32_u24 v24, v25, 12, v24
    buffer_load_dwordx3 v[24:26], v24, s[44:47], s38 offen offset:3072
    s_waitcnt lgkmcnt(0)
    v_mad_u32_u24 v28, v29, 12, v28
    buffer_load_dwordx3 v[28:30], v28, s[44:47], s40 offen offset:3840
    s_cmp_le_u32 s28, 384
    s_cbranch_scc1 L_p2_kernel_norare_1
    v_readlane_b32 s42, v7, 12
    v_readlane_b32 s43, v7, 13
    s_nop 1
    v_mbcnt_lo_u32_b32 v120, s42, 0
    v_mbcnt_hi_u32_b32 v120, s43, v120
    s_bcnt1_i32_b64 s14, s[42:43]
    v_lshl_add_u32 v121, v120, 1, s25
    ds_read_u16 v121, v121
    v_mad_u32_u24 v120, v120, s23, v2
    s_mov_b32 s42, s26
    s_lshl1_add_u32 s25, s14, s25
    s_mul_i32 s14, s14, s23
    s_add_u32 s26, s26, s14
    s_waitcnt lgkmcnt(0)
    s_add_u32 s42, s42, 4608
    v_mad_u32_u24 v120, v121, 12, v120
    buffer_load_dwordx3 v[32:34], v120, s[44:47], s42 offen offset:0
L_p2_kernel_norare_1:
    s_waitcnt vmcnt(13)
    v_max3_u32 v36, v36, v40, v44
    v_add_f32 v37, v37, v41
    v_or3_b32 v38, v38, v42, v46
    v_add_f32 v45, v45, v49
    v_max_u32 v36, v36, v48
    v_or_b32 v38, v38, v50
    v_add_f32 v37, v37, v45
    v_cmp_ne_u32 vcc, 0, v38
    s_nop 1
    v_max_u32_dpp v36, v36, v36 row_shr:1 row_mask:0xf bank_mask:0xf bound_ctrl:0
    s_nop 1
    v_max_u32_dpp v36, v36, v36 row_shr:2 row_mask:0xf bank_mask:0xf bound_ctrl:0
    s_nop 1
    v_max_u32_dpp v36, v36, v36 row_shr:4 row_mask:0xf bank_mask:0xf bound_ctrl:0
    s_nop 1
    v_max_u32_dpp v36, v36, v36 row_shr:8 row_mask:0xf bank_mask:0xf bound_ctrl:0
    s_nop 1
    v_max_u32_dpp v36, v36, v36 row_bcast:15 row_mask:0xa bank_mask:0xf
    s_nop 1
    v_max_u32_dpp v36, v36, v36 row_bcast:31 row_mask:0xc bank_mask:0xf
    s_nop 1
    v_add_f32_dpp v37, v37, v37 row_shr:1 row_mask:0xf bank_mask:0xf bound_ctrl:0
    s_nop 1
    v_add_f32_dpp v37, v37, v37 row_shr:2 row_mask:0xf bank_mask:0xf bound_ctrl:0
    s_nop 1
    v_add_f32_dpp v37, v37, v37 row_shr:4 row_mask:0xf bank_mask:0xf bound_ctrl:0
    s_nop 1
    v_add_f32_dpp v37, v37, v37 row_shr:8 row_mask:0xf bank_mask:0xf bound_ctrl:0
    s_nop 1
    v_add_f32_dpp v37, v37, v37 row_bcast:15 row_mask:0xa bank_mask:0xf
    s_nop 1
    v_add_f32_dpp v37, v37, v37 row_bcast:31 row_mask:0xc bank_mask:0xf
    s_cmp_lg_u64 vcc, 0
    s_cselect_b32 s2, 1, s2
    v_lshlrev_b32 v36, 16, v36
    v_mul_f32 v38, 936490775, v37
    v_mul_f32 v37, 928531664, v37
    v_cmp_nle_f32 vcc, v36, v38
    v_max_u32 v36, v36, v37
    s_nop 0
    v_readlane_b32 s14, v36, 63
    s_bitcmp1_b32 vcc_hi, 31
    s_cselect_b32 s2, 1, s2
    s_lshr_b32 s14, s14, 23
    s_add_u32 s14, s14, 1
    s_cmp_lt_u32 s14, 40
    s_cselect_b32 s2, 1, s2
    s_cmp_gt_u32 s14, 230
    s_cselect_b32 s2, 1, s2
    s_sub_u32 s48, s14, 14
    s_lshl_b32 s48, s48, 23
    s_add_u32 s16, s48, 197148672
    s_waitcnt vmcnt(6)
    ds_write_b128 v3, v[88:91] offset:0
    ds_write_b128 v3, v[92:95] offset:16384
    ds_write_b128 v3, v[96:99] offset:32768
    ds_write_b128 v3, v[100:103] offset:49152
    ds_write_b128 v124, v[104:107]
    v_add_u32_sdwa v113, 1, v43 dst_sel:DWORD dst_unused:UNUSED_PAD src0_sel:DWORD src1_sel:WORD_1
    v_lshrrev_b32_sdwa v112, 1, v11 dst_sel:DWORD dst_unused:UNUSED_PAD src0_sel:DWORD src1_sel:WORD_1
    v_lshrrev_b32 v113, 1, v113
    v_sub_u32 v114, v113, v112
    v_add_u32 v113, 448, v113
    s_nop 0
    v_add_u32_dpp v114, v114, v114 row_shr:1 row_mask:0xf bank_mask:0xf bound_ctrl:0
    s_nop 1
    v_add_u32_dpp v114, v114, v114 row_shr:2 row_mask:0xf bank_mask:0xf bound_ctrl:0
    s_nop 1
    v_add_u32_dpp v114, v114, v114 row_shr:4 row_mask:0xf bank_mask:0xf bound_ctrl:0
    s_nop 1
    v_add_u32_dpp v114, v114, v114 row_shr:8 row_mask:0xf bank_mask:0xf bound_ctrl:0
    s_nop 1
    v_add_u32_dpp v114, v114, v114 row_bcast:15 row_mask:0xa bank_mask:0xf
    s_nop 1
    v_add_u32_dpp v114, v114, v114 row_bcast:31 row_mask:0xc bank_mask:0xf
    v_sub_u32 v113, v113, v114
    v_readlane_b32 s56, v114, 63
    v_add_u32 v114, -1, v114
    ds_write_b16 v126, v113
    v_lshlrev_b32_e64 v115, v114, 1
    v_lshrrev_b32 v114, 5, v114
    v_lshl_add_u32 v114, v114, 2, s19
    s_cmp_gt_u32 s56, 448
    s_cselect_b32 s2, 1, s2
    s_cselect_b64 exec, 0, -1
    ds_or_b32 v114, v115 offset:160
    s_mov_b64 exec, -1
    ds_wrxchg_rtn_b32 v7, v6, v5 offset:160
    s_waitcnt lgkmcnt(0)
    v_readlane_b32 s30, v7, 0
    v_readlane_b32 s31, v7, 1
    v_readlane_b32 s32, v7, 2
    v_readlane_b32 s33, v7, 3
    v_readlane_b32 s34, v7, 4
    v_readlane_b32 s35, v7, 5
    v_readlane_b32 s36, v7, 6
    v_readlane_b32 s37, v7, 7
    v_readlane_b32 s38, v7, 8
    v_readlane_b32 s39, v7, 9
    v_readlane_b32 s40, v7, 10
    v_readlane_b32 s41, v7, 11
    s_mov_b32 s25, s19
    s_mov_b32 s26, s27
    s_mov_b32 s29, s56
    v_mbcnt_lo_u32_b32 v36, s30, 0
    v_mbcnt_hi_u32_b32 v36, s31, v36
    s_bcnt1_i32_b64 s14, s[30:31]
    v_lshl_add_u32 v37, v36, 1, s25
    ds_read_u16 v37, v37
    v_mad_u32_u24 v36, v36, s23, v2
    s_mov_b32 s30, s26
    s_lshl1_add_u32 s25, s14, s25
    s_mul_i32 s14, s14, s23
    s_add_u32 s26, s26, s14
    v_mbcnt_lo_u32_b32 v40, s32, 0
    v_mbcnt_hi_u32_b32 v40, s33, v40
    s_bcnt1_i32_b64 s14, s[32:33]
    v_lshl_add_u32 v41, v40, 1, s25
    ds_read_u16 v41, v41
    v_mad_u32_u24 v40, v40, s23, v2
    s_mov_b32 s32, s26
    s_lshl1_add_u32 s25, s14, s25
    s_mul_i32 s14, s14, s23
    s_add_u32 s26, s26, s14
    v_mbcnt_lo_u32_b32 v44, s34, 0
    v_mbcnt_hi_u32_b32 v44, s35, v44
    s_bcnt1_i32_b64 s14, s[34:35]
    v_lshl_add_u32 v45, v44, 1, s25
    ds_read_u16 v45, v45
    v_mad_u32_u24 v44, v44, s23, v2
    s_mov_b32 s34, s26
    s_lshl1_add_u32 s25, s14, s25
    s_mul_i32 s14, s14, s23
    s_add_u32 s26, s26, s14
    v_mbcnt_lo_u32_b32 v48, s36, 0
    v_mbcnt_hi_u32_b32 v48, s37, v48
    s_bcnt1_i32_b64 s14, s[36:37]
    v_lshl_add_u32 v49, v48, 1, s25
    ds_read_u16 v49, v49
    v_mad_u32_u24 v48, v48, s23, v2
    s_mov_b32 s36, s26
    s_lshl1_add_u32 s25, s14, s25
    s_mul_i32 s14, s14, s23
    s_add_u32 s26, s26, s14
    v_mbcnt_lo_u32_b32 v52, s38, 0
    v_mbcnt_hi_u32_b32 v52, s39, v52
    s_bcnt1_i32_b64 s14, s[38:39]
    v_lshl_add_u32 v53, v52, 1, s25
    ds_read_u16 v53, v53
    v_mad_u32_u24 v52, v52, s23, v2
    s_mov_b32 s38, s26
    s_lshl1_add_u32 s25, s14, s25
    s_mul_i32 s14, s14, s23
    s_add_u32 s26, s26, s14
    v_mbcnt_lo_u32_b32 v56, s40, 0
    v_mbcnt_hi_u32_b32 v56, s41, v56
    s_bcnt1_i32_b64 s14, s[40:41]
    v_lshl_add_u32 v57, v56, 1, s25
    ds_read_u16 v57, v57
    v_mad_u32_u24 v56, v56, s23, v2
    s_mov_b32 s40, s26
    s_lshl1_add_u32 s25, s14, s25
    s_mul_i32 s14, s14, s23
    s_add_u32 s26, s26, s14
    s_waitcnt lgkmcnt(5)
    v_mad_u32_u24 v36, v37, 12, v36
    buffer_load_dwordx3 v[36:38], v36, s[44:47], s30 offen offset:0
    s_waitcnt lgkmcnt(4)
    v_mad_u32_u24 v40, v41, 12, v40
    buffer_load_dwordx3 v[40:42], v40, s[44:47], s32 offen offset:768
    s_waitcnt lgkmcnt(3)
    v_mad_u32_u24 v44, v45, 12, v44
    buffer_load_dwordx3 v[44:46], v44, s[44:47], s34 offen offset:1536
    s_waitcnt lgkmcnt(2)
    v_mad_u32_u24 v48, v49, 12, v48
    buffer_load_dwordx3 v[48:50], v48, s[44:47], s36 offen offset:2304
    s_waitcnt lgkmcnt(1)
    v_mad_u32_u24 v52, v53, 12, v52
    buffer_load_dwordx3 v[52:54], v52, s[44:47], s38 offen offset:3072
    s_waitcnt lgkmcnt(0)
    v_mad_u32_u24 v56, v57, 12, v56
    buffer_load_dwordx3 v[56:58], v56, s[44:47], s40 offen offset:3840
    s_cmp_le_u32 s29, 384
    s_cbranch_scc1 L_p2_kernel_norare_2
    v_readlane_b32 s42, v7, 12
    v_readlane_b32 s43, v7, 13
    s_nop 1
    v_mbcnt_lo_u32_b32 v120, s42, 0
    v_mbcnt_hi_u32_b32 v120, s43, v120
    s_bcnt1_i32_b64 s14, s[42:43]
    v_lshl_add_u32 v121, v120, 1, s25
    ds_read_u16 v121, v121
    v_mad_u32_u24 v120, v120, s23, v2
    s_mov_b32 s42, s26
    s_lshl1_add_u32 s25, s14, s25
    s_mul_i32 s14, s14, s23
    s_add_u32 s26, s26, s14
    s_waitcnt lgkmcnt(0)
    s_add_u32 s42, s42, 4608
    v_mad_u32_u24 v120, v121, 12, v120
    buffer_load_dwordx3 v[60:62], v120, s[44:47], s42 offen offset:0
L_p2_kernel_norare_2:
    v_mov_b32 v11, v15
    v_mov_b32 v43, v47
    v_mov_b32 v15, v19
    v_mov_b32 v47, v51
    v_mov_b32 v19, v23
    v_mov_b32 v51, v55
    v_mov_b32 v23, v27
    v_mov_b32 v55, v59
    v_mov_b32 v27, v31
    v_mov_b32 v59, v63
    v_mov_b32 v31, v35
    v_mov_b32 v63, v122
    v_mov_b32 v35, v39
    v_mov_b32 v122, v123
    v_mov_b32 v39, 0
    v_mov_b32 v123, 0
    v_add_u32_sdwa v113, 1, v43 dst_sel:DWORD dst_unused:UNUSED_PAD src0_sel:DWORD src1_sel:WORD_0
    v_lshrrev_b32_sdwa v112, 1, v11 dst_sel:DWORD dst_unused:UNUSED_PAD src0_sel:DWORD src1_sel:WORD_0
    v_lshrrev_b32 v113, 1, v113
    v_sub_u32 v114, v113, v112
    v_add_u32 v113, 448, v113
    s_nop 0
    v_add_u32_dpp v114, v114, v114 row_shr:1 row_mask:0xf bank_mask:0xf bound_ctrl:0
    s_nop 1
    v_add_u32_dpp v114, v114, v114 row_shr:2 row_mask:0xf bank_mask:0xf bound_ctrl:0
    s_nop 1
    v_add_u32_dpp v114, v114, v114 row_shr:4 row_mask:0xf bank_mask:0xf bound_ctrl:0
    s_nop 1
    v_add_u32_dpp v114, v114, v114 row_shr:8 row_mask:0xf bank_mask:0xf bound_ctrl:0
    s_nop 1
    v_add_u32_dpp v114, v114, v114 row_bcast:15 row_mask:0xa bank_mask:0xf
    s_nop 1
    v_add_u32_dpp v114, v114, v114 row_bcast:31 row_mask:0xc bank_mask:0xf
    v_sub_u32 v113, v113, v114
    v_readlane_b32 s56, v114, 63
    v_add_u32 v114, -1, v114
    ds_write_b16 v126, v113
    v_lshlrev_b32_e64 v115, v114, 1
    v_lshrrev_b32 v114, 5, v114
    v_lshl_add_u32 v114, v114, 2, s19
    s_cmp_gt_u32 s56, 448
    s_cselect_b32 s2, 1, s2
    s_cselect_b64 exec, 0, -1
    ds_or_b32 v114, v115 offset:160
    s_mov_b64 exec, -1
    ds_wrxchg_rtn_b32 v7, v6, v5 offset:160
    s_mov_b32 s24, 0
    s_barrier
L_p2_loop:
    s_cmp_le_u32 s28, 384
    s_cbranch_scc1 L_p2_kernel_norare2_3
    s_waitcnt vmcnt(0)
    v_mad_u32_u16 v64, v32, 8, s18
    v_mad_u32_u16 v66, v33, 8, s18
    ds_read_b64 v[64:65], v64
    ds_read_b64 v[66:67], v66
    v_and_b32 v112, 0xffff, v34
    v_lshrrev_b32 v114, 16, v34
    v_lshlrev_b32 v113, 16, v34
    v_and_b32 v34, 0xffff0000, v34
    v_mad_u32_u16 v32, v32, 8, s50 op_sel:[1,0,0,0]
    v_mad_u32_u16 v33, v33, 8, s50 op_sel:[1,0,0,0]
    s_waitcnt lgkmcnt(0)
    v_dot2_f32_bf16 v115, v64, v112, s16
    v_dot2_f32_bf16 v64, v64, v113, s16
    v_dot2_f32_bf16 v116, v65, v112, s16
    v_dot2_f32_bf16 v65, v65, v113, s16
    v_dot2_f32_bf16 v117, v66, v114, s16
    v_dot2_f32_bf16 v66, v66, v34, s16
    v_dot2_f32_bf16 v118, v67, v114, s16
    v_dot2_f32_bf16 v67, v67, v34, s16
    v_perm_b32 v64, v64, v115, s17
    v_perm_b32 v65, v65, v116, s17
    v_perm_b32 v66, v66, v117, s17
    v_perm_b32 v67, v67, v118, s17
    v_lshl_add_u64 v[64:65], v[64:65], 0, s[20:21]
    v_lshl_add_u64 v[66:67], v[66:67], 0, s[20:21]
    v_or3_b32 v4, v108, v109, v4
    v_or3_b32 v4, v110, v111, v4
    ds_add_rtn_u64 v[108:109], v32, v[64:65]
    ds_add_rtn_u64 v[110:111], v33, v[66:67]
    s_waitcnt lgkmcnt(0)
L_p2_kernel_norare2_3:
    s_add_u32 s22, s22, 80000
    s_cmp_eq_u32 s24, 7
    s_cselect_b32 s46, 0, s46
    s_waitcnt vmcnt(6)
    v_mad_u32_u16 v64, v8, 8, s18
    v_mad_u32_u16 v66, v9, 8, s18
    ds_read_b64 v[64:65], v64
    ds_read_b64 v[66:67], v66
    s_add_u32 s14, s22, 0
    buffer_load_dwordx4 v[88:91], v1, s[8:11], s14 offen
    v_mad_u32_u16 v68, v12, 8, s18
    v_mad_u32_u16 v70, v13, 8, s18
    ds_read_b64 v[68:69], v68
    ds_read_b64 v[70:71], v70
    s_add_u32 s14, s22, 16384
    buffer_load_dwordx4 v[92:95], v1, s[8:11], s14 offen
    v_mad_u32_u16 v72, v16, 8, s18
    v_mad_u32_u16 v74, v17, 8, s18
    ds_read_b64 v[72:73], v72
    ds_read_b64 v[74:75], v74
    s_add_u32 s14, s22, 32768
    buffer_load_dwordx4 v[96:99], v1, s[8:11], s14 offen
    v_mad_u32_u16 v76, v20, 8, s18
    v_mad_u32_u16 v78, v21, 8, s18
    ds_read_b64 v[76:77], v76
    ds_read_b64 v[78:79], v78
    s_add_u32 s14, s22, 49152
    buffer_load_dwordx4 v[100:103], v1, s[8:11], s14 offen
    v_mad_u32_u16 v80, v24, 8, s18
    v_mad_u32_u16 v82, v25, 8, s18
    ds_read_b64 v[80:81], v80
    ds_read_b64 v[82:83], v82
    s_add_u32 s14, s22, 65536
    buffer_load_dwordx4 v[104:107], v1, s[8:11], s14 offen
    v_mad_u32_u16 v84, v28, 8, s18
    v_mad_u32_u16 v86, v29, 8, s18
    ds_read_b64 v[84:85], v84
    ds_read_b64 v[86:87], v86
    s_add_u32 s14, s51, s22
    s_add_u32 s14, s14, 80000
    s_mov_b64 exec, 0x101
    buffer_load_dword v125, v1, s[8:11], s14 offen
    s_mov_b64 exec, -1
    s_waitcnt lgkmcnt(12)
    v_readlane_b32 s30, v7, 0
    v_readlane_b32 s31, v7, 1
    v_readlane_b32 s32, v7, 2
    v_readlane_b32 s33, v7, 3
    v_readlane_b32 s34, v7, 4
    v_readlane_b32 s35, v7, 5
    v_readlane_b32 s36, v7, 6
    v_readlane_b32 s37, v7, 7
    v_readlane_b32 s38, v7, 8
    v_readlane_b32 s39, v7, 9
    v_readlane_b32 s40, v7, 10
    v_readlane_b32 s41, v7, 11
    s_mov_b32 s25, s19
    s_mov_b32 s26, s27
    s_mov_b32 s28, s56
    v_mbcnt_lo_u32_b32 v120, s30, 0
    v_mbcnt_hi_u32_b32 v120, s31, v120
    s_bcnt1_i32_b64 s14, s[30:31]
    v_lshl_add_u32 v121, v120, 1, s25
    ds_read_u16 v121, v121
    v_mad_u32_u24 v120, v120, s23, v2
    s_mov_b32 s30, s26
    s_lshl1_add_u32 s25, s14, s25
    s_mul_i32 s14, s14, s23
    s_add_u32 s26, s26, s14
    v_and_b32 v112, 0xffff, v10
    v_lshrrev_b32 v114, 16, v10
    v_lshlrev_b32 v113, 16, v10
    v_and_b32 v10, 0xffff0000, v10
    v_mad_u32_u16 v8, v8, 8, s50 op_sel:[1,0,0,0]
    v_mad_u32_u16 v9, v9, 8, s50 op_sel:[1,0,0,0]
    s_waitcnt lgkmcnt(11)
    v_dot2_f32_bf16 v115, v64, v112, s16
    v_dot2_f32_bf16 v64, v64, v113, s16
    v_dot2_f32_bf16 v116, v65, v112, s16
    v_dot2_f32_bf16 v65, v65, v113, s16
    v_dot2_f32_bf16 v117, v66, v114, s16
    v_dot2_f32_bf16 v66, v66, v10, s16
    v_dot2_f32_bf16 v118, v67, v114, s16
    v_dot2_f32_bf16 v67, v67, v10, s16
    v_perm_b32 v64, v64, v115, s17
    v_perm_b32 v65, v65, v116, s17
    v_perm_b32 v66, v66, v117, s17
    v_perm_b32 v67, v67, v118, s17
    v_lshl_add_u64 v[64:65], v[64:65], 0, s[20:21]
    v_lshl_add_u64 v[66:67], v[66:67], 0, s[20:21]
    v_or3_b32 v4, v108, v109, v4
    v_or3_b32 v4, v110, v111, v4
    ds_add_rtn_u64 v[108:109], v8, v[64:65]
    ds_add_rtn_u64 v[110:111], v9, v[66:67]
    s_waitcnt lgkmcnt(2)
    v_mad_u32_u24 v120, v121, 12, v120
    buffer_load_dwordx3 v[8:10], v120, s[44:47], s30 offen offset:0
    v_mbcnt_lo_u32_b32 v120, s32, 0
    v_mbcnt_hi_u32_b32 v120, s33, v120
    s_bcnt1_i32_b64 s14, s[32:33]
    v_lshl_add_u32 v121, v120, 1, s25
    ds_read_u16 v121, v121
    v_mad_u32_u24 v120, v120, s23, v2
    s_mov_b32 s32, s26
    s_lshl1_add_u32 s25, s14, s25
    s_mul_i32 s14, s14, s23
    s_add_u32 s26, s26, s14
    v_and_b32 v112, 0xffff, v14
    v_lshrrev_b32 v114, 16, v14
    v_lshlrev_b32 v113, 16, v14
    v_and_b32 v14, 0xffff0000, v14
    v_mad_u32_u16 v12, v12, 8, s50 op_sel:[1,0,0,0]
    v_mad_u32_u16 v13, v13, 8, s50 op_sel:[1,0,0,0]
    v_dot2_f32_bf16 v115, v68, v112, s16
    v_dot2_f32_bf16 v68, v68, v113, s16
    v_dot2_f32_bf16 v116, v69, v112, s16
    v_dot2_f32_bf16 v69, v69, v113, s16
    v_dot2_f32_bf16 v117, v70, v114, s16
    v_dot2_f32_bf16 v70, v70, v14, s16
    v_dot2_f32_bf16 v118, v71, v114, s16
    v_dot2_f32_bf16 v71, v71, v14, s16
    v_perm_b32 v68, v68, v115, s17
    v_perm_b32 v69, v69, v116, s17
    v_perm_b32 v70, v70, v117, s17
    v_perm_b32 v71, v71, v118, s17
    v_lshl_add_u64 v[68:69], v[68:69], 0, s[20:21]
    v_lshl_add_u64 v[70:71], v[70:71], 0, s[20:21]
    s_waitcnt lgkmcnt(1)
    v_or3_b32 v4, v108, v109, v4
    v_or3_b32 v4, v110, v111, v4
    ds_add_rtn_u64 v[108:109], v12, v[68:69]
    ds_add_rtn_u64 v[110:111], v13, v[70:71]
    s_waitcnt lgkmcnt(2)
    v_mad_u32_u24 v120, v121, 12, v120
    buffer_load_dwordx3 v[12:14], v120, s[44:47], s32 offen offset:768
    v_mbcnt_lo_u32_b32 v120, s34, 0
    v_mbcnt_hi_u32_b32 v120, s35, v120
    s_bcnt1_i32_b64 s14, s[34:35]
    v_lshl_add_u32 v121, v120, 1, s25
    ds_read_u16 v121, v121
    v_mad_u32_u24 v120, v120, s23, v2
    s_mov_b32 s34, s26
    s_lshl1_add_u32 s25, s14, s25
    s_mul_i32 s14, s14, s23
    s_add_u32 s26, s26, s14
    v_and_b32 v112, 0xffff, v18
    v_lshrrev_b32 v114, 16, v18
    v_lshlrev_b32 v113, 16, v18
    v_and_b32 v18, 0xffff0000, v18
    v_mad_u32_u16 v16, v16, 8, s50 op_sel:[1,0,0,0]
    v_mad_u32_u16 v17, v17, 8, s50 op_sel:[1,0,0,0]
    v_dot2_f32_bf16 v115, v72, v112, s16
    v_dot2_f32_bf16 v72, v72, v113, s16
    v_dot2_f32_bf16 v116, v73, v112, s16
    v_dot2_f32_bf16 v73, v73, v113, s16
    v_dot2_f32_bf16 v117, v74, v114, s16
    v_dot2_f32_bf16 v74, v74, v18, s16
    v_dot2_f32_bf16 v118, v75, v114, s16
    v_dot2_f32_bf16 v75, v75, v18, s16
    v_perm_b32 v72, v72, v115, s17
    v_perm_b32 v73, v73, v116, s17
    v_perm_b32 v74, v74, v117, s17
    v_perm_b32 v75, v75, v118, s17
    v_lshl_add_u64 v[72:73], v[72:73], 0, s[20:21]
    v_lshl_add_u64 v[74:75], v[74:75], 0, s[20:21]
    s_waitcnt lgkmcnt(1)
    v_or3_b32 v4, v108, v109, v4
    v_or3_b32 v4, v110, v111, v4
    ds_add_rtn_u64 v[108:109], v16, v[72:73]
    ds_add_rtn_u64 v[110:111], v17, v[74:75]
    s_waitcnt lgkmcnt(2)
    v_mad_u32_u24 v120, v121, 12, v120
    buffer_load_dwordx3 v[16:18], v120, s[44:47], s34 offen offset:1536
    s_barrier
    s_waitcnt vmcnt(4)
    ds_write_b128 v3, v[88:91] offset:0
    ds_write_b128 v3, v[92:95] offset:16384
    ds_write_b128 v3, v[96:99] offset:32768
    ds_write_b128 v3, v[100:103] offset:49152
    ds_write_b128 v124, v[104:107]
    v_mbcnt_lo_u32_b32 v120, s36, 0
    v_mbcnt_hi_u32_b32 v120, s37, v120
    s_bcnt1_i32_b64 s14, s[36:37]
    v_lshl_add_u32 v121, v120, 1, s25
    ds_read_u16 v121, v121
    v_mad_u32_u24 v120, v120, s23, v2
    s_mov_b32 s36, s26
    s_lshl1_add_u32 s25, s14, s25
    s_mul_i32 s14, s14, s23
    s_add_u32 s26, s26, s14
    v_and_b32 v112, 0xffff, v22
    v_lshrrev_b32 v114, 16, v22
    v_lshlrev_b32 v113, 16, v22
    v_and_b32 v22, 0xffff0000, v22
    v_mad_u32_u16 v20, v20, 8, s50 op_sel:[1,0,0,0]
    v_mad_u32_u16 v21, v21, 8, s50 op_sel:[1,0,0,0]
    v_dot2_f32_bf16 v115, v76, v112, s16
    v_dot2_f32_bf16 v76, v76, v113, s16
    v_dot2_f32_bf16 v116, v77, v112, s16
    v_dot2_f32_bf16 v77, v77, v113, s16
    v_dot2_f32_bf16 v117, v78, v114, s16
    v_dot2_f32_bf16 v78, v78, v22, s16
    v_dot2_f32_bf16 v118, v79, v114, s16
    v_dot2_f32_bf16 v79, v79, v22, s16
    v_perm_b32 v76, v76, v115, s17
    v_perm_b32 v77, v77, v116, s17
    v_perm_b32 v78, v78, v117, s17
    v_perm_b32 v79, v79, v118, s17
    v_lshl_add_u64 v[76:77], v[76:77], 0, s[20:21]
    v_lshl_add_u64 v[78:79], v[78:79], 0, s[20:21]
    s_waitcnt lgkmcnt(6)
    v_or3_b32 v4, v108, v109, v4
    v_or3_b32 v4, v110, v111, v4
    ds_add_rtn_u64 v[108:109], v20, v[76:77]
    ds_add_rtn_u64 v[110:111], v21, v[78:79]
    s_waitcnt lgkmcnt(2)
    v_mad_u32_u24 v120, v121, 12, v120
    buffer_load_dwordx3 v[20:22], v120, s[44:47], s36 offen offset:2304
    v_mbcnt_lo_u32_b32 v120, s38, 0
    v_mbcnt_hi_u32_b32 v120, s39, v120
    s_bcnt1_i32_b64 s14, s[38:39]
    v_lshl_add_u32 v121, v120, 1, s25
    ds_read_u16 v121, v121
    v_mad_u32_u24 v120, v120, s23, v2
    s_mov_b32 s38, s26
    s_lshl1_add_u32 s25, s14, s25
    s_mul_i32 s14, s14, s23
    s_add_u32 s26, s26, s14
    v_and_b32 v112, 0xffff, v26
    v_lshrrev_b32 v114, 16, v26
    v_lshlrev_b32 v113, 16, v26
    v_and_b32 v26, 0xffff0000, v26
    v_mad_u32_u16 v24, v24, 8, s50 op_sel:[1,0,0,0]
    v_mad_u32_u16 v25, v25, 8, s50 op_sel:[1,0,0,0]
    v_dot2_f32_bf16 v115, v80, v112, s16
    v_dot2_f32_bf16 v80, v80, v113, s16
    v_dot2_f32_bf16 v116, v81, v112, s16
    v_dot2_f32_bf16 v81, v81, v113, s16
    v_dot2_f32_bf16 v117, v82, v114, s16
    v_dot2_f32_bf16 v82, v82, v26, s16
    v_dot2_f32_bf16 v118, v83, v114, s16
    v_dot2_f32_bf16 v83, v83, v26, s16
    v_perm_b32 v80, v80, v115, s17
    v_perm_b32 v81, v81, v116, s17
    v_perm_b32 v82, v82, v117, s17
    v_perm_b32 v83, v83, v118, s17
    v_lshl_add_u64 v[80:81], v[80:81], 0, s[20:21]
    v_lshl_add_u64 v[82:83], v[82:83], 0, s[20:21]
    s_waitcnt lgkmcnt(1)
    v_or3_b32 v4, v108, v109, v4
    v_or3_b32 v4, v110, v111, v4
    ds_add_rtn_u64 v[108:109], v24, v[80:81]
    ds_add_rtn_u64 v[110:111], v25, v[82:83]
    s_waitcnt lgkmcnt(2)
    v_mad_u32_u24 v120, v121, 12, v120
    buffer_load_dwordx3 v[24:26], v120, s[44:47], s38 offen offset:3072
    v_mbcnt_lo_u32_b32 v120, s40, 0
    v_mbcnt_hi_u32_b32 v120, s41, v120
    s_bcnt1_i32_b64 s14, s[40:41]
    v_lshl_add_u32 v121, v120, 1, s25
    ds_read_u16 v121, v121
    v_mad_u32_u24 v120, v120, s23, v2
    s_mov_b32 s40, s26
    s_lshl1_add_u32 s25, s14, s25
    s_mul_i32 s14, s14, s23
    s_add_u32 s26, s26, s14
    v_and_b32 v112, 0xffff, v30
    v_lshrrev_b32 v114, 16, v30
    v_lshlrev_b32 v113, 16, v30
    v_and_b32 v30, 0xffff0000, v30
    v_mad_u32_u16 v28, v28, 8, s50 op_sel:[1,0,0,0]
    v_mad_u32_u16 v29, v29, 8, s50 op_sel:[1,0,0,0]
    v_dot2_f32_bf16 v115, v84, v112, s16
    v_dot2_f32_bf16 v84, v84, v113, s16
    v_dot2_f32_bf16 v116, v85, v112, s16
    v_dot2_f32_bf16 v85, v85, v113, s16
    v_dot2_f32_bf16 v117, v86, v114, s16
    v_dot2_f32_bf16 v86, v86, v30, s16
    v_dot2_f32_bf16 v118, v87, v114, s16
    v_dot2_f32_bf16 v87, v87, v30, s16
    v_perm_b32 v84, v84, v115, s17
    v_perm_b32 v85, v85, v116, s17
    v_perm_b32 v86, v86, v117, s17
    v_perm_b32 v87, v87, v118, s17
    v_lshl_add_u64 v[84:85], v[84:85], 0, s[20:21]
    v_lshl_add_u64 v[86:87], v[86:87], 0, s[20:21]
    s_waitcnt lgkmcnt(1)
    v_or3_b32 v4, v108, v109, v4
    v_or3_b32 v4, v110, v111, v4
    ds_add_rtn_u64 v[108:109], v28, v[84:85]
    ds_add_rtn_u64 v[110:111], v29, v[86:87]
    s_waitcnt lgkmcnt(2)
    v_mad_u32_u24 v120, v121, 12, v120
    buffer_load_dwordx3 v[28:30], v120, s[44:47], s40 offen offset:3840
    s_cmp_le_u32 s28, 384
    s_cbranch_scc1 L_p2_kernel_norare_4
    v_readlane_b32 s42, v7, 12
    v_readlane_b32 s43, v7, 13
    s_nop 1
    v_mbcnt_lo_u32_b32 v120, s42, 0
    v_mbcnt_hi_u32_b32 v120, s43, v120
    s_bcnt1_i32_b64 s14, s[42:43]
    v_lshl_add_u32 v121, v120, 1, s25
    ds_read_u16 v121, v121
    v_mad_u32_u24 v120, v120, s23, v2
    s_mov_b32 s42, s26
    s_lshl1_add_u32 s25, s14, s25
    s_mul_i32 s14, s14, s23
    s_add_u32 s26, s26, s14
    s_waitcnt lgkmcnt(0)
    s_add_u32 s42, s42, 4608
    v_mad_u32_u24 v120, v121, 12, v120
    buffer_load_dwordx3 v[32:34], v120, s[44:47], s42 offen offset:0
L_p2_kernel_norare_4:
    v_add_u32_sdwa v113, 1, v43 dst_sel:DWORD dst_unused:UNUSED_PAD src0_sel:DWORD src1_sel:WORD_1
    v_lshrrev_b32_sdwa v112, 1, v11 dst_sel:DWORD dst_unused:UNUSED_PAD src0_sel:DWORD src1_sel:WORD_1
    v_lshrrev_b32 v113, 1, v113
    v_sub_u32 v114, v113, v112
    v_add_u32 v113, 448, v113
    s_nop 0
    v_add_u32_dpp v114, v114, v114 row_shr:1 row_mask:0xf bank_mask:0xf bound_ctrl:0
    s_nop 1
    v_add_u32_dpp v114, v114, v114 row_shr:2 row_mask:0xf bank_mask:0xf bound_ctrl:0
    s_nop 1
    v_add_u32_dpp v114, v114, v114 row_shr:4 row_mask:0xf bank_mask:0xf bound_ctrl:0
    s_nop 1
    v_add_u32_dpp v114, v114, v114 row_shr:8 row_mask:0xf bank_mask:0xf bound_ctrl:0
    s_nop 1
    v_add_u32_dpp v114, v114, v114 row_bcast:15 row_mask:0xa bank_mask:0xf
    s_nop 1
    v_add_u32_dpp v114, v114, v114 row_bcast:31 row_mask:0xc bank_mask:0xf
    v_sub_u32 v113, v113, v114
    v_readlane_b32 s56, v114, 63
    v_add_u32 v114, -1, v114
    ds_write_b16 v126, v113
    v_lshlrev_b32_e64 v115, v114, 1
    v_lshrrev_b32 v114, 5, v114
    v_lshl_add_u32 v114, v114, 2, s19
    s_cmp_gt_u32 s56, 448
    s_cselect_b32 s2, 1, s2
    s_cselect_b64 exec, 0, -1
    ds_or_b32 v114, v115 offset:160
    s_mov_b64 exec, -1
    ds_wrxchg_rtn_b32 v7, v6, v5 offset:160
    s_barrier
    s_cmp_le_u32 s29, 384
    s_cbranch_scc1 L_p2_kernel_norare2_5
    s_waitcnt vmcnt(0)
    v_mad_u32_u16 v64, v60, 8, s18
    v_mad_u32_u16 v66, v61, 8, s18
    ds_read_b64 v[64:65], v64
    ds_read_b64 v[66:67], v66
    v_and_b32 v112, 0xffff, v62
    v_lshrrev_b32 v114, 16, v62
    v_lshlrev_b32 v113, 16, v62
    v_and_b32 v62, 0xffff0000, v62
    v_mad_u32_u16 v60, v60, 8, s50 op_sel:[1,0,0,0]
    v_mad_u32_u16 v61, v61, 8, s50 op_sel:[1,0,0,0]
    s_waitcnt lgkmcnt(0)
    v_dot2_f32_bf16 v115, v64, v112, s16
    v_dot2_f32_bf16 v64, v64, v113, s16
    v_dot2_f32_bf16 v116, v65, v112, s16
    v_dot2_f32_bf16 v65, v65, v113, s16
    v_dot2_f32_bf16 v117, v66, v114, s16
    v_dot2_f32_bf16 v66, v66, v62, s16
    v_dot2_f32_bf16 v118, v67, v114, s16
    v_dot2_f32_bf16 v67, v67, v62, s16
    v_perm_b32 v64, v64, v115, s17
    v_perm_b32 v65, v65, v116, s17
    v_perm_b32 v66, v66, v117, s17
    v_perm_b32 v67, v67, v118, s17
    v_lshl_add_u64 v[64:65], v[64:65], 0, s[20:21]
    v_lshl_add_u64 v[66:67], v[66:67], 0, s[20:21]
    v_or3_b32 v4, v108, v109, v4
    v_or3_b32 v4, v110, v111, v4
    ds_add_rtn_u64 v[108:109], v60, v[64:65]
    ds_add_rtn_u64 v[110:111], v61, v[66:67]
    s_waitcnt lgkmcnt(0)
L_p2_kernel_norare2_5:
    s_add_u32 s22, s22, 80000
    v_mad_u32_u16 v64, v36, 8, s18
    v_mad_u32_u16 v66, v37, 8, s18
    ds_read_b64 v[64:65], v64
    ds_read_b64 v[66:67], v66
    s_add_u32 s14, s22, 0
    buffer_load_dwordx4 v[88:91], v1, s[8:11], s14 offen
    v_mad_u32_u16 v68, v40, 8, s18
    v_mad_u32_u16 v70, v41, 8, s18
    ds_read_b64 v[68:69], v68
    ds_read_b64 v[70:71], v70
    s_add_u32 s14, s22, 16384
    buffer_load_dwordx4 v[92:95], v1, s[8:11], s14 offen
    v_mad_u32_u16 v72, v44, 8, s18
    v_mad_u32_u16 v74, v45, 8, s18
    ds_read_b64 v[72:73], v72
    ds_read_b64 v[74:75], v74
    s_add_u32 s14, s22, 32768
    buffer_load_dwordx4 v[96:99], v1, s[8:11], s14 offen
    v_mad_u32_u16 v76, v48, 8, s18
    v_mad_u32_u16 v78, v49, 8, s18
    ds_read_b64 v[76:77], v76
    ds_read_b64 v[78:79], v78
    s_add_u32 s14, s22, 49152
    buffer_load_dwordx4 v[100:103], v1, s[8:11], s14 offen
    v_mad_u32_u16 v80, v52, 8, s18
    v_mad_u32_u16 v82, v53, 8, s18
    ds_read_b64 v[80:81], v80
    ds_read_b64 v[82:83], v82
    s_add_u32 s14, s22, 65536
    buffer_load_dwordx4 v[104:107], v1, s[8:11], s14 offen
    v_mad_u32_u16 v84, v56, 8, s18
    v_mad_u32_u16 v86, v57, 8, s18
    ds_read_b64 v[84:85], v84
    ds_read_b64 v[86:87], v86
    s_add_u32 s14, s51, s22
    s_add_u32 s14, s14, 80000
    s_mov_b64 exec, 0x101
    buffer_load_dword v125, v1, s[8:11], s14 offen
    s_mov_b64 exec, -1
    s_waitcnt lgkmcnt(12)
    v_readlane_b32 s30, v7, 0
    v_readlane_b32 s31, v7, 1
    v_readlane_b32 s32, v7, 2
    v_readlane_b32 s33, v7, 3
    v_readlane_b32 s34, v7, 4
    v_readlane_b32 s35, v7, 5
    v_readlane_b32 s36, v7, 6
    v_readlane_b32 s37, v7, 7
    v_readlane_b32 s38, v7, 8
    v_readlane_b32 s39, v7, 9
    v_readlane_b32 s40, v7, 10
    v_readlane_b32 s41, v7, 11
    s_mov_b32 s25, s19
    s_mov_b32 s26, s27
    s_mov_b32 s29, s56
    v_mbcnt_lo_u32_b32 v120, s30, 0
    v_mbcnt_hi_u32_b32 v120, s31, v120
    s_bcnt1_i32_b64 s14, s[30:31]
    v_lshl_add_u32 v121, v120, 1, s25
    ds_read_u16 v121, v121
    v_mad_u32_u24 v120, v120, s23, v2
    s_mov_b32 s30, s26
    s_lshl1_add_u32 s25, s14, s25
    s_mul_i32 s14, s14, s23
    s_add_u32 s26, s26, s14
    v_and_b32 v112, 0xffff, v38
    v_lshrrev_b32 v114, 16, v38
    v_lshlrev_b32 v113, 16, v38
    v_and_b32 v38, 0xffff0000, v38
    v_mad_u32_u16 v36, v36, 8, s50 op_sel:[1,0,0,0]
    v_mad_u32_u16 v37, v37, 8, s50 op_sel:[1,0,0,0]
    s_waitcnt lgkmcnt(11)
    v_dot2_f32_bf16 v115, v64, v112, s16
    v_dot2_f32_bf16 v64, v64, v113, s16
    v_dot2_f32_bf16 v116, v65, v112, s16
    v_dot2_f32_bf16 v65, v65, v113, s16
    v_dot2_f32_bf16 v117, v66, v114, s16
    v_dot2_f32_bf16 v66, v66, v38, s16
    v_dot2_f32_bf16 v118, v67, v114, s16
    v_dot2_f32_bf16 v67, v67, v38, s16
    v_perm_b32 v64, v64, v115, s17
    v_perm_b32 v65, v65, v116, s17
    v_perm_b32 v66, v66, v117, s17
    v_perm_b32 v67, v67, v118, s17
    v_lshl_add_u64 v[64:65], v[64:65], 0, s[20:21]
    v_lshl_add_u64 v[66:67], v[66:67], 0, s[20:21]
    v_or3_b32 v4, v108, v109, v4
    v_or3_b32 v4, v110, v111, v4
    ds_add_rtn_u64 v[108:109], v36, v[64:65]
    ds_add_rtn_u64 v[110:111], v37, v[66:67]
    s_waitcnt lgkmcnt(2)
    v_mad_u32_u24 v120, v121, 12, v120
    buffer_load_dwordx3 v[36:38], v120, s[44:47], s30 offen offset:0
    v_mbcnt_lo_u32_b32 v120, s32, 0
    v_mbcnt_hi_u32_b32 v120, s33, v120
    s_bcnt1_i32_b64 s14, s[32:33]
    v_lshl_add_u32 v121, v120, 1, s25
    ds_read_u16 v121, v121
    v_mad_u32_u24 v120, v120, s23, v2
    s_mov_b32 s32, s26
    s_lshl1_add_u32 s25, s14, s25
    s_mul_i32 s14, s14, s23
    s_add_u32 s26, s26, s14
    v_and_b32 v112, 0xffff, v42
    v_lshrrev_b32 v114, 16, v42
    v_lshlrev_b32 v113, 16, v42
    v_and_b32 v42, 0xffff0000, v42
    v_mad_u32_u16 v40, v40, 8, s50 op_sel:[1,0,0,0]
    v_mad_u32_u16 v41, v41, 8, s50 op_sel:[1,0,0,0]
    v_dot2_f32_bf16 v115, v68, v112, s16
    v_dot2_f32_bf16 v68, v68, v113, s16
    v_dot2_f32_bf16 v116, v69, v112, s16
    v_dot2_f32_bf16 v69, v69, v113, s16
    v_dot2_f32_bf16 v117, v70, v114, s16
    v_dot2_f32_bf16 v70, v70, v42, s16
    v_dot2_f32_bf16 v118, v71, v114, s16
    v_dot2_f32_bf16 v71, v71, v42, s16
    v_perm_b32 v68, v68, v115, s17
    v_perm_b32 v69, v69, v116, s17
    v_perm_b32 v70, v70, v117, s17
    v_perm_b32 v71, v71, v118, s17
    v_lshl_add_u64 v[68:69], v[68:69], 0, s[20:21]
    v_lshl_add_u64 v[70:71], v[70:71], 0, s[20:21]
    s_waitcnt lgkmcnt(1)
    v_or3_b32 v4, v108, v109, v4
    v_or3_b32 v4, v110, v111, v4
    ds_add_rtn_u64 v[108:109], v40, v[68:69]
    ds_add_rtn_u64 v[110:111], v41, v[70:71]
    s_waitcnt lgkmcnt(2)
    v_mad_u32_u24 v120, v121, 12, v120
    buffer_load_dwordx3 v[40:42], v120, s[44:47], s32 offen offset:768
    v_mbcnt_lo_u32_b32 v120, s34, 0
    v_mbcnt_hi_u32_b32 v120, s35, v120
    s_bcnt1_i32_b64 s14, s[34:35]
    v_lshl_add_u32 v121, v120, 1, s25
    ds_read_u16 v121, v121
    v_mad_u32_u24 v120, v120, s23, v2
    s_mov_b32 s34, s26
    s_lshl1_add_u32 s25, s14, s25
    s_mul_i32 s14, s14, s23
    s_add_u32 s26, s26, s14
    v_and_b32 v112, 0xffff, v46
    v_lshrrev_b32 v114, 16, v46
    v_lshlrev_b32 v113, 16, v46
    v_and_b32 v46, 0xffff0000, v46
    v_mad_u32_u16 v44, v44, 8, s50 op_sel:[1,0,0,0]
    v_mad_u32_u16 v45, v45, 8, s50 op_sel:[1,0,0,0]
    v_dot2_f32_bf16 v115, v72, v112, s16
    v_dot2_f32_bf16 v72, v72, v113, s16
    v_dot2_f32_bf16 v116, v73, v112, s16
    v_dot2_f32_bf16 v73, v73, v113, s16
    v_dot2_f32_bf16 v117, v74, v114, s16
    v_dot2_f32_bf16 v74, v74, v46, s16
    v_dot2_f32_bf16 v118, v75, v114, s16
    v_dot2_f32_bf16 v75, v75, v46, s16
    v_perm_b32 v72, v72, v115, s17
    v_perm_b32 v73, v73, v116, s17
    v_perm_b32 v74, v74, v117, s17
    v_perm_b32 v75, v75, v118, s17
    v_lshl_add_u64 v[72:73], v[72:73], 0, s[20:21]
    v_lshl_add_u64 v[74:75], v[74:75], 0, s[20:21]
    s_waitcnt lgkmcnt(1)
    v_or3_b32 v4, v108, v109, v4
    v_or3_b32 v4, v110, v111, v4
    ds_add_rtn_u64 v[108:109], v44, v[72:73]
    ds_add_rtn_u64 v[110:111], v45, v[74:75]
    s_waitcnt lgkmcnt(2)
    v_mad_u32_u24 v120, v121, 12, v120
    buffer_load_dwordx3 v[44:46], v120, s[44:47], s34 offen offset:1536
    s_barrier
    s_waitcnt vmcnt(4)
    ds_write_b128 v3, v[88:91] offset:0
    ds_write_b128 v3, v[92:95] offset:16384
    ds_write_b128 v3, v[96:99] offset:32768
    ds_write_b128 v3, v[100:103] offset:49152
    ds_write_b128 v124, v[104:107]
    v_mbcnt_lo_u32_b32 v120, s36, 0
    v_mbcnt_hi_u32_b32 v120, s37, v120
    s_bcnt1_i32_b64 s14, s[36:37]
    v_lshl_add_u32 v121, v120, 1, s25
    ds_read_u16 v121, v121
    v_mad_u32_u24 v120, v120, s23, v2
    s_mov_b32 s36, s26
    s_lshl1_add_u32 s25, s14, s25
    s_mul_i32 s14, s14, s23
    s_add_u32 s26, s26, s14
    v_and_b32 v112, 0xffff, v50
    v_lshrrev_b32 v114, 16, v50
    v_lshlrev_b32 v113, 16, v50
    v_and_b32 v50, 0xffff0000, v50
    v_mad_u32_u16 v48, v48, 8, s50 op_sel:[1,0,0,0]
    v_mad_u32_u16 v49, v49, 8, s50 op_sel:[1,0,0,0]
    v_dot2_f32_bf16 v115, v76, v112, s16
    v_dot2_f32_bf16 v76, v76, v113, s16
    v_dot2_f32_bf16 v116, v77, v112, s16
    v_dot2_f32_bf16 v77, v77, v113, s16
    v_dot2_f32_bf16 v117, v78, v114, s16
    v_dot2_f32_bf16 v78, v78, v50, s16
    v_dot2_f32_bf16 v118, v79, v114, s16
    v_dot2_f32_bf16 v79, v79, v50, s16
    v_perm_b32 v76, v76, v115, s17
    v_perm_b32 v77, v77, v116, s17
    v_perm_b32 v78, v78, v117, s17
    v_perm_b32 v79, v79, v118, s17
    v_lshl_add_u64 v[76:77], v[76:77], 0, s[20:21]
    v_lshl_add_u64 v[78:79], v[78:79], 0, s[20:21]
    s_waitcnt lgkmcnt(6)
    v_or3_b32 v4, v108, v109, v4
    v_or3_b32 v4, v110, v111, v4
    ds_add_rtn_u64 v[108:109], v48, v[76:77]
    ds_add_rtn_u64 v[110:111], v49, v[78:79]
    s_waitcnt lgkmcnt(2)
    v_mad_u32_u24 v120, v121, 12, v120
    buffer_load_dwordx3 v[48:50], v120, s[44:47], s36 offen offset:2304
    v_mbcnt_lo_u32_b32 v120, s38, 0
    v_mbcnt_hi_u32_b32 v120, s39, v120
    s_bcnt1_i32_b64 s14, s[38:39]
    v_lshl_add_u32 v121, v120, 1, s25
    ds_read_u16 v121, v121
    v_mad_u32_u24 v120, v120, s23, v2
    s_mov_b32 s38, s26
    s_lshl1_add_u32 s25, s14, s25
    s_mul_i32 s14, s14, s23
    s_add_u32 s26, s26, s14
    v_and_b32 v112, 0xffff, v54
    v_lshrrev_b32 v114, 16, v54
    v_lshlrev_b32 v113, 16, v54
    v_and_b32 v54, 0xffff0000, v54
    v_mad_u32_u16 v52, v52, 8, s50 op_sel:[1,0,0,0]
    v_mad_u32_u16 v53, v53, 8, s50 op_sel:[1,0,0,0]
    v_dot2_f32_bf16 v115, v80, v112, s16
    v_dot2_f32_bf16 v80, v80, v113, s16
    v_dot2_f32_bf16 v116, v81, v112, s16
    v_dot2_f32_bf16 v81, v81, v113, s16
    v_dot2_f32_bf16 v117, v82, v114, s16
    v_dot2_f32_bf16 v82, v82, v54, s16
    v_dot2_f32_bf16 v118, v83, v114, s16
    v_dot2_f32_bf16 v83, v83, v54, s16
    v_perm_b32 v80, v80, v115, s17
    v_perm_b32 v81, v81, v116, s17
    v_perm_b32 v82, v82, v117, s17
    v_perm_b32 v83, v83, v118, s17
    v_lshl_add_u64 v[80:81], v[80:81], 0, s[20:21]
    v_lshl_add_u64 v[82:83], v[82:83], 0, s[20:21]
    s_waitcnt lgkmcnt(1)
    v_or3_b32 v4, v108, v109, v4
    v_or3_b32 v4, v110, v111, v4
    ds_add_rtn_u64 v[108:109], v52, v[80:81]
    ds_add_rtn_u64 v[110:111], v53, v[82:83]
    s_waitcnt lgkmcnt(2)
    v_mad_u32_u24 v120, v121, 12, v120
    buffer_load_dwordx3 v[52:54], v120, s[44:47], s38 offen offset:3072
    v_mbcnt_lo_u32_b32 v120, s40, 0
    v_mbcnt_hi_u32_b32 v120, s41, v120
    s_bcnt1_i32_b64 s14, s[40:41]
    v_lshl_add_u32 v121, v120, 1, s25
    ds_read_u16 v121, v121
    v_mad_u32_u24 v120, v120, s23, v2
    s_mov_b32 s40, s26
    s_lshl1_add_u32 s25, s14, s25
    s_mul_i32 s14, s14, s23
    s_add_u32 s26, s26, s14
    v_and_b32 v112, 0xffff, v58
    v_lshrrev_b32 v114, 16, v58
    v_lshlrev_b32 v113, 16, v58
    v_and_b32 v58, 0xffff0000, v58
    v_mad_u32_u16 v56, v56, 8, s50 op_sel:[1,0,0,0]
    v_mad_u32_u16 v57, v57, 8, s50 op_sel:[1,0,0,0]
    v_dot2_f32_bf16 v115, v84, v112, s16
    v_dot2_f32_bf16 v84, v84, v113, s16
    v_dot2_f32_bf16 v116, v85, v112, s16
    v_dot2_f32_bf16 v85, v85, v113, s16
    v_dot2_f32_bf16 v117, v86, v114, s16
    v_dot2_f32_bf16 v86, v86, v58, s16
    v_dot2_f32_bf16 v118, v87, v114, s16
    v_dot2_f32_bf16 v87, v87, v58, s16
    v_perm_b32 v84, v84, v115, s17
    v_perm_b32 v85, v85, v116, s17
    v_perm_b32 v86, v86, v117, s17
    v_perm_b32 v87, v87, v118, s17
    v_lshl_add_u64 v[84:85], v[84:85], 0, s[20:21]
    v_lshl_add_u64 v[86:87], v[86:87], 0, s[20:21]
    s_waitcnt lgkmcnt(1)
    v_or3_b32 v4, v108, v109, v4
    v_or3_b32 v4, v110, v111, v4
    ds_add_rtn_u64 v[108:109], v56, v[84:85]
    ds_add_rtn_u64 v[110:111], v57, v[86:87]
    s_waitcnt lgkmcnt(2)
    v_mad_u32_u24 v120, v121, 12, v120
    buffer_load_dwordx3 v[56:58], v120, s[44:47], s40 offen offset:3840
    s_cmp_le_u32 s29, 384
    s_cbranch_scc1 L_p2_kernel_norare_6
    v_readlane_b32 s42, v7, 12
    v_readlane_b32 s43, v7, 13
    s_nop 1
    v_mbcnt_lo_u32_b32 v120, s42, 0
    v_mbcnt_hi_u32_b32 v120, s43, v120
    s_bcnt1_i32_b64 s14, s[42:43]
    v_lshl_add_u32 v121, v120, 1, s25
    ds_read_u16 v121, v121
    v_mad_u32_u24 v120, v120, s23, v2
    s_mov_b32 s42, s26
    s_lshl1_add_u32 s25, s14, s25
    s_mul_i32 s14, s14, s23
    s_add_u32 s26, s26, s14
    s_waitcnt lgkmcnt(0)
    s_add_u32 s42, s42, 4608
    v_mad_u32_u24 v120, v121, 12, v120
    buffer_load_dwordx3 v[60:62], v120, s[44:47], s42 offen offset:0
L_p2_kernel_norare_6:
    v_mov_b32 v11, v15
    v_mov_b32 v43, v47
    v_mov_b32 v15, v19
    v_mov_b32 v47, v51
    v_mov_b32 v19, v23
    v_mov_b32 v51, v55
    v_mov_b32 v23, v27
    v_mov_b32 v55, v59
    v_mov_b32 v27, v31
    v_mov_b32 v59, v63
    v_mov_b32 v31, v35
    v_mov_b32 v63, v122
    v_mov_b32 v35, v39
    v_mov_b32 v122, v123
    v_mov_b32 v39, 0
    v_mov_b32 v123, 0
    v_add_u32_sdwa v113, 1, v43 dst_sel:DWORD dst_unused:UNUSED_PAD src0_sel:DWORD src1_sel:WORD_0
    v_lshrrev_b32_sdwa v112, 1, v11 dst_sel:DWORD dst_unused:UNUSED_PAD src0_sel:DWORD src1_sel:WORD_0
    v_lshrrev_b32 v113, 1, v113
    v_sub_u32 v114, v113, v112
    v_add_u32 v113, 448, v113
    s_nop 0
    v_add_u32_dpp v114, v114, v114 row_shr:1 row_mask:0xf bank_mask:0xf bound_ctrl:0
    s_nop 1
    v_add_u32_dpp v114, v114, v114 row_shr:2 row_mask:0xf bank_mask:0xf bound_ctrl:0
    s_nop 1
    v_add_u32_dpp v114, v114, v114 row_shr:4 row_mask:0xf bank_mask:0xf bound_ctrl:0
    s_nop 1
    v_add_u32_dpp v114, v114, v114 row_shr:8 row_mask:0xf bank_mask:0xf bound_ctrl:0
    s_nop 1
    v_add_u32_dpp v114, v114, v114 row_bcast:15 row_mask:0xa bank_mask:0xf
    s_nop 1
    v_add_u32_dpp v114, v114, v114 row_bcast:31 row_mask:0xc bank_mask:0xf
    v_sub_u32 v113, v113, v114
    v_readlane_b32 s56, v114, 63
    v_add_u32 v114, -1, v114
    ds_write_b16 v126, v113
    v_lshlrev_b32_e64 v115, v114, 1
    v_lshrrev_b32 v114, 5, v114
    v_lshl_add_u32 v114, v114, 2, s19
    s_cmp_gt_u32 s56, 448
    s_cselect_b32 s2, 1, s2
    s_cselect_b64 exec, 0, -1
    ds_or_b32 v114, v115 offset:160
    s_mov_b64 exec, -1
    ds_wrxchg_rtn_b32 v7, v6, v5 offset:160
    s_add_u32 s24, s24, 1
    s_cmp_lt_u32 s24, 8
    s_barrier
    s_cbranch_scc1 L_p2_loop
    s_waitcnt lgkmcnt(3)
    v_or3_b32 v4, v108, v109, v4
    v_or3_b32 v4, v110, v111, v4
    s_waitcnt vmcnt(0) lgkmcnt(0)
    s_barrier
    v_subrev_u32 v112, 80000, v124
    ds_read_b128 v[88:91], v1 offset:0
    ds_read_b128 v[92:95], v1 offset:16384
    ds_read_b128 v[96:99], v1 offset:32768
    ds_read_b128 v[100:103], v1 offset:49152
    ds_read_b128 v[104:107], v112
    s_mul_i32 s14, s12, 5120000
    s_mul_i32 s15, s3, 80000
    s_add_u32 s26, s14, s15
    s_add_u32 s26, s26, 259973632
    s_waitcnt lgkmcnt(4)
    s_add_u32 s14, s26, 0
    buffer_store_dwordx4 v[88:91], v1, s[4:7], s14 offen
    v_or3_b32 v4, v88, v89, v4
    v_or3_b32 v4, v90, v91, v4
    s_waitcnt lgkmcnt(3)
    s_add_u32 s14, s26, 16384
    buffer_store_dwordx4 v[92:95], v1, s[4:7], s14 offen
    v_or3_b32 v4, v92, v93, v4
    v_or3_b32 v4, v94, v95, v4
    s_waitcnt lgkmcnt(2)
    s_add_u32 s14, s26, 32768
    buffer_store_dwordx4 v[96:99], v1, s[4:7], s14 offen
    v_or3_b32 v4, v96, v97, v4
    v_or3_b32 v4, v98, v99, v4
    s_waitcnt lgkmcnt(1)
    s_add_u32 s14, s26, 49152
    buffer_store_dwordx4 v[100:103], v1, s[4:7], s14 offen
    v_or3_b32 v4, v100, v101, v4
    v_or3_b32 v4, v102, v103, v4
    s_waitcnt lgkmcnt(0)
    buffer_store_dwordx4 v[104:107], v112, s[4:7], s26 offen
    v_or3_b32 v4, v104, v105, v4
    v_or3_b32 v4, v106, v107, v4
    v_and_b32 v4, 0x80008000, v4
    v_cmp_ne_u32 vcc, 0, v4
    v_mov_b32 v113, s19
    v_and_b32 v115, 15, v0
    v_mul_u32_u24 v115, 240, v115
    v_add_u32 v115, 160000, v115
    s_cmp_lg_u64 vcc, 0
    s_cselect_b32 s2, 1, s2
    v_mov_b32 v114, s2
    s_mov_b64 exec, 1
    ds_write_b32 v113, v114
    s_mov_b64 exec, -1
    s_waitcnt lgkmcnt(0)
    s_barrier
    ds_read_b32 v114, v115
    s_lshl_b32 s14, s3, 4
    s_lshl_b32 s15, s12, 2
    s_add_u32 s25, s14, s15
    s_add_u32 s25, s25, 254849536
    s_waitcnt lgkmcnt(0)
    v_cmp_ne_u32 vcc, 0, v114
    v_mov_b32 v113, 0
    s_nop 1
    s_cmp_lg_u64 vcc, 0
    s_cselect_b32 s14, 0, s48
    v_mov_b32 v114, s14
    s_mov_b64 exec, 1
    buffer_store_dword v114, v113, s[4:7], s25 offen
    s_mov_b64 exec, -1
    s_cbranch_scc0 L_p2_end
    s_barrier
    v_mov_b32 v8, 0
    v_mov_b32 v9, 0
    v_mov_b32 v10, 0
    v_mov_b32 v11, 0
    v_mov_b32 v12, v1
    ds_write_b128 v12, v[8:11]
    v_add_u32 v12, 16384, v12
    ds_write_b128 v12, v[8:11]
    v_add_u32 v12, 16384, v12
    ds_write_b128 v12, v[8:11]
    v_add_u32 v12, 16384, v12
    ds_write_b128 v12, v[8:11]
    v_add_u32 v12, 16384, v12
    ds_write_b128 v12, v[8:11]
    v_add_u32 v12, 16384, v12
    ds_write_b128 v12, v[8:11]
    v_add_u32 v12, 16384, v12
    ds_write_b128 v12, v[8:11]
    v_add_u32 v12, 16384, v12
    ds_write_b128 v12, v[8:11]
    v_add_u32 v12, 16384, v12
    ds_write_b128 v12, v[8:11]
    v_add_u32 v12, 16384, v12
    ds_write_b128 v12, v[8:11]
    v_add_u32 v12, 16384, v12
    v_lshlrev_b32 v13, 5, v0
    v_add_u32 v28, 32896, v13
    v_mul_lo_u32 v14, v0, s23
    v_add_u32 v14, 8192, v14
    s_mul_i32 s25, s12, 65
    s_add_u32 s25, s25, s3
    s_mul_i32 s25, s25, 32896
    s_add_u32 s25, s25, 246292480
    s_lshl_b32 s50, s50, 1
    s_mul_i32 s22, s12, 1280000
    s_mov_b32 s24, 0
    s_waitcnt lgkmcnt(0)
    s_barrier
L_p2_sstep:
    buffer_load_ushort v15, v13, s[4:7], s25 offen
    buffer_load_ushort v16, v28, s[4:7], s25 offen
    s_waitcnt vmcnt(0)
L_p2_srec:
    v_cmp_lt_u32 vcc, v15, v16
    s_nop 1
    s_and_b64 exec, exec, vcc
    s_cbranch_execz L_p2_sdone
    v_lshrrev_b32 v17, 1, v15
    v_and_b32 v18, 1, v15
    v_mad_u32_u24 v17, v17, 12, v14
    v_lshl_add_u32 v19, v18, 2, v17
    v_lshl_add_u32 v17, v18, 1, v17
    buffer_load_dword v20, v19, s[4:7], 0 offen
    buffer_load_ushort v21, v17, s[4:7], 0 offen offset:8
    v_add_u32 v15, 1, v15
    s_waitcnt vmcnt(0)
    v_lshlrev_b32_sdwa v19, 3, v20 dst_sel:DWORD dst_unused:UNUSED_PAD src0_sel:DWORD src1_sel:WORD_0
    buffer_load_dwordx2 v[22:23], v19, s[8:11], s22 offen
    v_mad_u32_u16 v20, v20, 16, s50 op_sel:[1,0,0,0]
    v_lshlrev_b32 v21, 16, v21
    s_waitcnt vmcnt(0)
    v_lshlrev_b32 v24, 16, v22
    v_and_b32 v25, 0xffff0000, v22
    v_lshlrev_b32 v26, 16, v23
    v_and_b32 v27, 0xffff0000, v23
    v_mul_f32 v24, v21, v24
    v_mul_f32 v25, v21, v25
    v_mul_f32 v26, v21, v26
    v_mul_f32 v27, v21, v27
    ds_add_f32 v20, v24
    ds_add_f32 v20, v25 offset:4
    ds_add_f32 v20, v26 offset:8
    ds_add_f32 v20, v27 offset:12
    s_branch L_p2_srec
L_p2_sdone:
    s_mov_b64 exec, -1
    s_add_u32 s25, s25, 2
    s_add_u32 s22, s22, 80000
    s_add_u32 s24, s24, 1
    s_cmp_lt_u32 s24, 16
    s_cbranch_scc1 L_p2_sstep
    s_waitcnt lgkmcnt(0)
    s_barrier
    s_mul_i32 s14, s12, 10240000
    s_mul_i32 s15, s3, 160000
    s_add_u32 s26, s14, s15
    s_add_u32 s26, s26, 280453632
    v_mov_b32 v12, v1
    s_mov_b32 s24, 0
L_p2_sout:
    v_cmp_gt_u32 vcc, 160000, v12
    ds_read_b128 v[8:11], v12
    s_nop 0
    s_and_b64 exec, exec, vcc
    s_cbranch_execz L_p2_end
    s_waitcnt lgkmcnt(0)
    buffer_store_dwordx4 v[8:11], v12, s[4:7], s26 offen
    s_waitcnt vmcnt(0)
    v_add_u32 v12, 16384, v12
    s_branch L_p2_sout
L_p2_end:
    s_endpgm
.globl p3_kernel
.p2align 8
.type p3_kernel,@function
p3_kernel:
    s_cmp_ge_u32 s2, 1250
    s_cbranch_scc1 L_p3_end
    s_load_dwordx2 s[4:5], s[0:1], 104
    s_load_dwordx2 s[8:9], s[0:1], 0
    s_load_dwordx2 s[12:13], s[0:1], 24
    s_load_dwordx2 s[16:17], s[0:1], 88
    s_load_dwordx2 s[20:21], s[0:1], 40
    s_load_dwordx4 s[24:27], s[0:1], 56
    s_load_dwordx4 s[28:31], s[0:1], 72
    s_lshl_b32 s3, s2, 8
    v_add_u32 v0, s3, v0
    v_lshlrev_b32 v1, 4, v0
    v_lshlrev_b32 v2, 2, v0
    v_mul_hi_u32_u24 v3, 858994, v0
    v_lshlrev_b32 v3, 4, v3
    s_waitcnt lgkmcnt(0)
    s_mov_b32 s6, 655360000
    s_mov_b32 s7, 0x00020000
    s_mov_b32 s10, 5120000
    s_mov_b32 s11, 0x00020000
    s_mov_b32 s14, 1280000
    s_mov_b32 s15, 0x00020000
    s_mov_b32 s18, 5120000
    s_mov_b32 s19, 0x00020000
    s_load_dwordx4 s[96:99], s[20:21], 0
    s_load_dwordx16 s[32:47], s[24:25], 0
    s_load_dwordx16 s[48:63], s[26:27], 0
    s_load_dwordx8 s[64:71], s[28:29], 0
    s_load_dwordx8 s[80:87], s[30:31], 0
    buffer_load_dword v4, v2, s[12:15], 0 offen
    s_mov_b32 s3, 254849536
    buffer_load_dwordx4 v[8:11], v3, s[4:7], s3 offen
    s_mov_b32 s3, 259973632
    buffer_load_dwordx4 v[12:15], v1, s[4:7], s3 offen
    s_mov_b32 s3, 265093632
    buffer_load_dwordx4 v[16:19], v1, s[4:7], s3 offen
    s_mov_b32 s3, 270213632
    buffer_load_dwordx4 v[20:23], v1, s[4:7], s3 offen
    s_mov_b32 s3, 275333632
    buffer_load_dwordx4 v[24:27], v1, s[4:7], s3 offen
    buffer_load_dwordx4 v[28:31], v1, s[8:11], 0 offen
    s_waitcnt lgkmcnt(0)
    s_pack_ll_b32_b16 s20, s32, s34
    s_pack_hh_b32_b16 s21, s32, s34
    s_pack_ll_b32_b16 s22, s33, s35
    s_pack_hh_b32_b16 s35, s33, s35
    s_mov_b32 s32, s20
    s_mov_b32 s33, s21
    s_mov_b32 s34, s22
    s_pack_ll_b32_b16 s20, s36, s38
    s_pack_hh_b32_b16 s21, s36, s38
    s_pack_ll_b32_b16 s22, s37, s39
    s_pack_hh_b32_b16 s39, s37, s39
    s_mov_b32 s36, s20
    s_mov_b32 s37, s21
    s_mov_b32 s38, s22
    s_pack_ll_b32_b16 s20, s40, s42
    s_pack_hh_b32_b16 s21, s40, s42
    s_pack_ll_b32_b16 s22, s41, s43
    s_pack_hh_b32_b16 s43, s41, s43
    s_mov_b32 s40, s20
    s_mov_b32 s41, s21
    s_mov_b32 s42, s22
    s_pack_ll_b32_b16 s20, s44, s46
    s_pack_hh_b32_b16 s21, s44, s46
    s_pack_ll_b32_b16 s22, s45, s47
    s_pack_hh_b32_b16 s47, s45, s47
    s_mov_b32 s44, s20
    s_mov_b32 s45, s21
    s_mov_b32 s46, s22
    s_pack_ll_b32_b16 s20, s48, s50
    s_pack_hh_b32_b16 s21, s48, s50
    s_pack_ll_b32_b16 s22, s49, s51
    s_pack_hh_b32_b16 s51, s49, s51
    s_mov_b32 s48, s20
    s_mov_b32 s49, s21
    s_mov_b32 s50, s22
    s_pack_ll_b32_b16 s20, s52, s54
    s_pack_hh_b32_b16 s21, s52, s54
    s_pack_ll_b32_b16 s22, s53, s55
    s_pack_hh_b32_b16 s55, s53, s55
    s_mov_b32 s52, s20
    s_mov_b32 s53, s21
    s_mov_b32 s54, s22
    s_pack_ll_b32_b16 s20, s56, s58
    s_pack_hh_b32_b16 s21, s56, s58
    s_pack_ll_b32_b16 s22, s57, s59
    s_pack_hh_b32_b16 s59, s57, s59
    s_mov_b32 s56, s20
    s_mov_b32 s57, s21
    s_mov_b32 s58, s22
    s_pack_ll_b32_b16 s20, s60, s62
    s_pack_hh_b32_b16 s21, s60, s62
    s_pack_ll_b32_b16 s22, s61, s63
    s_pack_hh_b32_b16 s63, s61, s63
    s_mov_b32 s60, s20
    s_mov_b32 s61, s21
    s_mov_b32 s62, s22
    s_and_b32 s79, s71, 0xffff0000
    s_lshl_b32 s78, s71, 16
    s_and_b32 s77, s70, 0xffff0000
    s_lshl_b32 s76, s70, 16
    s_and_b32 s75, s69, 0xffff0000
    s_lshl_b32 s74, s69, 16
    s_and_b32 s73, s68, 0xffff0000
    s_lshl_b32 s72, s68, 16
    s_and_b32 s71, s67, 0xffff0000
    s_lshl_b32 s70, s67, 16
    s_and_b32 s69, s66, 0xffff0000
    s_lshl_b32 s68, s66, 16
    s_and_b32 s67, s65, 0xffff0000
    s_lshl_b32 s66, s65, 16
    s_and_b32 s65, s64, 0xffff0000
    s_lshl_b32 s64, s64, 16
    s_and_b32 s95, s87, 0xffff0000
    s_lshl_b32 s94, s87, 16
    s_and_b32 s93, s86, 0xffff0000
    s_lshl_b32 s92, s86, 16
    s_and_b32 s91, s85, 0xffff0000
    s_lshl_b32 s90, s85, 16
    s_and_b32 s89, s84, 0xffff0000
    s_lshl_b32 s88, s84, 16
    s_and_b32 s87, s83, 0xffff0000
    s_lshl_b32 s86, s83, 16
    s_and_b32 s85, s82, 0xffff0000
    s_lshl_b32 s84, s82, 16
    s_and_b32 s83, s81, 0xffff0000
    s_lshl_b32 s82, s81, 16
    s_and_b32 s81, s80, 0xffff0000
    s_lshl_b32 s80, s80, 16
    s_lshl_b32 s20, s96, 16
    s_and_b32 s21, s96, 0xffff0000
    s_lshl_b32 s22, s97, 16
    s_and_b32 s23, s97, 0xffff0000
    s_lshl_b32 s24, s98, 16
    s_and_b32 s25, s98, 0xffff0000
    s_lshl_b32 s26, s99, 16
    s_and_b32 s27, s99, 0xffff0000
    s_waitcnt vmcnt(6)
    v_and_b32 v5, 0xffff0000, v4
    v_lshlrev_b32 v4, 16, v4
    v_subrev_f32 v32, s20, v4
    v_subrev_f32 v33, s21, v4
    v_subrev_f32 v34, s22, v4
    v_subrev_f32 v35, s23, v4
    v_subrev_f32 v36, s24, v4
    v_subrev_f32 v37, s25, v4
    v_subrev_f32 v38, s26, v4
    v_subrev_f32 v39, s27, v4
    v_cvt_pk_bf16_f32 v6, v32, v33
    v_lshlrev_b32 v32, 16, v6
    v_and_b32 v33, 0xffff0000, v6
    v_cvt_pk_bf16_f32 v6, v34, v35
    v_lshlrev_b32 v34, 16, v6
    v_and_b32 v35, 0xffff0000, v6
    v_cvt_pk_bf16_f32 v6, v36, v37
    v_lshlrev_b32 v36, 16, v6
    v_and_b32 v37, 0xffff0000, v6
    v_cvt_pk_bf16_f32 v6, v38, v39
    v_lshlrev_b32 v38, 16, v6
    v_and_b32 v39, 0xffff0000, v6
    v_mul_f32 v32, v32, v32
    v_mul_f32 v33, v33, v33
    v_mul_f32 v34, v34, v34
    v_mul_f32 v35, v35, v35
    v_mul_f32 v36, v36, v36
    v_mul_f32 v37, v37, v37
    v_mul_f32 v38, v38, v38
    v_mul_f32 v39, v39, v39
    v_cvt_pk_bf16_f32 v6, v32, v33
    v_lshlrev_b32 v32, 16, v6
    v_and_b32 v33, 0xffff0000, v6
    v_cvt_pk_bf16_f32 v6, v34, v35
    v_lshlrev_b32 v34, 16, v6
    v_and_b32 v35, 0xffff0000, v6
    v_cvt_pk_bf16_f32 v6, v36, v37
    v_lshlrev_b32 v36, 16, v6
    v_and_b32 v37, 0xffff0000, v6
    v_cvt_pk_bf16_f32 v6, v38, v39
    v_lshlrev_b32 v38, 16, v6
    v_and_b32 v39, 0xffff0000, v6
    v_mul_f32 v32, 0xc1200000, v32
    v_mul_f32 v33, 0xc1200000, v33
    v_mul_f32 v34, 0xc1200000, v34
    v_mul_f32 v35, 0xc1200000, v35
    v_mul_f32 v36, 0xc1200000, v36
    v_mul_f32 v37, 0xc1200000, v37
    v_mul_f32 v38, 0xc1200000, v38
    v_mul_f32 v39, 0xc1200000, v39
    v_cvt_pk_bf16_f32 v6, v32, v33
    v_lshlrev_b32 v32, 16, v6
    v_and_b32 v33, 0xffff0000, v6
    v_cvt_pk_bf16_f32 v6, v34, v35
    v_lshlrev_b32 v34, 16, v6
    v_and_b32 v35, 0xffff0000, v6
    v_cvt_pk_bf16_f32 v6, v36, v37
    v_lshlrev_b32 v36, 16, v6
    v_and_b32 v37, 0xffff0000, v6
    v_cvt_pk_bf16_f32 v6, v38, v39
    v_lshlrev_b32 v38, 16, v6
    v_and_b32 v39, 0xffff0000, v6
    v_mul_f32 v32, 0x3fb8aa3b, v32
    v_mul_f32 v33, 0x3fb8aa3b, v33
    v_mul_f32 v34, 0x3fb8aa3b, v34
    v_mul_f32 v35, 0x3fb8aa3b, v35
    v_mul_f32 v36, 0x3fb8aa3b, v36
    v_mul_f32 v37, 0x3fb8aa3b, v37
    v_mul_f32 v38, 0x3fb8aa3b, v38
    v_mul_f32 v39, 0x3fb8aa3b, v39
    v_exp_f32 v32, v32
    v_exp_f32 v33, v33
    v_exp_f32 v34, v34
    v_exp_f32 v35, v35
    v_exp_f32 v36, v36
    v_exp_f32 v37, v37
    v_exp_f32 v38, v38
    v_exp_f32 v39, v39
    v_cvt_pk_bf16_f32 v40, v32, v33
    v_cvt_pk_bf16_f32 v41, v34, v35
    v_cvt_pk_bf16_f32 v42, v36, v37
    v_cvt_pk_bf16_f32 v43, v38, v39
    v_dot2_f32_bf16 v44, v40, s32, 0
    v_dot2_f32_bf16 v45, v40, s33, 0
    v_dot2_f32_bf16 v46, v40, s34, 0
    v_dot2_f32_bf16 v47, v40, s35, 0
    v_dot2_f32_bf16 v48, v40, s48, 0
    v_dot2_f32_bf16 v49, v40, s49, 0
    v_dot2_f32_bf16 v50, v40, s50, 0
    v_dot2_f32_bf16 v51, v40, s51, 0
    v_dot2_f32_bf16 v44, v41, s36, v44
    v_dot2_f32_bf16 v45, v41, s37, v45
    v_dot2_f32_bf16 v46, v41, s38, v46
    v_dot2_f32_bf16 v47, v41, s39, v47
    v_dot2_f32_bf16 v48, v41, s52, v48
    v_dot2_f32_bf16 v49, v41, s53, v49
    v_dot2_f32_bf16 v50, v41, s54, v50
    v_dot2_f32_bf16 v51, v41, s55, v51
    v_dot2_f32_bf16 v44, v42, s40, v44
    v_dot2_f32_bf16 v45, v42, s41, v45
    v_dot2_f32_bf16 v46, v42, s42, v46
    v_dot2_f32_bf16 v47, v42, s43, v47
    v_dot2_f32_bf16 v48, v42, s56, v48
    v_dot2_f32_bf16 v49, v42, s57, v49
    v_dot2_f32_bf16 v50, v42, s58, v50
    v_dot2_f32_bf16 v51, v42, s59, v51
    v_dot2_f32_bf16 v44, v43, s44, v44
    v_dot2_f32_bf16 v45, v43, s45, v45
    v_dot2_f32_bf16 v46, v43, s46, v46
    v_dot2_f32_bf16 v47, v43, s47, v47
    v_dot2_f32_bf16 v48, v43, s60, v48
    v_dot2_f32_bf16 v49, v43, s61, v49
    v_dot2_f32_bf16 v50, v43, s62, v50
    v_dot2_f32_bf16 v51, v43, s63, v51
    v_subrev_f32 v32, s20, v5
    v_subrev_f32 v33, s21, v5
    v_subrev_f32 v34, s22, v5
    v_subrev_f32 v35, s23, v5
    v_subrev_f32 v36, s24, v5
    v_subrev_f32 v37, s25, v5
    v_subrev_f32 v38, s26, v5
    v_subrev_f32 v39, s27, v5
    v_cvt_pk_bf16_f32 v6, v32, v33
    v_lshlrev_b32 v32, 16, v6
    v_and_b32 v33, 0xffff0000, v6
    v_cvt_pk_bf16_f32 v6, v34, v35
    v_lshlrev_b32 v34, 16, v6
    v_and_b32 v35, 0xffff0000, v6
    v_cvt_pk_bf16_f32 v6, v36, v37
    v_lshlrev_b32 v36, 16, v6
    v_and_b32 v37, 0xffff0000, v6
    v_cvt_pk_bf16_f32 v6, v38, v39
    v_lshlrev_b32 v38, 16, v6
    v_and_b32 v39, 0xffff0000, v6
    v_mul_f32 v32, v32, v32
    v_mul_f32 v33, v33, v33
    v_mul_f32 v34, v34, v34
    v_mul_f32 v35, v35, v35
    v_mul_f32 v36, v36, v36
    v_mul_f32 v37, v37, v37
    v_mul_f32 v38, v38, v38
    v_mul_f32 v39, v39, v39
    v_cvt_pk_bf16_f32 v6, v32, v33
    v_lshlrev_b32 v32, 16, v6
    v_and_b32 v33, 0xffff0000, v6
    v_cvt_pk_bf16_f32 v6, v34, v35
    v_lshlrev_b32 v34, 16, v6
    v_and_b32 v35, 0xffff0000, v6
    v_cvt_pk_bf16_f32 v6, v36, v37
    v_lshlrev_b32 v36, 16, v6
    v_and_b32 v37, 0xffff0000, v6
    v_cvt_pk_bf16_f32 v6, v38, v39
    v_lshlrev_b32 v38, 16, v6
    v_and_b32 v39, 0xffff0000, v6
    v_mul_f32 v32, 0xc1200000, v32
    v_mul_f32 v33, 0xc1200000, v33
    v_mul_f32 v34, 0xc1200000, v34
    v_mul_f32 v35, 0xc1200000, v35
    v_mul_f32 v36, 0xc1200000, v36
    v_mul_f32 v37, 0xc1200000, v37
    v_mul_f32 v38, 0xc1200000, v38
    v_mul_f32 v39, 0xc1200000, v39
    v_cvt_pk_bf16_f32 v6, v32, v33
    v_lshlrev_b32 v32, 16, v6
    v_and_b32 v33, 0xffff0000, v6
    v_cvt_pk_bf16_f32 v6, v34, v35
    v_lshlrev_b32 v34, 16, v6
    v_and_b32 v35, 0xffff0000, v6
    v_cvt_pk_bf16_f32 v6, v36, v37
    v_lshlrev_b32 v36, 16, v6
    v_and_b32 v37, 0xffff0000, v6
    v_cvt_pk_bf16_f32 v6, v38, v39
    v_lshlrev_b32 v38, 16, v6
    v_and_b32 v39, 0xffff0000, v6
    v_mul_f32 v32, 0x3fb8aa3b, v32
    v_mul_f32 v33, 0x3fb8aa3b, v33
    v_mul_f32 v34, 0x3fb8aa3b, v34
    v_mul_f32 v35, 0x3fb8aa3b, v35
    v_mul_f32 v36, 0x3fb8aa3b, v36
    v_mul_f32 v37, 0x3fb8aa3b, v37
    v_mul_f32 v38, 0x3fb8aa3b, v38
    v_mul_f32 v39, 0x3fb8aa3b, v39
    v_exp_f32 v32, v32
    v_exp_f32 v33, v33
    v_exp_f32 v34, v34
    v_exp_f32 v35, v35
    v_exp_f32 v36, v36
    v_exp_f32 v37, v37
    v_exp_f32 v38, v38
    v_exp_f32 v39, v39
    v_cvt_pk_bf16_f32 v40, v32, v33
    v_cvt_pk_bf16_f32 v41, v34, v35
    v_cvt_pk_bf16_f32 v42, v36, v37
    v_cvt_pk_bf16_f32 v43, v38, v39
    v_dot2_f32_bf16 v52, v40, s32, 0
    v_dot2_f32_bf16 v53, v40, s33, 0
    v_dot2_f32_bf16 v54, v40, s34, 0
    v_dot2_f32_bf16 v55, v40, s35, 0
    v_dot2_f32_bf16 v56, v40, s48, 0
    v_dot2_f32_bf16 v57, v40, s49, 0
    v_dot2_f32_bf16 v58, v40, s50, 0
    v_dot2_f32_bf16 v59, v40, s51, 0
    v_dot2_f32_bf16 v52, v41, s36, v52
    v_dot2_f32_bf16 v53, v41, s37, v53
    v_dot2_f32_bf16 v54, v41, s38, v54
    v_dot2_f32_bf16 v55, v41, s39, v55
    v_dot2_f32_bf16 v56, v41, s52, v56
    v_dot2_f32_bf16 v57, v41, s53, v57
    v_dot2_f32_bf16 v58, v41, s54, v58
    v_dot2_f32_bf16 v59, v41, s55, v59
    v_dot2_f32_bf16 v52, v42, s40, v52
    v_dot2_f32_bf16 v53, v42, s41, v53
    v_dot2_f32_bf16 v54, v42, s42, v54
    v_dot2_f32_bf16 v55, v42, s43, v55
    v_dot2_f32_bf16 v56, v42, s56, v56
    v_dot2_f32_bf16 v57, v42, s57, v57
    v_dot2_f32_bf16 v58, v42, s58, v58
    v_dot2_f32_bf16 v59, v42, s59, v59
    v_dot2_f32_bf16 v52, v43, s44, v52
    v_dot2_f32_bf16 v53, v43, s45, v53
    v_dot2_f32_bf16 v54, v43, s46, v54
    v_dot2_f32_bf16 v55, v43, s47, v55
    v_dot2_f32_bf16 v56, v43, s60, v56
    v_dot2_f32_bf16 v57, v43, s61, v57
    v_dot2_f32_bf16 v58, v43, s62, v58
    v_dot2_f32_bf16 v59, v43, s63, v59
    s_waitcnt vmcnt(1)
    v_cvt_f32_u32_sdwa v40, v12 dst_sel:DWORD dst_unused:UNUSED_PAD src0_sel:WORD_0
    v_add_f32 v40, 3330277376, v40
    v_mul_f32 v32, v8, v40
    v_cvt_f32_u32_sdwa v41, v12 dst_sel:DWORD dst_unused:UNUSED_PAD src0_sel:WORD_1
    v_add_f32 v41, 3330277376, v41
    v_mul_f32 v33, v8, v41
    v_cvt_f32_u32_sdwa v42, v13 dst_sel:DWORD dst_unused:UNUSED_PAD src0_sel:WORD_0
    v_add_f32 v42, 3330277376, v42
    v_mul_f32 v34, v8, v42
    v_cvt_f32_u32_sdwa v43, v13 dst_sel:DWORD dst_unused:UNUSED_PAD src0_sel:WORD_1
    v_add_f32 v43, 3330277376, v43
    v_mul_f32 v35, v8, v43
    v_cvt_f32_u32_sdwa v40, v14 dst_sel:DWORD dst_unused:UNUSED_PAD src0_sel:WORD_0
    v_add_f32 v40, 3330277376, v40
    v_mul_f32 v36, v8, v40
    v_cvt_f32_u32_sdwa v41, v14 dst_sel:DWORD dst_unused:UNUSED_PAD src0_sel:WORD_1
    v_add_f32 v41, 3330277376, v41
    v_mul_f32 v37, v8, v41
    v_cvt_f32_u32_sdwa v42, v15 dst_sel:DWORD dst_unused:UNUSED_PAD src0_sel:WORD_0
    v_add_f32 v42, 3330277376, v42
    v_mul_f32 v38, v8, v42
    v_cvt_f32_u32_sdwa v43, v15 dst_sel:DWORD dst_unused:UNUSED_PAD src0_sel:WORD_1
    v_add_f32 v43, 3330277376, v43
    v_mul_f32 v39, v8, v43
    v_cvt_f32_u32_sdwa v40, v16 dst_sel:DWORD dst_unused:UNUSED_PAD src0_sel:WORD_0
    v_add_f32 v40, 3330277376, v40
    v_fmac_f32 v32, v9, v40
    v_cvt_f32_u32_sdwa v41, v16 dst_sel:DWORD dst_unused:UNUSED_PAD src0_sel:WORD_1
    v_add_f32 v41, 3330277376, v41
    v_fmac_f32 v33, v9, v41
    v_cvt_f32_u32_sdwa v42, v17 dst_sel:DWORD dst_unused:UNUSED_PAD src0_sel:WORD_0
    v_add_f32 v42, 3330277376, v42
    v_fmac_f32 v34, v9, v42
    v_cvt_f32_u32_sdwa v43, v17 dst_sel:DWORD dst_unused:UNUSED_PAD src0_sel:WORD_1
    v_add_f32 v43, 3330277376, v43
    v_fmac_f32 v35, v9, v43
    v_cvt_f32_u32_sdwa v40, v18 dst_sel:DWORD dst_unused:UNUSED_PAD src0_sel:WORD_0
    v_add_f32 v40, 3330277376, v40
    v_fmac_f32 v36, v9, v40
    v_cvt_f32_u32_sdwa v41, v18 dst_sel:DWORD dst_unused:UNUSED_PAD src0_sel:WORD_1
    v_add_f32 v41, 3330277376, v41
    v_fmac_f32 v37, v9, v41
    v_cvt_f32_u32_sdwa v42, v19 dst_sel:DWORD dst_unused:UNUSED_PAD src0_sel:WORD_0
    v_add_f32 v42, 3330277376, v42
    v_fmac_f32 v38, v9, v42
    v_cvt_f32_u32_sdwa v43, v19 dst_sel:DWORD dst_unused:UNUSED_PAD src0_sel:WORD_1
    v_add_f32 v43, 3330277376, v43
    v_fmac_f32 v39, v9, v43
    v_cvt_f32_u32_sdwa v40, v20 dst_sel:DWORD dst_unused:UNUSED_PAD src0_sel:WORD_0
    v_add_f32 v40, 3330277376, v40
    v_fmac_f32 v32, v10, v40
    v_cvt_f32_u32_sdwa v41, v20 dst_sel:DWORD dst_unused:UNUSED_PAD src0_sel:WORD_1
    v_add_f32 v41, 3330277376, v41
    v_fmac_f32 v33, v10, v41
    v_cvt_f32_u32_sdwa v42, v21 dst_sel:DWORD dst_unused:UNUSED_PAD src0_sel:WORD_0
    v_add_f32 v42, 3330277376, v42
    v_fmac_f32 v34, v10, v42
    v_cvt_f32_u32_sdwa v43, v21 dst_sel:DWORD dst_unused:UNUSED_PAD src0_sel:WORD_1
    v_add_f32 v43, 3330277376, v43
    v_fmac_f32 v35, v10, v43
    v_cvt_f32_u32_sdwa v40, v22 dst_sel:DWORD dst_unused:UNUSED_PAD src0_sel:WORD_0
    v_add_f32 v40, 3330277376, v40
    v_fmac_f32 v36, v10, v40
    v_cvt_f32_u32_sdwa v41, v22 dst_sel:DWORD dst_unused:UNUSED_PAD src0_sel:WORD_1
    v_add_f32 v41, 3330277376, v41
    v_fmac_f32 v37, v10, v41
    v_cvt_f32_u32_sdwa v42, v23 dst_sel:DWORD dst_unused:UNUSED_PAD src0_sel:WORD_0
    v_add_f32 v42, 3330277376, v42
    v_fmac_f32 v38, v10, v42
    v_cvt_f32_u32_sdwa v43, v23 dst_sel:DWORD dst_unused:UNUSED_PAD src0_sel:WORD_1
    v_add_f32 v43, 3330277376, v43
    v_fmac_f32 v39, v10, v43
    v_cvt_f32_u32_sdwa v40, v24 dst_sel:DWORD dst_unused:UNUSED_PAD src0_sel:WORD_0
    v_add_f32 v40, 3330277376, v40
    v_fmac_f32 v32, v11, v40
    v_cvt_f32_u32_sdwa v41, v24 dst_sel:DWORD dst_unused:UNUSED_PAD src0_sel:WORD_1
    v_add_f32 v41, 3330277376, v41
    v_fmac_f32 v33, v11, v41
    v_cvt_f32_u32_sdwa v42, v25 dst_sel:DWORD dst_unused:UNUSED_PAD src0_sel:WORD_0
    v_add_f32 v42, 3330277376, v42
    v_fmac_f32 v34, v11, v42
    v_cvt_f32_u32_sdwa v43, v25 dst_sel:DWORD dst_unused:UNUSED_PAD src0_sel:WORD_1
    v_add_f32 v43, 3330277376, v43
    v_fmac_f32 v35, v11, v43
    v_cvt_f32_u32_sdwa v40, v26 dst_sel:DWORD dst_unused:UNUSED_PAD src0_sel:WORD_0
    v_add_f32 v40, 3330277376, v40
    v_fmac_f32 v36, v11, v40
    v_cvt_f32_u32_sdwa v41, v26 dst_sel:DWORD dst_unused:UNUSED_PAD src0_sel:WORD_1
    v_add_f32 v41, 3330277376, v41
    v_fmac_f32 v37, v11, v41
    v_cvt_f32_u32_sdwa v42, v27 dst_sel:DWORD dst_unused:UNUSED_PAD src0_sel:WORD_0
    v_add_f32 v42, 3330277376, v42
    v_fmac_f32 v38, v11, v42
    v_cvt_f32_u32_sdwa v43, v27 dst_sel:DWORD dst_unused:UNUSED_PAD src0_sel:WORD_1
    v_add_f32 v43, 3330277376, v43
    v_fmac_f32 v39, v11, v43
    v_min_u32 v6, v8, v9
    v_min3_u32 v6, v6, v10, v11
    v_cmp_eq_u32 vcc, 0, v6
    s_nop 1
    s_cbranch_vccz L_p3_fast
    v_lshlrev_b32 v7, 5, v0
    v_cmp_eq_u32 vcc, 0, v8
    s_nop 1
    s_and_b64 exec, exec, vcc
    s_cbranch_execz L_p3_kernel_q_1
    s_mov_b32 s3, 280453632
    buffer_load_dwordx4 v[12:15], v7, s[4:7], s3 offen
    buffer_load_dwordx4 v[16:19], v7, s[4:7], s3 offen offset:16
    s_waitcnt vmcnt(0)
    v_add_f32 v32, v32, v12
    v_add_f32 v33, v33, v13
    v_add_f32 v34, v34, v14
    v_add_f32 v35, v35, v15
    v_add_f32 v36, v36, v16
    v_add_f32 v37, v37, v17
    v_add_f32 v38, v38, v18
    v_add_f32 v39, v39, v19
L_p3_kernel_q_1:
    s_mov_b64 exec, -1
    v_cmp_eq_u32 vcc, 0, v9
    s_nop 1
    s_and_b64 exec, exec, vcc
    s_cbranch_execz L_p3_kernel_q_2
    s_mov_b32 s3, 290693632
    buffer_load_dwordx4 v[12:15], v7, s[4:7], s3 offen
    buffer_load_dwordx4 v[16:19], v7, s[4:7], s3 offen offset:16
    s_waitcnt vmcnt(0)
    v_add_f32 v32, v32, v12
    v_add_f32 v33, v33, v13
    v_add_f32 v34, v34, v14
    v_add_f32 v35, v35, v15
    v_add_f32 v36, v36, v16
    v_add_f32 v37, v37, v17
    v_add_f32 v38, v38, v18
    v_add_f32 v39, v39, v19
L_p3_kernel_q_2:
    s_mov_b64 exec, -1
    v_cmp_eq_u32 vcc, 0, v10
    s_nop 1
    s_and_b64 exec, exec, vcc
    s_cbranch_execz L_p3_kernel_q_3
    s_mov_b32 s3, 300933632
    buffer_load_dwordx4 v[12:15], v7, s[4:7], s3 offen
    buffer_load_dwordx4 v[16:19], v7, s[4:7], s3 offen offset:16
    s_waitcnt vmcnt(0)
    v_add_f32 v32, v32, v12
    v_add_f32 v33, v33, v13
    v_add_f32 v34, v34, v14
    v_add_f32 v35, v35, v15
    v_add_f32 v36, v36, v16
    v_add_f32 v37, v37, v17
    v_add_f32 v38, v38, v18
    v_add_f32 v39, v39, v19
L_p3_kernel_q_3:
    s_mov_b64 exec, -1
    v_cmp_eq_u32 vcc, 0, v11
    s_nop 1
    s_and_b64 exec, exec, vcc
    s_cbranch_execz L_p3_kernel_q_4
    s_mov_b32 s3, 311173632
    buffer_load_dwordx4 v[12:15], v7, s[4:7], s3 offen
    buffer_load_dwordx4 v[16:19], v7, s[4:7], s3 offen offset:16
    s_waitcnt vmcnt(0)
    v_add_f32 v32, v32, v12
    v_add_f32 v33, v33, v13
    v_add_f32 v34, v34, v14
    v_add_f32 v35, v35, v15
    v_add_f32 v36, v36, v16
    v_add_f32 v37, v37, v17
    v_add_f32 v38, v38, v18
    v_add_f32 v39, v39, v19
L_p3_kernel_q_4:
    s_mov_b64 exec, -1
L_p3_fast:
    s_waitcnt vmcnt(0)
    v_mul_f32 v12, s64, v32
    v_mul_f32 v13, s65, v32
    v_mul_f32 v14, s66, v32
    v_mul_f32 v15, s67, v32
    v_fmac_f32 v12, s68, v33
    v_fmac_f32 v13, s69, v33
    v_fmac_f32 v14, s70, v33
    v_fmac_f32 v15, s71, v33
    v_fmac_f32 v12, s72, v34
    v_fmac_f32 v13, s73, v34
    v_fmac_f32 v14, s74, v34
    v_fmac_f32 v15, s75, v34
    v_fmac_f32 v12, s76, v35
    v_fmac_f32 v13, s77, v35
    v_fmac_f32 v14, s78, v35
    v_fmac_f32 v15, s79, v35
    v_mul_f32 v12, v12, v48
    v_mul_f32 v13, v13, v49
    v_mul_f32 v14, v14, v50
    v_mul_f32 v15, v15, v51
    v_mul_f32 v16, s80, v12
    v_mul_f32 v17, s81, v12
    v_mul_f32 v18, s82, v12
    v_mul_f32 v19, s83, v12
    v_fmac_f32 v16, s84, v13
    v_fmac_f32 v17, s85, v13
    v_fmac_f32 v18, s86, v13
    v_fmac_f32 v19, s87, v13
    v_fmac_f32 v16, s88, v14
    v_fmac_f32 v17, s89, v14
    v_fmac_f32 v18, s90, v14
    v_fmac_f32 v19, s91, v14
    v_fmac_f32 v16, s92, v15
    v_fmac_f32 v17, s93, v15
    v_fmac_f32 v18, s94, v15
    v_fmac_f32 v19, s95, v15
    v_lshlrev_b32 v20, 16, v28
    v_and_b32 v21, 0xffff0000, v28
    v_lshlrev_b32 v22, 16, v29
    v_and_b32 v23, 0xffff0000, v29
    v_fmac_f32 v20, v16, v44
    v_fmac_f32 v21, v17, v45
    v_fmac_f32 v22, v18, v46
    v_fmac_f32 v23, v19, v47
    v_cvt_pk_bf16_f32 v28, v20, v21
    v_cvt_pk_bf16_f32 v29, v22, v23
    v_mul_f32 v12, s64, v36
    v_mul_f32 v13, s65, v36
    v_mul_f32 v14, s66, v36
    v_mul_f32 v15, s67, v36
    v_fmac_f32 v12, s68, v37
    v_fmac_f32 v13, s69, v37
    v_fmac_f32 v14, s70, v37
    v_fmac_f32 v15, s71, v37
    v_fmac_f32 v12, s72, v38
    v_fmac_f32 v13, s73, v38
    v_fmac_f32 v14, s74, v38
    v_fmac_f32 v15, s75, v38
    v_fmac_f32 v12, s76, v39
    v_fmac_f32 v13, s77, v39
    v_fmac_f32 v14, s78, v39
    v_fmac_f32 v15, s79, v39
    v_mul_f32 v12, v12, v56
    v_mul_f32 v13, v13, v57
    v_mul_f32 v14, v14, v58
    v_mul_f32 v15, v15, v59
    v_mul_f32 v16, s80, v12
    v_mul_f32 v17, s81, v12
    v_mul_f32 v18, s82, v12
    v_mul_f32 v19, s83, v12
    v_fmac_f32 v16, s84, v13
    v_fmac_f32 v17, s85, v13
    v_fmac_f32 v18, s86, v13
    v_fmac_f32 v19, s87, v13
    v_fmac_f32 v16, s88, v14
    v_fmac_f32 v17, s89, v14
    v_fmac_f32 v18, s90, v14
    v_fmac_f32 v19, s91, v14
    v_fmac_f32 v16, s92, v15
    v_fmac_f32 v17, s93, v15
    v_fmac_f32 v18, s94, v15
    v_fmac_f32 v19, s95, v15
    v_lshlrev_b32 v20, 16, v30
    v_and_b32 v21, 0xffff0000, v30
    v_lshlrev_b32 v22, 16, v31
    v_and_b32 v23, 0xffff0000, v31
    v_fmac_f32 v20, v16, v52
    v_fmac_f32 v21, v17, v53
    v_fmac_f32 v22, v18, v54
    v_fmac_f32 v23, v19, v55
    v_cvt_pk_bf16_f32 v30, v20, v21
    v_cvt_pk_bf16_f32 v31, v22, v23
    buffer_store_dwordx4 v[28:31], v1, s[16:19], 0 offen
L_p3_end:
    s_endpgm
.section .rodata,"a"
.p2align 6
.amdhsa_kernel p1_kernel
  .amdhsa_next_free_vgpr 128
  .amdhsa_next_free_sgpr 96
  .amdhsa_accum_offset 128
  .amdhsa_group_segment_fixed_size 0
  .amdhsa_kernarg_size 112
  .amdhsa_user_sgpr_count 2
  .amdhsa_user_sgpr_kernarg_segment_ptr 1
  .amdhsa_system_sgpr_workgroup_id_x 1
  .amdhsa_float_denorm_mode_32 0
.end_amdhsa_kernel
.p2align 6
.amdhsa_kernel p2_kernel
  .amdhsa_next_free_vgpr 128
  .amdhsa_next_free_sgpr 102
  .amdhsa_accum_offset 128
  .amdhsa_group_segment_fixed_size 0
  .amdhsa_kernarg_size 112
  .amdhsa_user_sgpr_count 2
  .amdhsa_user_sgpr_kernarg_segment_ptr 1
  .amdhsa_system_sgpr_workgroup_id_x 1
  .amdhsa_float_denorm_mode_32 0
.end_amdhsa_kernel
.p2align 6
.amdhsa_kernel p3_kernel
  .amdhsa_next_free_vgpr 64
  .amdhsa_next_free_sgpr 102
  .amdhsa_accum_offset 64
  .amdhsa_group_segment_fixed_size 0
  .amdhsa_kernarg_size 112
  .amdhsa_user_sgpr_count 2
  .amdhsa_user_sgpr_kernarg_segment_ptr 1
  .amdhsa_system_sgpr_workgroup_id_x 1
  .amdhsa_float_denorm_mode_32 0
.end_amdhsa_kernel
```

```asm
; @launch kernel=p1_kernel grid=(256,1,1) block=(1024,1,1) lds=163840
; @launch kernel=p2_kernel grid=(256,1,1) block=(1024,1,1) lds=163840
; @launch kernel=p3_kernel grid=(1250,1,1) block=(256,1,1) lds=0
.amdgcn_target "amdgcn-amd-amdhsa--gfx950"
.text
.globl p1_kernel
.p2align 8
.type p1_kernel,@function
p1_kernel:
    s_cmp_ge_u32 s2, 256
    s_cbranch_scc1 L_p1_end
    s_load_dwordx2 s[4:5], s[0:1], 104
    s_load_dwordx2 s[8:9], s[0:1], 8
    s_load_dwordx2 s[12:13], s[0:1], 16
    s_load_dwordx2 s[16:17], s[0:1], 32
    s_load_dwordx2 s[28:29], s[0:1], 0
    s_load_dwordx2 s[6:7], s[0:1], 48
    v_lshlrev_b32 v1, 4, v0
    v_lshlrev_b32 v2, 3, v0
    v_lshrrev_b32 v6, 6, v0
    v_mul_u32_u24 v3, 1216, v6
    v_add_u32 v3, v3, v0
    v_mul_u32_u24 v3, 12, v3
    v_mov_b32 v4, 1
    v_mov_b32 v5, 0
    v_readfirstlane_b32 s39, v6
    v_cmp_gt_u32 vcc, 784, v0
    s_mov_b32 s32, s2
    s_lshl_b32 s33, s2, 14
    s_lshl_b32 s34, s2, 13
    s_mul_i32 s48, s2, 3840
    s_mul_i32 s49, s2, 1920
    s_mov_b64 s[44:45], vcc
    s_waitcnt lgkmcnt(0)
    s_load_dword s3, s[6:7], 0
    s_mov_b32 s10, 163840000
    s_mov_b32 s11, 0x00020000
    s_mov_b32 s14, 163840000
    s_mov_b32 s15, 0x00020000
    s_mov_b32 s18, 81920000
    s_mov_b32 s19, 0x00020000
    s_mul_i32 s36, s2, 20000
    s_add_u32 s30, s36, 20000
    s_mov_b32 s31, 0x00020000
    s_add_u32 s35, s36, 16384
    buffer_load_dwordx4 v[48:51], v1, s[28:31], s36 offen nt
    buffer_load_dwordx4 v[52:55], v1, s[28:31], s35 offen nt
    s_add_u32 s35, s33, 0
    buffer_load_dwordx4 v[16:19], v1, s[8:11], s35 offen nt
    s_add_u32 s35, s33, 0
    buffer_load_dwordx4 v[20:23], v1, s[12:15], s35 offen nt
    s_add_u32 s35, s33, 4194304
    buffer_load_dwordx4 v[24:27], v1, s[8:11], s35 offen nt
    s_add_u32 s35, s33, 4194304
    buffer_load_dwordx4 v[28:31], v1, s[12:15], s35 offen nt
    s_add_u32 s35, s33, 8388608
    buffer_load_dwordx4 v[32:35], v1, s[8:11], s35 offen nt
    s_add_u32 s35, s33, 8388608
    buffer_load_dwordx4 v[36:39], v1, s[12:15], s35 offen nt
    s_add_u32 s35, s33, 12582912
    buffer_load_dwordx4 v[40:43], v1, s[8:11], s35 offen nt
    s_add_u32 s35, s33, 12582912
    buffer_load_dwordx4 v[44:47], v1, s[12:15], s35 offen nt
    s_mov_b32 s20, s4
    s_mov_b32 s21, s5
    s_mov_b32 s22, 0
    s_mov_b32 s23, 0x00020000
    s_add_u32 s24, s4, 246292480
    s_addc_u32 s25, s5, 0
    s_mov_b32 s26, 8557056
    s_mov_b32 s27, 0x00020000
    s_mov_b32 s37, 1492179184
    s_mov_b32 s55, 0
    s_mov_b32 s38, 262400
    s_mov_b32 s43, 0x05040100
    s_mov_b32 s40, 0
    v_mov_b32 v8, 0
    v_mov_b32 v9, 0
    v_mov_b32 v10, 0
    v_mov_b32 v11, 0
    ds_write_b128 v1, v[8:11] offset:0
    s_waitcnt lgkmcnt(0)
    s_lshl_b32 s3, s3, 16
    v_mov_b32 v12, s3
    v_mul_f32 v12, 0.15915494, v12
    s_nop 0
    v_readfirstlane_b32 s41, v12
    s_waitcnt vmcnt(8)
    s_add_u32 s28, s4, 254853632
    s_addc_u32 s29, s5, 0
    s_mul_i32 s36, s2, 20000
    s_add_u32 s35, s36, 16384
    buffer_store_dwordx4 v[48:51], v1, s[28:31], s36 offen
    buffer_store_dwordx4 v[52:55], v1, s[28:31], s35 offen
    s_nop 0
    v_mov_b32 v12, 0x3f803f80
    v_and_b32 v48, 0x7fff7fff, v48
    v_and_b32 v49, 0x7fff7fff, v49
    v_and_b32 v50, 0x7fff7fff, v50
    v_and_b32 v51, 0x7fff7fff, v51
    v_and_b32 v52, 0x7fff7fff, v52
    v_and_b32 v53, 0x7fff7fff, v53
    v_and_b32 v54, 0x7fff7fff, v54
    v_and_b32 v55, 0x7fff7fff, v55
    v_pk_max_u16 v8, v8, v48
    v_dot2c_f32_bf16 v9, v48, v12
    v_pk_max_u16 v8, v8, v49
    v_dot2c_f32_bf16 v9, v49, v12
    v_pk_max_u16 v8, v8, v50
    v_dot2c_f32_bf16 v9, v50, v12
    v_pk_max_u16 v8, v8, v51
    v_dot2c_f32_bf16 v9, v51, v12
    v_pk_max_u16 v8, v8, v52
    v_dot2c_f32_bf16 v9, v52, v12
    v_pk_max_u16 v8, v8, v53
    v_dot2c_f32_bf16 v9, v53, v12
    v_pk_max_u16 v8, v8, v54
    v_dot2c_f32_bf16 v9, v54, v12
    v_pk_max_u16 v8, v8, v55
    v_dot2c_f32_bf16 v9, v55, v12
    v_lshrrev_b32 v10, 16, v8
    v_and_b32 v8, 0xffff, v8
    v_max_u32 v8, v8, v10
    s_nop 0
    s_nop 1
    v_max_u32_dpp v8, v8, v8 row_shr:1 row_mask:0xf bank_mask:0xf bound_ctrl:0
    s_nop 1
    v_max_u32_dpp v8, v8, v8 row_shr:2 row_mask:0xf bank_mask:0xf bound_ctrl:0
    s_nop 1
    v_max_u32_dpp v8, v8, v8 row_shr:4 row_mask:0xf bank_mask:0xf bound_ctrl:0
    s_nop 1
    v_max_u32_dpp v8, v8, v8 row_shr:8 row_mask:0xf bank_mask:0xf bound_ctrl:0
    s_nop 1
    v_max_u32_dpp v8, v8, v8 row_bcast:15 row_mask:0xa bank_mask:0xf
    s_nop 1
    v_max_u32_dpp v8, v8, v8 row_bcast:31 row_mask:0xc bank_mask:0xf
    s_nop 1
    v_add_f32_dpp v9, v9, v9 row_shr:1 row_mask:0xf bank_mask:0xf bound_ctrl:0
    s_nop 1
    v_add_f32_dpp v9, v9, v9 row_shr:2 row_mask:0xf bank_mask:0xf bound_ctrl:0
    s_nop 1
    v_add_f32_dpp v9, v9, v9 row_shr:4 row_mask:0xf bank_mask:0xf bound_ctrl:0
    s_nop 1
    v_add_f32_dpp v9, v9, v9 row_shr:8 row_mask:0xf bank_mask:0xf bound_ctrl:0
    s_nop 1
    v_add_f32_dpp v9, v9, v9 row_bcast:15 row_mask:0xa bank_mask:0xf
    s_nop 1
    v_add_f32_dpp v9, v9, v9 row_bcast:31 row_mask:0xc bank_mask:0xf
    s_lshl_b32 s35, s39, 4
    s_add_u32 s35, s35, 160320
    v_mov_b32 v10, s35
    s_mov_b32 exec_lo, 0
    s_brev_b32 exec_hi, 1
    ds_write_b64 v10, v[8:9]
    s_mov_b64 exec, -1
    s_waitcnt lgkmcnt(0)
    s_barrier
    s_branch L_p1_first
L_p1_loop:
    s_mov_b32 s36, 6144
    buffer_store_dwordx3 v[80:82], v3, s[20:23], s36 offen sc1
    s_mov_b32 s36, 6912
    buffer_store_dwordx3 v[84:86], v3, s[20:23], s36 offen sc1
    s_nop 0
    s_add_u32 s35, s33, 16777216
    buffer_load_dwordx4 v[80:83], v1, s[8:11], s35 offen nt
    s_add_u32 s35, s33, 16777216
    buffer_load_dwordx4 v[84:87], v1, s[12:15], s35 offen nt
    s_mov_b32 s36, 7680
    buffer_store_dwordx3 v[88:90], v3, s[20:23], s36 offen sc1
    s_mov_b32 s36, 8448
    buffer_store_dwordx3 v[92:94], v3, s[20:23], s36 offen sc1
    s_nop 0
    s_add_u32 s35, s33, 20971520
    buffer_load_dwordx4 v[88:91], v1, s[8:11], s35 offen nt
    s_add_u32 s35, s33, 20971520
    buffer_load_dwordx4 v[92:95], v1, s[12:15], s35 offen nt
    s_mov_b32 s36, 9216
    buffer_store_dwordx3 v[96:98], v3, s[20:23], s36 offen sc1
    s_mov_b32 s36, 9984
    buffer_store_dwordx3 v[100:102], v3, s[20:23], s36 offen sc1
    s_nop 0
    s_add_u32 s35, s33, 25165824
    buffer_load_dwordx4 v[96:99], v1, s[8:11], s35 offen nt
    s_add_u32 s35, s33, 25165824
    buffer_load_dwordx4 v[100:103], v1, s[12:15], s35 offen nt
    s_mov_b32 s36, 10752
    buffer_store_dwordx3 v[104:106], v3, s[20:23], s36 offen sc1
    s_mov_b32 s36, 11520
    buffer_store_dwordx3 v[108:110], v3, s[20:23], s36 offen sc1
    s_nop 0
    s_add_u32 s35, s33, 29360128
    buffer_load_dwordx4 v[104:107], v1, s[8:11], s35 offen nt
    s_add_u32 s35, s33, 29360128
    buffer_load_dwordx4 v[108:111], v1, s[12:15], s35 offen nt
    s_mov_b32 s36, 12288
    buffer_store_dwordx3 v[112:114], v3, s[20:23], s36 offen sc1
    s_mov_b32 s36, 13056
    buffer_store_dwordx3 v[116:118], v3, s[20:23], s36 offen sc1
    s_nop 0
    s_add_u32 s35, s33, 33554432
    buffer_load_dwordx4 v[112:115], v1, s[8:11], s35 offen nt
    s_add_u32 s35, s33, 33554432
    buffer_load_dwordx4 v[116:119], v1, s[12:15], s35 offen nt
    s_mov_b32 s36, 13824
    buffer_store_dwordx3 v[120:122], v3, s[20:23], s36 offen sc1
    s_mov_b32 s36, 14592
    buffer_store_dwordx3 v[124:126], v3, s[20:23], s36 offen sc1
    s_nop 0
    s_add_u32 s35, s33, 37748736
    s_sub_u32 s35, s35, s48
    s_mov_b64 exec, s[44:45]
    buffer_load_dwordx4 v[120:123], v1, s[8:11], s35 offen nt
    s_mov_b64 exec, -1
    s_add_u32 s35, s33, 37748736
    s_sub_u32 s35, s35, s48
    s_mov_b64 exec, s[44:45]
    buffer_load_dwordx4 v[124:127], v1, s[12:15], s35 offen nt
    s_mov_b64 exec, -1
    s_mov_b32 s36, 0
    buffer_store_dwordx3 v[48:50], v3, s[20:23], s36 offen sc1
    s_mov_b32 s36, 768
    buffer_store_dwordx3 v[52:54], v3, s[20:23], s36 offen sc1
    s_mov_b32 s36, 1536
    buffer_store_dwordx3 v[56:58], v3, s[20:23], s36 offen sc1
    s_mov_b32 s36, 2304
    buffer_store_dwordx3 v[60:62], v3, s[20:23], s36 offen sc1
    s_mov_b32 s36, 3072
    buffer_store_dwordx3 v[64:66], v3, s[20:23], s36 offen sc1
    s_mov_b32 s36, 3840
    buffer_store_dwordx3 v[68:70], v3, s[20:23], s36 offen sc1
    s_mov_b32 s36, 4608
    buffer_store_dwordx3 v[72:74], v3, s[20:23], s36 offen sc1
    s_mov_b32 s36, 5376
    buffer_store_dwordx3 v[76:78], v3, s[20:23], s36 offen sc1
    s_branch L_p1_join
L_p1_first:
    s_add_u32 s35, s33, 16777216
    buffer_load_dwordx4 v[80:83], v1, s[8:11], s35 offen nt
    s_add_u32 s35, s33, 16777216
    buffer_load_dwordx4 v[84:87], v1, s[12:15], s35 offen nt
    s_add_u32 s35, s33, 20971520
    buffer_load_dwordx4 v[88:91], v1, s[8:11], s35 offen nt
    s_add_u32 s35, s33, 20971520
    buffer_load_dwordx4 v[92:95], v1, s[12:15], s35 offen nt
    s_add_u32 s35, s33, 25165824
    buffer_load_dwordx4 v[96:99], v1, s[8:11], s35 offen nt
    s_add_u32 s35, s33, 25165824
    buffer_load_dwordx4 v[100:103], v1, s[12:15], s35 offen nt
    s_add_u32 s35, s33, 29360128
    buffer_load_dwordx4 v[104:107], v1, s[8:11], s35 offen nt
    s_add_u32 s35, s33, 29360128
    buffer_load_dwordx4 v[108:111], v1, s[12:15], s35 offen nt
    s_add_u32 s35, s33, 33554432
    buffer_load_dwordx4 v[112:115], v1, s[8:11], s35 offen nt
    s_add_u32 s35, s33, 33554432
    buffer_load_dwordx4 v[116:119], v1, s[12:15], s35 offen nt
    s_add_u32 s35, s33, 37748736
    s_sub_u32 s35, s35, s48
    s_mov_b64 exec, s[44:45]
    buffer_load_dwordx4 v[120:123], v1, s[8:11], s35 offen nt
    s_mov_b64 exec, -1
    s_add_u32 s35, s33, 37748736
    s_sub_u32 s35, s35, s48
    s_mov_b64 exec, s[44:45]
    buffer_load_dwordx4 v[124:127], v1, s[12:15], s35 offen nt
    s_mov_b64 exec, -1
L_p1_join:
    s_waitcnt vmcnt(18)
    v_perm_b32 v6, v20, v16, s43
    v_perm_b32 v7, v21, v17, s43
    v_perm_b32 v8, v22, v18, s43
    v_perm_b32 v9, v23, v19, s43
    v_mul_hi_u32_u24 v16, 429497, v16
    v_mul_hi_u32_u24 v20, 429497, v20
    v_mul_hi_u32_u24 v17, 429497, v17
    v_mul_hi_u32_u24 v21, 429497, v21
    v_mul_hi_u32_u24 v18, 429497, v18
    v_mul_hi_u32_u24 v22, 429497, v22
    v_mul_hi_u32_u24 v19, 429497, v19
    v_mul_hi_u32_u24 v23, 429497, v23
    v_lshl_or_b32 v16, v20, 16, v16
    v_lshl_or_b32 v17, v21, 16, v17
    v_lshl_or_b32 v18, v22, 16, v18
    v_lshl_or_b32 v19, v23, 16, v19
    v_dot2_u32_u16 v20, v16, s38, 0
    v_dot2_u32_u16 v21, v17, s38, 0
    v_dot2_u32_u16 v22, v18, s38, 0
    v_dot2_u32_u16 v23, v19, s38, 0
    v_pk_mad_u16 v6, v16, s37, v6
    v_pk_mad_u16 v7, v17, s37, v7
    v_pk_mad_u16 v8, v18, s37, v8
    v_pk_mad_u16 v9, v19, s37, v9
    ds_add_u32 v20, v4 offset:0
    ds_add_u32 v21, v4 offset:0
    ds_add_u32 v22, v4 offset:0
    ds_add_u32 v23, v4 offset:0
    v_perm_b32 v55, v23, v22, s43
    v_perm_b32 v54, v21, v20, s43
    v_or_b32 v48, 0x40000000, v6
    v_or_b32 v49, 0x40000000, v7
    v_or_b32 v52, 0x40000000, v8
    v_or_b32 v53, 0x40000000, v9
    s_waitcnt vmcnt(16)
    v_perm_b32 v6, v28, v24, s43
    v_perm_b32 v7, v29, v25, s43
    v_perm_b32 v8, v30, v26, s43
    v_perm_b32 v9, v31, v27, s43
    v_mul_hi_u32_u24 v24, 429497, v24
    v_mul_hi_u32_u24 v28, 429497, v28
    v_mul_hi_u32_u24 v25, 429497, v25
    v_mul_hi_u32_u24 v29, 429497, v29
    v_mul_hi_u32_u24 v26, 429497, v26
    v_mul_hi_u32_u24 v30, 429497, v30
    v_mul_hi_u32_u24 v27, 429497, v27
    v_mul_hi_u32_u24 v31, 429497, v31
    v_lshl_or_b32 v24, v28, 16, v24
    v_lshl_or_b32 v25, v29, 16, v25
    v_lshl_or_b32 v26, v30, 16, v26
    v_lshl_or_b32 v27, v31, 16, v27
    v_dot2_u32_u16 v28, v24, s38, 0
    v_dot2_u32_u16 v29, v25, s38, 0
    v_dot2_u32_u16 v30, v26, s38, 0
    v_dot2_u32_u16 v31, v27, s38, 0
    v_pk_mad_u16 v6, v24, s37, v6
    v_pk_mad_u16 v7, v25, s37, v7
    v_pk_mad_u16 v8, v26, s37, v8
    v_pk_mad_u16 v9, v27, s37, v9
    ds_add_u32 v28, v4 offset:0
    ds_add_u32 v29, v4 offset:0
    ds_add_u32 v30, v4 offset:0
    ds_add_u32 v31, v4 offset:0
    v_perm_b32 v63, v31, v30, s43
    v_perm_b32 v62, v29, v28, s43
    v_or_b32 v56, 0x40000000, v6
    v_or_b32 v57, 0x40000000, v7
    v_or_b32 v60, 0x40000000, v8
    v_or_b32 v61, 0x40000000, v9
    s_waitcnt vmcnt(14)
    v_perm_b32 v6, v36, v32, s43
    v_perm_b32 v7, v37, v33, s43
    v_perm_b32 v8, v38, v34, s43
    v_perm_b32 v9, v39, v35, s43
    v_mul_hi_u32_u24 v32, 429497, v32
    v_mul_hi_u32_u24 v36, 429497, v36
    v_mul_hi_u32_u24 v33, 429497, v33
    v_mul_hi_u32_u24 v37, 429497, v37
    v_mul_hi_u32_u24 v34, 429497, v34
    v_mul_hi_u32_u24 v38, 429497, v38
    v_mul_hi_u32_u24 v35, 429497, v35
    v_mul_hi_u32_u24 v39, 429497, v39
    v_lshl_or_b32 v32, v36, 16, v32
    v_lshl_or_b32 v33, v37, 16, v33
    v_lshl_or_b32 v34, v38, 16, v34
    v_lshl_or_b32 v35, v39, 16, v35
    v_dot2_u32_u16 v36, v32, s38, 0
    v_dot2_u32_u16 v37, v33, s38, 0
    v_dot2_u32_u16 v38, v34, s38, 0
    v_dot2_u32_u16 v39, v35, s38, 0
    v_pk_mad_u16 v6, v32, s37, v6
    v_pk_mad_u16 v7, v33, s37, v7
    v_pk_mad_u16 v8, v34, s37, v8
    v_pk_mad_u16 v9, v35, s37, v9
    ds_add_u32 v36, v4 offset:0
    ds_add_u32 v37, v4 offset:0
    ds_add_u32 v38, v4 offset:0
    ds_add_u32 v39, v4 offset:0
    v_perm_b32 v71, v39, v38, s43
    v_perm_b32 v70, v37, v36, s43
    v_or_b32 v64, 0x40000000, v6
    v_or_b32 v65, 0x40000000, v7
    v_or_b32 v68, 0x40000000, v8
    v_or_b32 v69, 0x40000000, v9
    s_waitcnt vmcnt(12)
    v_perm_b32 v6, v44, v40, s43
    v_perm_b32 v7, v45, v41, s43
    v_perm_b32 v8, v46, v42, s43
    v_perm_b32 v9, v47, v43, s43
    v_mul_hi_u32_u24 v40, 429497, v40
    v_mul_hi_u32_u24 v44, 429497, v44
    v_mul_hi_u32_u24 v41, 429497, v41
    v_mul_hi_u32_u24 v45, 429497, v45
    v_mul_hi_u32_u24 v42, 429497, v42
    v_mul_hi_u32_u24 v46, 429497, v46
    v_mul_hi_u32_u24 v43, 429497, v43
    v_mul_hi_u32_u24 v47, 429497, v47
    v_lshl_or_b32 v40, v44, 16, v40
    v_lshl_or_b32 v41, v45, 16, v41
    v_lshl_or_b32 v42, v46, 16, v42
    v_lshl_or_b32 v43, v47, 16, v43
    v_dot2_u32_u16 v44, v40, s38, 0
    v_dot2_u32_u16 v45, v41, s38, 0
    v_dot2_u32_u16 v46, v42, s38, 0
    v_dot2_u32_u16 v47, v43, s38, 0
    v_pk_mad_u16 v6, v40, s37, v6
    v_pk_mad_u16 v7, v41, s37, v7
    v_pk_mad_u16 v8, v42, s37, v8
    v_pk_mad_u16 v9, v43, s37, v9
    ds_add_u32 v44, v4 offset:0
    ds_add_u32 v45, v4 offset:0
    ds_add_u32 v46, v4 offset:0
    ds_add_u32 v47, v4 offset:0
    v_perm_b32 v79, v47, v46, s43
    v_perm_b32 v78, v45, v44, s43
    v_or_b32 v72, 0x40000000, v6
    v_or_b32 v73, 0x40000000, v7
    v_or_b32 v76, 0x40000000, v8
    v_or_b32 v77, 0x40000000, v9
    s_waitcnt vmcnt(10)
    v_perm_b32 v6, v84, v80, s43
    v_perm_b32 v7, v85, v81, s43
    v_perm_b32 v8, v86, v82, s43
    v_perm_b32 v9, v87, v83, s43
    v_mul_hi_u32_u24 v80, 429497, v80
    v_mul_hi_u32_u24 v84, 429497, v84
    v_mul_hi_u32_u24 v81, 429497, v81
    v_mul_hi_u32_u24 v85, 429497, v85
    v_mul_hi_u32_u24 v82, 429497, v82
    v_mul_hi_u32_u24 v86, 429497, v86
    v_mul_hi_u32_u24 v83, 429497, v83
    v_mul_hi_u32_u24 v87, 429497, v87
    v_lshl_or_b32 v80, v84, 16, v80
    v_lshl_or_b32 v81, v85, 16, v81
    v_lshl_or_b32 v82, v86, 16, v82
    v_lshl_or_b32 v83, v87, 16, v83
    v_dot2_u32_u16 v84, v80, s38, 0
    v_dot2_u32_u16 v85, v81, s38, 0
    v_dot2_u32_u16 v86, v82, s38, 0
    v_dot2_u32_u16 v87, v83, s38, 0
    v_pk_mad_u16 v6, v80, s37, v6
    v_pk_mad_u16 v7, v81, s37, v7
    v_pk_mad_u16 v8, v82, s37, v8
    v_pk_mad_u16 v9, v83, s37, v9
    ds_add_u32 v84, v4 offset:0
    ds_add_u32 v85, v4 offset:0
    ds_add_u32 v86, v4 offset:0
    ds_add_u32 v87, v4 offset:0
    v_perm_b32 v87, v87, v86, s43
    v_perm_b32 v86, v85, v84, s43
    v_or_b32 v80, 0x40000000, v6
    v_or_b32 v81, 0x40000000, v7
    v_or_b32 v84, 0x40000000, v8
    v_or_b32 v85, 0x40000000, v9
    s_waitcnt vmcnt(8)
    v_perm_b32 v6, v92, v88, s43
    v_perm_b32 v7, v93, v89, s43
    v_perm_b32 v8, v94, v90, s43
    v_perm_b32 v9, v95, v91, s43
    v_mul_hi_u32_u24 v88, 429497, v88
    v_mul_hi_u32_u24 v92, 429497, v92
    v_mul_hi_u32_u24 v89, 429497, v89
    v_mul_hi_u32_u24 v93, 429497, v93
    v_mul_hi_u32_u24 v90, 429497, v90
    v_mul_hi_u32_u24 v94, 429497, v94
    v_mul_hi_u32_u24 v91, 429497, v91
    v_mul_hi_u32_u24 v95, 429497, v95
    v_lshl_or_b32 v88, v92, 16, v88
    v_lshl_or_b32 v89, v93, 16, v89
    v_lshl_or_b32 v90, v94, 16, v90
    v_lshl_or_b32 v91, v95, 16, v91
    v_dot2_u32_u16 v92, v88, s38, 0
    v_dot2_u32_u16 v93, v89, s38, 0
    v_dot2_u32_u16 v94, v90, s38, 0
    v_dot2_u32_u16 v95, v91, s38, 0
    v_pk_mad_u16 v6, v88, s37, v6
    v_pk_mad_u16 v7, v89, s37, v7
    v_pk_mad_u16 v8, v90, s37, v8
    v_pk_mad_u16 v9, v91, s37, v9
    ds_add_u32 v92, v4 offset:0
    ds_add_u32 v93, v4 offset:0
    ds_add_u32 v94, v4 offset:0
    ds_add_u32 v95, v4 offset:0
    v_perm_b32 v95, v95, v94, s43
    v_perm_b32 v94, v93, v92, s43
    v_or_b32 v88, 0x40000000, v6
    v_or_b32 v89, 0x40000000, v7
    v_or_b32 v92, 0x40000000, v8
    v_or_b32 v93, 0x40000000, v9
    s_waitcnt vmcnt(6)
    v_perm_b32 v6, v100, v96, s43
    v_perm_b32 v7, v101, v97, s43
    v_perm_b32 v8, v102, v98, s43
    v_perm_b32 v9, v103, v99, s43
    v_mul_hi_u32_u24 v96, 429497, v96
    v_mul_hi_u32_u24 v100, 429497, v100
    v_mul_hi_u32_u24 v97, 429497, v97
    v_mul_hi_u32_u24 v101, 429497, v101
    v_mul_hi_u32_u24 v98, 429497, v98
    v_mul_hi_u32_u24 v102, 429497, v102
    v_mul_hi_u32_u24 v99, 429497, v99
    v_mul_hi_u32_u24 v103, 429497, v103
    v_lshl_or_b32 v96, v100, 16, v96
    v_lshl_or_b32 v97, v101, 16, v97
    v_lshl_or_b32 v98, v102, 16, v98
    v_lshl_or_b32 v99, v103, 16, v99
    v_dot2_u32_u16 v100, v96, s38, 0
    v_dot2_u32_u16 v101, v97, s38, 0
    v_dot2_u32_u16 v102, v98, s38, 0
    v_dot2_u32_u16 v103, v99, s38, 0
    v_pk_mad_u16 v6, v96, s37, v6
    v_pk_mad_u16 v7, v97, s37, v7
    v_pk_mad_u16 v8, v98, s37, v8
    v_pk_mad_u16 v9, v99, s37, v9
    ds_add_u32 v100, v4 offset:0
    ds_add_u32 v101, v4 offset:0
    ds_add_u32 v102, v4 offset:0
    ds_add_u32 v103, v4 offset:0
    v_perm_b32 v103, v103, v102, s43
    v_perm_b32 v102, v101, v100, s43
    v_or_b32 v96, 0x40000000, v6
    v_or_b32 v97, 0x40000000, v7
    v_or_b32 v100, 0x40000000, v8
    v_or_b32 v101, 0x40000000, v9
    s_waitcnt vmcnt(4)
    v_perm_b32 v6, v108, v104, s43
    v_perm_b32 v7, v109, v105, s43
    v_perm_b32 v8, v110, v106, s43
    v_perm_b32 v9, v111, v107, s43
    v_mul_hi_u32_u24 v104, 429497, v104
    v_mul_hi_u32_u24 v108, 429497, v108
    v_mul_hi_u32_u24 v105, 429497, v105
    v_mul_hi_u32_u24 v109, 429497, v109
    v_mul_hi_u32_u24 v106, 429497, v106
    v_mul_hi_u32_u24 v110, 429497, v110
    v_mul_hi_u32_u24 v107, 429497, v107
    v_mul_hi_u32_u24 v111, 429497, v111
    v_lshl_or_b32 v104, v108, 16, v104
    v_lshl_or_b32 v105, v109, 16, v105
    v_lshl_or_b32 v106, v110, 16, v106
    v_lshl_or_b32 v107, v111, 16, v107
    v_dot2_u32_u16 v108, v104, s38, 0
    v_dot2_u32_u16 v109, v105, s38, 0
    v_dot2_u32_u16 v110, v106, s38, 0
    v_dot2_u32_u16 v111, v107, s38, 0
    v_pk_mad_u16 v6, v104, s37, v6
    v_pk_mad_u16 v7, v105, s37, v7
    v_pk_mad_u16 v8, v106, s37, v8
    v_pk_mad_u16 v9, v107, s37, v9
    ds_add_u32 v108, v4 offset:0
    ds_add_u32 v109, v4 offset:0
    ds_add_u32 v110, v4 offset:0
    ds_add_u32 v111, v4 offset:0
    v_perm_b32 v111, v111, v110, s43
    v_perm_b32 v110, v109, v108, s43
    v_or_b32 v104, 0x40000000, v6
    v_or_b32 v105, 0x40000000, v7
    v_or_b32 v108, 0x40000000, v8
    v_or_b32 v109, 0x40000000, v9
    s_waitcnt vmcnt(2)
    v_perm_b32 v6, v116, v112, s43
    v_perm_b32 v7, v117, v113, s43
    v_perm_b32 v8, v118, v114, s43
    v_perm_b32 v9, v119, v115, s43
    v_mul_hi_u32_u24 v112, 429497, v112
    v_mul_hi_u32_u24 v116, 429497, v116
    v_mul_hi_u32_u24 v113, 429497, v113
    v_mul_hi_u32_u24 v117, 429497, v117
    v_mul_hi_u32_u24 v114, 429497, v114
    v_mul_hi_u32_u24 v118, 429497, v118
    v_mul_hi_u32_u24 v115, 429497, v115
    v_mul_hi_u32_u24 v119, 429497, v119
    v_lshl_or_b32 v112, v116, 16, v112
    v_lshl_or_b32 v113, v117, 16, v113
    v_lshl_or_b32 v114, v118, 16, v114
    v_lshl_or_b32 v115, v119, 16, v115
    v_dot2_u32_u16 v116, v112, s38, 0
    v_dot2_u32_u16 v117, v113, s38, 0
    v_dot2_u32_u16 v118, v114, s38, 0
    v_dot2_u32_u16 v119, v115, s38, 0
    v_pk_mad_u16 v6, v112, s37, v6
    v_pk_mad_u16 v7, v113, s37, v7
    v_pk_mad_u16 v8, v114, s37, v8
    v_pk_mad_u16 v9, v115, s37, v9
    ds_add_u32 v116, v4 offset:0
    ds_add_u32 v117, v4 offset:0
    ds_add_u32 v118, v4 offset:0
    ds_add_u32 v119, v4 offset:0
    v_perm_b32 v119, v119, v118, s43
    v_perm_b32 v118, v117, v116, s43
    v_or_b32 v112, 0x40000000, v6
    v_or_b32 v113, 0x40000000, v7
    v_or_b32 v116, 0x40000000, v8
    v_or_b32 v117, 0x40000000, v9
    s_waitcnt vmcnt(0)
    s_mov_b64 exec, s[44:45]
    v_perm_b32 v6, v124, v120, s43
    v_perm_b32 v7, v125, v121, s43
    v_perm_b32 v8, v126, v122, s43
    v_perm_b32 v9, v127, v123, s43
    v_mul_hi_u32_u24 v120, 429497, v120
    v_mul_hi_u32_u24 v124, 429497, v124
    v_mul_hi_u32_u24 v121, 429497, v121
    v_mul_hi_u32_u24 v125, 429497, v125
    v_mul_hi_u32_u24 v122, 429497, v122
    v_mul_hi_u32_u24 v126, 429497, v126
    v_mul_hi_u32_u24 v123, 429497, v123
    v_mul_hi_u32_u24 v127, 429497, v127
    v_lshl_or_b32 v120, v124, 16, v120
    v_lshl_or_b32 v121, v125, 16, v121
    v_lshl_or_b32 v122, v126, 16, v122
    v_lshl_or_b32 v123, v127, 16, v123
    v_dot2_u32_u16 v124, v120, s38, 0
    v_dot2_u32_u16 v125, v121, s38, 0
    v_dot2_u32_u16 v126, v122, s38, 0
    v_dot2_u32_u16 v127, v123, s38, 0
    v_pk_mad_u16 v6, v120, s37, v6
    v_pk_mad_u16 v7, v121, s37, v7
    v_pk_mad_u16 v8, v122, s37, v8
    v_pk_mad_u16 v9, v123, s37, v9
    ds_add_u32 v124, v4 offset:0
    ds_add_u32 v125, v4 offset:0
    ds_add_u32 v126, v4 offset:0
    ds_add_u32 v127, v4 offset:0
    v_perm_b32 v127, v127, v126, s43
    v_perm_b32 v126, v125, v124, s43
    v_or_b32 v120, 0x40000000, v6
    v_or_b32 v121, 0x40000000, v7
    v_or_b32 v124, 0x40000000, v8
    v_or_b32 v125, 0x40000000, v9
    s_mov_b64 exec, -1
    s_add_u32 s35, s34, 0
    buffer_load_dwordx2 v[50:51], v2, s[16:19], s35 offen nt
    s_add_u32 s35, s34, 2097152
    buffer_load_dwordx2 v[58:59], v2, s[16:19], s35 offen nt
    s_add_u32 s35, s34, 4194304
    buffer_load_dwordx2 v[66:67], v2, s[16:19], s35 offen nt
    s_and_b32 s35, s32, 15
    s_lshl_b32 s35, s35, 6
    s_lshr_b32 s36, s32, 4
    s_add_u32 s35, s35, s36
    s_lshl_b32 s42, s35, 4
    s_mul_i32 s35, s35, 240512
    s_add_u32 s35, s35, 8192
    s_add_u32 s20, s4, s35
    s_addc_u32 s21, s5, 0
    s_waitcnt lgkmcnt(0)
    s_barrier
    ds_read_b128 v[8:11], v1 offset:0
    s_add_u32 s35, s34, 6291456
    buffer_load_dwordx2 v[74:75], v2, s[16:19], s35 offen nt
    s_lshl_b32 s35, s39, 2
    s_add_u32 s35, s35, 160256
    v_mov_b32 v7, s35
    v_and_b32 v14, 15, v0
    v_lshlrev_b32 v14, 2, v14
    v_add_u32 v14, 160256, v14
    s_waitcnt lgkmcnt(0)
    v_cmp_eq_u32 s[56:57], 0, v8
    v_max_u32 v12, 1, v8
    v_lshl_or_b32 v8, v8, 16, v12
    v_cmp_eq_u32 s[58:59], 0, v9
    v_max_u32 v12, 1, v9
    v_lshl_or_b32 v9, v9, 16, v12
    v_cmp_eq_u32 s[60:61], 0, v10
    v_max_u32 v12, 1, v10
    v_lshl_or_b32 v10, v10, 16, v12
    v_cmp_eq_u32 s[62:63], 0, v11
    v_max_u32 v12, 1, v11
    v_lshl_or_b32 v11, v11, 16, v12
    v_add_u32 v9, v8, v9
    v_add_u32 v10, v9, v10
    v_add_u32 v11, v10, v11
    v_mov_b32 v6, v11
    s_nop 1
    v_add_u32_dpp v6, v6, v6 row_shr:1 row_mask:0xf bank_mask:0xf bound_ctrl:0
    s_nop 1
    v_add_u32_dpp v6, v6, v6 row_shr:2 row_mask:0xf bank_mask:0xf bound_ctrl:0
    s_nop 1
    v_add_u32_dpp v6, v6, v6 row_shr:4 row_mask:0xf bank_mask:0xf bound_ctrl:0
    s_nop 1
    v_add_u32_dpp v6, v6, v6 row_shr:8 row_mask:0xf bank_mask:0xf bound_ctrl:0
    s_nop 1
    v_add_u32_dpp v6, v6, v6 row_bcast:15 row_mask:0xa bank_mask:0xf
    s_nop 1
    v_add_u32_dpp v6, v6, v6 row_bcast:31 row_mask:0xc bank_mask:0xf
    s_mov_b32 exec_lo, 0
    s_brev_b32 exec_hi, 1
    ds_write_b32 v7, v6
    s_mov_b64 exec, -1
    v_sub_u32 v6, v6, v11
    s_or_b64 s[46:47], s[56:57], s[58:59]
    s_or_b64 vcc, s[60:61], s[62:63]
    s_or_b64 s[46:47], s[46:47], vcc
    s_waitcnt lgkmcnt(0)
    s_barrier
    ds_read_b32 v7, v14
    s_add_u32 s35, s34, 8388608
    buffer_load_dwordx2 v[82:83], v2, s[16:19], s35 offen nt
    s_waitcnt lgkmcnt(0)
    v_mov_b32 v15, v7
    s_nop 1
    v_add_u32_dpp v7, v7, v7 row_shr:1 row_mask:0xf bank_mask:0xf bound_ctrl:0
    s_nop 1
    v_add_u32_dpp v7, v7, v7 row_shr:2 row_mask:0xf bank_mask:0xf bound_ctrl:0
    s_nop 1
    v_add_u32_dpp v7, v7, v7 row_shr:4 row_mask:0xf bank_mask:0xf bound_ctrl:0
    s_nop 1
    v_add_u32_dpp v7, v7, v7 row_shr:8 row_mask:0xf bank_mask:0xf bound_ctrl:0
    s_nop 0
    v_readlane_b32 s54, v7, 15
    v_sub_u32 v7, v7, v15
    s_nop 0
    v_readlane_b32 s35, v7, s39
    s_and_b32 s54, s54, 0xffff
    s_cmp_ge_u32 s54, 40064
    s_cselect_b32 s36, 16, 0
    s_cselect_b32 s54, 40000, s54
    s_cselect_b32 s55, 1, s55
    s_cselect_b64 s[46:47], 0, s[46:47]
    v_add_u32 v12, s35, v6
    v_add_u32 v13, v12, v8
    v_add_u32 v14, v12, v9
    v_add_u32 v15, v12, v10
    v_bfe_u32 v12, v12, s36, 16
    v_bfe_u32 v13, v13, s36, 16
    v_bfe_u32 v14, v14, s36, 16
    v_bfe_u32 v15, v15, s36, 16
    ds_write_b128 v1, v[12:15] offset:0
    ds_write_b128 v1, v[12:15] offset:16384
    v_mov_b32 v6, 32768
    v_mov_b32 v7, s54
    s_mov_b64 exec, 1
    ds_write_b32 v6, v7
    s_mov_b64 exec, -1
    s_add_u32 s35, s54, 1
    s_lshr_b32 s35, s35, 1
    s_mul_i32 s35, s35, 12
    s_min_u32 s22, s35, 240512
    v_perm_b32 v15, v15, v14, s43
    v_perm_b32 v14, v13, v12, s43
    s_waitcnt lgkmcnt(0)
    s_barrier
    s_add_u32 s35, s34, 10485760
    buffer_load_dwordx2 v[90:91], v2, s[16:19], s35 offen nt
    v_and_b32 v6, 63, v0
    s_lshl_b32 s35, s39, 10
    v_lshl_add_u32 v7, v6, 2, s35
    v_lshl_add_u32 v12, v6, 8, s35
    ds_read_b32 v8, v7 offset:16384
    ds_read_b32 v9, v7 offset:16640
    ds_read_b32 v10, v7 offset:16896
    ds_read_b32 v11, v7 offset:17152
    s_mov_b64 exec, 15
    ds_read_b32 v12, v12 offset:16640
    s_mov_b64 exec, -1
    s_lshr_b32 s35, s39, 2
    s_mul_i32 s35, s35, 2138240
    s_and_b32 s36, s39, 1
    s_lshl_b32 s36, s36, 3
    s_add_u32 s35, s35, s36
    s_and_b32 s36, s39, 2
    s_lshl_b32 s36, s36, 13
    s_add_u32 s35, s35, s36
    s_add_u32 s35, s35, s42
    s_add_u32 s36, s35, 2105344
    v_mul_u32_u24 v7, 32896, v6
    v_lshlrev_b32 v13, 1, v6
    s_waitcnt lgkmcnt(1)
    v_perm_b32 v8, v9, v8, s43
    v_perm_b32 v9, v11, v10, s43
    buffer_store_dwordx2 v[8:9], v7, s[24:27], s35 offen
    s_waitcnt lgkmcnt(0)
    s_mov_b64 exec, 15
    buffer_store_short v12, v13, s[24:27], s36 offen
    s_mov_b64 exec, -1
    s_nop 0
    v_and_b32 v6, 0xffff, v54
    v_lshrrev_b32 v7, 16, v54
    v_and_b32 v8, 0xffff, v55
    v_lshrrev_b32 v9, 16, v55
    ds_add_rtn_u32 v6, v6, v4 offset:0
    ds_add_rtn_u32 v7, v7, v4 offset:0
    ds_add_rtn_u32 v8, v8, v4 offset:0
    ds_add_rtn_u32 v9, v9, v4 offset:0
    v_and_b32 v10, 0xffff, v62
    v_lshrrev_b32 v11, 16, v62
    v_and_b32 v12, 0xffff, v63
    v_lshrrev_b32 v13, 16, v63
    ds_add_rtn_u32 v10, v10, v4 offset:0
    ds_add_rtn_u32 v11, v11, v4 offset:0
    ds_add_rtn_u32 v12, v12, v4 offset:0
    ds_add_rtn_u32 v13, v13, v4 offset:0
    s_waitcnt lgkmcnt(4)
    v_perm_b32 v54, v7, v6, s43
    v_perm_b32 v55, v9, v8, s43
    v_and_b32 v6, 0xffff, v70
    v_lshrrev_b32 v7, 16, v70
    v_and_b32 v8, 0xffff, v71
    v_lshrrev_b32 v9, 16, v71
    ds_add_rtn_u32 v6, v6, v4 offset:0
    ds_add_rtn_u32 v7, v7, v4 offset:0
    ds_add_rtn_u32 v8, v8, v4 offset:0
    ds_add_rtn_u32 v9, v9, v4 offset:0
    s_waitcnt lgkmcnt(4)
    v_perm_b32 v62, v11, v10, s43
    v_perm_b32 v63, v13, v12, s43
    s_add_u32 s35, s34, 12582912
    buffer_load_dwordx2 v[98:99], v2, s[16:19], s35 offen nt
    s_add_u32 s35, s34, 14680064
    buffer_load_dwordx2 v[106:107], v2, s[16:19], s35 offen nt
    v_and_b32 v10, 0xffff, v78
    v_lshrrev_b32 v11, 16, v78
    v_and_b32 v12, 0xffff, v79
    v_lshrrev_b32 v13, 16, v79
    ds_add_rtn_u32 v10, v10, v4 offset:0
    ds_add_rtn_u32 v11, v11, v4 offset:0
    ds_add_rtn_u32 v12, v12, v4 offset:0
    ds_add_rtn_u32 v13, v13, v4 offset:0
    s_waitcnt lgkmcnt(4)
    v_perm_b32 v70, v7, v6, s43
    v_perm_b32 v71, v9, v8, s43
    v_and_b32 v6, 0xffff, v86
    v_lshrrev_b32 v7, 16, v86
    v_and_b32 v8, 0xffff, v87
    v_lshrrev_b32 v9, 16, v87
    ds_add_rtn_u32 v6, v6, v4 offset:0
    ds_add_rtn_u32 v7, v7, v4 offset:0
    ds_add_rtn_u32 v8, v8, v4 offset:0
    ds_add_rtn_u32 v9, v9, v4 offset:0
    s_waitcnt lgkmcnt(4)
    v_perm_b32 v78, v11, v10, s43
    v_perm_b32 v79, v13, v12, s43
    v_and_b32 v10, 0xffff, v94
    v_lshrrev_b32 v11, 16, v94
    v_and_b32 v12, 0xffff, v95
    v_lshrrev_b32 v13, 16, v95
    ds_add_rtn_u32 v10, v10, v4 offset:0
    ds_add_rtn_u32 v11, v11, v4 offset:0
    ds_add_rtn_u32 v12, v12, v4 offset:0
    ds_add_rtn_u32 v13, v13, v4 offset:0
    s_waitcnt lgkmcnt(4)
    v_perm_b32 v86, v7, v6, s43
    v_perm_b32 v87, v9, v8, s43
    s_add_u32 s35, s34, 16777216
    buffer_load_dwordx2 v[114:115], v2, s[16:19], s35 offen nt
    s_add_u32 s35, s34, 18874368
    s_sub_u32 s35, s35, s49
    s_mov_b64 exec, s[44:45]
    buffer_load_dwordx2 v[122:123], v2, s[16:19], s35 offen nt
    s_mov_b64 exec, -1
    v_and_b32 v6, 0xffff, v102
    v_lshrrev_b32 v7, 16, v102
    v_and_b32 v8, 0xffff, v103
    v_lshrrev_b32 v9, 16, v103
    ds_add_rtn_u32 v6, v6, v4 offset:0
    ds_add_rtn_u32 v7, v7, v4 offset:0
    ds_add_rtn_u32 v8, v8, v4 offset:0
    ds_add_rtn_u32 v9, v9, v4 offset:0
    s_waitcnt lgkmcnt(4)
    v_perm_b32 v94, v11, v10, s43
    v_perm_b32 v95, v13, v12, s43
    v_and_b32 v10, 0xffff, v110
    v_lshrrev_b32 v11, 16, v110
    v_and_b32 v12, 0xffff, v111
    v_lshrrev_b32 v13, 16, v111
    ds_add_rtn_u32 v10, v10, v4 offset:0
    ds_add_rtn_u32 v11, v11, v4 offset:0
    ds_add_rtn_u32 v12, v12, v4 offset:0
    ds_add_rtn_u32 v13, v13, v4 offset:0
    s_waitcnt lgkmcnt(4)
    v_perm_b32 v102, v7, v6, s43
    v_perm_b32 v103, v9, v8, s43
    v_and_b32 v6, 0xffff, v118
    v_lshrrev_b32 v7, 16, v118
    v_and_b32 v8, 0xffff, v119
    v_lshrrev_b32 v9, 16, v119
    ds_add_rtn_u32 v6, v6, v4 offset:0
    ds_add_rtn_u32 v7, v7, v4 offset:0
    ds_add_rtn_u32 v8, v8, v4 offset:0
    ds_add_rtn_u32 v9, v9, v4 offset:0
    s_waitcnt lgkmcnt(4)
    v_perm_b32 v110, v11, v10, s43
    v_perm_b32 v111, v13, v12, s43
    s_add_u32 s35, s33, 40960000
    buffer_load_dwordx4 v[16:19], v1, s[8:11], s35 offen nt
    s_mov_b64 exec, s[44:45]
    v_and_b32 v10, 0xffff, v126
    v_lshrrev_b32 v11, 16, v126
    v_and_b32 v12, 0xffff, v127
    v_lshrrev_b32 v13, 16, v127
    ds_add_rtn_u32 v10, v10, v4 offset:0
    ds_add_rtn_u32 v11, v11, v4 offset:0
    ds_add_rtn_u32 v12, v12, v4 offset:0
    ds_add_rtn_u32 v13, v13, v4 offset:0
    s_mov_b64 exec, -1
    s_waitcnt lgkmcnt(4)
    v_perm_b32 v118, v7, v6, s43
    v_perm_b32 v119, v9, v8, s43
    s_waitcnt lgkmcnt(0)
    v_perm_b32 v126, v11, v10, s43
    v_perm_b32 v127, v13, v12, s43
    s_barrier
    s_lshl_b32 s35, s54, 2
    v_mov_b32 v6, s35
    v_mov_b32 v7, 0
    s_mov_b64 exec, 1
    ds_write_b32 v6, v7
    s_cmp_eq_u64 s[46:47], 0
    s_cbranch_scc1 L_p1_kernel_nonull_1
    s_mov_b64 exec, s[56:57]
    v_lshlrev_b32_sdwa v6, 2, v14 dst_sel:DWORD dst_unused:UNUSED_PAD src0_sel:DWORD src1_sel:WORD_0
    ds_write_b32 v6, v7
    s_mov_b64 exec, s[58:59]
    v_lshlrev_b32_sdwa v6, 2, v14 dst_sel:DWORD dst_unused:UNUSED_PAD src0_sel:DWORD src1_sel:WORD_1
    ds_write_b32 v6, v7
    s_mov_b64 exec, s[60:61]
    v_lshlrev_b32_sdwa v6, 2, v15 dst_sel:DWORD dst_unused:UNUSED_PAD src0_sel:DWORD src1_sel:WORD_0
    ds_write_b32 v6, v7
    s_mov_b64 exec, s[62:63]
    v_lshlrev_b32_sdwa v6, 2, v15 dst_sel:DWORD dst_unused:UNUSED_PAD src0_sel:DWORD src1_sel:WORD_1
    ds_write_b32 v6, v7
L_p1_kernel_nonull_1:
    s_mov_b64 exec, -1
    v_lshlrev_b32_sdwa v6, 2, v54 dst_sel:DWORD dst_unused:UNUSED_PAD src0_sel:DWORD src1_sel:WORD_0
    v_lshlrev_b32_sdwa v7, 2, v54 dst_sel:DWORD dst_unused:UNUSED_PAD src0_sel:DWORD src1_sel:WORD_1
    v_lshlrev_b32_sdwa v8, 2, v55 dst_sel:DWORD dst_unused:UNUSED_PAD src0_sel:DWORD src1_sel:WORD_0
    v_lshlrev_b32_sdwa v9, 2, v55 dst_sel:DWORD dst_unused:UNUSED_PAD src0_sel:DWORD src1_sel:WORD_1
    ds_write_b32 v6, v48
    ds_write_b32 v7, v49
    ds_write_b32 v8, v52
    ds_write_b32 v9, v53
    s_waitcnt vmcnt(12)
    v_lshlrev_b32 v10, 16, v50
    v_lshlrev_b32 v11, 16, v51
    v_and_b32 v50, 0xffff0000, v50
    v_and_b32 v51, 0xffff0000, v51
    v_mul_f32 v10, s41, v10
    v_mul_f32 v50, s41, v50
    v_mul_f32 v11, s41, v11
    v_mul_f32 v51, s41, v51
    v_fract_f32 v10, v10
    v_fract_f32 v50, v50
    v_fract_f32 v11, v11
    v_fract_f32 v51, v51
    v_cos_f32 v10, v10
    v_cos_f32 v50, v50
    v_cos_f32 v11, v11
    v_cos_f32 v51, v51
    v_cvt_pk_bf16_f32 v50, v10, v50
    v_cvt_pk_bf16_f32 v51, v11, v51
    v_or3_b32 v5, v50, v51, v5
    v_lshlrev_b32_sdwa v6, 2, v62 dst_sel:DWORD dst_unused:UNUSED_PAD src0_sel:DWORD src1_sel:WORD_0
    v_lshlrev_b32_sdwa v7, 2, v62 dst_sel:DWORD dst_unused:UNUSED_PAD src0_sel:DWORD src1_sel:WORD_1
    v_lshlrev_b32_sdwa v8, 2, v63 dst_sel:DWORD dst_unused:UNUSED_PAD src0_sel:DWORD src1_sel:WORD_0
    v_lshlrev_b32_sdwa v9, 2, v63 dst_sel:DWORD dst_unused:UNUSED_PAD src0_sel:DWORD src1_sel:WORD_1
    ds_write_b32 v6, v56
    ds_write_b32 v7, v57
    ds_write_b32 v8, v60
    ds_write_b32 v9, v61
    s_waitcnt vmcnt(11)
    v_lshlrev_b32 v10, 16, v58
    v_lshlrev_b32 v11, 16, v59
    v_and_b32 v58, 0xffff0000, v58
    v_and_b32 v59, 0xffff0000, v59
    v_mul_f32 v10, s41, v10
    v_mul_f32 v58, s41, v58
    v_mul_f32 v11, s41, v11
    v_mul_f32 v59, s41, v59
    v_fract_f32 v10, v10
    v_fract_f32 v58, v58
    v_fract_f32 v11, v11
    v_fract_f32 v59, v59
    v_cos_f32 v10, v10
    v_cos_f32 v58, v58
    v_cos_f32 v11, v11
    v_cos_f32 v59, v59
    v_cvt_pk_bf16_f32 v58, v10, v58
    v_cvt_pk_bf16_f32 v59, v11, v59
    v_or3_b32 v5, v58, v59, v5
    s_add_u32 s35, s33, 40960000
    buffer_load_dwordx4 v[20:23], v1, s[12:15], s35 offen nt
    v_lshlrev_b32_sdwa v6, 2, v70 dst_sel:DWORD dst_unused:UNUSED_PAD src0_sel:DWORD src1_sel:WORD_0
    v_lshlrev_b32_sdwa v7, 2, v70 dst_sel:DWORD dst_unused:UNUSED_PAD src0_sel:DWORD src1_sel:WORD_1
    v_lshlrev_b32_sdwa v8, 2, v71 dst_sel:DWORD dst_unused:UNUSED_PAD src0_sel:DWORD src1_sel:WORD_0
    v_lshlrev_b32_sdwa v9, 2, v71 dst_sel:DWORD dst_unused:UNUSED_PAD src0_sel:DWORD src1_sel:WORD_1
    ds_write_b32 v6, v64
    ds_write_b32 v7, v65
    ds_write_b32 v8, v68
    ds_write_b32 v9, v69
    s_waitcnt vmcnt(11)
    v_lshlrev_b32 v10, 16, v66
    v_lshlrev_b32 v11, 16, v67
    v_and_b32 v66, 0xffff0000, v66
    v_and_b32 v67, 0xffff0000, v67
    v_mul_f32 v10, s41, v10
    v_mul_f32 v66, s41, v66
    v_mul_f32 v11, s41, v11
    v_mul_f32 v67, s41, v67
    v_fract_f32 v10, v10
    v_fract_f32 v66, v66
    v_fract_f32 v11, v11
    v_fract_f32 v67, v67
    v_cos_f32 v10, v10
    v_cos_f32 v66, v66
    v_cos_f32 v11, v11
    v_cos_f32 v67, v67
    v_cvt_pk_bf16_f32 v66, v10, v66
    v_cvt_pk_bf16_f32 v67, v11, v67
    v_or3_b32 v5, v66, v67, v5
    v_lshlrev_b32_sdwa v6, 2, v78 dst_sel:DWORD dst_unused:UNUSED_PAD src0_sel:DWORD src1_sel:WORD_0
    v_lshlrev_b32_sdwa v7, 2, v78 dst_sel:DWORD dst_unused:UNUSED_PAD src0_sel:DWORD src1_sel:WORD_1
    v_lshlrev_b32_sdwa v8, 2, v79 dst_sel:DWORD dst_unused:UNUSED_PAD src0_sel:DWORD src1_sel:WORD_0
    v_lshlrev_b32_sdwa v9, 2, v79 dst_sel:DWORD dst_unused:UNUSED_PAD src0_sel:DWORD src1_sel:WORD_1
    ds_write_b32 v6, v72
    ds_write_b32 v7, v73
    ds_write_b32 v8, v76
    ds_write_b32 v9, v77
    s_waitcnt vmcnt(10)
    v_lshlrev_b32 v10, 16, v74
    v_lshlrev_b32 v11, 16, v75
    v_and_b32 v74, 0xffff0000, v74
    v_and_b32 v75, 0xffff0000, v75
    v_mul_f32 v10, s41, v10
    v_mul_f32 v74, s41, v74
    v_mul_f32 v11, s41, v11
    v_mul_f32 v75, s41, v75
    v_fract_f32 v10, v10
    v_fract_f32 v74, v74
    v_fract_f32 v11, v11
    v_fract_f32 v75, v75
    v_cos_f32 v10, v10
    v_cos_f32 v74, v74
    v_cos_f32 v11, v11
    v_cos_f32 v75, v75
    v_cvt_pk_bf16_f32 v74, v10, v74
    v_cvt_pk_bf16_f32 v75, v11, v75
    v_or3_b32 v5, v74, v75, v5
    v_lshlrev_b32_sdwa v6, 2, v86 dst_sel:DWORD dst_unused:UNUSED_PAD src0_sel:DWORD src1_sel:WORD_0
    v_lshlrev_b32_sdwa v7, 2, v86 dst_sel:DWORD dst_unused:UNUSED_PAD src0_sel:DWORD src1_sel:WORD_1
    v_lshlrev_b32_sdwa v8, 2, v87 dst_sel:DWORD dst_unused:UNUSED_PAD src0_sel:DWORD src1_sel:WORD_0
    v_lshlrev_b32_sdwa v9, 2, v87 dst_sel:DWORD dst_unused:UNUSED_PAD src0_sel:DWORD src1_sel:WORD_1
    ds_write_b32 v6, v80
    ds_write_b32 v7, v81
    ds_write_b32 v8, v84
    ds_write_b32 v9, v85
    s_waitcnt vmcnt(9)
    v_lshlrev_b32 v10, 16, v82
    v_lshlrev_b32 v11, 16, v83
    v_and_b32 v82, 0xffff0000, v82
    v_and_b32 v83, 0xffff0000, v83
    v_mul_f32 v10, s41, v10
    v_mul_f32 v82, s41, v82
    v_mul_f32 v11, s41, v11
    v_mul_f32 v83, s41, v83
    v_fract_f32 v10, v10
    v_fract_f32 v82, v82
    v_fract_f32 v11, v11
    v_fract_f32 v83, v83
    v_cos_f32 v10, v10
    v_cos_f32 v82, v82
    v_cos_f32 v11, v11
    v_cos_f32 v83, v83
    v_cvt_pk_bf16_f32 v82, v10, v82
    v_cvt_pk_bf16_f32 v83, v11, v83
    v_or3_b32 v5, v82, v83, v5
    s_add_u32 s35, s33, 45154304
    buffer_load_dwordx4 v[24:27], v1, s[8:11], s35 offen nt
    v_lshlrev_b32_sdwa v6, 2, v94 dst_sel:DWORD dst_unused:UNUSED_PAD src0_sel:DWORD src1_sel:WORD_0
    v_lshlrev_b32_sdwa v7, 2, v94 dst_sel:DWORD dst_unused:UNUSED_PAD src0_sel:DWORD src1_sel:WORD_1
    v_lshlrev_b32_sdwa v8, 2, v95 dst_sel:DWORD dst_unused:UNUSED_PAD src0_sel:DWORD src1_sel:WORD_0
    v_lshlrev_b32_sdwa v9, 2, v95 dst_sel:DWORD dst_unused:UNUSED_PAD src0_sel:DWORD src1_sel:WORD_1
    ds_write_b32 v6, v88
    ds_write_b32 v7, v89
    ds_write_b32 v8, v92
    ds_write_b32 v9, v93
    s_waitcnt vmcnt(9)
    v_lshlrev_b32 v10, 16, v90
    v_lshlrev_b32 v11, 16, v91
    v_and_b32 v90, 0xffff0000, v90
    v_and_b32 v91, 0xffff0000, v91
    v_mul_f32 v10, s41, v10
    v_mul_f32 v90, s41, v90
    v_mul_f32 v11, s41, v11
    v_mul_f32 v91, s41, v91
    v_fract_f32 v10, v10
    v_fract_f32 v90, v90
    v_fract_f32 v11, v11
    v_fract_f32 v91, v91
    v_cos_f32 v10, v10
    v_cos_f32 v90, v90
    v_cos_f32 v11, v11
    v_cos_f32 v91, v91
    v_cvt_pk_bf16_f32 v90, v10, v90
    v_cvt_pk_bf16_f32 v91, v11, v91
    v_or3_b32 v5, v90, v91, v5
    v_lshlrev_b32_sdwa v6, 2, v102 dst_sel:DWORD dst_unused:UNUSED_PAD src0_sel:DWORD src1_sel:WORD_0
    v_lshlrev_b32_sdwa v7, 2, v102 dst_sel:DWORD dst_unused:UNUSED_PAD src0_sel:DWORD src1_sel:WORD_1
    v_lshlrev_b32_sdwa v8, 2, v103 dst_sel:DWORD dst_unused:UNUSED_PAD src0_sel:DWORD src1_sel:WORD_0
    v_lshlrev_b32_sdwa v9, 2, v103 dst_sel:DWORD dst_unused:UNUSED_PAD src0_sel:DWORD src1_sel:WORD_1
    ds_write_b32 v6, v96
    ds_write_b32 v7, v97
    ds_write_b32 v8, v100
    ds_write_b32 v9, v101
    s_waitcnt vmcnt(6)
    v_lshlrev_b32 v10, 16, v98
    v_lshlrev_b32 v11, 16, v99
    v_and_b32 v98, 0xffff0000, v98
    v_and_b32 v99, 0xffff0000, v99
    v_mul_f32 v10, s41, v10
    v_mul_f32 v98, s41, v98
    v_mul_f32 v11, s41, v11
    v_mul_f32 v99, s41, v99
    v_fract_f32 v10, v10
    v_fract_f32 v98, v98
    v_fract_f32 v11, v11
    v_fract_f32 v99, v99
    v_cos_f32 v10, v10
    v_cos_f32 v98, v98
    v_cos_f32 v11, v11
    v_cos_f32 v99, v99
    v_cvt_pk_bf16_f32 v98, v10, v98
    v_cvt_pk_bf16_f32 v99, v11, v99
    v_or3_b32 v5, v98, v99, v5
    v_lshlrev_b32_sdwa v6, 2, v110 dst_sel:DWORD dst_unused:UNUSED_PAD src0_sel:DWORD src1_sel:WORD_0
    v_lshlrev_b32_sdwa v7, 2, v110 dst_sel:DWORD dst_unused:UNUSED_PAD src0_sel:DWORD src1_sel:WORD_1
    v_lshlrev_b32_sdwa v8, 2, v111 dst_sel:DWORD dst_unused:UNUSED_PAD src0_sel:DWORD src1_sel:WORD_0
    v_lshlrev_b32_sdwa v9, 2, v111 dst_sel:DWORD dst_unused:UNUSED_PAD src0_sel:DWORD src1_sel:WORD_1
    ds_write_b32 v6, v104
    ds_write_b32 v7, v105
    ds_write_b32 v8, v108
    ds_write_b32 v9, v109
    s_waitcnt vmcnt(5)
    v_lshlrev_b32 v10, 16, v106
    v_lshlrev_b32 v11, 16, v107
    v_and_b32 v106, 0xffff0000, v106
    v_and_b32 v107, 0xffff0000, v107
    v_mul_f32 v10, s41, v10
    v_mul_f32 v106, s41, v106
    v_mul_f32 v11, s41, v11
    v_mul_f32 v107, s41, v107
    v_fract_f32 v10, v10
    v_fract_f32 v106, v106
    v_fract_f32 v11, v11
    v_fract_f32 v107, v107
    v_cos_f32 v10, v10
    v_cos_f32 v106, v106
    v_cos_f32 v11, v11
    v_cos_f32 v107, v107
    v_cvt_pk_bf16_f32 v106, v10, v106
    v_cvt_pk_bf16_f32 v107, v11, v107
    v_or3_b32 v5, v106, v107, v5
    s_add_u32 s35, s33, 45154304
    buffer_load_dwordx4 v[28:31], v1, s[12:15], s35 offen nt
    v_lshlrev_b32_sdwa v6, 2, v118 dst_sel:DWORD dst_unused:UNUSED_PAD src0_sel:DWORD src1_sel:WORD_0
    v_lshlrev_b32_sdwa v7, 2, v118 dst_sel:DWORD dst_unused:UNUSED_PAD src0_sel:DWORD src1_sel:WORD_1
    v_lshlrev_b32_sdwa v8, 2, v119 dst_sel:DWORD dst_unused:UNUSED_PAD src0_sel:DWORD src1_sel:WORD_0
    v_lshlrev_b32_sdwa v9, 2, v119 dst_sel:DWORD dst_unused:UNUSED_PAD src0_sel:DWORD src1_sel:WORD_1
    ds_write_b32 v6, v112
    ds_write_b32 v7, v113
    ds_write_b32 v8, v116
    ds_write_b32 v9, v117
    s_waitcnt vmcnt(5)
    v_lshlrev_b32 v10, 16, v114
    v_lshlrev_b32 v11, 16, v115
    v_and_b32 v114, 0xffff0000, v114
    v_and_b32 v115, 0xffff0000, v115
    v_mul_f32 v10, s41, v10
    v_mul_f32 v114, s41, v114
    v_mul_f32 v11, s41, v11
    v_mul_f32 v115, s41, v115
    v_fract_f32 v10, v10
    v_fract_f32 v114, v114
    v_fract_f32 v11, v11
    v_fract_f32 v115, v115
    v_cos_f32 v10, v10
    v_cos_f32 v114, v114
    v_cos_f32 v11, v11
    v_cos_f32 v115, v115
    v_cvt_pk_bf16_f32 v114, v10, v114
    v_cvt_pk_bf16_f32 v115, v11, v115
    v_or3_b32 v5, v114, v115, v5
    s_mov_b64 exec, s[44:45]
    v_lshlrev_b32_sdwa v6, 2, v126 dst_sel:DWORD dst_unused:UNUSED_PAD src0_sel:DWORD src1_sel:WORD_0
    v_lshlrev_b32_sdwa v7, 2, v126 dst_sel:DWORD dst_unused:UNUSED_PAD src0_sel:DWORD src1_sel:WORD_1
    v_lshlrev_b32_sdwa v8, 2, v127 dst_sel:DWORD dst_unused:UNUSED_PAD src0_sel:DWORD src1_sel:WORD_0
    v_lshlrev_b32_sdwa v9, 2, v127 dst_sel:DWORD dst_unused:UNUSED_PAD src0_sel:DWORD src1_sel:WORD_1
    ds_write_b32 v6, v120
    ds_write_b32 v7, v121
    ds_write_b32 v8, v124
    ds_write_b32 v9, v125
    s_waitcnt vmcnt(4)
    v_lshlrev_b32 v10, 16, v122
    v_lshlrev_b32 v11, 16, v123
    v_and_b32 v122, 0xffff0000, v122
    v_and_b32 v123, 0xffff0000, v123
    v_mul_f32 v10, s41, v10
    v_mul_f32 v122, s41, v122
    v_mul_f32 v11, s41, v11
    v_mul_f32 v123, s41, v123
    v_fract_f32 v10, v10
    v_fract_f32 v122, v122
    v_fract_f32 v11, v11
    v_fract_f32 v123, v123
    v_cos_f32 v10, v10
    v_cos_f32 v122, v122
    v_cos_f32 v11, v11
    v_cos_f32 v123, v123
    v_cvt_pk_bf16_f32 v122, v10, v122
    v_cvt_pk_bf16_f32 v123, v11, v123
    v_or3_b32 v5, v122, v123, v5
    s_mov_b64 exec, -1
    s_mul_i32 s35, s39, 9728
    v_add_u32 v6, s35, v2
    s_waitcnt lgkmcnt(0)
    s_barrier
    ds_read_b64 v[48:49], v6 offset:0
    ds_read_b64 v[52:53], v6 offset:512
    ds_read_b64 v[56:57], v6 offset:1024
    ds_read_b64 v[60:61], v6 offset:1536
    ds_read_b64 v[64:65], v6 offset:2048
    ds_read_b64 v[68:69], v6 offset:2560
    ds_read_b64 v[72:73], v6 offset:3072
    ds_read_b64 v[76:77], v6 offset:3584
    ds_read_b64 v[80:81], v6 offset:4096
    ds_read_b64 v[84:85], v6 offset:4608
    ds_read_b64 v[88:89], v6 offset:5120
    ds_read_b64 v[92:93], v6 offset:5632
    ds_read_b64 v[96:97], v6 offset:6144
    ds_read_b64 v[100:101], v6 offset:6656
    ds_read_b64 v[104:105], v6 offset:7168
    ds_read_b64 v[108:109], v6 offset:7680
    ds_read_b64 v[112:113], v6 offset:8192
    ds_read_b64 v[116:117], v6 offset:8704
    ds_read_b64 v[120:121], v6 offset:9216
    ds_read_b64 v[124:125], v6 offset:9728
    s_add_u32 s35, s33, 49348608
    buffer_load_dwordx4 v[32:35], v1, s[8:11], s35 offen nt
    v_mov_b32 v12, 0
    v_mov_b32 v13, 0
    v_mov_b32 v14, 0
    v_mov_b32 v15, 0
    s_waitcnt lgkmcnt(0)
    s_barrier
    ds_write_b128 v1, v[12:15] offset:0
    v_lshlrev_b32_sdwa v6, 1, v54 dst_sel:DWORD dst_unused:UNUSED_PAD src0_sel:DWORD src1_sel:WORD_0
    v_lshlrev_b32_sdwa v7, 1, v54 dst_sel:DWORD dst_unused:UNUSED_PAD src0_sel:DWORD src1_sel:WORD_1
    v_lshlrev_b32_sdwa v8, 1, v55 dst_sel:DWORD dst_unused:UNUSED_PAD src0_sel:DWORD src1_sel:WORD_0
    v_lshlrev_b32_sdwa v9, 1, v55 dst_sel:DWORD dst_unused:UNUSED_PAD src0_sel:DWORD src1_sel:WORD_1
    ds_write_b16 v6, v50 offset:16384
    ds_write_b16_d16_hi v7, v50 offset:16384
    ds_write_b16 v8, v51 offset:16384
    ds_write_b16_d16_hi v9, v51 offset:16384
    v_lshlrev_b32_sdwa v6, 1, v62 dst_sel:DWORD dst_unused:UNUSED_PAD src0_sel:DWORD src1_sel:WORD_0
    v_lshlrev_b32_sdwa v7, 1, v62 dst_sel:DWORD dst_unused:UNUSED_PAD src0_sel:DWORD src1_sel:WORD_1
    v_lshlrev_b32_sdwa v8, 1, v63 dst_sel:DWORD dst_unused:UNUSED_PAD src0_sel:DWORD src1_sel:WORD_0
    v_lshlrev_b32_sdwa v9, 1, v63 dst_sel:DWORD dst_unused:UNUSED_PAD src0_sel:DWORD src1_sel:WORD_1
    ds_write_b16 v6, v58 offset:16384
    ds_write_b16_d16_hi v7, v58 offset:16384
    ds_write_b16 v8, v59 offset:16384
    ds_write_b16_d16_hi v9, v59 offset:16384
    s_add_u32 s35, s33, 49348608
    buffer_load_dwordx4 v[36:39], v1, s[12:15], s35 offen nt
    v_lshlrev_b32_sdwa v6, 1, v70 dst_sel:DWORD dst_unused:UNUSED_PAD src0_sel:DWORD src1_sel:WORD_0
    v_lshlrev_b32_sdwa v7, 1, v70 dst_sel:DWORD dst_unused:UNUSED_PAD src0_sel:DWORD src1_sel:WORD_1
    v_lshlrev_b32_sdwa v8, 1, v71 dst_sel:DWORD dst_unused:UNUSED_PAD src0_sel:DWORD src1_sel:WORD_0
    v_lshlrev_b32_sdwa v9, 1, v71 dst_sel:DWORD dst_unused:UNUSED_PAD src0_sel:DWORD src1_sel:WORD_1
    ds_write_b16 v6, v66 offset:16384
    ds_write_b16_d16_hi v7, v66 offset:16384
    ds_write_b16 v8, v67 offset:16384
    ds_write_b16_d16_hi v9, v67 offset:16384
    v_lshlrev_b32_sdwa v6, 1, v78 dst_sel:DWORD dst_unused:UNUSED_PAD src0_sel:DWORD src1_sel:WORD_0
    v_lshlrev_b32_sdwa v7, 1, v78 dst_sel:DWORD dst_unused:UNUSED_PAD src0_sel:DWORD src1_sel:WORD_1
    v_lshlrev_b32_sdwa v8, 1, v79 dst_sel:DWORD dst_unused:UNUSED_PAD src0_sel:DWORD src1_sel:WORD_0
    v_lshlrev_b32_sdwa v9, 1, v79 dst_sel:DWORD dst_unused:UNUSED_PAD src0_sel:DWORD src1_sel:WORD_1
    ds_write_b16 v6, v74 offset:16384
    ds_write_b16_d16_hi v7, v74 offset:16384
    ds_write_b16 v8, v75 offset:16384
    ds_write_b16_d16_hi v9, v75 offset:16384
    v_lshlrev_b32_sdwa v6, 1, v86 dst_sel:DWORD dst_unused:UNUSED_PAD src0_sel:DWORD src1_sel:WORD_0
    v_lshlrev_b32_sdwa v7, 1, v86 dst_sel:DWORD dst_unused:UNUSED_PAD src0_sel:DWORD src1_sel:WORD_1
    v_lshlrev_b32_sdwa v8, 1, v87 dst_sel:DWORD dst_unused:UNUSED_PAD src0_sel:DWORD src1_sel:WORD_0
    v_lshlrev_b32_sdwa v9, 1, v87 dst_sel:DWORD dst_unused:UNUSED_PAD src0_sel:DWORD src1_sel:WORD_1
    ds_write_b16 v6, v82 offset:16384
    ds_write_b16_d16_hi v7, v82 offset:16384
    ds_write_b16 v8, v83 offset:16384
    ds_write_b16_d16_hi v9, v83 offset:16384
    s_add_u32 s35, s33, 53542912
    buffer_load_dwordx4 v[40:43], v1, s[8:11], s35 offen nt
    v_lshlrev_b32_sdwa v6, 1, v94 dst_sel:DWORD dst_unused:UNUSED_PAD src0_sel:DWORD src1_sel:WORD_0
    v_lshlrev_b32_sdwa v7, 1, v94 dst_sel:DWORD dst_unused:UNUSED_PAD src0_sel:DWORD src1_sel:WORD_1
    v_lshlrev_b32_sdwa v8, 1, v95 dst_sel:DWORD dst_unused:UNUSED_PAD src0_sel:DWORD src1_sel:WORD_0
    v_lshlrev_b32_sdwa v9, 1, v95 dst_sel:DWORD dst_unused:UNUSED_PAD src0_sel:DWORD src1_sel:WORD_1
    ds_write_b16 v6, v90 offset:16384
    ds_write_b16_d16_hi v7, v90 offset:16384
    ds_write_b16 v8, v91 offset:16384
    ds_write_b16_d16_hi v9, v91 offset:16384
    v_lshlrev_b32_sdwa v6, 1, v102 dst_sel:DWORD dst_unused:UNUSED_PAD src0_sel:DWORD src1_sel:WORD_0
    v_lshlrev_b32_sdwa v7, 1, v102 dst_sel:DWORD dst_unused:UNUSED_PAD src0_sel:DWORD src1_sel:WORD_1
    v_lshlrev_b32_sdwa v8, 1, v103 dst_sel:DWORD dst_unused:UNUSED_PAD src0_sel:DWORD src1_sel:WORD_0
    v_lshlrev_b32_sdwa v9, 1, v103 dst_sel:DWORD dst_unused:UNUSED_PAD src0_sel:DWORD src1_sel:WORD_1
    ds_write_b16 v6, v98 offset:16384
    ds_write_b16_d16_hi v7, v98 offset:16384
    ds_write_b16 v8, v99 offset:16384
    ds_write_b16_d16_hi v9, v99 offset:16384
    v_lshlrev_b32_sdwa v6, 1, v110 dst_sel:DWORD dst_unused:UNUSED_PAD src0_sel:DWORD src1_sel:WORD_0
    v_lshlrev_b32_sdwa v7, 1, v110 dst_sel:DWORD dst_unused:UNUSED_PAD src0_sel:DWORD src1_sel:WORD_1
    v_lshlrev_b32_sdwa v8, 1, v111 dst_sel:DWORD dst_unused:UNUSED_PAD src0_sel:DWORD src1_sel:WORD_0
    v_lshlrev_b32_sdwa v9, 1, v111 dst_sel:DWORD dst_unused:UNUSED_PAD src0_sel:DWORD src1_sel:WORD_1
    ds_write_b16 v6, v106 offset:16384
    ds_write_b16_d16_hi v7, v106 offset:16384
    ds_write_b16 v8, v107 offset:16384
    ds_write_b16_d16_hi v9, v107 offset:16384
    s_add_u32 s35, s33, 53542912
    buffer_load_dwordx4 v[44:47], v1, s[12:15], s35 offen nt
    v_lshlrev_b32_sdwa v6, 1, v118 dst_sel:DWORD dst_unused:UNUSED_PAD src0_sel:DWORD src1_sel:WORD_0
    v_lshlrev_b32_sdwa v7, 1, v118 dst_sel:DWORD dst_unused:UNUSED_PAD src0_sel:DWORD src1_sel:WORD_1
    v_lshlrev_b32_sdwa v8, 1, v119 dst_sel:DWORD dst_unused:UNUSED_PAD src0_sel:DWORD src1_sel:WORD_0
    v_lshlrev_b32_sdwa v9, 1, v119 dst_sel:DWORD dst_unused:UNUSED_PAD src0_sel:DWORD src1_sel:WORD_1
    ds_write_b16 v6, v114 offset:16384
    ds_write_b16_d16_hi v7, v114 offset:16384
    ds_write_b16 v8, v115 offset:16384
    ds_write_b16_d16_hi v9, v115 offset:16384
    s_mov_b64 exec, s[44:45]
    v_lshlrev_b32_sdwa v6, 1, v126 dst_sel:DWORD dst_unused:UNUSED_PAD src0_sel:DWORD src1_sel:WORD_0
    v_lshlrev_b32_sdwa v7, 1, v126 dst_sel:DWORD dst_unused:UNUSED_PAD src0_sel:DWORD src1_sel:WORD_1
    v_lshlrev_b32_sdwa v8, 1, v127 dst_sel:DWORD dst_unused:UNUSED_PAD src0_sel:DWORD src1_sel:WORD_0
    v_lshlrev_b32_sdwa v9, 1, v127 dst_sel:DWORD dst_unused:UNUSED_PAD src0_sel:DWORD src1_sel:WORD_1
    ds_write_b16 v6, v122 offset:16384
    ds_write_b16_d16_hi v7, v122 offset:16384
    ds_write_b16 v8, v123 offset:16384
    ds_write_b16_d16_hi v9, v123 offset:16384
    s_mov_b64 exec, -1
    v_lshlrev_b32 v6, 2, v0
    s_mul_i32 s35, s39, 4864
    v_add_u32 v7, s35, v6
    s_waitcnt lgkmcnt(0)
    s_barrier
    ds_read_b32 v50, v7 offset:16384
    ds_read_b32 v54, v7 offset:16640
    ds_read_b32 v58, v7 offset:16896
    ds_read_b32 v62, v7 offset:17152
    ds_read_b32 v66, v7 offset:17408
    ds_read_b32 v70, v7 offset:17664
    ds_read_b32 v74, v7 offset:17920
    ds_read_b32 v78, v7 offset:18176
    ds_read_b32 v82, v7 offset:18432
    ds_read_b32 v86, v7 offset:18688
    ds_read_b32 v90, v7 offset:18944
    ds_read_b32 v94, v7 offset:19200
    ds_read_b32 v98, v7 offset:19456
    ds_read_b32 v102, v7 offset:19712
    ds_read_b32 v106, v7 offset:19968
    ds_read_b32 v110, v7 offset:20224
    ds_read_b32 v114, v7 offset:20480
    ds_read_b32 v118, v7 offset:20736
    ds_read_b32 v122, v7 offset:20992
    ds_read_b32 v126, v7 offset:21248
    s_add_u32 s32, s32, 256
    s_add_u32 s33, s33, 40960000
    s_add_u32 s34, s34, 20480000
    s_add_u32 s40, s40, 1
    s_cmp_lt_u32 s40, 4
    s_waitcnt lgkmcnt(0)
    s_cbranch_scc1 L_p1_loop
    s_mov_b32 s36, 0
    buffer_store_dwordx3 v[48:50], v3, s[20:23], s36 offen sc1
    s_mov_b32 s36, 768
    buffer_store_dwordx3 v[52:54], v3, s[20:23], s36 offen sc1
    s_mov_b32 s36, 1536
    buffer_store_dwordx3 v[56:58], v3, s[20:23], s36 offen sc1
    s_mov_b32 s36, 2304
    buffer_store_dwordx3 v[60:62], v3, s[20:23], s36 offen sc1
    s_mov_b32 s36, 3072
    buffer_store_dwordx3 v[64:66], v3, s[20:23], s36 offen sc1
    s_mov_b32 s36, 3840
    buffer_store_dwordx3 v[68:70], v3, s[20:23], s36 offen sc1
    s_mov_b32 s36, 4608
    buffer_store_dwordx3 v[72:74], v3, s[20:23], s36 offen sc1
    s_mov_b32 s36, 5376
    buffer_store_dwordx3 v[76:78], v3, s[20:23], s36 offen sc1
    s_mov_b32 s36, 6144
    buffer_store_dwordx3 v[80:82], v3, s[20:23], s36 offen sc1
    s_mov_b32 s36, 6912
    buffer_store_dwordx3 v[84:86], v3, s[20:23], s36 offen sc1
    s_mov_b32 s36, 7680
    buffer_store_dwordx3 v[88:90], v3, s[20:23], s36 offen sc1
    s_mov_b32 s36, 8448
    buffer_store_dwordx3 v[92:94], v3, s[20:23], s36 offen sc1
    s_mov_b32 s36, 9216
    buffer_store_dwordx3 v[96:98], v3, s[20:23], s36 offen sc1
    s_mov_b32 s36, 9984
    buffer_store_dwordx3 v[100:102], v3, s[20:23], s36 offen sc1
    s_mov_b32 s36, 10752
    buffer_store_dwordx3 v[104:106], v3, s[20:23], s36 offen sc1
    s_mov_b32 s36, 11520
    buffer_store_dwordx3 v[108:110], v3, s[20:23], s36 offen sc1
    s_mov_b32 s36, 12288
    buffer_store_dwordx3 v[112:114], v3, s[20:23], s36 offen sc1
    s_mov_b32 s36, 13056
    buffer_store_dwordx3 v[116:118], v3, s[20:23], s36 offen sc1
    s_mov_b32 s36, 13824
    buffer_store_dwordx3 v[120:122], v3, s[20:23], s36 offen sc1
    s_mov_b32 s36, 14592
    buffer_store_dwordx3 v[124:126], v3, s[20:23], s36 offen sc1
    v_and_b32 v6, 0x40004000, v5
    v_cmp_ne_u32 vcc, 0, v6
    s_lshl_b32 s35, s39, 4
    s_add_u32 s35, s35, 160328
    v_mov_b32 v10, s35
    s_cmp_lg_u64 vcc, 0
    s_cselect_b32 s36, 1, s55
    v_mov_b32 v11, s36
    ds_write_b32 v10, v11
    s_waitcnt lgkmcnt(0)
    s_barrier
    s_cmp_lg_u32 s39, 0
    s_cbranch_scc1 L_p1_end
    v_and_b32 v6, 15, v0
    v_lshlrev_b32 v6, 4, v6
    v_add_u32 v6, 160320, v6
    ds_read_b128 v[8:11], v6
    s_waitcnt lgkmcnt(0)
    s_nop 1
    v_max_u32_dpp v8, v8, v8 row_shr:1 row_mask:0xf bank_mask:0xf bound_ctrl:0
    s_nop 1
    v_max_u32_dpp v8, v8, v8 row_shr:2 row_mask:0xf bank_mask:0xf bound_ctrl:0
    s_nop 1
    v_max_u32_dpp v8, v8, v8 row_shr:4 row_mask:0xf bank_mask:0xf bound_ctrl:0
    s_nop 1
    v_max_u32_dpp v8, v8, v8 row_shr:8 row_mask:0xf bank_mask:0xf bound_ctrl:0
    s_nop 1
    v_add_f32_dpp v9, v9, v9 row_shr:1 row_mask:0xf bank_mask:0xf bound_ctrl:0
    s_nop 1
    v_add_f32_dpp v9, v9, v9 row_shr:2 row_mask:0xf bank_mask:0xf bound_ctrl:0
    s_nop 1
    v_add_f32_dpp v9, v9, v9 row_shr:4 row_mask:0xf bank_mask:0xf bound_ctrl:0
    s_nop 1
    v_add_f32_dpp v9, v9, v9 row_shr:8 row_mask:0xf bank_mask:0xf bound_ctrl:0
    s_nop 1
    v_or_b32_dpp v10, v10, v10 row_shr:1 row_mask:0xf bank_mask:0xf bound_ctrl:0
    s_nop 1
    v_or_b32_dpp v10, v10, v10 row_shr:2 row_mask:0xf bank_mask:0xf bound_ctrl:0
    s_nop 1
    v_or_b32_dpp v10, v10, v10 row_shr:4 row_mask:0xf bank_mask:0xf bound_ctrl:0
    s_nop 1
    v_or_b32_dpp v10, v10, v10 row_shr:8 row_mask:0xf bank_mask:0xf bound_ctrl:0
    s_lshl_b32 s35, s2, 3
    s_add_u32 s35, s35, 8552960
    v_mov_b32 v6, 0
    v_lshl_or_b32 v8, v10, 16, v8
    s_mov_b64 exec, 0x8000
    buffer_store_dwordx2 v[8:9], v6, s[24:27], s35 offen
L_p1_end:
    s_endpgm
.globl p2_kernel
.p2align 8
.type p2_kernel,@function
p2_kernel:
    s_cmp_ge_u32 s2, 256
    s_cbranch_scc1 L_p2_end
    s_load_dwordx2 s[4:5], s[0:1], 104
    s_load_dwordx2 s[8:9], s[0:1], 0
    s_and_b32 s14, s2, 7
    s_lshr_b32 s49, s2, 3
    s_and_b32 s3, s14, 1
    s_lshl_b32 s3, s3, 5
    s_add_u32 s3, s3, s49
    s_lshr_b32 s12, s14, 1
    v_lshrrev_b32 v112, 6, v0
    v_lshlrev_b32 v1, 4, v0
    v_and_b32 v113, 63, v0
    v_readfirstlane_b32 s13, v112
    v_lshlrev_b32 v115, 4, v113
    s_mul_i32 s14, s12, 65
    s_add_u32 s14, s14, s3
    s_mul_i32 s14, s14, 32896
    s_add_u32 s25, s14, 246292480
    s_mul_i32 s22, s12, 1280000
    s_mov_b32 s2, 0
    s_waitcnt lgkmcnt(0)
    s_mov_b32 s6, 655360000
    s_mov_b32 s7, 0x00020000
    s_add_u32 s8, s4, 254853632
    s_addc_u32 s9, s5, 0
    s_add_u32 s10, s22, 1280000
    s_mov_b32 s11, 0x00020000
    s_add_u32 s15, s25, 0
    buffer_load_dwordx4 v[64:67], v1, s[4:7], s15 offen
    s_add_u32 s15, s25, 32896
    buffer_load_dwordx4 v[72:75], v1, s[4:7], s15 offen
    s_and_b32 s14, s49, 3
    s_lshl_b32 s14, s14, 8
    s_lshr_b32 s15, s49, 2
    s_lshl_b32 s15, s15, 14
    s_add_u32 s51, s14, s15
    s_add_u32 s14, s22, 0
    buffer_load_dwordx4 v[88:91], v1, s[8:11], s14 offen
    s_add_u32 s14, s22, 16384
    buffer_load_dwordx4 v[92:95], v1, s[8:11], s14 offen
    s_add_u32 s14, s22, 32768
    buffer_load_dwordx4 v[96:99], v1, s[8:11], s14 offen
    s_add_u32 s14, s22, 49152
    buffer_load_dwordx4 v[100:103], v1, s[8:11], s14 offen
    s_add_u32 s14, s22, 65536
    buffer_load_dwordx4 v[104:107], v1, s[8:11], s14 offen
    s_mov_b32 s15, 254845440
    buffer_load_dwordx4 v[80:83], v115, s[4:7], s15 offen offset:0
    buffer_load_dwordx4 v[84:87], v115, s[4:7], s15 offen offset:1024
    s_add_u32 s15, s25, 16384
    buffer_load_dwordx4 v[68:71], v1, s[4:7], s15 offen
    s_add_u32 s15, s25, 49280
    buffer_load_dwordx4 v[76:79], v1, s[4:7], s15 offen
    v_mul_u32_u24 v2, 12, v113
    v_add_u32 v2, 2816, v2
    v_add_u32 v3, 80000, v1
    v_add_u32 v124, 145536, v1
    v_add_u32 v117, 65536, v1
    v_mov_b32 v116, 0x7f000000
    v_cmp_gt_u32 vcc, 904, v0
    s_mul_i32 s19, s13, 240
    s_add_u32 s19, s19, 160000
    v_cndmask_b32 v124, v116, v124, vcc
    v_cndmask_b32 v117, v116, v117, vcc
    v_lshl_add_u32 v6, v113, 2, s19
    v_lshl_add_u32 v126, v113, 1, s19
    v_cmp_gt_u32 vcc, 14, v113
    s_mul_i32 s27, s13, 15392768
    s_mov_b32 s23, 240512
    v_cndmask_b32 v6, v116, v6, vcc
    s_mov_b32 s44, s4
    s_mov_b32 s45, s5
    s_add_u32 s46, s27, 15400960
    s_mov_b32 s47, 0x00020000
    s_mov_b32 s17, 0x05040100
    s_mov_b32 s18, 80000
    s_and_b32 s50, s3, 1
    s_lshl_b32 s50, s50, 18
    s_sub_u32 s50, 4294836224, s50
    s_mov_b32 s20, 3221209088
    s_mov_b32 s21, 3221209087
    v_mov_b32 v4, 0
    v_mov_b32 v5, 0
    v_mov_b32 v118, 448
    ds_write_b32 v6, v5 offset:160
    ds_write_b16 v126, v118 offset:2
    v_mov_b32 v108, 1073758208
    v_mov_b32 v109, 1073758208
    v_mov_b32 v110, 1073758208
    v_mov_b32 v111, 1073758208
    ds_write_b128 v1, v[108:111] offset:0
    ds_write_b128 v1, v[108:111] offset:16384
    ds_write_b128 v1, v[108:111] offset:32768
    ds_write_b128 v1, v[108:111] offset:49152
    ds_write_b128 v117, v[108:111]
    s_waitcnt vmcnt(9)
    v_mov_b32 v11, v64
    v_mov_b32 v43, v72
    v_mov_b32 v15, v65
    v_mov_b32 v47, v73
    v_mov_b32 v19, v66
    v_mov_b32 v51, v74
    v_mov_b32 v23, v67
    v_mov_b32 v55, v75
    v_add_u32_sdwa v113, 1, v43 dst_sel:DWORD dst_unused:UNUSED_PAD src0_sel:DWORD src1_sel:WORD_0
    v_lshrrev_b32_sdwa v112, 1, v11 dst_sel:DWORD dst_unused:UNUSED_PAD src0_sel:DWORD src1_sel:WORD_0
    v_lshrrev_b32 v113, 1, v113
    v_sub_u32 v114, v113, v112
    v_add_u32 v113, 448, v113
    s_nop 0
    v_add_u32_dpp v114, v114, v114 row_shr:1 row_mask:0xf bank_mask:0xf bound_ctrl:0
    s_nop 1
    v_add_u32_dpp v114, v114, v114 row_shr:2 row_mask:0xf bank_mask:0xf bound_ctrl:0
    s_nop 1
    v_add_u32_dpp v114, v114, v114 row_shr:4 row_mask:0xf bank_mask:0xf bound_ctrl:0
    s_nop 1
    v_add_u32_dpp v114, v114, v114 row_shr:8 row_mask:0xf bank_mask:0xf bound_ctrl:0
    s_nop 1
    v_add_u32_dpp v114, v114, v114 row_bcast:15 row_mask:0xa bank_mask:0xf
    s_nop 1
    v_add_u32_dpp v114, v114, v114 row_bcast:31 row_mask:0xc bank_mask:0xf
    v_sub_u32 v113, v113, v114
    v_readlane_b32 s56, v114, 63
    v_add_u32 v114, -1, v114
    ds_write_b16 v126, v113
    v_lshlrev_b32_e64 v115, v114, 1
    v_lshrrev_b32 v114, 5, v114
    v_lshl_add_u32 v114, v114, 2, s19
    s_cmp_gt_u32 s56, 448
    s_cselect_b32 s2, 1, s2
    s_cselect_b64 exec, 0, -1
    ds_or_b32 v114, v115 offset:160
    s_mov_b64 exec, -1
    ds_wrxchg_rtn_b32 v7, v6, v5 offset:160
    s_waitcnt lgkmcnt(0)
    v_readlane_b32 s30, v7, 0
    v_readlane_b32 s31, v7, 1
    v_readlane_b32 s32, v7, 2
    v_readlane_b32 s33, v7, 3
    v_readlane_b32 s34, v7, 4
    v_readlane_b32 s35, v7, 5
    v_readlane_b32 s36, v7, 6
    v_readlane_b32 s37, v7, 7
    v_readlane_b32 s38, v7, 8
    v_readlane_b32 s39, v7, 9
    v_readlane_b32 s40, v7, 10
    v_readlane_b32 s41, v7, 11
    s_mov_b32 s25, s19
    s_mov_b32 s26, s27
    s_mov_b32 s28, s56
    v_mbcnt_lo_u32_b32 v8, s30, 0
    v_mbcnt_hi_u32_b32 v8, s31, v8
    s_bcnt1_i32_b64 s14, s[30:31]
    v_lshl_add_u32 v9, v8, 1, s25
    ds_read_u16 v9, v9
    v_mad_u32_u24 v8, v8, s23, v2
    s_mov_b32 s30, s26
    s_lshl1_add_u32 s25, s14, s25
    s_mul_i32 s14, s14, s23
    s_add_u32 s26, s26, s14
    v_mbcnt_lo_u32_b32 v12, s32, 0
    v_mbcnt_hi_u32_b32 v12, s33, v12
    s_bcnt1_i32_b64 s14, s[32:33]
    v_lshl_add_u32 v13, v12, 1, s25
    ds_read_u16 v13, v13
    v_mad_u32_u24 v12, v12, s23, v2
    s_mov_b32 s32, s26
    s_lshl1_add_u32 s25, s14, s25
    s_mul_i32 s14, s14, s23
    s_add_u32 s26, s26, s14
    v_mbcnt_lo_u32_b32 v16, s34, 0
    v_mbcnt_hi_u32_b32 v16, s35, v16
    s_bcnt1_i32_b64 s14, s[34:35]
    v_lshl_add_u32 v17, v16, 1, s25
    ds_read_u16 v17, v17
    v_mad_u32_u24 v16, v16, s23, v2
    s_mov_b32 s34, s26
    s_lshl1_add_u32 s25, s14, s25
    s_mul_i32 s14, s14, s23
    s_add_u32 s26, s26, s14
    v_mbcnt_lo_u32_b32 v20, s36, 0
    v_mbcnt_hi_u32_b32 v20, s37, v20
    s_bcnt1_i32_b64 s14, s[36:37]
    v_lshl_add_u32 v21, v20, 1, s25
    ds_read_u16 v21, v21
    v_mad_u32_u24 v20, v20, s23, v2
    s_mov_b32 s36, s26
    s_lshl1_add_u32 s25, s14, s25
    s_mul_i32 s14, s14, s23
    s_add_u32 s26, s26, s14
    v_mbcnt_lo_u32_b32 v24, s38, 0
    v_mbcnt_hi_u32_b32 v24, s39, v24
    s_bcnt1_i32_b64 s14, s[38:39]
    v_lshl_add_u32 v25, v24, 1, s25
    ds_read_u16 v25, v25
    v_mad_u32_u24 v24, v24, s23, v2
    s_mov_b32 s38, s26
    s_lshl1_add_u32 s25, s14, s25
    s_mul_i32 s14, s14, s23
    s_add_u32 s26, s26, s14
    v_mbcnt_lo_u32_b32 v28, s40, 0
    v_mbcnt_hi_u32_b32 v28, s41, v28
    s_bcnt1_i32_b64 s14, s[40:41]
    v_lshl_add_u32 v29, v28, 1, s25
    ds_read_u16 v29, v29
    v_mad_u32_u24 v28, v28, s23, v2
    s_mov_b32 s40, s26
    s_lshl1_add_u32 s25, s14, s25
    s_mul_i32 s14, s14, s23
    s_add_u32 s26, s26, s14
    s_waitcnt lgkmcnt(5)
    v_mad_u32_u24 v8, v9, 12, v8
    buffer_load_dwordx3 v[8:10], v8, s[44:47], s30 offen offset:0
    s_waitcnt lgkmcnt(4)
    v_mad_u32_u24 v12, v13, 12, v12
    buffer_load_dwordx3 v[12:14], v12, s[44:47], s32 offen offset:768
    s_waitcnt lgkmcnt(3)
    v_mad_u32_u24 v16, v17, 12, v16
    buffer_load_dwordx3 v[16:18], v16, s[44:47], s34 offen offset:1536
    s_waitcnt lgkmcnt(2)
    v_mad_u32_u24 v20, v21, 12, v20
    buffer_load_dwordx3 v[20:22], v20, s[44:47], s36 offen offset:2304
    s_waitcnt lgkmcnt(1)
    v_mad_u32_u24 v24, v25, 12, v24
    buffer_load_dwordx3 v[24:26], v24, s[44:47], s38 offen offset:3072
    s_waitcnt lgkmcnt(0)
    v_mad_u32_u24 v28, v29, 12, v28
    buffer_load_dwordx3 v[28:30], v28, s[44:47], s40 offen offset:3840
    s_cmp_le_u32 s28, 384
    s_cbranch_scc1 L_p2_kernel_norare_1
    v_readlane_b32 s42, v7, 12
    v_readlane_b32 s43, v7, 13
    s_nop 1
    v_mbcnt_lo_u32_b32 v120, s42, 0
    v_mbcnt_hi_u32_b32 v120, s43, v120
    s_bcnt1_i32_b64 s14, s[42:43]
    v_lshl_add_u32 v121, v120, 1, s25
    ds_read_u16 v121, v121
    v_mad_u32_u24 v120, v120, s23, v2
    s_mov_b32 s42, s26
    s_lshl1_add_u32 s25, s14, s25
    s_mul_i32 s14, s14, s23
    s_add_u32 s26, s26, s14
    s_waitcnt lgkmcnt(0)
    s_add_u32 s42, s42, 4608
    v_mad_u32_u24 v120, v121, 12, v120
    buffer_load_dwordx3 v[32:34], v120, s[44:47], s42 offen offset:0
L_p2_kernel_norare_1:
    s_waitcnt vmcnt(10)
    ds_write_b128 v3, v[88:91] offset:0
    ds_write_b128 v3, v[92:95] offset:16384
    ds_write_b128 v3, v[96:99] offset:32768
    ds_write_b128 v3, v[100:103] offset:49152
    ds_write_b128 v124, v[104:107]
    s_waitcnt vmcnt(6)
    v_mov_b32 v27, v68
    v_mov_b32 v59, v76
    v_mov_b32 v31, v69
    v_mov_b32 v63, v77
    v_mov_b32 v35, v70
    v_mov_b32 v122, v78
    v_mov_b32 v39, v71
    v_mov_b32 v123, v79
    v_max3_u32 v36, v80, v82, v84
    v_add_f32 v37, v81, v83
    v_add_f32 v38, v85, v87
    v_max_u32 v36, v36, v86
    v_add_f32 v37, v37, v38
    v_cmp_lt_u32 vcc, 0xffff, v36
    s_nop 1
    v_max_u32_dpp v36, v36, v36 row_shr:1 row_mask:0xf bank_mask:0xf bound_ctrl:0
    s_nop 1
    v_max_u32_dpp v36, v36, v36 row_shr:2 row_mask:0xf bank_mask:0xf bound_ctrl:0
    s_nop 1
    v_max_u32_dpp v36, v36, v36 row_shr:4 row_mask:0xf bank_mask:0xf bound_ctrl:0
    s_nop 1
    v_max_u32_dpp v36, v36, v36 row_shr:8 row_mask:0xf bank_mask:0xf bound_ctrl:0
    s_nop 1
    v_max_u32_dpp v36, v36, v36 row_bcast:15 row_mask:0xa bank_mask:0xf
    s_nop 1
    v_max_u32_dpp v36, v36, v36 row_bcast:31 row_mask:0xc bank_mask:0xf
    s_nop 1
    v_add_f32_dpp v37, v37, v37 row_shr:1 row_mask:0xf bank_mask:0xf bound_ctrl:0
    s_nop 1
    v_add_f32_dpp v37, v37, v37 row_shr:2 row_mask:0xf bank_mask:0xf bound_ctrl:0
    s_nop 1
    v_add_f32_dpp v37, v37, v37 row_shr:4 row_mask:0xf bank_mask:0xf bound_ctrl:0
    s_nop 1
    v_add_f32_dpp v37, v37, v37 row_shr:8 row_mask:0xf bank_mask:0xf bound_ctrl:0
    s_nop 1
    v_add_f32_dpp v37, v37, v37 row_bcast:15 row_mask:0xa bank_mask:0xf
    s_nop 1
    v_add_f32_dpp v37, v37, v37 row_bcast:31 row_mask:0xc bank_mask:0xf
    s_cmp_lg_u64 vcc, 0
    s_cselect_b32 s2, 1, s2
    v_lshlrev_b32 v36, 16, v36
    v_mul_f32 v38, 936490775, v37
    v_mul_f32 v37, 928531664, v37
    v_cmp_nle_f32 vcc, v36, v38
    v_max_u32 v36, v36, v37
    s_nop 0
    v_readlane_b32 s14, v36, 63
    s_bitcmp1_b32 vcc_hi, 31
    s_cselect_b32 s2, 1, s2
    s_lshr_b32 s14, s14, 23
    s_add_u32 s14, s14, 1
    s_cmp_lt_u32 s14, 40
    s_cselect_b32 s2, 1, s2
    s_cmp_gt_u32 s14, 230
    s_cselect_b32 s2, 1, s2
    s_sub_u32 s48, s14, 14
    s_lshl_b32 s48, s48, 23
    s_add_u32 s16, s48, 197148672
    s_waitcnt lgkmcnt(0)
    s_barrier
    v_add_u32_sdwa v113, 1, v43 dst_sel:DWORD dst_unused:UNUSED_PAD src0_sel:DWORD src1_sel:WORD_1
    v_lshrrev_b32_sdwa v112, 1, v11 dst_sel:DWORD dst_unused:UNUSED_PAD src0_sel:DWORD src1_sel:WORD_1
    v_lshrrev_b32 v113, 1, v113
    v_sub_u32 v114, v113, v112
    v_add_u32 v113, 448, v113
    s_nop 0
    v_add_u32_dpp v114, v114, v114 row_shr:1 row_mask:0xf bank_mask:0xf bound_ctrl:0
    s_nop 1
    v_add_u32_dpp v114, v114, v114 row_shr:2 row_mask:0xf bank_mask:0xf bound_ctrl:0
    s_nop 1
    v_add_u32_dpp v114, v114, v114 row_shr:4 row_mask:0xf bank_mask:0xf bound_ctrl:0
    s_nop 1
    v_add_u32_dpp v114, v114, v114 row_shr:8 row_mask:0xf bank_mask:0xf bound_ctrl:0
    s_nop 1
    v_add_u32_dpp v114, v114, v114 row_bcast:15 row_mask:0xa bank_mask:0xf
    s_nop 1
    v_add_u32_dpp v114, v114, v114 row_bcast:31 row_mask:0xc bank_mask:0xf
    v_sub_u32 v113, v113, v114
    v_readlane_b32 s56, v114, 63
    v_add_u32 v114, -1, v114
    ds_write_b16 v126, v113
    v_lshlrev_b32_e64 v115, v114, 1
    v_lshrrev_b32 v114, 5, v114
    v_lshl_add_u32 v114, v114, 2, s19
    s_cmp_gt_u32 s56, 448
    s_cselect_b32 s2, 1, s2
    s_cselect_b64 exec, 0, -1
    ds_or_b32 v114, v115 offset:160
    s_mov_b64 exec, -1
    ds_wrxchg_rtn_b32 v7, v6, v5 offset:160
    s_waitcnt lgkmcnt(0)
    v_readlane_b32 s30, v7, 0
    v_readlane_b32 s31, v7, 1
    v_readlane_b32 s32, v7, 2
    v_readlane_b32 s33, v7, 3
    v_readlane_b32 s34, v7, 4
    v_readlane_b32 s35, v7, 5
    v_readlane_b32 s36, v7, 6
    v_readlane_b32 s37, v7, 7
    v_readlane_b32 s38, v7, 8
    v_readlane_b32 s39, v7, 9
    v_readlane_b32 s40, v7, 10
    v_readlane_b32 s41, v7, 11
    s_mov_b32 s25, s19
    s_mov_b32 s26, s27
    s_mov_b32 s29, s56
    v_mbcnt_lo_u32_b32 v36, s30, 0
    v_mbcnt_hi_u32_b32 v36, s31, v36
    s_bcnt1_i32_b64 s14, s[30:31]
    v_lshl_add_u32 v37, v36, 1, s25
    ds_read_u16 v37, v37
    v_mad_u32_u24 v36, v36, s23, v2
    s_mov_b32 s30, s26
    s_lshl1_add_u32 s25, s14, s25
    s_mul_i32 s14, s14, s23
    s_add_u32 s26, s26, s14
    v_mbcnt_lo_u32_b32 v40, s32, 0
    v_mbcnt_hi_u32_b32 v40, s33, v40
    s_bcnt1_i32_b64 s14, s[32:33]
    v_lshl_add_u32 v41, v40, 1, s25
    ds_read_u16 v41, v41
    v_mad_u32_u24 v40, v40, s23, v2
    s_mov_b32 s32, s26
    s_lshl1_add_u32 s25, s14, s25
    s_mul_i32 s14, s14, s23
    s_add_u32 s26, s26, s14
    v_mbcnt_lo_u32_b32 v44, s34, 0
    v_mbcnt_hi_u32_b32 v44, s35, v44
    s_bcnt1_i32_b64 s14, s[34:35]
    v_lshl_add_u32 v45, v44, 1, s25
    ds_read_u16 v45, v45
    v_mad_u32_u24 v44, v44, s23, v2
    s_mov_b32 s34, s26
    s_lshl1_add_u32 s25, s14, s25
    s_mul_i32 s14, s14, s23
    s_add_u32 s26, s26, s14
    v_mbcnt_lo_u32_b32 v48, s36, 0
    v_mbcnt_hi_u32_b32 v48, s37, v48
    s_bcnt1_i32_b64 s14, s[36:37]
    v_lshl_add_u32 v49, v48, 1, s25
    ds_read_u16 v49, v49
    v_mad_u32_u24 v48, v48, s23, v2
    s_mov_b32 s36, s26
    s_lshl1_add_u32 s25, s14, s25
    s_mul_i32 s14, s14, s23
    s_add_u32 s26, s26, s14
    v_mbcnt_lo_u32_b32 v52, s38, 0
    v_mbcnt_hi_u32_b32 v52, s39, v52
    s_bcnt1_i32_b64 s14, s[38:39]
    v_lshl_add_u32 v53, v52, 1, s25
    ds_read_u16 v53, v53
    v_mad_u32_u24 v52, v52, s23, v2
    s_mov_b32 s38, s26
    s_lshl1_add_u32 s25, s14, s25
    s_mul_i32 s14, s14, s23
    s_add_u32 s26, s26, s14
    v_mbcnt_lo_u32_b32 v56, s40, 0
    v_mbcnt_hi_u32_b32 v56, s41, v56
    s_bcnt1_i32_b64 s14, s[40:41]
    v_lshl_add_u32 v57, v56, 1, s25
    ds_read_u16 v57, v57
    v_mad_u32_u24 v56, v56, s23, v2
    s_mov_b32 s40, s26
    s_lshl1_add_u32 s25, s14, s25
    s_mul_i32 s14, s14, s23
    s_add_u32 s26, s26, s14
    s_waitcnt lgkmcnt(5)
    v_mad_u32_u24 v36, v37, 12, v36
    buffer_load_dwordx3 v[36:38], v36, s[44:47], s30 offen offset:0
    s_waitcnt lgkmcnt(4)
    v_mad_u32_u24 v40, v41, 12, v40
    buffer_load_dwordx3 v[40:42], v40, s[44:47], s32 offen offset:768
    s_waitcnt lgkmcnt(3)
    v_mad_u32_u24 v44, v45, 12, v44
    buffer_load_dwordx3 v[44:46], v44, s[44:47], s34 offen offset:1536
    s_waitcnt lgkmcnt(2)
    v_mad_u32_u24 v48, v49, 12, v48
    buffer_load_dwordx3 v[48:50], v48, s[44:47], s36 offen offset:2304
    s_waitcnt lgkmcnt(1)
    v_mad_u32_u24 v52, v53, 12, v52
    buffer_load_dwordx3 v[52:54], v52, s[44:47], s38 offen offset:3072
    s_waitcnt lgkmcnt(0)
    v_mad_u32_u24 v56, v57, 12, v56
    buffer_load_dwordx3 v[56:58], v56, s[44:47], s40 offen offset:3840
    s_cmp_le_u32 s29, 384
    s_cbranch_scc1 L_p2_kernel_norare_2
    v_readlane_b32 s42, v7, 12
    v_readlane_b32 s43, v7, 13
    s_nop 1
    v_mbcnt_lo_u32_b32 v120, s42, 0
    v_mbcnt_hi_u32_b32 v120, s43, v120
    s_bcnt1_i32_b64 s14, s[42:43]
    v_lshl_add_u32 v121, v120, 1, s25
    ds_read_u16 v121, v121
    v_mad_u32_u24 v120, v120, s23, v2
    s_mov_b32 s42, s26
    s_lshl1_add_u32 s25, s14, s25
    s_mul_i32 s14, s14, s23
    s_add_u32 s26, s26, s14
    s_waitcnt lgkmcnt(0)
    s_add_u32 s42, s42, 4608
    v_mad_u32_u24 v120, v121, 12, v120
    buffer_load_dwordx3 v[60:62], v120, s[44:47], s42 offen offset:0
L_p2_kernel_norare_2:
    v_mov_b32 v11, v15
    v_mov_b32 v43, v47
    v_mov_b32 v15, v19
    v_mov_b32 v47, v51
    v_mov_b32 v19, v23
    v_mov_b32 v51, v55
    v_mov_b32 v23, v27
    v_mov_b32 v55, v59
    v_mov_b32 v27, v31
    v_mov_b32 v59, v63
    v_mov_b32 v31, v35
    v_mov_b32 v63, v122
    v_mov_b32 v35, v39
    v_mov_b32 v122, v123
    v_mov_b32 v39, 0
    v_mov_b32 v123, 0
    v_add_u32_sdwa v113, 1, v43 dst_sel:DWORD dst_unused:UNUSED_PAD src0_sel:DWORD src1_sel:WORD_0
    v_lshrrev_b32_sdwa v112, 1, v11 dst_sel:DWORD dst_unused:UNUSED_PAD src0_sel:DWORD src1_sel:WORD_0
    v_lshrrev_b32 v113, 1, v113
    v_sub_u32 v114, v113, v112
    v_add_u32 v113, 448, v113
    s_nop 0
    v_add_u32_dpp v114, v114, v114 row_shr:1 row_mask:0xf bank_mask:0xf bound_ctrl:0
    s_nop 1
    v_add_u32_dpp v114, v114, v114 row_shr:2 row_mask:0xf bank_mask:0xf bound_ctrl:0
    s_nop 1
    v_add_u32_dpp v114, v114, v114 row_shr:4 row_mask:0xf bank_mask:0xf bound_ctrl:0
    s_nop 1
    v_add_u32_dpp v114, v114, v114 row_shr:8 row_mask:0xf bank_mask:0xf bound_ctrl:0
    s_nop 1
    v_add_u32_dpp v114, v114, v114 row_bcast:15 row_mask:0xa bank_mask:0xf
    s_nop 1
    v_add_u32_dpp v114, v114, v114 row_bcast:31 row_mask:0xc bank_mask:0xf
    v_sub_u32 v113, v113, v114
    v_readlane_b32 s56, v114, 63
    v_add_u32 v114, -1, v114
    ds_write_b16 v126, v113
    v_lshlrev_b32_e64 v115, v114, 1
    v_lshrrev_b32 v114, 5, v114
    v_lshl_add_u32 v114, v114, 2, s19
    s_cmp_gt_u32 s56, 448
    s_cselect_b32 s2, 1, s2
    s_cselect_b64 exec, 0, -1
    ds_or_b32 v114, v115 offset:160
    s_mov_b64 exec, -1
    ds_wrxchg_rtn_b32 v7, v6, v5 offset:160
    s_mov_b32 s24, 0
L_p2_loop:
    s_cmp_le_u32 s28, 384
    s_cbranch_scc1 L_p2_kernel_norare2_3
    s_waitcnt vmcnt(0)
    v_mad_u32_u16 v64, v32, 8, s18
    v_mad_u32_u16 v66, v33, 8, s18
    ds_read_b64 v[64:65], v64
    ds_read_b64 v[66:67], v66
    v_and_b32 v112, 0xffff, v34
    v_lshrrev_b32 v114, 16, v34
    v_lshlrev_b32 v113, 16, v34
    v_and_b32 v34, 0xffff0000, v34
    v_mad_u32_u16 v32, v32, 8, s50 op_sel:[1,0,0,0]
    v_mad_u32_u16 v33, v33, 8, s50 op_sel:[1,0,0,0]
    s_waitcnt lgkmcnt(0)
    v_dot2_f32_bf16 v115, v64, v112, s16
    v_dot2_f32_bf16 v64, v64, v113, s16
    v_dot2_f32_bf16 v116, v65, v112, s16
    v_dot2_f32_bf16 v65, v65, v113, s16
    v_dot2_f32_bf16 v117, v66, v114, s16
    v_dot2_f32_bf16 v66, v66, v34, s16
    v_dot2_f32_bf16 v118, v67, v114, s16
    v_dot2_f32_bf16 v67, v67, v34, s16
    v_perm_b32 v64, v64, v115, s17
    v_perm_b32 v65, v65, v116, s17
    v_perm_b32 v66, v66, v117, s17
    v_perm_b32 v67, v67, v118, s17
    v_lshl_add_u64 v[64:65], v[64:65], 0, s[20:21]
    v_lshl_add_u64 v[66:67], v[66:67], 0, s[20:21]
    v_or3_b32 v4, v108, v109, v4
    v_or3_b32 v4, v110, v111, v4
    ds_add_rtn_u64 v[108:109], v32, v[64:65]
    ds_add_rtn_u64 v[110:111], v33, v[66:67]
    s_waitcnt lgkmcnt(0)
L_p2_kernel_norare2_3:
    s_add_u32 s22, s22, 80000
    s_cmp_eq_u32 s24, 7
    s_cselect_b32 s46, 0, s46
    s_waitcnt vmcnt(6)
    v_mad_u32_u16 v64, v8, 8, s18
    v_mad_u32_u16 v66, v9, 8, s18
    ds_read_b64 v[64:65], v64
    ds_read_b64 v[66:67], v66
    s_add_u32 s14, s22, 0
    buffer_load_dwordx4 v[88:91], v1, s[8:11], s14 offen
    v_mad_u32_u16 v68, v12, 8, s18
    v_mad_u32_u16 v70, v13, 8, s18
    ds_read_b64 v[68:69], v68
    ds_read_b64 v[70:71], v70
    s_add_u32 s14, s22, 16384
    buffer_load_dwordx4 v[92:95], v1, s[8:11], s14 offen
    v_mad_u32_u16 v72, v16, 8, s18
    v_mad_u32_u16 v74, v17, 8, s18
    ds_read_b64 v[72:73], v72
    ds_read_b64 v[74:75], v74
    s_add_u32 s14, s22, 32768
    buffer_load_dwordx4 v[96:99], v1, s[8:11], s14 offen
    v_mad_u32_u16 v76, v20, 8, s18
    v_mad_u32_u16 v78, v21, 8, s18
    ds_read_b64 v[76:77], v76
    ds_read_b64 v[78:79], v78
    s_add_u32 s14, s22, 49152
    buffer_load_dwordx4 v[100:103], v1, s[8:11], s14 offen
    v_mad_u32_u16 v80, v24, 8, s18
    v_mad_u32_u16 v82, v25, 8, s18
    ds_read_b64 v[80:81], v80
    ds_read_b64 v[82:83], v82
    s_add_u32 s14, s22, 65536
    buffer_load_dwordx4 v[104:107], v1, s[8:11], s14 offen
    v_mad_u32_u16 v84, v28, 8, s18
    v_mad_u32_u16 v86, v29, 8, s18
    ds_read_b64 v[84:85], v84
    ds_read_b64 v[86:87], v86
    s_waitcnt lgkmcnt(12)
    v_readlane_b32 s30, v7, 0
    v_readlane_b32 s31, v7, 1
    v_readlane_b32 s32, v7, 2
    v_readlane_b32 s33, v7, 3
    v_readlane_b32 s34, v7, 4
    v_readlane_b32 s35, v7, 5
    v_readlane_b32 s36, v7, 6
    v_readlane_b32 s37, v7, 7
    v_readlane_b32 s38, v7, 8
    v_readlane_b32 s39, v7, 9
    v_readlane_b32 s40, v7, 10
    v_readlane_b32 s41, v7, 11
    s_mov_b32 s25, s19
    s_mov_b32 s26, s27
    s_mov_b32 s28, s56
    v_mbcnt_lo_u32_b32 v120, s30, 0
    v_mbcnt_hi_u32_b32 v120, s31, v120
    s_bcnt1_i32_b64 s14, s[30:31]
    v_lshl_add_u32 v121, v120, 1, s25
    ds_read_u16 v121, v121
    v_mad_u32_u24 v120, v120, s23, v2
    s_mov_b32 s30, s26
    s_lshl1_add_u32 s25, s14, s25
    s_mul_i32 s14, s14, s23
    s_add_u32 s26, s26, s14
    v_and_b32 v112, 0xffff, v10
    v_lshrrev_b32 v114, 16, v10
    v_lshlrev_b32 v113, 16, v10
    v_and_b32 v10, 0xffff0000, v10
    v_mad_u32_u16 v8, v8, 8, s50 op_sel:[1,0,0,0]
    v_mad_u32_u16 v9, v9, 8, s50 op_sel:[1,0,0,0]
    s_waitcnt lgkmcnt(11)
    v_dot2_f32_bf16 v115, v64, v112, s16
    v_dot2_f32_bf16 v64, v64, v113, s16
    v_dot2_f32_bf16 v116, v65, v112, s16
    v_dot2_f32_bf16 v65, v65, v113, s16
    v_dot2_f32_bf16 v117, v66, v114, s16
    v_dot2_f32_bf16 v66, v66, v10, s16
    v_dot2_f32_bf16 v118, v67, v114, s16
    v_dot2_f32_bf16 v67, v67, v10, s16
    v_perm_b32 v64, v64, v115, s17
    v_perm_b32 v65, v65, v116, s17
    v_perm_b32 v66, v66, v117, s17
    v_perm_b32 v67, v67, v118, s17
    v_lshl_add_u64 v[64:65], v[64:65], 0, s[20:21]
    v_lshl_add_u64 v[66:67], v[66:67], 0, s[20:21]
    v_or3_b32 v4, v108, v109, v4
    v_or3_b32 v4, v110, v111, v4
    ds_add_rtn_u64 v[108:109], v8, v[64:65]
    ds_add_rtn_u64 v[110:111], v9, v[66:67]
    s_waitcnt lgkmcnt(2)
    v_mad_u32_u24 v120, v121, 12, v120
    buffer_load_dwordx3 v[8:10], v120, s[44:47], s30 offen offset:0
    v_mbcnt_lo_u32_b32 v120, s32, 0
    v_mbcnt_hi_u32_b32 v120, s33, v120
    s_bcnt1_i32_b64 s14, s[32:33]
    v_lshl_add_u32 v121, v120, 1, s25
    ds_read_u16 v121, v121
    v_mad_u32_u24 v120, v120, s23, v2
    s_mov_b32 s32, s26
    s_lshl1_add_u32 s25, s14, s25
    s_mul_i32 s14, s14, s23
    s_add_u32 s26, s26, s14
    v_and_b32 v112, 0xffff, v14
    v_lshrrev_b32 v114, 16, v14
    v_lshlrev_b32 v113, 16, v14
    v_and_b32 v14, 0xffff0000, v14
    v_mad_u32_u16 v12, v12, 8, s50 op_sel:[1,0,0,0]
    v_mad_u32_u16 v13, v13, 8, s50 op_sel:[1,0,0,0]
    v_dot2_f32_bf16 v115, v68, v112, s16
    v_dot2_f32_bf16 v68, v68, v113, s16
    v_dot2_f32_bf16 v116, v69, v112, s16
    v_dot2_f32_bf16 v69, v69, v113, s16
    v_dot2_f32_bf16 v117, v70, v114, s16
    v_dot2_f32_bf16 v70, v70, v14, s16
    v_dot2_f32_bf16 v118, v71, v114, s16
    v_dot2_f32_bf16 v71, v71, v14, s16
    v_perm_b32 v68, v68, v115, s17
    v_perm_b32 v69, v69, v116, s17
    v_perm_b32 v70, v70, v117, s17
    v_perm_b32 v71, v71, v118, s17
    v_lshl_add_u64 v[68:69], v[68:69], 0, s[20:21]
    v_lshl_add_u64 v[70:71], v[70:71], 0, s[20:21]
    s_waitcnt lgkmcnt(1)
    v_or3_b32 v4, v108, v109, v4
    v_or3_b32 v4, v110, v111, v4
    ds_add_rtn_u64 v[108:109], v12, v[68:69]
    ds_add_rtn_u64 v[110:111], v13, v[70:71]
    s_waitcnt lgkmcnt(2)
    v_mad_u32_u24 v120, v121, 12, v120
    buffer_load_dwordx3 v[12:14], v120, s[44:47], s32 offen offset:768
    v_mbcnt_lo_u32_b32 v120, s34, 0
    v_mbcnt_hi_u32_b32 v120, s35, v120
    s_bcnt1_i32_b64 s14, s[34:35]
    v_lshl_add_u32 v121, v120, 1, s25
    ds_read_u16 v121, v121
    v_mad_u32_u24 v120, v120, s23, v2
    s_mov_b32 s34, s26
    s_lshl1_add_u32 s25, s14, s25
    s_mul_i32 s14, s14, s23
    s_add_u32 s26, s26, s14
    v_and_b32 v112, 0xffff, v18
    v_lshrrev_b32 v114, 16, v18
    v_lshlrev_b32 v113, 16, v18
    v_and_b32 v18, 0xffff0000, v18
    v_mad_u32_u16 v16, v16, 8, s50 op_sel:[1,0,0,0]
    v_mad_u32_u16 v17, v17, 8, s50 op_sel:[1,0,0,0]
    v_dot2_f32_bf16 v115, v72, v112, s16
    v_dot2_f32_bf16 v72, v72, v113, s16
    v_dot2_f32_bf16 v116, v73, v112, s16
    v_dot2_f32_bf16 v73, v73, v113, s16
    v_dot2_f32_bf16 v117, v74, v114, s16
    v_dot2_f32_bf16 v74, v74, v18, s16
    v_dot2_f32_bf16 v118, v75, v114, s16
    v_dot2_f32_bf16 v75, v75, v18, s16
    v_perm_b32 v72, v72, v115, s17
    v_perm_b32 v73, v73, v116, s17
    v_perm_b32 v74, v74, v117, s17
    v_perm_b32 v75, v75, v118, s17
    v_lshl_add_u64 v[72:73], v[72:73], 0, s[20:21]
    v_lshl_add_u64 v[74:75], v[74:75], 0, s[20:21]
    s_waitcnt lgkmcnt(1)
    v_or3_b32 v4, v108, v109, v4
    v_or3_b32 v4, v110, v111, v4
    ds_add_rtn_u64 v[108:109], v16, v[72:73]
    ds_add_rtn_u64 v[110:111], v17, v[74:75]
    s_waitcnt lgkmcnt(2)
    v_mad_u32_u24 v120, v121, 12, v120
    buffer_load_dwordx3 v[16:18], v120, s[44:47], s34 offen offset:1536
    s_barrier
    s_waitcnt vmcnt(3)
    ds_write_b128 v3, v[88:91] offset:0
    ds_write_b128 v3, v[92:95] offset:16384
    ds_write_b128 v3, v[96:99] offset:32768
    ds_write_b128 v3, v[100:103] offset:49152
    ds_write_b128 v124, v[104:107]
    v_mbcnt_lo_u32_b32 v120, s36, 0
    v_mbcnt_hi_u32_b32 v120, s37, v120
    s_bcnt1_i32_b64 s14, s[36:37]
    v_lshl_add_u32 v121, v120, 1, s25
    ds_read_u16 v121, v121
    v_mad_u32_u24 v120, v120, s23, v2
    s_mov_b32 s36, s26
    s_lshl1_add_u32 s25, s14, s25
    s_mul_i32 s14, s14, s23
    s_add_u32 s26, s26, s14
    v_and_b32 v112, 0xffff, v22
    v_lshrrev_b32 v114, 16, v22
    v_lshlrev_b32 v113, 16, v22
    v_and_b32 v22, 0xffff0000, v22
    v_mad_u32_u16 v20, v20, 8, s50 op_sel:[1,0,0,0]
    v_mad_u32_u16 v21, v21, 8, s50 op_sel:[1,0,0,0]
    v_dot2_f32_bf16 v115, v76, v112, s16
    v_dot2_f32_bf16 v76, v76, v113, s16
    v_dot2_f32_bf16 v116, v77, v112, s16
    v_dot2_f32_bf16 v77, v77, v113, s16
    v_dot2_f32_bf16 v117, v78, v114, s16
    v_dot2_f32_bf16 v78, v78, v22, s16
    v_dot2_f32_bf16 v118, v79, v114, s16
    v_dot2_f32_bf16 v79, v79, v22, s16
    v_perm_b32 v76, v76, v115, s17
    v_perm_b32 v77, v77, v116, s17
    v_perm_b32 v78, v78, v117, s17
    v_perm_b32 v79, v79, v118, s17
    v_lshl_add_u64 v[76:77], v[76:77], 0, s[20:21]
    v_lshl_add_u64 v[78:79], v[78:79], 0, s[20:21]
    s_waitcnt lgkmcnt(6)
    v_or3_b32 v4, v108, v109, v4
    v_or3_b32 v4, v110, v111, v4
    ds_add_rtn_u64 v[108:109], v20, v[76:77]
    ds_add_rtn_u64 v[110:111], v21, v[78:79]
    s_waitcnt lgkmcnt(2)
    v_mad_u32_u24 v120, v121, 12, v120
    buffer_load_dwordx3 v[20:22], v120, s[44:47], s36 offen offset:2304
    v_mbcnt_lo_u32_b32 v120, s38, 0
    v_mbcnt_hi_u32_b32 v120, s39, v120
    s_bcnt1_i32_b64 s14, s[38:39]
    v_lshl_add_u32 v121, v120, 1, s25
    ds_read_u16 v121, v121
    v_mad_u32_u24 v120, v120, s23, v2
    s_mov_b32 s38, s26
    s_lshl1_add_u32 s25, s14, s25
    s_mul_i32 s14, s14, s23
    s_add_u32 s26, s26, s14
    v_and_b32 v112, 0xffff, v26
    v_lshrrev_b32 v114, 16, v26
    v_lshlrev_b32 v113, 16, v26
    v_and_b32 v26, 0xffff0000, v26
    v_mad_u32_u16 v24, v24, 8, s50 op_sel:[1,0,0,0]
    v_mad_u32_u16 v25, v25, 8, s50 op_sel:[1,0,0,0]
    v_dot2_f32_bf16 v115, v80, v112, s16
    v_dot2_f32_bf16 v80, v80, v113, s16
    v_dot2_f32_bf16 v116, v81, v112, s16
    v_dot2_f32_bf16 v81, v81, v113, s16
    v_dot2_f32_bf16 v117, v82, v114, s16
    v_dot2_f32_bf16 v82, v82, v26, s16
    v_dot2_f32_bf16 v118, v83, v114, s16
    v_dot2_f32_bf16 v83, v83, v26, s16
    v_perm_b32 v80, v80, v115, s17
    v_perm_b32 v81, v81, v116, s17
    v_perm_b32 v82, v82, v117, s17
    v_perm_b32 v83, v83, v118, s17
    v_lshl_add_u64 v[80:81], v[80:81], 0, s[20:21]
    v_lshl_add_u64 v[82:83], v[82:83], 0, s[20:21]
    s_waitcnt lgkmcnt(1)
    v_or3_b32 v4, v108, v109, v4
    v_or3_b32 v4, v110, v111, v4
    ds_add_rtn_u64 v[108:109], v24, v[80:81]
    ds_add_rtn_u64 v[110:111], v25, v[82:83]
    s_waitcnt lgkmcnt(2)
    v_mad_u32_u24 v120, v121, 12, v120
    buffer_load_dwordx3 v[24:26], v120, s[44:47], s38 offen offset:3072
    v_mbcnt_lo_u32_b32 v120, s40, 0
    v_mbcnt_hi_u32_b32 v120, s41, v120
    s_bcnt1_i32_b64 s14, s[40:41]
    v_lshl_add_u32 v121, v120, 1, s25
    ds_read_u16 v121, v121
    v_mad_u32_u24 v120, v120, s23, v2
    s_mov_b32 s40, s26
    s_lshl1_add_u32 s25, s14, s25
    s_mul_i32 s14, s14, s23
    s_add_u32 s26, s26, s14
    v_and_b32 v112, 0xffff, v30
    v_lshrrev_b32 v114, 16, v30
    v_lshlrev_b32 v113, 16, v30
    v_and_b32 v30, 0xffff0000, v30
    v_mad_u32_u16 v28, v28, 8, s50 op_sel:[1,0,0,0]
    v_mad_u32_u16 v29, v29, 8, s50 op_sel:[1,0,0,0]
    v_dot2_f32_bf16 v115, v84, v112, s16
    v_dot2_f32_bf16 v84, v84, v113, s16
    v_dot2_f32_bf16 v116, v85, v112, s16
    v_dot2_f32_bf16 v85, v85, v113, s16
    v_dot2_f32_bf16 v117, v86, v114, s16
    v_dot2_f32_bf16 v86, v86, v30, s16
    v_dot2_f32_bf16 v118, v87, v114, s16
    v_dot2_f32_bf16 v87, v87, v30, s16
    v_perm_b32 v84, v84, v115, s17
    v_perm_b32 v85, v85, v116, s17
    v_perm_b32 v86, v86, v117, s17
    v_perm_b32 v87, v87, v118, s17
    v_lshl_add_u64 v[84:85], v[84:85], 0, s[20:21]
    v_lshl_add_u64 v[86:87], v[86:87], 0, s[20:21]
    s_waitcnt lgkmcnt(1)
    v_or3_b32 v4, v108, v109, v4
    v_or3_b32 v4, v110, v111, v4
    ds_add_rtn_u64 v[108:109], v28, v[84:85]
    ds_add_rtn_u64 v[110:111], v29, v[86:87]
    s_waitcnt lgkmcnt(2)
    v_mad_u32_u24 v120, v121, 12, v120
    buffer_load_dwordx3 v[28:30], v120, s[44:47], s40 offen offset:3840
    s_cmp_le_u32 s28, 384
    s_cbranch_scc1 L_p2_kernel_norare_4
    v_readlane_b32 s42, v7, 12
    v_readlane_b32 s43, v7, 13
    s_nop 1
    v_mbcnt_lo_u32_b32 v120, s42, 0
    v_mbcnt_hi_u32_b32 v120, s43, v120
    s_bcnt1_i32_b64 s14, s[42:43]
    v_lshl_add_u32 v121, v120, 1, s25
    ds_read_u16 v121, v121
    v_mad_u32_u24 v120, v120, s23, v2
    s_mov_b32 s42, s26
    s_lshl1_add_u32 s25, s14, s25
    s_mul_i32 s14, s14, s23
    s_add_u32 s26, s26, s14
    s_waitcnt lgkmcnt(0)
    s_add_u32 s42, s42, 4608
    v_mad_u32_u24 v120, v121, 12, v120
    buffer_load_dwordx3 v[32:34], v120, s[44:47], s42 offen offset:0
L_p2_kernel_norare_4:
    v_add_u32_sdwa v113, 1, v43 dst_sel:DWORD dst_unused:UNUSED_PAD src0_sel:DWORD src1_sel:WORD_1
    v_lshrrev_b32_sdwa v112, 1, v11 dst_sel:DWORD dst_unused:UNUSED_PAD src0_sel:DWORD src1_sel:WORD_1
    v_lshrrev_b32 v113, 1, v113
    v_sub_u32 v114, v113, v112
    v_add_u32 v113, 448, v113
    s_nop 0
    v_add_u32_dpp v114, v114, v114 row_shr:1 row_mask:0xf bank_mask:0xf bound_ctrl:0
    s_nop 1
    v_add_u32_dpp v114, v114, v114 row_shr:2 row_mask:0xf bank_mask:0xf bound_ctrl:0
    s_nop 1
    v_add_u32_dpp v114, v114, v114 row_shr:4 row_mask:0xf bank_mask:0xf bound_ctrl:0
    s_nop 1
    v_add_u32_dpp v114, v114, v114 row_shr:8 row_mask:0xf bank_mask:0xf bound_ctrl:0
    s_nop 1
    v_add_u32_dpp v114, v114, v114 row_bcast:15 row_mask:0xa bank_mask:0xf
    s_nop 1
    v_add_u32_dpp v114, v114, v114 row_bcast:31 row_mask:0xc bank_mask:0xf
    v_sub_u32 v113, v113, v114
    v_readlane_b32 s56, v114, 63
    v_add_u32 v114, -1, v114
    ds_write_b16 v126, v113
    v_lshlrev_b32_e64 v115, v114, 1
    v_lshrrev_b32 v114, 5, v114
    v_lshl_add_u32 v114, v114, 2, s19
    s_cmp_gt_u32 s56, 448
    s_cselect_b32 s2, 1, s2
    s_cselect_b64 exec, 0, -1
    ds_or_b32 v114, v115 offset:160
    s_mov_b64 exec, -1
    ds_wrxchg_rtn_b32 v7, v6, v5 offset:160
    s_barrier
    s_cmp_le_u32 s29, 384
    s_cbranch_scc1 L_p2_kernel_norare2_5
    s_waitcnt vmcnt(0)
    v_mad_u32_u16 v64, v60, 8, s18
    v_mad_u32_u16 v66, v61, 8, s18
    ds_read_b64 v[64:65], v64
    ds_read_b64 v[66:67], v66
    v_and_b32 v112, 0xffff, v62
    v_lshrrev_b32 v114, 16, v62
    v_lshlrev_b32 v113, 16, v62
    v_and_b32 v62, 0xffff0000, v62
    v_mad_u32_u16 v60, v60, 8, s50 op_sel:[1,0,0,0]
    v_mad_u32_u16 v61, v61, 8, s50 op_sel:[1,0,0,0]
    s_waitcnt lgkmcnt(0)
    v_dot2_f32_bf16 v115, v64, v112, s16
    v_dot2_f32_bf16 v64, v64, v113, s16
    v_dot2_f32_bf16 v116, v65, v112, s16
    v_dot2_f32_bf16 v65, v65, v113, s16
    v_dot2_f32_bf16 v117, v66, v114, s16
    v_dot2_f32_bf16 v66, v66, v62, s16
    v_dot2_f32_bf16 v118, v67, v114, s16
    v_dot2_f32_bf16 v67, v67, v62, s16
    v_perm_b32 v64, v64, v115, s17
    v_perm_b32 v65, v65, v116, s17
    v_perm_b32 v66, v66, v117, s17
    v_perm_b32 v67, v67, v118, s17
    v_lshl_add_u64 v[64:65], v[64:65], 0, s[20:21]
    v_lshl_add_u64 v[66:67], v[66:67], 0, s[20:21]
    v_or3_b32 v4, v108, v109, v4
    v_or3_b32 v4, v110, v111, v4
    ds_add_rtn_u64 v[108:109], v60, v[64:65]
    ds_add_rtn_u64 v[110:111], v61, v[66:67]
    s_waitcnt lgkmcnt(0)
L_p2_kernel_norare2_5:
    s_add_u32 s22, s22, 80000
    v_mad_u32_u16 v64, v36, 8, s18
    v_mad_u32_u16 v66, v37, 8, s18
    ds_read_b64 v[64:65], v64
    ds_read_b64 v[66:67], v66
    s_add_u32 s14, s22, 0
    buffer_load_dwordx4 v[88:91], v1, s[8:11], s14 offen
    v_mad_u32_u16 v68, v40, 8, s18
    v_mad_u32_u16 v70, v41, 8, s18
    ds_read_b64 v[68:69], v68
    ds_read_b64 v[70:71], v70
    s_add_u32 s14, s22, 16384
    buffer_load_dwordx4 v[92:95], v1, s[8:11], s14 offen
    v_mad_u32_u16 v72, v44, 8, s18
    v_mad_u32_u16 v74, v45, 8, s18
    ds_read_b64 v[72:73], v72
    ds_read_b64 v[74:75], v74
    s_add_u32 s14, s22, 32768
    buffer_load_dwordx4 v[96:99], v1, s[8:11], s14 offen
    v_mad_u32_u16 v76, v48, 8, s18
    v_mad_u32_u16 v78, v49, 8, s18
    ds_read_b64 v[76:77], v76
    ds_read_b64 v[78:79], v78
    s_add_u32 s14, s22, 49152
    buffer_load_dwordx4 v[100:103], v1, s[8:11], s14 offen
    v_mad_u32_u16 v80, v52, 8, s18
    v_mad_u32_u16 v82, v53, 8, s18
    ds_read_b64 v[80:81], v80
    ds_read_b64 v[82:83], v82
    s_add_u32 s14, s22, 65536
    buffer_load_dwordx4 v[104:107], v1, s[8:11], s14 offen
    v_mad_u32_u16 v84, v56, 8, s18
    v_mad_u32_u16 v86, v57, 8, s18
    ds_read_b64 v[84:85], v84
    ds_read_b64 v[86:87], v86
    s_waitcnt lgkmcnt(12)
    v_readlane_b32 s30, v7, 0
    v_readlane_b32 s31, v7, 1
    v_readlane_b32 s32, v7, 2
    v_readlane_b32 s33, v7, 3
    v_readlane_b32 s34, v7, 4
    v_readlane_b32 s35, v7, 5
    v_readlane_b32 s36, v7, 6
    v_readlane_b32 s37, v7, 7
    v_readlane_b32 s38, v7, 8
    v_readlane_b32 s39, v7, 9
    v_readlane_b32 s40, v7, 10
    v_readlane_b32 s41, v7, 11
    s_mov_b32 s25, s19
    s_mov_b32 s26, s27
    s_mov_b32 s29, s56
    v_mbcnt_lo_u32_b32 v120, s30, 0
    v_mbcnt_hi_u32_b32 v120, s31, v120
    s_bcnt1_i32_b64 s14, s[30:31]
    v_lshl_add_u32 v121, v120, 1, s25
    ds_read_u16 v121, v121
    v_mad_u32_u24 v120, v120, s23, v2
    s_mov_b32 s30, s26
    s_lshl1_add_u32 s25, s14, s25
    s_mul_i32 s14, s14, s23
    s_add_u32 s26, s26, s14
    v_and_b32 v112, 0xffff, v38
    v_lshrrev_b32 v114, 16, v38
    v_lshlrev_b32 v113, 16, v38
    v_and_b32 v38, 0xffff0000, v38
    v_mad_u32_u16 v36, v36, 8, s50 op_sel:[1,0,0,0]
    v_mad_u32_u16 v37, v37, 8, s50 op_sel:[1,0,0,0]
    s_waitcnt lgkmcnt(11)
    v_dot2_f32_bf16 v115, v64, v112, s16
    v_dot2_f32_bf16 v64, v64, v113, s16
    v_dot2_f32_bf16 v116, v65, v112, s16
    v_dot2_f32_bf16 v65, v65, v113, s16
    v_dot2_f32_bf16 v117, v66, v114, s16
    v_dot2_f32_bf16 v66, v66, v38, s16
    v_dot2_f32_bf16 v118, v67, v114, s16
    v_dot2_f32_bf16 v67, v67, v38, s16
    v_perm_b32 v64, v64, v115, s17
    v_perm_b32 v65, v65, v116, s17
    v_perm_b32 v66, v66, v117, s17
    v_perm_b32 v67, v67, v118, s17
    v_lshl_add_u64 v[64:65], v[64:65], 0, s[20:21]
    v_lshl_add_u64 v[66:67], v[66:67], 0, s[20:21]
    v_or3_b32 v4, v108, v109, v4
    v_or3_b32 v4, v110, v111, v4
    ds_add_rtn_u64 v[108:109], v36, v[64:65]
    ds_add_rtn_u64 v[110:111], v37, v[66:67]
    s_waitcnt lgkmcnt(2)
    v_mad_u32_u24 v120, v121, 12, v120
    buffer_load_dwordx3 v[36:38], v120, s[44:47], s30 offen offset:0
    v_mbcnt_lo_u32_b32 v120, s32, 0
    v_mbcnt_hi_u32_b32 v120, s33, v120
    s_bcnt1_i32_b64 s14, s[32:33]
    v_lshl_add_u32 v121, v120, 1, s25
    ds_read_u16 v121, v121
    v_mad_u32_u24 v120, v120, s23, v2
    s_mov_b32 s32, s26
    s_lshl1_add_u32 s25, s14, s25
    s_mul_i32 s14, s14, s23
    s_add_u32 s26, s26, s14
    v_and_b32 v112, 0xffff, v42
    v_lshrrev_b32 v114, 16, v42
    v_lshlrev_b32 v113, 16, v42
    v_and_b32 v42, 0xffff0000, v42
    v_mad_u32_u16 v40, v40, 8, s50 op_sel:[1,0,0,0]
    v_mad_u32_u16 v41, v41, 8, s50 op_sel:[1,0,0,0]
    v_dot2_f32_bf16 v115, v68, v112, s16
    v_dot2_f32_bf16 v68, v68, v113, s16
    v_dot2_f32_bf16 v116, v69, v112, s16
    v_dot2_f32_bf16 v69, v69, v113, s16
    v_dot2_f32_bf16 v117, v70, v114, s16
    v_dot2_f32_bf16 v70, v70, v42, s16
    v_dot2_f32_bf16 v118, v71, v114, s16
    v_dot2_f32_bf16 v71, v71, v42, s16
    v_perm_b32 v68, v68, v115, s17
    v_perm_b32 v69, v69, v116, s17
    v_perm_b32 v70, v70, v117, s17
    v_perm_b32 v71, v71, v118, s17
    v_lshl_add_u64 v[68:69], v[68:69], 0, s[20:21]
    v_lshl_add_u64 v[70:71], v[70:71], 0, s[20:21]
    s_waitcnt lgkmcnt(1)
    v_or3_b32 v4, v108, v109, v4
    v_or3_b32 v4, v110, v111, v4
    ds_add_rtn_u64 v[108:109], v40, v[68:69]
    ds_add_rtn_u64 v[110:111], v41, v[70:71]
    s_waitcnt lgkmcnt(2)
    v_mad_u32_u24 v120, v121, 12, v120
    buffer_load_dwordx3 v[40:42], v120, s[44:47], s32 offen offset:768
    v_mbcnt_lo_u32_b32 v120, s34, 0
    v_mbcnt_hi_u32_b32 v120, s35, v120
    s_bcnt1_i32_b64 s14, s[34:35]
    v_lshl_add_u32 v121, v120, 1, s25
    ds_read_u16 v121, v121
    v_mad_u32_u24 v120, v120, s23, v2
    s_mov_b32 s34, s26
    s_lshl1_add_u32 s25, s14, s25
    s_mul_i32 s14, s14, s23
    s_add_u32 s26, s26, s14
    v_and_b32 v112, 0xffff, v46
    v_lshrrev_b32 v114, 16, v46
    v_lshlrev_b32 v113, 16, v46
    v_and_b32 v46, 0xffff0000, v46
    v_mad_u32_u16 v44, v44, 8, s50 op_sel:[1,0,0,0]
    v_mad_u32_u16 v45, v45, 8, s50 op_sel:[1,0,0,0]
    v_dot2_f32_bf16 v115, v72, v112, s16
    v_dot2_f32_bf16 v72, v72, v113, s16
    v_dot2_f32_bf16 v116, v73, v112, s16
    v_dot2_f32_bf16 v73, v73, v113, s16
    v_dot2_f32_bf16 v117, v74, v114, s16
    v_dot2_f32_bf16 v74, v74, v46, s16
    v_dot2_f32_bf16 v118, v75, v114, s16
    v_dot2_f32_bf16 v75, v75, v46, s16
    v_perm_b32 v72, v72, v115, s17
    v_perm_b32 v73, v73, v116, s17
    v_perm_b32 v74, v74, v117, s17
    v_perm_b32 v75, v75, v118, s17
    v_lshl_add_u64 v[72:73], v[72:73], 0, s[20:21]
    v_lshl_add_u64 v[74:75], v[74:75], 0, s[20:21]
    s_waitcnt lgkmcnt(1)
    v_or3_b32 v4, v108, v109, v4
    v_or3_b32 v4, v110, v111, v4
    ds_add_rtn_u64 v[108:109], v44, v[72:73]
    ds_add_rtn_u64 v[110:111], v45, v[74:75]
    s_waitcnt lgkmcnt(2)
    v_mad_u32_u24 v120, v121, 12, v120
    buffer_load_dwordx3 v[44:46], v120, s[44:47], s34 offen offset:1536
    s_barrier
    s_waitcnt vmcnt(3)
    ds_write_b128 v3, v[88:91] offset:0
    ds_write_b128 v3, v[92:95] offset:16384
    ds_write_b128 v3, v[96:99] offset:32768
    ds_write_b128 v3, v[100:103] offset:49152
    ds_write_b128 v124, v[104:107]
    v_mbcnt_lo_u32_b32 v120, s36, 0
    v_mbcnt_hi_u32_b32 v120, s37, v120
    s_bcnt1_i32_b64 s14, s[36:37]
    v_lshl_add_u32 v121, v120, 1, s25
    ds_read_u16 v121, v121
    v_mad_u32_u24 v120, v120, s23, v2
    s_mov_b32 s36, s26
    s_lshl1_add_u32 s25, s14, s25
    s_mul_i32 s14, s14, s23
    s_add_u32 s26, s26, s14
    v_and_b32 v112, 0xffff, v50
    v_lshrrev_b32 v114, 16, v50
    v_lshlrev_b32 v113, 16, v50
    v_and_b32 v50, 0xffff0000, v50
    v_mad_u32_u16 v48, v48, 8, s50 op_sel:[1,0,0,0]
    v_mad_u32_u16 v49, v49, 8, s50 op_sel:[1,0,0,0]
    v_dot2_f32_bf16 v115, v76, v112, s16
    v_dot2_f32_bf16 v76, v76, v113, s16
    v_dot2_f32_bf16 v116, v77, v112, s16
    v_dot2_f32_bf16 v77, v77, v113, s16
    v_dot2_f32_bf16 v117, v78, v114, s16
    v_dot2_f32_bf16 v78, v78, v50, s16
    v_dot2_f32_bf16 v118, v79, v114, s16
    v_dot2_f32_bf16 v79, v79, v50, s16
    v_perm_b32 v76, v76, v115, s17
    v_perm_b32 v77, v77, v116, s17
    v_perm_b32 v78, v78, v117, s17
    v_perm_b32 v79, v79, v118, s17
    v_lshl_add_u64 v[76:77], v[76:77], 0, s[20:21]
    v_lshl_add_u64 v[78:79], v[78:79], 0, s[20:21]
    s_waitcnt lgkmcnt(6)
    v_or3_b32 v4, v108, v109, v4
    v_or3_b32 v4, v110, v111, v4
    ds_add_rtn_u64 v[108:109], v48, v[76:77]
    ds_add_rtn_u64 v[110:111], v49, v[78:79]
    s_waitcnt lgkmcnt(2)
    v_mad_u32_u24 v120, v121, 12, v120
    buffer_load_dwordx3 v[48:50], v120, s[44:47], s36 offen offset:2304
    v_mbcnt_lo_u32_b32 v120, s38, 0
    v_mbcnt_hi_u32_b32 v120, s39, v120
    s_bcnt1_i32_b64 s14, s[38:39]
    v_lshl_add_u32 v121, v120, 1, s25
    ds_read_u16 v121, v121
    v_mad_u32_u24 v120, v120, s23, v2
    s_mov_b32 s38, s26
    s_lshl1_add_u32 s25, s14, s25
    s_mul_i32 s14, s14, s23
    s_add_u32 s26, s26, s14
    v_and_b32 v112, 0xffff, v54
    v_lshrrev_b32 v114, 16, v54
    v_lshlrev_b32 v113, 16, v54
    v_and_b32 v54, 0xffff0000, v54
    v_mad_u32_u16 v52, v52, 8, s50 op_sel:[1,0,0,0]
    v_mad_u32_u16 v53, v53, 8, s50 op_sel:[1,0,0,0]
    v_dot2_f32_bf16 v115, v80, v112, s16
    v_dot2_f32_bf16 v80, v80, v113, s16
    v_dot2_f32_bf16 v116, v81, v112, s16
    v_dot2_f32_bf16 v81, v81, v113, s16
    v_dot2_f32_bf16 v117, v82, v114, s16
    v_dot2_f32_bf16 v82, v82, v54, s16
    v_dot2_f32_bf16 v118, v83, v114, s16
    v_dot2_f32_bf16 v83, v83, v54, s16
    v_perm_b32 v80, v80, v115, s17
    v_perm_b32 v81, v81, v116, s17
    v_perm_b32 v82, v82, v117, s17
    v_perm_b32 v83, v83, v118, s17
    v_lshl_add_u64 v[80:81], v[80:81], 0, s[20:21]
    v_lshl_add_u64 v[82:83], v[82:83], 0, s[20:21]
    s_waitcnt lgkmcnt(1)
    v_or3_b32 v4, v108, v109, v4
    v_or3_b32 v4, v110, v111, v4
    ds_add_rtn_u64 v[108:109], v52, v[80:81]
    ds_add_rtn_u64 v[110:111], v53, v[82:83]
    s_waitcnt lgkmcnt(2)
    v_mad_u32_u24 v120, v121, 12, v120
    buffer_load_dwordx3 v[52:54], v120, s[44:47], s38 offen offset:3072
    v_mbcnt_lo_u32_b32 v120, s40, 0
    v_mbcnt_hi_u32_b32 v120, s41, v120
    s_bcnt1_i32_b64 s14, s[40:41]
    v_lshl_add_u32 v121, v120, 1, s25
    ds_read_u16 v121, v121
    v_mad_u32_u24 v120, v120, s23, v2
    s_mov_b32 s40, s26
    s_lshl1_add_u32 s25, s14, s25
    s_mul_i32 s14, s14, s23
    s_add_u32 s26, s26, s14
    v_and_b32 v112, 0xffff, v58
    v_lshrrev_b32 v114, 16, v58
    v_lshlrev_b32 v113, 16, v58
    v_and_b32 v58, 0xffff0000, v58
    v_mad_u32_u16 v56, v56, 8, s50 op_sel:[1,0,0,0]
    v_mad_u32_u16 v57, v57, 8, s50 op_sel:[1,0,0,0]
    v_dot2_f32_bf16 v115, v84, v112, s16
    v_dot2_f32_bf16 v84, v84, v113, s16
    v_dot2_f32_bf16 v116, v85, v112, s16
    v_dot2_f32_bf16 v85, v85, v113, s16
    v_dot2_f32_bf16 v117, v86, v114, s16
    v_dot2_f32_bf16 v86, v86, v58, s16
    v_dot2_f32_bf16 v118, v87, v114, s16
    v_dot2_f32_bf16 v87, v87, v58, s16
    v_perm_b32 v84, v84, v115, s17
    v_perm_b32 v85, v85, v116, s17
    v_perm_b32 v86, v86, v117, s17
    v_perm_b32 v87, v87, v118, s17
    v_lshl_add_u64 v[84:85], v[84:85], 0, s[20:21]
    v_lshl_add_u64 v[86:87], v[86:87], 0, s[20:21]
    s_waitcnt lgkmcnt(1)
    v_or3_b32 v4, v108, v109, v4
    v_or3_b32 v4, v110, v111, v4
    ds_add_rtn_u64 v[108:109], v56, v[84:85]
    ds_add_rtn_u64 v[110:111], v57, v[86:87]
    s_waitcnt lgkmcnt(2)
    v_mad_u32_u24 v120, v121, 12, v120
    buffer_load_dwordx3 v[56:58], v120, s[44:47], s40 offen offset:3840
    s_cmp_le_u32 s29, 384
    s_cbranch_scc1 L_p2_kernel_norare_6
    v_readlane_b32 s42, v7, 12
    v_readlane_b32 s43, v7, 13
    s_nop 1
    v_mbcnt_lo_u32_b32 v120, s42, 0
    v_mbcnt_hi_u32_b32 v120, s43, v120
    s_bcnt1_i32_b64 s14, s[42:43]
    v_lshl_add_u32 v121, v120, 1, s25
    ds_read_u16 v121, v121
    v_mad_u32_u24 v120, v120, s23, v2
    s_mov_b32 s42, s26
    s_lshl1_add_u32 s25, s14, s25
    s_mul_i32 s14, s14, s23
    s_add_u32 s26, s26, s14
    s_waitcnt lgkmcnt(0)
    s_add_u32 s42, s42, 4608
    v_mad_u32_u24 v120, v121, 12, v120
    buffer_load_dwordx3 v[60:62], v120, s[44:47], s42 offen offset:0
L_p2_kernel_norare_6:
    v_mov_b32 v11, v15
    v_mov_b32 v43, v47
    v_mov_b32 v15, v19
    v_mov_b32 v47, v51
    v_mov_b32 v19, v23
    v_mov_b32 v51, v55
    v_mov_b32 v23, v27
    v_mov_b32 v55, v59
    v_mov_b32 v27, v31
    v_mov_b32 v59, v63
    v_mov_b32 v31, v35
    v_mov_b32 v63, v122
    v_mov_b32 v35, v39
    v_mov_b32 v122, v123
    v_mov_b32 v39, 0
    v_mov_b32 v123, 0
    v_add_u32_sdwa v113, 1, v43 dst_sel:DWORD dst_unused:UNUSED_PAD src0_sel:DWORD src1_sel:WORD_0
    v_lshrrev_b32_sdwa v112, 1, v11 dst_sel:DWORD dst_unused:UNUSED_PAD src0_sel:DWORD src1_sel:WORD_0
    v_lshrrev_b32 v113, 1, v113
    v_sub_u32 v114, v113, v112
    v_add_u32 v113, 448, v113
    s_nop 0
    v_add_u32_dpp v114, v114, v114 row_shr:1 row_mask:0xf bank_mask:0xf bound_ctrl:0
    s_nop 1
    v_add_u32_dpp v114, v114, v114 row_shr:2 row_mask:0xf bank_mask:0xf bound_ctrl:0
    s_nop 1
    v_add_u32_dpp v114, v114, v114 row_shr:4 row_mask:0xf bank_mask:0xf bound_ctrl:0
    s_nop 1
    v_add_u32_dpp v114, v114, v114 row_shr:8 row_mask:0xf bank_mask:0xf bound_ctrl:0
    s_nop 1
    v_add_u32_dpp v114, v114, v114 row_bcast:15 row_mask:0xa bank_mask:0xf
    s_nop 1
    v_add_u32_dpp v114, v114, v114 row_bcast:31 row_mask:0xc bank_mask:0xf
    v_sub_u32 v113, v113, v114
    v_readlane_b32 s56, v114, 63
    v_add_u32 v114, -1, v114
    ds_write_b16 v126, v113
    v_lshlrev_b32_e64 v115, v114, 1
    v_lshrrev_b32 v114, 5, v114
    v_lshl_add_u32 v114, v114, 2, s19
    s_cmp_gt_u32 s56, 448
    s_cselect_b32 s2, 1, s2
    s_cselect_b64 exec, 0, -1
    ds_or_b32 v114, v115 offset:160
    s_mov_b64 exec, -1
    ds_wrxchg_rtn_b32 v7, v6, v5 offset:160
    s_add_u32 s24, s24, 1
    s_cmp_lt_u32 s24, 8
    s_barrier
    s_cbranch_scc1 L_p2_loop
    s_waitcnt lgkmcnt(3)
    v_or3_b32 v4, v108, v109, v4
    v_or3_b32 v4, v110, v111, v4
    s_waitcnt vmcnt(0) lgkmcnt(0)
    s_barrier
    v_subrev_u32 v112, 80000, v124
    ds_read_b128 v[88:91], v1 offset:0
    ds_read_b128 v[92:95], v1 offset:16384
    ds_read_b128 v[96:99], v1 offset:32768
    ds_read_b128 v[100:103], v1 offset:49152
    ds_read_b128 v[104:107], v112
    s_mul_i32 s14, s12, 5120000
    s_mul_i32 s15, s3, 80000
    s_add_u32 s26, s14, s15
    s_add_u32 s26, s26, 259973632
    s_waitcnt lgkmcnt(4)
    s_add_u32 s14, s26, 0
    buffer_store_dwordx4 v[88:91], v1, s[4:7], s14 offen
    v_or3_b32 v4, v88, v89, v4
    v_or3_b32 v4, v90, v91, v4
    s_waitcnt lgkmcnt(3)
    s_add_u32 s14, s26, 16384
    buffer_store_dwordx4 v[92:95], v1, s[4:7], s14 offen
    v_or3_b32 v4, v92, v93, v4
    v_or3_b32 v4, v94, v95, v4
    s_waitcnt lgkmcnt(2)
    s_add_u32 s14, s26, 32768
    buffer_store_dwordx4 v[96:99], v1, s[4:7], s14 offen
    v_or3_b32 v4, v96, v97, v4
    v_or3_b32 v4, v98, v99, v4
    s_waitcnt lgkmcnt(1)
    s_add_u32 s14, s26, 49152
    buffer_store_dwordx4 v[100:103], v1, s[4:7], s14 offen
    v_or3_b32 v4, v100, v101, v4
    v_or3_b32 v4, v102, v103, v4
    s_waitcnt lgkmcnt(0)
    buffer_store_dwordx4 v[104:107], v112, s[4:7], s26 offen
    v_or3_b32 v4, v104, v105, v4
    v_or3_b32 v4, v106, v107, v4
    v_and_b32 v4, 0x80008000, v4
    v_cmp_ne_u32 vcc, 0, v4
    v_mov_b32 v113, s19
    v_and_b32 v115, 15, v0
    v_mul_u32_u24 v115, 240, v115
    v_add_u32 v115, 160000, v115
    s_cmp_lg_u64 vcc, 0
    s_cselect_b32 s2, 1, s2
    v_mov_b32 v114, s2
    s_mov_b64 exec, 1
    ds_write_b32 v113, v114
    s_mov_b64 exec, -1
    s_waitcnt lgkmcnt(0)
    s_barrier
    ds_read_b32 v114, v115
    s_lshl_b32 s14, s3, 4
    s_lshl_b32 s15, s12, 2
    s_add_u32 s25, s14, s15
    s_add_u32 s25, s25, 254849536
    s_waitcnt lgkmcnt(0)
    v_cmp_ne_u32 vcc, 0, v114
    v_mov_b32 v113, 0
    s_nop 1
    s_cmp_lg_u64 vcc, 0
    s_cselect_b32 s14, 0, s48
    v_mov_b32 v114, s14
    s_mov_b64 exec, 1
    buffer_store_dword v114, v113, s[4:7], s25 offen
    s_mov_b64 exec, -1
    s_cbranch_scc0 L_p2_end
    s_barrier
    v_mov_b32 v8, 0
    v_mov_b32 v9, 0
    v_mov_b32 v10, 0
    v_mov_b32 v11, 0
    v_mov_b32 v12, v1
    ds_write_b128 v12, v[8:11]
    v_add_u32 v12, 16384, v12
    ds_write_b128 v12, v[8:11]
    v_add_u32 v12, 16384, v12
    ds_write_b128 v12, v[8:11]
    v_add_u32 v12, 16384, v12
    ds_write_b128 v12, v[8:11]
    v_add_u32 v12, 16384, v12
    ds_write_b128 v12, v[8:11]
    v_add_u32 v12, 16384, v12
    ds_write_b128 v12, v[8:11]
    v_add_u32 v12, 16384, v12
    ds_write_b128 v12, v[8:11]
    v_add_u32 v12, 16384, v12
    ds_write_b128 v12, v[8:11]
    v_add_u32 v12, 16384, v12
    ds_write_b128 v12, v[8:11]
    v_add_u32 v12, 16384, v12
    ds_write_b128 v12, v[8:11]
    v_add_u32 v12, 16384, v12
    v_lshlrev_b32 v13, 4, v0
    v_add_u32 v28, 32896, v13
    v_mul_lo_u32 v14, v0, s23
    v_add_u32 v14, 8192, v14
    s_mul_i32 s25, s12, 65
    s_add_u32 s25, s25, s3
    s_mul_i32 s25, s25, 32896
    s_add_u32 s25, s25, 246292480
    s_lshl_b32 s50, s50, 1
    s_mul_i32 s22, s12, 1280000
    s_mov_b32 s24, 0
    s_waitcnt lgkmcnt(0)
    s_barrier
L_p2_sstep:
    buffer_load_ushort v15, v13, s[4:7], s25 offen
    buffer_load_ushort v16, v28, s[4:7], s25 offen
    s_waitcnt vmcnt(0)
L_p2_srec:
    v_cmp_lt_u32 vcc, v15, v16
    s_nop 1
    s_and_b64 exec, exec, vcc
    s_cbranch_execz L_p2_sdone
    v_lshrrev_b32 v17, 1, v15
    v_and_b32 v18, 1, v15
    v_mad_u32_u24 v17, v17, 12, v14
    v_lshl_add_u32 v19, v18, 2, v17
    v_lshl_add_u32 v17, v18, 1, v17
    buffer_load_dword v20, v19, s[4:7], 0 offen
    buffer_load_ushort v21, v17, s[4:7], 0 offen offset:8
    v_add_u32 v15, 1, v15
    s_waitcnt vmcnt(0)
    v_lshlrev_b32_sdwa v19, 3, v20 dst_sel:DWORD dst_unused:UNUSED_PAD src0_sel:DWORD src1_sel:WORD_0
    buffer_load_dwordx2 v[22:23], v19, s[8:11], s22 offen
    v_mad_u32_u16 v20, v20, 16, s50 op_sel:[1,0,0,0]
    v_lshlrev_b32 v21, 16, v21
    s_waitcnt vmcnt(0)
    v_lshlrev_b32 v24, 16, v22
    v_and_b32 v25, 0xffff0000, v22
    v_lshlrev_b32 v26, 16, v23
    v_and_b32 v27, 0xffff0000, v23
    v_mul_f32 v24, v21, v24
    v_mul_f32 v25, v21, v25
    v_mul_f32 v26, v21, v26
    v_mul_f32 v27, v21, v27
    ds_add_f32 v20, v24
    ds_add_f32 v20, v25 offset:4
    ds_add_f32 v20, v26 offset:8
    ds_add_f32 v20, v27 offset:12
    s_branch L_p2_srec
L_p2_sdone:
    s_mov_b64 exec, -1
    s_cmp_eq_u32 s24, 7
    s_cselect_b32 s14, 16370, 2
    s_add_u32 s25, s25, s14
    s_add_u32 s22, s22, 80000
    s_add_u32 s24, s24, 1
    s_cmp_lt_u32 s24, 16
    s_cbranch_scc1 L_p2_sstep
    s_waitcnt lgkmcnt(0)
    s_barrier
    s_mul_i32 s14, s12, 10240000
    s_mul_i32 s15, s3, 160000
    s_add_u32 s26, s14, s15
    s_add_u32 s26, s26, 280453632
    v_mov_b32 v12, v1
    s_mov_b32 s24, 0
L_p2_sout:
    v_cmp_gt_u32 vcc, 160000, v12
    ds_read_b128 v[8:11], v12
    s_nop 0
    s_and_b64 exec, exec, vcc
    s_cbranch_execz L_p2_end
    s_waitcnt lgkmcnt(0)
    buffer_store_dwordx4 v[8:11], v12, s[4:7], s26 offen
    s_waitcnt vmcnt(0)
    v_add_u32 v12, 16384, v12
    s_branch L_p2_sout
L_p2_end:
    s_endpgm
.globl p3_kernel
.p2align 8
.type p3_kernel,@function
p3_kernel:
    s_cmp_ge_u32 s2, 1250
    s_cbranch_scc1 L_p3_end
    s_load_dwordx2 s[4:5], s[0:1], 104
    s_load_dwordx2 s[8:9], s[0:1], 0
    s_load_dwordx2 s[12:13], s[0:1], 24
    s_load_dwordx2 s[16:17], s[0:1], 88
    s_load_dwordx2 s[20:21], s[0:1], 40
    s_load_dwordx4 s[24:27], s[0:1], 56
    s_load_dwordx4 s[28:31], s[0:1], 72
    s_lshl_b32 s3, s2, 8
    v_add_u32 v0, s3, v0
    v_lshlrev_b32 v1, 4, v0
    v_lshlrev_b32 v2, 2, v0
    v_mul_hi_u32_u24 v3, 858994, v0
    v_lshlrev_b32 v3, 4, v3
    s_waitcnt lgkmcnt(0)
    s_mov_b32 s6, 655360000
    s_mov_b32 s7, 0x00020000
    s_mov_b32 s10, 5120000
    s_mov_b32 s11, 0x00020000
    s_mov_b32 s14, 1280000
    s_mov_b32 s15, 0x00020000
    s_mov_b32 s18, 5120000
    s_mov_b32 s19, 0x00020000
    s_load_dwordx4 s[72:75], s[20:21], 0
    s_load_dwordx16 s[32:47], s[24:25], 0
    s_load_dwordx16 s[48:63], s[26:27], 0
    s_load_dwordx8 s[64:71], s[28:29], 0
    s_load_dwordx8 s[80:87], s[30:31], 0
    buffer_load_dword v4, v2, s[12:15], 0 offen
    s_mov_b32 s3, 254849536
    buffer_load_dwordx4 v[8:11], v3, s[4:7], s3 offen
    s_mov_b32 s3, 259973632
    buffer_load_dwordx4 v[12:15], v1, s[4:7], s3 offen
    s_mov_b32 s3, 265093632
    buffer_load_dwordx4 v[16:19], v1, s[4:7], s3 offen
    s_mov_b32 s3, 270213632
    buffer_load_dwordx4 v[20:23], v1, s[4:7], s3 offen
    s_mov_b32 s3, 275333632
    buffer_load_dwordx4 v[24:27], v1, s[4:7], s3 offen
    buffer_load_dwordx4 v[28:31], v1, s[8:11], 0 offen
    s_waitcnt lgkmcnt(0)
    s_pack_ll_b32_b16 s20, s32, s34
    s_pack_hh_b32_b16 s21, s32, s34
    s_pack_ll_b32_b16 s22, s33, s35
    s_pack_hh_b32_b16 s35, s33, s35
    s_mov_b32 s32, s20
    s_mov_b32 s33, s21
    s_mov_b32 s34, s22
    s_pack_ll_b32_b16 s20, s36, s38
    s_pack_hh_b32_b16 s21, s36, s38
    s_pack_ll_b32_b16 s22, s37, s39
    s_pack_hh_b32_b16 s39, s37, s39
    s_mov_b32 s36, s20
    s_mov_b32 s37, s21
    s_mov_b32 s38, s22
    s_pack_ll_b32_b16 s20, s40, s42
    s_pack_hh_b32_b16 s21, s40, s42
    s_pack_ll_b32_b16 s22, s41, s43
    s_pack_hh_b32_b16 s43, s41, s43
    s_mov_b32 s40, s20
    s_mov_b32 s41, s21
    s_mov_b32 s42, s22
    s_pack_ll_b32_b16 s20, s44, s46
    s_pack_hh_b32_b16 s21, s44, s46
    s_pack_ll_b32_b16 s22, s45, s47
    s_pack_hh_b32_b16 s47, s45, s47
    s_mov_b32 s44, s20
    s_mov_b32 s45, s21
    s_mov_b32 s46, s22
    s_pack_ll_b32_b16 s20, s48, s50
    s_pack_hh_b32_b16 s21, s48, s50
    s_pack_ll_b32_b16 s22, s49, s51
    s_pack_hh_b32_b16 s51, s49, s51
    s_mov_b32 s48, s20
    s_mov_b32 s49, s21
    s_mov_b32 s50, s22
    s_pack_ll_b32_b16 s20, s52, s54
    s_pack_hh_b32_b16 s21, s52, s54
    s_pack_ll_b32_b16 s22, s53, s55
    s_pack_hh_b32_b16 s55, s53, s55
    s_mov_b32 s52, s20
    s_mov_b32 s53, s21
    s_mov_b32 s54, s22
    s_pack_ll_b32_b16 s20, s56, s58
    s_pack_hh_b32_b16 s21, s56, s58
    s_pack_ll_b32_b16 s22, s57, s59
    s_pack_hh_b32_b16 s59, s57, s59
    s_mov_b32 s56, s20
    s_mov_b32 s57, s21
    s_mov_b32 s58, s22
    s_pack_ll_b32_b16 s20, s60, s62
    s_pack_hh_b32_b16 s21, s60, s62
    s_pack_ll_b32_b16 s22, s61, s63
    s_pack_hh_b32_b16 s63, s61, s63
    s_mov_b32 s60, s20
    s_mov_b32 s61, s21
    s_mov_b32 s62, s22
    s_lshl_b32 s20, s72, 16
    s_and_b32 s21, s72, 0xffff0000
    s_lshl_b32 s22, s73, 16
    s_and_b32 s23, s73, 0xffff0000
    s_lshl_b32 s24, s74, 16
    s_and_b32 s25, s74, 0xffff0000
    s_lshl_b32 s26, s75, 16
    s_and_b32 s27, s75, 0xffff0000
    s_and_b32 s79, s71, 0xffff0000
    s_lshl_b32 s78, s71, 16
    s_and_b32 s77, s70, 0xffff0000
    s_lshl_b32 s76, s70, 16
    s_and_b32 s75, s69, 0xffff0000
    s_lshl_b32 s74, s69, 16
    s_and_b32 s73, s68, 0xffff0000
    s_lshl_b32 s72, s68, 16
    s_and_b32 s71, s67, 0xffff0000
    s_lshl_b32 s70, s67, 16
    s_and_b32 s69, s66, 0xffff0000
    s_lshl_b32 s68, s66, 16
    s_and_b32 s67, s65, 0xffff0000
    s_lshl_b32 s66, s65, 16
    s_and_b32 s65, s64, 0xffff0000
    s_lshl_b32 s64, s64, 16
    s_and_b32 s95, s87, 0xffff0000
    s_lshl_b32 s94, s87, 16
    s_and_b32 s93, s86, 0xffff0000
    s_lshl_b32 s92, s86, 16
    s_and_b32 s91, s85, 0xffff0000
    s_lshl_b32 s90, s85, 16
    s_and_b32 s89, s84, 0xffff0000
    s_lshl_b32 s88, s84, 16
    s_and_b32 s87, s83, 0xffff0000
    s_lshl_b32 s86, s83, 16
    s_and_b32 s85, s82, 0xffff0000
    s_lshl_b32 s84, s82, 16
    s_and_b32 s83, s81, 0xffff0000
    s_lshl_b32 s82, s81, 16
    s_and_b32 s81, s80, 0xffff0000
    s_lshl_b32 s80, s80, 16
    s_waitcnt vmcnt(6)
    v_and_b32 v5, 0xffff0000, v4
    v_lshlrev_b32 v4, 16, v4
    v_subrev_f32 v32, s20, v4
    v_subrev_f32 v33, s21, v4
    v_subrev_f32 v34, s22, v4
    v_subrev_f32 v35, s23, v4
    v_subrev_f32 v36, s24, v4
    v_subrev_f32 v37, s25, v4
    v_subrev_f32 v38, s26, v4
    v_subrev_f32 v39, s27, v4
    v_cvt_pk_bf16_f32 v6, v32, v33
    v_lshlrev_b32 v32, 16, v6
    v_and_b32 v33, 0xffff0000, v6
    v_cvt_pk_bf16_f32 v6, v34, v35
    v_lshlrev_b32 v34, 16, v6
    v_and_b32 v35, 0xffff0000, v6
    v_cvt_pk_bf16_f32 v6, v36, v37
    v_lshlrev_b32 v36, 16, v6
    v_and_b32 v37, 0xffff0000, v6
    v_cvt_pk_bf16_f32 v6, v38, v39
    v_lshlrev_b32 v38, 16, v6
    v_and_b32 v39, 0xffff0000, v6
    v_mul_f32 v32, v32, v32
    v_mul_f32 v33, v33, v33
    v_mul_f32 v34, v34, v34
    v_mul_f32 v35, v35, v35
    v_mul_f32 v36, v36, v36
    v_mul_f32 v37, v37, v37
    v_mul_f32 v38, v38, v38
    v_mul_f32 v39, v39, v39
    v_cvt_pk_bf16_f32 v6, v32, v33
    v_lshlrev_b32 v32, 16, v6
    v_and_b32 v33, 0xffff0000, v6
    v_cvt_pk_bf16_f32 v6, v34, v35
    v_lshlrev_b32 v34, 16, v6
    v_and_b32 v35, 0xffff0000, v6
    v_cvt_pk_bf16_f32 v6, v36, v37
    v_lshlrev_b32 v36, 16, v6
    v_and_b32 v37, 0xffff0000, v6
    v_cvt_pk_bf16_f32 v6, v38, v39
    v_lshlrev_b32 v38, 16, v6
    v_and_b32 v39, 0xffff0000, v6
    v_mul_f32 v32, 0xc1200000, v32
    v_mul_f32 v33, 0xc1200000, v33
    v_mul_f32 v34, 0xc1200000, v34
    v_mul_f32 v35, 0xc1200000, v35
    v_mul_f32 v36, 0xc1200000, v36
    v_mul_f32 v37, 0xc1200000, v37
    v_mul_f32 v38, 0xc1200000, v38
    v_mul_f32 v39, 0xc1200000, v39
    v_cvt_pk_bf16_f32 v6, v32, v33
    v_lshlrev_b32 v32, 16, v6
    v_and_b32 v33, 0xffff0000, v6
    v_cvt_pk_bf16_f32 v6, v34, v35
    v_lshlrev_b32 v34, 16, v6
    v_and_b32 v35, 0xffff0000, v6
    v_cvt_pk_bf16_f32 v6, v36, v37
    v_lshlrev_b32 v36, 16, v6
    v_and_b32 v37, 0xffff0000, v6
    v_cvt_pk_bf16_f32 v6, v38, v39
    v_lshlrev_b32 v38, 16, v6
    v_and_b32 v39, 0xffff0000, v6
    v_mul_f32 v32, 0x3fb8aa3b, v32
    v_mul_f32 v33, 0x3fb8aa3b, v33
    v_mul_f32 v34, 0x3fb8aa3b, v34
    v_mul_f32 v35, 0x3fb8aa3b, v35
    v_mul_f32 v36, 0x3fb8aa3b, v36
    v_mul_f32 v37, 0x3fb8aa3b, v37
    v_mul_f32 v38, 0x3fb8aa3b, v38
    v_mul_f32 v39, 0x3fb8aa3b, v39
    v_exp_f32 v32, v32
    v_exp_f32 v33, v33
    v_exp_f32 v34, v34
    v_exp_f32 v35, v35
    v_exp_f32 v36, v36
    v_exp_f32 v37, v37
    v_exp_f32 v38, v38
    v_exp_f32 v39, v39
    v_cvt_pk_bf16_f32 v40, v32, v33
    v_cvt_pk_bf16_f32 v41, v34, v35
    v_cvt_pk_bf16_f32 v42, v36, v37
    v_cvt_pk_bf16_f32 v43, v38, v39
    v_dot2_f32_bf16 v44, v40, s32, 0
    v_dot2_f32_bf16 v45, v40, s33, 0
    v_dot2_f32_bf16 v46, v40, s34, 0
    v_dot2_f32_bf16 v47, v40, s35, 0
    v_dot2_f32_bf16 v48, v40, s48, 0
    v_dot2_f32_bf16 v49, v40, s49, 0
    v_dot2_f32_bf16 v50, v40, s50, 0
    v_dot2_f32_bf16 v51, v40, s51, 0
    v_dot2_f32_bf16 v44, v41, s36, v44
    v_dot2_f32_bf16 v45, v41, s37, v45
    v_dot2_f32_bf16 v46, v41, s38, v46
    v_dot2_f32_bf16 v47, v41, s39, v47
    v_dot2_f32_bf16 v48, v41, s52, v48
    v_dot2_f32_bf16 v49, v41, s53, v49
    v_dot2_f32_bf16 v50, v41, s54, v50
    v_dot2_f32_bf16 v51, v41, s55, v51
    v_dot2_f32_bf16 v44, v42, s40, v44
    v_dot2_f32_bf16 v45, v42, s41, v45
    v_dot2_f32_bf16 v46, v42, s42, v46
    v_dot2_f32_bf16 v47, v42, s43, v47
    v_dot2_f32_bf16 v48, v42, s56, v48
    v_dot2_f32_bf16 v49, v42, s57, v49
    v_dot2_f32_bf16 v50, v42, s58, v50
    v_dot2_f32_bf16 v51, v42, s59, v51
    v_dot2_f32_bf16 v44, v43, s44, v44
    v_dot2_f32_bf16 v45, v43, s45, v45
    v_dot2_f32_bf16 v46, v43, s46, v46
    v_dot2_f32_bf16 v47, v43, s47, v47
    v_dot2_f32_bf16 v48, v43, s60, v48
    v_dot2_f32_bf16 v49, v43, s61, v49
    v_dot2_f32_bf16 v50, v43, s62, v50
    v_dot2_f32_bf16 v51, v43, s63, v51
    v_subrev_f32 v32, s20, v5
    v_subrev_f32 v33, s21, v5
    v_subrev_f32 v34, s22, v5
    v_subrev_f32 v35, s23, v5
    v_subrev_f32 v36, s24, v5
    v_subrev_f32 v37, s25, v5
    v_subrev_f32 v38, s26, v5
    v_subrev_f32 v39, s27, v5
    v_cvt_pk_bf16_f32 v6, v32, v33
    v_lshlrev_b32 v32, 16, v6
    v_and_b32 v33, 0xffff0000, v6
    v_cvt_pk_bf16_f32 v6, v34, v35
    v_lshlrev_b32 v34, 16, v6
    v_and_b32 v35, 0xffff0000, v6
    v_cvt_pk_bf16_f32 v6, v36, v37
    v_lshlrev_b32 v36, 16, v6
    v_and_b32 v37, 0xffff0000, v6
    v_cvt_pk_bf16_f32 v6, v38, v39
    v_lshlrev_b32 v38, 16, v6
    v_and_b32 v39, 0xffff0000, v6
    v_mul_f32 v32, v32, v32
    v_mul_f32 v33, v33, v33
    v_mul_f32 v34, v34, v34
    v_mul_f32 v35, v35, v35
    v_mul_f32 v36, v36, v36
    v_mul_f32 v37, v37, v37
    v_mul_f32 v38, v38, v38
    v_mul_f32 v39, v39, v39
    v_cvt_pk_bf16_f32 v6, v32, v33
    v_lshlrev_b32 v32, 16, v6
    v_and_b32 v33, 0xffff0000, v6
    v_cvt_pk_bf16_f32 v6, v34, v35
    v_lshlrev_b32 v34, 16, v6
    v_and_b32 v35, 0xffff0000, v6
    v_cvt_pk_bf16_f32 v6, v36, v37
    v_lshlrev_b32 v36, 16, v6
    v_and_b32 v37, 0xffff0000, v6
    v_cvt_pk_bf16_f32 v6, v38, v39
    v_lshlrev_b32 v38, 16, v6
    v_and_b32 v39, 0xffff0000, v6
    v_mul_f32 v32, 0xc1200000, v32
    v_mul_f32 v33, 0xc1200000, v33
    v_mul_f32 v34, 0xc1200000, v34
    v_mul_f32 v35, 0xc1200000, v35
    v_mul_f32 v36, 0xc1200000, v36
    v_mul_f32 v37, 0xc1200000, v37
    v_mul_f32 v38, 0xc1200000, v38
    v_mul_f32 v39, 0xc1200000, v39
    v_cvt_pk_bf16_f32 v6, v32, v33
    v_lshlrev_b32 v32, 16, v6
    v_and_b32 v33, 0xffff0000, v6
    v_cvt_pk_bf16_f32 v6, v34, v35
    v_lshlrev_b32 v34, 16, v6
    v_and_b32 v35, 0xffff0000, v6
    v_cvt_pk_bf16_f32 v6, v36, v37
    v_lshlrev_b32 v36, 16, v6
    v_and_b32 v37, 0xffff0000, v6
    v_cvt_pk_bf16_f32 v6, v38, v39
    v_lshlrev_b32 v38, 16, v6
    v_and_b32 v39, 0xffff0000, v6
    v_mul_f32 v32, 0x3fb8aa3b, v32
    v_mul_f32 v33, 0x3fb8aa3b, v33
    v_mul_f32 v34, 0x3fb8aa3b, v34
    v_mul_f32 v35, 0x3fb8aa3b, v35
    v_mul_f32 v36, 0x3fb8aa3b, v36
    v_mul_f32 v37, 0x3fb8aa3b, v37
    v_mul_f32 v38, 0x3fb8aa3b, v38
    v_mul_f32 v39, 0x3fb8aa3b, v39
    v_exp_f32 v32, v32
    v_exp_f32 v33, v33
    v_exp_f32 v34, v34
    v_exp_f32 v35, v35
    v_exp_f32 v36, v36
    v_exp_f32 v37, v37
    v_exp_f32 v38, v38
    v_exp_f32 v39, v39
    v_cvt_pk_bf16_f32 v40, v32, v33
    v_cvt_pk_bf16_f32 v41, v34, v35
    v_cvt_pk_bf16_f32 v42, v36, v37
    v_cvt_pk_bf16_f32 v43, v38, v39
    v_dot2_f32_bf16 v52, v40, s32, 0
    v_dot2_f32_bf16 v53, v40, s33, 0
    v_dot2_f32_bf16 v54, v40, s34, 0
    v_dot2_f32_bf16 v55, v40, s35, 0
    v_dot2_f32_bf16 v56, v40, s48, 0
    v_dot2_f32_bf16 v57, v40, s49, 0
    v_dot2_f32_bf16 v58, v40, s50, 0
    v_dot2_f32_bf16 v59, v40, s51, 0
    v_dot2_f32_bf16 v52, v41, s36, v52
    v_dot2_f32_bf16 v53, v41, s37, v53
    v_dot2_f32_bf16 v54, v41, s38, v54
    v_dot2_f32_bf16 v55, v41, s39, v55
    v_dot2_f32_bf16 v56, v41, s52, v56
    v_dot2_f32_bf16 v57, v41, s53, v57
    v_dot2_f32_bf16 v58, v41, s54, v58
    v_dot2_f32_bf16 v59, v41, s55, v59
    v_dot2_f32_bf16 v52, v42, s40, v52
    v_dot2_f32_bf16 v53, v42, s41, v53
    v_dot2_f32_bf16 v54, v42, s42, v54
    v_dot2_f32_bf16 v55, v42, s43, v55
    v_dot2_f32_bf16 v56, v42, s56, v56
    v_dot2_f32_bf16 v57, v42, s57, v57
    v_dot2_f32_bf16 v58, v42, s58, v58
    v_dot2_f32_bf16 v59, v42, s59, v59
    v_dot2_f32_bf16 v52, v43, s44, v52
    v_dot2_f32_bf16 v53, v43, s45, v53
    v_dot2_f32_bf16 v54, v43, s46, v54
    v_dot2_f32_bf16 v55, v43, s47, v55
    v_dot2_f32_bf16 v56, v43, s60, v56
    v_dot2_f32_bf16 v57, v43, s61, v57
    v_dot2_f32_bf16 v58, v43, s62, v58
    v_dot2_f32_bf16 v59, v43, s63, v59
    s_waitcnt vmcnt(1)
    v_cvt_f32_u32_sdwa v40, v12 dst_sel:DWORD dst_unused:UNUSED_PAD src0_sel:WORD_0
    v_add_f32 v40, 3330277376, v40
    v_mul_f32 v32, v8, v40
    v_cvt_f32_u32_sdwa v41, v12 dst_sel:DWORD dst_unused:UNUSED_PAD src0_sel:WORD_1
    v_add_f32 v41, 3330277376, v41
    v_mul_f32 v33, v8, v41
    v_cvt_f32_u32_sdwa v42, v13 dst_sel:DWORD dst_unused:UNUSED_PAD src0_sel:WORD_0
    v_add_f32 v42, 3330277376, v42
    v_mul_f32 v34, v8, v42
    v_cvt_f32_u32_sdwa v43, v13 dst_sel:DWORD dst_unused:UNUSED_PAD src0_sel:WORD_1
    v_add_f32 v43, 3330277376, v43
    v_mul_f32 v35, v8, v43
    v_cvt_f32_u32_sdwa v40, v14 dst_sel:DWORD dst_unused:UNUSED_PAD src0_sel:WORD_0
    v_add_f32 v40, 3330277376, v40
    v_mul_f32 v36, v8, v40
    v_cvt_f32_u32_sdwa v41, v14 dst_sel:DWORD dst_unused:UNUSED_PAD src0_sel:WORD_1
    v_add_f32 v41, 3330277376, v41
    v_mul_f32 v37, v8, v41
    v_cvt_f32_u32_sdwa v42, v15 dst_sel:DWORD dst_unused:UNUSED_PAD src0_sel:WORD_0
    v_add_f32 v42, 3330277376, v42
    v_mul_f32 v38, v8, v42
    v_cvt_f32_u32_sdwa v43, v15 dst_sel:DWORD dst_unused:UNUSED_PAD src0_sel:WORD_1
    v_add_f32 v43, 3330277376, v43
    v_mul_f32 v39, v8, v43
    v_cvt_f32_u32_sdwa v40, v16 dst_sel:DWORD dst_unused:UNUSED_PAD src0_sel:WORD_0
    v_add_f32 v40, 3330277376, v40
    v_fmac_f32 v32, v9, v40
    v_cvt_f32_u32_sdwa v41, v16 dst_sel:DWORD dst_unused:UNUSED_PAD src0_sel:WORD_1
    v_add_f32 v41, 3330277376, v41
    v_fmac_f32 v33, v9, v41
    v_cvt_f32_u32_sdwa v42, v17 dst_sel:DWORD dst_unused:UNUSED_PAD src0_sel:WORD_0
    v_add_f32 v42, 3330277376, v42
    v_fmac_f32 v34, v9, v42
    v_cvt_f32_u32_sdwa v43, v17 dst_sel:DWORD dst_unused:UNUSED_PAD src0_sel:WORD_1
    v_add_f32 v43, 3330277376, v43
    v_fmac_f32 v35, v9, v43
    v_cvt_f32_u32_sdwa v40, v18 dst_sel:DWORD dst_unused:UNUSED_PAD src0_sel:WORD_0
    v_add_f32 v40, 3330277376, v40
    v_fmac_f32 v36, v9, v40
    v_cvt_f32_u32_sdwa v41, v18 dst_sel:DWORD dst_unused:UNUSED_PAD src0_sel:WORD_1
    v_add_f32 v41, 3330277376, v41
    v_fmac_f32 v37, v9, v41
    v_cvt_f32_u32_sdwa v42, v19 dst_sel:DWORD dst_unused:UNUSED_PAD src0_sel:WORD_0
    v_add_f32 v42, 3330277376, v42
    v_fmac_f32 v38, v9, v42
    v_cvt_f32_u32_sdwa v43, v19 dst_sel:DWORD dst_unused:UNUSED_PAD src0_sel:WORD_1
    v_add_f32 v43, 3330277376, v43
    v_fmac_f32 v39, v9, v43
    v_cvt_f32_u32_sdwa v40, v20 dst_sel:DWORD dst_unused:UNUSED_PAD src0_sel:WORD_0
    v_add_f32 v40, 3330277376, v40
    v_fmac_f32 v32, v10, v40
    v_cvt_f32_u32_sdwa v41, v20 dst_sel:DWORD dst_unused:UNUSED_PAD src0_sel:WORD_1
    v_add_f32 v41, 3330277376, v41
    v_fmac_f32 v33, v10, v41
    v_cvt_f32_u32_sdwa v42, v21 dst_sel:DWORD dst_unused:UNUSED_PAD src0_sel:WORD_0
    v_add_f32 v42, 3330277376, v42
    v_fmac_f32 v34, v10, v42
    v_cvt_f32_u32_sdwa v43, v21 dst_sel:DWORD dst_unused:UNUSED_PAD src0_sel:WORD_1
    v_add_f32 v43, 3330277376, v43
    v_fmac_f32 v35, v10, v43
    v_cvt_f32_u32_sdwa v40, v22 dst_sel:DWORD dst_unused:UNUSED_PAD src0_sel:WORD_0
    v_add_f32 v40, 3330277376, v40
    v_fmac_f32 v36, v10, v40
    v_cvt_f32_u32_sdwa v41, v22 dst_sel:DWORD dst_unused:UNUSED_PAD src0_sel:WORD_1
    v_add_f32 v41, 3330277376, v41
    v_fmac_f32 v37, v10, v41
    v_cvt_f32_u32_sdwa v42, v23 dst_sel:DWORD dst_unused:UNUSED_PAD src0_sel:WORD_0
    v_add_f32 v42, 3330277376, v42
    v_fmac_f32 v38, v10, v42
    v_cvt_f32_u32_sdwa v43, v23 dst_sel:DWORD dst_unused:UNUSED_PAD src0_sel:WORD_1
    v_add_f32 v43, 3330277376, v43
    v_fmac_f32 v39, v10, v43
    v_cvt_f32_u32_sdwa v40, v24 dst_sel:DWORD dst_unused:UNUSED_PAD src0_sel:WORD_0
    v_add_f32 v40, 3330277376, v40
    v_fmac_f32 v32, v11, v40
    v_cvt_f32_u32_sdwa v41, v24 dst_sel:DWORD dst_unused:UNUSED_PAD src0_sel:WORD_1
    v_add_f32 v41, 3330277376, v41
    v_fmac_f32 v33, v11, v41
    v_cvt_f32_u32_sdwa v42, v25 dst_sel:DWORD dst_unused:UNUSED_PAD src0_sel:WORD_0
    v_add_f32 v42, 3330277376, v42
    v_fmac_f32 v34, v11, v42
    v_cvt_f32_u32_sdwa v43, v25 dst_sel:DWORD dst_unused:UNUSED_PAD src0_sel:WORD_1
    v_add_f32 v43, 3330277376, v43
    v_fmac_f32 v35, v11, v43
    v_cvt_f32_u32_sdwa v40, v26 dst_sel:DWORD dst_unused:UNUSED_PAD src0_sel:WORD_0
    v_add_f32 v40, 3330277376, v40
    v_fmac_f32 v36, v11, v40
    v_cvt_f32_u32_sdwa v41, v26 dst_sel:DWORD dst_unused:UNUSED_PAD src0_sel:WORD_1
    v_add_f32 v41, 3330277376, v41
    v_fmac_f32 v37, v11, v41
    v_cvt_f32_u32_sdwa v42, v27 dst_sel:DWORD dst_unused:UNUSED_PAD src0_sel:WORD_0
    v_add_f32 v42, 3330277376, v42
    v_fmac_f32 v38, v11, v42
    v_cvt_f32_u32_sdwa v43, v27 dst_sel:DWORD dst_unused:UNUSED_PAD src0_sel:WORD_1
    v_add_f32 v43, 3330277376, v43
    v_fmac_f32 v39, v11, v43
    v_min_u32 v6, v8, v9
    v_min3_u32 v6, v6, v10, v11
    v_cmp_eq_u32 vcc, 0, v6
    s_nop 1
    s_cbranch_vccz L_p3_fast
    v_lshlrev_b32 v7, 5, v0
    v_cmp_eq_u32 vcc, 0, v8
    s_nop 1
    s_and_b64 exec, exec, vcc
    s_cbranch_execz L_p3_kernel_q_1
    s_mov_b32 s3, 280453632
    buffer_load_dwordx4 v[12:15], v7, s[4:7], s3 offen
    buffer_load_dwordx4 v[16:19], v7, s[4:7], s3 offen offset:16
    s_waitcnt vmcnt(0)
    v_add_f32 v32, v32, v12
    v_add_f32 v33, v33, v13
    v_add_f32 v34, v34, v14
    v_add_f32 v35, v35, v15
    v_add_f32 v36, v36, v16
    v_add_f32 v37, v37, v17
    v_add_f32 v38, v38, v18
    v_add_f32 v39, v39, v19
L_p3_kernel_q_1:
    s_mov_b64 exec, -1
    v_cmp_eq_u32 vcc, 0, v9
    s_nop 1
    s_and_b64 exec, exec, vcc
    s_cbranch_execz L_p3_kernel_q_2
    s_mov_b32 s3, 290693632
    buffer_load_dwordx4 v[12:15], v7, s[4:7], s3 offen
    buffer_load_dwordx4 v[16:19], v7, s[4:7], s3 offen offset:16
    s_waitcnt vmcnt(0)
    v_add_f32 v32, v32, v12
    v_add_f32 v33, v33, v13
    v_add_f32 v34, v34, v14
    v_add_f32 v35, v35, v15
    v_add_f32 v36, v36, v16
    v_add_f32 v37, v37, v17
    v_add_f32 v38, v38, v18
    v_add_f32 v39, v39, v19
L_p3_kernel_q_2:
    s_mov_b64 exec, -1
    v_cmp_eq_u32 vcc, 0, v10
    s_nop 1
    s_and_b64 exec, exec, vcc
    s_cbranch_execz L_p3_kernel_q_3
    s_mov_b32 s3, 300933632
    buffer_load_dwordx4 v[12:15], v7, s[4:7], s3 offen
    buffer_load_dwordx4 v[16:19], v7, s[4:7], s3 offen offset:16
    s_waitcnt vmcnt(0)
    v_add_f32 v32, v32, v12
    v_add_f32 v33, v33, v13
    v_add_f32 v34, v34, v14
    v_add_f32 v35, v35, v15
    v_add_f32 v36, v36, v16
    v_add_f32 v37, v37, v17
    v_add_f32 v38, v38, v18
    v_add_f32 v39, v39, v19
L_p3_kernel_q_3:
    s_mov_b64 exec, -1
    v_cmp_eq_u32 vcc, 0, v11
    s_nop 1
    s_and_b64 exec, exec, vcc
    s_cbranch_execz L_p3_kernel_q_4
    s_mov_b32 s3, 311173632
    buffer_load_dwordx4 v[12:15], v7, s[4:7], s3 offen
    buffer_load_dwordx4 v[16:19], v7, s[4:7], s3 offen offset:16
    s_waitcnt vmcnt(0)
    v_add_f32 v32, v32, v12
    v_add_f32 v33, v33, v13
    v_add_f32 v34, v34, v14
    v_add_f32 v35, v35, v15
    v_add_f32 v36, v36, v16
    v_add_f32 v37, v37, v17
    v_add_f32 v38, v38, v18
    v_add_f32 v39, v39, v19
L_p3_kernel_q_4:
    s_mov_b64 exec, -1
L_p3_fast:
    s_waitcnt vmcnt(0)
    v_mul_f32 v12, s64, v32
    v_mul_f32 v13, s65, v32
    v_mul_f32 v14, s66, v32
    v_mul_f32 v15, s67, v32
    v_fmac_f32 v12, s68, v33
    v_fmac_f32 v13, s69, v33
    v_fmac_f32 v14, s70, v33
    v_fmac_f32 v15, s71, v33
    v_fmac_f32 v12, s72, v34
    v_fmac_f32 v13, s73, v34
    v_fmac_f32 v14, s74, v34
    v_fmac_f32 v15, s75, v34
    v_fmac_f32 v12, s76, v35
    v_fmac_f32 v13, s77, v35
    v_fmac_f32 v14, s78, v35
    v_fmac_f32 v15, s79, v35
    v_mul_f32 v12, v12, v48
    v_mul_f32 v13, v13, v49
    v_mul_f32 v14, v14, v50
    v_mul_f32 v15, v15, v51
    v_mul_f32 v16, s80, v12
    v_mul_f32 v17, s81, v12
    v_mul_f32 v18, s82, v12
    v_mul_f32 v19, s83, v12
    v_fmac_f32 v16, s84, v13
    v_fmac_f32 v17, s85, v13
    v_fmac_f32 v18, s86, v13
    v_fmac_f32 v19, s87, v13
    v_fmac_f32 v16, s88, v14
    v_fmac_f32 v17, s89, v14
    v_fmac_f32 v18, s90, v14
    v_fmac_f32 v19, s91, v14
    v_fmac_f32 v16, s92, v15
    v_fmac_f32 v17, s93, v15
    v_fmac_f32 v18, s94, v15
    v_fmac_f32 v19, s95, v15
    v_lshlrev_b32 v20, 16, v28
    v_and_b32 v21, 0xffff0000, v28
    v_lshlrev_b32 v22, 16, v29
    v_and_b32 v23, 0xffff0000, v29
    v_fmac_f32 v20, v16, v44
    v_fmac_f32 v21, v17, v45
    v_fmac_f32 v22, v18, v46
    v_fmac_f32 v23, v19, v47
    v_cvt_pk_bf16_f32 v28, v20, v21
    v_cvt_pk_bf16_f32 v29, v22, v23
    v_mul_f32 v12, s64, v36
    v_mul_f32 v13, s65, v36
    v_mul_f32 v14, s66, v36
    v_mul_f32 v15, s67, v36
    v_fmac_f32 v12, s68, v37
    v_fmac_f32 v13, s69, v37
    v_fmac_f32 v14, s70, v37
    v_fmac_f32 v15, s71, v37
    v_fmac_f32 v12, s72, v38
    v_fmac_f32 v13, s73, v38
    v_fmac_f32 v14, s74, v38
    v_fmac_f32 v15, s75, v38
    v_fmac_f32 v12, s76, v39
    v_fmac_f32 v13, s77, v39
    v_fmac_f32 v14, s78, v39
    v_fmac_f32 v15, s79, v39
    v_mul_f32 v12, v12, v56
    v_mul_f32 v13, v13, v57
    v_mul_f32 v14, v14, v58
    v_mul_f32 v15, v15, v59
    v_mul_f32 v16, s80, v12
    v_mul_f32 v17, s81, v12
    v_mul_f32 v18, s82, v12
    v_mul_f32 v19, s83, v12
    v_fmac_f32 v16, s84, v13
    v_fmac_f32 v17, s85, v13
    v_fmac_f32 v18, s86, v13
    v_fmac_f32 v19, s87, v13
    v_fmac_f32 v16, s88, v14
    v_fmac_f32 v17, s89, v14
    v_fmac_f32 v18, s90, v14
    v_fmac_f32 v19, s91, v14
    v_fmac_f32 v16, s92, v15
    v_fmac_f32 v17, s93, v15
    v_fmac_f32 v18, s94, v15
    v_fmac_f32 v19, s95, v15
    v_lshlrev_b32 v20, 16, v30
    v_and_b32 v21, 0xffff0000, v30
    v_lshlrev_b32 v22, 16, v31
    v_and_b32 v23, 0xffff0000, v31
    v_fmac_f32 v20, v16, v52
    v_fmac_f32 v21, v17, v53
    v_fmac_f32 v22, v18, v54
    v_fmac_f32 v23, v19, v55
    v_cvt_pk_bf16_f32 v30, v20, v21
    v_cvt_pk_bf16_f32 v31, v22, v23
    buffer_store_dwordx4 v[28:31], v1, s[16:19], 0 offen
L_p3_end:
    s_endpgm
.section .rodata,"a"
.p2align 6
.amdhsa_kernel p1_kernel
  .amdhsa_next_free_vgpr 128
  .amdhsa_next_free_sgpr 96
  .amdhsa_accum_offset 128
  .amdhsa_group_segment_fixed_size 0
  .amdhsa_kernarg_size 112
  .amdhsa_user_sgpr_count 2
  .amdhsa_user_sgpr_kernarg_segment_ptr 1
  .amdhsa_system_sgpr_workgroup_id_x 1
  .amdhsa_float_denorm_mode_32 0
.end_amdhsa_kernel
.p2align 6
.amdhsa_kernel p2_kernel
  .amdhsa_next_free_vgpr 128
  .amdhsa_next_free_sgpr 102
  .amdhsa_accum_offset 128
  .amdhsa_group_segment_fixed_size 0
  .amdhsa_kernarg_size 112
  .amdhsa_user_sgpr_count 2
  .amdhsa_user_sgpr_kernarg_segment_ptr 1
  .amdhsa_system_sgpr_workgroup_id_x 1
  .amdhsa_float_denorm_mode_32 0
.end_amdhsa_kernel
.p2align 6
.amdhsa_kernel p3_kernel
  .amdhsa_next_free_vgpr 64
  .amdhsa_next_free_sgpr 102
  .amdhsa_accum_offset 64
  .amdhsa_group_segment_fixed_size 0
  .amdhsa_kernarg_size 112
  .amdhsa_user_sgpr_count 2
  .amdhsa_user_sgpr_kernarg_segment_ptr 1
  .amdhsa_system_sgpr_workgroup_id_x 1
  .amdhsa_float_denorm_mode_32 0
.end_amdhsa_kernel
```

```asm
; @launch kernel=p1_kernel grid=(256,1,1) block=(1024,1,1) lds=163840
; @launch kernel=p2_kernel grid=(256,1,1) block=(1024,1,1) lds=163840
; @launch kernel=p3_kernel grid=(1250,1,1) block=(256,1,1) lds=0
.amdgcn_target "amdgcn-amd-amdhsa--gfx950"
.text
.globl p1_kernel
.p2align 8
.type p1_kernel,@function
p1_kernel:
    s_cmp_ge_u32 s2, 256
    s_cbranch_scc1 L_p1_end
    s_load_dwordx2 s[4:5], s[0:1], 104
    s_load_dwordx2 s[8:9], s[0:1], 8
    s_load_dwordx2 s[12:13], s[0:1], 16
    s_load_dwordx2 s[16:17], s[0:1], 32
    s_load_dwordx2 s[28:29], s[0:1], 0
    s_load_dwordx2 s[6:7], s[0:1], 48
    v_lshlrev_b32 v1, 4, v0
    v_lshlrev_b32 v2, 3, v0
    v_lshrrev_b32 v6, 6, v0
    v_mul_u32_u24 v3, 1216, v6
    v_add_u32 v3, v3, v0
    v_mul_u32_u24 v3, 12, v3
    v_mov_b32 v4, 1
    v_mov_b32 v5, 0
    v_readfirstlane_b32 s39, v6
    v_cmp_gt_u32 vcc, 784, v0
    s_mov_b32 s32, s2
    s_lshl_b32 s33, s2, 14
    s_lshl_b32 s34, s2, 13
    s_mul_i32 s48, s2, 3840
    s_mul_i32 s49, s2, 1920
    s_mov_b64 s[44:45], vcc
    s_waitcnt lgkmcnt(0)
    s_load_dword s3, s[6:7], 0
    s_mov_b32 s10, 163840000
    s_mov_b32 s11, 0x00020000
    s_mov_b32 s14, 163840000
    s_mov_b32 s15, 0x00020000
    s_mov_b32 s18, 81920000
    s_mov_b32 s19, 0x00020000
    s_mul_i32 s36, s2, 20000
    s_add_u32 s30, s36, 20000
    s_mov_b32 s31, 0x00020000
    s_add_u32 s35, s36, 16384
    buffer_load_dwordx4 v[48:51], v1, s[28:31], s36 offen nt
    buffer_load_dwordx4 v[52:55], v1, s[28:31], s35 offen nt
    s_add_u32 s35, s33, 0
    buffer_load_dwordx4 v[16:19], v1, s[8:11], s35 offen nt
    s_add_u32 s35, s33, 0
    buffer_load_dwordx4 v[20:23], v1, s[12:15], s35 offen nt
    s_add_u32 s35, s33, 4194304
    buffer_load_dwordx4 v[24:27], v1, s[8:11], s35 offen nt
    s_add_u32 s35, s33, 4194304
    buffer_load_dwordx4 v[28:31], v1, s[12:15], s35 offen nt
    s_add_u32 s35, s33, 8388608
    buffer_load_dwordx4 v[32:35], v1, s[8:11], s35 offen nt
    s_add_u32 s35, s33, 8388608
    buffer_load_dwordx4 v[36:39], v1, s[12:15], s35 offen nt
    s_add_u32 s35, s33, 12582912
    buffer_load_dwordx4 v[40:43], v1, s[8:11], s35 offen nt
    s_add_u32 s35, s33, 12582912
    buffer_load_dwordx4 v[44:47], v1, s[12:15], s35 offen nt
    s_mov_b32 s20, s4
    s_mov_b32 s21, s5
    s_mov_b32 s22, 0
    s_mov_b32 s23, 0x00020000
    s_add_u32 s24, s4, 246292480
    s_addc_u32 s25, s5, 0
    s_mov_b32 s26, 8557056
    s_mov_b32 s27, 0x00020000
    s_mov_b32 s37, 1492179184
    s_mov_b32 s55, 0
    s_mov_b32 s38, 262400
    s_mov_b32 s43, 0x05040100
    s_mov_b32 s40, 0
    v_mov_b32 v8, 0
    v_mov_b32 v9, 0
    v_mov_b32 v10, 0
    v_mov_b32 v11, 0
    ds_write_b128 v1, v[8:11] offset:0
    s_waitcnt lgkmcnt(0)
    s_lshl_b32 s3, s3, 16
    v_mov_b32 v12, s3
    v_mul_f32 v12, 0.15915494, v12
    s_nop 0
    v_readfirstlane_b32 s41, v12
    s_waitcnt vmcnt(8)
    s_add_u32 s28, s4, 254853632
    s_addc_u32 s29, s5, 0
    s_mul_i32 s36, s2, 20000
    s_add_u32 s35, s36, 16384
    buffer_store_dwordx4 v[48:51], v1, s[28:31], s36 offen
    buffer_store_dwordx4 v[52:55], v1, s[28:31], s35 offen
    s_nop 0
    v_mov_b32 v12, 0x3f803f80
    v_and_b32 v48, 0x7fff7fff, v48
    v_and_b32 v49, 0x7fff7fff, v49
    v_and_b32 v50, 0x7fff7fff, v50
    v_and_b32 v51, 0x7fff7fff, v51
    v_and_b32 v52, 0x7fff7fff, v52
    v_and_b32 v53, 0x7fff7fff, v53
    v_and_b32 v54, 0x7fff7fff, v54
    v_and_b32 v55, 0x7fff7fff, v55
    v_pk_max_u16 v8, v8, v48
    v_dot2c_f32_bf16 v9, v48, v12
    v_pk_max_u16 v8, v8, v49
    v_dot2c_f32_bf16 v9, v49, v12
    v_pk_max_u16 v8, v8, v50
    v_dot2c_f32_bf16 v9, v50, v12
    v_pk_max_u16 v8, v8, v51
    v_dot2c_f32_bf16 v9, v51, v12
    v_pk_max_u16 v8, v8, v52
    v_dot2c_f32_bf16 v9, v52, v12
    v_pk_max_u16 v8, v8, v53
    v_dot2c_f32_bf16 v9, v53, v12
    v_pk_max_u16 v8, v8, v54
    v_dot2c_f32_bf16 v9, v54, v12
    v_pk_max_u16 v8, v8, v55
    v_dot2c_f32_bf16 v9, v55, v12
    v_lshrrev_b32 v10, 16, v8
    v_and_b32 v8, 0xffff, v8
    v_max_u32 v8, v8, v10
    s_nop 0
    s_nop 1
    v_max_u32_dpp v8, v8, v8 row_shr:1 row_mask:0xf bank_mask:0xf bound_ctrl:0
    s_nop 1
    v_max_u32_dpp v8, v8, v8 row_shr:2 row_mask:0xf bank_mask:0xf bound_ctrl:0
    s_nop 1
    v_max_u32_dpp v8, v8, v8 row_shr:4 row_mask:0xf bank_mask:0xf bound_ctrl:0
    s_nop 1
    v_max_u32_dpp v8, v8, v8 row_shr:8 row_mask:0xf bank_mask:0xf bound_ctrl:0
    s_nop 1
    v_max_u32_dpp v8, v8, v8 row_bcast:15 row_mask:0xa bank_mask:0xf
    s_nop 1
    v_max_u32_dpp v8, v8, v8 row_bcast:31 row_mask:0xc bank_mask:0xf
    s_nop 1
    v_add_f32_dpp v9, v9, v9 row_shr:1 row_mask:0xf bank_mask:0xf bound_ctrl:0
    s_nop 1
    v_add_f32_dpp v9, v9, v9 row_shr:2 row_mask:0xf bank_mask:0xf bound_ctrl:0
    s_nop 1
    v_add_f32_dpp v9, v9, v9 row_shr:4 row_mask:0xf bank_mask:0xf bound_ctrl:0
    s_nop 1
    v_add_f32_dpp v9, v9, v9 row_shr:8 row_mask:0xf bank_mask:0xf bound_ctrl:0
    s_nop 1
    v_add_f32_dpp v9, v9, v9 row_bcast:15 row_mask:0xa bank_mask:0xf
    s_nop 1
    v_add_f32_dpp v9, v9, v9 row_bcast:31 row_mask:0xc bank_mask:0xf
    s_lshl_b32 s35, s39, 4
    s_add_u32 s35, s35, 160320
    v_mov_b32 v10, s35
    s_mov_b32 exec_lo, 0
    s_brev_b32 exec_hi, 1
    ds_write_b64 v10, v[8:9]
    s_mov_b64 exec, -1
    s_waitcnt lgkmcnt(0)
    s_barrier
    s_branch L_p1_first
L_p1_loop:
    s_mov_b32 s36, 6144
    buffer_store_dwordx3 v[80:82], v3, s[20:23], s36 offen sc1
    s_mov_b32 s36, 6912
    buffer_store_dwordx3 v[84:86], v3, s[20:23], s36 offen sc1
    s_nop 0
    s_add_u32 s35, s33, 16777216
    buffer_load_dwordx4 v[80:83], v1, s[8:11], s35 offen nt
    s_add_u32 s35, s33, 16777216
    buffer_load_dwordx4 v[84:87], v1, s[12:15], s35 offen nt
    s_mov_b32 s36, 7680
    buffer_store_dwordx3 v[88:90], v3, s[20:23], s36 offen sc1
    s_mov_b32 s36, 8448
    buffer_store_dwordx3 v[92:94], v3, s[20:23], s36 offen sc1
    s_nop 0
    s_add_u32 s35, s33, 20971520
    buffer_load_dwordx4 v[88:91], v1, s[8:11], s35 offen nt
    s_add_u32 s35, s33, 20971520
    buffer_load_dwordx4 v[92:95], v1, s[12:15], s35 offen nt
    s_mov_b32 s36, 9216
    buffer_store_dwordx3 v[96:98], v3, s[20:23], s36 offen sc1
    s_mov_b32 s36, 9984
    buffer_store_dwordx3 v[100:102], v3, s[20:23], s36 offen sc1
    s_nop 0
    s_add_u32 s35, s33, 25165824
    buffer_load_dwordx4 v[96:99], v1, s[8:11], s35 offen nt
    s_add_u32 s35, s33, 25165824
    buffer_load_dwordx4 v[100:103], v1, s[12:15], s35 offen nt
    s_mov_b32 s36, 10752
    buffer_store_dwordx3 v[104:106], v3, s[20:23], s36 offen sc1
    s_mov_b32 s36, 11520
    buffer_store_dwordx3 v[108:110], v3, s[20:23], s36 offen sc1
    s_nop 0
    s_add_u32 s35, s33, 29360128
    buffer_load_dwordx4 v[104:107], v1, s[8:11], s35 offen nt
    s_add_u32 s35, s33, 29360128
    buffer_load_dwordx4 v[108:111], v1, s[12:15], s35 offen nt
    s_mov_b32 s36, 12288
    buffer_store_dwordx3 v[112:114], v3, s[20:23], s36 offen sc1
    s_mov_b32 s36, 13056
    buffer_store_dwordx3 v[116:118], v3, s[20:23], s36 offen sc1
    s_nop 0
    s_add_u32 s35, s33, 33554432
    buffer_load_dwordx4 v[112:115], v1, s[8:11], s35 offen nt
    s_add_u32 s35, s33, 33554432
    buffer_load_dwordx4 v[116:119], v1, s[12:15], s35 offen nt
    s_mov_b32 s36, 13824
    buffer_store_dwordx3 v[120:122], v3, s[20:23], s36 offen sc1
    s_mov_b32 s36, 14592
    buffer_store_dwordx3 v[124:126], v3, s[20:23], s36 offen sc1
    s_nop 0
    s_add_u32 s35, s33, 37748736
    s_sub_u32 s35, s35, s48
    s_mov_b64 exec, s[44:45]
    buffer_load_dwordx4 v[120:123], v1, s[8:11], s35 offen nt
    s_mov_b64 exec, -1
    s_add_u32 s35, s33, 37748736
    s_sub_u32 s35, s35, s48
    s_mov_b64 exec, s[44:45]
    buffer_load_dwordx4 v[124:127], v1, s[12:15], s35 offen nt
    s_mov_b64 exec, -1
    s_mov_b32 s36, 0
    buffer_store_dwordx3 v[48:50], v3, s[20:23], s36 offen sc1
    s_mov_b32 s36, 768
    buffer_store_dwordx3 v[52:54], v3, s[20:23], s36 offen sc1
    s_mov_b32 s36, 1536
    buffer_store_dwordx3 v[56:58], v3, s[20:23], s36 offen sc1
    s_mov_b32 s36, 2304
    buffer_store_dwordx3 v[60:62], v3, s[20:23], s36 offen sc1
    s_mov_b32 s36, 3072
    buffer_store_dwordx3 v[64:66], v3, s[20:23], s36 offen sc1
    s_mov_b32 s36, 3840
    buffer_store_dwordx3 v[68:70], v3, s[20:23], s36 offen sc1
    s_mov_b32 s36, 4608
    buffer_store_dwordx3 v[72:74], v3, s[20:23], s36 offen sc1
    s_mov_b32 s36, 5376
    buffer_store_dwordx3 v[76:78], v3, s[20:23], s36 offen sc1
    s_branch L_p1_join
L_p1_first:
    s_add_u32 s35, s33, 16777216
    buffer_load_dwordx4 v[80:83], v1, s[8:11], s35 offen nt
    s_add_u32 s35, s33, 16777216
    buffer_load_dwordx4 v[84:87], v1, s[12:15], s35 offen nt
    s_add_u32 s35, s33, 20971520
    buffer_load_dwordx4 v[88:91], v1, s[8:11], s35 offen nt
    s_add_u32 s35, s33, 20971520
    buffer_load_dwordx4 v[92:95], v1, s[12:15], s35 offen nt
    s_add_u32 s35, s33, 25165824
    buffer_load_dwordx4 v[96:99], v1, s[8:11], s35 offen nt
    s_add_u32 s35, s33, 25165824
    buffer_load_dwordx4 v[100:103], v1, s[12:15], s35 offen nt
    s_add_u32 s35, s33, 29360128
    buffer_load_dwordx4 v[104:107], v1, s[8:11], s35 offen nt
    s_add_u32 s35, s33, 29360128
    buffer_load_dwordx4 v[108:111], v1, s[12:15], s35 offen nt
    s_add_u32 s35, s33, 33554432
    buffer_load_dwordx4 v[112:115], v1, s[8:11], s35 offen nt
    s_add_u32 s35, s33, 33554432
    buffer_load_dwordx4 v[116:119], v1, s[12:15], s35 offen nt
    s_add_u32 s35, s33, 37748736
    s_sub_u32 s35, s35, s48
    s_mov_b64 exec, s[44:45]
    buffer_load_dwordx4 v[120:123], v1, s[8:11], s35 offen nt
    s_mov_b64 exec, -1
    s_add_u32 s35, s33, 37748736
    s_sub_u32 s35, s35, s48
    s_mov_b64 exec, s[44:45]
    buffer_load_dwordx4 v[124:127], v1, s[12:15], s35 offen nt
    s_mov_b64 exec, -1
L_p1_join:
    s_waitcnt vmcnt(18)
    v_perm_b32 v6, v20, v16, s43
    v_perm_b32 v7, v21, v17, s43
    v_perm_b32 v8, v22, v18, s43
    v_perm_b32 v9, v23, v19, s43
    v_mul_hi_u32_u24 v16, 429497, v16
    v_mul_hi_u32_u24 v20, 429497, v20
    v_mul_hi_u32_u24 v17, 429497, v17
    v_mul_hi_u32_u24 v21, 429497, v21
    v_mul_hi_u32_u24 v18, 429497, v18
    v_mul_hi_u32_u24 v22, 429497, v22
    v_mul_hi_u32_u24 v19, 429497, v19
    v_mul_hi_u32_u24 v23, 429497, v23
    v_lshl_or_b32 v16, v20, 16, v16
    v_lshl_or_b32 v17, v21, 16, v17
    v_lshl_or_b32 v18, v22, 16, v18
    v_lshl_or_b32 v19, v23, 16, v19
    v_dot2_u32_u16 v20, v16, s38, 0
    v_dot2_u32_u16 v21, v17, s38, 0
    v_dot2_u32_u16 v22, v18, s38, 0
    v_dot2_u32_u16 v23, v19, s38, 0
    v_pk_mad_u16 v6, v16, s37, v6
    v_pk_mad_u16 v7, v17, s37, v7
    v_pk_mad_u16 v8, v18, s37, v8
    v_pk_mad_u16 v9, v19, s37, v9
    ds_add_u32 v20, v4 offset:0
    ds_add_u32 v21, v4 offset:0
    ds_add_u32 v22, v4 offset:0
    ds_add_u32 v23, v4 offset:0
    v_perm_b32 v55, v23, v22, s43
    v_perm_b32 v54, v21, v20, s43
    v_or_b32 v48, 0x40000000, v6
    v_or_b32 v49, 0x40000000, v7
    v_or_b32 v52, 0x40000000, v8
    v_or_b32 v53, 0x40000000, v9
    s_waitcnt vmcnt(16)
    v_perm_b32 v6, v28, v24, s43
    v_perm_b32 v7, v29, v25, s43
    v_perm_b32 v8, v30, v26, s43
    v_perm_b32 v9, v31, v27, s43
    v_mul_hi_u32_u24 v24, 429497, v24
    v_mul_hi_u32_u24 v28, 429497, v28
    v_mul_hi_u32_u24 v25, 429497, v25
    v_mul_hi_u32_u24 v29, 429497, v29
    v_mul_hi_u32_u24 v26, 429497, v26
    v_mul_hi_u32_u24 v30, 429497, v30
    v_mul_hi_u32_u24 v27, 429497, v27
    v_mul_hi_u32_u24 v31, 429497, v31
    v_lshl_or_b32 v24, v28, 16, v24
    v_lshl_or_b32 v25, v29, 16, v25
    v_lshl_or_b32 v26, v30, 16, v26
    v_lshl_or_b32 v27, v31, 16, v27
    v_dot2_u32_u16 v28, v24, s38, 0
    v_dot2_u32_u16 v29, v25, s38, 0
    v_dot2_u32_u16 v30, v26, s38, 0
    v_dot2_u32_u16 v31, v27, s38, 0
    v_pk_mad_u16 v6, v24, s37, v6
    v_pk_mad_u16 v7, v25, s37, v7
    v_pk_mad_u16 v8, v26, s37, v8
    v_pk_mad_u16 v9, v27, s37, v9
    ds_add_u32 v28, v4 offset:0
    ds_add_u32 v29, v4 offset:0
    ds_add_u32 v30, v4 offset:0
    ds_add_u32 v31, v4 offset:0
    v_perm_b32 v63, v31, v30, s43
    v_perm_b32 v62, v29, v28, s43
    v_or_b32 v56, 0x40000000, v6
    v_or_b32 v57, 0x40000000, v7
    v_or_b32 v60, 0x40000000, v8
    v_or_b32 v61, 0x40000000, v9
    s_waitcnt vmcnt(14)
    v_perm_b32 v6, v36, v32, s43
    v_perm_b32 v7, v37, v33, s43
    v_perm_b32 v8, v38, v34, s43
    v_perm_b32 v9, v39, v35, s43
    v_mul_hi_u32_u24 v32, 429497, v32
    v_mul_hi_u32_u24 v36, 429497, v36
    v_mul_hi_u32_u24 v33, 429497, v33
    v_mul_hi_u32_u24 v37, 429497, v37
    v_mul_hi_u32_u24 v34, 429497, v34
    v_mul_hi_u32_u24 v38, 429497, v38
    v_mul_hi_u32_u24 v35, 429497, v35
    v_mul_hi_u32_u24 v39, 429497, v39
    v_lshl_or_b32 v32, v36, 16, v32
    v_lshl_or_b32 v33, v37, 16, v33
    v_lshl_or_b32 v34, v38, 16, v34
    v_lshl_or_b32 v35, v39, 16, v35
    v_dot2_u32_u16 v36, v32, s38, 0
    v_dot2_u32_u16 v37, v33, s38, 0
    v_dot2_u32_u16 v38, v34, s38, 0
    v_dot2_u32_u16 v39, v35, s38, 0
    v_pk_mad_u16 v6, v32, s37, v6
    v_pk_mad_u16 v7, v33, s37, v7
    v_pk_mad_u16 v8, v34, s37, v8
    v_pk_mad_u16 v9, v35, s37, v9
    ds_add_u32 v36, v4 offset:0
    ds_add_u32 v37, v4 offset:0
    ds_add_u32 v38, v4 offset:0
    ds_add_u32 v39, v4 offset:0
    v_perm_b32 v71, v39, v38, s43
    v_perm_b32 v70, v37, v36, s43
    v_or_b32 v64, 0x40000000, v6
    v_or_b32 v65, 0x40000000, v7
    v_or_b32 v68, 0x40000000, v8
    v_or_b32 v69, 0x40000000, v9
    s_waitcnt vmcnt(12)
    v_perm_b32 v6, v44, v40, s43
    v_perm_b32 v7, v45, v41, s43
    v_perm_b32 v8, v46, v42, s43
    v_perm_b32 v9, v47, v43, s43
    v_mul_hi_u32_u24 v40, 429497, v40
    v_mul_hi_u32_u24 v44, 429497, v44
    v_mul_hi_u32_u24 v41, 429497, v41
    v_mul_hi_u32_u24 v45, 429497, v45
    v_mul_hi_u32_u24 v42, 429497, v42
    v_mul_hi_u32_u24 v46, 429497, v46
    v_mul_hi_u32_u24 v43, 429497, v43
    v_mul_hi_u32_u24 v47, 429497, v47
    v_lshl_or_b32 v40, v44, 16, v40
    v_lshl_or_b32 v41, v45, 16, v41
    v_lshl_or_b32 v42, v46, 16, v42
    v_lshl_or_b32 v43, v47, 16, v43
    v_dot2_u32_u16 v44, v40, s38, 0
    v_dot2_u32_u16 v45, v41, s38, 0
    v_dot2_u32_u16 v46, v42, s38, 0
    v_dot2_u32_u16 v47, v43, s38, 0
    v_pk_mad_u16 v6, v40, s37, v6
    v_pk_mad_u16 v7, v41, s37, v7
    v_pk_mad_u16 v8, v42, s37, v8
    v_pk_mad_u16 v9, v43, s37, v9
    ds_add_u32 v44, v4 offset:0
    ds_add_u32 v45, v4 offset:0
    ds_add_u32 v46, v4 offset:0
    ds_add_u32 v47, v4 offset:0
    v_perm_b32 v79, v47, v46, s43
    v_perm_b32 v78, v45, v44, s43
    v_or_b32 v72, 0x40000000, v6
    v_or_b32 v73, 0x40000000, v7
    v_or_b32 v76, 0x40000000, v8
    v_or_b32 v77, 0x40000000, v9
    s_waitcnt vmcnt(10)
    v_perm_b32 v6, v84, v80, s43
    v_perm_b32 v7, v85, v81, s43
    v_perm_b32 v8, v86, v82, s43
    v_perm_b32 v9, v87, v83, s43
    v_mul_hi_u32_u24 v80, 429497, v80
    v_mul_hi_u32_u24 v84, 429497, v84
    v_mul_hi_u32_u24 v81, 429497, v81
    v_mul_hi_u32_u24 v85, 429497, v85
    v_mul_hi_u32_u24 v82, 429497, v82
    v_mul_hi_u32_u24 v86, 429497, v86
    v_mul_hi_u32_u24 v83, 429497, v83
    v_mul_hi_u32_u24 v87, 429497, v87
    v_lshl_or_b32 v80, v84, 16, v80
    v_lshl_or_b32 v81, v85, 16, v81
    v_lshl_or_b32 v82, v86, 16, v82
    v_lshl_or_b32 v83, v87, 16, v83
    v_dot2_u32_u16 v84, v80, s38, 0
    v_dot2_u32_u16 v85, v81, s38, 0
    v_dot2_u32_u16 v86, v82, s38, 0
    v_dot2_u32_u16 v87, v83, s38, 0
    v_pk_mad_u16 v6, v80, s37, v6
    v_pk_mad_u16 v7, v81, s37, v7
    v_pk_mad_u16 v8, v82, s37, v8
    v_pk_mad_u16 v9, v83, s37, v9
    ds_add_u32 v84, v4 offset:0
    ds_add_u32 v85, v4 offset:0
    ds_add_u32 v86, v4 offset:0
    ds_add_u32 v87, v4 offset:0
    v_perm_b32 v87, v87, v86, s43
    v_perm_b32 v86, v85, v84, s43
    v_or_b32 v80, 0x40000000, v6
    v_or_b32 v81, 0x40000000, v7
    v_or_b32 v84, 0x40000000, v8
    v_or_b32 v85, 0x40000000, v9
    s_waitcnt vmcnt(8)
    v_perm_b32 v6, v92, v88, s43
    v_perm_b32 v7, v93, v89, s43
    v_perm_b32 v8, v94, v90, s43
    v_perm_b32 v9, v95, v91, s43
    v_mul_hi_u32_u24 v88, 429497, v88
    v_mul_hi_u32_u24 v92, 429497, v92
    v_mul_hi_u32_u24 v89, 429497, v89
    v_mul_hi_u32_u24 v93, 429497, v93
    v_mul_hi_u32_u24 v90, 429497, v90
    v_mul_hi_u32_u24 v94, 429497, v94
    v_mul_hi_u32_u24 v91, 429497, v91
    v_mul_hi_u32_u24 v95, 429497, v95
    v_lshl_or_b32 v88, v92, 16, v88
    v_lshl_or_b32 v89, v93, 16, v89
    v_lshl_or_b32 v90, v94, 16, v90
    v_lshl_or_b32 v91, v95, 16, v91
    v_dot2_u32_u16 v92, v88, s38, 0
    v_dot2_u32_u16 v93, v89, s38, 0
    v_dot2_u32_u16 v94, v90, s38, 0
    v_dot2_u32_u16 v95, v91, s38, 0
    v_pk_mad_u16 v6, v88, s37, v6
    v_pk_mad_u16 v7, v89, s37, v7
    v_pk_mad_u16 v8, v90, s37, v8
    v_pk_mad_u16 v9, v91, s37, v9
    ds_add_u32 v92, v4 offset:0
    ds_add_u32 v93, v4 offset:0
    ds_add_u32 v94, v4 offset:0
    ds_add_u32 v95, v4 offset:0
    v_perm_b32 v95, v95, v94, s43
    v_perm_b32 v94, v93, v92, s43
    v_or_b32 v88, 0x40000000, v6
    v_or_b32 v89, 0x40000000, v7
    v_or_b32 v92, 0x40000000, v8
    v_or_b32 v93, 0x40000000, v9
    s_waitcnt vmcnt(6)
    v_perm_b32 v6, v100, v96, s43
    v_perm_b32 v7, v101, v97, s43
    v_perm_b32 v8, v102, v98, s43
    v_perm_b32 v9, v103, v99, s43
    v_mul_hi_u32_u24 v96, 429497, v96
    v_mul_hi_u32_u24 v100, 429497, v100
    v_mul_hi_u32_u24 v97, 429497, v97
    v_mul_hi_u32_u24 v101, 429497, v101
    v_mul_hi_u32_u24 v98, 429497, v98
    v_mul_hi_u32_u24 v102, 429497, v102
    v_mul_hi_u32_u24 v99, 429497, v99
    v_mul_hi_u32_u24 v103, 429497, v103
    v_lshl_or_b32 v96, v100, 16, v96
    v_lshl_or_b32 v97, v101, 16, v97
    v_lshl_or_b32 v98, v102, 16, v98
    v_lshl_or_b32 v99, v103, 16, v99
    v_dot2_u32_u16 v100, v96, s38, 0
    v_dot2_u32_u16 v101, v97, s38, 0
    v_dot2_u32_u16 v102, v98, s38, 0
    v_dot2_u32_u16 v103, v99, s38, 0
    v_pk_mad_u16 v6, v96, s37, v6
    v_pk_mad_u16 v7, v97, s37, v7
    v_pk_mad_u16 v8, v98, s37, v8
    v_pk_mad_u16 v9, v99, s37, v9
    ds_add_u32 v100, v4 offset:0
    ds_add_u32 v101, v4 offset:0
    ds_add_u32 v102, v4 offset:0
    ds_add_u32 v103, v4 offset:0
    v_perm_b32 v103, v103, v102, s43
    v_perm_b32 v102, v101, v100, s43
    v_or_b32 v96, 0x40000000, v6
    v_or_b32 v97, 0x40000000, v7
    v_or_b32 v100, 0x40000000, v8
    v_or_b32 v101, 0x40000000, v9
    s_waitcnt vmcnt(4)
    v_perm_b32 v6, v108, v104, s43
    v_perm_b32 v7, v109, v105, s43
    v_perm_b32 v8, v110, v106, s43
    v_perm_b32 v9, v111, v107, s43
    v_mul_hi_u32_u24 v104, 429497, v104
    v_mul_hi_u32_u24 v108, 429497, v108
    v_mul_hi_u32_u24 v105, 429497, v105
    v_mul_hi_u32_u24 v109, 429497, v109
    v_mul_hi_u32_u24 v106, 429497, v106
    v_mul_hi_u32_u24 v110, 429497, v110
    v_mul_hi_u32_u24 v107, 429497, v107
    v_mul_hi_u32_u24 v111, 429497, v111
    v_lshl_or_b32 v104, v108, 16, v104
    v_lshl_or_b32 v105, v109, 16, v105
    v_lshl_or_b32 v106, v110, 16, v106
    v_lshl_or_b32 v107, v111, 16, v107
    v_dot2_u32_u16 v108, v104, s38, 0
    v_dot2_u32_u16 v109, v105, s38, 0
    v_dot2_u32_u16 v110, v106, s38, 0
    v_dot2_u32_u16 v111, v107, s38, 0
    v_pk_mad_u16 v6, v104, s37, v6
    v_pk_mad_u16 v7, v105, s37, v7
    v_pk_mad_u16 v8, v106, s37, v8
    v_pk_mad_u16 v9, v107, s37, v9
    ds_add_u32 v108, v4 offset:0
    ds_add_u32 v109, v4 offset:0
    ds_add_u32 v110, v4 offset:0
    ds_add_u32 v111, v4 offset:0
    v_perm_b32 v111, v111, v110, s43
    v_perm_b32 v110, v109, v108, s43
    v_or_b32 v104, 0x40000000, v6
    v_or_b32 v105, 0x40000000, v7
    v_or_b32 v108, 0x40000000, v8
    v_or_b32 v109, 0x40000000, v9
    s_waitcnt vmcnt(2)
    v_perm_b32 v6, v116, v112, s43
    v_perm_b32 v7, v117, v113, s43
    v_perm_b32 v8, v118, v114, s43
    v_perm_b32 v9, v119, v115, s43
    v_mul_hi_u32_u24 v112, 429497, v112
    v_mul_hi_u32_u24 v116, 429497, v116
    v_mul_hi_u32_u24 v113, 429497, v113
    v_mul_hi_u32_u24 v117, 429497, v117
    v_mul_hi_u32_u24 v114, 429497, v114
    v_mul_hi_u32_u24 v118, 429497, v118
    v_mul_hi_u32_u24 v115, 429497, v115
    v_mul_hi_u32_u24 v119, 429497, v119
    v_lshl_or_b32 v112, v116, 16, v112
    v_lshl_or_b32 v113, v117, 16, v113
    v_lshl_or_b32 v114, v118, 16, v114
    v_lshl_or_b32 v115, v119, 16, v115
    v_dot2_u32_u16 v116, v112, s38, 0
    v_dot2_u32_u16 v117, v113, s38, 0
    v_dot2_u32_u16 v118, v114, s38, 0
    v_dot2_u32_u16 v119, v115, s38, 0
    v_pk_mad_u16 v6, v112, s37, v6
    v_pk_mad_u16 v7, v113, s37, v7
    v_pk_mad_u16 v8, v114, s37, v8
    v_pk_mad_u16 v9, v115, s37, v9
    ds_add_u32 v116, v4 offset:0
    ds_add_u32 v117, v4 offset:0
    ds_add_u32 v118, v4 offset:0
    ds_add_u32 v119, v4 offset:0
    v_perm_b32 v119, v119, v118, s43
    v_perm_b32 v118, v117, v116, s43
    v_or_b32 v112, 0x40000000, v6
    v_or_b32 v113, 0x40000000, v7
    v_or_b32 v116, 0x40000000, v8
    v_or_b32 v117, 0x40000000, v9
    s_waitcnt vmcnt(0)
    s_mov_b64 exec, s[44:45]
    v_perm_b32 v6, v124, v120, s43
    v_perm_b32 v7, v125, v121, s43
    v_perm_b32 v8, v126, v122, s43
    v_perm_b32 v9, v127, v123, s43
    v_mul_hi_u32_u24 v120, 429497, v120
    v_mul_hi_u32_u24 v124, 429497, v124
    v_mul_hi_u32_u24 v121, 429497, v121
    v_mul_hi_u32_u24 v125, 429497, v125
    v_mul_hi_u32_u24 v122, 429497, v122
    v_mul_hi_u32_u24 v126, 429497, v126
    v_mul_hi_u32_u24 v123, 429497, v123
    v_mul_hi_u32_u24 v127, 429497, v127
    v_lshl_or_b32 v120, v124, 16, v120
    v_lshl_or_b32 v121, v125, 16, v121
    v_lshl_or_b32 v122, v126, 16, v122
    v_lshl_or_b32 v123, v127, 16, v123
    v_dot2_u32_u16 v124, v120, s38, 0
    v_dot2_u32_u16 v125, v121, s38, 0
    v_dot2_u32_u16 v126, v122, s38, 0
    v_dot2_u32_u16 v127, v123, s38, 0
    v_pk_mad_u16 v6, v120, s37, v6
    v_pk_mad_u16 v7, v121, s37, v7
    v_pk_mad_u16 v8, v122, s37, v8
    v_pk_mad_u16 v9, v123, s37, v9
    ds_add_u32 v124, v4 offset:0
    ds_add_u32 v125, v4 offset:0
    ds_add_u32 v126, v4 offset:0
    ds_add_u32 v127, v4 offset:0
    v_perm_b32 v127, v127, v126, s43
    v_perm_b32 v126, v125, v124, s43
    v_or_b32 v120, 0x40000000, v6
    v_or_b32 v121, 0x40000000, v7
    v_or_b32 v124, 0x40000000, v8
    v_or_b32 v125, 0x40000000, v9
    s_mov_b64 exec, -1
    s_add_u32 s35, s34, 0
    buffer_load_dwordx2 v[50:51], v2, s[16:19], s35 offen nt
    s_add_u32 s35, s34, 2097152
    buffer_load_dwordx2 v[58:59], v2, s[16:19], s35 offen nt
    s_add_u32 s35, s34, 4194304
    buffer_load_dwordx2 v[66:67], v2, s[16:19], s35 offen nt
    s_and_b32 s35, s32, 15
    s_lshl_b32 s35, s35, 6
    s_lshr_b32 s36, s32, 4
    s_add_u32 s35, s35, s36
    s_lshl_b32 s42, s35, 4
    s_mul_i32 s35, s35, 240512
    s_add_u32 s35, s35, 8192
    s_add_u32 s20, s4, s35
    s_addc_u32 s21, s5, 0
    s_waitcnt lgkmcnt(0)
    s_barrier
    ds_read_b128 v[8:11], v1 offset:0
    s_add_u32 s35, s34, 6291456
    buffer_load_dwordx2 v[74:75], v2, s[16:19], s35 offen nt
    s_lshl_b32 s35, s39, 2
    s_add_u32 s35, s35, 160256
    v_mov_b32 v7, s35
    v_and_b32 v14, 15, v0
    v_lshlrev_b32 v14, 2, v14
    v_add_u32 v14, 160256, v14
    s_waitcnt lgkmcnt(0)
    v_cmp_eq_u32 s[56:57], 0, v8
    v_max_u32 v12, 1, v8
    v_lshl_or_b32 v8, v8, 16, v12
    v_cmp_eq_u32 s[58:59], 0, v9
    v_max_u32 v12, 1, v9
    v_lshl_or_b32 v9, v9, 16, v12
    v_cmp_eq_u32 s[60:61], 0, v10
    v_max_u32 v12, 1, v10
    v_lshl_or_b32 v10, v10, 16, v12
    v_cmp_eq_u32 s[62:63], 0, v11
    v_max_u32 v12, 1, v11
    v_lshl_or_b32 v11, v11, 16, v12
    v_add_u32 v9, v8, v9
    v_add_u32 v10, v9, v10
    v_add_u32 v11, v10, v11
    v_mov_b32 v6, v11
    s_nop 1
    v_add_u32_dpp v6, v6, v6 row_shr:1 row_mask:0xf bank_mask:0xf bound_ctrl:0
    s_nop 1
    v_add_u32_dpp v6, v6, v6 row_shr:2 row_mask:0xf bank_mask:0xf bound_ctrl:0
    s_nop 1
    v_add_u32_dpp v6, v6, v6 row_shr:4 row_mask:0xf bank_mask:0xf bound_ctrl:0
    s_nop 1
    v_add_u32_dpp v6, v6, v6 row_shr:8 row_mask:0xf bank_mask:0xf bound_ctrl:0
    s_nop 1
    v_add_u32_dpp v6, v6, v6 row_bcast:15 row_mask:0xa bank_mask:0xf
    s_nop 1
    v_add_u32_dpp v6, v6, v6 row_bcast:31 row_mask:0xc bank_mask:0xf
    s_mov_b32 exec_lo, 0
    s_brev_b32 exec_hi, 1
    ds_write_b32 v7, v6
    s_mov_b64 exec, -1
    v_sub_u32 v6, v6, v11
    s_or_b64 s[46:47], s[56:57], s[58:59]
    s_or_b64 vcc, s[60:61], s[62:63]
    s_or_b64 s[46:47], s[46:47], vcc
    s_waitcnt lgkmcnt(0)
    s_barrier
    ds_read_b32 v7, v14
    s_add_u32 s35, s34, 8388608
    buffer_load_dwordx2 v[82:83], v2, s[16:19], s35 offen nt
    s_waitcnt lgkmcnt(0)
    v_mov_b32 v15, v7
    s_nop 1
    v_add_u32_dpp v7, v7, v7 row_shr:1 row_mask:0xf bank_mask:0xf bound_ctrl:0
    s_nop 1
    v_add_u32_dpp v7, v7, v7 row_shr:2 row_mask:0xf bank_mask:0xf bound_ctrl:0
    s_nop 1
    v_add_u32_dpp v7, v7, v7 row_shr:4 row_mask:0xf bank_mask:0xf bound_ctrl:0
    s_nop 1
    v_add_u32_dpp v7, v7, v7 row_shr:8 row_mask:0xf bank_mask:0xf bound_ctrl:0
    s_nop 0
    v_readlane_b32 s54, v7, 15
    v_sub_u32 v7, v7, v15
    s_nop 0
    v_readlane_b32 s35, v7, s39
    s_and_b32 s54, s54, 0xffff
    s_cmp_ge_u32 s54, 40064
    s_cselect_b32 s36, 16, 0
    s_cselect_b32 s54, 40000, s54
    s_cselect_b32 s55, 1, s55
    s_cselect_b64 s[46:47], 0, s[46:47]
    v_add_u32 v12, s35, v6
    v_add_u32 v13, v12, v8
    v_add_u32 v14, v12, v9
    v_add_u32 v15, v12, v10
    v_bfe_u32 v12, v12, s36, 16
    v_bfe_u32 v13, v13, s36, 16
    v_bfe_u32 v14, v14, s36, 16
    v_bfe_u32 v15, v15, s36, 16
    ds_write_b128 v1, v[12:15] offset:0
    ds_write_b128 v1, v[12:15] offset:16384
    v_mov_b32 v6, 32768
    v_mov_b32 v7, s54
    s_mov_b64 exec, 1
    ds_write_b32 v6, v7
    s_mov_b64 exec, -1
    s_add_u32 s35, s54, 1
    s_lshr_b32 s35, s35, 1
    s_mul_i32 s35, s35, 12
    s_min_u32 s22, s35, 240512
    v_perm_b32 v15, v15, v14, s43
    v_perm_b32 v14, v13, v12, s43
    s_waitcnt lgkmcnt(0)
    s_barrier
    s_add_u32 s35, s34, 10485760
    buffer_load_dwordx2 v[90:91], v2, s[16:19], s35 offen nt
    v_and_b32 v6, 63, v0
    s_lshl_b32 s35, s39, 10
    v_lshl_add_u32 v7, v6, 2, s35
    v_lshl_add_u32 v12, v6, 8, s35
    ds_read_b32 v8, v7 offset:16384
    ds_read_b32 v9, v7 offset:16640
    ds_read_b32 v10, v7 offset:16896
    ds_read_b32 v11, v7 offset:17152
    s_mov_b64 exec, 15
    ds_read_b32 v12, v12 offset:16640
    s_mov_b64 exec, -1
    s_lshr_b32 s35, s39, 2
    s_mul_i32 s35, s35, 2138240
    s_and_b32 s36, s39, 1
    s_lshl_b32 s36, s36, 3
    s_add_u32 s35, s35, s36
    s_and_b32 s36, s39, 2
    s_lshl_b32 s36, s36, 13
    s_add_u32 s35, s35, s36
    s_add_u32 s35, s35, s42
    s_add_u32 s36, s35, 2105344
    v_mul_u32_u24 v7, 32896, v6
    v_lshlrev_b32 v13, 1, v6
    s_waitcnt lgkmcnt(1)
    v_perm_b32 v8, v9, v8, s43
    v_perm_b32 v9, v11, v10, s43
    buffer_store_dwordx2 v[8:9], v7, s[24:27], s35 offen
    s_waitcnt lgkmcnt(0)
    s_mov_b64 exec, 15
    buffer_store_short v12, v13, s[24:27], s36 offen
    s_mov_b64 exec, -1
    s_nop 0
    v_and_b32 v6, 0xffff, v54
    v_lshrrev_b32 v7, 16, v54
    v_and_b32 v8, 0xffff, v55
    v_lshrrev_b32 v9, 16, v55
    ds_add_rtn_u32 v6, v6, v4 offset:0
    ds_add_rtn_u32 v7, v7, v4 offset:0
    ds_add_rtn_u32 v8, v8, v4 offset:0
    ds_add_rtn_u32 v9, v9, v4 offset:0
    v_and_b32 v10, 0xffff, v62
    v_lshrrev_b32 v11, 16, v62
    v_and_b32 v12, 0xffff, v63
    v_lshrrev_b32 v13, 16, v63
    ds_add_rtn_u32 v10, v10, v4 offset:0
    ds_add_rtn_u32 v11, v11, v4 offset:0
    ds_add_rtn_u32 v12, v12, v4 offset:0
    ds_add_rtn_u32 v13, v13, v4 offset:0
    s_waitcnt lgkmcnt(4)
    v_perm_b32 v54, v7, v6, s43
    v_perm_b32 v55, v9, v8, s43
    v_and_b32 v6, 0xffff, v70
    v_lshrrev_b32 v7, 16, v70
    v_and_b32 v8, 0xffff, v71
    v_lshrrev_b32 v9, 16, v71
    ds_add_rtn_u32 v6, v6, v4 offset:0
    ds_add_rtn_u32 v7, v7, v4 offset:0
    ds_add_rtn_u32 v8, v8, v4 offset:0
    ds_add_rtn_u32 v9, v9, v4 offset:0
    s_waitcnt lgkmcnt(4)
    v_perm_b32 v62, v11, v10, s43
    v_perm_b32 v63, v13, v12, s43
    s_add_u32 s35, s34, 12582912
    buffer_load_dwordx2 v[98:99], v2, s[16:19], s35 offen nt
    s_add_u32 s35, s34, 14680064
    buffer_load_dwordx2 v[106:107], v2, s[16:19], s35 offen nt
    v_and_b32 v10, 0xffff, v78
    v_lshrrev_b32 v11, 16, v78
    v_and_b32 v12, 0xffff, v79
    v_lshrrev_b32 v13, 16, v79
    ds_add_rtn_u32 v10, v10, v4 offset:0
    ds_add_rtn_u32 v11, v11, v4 offset:0
    ds_add_rtn_u32 v12, v12, v4 offset:0
    ds_add_rtn_u32 v13, v13, v4 offset:0
    s_waitcnt lgkmcnt(4)
    v_perm_b32 v70, v7, v6, s43
    v_perm_b32 v71, v9, v8, s43
    v_and_b32 v6, 0xffff, v86
    v_lshrrev_b32 v7, 16, v86
    v_and_b32 v8, 0xffff, v87
    v_lshrrev_b32 v9, 16, v87
    ds_add_rtn_u32 v6, v6, v4 offset:0
    ds_add_rtn_u32 v7, v7, v4 offset:0
    ds_add_rtn_u32 v8, v8, v4 offset:0
    ds_add_rtn_u32 v9, v9, v4 offset:0
    s_waitcnt lgkmcnt(4)
    v_perm_b32 v78, v11, v10, s43
    v_perm_b32 v79, v13, v12, s43
    v_and_b32 v10, 0xffff, v94
    v_lshrrev_b32 v11, 16, v94
    v_and_b32 v12, 0xffff, v95
    v_lshrrev_b32 v13, 16, v95
    ds_add_rtn_u32 v10, v10, v4 offset:0
    ds_add_rtn_u32 v11, v11, v4 offset:0
    ds_add_rtn_u32 v12, v12, v4 offset:0
    ds_add_rtn_u32 v13, v13, v4 offset:0
    s_waitcnt lgkmcnt(4)
    v_perm_b32 v86, v7, v6, s43
    v_perm_b32 v87, v9, v8, s43
    s_add_u32 s35, s34, 16777216
    buffer_load_dwordx2 v[114:115], v2, s[16:19], s35 offen nt
    s_add_u32 s35, s34, 18874368
    s_sub_u32 s35, s35, s49
    s_mov_b64 exec, s[44:45]
    buffer_load_dwordx2 v[122:123], v2, s[16:19], s35 offen nt
    s_mov_b64 exec, -1
    v_and_b32 v6, 0xffff, v102
    v_lshrrev_b32 v7, 16, v102
    v_and_b32 v8, 0xffff, v103
    v_lshrrev_b32 v9, 16, v103
    ds_add_rtn_u32 v6, v6, v4 offset:0
    ds_add_rtn_u32 v7, v7, v4 offset:0
    ds_add_rtn_u32 v8, v8, v4 offset:0
    ds_add_rtn_u32 v9, v9, v4 offset:0
    s_waitcnt lgkmcnt(4)
    v_perm_b32 v94, v11, v10, s43
    v_perm_b32 v95, v13, v12, s43
    v_and_b32 v10, 0xffff, v110
    v_lshrrev_b32 v11, 16, v110
    v_and_b32 v12, 0xffff, v111
    v_lshrrev_b32 v13, 16, v111
    ds_add_rtn_u32 v10, v10, v4 offset:0
    ds_add_rtn_u32 v11, v11, v4 offset:0
    ds_add_rtn_u32 v12, v12, v4 offset:0
    ds_add_rtn_u32 v13, v13, v4 offset:0
    s_waitcnt lgkmcnt(4)
    v_perm_b32 v102, v7, v6, s43
    v_perm_b32 v103, v9, v8, s43
    v_and_b32 v6, 0xffff, v118
    v_lshrrev_b32 v7, 16, v118
    v_and_b32 v8, 0xffff, v119
    v_lshrrev_b32 v9, 16, v119
    ds_add_rtn_u32 v6, v6, v4 offset:0
    ds_add_rtn_u32 v7, v7, v4 offset:0
    ds_add_rtn_u32 v8, v8, v4 offset:0
    ds_add_rtn_u32 v9, v9, v4 offset:0
    s_waitcnt lgkmcnt(4)
    v_perm_b32 v110, v11, v10, s43
    v_perm_b32 v111, v13, v12, s43
    s_add_u32 s35, s33, 40960000
    buffer_load_dwordx4 v[16:19], v1, s[8:11], s35 offen nt
    s_mov_b64 exec, s[44:45]
    v_and_b32 v10, 0xffff, v126
    v_lshrrev_b32 v11, 16, v126
    v_and_b32 v12, 0xffff, v127
    v_lshrrev_b32 v13, 16, v127
    ds_add_rtn_u32 v10, v10, v4 offset:0
    ds_add_rtn_u32 v11, v11, v4 offset:0
    ds_add_rtn_u32 v12, v12, v4 offset:0
    ds_add_rtn_u32 v13, v13, v4 offset:0
    s_mov_b64 exec, -1
    s_waitcnt lgkmcnt(4)
    v_perm_b32 v118, v7, v6, s43
    v_perm_b32 v119, v9, v8, s43
    s_waitcnt lgkmcnt(0)
    v_perm_b32 v126, v11, v10, s43
    v_perm_b32 v127, v13, v12, s43
    s_barrier
    s_lshl_b32 s35, s54, 2
    v_mov_b32 v6, s35
    v_mov_b32 v7, 0
    s_mov_b64 exec, 1
    ds_write_b32 v6, v7
    s_cmp_eq_u64 s[46:47], 0
    s_cbranch_scc1 L_p1_kernel_nonull_1
    s_mov_b64 exec, s[56:57]
    v_lshlrev_b32_sdwa v6, 2, v14 dst_sel:DWORD dst_unused:UNUSED_PAD src0_sel:DWORD src1_sel:WORD_0
    ds_write_b32 v6, v7
    s_mov_b64 exec, s[58:59]
    v_lshlrev_b32_sdwa v6, 2, v14 dst_sel:DWORD dst_unused:UNUSED_PAD src0_sel:DWORD src1_sel:WORD_1
    ds_write_b32 v6, v7
    s_mov_b64 exec, s[60:61]
    v_lshlrev_b32_sdwa v6, 2, v15 dst_sel:DWORD dst_unused:UNUSED_PAD src0_sel:DWORD src1_sel:WORD_0
    ds_write_b32 v6, v7
    s_mov_b64 exec, s[62:63]
    v_lshlrev_b32_sdwa v6, 2, v15 dst_sel:DWORD dst_unused:UNUSED_PAD src0_sel:DWORD src1_sel:WORD_1
    ds_write_b32 v6, v7
L_p1_kernel_nonull_1:
    s_mov_b64 exec, -1
    v_lshlrev_b32_sdwa v6, 2, v54 dst_sel:DWORD dst_unused:UNUSED_PAD src0_sel:DWORD src1_sel:WORD_0
    v_lshlrev_b32_sdwa v7, 2, v54 dst_sel:DWORD dst_unused:UNUSED_PAD src0_sel:DWORD src1_sel:WORD_1
    v_lshlrev_b32_sdwa v8, 2, v55 dst_sel:DWORD dst_unused:UNUSED_PAD src0_sel:DWORD src1_sel:WORD_0
    v_lshlrev_b32_sdwa v9, 2, v55 dst_sel:DWORD dst_unused:UNUSED_PAD src0_sel:DWORD src1_sel:WORD_1
    ds_write_b32 v6, v48
    ds_write_b32 v7, v49
    ds_write_b32 v8, v52
    ds_write_b32 v9, v53
    s_waitcnt vmcnt(12)
    v_lshlrev_b32 v10, 16, v50
    v_lshlrev_b32 v11, 16, v51
    v_and_b32 v50, 0xffff0000, v50
    v_and_b32 v51, 0xffff0000, v51
    v_mul_f32 v10, s41, v10
    v_mul_f32 v50, s41, v50
    v_mul_f32 v11, s41, v11
    v_mul_f32 v51, s41, v51
    v_fract_f32 v10, v10
    v_fract_f32 v50, v50
    v_fract_f32 v11, v11
    v_fract_f32 v51, v51
    v_cos_f32 v10, v10
    v_cos_f32 v50, v50
    v_cos_f32 v11, v11
    v_cos_f32 v51, v51
    v_cvt_pk_bf16_f32 v50, v10, v50
    v_cvt_pk_bf16_f32 v51, v11, v51
    v_or3_b32 v5, v50, v51, v5
    v_lshlrev_b32_sdwa v6, 2, v62 dst_sel:DWORD dst_unused:UNUSED_PAD src0_sel:DWORD src1_sel:WORD_0
    v_lshlrev_b32_sdwa v7, 2, v62 dst_sel:DWORD dst_unused:UNUSED_PAD src0_sel:DWORD src1_sel:WORD_1
    v_lshlrev_b32_sdwa v8, 2, v63 dst_sel:DWORD dst_unused:UNUSED_PAD src0_sel:DWORD src1_sel:WORD_0
    v_lshlrev_b32_sdwa v9, 2, v63 dst_sel:DWORD dst_unused:UNUSED_PAD src0_sel:DWORD src1_sel:WORD_1
    ds_write_b32 v6, v56
    ds_write_b32 v7, v57
    ds_write_b32 v8, v60
    ds_write_b32 v9, v61
    s_waitcnt vmcnt(11)
    v_lshlrev_b32 v10, 16, v58
    v_lshlrev_b32 v11, 16, v59
    v_and_b32 v58, 0xffff0000, v58
    v_and_b32 v59, 0xffff0000, v59
    v_mul_f32 v10, s41, v10
    v_mul_f32 v58, s41, v58
    v_mul_f32 v11, s41, v11
    v_mul_f32 v59, s41, v59
    v_fract_f32 v10, v10
    v_fract_f32 v58, v58
    v_fract_f32 v11, v11
    v_fract_f32 v59, v59
    v_cos_f32 v10, v10
    v_cos_f32 v58, v58
    v_cos_f32 v11, v11
    v_cos_f32 v59, v59
    v_cvt_pk_bf16_f32 v58, v10, v58
    v_cvt_pk_bf16_f32 v59, v11, v59
    v_or3_b32 v5, v58, v59, v5
    s_add_u32 s35, s33, 40960000
    buffer_load_dwordx4 v[20:23], v1, s[12:15], s35 offen nt
    v_lshlrev_b32_sdwa v6, 2, v70 dst_sel:DWORD dst_unused:UNUSED_PAD src0_sel:DWORD src1_sel:WORD_0
    v_lshlrev_b32_sdwa v7, 2, v70 dst_sel:DWORD dst_unused:UNUSED_PAD src0_sel:DWORD src1_sel:WORD_1
    v_lshlrev_b32_sdwa v8, 2, v71 dst_sel:DWORD dst_unused:UNUSED_PAD src0_sel:DWORD src1_sel:WORD_0
    v_lshlrev_b32_sdwa v9, 2, v71 dst_sel:DWORD dst_unused:UNUSED_PAD src0_sel:DWORD src1_sel:WORD_1
    ds_write_b32 v6, v64
    ds_write_b32 v7, v65
    ds_write_b32 v8, v68
    ds_write_b32 v9, v69
    s_waitcnt vmcnt(11)
    v_lshlrev_b32 v10, 16, v66
    v_lshlrev_b32 v11, 16, v67
    v_and_b32 v66, 0xffff0000, v66
    v_and_b32 v67, 0xffff0000, v67
    v_mul_f32 v10, s41, v10
    v_mul_f32 v66, s41, v66
    v_mul_f32 v11, s41, v11
    v_mul_f32 v67, s41, v67
    v_fract_f32 v10, v10
    v_fract_f32 v66, v66
    v_fract_f32 v11, v11
    v_fract_f32 v67, v67
    v_cos_f32 v10, v10
    v_cos_f32 v66, v66
    v_cos_f32 v11, v11
    v_cos_f32 v67, v67
    v_cvt_pk_bf16_f32 v66, v10, v66
    v_cvt_pk_bf16_f32 v67, v11, v67
    v_or3_b32 v5, v66, v67, v5
    v_lshlrev_b32_sdwa v6, 2, v78 dst_sel:DWORD dst_unused:UNUSED_PAD src0_sel:DWORD src1_sel:WORD_0
    v_lshlrev_b32_sdwa v7, 2, v78 dst_sel:DWORD dst_unused:UNUSED_PAD src0_sel:DWORD src1_sel:WORD_1
    v_lshlrev_b32_sdwa v8, 2, v79 dst_sel:DWORD dst_unused:UNUSED_PAD src0_sel:DWORD src1_sel:WORD_0
    v_lshlrev_b32_sdwa v9, 2, v79 dst_sel:DWORD dst_unused:UNUSED_PAD src0_sel:DWORD src1_sel:WORD_1
    ds_write_b32 v6, v72
    ds_write_b32 v7, v73
    ds_write_b32 v8, v76
    ds_write_b32 v9, v77
    s_waitcnt vmcnt(10)
    v_lshlrev_b32 v10, 16, v74
    v_lshlrev_b32 v11, 16, v75
    v_and_b32 v74, 0xffff0000, v74
    v_and_b32 v75, 0xffff0000, v75
    v_mul_f32 v10, s41, v10
    v_mul_f32 v74, s41, v74
    v_mul_f32 v11, s41, v11
    v_mul_f32 v75, s41, v75
    v_fract_f32 v10, v10
    v_fract_f32 v74, v74
    v_fract_f32 v11, v11
    v_fract_f32 v75, v75
    v_cos_f32 v10, v10
    v_cos_f32 v74, v74
    v_cos_f32 v11, v11
    v_cos_f32 v75, v75
    v_cvt_pk_bf16_f32 v74, v10, v74
    v_cvt_pk_bf16_f32 v75, v11, v75
    v_or3_b32 v5, v74, v75, v5
    v_lshlrev_b32_sdwa v6, 2, v86 dst_sel:DWORD dst_unused:UNUSED_PAD src0_sel:DWORD src1_sel:WORD_0
    v_lshlrev_b32_sdwa v7, 2, v86 dst_sel:DWORD dst_unused:UNUSED_PAD src0_sel:DWORD src1_sel:WORD_1
    v_lshlrev_b32_sdwa v8, 2, v87 dst_sel:DWORD dst_unused:UNUSED_PAD src0_sel:DWORD src1_sel:WORD_0
    v_lshlrev_b32_sdwa v9, 2, v87 dst_sel:DWORD dst_unused:UNUSED_PAD src0_sel:DWORD src1_sel:WORD_1
    ds_write_b32 v6, v80
    ds_write_b32 v7, v81
    ds_write_b32 v8, v84
    ds_write_b32 v9, v85
    s_waitcnt vmcnt(9)
    v_lshlrev_b32 v10, 16, v82
    v_lshlrev_b32 v11, 16, v83
    v_and_b32 v82, 0xffff0000, v82
    v_and_b32 v83, 0xffff0000, v83
    v_mul_f32 v10, s41, v10
    v_mul_f32 v82, s41, v82
    v_mul_f32 v11, s41, v11
    v_mul_f32 v83, s41, v83
    v_fract_f32 v10, v10
    v_fract_f32 v82, v82
    v_fract_f32 v11, v11
    v_fract_f32 v83, v83
    v_cos_f32 v10, v10
    v_cos_f32 v82, v82
    v_cos_f32 v11, v11
    v_cos_f32 v83, v83
    v_cvt_pk_bf16_f32 v82, v10, v82
    v_cvt_pk_bf16_f32 v83, v11, v83
    v_or3_b32 v5, v82, v83, v5
    s_add_u32 s35, s33, 45154304
    buffer_load_dwordx4 v[24:27], v1, s[8:11], s35 offen nt
    v_lshlrev_b32_sdwa v6, 2, v94 dst_sel:DWORD dst_unused:UNUSED_PAD src0_sel:DWORD src1_sel:WORD_0
    v_lshlrev_b32_sdwa v7, 2, v94 dst_sel:DWORD dst_unused:UNUSED_PAD src0_sel:DWORD src1_sel:WORD_1
    v_lshlrev_b32_sdwa v8, 2, v95 dst_sel:DWORD dst_unused:UNUSED_PAD src0_sel:DWORD src1_sel:WORD_0
    v_lshlrev_b32_sdwa v9, 2, v95 dst_sel:DWORD dst_unused:UNUSED_PAD src0_sel:DWORD src1_sel:WORD_1
    ds_write_b32 v6, v88
    ds_write_b32 v7, v89
    ds_write_b32 v8, v92
    ds_write_b32 v9, v93
    s_waitcnt vmcnt(9)
    v_lshlrev_b32 v10, 16, v90
    v_lshlrev_b32 v11, 16, v91
    v_and_b32 v90, 0xffff0000, v90
    v_and_b32 v91, 0xffff0000, v91
    v_mul_f32 v10, s41, v10
    v_mul_f32 v90, s41, v90
    v_mul_f32 v11, s41, v11
    v_mul_f32 v91, s41, v91
    v_fract_f32 v10, v10
    v_fract_f32 v90, v90
    v_fract_f32 v11, v11
    v_fract_f32 v91, v91
    v_cos_f32 v10, v10
    v_cos_f32 v90, v90
    v_cos_f32 v11, v11
    v_cos_f32 v91, v91
    v_cvt_pk_bf16_f32 v90, v10, v90
    v_cvt_pk_bf16_f32 v91, v11, v91
    v_or3_b32 v5, v90, v91, v5
    v_lshlrev_b32_sdwa v6, 2, v102 dst_sel:DWORD dst_unused:UNUSED_PAD src0_sel:DWORD src1_sel:WORD_0
    v_lshlrev_b32_sdwa v7, 2, v102 dst_sel:DWORD dst_unused:UNUSED_PAD src0_sel:DWORD src1_sel:WORD_1
    v_lshlrev_b32_sdwa v8, 2, v103 dst_sel:DWORD dst_unused:UNUSED_PAD src0_sel:DWORD src1_sel:WORD_0
    v_lshlrev_b32_sdwa v9, 2, v103 dst_sel:DWORD dst_unused:UNUSED_PAD src0_sel:DWORD src1_sel:WORD_1
    ds_write_b32 v6, v96
    ds_write_b32 v7, v97
    ds_write_b32 v8, v100
    ds_write_b32 v9, v101
    s_waitcnt vmcnt(6)
    v_lshlrev_b32 v10, 16, v98
    v_lshlrev_b32 v11, 16, v99
    v_and_b32 v98, 0xffff0000, v98
    v_and_b32 v99, 0xffff0000, v99
    v_mul_f32 v10, s41, v10
    v_mul_f32 v98, s41, v98
    v_mul_f32 v11, s41, v11
    v_mul_f32 v99, s41, v99
    v_fract_f32 v10, v10
    v_fract_f32 v98, v98
    v_fract_f32 v11, v11
    v_fract_f32 v99, v99
    v_cos_f32 v10, v10
    v_cos_f32 v98, v98
    v_cos_f32 v11, v11
    v_cos_f32 v99, v99
    v_cvt_pk_bf16_f32 v98, v10, v98
    v_cvt_pk_bf16_f32 v99, v11, v99
    v_or3_b32 v5, v98, v99, v5
    v_lshlrev_b32_sdwa v6, 2, v110 dst_sel:DWORD dst_unused:UNUSED_PAD src0_sel:DWORD src1_sel:WORD_0
    v_lshlrev_b32_sdwa v7, 2, v110 dst_sel:DWORD dst_unused:UNUSED_PAD src0_sel:DWORD src1_sel:WORD_1
    v_lshlrev_b32_sdwa v8, 2, v111 dst_sel:DWORD dst_unused:UNUSED_PAD src0_sel:DWORD src1_sel:WORD_0
    v_lshlrev_b32_sdwa v9, 2, v111 dst_sel:DWORD dst_unused:UNUSED_PAD src0_sel:DWORD src1_sel:WORD_1
    ds_write_b32 v6, v104
    ds_write_b32 v7, v105
    ds_write_b32 v8, v108
    ds_write_b32 v9, v109
    s_waitcnt vmcnt(5)
    v_lshlrev_b32 v10, 16, v106
    v_lshlrev_b32 v11, 16, v107
    v_and_b32 v106, 0xffff0000, v106
    v_and_b32 v107, 0xffff0000, v107
    v_mul_f32 v10, s41, v10
    v_mul_f32 v106, s41, v106
    v_mul_f32 v11, s41, v11
    v_mul_f32 v107, s41, v107
    v_fract_f32 v10, v10
    v_fract_f32 v106, v106
    v_fract_f32 v11, v11
    v_fract_f32 v107, v107
    v_cos_f32 v10, v10
    v_cos_f32 v106, v106
    v_cos_f32 v11, v11
    v_cos_f32 v107, v107
    v_cvt_pk_bf16_f32 v106, v10, v106
    v_cvt_pk_bf16_f32 v107, v11, v107
    v_or3_b32 v5, v106, v107, v5
    s_add_u32 s35, s33, 45154304
    buffer_load_dwordx4 v[28:31], v1, s[12:15], s35 offen nt
    v_lshlrev_b32_sdwa v6, 2, v118 dst_sel:DWORD dst_unused:UNUSED_PAD src0_sel:DWORD src1_sel:WORD_0
    v_lshlrev_b32_sdwa v7, 2, v118 dst_sel:DWORD dst_unused:UNUSED_PAD src0_sel:DWORD src1_sel:WORD_1
    v_lshlrev_b32_sdwa v8, 2, v119 dst_sel:DWORD dst_unused:UNUSED_PAD src0_sel:DWORD src1_sel:WORD_0
    v_lshlrev_b32_sdwa v9, 2, v119 dst_sel:DWORD dst_unused:UNUSED_PAD src0_sel:DWORD src1_sel:WORD_1
    ds_write_b32 v6, v112
    ds_write_b32 v7, v113
    ds_write_b32 v8, v116
    ds_write_b32 v9, v117
    s_waitcnt vmcnt(5)
    v_lshlrev_b32 v10, 16, v114
    v_lshlrev_b32 v11, 16, v115
    v_and_b32 v114, 0xffff0000, v114
    v_and_b32 v115, 0xffff0000, v115
    v_mul_f32 v10, s41, v10
    v_mul_f32 v114, s41, v114
    v_mul_f32 v11, s41, v11
    v_mul_f32 v115, s41, v115
    v_fract_f32 v10, v10
    v_fract_f32 v114, v114
    v_fract_f32 v11, v11
    v_fract_f32 v115, v115
    v_cos_f32 v10, v10
    v_cos_f32 v114, v114
    v_cos_f32 v11, v11
    v_cos_f32 v115, v115
    v_cvt_pk_bf16_f32 v114, v10, v114
    v_cvt_pk_bf16_f32 v115, v11, v115
    v_or3_b32 v5, v114, v115, v5
    s_mov_b64 exec, s[44:45]
    v_lshlrev_b32_sdwa v6, 2, v126 dst_sel:DWORD dst_unused:UNUSED_PAD src0_sel:DWORD src1_sel:WORD_0
    v_lshlrev_b32_sdwa v7, 2, v126 dst_sel:DWORD dst_unused:UNUSED_PAD src0_sel:DWORD src1_sel:WORD_1
    v_lshlrev_b32_sdwa v8, 2, v127 dst_sel:DWORD dst_unused:UNUSED_PAD src0_sel:DWORD src1_sel:WORD_0
    v_lshlrev_b32_sdwa v9, 2, v127 dst_sel:DWORD dst_unused:UNUSED_PAD src0_sel:DWORD src1_sel:WORD_1
    ds_write_b32 v6, v120
    ds_write_b32 v7, v121
    ds_write_b32 v8, v124
    ds_write_b32 v9, v125
    s_waitcnt vmcnt(4)
    v_lshlrev_b32 v10, 16, v122
    v_lshlrev_b32 v11, 16, v123
    v_and_b32 v122, 0xffff0000, v122
    v_and_b32 v123, 0xffff0000, v123
    v_mul_f32 v10, s41, v10
    v_mul_f32 v122, s41, v122
    v_mul_f32 v11, s41, v11
    v_mul_f32 v123, s41, v123
    v_fract_f32 v10, v10
    v_fract_f32 v122, v122
    v_fract_f32 v11, v11
    v_fract_f32 v123, v123
    v_cos_f32 v10, v10
    v_cos_f32 v122, v122
    v_cos_f32 v11, v11
    v_cos_f32 v123, v123
    v_cvt_pk_bf16_f32 v122, v10, v122
    v_cvt_pk_bf16_f32 v123, v11, v123
    v_or3_b32 v5, v122, v123, v5
    s_mov_b64 exec, -1
    s_mul_i32 s35, s39, 9728
    v_add_u32 v6, s35, v2
    s_waitcnt lgkmcnt(0)
    s_barrier
    ds_read_b64 v[48:49], v6 offset:0
    ds_read_b64 v[52:53], v6 offset:512
    ds_read_b64 v[56:57], v6 offset:1024
    ds_read_b64 v[60:61], v6 offset:1536
    ds_read_b64 v[64:65], v6 offset:2048
    ds_read_b64 v[68:69], v6 offset:2560
    ds_read_b64 v[72:73], v6 offset:3072
    ds_read_b64 v[76:77], v6 offset:3584
    ds_read_b64 v[80:81], v6 offset:4096
    ds_read_b64 v[84:85], v6 offset:4608
    ds_read_b64 v[88:89], v6 offset:5120
    ds_read_b64 v[92:93], v6 offset:5632
    ds_read_b64 v[96:97], v6 offset:6144
    ds_read_b64 v[100:101], v6 offset:6656
    ds_read_b64 v[104:105], v6 offset:7168
    ds_read_b64 v[108:109], v6 offset:7680
    ds_read_b64 v[112:113], v6 offset:8192
    ds_read_b64 v[116:117], v6 offset:8704
    ds_read_b64 v[120:121], v6 offset:9216
    ds_read_b64 v[124:125], v6 offset:9728
    s_add_u32 s35, s33, 49348608
    buffer_load_dwordx4 v[32:35], v1, s[8:11], s35 offen nt
    v_mov_b32 v12, 0
    v_mov_b32 v13, 0
    v_mov_b32 v14, 0
    v_mov_b32 v15, 0
    s_waitcnt lgkmcnt(0)
    s_barrier
    ds_write_b128 v1, v[12:15] offset:0
    v_lshlrev_b32_sdwa v6, 1, v54 dst_sel:DWORD dst_unused:UNUSED_PAD src0_sel:DWORD src1_sel:WORD_0
    v_lshlrev_b32_sdwa v7, 1, v54 dst_sel:DWORD dst_unused:UNUSED_PAD src0_sel:DWORD src1_sel:WORD_1
    v_lshlrev_b32_sdwa v8, 1, v55 dst_sel:DWORD dst_unused:UNUSED_PAD src0_sel:DWORD src1_sel:WORD_0
    v_lshlrev_b32_sdwa v9, 1, v55 dst_sel:DWORD dst_unused:UNUSED_PAD src0_sel:DWORD src1_sel:WORD_1
    ds_write_b16 v6, v50 offset:16384
    ds_write_b16_d16_hi v7, v50 offset:16384
    ds_write_b16 v8, v51 offset:16384
    ds_write_b16_d16_hi v9, v51 offset:16384
    v_lshlrev_b32_sdwa v6, 1, v62 dst_sel:DWORD dst_unused:UNUSED_PAD src0_sel:DWORD src1_sel:WORD_0
    v_lshlrev_b32_sdwa v7, 1, v62 dst_sel:DWORD dst_unused:UNUSED_PAD src0_sel:DWORD src1_sel:WORD_1
    v_lshlrev_b32_sdwa v8, 1, v63 dst_sel:DWORD dst_unused:UNUSED_PAD src0_sel:DWORD src1_sel:WORD_0
    v_lshlrev_b32_sdwa v9, 1, v63 dst_sel:DWORD dst_unused:UNUSED_PAD src0_sel:DWORD src1_sel:WORD_1
    ds_write_b16 v6, v58 offset:16384
    ds_write_b16_d16_hi v7, v58 offset:16384
    ds_write_b16 v8, v59 offset:16384
    ds_write_b16_d16_hi v9, v59 offset:16384
    s_add_u32 s35, s33, 49348608
    buffer_load_dwordx4 v[36:39], v1, s[12:15], s35 offen nt
    v_lshlrev_b32_sdwa v6, 1, v70 dst_sel:DWORD dst_unused:UNUSED_PAD src0_sel:DWORD src1_sel:WORD_0
    v_lshlrev_b32_sdwa v7, 1, v70 dst_sel:DWORD dst_unused:UNUSED_PAD src0_sel:DWORD src1_sel:WORD_1
    v_lshlrev_b32_sdwa v8, 1, v71 dst_sel:DWORD dst_unused:UNUSED_PAD src0_sel:DWORD src1_sel:WORD_0
    v_lshlrev_b32_sdwa v9, 1, v71 dst_sel:DWORD dst_unused:UNUSED_PAD src0_sel:DWORD src1_sel:WORD_1
    ds_write_b16 v6, v66 offset:16384
    ds_write_b16_d16_hi v7, v66 offset:16384
    ds_write_b16 v8, v67 offset:16384
    ds_write_b16_d16_hi v9, v67 offset:16384
    v_lshlrev_b32_sdwa v6, 1, v78 dst_sel:DWORD dst_unused:UNUSED_PAD src0_sel:DWORD src1_sel:WORD_0
    v_lshlrev_b32_sdwa v7, 1, v78 dst_sel:DWORD dst_unused:UNUSED_PAD src0_sel:DWORD src1_sel:WORD_1
    v_lshlrev_b32_sdwa v8, 1, v79 dst_sel:DWORD dst_unused:UNUSED_PAD src0_sel:DWORD src1_sel:WORD_0
    v_lshlrev_b32_sdwa v9, 1, v79 dst_sel:DWORD dst_unused:UNUSED_PAD src0_sel:DWORD src1_sel:WORD_1
    ds_write_b16 v6, v74 offset:16384
    ds_write_b16_d16_hi v7, v74 offset:16384
    ds_write_b16 v8, v75 offset:16384
    ds_write_b16_d16_hi v9, v75 offset:16384
    v_lshlrev_b32_sdwa v6, 1, v86 dst_sel:DWORD dst_unused:UNUSED_PAD src0_sel:DWORD src1_sel:WORD_0
    v_lshlrev_b32_sdwa v7, 1, v86 dst_sel:DWORD dst_unused:UNUSED_PAD src0_sel:DWORD src1_sel:WORD_1
    v_lshlrev_b32_sdwa v8, 1, v87 dst_sel:DWORD dst_unused:UNUSED_PAD src0_sel:DWORD src1_sel:WORD_0
    v_lshlrev_b32_sdwa v9, 1, v87 dst_sel:DWORD dst_unused:UNUSED_PAD src0_sel:DWORD src1_sel:WORD_1
    ds_write_b16 v6, v82 offset:16384
    ds_write_b16_d16_hi v7, v82 offset:16384
    ds_write_b16 v8, v83 offset:16384
    ds_write_b16_d16_hi v9, v83 offset:16384
    s_add_u32 s35, s33, 53542912
    buffer_load_dwordx4 v[40:43], v1, s[8:11], s35 offen nt
    v_lshlrev_b32_sdwa v6, 1, v94 dst_sel:DWORD dst_unused:UNUSED_PAD src0_sel:DWORD src1_sel:WORD_0
    v_lshlrev_b32_sdwa v7, 1, v94 dst_sel:DWORD dst_unused:UNUSED_PAD src0_sel:DWORD src1_sel:WORD_1
    v_lshlrev_b32_sdwa v8, 1, v95 dst_sel:DWORD dst_unused:UNUSED_PAD src0_sel:DWORD src1_sel:WORD_0
    v_lshlrev_b32_sdwa v9, 1, v95 dst_sel:DWORD dst_unused:UNUSED_PAD src0_sel:DWORD src1_sel:WORD_1
    ds_write_b16 v6, v90 offset:16384
    ds_write_b16_d16_hi v7, v90 offset:16384
    ds_write_b16 v8, v91 offset:16384
    ds_write_b16_d16_hi v9, v91 offset:16384
    v_lshlrev_b32_sdwa v6, 1, v102 dst_sel:DWORD dst_unused:UNUSED_PAD src0_sel:DWORD src1_sel:WORD_0
    v_lshlrev_b32_sdwa v7, 1, v102 dst_sel:DWORD dst_unused:UNUSED_PAD src0_sel:DWORD src1_sel:WORD_1
    v_lshlrev_b32_sdwa v8, 1, v103 dst_sel:DWORD dst_unused:UNUSED_PAD src0_sel:DWORD src1_sel:WORD_0
    v_lshlrev_b32_sdwa v9, 1, v103 dst_sel:DWORD dst_unused:UNUSED_PAD src0_sel:DWORD src1_sel:WORD_1
    ds_write_b16 v6, v98 offset:16384
    ds_write_b16_d16_hi v7, v98 offset:16384
    ds_write_b16 v8, v99 offset:16384
    ds_write_b16_d16_hi v9, v99 offset:16384
    v_lshlrev_b32_sdwa v6, 1, v110 dst_sel:DWORD dst_unused:UNUSED_PAD src0_sel:DWORD src1_sel:WORD_0
    v_lshlrev_b32_sdwa v7, 1, v110 dst_sel:DWORD dst_unused:UNUSED_PAD src0_sel:DWORD src1_sel:WORD_1
    v_lshlrev_b32_sdwa v8, 1, v111 dst_sel:DWORD dst_unused:UNUSED_PAD src0_sel:DWORD src1_sel:WORD_0
    v_lshlrev_b32_sdwa v9, 1, v111 dst_sel:DWORD dst_unused:UNUSED_PAD src0_sel:DWORD src1_sel:WORD_1
    ds_write_b16 v6, v106 offset:16384
    ds_write_b16_d16_hi v7, v106 offset:16384
    ds_write_b16 v8, v107 offset:16384
    ds_write_b16_d16_hi v9, v107 offset:16384
    s_add_u32 s35, s33, 53542912
    buffer_load_dwordx4 v[44:47], v1, s[12:15], s35 offen nt
    v_lshlrev_b32_sdwa v6, 1, v118 dst_sel:DWORD dst_unused:UNUSED_PAD src0_sel:DWORD src1_sel:WORD_0
    v_lshlrev_b32_sdwa v7, 1, v118 dst_sel:DWORD dst_unused:UNUSED_PAD src0_sel:DWORD src1_sel:WORD_1
    v_lshlrev_b32_sdwa v8, 1, v119 dst_sel:DWORD dst_unused:UNUSED_PAD src0_sel:DWORD src1_sel:WORD_0
    v_lshlrev_b32_sdwa v9, 1, v119 dst_sel:DWORD dst_unused:UNUSED_PAD src0_sel:DWORD src1_sel:WORD_1
    ds_write_b16 v6, v114 offset:16384
    ds_write_b16_d16_hi v7, v114 offset:16384
    ds_write_b16 v8, v115 offset:16384
    ds_write_b16_d16_hi v9, v115 offset:16384
    s_mov_b64 exec, s[44:45]
    v_lshlrev_b32_sdwa v6, 1, v126 dst_sel:DWORD dst_unused:UNUSED_PAD src0_sel:DWORD src1_sel:WORD_0
    v_lshlrev_b32_sdwa v7, 1, v126 dst_sel:DWORD dst_unused:UNUSED_PAD src0_sel:DWORD src1_sel:WORD_1
    v_lshlrev_b32_sdwa v8, 1, v127 dst_sel:DWORD dst_unused:UNUSED_PAD src0_sel:DWORD src1_sel:WORD_0
    v_lshlrev_b32_sdwa v9, 1, v127 dst_sel:DWORD dst_unused:UNUSED_PAD src0_sel:DWORD src1_sel:WORD_1
    ds_write_b16 v6, v122 offset:16384
    ds_write_b16_d16_hi v7, v122 offset:16384
    ds_write_b16 v8, v123 offset:16384
    ds_write_b16_d16_hi v9, v123 offset:16384
    s_mov_b64 exec, -1
    v_lshlrev_b32 v6, 2, v0
    s_mul_i32 s35, s39, 4864
    v_add_u32 v7, s35, v6
    s_waitcnt lgkmcnt(0)
    s_barrier
    ds_read_b32 v50, v7 offset:16384
    ds_read_b32 v54, v7 offset:16640
    ds_read_b32 v58, v7 offset:16896
    ds_read_b32 v62, v7 offset:17152
    ds_read_b32 v66, v7 offset:17408
    ds_read_b32 v70, v7 offset:17664
    ds_read_b32 v74, v7 offset:17920
    ds_read_b32 v78, v7 offset:18176
    ds_read_b32 v82, v7 offset:18432
    ds_read_b32 v86, v7 offset:18688
    ds_read_b32 v90, v7 offset:18944
    ds_read_b32 v94, v7 offset:19200
    ds_read_b32 v98, v7 offset:19456
    ds_read_b32 v102, v7 offset:19712
    ds_read_b32 v106, v7 offset:19968
    ds_read_b32 v110, v7 offset:20224
    ds_read_b32 v114, v7 offset:20480
    ds_read_b32 v118, v7 offset:20736
    ds_read_b32 v122, v7 offset:20992
    ds_read_b32 v126, v7 offset:21248
    s_add_u32 s32, s32, 256
    s_add_u32 s33, s33, 40960000
    s_add_u32 s34, s34, 20480000
    s_add_u32 s40, s40, 1
    s_cmp_lt_u32 s40, 4
    s_waitcnt lgkmcnt(0)
    s_cbranch_scc1 L_p1_loop
    s_mov_b32 s36, 0
    buffer_store_dwordx3 v[48:50], v3, s[20:23], s36 offen sc1
    s_mov_b32 s36, 768
    buffer_store_dwordx3 v[52:54], v3, s[20:23], s36 offen sc1
    s_mov_b32 s36, 1536
    buffer_store_dwordx3 v[56:58], v3, s[20:23], s36 offen sc1
    s_mov_b32 s36, 2304
    buffer_store_dwordx3 v[60:62], v3, s[20:23], s36 offen sc1
    s_mov_b32 s36, 3072
    buffer_store_dwordx3 v[64:66], v3, s[20:23], s36 offen sc1
    s_mov_b32 s36, 3840
    buffer_store_dwordx3 v[68:70], v3, s[20:23], s36 offen sc1
    s_mov_b32 s36, 4608
    buffer_store_dwordx3 v[72:74], v3, s[20:23], s36 offen sc1
    s_mov_b32 s36, 5376
    buffer_store_dwordx3 v[76:78], v3, s[20:23], s36 offen sc1
    s_mov_b32 s36, 6144
    buffer_store_dwordx3 v[80:82], v3, s[20:23], s36 offen sc1
    s_mov_b32 s36, 6912
    buffer_store_dwordx3 v[84:86], v3, s[20:23], s36 offen sc1
    s_mov_b32 s36, 7680
    buffer_store_dwordx3 v[88:90], v3, s[20:23], s36 offen sc1
    s_mov_b32 s36, 8448
    buffer_store_dwordx3 v[92:94], v3, s[20:23], s36 offen sc1
    s_mov_b32 s36, 9216
    buffer_store_dwordx3 v[96:98], v3, s[20:23], s36 offen sc1
    s_mov_b32 s36, 9984
    buffer_store_dwordx3 v[100:102], v3, s[20:23], s36 offen sc1
    s_mov_b32 s36, 10752
    buffer_store_dwordx3 v[104:106], v3, s[20:23], s36 offen sc1
    s_mov_b32 s36, 11520
    buffer_store_dwordx3 v[108:110], v3, s[20:23], s36 offen sc1
    s_mov_b32 s36, 12288
    buffer_store_dwordx3 v[112:114], v3, s[20:23], s36 offen sc1
    s_mov_b32 s36, 13056
    buffer_store_dwordx3 v[116:118], v3, s[20:23], s36 offen sc1
    s_mov_b32 s36, 13824
    buffer_store_dwordx3 v[120:122], v3, s[20:23], s36 offen sc1
    s_mov_b32 s36, 14592
    buffer_store_dwordx3 v[124:126], v3, s[20:23], s36 offen sc1
    v_and_b32 v6, 0x40004000, v5
    v_cmp_ne_u32 vcc, 0, v6
    s_lshl_b32 s35, s39, 4
    s_add_u32 s35, s35, 160328
    v_mov_b32 v10, s35
    s_cmp_lg_u64 vcc, 0
    s_cselect_b32 s36, 1, s55
    v_mov_b32 v11, s36
    ds_write_b32 v10, v11
    s_waitcnt lgkmcnt(0)
    s_barrier
    s_cmp_lg_u32 s39, 0
    s_cbranch_scc1 L_p1_end
    v_and_b32 v6, 15, v0
    v_lshlrev_b32 v6, 4, v6
    v_add_u32 v6, 160320, v6
    ds_read_b128 v[8:11], v6
    s_waitcnt lgkmcnt(0)
    s_nop 1
    v_max_u32_dpp v8, v8, v8 row_shr:1 row_mask:0xf bank_mask:0xf bound_ctrl:0
    s_nop 1
    v_max_u32_dpp v8, v8, v8 row_shr:2 row_mask:0xf bank_mask:0xf bound_ctrl:0
    s_nop 1
    v_max_u32_dpp v8, v8, v8 row_shr:4 row_mask:0xf bank_mask:0xf bound_ctrl:0
    s_nop 1
    v_max_u32_dpp v8, v8, v8 row_shr:8 row_mask:0xf bank_mask:0xf bound_ctrl:0
    s_nop 1
    v_add_f32_dpp v9, v9, v9 row_shr:1 row_mask:0xf bank_mask:0xf bound_ctrl:0
    s_nop 1
    v_add_f32_dpp v9, v9, v9 row_shr:2 row_mask:0xf bank_mask:0xf bound_ctrl:0
    s_nop 1
    v_add_f32_dpp v9, v9, v9 row_shr:4 row_mask:0xf bank_mask:0xf bound_ctrl:0
    s_nop 1
    v_add_f32_dpp v9, v9, v9 row_shr:8 row_mask:0xf bank_mask:0xf bound_ctrl:0
    s_nop 1
    v_or_b32_dpp v10, v10, v10 row_shr:1 row_mask:0xf bank_mask:0xf bound_ctrl:0
    s_nop 1
    v_or_b32_dpp v10, v10, v10 row_shr:2 row_mask:0xf bank_mask:0xf bound_ctrl:0
    s_nop 1
    v_or_b32_dpp v10, v10, v10 row_shr:4 row_mask:0xf bank_mask:0xf bound_ctrl:0
    s_nop 1
    v_or_b32_dpp v10, v10, v10 row_shr:8 row_mask:0xf bank_mask:0xf bound_ctrl:0
    s_lshl_b32 s35, s2, 3
    s_add_u32 s35, s35, 8552960
    v_mov_b32 v6, 0
    v_lshl_or_b32 v8, v10, 16, v8
    s_mov_b64 exec, 0x8000
    buffer_store_dwordx2 v[8:9], v6, s[24:27], s35 offen
L_p1_end:
    s_endpgm
.globl p2_kernel
.p2align 8
.type p2_kernel,@function
p2_kernel:
    s_cmp_ge_u32 s2, 256
    s_cbranch_scc1 L_p2_end
    s_load_dwordx2 s[4:5], s[0:1], 104
    s_load_dwordx2 s[8:9], s[0:1], 0
    s_and_b32 s14, s2, 7
    s_lshr_b32 s49, s2, 3
    s_and_b32 s3, s14, 1
    s_lshl_b32 s3, s3, 5
    s_add_u32 s3, s3, s49
    s_lshr_b32 s12, s14, 1
    v_lshrrev_b32 v112, 6, v0
    v_lshlrev_b32 v1, 4, v0
    v_and_b32 v113, 63, v0
    v_readfirstlane_b32 s13, v112
    v_lshlrev_b32 v115, 4, v113
    s_mul_i32 s14, s12, 65
    s_add_u32 s14, s14, s3
    s_mul_i32 s14, s14, 32896
    s_add_u32 s25, s14, 246292480
    s_mul_i32 s22, s12, 1280000
    s_mov_b32 s2, 0
    s_waitcnt lgkmcnt(0)
    s_mov_b32 s6, 655360000
    s_mov_b32 s7, 0x00020000
    s_add_u32 s8, s4, 254853632
    s_addc_u32 s9, s5, 0
    s_add_u32 s10, s22, 1280000
    s_mov_b32 s11, 0x00020000
    s_add_u32 s15, s25, 0
    buffer_load_dwordx4 v[64:67], v1, s[4:7], s15 offen
    s_add_u32 s15, s25, 32896
    buffer_load_dwordx4 v[72:75], v1, s[4:7], s15 offen
    s_and_b32 s14, s49, 3
    s_lshl_b32 s14, s14, 8
    s_lshr_b32 s15, s49, 2
    s_lshl_b32 s15, s15, 14
    s_add_u32 s51, s14, s15
    s_add_u32 s14, s22, 0
    buffer_load_dwordx4 v[88:91], v1, s[8:11], s14 offen
    s_add_u32 s14, s22, 16384
    buffer_load_dwordx4 v[92:95], v1, s[8:11], s14 offen
    s_add_u32 s14, s22, 32768
    buffer_load_dwordx4 v[96:99], v1, s[8:11], s14 offen
    s_add_u32 s14, s22, 49152
    buffer_load_dwordx4 v[100:103], v1, s[8:11], s14 offen
    s_add_u32 s14, s22, 65536
    buffer_load_dwordx4 v[104:107], v1, s[8:11], s14 offen
    s_mov_b32 s15, 254845440
    buffer_load_dwordx4 v[80:83], v115, s[4:7], s15 offen offset:0
    buffer_load_dwordx4 v[84:87], v115, s[4:7], s15 offen offset:1024
    s_add_u32 s15, s25, 16384
    buffer_load_dwordx4 v[68:71], v1, s[4:7], s15 offen
    s_add_u32 s15, s25, 49280
    buffer_load_dwordx4 v[76:79], v1, s[4:7], s15 offen
    v_mul_u32_u24 v2, 12, v113
    v_add_u32 v2, 2816, v2
    v_add_u32 v3, 80000, v1
    v_add_u32 v124, 145536, v1
    v_add_u32 v117, 65536, v1
    v_mov_b32 v116, 0x7f000000
    v_cmp_gt_u32 vcc, 904, v0
    s_lshl_b32 s57, s13, 10
    s_add_u32 s57, s57, 80000
    s_mov_b64 s[58:59], vcc
    s_mul_i32 s19, s13, 240
    s_add_u32 s19, s19, 160000
    v_cndmask_b32 v124, v116, v124, vcc
    v_cndmask_b32 v117, v116, v117, vcc
    v_lshl_add_u32 v6, v113, 2, s19
    v_lshl_add_u32 v126, v113, 1, s19
    v_cmp_gt_u32 vcc, 14, v113
    s_mul_i32 s27, s13, 15392768
    s_mov_b32 s23, 240512
    v_cndmask_b32 v6, v116, v6, vcc
    s_mov_b32 s44, s4
    s_mov_b32 s45, s5
    s_add_u32 s46, s27, 15400960
    s_mov_b32 s47, 0x00020000
    s_mov_b32 s17, 0x05040100
    s_mov_b32 s18, 80000
    s_and_b32 s50, s3, 1
    s_lshl_b32 s50, s50, 18
    s_sub_u32 s50, 4294836224, s50
    s_mov_b32 s20, 3221209088
    s_mov_b32 s21, 3221209087
    v_mov_b32 v4, 0
    v_mov_b32 v5, 0
    v_mov_b32 v118, 448
    ds_write_b32 v6, v5 offset:160
    ds_write_b16 v126, v118 offset:2
    v_mov_b32 v108, 1073758208
    v_mov_b32 v109, 1073758208
    v_mov_b32 v110, 1073758208
    v_mov_b32 v111, 1073758208
    ds_write_b128 v1, v[108:111] offset:0
    ds_write_b128 v1, v[108:111] offset:16384
    ds_write_b128 v1, v[108:111] offset:32768
    ds_write_b128 v1, v[108:111] offset:49152
    ds_write_b128 v117, v[108:111]
    s_waitcnt vmcnt(9)
    v_mov_b32 v11, v64
    v_mov_b32 v43, v72
    v_mov_b32 v15, v65
    v_mov_b32 v47, v73
    v_mov_b32 v19, v66
    v_mov_b32 v51, v74
    v_mov_b32 v23, v67
    v_mov_b32 v55, v75
    v_add_u32_sdwa v113, 1, v43 dst_sel:DWORD dst_unused:UNUSED_PAD src0_sel:DWORD src1_sel:WORD_0
    v_lshrrev_b32_sdwa v112, 1, v11 dst_sel:DWORD dst_unused:UNUSED_PAD src0_sel:DWORD src1_sel:WORD_0
    v_lshrrev_b32 v113, 1, v113
    v_sub_u32 v114, v113, v112
    v_add_u32 v113, 448, v113
    s_nop 0
    v_add_u32_dpp v114, v114, v114 row_shr:1 row_mask:0xf bank_mask:0xf bound_ctrl:0
    s_nop 1
    v_add_u32_dpp v114, v114, v114 row_shr:2 row_mask:0xf bank_mask:0xf bound_ctrl:0
    s_nop 1
    v_add_u32_dpp v114, v114, v114 row_shr:4 row_mask:0xf bank_mask:0xf bound_ctrl:0
    s_nop 1
    v_add_u32_dpp v114, v114, v114 row_shr:8 row_mask:0xf bank_mask:0xf bound_ctrl:0
    s_nop 1
    v_add_u32_dpp v114, v114, v114 row_bcast:15 row_mask:0xa bank_mask:0xf
    s_nop 1
    v_add_u32_dpp v114, v114, v114 row_bcast:31 row_mask:0xc bank_mask:0xf
    v_sub_u32 v113, v113, v114
    v_readlane_b32 s56, v114, 63
    v_add_u32 v114, -1, v114
    ds_write_b16 v126, v113
    v_lshlrev_b32_e64 v115, v114, 1
    v_lshrrev_b32 v114, 5, v114
    v_lshl_add_u32 v114, v114, 2, s19
    s_cmp_gt_u32 s56, 448
    s_cselect_b32 s2, 1, s2
    s_cselect_b64 exec, 0, -1
    ds_or_b32 v114, v115 offset:160
    s_mov_b64 exec, -1
    ds_wrxchg_rtn_b32 v7, v6, v5 offset:160
    s_waitcnt lgkmcnt(0)
    v_readlane_b32 s30, v7, 0
    v_readlane_b32 s31, v7, 1
    v_readlane_b32 s32, v7, 2
    v_readlane_b32 s33, v7, 3
    v_readlane_b32 s34, v7, 4
    v_readlane_b32 s35, v7, 5
    v_readlane_b32 s36, v7, 6
    v_readlane_b32 s37, v7, 7
    v_readlane_b32 s38, v7, 8
    v_readlane_b32 s39, v7, 9
    v_readlane_b32 s40, v7, 10
    v_readlane_b32 s41, v7, 11
    s_mov_b32 s25, s19
    s_mov_b32 s26, s27
    s_mov_b32 s28, s56
    v_mbcnt_lo_u32_b32 v8, s30, 0
    v_mbcnt_hi_u32_b32 v8, s31, v8
    s_bcnt1_i32_b64 s14, s[30:31]
    v_lshl_add_u32 v9, v8, 1, s25
    ds_read_u16 v9, v9
    v_mad_u32_u24 v8, v8, s23, v2
    s_mov_b32 s30, s26
    s_lshl1_add_u32 s25, s14, s25
    s_mul_i32 s14, s14, s23
    s_add_u32 s26, s26, s14
    v_mbcnt_lo_u32_b32 v12, s32, 0
    v_mbcnt_hi_u32_b32 v12, s33, v12
    s_bcnt1_i32_b64 s14, s[32:33]
    v_lshl_add_u32 v13, v12, 1, s25
    ds_read_u16 v13, v13
    v_mad_u32_u24 v12, v12, s23, v2
    s_mov_b32 s32, s26
    s_lshl1_add_u32 s25, s14, s25
    s_mul_i32 s14, s14, s23
    s_add_u32 s26, s26, s14
    v_mbcnt_lo_u32_b32 v16, s34, 0
    v_mbcnt_hi_u32_b32 v16, s35, v16
    s_bcnt1_i32_b64 s14, s[34:35]
    v_lshl_add_u32 v17, v16, 1, s25
    ds_read_u16 v17, v17
    v_mad_u32_u24 v16, v16, s23, v2
    s_mov_b32 s34, s26
    s_lshl1_add_u32 s25, s14, s25
    s_mul_i32 s14, s14, s23
    s_add_u32 s26, s26, s14
    v_mbcnt_lo_u32_b32 v20, s36, 0
    v_mbcnt_hi_u32_b32 v20, s37, v20
    s_bcnt1_i32_b64 s14, s[36:37]
    v_lshl_add_u32 v21, v20, 1, s25
    ds_read_u16 v21, v21
    v_mad_u32_u24 v20, v20, s23, v2
    s_mov_b32 s36, s26
    s_lshl1_add_u32 s25, s14, s25
    s_mul_i32 s14, s14, s23
    s_add_u32 s26, s26, s14
    v_mbcnt_lo_u32_b32 v24, s38, 0
    v_mbcnt_hi_u32_b32 v24, s39, v24
    s_bcnt1_i32_b64 s14, s[38:39]
    v_lshl_add_u32 v25, v24, 1, s25
    ds_read_u16 v25, v25
    v_mad_u32_u24 v24, v24, s23, v2
    s_mov_b32 s38, s26
    s_lshl1_add_u32 s25, s14, s25
    s_mul_i32 s14, s14, s23
    s_add_u32 s26, s26, s14
    v_mbcnt_lo_u32_b32 v28, s40, 0
    v_mbcnt_hi_u32_b32 v28, s41, v28
    s_bcnt1_i32_b64 s14, s[40:41]
    v_lshl_add_u32 v29, v28, 1, s25
    ds_read_u16 v29, v29
    v_mad_u32_u24 v28, v28, s23, v2
    s_mov_b32 s40, s26
    s_lshl1_add_u32 s25, s14, s25
    s_mul_i32 s14, s14, s23
    s_add_u32 s26, s26, s14
    s_waitcnt lgkmcnt(5)
    v_mad_u32_u24 v8, v9, 12, v8
    buffer_load_dwordx3 v[8:10], v8, s[44:47], s30 offen offset:0
    s_waitcnt lgkmcnt(4)
    v_mad_u32_u24 v12, v13, 12, v12
    buffer_load_dwordx3 v[12:14], v12, s[44:47], s32 offen offset:768
    s_waitcnt lgkmcnt(3)
    v_mad_u32_u24 v16, v17, 12, v16
    buffer_load_dwordx3 v[16:18], v16, s[44:47], s34 offen offset:1536
    s_waitcnt lgkmcnt(2)
    v_mad_u32_u24 v20, v21, 12, v20
    buffer_load_dwordx3 v[20:22], v20, s[44:47], s36 offen offset:2304
    s_waitcnt lgkmcnt(1)
    v_mad_u32_u24 v24, v25, 12, v24
    buffer_load_dwordx3 v[24:26], v24, s[44:47], s38 offen offset:3072
    s_waitcnt lgkmcnt(0)
    v_mad_u32_u24 v28, v29, 12, v28
    buffer_load_dwordx3 v[28:30], v28, s[44:47], s40 offen offset:3840
    s_cmp_le_u32 s28, 384
    s_cbranch_scc1 L_p2_kernel_norare_1
    v_readlane_b32 s42, v7, 12
    v_readlane_b32 s43, v7, 13
    s_nop 1
    v_mbcnt_lo_u32_b32 v120, s42, 0
    v_mbcnt_hi_u32_b32 v120, s43, v120
    s_bcnt1_i32_b64 s14, s[42:43]
    v_lshl_add_u32 v121, v120, 1, s25
    ds_read_u16 v121, v121
    v_mad_u32_u24 v120, v120, s23, v2
    s_mov_b32 s42, s26
    s_lshl1_add_u32 s25, s14, s25
    s_mul_i32 s14, s14, s23
    s_add_u32 s26, s26, s14
    s_waitcnt lgkmcnt(0)
    s_add_u32 s42, s42, 4608
    v_mad_u32_u24 v120, v121, 12, v120
    buffer_load_dwordx3 v[32:34], v120, s[44:47], s42 offen offset:0
L_p2_kernel_norare_1:
    s_waitcnt vmcnt(10)
    ds_write_b128 v3, v[88:91] offset:0
    ds_write_b128 v3, v[92:95] offset:16384
    ds_write_b128 v3, v[96:99] offset:32768
    ds_write_b128 v3, v[100:103] offset:49152
    ds_write_b128 v124, v[104:107]
    s_waitcnt vmcnt(6)
    v_mov_b32 v27, v68
    v_mov_b32 v59, v76
    v_mov_b32 v31, v69
    v_mov_b32 v63, v77
    v_mov_b32 v35, v70
    v_mov_b32 v122, v78
    v_mov_b32 v39, v71
    v_mov_b32 v123, v79
    v_max3_u32 v36, v80, v82, v84
    v_add_f32 v37, v81, v83
    v_add_f32 v38, v85, v87
    v_max_u32 v36, v36, v86
    v_add_f32 v37, v37, v38
    v_cmp_lt_u32 vcc, 0xffff, v36
    s_nop 1
    v_max_u32_dpp v36, v36, v36 row_shr:1 row_mask:0xf bank_mask:0xf bound_ctrl:0
    s_nop 1
    v_max_u32_dpp v36, v36, v36 row_shr:2 row_mask:0xf bank_mask:0xf bound_ctrl:0
    s_nop 1
    v_max_u32_dpp v36, v36, v36 row_shr:4 row_mask:0xf bank_mask:0xf bound_ctrl:0
    s_nop 1
    v_max_u32_dpp v36, v36, v36 row_shr:8 row_mask:0xf bank_mask:0xf bound_ctrl:0
    s_nop 1
    v_max_u32_dpp v36, v36, v36 row_bcast:15 row_mask:0xa bank_mask:0xf
    s_nop 1
    v_max_u32_dpp v36, v36, v36 row_bcast:31 row_mask:0xc bank_mask:0xf
    s_nop 1
    v_add_f32_dpp v37, v37, v37 row_shr:1 row_mask:0xf bank_mask:0xf bound_ctrl:0
    s_nop 1
    v_add_f32_dpp v37, v37, v37 row_shr:2 row_mask:0xf bank_mask:0xf bound_ctrl:0
    s_nop 1
    v_add_f32_dpp v37, v37, v37 row_shr:4 row_mask:0xf bank_mask:0xf bound_ctrl:0
    s_nop 1
    v_add_f32_dpp v37, v37, v37 row_shr:8 row_mask:0xf bank_mask:0xf bound_ctrl:0
    s_nop 1
    v_add_f32_dpp v37, v37, v37 row_bcast:15 row_mask:0xa bank_mask:0xf
    s_nop 1
    v_add_f32_dpp v37, v37, v37 row_bcast:31 row_mask:0xc bank_mask:0xf
    s_cmp_lg_u64 vcc, 0
    s_cselect_b32 s2, 1, s2
    v_lshlrev_b32 v36, 16, v36
    v_mul_f32 v38, 936490775, v37
    v_mul_f32 v37, 928531664, v37
    v_cmp_nle_f32 vcc, v36, v38
    v_max_u32 v36, v36, v37
    s_nop 0
    v_readlane_b32 s14, v36, 63
    s_bitcmp1_b32 vcc_hi, 31
    s_cselect_b32 s2, 1, s2
    s_lshr_b32 s14, s14, 23
    s_add_u32 s14, s14, 1
    s_cmp_lt_u32 s14, 40
    s_cselect_b32 s2, 1, s2
    s_cmp_gt_u32 s14, 230
    s_cselect_b32 s2, 1, s2
    s_sub_u32 s48, s14, 14
    s_lshl_b32 s48, s48, 23
    s_add_u32 s16, s48, 197148672
    s_waitcnt lgkmcnt(0)
    s_barrier
    s_add_u32 s14, s22, 80000
    buffer_load_dwordx4 v[88:91], v1, s[8:11], s14 offen
    s_add_u32 s14, s22, 96384
    buffer_load_dwordx4 v[92:95], v1, s[8:11], s14 offen
    s_add_u32 s14, s22, 112768
    buffer_load_dwordx4 v[96:99], v1, s[8:11], s14 offen
    v_add_u32_sdwa v113, 1, v43 dst_sel:DWORD dst_unused:UNUSED_PAD src0_sel:DWORD src1_sel:WORD_1
    v_lshrrev_b32_sdwa v112, 1, v11 dst_sel:DWORD dst_unused:UNUSED_PAD src0_sel:DWORD src1_sel:WORD_1
    v_lshrrev_b32 v113, 1, v113
    v_sub_u32 v114, v113, v112
    v_add_u32 v113, 448, v113
    s_nop 0
    v_add_u32_dpp v114, v114, v114 row_shr:1 row_mask:0xf bank_mask:0xf bound_ctrl:0
    s_nop 1
    v_add_u32_dpp v114, v114, v114 row_shr:2 row_mask:0xf bank_mask:0xf bound_ctrl:0
    s_nop 1
    v_add_u32_dpp v114, v114, v114 row_shr:4 row_mask:0xf bank_mask:0xf bound_ctrl:0
    s_nop 1
    v_add_u32_dpp v114, v114, v114 row_shr:8 row_mask:0xf bank_mask:0xf bound_ctrl:0
    s_nop 1
    v_add_u32_dpp v114, v114, v114 row_bcast:15 row_mask:0xa bank_mask:0xf
    s_nop 1
    v_add_u32_dpp v114, v114, v114 row_bcast:31 row_mask:0xc bank_mask:0xf
    v_sub_u32 v113, v113, v114
    v_readlane_b32 s56, v114, 63
    v_add_u32 v114, -1, v114
    ds_write_b16 v126, v113
    v_lshlrev_b32_e64 v115, v114, 1
    v_lshrrev_b32 v114, 5, v114
    v_lshl_add_u32 v114, v114, 2, s19
    s_cmp_gt_u32 s56, 448
    s_cselect_b32 s2, 1, s2
    s_cselect_b64 exec, 0, -1
    ds_or_b32 v114, v115 offset:160
    s_mov_b64 exec, -1
    ds_wrxchg_rtn_b32 v7, v6, v5 offset:160
    s_mov_b32 s24, 0
L_p2_loop:
    s_cmp_le_u32 s28, 384
    s_cbranch_scc1 L_p2_kernel_norare2_2
    s_waitcnt vmcnt(0)
    v_mad_u32_u16 v64, v32, 8, s18
    v_mad_u32_u16 v66, v33, 8, s18
    ds_read_b64 v[64:65], v64
    ds_read_b64 v[66:67], v66
    v_and_b32 v112, 0xffff, v34
    v_lshrrev_b32 v114, 16, v34
    v_lshlrev_b32 v113, 16, v34
    v_and_b32 v34, 0xffff0000, v34
    v_mad_u32_u16 v32, v32, 8, s50 op_sel:[1,0,0,0]
    v_mad_u32_u16 v33, v33, 8, s50 op_sel:[1,0,0,0]
    s_waitcnt lgkmcnt(0)
    v_dot2_f32_bf16 v115, v64, v112, s16
    v_dot2_f32_bf16 v64, v64, v113, s16
    v_dot2_f32_bf16 v116, v65, v112, s16
    v_dot2_f32_bf16 v65, v65, v113, s16
    v_dot2_f32_bf16 v117, v66, v114, s16
    v_dot2_f32_bf16 v66, v66, v34, s16
    v_dot2_f32_bf16 v118, v67, v114, s16
    v_dot2_f32_bf16 v67, v67, v34, s16
    v_perm_b32 v64, v64, v115, s17
    v_perm_b32 v65, v65, v116, s17
    v_perm_b32 v66, v66, v117, s17
    v_perm_b32 v67, v67, v118, s17
    v_lshl_add_u64 v[64:65], v[64:65], 0, s[20:21]
    v_lshl_add_u64 v[66:67], v[66:67], 0, s[20:21]
    v_or3_b32 v4, v108, v109, v4
    v_or3_b32 v4, v110, v111, v4
    ds_add_rtn_u64 v[108:109], v32, v[64:65]
    ds_add_rtn_u64 v[110:111], v33, v[66:67]
    s_waitcnt lgkmcnt(0)
L_p2_kernel_norare2_2:
    s_add_u32 s22, s22, 80000
    s_waitcnt vmcnt(8)
    v_mad_u32_u16 v64, v8, 8, s18
    v_mad_u32_u16 v66, v9, 8, s18
    ds_read_b64 v[64:65], v64
    ds_read_b64 v[66:67], v66
    s_add_u32 s14, s22, 49152
    buffer_load_dwordx4 v[100:103], v1, s[8:11], s14 offen
    s_waitcnt vmcnt(8)
    v_mad_u32_u16 v68, v12, 8, s18
    v_mad_u32_u16 v70, v13, 8, s18
    ds_read_b64 v[68:69], v68
    ds_read_b64 v[70:71], v70
    s_add_u32 s14, s22, 65536
    buffer_load_dwordx4 v[104:107], v1, s[8:11], s14 offen
    s_waitcnt vmcnt(8)
    v_mad_u32_u16 v72, v16, 8, s18
    v_mad_u32_u16 v74, v17, 8, s18
    ds_read_b64 v[72:73], v72
    ds_read_b64 v[74:75], v74
    s_waitcnt lgkmcnt(6)
    v_readlane_b32 s30, v7, 0
    v_readlane_b32 s31, v7, 1
    v_readlane_b32 s32, v7, 2
    v_readlane_b32 s33, v7, 3
    v_readlane_b32 s34, v7, 4
    v_readlane_b32 s35, v7, 5
    v_readlane_b32 s36, v7, 6
    v_readlane_b32 s37, v7, 7
    v_readlane_b32 s38, v7, 8
    v_readlane_b32 s39, v7, 9
    v_readlane_b32 s40, v7, 10
    v_readlane_b32 s41, v7, 11
    s_mov_b32 s25, s19
    s_mov_b32 s26, s27
    s_mov_b32 s28, s56
    v_mbcnt_lo_u32_b32 v120, s30, 0
    v_mbcnt_hi_u32_b32 v120, s31, v120
    s_bcnt1_i32_b64 s14, s[30:31]
    v_lshl_add_u32 v121, v120, 1, s25
    ds_read_u16 v121, v121
    v_mad_u32_u24 v120, v120, s23, v2
    s_mov_b32 s30, s26
    s_lshl1_add_u32 s25, s14, s25
    s_mul_i32 s14, s14, s23
    s_add_u32 s26, s26, s14
    v_and_b32 v112, 0xffff, v10
    v_lshrrev_b32 v114, 16, v10
    v_lshlrev_b32 v113, 16, v10
    v_and_b32 v10, 0xffff0000, v10
    v_mad_u32_u16 v8, v8, 8, s50 op_sel:[1,0,0,0]
    v_mad_u32_u16 v9, v9, 8, s50 op_sel:[1,0,0,0]
    s_waitcnt lgkmcnt(5)
    v_dot2_f32_bf16 v115, v64, v112, s16
    v_dot2_f32_bf16 v64, v64, v113, s16
    v_dot2_f32_bf16 v116, v65, v112, s16
    v_dot2_f32_bf16 v65, v65, v113, s16
    v_dot2_f32_bf16 v117, v66, v114, s16
    v_dot2_f32_bf16 v66, v66, v10, s16
    v_dot2_f32_bf16 v118, v67, v114, s16
    v_dot2_f32_bf16 v67, v67, v10, s16
    v_perm_b32 v64, v64, v115, s17
    v_perm_b32 v65, v65, v116, s17
    v_perm_b32 v66, v66, v117, s17
    v_perm_b32 v67, v67, v118, s17
    v_lshl_add_u64 v[64:65], v[64:65], 0, s[20:21]
    v_lshl_add_u64 v[66:67], v[66:67], 0, s[20:21]
    v_or3_b32 v4, v108, v109, v4
    v_or3_b32 v4, v110, v111, v4
    ds_add_rtn_u64 v[108:109], v8, v[64:65]
    ds_add_rtn_u64 v[110:111], v9, v[66:67]
    s_waitcnt lgkmcnt(2)
    v_mad_u32_u24 v120, v121, 12, v120
    buffer_load_dwordx3 v[8:10], v120, s[44:47], s30 offen offset:0
    s_waitcnt vmcnt(8)
    v_mad_u32_u16 v76, v20, 8, s18
    v_mad_u32_u16 v78, v21, 8, s18
    ds_read_b64 v[76:77], v76
    ds_read_b64 v[78:79], v78
    v_mbcnt_lo_u32_b32 v120, s32, 0
    v_mbcnt_hi_u32_b32 v120, s33, v120
    s_bcnt1_i32_b64 s14, s[32:33]
    v_lshl_add_u32 v121, v120, 1, s25
    ds_read_u16 v121, v121
    v_mad_u32_u24 v120, v120, s23, v2
    s_mov_b32 s32, s26
    s_lshl1_add_u32 s25, s14, s25
    s_mul_i32 s14, s14, s23
    s_add_u32 s26, s26, s14
    v_and_b32 v112, 0xffff, v14
    v_lshrrev_b32 v114, 16, v14
    v_lshlrev_b32 v113, 16, v14
    v_and_b32 v14, 0xffff0000, v14
    v_mad_u32_u16 v12, v12, 8, s50 op_sel:[1,0,0,0]
    v_mad_u32_u16 v13, v13, 8, s50 op_sel:[1,0,0,0]
    v_dot2_f32_bf16 v115, v68, v112, s16
    v_dot2_f32_bf16 v68, v68, v113, s16
    v_dot2_f32_bf16 v116, v69, v112, s16
    v_dot2_f32_bf16 v69, v69, v113, s16
    v_dot2_f32_bf16 v117, v70, v114, s16
    v_dot2_f32_bf16 v70, v70, v14, s16
    v_dot2_f32_bf16 v118, v71, v114, s16
    v_dot2_f32_bf16 v71, v71, v14, s16
    v_perm_b32 v68, v68, v115, s17
    v_perm_b32 v69, v69, v116, s17
    v_perm_b32 v70, v70, v117, s17
    v_perm_b32 v71, v71, v118, s17
    v_lshl_add_u64 v[68:69], v[68:69], 0, s[20:21]
    v_lshl_add_u64 v[70:71], v[70:71], 0, s[20:21]
    s_waitcnt lgkmcnt(3)
    v_or3_b32 v4, v108, v109, v4
    v_or3_b32 v4, v110, v111, v4
    ds_add_rtn_u64 v[108:109], v12, v[68:69]
    ds_add_rtn_u64 v[110:111], v13, v[70:71]
    s_waitcnt lgkmcnt(2)
    v_mad_u32_u24 v120, v121, 12, v120
    buffer_load_dwordx3 v[12:14], v120, s[44:47], s32 offen offset:768
    s_waitcnt vmcnt(8)
    v_mad_u32_u16 v80, v24, 8, s18
    v_mad_u32_u16 v82, v25, 8, s18
    ds_read_b64 v[80:81], v80
    ds_read_b64 v[82:83], v82
    s_waitcnt vmcnt(7)
    v_mad_u32_u16 v84, v28, 8, s18
    v_mad_u32_u16 v86, v29, 8, s18
    ds_read_b64 v[84:85], v84
    ds_read_b64 v[86:87], v86
    v_mbcnt_lo_u32_b32 v120, s34, 0
    v_mbcnt_hi_u32_b32 v120, s35, v120
    s_bcnt1_i32_b64 s14, s[34:35]
    v_lshl_add_u32 v121, v120, 1, s25
    ds_read_u16 v121, v121
    v_mad_u32_u24 v120, v120, s23, v2
    s_mov_b32 s34, s26
    s_lshl1_add_u32 s25, s14, s25
    s_mul_i32 s14, s14, s23
    s_add_u32 s26, s26, s14
    v_and_b32 v112, 0xffff, v18
    v_lshrrev_b32 v114, 16, v18
    v_lshlrev_b32 v113, 16, v18
    v_and_b32 v18, 0xffff0000, v18
    v_mad_u32_u16 v16, v16, 8, s50 op_sel:[1,0,0,0]
    v_mad_u32_u16 v17, v17, 8, s50 op_sel:[1,0,0,0]
    v_dot2_f32_bf16 v115, v72, v112, s16
    v_dot2_f32_bf16 v72, v72, v113, s16
    v_dot2_f32_bf16 v116, v73, v112, s16
    v_dot2_f32_bf16 v73, v73, v113, s16
    v_dot2_f32_bf16 v117, v74, v114, s16
    v_dot2_f32_bf16 v74, v74, v18, s16
    v_dot2_f32_bf16 v118, v75, v114, s16
    v_dot2_f32_bf16 v75, v75, v18, s16
    v_perm_b32 v72, v72, v115, s17
    v_perm_b32 v73, v73, v116, s17
    v_perm_b32 v74, v74, v117, s17
    v_perm_b32 v75, v75, v118, s17
    v_lshl_add_u64 v[72:73], v[72:73], 0, s[20:21]
    v_lshl_add_u64 v[74:75], v[74:75], 0, s[20:21]
    s_waitcnt lgkmcnt(5)
    v_or3_b32 v4, v108, v109, v4
    v_or3_b32 v4, v110, v111, v4
    ds_add_rtn_u64 v[108:109], v16, v[72:73]
    ds_add_rtn_u64 v[110:111], v17, v[74:75]
    s_waitcnt lgkmcnt(2)
    v_mad_u32_u24 v120, v121, 12, v120
    buffer_load_dwordx3 v[16:18], v120, s[44:47], s34 offen offset:1536
    s_barrier
    s_waitcnt vmcnt(3)
    ds_write_b128 v3, v[88:91] offset:0
    ds_write_b128 v3, v[92:95] offset:16384
    ds_write_b128 v3, v[96:99] offset:32768
    ds_write_b128 v3, v[100:103] offset:49152
    ds_write_b128 v124, v[104:107]
    v_mbcnt_lo_u32_b32 v120, s36, 0
    v_mbcnt_hi_u32_b32 v120, s37, v120
    s_bcnt1_i32_b64 s14, s[36:37]
    v_lshl_add_u32 v121, v120, 1, s25
    ds_read_u16 v121, v121
    v_mad_u32_u24 v120, v120, s23, v2
    s_mov_b32 s36, s26
    s_lshl1_add_u32 s25, s14, s25
    s_mul_i32 s14, s14, s23
    s_add_u32 s26, s26, s14
    v_and_b32 v112, 0xffff, v22
    v_lshrrev_b32 v114, 16, v22
    v_lshlrev_b32 v113, 16, v22
    v_and_b32 v22, 0xffff0000, v22
    v_mad_u32_u16 v20, v20, 8, s50 op_sel:[1,0,0,0]
    v_mad_u32_u16 v21, v21, 8, s50 op_sel:[1,0,0,0]
    v_dot2_f32_bf16 v115, v76, v112, s16
    v_dot2_f32_bf16 v76, v76, v113, s16
    v_dot2_f32_bf16 v116, v77, v112, s16
    v_dot2_f32_bf16 v77, v77, v113, s16
    v_dot2_f32_bf16 v117, v78, v114, s16
    v_dot2_f32_bf16 v78, v78, v22, s16
    v_dot2_f32_bf16 v118, v79, v114, s16
    v_dot2_f32_bf16 v79, v79, v22, s16
    v_perm_b32 v76, v76, v115, s17
    v_perm_b32 v77, v77, v116, s17
    v_perm_b32 v78, v78, v117, s17
    v_perm_b32 v79, v79, v118, s17
    v_lshl_add_u64 v[76:77], v[76:77], 0, s[20:21]
    v_lshl_add_u64 v[78:79], v[78:79], 0, s[20:21]
    s_waitcnt lgkmcnt(6)
    v_or3_b32 v4, v108, v109, v4
    v_or3_b32 v4, v110, v111, v4
    ds_add_rtn_u64 v[108:109], v20, v[76:77]
    ds_add_rtn_u64 v[110:111], v21, v[78:79]
    s_waitcnt lgkmcnt(2)
    v_mad_u32_u24 v120, v121, 12, v120
    buffer_load_dwordx3 v[20:22], v120, s[44:47], s36 offen offset:2304
    v_mbcnt_lo_u32_b32 v120, s38, 0
    v_mbcnt_hi_u32_b32 v120, s39, v120
    s_bcnt1_i32_b64 s14, s[38:39]
    v_lshl_add_u32 v121, v120, 1, s25
    ds_read_u16 v121, v121
    v_mad_u32_u24 v120, v120, s23, v2
    s_mov_b32 s38, s26
    s_lshl1_add_u32 s25, s14, s25
    s_mul_i32 s14, s14, s23
    s_add_u32 s26, s26, s14
    v_and_b32 v112, 0xffff, v26
    v_lshrrev_b32 v114, 16, v26
    v_lshlrev_b32 v113, 16, v26
    v_and_b32 v26, 0xffff0000, v26
    v_mad_u32_u16 v24, v24, 8, s50 op_sel:[1,0,0,0]
    v_mad_u32_u16 v25, v25, 8, s50 op_sel:[1,0,0,0]
    v_dot2_f32_bf16 v115, v80, v112, s16
    v_dot2_f32_bf16 v80, v80, v113, s16
    v_dot2_f32_bf16 v116, v81, v112, s16
    v_dot2_f32_bf16 v81, v81, v113, s16
    v_dot2_f32_bf16 v117, v82, v114, s16
    v_dot2_f32_bf16 v82, v82, v26, s16
    v_dot2_f32_bf16 v118, v83, v114, s16
    v_dot2_f32_bf16 v83, v83, v26, s16
    v_perm_b32 v80, v80, v115, s17
    v_perm_b32 v81, v81, v116, s17
    v_perm_b32 v82, v82, v117, s17
    v_perm_b32 v83, v83, v118, s17
    v_lshl_add_u64 v[80:81], v[80:81], 0, s[20:21]
    v_lshl_add_u64 v[82:83], v[82:83], 0, s[20:21]
    s_waitcnt lgkmcnt(1)
    v_or3_b32 v4, v108, v109, v4
    v_or3_b32 v4, v110, v111, v4
    ds_add_rtn_u64 v[108:109], v24, v[80:81]
    ds_add_rtn_u64 v[110:111], v25, v[82:83]
    s_waitcnt lgkmcnt(2)
    v_mad_u32_u24 v120, v121, 12, v120
    buffer_load_dwordx3 v[24:26], v120, s[44:47], s38 offen offset:3072
    v_mbcnt_lo_u32_b32 v120, s40, 0
    v_mbcnt_hi_u32_b32 v120, s41, v120
    s_bcnt1_i32_b64 s14, s[40:41]
    v_lshl_add_u32 v121, v120, 1, s25
    ds_read_u16 v121, v121
    v_mad_u32_u24 v120, v120, s23, v2
    s_mov_b32 s40, s26
    s_lshl1_add_u32 s25, s14, s25
    s_mul_i32 s14, s14, s23
    s_add_u32 s26, s26, s14
    v_and_b32 v112, 0xffff, v30
    v_lshrrev_b32 v114, 16, v30
    v_lshlrev_b32 v113, 16, v30
    v_and_b32 v30, 0xffff0000, v30
    v_mad_u32_u16 v28, v28, 8, s50 op_sel:[1,0,0,0]
    v_mad_u32_u16 v29, v29, 8, s50 op_sel:[1,0,0,0]
    v_dot2_f32_bf16 v115, v84, v112, s16
    v_dot2_f32_bf16 v84, v84, v113, s16
    v_dot2_f32_bf16 v116, v85, v112, s16
    v_dot2_f32_bf16 v85, v85, v113, s16
    v_dot2_f32_bf16 v117, v86, v114, s16
    v_dot2_f32_bf16 v86, v86, v30, s16
    v_dot2_f32_bf16 v118, v87, v114, s16
    v_dot2_f32_bf16 v87, v87, v30, s16
    v_perm_b32 v84, v84, v115, s17
    v_perm_b32 v85, v85, v116, s17
    v_perm_b32 v86, v86, v117, s17
    v_perm_b32 v87, v87, v118, s17
    v_lshl_add_u64 v[84:85], v[84:85], 0, s[20:21]
    v_lshl_add_u64 v[86:87], v[86:87], 0, s[20:21]
    s_waitcnt lgkmcnt(1)
    v_or3_b32 v4, v108, v109, v4
    v_or3_b32 v4, v110, v111, v4
    ds_add_rtn_u64 v[108:109], v28, v[84:85]
    ds_add_rtn_u64 v[110:111], v29, v[86:87]
    s_waitcnt lgkmcnt(2)
    v_mad_u32_u24 v120, v121, 12, v120
    buffer_load_dwordx3 v[28:30], v120, s[44:47], s40 offen offset:3840
    s_cmp_le_u32 s28, 384
    s_cbranch_scc1 L_p2_kernel_norare_3
    v_readlane_b32 s42, v7, 12
    v_readlane_b32 s43, v7, 13
    s_nop 1
    v_mbcnt_lo_u32_b32 v120, s42, 0
    v_mbcnt_hi_u32_b32 v120, s43, v120
    s_bcnt1_i32_b64 s14, s[42:43]
    v_lshl_add_u32 v121, v120, 1, s25
    ds_read_u16 v121, v121
    v_mad_u32_u24 v120, v120, s23, v2
    s_mov_b32 s42, s26
    s_lshl1_add_u32 s25, s14, s25
    s_mul_i32 s14, s14, s23
    s_add_u32 s26, s26, s14
    s_waitcnt lgkmcnt(0)
    s_add_u32 s42, s42, 4608
    v_mad_u32_u24 v120, v121, 12, v120
    buffer_load_dwordx3 v[32:34], v120, s[44:47], s42 offen offset:0
L_p2_kernel_norare_3:
    v_mov_b32 v11, v15
    v_mov_b32 v43, v47
    v_mov_b32 v15, v19
    v_mov_b32 v47, v51
    v_mov_b32 v19, v23
    v_mov_b32 v51, v55
    v_mov_b32 v23, v27
    v_mov_b32 v55, v59
    v_mov_b32 v27, v31
    v_mov_b32 v59, v63
    v_mov_b32 v31, v35
    v_mov_b32 v63, v122
    v_mov_b32 v35, v39
    v_mov_b32 v122, v123
    v_mov_b32 v39, 0
    v_mov_b32 v123, 0
    v_add_u32_sdwa v113, 1, v43 dst_sel:DWORD dst_unused:UNUSED_PAD src0_sel:DWORD src1_sel:WORD_0
    v_lshrrev_b32_sdwa v112, 1, v11 dst_sel:DWORD dst_unused:UNUSED_PAD src0_sel:DWORD src1_sel:WORD_0
    v_lshrrev_b32 v113, 1, v113
    v_sub_u32 v114, v113, v112
    v_add_u32 v113, 448, v113
    s_nop 0
    v_add_u32_dpp v114, v114, v114 row_shr:1 row_mask:0xf bank_mask:0xf bound_ctrl:0
    s_nop 1
    v_add_u32_dpp v114, v114, v114 row_shr:2 row_mask:0xf bank_mask:0xf bound_ctrl:0
    s_nop 1
    v_add_u32_dpp v114, v114, v114 row_shr:4 row_mask:0xf bank_mask:0xf bound_ctrl:0
    s_nop 1
    v_add_u32_dpp v114, v114, v114 row_shr:8 row_mask:0xf bank_mask:0xf bound_ctrl:0
    s_nop 1
    v_add_u32_dpp v114, v114, v114 row_bcast:15 row_mask:0xa bank_mask:0xf
    s_nop 1
    v_add_u32_dpp v114, v114, v114 row_bcast:31 row_mask:0xc bank_mask:0xf
    v_sub_u32 v113, v113, v114
    v_readlane_b32 s56, v114, 63
    v_add_u32 v114, -1, v114
    ds_write_b16 v126, v113
    v_lshlrev_b32_e64 v115, v114, 1
    v_lshrrev_b32 v114, 5, v114
    v_lshl_add_u32 v114, v114, 2, s19
    s_cmp_gt_u32 s56, 448
    s_cselect_b32 s2, 1, s2
    s_cselect_b64 exec, 0, -1
    ds_or_b32 v114, v115 offset:160
    s_mov_b64 exec, -1
    ds_wrxchg_rtn_b32 v7, v6, v5 offset:160
    s_add_u32 s14, s22, 80000
    buffer_load_dwordx4 v[88:91], v1, s[8:11], s14 offen
    s_add_u32 s14, s22, 96384
    buffer_load_dwordx4 v[92:95], v1, s[8:11], s14 offen
    s_add_u32 s14, s22, 112768
    buffer_load_dwordx4 v[96:99], v1, s[8:11], s14 offen
    s_barrier
    s_cmp_le_u32 s28, 384
    s_cbranch_scc1 L_p2_kernel_norare2_4
    s_waitcnt vmcnt(0)
    v_mad_u32_u16 v64, v32, 8, s18
    v_mad_u32_u16 v66, v33, 8, s18
    ds_read_b64 v[64:65], v64
    ds_read_b64 v[66:67], v66
    v_and_b32 v112, 0xffff, v34
    v_lshrrev_b32 v114, 16, v34
    v_lshlrev_b32 v113, 16, v34
    v_and_b32 v34, 0xffff0000, v34
    v_mad_u32_u16 v32, v32, 8, s50 op_sel:[1,0,0,0]
    v_mad_u32_u16 v33, v33, 8, s50 op_sel:[1,0,0,0]
    s_waitcnt lgkmcnt(0)
    v_dot2_f32_bf16 v115, v64, v112, s16
    v_dot2_f32_bf16 v64, v64, v113, s16
    v_dot2_f32_bf16 v116, v65, v112, s16
    v_dot2_f32_bf16 v65, v65, v113, s16
    v_dot2_f32_bf16 v117, v66, v114, s16
    v_dot2_f32_bf16 v66, v66, v34, s16
    v_dot2_f32_bf16 v118, v67, v114, s16
    v_dot2_f32_bf16 v67, v67, v34, s16
    v_perm_b32 v64, v64, v115, s17
    v_perm_b32 v65, v65, v116, s17
    v_perm_b32 v66, v66, v117, s17
    v_perm_b32 v67, v67, v118, s17
    v_lshl_add_u64 v[64:65], v[64:65], 0, s[20:21]
    v_lshl_add_u64 v[66:67], v[66:67], 0, s[20:21]
    v_or3_b32 v4, v108, v109, v4
    v_or3_b32 v4, v110, v111, v4
    ds_add_rtn_u64 v[108:109], v32, v[64:65]
    ds_add_rtn_u64 v[110:111], v33, v[66:67]
    s_waitcnt lgkmcnt(0)
L_p2_kernel_norare2_4:
    s_add_u32 s22, s22, 80000
    s_cmp_eq_u32 s24, 7
    s_cselect_b32 s46, 0, s46
    s_waitcnt vmcnt(8)
    v_mad_u32_u16 v64, v8, 8, s18
    v_mad_u32_u16 v66, v9, 8, s18
    ds_read_b64 v[64:65], v64
    ds_read_b64 v[66:67], v66
    s_add_u32 s14, s22, 49152
    buffer_load_dwordx4 v[100:103], v1, s[8:11], s14 offen
    s_waitcnt vmcnt(8)
    v_mad_u32_u16 v68, v12, 8, s18
    v_mad_u32_u16 v70, v13, 8, s18
    ds_read_b64 v[68:69], v68
    ds_read_b64 v[70:71], v70
    s_add_u32 s14, s22, 65536
    buffer_load_dwordx4 v[104:107], v1, s[8:11], s14 offen
    s_waitcnt vmcnt(8)
    v_mad_u32_u16 v72, v16, 8, s18
    v_mad_u32_u16 v74, v17, 8, s18
    ds_read_b64 v[72:73], v72
    ds_read_b64 v[74:75], v74
    s_waitcnt lgkmcnt(6)
    v_readlane_b32 s30, v7, 0
    v_readlane_b32 s31, v7, 1
    v_readlane_b32 s32, v7, 2
    v_readlane_b32 s33, v7, 3
    v_readlane_b32 s34, v7, 4
    v_readlane_b32 s35, v7, 5
    v_readlane_b32 s36, v7, 6
    v_readlane_b32 s37, v7, 7
    v_readlane_b32 s38, v7, 8
    v_readlane_b32 s39, v7, 9
    v_readlane_b32 s40, v7, 10
    v_readlane_b32 s41, v7, 11
    s_mov_b32 s25, s19
    s_mov_b32 s26, s27
    s_mov_b32 s28, s56
    v_mbcnt_lo_u32_b32 v120, s30, 0
    v_mbcnt_hi_u32_b32 v120, s31, v120
    s_bcnt1_i32_b64 s14, s[30:31]
    v_lshl_add_u32 v121, v120, 1, s25
    ds_read_u16 v121, v121
    v_mad_u32_u24 v120, v120, s23, v2
    s_mov_b32 s30, s26
    s_lshl1_add_u32 s25, s14, s25
    s_mul_i32 s14, s14, s23
    s_add_u32 s26, s26, s14
    v_and_b32 v112, 0xffff, v10
    v_lshrrev_b32 v114, 16, v10
    v_lshlrev_b32 v113, 16, v10
    v_and_b32 v10, 0xffff0000, v10
    v_mad_u32_u16 v8, v8, 8, s50 op_sel:[1,0,0,0]
    v_mad_u32_u16 v9, v9, 8, s50 op_sel:[1,0,0,0]
    s_waitcnt lgkmcnt(5)
    v_dot2_f32_bf16 v115, v64, v112, s16
    v_dot2_f32_bf16 v64, v64, v113, s16
    v_dot2_f32_bf16 v116, v65, v112, s16
    v_dot2_f32_bf16 v65, v65, v113, s16
    v_dot2_f32_bf16 v117, v66, v114, s16
    v_dot2_f32_bf16 v66, v66, v10, s16
    v_dot2_f32_bf16 v118, v67, v114, s16
    v_dot2_f32_bf16 v67, v67, v10, s16
    v_perm_b32 v64, v64, v115, s17
    v_perm_b32 v65, v65, v116, s17
    v_perm_b32 v66, v66, v117, s17
    v_perm_b32 v67, v67, v118, s17
    v_lshl_add_u64 v[64:65], v[64:65], 0, s[20:21]
    v_lshl_add_u64 v[66:67], v[66:67], 0, s[20:21]
    v_or3_b32 v4, v108, v109, v4
    v_or3_b32 v4, v110, v111, v4
    ds_add_rtn_u64 v[108:109], v8, v[64:65]
    ds_add_rtn_u64 v[110:111], v9, v[66:67]
    s_waitcnt lgkmcnt(2)
    v_mad_u32_u24 v120, v121, 12, v120
    buffer_load_dwordx3 v[8:10], v120, s[44:47], s30 offen offset:0
    s_waitcnt vmcnt(8)
    v_mad_u32_u16 v76, v20, 8, s18
    v_mad_u32_u16 v78, v21, 8, s18
    ds_read_b64 v[76:77], v76
    ds_read_b64 v[78:79], v78
    v_mbcnt_lo_u32_b32 v120, s32, 0
    v_mbcnt_hi_u32_b32 v120, s33, v120
    s_bcnt1_i32_b64 s14, s[32:33]
    v_lshl_add_u32 v121, v120, 1, s25
    ds_read_u16 v121, v121
    v_mad_u32_u24 v120, v120, s23, v2
    s_mov_b32 s32, s26
    s_lshl1_add_u32 s25, s14, s25
    s_mul_i32 s14, s14, s23
    s_add_u32 s26, s26, s14
    v_and_b32 v112, 0xffff, v14
    v_lshrrev_b32 v114, 16, v14
    v_lshlrev_b32 v113, 16, v14
    v_and_b32 v14, 0xffff0000, v14
    v_mad_u32_u16 v12, v12, 8, s50 op_sel:[1,0,0,0]
    v_mad_u32_u16 v13, v13, 8, s50 op_sel:[1,0,0,0]
    v_dot2_f32_bf16 v115, v68, v112, s16
    v_dot2_f32_bf16 v68, v68, v113, s16
    v_dot2_f32_bf16 v116, v69, v112, s16
    v_dot2_f32_bf16 v69, v69, v113, s16
    v_dot2_f32_bf16 v117, v70, v114, s16
    v_dot2_f32_bf16 v70, v70, v14, s16
    v_dot2_f32_bf16 v118, v71, v114, s16
    v_dot2_f32_bf16 v71, v71, v14, s16
    v_perm_b32 v68, v68, v115, s17
    v_perm_b32 v69, v69, v116, s17
    v_perm_b32 v70, v70, v117, s17
    v_perm_b32 v71, v71, v118, s17
    v_lshl_add_u64 v[68:69], v[68:69], 0, s[20:21]
    v_lshl_add_u64 v[70:71], v[70:71], 0, s[20:21]
    s_waitcnt lgkmcnt(3)
    v_or3_b32 v4, v108, v109, v4
    v_or3_b32 v4, v110, v111, v4
    ds_add_rtn_u64 v[108:109], v12, v[68:69]
    ds_add_rtn_u64 v[110:111], v13, v[70:71]
    s_waitcnt lgkmcnt(2)
    v_mad_u32_u24 v120, v121, 12, v120
    buffer_load_dwordx3 v[12:14], v120, s[44:47], s32 offen offset:768
    s_waitcnt vmcnt(8)
    v_mad_u32_u16 v80, v24, 8, s18
    v_mad_u32_u16 v82, v25, 8, s18
    ds_read_b64 v[80:81], v80
    ds_read_b64 v[82:83], v82
    s_waitcnt vmcnt(7)
    v_mad_u32_u16 v84, v28, 8, s18
    v_mad_u32_u16 v86, v29, 8, s18
    ds_read_b64 v[84:85], v84
    ds_read_b64 v[86:87], v86
    v_mbcnt_lo_u32_b32 v120, s34, 0
    v_mbcnt_hi_u32_b32 v120, s35, v120
    s_bcnt1_i32_b64 s14, s[34:35]
    v_lshl_add_u32 v121, v120, 1, s25
    ds_read_u16 v121, v121
    v_mad_u32_u24 v120, v120, s23, v2
    s_mov_b32 s34, s26
    s_lshl1_add_u32 s25, s14, s25
    s_mul_i32 s14, s14, s23
    s_add_u32 s26, s26, s14
    v_and_b32 v112, 0xffff, v18
    v_lshrrev_b32 v114, 16, v18
    v_lshlrev_b32 v113, 16, v18
    v_and_b32 v18, 0xffff0000, v18
    v_mad_u32_u16 v16, v16, 8, s50 op_sel:[1,0,0,0]
    v_mad_u32_u16 v17, v17, 8, s50 op_sel:[1,0,0,0]
    v_dot2_f32_bf16 v115, v72, v112, s16
    v_dot2_f32_bf16 v72, v72, v113, s16
    v_dot2_f32_bf16 v116, v73, v112, s16
    v_dot2_f32_bf16 v73, v73, v113, s16
    v_dot2_f32_bf16 v117, v74, v114, s16
    v_dot2_f32_bf16 v74, v74, v18, s16
    v_dot2_f32_bf16 v118, v75, v114, s16
    v_dot2_f32_bf16 v75, v75, v18, s16
    v_perm_b32 v72, v72, v115, s17
    v_perm_b32 v73, v73, v116, s17
    v_perm_b32 v74, v74, v117, s17
    v_perm_b32 v75, v75, v118, s17
    v_lshl_add_u64 v[72:73], v[72:73], 0, s[20:21]
    v_lshl_add_u64 v[74:75], v[74:75], 0, s[20:21]
    s_waitcnt lgkmcnt(5)
    v_or3_b32 v4, v108, v109, v4
    v_or3_b32 v4, v110, v111, v4
    ds_add_rtn_u64 v[108:109], v16, v[72:73]
    ds_add_rtn_u64 v[110:111], v17, v[74:75]
    s_waitcnt lgkmcnt(2)
    v_mad_u32_u24 v120, v121, 12, v120
    buffer_load_dwordx3 v[16:18], v120, s[44:47], s34 offen offset:1536
    s_barrier
    s_waitcnt vmcnt(3)
    ds_write_b128 v3, v[88:91] offset:0
    ds_write_b128 v3, v[92:95] offset:16384
    ds_write_b128 v3, v[96:99] offset:32768
    ds_write_b128 v3, v[100:103] offset:49152
    ds_write_b128 v124, v[104:107]
    v_mbcnt_lo_u32_b32 v120, s36, 0
    v_mbcnt_hi_u32_b32 v120, s37, v120
    s_bcnt1_i32_b64 s14, s[36:37]
    v_lshl_add_u32 v121, v120, 1, s25
    ds_read_u16 v121, v121
    v_mad_u32_u24 v120, v120, s23, v2
    s_mov_b32 s36, s26
    s_lshl1_add_u32 s25, s14, s25
    s_mul_i32 s14, s14, s23
    s_add_u32 s26, s26, s14
    v_and_b32 v112, 0xffff, v22
    v_lshrrev_b32 v114, 16, v22
    v_lshlrev_b32 v113, 16, v22
    v_and_b32 v22, 0xffff0000, v22
    v_mad_u32_u16 v20, v20, 8, s50 op_sel:[1,0,0,0]
    v_mad_u32_u16 v21, v21, 8, s50 op_sel:[1,0,0,0]
    v_dot2_f32_bf16 v115, v76, v112, s16
    v_dot2_f32_bf16 v76, v76, v113, s16
    v_dot2_f32_bf16 v116, v77, v112, s16
    v_dot2_f32_bf16 v77, v77, v113, s16
    v_dot2_f32_bf16 v117, v78, v114, s16
    v_dot2_f32_bf16 v78, v78, v22, s16
    v_dot2_f32_bf16 v118, v79, v114, s16
    v_dot2_f32_bf16 v79, v79, v22, s16
    v_perm_b32 v76, v76, v115, s17
    v_perm_b32 v77, v77, v116, s17
    v_perm_b32 v78, v78, v117, s17
    v_perm_b32 v79, v79, v118, s17
    v_lshl_add_u64 v[76:77], v[76:77], 0, s[20:21]
    v_lshl_add_u64 v[78:79], v[78:79], 0, s[20:21]
    s_waitcnt lgkmcnt(6)
    v_or3_b32 v4, v108, v109, v4
    v_or3_b32 v4, v110, v111, v4
    ds_add_rtn_u64 v[108:109], v20, v[76:77]
    ds_add_rtn_u64 v[110:111], v21, v[78:79]
    s_waitcnt lgkmcnt(2)
    v_mad_u32_u24 v120, v121, 12, v120
    buffer_load_dwordx3 v[20:22], v120, s[44:47], s36 offen offset:2304
    v_mbcnt_lo_u32_b32 v120, s38, 0
    v_mbcnt_hi_u32_b32 v120, s39, v120
    s_bcnt1_i32_b64 s14, s[38:39]
    v_lshl_add_u32 v121, v120, 1, s25
    ds_read_u16 v121, v121
    v_mad_u32_u24 v120, v120, s23, v2
    s_mov_b32 s38, s26
    s_lshl1_add_u32 s25, s14, s25
    s_mul_i32 s14, s14, s23
    s_add_u32 s26, s26, s14
    v_and_b32 v112, 0xffff, v26
    v_lshrrev_b32 v114, 16, v26
    v_lshlrev_b32 v113, 16, v26
    v_and_b32 v26, 0xffff0000, v26
    v_mad_u32_u16 v24, v24, 8, s50 op_sel:[1,0,0,0]
    v_mad_u32_u16 v25, v25, 8, s50 op_sel:[1,0,0,0]
    v_dot2_f32_bf16 v115, v80, v112, s16
    v_dot2_f32_bf16 v80, v80, v113, s16
    v_dot2_f32_bf16 v116, v81, v112, s16
    v_dot2_f32_bf16 v81, v81, v113, s16
    v_dot2_f32_bf16 v117, v82, v114, s16
    v_dot2_f32_bf16 v82, v82, v26, s16
    v_dot2_f32_bf16 v118, v83, v114, s16
    v_dot2_f32_bf16 v83, v83, v26, s16
    v_perm_b32 v80, v80, v115, s17
    v_perm_b32 v81, v81, v116, s17
    v_perm_b32 v82, v82, v117, s17
    v_perm_b32 v83, v83, v118, s17
    v_lshl_add_u64 v[80:81], v[80:81], 0, s[20:21]
    v_lshl_add_u64 v[82:83], v[82:83], 0, s[20:21]
    s_waitcnt lgkmcnt(1)
    v_or3_b32 v4, v108, v109, v4
    v_or3_b32 v4, v110, v111, v4
    ds_add_rtn_u64 v[108:109], v24, v[80:81]
    ds_add_rtn_u64 v[110:111], v25, v[82:83]
    s_waitcnt lgkmcnt(2)
    v_mad_u32_u24 v120, v121, 12, v120
    buffer_load_dwordx3 v[24:26], v120, s[44:47], s38 offen offset:3072
    v_mbcnt_lo_u32_b32 v120, s40, 0
    v_mbcnt_hi_u32_b32 v120, s41, v120
    s_bcnt1_i32_b64 s14, s[40:41]
    v_lshl_add_u32 v121, v120, 1, s25
    ds_read_u16 v121, v121
    v_mad_u32_u24 v120, v120, s23, v2
    s_mov_b32 s40, s26
    s_lshl1_add_u32 s25, s14, s25
    s_mul_i32 s14, s14, s23
    s_add_u32 s26, s26, s14
    v_and_b32 v112, 0xffff, v30
    v_lshrrev_b32 v114, 16, v30
    v_lshlrev_b32 v113, 16, v30
    v_and_b32 v30, 0xffff0000, v30
    v_mad_u32_u16 v28, v28, 8, s50 op_sel:[1,0,0,0]
    v_mad_u32_u16 v29, v29, 8, s50 op_sel:[1,0,0,0]
    v_dot2_f32_bf16 v115, v84, v112, s16
    v_dot2_f32_bf16 v84, v84, v113, s16
    v_dot2_f32_bf16 v116, v85, v112, s16
    v_dot2_f32_bf16 v85, v85, v113, s16
    v_dot2_f32_bf16 v117, v86, v114, s16
    v_dot2_f32_bf16 v86, v86, v30, s16
    v_dot2_f32_bf16 v118, v87, v114, s16
    v_dot2_f32_bf16 v87, v87, v30, s16
    v_perm_b32 v84, v84, v115, s17
    v_perm_b32 v85, v85, v116, s17
    v_perm_b32 v86, v86, v117, s17
    v_perm_b32 v87, v87, v118, s17
    v_lshl_add_u64 v[84:85], v[84:85], 0, s[20:21]
    v_lshl_add_u64 v[86:87], v[86:87], 0, s[20:21]
    s_waitcnt lgkmcnt(1)
    v_or3_b32 v4, v108, v109, v4
    v_or3_b32 v4, v110, v111, v4
    ds_add_rtn_u64 v[108:109], v28, v[84:85]
    ds_add_rtn_u64 v[110:111], v29, v[86:87]
    s_waitcnt lgkmcnt(2)
    v_mad_u32_u24 v120, v121, 12, v120
    buffer_load_dwordx3 v[28:30], v120, s[44:47], s40 offen offset:3840
    s_cmp_le_u32 s28, 384
    s_cbranch_scc1 L_p2_kernel_norare_5
    v_readlane_b32 s42, v7, 12
    v_readlane_b32 s43, v7, 13
    s_nop 1
    v_mbcnt_lo_u32_b32 v120, s42, 0
    v_mbcnt_hi_u32_b32 v120, s43, v120
    s_bcnt1_i32_b64 s14, s[42:43]
    v_lshl_add_u32 v121, v120, 1, s25
    ds_read_u16 v121, v121
    v_mad_u32_u24 v120, v120, s23, v2
    s_mov_b32 s42, s26
    s_lshl1_add_u32 s25, s14, s25
    s_mul_i32 s14, s14, s23
    s_add_u32 s26, s26, s14
    s_waitcnt lgkmcnt(0)
    s_add_u32 s42, s42, 4608
    v_mad_u32_u24 v120, v121, 12, v120
    buffer_load_dwordx3 v[32:34], v120, s[44:47], s42 offen offset:0
L_p2_kernel_norare_5:
    v_add_u32_sdwa v113, 1, v43 dst_sel:DWORD dst_unused:UNUSED_PAD src0_sel:DWORD src1_sel:WORD_1
    v_lshrrev_b32_sdwa v112, 1, v11 dst_sel:DWORD dst_unused:UNUSED_PAD src0_sel:DWORD src1_sel:WORD_1
    v_lshrrev_b32 v113, 1, v113
    v_sub_u32 v114, v113, v112
    v_add_u32 v113, 448, v113
    s_nop 0
    v_add_u32_dpp v114, v114, v114 row_shr:1 row_mask:0xf bank_mask:0xf bound_ctrl:0
    s_nop 1
    v_add_u32_dpp v114, v114, v114 row_shr:2 row_mask:0xf bank_mask:0xf bound_ctrl:0
    s_nop 1
    v_add_u32_dpp v114, v114, v114 row_shr:4 row_mask:0xf bank_mask:0xf bound_ctrl:0
    s_nop 1
    v_add_u32_dpp v114, v114, v114 row_shr:8 row_mask:0xf bank_mask:0xf bound_ctrl:0
    s_nop 1
    v_add_u32_dpp v114, v114, v114 row_bcast:15 row_mask:0xa bank_mask:0xf
    s_nop 1
    v_add_u32_dpp v114, v114, v114 row_bcast:31 row_mask:0xc bank_mask:0xf
    v_sub_u32 v113, v113, v114
    v_readlane_b32 s56, v114, 63
    v_add_u32 v114, -1, v114
    ds_write_b16 v126, v113
    v_lshlrev_b32_e64 v115, v114, 1
    v_lshrrev_b32 v114, 5, v114
    v_lshl_add_u32 v114, v114, 2, s19
    s_cmp_gt_u32 s56, 448
    s_cselect_b32 s2, 1, s2
    s_cselect_b64 exec, 0, -1
    ds_or_b32 v114, v115 offset:160
    s_mov_b64 exec, -1
    ds_wrxchg_rtn_b32 v7, v6, v5 offset:160
    s_add_u32 s14, s22, 80000
    buffer_load_dwordx4 v[88:91], v1, s[8:11], s14 offen
    s_add_u32 s14, s22, 96384
    buffer_load_dwordx4 v[92:95], v1, s[8:11], s14 offen
    s_add_u32 s14, s22, 112768
    buffer_load_dwordx4 v[96:99], v1, s[8:11], s14 offen
    s_add_u32 s24, s24, 1
    s_cmp_lt_u32 s24, 8
    s_barrier
    s_cbranch_scc1 L_p2_loop
    s_waitcnt lgkmcnt(3)
    v_or3_b32 v4, v108, v109, v4
    v_or3_b32 v4, v110, v111, v4
    s_waitcnt vmcnt(0) lgkmcnt(0)
    s_barrier
    v_subrev_u32 v112, 80000, v124
    ds_read_b128 v[88:91], v1 offset:0
    ds_read_b128 v[92:95], v1 offset:16384
    ds_read_b128 v[96:99], v1 offset:32768
    ds_read_b128 v[100:103], v1 offset:49152
    ds_read_b128 v[104:107], v112
    s_mul_i32 s14, s12, 5120000
    s_mul_i32 s15, s3, 80000
    s_add_u32 s26, s14, s15
    s_add_u32 s26, s26, 259973632
    s_waitcnt lgkmcnt(4)
    s_add_u32 s14, s26, 0
    buffer_store_dwordx4 v[88:91], v1, s[4:7], s14 offen
    v_or3_b32 v4, v88, v89, v4
    v_or3_b32 v4, v90, v91, v4
    s_waitcnt lgkmcnt(3)
    s_add_u32 s14, s26, 16384
    buffer_store_dwordx4 v[92:95], v1, s[4:7], s14 offen
    v_or3_b32 v4, v92, v93, v4
    v_or3_b32 v4, v94, v95, v4
    s_waitcnt lgkmcnt(2)
    s_add_u32 s14, s26, 32768
    buffer_store_dwordx4 v[96:99], v1, s[4:7], s14 offen
    v_or3_b32 v4, v96, v97, v4
    v_or3_b32 v4, v98, v99, v4
    s_waitcnt lgkmcnt(1)
    s_add_u32 s14, s26, 49152
    buffer_store_dwordx4 v[100:103], v1, s[4:7], s14 offen
    v_or3_b32 v4, v100, v101, v4
    v_or3_b32 v4, v102, v103, v4
    s_waitcnt lgkmcnt(0)
    buffer_store_dwordx4 v[104:107], v112, s[4:7], s26 offen
    v_or3_b32 v4, v104, v105, v4
    v_or3_b32 v4, v106, v107, v4
    v_and_b32 v4, 0x80008000, v4
    v_cmp_ne_u32 vcc, 0, v4
    v_mov_b32 v113, s19
    v_and_b32 v115, 15, v0
    v_mul_u32_u24 v115, 240, v115
    v_add_u32 v115, 160000, v115
    s_cmp_lg_u64 vcc, 0
    s_cselect_b32 s2, 1, s2
    v_mov_b32 v114, s2
    s_mov_b64 exec, 1
    ds_write_b32 v113, v114
    s_mov_b64 exec, -1
    s_waitcnt lgkmcnt(0)
    s_barrier
    ds_read_b32 v114, v115
    s_lshl_b32 s14, s3, 4
    s_lshl_b32 s15, s12, 2
    s_add_u32 s25, s14, s15
    s_add_u32 s25, s25, 254849536
    s_waitcnt lgkmcnt(0)
    v_cmp_ne_u32 vcc, 0, v114
    v_mov_b32 v113, 0
    s_nop 1
    s_cmp_lg_u64 vcc, 0
    s_cselect_b32 s14, 0, s48
    v_mov_b32 v114, s14
    s_mov_b64 exec, 1
    buffer_store_dword v114, v113, s[4:7], s25 offen
    s_mov_b64 exec, -1
    s_cbranch_scc0 L_p2_end
    s_barrier
    v_mov_b32 v8, 0
    v_mov_b32 v9, 0
    v_mov_b32 v10, 0
    v_mov_b32 v11, 0
    v_mov_b32 v12, v1
    ds_write_b128 v12, v[8:11]
    v_add_u32 v12, 16384, v12
    ds_write_b128 v12, v[8:11]
    v_add_u32 v12, 16384, v12
    ds_write_b128 v12, v[8:11]
    v_add_u32 v12, 16384, v12
    ds_write_b128 v12, v[8:11]
    v_add_u32 v12, 16384, v12
    ds_write_b128 v12, v[8:11]
    v_add_u32 v12, 16384, v12
    ds_write_b128 v12, v[8:11]
    v_add_u32 v12, 16384, v12
    ds_write_b128 v12, v[8:11]
    v_add_u32 v12, 16384, v12
    ds_write_b128 v12, v[8:11]
    v_add_u32 v12, 16384, v12
    ds_write_b128 v12, v[8:11]
    v_add_u32 v12, 16384, v12
    ds_write_b128 v12, v[8:11]
    v_add_u32 v12, 16384, v12
    v_lshlrev_b32 v13, 4, v0
    v_add_u32 v28, 32896, v13
    v_mul_lo_u32 v14, v0, s23
    v_add_u32 v14, 8192, v14
    s_mul_i32 s25, s12, 65
    s_add_u32 s25, s25, s3
    s_mul_i32 s25, s25, 32896
    s_add_u32 s25, s25, 246292480
    s_lshl_b32 s50, s50, 1
    s_mul_i32 s22, s12, 1280000
    s_mov_b32 s24, 0
    s_waitcnt lgkmcnt(0)
    s_barrier
L_p2_sstep:
    buffer_load_ushort v15, v13, s[4:7], s25 offen
    buffer_load_ushort v16, v28, s[4:7], s25 offen
    s_waitcnt vmcnt(0)
L_p2_srec:
    v_cmp_lt_u32 vcc, v15, v16
    s_nop 1
    s_and_b64 exec, exec, vcc
    s_cbranch_execz L_p2_sdone
    v_lshrrev_b32 v17, 1, v15
    v_and_b32 v18, 1, v15
    v_mad_u32_u24 v17, v17, 12, v14
    v_lshl_add_u32 v19, v18, 2, v17
    v_lshl_add_u32 v17, v18, 1, v17
    buffer_load_dword v20, v19, s[4:7], 0 offen
    buffer_load_ushort v21, v17, s[4:7], 0 offen offset:8
    v_add_u32 v15, 1, v15
    s_waitcnt vmcnt(0)
    v_lshlrev_b32_sdwa v19, 3, v20 dst_sel:DWORD dst_unused:UNUSED_PAD src0_sel:DWORD src1_sel:WORD_0
    buffer_load_dwordx2 v[22:23], v19, s[8:11], s22 offen
    v_mad_u32_u16 v20, v20, 16, s50 op_sel:[1,0,0,0]
    v_lshlrev_b32 v21, 16, v21
    s_waitcnt vmcnt(0)
    v_lshlrev_b32 v24, 16, v22
    v_and_b32 v25, 0xffff0000, v22
    v_lshlrev_b32 v26, 16, v23
    v_and_b32 v27, 0xffff0000, v23
    v_mul_f32 v24, v21, v24
    v_mul_f32 v25, v21, v25
    v_mul_f32 v26, v21, v26
    v_mul_f32 v27, v21, v27
    ds_add_f32 v20, v24
    ds_add_f32 v20, v25 offset:4
    ds_add_f32 v20, v26 offset:8
    ds_add_f32 v20, v27 offset:12
    s_branch L_p2_srec
L_p2_sdone:
    s_mov_b64 exec, -1
    s_cmp_eq_u32 s24, 7
    s_cselect_b32 s14, 16370, 2
    s_add_u32 s25, s25, s14
    s_add_u32 s22, s22, 80000
    s_add_u32 s24, s24, 1
    s_cmp_lt_u32 s24, 16
    s_cbranch_scc1 L_p2_sstep
    s_waitcnt lgkmcnt(0)
    s_barrier
    s_mul_i32 s14, s12, 10240000
    s_mul_i32 s15, s3, 160000
    s_add_u32 s26, s14, s15
    s_add_u32 s26, s26, 280453632
    v_mov_b32 v12, v1
    s_mov_b32 s24, 0
L_p2_sout:
    v_cmp_gt_u32 vcc, 160000, v12
    ds_read_b128 v[8:11], v12
    s_nop 0
    s_and_b64 exec, exec, vcc
    s_cbranch_execz L_p2_end
    s_waitcnt lgkmcnt(0)
    buffer_store_dwordx4 v[8:11], v12, s[4:7], s26 offen
    s_waitcnt vmcnt(0)
    v_add_u32 v12, 16384, v12
    s_branch L_p2_sout
L_p2_end:
    s_endpgm
.globl p3_kernel
.p2align 8
.type p3_kernel,@function
p3_kernel:
    s_cmp_ge_u32 s2, 1250
    s_cbranch_scc1 L_p3_end
    s_load_dwordx2 s[4:5], s[0:1], 104
    s_load_dwordx2 s[8:9], s[0:1], 0
    s_load_dwordx2 s[12:13], s[0:1], 24
    s_load_dwordx2 s[16:17], s[0:1], 88
    s_load_dwordx2 s[20:21], s[0:1], 40
    s_load_dwordx4 s[24:27], s[0:1], 56
    s_load_dwordx4 s[28:31], s[0:1], 72
    s_lshl_b32 s3, s2, 8
    v_add_u32 v0, s3, v0
    v_lshlrev_b32 v1, 4, v0
    v_lshlrev_b32 v2, 2, v0
    v_mul_hi_u32_u24 v3, 858994, v0
    v_lshlrev_b32 v3, 4, v3
    s_waitcnt lgkmcnt(0)
    s_mov_b32 s6, 655360000
    s_mov_b32 s7, 0x00020000
    s_mov_b32 s10, 5120000
    s_mov_b32 s11, 0x00020000
    s_mov_b32 s14, 1280000
    s_mov_b32 s15, 0x00020000
    s_mov_b32 s18, 5120000
    s_mov_b32 s19, 0x00020000
    s_load_dwordx4 s[72:75], s[20:21], 0
    s_load_dwordx16 s[32:47], s[24:25], 0
    s_load_dwordx16 s[48:63], s[26:27], 0
    s_load_dwordx8 s[64:71], s[28:29], 0
    s_load_dwordx8 s[80:87], s[30:31], 0
    buffer_load_dword v4, v2, s[12:15], 0 offen
    s_mov_b32 s3, 254849536
    buffer_load_dwordx4 v[8:11], v3, s[4:7], s3 offen
    s_mov_b32 s3, 259973632
    buffer_load_dwordx4 v[12:15], v1, s[4:7], s3 offen
    s_mov_b32 s3, 265093632
    buffer_load_dwordx4 v[16:19], v1, s[4:7], s3 offen
    s_mov_b32 s3, 270213632
    buffer_load_dwordx4 v[20:23], v1, s[4:7], s3 offen
    s_mov_b32 s3, 275333632
    buffer_load_dwordx4 v[24:27], v1, s[4:7], s3 offen
    buffer_load_dwordx4 v[28:31], v1, s[8:11], 0 offen
    s_waitcnt lgkmcnt(0)
    s_pack_ll_b32_b16 s20, s32, s34
    s_pack_hh_b32_b16 s21, s32, s34
    s_pack_ll_b32_b16 s22, s33, s35
    s_pack_hh_b32_b16 s35, s33, s35
    s_mov_b32 s32, s20
    s_mov_b32 s33, s21
    s_mov_b32 s34, s22
    s_pack_ll_b32_b16 s20, s36, s38
    s_pack_hh_b32_b16 s21, s36, s38
    s_pack_ll_b32_b16 s22, s37, s39
    s_pack_hh_b32_b16 s39, s37, s39
    s_mov_b32 s36, s20
    s_mov_b32 s37, s21
    s_mov_b32 s38, s22
    s_pack_ll_b32_b16 s20, s40, s42
    s_pack_hh_b32_b16 s21, s40, s42
    s_pack_ll_b32_b16 s22, s41, s43
    s_pack_hh_b32_b16 s43, s41, s43
    s_mov_b32 s40, s20
    s_mov_b32 s41, s21
    s_mov_b32 s42, s22
    s_pack_ll_b32_b16 s20, s44, s46
    s_pack_hh_b32_b16 s21, s44, s46
    s_pack_ll_b32_b16 s22, s45, s47
    s_pack_hh_b32_b16 s47, s45, s47
    s_mov_b32 s44, s20
    s_mov_b32 s45, s21
    s_mov_b32 s46, s22
    s_pack_ll_b32_b16 s20, s48, s50
    s_pack_hh_b32_b16 s21, s48, s50
    s_pack_ll_b32_b16 s22, s49, s51
    s_pack_hh_b32_b16 s51, s49, s51
    s_mov_b32 s48, s20
    s_mov_b32 s49, s21
    s_mov_b32 s50, s22
    s_pack_ll_b32_b16 s20, s52, s54
    s_pack_hh_b32_b16 s21, s52, s54
    s_pack_ll_b32_b16 s22, s53, s55
    s_pack_hh_b32_b16 s55, s53, s55
    s_mov_b32 s52, s20
    s_mov_b32 s53, s21
    s_mov_b32 s54, s22
    s_pack_ll_b32_b16 s20, s56, s58
    s_pack_hh_b32_b16 s21, s56, s58
    s_pack_ll_b32_b16 s22, s57, s59
    s_pack_hh_b32_b16 s59, s57, s59
    s_mov_b32 s56, s20
    s_mov_b32 s57, s21
    s_mov_b32 s58, s22
    s_pack_ll_b32_b16 s20, s60, s62
    s_pack_hh_b32_b16 s21, s60, s62
    s_pack_ll_b32_b16 s22, s61, s63
    s_pack_hh_b32_b16 s63, s61, s63
    s_mov_b32 s60, s20
    s_mov_b32 s61, s21
    s_mov_b32 s62, s22
    s_lshl_b32 s20, s72, 16
    s_and_b32 s21, s72, 0xffff0000
    s_lshl_b32 s22, s73, 16
    s_and_b32 s23, s73, 0xffff0000
    s_lshl_b32 s24, s74, 16
    s_and_b32 s25, s74, 0xffff0000
    s_lshl_b32 s26, s75, 16
    s_and_b32 s27, s75, 0xffff0000
    s_and_b32 s79, s71, 0xffff0000
    s_lshl_b32 s78, s71, 16
    s_and_b32 s77, s70, 0xffff0000
    s_lshl_b32 s76, s70, 16
    s_and_b32 s75, s69, 0xffff0000
    s_lshl_b32 s74, s69, 16
    s_and_b32 s73, s68, 0xffff0000
    s_lshl_b32 s72, s68, 16
    s_and_b32 s71, s67, 0xffff0000
    s_lshl_b32 s70, s67, 16
    s_and_b32 s69, s66, 0xffff0000
    s_lshl_b32 s68, s66, 16
    s_and_b32 s67, s65, 0xffff0000
    s_lshl_b32 s66, s65, 16
    s_and_b32 s65, s64, 0xffff0000
    s_lshl_b32 s64, s64, 16
    s_and_b32 s95, s87, 0xffff0000
    s_lshl_b32 s94, s87, 16
    s_and_b32 s93, s86, 0xffff0000
    s_lshl_b32 s92, s86, 16
    s_and_b32 s91, s85, 0xffff0000
    s_lshl_b32 s90, s85, 16
    s_and_b32 s89, s84, 0xffff0000
    s_lshl_b32 s88, s84, 16
    s_and_b32 s87, s83, 0xffff0000
    s_lshl_b32 s86, s83, 16
    s_and_b32 s85, s82, 0xffff0000
    s_lshl_b32 s84, s82, 16
    s_and_b32 s83, s81, 0xffff0000
    s_lshl_b32 s82, s81, 16
    s_and_b32 s81, s80, 0xffff0000
    s_lshl_b32 s80, s80, 16
    s_waitcnt vmcnt(6)
    v_and_b32 v5, 0xffff0000, v4
    v_lshlrev_b32 v4, 16, v4
    v_subrev_f32 v32, s20, v4
    v_subrev_f32 v33, s21, v4
    v_subrev_f32 v34, s22, v4
    v_subrev_f32 v35, s23, v4
    v_subrev_f32 v36, s24, v4
    v_subrev_f32 v37, s25, v4
    v_subrev_f32 v38, s26, v4
    v_subrev_f32 v39, s27, v4
    v_cvt_pk_bf16_f32 v6, v32, v33
    v_lshlrev_b32 v32, 16, v6
    v_and_b32 v33, 0xffff0000, v6
    v_cvt_pk_bf16_f32 v6, v34, v35
    v_lshlrev_b32 v34, 16, v6
    v_and_b32 v35, 0xffff0000, v6
    v_cvt_pk_bf16_f32 v6, v36, v37
    v_lshlrev_b32 v36, 16, v6
    v_and_b32 v37, 0xffff0000, v6
    v_cvt_pk_bf16_f32 v6, v38, v39
    v_lshlrev_b32 v38, 16, v6
    v_and_b32 v39, 0xffff0000, v6
    v_mul_f32 v32, v32, v32
    v_mul_f32 v33, v33, v33
    v_mul_f32 v34, v34, v34
    v_mul_f32 v35, v35, v35
    v_mul_f32 v36, v36, v36
    v_mul_f32 v37, v37, v37
    v_mul_f32 v38, v38, v38
    v_mul_f32 v39, v39, v39
    v_cvt_pk_bf16_f32 v6, v32, v33
    v_lshlrev_b32 v32, 16, v6
    v_and_b32 v33, 0xffff0000, v6
    v_cvt_pk_bf16_f32 v6, v34, v35
    v_lshlrev_b32 v34, 16, v6
    v_and_b32 v35, 0xffff0000, v6
    v_cvt_pk_bf16_f32 v6, v36, v37
    v_lshlrev_b32 v36, 16, v6
    v_and_b32 v37, 0xffff0000, v6
    v_cvt_pk_bf16_f32 v6, v38, v39
    v_lshlrev_b32 v38, 16, v6
    v_and_b32 v39, 0xffff0000, v6
    v_mul_f32 v32, 0xc1200000, v32
    v_mul_f32 v33, 0xc1200000, v33
    v_mul_f32 v34, 0xc1200000, v34
    v_mul_f32 v35, 0xc1200000, v35
    v_mul_f32 v36, 0xc1200000, v36
    v_mul_f32 v37, 0xc1200000, v37
    v_mul_f32 v38, 0xc1200000, v38
    v_mul_f32 v39, 0xc1200000, v39
    v_cvt_pk_bf16_f32 v6, v32, v33
    v_lshlrev_b32 v32, 16, v6
    v_and_b32 v33, 0xffff0000, v6
    v_cvt_pk_bf16_f32 v6, v34, v35
    v_lshlrev_b32 v34, 16, v6
    v_and_b32 v35, 0xffff0000, v6
    v_cvt_pk_bf16_f32 v6, v36, v37
    v_lshlrev_b32 v36, 16, v6
    v_and_b32 v37, 0xffff0000, v6
    v_cvt_pk_bf16_f32 v6, v38, v39
    v_lshlrev_b32 v38, 16, v6
    v_and_b32 v39, 0xffff0000, v6
    v_mul_f32 v32, 0x3fb8aa3b, v32
    v_mul_f32 v33, 0x3fb8aa3b, v33
    v_mul_f32 v34, 0x3fb8aa3b, v34
    v_mul_f32 v35, 0x3fb8aa3b, v35
    v_mul_f32 v36, 0x3fb8aa3b, v36
    v_mul_f32 v37, 0x3fb8aa3b, v37
    v_mul_f32 v38, 0x3fb8aa3b, v38
    v_mul_f32 v39, 0x3fb8aa3b, v39
    v_exp_f32 v32, v32
    v_exp_f32 v33, v33
    v_exp_f32 v34, v34
    v_exp_f32 v35, v35
    v_exp_f32 v36, v36
    v_exp_f32 v37, v37
    v_exp_f32 v38, v38
    v_exp_f32 v39, v39
    v_cvt_pk_bf16_f32 v40, v32, v33
    v_cvt_pk_bf16_f32 v41, v34, v35
    v_cvt_pk_bf16_f32 v42, v36, v37
    v_cvt_pk_bf16_f32 v43, v38, v39
    v_dot2_f32_bf16 v44, v40, s32, 0
    v_dot2_f32_bf16 v45, v40, s33, 0
    v_dot2_f32_bf16 v46, v40, s34, 0
    v_dot2_f32_bf16 v47, v40, s35, 0
    v_dot2_f32_bf16 v48, v40, s48, 0
    v_dot2_f32_bf16 v49, v40, s49, 0
    v_dot2_f32_bf16 v50, v40, s50, 0
    v_dot2_f32_bf16 v51, v40, s51, 0
    v_dot2_f32_bf16 v44, v41, s36, v44
    v_dot2_f32_bf16 v45, v41, s37, v45
    v_dot2_f32_bf16 v46, v41, s38, v46
    v_dot2_f32_bf16 v47, v41, s39, v47
    v_dot2_f32_bf16 v48, v41, s52, v48
    v_dot2_f32_bf16 v49, v41, s53, v49
    v_dot2_f32_bf16 v50, v41, s54, v50
    v_dot2_f32_bf16 v51, v41, s55, v51
    v_dot2_f32_bf16 v44, v42, s40, v44
    v_dot2_f32_bf16 v45, v42, s41, v45
    v_dot2_f32_bf16 v46, v42, s42, v46
    v_dot2_f32_bf16 v47, v42, s43, v47
    v_dot2_f32_bf16 v48, v42, s56, v48
    v_dot2_f32_bf16 v49, v42, s57, v49
    v_dot2_f32_bf16 v50, v42, s58, v50
    v_dot2_f32_bf16 v51, v42, s59, v51
    v_dot2_f32_bf16 v44, v43, s44, v44
    v_dot2_f32_bf16 v45, v43, s45, v45
    v_dot2_f32_bf16 v46, v43, s46, v46
    v_dot2_f32_bf16 v47, v43, s47, v47
    v_dot2_f32_bf16 v48, v43, s60, v48
    v_dot2_f32_bf16 v49, v43, s61, v49
    v_dot2_f32_bf16 v50, v43, s62, v50
    v_dot2_f32_bf16 v51, v43, s63, v51
    v_subrev_f32 v32, s20, v5
    v_subrev_f32 v33, s21, v5
    v_subrev_f32 v34, s22, v5
    v_subrev_f32 v35, s23, v5
    v_subrev_f32 v36, s24, v5
    v_subrev_f32 v37, s25, v5
    v_subrev_f32 v38, s26, v5
    v_subrev_f32 v39, s27, v5
    v_cvt_pk_bf16_f32 v6, v32, v33
    v_lshlrev_b32 v32, 16, v6
    v_and_b32 v33, 0xffff0000, v6
    v_cvt_pk_bf16_f32 v6, v34, v35
    v_lshlrev_b32 v34, 16, v6
    v_and_b32 v35, 0xffff0000, v6
    v_cvt_pk_bf16_f32 v6, v36, v37
    v_lshlrev_b32 v36, 16, v6
    v_and_b32 v37, 0xffff0000, v6
    v_cvt_pk_bf16_f32 v6, v38, v39
    v_lshlrev_b32 v38, 16, v6
    v_and_b32 v39, 0xffff0000, v6
    v_mul_f32 v32, v32, v32
    v_mul_f32 v33, v33, v33
    v_mul_f32 v34, v34, v34
    v_mul_f32 v35, v35, v35
    v_mul_f32 v36, v36, v36
    v_mul_f32 v37, v37, v37
    v_mul_f32 v38, v38, v38
    v_mul_f32 v39, v39, v39
    v_cvt_pk_bf16_f32 v6, v32, v33
    v_lshlrev_b32 v32, 16, v6
    v_and_b32 v33, 0xffff0000, v6
    v_cvt_pk_bf16_f32 v6, v34, v35
    v_lshlrev_b32 v34, 16, v6
    v_and_b32 v35, 0xffff0000, v6
    v_cvt_pk_bf16_f32 v6, v36, v37
    v_lshlrev_b32 v36, 16, v6
    v_and_b32 v37, 0xffff0000, v6
    v_cvt_pk_bf16_f32 v6, v38, v39
    v_lshlrev_b32 v38, 16, v6
    v_and_b32 v39, 0xffff0000, v6
    v_mul_f32 v32, 0xc1200000, v32
    v_mul_f32 v33, 0xc1200000, v33
    v_mul_f32 v34, 0xc1200000, v34
    v_mul_f32 v35, 0xc1200000, v35
    v_mul_f32 v36, 0xc1200000, v36
    v_mul_f32 v37, 0xc1200000, v37
    v_mul_f32 v38, 0xc1200000, v38
    v_mul_f32 v39, 0xc1200000, v39
    v_cvt_pk_bf16_f32 v6, v32, v33
    v_lshlrev_b32 v32, 16, v6
    v_and_b32 v33, 0xffff0000, v6
    v_cvt_pk_bf16_f32 v6, v34, v35
    v_lshlrev_b32 v34, 16, v6
    v_and_b32 v35, 0xffff0000, v6
    v_cvt_pk_bf16_f32 v6, v36, v37
    v_lshlrev_b32 v36, 16, v6
    v_and_b32 v37, 0xffff0000, v6
    v_cvt_pk_bf16_f32 v6, v38, v39
    v_lshlrev_b32 v38, 16, v6
    v_and_b32 v39, 0xffff0000, v6
    v_mul_f32 v32, 0x3fb8aa3b, v32
    v_mul_f32 v33, 0x3fb8aa3b, v33
    v_mul_f32 v34, 0x3fb8aa3b, v34
    v_mul_f32 v35, 0x3fb8aa3b, v35
    v_mul_f32 v36, 0x3fb8aa3b, v36
    v_mul_f32 v37, 0x3fb8aa3b, v37
    v_mul_f32 v38, 0x3fb8aa3b, v38
    v_mul_f32 v39, 0x3fb8aa3b, v39
    v_exp_f32 v32, v32
    v_exp_f32 v33, v33
    v_exp_f32 v34, v34
    v_exp_f32 v35, v35
    v_exp_f32 v36, v36
    v_exp_f32 v37, v37
    v_exp_f32 v38, v38
    v_exp_f32 v39, v39
    v_cvt_pk_bf16_f32 v40, v32, v33
    v_cvt_pk_bf16_f32 v41, v34, v35
    v_cvt_pk_bf16_f32 v42, v36, v37
    v_cvt_pk_bf16_f32 v43, v38, v39
    v_dot2_f32_bf16 v52, v40, s32, 0
    v_dot2_f32_bf16 v53, v40, s33, 0
    v_dot2_f32_bf16 v54, v40, s34, 0
    v_dot2_f32_bf16 v55, v40, s35, 0
    v_dot2_f32_bf16 v56, v40, s48, 0
    v_dot2_f32_bf16 v57, v40, s49, 0
    v_dot2_f32_bf16 v58, v40, s50, 0
    v_dot2_f32_bf16 v59, v40, s51, 0
    v_dot2_f32_bf16 v52, v41, s36, v52
    v_dot2_f32_bf16 v53, v41, s37, v53
    v_dot2_f32_bf16 v54, v41, s38, v54
    v_dot2_f32_bf16 v55, v41, s39, v55
    v_dot2_f32_bf16 v56, v41, s52, v56
    v_dot2_f32_bf16 v57, v41, s53, v57
    v_dot2_f32_bf16 v58, v41, s54, v58
    v_dot2_f32_bf16 v59, v41, s55, v59
    v_dot2_f32_bf16 v52, v42, s40, v52
    v_dot2_f32_bf16 v53, v42, s41, v53
    v_dot2_f32_bf16 v54, v42, s42, v54
    v_dot2_f32_bf16 v55, v42, s43, v55
    v_dot2_f32_bf16 v56, v42, s56, v56
    v_dot2_f32_bf16 v57, v42, s57, v57
    v_dot2_f32_bf16 v58, v42, s58, v58
    v_dot2_f32_bf16 v59, v42, s59, v59
    v_dot2_f32_bf16 v52, v43, s44, v52
    v_dot2_f32_bf16 v53, v43, s45, v53
    v_dot2_f32_bf16 v54, v43, s46, v54
    v_dot2_f32_bf16 v55, v43, s47, v55
    v_dot2_f32_bf16 v56, v43, s60, v56
    v_dot2_f32_bf16 v57, v43, s61, v57
    v_dot2_f32_bf16 v58, v43, s62, v58
    v_dot2_f32_bf16 v59, v43, s63, v59
    s_waitcnt vmcnt(1)
    v_cvt_f32_u32_sdwa v40, v12 dst_sel:DWORD dst_unused:UNUSED_PAD src0_sel:WORD_0
    v_add_f32 v40, 3330277376, v40
    v_mul_f32 v32, v8, v40
    v_cvt_f32_u32_sdwa v41, v12 dst_sel:DWORD dst_unused:UNUSED_PAD src0_sel:WORD_1
    v_add_f32 v41, 3330277376, v41
    v_mul_f32 v33, v8, v41
    v_cvt_f32_u32_sdwa v42, v13 dst_sel:DWORD dst_unused:UNUSED_PAD src0_sel:WORD_0
    v_add_f32 v42, 3330277376, v42
    v_mul_f32 v34, v8, v42
    v_cvt_f32_u32_sdwa v43, v13 dst_sel:DWORD dst_unused:UNUSED_PAD src0_sel:WORD_1
    v_add_f32 v43, 3330277376, v43
    v_mul_f32 v35, v8, v43
    v_cvt_f32_u32_sdwa v40, v14 dst_sel:DWORD dst_unused:UNUSED_PAD src0_sel:WORD_0
    v_add_f32 v40, 3330277376, v40
    v_mul_f32 v36, v8, v40
    v_cvt_f32_u32_sdwa v41, v14 dst_sel:DWORD dst_unused:UNUSED_PAD src0_sel:WORD_1
    v_add_f32 v41, 3330277376, v41
    v_mul_f32 v37, v8, v41
    v_cvt_f32_u32_sdwa v42, v15 dst_sel:DWORD dst_unused:UNUSED_PAD src0_sel:WORD_0
    v_add_f32 v42, 3330277376, v42
    v_mul_f32 v38, v8, v42
    v_cvt_f32_u32_sdwa v43, v15 dst_sel:DWORD dst_unused:UNUSED_PAD src0_sel:WORD_1
    v_add_f32 v43, 3330277376, v43
    v_mul_f32 v39, v8, v43
    v_cvt_f32_u32_sdwa v40, v16 dst_sel:DWORD dst_unused:UNUSED_PAD src0_sel:WORD_0
    v_add_f32 v40, 3330277376, v40
    v_fmac_f32 v32, v9, v40
    v_cvt_f32_u32_sdwa v41, v16 dst_sel:DWORD dst_unused:UNUSED_PAD src0_sel:WORD_1
    v_add_f32 v41, 3330277376, v41
    v_fmac_f32 v33, v9, v41
    v_cvt_f32_u32_sdwa v42, v17 dst_sel:DWORD dst_unused:UNUSED_PAD src0_sel:WORD_0
    v_add_f32 v42, 3330277376, v42
    v_fmac_f32 v34, v9, v42
    v_cvt_f32_u32_sdwa v43, v17 dst_sel:DWORD dst_unused:UNUSED_PAD src0_sel:WORD_1
    v_add_f32 v43, 3330277376, v43
    v_fmac_f32 v35, v9, v43
    v_cvt_f32_u32_sdwa v40, v18 dst_sel:DWORD dst_unused:UNUSED_PAD src0_sel:WORD_0
    v_add_f32 v40, 3330277376, v40
    v_fmac_f32 v36, v9, v40
    v_cvt_f32_u32_sdwa v41, v18 dst_sel:DWORD dst_unused:UNUSED_PAD src0_sel:WORD_1
    v_add_f32 v41, 3330277376, v41
    v_fmac_f32 v37, v9, v41
    v_cvt_f32_u32_sdwa v42, v19 dst_sel:DWORD dst_unused:UNUSED_PAD src0_sel:WORD_0
    v_add_f32 v42, 3330277376, v42
    v_fmac_f32 v38, v9, v42
    v_cvt_f32_u32_sdwa v43, v19 dst_sel:DWORD dst_unused:UNUSED_PAD src0_sel:WORD_1
    v_add_f32 v43, 3330277376, v43
    v_fmac_f32 v39, v9, v43
    v_cvt_f32_u32_sdwa v40, v20 dst_sel:DWORD dst_unused:UNUSED_PAD src0_sel:WORD_0
    v_add_f32 v40, 3330277376, v40
    v_fmac_f32 v32, v10, v40
    v_cvt_f32_u32_sdwa v41, v20 dst_sel:DWORD dst_unused:UNUSED_PAD src0_sel:WORD_1
    v_add_f32 v41, 3330277376, v41
    v_fmac_f32 v33, v10, v41
    v_cvt_f32_u32_sdwa v42, v21 dst_sel:DWORD dst_unused:UNUSED_PAD src0_sel:WORD_0
    v_add_f32 v42, 3330277376, v42
    v_fmac_f32 v34, v10, v42
    v_cvt_f32_u32_sdwa v43, v21 dst_sel:DWORD dst_unused:UNUSED_PAD src0_sel:WORD_1
    v_add_f32 v43, 3330277376, v43
    v_fmac_f32 v35, v10, v43
    v_cvt_f32_u32_sdwa v40, v22 dst_sel:DWORD dst_unused:UNUSED_PAD src0_sel:WORD_0
    v_add_f32 v40, 3330277376, v40
    v_fmac_f32 v36, v10, v40
    v_cvt_f32_u32_sdwa v41, v22 dst_sel:DWORD dst_unused:UNUSED_PAD src0_sel:WORD_1
    v_add_f32 v41, 3330277376, v41
    v_fmac_f32 v37, v10, v41
    v_cvt_f32_u32_sdwa v42, v23 dst_sel:DWORD dst_unused:UNUSED_PAD src0_sel:WORD_0
    v_add_f32 v42, 3330277376, v42
    v_fmac_f32 v38, v10, v42
    v_cvt_f32_u32_sdwa v43, v23 dst_sel:DWORD dst_unused:UNUSED_PAD src0_sel:WORD_1
    v_add_f32 v43, 3330277376, v43
    v_fmac_f32 v39, v10, v43
    v_cvt_f32_u32_sdwa v40, v24 dst_sel:DWORD dst_unused:UNUSED_PAD src0_sel:WORD_0
    v_add_f32 v40, 3330277376, v40
    v_fmac_f32 v32, v11, v40
    v_cvt_f32_u32_sdwa v41, v24 dst_sel:DWORD dst_unused:UNUSED_PAD src0_sel:WORD_1
    v_add_f32 v41, 3330277376, v41
    v_fmac_f32 v33, v11, v41
    v_cvt_f32_u32_sdwa v42, v25 dst_sel:DWORD dst_unused:UNUSED_PAD src0_sel:WORD_0
    v_add_f32 v42, 3330277376, v42
    v_fmac_f32 v34, v11, v42
    v_cvt_f32_u32_sdwa v43, v25 dst_sel:DWORD dst_unused:UNUSED_PAD src0_sel:WORD_1
    v_add_f32 v43, 3330277376, v43
    v_fmac_f32 v35, v11, v43
    v_cvt_f32_u32_sdwa v40, v26 dst_sel:DWORD dst_unused:UNUSED_PAD src0_sel:WORD_0
    v_add_f32 v40, 3330277376, v40
    v_fmac_f32 v36, v11, v40
    v_cvt_f32_u32_sdwa v41, v26 dst_sel:DWORD dst_unused:UNUSED_PAD src0_sel:WORD_1
    v_add_f32 v41, 3330277376, v41
    v_fmac_f32 v37, v11, v41
    v_cvt_f32_u32_sdwa v42, v27 dst_sel:DWORD dst_unused:UNUSED_PAD src0_sel:WORD_0
    v_add_f32 v42, 3330277376, v42
    v_fmac_f32 v38, v11, v42
    v_cvt_f32_u32_sdwa v43, v27 dst_sel:DWORD dst_unused:UNUSED_PAD src0_sel:WORD_1
    v_add_f32 v43, 3330277376, v43
    v_fmac_f32 v39, v11, v43
    v_min_u32 v6, v8, v9
    v_min3_u32 v6, v6, v10, v11
    v_cmp_eq_u32 vcc, 0, v6
    s_nop 1
    s_cbranch_vccz L_p3_fast
    v_lshlrev_b32 v7, 5, v0
    v_cmp_eq_u32 vcc, 0, v8
    s_nop 1
    s_and_b64 exec, exec, vcc
    s_cbranch_execz L_p3_kernel_q_1
    s_mov_b32 s3, 280453632
    buffer_load_dwordx4 v[12:15], v7, s[4:7], s3 offen
    buffer_load_dwordx4 v[16:19], v7, s[4:7], s3 offen offset:16
    s_waitcnt vmcnt(0)
    v_add_f32 v32, v32, v12
    v_add_f32 v33, v33, v13
    v_add_f32 v34, v34, v14
    v_add_f32 v35, v35, v15
    v_add_f32 v36, v36, v16
    v_add_f32 v37, v37, v17
    v_add_f32 v38, v38, v18
    v_add_f32 v39, v39, v19
L_p3_kernel_q_1:
    s_mov_b64 exec, -1
    v_cmp_eq_u32 vcc, 0, v9
    s_nop 1
    s_and_b64 exec, exec, vcc
    s_cbranch_execz L_p3_kernel_q_2
    s_mov_b32 s3, 290693632
    buffer_load_dwordx4 v[12:15], v7, s[4:7], s3 offen
    buffer_load_dwordx4 v[16:19], v7, s[4:7], s3 offen offset:16
    s_waitcnt vmcnt(0)
    v_add_f32 v32, v32, v12
    v_add_f32 v33, v33, v13
    v_add_f32 v34, v34, v14
    v_add_f32 v35, v35, v15
    v_add_f32 v36, v36, v16
    v_add_f32 v37, v37, v17
    v_add_f32 v38, v38, v18
    v_add_f32 v39, v39, v19
L_p3_kernel_q_2:
    s_mov_b64 exec, -1
    v_cmp_eq_u32 vcc, 0, v10
    s_nop 1
    s_and_b64 exec, exec, vcc
    s_cbranch_execz L_p3_kernel_q_3
    s_mov_b32 s3, 300933632
    buffer_load_dwordx4 v[12:15], v7, s[4:7], s3 offen
    buffer_load_dwordx4 v[16:19], v7, s[4:7], s3 offen offset:16
    s_waitcnt vmcnt(0)
    v_add_f32 v32, v32, v12
    v_add_f32 v33, v33, v13
    v_add_f32 v34, v34, v14
    v_add_f32 v35, v35, v15
    v_add_f32 v36, v36, v16
    v_add_f32 v37, v37, v17
    v_add_f32 v38, v38, v18
    v_add_f32 v39, v39, v19
L_p3_kernel_q_3:
    s_mov_b64 exec, -1
    v_cmp_eq_u32 vcc, 0, v11
    s_nop 1
    s_and_b64 exec, exec, vcc
    s_cbranch_execz L_p3_kernel_q_4
    s_mov_b32 s3, 311173632
    buffer_load_dwordx4 v[12:15], v7, s[4:7], s3 offen
    buffer_load_dwordx4 v[16:19], v7, s[4:7], s3 offen offset:16
    s_waitcnt vmcnt(0)
    v_add_f32 v32, v32, v12
    v_add_f32 v33, v33, v13
    v_add_f32 v34, v34, v14
    v_add_f32 v35, v35, v15
    v_add_f32 v36, v36, v16
    v_add_f32 v37, v37, v17
    v_add_f32 v38, v38, v18
    v_add_f32 v39, v39, v19
L_p3_kernel_q_4:
    s_mov_b64 exec, -1
L_p3_fast:
    s_waitcnt vmcnt(0)
    v_mul_f32 v12, s64, v32
    v_mul_f32 v13, s65, v32
    v_mul_f32 v14, s66, v32
    v_mul_f32 v15, s67, v32
    v_fmac_f32 v12, s68, v33
    v_fmac_f32 v13, s69, v33
    v_fmac_f32 v14, s70, v33
    v_fmac_f32 v15, s71, v33
    v_fmac_f32 v12, s72, v34
    v_fmac_f32 v13, s73, v34
    v_fmac_f32 v14, s74, v34
    v_fmac_f32 v15, s75, v34
    v_fmac_f32 v12, s76, v35
    v_fmac_f32 v13, s77, v35
    v_fmac_f32 v14, s78, v35
    v_fmac_f32 v15, s79, v35
    v_mul_f32 v12, v12, v48
    v_mul_f32 v13, v13, v49
    v_mul_f32 v14, v14, v50
    v_mul_f32 v15, v15, v51
    v_mul_f32 v16, s80, v12
    v_mul_f32 v17, s81, v12
    v_mul_f32 v18, s82, v12
    v_mul_f32 v19, s83, v12
    v_fmac_f32 v16, s84, v13
    v_fmac_f32 v17, s85, v13
    v_fmac_f32 v18, s86, v13
    v_fmac_f32 v19, s87, v13
    v_fmac_f32 v16, s88, v14
    v_fmac_f32 v17, s89, v14
    v_fmac_f32 v18, s90, v14
    v_fmac_f32 v19, s91, v14
    v_fmac_f32 v16, s92, v15
    v_fmac_f32 v17, s93, v15
    v_fmac_f32 v18, s94, v15
    v_fmac_f32 v19, s95, v15
    v_lshlrev_b32 v20, 16, v28
    v_and_b32 v21, 0xffff0000, v28
    v_lshlrev_b32 v22, 16, v29
    v_and_b32 v23, 0xffff0000, v29
    v_fmac_f32 v20, v16, v44
    v_fmac_f32 v21, v17, v45
    v_fmac_f32 v22, v18, v46
    v_fmac_f32 v23, v19, v47
    v_cvt_pk_bf16_f32 v28, v20, v21
    v_cvt_pk_bf16_f32 v29, v22, v23
    v_mul_f32 v12, s64, v36
    v_mul_f32 v13, s65, v36
    v_mul_f32 v14, s66, v36
    v_mul_f32 v15, s67, v36
    v_fmac_f32 v12, s68, v37
    v_fmac_f32 v13, s69, v37
    v_fmac_f32 v14, s70, v37
    v_fmac_f32 v15, s71, v37
    v_fmac_f32 v12, s72, v38
    v_fmac_f32 v13, s73, v38
    v_fmac_f32 v14, s74, v38
    v_fmac_f32 v15, s75, v38
    v_fmac_f32 v12, s76, v39
    v_fmac_f32 v13, s77, v39
    v_fmac_f32 v14, s78, v39
    v_fmac_f32 v15, s79, v39
    v_mul_f32 v12, v12, v56
    v_mul_f32 v13, v13, v57
    v_mul_f32 v14, v14, v58
    v_mul_f32 v15, v15, v59
    v_mul_f32 v16, s80, v12
    v_mul_f32 v17, s81, v12
    v_mul_f32 v18, s82, v12
    v_mul_f32 v19, s83, v12
    v_fmac_f32 v16, s84, v13
    v_fmac_f32 v17, s85, v13
    v_fmac_f32 v18, s86, v13
    v_fmac_f32 v19, s87, v13
    v_fmac_f32 v16, s88, v14
    v_fmac_f32 v17, s89, v14
    v_fmac_f32 v18, s90, v14
    v_fmac_f32 v19, s91, v14
    v_fmac_f32 v16, s92, v15
    v_fmac_f32 v17, s93, v15
    v_fmac_f32 v18, s94, v15
    v_fmac_f32 v19, s95, v15
    v_lshlrev_b32 v20, 16, v30
    v_and_b32 v21, 0xffff0000, v30
    v_lshlrev_b32 v22, 16, v31
    v_and_b32 v23, 0xffff0000, v31
    v_fmac_f32 v20, v16, v52
    v_fmac_f32 v21, v17, v53
    v_fmac_f32 v22, v18, v54
    v_fmac_f32 v23, v19, v55
    v_cvt_pk_bf16_f32 v30, v20, v21
    v_cvt_pk_bf16_f32 v31, v22, v23
    buffer_store_dwordx4 v[28:31], v1, s[16:19], 0 offen
L_p3_end:
    s_endpgm
.section .rodata,"a"
.p2align 6
.amdhsa_kernel p1_kernel
  .amdhsa_next_free_vgpr 128
  .amdhsa_next_free_sgpr 96
  .amdhsa_accum_offset 128
  .amdhsa_group_segment_fixed_size 0
  .amdhsa_kernarg_size 112
  .amdhsa_user_sgpr_count 2
  .amdhsa_user_sgpr_kernarg_segment_ptr 1
  .amdhsa_system_sgpr_workgroup_id_x 1
  .amdhsa_float_denorm_mode_32 0
.end_amdhsa_kernel
.p2align 6
.amdhsa_kernel p2_kernel
  .amdhsa_next_free_vgpr 128
  .amdhsa_next_free_sgpr 102
  .amdhsa_accum_offset 128
  .amdhsa_group_segment_fixed_size 0
  .amdhsa_kernarg_size 112
  .amdhsa_user_sgpr_count 2
  .amdhsa_user_sgpr_kernarg_segment_ptr 1
  .amdhsa_system_sgpr_workgroup_id_x 1
  .amdhsa_float_denorm_mode_32 0
.end_amdhsa_kernel
.p2align 6
.amdhsa_kernel p3_kernel
  .amdhsa_next_free_vgpr 64
  .amdhsa_next_free_sgpr 102
  .amdhsa_accum_offset 64
  .amdhsa_group_segment_fixed_size 0
  .amdhsa_kernarg_size 112
  .amdhsa_user_sgpr_count 2
  .amdhsa_user_sgpr_kernarg_segment_ptr 1
  .amdhsa_system_sgpr_workgroup_id_x 1
  .amdhsa_float_denorm_mode_32 0
.end_amdhsa_kernel
```

```asm
; @launch kernel=p1_kernel grid=(256,1,1) block=(1024,1,1) lds=163840
; @launch kernel=p2_kernel grid=(256,1,1) block=(1024,1,1) lds=163840
.amdgcn_target "amdgcn-amd-amdhsa--gfx950"
.text
.globl p1_kernel
.p2align 8
.type p1_kernel,@function
p1_kernel:
    s_cmp_ge_u32 s2, 256
    s_cbranch_scc1 L_p1_end
    s_load_dwordx2 s[4:5], s[0:1], 104
    s_load_dwordx2 s[8:9], s[0:1], 8
    s_load_dwordx2 s[12:13], s[0:1], 16
    s_load_dwordx2 s[16:17], s[0:1], 32
    s_load_dwordx2 s[28:29], s[0:1], 0
    s_load_dwordx2 s[6:7], s[0:1], 48
    v_lshlrev_b32 v1, 4, v0
    v_lshlrev_b32 v2, 3, v0
    v_lshrrev_b32 v6, 6, v0
    v_mul_u32_u24 v3, 1216, v6
    v_add_u32 v3, v3, v0
    v_mul_u32_u24 v3, 12, v3
    v_mov_b32 v4, 1
    v_mov_b32 v5, 0
    v_readfirstlane_b32 s39, v6
    v_cmp_gt_u32 vcc, 784, v0
    s_mov_b32 s32, s2
    s_lshl_b32 s33, s2, 14
    s_lshl_b32 s34, s2, 13
    s_mul_i32 s48, s2, 3840
    s_mul_i32 s49, s2, 1920
    s_mov_b64 s[44:45], vcc
    s_waitcnt lgkmcnt(0)
    s_load_dword s3, s[6:7], 0
    s_mov_b32 s10, 163840000
    s_mov_b32 s11, 0x00020000
    s_mov_b32 s14, 163840000
    s_mov_b32 s15, 0x00020000
    s_mov_b32 s18, 81920000
    s_mov_b32 s19, 0x00020000
    s_mul_i32 s36, s2, 20000
    s_add_u32 s30, s36, 20000
    s_mov_b32 s31, 0x00020000
    s_add_u32 s35, s36, 16384
    buffer_load_dwordx4 v[48:51], v1, s[28:31], s36 offen nt
    buffer_load_dwordx4 v[52:55], v1, s[28:31], s35 offen nt
    s_add_u32 s35, s33, 0
    buffer_load_dwordx4 v[16:19], v1, s[8:11], s35 offen nt
    s_add_u32 s35, s33, 0
    buffer_load_dwordx4 v[20:23], v1, s[12:15], s35 offen nt
    s_add_u32 s35, s33, 4194304
    buffer_load_dwordx4 v[24:27], v1, s[8:11], s35 offen nt
    s_add_u32 s35, s33, 4194304
    buffer_load_dwordx4 v[28:31], v1, s[12:15], s35 offen nt
    s_add_u32 s35, s33, 8388608
    buffer_load_dwordx4 v[32:35], v1, s[8:11], s35 offen nt
    s_add_u32 s35, s33, 8388608
    buffer_load_dwordx4 v[36:39], v1, s[12:15], s35 offen nt
    s_add_u32 s35, s33, 12582912
    buffer_load_dwordx4 v[40:43], v1, s[8:11], s35 offen nt
    s_add_u32 s35, s33, 12582912
    buffer_load_dwordx4 v[44:47], v1, s[12:15], s35 offen nt
    s_mov_b32 s20, s4
    s_mov_b32 s21, s5
    s_mov_b32 s22, 0
    s_mov_b32 s23, 0x00020000
    s_add_u32 s24, s4, 246292480
    s_addc_u32 s25, s5, 0
    s_mov_b32 s26, 8577536
    s_mov_b32 s27, 0x00020000
    s_mov_b32 s37, 1492179184
    s_mov_b32 s55, 0
    s_mov_b32 s38, 262400
    s_mov_b32 s43, 0x05040100
    s_mov_b32 s40, 0
    v_mov_b32 v8, 0
    v_mov_b32 v9, 0
    v_mov_b32 v10, 0
    v_mov_b32 v11, 0
    ds_write_b128 v1, v[8:11] offset:0
    s_waitcnt lgkmcnt(0)
    s_lshl_b32 s3, s3, 16
    v_mov_b32 v12, s3
    v_mul_f32 v12, 0.15915494, v12
    s_nop 0
    v_readfirstlane_b32 s41, v12
    s_waitcnt vmcnt(8)
    s_add_u32 s28, s4, 254870016
    s_addc_u32 s29, s5, 0
    s_mul_i32 s36, s2, 20000
    s_add_u32 s35, s36, 16384
    buffer_store_dwordx4 v[48:51], v1, s[28:31], s36 offen
    buffer_store_dwordx4 v[52:55], v1, s[28:31], s35 offen
    s_nop 0
    v_mov_b32 v12, 0x3f803f80
    v_and_b32 v48, 0x7fff7fff, v48
    v_and_b32 v49, 0x7fff7fff, v49
    v_and_b32 v50, 0x7fff7fff, v50
    v_and_b32 v51, 0x7fff7fff, v51
    v_and_b32 v52, 0x7fff7fff, v52
    v_and_b32 v53, 0x7fff7fff, v53
    v_and_b32 v54, 0x7fff7fff, v54
    v_and_b32 v55, 0x7fff7fff, v55
    v_pk_max_u16 v8, v8, v48
    v_dot2c_f32_bf16 v9, v48, v12
    v_pk_max_u16 v8, v8, v49
    v_dot2c_f32_bf16 v9, v49, v12
    v_pk_max_u16 v8, v8, v50
    v_dot2c_f32_bf16 v9, v50, v12
    v_pk_max_u16 v8, v8, v51
    v_dot2c_f32_bf16 v9, v51, v12
    v_pk_max_u16 v8, v8, v52
    v_dot2c_f32_bf16 v9, v52, v12
    v_pk_max_u16 v8, v8, v53
    v_dot2c_f32_bf16 v9, v53, v12
    v_pk_max_u16 v8, v8, v54
    v_dot2c_f32_bf16 v9, v54, v12
    v_pk_max_u16 v8, v8, v55
    v_dot2c_f32_bf16 v9, v55, v12
    v_lshrrev_b32 v10, 16, v8
    v_and_b32 v8, 0xffff, v8
    v_max_u32 v8, v8, v10
    s_nop 0
    s_nop 1
    v_max_u32_dpp v8, v8, v8 row_shr:1 row_mask:0xf bank_mask:0xf bound_ctrl:0
    s_nop 1
    v_max_u32_dpp v8, v8, v8 row_shr:2 row_mask:0xf bank_mask:0xf bound_ctrl:0
    s_nop 1
    v_max_u32_dpp v8, v8, v8 row_shr:4 row_mask:0xf bank_mask:0xf bound_ctrl:0
    s_nop 1
    v_max_u32_dpp v8, v8, v8 row_shr:8 row_mask:0xf bank_mask:0xf bound_ctrl:0
    s_nop 1
    v_max_u32_dpp v8, v8, v8 row_bcast:15 row_mask:0xa bank_mask:0xf
    s_nop 1
    v_max_u32_dpp v8, v8, v8 row_bcast:31 row_mask:0xc bank_mask:0xf
    s_nop 1
    v_add_f32_dpp v9, v9, v9 row_shr:1 row_mask:0xf bank_mask:0xf bound_ctrl:0
    s_nop 1
    v_add_f32_dpp v9, v9, v9 row_shr:2 row_mask:0xf bank_mask:0xf bound_ctrl:0
    s_nop 1
    v_add_f32_dpp v9, v9, v9 row_shr:4 row_mask:0xf bank_mask:0xf bound_ctrl:0
    s_nop 1
    v_add_f32_dpp v9, v9, v9 row_shr:8 row_mask:0xf bank_mask:0xf bound_ctrl:0
    s_nop 1
    v_add_f32_dpp v9, v9, v9 row_bcast:15 row_mask:0xa bank_mask:0xf
    s_nop 1
    v_add_f32_dpp v9, v9, v9 row_bcast:31 row_mask:0xc bank_mask:0xf
    s_lshl_b32 s35, s39, 4
    s_add_u32 s35, s35, 160320
    v_mov_b32 v10, s35
    s_mov_b32 exec_lo, 0
    s_brev_b32 exec_hi, 1
    ds_write_b64 v10, v[8:9]
    s_mov_b64 exec, -1
    s_waitcnt lgkmcnt(0)
    s_barrier
    s_branch L_p1_first
L_p1_loop:
    s_mov_b32 s36, 6144
    buffer_store_dwordx3 v[80:82], v3, s[20:23], s36 offen sc1
    s_mov_b32 s36, 6912
    buffer_store_dwordx3 v[84:86], v3, s[20:23], s36 offen sc1
    s_nop 0
    s_add_u32 s35, s33, 16777216
    buffer_load_dwordx4 v[80:83], v1, s[8:11], s35 offen nt
    s_add_u32 s35, s33, 16777216
    buffer_load_dwordx4 v[84:87], v1, s[12:15], s35 offen nt
    s_mov_b32 s36, 7680
    buffer_store_dwordx3 v[88:90], v3, s[20:23], s36 offen sc1
    s_mov_b32 s36, 8448
    buffer_store_dwordx3 v[92:94], v3, s[20:23], s36 offen sc1
    s_nop 0
    s_add_u32 s35, s33, 20971520
    buffer_load_dwordx4 v[88:91], v1, s[8:11], s35 offen nt
    s_add_u32 s35, s33, 20971520
    buffer_load_dwordx4 v[92:95], v1, s[12:15], s35 offen nt
    s_mov_b32 s36, 9216
    buffer_store_dwordx3 v[96:98], v3, s[20:23], s36 offen sc1
    s_mov_b32 s36, 9984
    buffer_store_dwordx3 v[100:102], v3, s[20:23], s36 offen sc1
    s_nop 0
    s_add_u32 s35, s33, 25165824
    buffer_load_dwordx4 v[96:99], v1, s[8:11], s35 offen nt
    s_add_u32 s35, s33, 25165824
    buffer_load_dwordx4 v[100:103], v1, s[12:15], s35 offen nt
    s_mov_b32 s36, 10752
    buffer_store_dwordx3 v[104:106], v3, s[20:23], s36 offen sc1
    s_mov_b32 s36, 11520
    buffer_store_dwordx3 v[108:110], v3, s[20:23], s36 offen sc1
    s_nop 0
    s_add_u32 s35, s33, 29360128
    buffer_load_dwordx4 v[104:107], v1, s[8:11], s35 offen nt
    s_add_u32 s35, s33, 29360128
    buffer_load_dwordx4 v[108:111], v1, s[12:15], s35 offen nt
    s_mov_b32 s36, 12288
    buffer_store_dwordx3 v[112:114], v3, s[20:23], s36 offen sc1
    s_mov_b32 s36, 13056
    buffer_store_dwordx3 v[116:118], v3, s[20:23], s36 offen sc1
    s_nop 0
    s_add_u32 s35, s33, 33554432
    buffer_load_dwordx4 v[112:115], v1, s[8:11], s35 offen nt
    s_add_u32 s35, s33, 33554432
    buffer_load_dwordx4 v[116:119], v1, s[12:15], s35 offen nt
    s_mov_b32 s36, 13824
    buffer_store_dwordx3 v[120:122], v3, s[20:23], s36 offen sc1
    s_mov_b32 s36, 14592
    buffer_store_dwordx3 v[124:126], v3, s[20:23], s36 offen sc1
    s_nop 0
    s_add_u32 s35, s33, 37748736
    s_sub_u32 s35, s35, s48
    v_cndmask_b32 v120, 2.0, v1, s[44:45]
    buffer_load_dwordx4 v[120:123], v120, s[8:11], s35 offen nt
    s_add_u32 s35, s33, 37748736
    s_sub_u32 s35, s35, s48
    v_cndmask_b32 v124, 2.0, v1, s[44:45]
    buffer_load_dwordx4 v[124:127], v124, s[12:15], s35 offen nt
    s_mov_b32 s36, 0
    buffer_store_dwordx3 v[48:50], v3, s[20:23], s36 offen sc1
    s_mov_b32 s36, 768
    buffer_store_dwordx3 v[52:54], v3, s[20:23], s36 offen sc1
    s_mov_b32 s36, 1536
    buffer_store_dwordx3 v[56:58], v3, s[20:23], s36 offen sc1
    s_mov_b32 s36, 2304
    buffer_store_dwordx3 v[60:62], v3, s[20:23], s36 offen sc1
    s_mov_b32 s36, 3072
    buffer_store_dwordx3 v[64:66], v3, s[20:23], s36 offen sc1
    s_mov_b32 s36, 3840
    buffer_store_dwordx3 v[68:70], v3, s[20:23], s36 offen sc1
    s_mov_b32 s36, 4608
    buffer_store_dwordx3 v[72:74], v3, s[20:23], s36 offen sc1
    s_mov_b32 s36, 5376
    buffer_store_dwordx3 v[76:78], v3, s[20:23], s36 offen sc1
    s_branch L_p1_join
L_p1_first:
    s_add_u32 s35, s33, 16777216
    buffer_load_dwordx4 v[80:83], v1, s[8:11], s35 offen nt
    s_add_u32 s35, s33, 16777216
    buffer_load_dwordx4 v[84:87], v1, s[12:15], s35 offen nt
    s_add_u32 s35, s33, 20971520
    buffer_load_dwordx4 v[88:91], v1, s[8:11], s35 offen nt
    s_add_u32 s35, s33, 20971520
    buffer_load_dwordx4 v[92:95], v1, s[12:15], s35 offen nt
    s_add_u32 s35, s33, 25165824
    buffer_load_dwordx4 v[96:99], v1, s[8:11], s35 offen nt
    s_add_u32 s35, s33, 25165824
    buffer_load_dwordx4 v[100:103], v1, s[12:15], s35 offen nt
    s_add_u32 s35, s33, 29360128
    buffer_load_dwordx4 v[104:107], v1, s[8:11], s35 offen nt
    s_add_u32 s35, s33, 29360128
    buffer_load_dwordx4 v[108:111], v1, s[12:15], s35 offen nt
    s_add_u32 s35, s33, 33554432
    buffer_load_dwordx4 v[112:115], v1, s[8:11], s35 offen nt
    s_add_u32 s35, s33, 33554432
    buffer_load_dwordx4 v[116:119], v1, s[12:15], s35 offen nt
    s_add_u32 s35, s33, 37748736
    s_sub_u32 s35, s35, s48
    v_cndmask_b32 v120, 2.0, v1, s[44:45]
    buffer_load_dwordx4 v[120:123], v120, s[8:11], s35 offen nt
    s_add_u32 s35, s33, 37748736
    s_sub_u32 s35, s35, s48
    v_cndmask_b32 v124, 2.0, v1, s[44:45]
    buffer_load_dwordx4 v[124:127], v124, s[12:15], s35 offen nt
L_p1_join:
    s_waitcnt vmcnt(18)
    v_perm_b32 v6, v20, v16, s43
    v_perm_b32 v7, v21, v17, s43
    v_perm_b32 v8, v22, v18, s43
    v_perm_b32 v9, v23, v19, s43
    v_mul_hi_u32_u24 v16, 429497, v16
    v_mul_hi_u32_u24 v20, 429497, v20
    v_mul_hi_u32_u24 v17, 429497, v17
    v_mul_hi_u32_u24 v21, 429497, v21
    v_mul_hi_u32_u24 v18, 429497, v18
    v_mul_hi_u32_u24 v22, 429497, v22
    v_mul_hi_u32_u24 v19, 429497, v19
    v_mul_hi_u32_u24 v23, 429497, v23
    v_lshl_or_b32 v16, v20, 16, v16
    v_lshl_or_b32 v17, v21, 16, v17
    v_lshl_or_b32 v18, v22, 16, v18
    v_lshl_or_b32 v19, v23, 16, v19
    v_dot2_u32_u16 v20, v16, s38, 0
    v_dot2_u32_u16 v21, v17, s38, 0
    v_dot2_u32_u16 v22, v18, s38, 0
    v_dot2_u32_u16 v23, v19, s38, 0
    v_pk_mad_u16 v6, v16, s37, v6
    v_pk_mad_u16 v7, v17, s37, v7
    v_pk_mad_u16 v8, v18, s37, v8
    v_pk_mad_u16 v9, v19, s37, v9
    ds_add_u32 v20, v4 offset:0
    ds_add_u32 v21, v4 offset:0
    ds_add_u32 v22, v4 offset:0
    ds_add_u32 v23, v4 offset:0
    v_perm_b32 v55, v23, v22, s43
    v_perm_b32 v54, v21, v20, s43
    v_or_b32 v48, 0x40000000, v6
    v_or_b32 v49, 0x40000000, v7
    v_or_b32 v52, 0x40000000, v8
    v_or_b32 v53, 0x40000000, v9
    s_waitcnt vmcnt(16)
    v_perm_b32 v6, v28, v24, s43
    v_perm_b32 v7, v29, v25, s43
    v_perm_b32 v8, v30, v26, s43
    v_perm_b32 v9, v31, v27, s43
    v_mul_hi_u32_u24 v24, 429497, v24
    v_mul_hi_u32_u24 v28, 429497, v28
    v_mul_hi_u32_u24 v25, 429497, v25
    v_mul_hi_u32_u24 v29, 429497, v29
    v_mul_hi_u32_u24 v26, 429497, v26
    v_mul_hi_u32_u24 v30, 429497, v30
    v_mul_hi_u32_u24 v27, 429497, v27
    v_mul_hi_u32_u24 v31, 429497, v31
    v_lshl_or_b32 v24, v28, 16, v24
    v_lshl_or_b32 v25, v29, 16, v25
    v_lshl_or_b32 v26, v30, 16, v26
    v_lshl_or_b32 v27, v31, 16, v27
    v_dot2_u32_u16 v28, v24, s38, 0
    v_dot2_u32_u16 v29, v25, s38, 0
    v_dot2_u32_u16 v30, v26, s38, 0
    v_dot2_u32_u16 v31, v27, s38, 0
    v_pk_mad_u16 v6, v24, s37, v6
    v_pk_mad_u16 v7, v25, s37, v7
    v_pk_mad_u16 v8, v26, s37, v8
    v_pk_mad_u16 v9, v27, s37, v9
    ds_add_u32 v28, v4 offset:0
    ds_add_u32 v29, v4 offset:0
    ds_add_u32 v30, v4 offset:0
    ds_add_u32 v31, v4 offset:0
    v_perm_b32 v63, v31, v30, s43
    v_perm_b32 v62, v29, v28, s43
    v_or_b32 v56, 0x40000000, v6
    v_or_b32 v57, 0x40000000, v7
    v_or_b32 v60, 0x40000000, v8
    v_or_b32 v61, 0x40000000, v9
    s_waitcnt vmcnt(14)
    v_perm_b32 v6, v36, v32, s43
    v_perm_b32 v7, v37, v33, s43
    v_perm_b32 v8, v38, v34, s43
    v_perm_b32 v9, v39, v35, s43
    v_mul_hi_u32_u24 v32, 429497, v32
    v_mul_hi_u32_u24 v36, 429497, v36
    v_mul_hi_u32_u24 v33, 429497, v33
    v_mul_hi_u32_u24 v37, 429497, v37
    v_mul_hi_u32_u24 v34, 429497, v34
    v_mul_hi_u32_u24 v38, 429497, v38
    v_mul_hi_u32_u24 v35, 429497, v35
    v_mul_hi_u32_u24 v39, 429497, v39
    v_lshl_or_b32 v32, v36, 16, v32
    v_lshl_or_b32 v33, v37, 16, v33
    v_lshl_or_b32 v34, v38, 16, v34
    v_lshl_or_b32 v35, v39, 16, v35
    v_dot2_u32_u16 v36, v32, s38, 0
    v_dot2_u32_u16 v37, v33, s38, 0
    v_dot2_u32_u16 v38, v34, s38, 0
    v_dot2_u32_u16 v39, v35, s38, 0
    v_pk_mad_u16 v6, v32, s37, v6
    v_pk_mad_u16 v7, v33, s37, v7
    v_pk_mad_u16 v8, v34, s37, v8
    v_pk_mad_u16 v9, v35, s37, v9
    ds_add_u32 v36, v4 offset:0
    ds_add_u32 v37, v4 offset:0
    ds_add_u32 v38, v4 offset:0
    ds_add_u32 v39, v4 offset:0
    v_perm_b32 v71, v39, v38, s43
    v_perm_b32 v70, v37, v36, s43
    v_or_b32 v64, 0x40000000, v6
    v_or_b32 v65, 0x40000000, v7
    v_or_b32 v68, 0x40000000, v8
    v_or_b32 v69, 0x40000000, v9
    s_waitcnt vmcnt(12)
    v_perm_b32 v6, v44, v40, s43
    v_perm_b32 v7, v45, v41, s43
    v_perm_b32 v8, v46, v42, s43
    v_perm_b32 v9, v47, v43, s43
    v_mul_hi_u32_u24 v40, 429497, v40
    v_mul_hi_u32_u24 v44, 429497, v44
    v_mul_hi_u32_u24 v41, 429497, v41
    v_mul_hi_u32_u24 v45, 429497, v45
    v_mul_hi_u32_u24 v42, 429497, v42
    v_mul_hi_u32_u24 v46, 429497, v46
    v_mul_hi_u32_u24 v43, 429497, v43
    v_mul_hi_u32_u24 v47, 429497, v47
    v_lshl_or_b32 v40, v44, 16, v40
    v_lshl_or_b32 v41, v45, 16, v41
    v_lshl_or_b32 v42, v46, 16, v42
    v_lshl_or_b32 v43, v47, 16, v43
    v_dot2_u32_u16 v44, v40, s38, 0
    v_dot2_u32_u16 v45, v41, s38, 0
    v_dot2_u32_u16 v46, v42, s38, 0
    v_dot2_u32_u16 v47, v43, s38, 0
    v_pk_mad_u16 v6, v40, s37, v6
    v_pk_mad_u16 v7, v41, s37, v7
    v_pk_mad_u16 v8, v42, s37, v8
    v_pk_mad_u16 v9, v43, s37, v9
    ds_add_u32 v44, v4 offset:0
    ds_add_u32 v45, v4 offset:0
    ds_add_u32 v46, v4 offset:0
    ds_add_u32 v47, v4 offset:0
    v_perm_b32 v79, v47, v46, s43
    v_perm_b32 v78, v45, v44, s43
    v_or_b32 v72, 0x40000000, v6
    v_or_b32 v73, 0x40000000, v7
    v_or_b32 v76, 0x40000000, v8
    v_or_b32 v77, 0x40000000, v9
    s_waitcnt vmcnt(10)
    v_perm_b32 v6, v84, v80, s43
    v_perm_b32 v7, v85, v81, s43
    v_perm_b32 v8, v86, v82, s43
    v_perm_b32 v9, v87, v83, s43
    v_mul_hi_u32_u24 v80, 429497, v80
    v_mul_hi_u32_u24 v84, 429497, v84
    v_mul_hi_u32_u24 v81, 429497, v81
    v_mul_hi_u32_u24 v85, 429497, v85
    v_mul_hi_u32_u24 v82, 429497, v82
    v_mul_hi_u32_u24 v86, 429497, v86
    v_mul_hi_u32_u24 v83, 429497, v83
    v_mul_hi_u32_u24 v87, 429497, v87
    v_lshl_or_b32 v80, v84, 16, v80
    v_lshl_or_b32 v81, v85, 16, v81
    v_lshl_or_b32 v82, v86, 16, v82
    v_lshl_or_b32 v83, v87, 16, v83
    v_dot2_u32_u16 v84, v80, s38, 0
    v_dot2_u32_u16 v85, v81, s38, 0
    v_dot2_u32_u16 v86, v82, s38, 0
    v_dot2_u32_u16 v87, v83, s38, 0
    v_pk_mad_u16 v6, v80, s37, v6
    v_pk_mad_u16 v7, v81, s37, v7
    v_pk_mad_u16 v8, v82, s37, v8
    v_pk_mad_u16 v9, v83, s37, v9
    ds_add_u32 v84, v4 offset:0
    ds_add_u32 v85, v4 offset:0
    ds_add_u32 v86, v4 offset:0
    ds_add_u32 v87, v4 offset:0
    v_perm_b32 v87, v87, v86, s43
    v_perm_b32 v86, v85, v84, s43
    v_or_b32 v80, 0x40000000, v6
    v_or_b32 v81, 0x40000000, v7
    v_or_b32 v84, 0x40000000, v8
    v_or_b32 v85, 0x40000000, v9
    s_waitcnt vmcnt(8)
    v_perm_b32 v6, v92, v88, s43
    v_perm_b32 v7, v93, v89, s43
    v_perm_b32 v8, v94, v90, s43
    v_perm_b32 v9, v95, v91, s43
    v_mul_hi_u32_u24 v88, 429497, v88
    v_mul_hi_u32_u24 v92, 429497, v92
    v_mul_hi_u32_u24 v89, 429497, v89
    v_mul_hi_u32_u24 v93, 429497, v93
    v_mul_hi_u32_u24 v90, 429497, v90
    v_mul_hi_u32_u24 v94, 429497, v94
    v_mul_hi_u32_u24 v91, 429497, v91
    v_mul_hi_u32_u24 v95, 429497, v95
    v_lshl_or_b32 v88, v92, 16, v88
    v_lshl_or_b32 v89, v93, 16, v89
    v_lshl_or_b32 v90, v94, 16, v90
    v_lshl_or_b32 v91, v95, 16, v91
    v_dot2_u32_u16 v92, v88, s38, 0
    v_dot2_u32_u16 v93, v89, s38, 0
    v_dot2_u32_u16 v94, v90, s38, 0
    v_dot2_u32_u16 v95, v91, s38, 0
    v_pk_mad_u16 v6, v88, s37, v6
    v_pk_mad_u16 v7, v89, s37, v7
    v_pk_mad_u16 v8, v90, s37, v8
    v_pk_mad_u16 v9, v91, s37, v9
    ds_add_u32 v92, v4 offset:0
    ds_add_u32 v93, v4 offset:0
    ds_add_u32 v94, v4 offset:0
    ds_add_u32 v95, v4 offset:0
    v_perm_b32 v95, v95, v94, s43
    v_perm_b32 v94, v93, v92, s43
    v_or_b32 v88, 0x40000000, v6
    v_or_b32 v89, 0x40000000, v7
    v_or_b32 v92, 0x40000000, v8
    v_or_b32 v93, 0x40000000, v9
    s_waitcnt vmcnt(6)
    v_perm_b32 v6, v100, v96, s43
    v_perm_b32 v7, v101, v97, s43
    v_perm_b32 v8, v102, v98, s43
    v_perm_b32 v9, v103, v99, s43
    v_mul_hi_u32_u24 v96, 429497, v96
    v_mul_hi_u32_u24 v100, 429497, v100
    v_mul_hi_u32_u24 v97, 429497, v97
    v_mul_hi_u32_u24 v101, 429497, v101
    v_mul_hi_u32_u24 v98, 429497, v98
    v_mul_hi_u32_u24 v102, 429497, v102
    v_mul_hi_u32_u24 v99, 429497, v99
    v_mul_hi_u32_u24 v103, 429497, v103
    v_lshl_or_b32 v96, v100, 16, v96
    v_lshl_or_b32 v97, v101, 16, v97
    v_lshl_or_b32 v98, v102, 16, v98
    v_lshl_or_b32 v99, v103, 16, v99
    v_dot2_u32_u16 v100, v96, s38, 0
    v_dot2_u32_u16 v101, v97, s38, 0
    v_dot2_u32_u16 v102, v98, s38, 0
    v_dot2_u32_u16 v103, v99, s38, 0
    v_pk_mad_u16 v6, v96, s37, v6
    v_pk_mad_u16 v7, v97, s37, v7
    v_pk_mad_u16 v8, v98, s37, v8
    v_pk_mad_u16 v9, v99, s37, v9
    ds_add_u32 v100, v4 offset:0
    ds_add_u32 v101, v4 offset:0
    ds_add_u32 v102, v4 offset:0
    ds_add_u32 v103, v4 offset:0
    v_perm_b32 v103, v103, v102, s43
    v_perm_b32 v102, v101, v100, s43
    v_or_b32 v96, 0x40000000, v6
    v_or_b32 v97, 0x40000000, v7
    v_or_b32 v100, 0x40000000, v8
    v_or_b32 v101, 0x40000000, v9
    s_waitcnt vmcnt(4)
    v_perm_b32 v6, v108, v104, s43
    v_perm_b32 v7, v109, v105, s43
    v_perm_b32 v8, v110, v106, s43
    v_perm_b32 v9, v111, v107, s43
    v_mul_hi_u32_u24 v104, 429497, v104
    v_mul_hi_u32_u24 v108, 429497, v108
    v_mul_hi_u32_u24 v105, 429497, v105
    v_mul_hi_u32_u24 v109, 429497, v109
    v_mul_hi_u32_u24 v106, 429497, v106
    v_mul_hi_u32_u24 v110, 429497, v110
    v_mul_hi_u32_u24 v107, 429497, v107
    v_mul_hi_u32_u24 v111, 429497, v111
    v_lshl_or_b32 v104, v108, 16, v104
    v_lshl_or_b32 v105, v109, 16, v105
    v_lshl_or_b32 v106, v110, 16, v106
    v_lshl_or_b32 v107, v111, 16, v107
    v_dot2_u32_u16 v108, v104, s38, 0
    v_dot2_u32_u16 v109, v105, s38, 0
    v_dot2_u32_u16 v110, v106, s38, 0
    v_dot2_u32_u16 v111, v107, s38, 0
    v_pk_mad_u16 v6, v104, s37, v6
    v_pk_mad_u16 v7, v105, s37, v7
    v_pk_mad_u16 v8, v106, s37, v8
    v_pk_mad_u16 v9, v107, s37, v9
    ds_add_u32 v108, v4 offset:0
    ds_add_u32 v109, v4 offset:0
    ds_add_u32 v110, v4 offset:0
    ds_add_u32 v111, v4 offset:0
    v_perm_b32 v111, v111, v110, s43
    v_perm_b32 v110, v109, v108, s43
    v_or_b32 v104, 0x40000000, v6
    v_or_b32 v105, 0x40000000, v7
    v_or_b32 v108, 0x40000000, v8
    v_or_b32 v109, 0x40000000, v9
    s_waitcnt vmcnt(2)
    v_perm_b32 v6, v116, v112, s43
    v_perm_b32 v7, v117, v113, s43
    v_perm_b32 v8, v118, v114, s43
    v_perm_b32 v9, v119, v115, s43
    v_mul_hi_u32_u24 v112, 429497, v112
    v_mul_hi_u32_u24 v116, 429497, v116
    v_mul_hi_u32_u24 v113, 429497, v113
    v_mul_hi_u32_u24 v117, 429497, v117
    v_mul_hi_u32_u24 v114, 429497, v114
    v_mul_hi_u32_u24 v118, 429497, v118
    v_mul_hi_u32_u24 v115, 429497, v115
    v_mul_hi_u32_u24 v119, 429497, v119
    v_lshl_or_b32 v112, v116, 16, v112
    v_lshl_or_b32 v113, v117, 16, v113
    v_lshl_or_b32 v114, v118, 16, v114
    v_lshl_or_b32 v115, v119, 16, v115
    v_dot2_u32_u16 v116, v112, s38, 0
    v_dot2_u32_u16 v117, v113, s38, 0
    v_dot2_u32_u16 v118, v114, s38, 0
    v_dot2_u32_u16 v119, v115, s38, 0
    v_pk_mad_u16 v6, v112, s37, v6
    v_pk_mad_u16 v7, v113, s37, v7
    v_pk_mad_u16 v8, v114, s37, v8
    v_pk_mad_u16 v9, v115, s37, v9
    ds_add_u32 v116, v4 offset:0
    ds_add_u32 v117, v4 offset:0
    ds_add_u32 v118, v4 offset:0
    ds_add_u32 v119, v4 offset:0
    v_perm_b32 v119, v119, v118, s43
    v_perm_b32 v118, v117, v116, s43
    v_or_b32 v112, 0x40000000, v6
    v_or_b32 v113, 0x40000000, v7
    v_or_b32 v116, 0x40000000, v8
    v_or_b32 v117, 0x40000000, v9
    s_waitcnt vmcnt(0)
    s_mov_b64 exec, s[44:45]
    v_perm_b32 v6, v124, v120, s43
    v_perm_b32 v7, v125, v121, s43
    v_perm_b32 v8, v126, v122, s43
    v_perm_b32 v9, v127, v123, s43
    v_mul_hi_u32_u24 v120, 429497, v120
    v_mul_hi_u32_u24 v124, 429497, v124
    v_mul_hi_u32_u24 v121, 429497, v121
    v_mul_hi_u32_u24 v125, 429497, v125
    v_mul_hi_u32_u24 v122, 429497, v122
    v_mul_hi_u32_u24 v126, 429497, v126
    v_mul_hi_u32_u24 v123, 429497, v123
    v_mul_hi_u32_u24 v127, 429497, v127
    v_lshl_or_b32 v120, v124, 16, v120
    v_lshl_or_b32 v121, v125, 16, v121
    v_lshl_or_b32 v122, v126, 16, v122
    v_lshl_or_b32 v123, v127, 16, v123
    v_dot2_u32_u16 v124, v120, s38, 0
    v_dot2_u32_u16 v125, v121, s38, 0
    v_dot2_u32_u16 v126, v122, s38, 0
    v_dot2_u32_u16 v127, v123, s38, 0
    v_pk_mad_u16 v6, v120, s37, v6
    v_pk_mad_u16 v7, v121, s37, v7
    v_pk_mad_u16 v8, v122, s37, v8
    v_pk_mad_u16 v9, v123, s37, v9
    ds_add_u32 v124, v4 offset:0
    ds_add_u32 v125, v4 offset:0
    ds_add_u32 v126, v4 offset:0
    ds_add_u32 v127, v4 offset:0
    v_perm_b32 v127, v127, v126, s43
    v_perm_b32 v126, v125, v124, s43
    v_or_b32 v120, 0x40000000, v6
    v_or_b32 v121, 0x40000000, v7
    v_or_b32 v124, 0x40000000, v8
    v_or_b32 v125, 0x40000000, v9
    s_mov_b64 exec, -1
    s_add_u32 s35, s34, 0
    buffer_load_dwordx2 v[50:51], v2, s[16:19], s35 offen nt
    s_add_u32 s35, s34, 2097152
    buffer_load_dwordx2 v[58:59], v2, s[16:19], s35 offen nt
    s_add_u32 s35, s34, 4194304
    buffer_load_dwordx2 v[66:67], v2, s[16:19], s35 offen nt
    s_and_b32 s35, s32, 15
    s_lshl_b32 s35, s35, 6
    s_lshr_b32 s36, s32, 4
    s_add_u32 s35, s35, s36
    s_lshl_b32 s42, s35, 4
    s_mul_i32 s35, s35, 240512
    s_add_u32 s35, s35, 8192
    s_add_u32 s20, s4, s35
    s_addc_u32 s21, s5, 0
    s_waitcnt lgkmcnt(0)
    s_barrier
    ds_read_b128 v[8:11], v1 offset:0
    s_add_u32 s35, s34, 6291456
    buffer_load_dwordx2 v[74:75], v2, s[16:19], s35 offen nt
    s_lshl_b32 s35, s39, 2
    s_add_u32 s35, s35, 160256
    v_mov_b32 v7, s35
    v_and_b32 v14, 15, v0
    v_lshlrev_b32 v14, 2, v14
    v_add_u32 v14, 160256, v14
    s_waitcnt lgkmcnt(0)
    v_cmp_eq_u32 s[56:57], 0, v8
    v_max_u32 v12, 1, v8
    v_lshl_or_b32 v8, v8, 16, v12
    v_cmp_eq_u32 s[58:59], 0, v9
    v_max_u32 v12, 1, v9
    v_lshl_or_b32 v9, v9, 16, v12
    v_cmp_eq_u32 s[60:61], 0, v10
    v_max_u32 v12, 1, v10
    v_lshl_or_b32 v10, v10, 16, v12
    v_cmp_eq_u32 s[62:63], 0, v11
    v_max_u32 v12, 1, v11
    v_lshl_or_b32 v11, v11, 16, v12
    v_add_u32 v9, v8, v9
    v_add_u32 v10, v9, v10
    v_add_u32 v11, v10, v11
    v_mov_b32 v6, v11
    s_nop 1
    v_add_u32_dpp v6, v6, v6 row_shr:1 row_mask:0xf bank_mask:0xf bound_ctrl:0
    s_nop 1
    v_add_u32_dpp v6, v6, v6 row_shr:2 row_mask:0xf bank_mask:0xf bound_ctrl:0
    s_nop 1
    v_add_u32_dpp v6, v6, v6 row_shr:4 row_mask:0xf bank_mask:0xf bound_ctrl:0
    s_nop 1
    v_add_u32_dpp v6, v6, v6 row_shr:8 row_mask:0xf bank_mask:0xf bound_ctrl:0
    s_nop 1
    v_add_u32_dpp v6, v6, v6 row_bcast:15 row_mask:0xa bank_mask:0xf
    s_nop 1
    v_add_u32_dpp v6, v6, v6 row_bcast:31 row_mask:0xc bank_mask:0xf
    s_mov_b32 exec_lo, 0
    s_brev_b32 exec_hi, 1
    ds_write_b32 v7, v6
    s_mov_b64 exec, -1
    v_sub_u32 v6, v6, v11
    s_or_b64 s[46:47], s[56:57], s[58:59]
    s_or_b64 vcc, s[60:61], s[62:63]
    s_or_b64 s[46:47], s[46:47], vcc
    s_waitcnt lgkmcnt(0)
    s_barrier
    ds_read_b32 v7, v14
    s_add_u32 s35, s34, 8388608
    buffer_load_dwordx2 v[82:83], v2, s[16:19], s35 offen nt
    s_waitcnt lgkmcnt(0)
    v_mov_b32 v15, v7
    s_nop 1
    v_add_u32_dpp v7, v7, v7 row_shr:1 row_mask:0xf bank_mask:0xf bound_ctrl:0
    s_nop 1
    v_add_u32_dpp v7, v7, v7 row_shr:2 row_mask:0xf bank_mask:0xf bound_ctrl:0
    s_nop 1
    v_add_u32_dpp v7, v7, v7 row_shr:4 row_mask:0xf bank_mask:0xf bound_ctrl:0
    s_nop 1
    v_add_u32_dpp v7, v7, v7 row_shr:8 row_mask:0xf bank_mask:0xf bound_ctrl:0
    s_nop 0
    v_readlane_b32 s54, v7, 15
    v_sub_u32 v7, v7, v15
    s_nop 0
    v_readlane_b32 s35, v7, s39
    s_and_b32 s54, s54, 0xffff
    s_cmp_ge_u32 s54, 40064
    s_cselect_b32 s36, 16, 0
    s_cselect_b32 s54, 40000, s54
    s_cselect_b32 s55, 1, s55
    s_cselect_b64 s[46:47], 0, s[46:47]
    v_add_u32 v12, s35, v6
    v_add_u32 v13, v12, v8
    v_add_u32 v14, v12, v9
    v_add_u32 v15, v12, v10
    v_bfe_u32 v12, v12, s36, 16
    v_bfe_u32 v13, v13, s36, 16
    v_bfe_u32 v14, v14, s36, 16
    v_bfe_u32 v15, v15, s36, 16
    ds_write_b128 v1, v[12:15] offset:0
    ds_write_b128 v1, v[12:15] offset:16384
    v_mov_b32 v6, 32768
    v_mov_b32 v7, s54
    s_mov_b64 exec, 1
    ds_write_b32 v6, v7
    s_mov_b64 exec, -1
    s_add_u32 s35, s54, 1
    s_lshr_b32 s35, s35, 1
    s_mul_i32 s35, s35, 12
    s_min_u32 s22, s35, 240512
    v_perm_b32 v15, v15, v14, s43
    v_perm_b32 v14, v13, v12, s43
    s_waitcnt lgkmcnt(0)
    s_barrier
    s_add_u32 s35, s34, 10485760
    buffer_load_dwordx2 v[90:91], v2, s[16:19], s35 offen nt
    v_and_b32 v6, 63, v0
    s_lshl_b32 s35, s39, 10
    v_lshl_add_u32 v7, v6, 2, s35
    v_lshl_add_u32 v12, v6, 8, s35
    ds_read_b32 v8, v7 offset:16384
    ds_read_b32 v9, v7 offset:16640
    ds_read_b32 v10, v7 offset:16896
    ds_read_b32 v11, v7 offset:17152
    s_mov_b64 exec, 15
    ds_read_b32 v12, v12 offset:16640
    s_mov_b64 exec, -1
    s_lshr_b32 s35, s39, 2
    s_mul_i32 s35, s35, 2138240
    s_and_b32 s36, s39, 1
    s_lshl_b32 s36, s36, 3
    s_add_u32 s35, s35, s36
    s_and_b32 s36, s39, 2
    s_lshl_b32 s36, s36, 13
    s_add_u32 s35, s35, s36
    s_add_u32 s35, s35, s42
    s_add_u32 s36, s35, 2105344
    v_mul_u32_u24 v7, 32896, v6
    v_lshlrev_b32 v13, 1, v6
    s_waitcnt lgkmcnt(1)
    v_perm_b32 v8, v9, v8, s43
    v_perm_b32 v9, v11, v10, s43
    buffer_store_dwordx2 v[8:9], v7, s[24:27], s35 offen
    s_waitcnt lgkmcnt(0)
    s_mov_b64 exec, 15
    buffer_store_short v12, v13, s[24:27], s36 offen
    s_mov_b64 exec, -1
    s_nop 0
    v_and_b32 v6, 0xffff, v54
    v_lshrrev_b32 v7, 16, v54
    v_and_b32 v8, 0xffff, v55
    v_lshrrev_b32 v9, 16, v55
    ds_add_rtn_u32 v6, v6, v4 offset:0
    ds_add_rtn_u32 v7, v7, v4 offset:0
    ds_add_rtn_u32 v8, v8, v4 offset:0
    ds_add_rtn_u32 v9, v9, v4 offset:0
    v_and_b32 v10, 0xffff, v62
    v_lshrrev_b32 v11, 16, v62
    v_and_b32 v12, 0xffff, v63
    v_lshrrev_b32 v13, 16, v63
    ds_add_rtn_u32 v10, v10, v4 offset:0
    ds_add_rtn_u32 v11, v11, v4 offset:0
    ds_add_rtn_u32 v12, v12, v4 offset:0
    ds_add_rtn_u32 v13, v13, v4 offset:0
    s_waitcnt lgkmcnt(4)
    v_perm_b32 v54, v7, v6, s43
    v_perm_b32 v55, v9, v8, s43
    v_and_b32 v6, 0xffff, v70
    v_lshrrev_b32 v7, 16, v70
    v_and_b32 v8, 0xffff, v71
    v_lshrrev_b32 v9, 16, v71
    ds_add_rtn_u32 v6, v6, v4 offset:0
    ds_add_rtn_u32 v7, v7, v4 offset:0
    ds_add_rtn_u32 v8, v8, v4 offset:0
    ds_add_rtn_u32 v9, v9, v4 offset:0
    s_waitcnt lgkmcnt(4)
    v_perm_b32 v62, v11, v10, s43
    v_perm_b32 v63, v13, v12, s43
    s_add_u32 s35, s34, 12582912
    buffer_load_dwordx2 v[98:99], v2, s[16:19], s35 offen nt
    s_add_u32 s35, s34, 14680064
    buffer_load_dwordx2 v[106:107], v2, s[16:19], s35 offen nt
    v_and_b32 v10, 0xffff, v78
    v_lshrrev_b32 v11, 16, v78
    v_and_b32 v12, 0xffff, v79
    v_lshrrev_b32 v13, 16, v79
    ds_add_rtn_u32 v10, v10, v4 offset:0
    ds_add_rtn_u32 v11, v11, v4 offset:0
    ds_add_rtn_u32 v12, v12, v4 offset:0
    ds_add_rtn_u32 v13, v13, v4 offset:0
    s_waitcnt lgkmcnt(4)
    v_perm_b32 v70, v7, v6, s43
    v_perm_b32 v71, v9, v8, s43
    v_and_b32 v6, 0xffff, v86
    v_lshrrev_b32 v7, 16, v86
    v_and_b32 v8, 0xffff, v87
    v_lshrrev_b32 v9, 16, v87
    ds_add_rtn_u32 v6, v6, v4 offset:0
    ds_add_rtn_u32 v7, v7, v4 offset:0
    ds_add_rtn_u32 v8, v8, v4 offset:0
    ds_add_rtn_u32 v9, v9, v4 offset:0
    s_waitcnt lgkmcnt(4)
    v_perm_b32 v78, v11, v10, s43
    v_perm_b32 v79, v13, v12, s43
    v_and_b32 v10, 0xffff, v94
    v_lshrrev_b32 v11, 16, v94
    v_and_b32 v12, 0xffff, v95
    v_lshrrev_b32 v13, 16, v95
    ds_add_rtn_u32 v10, v10, v4 offset:0
    ds_add_rtn_u32 v11, v11, v4 offset:0
    ds_add_rtn_u32 v12, v12, v4 offset:0
    ds_add_rtn_u32 v13, v13, v4 offset:0
    s_waitcnt lgkmcnt(4)
    v_perm_b32 v86, v7, v6, s43
    v_perm_b32 v87, v9, v8, s43
    s_add_u32 s35, s34, 16777216
    buffer_load_dwordx2 v[114:115], v2, s[16:19], s35 offen nt
    s_add_u32 s35, s34, 18874368
    s_sub_u32 s35, s35, s49
    v_cndmask_b32 v122, 2.0, v2, s[44:45]
    buffer_load_dwordx2 v[122:123], v122, s[16:19], s35 offen nt
    v_and_b32 v6, 0xffff, v102
    v_lshrrev_b32 v7, 16, v102
    v_and_b32 v8, 0xffff, v103
    v_lshrrev_b32 v9, 16, v103
    ds_add_rtn_u32 v6, v6, v4 offset:0
    ds_add_rtn_u32 v7, v7, v4 offset:0
    ds_add_rtn_u32 v8, v8, v4 offset:0
    ds_add_rtn_u32 v9, v9, v4 offset:0
    s_waitcnt lgkmcnt(4)
    v_perm_b32 v94, v11, v10, s43
    v_perm_b32 v95, v13, v12, s43
    v_and_b32 v10, 0xffff, v110
    v_lshrrev_b32 v11, 16, v110
    v_and_b32 v12, 0xffff, v111
    v_lshrrev_b32 v13, 16, v111
    ds_add_rtn_u32 v10, v10, v4 offset:0
    ds_add_rtn_u32 v11, v11, v4 offset:0
    ds_add_rtn_u32 v12, v12, v4 offset:0
    ds_add_rtn_u32 v13, v13, v4 offset:0
    s_waitcnt lgkmcnt(4)
    v_perm_b32 v102, v7, v6, s43
    v_perm_b32 v103, v9, v8, s43
    v_and_b32 v6, 0xffff, v118
    v_lshrrev_b32 v7, 16, v118
    v_and_b32 v8, 0xffff, v119
    v_lshrrev_b32 v9, 16, v119
    ds_add_rtn_u32 v6, v6, v4 offset:0
    ds_add_rtn_u32 v7, v7, v4 offset:0
    ds_add_rtn_u32 v8, v8, v4 offset:0
    ds_add_rtn_u32 v9, v9, v4 offset:0
    s_waitcnt lgkmcnt(4)
    v_perm_b32 v110, v11, v10, s43
    v_perm_b32 v111, v13, v12, s43
    s_add_u32 s35, s33, 40960000
    buffer_load_dwordx4 v[16:19], v1, s[8:11], s35 offen nt
    s_mov_b64 exec, s[44:45]
    v_and_b32 v10, 0xffff, v126
    v_lshrrev_b32 v11, 16, v126
    v_and_b32 v12, 0xffff, v127
    v_lshrrev_b32 v13, 16, v127
    ds_add_rtn_u32 v10, v10, v4 offset:0
    ds_add_rtn_u32 v11, v11, v4 offset:0
    ds_add_rtn_u32 v12, v12, v4 offset:0
    ds_add_rtn_u32 v13, v13, v4 offset:0
    s_mov_b64 exec, -1
    s_waitcnt lgkmcnt(4)
    v_perm_b32 v118, v7, v6, s43
    v_perm_b32 v119, v9, v8, s43
    s_waitcnt lgkmcnt(0)
    v_perm_b32 v126, v11, v10, s43
    v_perm_b32 v127, v13, v12, s43
    s_barrier
    s_lshl_b32 s35, s54, 2
    v_mov_b32 v6, s35
    v_mov_b32 v7, 0
    s_mov_b64 exec, 1
    ds_write_b32 v6, v7
    s_cmp_eq_u64 s[46:47], 0
    s_cbranch_scc1 L_p1_kernel_nonull_1
    s_mov_b64 exec, s[56:57]
    v_lshlrev_b32_sdwa v6, 2, v14 dst_sel:DWORD dst_unused:UNUSED_PAD src0_sel:DWORD src1_sel:WORD_0
    ds_write_b32 v6, v7
    s_mov_b64 exec, s[58:59]
    v_lshlrev_b32_sdwa v6, 2, v14 dst_sel:DWORD dst_unused:UNUSED_PAD src0_sel:DWORD src1_sel:WORD_1
    ds_write_b32 v6, v7
    s_mov_b64 exec, s[60:61]
    v_lshlrev_b32_sdwa v6, 2, v15 dst_sel:DWORD dst_unused:UNUSED_PAD src0_sel:DWORD src1_sel:WORD_0
    ds_write_b32 v6, v7
    s_mov_b64 exec, s[62:63]
    v_lshlrev_b32_sdwa v6, 2, v15 dst_sel:DWORD dst_unused:UNUSED_PAD src0_sel:DWORD src1_sel:WORD_1
    ds_write_b32 v6, v7
L_p1_kernel_nonull_1:
    s_mov_b64 exec, -1
    v_lshlrev_b32_sdwa v6, 2, v54 dst_sel:DWORD dst_unused:UNUSED_PAD src0_sel:DWORD src1_sel:WORD_0
    v_lshlrev_b32_sdwa v7, 2, v54 dst_sel:DWORD dst_unused:UNUSED_PAD src0_sel:DWORD src1_sel:WORD_1
    v_lshlrev_b32_sdwa v8, 2, v55 dst_sel:DWORD dst_unused:UNUSED_PAD src0_sel:DWORD src1_sel:WORD_0
    v_lshlrev_b32_sdwa v9, 2, v55 dst_sel:DWORD dst_unused:UNUSED_PAD src0_sel:DWORD src1_sel:WORD_1
    ds_write_b32 v6, v48
    ds_write_b32 v7, v49
    ds_write_b32 v8, v52
    ds_write_b32 v9, v53
    s_waitcnt vmcnt(12)
    v_lshlrev_b32 v10, 16, v50
    v_lshlrev_b32 v11, 16, v51
    v_and_b32 v50, 0xffff0000, v50
    v_and_b32 v51, 0xffff0000, v51
    v_mul_f32 v10, s41, v10
    v_mul_f32 v50, s41, v50
    v_mul_f32 v11, s41, v11
    v_mul_f32 v51, s41, v51
    v_fract_f32 v10, v10
    v_fract_f32 v50, v50
    v_fract_f32 v11, v11
    v_fract_f32 v51, v51
    v_cos_f32 v10, v10
    v_cos_f32 v50, v50
    v_cos_f32 v11, v11
    v_cos_f32 v51, v51
    v_cvt_pk_bf16_f32 v50, v10, v50
    v_cvt_pk_bf16_f32 v51, v11, v51
    v_or3_b32 v5, v50, v51, v5
    v_lshlrev_b32_sdwa v6, 2, v62 dst_sel:DWORD dst_unused:UNUSED_PAD src0_sel:DWORD src1_sel:WORD_0
    v_lshlrev_b32_sdwa v7, 2, v62 dst_sel:DWORD dst_unused:UNUSED_PAD src0_sel:DWORD src1_sel:WORD_1
    v_lshlrev_b32_sdwa v8, 2, v63 dst_sel:DWORD dst_unused:UNUSED_PAD src0_sel:DWORD src1_sel:WORD_0
    v_lshlrev_b32_sdwa v9, 2, v63 dst_sel:DWORD dst_unused:UNUSED_PAD src0_sel:DWORD src1_sel:WORD_1
    ds_write_b32 v6, v56
    ds_write_b32 v7, v57
    ds_write_b32 v8, v60
    ds_write_b32 v9, v61
    s_waitcnt vmcnt(11)
    v_lshlrev_b32 v10, 16, v58
    v_lshlrev_b32 v11, 16, v59
    v_and_b32 v58, 0xffff0000, v58
    v_and_b32 v59, 0xffff0000, v59
    v_mul_f32 v10, s41, v10
    v_mul_f32 v58, s41, v58
    v_mul_f32 v11, s41, v11
    v_mul_f32 v59, s41, v59
    v_fract_f32 v10, v10
    v_fract_f32 v58, v58
    v_fract_f32 v11, v11
    v_fract_f32 v59, v59
    v_cos_f32 v10, v10
    v_cos_f32 v58, v58
    v_cos_f32 v11, v11
    v_cos_f32 v59, v59
    v_cvt_pk_bf16_f32 v58, v10, v58
    v_cvt_pk_bf16_f32 v59, v11, v59
    v_or3_b32 v5, v58, v59, v5
    s_add_u32 s35, s33, 40960000
    buffer_load_dwordx4 v[20:23], v1, s[12:15], s35 offen nt
    v_lshlrev_b32_sdwa v6, 2, v70 dst_sel:DWORD dst_unused:UNUSED_PAD src0_sel:DWORD src1_sel:WORD_0
    v_lshlrev_b32_sdwa v7, 2, v70 dst_sel:DWORD dst_unused:UNUSED_PAD src0_sel:DWORD src1_sel:WORD_1
    v_lshlrev_b32_sdwa v8, 2, v71 dst_sel:DWORD dst_unused:UNUSED_PAD src0_sel:DWORD src1_sel:WORD_0
    v_lshlrev_b32_sdwa v9, 2, v71 dst_sel:DWORD dst_unused:UNUSED_PAD src0_sel:DWORD src1_sel:WORD_1
    ds_write_b32 v6, v64
    ds_write_b32 v7, v65
    ds_write_b32 v8, v68
    ds_write_b32 v9, v69
    s_waitcnt vmcnt(11)
    v_lshlrev_b32 v10, 16, v66
    v_lshlrev_b32 v11, 16, v67
    v_and_b32 v66, 0xffff0000, v66
    v_and_b32 v67, 0xffff0000, v67
    v_mul_f32 v10, s41, v10
    v_mul_f32 v66, s41, v66
    v_mul_f32 v11, s41, v11
    v_mul_f32 v67, s41, v67
    v_fract_f32 v10, v10
    v_fract_f32 v66, v66
    v_fract_f32 v11, v11
    v_fract_f32 v67, v67
    v_cos_f32 v10, v10
    v_cos_f32 v66, v66
    v_cos_f32 v11, v11
    v_cos_f32 v67, v67
    v_cvt_pk_bf16_f32 v66, v10, v66
    v_cvt_pk_bf16_f32 v67, v11, v67
    v_or3_b32 v5, v66, v67, v5
    v_lshlrev_b32_sdwa v6, 2, v78 dst_sel:DWORD dst_unused:UNUSED_PAD src0_sel:DWORD src1_sel:WORD_0
    v_lshlrev_b32_sdwa v7, 2, v78 dst_sel:DWORD dst_unused:UNUSED_PAD src0_sel:DWORD src1_sel:WORD_1
    v_lshlrev_b32_sdwa v8, 2, v79 dst_sel:DWORD dst_unused:UNUSED_PAD src0_sel:DWORD src1_sel:WORD_0
    v_lshlrev_b32_sdwa v9, 2, v79 dst_sel:DWORD dst_unused:UNUSED_PAD src0_sel:DWORD src1_sel:WORD_1
    ds_write_b32 v6, v72
    ds_write_b32 v7, v73
    ds_write_b32 v8, v76
    ds_write_b32 v9, v77
    s_waitcnt vmcnt(10)
    v_lshlrev_b32 v10, 16, v74
    v_lshlrev_b32 v11, 16, v75
    v_and_b32 v74, 0xffff0000, v74
    v_and_b32 v75, 0xffff0000, v75
    v_mul_f32 v10, s41, v10
    v_mul_f32 v74, s41, v74
    v_mul_f32 v11, s41, v11
    v_mul_f32 v75, s41, v75
    v_fract_f32 v10, v10
    v_fract_f32 v74, v74
    v_fract_f32 v11, v11
    v_fract_f32 v75, v75
    v_cos_f32 v10, v10
    v_cos_f32 v74, v74
    v_cos_f32 v11, v11
    v_cos_f32 v75, v75
    v_cvt_pk_bf16_f32 v74, v10, v74
    v_cvt_pk_bf16_f32 v75, v11, v75
    v_or3_b32 v5, v74, v75, v5
    v_lshlrev_b32_sdwa v6, 2, v86 dst_sel:DWORD dst_unused:UNUSED_PAD src0_sel:DWORD src1_sel:WORD_0
    v_lshlrev_b32_sdwa v7, 2, v86 dst_sel:DWORD dst_unused:UNUSED_PAD src0_sel:DWORD src1_sel:WORD_1
    v_lshlrev_b32_sdwa v8, 2, v87 dst_sel:DWORD dst_unused:UNUSED_PAD src0_sel:DWORD src1_sel:WORD_0
    v_lshlrev_b32_sdwa v9, 2, v87 dst_sel:DWORD dst_unused:UNUSED_PAD src0_sel:DWORD src1_sel:WORD_1
    ds_write_b32 v6, v80
    ds_write_b32 v7, v81
    ds_write_b32 v8, v84
    ds_write_b32 v9, v85
    s_waitcnt vmcnt(9)
    v_lshlrev_b32 v10, 16, v82
    v_lshlrev_b32 v11, 16, v83
    v_and_b32 v82, 0xffff0000, v82
    v_and_b32 v83, 0xffff0000, v83
    v_mul_f32 v10, s41, v10
    v_mul_f32 v82, s41, v82
    v_mul_f32 v11, s41, v11
    v_mul_f32 v83, s41, v83
    v_fract_f32 v10, v10
    v_fract_f32 v82, v82
    v_fract_f32 v11, v11
    v_fract_f32 v83, v83
    v_cos_f32 v10, v10
    v_cos_f32 v82, v82
    v_cos_f32 v11, v11
    v_cos_f32 v83, v83
    v_cvt_pk_bf16_f32 v82, v10, v82
    v_cvt_pk_bf16_f32 v83, v11, v83
    v_or3_b32 v5, v82, v83, v5
    s_add_u32 s35, s33, 45154304
    buffer_load_dwordx4 v[24:27], v1, s[8:11], s35 offen nt
    v_lshlrev_b32_sdwa v6, 2, v94 dst_sel:DWORD dst_unused:UNUSED_PAD src0_sel:DWORD src1_sel:WORD_0
    v_lshlrev_b32_sdwa v7, 2, v94 dst_sel:DWORD dst_unused:UNUSED_PAD src0_sel:DWORD src1_sel:WORD_1
    v_lshlrev_b32_sdwa v8, 2, v95 dst_sel:DWORD dst_unused:UNUSED_PAD src0_sel:DWORD src1_sel:WORD_0
    v_lshlrev_b32_sdwa v9, 2, v95 dst_sel:DWORD dst_unused:UNUSED_PAD src0_sel:DWORD src1_sel:WORD_1
    ds_write_b32 v6, v88
    ds_write_b32 v7, v89
    ds_write_b32 v8, v92
    ds_write_b32 v9, v93
    s_waitcnt vmcnt(9)
    v_lshlrev_b32 v10, 16, v90
    v_lshlrev_b32 v11, 16, v91
    v_and_b32 v90, 0xffff0000, v90
    v_and_b32 v91, 0xffff0000, v91
    v_mul_f32 v10, s41, v10
    v_mul_f32 v90, s41, v90
    v_mul_f32 v11, s41, v11
    v_mul_f32 v91, s41, v91
    v_fract_f32 v10, v10
    v_fract_f32 v90, v90
    v_fract_f32 v11, v11
    v_fract_f32 v91, v91
    v_cos_f32 v10, v10
    v_cos_f32 v90, v90
    v_cos_f32 v11, v11
    v_cos_f32 v91, v91
    v_cvt_pk_bf16_f32 v90, v10, v90
    v_cvt_pk_bf16_f32 v91, v11, v91
    v_or3_b32 v5, v90, v91, v5
    v_lshlrev_b32_sdwa v6, 2, v102 dst_sel:DWORD dst_unused:UNUSED_PAD src0_sel:DWORD src1_sel:WORD_0
    v_lshlrev_b32_sdwa v7, 2, v102 dst_sel:DWORD dst_unused:UNUSED_PAD src0_sel:DWORD src1_sel:WORD_1
    v_lshlrev_b32_sdwa v8, 2, v103 dst_sel:DWORD dst_unused:UNUSED_PAD src0_sel:DWORD src1_sel:WORD_0
    v_lshlrev_b32_sdwa v9, 2, v103 dst_sel:DWORD dst_unused:UNUSED_PAD src0_sel:DWORD src1_sel:WORD_1
    ds_write_b32 v6, v96
    ds_write_b32 v7, v97
    ds_write_b32 v8, v100
    ds_write_b32 v9, v101
    s_waitcnt vmcnt(6)
    v_lshlrev_b32 v10, 16, v98
    v_lshlrev_b32 v11, 16, v99
    v_and_b32 v98, 0xffff0000, v98
    v_and_b32 v99, 0xffff0000, v99
    v_mul_f32 v10, s41, v10
    v_mul_f32 v98, s41, v98
    v_mul_f32 v11, s41, v11
    v_mul_f32 v99, s41, v99
    v_fract_f32 v10, v10
    v_fract_f32 v98, v98
    v_fract_f32 v11, v11
    v_fract_f32 v99, v99
    v_cos_f32 v10, v10
    v_cos_f32 v98, v98
    v_cos_f32 v11, v11
    v_cos_f32 v99, v99
    v_cvt_pk_bf16_f32 v98, v10, v98
    v_cvt_pk_bf16_f32 v99, v11, v99
    v_or3_b32 v5, v98, v99, v5
    v_lshlrev_b32_sdwa v6, 2, v110 dst_sel:DWORD dst_unused:UNUSED_PAD src0_sel:DWORD src1_sel:WORD_0
    v_lshlrev_b32_sdwa v7, 2, v110 dst_sel:DWORD dst_unused:UNUSED_PAD src0_sel:DWORD src1_sel:WORD_1
    v_lshlrev_b32_sdwa v8, 2, v111 dst_sel:DWORD dst_unused:UNUSED_PAD src0_sel:DWORD src1_sel:WORD_0
    v_lshlrev_b32_sdwa v9, 2, v111 dst_sel:DWORD dst_unused:UNUSED_PAD src0_sel:DWORD src1_sel:WORD_1
    ds_write_b32 v6, v104
    ds_write_b32 v7, v105
    ds_write_b32 v8, v108
    ds_write_b32 v9, v109
    s_waitcnt vmcnt(5)
    v_lshlrev_b32 v10, 16, v106
    v_lshlrev_b32 v11, 16, v107
    v_and_b32 v106, 0xffff0000, v106
    v_and_b32 v107, 0xffff0000, v107
    v_mul_f32 v10, s41, v10
    v_mul_f32 v106, s41, v106
    v_mul_f32 v11, s41, v11
    v_mul_f32 v107, s41, v107
    v_fract_f32 v10, v10
    v_fract_f32 v106, v106
    v_fract_f32 v11, v11
    v_fract_f32 v107, v107
    v_cos_f32 v10, v10
    v_cos_f32 v106, v106
    v_cos_f32 v11, v11
    v_cos_f32 v107, v107
    v_cvt_pk_bf16_f32 v106, v10, v106
    v_cvt_pk_bf16_f32 v107, v11, v107
    v_or3_b32 v5, v106, v107, v5
    s_add_u32 s35, s33, 45154304
    buffer_load_dwordx4 v[28:31], v1, s[12:15], s35 offen nt
    v_lshlrev_b32_sdwa v6, 2, v118 dst_sel:DWORD dst_unused:UNUSED_PAD src0_sel:DWORD src1_sel:WORD_0
    v_lshlrev_b32_sdwa v7, 2, v118 dst_sel:DWORD dst_unused:UNUSED_PAD src0_sel:DWORD src1_sel:WORD_1
    v_lshlrev_b32_sdwa v8, 2, v119 dst_sel:DWORD dst_unused:UNUSED_PAD src0_sel:DWORD src1_sel:WORD_0
    v_lshlrev_b32_sdwa v9, 2, v119 dst_sel:DWORD dst_unused:UNUSED_PAD src0_sel:DWORD src1_sel:WORD_1
    ds_write_b32 v6, v112
    ds_write_b32 v7, v113
    ds_write_b32 v8, v116
    ds_write_b32 v9, v117
    s_waitcnt vmcnt(5)
    v_lshlrev_b32 v10, 16, v114
    v_lshlrev_b32 v11, 16, v115
    v_and_b32 v114, 0xffff0000, v114
    v_and_b32 v115, 0xffff0000, v115
    v_mul_f32 v10, s41, v10
    v_mul_f32 v114, s41, v114
    v_mul_f32 v11, s41, v11
    v_mul_f32 v115, s41, v115
    v_fract_f32 v10, v10
    v_fract_f32 v114, v114
    v_fract_f32 v11, v11
    v_fract_f32 v115, v115
    v_cos_f32 v10, v10
    v_cos_f32 v114, v114
    v_cos_f32 v11, v11
    v_cos_f32 v115, v115
    v_cvt_pk_bf16_f32 v114, v10, v114
    v_cvt_pk_bf16_f32 v115, v11, v115
    v_or3_b32 v5, v114, v115, v5
    s_mov_b64 exec, s[44:45]
    v_lshlrev_b32_sdwa v6, 2, v126 dst_sel:DWORD dst_unused:UNUSED_PAD src0_sel:DWORD src1_sel:WORD_0
    v_lshlrev_b32_sdwa v7, 2, v126 dst_sel:DWORD dst_unused:UNUSED_PAD src0_sel:DWORD src1_sel:WORD_1
    v_lshlrev_b32_sdwa v8, 2, v127 dst_sel:DWORD dst_unused:UNUSED_PAD src0_sel:DWORD src1_sel:WORD_0
    v_lshlrev_b32_sdwa v9, 2, v127 dst_sel:DWORD dst_unused:UNUSED_PAD src0_sel:DWORD src1_sel:WORD_1
    ds_write_b32 v6, v120
    ds_write_b32 v7, v121
    ds_write_b32 v8, v124
    ds_write_b32 v9, v125
    s_waitcnt vmcnt(4)
    v_lshlrev_b32 v10, 16, v122
    v_lshlrev_b32 v11, 16, v123
    v_and_b32 v122, 0xffff0000, v122
    v_and_b32 v123, 0xffff0000, v123
    v_mul_f32 v10, s41, v10
    v_mul_f32 v122, s41, v122
    v_mul_f32 v11, s41, v11
    v_mul_f32 v123, s41, v123
    v_fract_f32 v10, v10
    v_fract_f32 v122, v122
    v_fract_f32 v11, v11
    v_fract_f32 v123, v123
    v_cos_f32 v10, v10
    v_cos_f32 v122, v122
    v_cos_f32 v11, v11
    v_cos_f32 v123, v123
    v_cvt_pk_bf16_f32 v122, v10, v122
    v_cvt_pk_bf16_f32 v123, v11, v123
    v_or3_b32 v5, v122, v123, v5
    s_mov_b64 exec, -1
    s_mul_i32 s35, s39, 9728
    v_add_u32 v6, s35, v2
    s_waitcnt lgkmcnt(0)
    s_barrier
    ds_read_b64 v[48:49], v6 offset:0
    ds_read_b64 v[52:53], v6 offset:512
    ds_read_b64 v[56:57], v6 offset:1024
    ds_read_b64 v[60:61], v6 offset:1536
    ds_read_b64 v[64:65], v6 offset:2048
    ds_read_b64 v[68:69], v6 offset:2560
    ds_read_b64 v[72:73], v6 offset:3072
    ds_read_b64 v[76:77], v6 offset:3584
    ds_read_b64 v[80:81], v6 offset:4096
    ds_read_b64 v[84:85], v6 offset:4608
    ds_read_b64 v[88:89], v6 offset:5120
    ds_read_b64 v[92:93], v6 offset:5632
    ds_read_b64 v[96:97], v6 offset:6144
    ds_read_b64 v[100:101], v6 offset:6656
    ds_read_b64 v[104:105], v6 offset:7168
    ds_read_b64 v[108:109], v6 offset:7680
    ds_read_b64 v[112:113], v6 offset:8192
    ds_read_b64 v[116:117], v6 offset:8704
    ds_read_b64 v[120:121], v6 offset:9216
    ds_read_b64 v[124:125], v6 offset:9728
    s_add_u32 s35, s33, 49348608
    buffer_load_dwordx4 v[32:35], v1, s[8:11], s35 offen nt
    v_mov_b32 v12, 0
    v_mov_b32 v13, 0
    v_mov_b32 v14, 0
    v_mov_b32 v15, 0
    s_waitcnt lgkmcnt(0)
    s_barrier
    ds_write_b128 v1, v[12:15] offset:0
    v_lshlrev_b32_sdwa v6, 1, v54 dst_sel:DWORD dst_unused:UNUSED_PAD src0_sel:DWORD src1_sel:WORD_0
    v_lshlrev_b32_sdwa v7, 1, v54 dst_sel:DWORD dst_unused:UNUSED_PAD src0_sel:DWORD src1_sel:WORD_1
    v_lshlrev_b32_sdwa v8, 1, v55 dst_sel:DWORD dst_unused:UNUSED_PAD src0_sel:DWORD src1_sel:WORD_0
    v_lshlrev_b32_sdwa v9, 1, v55 dst_sel:DWORD dst_unused:UNUSED_PAD src0_sel:DWORD src1_sel:WORD_1
    ds_write_b16 v6, v50 offset:16384
    ds_write_b16_d16_hi v7, v50 offset:16384
    ds_write_b16 v8, v51 offset:16384
    ds_write_b16_d16_hi v9, v51 offset:16384
    v_lshlrev_b32_sdwa v6, 1, v62 dst_sel:DWORD dst_unused:UNUSED_PAD src0_sel:DWORD src1_sel:WORD_0
    v_lshlrev_b32_sdwa v7, 1, v62 dst_sel:DWORD dst_unused:UNUSED_PAD src0_sel:DWORD src1_sel:WORD_1
    v_lshlrev_b32_sdwa v8, 1, v63 dst_sel:DWORD dst_unused:UNUSED_PAD src0_sel:DWORD src1_sel:WORD_0
    v_lshlrev_b32_sdwa v9, 1, v63 dst_sel:DWORD dst_unused:UNUSED_PAD src0_sel:DWORD src1_sel:WORD_1
    ds_write_b16 v6, v58 offset:16384
    ds_write_b16_d16_hi v7, v58 offset:16384
    ds_write_b16 v8, v59 offset:16384
    ds_write_b16_d16_hi v9, v59 offset:16384
    s_add_u32 s35, s33, 49348608
    buffer_load_dwordx4 v[36:39], v1, s[12:15], s35 offen nt
    v_lshlrev_b32_sdwa v6, 1, v70 dst_sel:DWORD dst_unused:UNUSED_PAD src0_sel:DWORD src1_sel:WORD_0
    v_lshlrev_b32_sdwa v7, 1, v70 dst_sel:DWORD dst_unused:UNUSED_PAD src0_sel:DWORD src1_sel:WORD_1
    v_lshlrev_b32_sdwa v8, 1, v71 dst_sel:DWORD dst_unused:UNUSED_PAD src0_sel:DWORD src1_sel:WORD_0
    v_lshlrev_b32_sdwa v9, 1, v71 dst_sel:DWORD dst_unused:UNUSED_PAD src0_sel:DWORD src1_sel:WORD_1
    ds_write_b16 v6, v66 offset:16384
    ds_write_b16_d16_hi v7, v66 offset:16384
    ds_write_b16 v8, v67 offset:16384
    ds_write_b16_d16_hi v9, v67 offset:16384
    v_lshlrev_b32_sdwa v6, 1, v78 dst_sel:DWORD dst_unused:UNUSED_PAD src0_sel:DWORD src1_sel:WORD_0
    v_lshlrev_b32_sdwa v7, 1, v78 dst_sel:DWORD dst_unused:UNUSED_PAD src0_sel:DWORD src1_sel:WORD_1
    v_lshlrev_b32_sdwa v8, 1, v79 dst_sel:DWORD dst_unused:UNUSED_PAD src0_sel:DWORD src1_sel:WORD_0
    v_lshlrev_b32_sdwa v9, 1, v79 dst_sel:DWORD dst_unused:UNUSED_PAD src0_sel:DWORD src1_sel:WORD_1
    ds_write_b16 v6, v74 offset:16384
    ds_write_b16_d16_hi v7, v74 offset:16384
    ds_write_b16 v8, v75 offset:16384
    ds_write_b16_d16_hi v9, v75 offset:16384
    v_lshlrev_b32_sdwa v6, 1, v86 dst_sel:DWORD dst_unused:UNUSED_PAD src0_sel:DWORD src1_sel:WORD_0
    v_lshlrev_b32_sdwa v7, 1, v86 dst_sel:DWORD dst_unused:UNUSED_PAD src0_sel:DWORD src1_sel:WORD_1
    v_lshlrev_b32_sdwa v8, 1, v87 dst_sel:DWORD dst_unused:UNUSED_PAD src0_sel:DWORD src1_sel:WORD_0
    v_lshlrev_b32_sdwa v9, 1, v87 dst_sel:DWORD dst_unused:UNUSED_PAD src0_sel:DWORD src1_sel:WORD_1
    ds_write_b16 v6, v82 offset:16384
    ds_write_b16_d16_hi v7, v82 offset:16384
    ds_write_b16 v8, v83 offset:16384
    ds_write_b16_d16_hi v9, v83 offset:16384
    s_add_u32 s35, s33, 53542912
    buffer_load_dwordx4 v[40:43], v1, s[8:11], s35 offen nt
    v_lshlrev_b32_sdwa v6, 1, v94 dst_sel:DWORD dst_unused:UNUSED_PAD src0_sel:DWORD src1_sel:WORD_0
    v_lshlrev_b32_sdwa v7, 1, v94 dst_sel:DWORD dst_unused:UNUSED_PAD src0_sel:DWORD src1_sel:WORD_1
    v_lshlrev_b32_sdwa v8, 1, v95 dst_sel:DWORD dst_unused:UNUSED_PAD src0_sel:DWORD src1_sel:WORD_0
    v_lshlrev_b32_sdwa v9, 1, v95 dst_sel:DWORD dst_unused:UNUSED_PAD src0_sel:DWORD src1_sel:WORD_1
    ds_write_b16 v6, v90 offset:16384
    ds_write_b16_d16_hi v7, v90 offset:16384
    ds_write_b16 v8, v91 offset:16384
    ds_write_b16_d16_hi v9, v91 offset:16384
    v_lshlrev_b32_sdwa v6, 1, v102 dst_sel:DWORD dst_unused:UNUSED_PAD src0_sel:DWORD src1_sel:WORD_0
    v_lshlrev_b32_sdwa v7, 1, v102 dst_sel:DWORD dst_unused:UNUSED_PAD src0_sel:DWORD src1_sel:WORD_1
    v_lshlrev_b32_sdwa v8, 1, v103 dst_sel:DWORD dst_unused:UNUSED_PAD src0_sel:DWORD src1_sel:WORD_0
    v_lshlrev_b32_sdwa v9, 1, v103 dst_sel:DWORD dst_unused:UNUSED_PAD src0_sel:DWORD src1_sel:WORD_1
    ds_write_b16 v6, v98 offset:16384
    ds_write_b16_d16_hi v7, v98 offset:16384
    ds_write_b16 v8, v99 offset:16384
    ds_write_b16_d16_hi v9, v99 offset:16384
    v_lshlrev_b32_sdwa v6, 1, v110 dst_sel:DWORD dst_unused:UNUSED_PAD src0_sel:DWORD src1_sel:WORD_0
    v_lshlrev_b32_sdwa v7, 1, v110 dst_sel:DWORD dst_unused:UNUSED_PAD src0_sel:DWORD src1_sel:WORD_1
    v_lshlrev_b32_sdwa v8, 1, v111 dst_sel:DWORD dst_unused:UNUSED_PAD src0_sel:DWORD src1_sel:WORD_0
    v_lshlrev_b32_sdwa v9, 1, v111 dst_sel:DWORD dst_unused:UNUSED_PAD src0_sel:DWORD src1_sel:WORD_1
    ds_write_b16 v6, v106 offset:16384
    ds_write_b16_d16_hi v7, v106 offset:16384
    ds_write_b16 v8, v107 offset:16384
    ds_write_b16_d16_hi v9, v107 offset:16384
    s_add_u32 s35, s33, 53542912
    buffer_load_dwordx4 v[44:47], v1, s[12:15], s35 offen nt
    v_lshlrev_b32_sdwa v6, 1, v118 dst_sel:DWORD dst_unused:UNUSED_PAD src0_sel:DWORD src1_sel:WORD_0
    v_lshlrev_b32_sdwa v7, 1, v118 dst_sel:DWORD dst_unused:UNUSED_PAD src0_sel:DWORD src1_sel:WORD_1
    v_lshlrev_b32_sdwa v8, 1, v119 dst_sel:DWORD dst_unused:UNUSED_PAD src0_sel:DWORD src1_sel:WORD_0
    v_lshlrev_b32_sdwa v9, 1, v119 dst_sel:DWORD dst_unused:UNUSED_PAD src0_sel:DWORD src1_sel:WORD_1
    ds_write_b16 v6, v114 offset:16384
    ds_write_b16_d16_hi v7, v114 offset:16384
    ds_write_b16 v8, v115 offset:16384
    ds_write_b16_d16_hi v9, v115 offset:16384
    s_mov_b64 exec, s[44:45]
    v_lshlrev_b32_sdwa v6, 1, v126 dst_sel:DWORD dst_unused:UNUSED_PAD src0_sel:DWORD src1_sel:WORD_0
    v_lshlrev_b32_sdwa v7, 1, v126 dst_sel:DWORD dst_unused:UNUSED_PAD src0_sel:DWORD src1_sel:WORD_1
    v_lshlrev_b32_sdwa v8, 1, v127 dst_sel:DWORD dst_unused:UNUSED_PAD src0_sel:DWORD src1_sel:WORD_0
    v_lshlrev_b32_sdwa v9, 1, v127 dst_sel:DWORD dst_unused:UNUSED_PAD src0_sel:DWORD src1_sel:WORD_1
    ds_write_b16 v6, v122 offset:16384
    ds_write_b16_d16_hi v7, v122 offset:16384
    ds_write_b16 v8, v123 offset:16384
    ds_write_b16_d16_hi v9, v123 offset:16384
    s_mov_b64 exec, -1
    v_lshlrev_b32 v6, 2, v0
    s_mul_i32 s35, s39, 4864
    v_add_u32 v7, s35, v6
    s_waitcnt lgkmcnt(0)
    s_barrier
    ds_read_b32 v50, v7 offset:16384
    ds_read_b32 v54, v7 offset:16640
    ds_read_b32 v58, v7 offset:16896
    ds_read_b32 v62, v7 offset:17152
    ds_read_b32 v66, v7 offset:17408
    ds_read_b32 v70, v7 offset:17664
    ds_read_b32 v74, v7 offset:17920
    ds_read_b32 v78, v7 offset:18176
    ds_read_b32 v82, v7 offset:18432
    ds_read_b32 v86, v7 offset:18688
    ds_read_b32 v90, v7 offset:18944
    ds_read_b32 v94, v7 offset:19200
    ds_read_b32 v98, v7 offset:19456
    ds_read_b32 v102, v7 offset:19712
    ds_read_b32 v106, v7 offset:19968
    ds_read_b32 v110, v7 offset:20224
    ds_read_b32 v114, v7 offset:20480
    ds_read_b32 v118, v7 offset:20736
    ds_read_b32 v122, v7 offset:20992
    ds_read_b32 v126, v7 offset:21248
    s_add_u32 s32, s32, 256
    s_add_u32 s33, s33, 40960000
    s_add_u32 s34, s34, 20480000
    s_add_u32 s40, s40, 1
    s_cmp_lt_u32 s40, 4
    s_waitcnt lgkmcnt(0)
    s_cbranch_scc1 L_p1_loop
    s_mov_b32 s36, 0
    buffer_store_dwordx3 v[48:50], v3, s[20:23], s36 offen sc1
    s_mov_b32 s36, 768
    buffer_store_dwordx3 v[52:54], v3, s[20:23], s36 offen sc1
    s_mov_b32 s36, 1536
    buffer_store_dwordx3 v[56:58], v3, s[20:23], s36 offen sc1
    s_mov_b32 s36, 2304
    buffer_store_dwordx3 v[60:62], v3, s[20:23], s36 offen sc1
    s_mov_b32 s36, 3072
    buffer_store_dwordx3 v[64:66], v3, s[20:23], s36 offen sc1
    s_mov_b32 s36, 3840
    buffer_store_dwordx3 v[68:70], v3, s[20:23], s36 offen sc1
    s_mov_b32 s36, 4608
    buffer_store_dwordx3 v[72:74], v3, s[20:23], s36 offen sc1
    s_mov_b32 s36, 5376
    buffer_store_dwordx3 v[76:78], v3, s[20:23], s36 offen sc1
    s_mov_b32 s36, 6144
    buffer_store_dwordx3 v[80:82], v3, s[20:23], s36 offen sc1
    s_mov_b32 s36, 6912
    buffer_store_dwordx3 v[84:86], v3, s[20:23], s36 offen sc1
    s_mov_b32 s36, 7680
    buffer_store_dwordx3 v[88:90], v3, s[20:23], s36 offen sc1
    s_mov_b32 s36, 8448
    buffer_store_dwordx3 v[92:94], v3, s[20:23], s36 offen sc1
    s_mov_b32 s36, 9216
    buffer_store_dwordx3 v[96:98], v3, s[20:23], s36 offen sc1
    s_mov_b32 s36, 9984
    buffer_store_dwordx3 v[100:102], v3, s[20:23], s36 offen sc1
    s_mov_b32 s36, 10752
    buffer_store_dwordx3 v[104:106], v3, s[20:23], s36 offen sc1
    s_mov_b32 s36, 11520
    buffer_store_dwordx3 v[108:110], v3, s[20:23], s36 offen sc1
    s_mov_b32 s36, 12288
    buffer_store_dwordx3 v[112:114], v3, s[20:23], s36 offen sc1
    s_mov_b32 s36, 13056
    buffer_store_dwordx3 v[116:118], v3, s[20:23], s36 offen sc1
    s_mov_b32 s36, 13824
    buffer_store_dwordx3 v[120:122], v3, s[20:23], s36 offen sc1
    s_mov_b32 s36, 14592
    buffer_store_dwordx3 v[124:126], v3, s[20:23], s36 offen sc1
    v_and_b32 v6, 0x40004000, v5
    v_cmp_ne_u32 vcc, 0, v6
    s_lshl_b32 s35, s39, 4
    s_add_u32 s35, s35, 160328
    v_mov_b32 v10, s35
    s_cmp_lg_u64 vcc, 0
    s_cselect_b32 s36, 1, s55
    v_mov_b32 v11, s36
    ds_write_b32 v10, v11
    s_waitcnt lgkmcnt(0)
    s_barrier
    s_cmp_lg_u32 s39, 0
    s_cbranch_scc1 L_p1_end
    v_and_b32 v6, 15, v0
    v_lshlrev_b32 v6, 4, v6
    v_add_u32 v6, 160320, v6
    ds_read_b128 v[8:11], v6
    s_waitcnt lgkmcnt(0)
    s_nop 1
    v_max_u32_dpp v8, v8, v8 row_shr:1 row_mask:0xf bank_mask:0xf bound_ctrl:0
    s_nop 1
    v_max_u32_dpp v8, v8, v8 row_shr:2 row_mask:0xf bank_mask:0xf bound_ctrl:0
    s_nop 1
    v_max_u32_dpp v8, v8, v8 row_shr:4 row_mask:0xf bank_mask:0xf bound_ctrl:0
    s_nop 1
    v_max_u32_dpp v8, v8, v8 row_shr:8 row_mask:0xf bank_mask:0xf bound_ctrl:0
    s_nop 1
    v_add_f32_dpp v9, v9, v9 row_shr:1 row_mask:0xf bank_mask:0xf bound_ctrl:0
    s_nop 1
    v_add_f32_dpp v9, v9, v9 row_shr:2 row_mask:0xf bank_mask:0xf bound_ctrl:0
    s_nop 1
    v_add_f32_dpp v9, v9, v9 row_shr:4 row_mask:0xf bank_mask:0xf bound_ctrl:0
    s_nop 1
    v_add_f32_dpp v9, v9, v9 row_shr:8 row_mask:0xf bank_mask:0xf bound_ctrl:0
    s_nop 1
    v_or_b32_dpp v10, v10, v10 row_shr:1 row_mask:0xf bank_mask:0xf bound_ctrl:0
    s_nop 1
    v_or_b32_dpp v10, v10, v10 row_shr:2 row_mask:0xf bank_mask:0xf bound_ctrl:0
    s_nop 1
    v_or_b32_dpp v10, v10, v10 row_shr:4 row_mask:0xf bank_mask:0xf bound_ctrl:0
    s_nop 1
    v_or_b32_dpp v10, v10, v10 row_shr:8 row_mask:0xf bank_mask:0xf bound_ctrl:0
    s_lshl_b32 s35, s2, 3
    s_add_u32 s35, s35, 8552960
    v_mov_b32 v6, 0
    v_lshl_or_b32 v8, v10, 16, v8
    s_mov_b64 exec, 0x8000
    buffer_store_dwordx2 v[8:9], v6, s[24:27], s35 offen
    s_lshl_b32 s35, s2, 8
    s_add_u32 s35, s35, 8561152
    buffer_store_dword v6, v6, s[24:27], s35 offen
L_p1_end:
    s_endpgm
.globl p2_kernel
.p2align 8
.type p2_kernel,@function
p2_kernel:
    s_cmp_ge_u32 s2, 256
    s_cbranch_scc1 L_p2_end
    s_load_dwordx2 s[4:5], s[0:1], 104
    s_load_dwordx2 s[30:31], s[0:1], 40
    s_load_dwordx4 s[32:35], s[0:1], 56
    s_load_dwordx4 s[36:39], s[0:1], 72
    s_and_b32 s14, s2, 7
    s_lshr_b32 s49, s2, 3
    s_and_b32 s3, s14, 1
    s_lshl_b32 s3, s3, 5
    s_add_u32 s3, s3, s49
    s_lshr_b32 s12, s14, 1
    v_lshrrev_b32 v112, 6, v0
    v_lshlrev_b32 v1, 4, v0
    v_and_b32 v113, 63, v0
    v_readfirstlane_b32 s13, v112
    v_lshlrev_b32 v115, 4, v113
    s_mul_i32 s14, s12, 65
    s_add_u32 s14, s14, s3
    s_mul_i32 s14, s14, 32896
    s_add_u32 s25, s14, 246292480
    s_mul_i32 s22, s12, 1280000
    s_mov_b32 s2, 0
    s_waitcnt lgkmcnt(0)
    s_mov_b32 s6, 655360000
    s_mov_b32 s7, 0x00020000
    s_add_u32 s8, s4, 254870016
    s_addc_u32 s9, s5, 0
    s_add_u32 s10, s22, 1280000
    s_mov_b32 s11, 0x00020000
    s_add_u32 s15, s25, 0
    buffer_load_dwordx4 v[64:67], v1, s[4:7], s15 offen
    s_add_u32 s15, s25, 32896
    buffer_load_dwordx4 v[72:75], v1, s[4:7], s15 offen
    s_load_dwordx4 s[40:43], s[30:31], 0
    s_load_dwordx16 s[52:67], s[32:33], 0
    s_load_dwordx16 s[68:83], s[34:35], 0
    s_load_dwordx8 s[84:91], s[36:37], 0
    s_load_dwordx8 s[92:99], s[38:39], 0
    v_mov_b32 v52, 0x100
    s_cmp_lg_u32 s13, 0
    s_cbranch_scc1 L_p2_noann
    s_lshl_b32 s14, s3, 8
    s_add_u32 s14, s14, 254853632
    s_mov_b64 exec, 1
    buffer_atomic_add v52, off, s[4:7], s14
    s_mov_b64 exec, -1
L_p2_noann:
    s_and_b32 s14, s49, 3
    s_lshl_b32 s14, s14, 8
    s_lshr_b32 s15, s49, 2
    s_lshl_b32 s15, s15, 14
    s_add_u32 s51, s14, s15
    s_add_u32 s14, s22, 0
    buffer_load_dwordx4 v[88:91], v1, s[8:11], s14 offen
    s_add_u32 s14, s22, 16384
    buffer_load_dwordx4 v[92:95], v1, s[8:11], s14 offen
    s_add_u32 s14, s22, 32768
    buffer_load_dwordx4 v[96:99], v1, s[8:11], s14 offen
    s_add_u32 s14, s22, 49152
    buffer_load_dwordx4 v[100:103], v1, s[8:11], s14 offen
    s_add_u32 s14, s22, 65536
    buffer_load_dwordx4 v[104:107], v1, s[8:11], s14 offen
    s_mov_b32 s15, 254845440
    buffer_load_dwordx4 v[80:83], v115, s[4:7], s15 offen offset:0
    buffer_load_dwordx4 v[84:87], v115, s[4:7], s15 offen offset:1024
    s_add_u32 s15, s25, 16384
    buffer_load_dwordx4 v[68:71], v1, s[4:7], s15 offen
    s_add_u32 s15, s25, 49280
    buffer_load_dwordx4 v[76:79], v1, s[4:7], s15 offen
    v_mul_u32_u24 v2, 12, v113
    v_add_u32 v2, 2816, v2
    v_add_u32 v3, 80000, v1
    v_add_u32 v124, 145536, v1
    v_add_u32 v117, 65536, v1
    v_mov_b32 v116, 0x7f000000
    v_cmp_gt_u32 vcc, 904, v0
    s_mul_i32 s19, s13, 240
    s_add_u32 s19, s19, 160000
    v_cndmask_b32 v124, v116, v124, vcc
    v_cndmask_b32 v117, v116, v117, vcc
    v_lshl_add_u32 v6, v113, 2, s19
    v_lshl_add_u32 v126, v113, 1, s19
    v_cmp_gt_u32 vcc, 14, v113
    s_mul_i32 s27, s13, 15392768
    s_mov_b32 s23, 240512
    v_cndmask_b32 v6, v116, v6, vcc
    s_mov_b32 s44, s4
    s_mov_b32 s45, s5
    s_add_u32 s46, s27, 15400960
    s_mov_b32 s47, 0x00020000
    s_mov_b32 s17, 0x05040100
    s_mov_b32 s18, 80000
    s_and_b32 s50, s3, 1
    s_lshl_b32 s50, s50, 18
    s_sub_u32 s50, 4294836224, s50
    s_mov_b32 s20, 3221209088
    s_mov_b32 s21, 3221209087
    v_mov_b32 v4, 0
    v_mov_b32 v5, 0
    v_mov_b32 v118, 448
    ds_write_b32 v6, v5 offset:160
    ds_write_b16 v126, v118 offset:2
    v_mov_b32 v108, 1073758208
    v_mov_b32 v109, 1073758208
    v_mov_b32 v110, 1073758208
    v_mov_b32 v111, 1073758208
    ds_write_b128 v1, v[108:111] offset:0
    ds_write_b128 v1, v[108:111] offset:16384
    ds_write_b128 v1, v[108:111] offset:32768
    ds_write_b128 v1, v[108:111] offset:49152
    ds_write_b128 v117, v[108:111]
    s_waitcnt lgkmcnt(0)
    v_mov_b32 v53, s40
    v_mov_b32 v54, s41
    v_mov_b32 v56, s42
    v_mov_b32 v57, s43
    s_waitcnt vmcnt(9)
    v_mov_b32 v11, v64
    v_mov_b32 v43, v72
    v_mov_b32 v15, v65
    v_mov_b32 v47, v73
    v_mov_b32 v19, v66
    v_mov_b32 v51, v74
    v_mov_b32 v23, v67
    v_mov_b32 v55, v75
    v_add_u32_sdwa v113, 1, v43 dst_sel:DWORD dst_unused:UNUSED_PAD src0_sel:DWORD src1_sel:WORD_0
    v_lshrrev_b32_sdwa v112, 1, v11 dst_sel:DWORD dst_unused:UNUSED_PAD src0_sel:DWORD src1_sel:WORD_0
    v_lshrrev_b32 v113, 1, v113
    v_sub_u32 v114, v113, v112
    v_add_u32 v113, 448, v113
    s_nop 0
    v_add_u32_dpp v114, v114, v114 row_shr:1 row_mask:0xf bank_mask:0xf bound_ctrl:0
    s_nop 1
    v_add_u32_dpp v114, v114, v114 row_shr:2 row_mask:0xf bank_mask:0xf bound_ctrl:0
    s_nop 1
    v_add_u32_dpp v114, v114, v114 row_shr:4 row_mask:0xf bank_mask:0xf bound_ctrl:0
    s_nop 1
    v_add_u32_dpp v114, v114, v114 row_shr:8 row_mask:0xf bank_mask:0xf bound_ctrl:0
    s_nop 1
    v_add_u32_dpp v114, v114, v114 row_bcast:15 row_mask:0xa bank_mask:0xf
    s_nop 1
    v_add_u32_dpp v114, v114, v114 row_bcast:31 row_mask:0xc bank_mask:0xf
    v_sub_u32 v113, v113, v114
    v_readlane_b32 s29, v114, 63
    v_add_u32 v114, -1, v114
    ds_write_b16 v126, v113
    v_lshlrev_b32_e64 v115, v114, 1
    v_lshrrev_b32 v114, 5, v114
    v_lshl_add_u32 v114, v114, 2, s19
    s_cmp_gt_u32 s29, 448
    s_cselect_b32 s2, 1, s2
    s_cselect_b64 exec, 0, -1
    ds_or_b32 v114, v115 offset:160
    s_mov_b64 exec, -1
    ds_wrxchg_rtn_b32 v7, v6, v5 offset:160
    s_waitcnt lgkmcnt(0)
    v_readlane_b32 s30, v7, 0
    v_readlane_b32 s31, v7, 1
    v_readlane_b32 s32, v7, 2
    v_readlane_b32 s33, v7, 3
    v_readlane_b32 s34, v7, 4
    v_readlane_b32 s35, v7, 5
    v_readlane_b32 s36, v7, 6
    v_readlane_b32 s37, v7, 7
    v_readlane_b32 s38, v7, 8
    v_readlane_b32 s39, v7, 9
    v_readlane_b32 s40, v7, 10
    v_readlane_b32 s41, v7, 11
    s_mov_b32 s25, s19
    s_mov_b32 s26, s27
    s_mov_b32 s28, s29
    v_mbcnt_lo_u32_b32 v8, s30, 0
    v_mbcnt_hi_u32_b32 v8, s31, v8
    s_bcnt1_i32_b64 s14, s[30:31]
    v_lshl_add_u32 v9, v8, 1, s25
    ds_read_u16 v9, v9
    v_mad_u32_u24 v8, v8, s23, v2
    s_mov_b32 s30, s26
    s_lshl1_add_u32 s25, s14, s25
    s_mul_i32 s14, s14, s23
    s_add_u32 s26, s26, s14
    v_mbcnt_lo_u32_b32 v12, s32, 0
    v_mbcnt_hi_u32_b32 v12, s33, v12
    s_bcnt1_i32_b64 s14, s[32:33]
    v_lshl_add_u32 v13, v12, 1, s25
    ds_read_u16 v13, v13
    v_mad_u32_u24 v12, v12, s23, v2
    s_mov_b32 s32, s26
    s_lshl1_add_u32 s25, s14, s25
    s_mul_i32 s14, s14, s23
    s_add_u32 s26, s26, s14
    v_mbcnt_lo_u32_b32 v16, s34, 0
    v_mbcnt_hi_u32_b32 v16, s35, v16
    s_bcnt1_i32_b64 s14, s[34:35]
    v_lshl_add_u32 v17, v16, 1, s25
    ds_read_u16 v17, v17
    v_mad_u32_u24 v16, v16, s23, v2
    s_mov_b32 s34, s26
    s_lshl1_add_u32 s25, s14, s25
    s_mul_i32 s14, s14, s23
    s_add_u32 s26, s26, s14
    v_mbcnt_lo_u32_b32 v20, s36, 0
    v_mbcnt_hi_u32_b32 v20, s37, v20
    s_bcnt1_i32_b64 s14, s[36:37]
    v_lshl_add_u32 v21, v20, 1, s25
    ds_read_u16 v21, v21
    v_mad_u32_u24 v20, v20, s23, v2
    s_mov_b32 s36, s26
    s_lshl1_add_u32 s25, s14, s25
    s_mul_i32 s14, s14, s23
    s_add_u32 s26, s26, s14
    v_mbcnt_lo_u32_b32 v24, s38, 0
    v_mbcnt_hi_u32_b32 v24, s39, v24
    s_bcnt1_i32_b64 s14, s[38:39]
    v_lshl_add_u32 v25, v24, 1, s25
    ds_read_u16 v25, v25
    v_mad_u32_u24 v24, v24, s23, v2
    s_mov_b32 s38, s26
    s_lshl1_add_u32 s25, s14, s25
    s_mul_i32 s14, s14, s23
    s_add_u32 s26, s26, s14
    v_mbcnt_lo_u32_b32 v28, s40, 0
    v_mbcnt_hi_u32_b32 v28, s41, v28
    s_bcnt1_i32_b64 s14, s[40:41]
    v_lshl_add_u32 v29, v28, 1, s25
    ds_read_u16 v29, v29
    v_mad_u32_u24 v28, v28, s23, v2
    s_mov_b32 s40, s26
    s_lshl1_add_u32 s25, s14, s25
    s_mul_i32 s14, s14, s23
    s_add_u32 s26, s26, s14
    s_waitcnt lgkmcnt(5)
    v_mad_u32_u24 v8, v9, 12, v8
    buffer_load_dwordx3 v[8:10], v8, s[44:47], s30 offen offset:0
    s_waitcnt lgkmcnt(4)
    v_mad_u32_u24 v12, v13, 12, v12
    buffer_load_dwordx3 v[12:14], v12, s[44:47], s32 offen offset:768
    s_waitcnt lgkmcnt(3)
    v_mad_u32_u24 v16, v17, 12, v16
    buffer_load_dwordx3 v[16:18], v16, s[44:47], s34 offen offset:1536
    s_waitcnt lgkmcnt(2)
    v_mad_u32_u24 v20, v21, 12, v20
    buffer_load_dwordx3 v[20:22], v20, s[44:47], s36 offen offset:2304
    s_waitcnt lgkmcnt(1)
    v_mad_u32_u24 v24, v25, 12, v24
    buffer_load_dwordx3 v[24:26], v24, s[44:47], s38 offen offset:3072
    s_waitcnt lgkmcnt(0)
    v_mad_u32_u24 v28, v29, 12, v28
    buffer_load_dwordx3 v[28:30], v28, s[44:47], s40 offen offset:3840
    s_cmp_le_u32 s28, 384
    s_cbranch_scc1 L_p2_kernel_norare_1
    v_readlane_b32 s42, v7, 12
    v_readlane_b32 s43, v7, 13
    s_nop 1
    v_mbcnt_lo_u32_b32 v120, s42, 0
    v_mbcnt_hi_u32_b32 v120, s43, v120
    s_bcnt1_i32_b64 s14, s[42:43]
    v_lshl_add_u32 v121, v120, 1, s25
    ds_read_u16 v121, v121
    v_mad_u32_u24 v120, v120, s23, v2
    s_mov_b32 s42, s26
    s_lshl1_add_u32 s25, s14, s25
    s_mul_i32 s14, s14, s23
    s_add_u32 s26, s26, s14
    s_waitcnt lgkmcnt(0)
    s_add_u32 s42, s42, 4608
    v_mad_u32_u24 v120, v121, 12, v120
    buffer_load_dwordx3 v[32:34], v120, s[44:47], s42 offen offset:0
L_p2_kernel_norare_1:
    s_waitcnt vmcnt(10)
    ds_write_b128 v3, v[88:91] offset:0
    ds_write_b128 v3, v[92:95] offset:16384
    ds_write_b128 v3, v[96:99] offset:32768
    ds_write_b128 v3, v[100:103] offset:49152
    ds_write_b128 v124, v[104:107]
    s_waitcnt vmcnt(6)
    v_mov_b32 v27, v68
    v_mov_b32 v59, v76
    v_mov_b32 v31, v69
    v_mov_b32 v63, v77
    v_mov_b32 v35, v70
    v_mov_b32 v122, v78
    v_mov_b32 v39, v71
    v_mov_b32 v123, v79
    v_max3_u32 v36, v80, v82, v84
    v_add_f32 v37, v81, v83
    v_add_f32 v38, v85, v87
    v_max_u32 v36, v36, v86
    v_add_f32 v37, v37, v38
    v_cmp_lt_u32 vcc, 0xffff, v36
    s_nop 1
    v_max_u32_dpp v36, v36, v36 row_shr:1 row_mask:0xf bank_mask:0xf bound_ctrl:0
    s_nop 1
    v_max_u32_dpp v36, v36, v36 row_shr:2 row_mask:0xf bank_mask:0xf bound_ctrl:0
    s_nop 1
    v_max_u32_dpp v36, v36, v36 row_shr:4 row_mask:0xf bank_mask:0xf bound_ctrl:0
    s_nop 1
    v_max_u32_dpp v36, v36, v36 row_shr:8 row_mask:0xf bank_mask:0xf bound_ctrl:0
    s_nop 1
    v_max_u32_dpp v36, v36, v36 row_bcast:15 row_mask:0xa bank_mask:0xf
    s_nop 1
    v_max_u32_dpp v36, v36, v36 row_bcast:31 row_mask:0xc bank_mask:0xf
    s_nop 1
    v_add_f32_dpp v37, v37, v37 row_shr:1 row_mask:0xf bank_mask:0xf bound_ctrl:0
    s_nop 1
    v_add_f32_dpp v37, v37, v37 row_shr:2 row_mask:0xf bank_mask:0xf bound_ctrl:0
    s_nop 1
    v_add_f32_dpp v37, v37, v37 row_shr:4 row_mask:0xf bank_mask:0xf bound_ctrl:0
    s_nop 1
    v_add_f32_dpp v37, v37, v37 row_shr:8 row_mask:0xf bank_mask:0xf bound_ctrl:0
    s_nop 1
    v_add_f32_dpp v37, v37, v37 row_bcast:15 row_mask:0xa bank_mask:0xf
    s_nop 1
    v_add_f32_dpp v37, v37, v37 row_bcast:31 row_mask:0xc bank_mask:0xf
    s_cmp_lg_u64 vcc, 0
    s_cselect_b32 s2, 1, s2
    v_lshlrev_b32 v36, 16, v36
    v_mul_f32 v38, 936490775, v37
    v_mul_f32 v37, 928531664, v37
    v_cmp_nle_f32 vcc, v36, v38
    v_max_u32 v36, v36, v37
    s_nop 0
    v_readlane_b32 s14, v36, 63
    s_bitcmp1_b32 vcc_hi, 31
    s_cselect_b32 s2, 1, s2
    s_lshr_b32 s14, s14, 23
    s_add_u32 s14, s14, 1
    s_cmp_lt_u32 s14, 40
    s_cselect_b32 s2, 1, s2
    s_cmp_gt_u32 s14, 230
    s_cselect_b32 s2, 1, s2
    s_sub_u32 s48, s14, 14
    s_lshl_b32 s48, s48, 23
    s_add_u32 s16, s48, 197148672
    s_sub_u32 s14, s14, 40
    s_cmp_gt_u32 s14, 190
    s_cselect_b32 s48, 0, s48
    v_lshlrev_b32 v36, 16, v53
    v_and_b32 v37, 0xffff0000, v53
    v_lshlrev_b32 v40, 16, v54
    v_and_b32 v41, 0xffff0000, v54
    v_lshlrev_b32 v44, 16, v56
    v_and_b32 v45, 0xffff0000, v56
    v_lshlrev_b32 v48, 16, v57
    v_and_b32 v49, 0xffff0000, v57
    v_mul_f32 v36, 1081284368, v36
    v_mul_f32 v37, 1081284368, v37
    v_mul_f32 v40, 1081284368, v40
    v_mul_f32 v41, 1081284368, v41
    v_mul_f32 v44, 1081284368, v44
    v_mul_f32 v45, 1081284368, v45
    v_mul_f32 v48, 1081284368, v48
    v_mul_f32 v49, 1081284368, v49
    s_waitcnt lgkmcnt(0)
    s_barrier
    s_add_u32 s14, s22, 80000
    buffer_load_dwordx4 v[88:91], v1, s[8:11], s14 offen
    s_add_u32 s14, s22, 96384
    buffer_load_dwordx4 v[92:95], v1, s[8:11], s14 offen
    s_add_u32 s14, s22, 112768
    buffer_load_dwordx4 v[96:99], v1, s[8:11], s14 offen
    v_add_u32_sdwa v113, 1, v43 dst_sel:DWORD dst_unused:UNUSED_PAD src0_sel:DWORD src1_sel:WORD_1
    v_lshrrev_b32_sdwa v112, 1, v11 dst_sel:DWORD dst_unused:UNUSED_PAD src0_sel:DWORD src1_sel:WORD_1
    v_lshrrev_b32 v113, 1, v113
    v_sub_u32 v114, v113, v112
    v_add_u32 v113, 448, v113
    s_nop 0
    v_add_u32_dpp v114, v114, v114 row_shr:1 row_mask:0xf bank_mask:0xf bound_ctrl:0
    s_nop 1
    v_add_u32_dpp v114, v114, v114 row_shr:2 row_mask:0xf bank_mask:0xf bound_ctrl:0
    s_nop 1
    v_add_u32_dpp v114, v114, v114 row_shr:4 row_mask:0xf bank_mask:0xf bound_ctrl:0
    s_nop 1
    v_add_u32_dpp v114, v114, v114 row_shr:8 row_mask:0xf bank_mask:0xf bound_ctrl:0
    s_nop 1
    v_add_u32_dpp v114, v114, v114 row_bcast:15 row_mask:0xa bank_mask:0xf
    s_nop 1
    v_add_u32_dpp v114, v114, v114 row_bcast:31 row_mask:0xc bank_mask:0xf
    v_sub_u32 v113, v113, v114
    v_readlane_b32 s29, v114, 63
    v_add_u32 v114, -1, v114
    ds_write_b16 v126, v113
    v_lshlrev_b32_e64 v115, v114, 1
    v_lshrrev_b32 v114, 5, v114
    v_lshl_add_u32 v114, v114, 2, s19
    s_cmp_gt_u32 s29, 448
    s_cselect_b32 s2, 1, s2
    s_cselect_b64 exec, 0, -1
    ds_or_b32 v114, v115 offset:160
    s_mov_b64 exec, -1
    ds_wrxchg_rtn_b32 v7, v6, v5 offset:160
    s_mov_b32 s24, 0
L_p2_loop:
    s_cmp_le_u32 s28, 384
    s_cbranch_scc1 L_p2_kernel_norare2_2
    s_waitcnt vmcnt(0)
    v_mad_u32_u16 v64, v32, 8, s18
    v_mad_u32_u16 v66, v33, 8, s18
    ds_read_b64 v[64:65], v64
    ds_read_b64 v[66:67], v66
    v_and_b32 v112, 0xffff, v34
    v_lshrrev_b32 v114, 16, v34
    v_lshlrev_b32 v113, 16, v34
    v_and_b32 v34, 0xffff0000, v34
    v_mad_u32_u16 v32, v32, 8, s50 op_sel:[1,0,0,0]
    v_mad_u32_u16 v33, v33, 8, s50 op_sel:[1,0,0,0]
    s_waitcnt lgkmcnt(0)
    v_dot2_f32_bf16 v115, v64, v112, s16
    v_dot2_f32_bf16 v64, v64, v113, s16
    v_dot2_f32_bf16 v116, v65, v112, s16
    v_dot2_f32_bf16 v65, v65, v113, s16
    v_dot2_f32_bf16 v117, v66, v114, s16
    v_dot2_f32_bf16 v66, v66, v34, s16
    v_dot2_f32_bf16 v118, v67, v114, s16
    v_dot2_f32_bf16 v67, v67, v34, s16
    v_perm_b32 v64, v64, v115, s17
    v_perm_b32 v65, v65, v116, s17
    v_perm_b32 v66, v66, v117, s17
    v_perm_b32 v67, v67, v118, s17
    v_lshl_add_u64 v[64:65], v[64:65], 0, s[20:21]
    v_lshl_add_u64 v[66:67], v[66:67], 0, s[20:21]
    v_or3_b32 v4, v108, v109, v4
    v_or3_b32 v4, v110, v111, v4
    ds_add_rtn_u64 v[108:109], v32, v[64:65]
    ds_add_rtn_u64 v[110:111], v33, v[66:67]
    s_waitcnt lgkmcnt(0)
L_p2_kernel_norare2_2:
    s_add_u32 s22, s22, 80000
    s_lshl_b32 s14, s13, 4
    s_or_b32 s14, s14, s24
    s_cmp_lg_u32 s14, 5
    s_cbranch_scc1 L_p2_nost
    v_mov_b32 v52, 0
    s_lshl_b32 s14, s3, 8
    s_add_u32 s14, s14, 254853632
    s_mov_b64 exec, 1
    buffer_atomic_add v52, off, s[4:7], s14 sc0
    s_mov_b64 exec, -1
L_p2_nost:
    s_waitcnt vmcnt(8)
    v_mad_u32_u16 v64, v8, 8, s18
    v_mad_u32_u16 v66, v9, 8, s18
    ds_read_b64 v[64:65], v64
    ds_read_b64 v[66:67], v66
    s_add_u32 s14, s22, 49152
    buffer_load_dwordx4 v[100:103], v1, s[8:11], s14 offen
    s_waitcnt vmcnt(8)
    v_mad_u32_u16 v68, v12, 8, s18
    v_mad_u32_u16 v70, v13, 8, s18
    ds_read_b64 v[68:69], v68
    ds_read_b64 v[70:71], v70
    s_add_u32 s14, s22, 65536
    buffer_load_dwordx4 v[104:107], v1, s[8:11], s14 offen
    s_waitcnt vmcnt(8)
    v_mad_u32_u16 v72, v16, 8, s18
    v_mad_u32_u16 v74, v17, 8, s18
    ds_read_b64 v[72:73], v72
    ds_read_b64 v[74:75], v74
    s_waitcnt lgkmcnt(6)
    v_readlane_b32 s30, v7, 0
    v_readlane_b32 s31, v7, 1
    v_readlane_b32 s32, v7, 2
    v_readlane_b32 s33, v7, 3
    v_readlane_b32 s34, v7, 4
    v_readlane_b32 s35, v7, 5
    v_readlane_b32 s36, v7, 6
    v_readlane_b32 s37, v7, 7
    v_readlane_b32 s38, v7, 8
    v_readlane_b32 s39, v7, 9
    v_readlane_b32 s40, v7, 10
    v_readlane_b32 s41, v7, 11
    s_mov_b32 s25, s19
    s_mov_b32 s26, s27
    s_mov_b32 s28, s29
    v_mbcnt_lo_u32_b32 v120, s30, 0
    v_mbcnt_hi_u32_b32 v120, s31, v120
    s_bcnt1_i32_b64 s14, s[30:31]
    v_lshl_add_u32 v121, v120, 1, s25
    ds_read_u16 v121, v121
    v_mad_u32_u24 v120, v120, s23, v2
    s_mov_b32 s30, s26
    s_lshl1_add_u32 s25, s14, s25
    s_mul_i32 s14, s14, s23
    s_add_u32 s26, s26, s14
    v_and_b32 v112, 0xffff, v10
    v_lshrrev_b32 v114, 16, v10
    v_lshlrev_b32 v113, 16, v10
    v_and_b32 v10, 0xffff0000, v10
    v_mad_u32_u16 v8, v8, 8, s50 op_sel:[1,0,0,0]
    v_mad_u32_u16 v9, v9, 8, s50 op_sel:[1,0,0,0]
    s_waitcnt lgkmcnt(5)
    v_dot2_f32_bf16 v115, v64, v112, s16
    v_dot2_f32_bf16 v64, v64, v113, s16
    v_dot2_f32_bf16 v116, v65, v112, s16
    v_dot2_f32_bf16 v65, v65, v113, s16
    v_dot2_f32_bf16 v117, v66, v114, s16
    v_dot2_f32_bf16 v66, v66, v10, s16
    v_dot2_f32_bf16 v118, v67, v114, s16
    v_dot2_f32_bf16 v67, v67, v10, s16
    v_perm_b32 v64, v64, v115, s17
    v_perm_b32 v65, v65, v116, s17
    v_perm_b32 v66, v66, v117, s17
    v_perm_b32 v67, v67, v118, s17
    v_lshl_add_u64 v[64:65], v[64:65], 0, s[20:21]
    v_lshl_add_u64 v[66:67], v[66:67], 0, s[20:21]
    v_or3_b32 v4, v108, v109, v4
    v_or3_b32 v4, v110, v111, v4
    ds_add_rtn_u64 v[108:109], v8, v[64:65]
    ds_add_rtn_u64 v[110:111], v9, v[66:67]
    s_waitcnt lgkmcnt(2)
    v_mad_u32_u24 v120, v121, 12, v120
    buffer_load_dwordx3 v[8:10], v120, s[44:47], s30 offen offset:0
    s_waitcnt vmcnt(8)
    v_mad_u32_u16 v76, v20, 8, s18
    v_mad_u32_u16 v78, v21, 8, s18
    ds_read_b64 v[76:77], v76
    ds_read_b64 v[78:79], v78
    v_mbcnt_lo_u32_b32 v120, s32, 0
    v_mbcnt_hi_u32_b32 v120, s33, v120
    s_bcnt1_i32_b64 s14, s[32:33]
    v_lshl_add_u32 v121, v120, 1, s25
    ds_read_u16 v121, v121
    v_mad_u32_u24 v120, v120, s23, v2
    s_mov_b32 s32, s26
    s_lshl1_add_u32 s25, s14, s25
    s_mul_i32 s14, s14, s23
    s_add_u32 s26, s26, s14
    v_and_b32 v112, 0xffff, v14
    v_lshrrev_b32 v114, 16, v14
    v_lshlrev_b32 v113, 16, v14
    v_and_b32 v14, 0xffff0000, v14
    v_mad_u32_u16 v12, v12, 8, s50 op_sel:[1,0,0,0]
    v_mad_u32_u16 v13, v13, 8, s50 op_sel:[1,0,0,0]
    v_dot2_f32_bf16 v115, v68, v112, s16
    v_dot2_f32_bf16 v68, v68, v113, s16
    v_dot2_f32_bf16 v116, v69, v112, s16
    v_dot2_f32_bf16 v69, v69, v113, s16
    v_dot2_f32_bf16 v117, v70, v114, s16
    v_dot2_f32_bf16 v70, v70, v14, s16
    v_dot2_f32_bf16 v118, v71, v114, s16
    v_dot2_f32_bf16 v71, v71, v14, s16
    v_perm_b32 v68, v68, v115, s17
    v_perm_b32 v69, v69, v116, s17
    v_perm_b32 v70, v70, v117, s17
    v_perm_b32 v71, v71, v118, s17
    v_lshl_add_u64 v[68:69], v[68:69], 0, s[20:21]
    v_lshl_add_u64 v[70:71], v[70:71], 0, s[20:21]
    s_waitcnt lgkmcnt(3)
    v_or3_b32 v4, v108, v109, v4
    v_or3_b32 v4, v110, v111, v4
    ds_add_rtn_u64 v[108:109], v12, v[68:69]
    ds_add_rtn_u64 v[110:111], v13, v[70:71]
    s_waitcnt lgkmcnt(2)
    v_mad_u32_u24 v120, v121, 12, v120
    buffer_load_dwordx3 v[12:14], v120, s[44:47], s32 offen offset:768
    s_waitcnt vmcnt(8)
    v_mad_u32_u16 v80, v24, 8, s18
    v_mad_u32_u16 v82, v25, 8, s18
    ds_read_b64 v[80:81], v80
    ds_read_b64 v[82:83], v82
    s_waitcnt vmcnt(7)
    v_mad_u32_u16 v84, v28, 8, s18
    v_mad_u32_u16 v86, v29, 8, s18
    ds_read_b64 v[84:85], v84
    ds_read_b64 v[86:87], v86
    v_mbcnt_lo_u32_b32 v120, s34, 0
    v_mbcnt_hi_u32_b32 v120, s35, v120
    s_bcnt1_i32_b64 s14, s[34:35]
    v_lshl_add_u32 v121, v120, 1, s25
    ds_read_u16 v121, v121
    v_mad_u32_u24 v120, v120, s23, v2
    s_mov_b32 s34, s26
    s_lshl1_add_u32 s25, s14, s25
    s_mul_i32 s14, s14, s23
    s_add_u32 s26, s26, s14
    v_and_b32 v112, 0xffff, v18
    v_lshrrev_b32 v114, 16, v18
    v_lshlrev_b32 v113, 16, v18
    v_and_b32 v18, 0xffff0000, v18
    v_mad_u32_u16 v16, v16, 8, s50 op_sel:[1,0,0,0]
    v_mad_u32_u16 v17, v17, 8, s50 op_sel:[1,0,0,0]
    v_dot2_f32_bf16 v115, v72, v112, s16
    v_dot2_f32_bf16 v72, v72, v113, s16
    v_dot2_f32_bf16 v116, v73, v112, s16
    v_dot2_f32_bf16 v73, v73, v113, s16
    v_dot2_f32_bf16 v117, v74, v114, s16
    v_dot2_f32_bf16 v74, v74, v18, s16
    v_dot2_f32_bf16 v118, v75, v114, s16
    v_dot2_f32_bf16 v75, v75, v18, s16
    v_perm_b32 v72, v72, v115, s17
    v_perm_b32 v73, v73, v116, s17
    v_perm_b32 v74, v74, v117, s17
    v_perm_b32 v75, v75, v118, s17
    v_lshl_add_u64 v[72:73], v[72:73], 0, s[20:21]
    v_lshl_add_u64 v[74:75], v[74:75], 0, s[20:21]
    s_waitcnt lgkmcnt(5)
    v_or3_b32 v4, v108, v109, v4
    v_or3_b32 v4, v110, v111, v4
    ds_add_rtn_u64 v[108:109], v16, v[72:73]
    ds_add_rtn_u64 v[110:111], v17, v[74:75]
    s_waitcnt lgkmcnt(2)
    v_mad_u32_u24 v120, v121, 12, v120
    buffer_load_dwordx3 v[16:18], v120, s[44:47], s34 offen offset:1536
    s_barrier
    s_waitcnt vmcnt(3)
    ds_write_b128 v3, v[88:91] offset:0
    ds_write_b128 v3, v[92:95] offset:16384
    ds_write_b128 v3, v[96:99] offset:32768
    ds_write_b128 v3, v[100:103] offset:49152
    ds_write_b128 v124, v[104:107]
    v_mbcnt_lo_u32_b32 v120, s36, 0
    v_mbcnt_hi_u32_b32 v120, s37, v120
    s_bcnt1_i32_b64 s14, s[36:37]
    v_lshl_add_u32 v121, v120, 1, s25
    ds_read_u16 v121, v121
    v_mad_u32_u24 v120, v120, s23, v2
    s_mov_b32 s36, s26
    s_lshl1_add_u32 s25, s14, s25
    s_mul_i32 s14, s14, s23
    s_add_u32 s26, s26, s14
    v_and_b32 v112, 0xffff, v22
    v_lshrrev_b32 v114, 16, v22
    v_lshlrev_b32 v113, 16, v22
    v_and_b32 v22, 0xffff0000, v22
    v_mad_u32_u16 v20, v20, 8, s50 op_sel:[1,0,0,0]
    v_mad_u32_u16 v21, v21, 8, s50 op_sel:[1,0,0,0]
    v_dot2_f32_bf16 v115, v76, v112, s16
    v_dot2_f32_bf16 v76, v76, v113, s16
    v_dot2_f32_bf16 v116, v77, v112, s16
    v_dot2_f32_bf16 v77, v77, v113, s16
    v_dot2_f32_bf16 v117, v78, v114, s16
    v_dot2_f32_bf16 v78, v78, v22, s16
    v_dot2_f32_bf16 v118, v79, v114, s16
    v_dot2_f32_bf16 v79, v79, v22, s16
    v_perm_b32 v76, v76, v115, s17
    v_perm_b32 v77, v77, v116, s17
    v_perm_b32 v78, v78, v117, s17
    v_perm_b32 v79, v79, v118, s17
    v_lshl_add_u64 v[76:77], v[76:77], 0, s[20:21]
    v_lshl_add_u64 v[78:79], v[78:79], 0, s[20:21]
    s_waitcnt lgkmcnt(6)
    v_or3_b32 v4, v108, v109, v4
    v_or3_b32 v4, v110, v111, v4
    ds_add_rtn_u64 v[108:109], v20, v[76:77]
    ds_add_rtn_u64 v[110:111], v21, v[78:79]
    s_waitcnt lgkmcnt(2)
    v_mad_u32_u24 v120, v121, 12, v120
    buffer_load_dwordx3 v[20:22], v120, s[44:47], s36 offen offset:2304
    v_mbcnt_lo_u32_b32 v120, s38, 0
    v_mbcnt_hi_u32_b32 v120, s39, v120
    s_bcnt1_i32_b64 s14, s[38:39]
    v_lshl_add_u32 v121, v120, 1, s25
    ds_read_u16 v121, v121
    v_mad_u32_u24 v120, v120, s23, v2
    s_mov_b32 s38, s26
    s_lshl1_add_u32 s25, s14, s25
    s_mul_i32 s14, s14, s23
    s_add_u32 s26, s26, s14
    v_and_b32 v112, 0xffff, v26
    v_lshrrev_b32 v114, 16, v26
    v_lshlrev_b32 v113, 16, v26
    v_and_b32 v26, 0xffff0000, v26
    v_mad_u32_u16 v24, v24, 8, s50 op_sel:[1,0,0,0]
    v_mad_u32_u16 v25, v25, 8, s50 op_sel:[1,0,0,0]
    v_dot2_f32_bf16 v115, v80, v112, s16
    v_dot2_f32_bf16 v80, v80, v113, s16
    v_dot2_f32_bf16 v116, v81, v112, s16
    v_dot2_f32_bf16 v81, v81, v113, s16
    v_dot2_f32_bf16 v117, v82, v114, s16
    v_dot2_f32_bf16 v82, v82, v26, s16
    v_dot2_f32_bf16 v118, v83, v114, s16
    v_dot2_f32_bf16 v83, v83, v26, s16
    v_perm_b32 v80, v80, v115, s17
    v_perm_b32 v81, v81, v116, s17
    v_perm_b32 v82, v82, v117, s17
    v_perm_b32 v83, v83, v118, s17
    v_lshl_add_u64 v[80:81], v[80:81], 0, s[20:21]
    v_lshl_add_u64 v[82:83], v[82:83], 0, s[20:21]
    s_waitcnt lgkmcnt(1)
    v_or3_b32 v4, v108, v109, v4
    v_or3_b32 v4, v110, v111, v4
    ds_add_rtn_u64 v[108:109], v24, v[80:81]
    ds_add_rtn_u64 v[110:111], v25, v[82:83]
    s_waitcnt lgkmcnt(2)
    v_mad_u32_u24 v120, v121, 12, v120
    buffer_load_dwordx3 v[24:26], v120, s[44:47], s38 offen offset:3072
    v_mbcnt_lo_u32_b32 v120, s40, 0
    v_mbcnt_hi_u32_b32 v120, s41, v120
    s_bcnt1_i32_b64 s14, s[40:41]
    v_lshl_add_u32 v121, v120, 1, s25
    ds_read_u16 v121, v121
    v_mad_u32_u24 v120, v120, s23, v2
    s_mov_b32 s40, s26
    s_lshl1_add_u32 s25, s14, s25
    s_mul_i32 s14, s14, s23
    s_add_u32 s26, s26, s14
    v_and_b32 v112, 0xffff, v30
    v_lshrrev_b32 v114, 16, v30
    v_lshlrev_b32 v113, 16, v30
    v_and_b32 v30, 0xffff0000, v30
    v_mad_u32_u16 v28, v28, 8, s50 op_sel:[1,0,0,0]
    v_mad_u32_u16 v29, v29, 8, s50 op_sel:[1,0,0,0]
    v_dot2_f32_bf16 v115, v84, v112, s16
    v_dot2_f32_bf16 v84, v84, v113, s16
    v_dot2_f32_bf16 v116, v85, v112, s16
    v_dot2_f32_bf16 v85, v85, v113, s16
    v_dot2_f32_bf16 v117, v86, v114, s16
    v_dot2_f32_bf16 v86, v86, v30, s16
    v_dot2_f32_bf16 v118, v87, v114, s16
    v_dot2_f32_bf16 v87, v87, v30, s16
    v_perm_b32 v84, v84, v115, s17
    v_perm_b32 v85, v85, v116, s17
    v_perm_b32 v86, v86, v117, s17
    v_perm_b32 v87, v87, v118, s17
    v_lshl_add_u64 v[84:85], v[84:85], 0, s[20:21]
    v_lshl_add_u64 v[86:87], v[86:87], 0, s[20:21]
    s_waitcnt lgkmcnt(1)
    v_or3_b32 v4, v108, v109, v4
    v_or3_b32 v4, v110, v111, v4
    ds_add_rtn_u64 v[108:109], v28, v[84:85]
    ds_add_rtn_u64 v[110:111], v29, v[86:87]
    s_waitcnt lgkmcnt(2)
    v_mad_u32_u24 v120, v121, 12, v120
    buffer_load_dwordx3 v[28:30], v120, s[44:47], s40 offen offset:3840
    s_cmp_le_u32 s28, 384
    s_cbranch_scc1 L_p2_kernel_norare_3
    v_readlane_b32 s42, v7, 12
    v_readlane_b32 s43, v7, 13
    s_nop 1
    v_mbcnt_lo_u32_b32 v120, s42, 0
    v_mbcnt_hi_u32_b32 v120, s43, v120
    s_bcnt1_i32_b64 s14, s[42:43]
    v_lshl_add_u32 v121, v120, 1, s25
    ds_read_u16 v121, v121
    v_mad_u32_u24 v120, v120, s23, v2
    s_mov_b32 s42, s26
    s_lshl1_add_u32 s25, s14, s25
    s_mul_i32 s14, s14, s23
    s_add_u32 s26, s26, s14
    s_waitcnt lgkmcnt(0)
    s_add_u32 s42, s42, 4608
    v_mad_u32_u24 v120, v121, 12, v120
    buffer_load_dwordx3 v[32:34], v120, s[44:47], s42 offen offset:0
L_p2_kernel_norare_3:
    v_mov_b32 v11, v15
    v_mov_b32 v43, v47
    v_mov_b32 v15, v19
    v_mov_b32 v47, v51
    v_mov_b32 v19, v23
    v_mov_b32 v51, v55
    v_mov_b32 v23, v27
    v_mov_b32 v55, v59
    v_mov_b32 v27, v31
    v_mov_b32 v59, v63
    v_mov_b32 v31, v35
    v_mov_b32 v63, v122
    v_mov_b32 v35, v39
    v_mov_b32 v122, v123
    v_mov_b32 v39, 0
    v_mov_b32 v123, 0
    v_add_u32_sdwa v113, 1, v43 dst_sel:DWORD dst_unused:UNUSED_PAD src0_sel:DWORD src1_sel:WORD_0
    v_lshrrev_b32_sdwa v112, 1, v11 dst_sel:DWORD dst_unused:UNUSED_PAD src0_sel:DWORD src1_sel:WORD_0
    v_lshrrev_b32 v113, 1, v113
    v_sub_u32 v114, v113, v112
    v_add_u32 v113, 448, v113
    s_nop 0
    v_add_u32_dpp v114, v114, v114 row_shr:1 row_mask:0xf bank_mask:0xf bound_ctrl:0
    s_nop 1
    v_add_u32_dpp v114, v114, v114 row_shr:2 row_mask:0xf bank_mask:0xf bound_ctrl:0
    s_nop 1
    v_add_u32_dpp v114, v114, v114 row_shr:4 row_mask:0xf bank_mask:0xf bound_ctrl:0
    s_nop 1
    v_add_u32_dpp v114, v114, v114 row_shr:8 row_mask:0xf bank_mask:0xf bound_ctrl:0
    s_nop 1
    v_add_u32_dpp v114, v114, v114 row_bcast:15 row_mask:0xa bank_mask:0xf
    s_nop 1
    v_add_u32_dpp v114, v114, v114 row_bcast:31 row_mask:0xc bank_mask:0xf
    v_sub_u32 v113, v113, v114
    v_readlane_b32 s29, v114, 63
    v_add_u32 v114, -1, v114
    ds_write_b16 v126, v113
    v_lshlrev_b32_e64 v115, v114, 1
    v_lshrrev_b32 v114, 5, v114
    v_lshl_add_u32 v114, v114, 2, s19
    s_cmp_gt_u32 s29, 448
    s_cselect_b32 s2, 1, s2
    s_cselect_b64 exec, 0, -1
    ds_or_b32 v114, v115 offset:160
    s_mov_b64 exec, -1
    ds_wrxchg_rtn_b32 v7, v6, v5 offset:160
    s_add_u32 s14, s22, 80000
    buffer_load_dwordx4 v[88:91], v1, s[8:11], s14 offen
    s_add_u32 s14, s22, 96384
    buffer_load_dwordx4 v[92:95], v1, s[8:11], s14 offen
    s_add_u32 s14, s22, 112768
    buffer_load_dwordx4 v[96:99], v1, s[8:11], s14 offen
    s_barrier
    s_cmp_le_u32 s28, 384
    s_cbranch_scc1 L_p2_kernel_norare2_4
    s_waitcnt vmcnt(0)
    v_mad_u32_u16 v64, v32, 8, s18
    v_mad_u32_u16 v66, v33, 8, s18
    ds_read_b64 v[64:65], v64
    ds_read_b64 v[66:67], v66
    v_and_b32 v112, 0xffff, v34
    v_lshrrev_b32 v114, 16, v34
    v_lshlrev_b32 v113, 16, v34
    v_and_b32 v34, 0xffff0000, v34
    v_mad_u32_u16 v32, v32, 8, s50 op_sel:[1,0,0,0]
    v_mad_u32_u16 v33, v33, 8, s50 op_sel:[1,0,0,0]
    s_waitcnt lgkmcnt(0)
    v_dot2_f32_bf16 v115, v64, v112, s16
    v_dot2_f32_bf16 v64, v64, v113, s16
    v_dot2_f32_bf16 v116, v65, v112, s16
    v_dot2_f32_bf16 v65, v65, v113, s16
    v_dot2_f32_bf16 v117, v66, v114, s16
    v_dot2_f32_bf16 v66, v66, v34, s16
    v_dot2_f32_bf16 v118, v67, v114, s16
    v_dot2_f32_bf16 v67, v67, v34, s16
    v_perm_b32 v64, v64, v115, s17
    v_perm_b32 v65, v65, v116, s17
    v_perm_b32 v66, v66, v117, s17
    v_perm_b32 v67, v67, v118, s17
    v_lshl_add_u64 v[64:65], v[64:65], 0, s[20:21]
    v_lshl_add_u64 v[66:67], v[66:67], 0, s[20:21]
    v_or3_b32 v4, v108, v109, v4
    v_or3_b32 v4, v110, v111, v4
    ds_add_rtn_u64 v[108:109], v32, v[64:65]
    ds_add_rtn_u64 v[110:111], v33, v[66:67]
    s_waitcnt lgkmcnt(0)
L_p2_kernel_norare2_4:
    s_add_u32 s22, s22, 80000
    s_cmp_eq_u32 s24, 7
    s_cselect_b32 s46, 0, s46
    s_waitcnt vmcnt(8)
    v_mad_u32_u16 v64, v8, 8, s18
    v_mad_u32_u16 v66, v9, 8, s18
    ds_read_b64 v[64:65], v64
    ds_read_b64 v[66:67], v66
    s_add_u32 s14, s22, 49152
    buffer_load_dwordx4 v[100:103], v1, s[8:11], s14 offen
    s_waitcnt vmcnt(8)
    v_mad_u32_u16 v68, v12, 8, s18
    v_mad_u32_u16 v70, v13, 8, s18
    ds_read_b64 v[68:69], v68
    ds_read_b64 v[70:71], v70
    s_add_u32 s14, s22, 65536
    buffer_load_dwordx4 v[104:107], v1, s[8:11], s14 offen
    s_waitcnt vmcnt(8)
    v_mad_u32_u16 v72, v16, 8, s18
    v_mad_u32_u16 v74, v17, 8, s18
    ds_read_b64 v[72:73], v72
    ds_read_b64 v[74:75], v74
    s_waitcnt lgkmcnt(6)
    v_readlane_b32 s30, v7, 0
    v_readlane_b32 s31, v7, 1
    v_readlane_b32 s32, v7, 2
    v_readlane_b32 s33, v7, 3
    v_readlane_b32 s34, v7, 4
    v_readlane_b32 s35, v7, 5
    v_readlane_b32 s36, v7, 6
    v_readlane_b32 s37, v7, 7
    v_readlane_b32 s38, v7, 8
    v_readlane_b32 s39, v7, 9
    v_readlane_b32 s40, v7, 10
    v_readlane_b32 s41, v7, 11
    s_mov_b32 s25, s19
    s_mov_b32 s26, s27
    s_mov_b32 s28, s29
    v_mbcnt_lo_u32_b32 v120, s30, 0
    v_mbcnt_hi_u32_b32 v120, s31, v120
    s_bcnt1_i32_b64 s14, s[30:31]
    v_lshl_add_u32 v121, v120, 1, s25
    ds_read_u16 v121, v121
    v_mad_u32_u24 v120, v120, s23, v2
    s_mov_b32 s30, s26
    s_lshl1_add_u32 s25, s14, s25
    s_mul_i32 s14, s14, s23
    s_add_u32 s26, s26, s14
    v_and_b32 v112, 0xffff, v10
    v_lshrrev_b32 v114, 16, v10
    v_lshlrev_b32 v113, 16, v10
    v_and_b32 v10, 0xffff0000, v10
    v_mad_u32_u16 v8, v8, 8, s50 op_sel:[1,0,0,0]
    v_mad_u32_u16 v9, v9, 8, s50 op_sel:[1,0,0,0]
    s_waitcnt lgkmcnt(5)
    v_dot2_f32_bf16 v115, v64, v112, s16
    v_dot2_f32_bf16 v64, v64, v113, s16
    v_dot2_f32_bf16 v116, v65, v112, s16
    v_dot2_f32_bf16 v65, v65, v113, s16
    v_dot2_f32_bf16 v117, v66, v114, s16
    v_dot2_f32_bf16 v66, v66, v10, s16
    v_dot2_f32_bf16 v118, v67, v114, s16
    v_dot2_f32_bf16 v67, v67, v10, s16
    v_perm_b32 v64, v64, v115, s17
    v_perm_b32 v65, v65, v116, s17
    v_perm_b32 v66, v66, v117, s17
    v_perm_b32 v67, v67, v118, s17
    v_lshl_add_u64 v[64:65], v[64:65], 0, s[20:21]
    v_lshl_add_u64 v[66:67], v[66:67], 0, s[20:21]
    v_or3_b32 v4, v108, v109, v4
    v_or3_b32 v4, v110, v111, v4
    ds_add_rtn_u64 v[108:109], v8, v[64:65]
    ds_add_rtn_u64 v[110:111], v9, v[66:67]
    s_waitcnt lgkmcnt(2)
    v_mad_u32_u24 v120, v121, 12, v120
    buffer_load_dwordx3 v[8:10], v120, s[44:47], s30 offen offset:0
    s_waitcnt vmcnt(8)
    v_mad_u32_u16 v76, v20, 8, s18
    v_mad_u32_u16 v78, v21, 8, s18
    ds_read_b64 v[76:77], v76
    ds_read_b64 v[78:79], v78
    v_mbcnt_lo_u32_b32 v120, s32, 0
    v_mbcnt_hi_u32_b32 v120, s33, v120
    s_bcnt1_i32_b64 s14, s[32:33]
    v_lshl_add_u32 v121, v120, 1, s25
    ds_read_u16 v121, v121
    v_mad_u32_u24 v120, v120, s23, v2
    s_mov_b32 s32, s26
    s_lshl1_add_u32 s25, s14, s25
    s_mul_i32 s14, s14, s23
    s_add_u32 s26, s26, s14
    v_and_b32 v112, 0xffff, v14
    v_lshrrev_b32 v114, 16, v14
    v_lshlrev_b32 v113, 16, v14
    v_and_b32 v14, 0xffff0000, v14
    v_mad_u32_u16 v12, v12, 8, s50 op_sel:[1,0,0,0]
    v_mad_u32_u16 v13, v13, 8, s50 op_sel:[1,0,0,0]
    v_dot2_f32_bf16 v115, v68, v112, s16
    v_dot2_f32_bf16 v68, v68, v113, s16
    v_dot2_f32_bf16 v116, v69, v112, s16
    v_dot2_f32_bf16 v69, v69, v113, s16
    v_dot2_f32_bf16 v117, v70, v114, s16
    v_dot2_f32_bf16 v70, v70, v14, s16
    v_dot2_f32_bf16 v118, v71, v114, s16
    v_dot2_f32_bf16 v71, v71, v14, s16
    v_perm_b32 v68, v68, v115, s17
    v_perm_b32 v69, v69, v116, s17
    v_perm_b32 v70, v70, v117, s17
    v_perm_b32 v71, v71, v118, s17
    v_lshl_add_u64 v[68:69], v[68:69], 0, s[20:21]
    v_lshl_add_u64 v[70:71], v[70:71], 0, s[20:21]
    s_waitcnt lgkmcnt(3)
    v_or3_b32 v4, v108, v109, v4
    v_or3_b32 v4, v110, v111, v4
    ds_add_rtn_u64 v[108:109], v12, v[68:69]
    ds_add_rtn_u64 v[110:111], v13, v[70:71]
    s_waitcnt lgkmcnt(2)
    v_mad_u32_u24 v120, v121, 12, v120
    buffer_load_dwordx3 v[12:14], v120, s[44:47], s32 offen offset:768
    s_waitcnt vmcnt(8)
    v_mad_u32_u16 v80, v24, 8, s18
    v_mad_u32_u16 v82, v25, 8, s18
    ds_read_b64 v[80:81], v80
    ds_read_b64 v[82:83], v82
    s_waitcnt vmcnt(7)
    v_mad_u32_u16 v84, v28, 8, s18
    v_mad_u32_u16 v86, v29, 8, s18
    ds_read_b64 v[84:85], v84
    ds_read_b64 v[86:87], v86
    v_mbcnt_lo_u32_b32 v120, s34, 0
    v_mbcnt_hi_u32_b32 v120, s35, v120
    s_bcnt1_i32_b64 s14, s[34:35]
    v_lshl_add_u32 v121, v120, 1, s25
    ds_read_u16 v121, v121
    v_mad_u32_u24 v120, v120, s23, v2
    s_mov_b32 s34, s26
    s_lshl1_add_u32 s25, s14, s25
    s_mul_i32 s14, s14, s23
    s_add_u32 s26, s26, s14
    v_and_b32 v112, 0xffff, v18
    v_lshrrev_b32 v114, 16, v18
    v_lshlrev_b32 v113, 16, v18
    v_and_b32 v18, 0xffff0000, v18
    v_mad_u32_u16 v16, v16, 8, s50 op_sel:[1,0,0,0]
    v_mad_u32_u16 v17, v17, 8, s50 op_sel:[1,0,0,0]
    v_dot2_f32_bf16 v115, v72, v112, s16
    v_dot2_f32_bf16 v72, v72, v113, s16
    v_dot2_f32_bf16 v116, v73, v112, s16
    v_dot2_f32_bf16 v73, v73, v113, s16
    v_dot2_f32_bf16 v117, v74, v114, s16
    v_dot2_f32_bf16 v74, v74, v18, s16
    v_dot2_f32_bf16 v118, v75, v114, s16
    v_dot2_f32_bf16 v75, v75, v18, s16
    v_perm_b32 v72, v72, v115, s17
    v_perm_b32 v73, v73, v116, s17
    v_perm_b32 v74, v74, v117, s17
    v_perm_b32 v75, v75, v118, s17
    v_lshl_add_u64 v[72:73], v[72:73], 0, s[20:21]
    v_lshl_add_u64 v[74:75], v[74:75], 0, s[20:21]
    s_waitcnt lgkmcnt(5)
    v_or3_b32 v4, v108, v109, v4
    v_or3_b32 v4, v110, v111, v4
    ds_add_rtn_u64 v[108:109], v16, v[72:73]
    ds_add_rtn_u64 v[110:111], v17, v[74:75]
    s_waitcnt lgkmcnt(2)
    v_mad_u32_u24 v120, v121, 12, v120
    buffer_load_dwordx3 v[16:18], v120, s[44:47], s34 offen offset:1536
    s_barrier
    s_waitcnt vmcnt(3)
    ds_write_b128 v3, v[88:91] offset:0
    ds_write_b128 v3, v[92:95] offset:16384
    ds_write_b128 v3, v[96:99] offset:32768
    ds_write_b128 v3, v[100:103] offset:49152
    ds_write_b128 v124, v[104:107]
    v_mbcnt_lo_u32_b32 v120, s36, 0
    v_mbcnt_hi_u32_b32 v120, s37, v120
    s_bcnt1_i32_b64 s14, s[36:37]
    v_lshl_add_u32 v121, v120, 1, s25
    ds_read_u16 v121, v121
    v_mad_u32_u24 v120, v120, s23, v2
    s_mov_b32 s36, s26
    s_lshl1_add_u32 s25, s14, s25
    s_mul_i32 s14, s14, s23
    s_add_u32 s26, s26, s14
    v_and_b32 v112, 0xffff, v22
    v_lshrrev_b32 v114, 16, v22
    v_lshlrev_b32 v113, 16, v22
    v_and_b32 v22, 0xffff0000, v22
    v_mad_u32_u16 v20, v20, 8, s50 op_sel:[1,0,0,0]
    v_mad_u32_u16 v21, v21, 8, s50 op_sel:[1,0,0,0]
    v_dot2_f32_bf16 v115, v76, v112, s16
    v_dot2_f32_bf16 v76, v76, v113, s16
    v_dot2_f32_bf16 v116, v77, v112, s16
    v_dot2_f32_bf16 v77, v77, v113, s16
    v_dot2_f32_bf16 v117, v78, v114, s16
    v_dot2_f32_bf16 v78, v78, v22, s16
    v_dot2_f32_bf16 v118, v79, v114, s16
    v_dot2_f32_bf16 v79, v79, v22, s16
    v_perm_b32 v76, v76, v115, s17
    v_perm_b32 v77, v77, v116, s17
    v_perm_b32 v78, v78, v117, s17
    v_perm_b32 v79, v79, v118, s17
    v_lshl_add_u64 v[76:77], v[76:77], 0, s[20:21]
    v_lshl_add_u64 v[78:79], v[78:79], 0, s[20:21]
    s_waitcnt lgkmcnt(6)
    v_or3_b32 v4, v108, v109, v4
    v_or3_b32 v4, v110, v111, v4
    ds_add_rtn_u64 v[108:109], v20, v[76:77]
    ds_add_rtn_u64 v[110:111], v21, v[78:79]
    s_waitcnt lgkmcnt(2)
    v_mad_u32_u24 v120, v121, 12, v120
    buffer_load_dwordx3 v[20:22], v120, s[44:47], s36 offen offset:2304
    v_mbcnt_lo_u32_b32 v120, s38, 0
    v_mbcnt_hi_u32_b32 v120, s39, v120
    s_bcnt1_i32_b64 s14, s[38:39]
    v_lshl_add_u32 v121, v120, 1, s25
    ds_read_u16 v121, v121
    v_mad_u32_u24 v120, v120, s23, v2
    s_mov_b32 s38, s26
    s_lshl1_add_u32 s25, s14, s25
    s_mul_i32 s14, s14, s23
    s_add_u32 s26, s26, s14
    v_and_b32 v112, 0xffff, v26
    v_lshrrev_b32 v114, 16, v26
    v_lshlrev_b32 v113, 16, v26
    v_and_b32 v26, 0xffff0000, v26
    v_mad_u32_u16 v24, v24, 8, s50 op_sel:[1,0,0,0]
    v_mad_u32_u16 v25, v25, 8, s50 op_sel:[1,0,0,0]
    v_dot2_f32_bf16 v115, v80, v112, s16
    v_dot2_f32_bf16 v80, v80, v113, s16
    v_dot2_f32_bf16 v116, v81, v112, s16
    v_dot2_f32_bf16 v81, v81, v113, s16
    v_dot2_f32_bf16 v117, v82, v114, s16
    v_dot2_f32_bf16 v82, v82, v26, s16
    v_dot2_f32_bf16 v118, v83, v114, s16
    v_dot2_f32_bf16 v83, v83, v26, s16
    v_perm_b32 v80, v80, v115, s17
    v_perm_b32 v81, v81, v116, s17
    v_perm_b32 v82, v82, v117, s17
    v_perm_b32 v83, v83, v118, s17
    v_lshl_add_u64 v[80:81], v[80:81], 0, s[20:21]
    v_lshl_add_u64 v[82:83], v[82:83], 0, s[20:21]
    s_waitcnt lgkmcnt(1)
    v_or3_b32 v4, v108, v109, v4
    v_or3_b32 v4, v110, v111, v4
    ds_add_rtn_u64 v[108:109], v24, v[80:81]
    ds_add_rtn_u64 v[110:111], v25, v[82:83]
    s_waitcnt lgkmcnt(2)
    v_mad_u32_u24 v120, v121, 12, v120
    buffer_load_dwordx3 v[24:26], v120, s[44:47], s38 offen offset:3072
    v_mbcnt_lo_u32_b32 v120, s40, 0
    v_mbcnt_hi_u32_b32 v120, s41, v120
    s_bcnt1_i32_b64 s14, s[40:41]
    v_lshl_add_u32 v121, v120, 1, s25
    ds_read_u16 v121, v121
    v_mad_u32_u24 v120, v120, s23, v2
    s_mov_b32 s40, s26
    s_lshl1_add_u32 s25, s14, s25
    s_mul_i32 s14, s14, s23
    s_add_u32 s26, s26, s14
    v_and_b32 v112, 0xffff, v30
    v_lshrrev_b32 v114, 16, v30
    v_lshlrev_b32 v113, 16, v30
    v_and_b32 v30, 0xffff0000, v30
    v_mad_u32_u16 v28, v28, 8, s50 op_sel:[1,0,0,0]
    v_mad_u32_u16 v29, v29, 8, s50 op_sel:[1,0,0,0]
    v_dot2_f32_bf16 v115, v84, v112, s16
    v_dot2_f32_bf16 v84, v84, v113, s16
    v_dot2_f32_bf16 v116, v85, v112, s16
    v_dot2_f32_bf16 v85, v85, v113, s16
    v_dot2_f32_bf16 v117, v86, v114, s16
    v_dot2_f32_bf16 v86, v86, v30, s16
    v_dot2_f32_bf16 v118, v87, v114, s16
    v_dot2_f32_bf16 v87, v87, v30, s16
    v_perm_b32 v84, v84, v115, s17
    v_perm_b32 v85, v85, v116, s17
    v_perm_b32 v86, v86, v117, s17
    v_perm_b32 v87, v87, v118, s17
    v_lshl_add_u64 v[84:85], v[84:85], 0, s[20:21]
    v_lshl_add_u64 v[86:87], v[86:87], 0, s[20:21]
    s_waitcnt lgkmcnt(1)
    v_or3_b32 v4, v108, v109, v4
    v_or3_b32 v4, v110, v111, v4
    ds_add_rtn_u64 v[108:109], v28, v[84:85]
    ds_add_rtn_u64 v[110:111], v29, v[86:87]
    s_waitcnt lgkmcnt(2)
    v_mad_u32_u24 v120, v121, 12, v120
    buffer_load_dwordx3 v[28:30], v120, s[44:47], s40 offen offset:3840
    s_cmp_le_u32 s28, 384
    s_cbranch_scc1 L_p2_kernel_norare_5
    v_readlane_b32 s42, v7, 12
    v_readlane_b32 s43, v7, 13
    s_nop 1
    v_mbcnt_lo_u32_b32 v120, s42, 0
    v_mbcnt_hi_u32_b32 v120, s43, v120
    s_bcnt1_i32_b64 s14, s[42:43]
    v_lshl_add_u32 v121, v120, 1, s25
    ds_read_u16 v121, v121
    v_mad_u32_u24 v120, v120, s23, v2
    s_mov_b32 s42, s26
    s_lshl1_add_u32 s25, s14, s25
    s_mul_i32 s14, s14, s23
    s_add_u32 s26, s26, s14
    s_waitcnt lgkmcnt(0)
    s_add_u32 s42, s42, 4608
    v_mad_u32_u24 v120, v121, 12, v120
    buffer_load_dwordx3 v[32:34], v120, s[44:47], s42 offen offset:0
L_p2_kernel_norare_5:
    v_add_u32_sdwa v113, 1, v43 dst_sel:DWORD dst_unused:UNUSED_PAD src0_sel:DWORD src1_sel:WORD_1
    v_lshrrev_b32_sdwa v112, 1, v11 dst_sel:DWORD dst_unused:UNUSED_PAD src0_sel:DWORD src1_sel:WORD_1
    v_lshrrev_b32 v113, 1, v113
    v_sub_u32 v114, v113, v112
    v_add_u32 v113, 448, v113
    s_nop 0
    v_add_u32_dpp v114, v114, v114 row_shr:1 row_mask:0xf bank_mask:0xf bound_ctrl:0
    s_nop 1
    v_add_u32_dpp v114, v114, v114 row_shr:2 row_mask:0xf bank_mask:0xf bound_ctrl:0
    s_nop 1
    v_add_u32_dpp v114, v114, v114 row_shr:4 row_mask:0xf bank_mask:0xf bound_ctrl:0
    s_nop 1
    v_add_u32_dpp v114, v114, v114 row_shr:8 row_mask:0xf bank_mask:0xf bound_ctrl:0
    s_nop 1
    v_add_u32_dpp v114, v114, v114 row_bcast:15 row_mask:0xa bank_mask:0xf
    s_nop 1
    v_add_u32_dpp v114, v114, v114 row_bcast:31 row_mask:0xc bank_mask:0xf
    v_sub_u32 v113, v113, v114
    v_readlane_b32 s29, v114, 63
    v_add_u32 v114, -1, v114
    ds_write_b16 v126, v113
    v_lshlrev_b32_e64 v115, v114, 1
    v_lshrrev_b32 v114, 5, v114
    v_lshl_add_u32 v114, v114, 2, s19
    s_cmp_gt_u32 s29, 448
    s_cselect_b32 s2, 1, s2
    s_cselect_b64 exec, 0, -1
    ds_or_b32 v114, v115 offset:160
    s_mov_b64 exec, -1
    ds_wrxchg_rtn_b32 v7, v6, v5 offset:160
    s_add_u32 s14, s22, 80000
    buffer_load_dwordx4 v[88:91], v1, s[8:11], s14 offen
    s_add_u32 s14, s22, 96384
    buffer_load_dwordx4 v[92:95], v1, s[8:11], s14 offen
    s_add_u32 s14, s22, 112768
    buffer_load_dwordx4 v[96:99], v1, s[8:11], s14 offen
    s_add_u32 s24, s24, 1
    s_cmp_lt_u32 s24, 8
    s_barrier
    s_cbranch_scc1 L_p2_loop
    s_waitcnt lgkmcnt(3)
    v_or3_b32 v4, v108, v109, v4
    v_or3_b32 v4, v110, v111, v4
    s_mov_b32 s27, s19
    s_waitcnt vmcnt(0) lgkmcnt(0)
    s_load_dwordx2 s[44:45], s[0:1], 24
    s_load_dwordx2 s[16:17], s[0:1], 88
    v_mov_b32 v8, 160232
    s_cmp_lg_u32 s13, 0
    s_cselect_b64 exec, 0, 1
    ds_write_b32 v8, v52
    s_mov_b64 exec, -1
    v_subrev_u32 v6, 80000, v124
    v_add_u32 v2, 16384, v1
    v_mov_b32 v9, 0x3f000000
    v_cmp_gt_u32 vcc, 226, v0
    s_mov_b32 s49, s12
    s_mov_b32 s51, 0
    v_cndmask_b32 v2, v9, v2, vcc
    v_lshrrev_b32 v3, 2, v1
    v_lshrrev_b32 v5, 2, v2
    s_waitcnt lgkmcnt(0)
    s_mov_b32 s46, 1280000
    s_mov_b32 s47, 0x00020000
    s_mov_b32 s18, 5120000
    s_mov_b32 s19, 0x00020000
    s_lshl2_add_u32 s14, s3, s49
    s_mul_i32 s26, s14, 20000
    s_lshr_b32 s14, s26, 2
    s_add_u32 s15, s26, 254870016
    buffer_load_dword v60, v3, s[44:47], s14 offen nt
    buffer_load_dword v61, v5, s[44:47], s14 offen nt
    buffer_load_dwordx4 v[64:67], v1, s[4:7], s15 offen
    buffer_load_dwordx4 v[68:71], v2, s[4:7], s15 offen
    s_barrier
    ds_read_b32 v9, v8
    ds_read_b128 v[88:91], v1 offset:0
    ds_read_b128 v[92:95], v1 offset:16384
    ds_read_b128 v[96:99], v1 offset:32768
    ds_read_b128 v[100:103], v1 offset:49152
    ds_read_b128 v[104:107], v6
    s_mul_i32 s14, s12, 5120000
    s_mul_i32 s15, s3, 80000
    s_add_u32 s25, s14, s15
    s_add_u32 s25, s25, 259990016
    s_mul_i32 s24, s12, 20000
    s_waitcnt lgkmcnt(5)
    v_readfirstlane_b32 s21, v9
    v_subrev_u32 v10, s24, v1
    v_mov_b32 v11, 0x7f000000
    s_bfe_u32 s21, s21, 524296
    s_cmp_lg_u32 s21, 4
    s_cselect_b32 s21, 1, 0
    s_cselect_b32 s24, 0, 20000
    v_cmp_le_u32 vcc, s24, v10
    v_add_u32 v10, 16384, v10
    s_add_u32 s14, s25, 0
    v_cndmask_b32 v12, v11, v1, vcc
    s_waitcnt lgkmcnt(4)
    buffer_store_dwordx4 v[88:91], v12, s[4:7], s14 offen sc1
    v_or3_b32 v4, v88, v89, v4
    v_or3_b32 v4, v90, v91, v4
    v_cmp_le_u32 vcc, s24, v10
    v_add_u32 v10, 16384, v10
    s_add_u32 s14, s25, 16384
    v_cndmask_b32 v12, v11, v1, vcc
    s_waitcnt lgkmcnt(3)
    buffer_store_dwordx4 v[92:95], v12, s[4:7], s14 offen sc1
    v_or3_b32 v4, v92, v93, v4
    v_or3_b32 v4, v94, v95, v4
    v_cmp_le_u32 vcc, s24, v10
    v_add_u32 v10, 16384, v10
    s_add_u32 s14, s25, 32768
    v_cndmask_b32 v12, v11, v1, vcc
    s_waitcnt lgkmcnt(2)
    buffer_store_dwordx4 v[96:99], v12, s[4:7], s14 offen sc1
    v_or3_b32 v4, v96, v97, v4
    v_or3_b32 v4, v98, v99, v4
    v_cmp_le_u32 vcc, s24, v10
    v_add_u32 v10, 16384, v10
    s_add_u32 s14, s25, 49152
    v_cndmask_b32 v12, v11, v1, vcc
    s_waitcnt lgkmcnt(1)
    buffer_store_dwordx4 v[100:103], v12, s[4:7], s14 offen sc1
    v_or3_b32 v4, v100, v101, v4
    v_or3_b32 v4, v102, v103, v4
    v_cmp_le_u32 vcc, s24, v10
    v_add_u32 v10, 16384, v10
    s_add_u32 s14, s25, 0
    v_cndmask_b32 v12, v11, v6, vcc
    s_waitcnt lgkmcnt(0)
    buffer_store_dwordx4 v[104:107], v12, s[4:7], s14 offen sc1
    v_or3_b32 v4, v104, v105, v4
    v_or3_b32 v4, v106, v107, v4
    s_pack_ll_b32_b16 s14, s52, s54
    s_pack_hh_b32_b16 s15, s52, s54
    s_pack_ll_b32_b16 s54, s53, s55
    s_pack_hh_b32_b16 s55, s53, s55
    s_mov_b32 s52, s14
    s_mov_b32 s53, s15
    s_pack_ll_b32_b16 s14, s56, s58
    s_pack_hh_b32_b16 s15, s56, s58
    s_pack_ll_b32_b16 s58, s57, s59
    s_pack_hh_b32_b16 s59, s57, s59
    s_mov_b32 s56, s14
    s_mov_b32 s57, s15
    s_pack_ll_b32_b16 s14, s60, s62
    s_pack_hh_b32_b16 s15, s60, s62
    s_pack_ll_b32_b16 s62, s61, s63
    s_pack_hh_b32_b16 s63, s61, s63
    s_mov_b32 s60, s14
    s_mov_b32 s61, s15
    s_pack_ll_b32_b16 s14, s64, s66
    s_pack_hh_b32_b16 s15, s64, s66
    s_pack_ll_b32_b16 s66, s65, s67
    s_pack_hh_b32_b16 s67, s65, s67
    s_mov_b32 s64, s14
    s_mov_b32 s65, s15
    s_pack_ll_b32_b16 s14, s68, s70
    s_pack_hh_b32_b16 s15, s68, s70
    s_pack_ll_b32_b16 s70, s69, s71
    s_pack_hh_b32_b16 s71, s69, s71
    s_mov_b32 s68, s14
    s_mov_b32 s69, s15
    s_pack_ll_b32_b16 s14, s72, s74
    s_pack_hh_b32_b16 s15, s72, s74
    s_pack_ll_b32_b16 s74, s73, s75
    s_pack_hh_b32_b16 s75, s73, s75
    s_mov_b32 s72, s14
    s_mov_b32 s73, s15
    s_pack_ll_b32_b16 s14, s76, s78
    s_pack_hh_b32_b16 s15, s76, s78
    s_pack_ll_b32_b16 s78, s77, s79
    s_pack_hh_b32_b16 s79, s77, s79
    s_mov_b32 s76, s14
    s_mov_b32 s77, s15
    s_pack_ll_b32_b16 s14, s80, s82
    s_pack_hh_b32_b16 s15, s80, s82
    s_pack_ll_b32_b16 s82, s81, s83
    s_pack_hh_b32_b16 s83, s81, s83
    s_mov_b32 s80, s14
    s_mov_b32 s81, s15
    s_lshl_b32 s28, s92, 16
    s_and_b32 s29, s92, 0xffff0000
    s_lshl_b32 s30, s93, 16
    s_and_b32 s31, s93, 0xffff0000
    s_lshl_b32 s32, s94, 16
    s_and_b32 s33, s94, 0xffff0000
    s_lshl_b32 s34, s95, 16
    s_and_b32 s35, s95, 0xffff0000
    s_lshl_b32 s36, s96, 16
    s_and_b32 s37, s96, 0xffff0000
    s_lshl_b32 s38, s97, 16
    s_and_b32 s39, s97, 0xffff0000
    s_lshl_b32 s40, s98, 16
    s_and_b32 s41, s98, 0xffff0000
    s_lshl_b32 s42, s99, 16
    s_and_b32 s43, s99, 0xffff0000
    s_and_b32 s99, s91, 0xffff0000
    s_lshl_b32 s98, s91, 16
    s_and_b32 s97, s90, 0xffff0000
    s_lshl_b32 s96, s90, 16
    s_and_b32 s95, s89, 0xffff0000
    s_lshl_b32 s94, s89, 16
    s_and_b32 s93, s88, 0xffff0000
    s_lshl_b32 s92, s88, 16
    s_and_b32 s91, s87, 0xffff0000
    s_lshl_b32 s90, s87, 16
    s_and_b32 s89, s86, 0xffff0000
    s_lshl_b32 s88, s86, 16
    s_and_b32 s87, s85, 0xffff0000
    s_lshl_b32 s86, s85, 16
    s_and_b32 s85, s84, 0xffff0000
    s_lshl_b32 s84, s84, 16
    s_mov_b32 s100, s48
    s_add_u32 s101, s48, 2281701376
    s_cmp_eq_u32 s48, 0
    s_cselect_b32 s101, 0, s101
    s_waitcnt vmcnt(7)
L_p2_gates:
    v_lshlrev_b32 v24, 16, v60
    v_and_b32 v25, 0xffff0000, v60
    v_mul_f32 v24, 1081284368, v24
    v_mul_f32 v25, 1081284368, v25
    v_pk_add_f32 v[8:9], v[24:25], v[36:37] op_sel:[0,0] op_sel_hi:[1,0] neg_lo:[0,1] neg_hi:[0,1]
    v_pk_add_f32 v[10:11], v[24:25], v[36:37] op_sel:[0,1] op_sel_hi:[1,1] neg_lo:[0,1] neg_hi:[0,1]
    v_pk_add_f32 v[12:13], v[24:25], v[40:41] op_sel:[0,0] op_sel_hi:[1,0] neg_lo:[0,1] neg_hi:[0,1]
    v_pk_add_f32 v[14:15], v[24:25], v[40:41] op_sel:[0,1] op_sel_hi:[1,1] neg_lo:[0,1] neg_hi:[0,1]
    v_pk_add_f32 v[16:17], v[24:25], v[44:45] op_sel:[0,0] op_sel_hi:[1,0] neg_lo:[0,1] neg_hi:[0,1]
    v_pk_add_f32 v[18:19], v[24:25], v[44:45] op_sel:[0,1] op_sel_hi:[1,1] neg_lo:[0,1] neg_hi:[0,1]
    v_pk_add_f32 v[20:21], v[24:25], v[48:49] op_sel:[0,0] op_sel_hi:[1,0] neg_lo:[0,1] neg_hi:[0,1]
    v_pk_add_f32 v[22:23], v[24:25], v[48:49] op_sel:[0,1] op_sel_hi:[1,1] neg_lo:[0,1] neg_hi:[0,1]
    v_pk_mul_f32 v[8:9], v[8:9], v[8:9]
    v_pk_mul_f32 v[10:11], v[10:11], v[10:11]
    v_pk_mul_f32 v[12:13], v[12:13], v[12:13]
    v_pk_mul_f32 v[14:15], v[14:15], v[14:15]
    v_pk_mul_f32 v[16:17], v[16:17], v[16:17]
    v_pk_mul_f32 v[18:19], v[18:19], v[18:19]
    v_pk_mul_f32 v[20:21], v[20:21], v[20:21]
    v_pk_mul_f32 v[22:23], v[22:23], v[22:23]
    v_exp_f32 v8, -v8
    v_exp_f32 v9, -v9
    v_exp_f32 v10, -v10
    v_exp_f32 v11, -v11
    v_exp_f32 v12, -v12
    v_exp_f32 v13, -v13
    v_exp_f32 v14, -v14
    v_exp_f32 v15, -v15
    v_exp_f32 v16, -v16
    v_exp_f32 v17, -v17
    v_exp_f32 v18, -v18
    v_exp_f32 v19, -v19
    v_exp_f32 v20, -v20
    v_exp_f32 v21, -v21
    v_exp_f32 v22, -v22
    v_exp_f32 v23, -v23
    v_cvt_pk_bf16_f32 v8, v8, v10
    v_cvt_pk_bf16_f32 v9, v9, v11
    v_cvt_pk_bf16_f32 v12, v12, v14
    v_cvt_pk_bf16_f32 v13, v13, v15
    v_cvt_pk_bf16_f32 v16, v16, v18
    v_cvt_pk_bf16_f32 v17, v17, v19
    v_cvt_pk_bf16_f32 v20, v20, v22
    v_cvt_pk_bf16_f32 v21, v21, v23
    v_dot2_f32_bf16 v80, v8, s52, 0
    v_dot2_f32_bf16 v81, v9, s52, 0
    v_dot2_f32_bf16 v82, v8, s53, 0
    v_dot2_f32_bf16 v83, v9, s53, 0
    v_dot2_f32_bf16 v84, v8, s54, 0
    v_dot2_f32_bf16 v85, v9, s54, 0
    v_dot2_f32_bf16 v86, v8, s55, 0
    v_dot2_f32_bf16 v87, v9, s55, 0
    v_dot2_f32_bf16 v72, v8, s68, 0
    v_dot2_f32_bf16 v73, v9, s68, 0
    v_dot2_f32_bf16 v74, v8, s69, 0
    v_dot2_f32_bf16 v75, v9, s69, 0
    v_dot2_f32_bf16 v76, v8, s70, 0
    v_dot2_f32_bf16 v77, v9, s70, 0
    v_dot2_f32_bf16 v78, v8, s71, 0
    v_dot2_f32_bf16 v79, v9, s71, 0
    v_dot2_f32_bf16 v80, v12, s56, v80
    v_dot2_f32_bf16 v81, v13, s56, v81
    v_dot2_f32_bf16 v82, v12, s57, v82
    v_dot2_f32_bf16 v83, v13, s57, v83
    v_dot2_f32_bf16 v84, v12, s58, v84
    v_dot2_f32_bf16 v85, v13, s58, v85
    v_dot2_f32_bf16 v86, v12, s59, v86
    v_dot2_f32_bf16 v87, v13, s59, v87
    v_dot2_f32_bf16 v72, v12, s72, v72
    v_dot2_f32_bf16 v73, v13, s72, v73
    v_dot2_f32_bf16 v74, v12, s73, v74
    v_dot2_f32_bf16 v75, v13, s73, v75
    v_dot2_f32_bf16 v76, v12, s74, v76
    v_dot2_f32_bf16 v77, v13, s74, v77
    v_dot2_f32_bf16 v78, v12, s75, v78
    v_dot2_f32_bf16 v79, v13, s75, v79
    v_dot2_f32_bf16 v80, v16, s60, v80
    v_dot2_f32_bf16 v81, v17, s60, v81
    v_dot2_f32_bf16 v82, v16, s61, v82
    v_dot2_f32_bf16 v83, v17, s61, v83
    v_dot2_f32_bf16 v84, v16, s62, v84
    v_dot2_f32_bf16 v85, v17, s62, v85
    v_dot2_f32_bf16 v86, v16, s63, v86
    v_dot2_f32_bf16 v87, v17, s63, v87
    v_dot2_f32_bf16 v72, v16, s76, v72
    v_dot2_f32_bf16 v73, v17, s76, v73
    v_dot2_f32_bf16 v74, v16, s77, v74
    v_dot2_f32_bf16 v75, v17, s77, v75
    v_dot2_f32_bf16 v76, v16, s78, v76
    v_dot2_f32_bf16 v77, v17, s78, v77
    v_dot2_f32_bf16 v78, v16, s79, v78
    v_dot2_f32_bf16 v79, v17, s79, v79
    v_dot2_f32_bf16 v80, v20, s64, v80
    v_dot2_f32_bf16 v81, v21, s64, v81
    v_dot2_f32_bf16 v82, v20, s65, v82
    v_dot2_f32_bf16 v83, v21, s65, v83
    v_dot2_f32_bf16 v84, v20, s66, v84
    v_dot2_f32_bf16 v85, v21, s66, v85
    v_dot2_f32_bf16 v86, v20, s67, v86
    v_dot2_f32_bf16 v87, v21, s67, v87
    v_dot2_f32_bf16 v72, v20, s80, v72
    v_dot2_f32_bf16 v73, v21, s80, v73
    v_dot2_f32_bf16 v74, v20, s81, v74
    v_dot2_f32_bf16 v75, v21, s81, v75
    v_dot2_f32_bf16 v76, v20, s82, v76
    v_dot2_f32_bf16 v77, v21, s82, v77
    v_dot2_f32_bf16 v78, v20, s83, v78
    v_dot2_f32_bf16 v79, v21, s83, v79
    s_cmp_ge_u32 s13, 4
    s_cbranch_scc1 L_p2_g1
    v_lshlrev_b32 v24, 16, v61
    v_and_b32 v25, 0xffff0000, v61
    v_mul_f32 v24, 1081284368, v24
    v_mul_f32 v25, 1081284368, v25
    v_pk_add_f32 v[8:9], v[24:25], v[36:37] op_sel:[0,0] op_sel_hi:[1,0] neg_lo:[0,1] neg_hi:[0,1]
    v_pk_add_f32 v[10:11], v[24:25], v[36:37] op_sel:[0,1] op_sel_hi:[1,1] neg_lo:[0,1] neg_hi:[0,1]
    v_pk_add_f32 v[12:13], v[24:25], v[40:41] op_sel:[0,0] op_sel_hi:[1,0] neg_lo:[0,1] neg_hi:[0,1]
    v_pk_add_f32 v[14:15], v[24:25], v[40:41] op_sel:[0,1] op_sel_hi:[1,1] neg_lo:[0,1] neg_hi:[0,1]
    v_pk_add_f32 v[16:17], v[24:25], v[44:45] op_sel:[0,0] op_sel_hi:[1,0] neg_lo:[0,1] neg_hi:[0,1]
    v_pk_add_f32 v[18:19], v[24:25], v[44:45] op_sel:[0,1] op_sel_hi:[1,1] neg_lo:[0,1] neg_hi:[0,1]
    v_pk_add_f32 v[20:21], v[24:25], v[48:49] op_sel:[0,0] op_sel_hi:[1,0] neg_lo:[0,1] neg_hi:[0,1]
    v_pk_add_f32 v[22:23], v[24:25], v[48:49] op_sel:[0,1] op_sel_hi:[1,1] neg_lo:[0,1] neg_hi:[0,1]
    v_pk_mul_f32 v[8:9], v[8:9], v[8:9]
    v_pk_mul_f32 v[10:11], v[10:11], v[10:11]
    v_pk_mul_f32 v[12:13], v[12:13], v[12:13]
    v_pk_mul_f32 v[14:15], v[14:15], v[14:15]
    v_pk_mul_f32 v[16:17], v[16:17], v[16:17]
    v_pk_mul_f32 v[18:19], v[18:19], v[18:19]
    v_pk_mul_f32 v[20:21], v[20:21], v[20:21]
    v_pk_mul_f32 v[22:23], v[22:23], v[22:23]
    v_exp_f32 v8, -v8
    v_exp_f32 v9, -v9
    v_exp_f32 v10, -v10
    v_exp_f32 v11, -v11
    v_exp_f32 v12, -v12
    v_exp_f32 v13, -v13
    v_exp_f32 v14, -v14
    v_exp_f32 v15, -v15
    v_exp_f32 v16, -v16
    v_exp_f32 v17, -v17
    v_exp_f32 v18, -v18
    v_exp_f32 v19, -v19
    v_exp_f32 v20, -v20
    v_exp_f32 v21, -v21
    v_exp_f32 v22, -v22
    v_exp_f32 v23, -v23
    v_cvt_pk_bf16_f32 v8, v8, v10
    v_cvt_pk_bf16_f32 v9, v9, v11
    v_cvt_pk_bf16_f32 v12, v12, v14
    v_cvt_pk_bf16_f32 v13, v13, v15
    v_cvt_pk_bf16_f32 v16, v16, v18
    v_cvt_pk_bf16_f32 v17, v17, v19
    v_cvt_pk_bf16_f32 v20, v20, v22
    v_cvt_pk_bf16_f32 v21, v21, v23
    v_dot2_f32_bf16 v120, v8, s52, 0
    v_dot2_f32_bf16 v121, v9, s52, 0
    v_dot2_f32_bf16 v122, v8, s53, 0
    v_dot2_f32_bf16 v123, v9, s53, 0
    v_dot2_f32_bf16 v124, v8, s54, 0
    v_dot2_f32_bf16 v125, v9, s54, 0
    v_dot2_f32_bf16 v126, v8, s55, 0
    v_dot2_f32_bf16 v127, v9, s55, 0
    v_dot2_f32_bf16 v112, v8, s68, 0
    v_dot2_f32_bf16 v113, v9, s68, 0
    v_dot2_f32_bf16 v114, v8, s69, 0
    v_dot2_f32_bf16 v115, v9, s69, 0
    v_dot2_f32_bf16 v116, v8, s70, 0
    v_dot2_f32_bf16 v117, v9, s70, 0
    v_dot2_f32_bf16 v118, v8, s71, 0
    v_dot2_f32_bf16 v119, v9, s71, 0
    v_dot2_f32_bf16 v120, v12, s56, v120
    v_dot2_f32_bf16 v121, v13, s56, v121
    v_dot2_f32_bf16 v122, v12, s57, v122
    v_dot2_f32_bf16 v123, v13, s57, v123
    v_dot2_f32_bf16 v124, v12, s58, v124
    v_dot2_f32_bf16 v125, v13, s58, v125
    v_dot2_f32_bf16 v126, v12, s59, v126
    v_dot2_f32_bf16 v127, v13, s59, v127
    v_dot2_f32_bf16 v112, v12, s72, v112
    v_dot2_f32_bf16 v113, v13, s72, v113
    v_dot2_f32_bf16 v114, v12, s73, v114
    v_dot2_f32_bf16 v115, v13, s73, v115
    v_dot2_f32_bf16 v116, v12, s74, v116
    v_dot2_f32_bf16 v117, v13, s74, v117
    v_dot2_f32_bf16 v118, v12, s75, v118
    v_dot2_f32_bf16 v119, v13, s75, v119
    v_dot2_f32_bf16 v120, v16, s60, v120
    v_dot2_f32_bf16 v121, v17, s60, v121
    v_dot2_f32_bf16 v122, v16, s61, v122
    v_dot2_f32_bf16 v123, v17, s61, v123
    v_dot2_f32_bf16 v124, v16, s62, v124
    v_dot2_f32_bf16 v125, v17, s62, v125
    v_dot2_f32_bf16 v126, v16, s63, v126
    v_dot2_f32_bf16 v127, v17, s63, v127
    v_dot2_f32_bf16 v112, v16, s76, v112
    v_dot2_f32_bf16 v113, v17, s76, v113
    v_dot2_f32_bf16 v114, v16, s77, v114
    v_dot2_f32_bf16 v115, v17, s77, v115
    v_dot2_f32_bf16 v116, v16, s78, v116
    v_dot2_f32_bf16 v117, v17, s78, v117
    v_dot2_f32_bf16 v118, v16, s79, v118
    v_dot2_f32_bf16 v119, v17, s79, v119
    v_dot2_f32_bf16 v120, v20, s64, v120
    v_dot2_f32_bf16 v121, v21, s64, v121
    v_dot2_f32_bf16 v122, v20, s65, v122
    v_dot2_f32_bf16 v123, v21, s65, v123
    v_dot2_f32_bf16 v124, v20, s66, v124
    v_dot2_f32_bf16 v125, v21, s66, v125
    v_dot2_f32_bf16 v126, v20, s67, v126
    v_dot2_f32_bf16 v127, v21, s67, v127
    v_dot2_f32_bf16 v112, v20, s80, v112
    v_dot2_f32_bf16 v113, v21, s80, v113
    v_dot2_f32_bf16 v114, v20, s81, v114
    v_dot2_f32_bf16 v115, v21, s81, v115
    v_dot2_f32_bf16 v116, v20, s82, v116
    v_dot2_f32_bf16 v117, v21, s82, v117
    v_dot2_f32_bf16 v118, v20, s83, v118
    v_dot2_f32_bf16 v119, v21, s83, v119
L_p2_g1:
    s_cmp_lg_u32 s51, 0
    s_cbranch_scc1 L_p2_fin
    v_and_b32 v4, 0x80008000, v4
    v_cmp_ne_u32 vcc, 0, v4
    v_mov_b32 v8, s27
    v_and_b32 v10, 15, v0
    v_mul_u32_u24 v10, 240, v10
    v_add_u32 v10, 160000, v10
    s_cmp_lg_u64 vcc, 0
    s_cselect_b32 s2, 1, s2
    v_mov_b32 v9, s2
    s_mov_b64 exec, 1
    ds_write_b32 v8, v9
    s_mov_b64 exec, -1
    s_waitcnt vmcnt(0) lgkmcnt(0)
    s_barrier
    ds_read_b32 v9, v10
    s_waitcnt lgkmcnt(0)
    v_cmp_ne_u32 vcc, 0, v9
    s_nop 1
    s_cmp_lg_u64 vcc, 0
    s_cselect_b32 s2, 1, 0
    s_cbranch_scc1 L_p2_slow
L_p2_signal:
    v_mov_b32 v8, 160228
    s_cmp_lg_u32 s13, 0
    s_cbranch_scc1 L_p2_nosig
    s_lshl_b32 s15, s2, 4
    s_or_b32 s15, s15, s21
    s_add_u32 s14, s12, 16
    s_lshl_b32 s20, s15, s14
    s_add_u32 s20, s20, 1
    v_mov_b32 v9, s20
    s_lshl_b32 s14, s3, 8
    s_add_u32 s14, s14, 254853632
    s_mov_b64 exec, 1
    buffer_atomic_add v9, off, s[4:7], s14 sc0
    s_mov_b64 exec, -1
    s_waitcnt vmcnt(0)
    v_readfirstlane_b32 s15, v9
    s_lshl_b32 s51, 1, s12
    s_add_u32 s20, s20, s15
    s_and_b32 s15, s20, 0xff
    s_cmp_eq_u32 s15, 4
    s_cbranch_scc0 L_p2_notlast
    s_bfe_u32 s15, s20, 262160
    s_or_b32 s51, s51, s15
    s_branch L_p2_pub
L_p2_notlast:
    s_cmp_lg_u32 s21, 0
    s_cselect_b32 s51, 0, s51
    s_cbranch_scc1 L_p2_pub
L_p2_poll:
    v_mov_b32 v9, 0
    s_lshl_b32 s14, s3, 8
    s_add_u32 s14, s14, 254853632
    s_mov_b64 exec, 1
    buffer_atomic_add v9, off, s[4:7], s14 sc0
    s_mov_b64 exec, -1
    s_waitcnt vmcnt(0)
    v_readfirstlane_b32 s20, v9
    s_nop 0
    s_and_b32 s15, s20, 0xff
    s_cmp_lt_u32 s15, 4
    s_cbranch_scc1 L_p2_poll
L_p2_pub:
    s_lshl_b32 s15, s51, 24
    s_or_b32 s15, s15, s20
    v_mov_b32 v9, s15
    s_mov_b64 exec, 1
    ds_write_b32 v8, v9
    s_mov_b64 exec, -1
    s_waitcnt lgkmcnt(0)
L_p2_nosig:
    s_barrier
    ds_read_b32 v9, v8
    s_waitcnt lgkmcnt(0)
    v_readfirstlane_b32 s20, v9
    s_nop 0
    s_lshr_b32 s51, s20, 24
    s_cbranch_scc0 L_p2_end
L_p2_fin:
    s_lshl2_add_u32 s14, s3, s49
    s_mul_i32 s26, s14, 20000
    s_mul_i32 s24, s49, 20000
    s_add_u32 s14, s12, 1
    s_and_b32 s14, s14, 3
    s_mul_i32 s15, s14, 5120000
    s_add_u32 s15, s15, 259990016
    s_add_u32 s15, s15, s26
    buffer_load_dwordx4 v[12:15], v1, s[4:7], s15 offen sc1
    buffer_load_dwordx4 v[92:95], v2, s[4:7], s15 offen sc1
    s_add_u32 s14, s12, 2
    s_and_b32 s14, s14, 3
    s_mul_i32 s15, s14, 5120000
    s_add_u32 s15, s15, 259990016
    s_add_u32 s15, s15, s26
    buffer_load_dwordx4 v[16:19], v1, s[4:7], s15 offen sc1
    buffer_load_dwordx4 v[96:99], v2, s[4:7], s15 offen sc1
    s_add_u32 s14, s12, 3
    s_and_b32 s14, s14, 3
    s_mul_i32 s15, s14, 5120000
    s_add_u32 s15, s15, 259990016
    s_add_u32 s15, s15, s26
    buffer_load_dwordx4 v[20:23], v1, s[4:7], s15 offen sc1
    buffer_load_dwordx4 v[100:103], v2, s[4:7], s15 offen sc1
    v_add_u32 v24, s24, v1
    ds_read_b128 v[8:11], v24
    v_add_u32 v25, s24, v2
    ds_read_b128 v[88:91], v25
    s_waitcnt vmcnt(0) lgkmcnt(0)
    s_bfe_u32 s14, s20, 262164
    s_cbranch_scc0 L_p2_kernel_nof32a_6
    s_add_u32 s14, s12, 0
    s_and_b32 s14, s14, 3
    s_add_u32 s14, s14, 20
    s_bitcmp1_b32 s20, s14
    s_cbranch_scc0 L_p2_kernel_q_7
    v_mov_b32 v8, 1073758208
    v_mov_b32 v9, 1073758208
    v_mov_b32 v10, 1073758208
    v_mov_b32 v11, 1073758208
L_p2_kernel_q_7:
    s_add_u32 s14, s12, 1
    s_and_b32 s14, s14, 3
    s_add_u32 s14, s14, 20
    s_bitcmp1_b32 s20, s14
    s_cbranch_scc0 L_p2_kernel_q_8
    v_mov_b32 v12, 1073758208
    v_mov_b32 v13, 1073758208
    v_mov_b32 v14, 1073758208
    v_mov_b32 v15, 1073758208
L_p2_kernel_q_8:
    s_add_u32 s14, s12, 2
    s_and_b32 s14, s14, 3
    s_add_u32 s14, s14, 20
    s_bitcmp1_b32 s20, s14
    s_cbranch_scc0 L_p2_kernel_q_9
    v_mov_b32 v16, 1073758208
    v_mov_b32 v17, 1073758208
    v_mov_b32 v18, 1073758208
    v_mov_b32 v19, 1073758208
L_p2_kernel_q_9:
    s_add_u32 s14, s12, 3
    s_and_b32 s14, s14, 3
    s_add_u32 s14, s14, 20
    s_bitcmp1_b32 s20, s14
    s_cbranch_scc0 L_p2_kernel_q_10
    v_mov_b32 v20, 1073758208
    v_mov_b32 v21, 1073758208
    v_mov_b32 v22, 1073758208
    v_mov_b32 v23, 1073758208
L_p2_kernel_q_10:
L_p2_kernel_nof32a_6:
    v_pk_add_u16 v8, v8, v12
    v_pk_add_u16 v16, v16, v20
    v_pk_add_u16 v9, v9, v13
    v_pk_add_u16 v17, v17, v21
    v_pk_add_u16 v10, v10, v14
    v_pk_add_u16 v18, v18, v22
    v_pk_add_u16 v11, v11, v15
    v_pk_add_u16 v19, v19, v23
    v_add_u32_sdwa v24, v8, v16 dst_sel:DWORD dst_unused:UNUSED_PAD src0_sel:WORD_0 src1_sel:WORD_0
    v_add_u32_sdwa v25, v10, v18 dst_sel:DWORD dst_unused:UNUSED_PAD src0_sel:WORD_0 src1_sel:WORD_0
    v_add_u32_sdwa v26, v8, v16 dst_sel:DWORD dst_unused:UNUSED_PAD src0_sel:WORD_1 src1_sel:WORD_1
    v_add_u32_sdwa v27, v10, v18 dst_sel:DWORD dst_unused:UNUSED_PAD src0_sel:WORD_1 src1_sel:WORD_1
    v_add_u32_sdwa v28, v9, v17 dst_sel:DWORD dst_unused:UNUSED_PAD src0_sel:WORD_0 src1_sel:WORD_0
    v_add_u32_sdwa v29, v11, v19 dst_sel:DWORD dst_unused:UNUSED_PAD src0_sel:WORD_0 src1_sel:WORD_0
    v_add_u32_sdwa v30, v9, v17 dst_sel:DWORD dst_unused:UNUSED_PAD src0_sel:WORD_1 src1_sel:WORD_1
    v_add_u32_sdwa v31, v11, v19 dst_sel:DWORD dst_unused:UNUSED_PAD src0_sel:WORD_1 src1_sel:WORD_1
    v_cvt_f32_u32 v24, v24
    v_cvt_f32_u32 v25, v25
    v_cvt_f32_u32 v26, v26
    v_cvt_f32_u32 v27, v27
    v_cvt_f32_u32 v28, v28
    v_cvt_f32_u32 v29, v29
    v_cvt_f32_u32 v30, v30
    v_cvt_f32_u32 v31, v31
    v_pk_fma_f32 v[24:25], v[24:25], s[100:101], s[100:101] op_sel:[0,0,1] op_sel_hi:[1,0,1]
    v_pk_fma_f32 v[26:27], v[26:27], s[100:101], s[100:101] op_sel:[0,0,1] op_sel_hi:[1,0,1]
    v_pk_fma_f32 v[28:29], v[28:29], s[100:101], s[100:101] op_sel:[0,0,1] op_sel_hi:[1,0,1]
    v_pk_fma_f32 v[30:31], v[30:31], s[100:101], s[100:101] op_sel:[0,0,1] op_sel_hi:[1,0,1]
    s_bfe_u32 s14, s20, 262164
    s_cbranch_scc0 L_p2_kernel_nof32b_11
    v_lshlrev_b32 v32, 1, v1
    s_bitcmp1_b32 s20, 20
    s_cbranch_scc0 L_p2_kernel_q_12
    s_lshl_b32 s15, s26, 1
    s_add_u32 s15, s15, 280470016
    buffer_load_dwordx4 v[8:11], v32, s[4:7], s15 offen sc1
    buffer_load_dwordx4 v[12:15], v32, s[4:7], s15 offen offset:16 sc1
    s_waitcnt vmcnt(0)
    v_add_f32 v24, v24, v8
    v_add_f32 v25, v25, v12
    v_add_f32 v26, v26, v9
    v_add_f32 v27, v27, v13
    v_add_f32 v28, v28, v10
    v_add_f32 v29, v29, v14
    v_add_f32 v30, v30, v11
    v_add_f32 v31, v31, v15
L_p2_kernel_q_12:
    s_bitcmp1_b32 s20, 21
    s_cbranch_scc0 L_p2_kernel_q_13
    s_lshl_b32 s15, s26, 1
    s_add_u32 s15, s15, 290710016
    buffer_load_dwordx4 v[8:11], v32, s[4:7], s15 offen sc1
    buffer_load_dwordx4 v[12:15], v32, s[4:7], s15 offen offset:16 sc1
    s_waitcnt vmcnt(0)
    v_add_f32 v24, v24, v8
    v_add_f32 v25, v25, v12
    v_add_f32 v26, v26, v9
    v_add_f32 v27, v27, v13
    v_add_f32 v28, v28, v10
    v_add_f32 v29, v29, v14
    v_add_f32 v30, v30, v11
    v_add_f32 v31, v31, v15
L_p2_kernel_q_13:
    s_bitcmp1_b32 s20, 22
    s_cbranch_scc0 L_p2_kernel_q_14
    s_lshl_b32 s15, s26, 1
    s_add_u32 s15, s15, 300950016
    buffer_load_dwordx4 v[8:11], v32, s[4:7], s15 offen sc1
    buffer_load_dwordx4 v[12:15], v32, s[4:7], s15 offen offset:16 sc1
    s_waitcnt vmcnt(0)
    v_add_f32 v24, v24, v8
    v_add_f32 v25, v25, v12
    v_add_f32 v26, v26, v9
    v_add_f32 v27, v27, v13
    v_add_f32 v28, v28, v10
    v_add_f32 v29, v29, v14
    v_add_f32 v30, v30, v11
    v_add_f32 v31, v31, v15
L_p2_kernel_q_14:
    s_bitcmp1_b32 s20, 23
    s_cbranch_scc0 L_p2_kernel_q_15
    s_lshl_b32 s15, s26, 1
    s_add_u32 s15, s15, 311190016
    buffer_load_dwordx4 v[8:11], v32, s[4:7], s15 offen sc1
    buffer_load_dwordx4 v[12:15], v32, s[4:7], s15 offen offset:16 sc1
    s_waitcnt vmcnt(0)
    v_add_f32 v24, v24, v8
    v_add_f32 v25, v25, v12
    v_add_f32 v26, v26, v9
    v_add_f32 v27, v27, v13
    v_add_f32 v28, v28, v10
    v_add_f32 v29, v29, v14
    v_add_f32 v30, v30, v11
    v_add_f32 v31, v31, v15
L_p2_kernel_q_15:
L_p2_kernel_nof32b_11:
    v_pk_mul_f32 v[8:9], v[24:25], s[84:85] op_sel:[0,0] op_sel_hi:[1,0]
    v_pk_mul_f32 v[10:11], v[24:25], s[84:85] op_sel:[0,1] op_sel_hi:[1,1]
    v_pk_mul_f32 v[12:13], v[24:25], s[86:87] op_sel:[0,0] op_sel_hi:[1,0]
    v_pk_mul_f32 v[14:15], v[24:25], s[86:87] op_sel:[0,1] op_sel_hi:[1,1]
    v_pk_fma_f32 v[8:9], v[26:27], s[88:89], v[8:9] op_sel:[0,0,0] op_sel_hi:[1,0,1]
    v_pk_fma_f32 v[10:11], v[26:27], s[88:89], v[10:11] op_sel:[0,1,0] op_sel_hi:[1,1,1]
    v_pk_fma_f32 v[12:13], v[26:27], s[90:91], v[12:13] op_sel:[0,0,0] op_sel_hi:[1,0,1]
    v_pk_fma_f32 v[14:15], v[26:27], s[90:91], v[14:15] op_sel:[0,1,0] op_sel_hi:[1,1,1]
    v_pk_fma_f32 v[8:9], v[28:29], s[92:93], v[8:9] op_sel:[0,0,0] op_sel_hi:[1,0,1]
    v_pk_fma_f32 v[10:11], v[28:29], s[92:93], v[10:11] op_sel:[0,1,0] op_sel_hi:[1,1,1]
    v_pk_fma_f32 v[12:13], v[28:29], s[94:95], v[12:13] op_sel:[0,0,0] op_sel_hi:[1,0,1]
    v_pk_fma_f32 v[14:15], v[28:29], s[94:95], v[14:15] op_sel:[0,1,0] op_sel_hi:[1,1,1]
    v_pk_fma_f32 v[8:9], v[30:31], s[96:97], v[8:9] op_sel:[0,0,0] op_sel_hi:[1,0,1]
    v_pk_fma_f32 v[10:11], v[30:31], s[96:97], v[10:11] op_sel:[0,1,0] op_sel_hi:[1,1,1]
    v_pk_fma_f32 v[12:13], v[30:31], s[98:99], v[12:13] op_sel:[0,0,0] op_sel_hi:[1,0,1]
    v_pk_fma_f32 v[14:15], v[30:31], s[98:99], v[14:15] op_sel:[0,1,0] op_sel_hi:[1,1,1]
    v_pk_mul_f32 v[8:9], v[8:9], v[72:73]
    v_pk_mul_f32 v[10:11], v[10:11], v[74:75]
    v_pk_mul_f32 v[12:13], v[12:13], v[76:77]
    v_pk_mul_f32 v[14:15], v[14:15], v[78:79]
    v_pk_mul_f32 v[24:25], v[8:9], s[28:29] op_sel:[0,0] op_sel_hi:[1,0]
    v_pk_mul_f32 v[26:27], v[8:9], s[28:29] op_sel:[0,1] op_sel_hi:[1,1]
    v_pk_mul_f32 v[28:29], v[8:9], s[30:31] op_sel:[0,0] op_sel_hi:[1,0]
    v_pk_mul_f32 v[30:31], v[8:9], s[30:31] op_sel:[0,1] op_sel_hi:[1,1]
    v_pk_fma_f32 v[24:25], v[10:11], s[32:33], v[24:25] op_sel:[0,0,0] op_sel_hi:[1,0,1]
    v_pk_fma_f32 v[26:27], v[10:11], s[32:33], v[26:27] op_sel:[0,1,0] op_sel_hi:[1,1,1]
    v_pk_fma_f32 v[28:29], v[10:11], s[34:35], v[28:29] op_sel:[0,0,0] op_sel_hi:[1,0,1]
    v_pk_fma_f32 v[30:31], v[10:11], s[34:35], v[30:31] op_sel:[0,1,0] op_sel_hi:[1,1,1]
    v_pk_fma_f32 v[24:25], v[12:13], s[36:37], v[24:25] op_sel:[0,0,0] op_sel_hi:[1,0,1]
    v_pk_fma_f32 v[26:27], v[12:13], s[36:37], v[26:27] op_sel:[0,1,0] op_sel_hi:[1,1,1]
    v_pk_fma_f32 v[28:29], v[12:13], s[38:39], v[28:29] op_sel:[0,0,0] op_sel_hi:[1,0,1]
    v_pk_fma_f32 v[30:31], v[12:13], s[38:39], v[30:31] op_sel:[0,1,0] op_sel_hi:[1,1,1]
    v_pk_fma_f32 v[24:25], v[14:15], s[40:41], v[24:25] op_sel:[0,0,0] op_sel_hi:[1,0,1]
    v_pk_fma_f32 v[26:27], v[14:15], s[40:41], v[26:27] op_sel:[0,1,0] op_sel_hi:[1,1,1]
    v_pk_fma_f32 v[28:29], v[14:15], s[42:43], v[28:29] op_sel:[0,0,0] op_sel_hi:[1,0,1]
    v_pk_fma_f32 v[30:31], v[14:15], s[42:43], v[30:31] op_sel:[0,1,0] op_sel_hi:[1,1,1]
    v_lshlrev_b32 v8, 16, v64
    v_and_b32 v10, 0xffff0000, v64
    v_lshlrev_b32 v12, 16, v65
    v_and_b32 v14, 0xffff0000, v65
    v_lshlrev_b32 v9, 16, v66
    v_and_b32 v11, 0xffff0000, v66
    v_lshlrev_b32 v13, 16, v67
    v_and_b32 v15, 0xffff0000, v67
    v_pk_fma_f32 v[8:9], v[24:25], v[80:81], v[8:9]
    v_pk_fma_f32 v[10:11], v[26:27], v[82:83], v[10:11]
    v_pk_fma_f32 v[12:13], v[28:29], v[84:85], v[12:13]
    v_pk_fma_f32 v[14:15], v[30:31], v[86:87], v[14:15]
    v_cvt_pk_bf16_f32 v16, v8, v10
    v_cvt_pk_bf16_f32 v17, v12, v14
    v_cvt_pk_bf16_f32 v18, v9, v11
    v_cvt_pk_bf16_f32 v19, v13, v15
    buffer_store_dwordx4 v[16:19], v1, s[16:19], s26 offen
    s_cmp_ge_u32 s13, 4
    s_cbranch_scc1 L_p2_f1
    s_bfe_u32 s14, s20, 262164
    s_cbranch_scc0 L_p2_kernel_nof32a_16
    s_add_u32 s14, s12, 0
    s_and_b32 s14, s14, 3
    s_add_u32 s14, s14, 20
    s_bitcmp1_b32 s20, s14
    s_cbranch_scc0 L_p2_kernel_q_17
    v_mov_b32 v88, 1073758208
    v_mov_b32 v89, 1073758208
    v_mov_b32 v90, 1073758208
    v_mov_b32 v91, 1073758208
L_p2_kernel_q_17:
    s_add_u32 s14, s12, 1
    s_and_b32 s14, s14, 3
    s_add_u32 s14, s14, 20
    s_bitcmp1_b32 s20, s14
    s_cbranch_scc0 L_p2_kernel_q_18
    v_mov_b32 v92, 1073758208
    v_mov_b32 v93, 1073758208
    v_mov_b32 v94, 1073758208
    v_mov_b32 v95, 1073758208
L_p2_kernel_q_18:
    s_add_u32 s14, s12, 2
    s_and_b32 s14, s14, 3
    s_add_u32 s14, s14, 20
    s_bitcmp1_b32 s20, s14
    s_cbranch_scc0 L_p2_kernel_q_19
    v_mov_b32 v96, 1073758208
    v_mov_b32 v97, 1073758208
    v_mov_b32 v98, 1073758208
    v_mov_b32 v99, 1073758208
L_p2_kernel_q_19:
    s_add_u32 s14, s12, 3
    s_and_b32 s14, s14, 3
    s_add_u32 s14, s14, 20
    s_bitcmp1_b32 s20, s14
    s_cbranch_scc0 L_p2_kernel_q_20
    v_mov_b32 v100, 1073758208
    v_mov_b32 v101, 1073758208
    v_mov_b32 v102, 1073758208
    v_mov_b32 v103, 1073758208
L_p2_kernel_q_20:
L_p2_kernel_nof32a_16:
    v_pk_add_u16 v88, v88, v92
    v_pk_add_u16 v96, v96, v100
    v_pk_add_u16 v89, v89, v93
    v_pk_add_u16 v97, v97, v101
    v_pk_add_u16 v90, v90, v94
    v_pk_add_u16 v98, v98, v102
    v_pk_add_u16 v91, v91, v95
    v_pk_add_u16 v99, v99, v103
    v_add_u32_sdwa v24, v88, v96 dst_sel:DWORD dst_unused:UNUSED_PAD src0_sel:WORD_0 src1_sel:WORD_0
    v_add_u32_sdwa v25, v90, v98 dst_sel:DWORD dst_unused:UNUSED_PAD src0_sel:WORD_0 src1_sel:WORD_0
    v_add_u32_sdwa v26, v88, v96 dst_sel:DWORD dst_unused:UNUSED_PAD src0_sel:WORD_1 src1_sel:WORD_1
    v_add_u32_sdwa v27, v90, v98 dst_sel:DWORD dst_unused:UNUSED_PAD src0_sel:WORD_1 src1_sel:WORD_1
    v_add_u32_sdwa v28, v89, v97 dst_sel:DWORD dst_unused:UNUSED_PAD src0_sel:WORD_0 src1_sel:WORD_0
    v_add_u32_sdwa v29, v91, v99 dst_sel:DWORD dst_unused:UNUSED_PAD src0_sel:WORD_0 src1_sel:WORD_0
    v_add_u32_sdwa v30, v89, v97 dst_sel:DWORD dst_unused:UNUSED_PAD src0_sel:WORD_1 src1_sel:WORD_1
    v_add_u32_sdwa v31, v91, v99 dst_sel:DWORD dst_unused:UNUSED_PAD src0_sel:WORD_1 src1_sel:WORD_1
    v_cvt_f32_u32 v24, v24
    v_cvt_f32_u32 v25, v25
    v_cvt_f32_u32 v26, v26
    v_cvt_f32_u32 v27, v27
    v_cvt_f32_u32 v28, v28
    v_cvt_f32_u32 v29, v29
    v_cvt_f32_u32 v30, v30
    v_cvt_f32_u32 v31, v31
    v_pk_fma_f32 v[24:25], v[24:25], s[100:101], s[100:101] op_sel:[0,0,1] op_sel_hi:[1,0,1]
    v_pk_fma_f32 v[26:27], v[26:27], s[100:101], s[100:101] op_sel:[0,0,1] op_sel_hi:[1,0,1]
    v_pk_fma_f32 v[28:29], v[28:29], s[100:101], s[100:101] op_sel:[0,0,1] op_sel_hi:[1,0,1]
    v_pk_fma_f32 v[30:31], v[30:31], s[100:101], s[100:101] op_sel:[0,0,1] op_sel_hi:[1,0,1]
    s_bfe_u32 s14, s20, 262164
    s_cbranch_scc0 L_p2_kernel_nof32b_21
    v_lshlrev_b32 v32, 1, v2
    s_bitcmp1_b32 s20, 20
    s_cbranch_scc0 L_p2_kernel_q_22
    s_lshl_b32 s15, s26, 1
    s_add_u32 s15, s15, 280470016
    buffer_load_dwordx4 v[88:91], v32, s[4:7], s15 offen sc1
    buffer_load_dwordx4 v[92:95], v32, s[4:7], s15 offen offset:16 sc1
    s_waitcnt vmcnt(0)
    v_add_f32 v24, v24, v88
    v_add_f32 v25, v25, v92
    v_add_f32 v26, v26, v89
    v_add_f32 v27, v27, v93
    v_add_f32 v28, v28, v90
    v_add_f32 v29, v29, v94
    v_add_f32 v30, v30, v91
    v_add_f32 v31, v31, v95
L_p2_kernel_q_22:
    s_bitcmp1_b32 s20, 21
    s_cbranch_scc0 L_p2_kernel_q_23
    s_lshl_b32 s15, s26, 1
    s_add_u32 s15, s15, 290710016
    buffer_load_dwordx4 v[88:91], v32, s[4:7], s15 offen sc1
    buffer_load_dwordx4 v[92:95], v32, s[4:7], s15 offen offset:16 sc1
    s_waitcnt vmcnt(0)
    v_add_f32 v24, v24, v88
    v_add_f32 v25, v25, v92
    v_add_f32 v26, v26, v89
    v_add_f32 v27, v27, v93
    v_add_f32 v28, v28, v90
    v_add_f32 v29, v29, v94
    v_add_f32 v30, v30, v91
    v_add_f32 v31, v31, v95
L_p2_kernel_q_23:
    s_bitcmp1_b32 s20, 22
    s_cbranch_scc0 L_p2_kernel_q_24
    s_lshl_b32 s15, s26, 1
    s_add_u32 s15, s15, 300950016
    buffer_load_dwordx4 v[88:91], v32, s[4:7], s15 offen sc1
    buffer_load_dwordx4 v[92:95], v32, s[4:7], s15 offen offset:16 sc1
    s_waitcnt vmcnt(0)
    v_add_f32 v24, v24, v88
    v_add_f32 v25, v25, v92
    v_add_f32 v26, v26, v89
    v_add_f32 v27, v27, v93
    v_add_f32 v28, v28, v90
    v_add_f32 v29, v29, v94
    v_add_f32 v30, v30, v91
    v_add_f32 v31, v31, v95
L_p2_kernel_q_24:
    s_bitcmp1_b32 s20, 23
    s_cbranch_scc0 L_p2_kernel_q_25
    s_lshl_b32 s15, s26, 1
    s_add_u32 s15, s15, 311190016
    buffer_load_dwordx4 v[88:91], v32, s[4:7], s15 offen sc1
    buffer_load_dwordx4 v[92:95], v32, s[4:7], s15 offen offset:16 sc1
    s_waitcnt vmcnt(0)
    v_add_f32 v24, v24, v88
    v_add_f32 v25, v25, v92
    v_add_f32 v26, v26, v89
    v_add_f32 v27, v27, v93
    v_add_f32 v28, v28, v90
    v_add_f32 v29, v29, v94
    v_add_f32 v30, v30, v91
    v_add_f32 v31, v31, v95
L_p2_kernel_q_25:
L_p2_kernel_nof32b_21:
    v_pk_mul_f32 v[88:89], v[24:25], s[84:85] op_sel:[0,0] op_sel_hi:[1,0]
    v_pk_mul_f32 v[90:91], v[24:25], s[84:85] op_sel:[0,1] op_sel_hi:[1,1]
    v_pk_mul_f32 v[92:93], v[24:25], s[86:87] op_sel:[0,0] op_sel_hi:[1,0]
    v_pk_mul_f32 v[94:95], v[24:25], s[86:87] op_sel:[0,1] op_sel_hi:[1,1]
    v_pk_fma_f32 v[88:89], v[26:27], s[88:89], v[88:89] op_sel:[0,0,0] op_sel_hi:[1,0,1]
    v_pk_fma_f32 v[90:91], v[26:27], s[88:89], v[90:91] op_sel:[0,1,0] op_sel_hi:[1,1,1]
    v_pk_fma_f32 v[92:93], v[26:27], s[90:91], v[92:93] op_sel:[0,0,0] op_sel_hi:[1,0,1]
    v_pk_fma_f32 v[94:95], v[26:27], s[90:91], v[94:95] op_sel:[0,1,0] op_sel_hi:[1,1,1]
    v_pk_fma_f32 v[88:89], v[28:29], s[92:93], v[88:89] op_sel:[0,0,0] op_sel_hi:[1,0,1]
    v_pk_fma_f32 v[90:91], v[28:29], s[92:93], v[90:91] op_sel:[0,1,0] op_sel_hi:[1,1,1]
    v_pk_fma_f32 v[92:93], v[28:29], s[94:95], v[92:93] op_sel:[0,0,0] op_sel_hi:[1,0,1]
    v_pk_fma_f32 v[94:95], v[28:29], s[94:95], v[94:95] op_sel:[0,1,0] op_sel_hi:[1,1,1]
    v_pk_fma_f32 v[88:89], v[30:31], s[96:97], v[88:89] op_sel:[0,0,0] op_sel_hi:[1,0,1]
    v_pk_fma_f32 v[90:91], v[30:31], s[96:97], v[90:91] op_sel:[0,1,0] op_sel_hi:[1,1,1]
    v_pk_fma_f32 v[92:93], v[30:31], s[98:99], v[92:93] op_sel:[0,0,0] op_sel_hi:[1,0,1]
    v_pk_fma_f32 v[94:95], v[30:31], s[98:99], v[94:95] op_sel:[0,1,0] op_sel_hi:[1,1,1]
    v_pk_mul_f32 v[88:89], v[88:89], v[112:113]
    v_pk_mul_f32 v[90:91], v[90:91], v[114:115]
    v_pk_mul_f32 v[92:93], v[92:93], v[116:117]
    v_pk_mul_f32 v[94:95], v[94:95], v[118:119]
    v_pk_mul_f32 v[24:25], v[88:89], s[28:29] op_sel:[0,0] op_sel_hi:[1,0]
    v_pk_mul_f32 v[26:27], v[88:89], s[28:29] op_sel:[0,1] op_sel_hi:[1,1]
    v_pk_mul_f32 v[28:29], v[88:89], s[30:31] op_sel:[0,0] op_sel_hi:[1,0]
    v_pk_mul_f32 v[30:31], v[88:89], s[30:31] op_sel:[0,1] op_sel_hi:[1,1]
    v_pk_fma_f32 v[24:25], v[90:91], s[32:33], v[24:25] op_sel:[0,0,0] op_sel_hi:[1,0,1]
    v_pk_fma_f32 v[26:27], v[90:91], s[32:33], v[26:27] op_sel:[0,1,0] op_sel_hi:[1,1,1]
    v_pk_fma_f32 v[28:29], v[90:91], s[34:35], v[28:29] op_sel:[0,0,0] op_sel_hi:[1,0,1]
    v_pk_fma_f32 v[30:31], v[90:91], s[34:35], v[30:31] op_sel:[0,1,0] op_sel_hi:[1,1,1]
    v_pk_fma_f32 v[24:25], v[92:93], s[36:37], v[24:25] op_sel:[0,0,0] op_sel_hi:[1,0,1]
    v_pk_fma_f32 v[26:27], v[92:93], s[36:37], v[26:27] op_sel:[0,1,0] op_sel_hi:[1,1,1]
    v_pk_fma_f32 v[28:29], v[92:93], s[38:39], v[28:29] op_sel:[0,0,0] op_sel_hi:[1,0,1]
    v_pk_fma_f32 v[30:31], v[92:93], s[38:39], v[30:31] op_sel:[0,1,0] op_sel_hi:[1,1,1]
    v_pk_fma_f32 v[24:25], v[94:95], s[40:41], v[24:25] op_sel:[0,0,0] op_sel_hi:[1,0,1]
    v_pk_fma_f32 v[26:27], v[94:95], s[40:41], v[26:27] op_sel:[0,1,0] op_sel_hi:[1,1,1]
    v_pk_fma_f32 v[28:29], v[94:95], s[42:43], v[28:29] op_sel:[0,0,0] op_sel_hi:[1,0,1]
    v_pk_fma_f32 v[30:31], v[94:95], s[42:43], v[30:31] op_sel:[0,1,0] op_sel_hi:[1,1,1]
    v_lshlrev_b32 v88, 16, v68
    v_and_b32 v90, 0xffff0000, v68
    v_lshlrev_b32 v92, 16, v69
    v_and_b32 v94, 0xffff0000, v69
    v_lshlrev_b32 v89, 16, v70
    v_and_b32 v91, 0xffff0000, v70
    v_lshlrev_b32 v93, 16, v71
    v_and_b32 v95, 0xffff0000, v71
    v_pk_fma_f32 v[88:89], v[24:25], v[120:121], v[88:89]
    v_pk_fma_f32 v[90:91], v[26:27], v[122:123], v[90:91]
    v_pk_fma_f32 v[92:93], v[28:29], v[124:125], v[92:93]
    v_pk_fma_f32 v[94:95], v[30:31], v[126:127], v[94:95]
    v_cvt_pk_bf16_f32 v96, v88, v90
    v_cvt_pk_bf16_f32 v97, v92, v94
    v_cvt_pk_bf16_f32 v98, v89, v91
    v_cvt_pk_bf16_f32 v99, v93, v95
    buffer_store_dwordx4 v[96:99], v2, s[16:19], s26 offen
L_p2_f1:
    s_bitset0_b32 s51, s49
    s_cmp_eq_u32 s51, 0
    s_cbranch_scc1 L_p2_done
    s_ff1_i32_b32 s49, s51
    s_lshl2_add_u32 s14, s3, s49
    s_mul_i32 s26, s14, 20000
    s_lshr_b32 s14, s26, 2
    s_add_u32 s15, s26, 254870016
    buffer_load_dword v60, v3, s[44:47], s14 offen nt
    buffer_load_dword v61, v5, s[44:47], s14 offen nt
    buffer_load_dwordx4 v[64:67], v1, s[4:7], s15 offen
    buffer_load_dwordx4 v[68:71], v2, s[4:7], s15 offen
    s_waitcnt vmcnt(0)
    s_branch L_p2_gates
L_p2_done:
    s_branch L_p2_end
L_p2_slow:
    s_barrier
    v_mov_b32 v8, 0
    v_mov_b32 v9, 0
    v_mov_b32 v10, 0
    v_mov_b32 v11, 0
    v_mov_b32 v12, v1
    ds_write_b128 v12, v[8:11]
    v_add_u32 v12, 16384, v12
    ds_write_b128 v12, v[8:11]
    v_add_u32 v12, 16384, v12
    ds_write_b128 v12, v[8:11]
    v_add_u32 v12, 16384, v12
    ds_write_b128 v12, v[8:11]
    v_add_u32 v12, 16384, v12
    ds_write_b128 v12, v[8:11]
    v_add_u32 v12, 16384, v12
    ds_write_b128 v12, v[8:11]
    v_add_u32 v12, 16384, v12
    ds_write_b128 v12, v[8:11]
    v_add_u32 v12, 16384, v12
    ds_write_b128 v12, v[8:11]
    v_add_u32 v12, 16384, v12
    ds_write_b128 v12, v[8:11]
    v_add_u32 v12, 16384, v12
    ds_write_b128 v12, v[8:11]
    v_add_u32 v12, 16384, v12
    v_lshlrev_b32 v13, 4, v0
    v_add_u32 v28, 32896, v13
    v_mul_lo_u32 v14, v0, s23
    v_add_u32 v14, 8192, v14
    s_mul_i32 s25, s12, 65
    s_add_u32 s25, s25, s3
    s_mul_i32 s25, s25, 32896
    s_add_u32 s25, s25, 246292480
    s_lshl_b32 s50, s50, 1
    s_mul_i32 s22, s12, 1280000
    s_mov_b32 s24, 0
    s_waitcnt lgkmcnt(0)
    s_barrier
L_p2_sstep:
    buffer_load_ushort v15, v13, s[4:7], s25 offen
    buffer_load_ushort v16, v28, s[4:7], s25 offen
    s_waitcnt vmcnt(0)
L_p2_srec:
    v_cmp_lt_u32 vcc, v15, v16
    s_nop 1
    s_and_b64 exec, exec, vcc
    s_cbranch_execz L_p2_sdone
    v_lshrrev_b32 v17, 1, v15
    v_and_b32 v18, 1, v15
    v_mad_u32_u24 v17, v17, 12, v14
    v_lshl_add_u32 v19, v18, 2, v17
    v_lshl_add_u32 v17, v18, 1, v17
    buffer_load_dword v20, v19, s[4:7], 0 offen
    buffer_load_ushort v21, v17, s[4:7], 0 offen offset:8
    v_add_u32 v15, 1, v15
    s_waitcnt vmcnt(0)
    v_lshlrev_b32_sdwa v19, 3, v20 dst_sel:DWORD dst_unused:UNUSED_PAD src0_sel:DWORD src1_sel:WORD_0
    buffer_load_dwordx2 v[22:23], v19, s[8:11], s22 offen
    v_mad_u32_u16 v20, v20, 16, s50 op_sel:[1,0,0,0]
    v_lshlrev_b32 v21, 16, v21
    s_waitcnt vmcnt(0)
    v_lshlrev_b32 v24, 16, v22
    v_and_b32 v25, 0xffff0000, v22
    v_lshlrev_b32 v26, 16, v23
    v_and_b32 v27, 0xffff0000, v23
    v_mul_f32 v24, v21, v24
    v_mul_f32 v25, v21, v25
    v_mul_f32 v26, v21, v26
    v_mul_f32 v27, v21, v27
    ds_add_f32 v20, v24
    ds_add_f32 v20, v25 offset:4
    ds_add_f32 v20, v26 offset:8
    ds_add_f32 v20, v27 offset:12
    s_branch L_p2_srec
L_p2_sdone:
    s_mov_b64 exec, -1
    s_cmp_eq_u32 s24, 7
    s_cselect_b32 s14, 16370, 2
    s_add_u32 s25, s25, s14
    s_add_u32 s22, s22, 80000
    s_add_u32 s24, s24, 1
    s_cmp_lt_u32 s24, 16
    s_cbranch_scc1 L_p2_sstep
    s_waitcnt lgkmcnt(0)
    s_barrier
    s_mul_i32 s14, s12, 10240000
    s_mul_i32 s15, s3, 160000
    s_add_u32 s26, s14, s15
    s_add_u32 s26, s26, 280470016
    v_mov_b32 v12, v1
    s_mov_b32 s24, 0
L_p2_sout:
    v_cmp_gt_u32 vcc, 160000, v12
    ds_read_b128 v[8:11], v12
    s_nop 0
    s_and_b64 exec, exec, vcc
    s_cbranch_execz L_p2_sfin
    s_waitcnt lgkmcnt(0)
    buffer_store_dwordx4 v[8:11], v12, s[4:7], s26 offen sc1
    s_waitcnt vmcnt(0)
    v_add_u32 v12, 16384, v12
    s_branch L_p2_sout
L_p2_sfin:
    s_mov_b64 exec, -1
    s_waitcnt vmcnt(0) lgkmcnt(0)
    s_barrier
    s_branch L_p2_signal
L_p2_end:
    s_endpgm
.section .rodata,"a"
.p2align 6
.amdhsa_kernel p1_kernel
  .amdhsa_next_free_vgpr 128
  .amdhsa_next_free_sgpr 96
  .amdhsa_accum_offset 128
  .amdhsa_group_segment_fixed_size 0
  .amdhsa_kernarg_size 112
  .amdhsa_user_sgpr_count 2
  .amdhsa_user_sgpr_kernarg_segment_ptr 1
  .amdhsa_system_sgpr_workgroup_id_x 1
  .amdhsa_float_denorm_mode_32 0
.end_amdhsa_kernel
.p2align 6
.amdhsa_kernel p2_kernel
  .amdhsa_next_free_vgpr 128
  .amdhsa_next_free_sgpr 102
  .amdhsa_accum_offset 128
  .amdhsa_group_segment_fixed_size 0
  .amdhsa_kernarg_size 112
  .amdhsa_user_sgpr_count 2
  .amdhsa_user_sgpr_kernarg_segment_ptr 1
  .amdhsa_system_sgpr_workgroup_id_x 1
  .amdhsa_float_denorm_mode_32 0
.end_amdhsa_kernel
```

```asm
; @launch kernel=p1_kernel grid=(256,1,1) block=(1024,1,1) lds=163840
; @launch kernel=p2_kernel grid=(256,1,1) block=(1024,1,1) lds=163840
.amdgcn_target "amdgcn-amd-amdhsa--gfx950"
.text
.globl p1_kernel
.p2align 8
.type p1_kernel,@function
p1_kernel:
    s_cmp_ge_u32 s2, 256
    s_cbranch_scc1 L_p1_end
    s_load_dwordx2 s[4:5], s[0:1], 104
    s_load_dwordx2 s[8:9], s[0:1], 8
    s_load_dwordx2 s[12:13], s[0:1], 16
    s_load_dwordx2 s[16:17], s[0:1], 32
    s_load_dwordx2 s[28:29], s[0:1], 0
    s_load_dwordx2 s[6:7], s[0:1], 48
    v_lshlrev_b32 v1, 4, v0
    v_lshlrev_b32 v2, 3, v0
    v_lshrrev_b32 v6, 6, v0
    v_mul_u32_u24 v3, 1216, v6
    v_add_u32 v3, v3, v0
    v_mul_u32_u24 v3, 12, v3
    v_mov_b32 v4, 1
    v_mov_b32 v5, 0
    v_readfirstlane_b32 s39, v6
    v_cmp_gt_u32 vcc, 784, v0
    s_mov_b32 s32, s2
    s_lshl_b32 s33, s2, 14
    s_lshl_b32 s34, s2, 13
    s_mul_i32 s48, s2, 3840
    s_mul_i32 s49, s2, 1920
    s_mov_b64 s[44:45], vcc
    s_waitcnt lgkmcnt(0)
    s_load_dword s3, s[6:7], 0
    s_mov_b32 s10, 163840000
    s_mov_b32 s11, 0x00020000
    s_mov_b32 s14, 163840000
    s_mov_b32 s15, 0x00020000
    s_mov_b32 s18, 81920000
    s_mov_b32 s19, 0x00020000
    s_mul_i32 s36, s2, 20000
    s_add_u32 s30, s36, 20000
    s_mov_b32 s31, 0x00020000
    s_add_u32 s35, s36, 16384
    buffer_load_dwordx4 v[48:51], v1, s[28:31], s36 offen nt
    buffer_load_dwordx4 v[52:55], v1, s[28:31], s35 offen nt
    s_add_u32 s35, s33, 0
    buffer_load_dwordx4 v[16:19], v1, s[8:11], s35 offen nt
    s_add_u32 s35, s33, 0
    buffer_load_dwordx4 v[20:23], v1, s[12:15], s35 offen nt
    s_add_u32 s35, s33, 4194304
    buffer_load_dwordx4 v[24:27], v1, s[8:11], s35 offen nt
    s_add_u32 s35, s33, 4194304
    buffer_load_dwordx4 v[28:31], v1, s[12:15], s35 offen nt
    s_add_u32 s35, s33, 8388608
    buffer_load_dwordx4 v[32:35], v1, s[8:11], s35 offen nt
    s_add_u32 s35, s33, 8388608
    buffer_load_dwordx4 v[36:39], v1, s[12:15], s35 offen nt
    s_add_u32 s35, s33, 12582912
    buffer_load_dwordx4 v[40:43], v1, s[8:11], s35 offen nt
    s_add_u32 s35, s33, 12582912
    buffer_load_dwordx4 v[44:47], v1, s[12:15], s35 offen nt
    s_mov_b32 s20, s4
    s_mov_b32 s21, s5
    s_mov_b32 s22, 0
    s_mov_b32 s23, 0x00020000
    s_add_u32 s24, s4, 246292480
    s_addc_u32 s25, s5, 0
    s_mov_b32 s26, 8577536
    s_mov_b32 s27, 0x00020000
    s_mov_b32 s37, 1492179184
    s_mov_b32 s55, 0
    s_mov_b32 s38, 262400
    s_mov_b32 s43, 0x05040100
    s_mov_b32 s40, 0
    v_mov_b32 v8, 0
    v_mov_b32 v9, 0
    v_mov_b32 v10, 0
    v_mov_b32 v11, 0
    ds_write_b128 v1, v[8:11] offset:0
    s_waitcnt lgkmcnt(0)
    s_lshl_b32 s3, s3, 16
    v_mov_b32 v12, s3
    v_mul_f32 v12, 0.15915494, v12
    s_nop 0
    v_readfirstlane_b32 s41, v12
    s_waitcnt vmcnt(8)
    s_add_u32 s28, s4, 254870016
    s_addc_u32 s29, s5, 0
    s_mul_i32 s36, s2, 20000
    s_add_u32 s35, s36, 16384
    buffer_store_dwordx4 v[48:51], v1, s[28:31], s36 offen
    buffer_store_dwordx4 v[52:55], v1, s[28:31], s35 offen
    s_nop 0
    v_mov_b32 v12, 0x3f803f80
    v_and_b32 v48, 0x7fff7fff, v48
    v_and_b32 v49, 0x7fff7fff, v49
    v_and_b32 v50, 0x7fff7fff, v50
    v_and_b32 v51, 0x7fff7fff, v51
    v_and_b32 v52, 0x7fff7fff, v52
    v_and_b32 v53, 0x7fff7fff, v53
    v_and_b32 v54, 0x7fff7fff, v54
    v_and_b32 v55, 0x7fff7fff, v55
    v_pk_max_u16 v8, v8, v48
    v_dot2c_f32_bf16 v9, v48, v12
    v_pk_max_u16 v8, v8, v49
    v_dot2c_f32_bf16 v9, v49, v12
    v_pk_max_u16 v8, v8, v50
    v_dot2c_f32_bf16 v9, v50, v12
    v_pk_max_u16 v8, v8, v51
    v_dot2c_f32_bf16 v9, v51, v12
    v_pk_max_u16 v8, v8, v52
    v_dot2c_f32_bf16 v9, v52, v12
    v_pk_max_u16 v8, v8, v53
    v_dot2c_f32_bf16 v9, v53, v12
    v_pk_max_u16 v8, v8, v54
    v_dot2c_f32_bf16 v9, v54, v12
    v_pk_max_u16 v8, v8, v55
    v_dot2c_f32_bf16 v9, v55, v12
    v_lshrrev_b32 v10, 16, v8
    v_and_b32 v8, 0xffff, v8
    v_max_u32 v8, v8, v10
    s_nop 0
    s_nop 1
    v_max_u32_dpp v8, v8, v8 row_shr:1 row_mask:0xf bank_mask:0xf bound_ctrl:0
    s_nop 1
    v_max_u32_dpp v8, v8, v8 row_shr:2 row_mask:0xf bank_mask:0xf bound_ctrl:0
    s_nop 1
    v_max_u32_dpp v8, v8, v8 row_shr:4 row_mask:0xf bank_mask:0xf bound_ctrl:0
    s_nop 1
    v_max_u32_dpp v8, v8, v8 row_shr:8 row_mask:0xf bank_mask:0xf bound_ctrl:0
    s_nop 1
    v_max_u32_dpp v8, v8, v8 row_bcast:15 row_mask:0xa bank_mask:0xf
    s_nop 1
    v_max_u32_dpp v8, v8, v8 row_bcast:31 row_mask:0xc bank_mask:0xf
    s_nop 1
    v_add_f32_dpp v9, v9, v9 row_shr:1 row_mask:0xf bank_mask:0xf bound_ctrl:0
    s_nop 1
    v_add_f32_dpp v9, v9, v9 row_shr:2 row_mask:0xf bank_mask:0xf bound_ctrl:0
    s_nop 1
    v_add_f32_dpp v9, v9, v9 row_shr:4 row_mask:0xf bank_mask:0xf bound_ctrl:0
    s_nop 1
    v_add_f32_dpp v9, v9, v9 row_shr:8 row_mask:0xf bank_mask:0xf bound_ctrl:0
    s_nop 1
    v_add_f32_dpp v9, v9, v9 row_bcast:15 row_mask:0xa bank_mask:0xf
    s_nop 1
    v_add_f32_dpp v9, v9, v9 row_bcast:31 row_mask:0xc bank_mask:0xf
    s_lshl_b32 s35, s39, 4
    s_add_u32 s35, s35, 160320
    v_mov_b32 v10, s35
    s_mov_b32 exec_lo, 0
    s_brev_b32 exec_hi, 1
    ds_write_b64 v10, v[8:9]
    s_mov_b64 exec, -1
    s_waitcnt lgkmcnt(0)
    s_barrier
    s_branch L_p1_first
L_p1_loop:
    s_mov_b32 s36, 6144
    buffer_store_dwordx3 v[80:82], v3, s[20:23], s36 offen sc1
    s_mov_b32 s36, 6912
    buffer_store_dwordx3 v[84:86], v3, s[20:23], s36 offen sc1
    s_nop 0
    s_add_u32 s35, s33, 16777216
    buffer_load_dwordx4 v[80:83], v1, s[8:11], s35 offen nt
    s_add_u32 s35, s33, 16777216
    buffer_load_dwordx4 v[84:87], v1, s[12:15], s35 offen nt
    s_mov_b32 s36, 7680
    buffer_store_dwordx3 v[88:90], v3, s[20:23], s36 offen sc1
    s_mov_b32 s36, 8448
    buffer_store_dwordx3 v[92:94], v3, s[20:23], s36 offen sc1
    s_nop 0
    s_add_u32 s35, s33, 20971520
    buffer_load_dwordx4 v[88:91], v1, s[8:11], s35 offen nt
    s_add_u32 s35, s33, 20971520
    buffer_load_dwordx4 v[92:95], v1, s[12:15], s35 offen nt
    s_mov_b32 s36, 9216
    buffer_store_dwordx3 v[96:98], v3, s[20:23], s36 offen sc1
    s_mov_b32 s36, 9984
    buffer_store_dwordx3 v[100:102], v3, s[20:23], s36 offen sc1
    s_nop 0
    s_add_u32 s35, s33, 25165824
    buffer_load_dwordx4 v[96:99], v1, s[8:11], s35 offen nt
    s_add_u32 s35, s33, 25165824
    buffer_load_dwordx4 v[100:103], v1, s[12:15], s35 offen nt
    s_mov_b32 s36, 10752
    buffer_store_dwordx3 v[104:106], v3, s[20:23], s36 offen sc1
    s_mov_b32 s36, 11520
    buffer_store_dwordx3 v[108:110], v3, s[20:23], s36 offen sc1
    s_nop 0
    s_add_u32 s35, s33, 29360128
    buffer_load_dwordx4 v[104:107], v1, s[8:11], s35 offen nt
    s_add_u32 s35, s33, 29360128
    buffer_load_dwordx4 v[108:111], v1, s[12:15], s35 offen nt
    s_mov_b32 s36, 12288
    buffer_store_dwordx3 v[112:114], v3, s[20:23], s36 offen sc1
    s_mov_b32 s36, 13056
    buffer_store_dwordx3 v[116:118], v3, s[20:23], s36 offen sc1
    s_nop 0
    s_add_u32 s35, s33, 33554432
    buffer_load_dwordx4 v[112:115], v1, s[8:11], s35 offen nt
    s_add_u32 s35, s33, 33554432
    buffer_load_dwordx4 v[116:119], v1, s[12:15], s35 offen nt
    s_mov_b32 s36, 13824
    buffer_store_dwordx3 v[120:122], v3, s[20:23], s36 offen sc1
    s_mov_b32 s36, 14592
    buffer_store_dwordx3 v[124:126], v3, s[20:23], s36 offen sc1
    s_nop 0
    s_add_u32 s35, s33, 37748736
    s_sub_u32 s35, s35, s48
    v_cndmask_b32 v120, 2.0, v1, s[44:45]
    buffer_load_dwordx4 v[120:123], v120, s[8:11], s35 offen nt
    s_add_u32 s35, s33, 37748736
    s_sub_u32 s35, s35, s48
    v_cndmask_b32 v124, 2.0, v1, s[44:45]
    buffer_load_dwordx4 v[124:127], v124, s[12:15], s35 offen nt
    s_mov_b32 s36, 0
    buffer_store_dwordx3 v[48:50], v3, s[20:23], s36 offen sc1
    s_mov_b32 s36, 768
    buffer_store_dwordx3 v[52:54], v3, s[20:23], s36 offen sc1
    s_mov_b32 s36, 1536
    buffer_store_dwordx3 v[56:58], v3, s[20:23], s36 offen sc1
    s_mov_b32 s36, 2304
    buffer_store_dwordx3 v[60:62], v3, s[20:23], s36 offen sc1
    s_mov_b32 s36, 3072
    buffer_store_dwordx3 v[64:66], v3, s[20:23], s36 offen sc1
    s_mov_b32 s36, 3840
    buffer_store_dwordx3 v[68:70], v3, s[20:23], s36 offen sc1
    s_mov_b32 s36, 4608
    buffer_store_dwordx3 v[72:74], v3, s[20:23], s36 offen sc1
    s_mov_b32 s36, 5376
    buffer_store_dwordx3 v[76:78], v3, s[20:23], s36 offen sc1
    s_branch L_p1_join
L_p1_first:
    s_add_u32 s35, s33, 16777216
    buffer_load_dwordx4 v[80:83], v1, s[8:11], s35 offen nt
    s_add_u32 s35, s33, 16777216
    buffer_load_dwordx4 v[84:87], v1, s[12:15], s35 offen nt
    s_add_u32 s35, s33, 20971520
    buffer_load_dwordx4 v[88:91], v1, s[8:11], s35 offen nt
    s_add_u32 s35, s33, 20971520
    buffer_load_dwordx4 v[92:95], v1, s[12:15], s35 offen nt
    s_add_u32 s35, s33, 25165824
    buffer_load_dwordx4 v[96:99], v1, s[8:11], s35 offen nt
    s_add_u32 s35, s33, 25165824
    buffer_load_dwordx4 v[100:103], v1, s[12:15], s35 offen nt
    s_add_u32 s35, s33, 29360128
    buffer_load_dwordx4 v[104:107], v1, s[8:11], s35 offen nt
    s_add_u32 s35, s33, 29360128
    buffer_load_dwordx4 v[108:111], v1, s[12:15], s35 offen nt
    s_add_u32 s35, s33, 33554432
    buffer_load_dwordx4 v[112:115], v1, s[8:11], s35 offen nt
    s_add_u32 s35, s33, 33554432
    buffer_load_dwordx4 v[116:119], v1, s[12:15], s35 offen nt
    s_add_u32 s35, s33, 37748736
    s_sub_u32 s35, s35, s48
    v_cndmask_b32 v120, 2.0, v1, s[44:45]
    buffer_load_dwordx4 v[120:123], v120, s[8:11], s35 offen nt
    s_add_u32 s35, s33, 37748736
    s_sub_u32 s35, s35, s48
    v_cndmask_b32 v124, 2.0, v1, s[44:45]
    buffer_load_dwordx4 v[124:127], v124, s[12:15], s35 offen nt
L_p1_join:
    s_waitcnt vmcnt(18)
    v_perm_b32 v6, v20, v16, s43
    v_perm_b32 v7, v21, v17, s43
    v_perm_b32 v8, v22, v18, s43
    v_perm_b32 v9, v23, v19, s43
    v_mul_hi_u32_u24 v16, 429497, v16
    v_mul_hi_u32_u24 v20, 429497, v20
    v_mul_hi_u32_u24 v17, 429497, v17
    v_mul_hi_u32_u24 v21, 429497, v21
    v_mul_hi_u32_u24 v18, 429497, v18
    v_mul_hi_u32_u24 v22, 429497, v22
    v_mul_hi_u32_u24 v19, 429497, v19
    v_mul_hi_u32_u24 v23, 429497, v23
    v_lshl_or_b32 v16, v20, 16, v16
    v_lshl_or_b32 v17, v21, 16, v17
    v_lshl_or_b32 v18, v22, 16, v18
    v_lshl_or_b32 v19, v23, 16, v19
    v_dot2_u32_u16 v20, v16, s38, 0
    v_dot2_u32_u16 v21, v17, s38, 0
    v_dot2_u32_u16 v22, v18, s38, 0
    v_dot2_u32_u16 v23, v19, s38, 0
    v_pk_mad_u16 v6, v16, s37, v6
    v_pk_mad_u16 v7, v17, s37, v7
    v_pk_mad_u16 v8, v18, s37, v8
    v_pk_mad_u16 v9, v19, s37, v9
    ds_add_u32 v20, v4 offset:0
    ds_add_u32 v21, v4 offset:0
    ds_add_u32 v22, v4 offset:0
    ds_add_u32 v23, v4 offset:0
    v_perm_b32 v55, v23, v22, s43
    v_perm_b32 v54, v21, v20, s43
    v_or_b32 v48, 0x40000000, v6
    v_or_b32 v49, 0x40000000, v7
    v_or_b32 v52, 0x40000000, v8
    v_or_b32 v53, 0x40000000, v9
    s_waitcnt vmcnt(16)
    v_perm_b32 v6, v28, v24, s43
    v_perm_b32 v7, v29, v25, s43
    v_perm_b32 v8, v30, v26, s43
    v_perm_b32 v9, v31, v27, s43
    v_mul_hi_u32_u24 v24, 429497, v24
    v_mul_hi_u32_u24 v28, 429497, v28
    v_mul_hi_u32_u24 v25, 429497, v25
    v_mul_hi_u32_u24 v29, 429497, v29
    v_mul_hi_u32_u24 v26, 429497, v26
    v_mul_hi_u32_u24 v30, 429497, v30
    v_mul_hi_u32_u24 v27, 429497, v27
    v_mul_hi_u32_u24 v31, 429497, v31
    v_lshl_or_b32 v24, v28, 16, v24
    v_lshl_or_b32 v25, v29, 16, v25
    v_lshl_or_b32 v26, v30, 16, v26
    v_lshl_or_b32 v27, v31, 16, v27
    v_dot2_u32_u16 v28, v24, s38, 0
    v_dot2_u32_u16 v29, v25, s38, 0
    v_dot2_u32_u16 v30, v26, s38, 0
    v_dot2_u32_u16 v31, v27, s38, 0
    v_pk_mad_u16 v6, v24, s37, v6
    v_pk_mad_u16 v7, v25, s37, v7
    v_pk_mad_u16 v8, v26, s37, v8
    v_pk_mad_u16 v9, v27, s37, v9
    ds_add_u32 v28, v4 offset:0
    ds_add_u32 v29, v4 offset:0
    ds_add_u32 v30, v4 offset:0
    ds_add_u32 v31, v4 offset:0
    v_perm_b32 v63, v31, v30, s43
    v_perm_b32 v62, v29, v28, s43
    v_or_b32 v56, 0x40000000, v6
    v_or_b32 v57, 0x40000000, v7
    v_or_b32 v60, 0x40000000, v8
    v_or_b32 v61, 0x40000000, v9
    s_waitcnt vmcnt(14)
    v_perm_b32 v6, v36, v32, s43
    v_perm_b32 v7, v37, v33, s43
    v_perm_b32 v8, v38, v34, s43
    v_perm_b32 v9, v39, v35, s43
    v_mul_hi_u32_u24 v32, 429497, v32
    v_mul_hi_u32_u24 v36, 429497, v36
    v_mul_hi_u32_u24 v33, 429497, v33
    v_mul_hi_u32_u24 v37, 429497, v37
    v_mul_hi_u32_u24 v34, 429497, v34
    v_mul_hi_u32_u24 v38, 429497, v38
    v_mul_hi_u32_u24 v35, 429497, v35
    v_mul_hi_u32_u24 v39, 429497, v39
    v_lshl_or_b32 v32, v36, 16, v32
    v_lshl_or_b32 v33, v37, 16, v33
    v_lshl_or_b32 v34, v38, 16, v34
    v_lshl_or_b32 v35, v39, 16, v35
    v_dot2_u32_u16 v36, v32, s38, 0
    v_dot2_u32_u16 v37, v33, s38, 0
    v_dot2_u32_u16 v38, v34, s38, 0
    v_dot2_u32_u16 v39, v35, s38, 0
    v_pk_mad_u16 v6, v32, s37, v6
    v_pk_mad_u16 v7, v33, s37, v7
    v_pk_mad_u16 v8, v34, s37, v8
    v_pk_mad_u16 v9, v35, s37, v9
    ds_add_u32 v36, v4 offset:0
    ds_add_u32 v37, v4 offset:0
    ds_add_u32 v38, v4 offset:0
    ds_add_u32 v39, v4 offset:0
    v_perm_b32 v71, v39, v38, s43
    v_perm_b32 v70, v37, v36, s43
    v_or_b32 v64, 0x40000000, v6
    v_or_b32 v65, 0x40000000, v7
    v_or_b32 v68, 0x40000000, v8
    v_or_b32 v69, 0x40000000, v9
    s_waitcnt vmcnt(12)
    v_perm_b32 v6, v44, v40, s43
    v_perm_b32 v7, v45, v41, s43
    v_perm_b32 v8, v46, v42, s43
    v_perm_b32 v9, v47, v43, s43
    v_mul_hi_u32_u24 v40, 429497, v40
    v_mul_hi_u32_u24 v44, 429497, v44
    v_mul_hi_u32_u24 v41, 429497, v41
    v_mul_hi_u32_u24 v45, 429497, v45
    v_mul_hi_u32_u24 v42, 429497, v42
    v_mul_hi_u32_u24 v46, 429497, v46
    v_mul_hi_u32_u24 v43, 429497, v43
    v_mul_hi_u32_u24 v47, 429497, v47
    v_lshl_or_b32 v40, v44, 16, v40
    v_lshl_or_b32 v41, v45, 16, v41
    v_lshl_or_b32 v42, v46, 16, v42
    v_lshl_or_b32 v43, v47, 16, v43
    v_dot2_u32_u16 v44, v40, s38, 0
    v_dot2_u32_u16 v45, v41, s38, 0
    v_dot2_u32_u16 v46, v42, s38, 0
    v_dot2_u32_u16 v47, v43, s38, 0
    v_pk_mad_u16 v6, v40, s37, v6
    v_pk_mad_u16 v7, v41, s37, v7
    v_pk_mad_u16 v8, v42, s37, v8
    v_pk_mad_u16 v9, v43, s37, v9
    ds_add_u32 v44, v4 offset:0
    ds_add_u32 v45, v4 offset:0
    ds_add_u32 v46, v4 offset:0
    ds_add_u32 v47, v4 offset:0
    v_perm_b32 v79, v47, v46, s43
    v_perm_b32 v78, v45, v44, s43
    v_or_b32 v72, 0x40000000, v6
    v_or_b32 v73, 0x40000000, v7
    v_or_b32 v76, 0x40000000, v8
    v_or_b32 v77, 0x40000000, v9
    s_waitcnt vmcnt(10)
    v_perm_b32 v6, v84, v80, s43
    v_perm_b32 v7, v85, v81, s43
    v_perm_b32 v8, v86, v82, s43
    v_perm_b32 v9, v87, v83, s43
    v_mul_hi_u32_u24 v80, 429497, v80
    v_mul_hi_u32_u24 v84, 429497, v84
    v_mul_hi_u32_u24 v81, 429497, v81
    v_mul_hi_u32_u24 v85, 429497, v85
    v_mul_hi_u32_u24 v82, 429497, v82
    v_mul_hi_u32_u24 v86, 429497, v86
    v_mul_hi_u32_u24 v83, 429497, v83
    v_mul_hi_u32_u24 v87, 429497, v87
    v_lshl_or_b32 v80, v84, 16, v80
    v_lshl_or_b32 v81, v85, 16, v81
    v_lshl_or_b32 v82, v86, 16, v82
    v_lshl_or_b32 v83, v87, 16, v83
    v_dot2_u32_u16 v84, v80, s38, 0
    v_dot2_u32_u16 v85, v81, s38, 0
    v_dot2_u32_u16 v86, v82, s38, 0
    v_dot2_u32_u16 v87, v83, s38, 0
    v_pk_mad_u16 v6, v80, s37, v6
    v_pk_mad_u16 v7, v81, s37, v7
    v_pk_mad_u16 v8, v82, s37, v8
    v_pk_mad_u16 v9, v83, s37, v9
    ds_add_u32 v84, v4 offset:0
    ds_add_u32 v85, v4 offset:0
    ds_add_u32 v86, v4 offset:0
    ds_add_u32 v87, v4 offset:0
    v_perm_b32 v87, v87, v86, s43
    v_perm_b32 v86, v85, v84, s43
    v_or_b32 v80, 0x40000000, v6
    v_or_b32 v81, 0x40000000, v7
    v_or_b32 v84, 0x40000000, v8
    v_or_b32 v85, 0x40000000, v9
    s_waitcnt vmcnt(8)
    v_perm_b32 v6, v92, v88, s43
    v_perm_b32 v7, v93, v89, s43
    v_perm_b32 v8, v94, v90, s43
    v_perm_b32 v9, v95, v91, s43
    v_mul_hi_u32_u24 v88, 429497, v88
    v_mul_hi_u32_u24 v92, 429497, v92
    v_mul_hi_u32_u24 v89, 429497, v89
    v_mul_hi_u32_u24 v93, 429497, v93
    v_mul_hi_u32_u24 v90, 429497, v90
    v_mul_hi_u32_u24 v94, 429497, v94
    v_mul_hi_u32_u24 v91, 429497, v91
    v_mul_hi_u32_u24 v95, 429497, v95
    v_lshl_or_b32 v88, v92, 16, v88
    v_lshl_or_b32 v89, v93, 16, v89
    v_lshl_or_b32 v90, v94, 16, v90
    v_lshl_or_b32 v91, v95, 16, v91
    v_dot2_u32_u16 v92, v88, s38, 0
    v_dot2_u32_u16 v93, v89, s38, 0
    v_dot2_u32_u16 v94, v90, s38, 0
    v_dot2_u32_u16 v95, v91, s38, 0
    v_pk_mad_u16 v6, v88, s37, v6
    v_pk_mad_u16 v7, v89, s37, v7
    v_pk_mad_u16 v8, v90, s37, v8
    v_pk_mad_u16 v9, v91, s37, v9
    ds_add_u32 v92, v4 offset:0
    ds_add_u32 v93, v4 offset:0
    ds_add_u32 v94, v4 offset:0
    ds_add_u32 v95, v4 offset:0
    v_perm_b32 v95, v95, v94, s43
    v_perm_b32 v94, v93, v92, s43
    v_or_b32 v88, 0x40000000, v6
    v_or_b32 v89, 0x40000000, v7
    v_or_b32 v92, 0x40000000, v8
    v_or_b32 v93, 0x40000000, v9
    s_waitcnt vmcnt(6)
    v_perm_b32 v6, v100, v96, s43
    v_perm_b32 v7, v101, v97, s43
    v_perm_b32 v8, v102, v98, s43
    v_perm_b32 v9, v103, v99, s43
    v_mul_hi_u32_u24 v96, 429497, v96
    v_mul_hi_u32_u24 v100, 429497, v100
    v_mul_hi_u32_u24 v97, 429497, v97
    v_mul_hi_u32_u24 v101, 429497, v101
    v_mul_hi_u32_u24 v98, 429497, v98
    v_mul_hi_u32_u24 v102, 429497, v102
    v_mul_hi_u32_u24 v99, 429497, v99
    v_mul_hi_u32_u24 v103, 429497, v103
    v_lshl_or_b32 v96, v100, 16, v96
    v_lshl_or_b32 v97, v101, 16, v97
    v_lshl_or_b32 v98, v102, 16, v98
    v_lshl_or_b32 v99, v103, 16, v99
    v_dot2_u32_u16 v100, v96, s38, 0
    v_dot2_u32_u16 v101, v97, s38, 0
    v_dot2_u32_u16 v102, v98, s38, 0
    v_dot2_u32_u16 v103, v99, s38, 0
    v_pk_mad_u16 v6, v96, s37, v6
    v_pk_mad_u16 v7, v97, s37, v7
    v_pk_mad_u16 v8, v98, s37, v8
    v_pk_mad_u16 v9, v99, s37, v9
    ds_add_u32 v100, v4 offset:0
    ds_add_u32 v101, v4 offset:0
    ds_add_u32 v102, v4 offset:0
    ds_add_u32 v103, v4 offset:0
    v_perm_b32 v103, v103, v102, s43
    v_perm_b32 v102, v101, v100, s43
    v_or_b32 v96, 0x40000000, v6
    v_or_b32 v97, 0x40000000, v7
    v_or_b32 v100, 0x40000000, v8
    v_or_b32 v101, 0x40000000, v9
    s_waitcnt vmcnt(4)
    v_perm_b32 v6, v108, v104, s43
    v_perm_b32 v7, v109, v105, s43
    v_perm_b32 v8, v110, v106, s43
    v_perm_b32 v9, v111, v107, s43
    v_mul_hi_u32_u24 v104, 429497, v104
    v_mul_hi_u32_u24 v108, 429497, v108
    v_mul_hi_u32_u24 v105, 429497, v105
    v_mul_hi_u32_u24 v109, 429497, v109
    v_mul_hi_u32_u24 v106, 429497, v106
    v_mul_hi_u32_u24 v110, 429497, v110
    v_mul_hi_u32_u24 v107, 429497, v107
    v_mul_hi_u32_u24 v111, 429497, v111
    v_lshl_or_b32 v104, v108, 16, v104
    v_lshl_or_b32 v105, v109, 16, v105
    v_lshl_or_b32 v106, v110, 16, v106
    v_lshl_or_b32 v107, v111, 16, v107
    v_dot2_u32_u16 v108, v104, s38, 0
    v_dot2_u32_u16 v109, v105, s38, 0
    v_dot2_u32_u16 v110, v106, s38, 0
    v_dot2_u32_u16 v111, v107, s38, 0
    v_pk_mad_u16 v6, v104, s37, v6
    v_pk_mad_u16 v7, v105, s37, v7
    v_pk_mad_u16 v8, v106, s37, v8
    v_pk_mad_u16 v9, v107, s37, v9
    ds_add_u32 v108, v4 offset:0
    ds_add_u32 v109, v4 offset:0
    ds_add_u32 v110, v4 offset:0
    ds_add_u32 v111, v4 offset:0
    v_perm_b32 v111, v111, v110, s43
    v_perm_b32 v110, v109, v108, s43
    v_or_b32 v104, 0x40000000, v6
    v_or_b32 v105, 0x40000000, v7
    v_or_b32 v108, 0x40000000, v8
    v_or_b32 v109, 0x40000000, v9
    s_waitcnt vmcnt(2)
    v_perm_b32 v6, v116, v112, s43
    v_perm_b32 v7, v117, v113, s43
    v_perm_b32 v8, v118, v114, s43
    v_perm_b32 v9, v119, v115, s43
    v_mul_hi_u32_u24 v112, 429497, v112
    v_mul_hi_u32_u24 v116, 429497, v116
    v_mul_hi_u32_u24 v113, 429497, v113
    v_mul_hi_u32_u24 v117, 429497, v117
    v_mul_hi_u32_u24 v114, 429497, v114
    v_mul_hi_u32_u24 v118, 429497, v118
    v_mul_hi_u32_u24 v115, 429497, v115
    v_mul_hi_u32_u24 v119, 429497, v119
    v_lshl_or_b32 v112, v116, 16, v112
    v_lshl_or_b32 v113, v117, 16, v113
    v_lshl_or_b32 v114, v118, 16, v114
    v_lshl_or_b32 v115, v119, 16, v115
    v_dot2_u32_u16 v116, v112, s38, 0
    v_dot2_u32_u16 v117, v113, s38, 0
    v_dot2_u32_u16 v118, v114, s38, 0
    v_dot2_u32_u16 v119, v115, s38, 0
    v_pk_mad_u16 v6, v112, s37, v6
    v_pk_mad_u16 v7, v113, s37, v7
    v_pk_mad_u16 v8, v114, s37, v8
    v_pk_mad_u16 v9, v115, s37, v9
    ds_add_u32 v116, v4 offset:0
    ds_add_u32 v117, v4 offset:0
    ds_add_u32 v118, v4 offset:0
    ds_add_u32 v119, v4 offset:0
    v_perm_b32 v119, v119, v118, s43
    v_perm_b32 v118, v117, v116, s43
    v_or_b32 v112, 0x40000000, v6
    v_or_b32 v113, 0x40000000, v7
    v_or_b32 v116, 0x40000000, v8
    v_or_b32 v117, 0x40000000, v9
    s_waitcnt vmcnt(0)
    s_mov_b64 exec, s[44:45]
    v_perm_b32 v6, v124, v120, s43
    v_perm_b32 v7, v125, v121, s43
    v_perm_b32 v8, v126, v122, s43
    v_perm_b32 v9, v127, v123, s43
    v_mul_hi_u32_u24 v120, 429497, v120
    v_mul_hi_u32_u24 v124, 429497, v124
    v_mul_hi_u32_u24 v121, 429497, v121
    v_mul_hi_u32_u24 v125, 429497, v125
    v_mul_hi_u32_u24 v122, 429497, v122
    v_mul_hi_u32_u24 v126, 429497, v126
    v_mul_hi_u32_u24 v123, 429497, v123
    v_mul_hi_u32_u24 v127, 429497, v127
    v_lshl_or_b32 v120, v124, 16, v120
    v_lshl_or_b32 v121, v125, 16, v121
    v_lshl_or_b32 v122, v126, 16, v122
    v_lshl_or_b32 v123, v127, 16, v123
    v_dot2_u32_u16 v124, v120, s38, 0
    v_dot2_u32_u16 v125, v121, s38, 0
    v_dot2_u32_u16 v126, v122, s38, 0
    v_dot2_u32_u16 v127, v123, s38, 0
    v_pk_mad_u16 v6, v120, s37, v6
    v_pk_mad_u16 v7, v121, s37, v7
    v_pk_mad_u16 v8, v122, s37, v8
    v_pk_mad_u16 v9, v123, s37, v9
    ds_add_u32 v124, v4 offset:0
    ds_add_u32 v125, v4 offset:0
    ds_add_u32 v126, v4 offset:0
    ds_add_u32 v127, v4 offset:0
    v_perm_b32 v127, v127, v126, s43
    v_perm_b32 v126, v125, v124, s43
    v_or_b32 v120, 0x40000000, v6
    v_or_b32 v121, 0x40000000, v7
    v_or_b32 v124, 0x40000000, v8
    v_or_b32 v125, 0x40000000, v9
    s_mov_b64 exec, -1
    s_add_u32 s35, s34, 0
    buffer_load_dwordx2 v[50:51], v2, s[16:19], s35 offen nt
    s_add_u32 s35, s34, 2097152
    buffer_load_dwordx2 v[58:59], v2, s[16:19], s35 offen nt
    s_add_u32 s35, s34, 4194304
    buffer_load_dwordx2 v[66:67], v2, s[16:19], s35 offen nt
    s_and_b32 s35, s32, 15
    s_lshl_b32 s35, s35, 6
    s_lshr_b32 s36, s32, 4
    s_add_u32 s35, s35, s36
    s_lshl_b32 s42, s35, 4
    s_mul_i32 s35, s35, 240512
    s_add_u32 s35, s35, 8192
    s_add_u32 s20, s4, s35
    s_addc_u32 s21, s5, 0
    s_waitcnt lgkmcnt(0)
    s_barrier
    ds_read_b128 v[8:11], v1 offset:0
    s_add_u32 s35, s34, 6291456
    buffer_load_dwordx2 v[74:75], v2, s[16:19], s35 offen nt
    s_lshl_b32 s35, s39, 2
    s_add_u32 s35, s35, 160256
    v_mov_b32 v7, s35
    v_and_b32 v14, 15, v0
    v_lshlrev_b32 v14, 2, v14
    v_add_u32 v14, 160256, v14
    s_waitcnt lgkmcnt(0)
    v_cmp_eq_u32 s[56:57], 0, v8
    v_max_u32 v12, 1, v8
    v_lshl_or_b32 v8, v8, 16, v12
    v_cmp_eq_u32 s[58:59], 0, v9
    v_max_u32 v12, 1, v9
    v_lshl_or_b32 v9, v9, 16, v12
    v_cmp_eq_u32 s[60:61], 0, v10
    v_max_u32 v12, 1, v10
    v_lshl_or_b32 v10, v10, 16, v12
    v_cmp_eq_u32 s[62:63], 0, v11
    v_max_u32 v12, 1, v11
    v_lshl_or_b32 v11, v11, 16, v12
    v_add_u32 v9, v8, v9
    v_add_u32 v10, v9, v10
    v_add_u32 v11, v10, v11
    v_mov_b32 v6, v11
    s_nop 1
    v_add_u32_dpp v6, v6, v6 row_shr:1 row_mask:0xf bank_mask:0xf bound_ctrl:0
    s_nop 1
    v_add_u32_dpp v6, v6, v6 row_shr:2 row_mask:0xf bank_mask:0xf bound_ctrl:0
    s_nop 1
    v_add_u32_dpp v6, v6, v6 row_shr:4 row_mask:0xf bank_mask:0xf bound_ctrl:0
    s_nop 1
    v_add_u32_dpp v6, v6, v6 row_shr:8 row_mask:0xf bank_mask:0xf bound_ctrl:0
    s_nop 1
    v_add_u32_dpp v6, v6, v6 row_bcast:15 row_mask:0xa bank_mask:0xf
    s_nop 1
    v_add_u32_dpp v6, v6, v6 row_bcast:31 row_mask:0xc bank_mask:0xf
    s_mov_b32 exec_lo, 0
    s_brev_b32 exec_hi, 1
    ds_write_b32 v7, v6
    s_mov_b64 exec, -1
    v_sub_u32 v6, v6, v11
    s_or_b64 s[46:47], s[56:57], s[58:59]
    s_or_b64 vcc, s[60:61], s[62:63]
    s_or_b64 s[46:47], s[46:47], vcc
    s_waitcnt lgkmcnt(0)
    s_barrier
    ds_read_b32 v7, v14
    s_add_u32 s35, s34, 8388608
    buffer_load_dwordx2 v[82:83], v2, s[16:19], s35 offen nt
    s_waitcnt lgkmcnt(0)
    v_mov_b32 v15, v7
    s_nop 1
    v_add_u32_dpp v7, v7, v7 row_shr:1 row_mask:0xf bank_mask:0xf bound_ctrl:0
    s_nop 1
    v_add_u32_dpp v7, v7, v7 row_shr:2 row_mask:0xf bank_mask:0xf bound_ctrl:0
    s_nop 1
    v_add_u32_dpp v7, v7, v7 row_shr:4 row_mask:0xf bank_mask:0xf bound_ctrl:0
    s_nop 1
    v_add_u32_dpp v7, v7, v7 row_shr:8 row_mask:0xf bank_mask:0xf bound_ctrl:0
    s_nop 0
    v_readlane_b32 s54, v7, 15
    v_sub_u32 v7, v7, v15
    s_nop 0
    v_readlane_b32 s35, v7, s39
    s_and_b32 s54, s54, 0xffff
    s_cmp_ge_u32 s54, 40064
    s_cselect_b32 s36, 16, 0
    s_cselect_b32 s54, 40000, s54
    s_cselect_b32 s55, 1, s55
    s_cselect_b64 s[46:47], 0, s[46:47]
    v_add_u32 v12, s35, v6
    v_add_u32 v13, v12, v8
    v_add_u32 v14, v12, v9
    v_add_u32 v15, v12, v10
    v_bfe_u32 v12, v12, s36, 16
    v_bfe_u32 v13, v13, s36, 16
    v_bfe_u32 v14, v14, s36, 16
    v_bfe_u32 v15, v15, s36, 16
    ds_write_b128 v1, v[12:15] offset:0
    ds_write_b128 v1, v[12:15] offset:16384
    v_mov_b32 v6, 32768
    v_mov_b32 v7, s54
    s_mov_b64 exec, 1
    ds_write_b32 v6, v7
    s_mov_b64 exec, -1
    s_add_u32 s35, s54, 1
    s_lshr_b32 s35, s35, 1
    s_mul_i32 s35, s35, 12
    s_min_u32 s22, s35, 240512
    v_perm_b32 v15, v15, v14, s43
    v_perm_b32 v14, v13, v12, s43
    s_waitcnt lgkmcnt(0)
    s_barrier
    s_add_u32 s35, s34, 10485760
    buffer_load_dwordx2 v[90:91], v2, s[16:19], s35 offen nt
    v_and_b32 v6, 63, v0
    s_lshl_b32 s35, s39, 10
    v_lshl_add_u32 v7, v6, 2, s35
    v_lshl_add_u32 v12, v6, 8, s35
    ds_read_b32 v8, v7 offset:16384
    ds_read_b32 v9, v7 offset:16640
    ds_read_b32 v10, v7 offset:16896
    ds_read_b32 v11, v7 offset:17152
    s_mov_b64 exec, 15
    ds_read_b32 v12, v12 offset:16640
    s_mov_b64 exec, -1
    s_lshr_b32 s35, s39, 2
    s_mul_i32 s35, s35, 2138240
    s_and_b32 s36, s39, 1
    s_lshl_b32 s36, s36, 3
    s_add_u32 s35, s35, s36
    s_and_b32 s36, s39, 2
    s_lshl_b32 s36, s36, 13
    s_add_u32 s35, s35, s36
    s_add_u32 s35, s35, s42
    s_add_u32 s36, s35, 2105344
    v_mul_u32_u24 v7, 32896, v6
    v_lshlrev_b32 v13, 1, v6
    s_waitcnt lgkmcnt(1)
    v_perm_b32 v8, v9, v8, s43
    v_perm_b32 v9, v11, v10, s43
    buffer_store_dwordx2 v[8:9], v7, s[24:27], s35 offen
    s_waitcnt lgkmcnt(0)
    s_mov_b64 exec, 15
    buffer_store_short v12, v13, s[24:27], s36 offen
    s_mov_b64 exec, -1
    s_nop 0
    v_and_b32 v6, 0xffff, v54
    v_lshrrev_b32 v7, 16, v54
    v_and_b32 v8, 0xffff, v55
    v_lshrrev_b32 v9, 16, v55
    ds_add_rtn_u32 v6, v6, v4 offset:0
    ds_add_rtn_u32 v7, v7, v4 offset:0
    ds_add_rtn_u32 v8, v8, v4 offset:0
    ds_add_rtn_u32 v9, v9, v4 offset:0
    v_and_b32 v10, 0xffff, v62
    v_lshrrev_b32 v11, 16, v62
    v_and_b32 v12, 0xffff, v63
    v_lshrrev_b32 v13, 16, v63
    ds_add_rtn_u32 v10, v10, v4 offset:0
    ds_add_rtn_u32 v11, v11, v4 offset:0
    ds_add_rtn_u32 v12, v12, v4 offset:0
    ds_add_rtn_u32 v13, v13, v4 offset:0
    s_waitcnt lgkmcnt(4)
    v_perm_b32 v54, v7, v6, s43
    v_perm_b32 v55, v9, v8, s43
    v_and_b32 v6, 0xffff, v70
    v_lshrrev_b32 v7, 16, v70
    v_and_b32 v8, 0xffff, v71
    v_lshrrev_b32 v9, 16, v71
    ds_add_rtn_u32 v6, v6, v4 offset:0
    ds_add_rtn_u32 v7, v7, v4 offset:0
    ds_add_rtn_u32 v8, v8, v4 offset:0
    ds_add_rtn_u32 v9, v9, v4 offset:0
    s_waitcnt lgkmcnt(4)
    v_perm_b32 v62, v11, v10, s43
    v_perm_b32 v63, v13, v12, s43
    s_add_u32 s35, s34, 12582912
    buffer_load_dwordx2 v[98:99], v2, s[16:19], s35 offen nt
    s_add_u32 s35, s34, 14680064
    buffer_load_dwordx2 v[106:107], v2, s[16:19], s35 offen nt
    v_and_b32 v10, 0xffff, v78
    v_lshrrev_b32 v11, 16, v78
    v_and_b32 v12, 0xffff, v79
    v_lshrrev_b32 v13, 16, v79
    ds_add_rtn_u32 v10, v10, v4 offset:0
    ds_add_rtn_u32 v11, v11, v4 offset:0
    ds_add_rtn_u32 v12, v12, v4 offset:0
    ds_add_rtn_u32 v13, v13, v4 offset:0
    s_waitcnt lgkmcnt(4)
    v_perm_b32 v70, v7, v6, s43
    v_perm_b32 v71, v9, v8, s43
    v_and_b32 v6, 0xffff, v86
    v_lshrrev_b32 v7, 16, v86
    v_and_b32 v8, 0xffff, v87
    v_lshrrev_b32 v9, 16, v87
    ds_add_rtn_u32 v6, v6, v4 offset:0
    ds_add_rtn_u32 v7, v7, v4 offset:0
    ds_add_rtn_u32 v8, v8, v4 offset:0
    ds_add_rtn_u32 v9, v9, v4 offset:0
    s_waitcnt lgkmcnt(4)
    v_perm_b32 v78, v11, v10, s43
    v_perm_b32 v79, v13, v12, s43
    v_and_b32 v10, 0xffff, v94
    v_lshrrev_b32 v11, 16, v94
    v_and_b32 v12, 0xffff, v95
    v_lshrrev_b32 v13, 16, v95
    ds_add_rtn_u32 v10, v10, v4 offset:0
    ds_add_rtn_u32 v11, v11, v4 offset:0
    ds_add_rtn_u32 v12, v12, v4 offset:0
    ds_add_rtn_u32 v13, v13, v4 offset:0
    s_waitcnt lgkmcnt(4)
    v_perm_b32 v86, v7, v6, s43
    v_perm_b32 v87, v9, v8, s43
    s_add_u32 s35, s34, 16777216
    buffer_load_dwordx2 v[114:115], v2, s[16:19], s35 offen nt
    s_add_u32 s35, s34, 18874368
    s_sub_u32 s35, s35, s49
    v_cndmask_b32 v122, 2.0, v2, s[44:45]
    buffer_load_dwordx2 v[122:123], v122, s[16:19], s35 offen nt
    v_and_b32 v6, 0xffff, v102
    v_lshrrev_b32 v7, 16, v102
    v_and_b32 v8, 0xffff, v103
    v_lshrrev_b32 v9, 16, v103
    ds_add_rtn_u32 v6, v6, v4 offset:0
    ds_add_rtn_u32 v7, v7, v4 offset:0
    ds_add_rtn_u32 v8, v8, v4 offset:0
    ds_add_rtn_u32 v9, v9, v4 offset:0
    s_waitcnt lgkmcnt(4)
    v_perm_b32 v94, v11, v10, s43
    v_perm_b32 v95, v13, v12, s43
    v_and_b32 v10, 0xffff, v110
    v_lshrrev_b32 v11, 16, v110
    v_and_b32 v12, 0xffff, v111
    v_lshrrev_b32 v13, 16, v111
    ds_add_rtn_u32 v10, v10, v4 offset:0
    ds_add_rtn_u32 v11, v11, v4 offset:0
    ds_add_rtn_u32 v12, v12, v4 offset:0
    ds_add_rtn_u32 v13, v13, v4 offset:0
    s_waitcnt lgkmcnt(4)
    v_perm_b32 v102, v7, v6, s43
    v_perm_b32 v103, v9, v8, s43
    v_and_b32 v6, 0xffff, v118
    v_lshrrev_b32 v7, 16, v118
    v_and_b32 v8, 0xffff, v119
    v_lshrrev_b32 v9, 16, v119
    ds_add_rtn_u32 v6, v6, v4 offset:0
    ds_add_rtn_u32 v7, v7, v4 offset:0
    ds_add_rtn_u32 v8, v8, v4 offset:0
    ds_add_rtn_u32 v9, v9, v4 offset:0
    s_waitcnt lgkmcnt(4)
    v_perm_b32 v110, v11, v10, s43
    v_perm_b32 v111, v13, v12, s43
    s_add_u32 s35, s33, 40960000
    buffer_load_dwordx4 v[16:19], v1, s[8:11], s35 offen nt
    s_mov_b64 exec, s[44:45]
    v_and_b32 v10, 0xffff, v126
    v_lshrrev_b32 v11, 16, v126
    v_and_b32 v12, 0xffff, v127
    v_lshrrev_b32 v13, 16, v127
    ds_add_rtn_u32 v10, v10, v4 offset:0
    ds_add_rtn_u32 v11, v11, v4 offset:0
    ds_add_rtn_u32 v12, v12, v4 offset:0
    ds_add_rtn_u32 v13, v13, v4 offset:0
    s_mov_b64 exec, -1
    s_waitcnt lgkmcnt(4)
    v_perm_b32 v118, v7, v6, s43
    v_perm_b32 v119, v9, v8, s43
    s_waitcnt lgkmcnt(0)
    v_perm_b32 v126, v11, v10, s43
    v_perm_b32 v127, v13, v12, s43
    s_barrier
    s_lshl_b32 s35, s54, 2
    v_mov_b32 v6, s35
    v_mov_b32 v7, 0
    s_mov_b64 exec, 1
    ds_write_b32 v6, v7
    s_cmp_eq_u64 s[46:47], 0
    s_cbranch_scc1 L_p1_kernel_nonull_1
    s_mov_b64 exec, s[56:57]
    v_lshlrev_b32_sdwa v6, 2, v14 dst_sel:DWORD dst_unused:UNUSED_PAD src0_sel:DWORD src1_sel:WORD_0
    ds_write_b32 v6, v7
    s_mov_b64 exec, s[58:59]
    v_lshlrev_b32_sdwa v6, 2, v14 dst_sel:DWORD dst_unused:UNUSED_PAD src0_sel:DWORD src1_sel:WORD_1
    ds_write_b32 v6, v7
    s_mov_b64 exec, s[60:61]
    v_lshlrev_b32_sdwa v6, 2, v15 dst_sel:DWORD dst_unused:UNUSED_PAD src0_sel:DWORD src1_sel:WORD_0
    ds_write_b32 v6, v7
    s_mov_b64 exec, s[62:63]
    v_lshlrev_b32_sdwa v6, 2, v15 dst_sel:DWORD dst_unused:UNUSED_PAD src0_sel:DWORD src1_sel:WORD_1
    ds_write_b32 v6, v7
L_p1_kernel_nonull_1:
    s_mov_b64 exec, -1
    v_lshlrev_b32_sdwa v6, 2, v54 dst_sel:DWORD dst_unused:UNUSED_PAD src0_sel:DWORD src1_sel:WORD_0
    v_lshlrev_b32_sdwa v7, 2, v54 dst_sel:DWORD dst_unused:UNUSED_PAD src0_sel:DWORD src1_sel:WORD_1
    v_lshlrev_b32_sdwa v8, 2, v55 dst_sel:DWORD dst_unused:UNUSED_PAD src0_sel:DWORD src1_sel:WORD_0
    v_lshlrev_b32_sdwa v9, 2, v55 dst_sel:DWORD dst_unused:UNUSED_PAD src0_sel:DWORD src1_sel:WORD_1
    ds_write_b32 v6, v48
    ds_write_b32 v7, v49
    ds_write_b32 v8, v52
    ds_write_b32 v9, v53
    s_waitcnt vmcnt(12)
    v_lshlrev_b32 v10, 16, v50
    v_lshlrev_b32 v11, 16, v51
    v_and_b32 v50, 0xffff0000, v50
    v_and_b32 v51, 0xffff0000, v51
    v_mul_f32 v10, s41, v10
    v_mul_f32 v50, s41, v50
    v_mul_f32 v11, s41, v11
    v_mul_f32 v51, s41, v51
    v_fract_f32 v10, v10
    v_fract_f32 v50, v50
    v_fract_f32 v11, v11
    v_fract_f32 v51, v51
    v_cos_f32 v10, v10
    v_cos_f32 v50, v50
    v_cos_f32 v11, v11
    v_cos_f32 v51, v51
    v_cvt_pk_bf16_f32 v50, v10, v50
    v_cvt_pk_bf16_f32 v51, v11, v51
    v_or3_b32 v5, v50, v51, v5
    v_lshlrev_b32_sdwa v6, 2, v62 dst_sel:DWORD dst_unused:UNUSED_PAD src0_sel:DWORD src1_sel:WORD_0
    v_lshlrev_b32_sdwa v7, 2, v62 dst_sel:DWORD dst_unused:UNUSED_PAD src0_sel:DWORD src1_sel:WORD_1
    v_lshlrev_b32_sdwa v8, 2, v63 dst_sel:DWORD dst_unused:UNUSED_PAD src0_sel:DWORD src1_sel:WORD_0
    v_lshlrev_b32_sdwa v9, 2, v63 dst_sel:DWORD dst_unused:UNUSED_PAD src0_sel:DWORD src1_sel:WORD_1
    ds_write_b32 v6, v56
    ds_write_b32 v7, v57
    ds_write_b32 v8, v60
    ds_write_b32 v9, v61
    s_waitcnt vmcnt(11)
    v_lshlrev_b32 v10, 16, v58
    v_lshlrev_b32 v11, 16, v59
    v_and_b32 v58, 0xffff0000, v58
    v_and_b32 v59, 0xffff0000, v59
    v_mul_f32 v10, s41, v10
    v_mul_f32 v58, s41, v58
    v_mul_f32 v11, s41, v11
    v_mul_f32 v59, s41, v59
    v_fract_f32 v10, v10
    v_fract_f32 v58, v58
    v_fract_f32 v11, v11
    v_fract_f32 v59, v59
    v_cos_f32 v10, v10
    v_cos_f32 v58, v58
    v_cos_f32 v11, v11
    v_cos_f32 v59, v59
    v_cvt_pk_bf16_f32 v58, v10, v58
    v_cvt_pk_bf16_f32 v59, v11, v59
    v_or3_b32 v5, v58, v59, v5
    s_add_u32 s35, s33, 40960000
    buffer_load_dwordx4 v[20:23], v1, s[12:15], s35 offen nt
    v_lshlrev_b32_sdwa v6, 2, v70 dst_sel:DWORD dst_unused:UNUSED_PAD src0_sel:DWORD src1_sel:WORD_0
    v_lshlrev_b32_sdwa v7, 2, v70 dst_sel:DWORD dst_unused:UNUSED_PAD src0_sel:DWORD src1_sel:WORD_1
    v_lshlrev_b32_sdwa v8, 2, v71 dst_sel:DWORD dst_unused:UNUSED_PAD src0_sel:DWORD src1_sel:WORD_0
    v_lshlrev_b32_sdwa v9, 2, v71 dst_sel:DWORD dst_unused:UNUSED_PAD src0_sel:DWORD src1_sel:WORD_1
    ds_write_b32 v6, v64
    ds_write_b32 v7, v65
    ds_write_b32 v8, v68
    ds_write_b32 v9, v69
    s_waitcnt vmcnt(11)
    v_lshlrev_b32 v10, 16, v66
    v_lshlrev_b32 v11, 16, v67
    v_and_b32 v66, 0xffff0000, v66
    v_and_b32 v67, 0xffff0000, v67
    v_mul_f32 v10, s41, v10
    v_mul_f32 v66, s41, v66
    v_mul_f32 v11, s41, v11
    v_mul_f32 v67, s41, v67
    v_fract_f32 v10, v10
    v_fract_f32 v66, v66
    v_fract_f32 v11, v11
    v_fract_f32 v67, v67
    v_cos_f32 v10, v10
    v_cos_f32 v66, v66
    v_cos_f32 v11, v11
    v_cos_f32 v67, v67
    v_cvt_pk_bf16_f32 v66, v10, v66
    v_cvt_pk_bf16_f32 v67, v11, v67
    v_or3_b32 v5, v66, v67, v5
    v_lshlrev_b32_sdwa v6, 2, v78 dst_sel:DWORD dst_unused:UNUSED_PAD src0_sel:DWORD src1_sel:WORD_0
    v_lshlrev_b32_sdwa v7, 2, v78 dst_sel:DWORD dst_unused:UNUSED_PAD src0_sel:DWORD src1_sel:WORD_1
    v_lshlrev_b32_sdwa v8, 2, v79 dst_sel:DWORD dst_unused:UNUSED_PAD src0_sel:DWORD src1_sel:WORD_0
    v_lshlrev_b32_sdwa v9, 2, v79 dst_sel:DWORD dst_unused:UNUSED_PAD src0_sel:DWORD src1_sel:WORD_1
    ds_write_b32 v6, v72
    ds_write_b32 v7, v73
    ds_write_b32 v8, v76
    ds_write_b32 v9, v77
    s_waitcnt vmcnt(10)
    v_lshlrev_b32 v10, 16, v74
    v_lshlrev_b32 v11, 16, v75
    v_and_b32 v74, 0xffff0000, v74
    v_and_b32 v75, 0xffff0000, v75
    v_mul_f32 v10, s41, v10
    v_mul_f32 v74, s41, v74
    v_mul_f32 v11, s41, v11
    v_mul_f32 v75, s41, v75
    v_fract_f32 v10, v10
    v_fract_f32 v74, v74
    v_fract_f32 v11, v11
    v_fract_f32 v75, v75
    v_cos_f32 v10, v10
    v_cos_f32 v74, v74
    v_cos_f32 v11, v11
    v_cos_f32 v75, v75
    v_cvt_pk_bf16_f32 v74, v10, v74
    v_cvt_pk_bf16_f32 v75, v11, v75
    v_or3_b32 v5, v74, v75, v5
    v_lshlrev_b32_sdwa v6, 2, v86 dst_sel:DWORD dst_unused:UNUSED_PAD src0_sel:DWORD src1_sel:WORD_0
    v_lshlrev_b32_sdwa v7, 2, v86 dst_sel:DWORD dst_unused:UNUSED_PAD src0_sel:DWORD src1_sel:WORD_1
    v_lshlrev_b32_sdwa v8, 2, v87 dst_sel:DWORD dst_unused:UNUSED_PAD src0_sel:DWORD src1_sel:WORD_0
    v_lshlrev_b32_sdwa v9, 2, v87 dst_sel:DWORD dst_unused:UNUSED_PAD src0_sel:DWORD src1_sel:WORD_1
    ds_write_b32 v6, v80
    ds_write_b32 v7, v81
    ds_write_b32 v8, v84
    ds_write_b32 v9, v85
    s_waitcnt vmcnt(9)
    v_lshlrev_b32 v10, 16, v82
    v_lshlrev_b32 v11, 16, v83
    v_and_b32 v82, 0xffff0000, v82
    v_and_b32 v83, 0xffff0000, v83
    v_mul_f32 v10, s41, v10
    v_mul_f32 v82, s41, v82
    v_mul_f32 v11, s41, v11
    v_mul_f32 v83, s41, v83
    v_fract_f32 v10, v10
    v_fract_f32 v82, v82
    v_fract_f32 v11, v11
    v_fract_f32 v83, v83
    v_cos_f32 v10, v10
    v_cos_f32 v82, v82
    v_cos_f32 v11, v11
    v_cos_f32 v83, v83
    v_cvt_pk_bf16_f32 v82, v10, v82
    v_cvt_pk_bf16_f32 v83, v11, v83
    v_or3_b32 v5, v82, v83, v5
    s_add_u32 s35, s33, 45154304
    buffer_load_dwordx4 v[24:27], v1, s[8:11], s35 offen nt
    v_lshlrev_b32_sdwa v6, 2, v94 dst_sel:DWORD dst_unused:UNUSED_PAD src0_sel:DWORD src1_sel:WORD_0
    v_lshlrev_b32_sdwa v7, 2, v94 dst_sel:DWORD dst_unused:UNUSED_PAD src0_sel:DWORD src1_sel:WORD_1
    v_lshlrev_b32_sdwa v8, 2, v95 dst_sel:DWORD dst_unused:UNUSED_PAD src0_sel:DWORD src1_sel:WORD_0
    v_lshlrev_b32_sdwa v9, 2, v95 dst_sel:DWORD dst_unused:UNUSED_PAD src0_sel:DWORD src1_sel:WORD_1
    ds_write_b32 v6, v88
    ds_write_b32 v7, v89
    ds_write_b32 v8, v92
    ds_write_b32 v9, v93
    s_waitcnt vmcnt(9)
    v_lshlrev_b32 v10, 16, v90
    v_lshlrev_b32 v11, 16, v91
    v_and_b32 v90, 0xffff0000, v90
    v_and_b32 v91, 0xffff0000, v91
    v_mul_f32 v10, s41, v10
    v_mul_f32 v90, s41, v90
    v_mul_f32 v11, s41, v11
    v_mul_f32 v91, s41, v91
    v_fract_f32 v10, v10
    v_fract_f32 v90, v90
    v_fract_f32 v11, v11
    v_fract_f32 v91, v91
    v_cos_f32 v10, v10
    v_cos_f32 v90, v90
    v_cos_f32 v11, v11
    v_cos_f32 v91, v91
    v_cvt_pk_bf16_f32 v90, v10, v90
    v_cvt_pk_bf16_f32 v91, v11, v91
    v_or3_b32 v5, v90, v91, v5
    v_lshlrev_b32_sdwa v6, 2, v102 dst_sel:DWORD dst_unused:UNUSED_PAD src0_sel:DWORD src1_sel:WORD_0
    v_lshlrev_b32_sdwa v7, 2, v102 dst_sel:DWORD dst_unused:UNUSED_PAD src0_sel:DWORD src1_sel:WORD_1
    v_lshlrev_b32_sdwa v8, 2, v103 dst_sel:DWORD dst_unused:UNUSED_PAD src0_sel:DWORD src1_sel:WORD_0
    v_lshlrev_b32_sdwa v9, 2, v103 dst_sel:DWORD dst_unused:UNUSED_PAD src0_sel:DWORD src1_sel:WORD_1
    ds_write_b32 v6, v96
    ds_write_b32 v7, v97
    ds_write_b32 v8, v100
    ds_write_b32 v9, v101
    s_waitcnt vmcnt(6)
    v_lshlrev_b32 v10, 16, v98
    v_lshlrev_b32 v11, 16, v99
    v_and_b32 v98, 0xffff0000, v98
    v_and_b32 v99, 0xffff0000, v99
    v_mul_f32 v10, s41, v10
    v_mul_f32 v98, s41, v98
    v_mul_f32 v11, s41, v11
    v_mul_f32 v99, s41, v99
    v_fract_f32 v10, v10
    v_fract_f32 v98, v98
    v_fract_f32 v11, v11
    v_fract_f32 v99, v99
    v_cos_f32 v10, v10
    v_cos_f32 v98, v98
    v_cos_f32 v11, v11
    v_cos_f32 v99, v99
    v_cvt_pk_bf16_f32 v98, v10, v98
    v_cvt_pk_bf16_f32 v99, v11, v99
    v_or3_b32 v5, v98, v99, v5
    v_lshlrev_b32_sdwa v6, 2, v110 dst_sel:DWORD dst_unused:UNUSED_PAD src0_sel:DWORD src1_sel:WORD_0
    v_lshlrev_b32_sdwa v7, 2, v110 dst_sel:DWORD dst_unused:UNUSED_PAD src0_sel:DWORD src1_sel:WORD_1
    v_lshlrev_b32_sdwa v8, 2, v111 dst_sel:DWORD dst_unused:UNUSED_PAD src0_sel:DWORD src1_sel:WORD_0
    v_lshlrev_b32_sdwa v9, 2, v111 dst_sel:DWORD dst_unused:UNUSED_PAD src0_sel:DWORD src1_sel:WORD_1
    ds_write_b32 v6, v104
    ds_write_b32 v7, v105
    ds_write_b32 v8, v108
    ds_write_b32 v9, v109
    s_waitcnt vmcnt(5)
    v_lshlrev_b32 v10, 16, v106
    v_lshlrev_b32 v11, 16, v107
    v_and_b32 v106, 0xffff0000, v106
    v_and_b32 v107, 0xffff0000, v107
    v_mul_f32 v10, s41, v10
    v_mul_f32 v106, s41, v106
    v_mul_f32 v11, s41, v11
    v_mul_f32 v107, s41, v107
    v_fract_f32 v10, v10
    v_fract_f32 v106, v106
    v_fract_f32 v11, v11
    v_fract_f32 v107, v107
    v_cos_f32 v10, v10
    v_cos_f32 v106, v106
    v_cos_f32 v11, v11
    v_cos_f32 v107, v107
    v_cvt_pk_bf16_f32 v106, v10, v106
    v_cvt_pk_bf16_f32 v107, v11, v107
    v_or3_b32 v5, v106, v107, v5
    s_add_u32 s35, s33, 45154304
    buffer_load_dwordx4 v[28:31], v1, s[12:15], s35 offen nt
    v_lshlrev_b32_sdwa v6, 2, v118 dst_sel:DWORD dst_unused:UNUSED_PAD src0_sel:DWORD src1_sel:WORD_0
    v_lshlrev_b32_sdwa v7, 2, v118 dst_sel:DWORD dst_unused:UNUSED_PAD src0_sel:DWORD src1_sel:WORD_1
    v_lshlrev_b32_sdwa v8, 2, v119 dst_sel:DWORD dst_unused:UNUSED_PAD src0_sel:DWORD src1_sel:WORD_0
    v_lshlrev_b32_sdwa v9, 2, v119 dst_sel:DWORD dst_unused:UNUSED_PAD src0_sel:DWORD src1_sel:WORD_1
    ds_write_b32 v6, v112
    ds_write_b32 v7, v113
    ds_write_b32 v8, v116
    ds_write_b32 v9, v117
    s_waitcnt vmcnt(5)
    v_lshlrev_b32 v10, 16, v114
    v_lshlrev_b32 v11, 16, v115
    v_and_b32 v114, 0xffff0000, v114
    v_and_b32 v115, 0xffff0000, v115
    v_mul_f32 v10, s41, v10
    v_mul_f32 v114, s41, v114
    v_mul_f32 v11, s41, v11
    v_mul_f32 v115, s41, v115
    v_fract_f32 v10, v10
    v_fract_f32 v114, v114
    v_fract_f32 v11, v11
    v_fract_f32 v115, v115
    v_cos_f32 v10, v10
    v_cos_f32 v114, v114
    v_cos_f32 v11, v11
    v_cos_f32 v115, v115
    v_cvt_pk_bf16_f32 v114, v10, v114
    v_cvt_pk_bf16_f32 v115, v11, v115
    v_or3_b32 v5, v114, v115, v5
    s_mov_b64 exec, s[44:45]
    v_lshlrev_b32_sdwa v6, 2, v126 dst_sel:DWORD dst_unused:UNUSED_PAD src0_sel:DWORD src1_sel:WORD_0
    v_lshlrev_b32_sdwa v7, 2, v126 dst_sel:DWORD dst_unused:UNUSED_PAD src0_sel:DWORD src1_sel:WORD_1
    v_lshlrev_b32_sdwa v8, 2, v127 dst_sel:DWORD dst_unused:UNUSED_PAD src0_sel:DWORD src1_sel:WORD_0
    v_lshlrev_b32_sdwa v9, 2, v127 dst_sel:DWORD dst_unused:UNUSED_PAD src0_sel:DWORD src1_sel:WORD_1
    ds_write_b32 v6, v120
    ds_write_b32 v7, v121
    ds_write_b32 v8, v124
    ds_write_b32 v9, v125
    s_waitcnt vmcnt(4)
    v_lshlrev_b32 v10, 16, v122
    v_lshlrev_b32 v11, 16, v123
    v_and_b32 v122, 0xffff0000, v122
    v_and_b32 v123, 0xffff0000, v123
    v_mul_f32 v10, s41, v10
    v_mul_f32 v122, s41, v122
    v_mul_f32 v11, s41, v11
    v_mul_f32 v123, s41, v123
    v_fract_f32 v10, v10
    v_fract_f32 v122, v122
    v_fract_f32 v11, v11
    v_fract_f32 v123, v123
    v_cos_f32 v10, v10
    v_cos_f32 v122, v122
    v_cos_f32 v11, v11
    v_cos_f32 v123, v123
    v_cvt_pk_bf16_f32 v122, v10, v122
    v_cvt_pk_bf16_f32 v123, v11, v123
    v_or3_b32 v5, v122, v123, v5
    s_mov_b64 exec, -1
    s_mul_i32 s35, s39, 9728
    v_add_u32 v6, s35, v2
    s_waitcnt lgkmcnt(0)
    s_barrier
    ds_read_b64 v[48:49], v6 offset:0
    ds_read_b64 v[52:53], v6 offset:512
    ds_read_b64 v[56:57], v6 offset:1024
    ds_read_b64 v[60:61], v6 offset:1536
    ds_read_b64 v[64:65], v6 offset:2048
    ds_read_b64 v[68:69], v6 offset:2560
    ds_read_b64 v[72:73], v6 offset:3072
    ds_read_b64 v[76:77], v6 offset:3584
    ds_read_b64 v[80:81], v6 offset:4096
    ds_read_b64 v[84:85], v6 offset:4608
    ds_read_b64 v[88:89], v6 offset:5120
    ds_read_b64 v[92:93], v6 offset:5632
    ds_read_b64 v[96:97], v6 offset:6144
    ds_read_b64 v[100:101], v6 offset:6656
    ds_read_b64 v[104:105], v6 offset:7168
    ds_read_b64 v[108:109], v6 offset:7680
    ds_read_b64 v[112:113], v6 offset:8192
    ds_read_b64 v[116:117], v6 offset:8704
    ds_read_b64 v[120:121], v6 offset:9216
    ds_read_b64 v[124:125], v6 offset:9728
    s_add_u32 s35, s33, 49348608
    buffer_load_dwordx4 v[32:35], v1, s[8:11], s35 offen nt
    v_mov_b32 v12, 0
    v_mov_b32 v13, 0
    v_mov_b32 v14, 0
    v_mov_b32 v15, 0
    s_waitcnt lgkmcnt(0)
    s_barrier
    ds_write_b128 v1, v[12:15] offset:0
    v_lshlrev_b32_sdwa v6, 1, v54 dst_sel:DWORD dst_unused:UNUSED_PAD src0_sel:DWORD src1_sel:WORD_0
    v_lshlrev_b32_sdwa v7, 1, v54 dst_sel:DWORD dst_unused:UNUSED_PAD src0_sel:DWORD src1_sel:WORD_1
    v_lshlrev_b32_sdwa v8, 1, v55 dst_sel:DWORD dst_unused:UNUSED_PAD src0_sel:DWORD src1_sel:WORD_0
    v_lshlrev_b32_sdwa v9, 1, v55 dst_sel:DWORD dst_unused:UNUSED_PAD src0_sel:DWORD src1_sel:WORD_1
    ds_write_b16 v6, v50 offset:16384
    ds_write_b16_d16_hi v7, v50 offset:16384
    ds_write_b16 v8, v51 offset:16384
    ds_write_b16_d16_hi v9, v51 offset:16384
    v_lshlrev_b32_sdwa v6, 1, v62 dst_sel:DWORD dst_unused:UNUSED_PAD src0_sel:DWORD src1_sel:WORD_0
    v_lshlrev_b32_sdwa v7, 1, v62 dst_sel:DWORD dst_unused:UNUSED_PAD src0_sel:DWORD src1_sel:WORD_1
    v_lshlrev_b32_sdwa v8, 1, v63 dst_sel:DWORD dst_unused:UNUSED_PAD src0_sel:DWORD src1_sel:WORD_0
    v_lshlrev_b32_sdwa v9, 1, v63 dst_sel:DWORD dst_unused:UNUSED_PAD src0_sel:DWORD src1_sel:WORD_1
    ds_write_b16 v6, v58 offset:16384
    ds_write_b16_d16_hi v7, v58 offset:16384
    ds_write_b16 v8, v59 offset:16384
    ds_write_b16_d16_hi v9, v59 offset:16384
    s_add_u32 s35, s33, 49348608
    buffer_load_dwordx4 v[36:39], v1, s[12:15], s35 offen nt
    v_lshlrev_b32_sdwa v6, 1, v70 dst_sel:DWORD dst_unused:UNUSED_PAD src0_sel:DWORD src1_sel:WORD_0
    v_lshlrev_b32_sdwa v7, 1, v70 dst_sel:DWORD dst_unused:UNUSED_PAD src0_sel:DWORD src1_sel:WORD_1
    v_lshlrev_b32_sdwa v8, 1, v71 dst_sel:DWORD dst_unused:UNUSED_PAD src0_sel:DWORD src1_sel:WORD_0
    v_lshlrev_b32_sdwa v9, 1, v71 dst_sel:DWORD dst_unused:UNUSED_PAD src0_sel:DWORD src1_sel:WORD_1
    ds_write_b16 v6, v66 offset:16384
    ds_write_b16_d16_hi v7, v66 offset:16384
    ds_write_b16 v8, v67 offset:16384
    ds_write_b16_d16_hi v9, v67 offset:16384
    v_lshlrev_b32_sdwa v6, 1, v78 dst_sel:DWORD dst_unused:UNUSED_PAD src0_sel:DWORD src1_sel:WORD_0
    v_lshlrev_b32_sdwa v7, 1, v78 dst_sel:DWORD dst_unused:UNUSED_PAD src0_sel:DWORD src1_sel:WORD_1
    v_lshlrev_b32_sdwa v8, 1, v79 dst_sel:DWORD dst_unused:UNUSED_PAD src0_sel:DWORD src1_sel:WORD_0
    v_lshlrev_b32_sdwa v9, 1, v79 dst_sel:DWORD dst_unused:UNUSED_PAD src0_sel:DWORD src1_sel:WORD_1
    ds_write_b16 v6, v74 offset:16384
    ds_write_b16_d16_hi v7, v74 offset:16384
    ds_write_b16 v8, v75 offset:16384
    ds_write_b16_d16_hi v9, v75 offset:16384
    v_lshlrev_b32_sdwa v6, 1, v86 dst_sel:DWORD dst_unused:UNUSED_PAD src0_sel:DWORD src1_sel:WORD_0
    v_lshlrev_b32_sdwa v7, 1, v86 dst_sel:DWORD dst_unused:UNUSED_PAD src0_sel:DWORD src1_sel:WORD_1
    v_lshlrev_b32_sdwa v8, 1, v87 dst_sel:DWORD dst_unused:UNUSED_PAD src0_sel:DWORD src1_sel:WORD_0
    v_lshlrev_b32_sdwa v9, 1, v87 dst_sel:DWORD dst_unused:UNUSED_PAD src0_sel:DWORD src1_sel:WORD_1
    ds_write_b16 v6, v82 offset:16384
    ds_write_b16_d16_hi v7, v82 offset:16384
    ds_write_b16 v8, v83 offset:16384
    ds_write_b16_d16_hi v9, v83 offset:16384
    s_add_u32 s35, s33, 53542912
    buffer_load_dwordx4 v[40:43], v1, s[8:11], s35 offen nt
    v_lshlrev_b32_sdwa v6, 1, v94 dst_sel:DWORD dst_unused:UNUSED_PAD src0_sel:DWORD src1_sel:WORD_0
    v_lshlrev_b32_sdwa v7, 1, v94 dst_sel:DWORD dst_unused:UNUSED_PAD src0_sel:DWORD src1_sel:WORD_1
    v_lshlrev_b32_sdwa v8, 1, v95 dst_sel:DWORD dst_unused:UNUSED_PAD src0_sel:DWORD src1_sel:WORD_0
    v_lshlrev_b32_sdwa v9, 1, v95 dst_sel:DWORD dst_unused:UNUSED_PAD src0_sel:DWORD src1_sel:WORD_1
    ds_write_b16 v6, v90 offset:16384
    ds_write_b16_d16_hi v7, v90 offset:16384
    ds_write_b16 v8, v91 offset:16384
    ds_write_b16_d16_hi v9, v91 offset:16384
    v_lshlrev_b32_sdwa v6, 1, v102 dst_sel:DWORD dst_unused:UNUSED_PAD src0_sel:DWORD src1_sel:WORD_0
    v_lshlrev_b32_sdwa v7, 1, v102 dst_sel:DWORD dst_unused:UNUSED_PAD src0_sel:DWORD src1_sel:WORD_1
    v_lshlrev_b32_sdwa v8, 1, v103 dst_sel:DWORD dst_unused:UNUSED_PAD src0_sel:DWORD src1_sel:WORD_0
    v_lshlrev_b32_sdwa v9, 1, v103 dst_sel:DWORD dst_unused:UNUSED_PAD src0_sel:DWORD src1_sel:WORD_1
    ds_write_b16 v6, v98 offset:16384
    ds_write_b16_d16_hi v7, v98 offset:16384
    ds_write_b16 v8, v99 offset:16384
    ds_write_b16_d16_hi v9, v99 offset:16384
    v_lshlrev_b32_sdwa v6, 1, v110 dst_sel:DWORD dst_unused:UNUSED_PAD src0_sel:DWORD src1_sel:WORD_0
    v_lshlrev_b32_sdwa v7, 1, v110 dst_sel:DWORD dst_unused:UNUSED_PAD src0_sel:DWORD src1_sel:WORD_1
    v_lshlrev_b32_sdwa v8, 1, v111 dst_sel:DWORD dst_unused:UNUSED_PAD src0_sel:DWORD src1_sel:WORD_0
    v_lshlrev_b32_sdwa v9, 1, v111 dst_sel:DWORD dst_unused:UNUSED_PAD src0_sel:DWORD src1_sel:WORD_1
    ds_write_b16 v6, v106 offset:16384
    ds_write_b16_d16_hi v7, v106 offset:16384
    ds_write_b16 v8, v107 offset:16384
    ds_write_b16_d16_hi v9, v107 offset:16384
    s_add_u32 s35, s33, 53542912
    buffer_load_dwordx4 v[44:47], v1, s[12:15], s35 offen nt
    v_lshlrev_b32_sdwa v6, 1, v118 dst_sel:DWORD dst_unused:UNUSED_PAD src0_sel:DWORD src1_sel:WORD_0
    v_lshlrev_b32_sdwa v7, 1, v118 dst_sel:DWORD dst_unused:UNUSED_PAD src0_sel:DWORD src1_sel:WORD_1
    v_lshlrev_b32_sdwa v8, 1, v119 dst_sel:DWORD dst_unused:UNUSED_PAD src0_sel:DWORD src1_sel:WORD_0
    v_lshlrev_b32_sdwa v9, 1, v119 dst_sel:DWORD dst_unused:UNUSED_PAD src0_sel:DWORD src1_sel:WORD_1
    ds_write_b16 v6, v114 offset:16384
    ds_write_b16_d16_hi v7, v114 offset:16384
    ds_write_b16 v8, v115 offset:16384
    ds_write_b16_d16_hi v9, v115 offset:16384
    s_mov_b64 exec, s[44:45]
    v_lshlrev_b32_sdwa v6, 1, v126 dst_sel:DWORD dst_unused:UNUSED_PAD src0_sel:DWORD src1_sel:WORD_0
    v_lshlrev_b32_sdwa v7, 1, v126 dst_sel:DWORD dst_unused:UNUSED_PAD src0_sel:DWORD src1_sel:WORD_1
    v_lshlrev_b32_sdwa v8, 1, v127 dst_sel:DWORD dst_unused:UNUSED_PAD src0_sel:DWORD src1_sel:WORD_0
    v_lshlrev_b32_sdwa v9, 1, v127 dst_sel:DWORD dst_unused:UNUSED_PAD src0_sel:DWORD src1_sel:WORD_1
    ds_write_b16 v6, v122 offset:16384
    ds_write_b16_d16_hi v7, v122 offset:16384
    ds_write_b16 v8, v123 offset:16384
    ds_write_b16_d16_hi v9, v123 offset:16384
    s_mov_b64 exec, -1
    v_lshlrev_b32 v6, 2, v0
    s_mul_i32 s35, s39, 4864
    v_add_u32 v7, s35, v6
    s_waitcnt lgkmcnt(0)
    s_barrier
    ds_read_b32 v50, v7 offset:16384
    ds_read_b32 v54, v7 offset:16640
    ds_read_b32 v58, v7 offset:16896
    ds_read_b32 v62, v7 offset:17152
    ds_read_b32 v66, v7 offset:17408
    ds_read_b32 v70, v7 offset:17664
    ds_read_b32 v74, v7 offset:17920
    ds_read_b32 v78, v7 offset:18176
    ds_read_b32 v82, v7 offset:18432
    ds_read_b32 v86, v7 offset:18688
    ds_read_b32 v90, v7 offset:18944
    ds_read_b32 v94, v7 offset:19200
    ds_read_b32 v98, v7 offset:19456
    ds_read_b32 v102, v7 offset:19712
    ds_read_b32 v106, v7 offset:19968
    ds_read_b32 v110, v7 offset:20224
    ds_read_b32 v114, v7 offset:20480
    ds_read_b32 v118, v7 offset:20736
    ds_read_b32 v122, v7 offset:20992
    ds_read_b32 v126, v7 offset:21248
    s_add_u32 s32, s32, 256
    s_add_u32 s33, s33, 40960000
    s_add_u32 s34, s34, 20480000
    s_add_u32 s40, s40, 1
    s_cmp_lt_u32 s40, 4
    s_waitcnt lgkmcnt(0)
    s_cbranch_scc1 L_p1_loop
    s_mov_b32 s36, 0
    buffer_store_dwordx3 v[48:50], v3, s[20:23], s36 offen sc1
    s_mov_b32 s36, 768
    buffer_store_dwordx3 v[52:54], v3, s[20:23], s36 offen sc1
    s_mov_b32 s36, 1536
    buffer_store_dwordx3 v[56:58], v3, s[20:23], s36 offen sc1
    s_mov_b32 s36, 2304
    buffer_store_dwordx3 v[60:62], v3, s[20:23], s36 offen sc1
    s_mov_b32 s36, 3072
    buffer_store_dwordx3 v[64:66], v3, s[20:23], s36 offen sc1
    s_mov_b32 s36, 3840
    buffer_store_dwordx3 v[68:70], v3, s[20:23], s36 offen sc1
    s_mov_b32 s36, 4608
    buffer_store_dwordx3 v[72:74], v3, s[20:23], s36 offen sc1
    s_mov_b32 s36, 5376
    buffer_store_dwordx3 v[76:78], v3, s[20:23], s36 offen sc1
    s_mov_b32 s36, 6144
    buffer_store_dwordx3 v[80:82], v3, s[20:23], s36 offen sc1
    s_mov_b32 s36, 6912
    buffer_store_dwordx3 v[84:86], v3, s[20:23], s36 offen sc1
    s_mov_b32 s36, 7680
    buffer_store_dwordx3 v[88:90], v3, s[20:23], s36 offen sc1
    s_mov_b32 s36, 8448
    buffer_store_dwordx3 v[92:94], v3, s[20:23], s36 offen sc1
    s_mov_b32 s36, 9216
    buffer_store_dwordx3 v[96:98], v3, s[20:23], s36 offen sc1
    s_mov_b32 s36, 9984
    buffer_store_dwordx3 v[100:102], v3, s[20:23], s36 offen sc1
    s_mov_b32 s36, 10752
    buffer_store_dwordx3 v[104:106], v3, s[20:23], s36 offen sc1
    s_mov_b32 s36, 11520
    buffer_store_dwordx3 v[108:110], v3, s[20:23], s36 offen sc1
    s_mov_b32 s36, 12288
    buffer_store_dwordx3 v[112:114], v3, s[20:23], s36 offen sc1
    s_mov_b32 s36, 13056
    buffer_store_dwordx3 v[116:118], v3, s[20:23], s36 offen sc1
    s_mov_b32 s36, 13824
    buffer_store_dwordx3 v[120:122], v3, s[20:23], s36 offen sc1
    s_mov_b32 s36, 14592
    buffer_store_dwordx3 v[124:126], v3, s[20:23], s36 offen sc1
    v_and_b32 v6, 0x40004000, v5
    v_cmp_ne_u32 vcc, 0, v6
    s_lshl_b32 s35, s39, 4
    s_add_u32 s35, s35, 160328
    v_mov_b32 v10, s35
    s_cmp_lg_u64 vcc, 0
    s_cselect_b32 s36, 1, s55
    v_mov_b32 v11, s36
    ds_write_b32 v10, v11
    s_waitcnt lgkmcnt(0)
    s_barrier
    s_cmp_lg_u32 s39, 0
    s_cbranch_scc1 L_p1_end
    v_and_b32 v6, 15, v0
    v_lshlrev_b32 v6, 4, v6
    v_add_u32 v6, 160320, v6
    ds_read_b128 v[8:11], v6
    s_waitcnt lgkmcnt(0)
    s_nop 1
    v_max_u32_dpp v8, v8, v8 row_shr:1 row_mask:0xf bank_mask:0xf bound_ctrl:0
    s_nop 1
    v_max_u32_dpp v8, v8, v8 row_shr:2 row_mask:0xf bank_mask:0xf bound_ctrl:0
    s_nop 1
    v_max_u32_dpp v8, v8, v8 row_shr:4 row_mask:0xf bank_mask:0xf bound_ctrl:0
    s_nop 1
    v_max_u32_dpp v8, v8, v8 row_shr:8 row_mask:0xf bank_mask:0xf bound_ctrl:0
    s_nop 1
    v_add_f32_dpp v9, v9, v9 row_shr:1 row_mask:0xf bank_mask:0xf bound_ctrl:0
    s_nop 1
    v_add_f32_dpp v9, v9, v9 row_shr:2 row_mask:0xf bank_mask:0xf bound_ctrl:0
    s_nop 1
    v_add_f32_dpp v9, v9, v9 row_shr:4 row_mask:0xf bank_mask:0xf bound_ctrl:0
    s_nop 1
    v_add_f32_dpp v9, v9, v9 row_shr:8 row_mask:0xf bank_mask:0xf bound_ctrl:0
    s_nop 1
    v_or_b32_dpp v10, v10, v10 row_shr:1 row_mask:0xf bank_mask:0xf bound_ctrl:0
    s_nop 1
    v_or_b32_dpp v10, v10, v10 row_shr:2 row_mask:0xf bank_mask:0xf bound_ctrl:0
    s_nop 1
    v_or_b32_dpp v10, v10, v10 row_shr:4 row_mask:0xf bank_mask:0xf bound_ctrl:0
    s_nop 1
    v_or_b32_dpp v10, v10, v10 row_shr:8 row_mask:0xf bank_mask:0xf bound_ctrl:0
    s_lshl_b32 s35, s2, 3
    s_add_u32 s35, s35, 8552960
    v_mov_b32 v6, 0
    v_lshl_or_b32 v8, v10, 16, v8
    s_mov_b64 exec, 0x8000
    buffer_store_dwordx2 v[8:9], v6, s[24:27], s35 offen
    s_lshl_b32 s35, s2, 8
    s_add_u32 s35, s35, 8561152
    buffer_store_dword v6, v6, s[24:27], s35 offen
L_p1_end:
    s_endpgm
.globl p2_kernel
.p2align 8
.type p2_kernel,@function
p2_kernel:
    s_cmp_ge_u32 s2, 256
    s_cbranch_scc1 L_p2_end
    s_load_dwordx2 s[4:5], s[0:1], 104
    s_load_dwordx2 s[100:101], s[0:1], 24
    s_load_dwordx2 s[30:31], s[0:1], 40
    s_load_dwordx4 s[32:35], s[0:1], 56
    s_load_dwordx4 s[36:39], s[0:1], 72
    s_and_b32 s14, s2, 7
    s_lshr_b32 s49, s2, 3
    s_and_b32 s3, s14, 1
    s_lshl_b32 s3, s3, 5
    s_add_u32 s3, s3, s49
    s_lshr_b32 s12, s14, 1
    v_lshrrev_b32 v112, 6, v0
    v_lshlrev_b32 v1, 4, v0
    v_and_b32 v113, 63, v0
    v_readfirstlane_b32 s13, v112
    v_lshlrev_b32 v115, 4, v113
    s_mul_i32 s14, s12, 65
    s_add_u32 s14, s14, s3
    s_mul_i32 s14, s14, 32896
    s_add_u32 s25, s14, 246292480
    s_mul_i32 s22, s12, 1280000
    s_mov_b32 s2, 0
    s_waitcnt lgkmcnt(0)
    s_mov_b32 s6, 655360000
    s_mov_b32 s7, 0x00020000
    s_add_u32 s8, s4, 254870016
    s_addc_u32 s9, s5, 0
    s_add_u32 s10, s22, 1280000
    s_mov_b32 s11, 0x00020000
    s_add_u32 s15, s25, 0
    buffer_load_dwordx4 v[64:67], v1, s[4:7], s15 offen
    s_add_u32 s15, s25, 32896
    buffer_load_dwordx4 v[72:75], v1, s[4:7], s15 offen
    s_load_dwordx4 s[40:43], s[30:31], 0
    s_load_dwordx16 s[52:67], s[32:33], 0
    s_load_dwordx16 s[68:83], s[34:35], 0
    s_load_dwordx8 s[84:91], s[36:37], 0
    s_load_dwordx8 s[92:99], s[38:39], 0
    v_mov_b32 v52, 0x100
    s_cmp_lg_u32 s13, 0
    s_cbranch_scc1 L_p2_noann
    s_lshl_b32 s14, s3, 8
    s_add_u32 s14, s14, 254853632
    s_mov_b64 exec, 1
    buffer_atomic_add v52, off, s[4:7], s14
    s_mov_b64 exec, -1
L_p2_noann:
    s_and_b32 s14, s49, 3
    s_lshl_b32 s14, s14, 8
    s_lshr_b32 s15, s49, 2
    s_lshl_b32 s15, s15, 14
    s_add_u32 s51, s14, s15
    s_add_u32 s14, s22, 0
    buffer_load_dwordx4 v[88:91], v1, s[8:11], s14 offen
    s_add_u32 s14, s22, 16384
    buffer_load_dwordx4 v[92:95], v1, s[8:11], s14 offen
    s_add_u32 s14, s22, 32768
    buffer_load_dwordx4 v[96:99], v1, s[8:11], s14 offen
    s_add_u32 s14, s22, 49152
    buffer_load_dwordx4 v[100:103], v1, s[8:11], s14 offen
    s_add_u32 s14, s22, 65536
    buffer_load_dwordx4 v[104:107], v1, s[8:11], s14 offen
    s_mov_b32 s15, 254845440
    buffer_load_dwordx4 v[80:83], v115, s[4:7], s15 offen offset:0
    buffer_load_dwordx4 v[84:87], v115, s[4:7], s15 offen offset:1024
    s_add_u32 s15, s25, 16384
    buffer_load_dwordx4 v[68:71], v1, s[4:7], s15 offen
    s_add_u32 s15, s25, 49280
    buffer_load_dwordx4 v[76:79], v1, s[4:7], s15 offen
    v_mul_u32_u24 v2, 12, v113
    v_add_u32 v2, 2816, v2
    v_add_u32 v3, 80000, v1
    v_add_u32 v124, 145536, v1
    v_add_u32 v117, 65536, v1
    v_mov_b32 v116, 0x7f000000
    v_cmp_gt_u32 vcc, 904, v0
    s_mul_i32 s19, s13, 240
    s_add_u32 s19, s19, 160000
    v_cndmask_b32 v124, v116, v124, vcc
    v_cndmask_b32 v117, v116, v117, vcc
    v_lshl_add_u32 v6, v113, 2, s19
    v_lshl_add_u32 v126, v113, 1, s19
    v_cmp_gt_u32 vcc, 14, v113
    s_mul_i32 s27, s13, 15392768
    s_mov_b32 s23, 240512
    v_cndmask_b32 v6, v116, v6, vcc
    s_mov_b32 s44, s4
    s_mov_b32 s45, s5
    s_add_u32 s46, s27, 15400960
    s_mov_b32 s47, 0x00020000
    s_mov_b32 s17, 0x05040100
    s_mov_b32 s18, 80000
    s_and_b32 s50, s3, 1
    s_lshl_b32 s50, s50, 18
    s_sub_u32 s50, 4294836224, s50
    s_mov_b32 s20, 3221209088
    s_mov_b32 s21, 3221209087
    v_mov_b32 v4, 0
    v_mov_b32 v5, 0
    v_mov_b32 v118, 448
    ds_write_b32 v6, v5 offset:160
    ds_write_b16 v126, v118 offset:2
    v_mov_b32 v108, 1073758208
    v_mov_b32 v109, 1073758208
    v_mov_b32 v110, 1073758208
    v_mov_b32 v111, 1073758208
    ds_write_b128 v1, v[108:111] offset:0
    ds_write_b128 v1, v[108:111] offset:16384
    ds_write_b128 v1, v[108:111] offset:32768
    ds_write_b128 v1, v[108:111] offset:49152
    ds_write_b128 v117, v[108:111]
    s_waitcnt lgkmcnt(0)
    v_mov_b32 v53, s40
    v_mov_b32 v54, s41
    v_mov_b32 v56, s42
    v_mov_b32 v57, s43
    s_pack_ll_b32_b16 s14, s52, s54
    s_pack_hh_b32_b16 s15, s52, s54
    s_pack_ll_b32_b16 s54, s53, s55
    s_pack_hh_b32_b16 s55, s53, s55
    s_mov_b32 s52, s14
    s_mov_b32 s53, s15
    s_pack_ll_b32_b16 s14, s56, s58
    s_pack_hh_b32_b16 s15, s56, s58
    s_pack_ll_b32_b16 s58, s57, s59
    s_pack_hh_b32_b16 s59, s57, s59
    s_mov_b32 s56, s14
    s_mov_b32 s57, s15
    s_pack_ll_b32_b16 s14, s60, s62
    s_pack_hh_b32_b16 s15, s60, s62
    s_pack_ll_b32_b16 s62, s61, s63
    s_pack_hh_b32_b16 s63, s61, s63
    s_mov_b32 s60, s14
    s_mov_b32 s61, s15
    s_pack_ll_b32_b16 s14, s64, s66
    s_pack_hh_b32_b16 s15, s64, s66
    s_pack_ll_b32_b16 s66, s65, s67
    s_pack_hh_b32_b16 s67, s65, s67
    s_mov_b32 s64, s14
    s_mov_b32 s65, s15
    s_pack_ll_b32_b16 s14, s68, s70
    s_pack_hh_b32_b16 s15, s68, s70
    s_pack_ll_b32_b16 s70, s69, s71
    s_pack_hh_b32_b16 s71, s69, s71
    s_mov_b32 s68, s14
    s_mov_b32 s69, s15
    s_pack_ll_b32_b16 s14, s72, s74
    s_pack_hh_b32_b16 s15, s72, s74
    s_pack_ll_b32_b16 s74, s73, s75
    s_pack_hh_b32_b16 s75, s73, s75
    s_mov_b32 s72, s14
    s_mov_b32 s73, s15
    s_pack_ll_b32_b16 s14, s76, s78
    s_pack_hh_b32_b16 s15, s76, s78
    s_pack_ll_b32_b16 s78, s77, s79
    s_pack_hh_b32_b16 s79, s77, s79
    s_mov_b32 s76, s14
    s_mov_b32 s77, s15
    s_pack_ll_b32_b16 s14, s80, s82
    s_pack_hh_b32_b16 s15, s80, s82
    s_pack_ll_b32_b16 s82, s81, s83
    s_pack_hh_b32_b16 s83, s81, s83
    s_mov_b32 s80, s14
    s_mov_b32 s81, s15
    s_waitcnt vmcnt(9)
    v_mov_b32 v11, v64
    v_mov_b32 v43, v72
    v_mov_b32 v15, v65
    v_mov_b32 v47, v73
    v_mov_b32 v19, v66
    v_mov_b32 v51, v74
    v_mov_b32 v23, v67
    v_mov_b32 v55, v75
    v_add_u32_sdwa v113, 1, v43 dst_sel:DWORD dst_unused:UNUSED_PAD src0_sel:DWORD src1_sel:WORD_0
    v_lshrrev_b32_sdwa v112, 1, v11 dst_sel:DWORD dst_unused:UNUSED_PAD src0_sel:DWORD src1_sel:WORD_0
    v_lshrrev_b32 v113, 1, v113
    v_sub_u32 v114, v113, v112
    v_add_u32 v113, 448, v113
    s_nop 0
    v_add_u32_dpp v114, v114, v114 row_shr:1 row_mask:0xf bank_mask:0xf bound_ctrl:0
    s_nop 1
    v_add_u32_dpp v114, v114, v114 row_shr:2 row_mask:0xf bank_mask:0xf bound_ctrl:0
    s_nop 1
    v_add_u32_dpp v114, v114, v114 row_shr:4 row_mask:0xf bank_mask:0xf bound_ctrl:0
    s_nop 1
    v_add_u32_dpp v114, v114, v114 row_shr:8 row_mask:0xf bank_mask:0xf bound_ctrl:0
    s_nop 1
    v_add_u32_dpp v114, v114, v114 row_bcast:15 row_mask:0xa bank_mask:0xf
    s_nop 1
    v_add_u32_dpp v114, v114, v114 row_bcast:31 row_mask:0xc bank_mask:0xf
    v_sub_u32 v113, v113, v114
    v_readlane_b32 s29, v114, 63
    v_add_u32 v114, -1, v114
    ds_write_b16 v126, v113
    v_lshlrev_b32_e64 v115, v114, 1
    v_lshrrev_b32 v114, 5, v114
    v_lshl_add_u32 v114, v114, 2, s19
    s_cmp_gt_u32 s29, 448
    s_cselect_b32 s2, 1, s2
    s_cselect_b64 exec, 0, -1
    ds_or_b32 v114, v115 offset:160
    s_mov_b64 exec, -1
    ds_wrxchg_rtn_b32 v7, v6, v5 offset:160
    s_waitcnt lgkmcnt(0)
    v_readlane_b32 s30, v7, 0
    v_readlane_b32 s31, v7, 1
    v_readlane_b32 s32, v7, 2
    v_readlane_b32 s33, v7, 3
    v_readlane_b32 s34, v7, 4
    v_readlane_b32 s35, v7, 5
    v_readlane_b32 s36, v7, 6
    v_readlane_b32 s37, v7, 7
    v_readlane_b32 s38, v7, 8
    v_readlane_b32 s39, v7, 9
    v_readlane_b32 s40, v7, 10
    v_readlane_b32 s41, v7, 11
    s_mov_b32 s25, s19
    s_mov_b32 s26, s27
    s_mov_b32 s28, s29
    v_mbcnt_lo_u32_b32 v8, s30, 0
    v_mbcnt_hi_u32_b32 v8, s31, v8
    s_bcnt1_i32_b64 s14, s[30:31]
    v_lshl_add_u32 v9, v8, 1, s25
    ds_read_u16 v9, v9
    v_mad_u32_u24 v8, v8, s23, v2
    s_mov_b32 s30, s26
    s_lshl1_add_u32 s25, s14, s25
    s_mul_i32 s14, s14, s23
    s_add_u32 s26, s26, s14
    v_mbcnt_lo_u32_b32 v12, s32, 0
    v_mbcnt_hi_u32_b32 v12, s33, v12
    s_bcnt1_i32_b64 s14, s[32:33]
    v_lshl_add_u32 v13, v12, 1, s25
    ds_read_u16 v13, v13
    v_mad_u32_u24 v12, v12, s23, v2
    s_mov_b32 s32, s26
    s_lshl1_add_u32 s25, s14, s25
    s_mul_i32 s14, s14, s23
    s_add_u32 s26, s26, s14
    v_mbcnt_lo_u32_b32 v16, s34, 0
    v_mbcnt_hi_u32_b32 v16, s35, v16
    s_bcnt1_i32_b64 s14, s[34:35]
    v_lshl_add_u32 v17, v16, 1, s25
    ds_read_u16 v17, v17
    v_mad_u32_u24 v16, v16, s23, v2
    s_mov_b32 s34, s26
    s_lshl1_add_u32 s25, s14, s25
    s_mul_i32 s14, s14, s23
    s_add_u32 s26, s26, s14
    v_mbcnt_lo_u32_b32 v20, s36, 0
    v_mbcnt_hi_u32_b32 v20, s37, v20
    s_bcnt1_i32_b64 s14, s[36:37]
    v_lshl_add_u32 v21, v20, 1, s25
    ds_read_u16 v21, v21
    v_mad_u32_u24 v20, v20, s23, v2
    s_mov_b32 s36, s26
    s_lshl1_add_u32 s25, s14, s25
    s_mul_i32 s14, s14, s23
    s_add_u32 s26, s26, s14
    v_mbcnt_lo_u32_b32 v24, s38, 0
    v_mbcnt_hi_u32_b32 v24, s39, v24
    s_bcnt1_i32_b64 s14, s[38:39]
    v_lshl_add_u32 v25, v24, 1, s25
    ds_read_u16 v25, v25
    v_mad_u32_u24 v24, v24, s23, v2
    s_mov_b32 s38, s26
    s_lshl1_add_u32 s25, s14, s25
    s_mul_i32 s14, s14, s23
    s_add_u32 s26, s26, s14
    v_mbcnt_lo_u32_b32 v28, s40, 0
    v_mbcnt_hi_u32_b32 v28, s41, v28
    s_bcnt1_i32_b64 s14, s[40:41]
    v_lshl_add_u32 v29, v28, 1, s25
    ds_read_u16 v29, v29
    v_mad_u32_u24 v28, v28, s23, v2
    s_mov_b32 s40, s26
    s_lshl1_add_u32 s25, s14, s25
    s_mul_i32 s14, s14, s23
    s_add_u32 s26, s26, s14
    s_waitcnt lgkmcnt(5)
    v_mad_u32_u24 v8, v9, 12, v8
    buffer_load_dwordx3 v[8:10], v8, s[44:47], s30 offen offset:0
    s_waitcnt lgkmcnt(4)
    v_mad_u32_u24 v12, v13, 12, v12
    buffer_load_dwordx3 v[12:14], v12, s[44:47], s32 offen offset:768
    s_waitcnt lgkmcnt(3)
    v_mad_u32_u24 v16, v17, 12, v16
    buffer_load_dwordx3 v[16:18], v16, s[44:47], s34 offen offset:1536
    s_waitcnt lgkmcnt(2)
    v_mad_u32_u24 v20, v21, 12, v20
    buffer_load_dwordx3 v[20:22], v20, s[44:47], s36 offen offset:2304
    s_waitcnt lgkmcnt(1)
    v_mad_u32_u24 v24, v25, 12, v24
    buffer_load_dwordx3 v[24:26], v24, s[44:47], s38 offen offset:3072
    s_waitcnt lgkmcnt(0)
    v_mad_u32_u24 v28, v29, 12, v28
    buffer_load_dwordx3 v[28:30], v28, s[44:47], s40 offen offset:3840
    s_cmp_le_u32 s28, 384
    s_cbranch_scc1 L_p2_kernel_norare_1
    v_readlane_b32 s42, v7, 12
    v_readlane_b32 s43, v7, 13
    s_nop 1
    v_mbcnt_lo_u32_b32 v120, s42, 0
    v_mbcnt_hi_u32_b32 v120, s43, v120
    s_bcnt1_i32_b64 s14, s[42:43]
    v_lshl_add_u32 v121, v120, 1, s25
    ds_read_u16 v121, v121
    v_mad_u32_u24 v120, v120, s23, v2
    s_mov_b32 s42, s26
    s_lshl1_add_u32 s25, s14, s25
    s_mul_i32 s14, s14, s23
    s_add_u32 s26, s26, s14
    s_waitcnt lgkmcnt(0)
    s_add_u32 s42, s42, 4608
    v_mad_u32_u24 v120, v121, 12, v120
    buffer_load_dwordx3 v[32:34], v120, s[44:47], s42 offen offset:0
L_p2_kernel_norare_1:
    s_waitcnt vmcnt(10)
    ds_write_b128 v3, v[88:91] offset:0
    ds_write_b128 v3, v[92:95] offset:16384
    ds_write_b128 v3, v[96:99] offset:32768
    ds_write_b128 v3, v[100:103] offset:49152
    ds_write_b128 v124, v[104:107]
    s_waitcnt vmcnt(6)
    v_mov_b32 v27, v68
    v_mov_b32 v59, v76
    v_mov_b32 v31, v69
    v_mov_b32 v63, v77
    v_mov_b32 v35, v70
    v_mov_b32 v122, v78
    v_mov_b32 v39, v71
    v_mov_b32 v123, v79
    v_max3_u32 v36, v80, v82, v84
    v_add_f32 v37, v81, v83
    v_add_f32 v38, v85, v87
    v_max_u32 v36, v36, v86
    v_add_f32 v37, v37, v38
    v_cmp_lt_u32 vcc, 0xffff, v36
    s_nop 1
    v_max_u32_dpp v36, v36, v36 row_shr:1 row_mask:0xf bank_mask:0xf bound_ctrl:0
    s_nop 1
    v_max_u32_dpp v36, v36, v36 row_shr:2 row_mask:0xf bank_mask:0xf bound_ctrl:0
    s_nop 1
    v_max_u32_dpp v36, v36, v36 row_shr:4 row_mask:0xf bank_mask:0xf bound_ctrl:0
    s_nop 1
    v_max_u32_dpp v36, v36, v36 row_shr:8 row_mask:0xf bank_mask:0xf bound_ctrl:0
    s_nop 1
    v_max_u32_dpp v36, v36, v36 row_bcast:15 row_mask:0xa bank_mask:0xf
    s_nop 1
    v_max_u32_dpp v36, v36, v36 row_bcast:31 row_mask:0xc bank_mask:0xf
    s_nop 1
    v_add_f32_dpp v37, v37, v37 row_shr:1 row_mask:0xf bank_mask:0xf bound_ctrl:0
    s_nop 1
    v_add_f32_dpp v37, v37, v37 row_shr:2 row_mask:0xf bank_mask:0xf bound_ctrl:0
    s_nop 1
    v_add_f32_dpp v37, v37, v37 row_shr:4 row_mask:0xf bank_mask:0xf bound_ctrl:0
    s_nop 1
    v_add_f32_dpp v37, v37, v37 row_shr:8 row_mask:0xf bank_mask:0xf bound_ctrl:0
    s_nop 1
    v_add_f32_dpp v37, v37, v37 row_bcast:15 row_mask:0xa bank_mask:0xf
    s_nop 1
    v_add_f32_dpp v37, v37, v37 row_bcast:31 row_mask:0xc bank_mask:0xf
    s_cmp_lg_u64 vcc, 0
    s_cselect_b32 s2, 1, s2
    v_lshlrev_b32 v36, 16, v36
    v_mul_f32 v38, 936490775, v37
    v_mul_f32 v37, 928531664, v37
    v_cmp_nle_f32 vcc, v36, v38
    v_max_u32 v36, v36, v37
    s_nop 0
    v_readlane_b32 s14, v36, 63
    s_bitcmp1_b32 vcc_hi, 31
    s_cselect_b32 s2, 1, s2
    s_lshr_b32 s14, s14, 23
    s_add_u32 s14, s14, 1
    s_cmp_lt_u32 s14, 40
    s_cselect_b32 s2, 1, s2
    s_cmp_gt_u32 s14, 230
    s_cselect_b32 s2, 1, s2
    s_sub_u32 s48, s14, 14
    s_lshl_b32 s48, s48, 23
    s_add_u32 s16, s48, 197148672
    s_sub_u32 s14, s14, 40
    s_cmp_gt_u32 s14, 190
    s_cselect_b32 s48, 0, s48
    s_waitcnt lgkmcnt(0)
    s_barrier
    s_add_u32 s14, s22, 80000
    buffer_load_dwordx4 v[88:91], v1, s[8:11], s14 offen
    s_add_u32 s14, s22, 96384
    buffer_load_dwordx4 v[92:95], v1, s[8:11], s14 offen
    s_add_u32 s14, s22, 112768
    buffer_load_dwordx4 v[96:99], v1, s[8:11], s14 offen
    v_add_u32_sdwa v113, 1, v43 dst_sel:DWORD dst_unused:UNUSED_PAD src0_sel:DWORD src1_sel:WORD_1
    v_lshrrev_b32_sdwa v112, 1, v11 dst_sel:DWORD dst_unused:UNUSED_PAD src0_sel:DWORD src1_sel:WORD_1
    v_lshrrev_b32 v113, 1, v113
    v_sub_u32 v114, v113, v112
    v_add_u32 v113, 448, v113
    s_nop 0
    v_add_u32_dpp v114, v114, v114 row_shr:1 row_mask:0xf bank_mask:0xf bound_ctrl:0
    s_nop 1
    v_add_u32_dpp v114, v114, v114 row_shr:2 row_mask:0xf bank_mask:0xf bound_ctrl:0
    s_nop 1
    v_add_u32_dpp v114, v114, v114 row_shr:4 row_mask:0xf bank_mask:0xf bound_ctrl:0
    s_nop 1
    v_add_u32_dpp v114, v114, v114 row_shr:8 row_mask:0xf bank_mask:0xf bound_ctrl:0
    s_nop 1
    v_add_u32_dpp v114, v114, v114 row_bcast:15 row_mask:0xa bank_mask:0xf
    s_nop 1
    v_add_u32_dpp v114, v114, v114 row_bcast:31 row_mask:0xc bank_mask:0xf
    v_sub_u32 v113, v113, v114
    v_readlane_b32 s29, v114, 63
    v_add_u32 v114, -1, v114
    ds_write_b16 v126, v113
    v_lshlrev_b32_e64 v115, v114, 1
    v_lshrrev_b32 v114, 5, v114
    v_lshl_add_u32 v114, v114, 2, s19
    s_cmp_gt_u32 s29, 448
    s_cselect_b32 s2, 1, s2
    s_cselect_b64 exec, 0, -1
    ds_or_b32 v114, v115 offset:160
    s_mov_b64 exec, -1
    ds_wrxchg_rtn_b32 v7, v6, v5 offset:160
    s_mov_b32 s24, 0
L_p2_loop:
    s_cmp_le_u32 s28, 384
    s_cbranch_scc1 L_p2_kernel_norare2_2
    s_waitcnt vmcnt(0)
    v_mad_u32_u16 v64, v32, 8, s18
    v_mad_u32_u16 v66, v33, 8, s18
    ds_read_b64 v[64:65], v64
    ds_read_b64 v[66:67], v66
    v_and_b32 v112, 0xffff, v34
    v_lshrrev_b32 v114, 16, v34
    v_lshlrev_b32 v113, 16, v34
    v_and_b32 v34, 0xffff0000, v34
    v_mad_u32_u16 v32, v32, 8, s50 op_sel:[1,0,0,0]
    v_mad_u32_u16 v33, v33, 8, s50 op_sel:[1,0,0,0]
    s_waitcnt lgkmcnt(0)
    v_dot2_f32_bf16 v115, v64, v112, s16
    v_dot2_f32_bf16 v64, v64, v113, s16
    v_dot2_f32_bf16 v116, v65, v112, s16
    v_dot2_f32_bf16 v65, v65, v113, s16
    v_dot2_f32_bf16 v117, v66, v114, s16
    v_dot2_f32_bf16 v66, v66, v34, s16
    v_dot2_f32_bf16 v118, v67, v114, s16
    v_dot2_f32_bf16 v67, v67, v34, s16
    v_perm_b32 v64, v64, v115, s17
    v_perm_b32 v65, v65, v116, s17
    v_perm_b32 v66, v66, v117, s17
    v_perm_b32 v67, v67, v118, s17
    v_lshl_add_u64 v[64:65], v[64:65], 0, s[20:21]
    v_lshl_add_u64 v[66:67], v[66:67], 0, s[20:21]
    v_or3_b32 v4, v108, v109, v4
    v_or3_b32 v4, v110, v111, v4
    ds_add_rtn_u64 v[108:109], v32, v[64:65]
    ds_add_rtn_u64 v[110:111], v33, v[66:67]
    s_waitcnt lgkmcnt(0)
L_p2_kernel_norare2_2:
    s_add_u32 s22, s22, 80000
    s_lshl_b32 s14, s13, 4
    s_or_b32 s14, s14, s24
    s_cmp_lg_u32 s14, 5
    s_cbranch_scc1 L_p2_nost
    v_mov_b32 v52, 0
    s_lshl_b32 s14, s3, 8
    s_add_u32 s14, s14, 254853632
    s_mov_b64 exec, 1
    buffer_atomic_add v52, off, s[4:7], s14 sc0
    s_mov_b64 exec, -1
L_p2_nost:
    s_waitcnt vmcnt(8)
    v_mad_u32_u16 v64, v8, 8, s18
    v_mad_u32_u16 v66, v9, 8, s18
    ds_read_b64 v[64:65], v64
    ds_read_b64 v[66:67], v66
    s_add_u32 s14, s22, 49152
    buffer_load_dwordx4 v[100:103], v1, s[8:11], s14 offen
    s_waitcnt vmcnt(8)
    v_mad_u32_u16 v68, v12, 8, s18
    v_mad_u32_u16 v70, v13, 8, s18
    ds_read_b64 v[68:69], v68
    ds_read_b64 v[70:71], v70
    s_add_u32 s14, s22, 65536
    buffer_load_dwordx4 v[104:107], v1, s[8:11], s14 offen
    s_waitcnt vmcnt(8)
    v_mad_u32_u16 v72, v16, 8, s18
    v_mad_u32_u16 v74, v17, 8, s18
    ds_read_b64 v[72:73], v72
    ds_read_b64 v[74:75], v74
    s_waitcnt lgkmcnt(6)
    v_readlane_b32 s30, v7, 0
    v_readlane_b32 s31, v7, 1
    v_readlane_b32 s32, v7, 2
    v_readlane_b32 s33, v7, 3
    v_readlane_b32 s34, v7, 4
    v_readlane_b32 s35, v7, 5
    v_readlane_b32 s36, v7, 6
    v_readlane_b32 s37, v7, 7
    v_readlane_b32 s38, v7, 8
    v_readlane_b32 s39, v7, 9
    v_readlane_b32 s40, v7, 10
    v_readlane_b32 s41, v7, 11
    s_mov_b32 s25, s19
    s_mov_b32 s26, s27
    s_mov_b32 s28, s29
    v_mbcnt_lo_u32_b32 v120, s30, 0
    v_mbcnt_hi_u32_b32 v120, s31, v120
    s_bcnt1_i32_b64 s14, s[30:31]
    v_lshl_add_u32 v121, v120, 1, s25
    ds_read_u16 v121, v121
    v_mad_u32_u24 v120, v120, s23, v2
    s_mov_b32 s30, s26
    s_lshl1_add_u32 s25, s14, s25
    s_mul_i32 s14, s14, s23
    s_add_u32 s26, s26, s14
    v_and_b32 v112, 0xffff, v10
    v_lshrrev_b32 v114, 16, v10
    v_lshlrev_b32 v113, 16, v10
    v_and_b32 v10, 0xffff0000, v10
    v_mad_u32_u16 v8, v8, 8, s50 op_sel:[1,0,0,0]
    v_mad_u32_u16 v9, v9, 8, s50 op_sel:[1,0,0,0]
    s_waitcnt lgkmcnt(5)
    v_dot2_f32_bf16 v115, v64, v112, s16
    v_dot2_f32_bf16 v64, v64, v113, s16
    v_dot2_f32_bf16 v116, v65, v112, s16
    v_dot2_f32_bf16 v65, v65, v113, s16
    v_dot2_f32_bf16 v117, v66, v114, s16
    v_dot2_f32_bf16 v66, v66, v10, s16
    v_dot2_f32_bf16 v118, v67, v114, s16
    v_dot2_f32_bf16 v67, v67, v10, s16
    v_perm_b32 v64, v64, v115, s17
    v_perm_b32 v65, v65, v116, s17
    v_perm_b32 v66, v66, v117, s17
    v_perm_b32 v67, v67, v118, s17
    v_lshl_add_u64 v[64:65], v[64:65], 0, s[20:21]
    v_lshl_add_u64 v[66:67], v[66:67], 0, s[20:21]
    v_or3_b32 v4, v108, v109, v4
    v_or3_b32 v4, v110, v111, v4
    ds_add_rtn_u64 v[108:109], v8, v[64:65]
    ds_add_rtn_u64 v[110:111], v9, v[66:67]
    s_waitcnt lgkmcnt(2)
    v_mad_u32_u24 v120, v121, 12, v120
    buffer_load_dwordx3 v[8:10], v120, s[44:47], s30 offen offset:0
    s_waitcnt vmcnt(8)
    v_mad_u32_u16 v76, v20, 8, s18
    v_mad_u32_u16 v78, v21, 8, s18
    ds_read_b64 v[76:77], v76
    ds_read_b64 v[78:79], v78
    v_mbcnt_lo_u32_b32 v120, s32, 0
    v_mbcnt_hi_u32_b32 v120, s33, v120
    s_bcnt1_i32_b64 s14, s[32:33]
    v_lshl_add_u32 v121, v120, 1, s25
    ds_read_u16 v121, v121
    v_mad_u32_u24 v120, v120, s23, v2
    s_mov_b32 s32, s26
    s_lshl1_add_u32 s25, s14, s25
    s_mul_i32 s14, s14, s23
    s_add_u32 s26, s26, s14
    v_and_b32 v112, 0xffff, v14
    v_lshrrev_b32 v114, 16, v14
    v_lshlrev_b32 v113, 16, v14
    v_and_b32 v14, 0xffff0000, v14
    v_mad_u32_u16 v12, v12, 8, s50 op_sel:[1,0,0,0]
    v_mad_u32_u16 v13, v13, 8, s50 op_sel:[1,0,0,0]
    v_dot2_f32_bf16 v115, v68, v112, s16
    v_dot2_f32_bf16 v68, v68, v113, s16
    v_dot2_f32_bf16 v116, v69, v112, s16
    v_dot2_f32_bf16 v69, v69, v113, s16
    v_dot2_f32_bf16 v117, v70, v114, s16
    v_dot2_f32_bf16 v70, v70, v14, s16
    v_dot2_f32_bf16 v118, v71, v114, s16
    v_dot2_f32_bf16 v71, v71, v14, s16
    v_perm_b32 v68, v68, v115, s17
    v_perm_b32 v69, v69, v116, s17
    v_perm_b32 v70, v70, v117, s17
    v_perm_b32 v71, v71, v118, s17
    v_lshl_add_u64 v[68:69], v[68:69], 0, s[20:21]
    v_lshl_add_u64 v[70:71], v[70:71], 0, s[20:21]
    s_waitcnt lgkmcnt(3)
    v_or3_b32 v4, v108, v109, v4
    v_or3_b32 v4, v110, v111, v4
    ds_add_rtn_u64 v[108:109], v12, v[68:69]
    ds_add_rtn_u64 v[110:111], v13, v[70:71]
    s_waitcnt lgkmcnt(2)
    v_mad_u32_u24 v120, v121, 12, v120
    buffer_load_dwordx3 v[12:14], v120, s[44:47], s32 offen offset:768
    s_waitcnt vmcnt(8)
    v_mad_u32_u16 v80, v24, 8, s18
    v_mad_u32_u16 v82, v25, 8, s18
    ds_read_b64 v[80:81], v80
    ds_read_b64 v[82:83], v82
    s_waitcnt vmcnt(7)
    v_mad_u32_u16 v84, v28, 8, s18
    v_mad_u32_u16 v86, v29, 8, s18
    ds_read_b64 v[84:85], v84
    ds_read_b64 v[86:87], v86
    v_mbcnt_lo_u32_b32 v120, s34, 0
    v_mbcnt_hi_u32_b32 v120, s35, v120
    s_bcnt1_i32_b64 s14, s[34:35]
    v_lshl_add_u32 v121, v120, 1, s25
    ds_read_u16 v121, v121
    v_mad_u32_u24 v120, v120, s23, v2
    s_mov_b32 s34, s26
    s_lshl1_add_u32 s25, s14, s25
    s_mul_i32 s14, s14, s23
    s_add_u32 s26, s26, s14
    v_and_b32 v112, 0xffff, v18
    v_lshrrev_b32 v114, 16, v18
    v_lshlrev_b32 v113, 16, v18
    v_and_b32 v18, 0xffff0000, v18
    v_mad_u32_u16 v16, v16, 8, s50 op_sel:[1,0,0,0]
    v_mad_u32_u16 v17, v17, 8, s50 op_sel:[1,0,0,0]
    v_dot2_f32_bf16 v115, v72, v112, s16
    v_dot2_f32_bf16 v72, v72, v113, s16
    v_dot2_f32_bf16 v116, v73, v112, s16
    v_dot2_f32_bf16 v73, v73, v113, s16
    v_dot2_f32_bf16 v117, v74, v114, s16
    v_dot2_f32_bf16 v74, v74, v18, s16
    v_dot2_f32_bf16 v118, v75, v114, s16
    v_dot2_f32_bf16 v75, v75, v18, s16
    v_perm_b32 v72, v72, v115, s17
    v_perm_b32 v73, v73, v116, s17
    v_perm_b32 v74, v74, v117, s17
    v_perm_b32 v75, v75, v118, s17
    v_lshl_add_u64 v[72:73], v[72:73], 0, s[20:21]
    v_lshl_add_u64 v[74:75], v[74:75], 0, s[20:21]
    s_waitcnt lgkmcnt(5)
    v_or3_b32 v4, v108, v109, v4
    v_or3_b32 v4, v110, v111, v4
    ds_add_rtn_u64 v[108:109], v16, v[72:73]
    ds_add_rtn_u64 v[110:111], v17, v[74:75]
    s_waitcnt lgkmcnt(2)
    v_mad_u32_u24 v120, v121, 12, v120
    buffer_load_dwordx3 v[16:18], v120, s[44:47], s34 offen offset:1536
    s_barrier
    s_waitcnt vmcnt(3)
    ds_write_b128 v3, v[88:91] offset:0
    ds_write_b128 v3, v[92:95] offset:16384
    ds_write_b128 v3, v[96:99] offset:32768
    ds_write_b128 v3, v[100:103] offset:49152
    ds_write_b128 v124, v[104:107]
    v_mbcnt_lo_u32_b32 v120, s36, 0
    v_mbcnt_hi_u32_b32 v120, s37, v120
    s_bcnt1_i32_b64 s14, s[36:37]
    v_lshl_add_u32 v121, v120, 1, s25
    ds_read_u16 v121, v121
    v_mad_u32_u24 v120, v120, s23, v2
    s_mov_b32 s36, s26
    s_lshl1_add_u32 s25, s14, s25
    s_mul_i32 s14, s14, s23
    s_add_u32 s26, s26, s14
    v_and_b32 v112, 0xffff, v22
    v_lshrrev_b32 v114, 16, v22
    v_lshlrev_b32 v113, 16, v22
    v_and_b32 v22, 0xffff0000, v22
    v_mad_u32_u16 v20, v20, 8, s50 op_sel:[1,0,0,0]
    v_mad_u32_u16 v21, v21, 8, s50 op_sel:[1,0,0,0]
    v_dot2_f32_bf16 v115, v76, v112, s16
    v_dot2_f32_bf16 v76, v76, v113, s16
    v_dot2_f32_bf16 v116, v77, v112, s16
    v_dot2_f32_bf16 v77, v77, v113, s16
    v_dot2_f32_bf16 v117, v78, v114, s16
    v_dot2_f32_bf16 v78, v78, v22, s16
    v_dot2_f32_bf16 v118, v79, v114, s16
    v_dot2_f32_bf16 v79, v79, v22, s16
    v_perm_b32 v76, v76, v115, s17
    v_perm_b32 v77, v77, v116, s17
    v_perm_b32 v78, v78, v117, s17
    v_perm_b32 v79, v79, v118, s17
    v_lshl_add_u64 v[76:77], v[76:77], 0, s[20:21]
    v_lshl_add_u64 v[78:79], v[78:79], 0, s[20:21]
    s_waitcnt lgkmcnt(6)
    v_or3_b32 v4, v108, v109, v4
    v_or3_b32 v4, v110, v111, v4
    ds_add_rtn_u64 v[108:109], v20, v[76:77]
    ds_add_rtn_u64 v[110:111], v21, v[78:79]
    s_waitcnt lgkmcnt(2)
    v_mad_u32_u24 v120, v121, 12, v120
    buffer_load_dwordx3 v[20:22], v120, s[44:47], s36 offen offset:2304
    v_mbcnt_lo_u32_b32 v120, s38, 0
    v_mbcnt_hi_u32_b32 v120, s39, v120
    s_bcnt1_i32_b64 s14, s[38:39]
    v_lshl_add_u32 v121, v120, 1, s25
    ds_read_u16 v121, v121
    v_mad_u32_u24 v120, v120, s23, v2
    s_mov_b32 s38, s26
    s_lshl1_add_u32 s25, s14, s25
    s_mul_i32 s14, s14, s23
    s_add_u32 s26, s26, s14
    v_and_b32 v112, 0xffff, v26
    v_lshrrev_b32 v114, 16, v26
    v_lshlrev_b32 v113, 16, v26
    v_and_b32 v26, 0xffff0000, v26
    v_mad_u32_u16 v24, v24, 8, s50 op_sel:[1,0,0,0]
    v_mad_u32_u16 v25, v25, 8, s50 op_sel:[1,0,0,0]
    v_dot2_f32_bf16 v115, v80, v112, s16
    v_dot2_f32_bf16 v80, v80, v113, s16
    v_dot2_f32_bf16 v116, v81, v112, s16
    v_dot2_f32_bf16 v81, v81, v113, s16
    v_dot2_f32_bf16 v117, v82, v114, s16
    v_dot2_f32_bf16 v82, v82, v26, s16
    v_dot2_f32_bf16 v118, v83, v114, s16
    v_dot2_f32_bf16 v83, v83, v26, s16
    v_perm_b32 v80, v80, v115, s17
    v_perm_b32 v81, v81, v116, s17
    v_perm_b32 v82, v82, v117, s17
    v_perm_b32 v83, v83, v118, s17
    v_lshl_add_u64 v[80:81], v[80:81], 0, s[20:21]
    v_lshl_add_u64 v[82:83], v[82:83], 0, s[20:21]
    s_waitcnt lgkmcnt(1)
    v_or3_b32 v4, v108, v109, v4
    v_or3_b32 v4, v110, v111, v4
    ds_add_rtn_u64 v[108:109], v24, v[80:81]
    ds_add_rtn_u64 v[110:111], v25, v[82:83]
    s_waitcnt lgkmcnt(2)
    v_mad_u32_u24 v120, v121, 12, v120
    buffer_load_dwordx3 v[24:26], v120, s[44:47], s38 offen offset:3072
    v_mbcnt_lo_u32_b32 v120, s40, 0
    v_mbcnt_hi_u32_b32 v120, s41, v120
    s_bcnt1_i32_b64 s14, s[40:41]
    v_lshl_add_u32 v121, v120, 1, s25
    ds_read_u16 v121, v121
    v_mad_u32_u24 v120, v120, s23, v2
    s_mov_b32 s40, s26
    s_lshl1_add_u32 s25, s14, s25
    s_mul_i32 s14, s14, s23
    s_add_u32 s26, s26, s14
    v_and_b32 v112, 0xffff, v30
    v_lshrrev_b32 v114, 16, v30
    v_lshlrev_b32 v113, 16, v30
    v_and_b32 v30, 0xffff0000, v30
    v_mad_u32_u16 v28, v28, 8, s50 op_sel:[1,0,0,0]
    v_mad_u32_u16 v29, v29, 8, s50 op_sel:[1,0,0,0]
    v_dot2_f32_bf16 v115, v84, v112, s16
    v_dot2_f32_bf16 v84, v84, v113, s16
    v_dot2_f32_bf16 v116, v85, v112, s16
    v_dot2_f32_bf16 v85, v85, v113, s16
    v_dot2_f32_bf16 v117, v86, v114, s16
    v_dot2_f32_bf16 v86, v86, v30, s16
    v_dot2_f32_bf16 v118, v87, v114, s16
    v_dot2_f32_bf16 v87, v87, v30, s16
    v_perm_b32 v84, v84, v115, s17
    v_perm_b32 v85, v85, v116, s17
    v_perm_b32 v86, v86, v117, s17
    v_perm_b32 v87, v87, v118, s17
    v_lshl_add_u64 v[84:85], v[84:85], 0, s[20:21]
    v_lshl_add_u64 v[86:87], v[86:87], 0, s[20:21]
    s_waitcnt lgkmcnt(1)
    v_or3_b32 v4, v108, v109, v4
    v_or3_b32 v4, v110, v111, v4
    ds_add_rtn_u64 v[108:109], v28, v[84:85]
    ds_add_rtn_u64 v[110:111], v29, v[86:87]
    s_waitcnt lgkmcnt(2)
    v_mad_u32_u24 v120, v121, 12, v120
    buffer_load_dwordx3 v[28:30], v120, s[44:47], s40 offen offset:3840
    s_cmp_le_u32 s28, 384
    s_cbranch_scc1 L_p2_kernel_norare_3
    v_readlane_b32 s42, v7, 12
    v_readlane_b32 s43, v7, 13
    s_nop 1
    v_mbcnt_lo_u32_b32 v120, s42, 0
    v_mbcnt_hi_u32_b32 v120, s43, v120
    s_bcnt1_i32_b64 s14, s[42:43]
    v_lshl_add_u32 v121, v120, 1, s25
    ds_read_u16 v121, v121
    v_mad_u32_u24 v120, v120, s23, v2
    s_mov_b32 s42, s26
    s_lshl1_add_u32 s25, s14, s25
    s_mul_i32 s14, s14, s23
    s_add_u32 s26, s26, s14
    s_waitcnt lgkmcnt(0)
    s_add_u32 s42, s42, 4608
    v_mad_u32_u24 v120, v121, 12, v120
    buffer_load_dwordx3 v[32:34], v120, s[44:47], s42 offen offset:0
L_p2_kernel_norare_3:
    v_mov_b32 v11, v15
    v_mov_b32 v43, v47
    v_mov_b32 v15, v19
    v_mov_b32 v47, v51
    v_mov_b32 v19, v23
    v_mov_b32 v51, v55
    v_mov_b32 v23, v27
    v_mov_b32 v55, v59
    v_mov_b32 v27, v31
    v_mov_b32 v59, v63
    v_mov_b32 v31, v35
    v_mov_b32 v63, v122
    v_mov_b32 v35, v39
    v_mov_b32 v122, v123
    v_mov_b32 v39, 0
    v_mov_b32 v123, 0
    v_add_u32_sdwa v113, 1, v43 dst_sel:DWORD dst_unused:UNUSED_PAD src0_sel:DWORD src1_sel:WORD_0
    v_lshrrev_b32_sdwa v112, 1, v11 dst_sel:DWORD dst_unused:UNUSED_PAD src0_sel:DWORD src1_sel:WORD_0
    v_lshrrev_b32 v113, 1, v113
    v_sub_u32 v114, v113, v112
    v_add_u32 v113, 448, v113
    s_nop 0
    v_add_u32_dpp v114, v114, v114 row_shr:1 row_mask:0xf bank_mask:0xf bound_ctrl:0
    s_nop 1
    v_add_u32_dpp v114, v114, v114 row_shr:2 row_mask:0xf bank_mask:0xf bound_ctrl:0
    s_nop 1
    v_add_u32_dpp v114, v114, v114 row_shr:4 row_mask:0xf bank_mask:0xf bound_ctrl:0
    s_nop 1
    v_add_u32_dpp v114, v114, v114 row_shr:8 row_mask:0xf bank_mask:0xf bound_ctrl:0
    s_nop 1
    v_add_u32_dpp v114, v114, v114 row_bcast:15 row_mask:0xa bank_mask:0xf
    s_nop 1
    v_add_u32_dpp v114, v114, v114 row_bcast:31 row_mask:0xc bank_mask:0xf
    v_sub_u32 v113, v113, v114
    v_readlane_b32 s29, v114, 63
    v_add_u32 v114, -1, v114
    ds_write_b16 v126, v113
    v_lshlrev_b32_e64 v115, v114, 1
    v_lshrrev_b32 v114, 5, v114
    v_lshl_add_u32 v114, v114, 2, s19
    s_cmp_gt_u32 s29, 448
    s_cselect_b32 s2, 1, s2
    s_cselect_b64 exec, 0, -1
    ds_or_b32 v114, v115 offset:160
    s_mov_b64 exec, -1
    ds_wrxchg_rtn_b32 v7, v6, v5 offset:160
    s_add_u32 s14, s22, 80000
    buffer_load_dwordx4 v[88:91], v1, s[8:11], s14 offen
    s_add_u32 s14, s22, 96384
    buffer_load_dwordx4 v[92:95], v1, s[8:11], s14 offen
    s_add_u32 s14, s22, 112768
    buffer_load_dwordx4 v[96:99], v1, s[8:11], s14 offen
    s_barrier
    s_cmp_le_u32 s28, 384
    s_cbranch_scc1 L_p2_kernel_norare2_4
    s_waitcnt vmcnt(0)
    v_mad_u32_u16 v64, v32, 8, s18
    v_mad_u32_u16 v66, v33, 8, s18
    ds_read_b64 v[64:65], v64
    ds_read_b64 v[66:67], v66
    v_and_b32 v112, 0xffff, v34
    v_lshrrev_b32 v114, 16, v34
    v_lshlrev_b32 v113, 16, v34
    v_and_b32 v34, 0xffff0000, v34
    v_mad_u32_u16 v32, v32, 8, s50 op_sel:[1,0,0,0]
    v_mad_u32_u16 v33, v33, 8, s50 op_sel:[1,0,0,0]
    s_waitcnt lgkmcnt(0)
    v_dot2_f32_bf16 v115, v64, v112, s16
    v_dot2_f32_bf16 v64, v64, v113, s16
    v_dot2_f32_bf16 v116, v65, v112, s16
    v_dot2_f32_bf16 v65, v65, v113, s16
    v_dot2_f32_bf16 v117, v66, v114, s16
    v_dot2_f32_bf16 v66, v66, v34, s16
    v_dot2_f32_bf16 v118, v67, v114, s16
    v_dot2_f32_bf16 v67, v67, v34, s16
    v_perm_b32 v64, v64, v115, s17
    v_perm_b32 v65, v65, v116, s17
    v_perm_b32 v66, v66, v117, s17
    v_perm_b32 v67, v67, v118, s17
    v_lshl_add_u64 v[64:65], v[64:65], 0, s[20:21]
    v_lshl_add_u64 v[66:67], v[66:67], 0, s[20:21]
    v_or3_b32 v4, v108, v109, v4
    v_or3_b32 v4, v110, v111, v4
    ds_add_rtn_u64 v[108:109], v32, v[64:65]
    ds_add_rtn_u64 v[110:111], v33, v[66:67]
    s_waitcnt lgkmcnt(0)
L_p2_kernel_norare2_4:
    s_add_u32 s22, s22, 80000
    s_cmp_eq_u32 s24, 7
    s_cselect_b32 s46, 0, s46
    s_cmp_lg_u32 s24, 7
    s_cbranch_scc1 L_p2_nodist
    s_lshl2_add_u32 s14, s3, s12
    s_mul_i32 s14, s14, 5000
    s_add_u32 s15, s14, 4096
    v_min_u32 v61, 225, v0
    v_lshl_add_u32 v60, v0, 2, s14
    v_lshl_add_u32 v61, v61, 2, s15
    global_load_dword v60, v60, s[100:101] nt
    global_load_dword v61, v61, s[100:101] nt
L_p2_nodist:
    s_waitcnt vmcnt(8)
    v_mad_u32_u16 v64, v8, 8, s18
    v_mad_u32_u16 v66, v9, 8, s18
    ds_read_b64 v[64:65], v64
    ds_read_b64 v[66:67], v66
    s_add_u32 s14, s22, 49152
    buffer_load_dwordx4 v[100:103], v1, s[8:11], s14 offen
    s_waitcnt vmcnt(8)
    v_mad_u32_u16 v68, v12, 8, s18
    v_mad_u32_u16 v70, v13, 8, s18
    ds_read_b64 v[68:69], v68
    ds_read_b64 v[70:71], v70
    s_add_u32 s14, s22, 65536
    buffer_load_dwordx4 v[104:107], v1, s[8:11], s14 offen
    s_waitcnt vmcnt(8)
    v_mad_u32_u16 v72, v16, 8, s18
    v_mad_u32_u16 v74, v17, 8, s18
    ds_read_b64 v[72:73], v72
    ds_read_b64 v[74:75], v74
    s_waitcnt lgkmcnt(6)
    v_readlane_b32 s30, v7, 0
    v_readlane_b32 s31, v7, 1
    v_readlane_b32 s32, v7, 2
    v_readlane_b32 s33, v7, 3
    v_readlane_b32 s34, v7, 4
    v_readlane_b32 s35, v7, 5
    v_readlane_b32 s36, v7, 6
    v_readlane_b32 s37, v7, 7
    v_readlane_b32 s38, v7, 8
    v_readlane_b32 s39, v7, 9
    v_readlane_b32 s40, v7, 10
    v_readlane_b32 s41, v7, 11
    s_mov_b32 s25, s19
    s_mov_b32 s26, s27
    s_mov_b32 s28, s29
    v_mbcnt_lo_u32_b32 v120, s30, 0
    v_mbcnt_hi_u32_b32 v120, s31, v120
    s_bcnt1_i32_b64 s14, s[30:31]
    v_lshl_add_u32 v121, v120, 1, s25
    ds_read_u16 v121, v121
    v_mad_u32_u24 v120, v120, s23, v2
    s_mov_b32 s30, s26
    s_lshl1_add_u32 s25, s14, s25
    s_mul_i32 s14, s14, s23
    s_add_u32 s26, s26, s14
    v_and_b32 v112, 0xffff, v10
    v_lshrrev_b32 v114, 16, v10
    v_lshlrev_b32 v113, 16, v10
    v_and_b32 v10, 0xffff0000, v10
    v_mad_u32_u16 v8, v8, 8, s50 op_sel:[1,0,0,0]
    v_mad_u32_u16 v9, v9, 8, s50 op_sel:[1,0,0,0]
    s_waitcnt lgkmcnt(5)
    v_dot2_f32_bf16 v115, v64, v112, s16
    v_dot2_f32_bf16 v64, v64, v113, s16
    v_dot2_f32_bf16 v116, v65, v112, s16
    v_dot2_f32_bf16 v65, v65, v113, s16
    v_dot2_f32_bf16 v117, v66, v114, s16
    v_dot2_f32_bf16 v66, v66, v10, s16
    v_dot2_f32_bf16 v118, v67, v114, s16
    v_dot2_f32_bf16 v67, v67, v10, s16
    v_perm_b32 v64, v64, v115, s17
    v_perm_b32 v65, v65, v116, s17
    v_perm_b32 v66, v66, v117, s17
    v_perm_b32 v67, v67, v118, s17
    v_lshl_add_u64 v[64:65], v[64:65], 0, s[20:21]
    v_lshl_add_u64 v[66:67], v[66:67], 0, s[20:21]
    v_or3_b32 v4, v108, v109, v4
    v_or3_b32 v4, v110, v111, v4
    ds_add_rtn_u64 v[108:109], v8, v[64:65]
    ds_add_rtn_u64 v[110:111], v9, v[66:67]
    s_waitcnt lgkmcnt(2)
    v_mad_u32_u24 v120, v121, 12, v120
    buffer_load_dwordx3 v[8:10], v120, s[44:47], s30 offen offset:0
    s_waitcnt vmcnt(8)
    v_mad_u32_u16 v76, v20, 8, s18
    v_mad_u32_u16 v78, v21, 8, s18
    ds_read_b64 v[76:77], v76
    ds_read_b64 v[78:79], v78
    v_mbcnt_lo_u32_b32 v120, s32, 0
    v_mbcnt_hi_u32_b32 v120, s33, v120
    s_bcnt1_i32_b64 s14, s[32:33]
    v_lshl_add_u32 v121, v120, 1, s25
    ds_read_u16 v121, v121
    v_mad_u32_u24 v120, v120, s23, v2
    s_mov_b32 s32, s26
    s_lshl1_add_u32 s25, s14, s25
    s_mul_i32 s14, s14, s23
    s_add_u32 s26, s26, s14
    v_and_b32 v112, 0xffff, v14
    v_lshrrev_b32 v114, 16, v14
    v_lshlrev_b32 v113, 16, v14
    v_and_b32 v14, 0xffff0000, v14
    v_mad_u32_u16 v12, v12, 8, s50 op_sel:[1,0,0,0]
    v_mad_u32_u16 v13, v13, 8, s50 op_sel:[1,0,0,0]
    v_dot2_f32_bf16 v115, v68, v112, s16
    v_dot2_f32_bf16 v68, v68, v113, s16
    v_dot2_f32_bf16 v116, v69, v112, s16
    v_dot2_f32_bf16 v69, v69, v113, s16
    v_dot2_f32_bf16 v117, v70, v114, s16
    v_dot2_f32_bf16 v70, v70, v14, s16
    v_dot2_f32_bf16 v118, v71, v114, s16
    v_dot2_f32_bf16 v71, v71, v14, s16
    v_perm_b32 v68, v68, v115, s17
    v_perm_b32 v69, v69, v116, s17
    v_perm_b32 v70, v70, v117, s17
    v_perm_b32 v71, v71, v118, s17
    v_lshl_add_u64 v[68:69], v[68:69], 0, s[20:21]
    v_lshl_add_u64 v[70:71], v[70:71], 0, s[20:21]
    s_waitcnt lgkmcnt(3)
    v_or3_b32 v4, v108, v109, v4
    v_or3_b32 v4, v110, v111, v4
    ds_add_rtn_u64 v[108:109], v12, v[68:69]
    ds_add_rtn_u64 v[110:111], v13, v[70:71]
    s_waitcnt lgkmcnt(2)
    v_mad_u32_u24 v120, v121, 12, v120
    buffer_load_dwordx3 v[12:14], v120, s[44:47], s32 offen offset:768
    s_waitcnt vmcnt(8)
    v_mad_u32_u16 v80, v24, 8, s18
    v_mad_u32_u16 v82, v25, 8, s18
    ds_read_b64 v[80:81], v80
    ds_read_b64 v[82:83], v82
    s_waitcnt vmcnt(7)
    v_mad_u32_u16 v84, v28, 8, s18
    v_mad_u32_u16 v86, v29, 8, s18
    ds_read_b64 v[84:85], v84
    ds_read_b64 v[86:87], v86
    v_mbcnt_lo_u32_b32 v120, s34, 0
    v_mbcnt_hi_u32_b32 v120, s35, v120
    s_bcnt1_i32_b64 s14, s[34:35]
    v_lshl_add_u32 v121, v120, 1, s25
    ds_read_u16 v121, v121
    v_mad_u32_u24 v120, v120, s23, v2
    s_mov_b32 s34, s26
    s_lshl1_add_u32 s25, s14, s25
    s_mul_i32 s14, s14, s23
    s_add_u32 s26, s26, s14
    v_and_b32 v112, 0xffff, v18
    v_lshrrev_b32 v114, 16, v18
    v_lshlrev_b32 v113, 16, v18
    v_and_b32 v18, 0xffff0000, v18
    v_mad_u32_u16 v16, v16, 8, s50 op_sel:[1,0,0,0]
    v_mad_u32_u16 v17, v17, 8, s50 op_sel:[1,0,0,0]
    v_dot2_f32_bf16 v115, v72, v112, s16
    v_dot2_f32_bf16 v72, v72, v113, s16
    v_dot2_f32_bf16 v116, v73, v112, s16
    v_dot2_f32_bf16 v73, v73, v113, s16
    v_dot2_f32_bf16 v117, v74, v114, s16
    v_dot2_f32_bf16 v74, v74, v18, s16
    v_dot2_f32_bf16 v118, v75, v114, s16
    v_dot2_f32_bf16 v75, v75, v18, s16
    v_perm_b32 v72, v72, v115, s17
    v_perm_b32 v73, v73, v116, s17
    v_perm_b32 v74, v74, v117, s17
    v_perm_b32 v75, v75, v118, s17
    v_lshl_add_u64 v[72:73], v[72:73], 0, s[20:21]
    v_lshl_add_u64 v[74:75], v[74:75], 0, s[20:21]
    s_waitcnt lgkmcnt(5)
    v_or3_b32 v4, v108, v109, v4
    v_or3_b32 v4, v110, v111, v4
    ds_add_rtn_u64 v[108:109], v16, v[72:73]
    ds_add_rtn_u64 v[110:111], v17, v[74:75]
    s_waitcnt lgkmcnt(2)
    v_mad_u32_u24 v120, v121, 12, v120
    buffer_load_dwordx3 v[16:18], v120, s[44:47], s34 offen offset:1536
    s_barrier
    s_waitcnt vmcnt(3)
    ds_write_b128 v3, v[88:91] offset:0
    ds_write_b128 v3, v[92:95] offset:16384
    ds_write_b128 v3, v[96:99] offset:32768
    ds_write_b128 v3, v[100:103] offset:49152
    ds_write_b128 v124, v[104:107]
    v_mbcnt_lo_u32_b32 v120, s36, 0
    v_mbcnt_hi_u32_b32 v120, s37, v120
    s_bcnt1_i32_b64 s14, s[36:37]
    v_lshl_add_u32 v121, v120, 1, s25
    ds_read_u16 v121, v121
    v_mad_u32_u24 v120, v120, s23, v2
    s_mov_b32 s36, s26
    s_lshl1_add_u32 s25, s14, s25
    s_mul_i32 s14, s14, s23
    s_add_u32 s26, s26, s14
    v_and_b32 v112, 0xffff, v22
    v_lshrrev_b32 v114, 16, v22
    v_lshlrev_b32 v113, 16, v22
    v_and_b32 v22, 0xffff0000, v22
    v_mad_u32_u16 v20, v20, 8, s50 op_sel:[1,0,0,0]
    v_mad_u32_u16 v21, v21, 8, s50 op_sel:[1,0,0,0]
    v_dot2_f32_bf16 v115, v76, v112, s16
    v_dot2_f32_bf16 v76, v76, v113, s16
    v_dot2_f32_bf16 v116, v77, v112, s16
    v_dot2_f32_bf16 v77, v77, v113, s16
    v_dot2_f32_bf16 v117, v78, v114, s16
    v_dot2_f32_bf16 v78, v78, v22, s16
    v_dot2_f32_bf16 v118, v79, v114, s16
    v_dot2_f32_bf16 v79, v79, v22, s16
    v_perm_b32 v76, v76, v115, s17
    v_perm_b32 v77, v77, v116, s17
    v_perm_b32 v78, v78, v117, s17
    v_perm_b32 v79, v79, v118, s17
    v_lshl_add_u64 v[76:77], v[76:77], 0, s[20:21]
    v_lshl_add_u64 v[78:79], v[78:79], 0, s[20:21]
    s_waitcnt lgkmcnt(6)
    v_or3_b32 v4, v108, v109, v4
    v_or3_b32 v4, v110, v111, v4
    ds_add_rtn_u64 v[108:109], v20, v[76:77]
    ds_add_rtn_u64 v[110:111], v21, v[78:79]
    s_waitcnt lgkmcnt(2)
    v_mad_u32_u24 v120, v121, 12, v120
    buffer_load_dwordx3 v[20:22], v120, s[44:47], s36 offen offset:2304
    v_mbcnt_lo_u32_b32 v120, s38, 0
    v_mbcnt_hi_u32_b32 v120, s39, v120
    s_bcnt1_i32_b64 s14, s[38:39]
    v_lshl_add_u32 v121, v120, 1, s25
    ds_read_u16 v121, v121
    v_mad_u32_u24 v120, v120, s23, v2
    s_mov_b32 s38, s26
    s_lshl1_add_u32 s25, s14, s25
    s_mul_i32 s14, s14, s23
    s_add_u32 s26, s26, s14
    v_and_b32 v112, 0xffff, v26
    v_lshrrev_b32 v114, 16, v26
    v_lshlrev_b32 v113, 16, v26
    v_and_b32 v26, 0xffff0000, v26
    v_mad_u32_u16 v24, v24, 8, s50 op_sel:[1,0,0,0]
    v_mad_u32_u16 v25, v25, 8, s50 op_sel:[1,0,0,0]
    v_dot2_f32_bf16 v115, v80, v112, s16
    v_dot2_f32_bf16 v80, v80, v113, s16
    v_dot2_f32_bf16 v116, v81, v112, s16
    v_dot2_f32_bf16 v81, v81, v113, s16
    v_dot2_f32_bf16 v117, v82, v114, s16
    v_dot2_f32_bf16 v82, v82, v26, s16
    v_dot2_f32_bf16 v118, v83, v114, s16
    v_dot2_f32_bf16 v83, v83, v26, s16
    v_perm_b32 v80, v80, v115, s17
    v_perm_b32 v81, v81, v116, s17
    v_perm_b32 v82, v82, v117, s17
    v_perm_b32 v83, v83, v118, s17
    v_lshl_add_u64 v[80:81], v[80:81], 0, s[20:21]
    v_lshl_add_u64 v[82:83], v[82:83], 0, s[20:21]
    s_waitcnt lgkmcnt(1)
    v_or3_b32 v4, v108, v109, v4
    v_or3_b32 v4, v110, v111, v4
    ds_add_rtn_u64 v[108:109], v24, v[80:81]
    ds_add_rtn_u64 v[110:111], v25, v[82:83]
    s_waitcnt lgkmcnt(2)
    v_mad_u32_u24 v120, v121, 12, v120
    buffer_load_dwordx3 v[24:26], v120, s[44:47], s38 offen offset:3072
    v_mbcnt_lo_u32_b32 v120, s40, 0
    v_mbcnt_hi_u32_b32 v120, s41, v120
    s_bcnt1_i32_b64 s14, s[40:41]
    v_lshl_add_u32 v121, v120, 1, s25
    ds_read_u16 v121, v121
    v_mad_u32_u24 v120, v120, s23, v2
    s_mov_b32 s40, s26
    s_lshl1_add_u32 s25, s14, s25
    s_mul_i32 s14, s14, s23
    s_add_u32 s26, s26, s14
    v_and_b32 v112, 0xffff, v30
    v_lshrrev_b32 v114, 16, v30
    v_lshlrev_b32 v113, 16, v30
    v_and_b32 v30, 0xffff0000, v30
    v_mad_u32_u16 v28, v28, 8, s50 op_sel:[1,0,0,0]
    v_mad_u32_u16 v29, v29, 8, s50 op_sel:[1,0,0,0]
    v_dot2_f32_bf16 v115, v84, v112, s16
    v_dot2_f32_bf16 v84, v84, v113, s16
    v_dot2_f32_bf16 v116, v85, v112, s16
    v_dot2_f32_bf16 v85, v85, v113, s16
    v_dot2_f32_bf16 v117, v86, v114, s16
    v_dot2_f32_bf16 v86, v86, v30, s16
    v_dot2_f32_bf16 v118, v87, v114, s16
    v_dot2_f32_bf16 v87, v87, v30, s16
    v_perm_b32 v84, v84, v115, s17
    v_perm_b32 v85, v85, v116, s17
    v_perm_b32 v86, v86, v117, s17
    v_perm_b32 v87, v87, v118, s17
    v_lshl_add_u64 v[84:85], v[84:85], 0, s[20:21]
    v_lshl_add_u64 v[86:87], v[86:87], 0, s[20:21]
    s_waitcnt lgkmcnt(1)
    v_or3_b32 v4, v108, v109, v4
    v_or3_b32 v4, v110, v111, v4
    ds_add_rtn_u64 v[108:109], v28, v[84:85]
    ds_add_rtn_u64 v[110:111], v29, v[86:87]
    s_waitcnt lgkmcnt(2)
    v_mad_u32_u24 v120, v121, 12, v120
    buffer_load_dwordx3 v[28:30], v120, s[44:47], s40 offen offset:3840
    s_cmp_le_u32 s28, 384
    s_cbranch_scc1 L_p2_kernel_norare_5
    v_readlane_b32 s42, v7, 12
    v_readlane_b32 s43, v7, 13
    s_nop 1
    v_mbcnt_lo_u32_b32 v120, s42, 0
    v_mbcnt_hi_u32_b32 v120, s43, v120
    s_bcnt1_i32_b64 s14, s[42:43]
    v_lshl_add_u32 v121, v120, 1, s25
    ds_read_u16 v121, v121
    v_mad_u32_u24 v120, v120, s23, v2
    s_mov_b32 s42, s26
    s_lshl1_add_u32 s25, s14, s25
    s_mul_i32 s14, s14, s23
    s_add_u32 s26, s26, s14
    s_waitcnt lgkmcnt(0)
    s_add_u32 s42, s42, 4608
    v_mad_u32_u24 v120, v121, 12, v120
    buffer_load_dwordx3 v[32:34], v120, s[44:47], s42 offen offset:0
L_p2_kernel_norare_5:
    v_add_u32_sdwa v113, 1, v43 dst_sel:DWORD dst_unused:UNUSED_PAD src0_sel:DWORD src1_sel:WORD_1
    v_lshrrev_b32_sdwa v112, 1, v11 dst_sel:DWORD dst_unused:UNUSED_PAD src0_sel:DWORD src1_sel:WORD_1
    v_lshrrev_b32 v113, 1, v113
    v_sub_u32 v114, v113, v112
    v_add_u32 v113, 448, v113
    s_nop 0
    v_add_u32_dpp v114, v114, v114 row_shr:1 row_mask:0xf bank_mask:0xf bound_ctrl:0
    s_nop 1
    v_add_u32_dpp v114, v114, v114 row_shr:2 row_mask:0xf bank_mask:0xf bound_ctrl:0
    s_nop 1
    v_add_u32_dpp v114, v114, v114 row_shr:4 row_mask:0xf bank_mask:0xf bound_ctrl:0
    s_nop 1
    v_add_u32_dpp v114, v114, v114 row_shr:8 row_mask:0xf bank_mask:0xf bound_ctrl:0
    s_nop 1
    v_add_u32_dpp v114, v114, v114 row_bcast:15 row_mask:0xa bank_mask:0xf
    s_nop 1
    v_add_u32_dpp v114, v114, v114 row_bcast:31 row_mask:0xc bank_mask:0xf
    v_sub_u32 v113, v113, v114
    v_readlane_b32 s29, v114, 63
    v_add_u32 v114, -1, v114
    ds_write_b16 v126, v113
    v_lshlrev_b32_e64 v115, v114, 1
    v_lshrrev_b32 v114, 5, v114
    v_lshl_add_u32 v114, v114, 2, s19
    s_cmp_gt_u32 s29, 448
    s_cselect_b32 s2, 1, s2
    s_cselect_b64 exec, 0, -1
    ds_or_b32 v114, v115 offset:160
    s_mov_b64 exec, -1
    ds_wrxchg_rtn_b32 v7, v6, v5 offset:160
    s_add_u32 s14, s22, 80000
    buffer_load_dwordx4 v[88:91], v1, s[8:11], s14 offen
    s_add_u32 s14, s22, 96384
    buffer_load_dwordx4 v[92:95], v1, s[8:11], s14 offen
    s_add_u32 s14, s22, 112768
    buffer_load_dwordx4 v[96:99], v1, s[8:11], s14 offen
    s_add_u32 s24, s24, 1
    s_cmp_lt_u32 s24, 8
    s_barrier
    s_cbranch_scc1 L_p2_loop
    s_waitcnt lgkmcnt(3)
    v_or3_b32 v4, v108, v109, v4
    v_or3_b32 v4, v110, v111, v4
    s_mov_b32 s27, s19
    s_waitcnt vmcnt(0)
    v_mov_b32 v8, 160232
    s_cmp_lg_u32 s13, 0
    s_cselect_b64 exec, 0, 1
    ds_write_b32 v8, v52
    s_mov_b64 exec, -1
    v_subrev_u32 v6, 80000, v124
    s_mul_i32 s24, s12, 20000
    v_subrev_u32 v10, s24, v1
    v_mov_b32 v11, 0x7f000000
    s_waitcnt vmcnt(0) lgkmcnt(0)
    s_barrier
    s_cmp_lt_u32 s13, 4
    s_cbranch_scc1 L_p2_ga
    v_lshlrev_b32 v30, 16, v60
    v_and_b32 v31, 0xffff0000, v60
    v_lshlrev_b32 v36, 16, v53
    v_and_b32 v37, 0xffff0000, v53
    v_lshlrev_b32 v38, 16, v54
    v_and_b32 v39, 0xffff0000, v54
    v_lshlrev_b32 v40, 16, v56
    v_and_b32 v41, 0xffff0000, v56
    v_lshlrev_b32 v42, 16, v57
    v_and_b32 v43, 0xffff0000, v57
    v_pk_add_f32 v[14:15], v[30:31], v[36:37] op_sel:[0,0] op_sel_hi:[1,0] neg_lo:[0,1] neg_hi:[0,1]
    v_pk_add_f32 v[16:17], v[30:31], v[36:37] op_sel:[0,1] op_sel_hi:[1,1] neg_lo:[0,1] neg_hi:[0,1]
    v_pk_add_f32 v[18:19], v[30:31], v[38:39] op_sel:[0,0] op_sel_hi:[1,0] neg_lo:[0,1] neg_hi:[0,1]
    v_pk_add_f32 v[20:21], v[30:31], v[38:39] op_sel:[0,1] op_sel_hi:[1,1] neg_lo:[0,1] neg_hi:[0,1]
    v_pk_add_f32 v[22:23], v[30:31], v[40:41] op_sel:[0,0] op_sel_hi:[1,0] neg_lo:[0,1] neg_hi:[0,1]
    v_pk_add_f32 v[24:25], v[30:31], v[40:41] op_sel:[0,1] op_sel_hi:[1,1] neg_lo:[0,1] neg_hi:[0,1]
    v_pk_add_f32 v[26:27], v[30:31], v[42:43] op_sel:[0,0] op_sel_hi:[1,0] neg_lo:[0,1] neg_hi:[0,1]
    v_pk_add_f32 v[28:29], v[30:31], v[42:43] op_sel:[0,1] op_sel_hi:[1,1] neg_lo:[0,1] neg_hi:[0,1]
    v_cvt_pk_bf16_f32 v32, v14, v15
    v_lshlrev_b32 v14, 16, v32
    v_and_b32 v15, 0xffff0000, v32
    v_cvt_pk_bf16_f32 v32, v16, v17
    v_lshlrev_b32 v16, 16, v32
    v_and_b32 v17, 0xffff0000, v32
    v_cvt_pk_bf16_f32 v32, v18, v19
    v_lshlrev_b32 v18, 16, v32
    v_and_b32 v19, 0xffff0000, v32
    v_cvt_pk_bf16_f32 v32, v20, v21
    v_lshlrev_b32 v20, 16, v32
    v_and_b32 v21, 0xffff0000, v32
    v_cvt_pk_bf16_f32 v32, v22, v23
    v_lshlrev_b32 v22, 16, v32
    v_and_b32 v23, 0xffff0000, v32
    v_cvt_pk_bf16_f32 v32, v24, v25
    v_lshlrev_b32 v24, 16, v32
    v_and_b32 v25, 0xffff0000, v32
    v_cvt_pk_bf16_f32 v32, v26, v27
    v_lshlrev_b32 v26, 16, v32
    v_and_b32 v27, 0xffff0000, v32
    v_cvt_pk_bf16_f32 v32, v28, v29
    v_lshlrev_b32 v28, 16, v32
    v_and_b32 v29, 0xffff0000, v32
    v_pk_mul_f32 v[14:15], v[14:15], v[14:15]
    v_pk_mul_f32 v[16:17], v[16:17], v[16:17]
    v_pk_mul_f32 v[18:19], v[18:19], v[18:19]
    v_pk_mul_f32 v[20:21], v[20:21], v[20:21]
    v_pk_mul_f32 v[22:23], v[22:23], v[22:23]
    v_pk_mul_f32 v[24:25], v[24:25], v[24:25]
    v_pk_mul_f32 v[26:27], v[26:27], v[26:27]
    v_pk_mul_f32 v[28:29], v[28:29], v[28:29]
    v_cvt_pk_bf16_f32 v32, v14, v15
    v_lshlrev_b32 v14, 16, v32
    v_and_b32 v15, 0xffff0000, v32
    v_cvt_pk_bf16_f32 v32, v16, v17
    v_lshlrev_b32 v16, 16, v32
    v_and_b32 v17, 0xffff0000, v32
    v_cvt_pk_bf16_f32 v32, v18, v19
    v_lshlrev_b32 v18, 16, v32
    v_and_b32 v19, 0xffff0000, v32
    v_cvt_pk_bf16_f32 v32, v20, v21
    v_lshlrev_b32 v20, 16, v32
    v_and_b32 v21, 0xffff0000, v32
    v_cvt_pk_bf16_f32 v32, v22, v23
    v_lshlrev_b32 v22, 16, v32
    v_and_b32 v23, 0xffff0000, v32
    v_cvt_pk_bf16_f32 v32, v24, v25
    v_lshlrev_b32 v24, 16, v32
    v_and_b32 v25, 0xffff0000, v32
    v_cvt_pk_bf16_f32 v32, v26, v27
    v_lshlrev_b32 v26, 16, v32
    v_and_b32 v27, 0xffff0000, v32
    v_cvt_pk_bf16_f32 v32, v28, v29
    v_lshlrev_b32 v28, 16, v32
    v_and_b32 v29, 0xffff0000, v32
    v_mov_b32 v30, 1092616192
    v_mov_b32 v31, 0x3fb8aa3b
    v_pk_mul_f32 v[14:15], v[14:15], v[30:31] op_sel:[0,0] op_sel_hi:[1,0]
    v_pk_mul_f32 v[16:17], v[16:17], v[30:31] op_sel:[0,0] op_sel_hi:[1,0]
    v_pk_mul_f32 v[18:19], v[18:19], v[30:31] op_sel:[0,0] op_sel_hi:[1,0]
    v_pk_mul_f32 v[20:21], v[20:21], v[30:31] op_sel:[0,0] op_sel_hi:[1,0]
    v_pk_mul_f32 v[22:23], v[22:23], v[30:31] op_sel:[0,0] op_sel_hi:[1,0]
    v_pk_mul_f32 v[24:25], v[24:25], v[30:31] op_sel:[0,0] op_sel_hi:[1,0]
    v_pk_mul_f32 v[26:27], v[26:27], v[30:31] op_sel:[0,0] op_sel_hi:[1,0]
    v_pk_mul_f32 v[28:29], v[28:29], v[30:31] op_sel:[0,0] op_sel_hi:[1,0]
    v_cvt_pk_bf16_f32 v32, v14, v15
    v_lshlrev_b32 v14, 16, v32
    v_and_b32 v15, 0xffff0000, v32
    v_cvt_pk_bf16_f32 v32, v16, v17
    v_lshlrev_b32 v16, 16, v32
    v_and_b32 v17, 0xffff0000, v32
    v_cvt_pk_bf16_f32 v32, v18, v19
    v_lshlrev_b32 v18, 16, v32
    v_and_b32 v19, 0xffff0000, v32
    v_cvt_pk_bf16_f32 v32, v20, v21
    v_lshlrev_b32 v20, 16, v32
    v_and_b32 v21, 0xffff0000, v32
    v_cvt_pk_bf16_f32 v32, v22, v23
    v_lshlrev_b32 v22, 16, v32
    v_and_b32 v23, 0xffff0000, v32
    v_cvt_pk_bf16_f32 v32, v24, v25
    v_lshlrev_b32 v24, 16, v32
    v_and_b32 v25, 0xffff0000, v32
    v_cvt_pk_bf16_f32 v32, v26, v27
    v_lshlrev_b32 v26, 16, v32
    v_and_b32 v27, 0xffff0000, v32
    v_cvt_pk_bf16_f32 v32, v28, v29
    v_lshlrev_b32 v28, 16, v32
    v_and_b32 v29, 0xffff0000, v32
    v_pk_mul_f32 v[14:15], v[14:15], v[30:31] op_sel:[0,1] op_sel_hi:[1,1]
    v_pk_mul_f32 v[16:17], v[16:17], v[30:31] op_sel:[0,1] op_sel_hi:[1,1]
    v_pk_mul_f32 v[18:19], v[18:19], v[30:31] op_sel:[0,1] op_sel_hi:[1,1]
    v_pk_mul_f32 v[20:21], v[20:21], v[30:31] op_sel:[0,1] op_sel_hi:[1,1]
    v_pk_mul_f32 v[22:23], v[22:23], v[30:31] op_sel:[0,1] op_sel_hi:[1,1]
    v_pk_mul_f32 v[24:25], v[24:25], v[30:31] op_sel:[0,1] op_sel_hi:[1,1]
    v_pk_mul_f32 v[26:27], v[26:27], v[30:31] op_sel:[0,1] op_sel_hi:[1,1]
    v_pk_mul_f32 v[28:29], v[28:29], v[30:31] op_sel:[0,1] op_sel_hi:[1,1]
    v_exp_f32 v14, -v14
    v_exp_f32 v15, -v15
    v_exp_f32 v16, -v16
    v_exp_f32 v17, -v17
    v_exp_f32 v18, -v18
    v_exp_f32 v19, -v19
    v_exp_f32 v20, -v20
    v_exp_f32 v21, -v21
    v_exp_f32 v22, -v22
    v_exp_f32 v23, -v23
    v_exp_f32 v24, -v24
    v_exp_f32 v25, -v25
    v_exp_f32 v26, -v26
    v_exp_f32 v27, -v27
    v_exp_f32 v28, -v28
    v_exp_f32 v29, -v29
    v_cvt_pk_bf16_f32 v14, v14, v16
    v_cvt_pk_bf16_f32 v15, v15, v17
    v_cvt_pk_bf16_f32 v18, v18, v20
    v_cvt_pk_bf16_f32 v19, v19, v21
    v_cvt_pk_bf16_f32 v22, v22, v24
    v_cvt_pk_bf16_f32 v23, v23, v25
    v_cvt_pk_bf16_f32 v26, v26, v28
    v_cvt_pk_bf16_f32 v27, v27, v29
    v_dot2_f32_bf16 v72, v14, s68, 0
    v_dot2_f32_bf16 v73, v15, s68, 0
    v_dot2_f32_bf16 v74, v14, s69, 0
    v_dot2_f32_bf16 v75, v15, s69, 0
    v_dot2_f32_bf16 v76, v14, s70, 0
    v_dot2_f32_bf16 v77, v15, s70, 0
    v_dot2_f32_bf16 v78, v14, s71, 0
    v_dot2_f32_bf16 v79, v15, s71, 0
    v_dot2_f32_bf16 v80, v14, s52, 0
    v_dot2_f32_bf16 v81, v15, s52, 0
    v_dot2_f32_bf16 v82, v14, s53, 0
    v_dot2_f32_bf16 v83, v15, s53, 0
    v_dot2_f32_bf16 v84, v14, s54, 0
    v_dot2_f32_bf16 v85, v15, s54, 0
    v_dot2_f32_bf16 v86, v14, s55, 0
    v_dot2_f32_bf16 v87, v15, s55, 0
    v_dot2_f32_bf16 v72, v18, s72, v72
    v_dot2_f32_bf16 v73, v19, s72, v73
    v_dot2_f32_bf16 v74, v18, s73, v74
    v_dot2_f32_bf16 v75, v19, s73, v75
    v_dot2_f32_bf16 v76, v18, s74, v76
    v_dot2_f32_bf16 v77, v19, s74, v77
    v_dot2_f32_bf16 v78, v18, s75, v78
    v_dot2_f32_bf16 v79, v19, s75, v79
    v_dot2_f32_bf16 v80, v18, s56, v80
    v_dot2_f32_bf16 v81, v19, s56, v81
    v_dot2_f32_bf16 v82, v18, s57, v82
    v_dot2_f32_bf16 v83, v19, s57, v83
    v_dot2_f32_bf16 v84, v18, s58, v84
    v_dot2_f32_bf16 v85, v19, s58, v85
    v_dot2_f32_bf16 v86, v18, s59, v86
    v_dot2_f32_bf16 v87, v19, s59, v87
    v_dot2_f32_bf16 v72, v22, s76, v72
    v_dot2_f32_bf16 v73, v23, s76, v73
    v_dot2_f32_bf16 v74, v22, s77, v74
    v_dot2_f32_bf16 v75, v23, s77, v75
    v_dot2_f32_bf16 v76, v22, s78, v76
    v_dot2_f32_bf16 v77, v23, s78, v77
    v_dot2_f32_bf16 v78, v22, s79, v78
    v_dot2_f32_bf16 v79, v23, s79, v79
    v_dot2_f32_bf16 v80, v22, s60, v80
    v_dot2_f32_bf16 v81, v23, s60, v81
    v_dot2_f32_bf16 v82, v22, s61, v82
    v_dot2_f32_bf16 v83, v23, s61, v83
    v_dot2_f32_bf16 v84, v22, s62, v84
    v_dot2_f32_bf16 v85, v23, s62, v85
    v_dot2_f32_bf16 v86, v22, s63, v86
    v_dot2_f32_bf16 v87, v23, s63, v87
    v_dot2_f32_bf16 v72, v26, s80, v72
    v_dot2_f32_bf16 v73, v27, s80, v73
    v_dot2_f32_bf16 v74, v26, s81, v74
    v_dot2_f32_bf16 v75, v27, s81, v75
    v_dot2_f32_bf16 v76, v26, s82, v76
    v_dot2_f32_bf16 v77, v27, s82, v77
    v_dot2_f32_bf16 v78, v26, s83, v78
    v_dot2_f32_bf16 v79, v27, s83, v79
    v_dot2_f32_bf16 v80, v26, s64, v80
    v_dot2_f32_bf16 v81, v27, s64, v81
    v_dot2_f32_bf16 v82, v26, s65, v82
    v_dot2_f32_bf16 v83, v27, s65, v83
    v_dot2_f32_bf16 v84, v26, s66, v84
    v_dot2_f32_bf16 v85, v27, s66, v85
    v_dot2_f32_bf16 v86, v26, s67, v86
    v_dot2_f32_bf16 v87, v27, s67, v87
L_p2_ga:
    ds_read_b32 v9, v8
    ds_read_b128 v[88:91], v1 offset:0
    ds_read_b128 v[92:95], v1 offset:16384
    ds_read_b128 v[96:99], v1 offset:32768
    ds_read_b128 v[100:103], v1 offset:49152
    ds_read_b128 v[104:107], v6
    s_mul_i32 s14, s12, 5120000
    s_mul_i32 s15, s3, 80000
    s_add_u32 s25, s14, s15
    s_add_u32 s25, s25, 259990016
    s_waitcnt lgkmcnt(5)
    v_readfirstlane_b32 s21, v9
    s_nop 0
    s_bfe_u32 s21, s21, 524296
    s_cmp_lg_u32 s21, 4
    s_cselect_b32 s21, 1, 0
    s_cselect_b32 s24, 0, 20000
    v_cmp_le_u32 vcc, s24, v10
    v_add_u32 v10, 16384, v10
    s_add_u32 s14, s25, 0
    v_cndmask_b32 v12, v11, v1, vcc
    s_waitcnt lgkmcnt(4)
    buffer_store_dwordx4 v[88:91], v12, s[4:7], s14 offen sc1
    v_or3_b32 v4, v88, v89, v4
    v_or3_b32 v4, v90, v91, v4
    v_cmp_le_u32 vcc, s24, v10
    v_add_u32 v10, 16384, v10
    s_add_u32 s14, s25, 16384
    v_cndmask_b32 v12, v11, v1, vcc
    s_waitcnt lgkmcnt(3)
    buffer_store_dwordx4 v[92:95], v12, s[4:7], s14 offen sc1
    v_or3_b32 v4, v92, v93, v4
    v_or3_b32 v4, v94, v95, v4
    v_cmp_le_u32 vcc, s24, v10
    v_add_u32 v10, 16384, v10
    s_add_u32 s14, s25, 32768
    v_cndmask_b32 v12, v11, v1, vcc
    s_waitcnt lgkmcnt(2)
    buffer_store_dwordx4 v[96:99], v12, s[4:7], s14 offen sc1
    v_or3_b32 v4, v96, v97, v4
    v_or3_b32 v4, v98, v99, v4
    v_cmp_le_u32 vcc, s24, v10
    v_add_u32 v10, 16384, v10
    s_add_u32 s14, s25, 49152
    v_cndmask_b32 v12, v11, v1, vcc
    s_waitcnt lgkmcnt(1)
    buffer_store_dwordx4 v[100:103], v12, s[4:7], s14 offen sc1
    v_or3_b32 v4, v100, v101, v4
    v_or3_b32 v4, v102, v103, v4
    v_cmp_le_u32 vcc, s24, v10
    v_add_u32 v10, 16384, v10
    s_add_u32 s14, s25, 0
    v_cndmask_b32 v12, v11, v6, vcc
    s_waitcnt lgkmcnt(0)
    buffer_store_dwordx4 v[104:107], v12, s[4:7], s14 offen sc1
    v_or3_b32 v4, v104, v105, v4
    v_or3_b32 v4, v106, v107, v4
    s_load_dwordx2 s[16:17], s[0:1], 88
    s_cmp_ge_u32 s13, 4
    s_cbranch_scc1 L_p2_gb
    v_lshlrev_b32 v30, 16, v60
    v_and_b32 v31, 0xffff0000, v60
    v_lshlrev_b32 v36, 16, v53
    v_and_b32 v37, 0xffff0000, v53
    v_lshlrev_b32 v38, 16, v54
    v_and_b32 v39, 0xffff0000, v54
    v_lshlrev_b32 v40, 16, v56
    v_and_b32 v41, 0xffff0000, v56
    v_lshlrev_b32 v42, 16, v57
    v_and_b32 v43, 0xffff0000, v57
    v_pk_add_f32 v[14:15], v[30:31], v[36:37] op_sel:[0,0] op_sel_hi:[1,0] neg_lo:[0,1] neg_hi:[0,1]
    v_pk_add_f32 v[16:17], v[30:31], v[36:37] op_sel:[0,1] op_sel_hi:[1,1] neg_lo:[0,1] neg_hi:[0,1]
    v_pk_add_f32 v[18:19], v[30:31], v[38:39] op_sel:[0,0] op_sel_hi:[1,0] neg_lo:[0,1] neg_hi:[0,1]
    v_pk_add_f32 v[20:21], v[30:31], v[38:39] op_sel:[0,1] op_sel_hi:[1,1] neg_lo:[0,1] neg_hi:[0,1]
    v_pk_add_f32 v[22:23], v[30:31], v[40:41] op_sel:[0,0] op_sel_hi:[1,0] neg_lo:[0,1] neg_hi:[0,1]
    v_pk_add_f32 v[24:25], v[30:31], v[40:41] op_sel:[0,1] op_sel_hi:[1,1] neg_lo:[0,1] neg_hi:[0,1]
    v_pk_add_f32 v[26:27], v[30:31], v[42:43] op_sel:[0,0] op_sel_hi:[1,0] neg_lo:[0,1] neg_hi:[0,1]
    v_pk_add_f32 v[28:29], v[30:31], v[42:43] op_sel:[0,1] op_sel_hi:[1,1] neg_lo:[0,1] neg_hi:[0,1]
    v_cvt_pk_bf16_f32 v32, v14, v15
    v_lshlrev_b32 v14, 16, v32
    v_and_b32 v15, 0xffff0000, v32
    v_cvt_pk_bf16_f32 v32, v16, v17
    v_lshlrev_b32 v16, 16, v32
    v_and_b32 v17, 0xffff0000, v32
    v_cvt_pk_bf16_f32 v32, v18, v19
    v_lshlrev_b32 v18, 16, v32
    v_and_b32 v19, 0xffff0000, v32
    v_cvt_pk_bf16_f32 v32, v20, v21
    v_lshlrev_b32 v20, 16, v32
    v_and_b32 v21, 0xffff0000, v32
    v_cvt_pk_bf16_f32 v32, v22, v23
    v_lshlrev_b32 v22, 16, v32
    v_and_b32 v23, 0xffff0000, v32
    v_cvt_pk_bf16_f32 v32, v24, v25
    v_lshlrev_b32 v24, 16, v32
    v_and_b32 v25, 0xffff0000, v32
    v_cvt_pk_bf16_f32 v32, v26, v27
    v_lshlrev_b32 v26, 16, v32
    v_and_b32 v27, 0xffff0000, v32
    v_cvt_pk_bf16_f32 v32, v28, v29
    v_lshlrev_b32 v28, 16, v32
    v_and_b32 v29, 0xffff0000, v32
    v_pk_mul_f32 v[14:15], v[14:15], v[14:15]
    v_pk_mul_f32 v[16:17], v[16:17], v[16:17]
    v_pk_mul_f32 v[18:19], v[18:19], v[18:19]
    v_pk_mul_f32 v[20:21], v[20:21], v[20:21]
    v_pk_mul_f32 v[22:23], v[22:23], v[22:23]
    v_pk_mul_f32 v[24:25], v[24:25], v[24:25]
    v_pk_mul_f32 v[26:27], v[26:27], v[26:27]
    v_pk_mul_f32 v[28:29], v[28:29], v[28:29]
    v_cvt_pk_bf16_f32 v32, v14, v15
    v_lshlrev_b32 v14, 16, v32
    v_and_b32 v15, 0xffff0000, v32
    v_cvt_pk_bf16_f32 v32, v16, v17
    v_lshlrev_b32 v16, 16, v32
    v_and_b32 v17, 0xffff0000, v32
    v_cvt_pk_bf16_f32 v32, v18, v19
    v_lshlrev_b32 v18, 16, v32
    v_and_b32 v19, 0xffff0000, v32
    v_cvt_pk_bf16_f32 v32, v20, v21
    v_lshlrev_b32 v20, 16, v32
    v_and_b32 v21, 0xffff0000, v32
    v_cvt_pk_bf16_f32 v32, v22, v23
    v_lshlrev_b32 v22, 16, v32
    v_and_b32 v23, 0xffff0000, v32
    v_cvt_pk_bf16_f32 v32, v24, v25
    v_lshlrev_b32 v24, 16, v32
    v_and_b32 v25, 0xffff0000, v32
    v_cvt_pk_bf16_f32 v32, v26, v27
    v_lshlrev_b32 v26, 16, v32
    v_and_b32 v27, 0xffff0000, v32
    v_cvt_pk_bf16_f32 v32, v28, v29
    v_lshlrev_b32 v28, 16, v32
    v_and_b32 v29, 0xffff0000, v32
    v_mov_b32 v30, 1092616192
    v_mov_b32 v31, 0x3fb8aa3b
    v_pk_mul_f32 v[14:15], v[14:15], v[30:31] op_sel:[0,0] op_sel_hi:[1,0]
    v_pk_mul_f32 v[16:17], v[16:17], v[30:31] op_sel:[0,0] op_sel_hi:[1,0]
    v_pk_mul_f32 v[18:19], v[18:19], v[30:31] op_sel:[0,0] op_sel_hi:[1,0]
    v_pk_mul_f32 v[20:21], v[20:21], v[30:31] op_sel:[0,0] op_sel_hi:[1,0]
    v_pk_mul_f32 v[22:23], v[22:23], v[30:31] op_sel:[0,0] op_sel_hi:[1,0]
    v_pk_mul_f32 v[24:25], v[24:25], v[30:31] op_sel:[0,0] op_sel_hi:[1,0]
    v_pk_mul_f32 v[26:27], v[26:27], v[30:31] op_sel:[0,0] op_sel_hi:[1,0]
    v_pk_mul_f32 v[28:29], v[28:29], v[30:31] op_sel:[0,0] op_sel_hi:[1,0]
    v_cvt_pk_bf16_f32 v32, v14, v15
    v_lshlrev_b32 v14, 16, v32
    v_and_b32 v15, 0xffff0000, v32
    v_cvt_pk_bf16_f32 v32, v16, v17
    v_lshlrev_b32 v16, 16, v32
    v_and_b32 v17, 0xffff0000, v32
    v_cvt_pk_bf16_f32 v32, v18, v19
    v_lshlrev_b32 v18, 16, v32
    v_and_b32 v19, 0xffff0000, v32
    v_cvt_pk_bf16_f32 v32, v20, v21
    v_lshlrev_b32 v20, 16, v32
    v_and_b32 v21, 0xffff0000, v32
    v_cvt_pk_bf16_f32 v32, v22, v23
    v_lshlrev_b32 v22, 16, v32
    v_and_b32 v23, 0xffff0000, v32
    v_cvt_pk_bf16_f32 v32, v24, v25
    v_lshlrev_b32 v24, 16, v32
    v_and_b32 v25, 0xffff0000, v32
    v_cvt_pk_bf16_f32 v32, v26, v27
    v_lshlrev_b32 v26, 16, v32
    v_and_b32 v27, 0xffff0000, v32
    v_cvt_pk_bf16_f32 v32, v28, v29
    v_lshlrev_b32 v28, 16, v32
    v_and_b32 v29, 0xffff0000, v32
    v_pk_mul_f32 v[14:15], v[14:15], v[30:31] op_sel:[0,1] op_sel_hi:[1,1]
    v_pk_mul_f32 v[16:17], v[16:17], v[30:31] op_sel:[0,1] op_sel_hi:[1,1]
    v_pk_mul_f32 v[18:19], v[18:19], v[30:31] op_sel:[0,1] op_sel_hi:[1,1]
    v_pk_mul_f32 v[20:21], v[20:21], v[30:31] op_sel:[0,1] op_sel_hi:[1,1]
    v_pk_mul_f32 v[22:23], v[22:23], v[30:31] op_sel:[0,1] op_sel_hi:[1,1]
    v_pk_mul_f32 v[24:25], v[24:25], v[30:31] op_sel:[0,1] op_sel_hi:[1,1]
    v_pk_mul_f32 v[26:27], v[26:27], v[30:31] op_sel:[0,1] op_sel_hi:[1,1]
    v_pk_mul_f32 v[28:29], v[28:29], v[30:31] op_sel:[0,1] op_sel_hi:[1,1]
    v_exp_f32 v14, -v14
    v_exp_f32 v15, -v15
    v_exp_f32 v16, -v16
    v_exp_f32 v17, -v17
    v_exp_f32 v18, -v18
    v_exp_f32 v19, -v19
    v_exp_f32 v20, -v20
    v_exp_f32 v21, -v21
    v_exp_f32 v22, -v22
    v_exp_f32 v23, -v23
    v_exp_f32 v24, -v24
    v_exp_f32 v25, -v25
    v_exp_f32 v26, -v26
    v_exp_f32 v27, -v27
    v_exp_f32 v28, -v28
    v_exp_f32 v29, -v29
    v_cvt_pk_bf16_f32 v14, v14, v16
    v_cvt_pk_bf16_f32 v15, v15, v17
    v_cvt_pk_bf16_f32 v18, v18, v20
    v_cvt_pk_bf16_f32 v19, v19, v21
    v_cvt_pk_bf16_f32 v22, v22, v24
    v_cvt_pk_bf16_f32 v23, v23, v25
    v_cvt_pk_bf16_f32 v26, v26, v28
    v_cvt_pk_bf16_f32 v27, v27, v29
    v_dot2_f32_bf16 v72, v14, s68, 0
    v_dot2_f32_bf16 v73, v15, s68, 0
    v_dot2_f32_bf16 v74, v14, s69, 0
    v_dot2_f32_bf16 v75, v15, s69, 0
    v_dot2_f32_bf16 v76, v14, s70, 0
    v_dot2_f32_bf16 v77, v15, s70, 0
    v_dot2_f32_bf16 v78, v14, s71, 0
    v_dot2_f32_bf16 v79, v15, s71, 0
    v_dot2_f32_bf16 v80, v14, s52, 0
    v_dot2_f32_bf16 v81, v15, s52, 0
    v_dot2_f32_bf16 v82, v14, s53, 0
    v_dot2_f32_bf16 v83, v15, s53, 0
    v_dot2_f32_bf16 v84, v14, s54, 0
    v_dot2_f32_bf16 v85, v15, s54, 0
    v_dot2_f32_bf16 v86, v14, s55, 0
    v_dot2_f32_bf16 v87, v15, s55, 0
    v_dot2_f32_bf16 v72, v18, s72, v72
    v_dot2_f32_bf16 v73, v19, s72, v73
    v_dot2_f32_bf16 v74, v18, s73, v74
    v_dot2_f32_bf16 v75, v19, s73, v75
    v_dot2_f32_bf16 v76, v18, s74, v76
    v_dot2_f32_bf16 v77, v19, s74, v77
    v_dot2_f32_bf16 v78, v18, s75, v78
    v_dot2_f32_bf16 v79, v19, s75, v79
    v_dot2_f32_bf16 v80, v18, s56, v80
    v_dot2_f32_bf16 v81, v19, s56, v81
    v_dot2_f32_bf16 v82, v18, s57, v82
    v_dot2_f32_bf16 v83, v19, s57, v83
    v_dot2_f32_bf16 v84, v18, s58, v84
    v_dot2_f32_bf16 v85, v19, s58, v85
    v_dot2_f32_bf16 v86, v18, s59, v86
    v_dot2_f32_bf16 v87, v19, s59, v87
    v_dot2_f32_bf16 v72, v22, s76, v72
    v_dot2_f32_bf16 v73, v23, s76, v73
    v_dot2_f32_bf16 v74, v22, s77, v74
    v_dot2_f32_bf16 v75, v23, s77, v75
    v_dot2_f32_bf16 v76, v22, s78, v76
    v_dot2_f32_bf16 v77, v23, s78, v77
    v_dot2_f32_bf16 v78, v22, s79, v78
    v_dot2_f32_bf16 v79, v23, s79, v79
    v_dot2_f32_bf16 v80, v22, s60, v80
    v_dot2_f32_bf16 v81, v23, s60, v81
    v_dot2_f32_bf16 v82, v22, s61, v82
    v_dot2_f32_bf16 v83, v23, s61, v83
    v_dot2_f32_bf16 v84, v22, s62, v84
    v_dot2_f32_bf16 v85, v23, s62, v85
    v_dot2_f32_bf16 v86, v22, s63, v86
    v_dot2_f32_bf16 v87, v23, s63, v87
    v_dot2_f32_bf16 v72, v26, s80, v72
    v_dot2_f32_bf16 v73, v27, s80, v73
    v_dot2_f32_bf16 v74, v26, s81, v74
    v_dot2_f32_bf16 v75, v27, s81, v75
    v_dot2_f32_bf16 v76, v26, s82, v76
    v_dot2_f32_bf16 v77, v27, s82, v77
    v_dot2_f32_bf16 v78, v26, s83, v78
    v_dot2_f32_bf16 v79, v27, s83, v79
    v_dot2_f32_bf16 v80, v26, s64, v80
    v_dot2_f32_bf16 v81, v27, s64, v81
    v_dot2_f32_bf16 v82, v26, s65, v82
    v_dot2_f32_bf16 v83, v27, s65, v83
    v_dot2_f32_bf16 v84, v26, s66, v84
    v_dot2_f32_bf16 v85, v27, s66, v85
    v_dot2_f32_bf16 v86, v26, s67, v86
    v_dot2_f32_bf16 v87, v27, s67, v87
    s_cmp_ge_u32 s13, 4
    s_cbranch_scc1 L_p2_kernel_g1_6
    v_lshlrev_b32 v30, 16, v61
    v_and_b32 v31, 0xffff0000, v61
    v_pk_add_f32 v[14:15], v[30:31], v[36:37] op_sel:[0,0] op_sel_hi:[1,0] neg_lo:[0,1] neg_hi:[0,1]
    v_pk_add_f32 v[16:17], v[30:31], v[36:37] op_sel:[0,1] op_sel_hi:[1,1] neg_lo:[0,1] neg_hi:[0,1]
    v_pk_add_f32 v[18:19], v[30:31], v[38:39] op_sel:[0,0] op_sel_hi:[1,0] neg_lo:[0,1] neg_hi:[0,1]
    v_pk_add_f32 v[20:21], v[30:31], v[38:39] op_sel:[0,1] op_sel_hi:[1,1] neg_lo:[0,1] neg_hi:[0,1]
    v_pk_add_f32 v[22:23], v[30:31], v[40:41] op_sel:[0,0] op_sel_hi:[1,0] neg_lo:[0,1] neg_hi:[0,1]
    v_pk_add_f32 v[24:25], v[30:31], v[40:41] op_sel:[0,1] op_sel_hi:[1,1] neg_lo:[0,1] neg_hi:[0,1]
    v_pk_add_f32 v[26:27], v[30:31], v[42:43] op_sel:[0,0] op_sel_hi:[1,0] neg_lo:[0,1] neg_hi:[0,1]
    v_pk_add_f32 v[28:29], v[30:31], v[42:43] op_sel:[0,1] op_sel_hi:[1,1] neg_lo:[0,1] neg_hi:[0,1]
    v_cvt_pk_bf16_f32 v32, v14, v15
    v_lshlrev_b32 v14, 16, v32
    v_and_b32 v15, 0xffff0000, v32
    v_cvt_pk_bf16_f32 v32, v16, v17
    v_lshlrev_b32 v16, 16, v32
    v_and_b32 v17, 0xffff0000, v32
    v_cvt_pk_bf16_f32 v32, v18, v19
    v_lshlrev_b32 v18, 16, v32
    v_and_b32 v19, 0xffff0000, v32
    v_cvt_pk_bf16_f32 v32, v20, v21
    v_lshlrev_b32 v20, 16, v32
    v_and_b32 v21, 0xffff0000, v32
    v_cvt_pk_bf16_f32 v32, v22, v23
    v_lshlrev_b32 v22, 16, v32
    v_and_b32 v23, 0xffff0000, v32
    v_cvt_pk_bf16_f32 v32, v24, v25
    v_lshlrev_b32 v24, 16, v32
    v_and_b32 v25, 0xffff0000, v32
    v_cvt_pk_bf16_f32 v32, v26, v27
    v_lshlrev_b32 v26, 16, v32
    v_and_b32 v27, 0xffff0000, v32
    v_cvt_pk_bf16_f32 v32, v28, v29
    v_lshlrev_b32 v28, 16, v32
    v_and_b32 v29, 0xffff0000, v32
    v_pk_mul_f32 v[14:15], v[14:15], v[14:15]
    v_pk_mul_f32 v[16:17], v[16:17], v[16:17]
    v_pk_mul_f32 v[18:19], v[18:19], v[18:19]
    v_pk_mul_f32 v[20:21], v[20:21], v[20:21]
    v_pk_mul_f32 v[22:23], v[22:23], v[22:23]
    v_pk_mul_f32 v[24:25], v[24:25], v[24:25]
    v_pk_mul_f32 v[26:27], v[26:27], v[26:27]
    v_pk_mul_f32 v[28:29], v[28:29], v[28:29]
    v_cvt_pk_bf16_f32 v32, v14, v15
    v_lshlrev_b32 v14, 16, v32
    v_and_b32 v15, 0xffff0000, v32
    v_cvt_pk_bf16_f32 v32, v16, v17
    v_lshlrev_b32 v16, 16, v32
    v_and_b32 v17, 0xffff0000, v32
    v_cvt_pk_bf16_f32 v32, v18, v19
    v_lshlrev_b32 v18, 16, v32
    v_and_b32 v19, 0xffff0000, v32
    v_cvt_pk_bf16_f32 v32, v20, v21
    v_lshlrev_b32 v20, 16, v32
    v_and_b32 v21, 0xffff0000, v32
    v_cvt_pk_bf16_f32 v32, v22, v23
    v_lshlrev_b32 v22, 16, v32
    v_and_b32 v23, 0xffff0000, v32
    v_cvt_pk_bf16_f32 v32, v24, v25
    v_lshlrev_b32 v24, 16, v32
    v_and_b32 v25, 0xffff0000, v32
    v_cvt_pk_bf16_f32 v32, v26, v27
    v_lshlrev_b32 v26, 16, v32
    v_and_b32 v27, 0xffff0000, v32
    v_cvt_pk_bf16_f32 v32, v28, v29
    v_lshlrev_b32 v28, 16, v32
    v_and_b32 v29, 0xffff0000, v32
    v_mov_b32 v30, 1092616192
    v_mov_b32 v31, 0x3fb8aa3b
    v_pk_mul_f32 v[14:15], v[14:15], v[30:31] op_sel:[0,0] op_sel_hi:[1,0]
    v_pk_mul_f32 v[16:17], v[16:17], v[30:31] op_sel:[0,0] op_sel_hi:[1,0]
    v_pk_mul_f32 v[18:19], v[18:19], v[30:31] op_sel:[0,0] op_sel_hi:[1,0]
    v_pk_mul_f32 v[20:21], v[20:21], v[30:31] op_sel:[0,0] op_sel_hi:[1,0]
    v_pk_mul_f32 v[22:23], v[22:23], v[30:31] op_sel:[0,0] op_sel_hi:[1,0]
    v_pk_mul_f32 v[24:25], v[24:25], v[30:31] op_sel:[0,0] op_sel_hi:[1,0]
    v_pk_mul_f32 v[26:27], v[26:27], v[30:31] op_sel:[0,0] op_sel_hi:[1,0]
    v_pk_mul_f32 v[28:29], v[28:29], v[30:31] op_sel:[0,0] op_sel_hi:[1,0]
    v_cvt_pk_bf16_f32 v32, v14, v15
    v_lshlrev_b32 v14, 16, v32
    v_and_b32 v15, 0xffff0000, v32
    v_cvt_pk_bf16_f32 v32, v16, v17
    v_lshlrev_b32 v16, 16, v32
    v_and_b32 v17, 0xffff0000, v32
    v_cvt_pk_bf16_f32 v32, v18, v19
    v_lshlrev_b32 v18, 16, v32
    v_and_b32 v19, 0xffff0000, v32
    v_cvt_pk_bf16_f32 v32, v20, v21
    v_lshlrev_b32 v20, 16, v32
    v_and_b32 v21, 0xffff0000, v32
    v_cvt_pk_bf16_f32 v32, v22, v23
    v_lshlrev_b32 v22, 16, v32
    v_and_b32 v23, 0xffff0000, v32
    v_cvt_pk_bf16_f32 v32, v24, v25
    v_lshlrev_b32 v24, 16, v32
    v_and_b32 v25, 0xffff0000, v32
    v_cvt_pk_bf16_f32 v32, v26, v27
    v_lshlrev_b32 v26, 16, v32
    v_and_b32 v27, 0xffff0000, v32
    v_cvt_pk_bf16_f32 v32, v28, v29
    v_lshlrev_b32 v28, 16, v32
    v_and_b32 v29, 0xffff0000, v32
    v_pk_mul_f32 v[14:15], v[14:15], v[30:31] op_sel:[0,1] op_sel_hi:[1,1]
    v_pk_mul_f32 v[16:17], v[16:17], v[30:31] op_sel:[0,1] op_sel_hi:[1,1]
    v_pk_mul_f32 v[18:19], v[18:19], v[30:31] op_sel:[0,1] op_sel_hi:[1,1]
    v_pk_mul_f32 v[20:21], v[20:21], v[30:31] op_sel:[0,1] op_sel_hi:[1,1]
    v_pk_mul_f32 v[22:23], v[22:23], v[30:31] op_sel:[0,1] op_sel_hi:[1,1]
    v_pk_mul_f32 v[24:25], v[24:25], v[30:31] op_sel:[0,1] op_sel_hi:[1,1]
    v_pk_mul_f32 v[26:27], v[26:27], v[30:31] op_sel:[0,1] op_sel_hi:[1,1]
    v_pk_mul_f32 v[28:29], v[28:29], v[30:31] op_sel:[0,1] op_sel_hi:[1,1]
    v_exp_f32 v14, -v14
    v_exp_f32 v15, -v15
    v_exp_f32 v16, -v16
    v_exp_f32 v17, -v17
    v_exp_f32 v18, -v18
    v_exp_f32 v19, -v19
    v_exp_f32 v20, -v20
    v_exp_f32 v21, -v21
    v_exp_f32 v22, -v22
    v_exp_f32 v23, -v23
    v_exp_f32 v24, -v24
    v_exp_f32 v25, -v25
    v_exp_f32 v26, -v26
    v_exp_f32 v27, -v27
    v_exp_f32 v28, -v28
    v_exp_f32 v29, -v29
    v_cvt_pk_bf16_f32 v14, v14, v16
    v_cvt_pk_bf16_f32 v15, v15, v17
    v_cvt_pk_bf16_f32 v18, v18, v20
    v_cvt_pk_bf16_f32 v19, v19, v21
    v_cvt_pk_bf16_f32 v22, v22, v24
    v_cvt_pk_bf16_f32 v23, v23, v25
    v_cvt_pk_bf16_f32 v26, v26, v28
    v_cvt_pk_bf16_f32 v27, v27, v29
    v_dot2_f32_bf16 v112, v14, s68, 0
    v_dot2_f32_bf16 v113, v15, s68, 0
    v_dot2_f32_bf16 v114, v14, s69, 0
    v_dot2_f32_bf16 v115, v15, s69, 0
    v_dot2_f32_bf16 v116, v14, s70, 0
    v_dot2_f32_bf16 v117, v15, s70, 0
    v_dot2_f32_bf16 v118, v14, s71, 0
    v_dot2_f32_bf16 v119, v15, s71, 0
    v_dot2_f32_bf16 v120, v14, s52, 0
    v_dot2_f32_bf16 v121, v15, s52, 0
    v_dot2_f32_bf16 v122, v14, s53, 0
    v_dot2_f32_bf16 v123, v15, s53, 0
    v_dot2_f32_bf16 v124, v14, s54, 0
    v_dot2_f32_bf16 v125, v15, s54, 0
    v_dot2_f32_bf16 v126, v14, s55, 0
    v_dot2_f32_bf16 v127, v15, s55, 0
    v_dot2_f32_bf16 v112, v18, s72, v112
    v_dot2_f32_bf16 v113, v19, s72, v113
    v_dot2_f32_bf16 v114, v18, s73, v114
    v_dot2_f32_bf16 v115, v19, s73, v115
    v_dot2_f32_bf16 v116, v18, s74, v116
    v_dot2_f32_bf16 v117, v19, s74, v117
    v_dot2_f32_bf16 v118, v18, s75, v118
    v_dot2_f32_bf16 v119, v19, s75, v119
    v_dot2_f32_bf16 v120, v18, s56, v120
    v_dot2_f32_bf16 v121, v19, s56, v121
    v_dot2_f32_bf16 v122, v18, s57, v122
    v_dot2_f32_bf16 v123, v19, s57, v123
    v_dot2_f32_bf16 v124, v18, s58, v124
    v_dot2_f32_bf16 v125, v19, s58, v125
    v_dot2_f32_bf16 v126, v18, s59, v126
    v_dot2_f32_bf16 v127, v19, s59, v127
    v_dot2_f32_bf16 v112, v22, s76, v112
    v_dot2_f32_bf16 v113, v23, s76, v113
    v_dot2_f32_bf16 v114, v22, s77, v114
    v_dot2_f32_bf16 v115, v23, s77, v115
    v_dot2_f32_bf16 v116, v22, s78, v116
    v_dot2_f32_bf16 v117, v23, s78, v117
    v_dot2_f32_bf16 v118, v22, s79, v118
    v_dot2_f32_bf16 v119, v23, s79, v119
    v_dot2_f32_bf16 v120, v22, s60, v120
    v_dot2_f32_bf16 v121, v23, s60, v121
    v_dot2_f32_bf16 v122, v22, s61, v122
    v_dot2_f32_bf16 v123, v23, s61, v123
    v_dot2_f32_bf16 v124, v22, s62, v124
    v_dot2_f32_bf16 v125, v23, s62, v125
    v_dot2_f32_bf16 v126, v22, s63, v126
    v_dot2_f32_bf16 v127, v23, s63, v127
    v_dot2_f32_bf16 v112, v26, s80, v112
    v_dot2_f32_bf16 v113, v27, s80, v113
    v_dot2_f32_bf16 v114, v26, s81, v114
    v_dot2_f32_bf16 v115, v27, s81, v115
    v_dot2_f32_bf16 v116, v26, s82, v116
    v_dot2_f32_bf16 v117, v27, s82, v117
    v_dot2_f32_bf16 v118, v26, s83, v118
    v_dot2_f32_bf16 v119, v27, s83, v119
    v_dot2_f32_bf16 v120, v26, s64, v120
    v_dot2_f32_bf16 v121, v27, s64, v121
    v_dot2_f32_bf16 v122, v26, s65, v122
    v_dot2_f32_bf16 v123, v27, s65, v123
    v_dot2_f32_bf16 v124, v26, s66, v124
    v_dot2_f32_bf16 v125, v27, s66, v125
    v_dot2_f32_bf16 v126, v26, s67, v126
    v_dot2_f32_bf16 v127, v27, s67, v127
L_p2_kernel_g1_6:
L_p2_gb:
    v_and_b32 v4, 0x80008000, v4
    v_cmp_ne_u32 vcc, 0, v4
    v_mov_b32 v8, s27
    v_and_b32 v10, 15, v0
    v_mul_u32_u24 v10, 240, v10
    v_add_u32 v10, 160000, v10
    s_cmp_lg_u64 vcc, 0
    s_cselect_b32 s2, 1, s2
    v_mov_b32 v9, s2
    s_mov_b64 exec, 1
    ds_write_b32 v8, v9
    s_mov_b64 exec, -1
    v_add_u32 v2, 16384, v1
    v_mov_b32 v9, 0x3f000000
    v_cmp_gt_u32 vcc, 226, v0
    s_mov_b32 s49, s12
    s_mov_b32 s51, 0
    v_cndmask_b32 v2, v9, v2, vcc
    s_waitcnt vmcnt(0) lgkmcnt(0)
    s_barrier
    ds_read_b32 v9, v10
    s_mov_b32 s18, 5120000
    s_mov_b32 s19, 0x00020000
    s_waitcnt lgkmcnt(0)
    v_cmp_ne_u32 vcc, 0, v9
    s_nop 1
    s_cmp_lg_u64 vcc, 0
    s_cselect_b32 s2, 1, 0
    s_cbranch_scc1 L_p2_slow
L_p2_signal:
    v_mov_b32 v8, 160228
    s_lshl_b32 s15, s2, 4
    s_or_b32 s15, s15, s21
    s_add_u32 s14, s12, 16
    s_lshl_b32 s20, s15, s14
    s_add_u32 s20, s20, 1
    v_mov_b32 v9, s20
    s_cmp_lg_u32 s13, 15
    s_cbranch_scc1 L_p2_nosig0
    s_lshl_b32 s14, s3, 8
    s_add_u32 s14, s14, 254853632
    s_mov_b64 exec, 1
    buffer_atomic_add v9, off, s[4:7], s14 sc0
    s_mov_b64 exec, -1
L_p2_nosig0:
    s_lshl2_add_u32 s14, s3, s49
    s_mul_i32 s26, s14, 20000
    s_add_u32 s15, s26, 254870016
    buffer_load_dwordx4 v[64:67], v1, s[4:7], s15 offen
    buffer_load_dwordx4 v[68:71], v2, s[4:7], s15 offen
    s_lshl_b32 s28, s92, 16
    s_and_b32 s29, s92, 0xffff0000
    s_lshl_b32 s30, s93, 16
    s_and_b32 s31, s93, 0xffff0000
    s_lshl_b32 s32, s94, 16
    s_and_b32 s33, s94, 0xffff0000
    s_lshl_b32 s34, s95, 16
    s_and_b32 s35, s95, 0xffff0000
    s_lshl_b32 s36, s96, 16
    s_and_b32 s37, s96, 0xffff0000
    s_lshl_b32 s38, s97, 16
    s_and_b32 s39, s97, 0xffff0000
    s_lshl_b32 s40, s98, 16
    s_and_b32 s41, s98, 0xffff0000
    s_lshl_b32 s42, s99, 16
    s_and_b32 s43, s99, 0xffff0000
    s_and_b32 s99, s91, 0xffff0000
    s_lshl_b32 s98, s91, 16
    s_and_b32 s97, s90, 0xffff0000
    s_lshl_b32 s96, s90, 16
    s_and_b32 s95, s89, 0xffff0000
    s_lshl_b32 s94, s89, 16
    s_and_b32 s93, s88, 0xffff0000
    s_lshl_b32 s92, s88, 16
    s_and_b32 s91, s87, 0xffff0000
    s_lshl_b32 s90, s87, 16
    s_and_b32 s89, s86, 0xffff0000
    s_lshl_b32 s88, s86, 16
    s_and_b32 s87, s85, 0xffff0000
    s_lshl_b32 s86, s85, 16
    s_and_b32 s85, s84, 0xffff0000
    s_lshl_b32 s84, s84, 16
    s_mov_b32 s44, s48
    s_add_u32 s45, s48, 2281701376
    s_cmp_eq_u32 s48, 0
    s_cselect_b32 s45, 0, s45
    s_cmp_lg_u32 s13, 15
    s_cbranch_scc1 L_p2_nosig
    s_waitcnt vmcnt(2)
    v_readfirstlane_b32 s15, v9
    s_lshl_b32 s51, 1, s12
    s_add_u32 s20, s20, s15
    s_and_b32 s15, s20, 0xff
    s_cmp_eq_u32 s15, 4
    s_cbranch_scc0 L_p2_notlast
    s_bfe_u32 s15, s20, 262160
    s_or_b32 s51, s51, s15
    s_branch L_p2_pub
L_p2_notlast:
    s_cmp_lg_u32 s21, 0
    s_cselect_b32 s51, 0, s51
    s_cbranch_scc1 L_p2_pub
L_p2_poll:
    v_mov_b32 v9, 0
    s_lshl_b32 s14, s3, 8
    s_add_u32 s14, s14, 254853632
    s_mov_b64 exec, 1
    buffer_atomic_add v9, off, s[4:7], s14 sc0
    s_mov_b64 exec, -1
    s_waitcnt vmcnt(0)
    v_readfirstlane_b32 s20, v9
    s_nop 0
    s_and_b32 s15, s20, 0xff
    s_cmp_lt_u32 s15, 4
    s_cbranch_scc1 L_p2_poll
L_p2_pub:
    s_lshl_b32 s15, s51, 24
    s_or_b32 s15, s15, s20
    v_mov_b32 v9, s15
    s_mov_b64 exec, 1
    ds_write_b32 v8, v9
    s_mov_b64 exec, -1
    s_waitcnt lgkmcnt(0)
L_p2_nosig:
    s_barrier
    ds_read_b32 v9, v8
    s_waitcnt lgkmcnt(0)
    v_readfirstlane_b32 s20, v9
    s_nop 0
    s_lshr_b32 s51, s20, 24
    s_cbranch_scc0 L_p2_end
L_p2_fin:
    s_mul_i32 s24, s49, 20000
    s_add_u32 s14, s12, 1
    s_and_b32 s14, s14, 3
    s_mul_i32 s15, s14, 5120000
    s_add_u32 s15, s15, 259990016
    s_add_u32 s15, s15, s26
    buffer_load_dwordx4 v[12:15], v1, s[4:7], s15 offen sc1
    buffer_load_dwordx4 v[92:95], v2, s[4:7], s15 offen sc1
    s_add_u32 s14, s12, 2
    s_and_b32 s14, s14, 3
    s_mul_i32 s15, s14, 5120000
    s_add_u32 s15, s15, 259990016
    s_add_u32 s15, s15, s26
    buffer_load_dwordx4 v[16:19], v1, s[4:7], s15 offen sc1
    buffer_load_dwordx4 v[96:99], v2, s[4:7], s15 offen sc1
    s_add_u32 s14, s12, 3
    s_and_b32 s14, s14, 3
    s_mul_i32 s15, s14, 5120000
    s_add_u32 s15, s15, 259990016
    s_add_u32 s15, s15, s26
    buffer_load_dwordx4 v[20:23], v1, s[4:7], s15 offen sc1
    buffer_load_dwordx4 v[100:103], v2, s[4:7], s15 offen sc1
    v_add_u32 v24, s24, v1
    ds_read_b128 v[8:11], v24
    v_add_u32 v25, s24, v2
    ds_read_b128 v[88:91], v25
    s_waitcnt vmcnt(0) lgkmcnt(0)
    s_bfe_u32 s14, s20, 262164
    s_cbranch_scc0 L_p2_kernel_nof32a_7
    s_add_u32 s14, s12, 0
    s_and_b32 s14, s14, 3
    s_add_u32 s14, s14, 20
    s_bitcmp1_b32 s20, s14
    s_cbranch_scc0 L_p2_kernel_q_8
    v_mov_b32 v8, 1073758208
    v_mov_b32 v9, 1073758208
    v_mov_b32 v10, 1073758208
    v_mov_b32 v11, 1073758208
L_p2_kernel_q_8:
    s_add_u32 s14, s12, 1
    s_and_b32 s14, s14, 3
    s_add_u32 s14, s14, 20
    s_bitcmp1_b32 s20, s14
    s_cbranch_scc0 L_p2_kernel_q_9
    v_mov_b32 v12, 1073758208
    v_mov_b32 v13, 1073758208
    v_mov_b32 v14, 1073758208
    v_mov_b32 v15, 1073758208
L_p2_kernel_q_9:
    s_add_u32 s14, s12, 2
    s_and_b32 s14, s14, 3
    s_add_u32 s14, s14, 20
    s_bitcmp1_b32 s20, s14
    s_cbranch_scc0 L_p2_kernel_q_10
    v_mov_b32 v16, 1073758208
    v_mov_b32 v17, 1073758208
    v_mov_b32 v18, 1073758208
    v_mov_b32 v19, 1073758208
L_p2_kernel_q_10:
    s_add_u32 s14, s12, 3
    s_and_b32 s14, s14, 3
    s_add_u32 s14, s14, 20
    s_bitcmp1_b32 s20, s14
    s_cbranch_scc0 L_p2_kernel_q_11
    v_mov_b32 v20, 1073758208
    v_mov_b32 v21, 1073758208
    v_mov_b32 v22, 1073758208
    v_mov_b32 v23, 1073758208
L_p2_kernel_q_11:
L_p2_kernel_nof32a_7:
    v_pk_add_u16 v8, v8, v12
    v_pk_add_u16 v16, v16, v20
    v_pk_add_u16 v9, v9, v13
    v_pk_add_u16 v17, v17, v21
    v_pk_add_u16 v10, v10, v14
    v_pk_add_u16 v18, v18, v22
    v_pk_add_u16 v11, v11, v15
    v_pk_add_u16 v19, v19, v23
    v_add_u32_sdwa v24, v8, v16 dst_sel:DWORD dst_unused:UNUSED_PAD src0_sel:WORD_0 src1_sel:WORD_0
    v_add_u32_sdwa v25, v10, v18 dst_sel:DWORD dst_unused:UNUSED_PAD src0_sel:WORD_0 src1_sel:WORD_0
    v_add_u32_sdwa v26, v8, v16 dst_sel:DWORD dst_unused:UNUSED_PAD src0_sel:WORD_1 src1_sel:WORD_1
    v_add_u32_sdwa v27, v10, v18 dst_sel:DWORD dst_unused:UNUSED_PAD src0_sel:WORD_1 src1_sel:WORD_1
    v_add_u32_sdwa v28, v9, v17 dst_sel:DWORD dst_unused:UNUSED_PAD src0_sel:WORD_0 src1_sel:WORD_0
    v_add_u32_sdwa v29, v11, v19 dst_sel:DWORD dst_unused:UNUSED_PAD src0_sel:WORD_0 src1_sel:WORD_0
    v_add_u32_sdwa v30, v9, v17 dst_sel:DWORD dst_unused:UNUSED_PAD src0_sel:WORD_1 src1_sel:WORD_1
    v_add_u32_sdwa v31, v11, v19 dst_sel:DWORD dst_unused:UNUSED_PAD src0_sel:WORD_1 src1_sel:WORD_1
    v_cvt_f32_u32 v24, v24
    v_cvt_f32_u32 v25, v25
    v_cvt_f32_u32 v26, v26
    v_cvt_f32_u32 v27, v27
    v_cvt_f32_u32 v28, v28
    v_cvt_f32_u32 v29, v29
    v_cvt_f32_u32 v30, v30
    v_cvt_f32_u32 v31, v31
    v_pk_fma_f32 v[24:25], v[24:25], s[44:45], s[44:45] op_sel:[0,0,1] op_sel_hi:[1,0,1]
    v_pk_fma_f32 v[26:27], v[26:27], s[44:45], s[44:45] op_sel:[0,0,1] op_sel_hi:[1,0,1]
    v_pk_fma_f32 v[28:29], v[28:29], s[44:45], s[44:45] op_sel:[0,0,1] op_sel_hi:[1,0,1]
    v_pk_fma_f32 v[30:31], v[30:31], s[44:45], s[44:45] op_sel:[0,0,1] op_sel_hi:[1,0,1]
    s_bfe_u32 s14, s20, 262164
    s_cbranch_scc0 L_p2_kernel_nof32b_12
    v_lshlrev_b32 v32, 1, v1
    s_bitcmp1_b32 s20, 20
    s_cbranch_scc0 L_p2_kernel_q_13
    s_lshl_b32 s15, s26, 1
    s_add_u32 s15, s15, 280470016
    buffer_load_dwordx4 v[8:11], v32, s[4:7], s15 offen sc1
    buffer_load_dwordx4 v[12:15], v32, s[4:7], s15 offen offset:16 sc1
    s_waitcnt vmcnt(0)
    v_add_f32 v24, v24, v8
    v_add_f32 v25, v25, v12
    v_add_f32 v26, v26, v9
    v_add_f32 v27, v27, v13
    v_add_f32 v28, v28, v10
    v_add_f32 v29, v29, v14
    v_add_f32 v30, v30, v11
    v_add_f32 v31, v31, v15
L_p2_kernel_q_13:
    s_bitcmp1_b32 s20, 21
    s_cbranch_scc0 L_p2_kernel_q_14
    s_lshl_b32 s15, s26, 1
    s_add_u32 s15, s15, 290710016
    buffer_load_dwordx4 v[8:11], v32, s[4:7], s15 offen sc1
    buffer_load_dwordx4 v[12:15], v32, s[4:7], s15 offen offset:16 sc1
    s_waitcnt vmcnt(0)
    v_add_f32 v24, v24, v8
    v_add_f32 v25, v25, v12
    v_add_f32 v26, v26, v9
    v_add_f32 v27, v27, v13
    v_add_f32 v28, v28, v10
    v_add_f32 v29, v29, v14
    v_add_f32 v30, v30, v11
    v_add_f32 v31, v31, v15
L_p2_kernel_q_14:
    s_bitcmp1_b32 s20, 22
    s_cbranch_scc0 L_p2_kernel_q_15
    s_lshl_b32 s15, s26, 1
    s_add_u32 s15, s15, 300950016
    buffer_load_dwordx4 v[8:11], v32, s[4:7], s15 offen sc1
    buffer_load_dwordx4 v[12:15], v32, s[4:7], s15 offen offset:16 sc1
    s_waitcnt vmcnt(0)
    v_add_f32 v24, v24, v8
    v_add_f32 v25, v25, v12
    v_add_f32 v26, v26, v9
    v_add_f32 v27, v27, v13
    v_add_f32 v28, v28, v10
    v_add_f32 v29, v29, v14
    v_add_f32 v30, v30, v11
    v_add_f32 v31, v31, v15
L_p2_kernel_q_15:
    s_bitcmp1_b32 s20, 23
    s_cbranch_scc0 L_p2_kernel_q_16
    s_lshl_b32 s15, s26, 1
    s_add_u32 s15, s15, 311190016
    buffer_load_dwordx4 v[8:11], v32, s[4:7], s15 offen sc1
    buffer_load_dwordx4 v[12:15], v32, s[4:7], s15 offen offset:16 sc1
    s_waitcnt vmcnt(0)
    v_add_f32 v24, v24, v8
    v_add_f32 v25, v25, v12
    v_add_f32 v26, v26, v9
    v_add_f32 v27, v27, v13
    v_add_f32 v28, v28, v10
    v_add_f32 v29, v29, v14
    v_add_f32 v30, v30, v11
    v_add_f32 v31, v31, v15
L_p2_kernel_q_16:
L_p2_kernel_nof32b_12:
    v_pk_mul_f32 v[8:9], v[24:25], s[84:85] op_sel:[0,0] op_sel_hi:[1,0]
    v_pk_mul_f32 v[10:11], v[24:25], s[84:85] op_sel:[0,1] op_sel_hi:[1,1]
    v_pk_mul_f32 v[12:13], v[24:25], s[86:87] op_sel:[0,0] op_sel_hi:[1,0]
    v_pk_mul_f32 v[14:15], v[24:25], s[86:87] op_sel:[0,1] op_sel_hi:[1,1]
    v_pk_fma_f32 v[8:9], v[26:27], s[88:89], v[8:9] op_sel:[0,0,0] op_sel_hi:[1,0,1]
    v_pk_fma_f32 v[10:11], v[26:27], s[88:89], v[10:11] op_sel:[0,1,0] op_sel_hi:[1,1,1]
    v_pk_fma_f32 v[12:13], v[26:27], s[90:91], v[12:13] op_sel:[0,0,0] op_sel_hi:[1,0,1]
    v_pk_fma_f32 v[14:15], v[26:27], s[90:91], v[14:15] op_sel:[0,1,0] op_sel_hi:[1,1,1]
    v_pk_fma_f32 v[8:9], v[28:29], s[92:93], v[8:9] op_sel:[0,0,0] op_sel_hi:[1,0,1]
    v_pk_fma_f32 v[10:11], v[28:29], s[92:93], v[10:11] op_sel:[0,1,0] op_sel_hi:[1,1,1]
    v_pk_fma_f32 v[12:13], v[28:29], s[94:95], v[12:13] op_sel:[0,0,0] op_sel_hi:[1,0,1]
    v_pk_fma_f32 v[14:15], v[28:29], s[94:95], v[14:15] op_sel:[0,1,0] op_sel_hi:[1,1,1]
    v_pk_fma_f32 v[8:9], v[30:31], s[96:97], v[8:9] op_sel:[0,0,0] op_sel_hi:[1,0,1]
    v_pk_fma_f32 v[10:11], v[30:31], s[96:97], v[10:11] op_sel:[0,1,0] op_sel_hi:[1,1,1]
    v_pk_fma_f32 v[12:13], v[30:31], s[98:99], v[12:13] op_sel:[0,0,0] op_sel_hi:[1,0,1]
    v_pk_fma_f32 v[14:15], v[30:31], s[98:99], v[14:15] op_sel:[0,1,0] op_sel_hi:[1,1,1]
    v_pk_mul_f32 v[8:9], v[8:9], v[72:73]
    v_pk_mul_f32 v[10:11], v[10:11], v[74:75]
    v_pk_mul_f32 v[12:13], v[12:13], v[76:77]
    v_pk_mul_f32 v[14:15], v[14:15], v[78:79]
    v_pk_mul_f32 v[24:25], v[8:9], s[28:29] op_sel:[0,0] op_sel_hi:[1,0]
    v_pk_mul_f32 v[26:27], v[8:9], s[28:29] op_sel:[0,1] op_sel_hi:[1,1]
    v_pk_mul_f32 v[28:29], v[8:9], s[30:31] op_sel:[0,0] op_sel_hi:[1,0]
    v_pk_mul_f32 v[30:31], v[8:9], s[30:31] op_sel:[0,1] op_sel_hi:[1,1]
    v_pk_fma_f32 v[24:25], v[10:11], s[32:33], v[24:25] op_sel:[0,0,0] op_sel_hi:[1,0,1]
    v_pk_fma_f32 v[26:27], v[10:11], s[32:33], v[26:27] op_sel:[0,1,0] op_sel_hi:[1,1,1]
    v_pk_fma_f32 v[28:29], v[10:11], s[34:35], v[28:29] op_sel:[0,0,0] op_sel_hi:[1,0,1]
    v_pk_fma_f32 v[30:31], v[10:11], s[34:35], v[30:31] op_sel:[0,1,0] op_sel_hi:[1,1,1]
    v_pk_fma_f32 v[24:25], v[12:13], s[36:37], v[24:25] op_sel:[0,0,0] op_sel_hi:[1,0,1]
    v_pk_fma_f32 v[26:27], v[12:13], s[36:37], v[26:27] op_sel:[0,1,0] op_sel_hi:[1,1,1]
    v_pk_fma_f32 v[28:29], v[12:13], s[38:39], v[28:29] op_sel:[0,0,0] op_sel_hi:[1,0,1]
    v_pk_fma_f32 v[30:31], v[12:13], s[38:39], v[30:31] op_sel:[0,1,0] op_sel_hi:[1,1,1]
    v_pk_fma_f32 v[24:25], v[14:15], s[40:41], v[24:25] op_sel:[0,0,0] op_sel_hi:[1,0,1]
    v_pk_fma_f32 v[26:27], v[14:15], s[40:41], v[26:27] op_sel:[0,1,0] op_sel_hi:[1,1,1]
    v_pk_fma_f32 v[28:29], v[14:15], s[42:43], v[28:29] op_sel:[0,0,0] op_sel_hi:[1,0,1]
    v_pk_fma_f32 v[30:31], v[14:15], s[42:43], v[30:31] op_sel:[0,1,0] op_sel_hi:[1,1,1]
    v_lshlrev_b32 v8, 16, v64
    v_and_b32 v10, 0xffff0000, v64
    v_lshlrev_b32 v12, 16, v65
    v_and_b32 v14, 0xffff0000, v65
    v_lshlrev_b32 v9, 16, v66
    v_and_b32 v11, 0xffff0000, v66
    v_lshlrev_b32 v13, 16, v67
    v_and_b32 v15, 0xffff0000, v67
    v_pk_fma_f32 v[8:9], v[24:25], v[80:81], v[8:9]
    v_pk_fma_f32 v[10:11], v[26:27], v[82:83], v[10:11]
    v_pk_fma_f32 v[12:13], v[28:29], v[84:85], v[12:13]
    v_pk_fma_f32 v[14:15], v[30:31], v[86:87], v[14:15]
    v_cvt_pk_bf16_f32 v16, v8, v10
    v_cvt_pk_bf16_f32 v17, v12, v14
    v_cvt_pk_bf16_f32 v18, v9, v11
    v_cvt_pk_bf16_f32 v19, v13, v15
    buffer_store_dwordx4 v[16:19], v1, s[16:19], s26 offen
    s_cmp_ge_u32 s13, 4
    s_cbranch_scc1 L_p2_f1
    s_bfe_u32 s14, s20, 262164
    s_cbranch_scc0 L_p2_kernel_nof32a_17
    s_add_u32 s14, s12, 0
    s_and_b32 s14, s14, 3
    s_add_u32 s14, s14, 20
    s_bitcmp1_b32 s20, s14
    s_cbranch_scc0 L_p2_kernel_q_18
    v_mov_b32 v88, 1073758208
    v_mov_b32 v89, 1073758208
    v_mov_b32 v90, 1073758208
    v_mov_b32 v91, 1073758208
L_p2_kernel_q_18:
    s_add_u32 s14, s12, 1
    s_and_b32 s14, s14, 3
    s_add_u32 s14, s14, 20
    s_bitcmp1_b32 s20, s14
    s_cbranch_scc0 L_p2_kernel_q_19
    v_mov_b32 v92, 1073758208
    v_mov_b32 v93, 1073758208
    v_mov_b32 v94, 1073758208
    v_mov_b32 v95, 1073758208
L_p2_kernel_q_19:
    s_add_u32 s14, s12, 2
    s_and_b32 s14, s14, 3
    s_add_u32 s14, s14, 20
    s_bitcmp1_b32 s20, s14
    s_cbranch_scc0 L_p2_kernel_q_20
    v_mov_b32 v96, 1073758208
    v_mov_b32 v97, 1073758208
    v_mov_b32 v98, 1073758208
    v_mov_b32 v99, 1073758208
L_p2_kernel_q_20:
    s_add_u32 s14, s12, 3
    s_and_b32 s14, s14, 3
    s_add_u32 s14, s14, 20
    s_bitcmp1_b32 s20, s14
    s_cbranch_scc0 L_p2_kernel_q_21
    v_mov_b32 v100, 1073758208
    v_mov_b32 v101, 1073758208
    v_mov_b32 v102, 1073758208
    v_mov_b32 v103, 1073758208
L_p2_kernel_q_21:
L_p2_kernel_nof32a_17:
    v_pk_add_u16 v88, v88, v92
    v_pk_add_u16 v96, v96, v100
    v_pk_add_u16 v89, v89, v93
    v_pk_add_u16 v97, v97, v101
    v_pk_add_u16 v90, v90, v94
    v_pk_add_u16 v98, v98, v102
    v_pk_add_u16 v91, v91, v95
    v_pk_add_u16 v99, v99, v103
    v_add_u32_sdwa v24, v88, v96 dst_sel:DWORD dst_unused:UNUSED_PAD src0_sel:WORD_0 src1_sel:WORD_0
    v_add_u32_sdwa v25, v90, v98 dst_sel:DWORD dst_unused:UNUSED_PAD src0_sel:WORD_0 src1_sel:WORD_0
    v_add_u32_sdwa v26, v88, v96 dst_sel:DWORD dst_unused:UNUSED_PAD src0_sel:WORD_1 src1_sel:WORD_1
    v_add_u32_sdwa v27, v90, v98 dst_sel:DWORD dst_unused:UNUSED_PAD src0_sel:WORD_1 src1_sel:WORD_1
    v_add_u32_sdwa v28, v89, v97 dst_sel:DWORD dst_unused:UNUSED_PAD src0_sel:WORD_0 src1_sel:WORD_0
    v_add_u32_sdwa v29, v91, v99 dst_sel:DWORD dst_unused:UNUSED_PAD src0_sel:WORD_0 src1_sel:WORD_0
    v_add_u32_sdwa v30, v89, v97 dst_sel:DWORD dst_unused:UNUSED_PAD src0_sel:WORD_1 src1_sel:WORD_1
    v_add_u32_sdwa v31, v91, v99 dst_sel:DWORD dst_unused:UNUSED_PAD src0_sel:WORD_1 src1_sel:WORD_1
    v_cvt_f32_u32 v24, v24
    v_cvt_f32_u32 v25, v25
    v_cvt_f32_u32 v26, v26
    v_cvt_f32_u32 v27, v27
    v_cvt_f32_u32 v28, v28
    v_cvt_f32_u32 v29, v29
    v_cvt_f32_u32 v30, v30
    v_cvt_f32_u32 v31, v31
    v_pk_fma_f32 v[24:25], v[24:25], s[44:45], s[44:45] op_sel:[0,0,1] op_sel_hi:[1,0,1]
    v_pk_fma_f32 v[26:27], v[26:27], s[44:45], s[44:45] op_sel:[0,0,1] op_sel_hi:[1,0,1]
    v_pk_fma_f32 v[28:29], v[28:29], s[44:45], s[44:45] op_sel:[0,0,1] op_sel_hi:[1,0,1]
    v_pk_fma_f32 v[30:31], v[30:31], s[44:45], s[44:45] op_sel:[0,0,1] op_sel_hi:[1,0,1]
    s_bfe_u32 s14, s20, 262164
    s_cbranch_scc0 L_p2_kernel_nof32b_22
    v_lshlrev_b32 v32, 1, v2
    s_bitcmp1_b32 s20, 20
    s_cbranch_scc0 L_p2_kernel_q_23
    s_lshl_b32 s15, s26, 1
    s_add_u32 s15, s15, 280470016
    buffer_load_dwordx4 v[88:91], v32, s[4:7], s15 offen sc1
    buffer_load_dwordx4 v[92:95], v32, s[4:7], s15 offen offset:16 sc1
    s_waitcnt vmcnt(0)
    v_add_f32 v24, v24, v88
    v_add_f32 v25, v25, v92
    v_add_f32 v26, v26, v89
    v_add_f32 v27, v27, v93
    v_add_f32 v28, v28, v90
    v_add_f32 v29, v29, v94
    v_add_f32 v30, v30, v91
    v_add_f32 v31, v31, v95
L_p2_kernel_q_23:
    s_bitcmp1_b32 s20, 21
    s_cbranch_scc0 L_p2_kernel_q_24
    s_lshl_b32 s15, s26, 1
    s_add_u32 s15, s15, 290710016
    buffer_load_dwordx4 v[88:91], v32, s[4:7], s15 offen sc1
    buffer_load_dwordx4 v[92:95], v32, s[4:7], s15 offen offset:16 sc1
    s_waitcnt vmcnt(0)
    v_add_f32 v24, v24, v88
    v_add_f32 v25, v25, v92
    v_add_f32 v26, v26, v89
    v_add_f32 v27, v27, v93
    v_add_f32 v28, v28, v90
    v_add_f32 v29, v29, v94
    v_add_f32 v30, v30, v91
    v_add_f32 v31, v31, v95
L_p2_kernel_q_24:
    s_bitcmp1_b32 s20, 22
    s_cbranch_scc0 L_p2_kernel_q_25
    s_lshl_b32 s15, s26, 1
    s_add_u32 s15, s15, 300950016
    buffer_load_dwordx4 v[88:91], v32, s[4:7], s15 offen sc1
    buffer_load_dwordx4 v[92:95], v32, s[4:7], s15 offen offset:16 sc1
    s_waitcnt vmcnt(0)
    v_add_f32 v24, v24, v88
    v_add_f32 v25, v25, v92
    v_add_f32 v26, v26, v89
    v_add_f32 v27, v27, v93
    v_add_f32 v28, v28, v90
    v_add_f32 v29, v29, v94
    v_add_f32 v30, v30, v91
    v_add_f32 v31, v31, v95
L_p2_kernel_q_25:
    s_bitcmp1_b32 s20, 23
    s_cbranch_scc0 L_p2_kernel_q_26
    s_lshl_b32 s15, s26, 1
    s_add_u32 s15, s15, 311190016
    buffer_load_dwordx4 v[88:91], v32, s[4:7], s15 offen sc1
    buffer_load_dwordx4 v[92:95], v32, s[4:7], s15 offen offset:16 sc1
    s_waitcnt vmcnt(0)
    v_add_f32 v24, v24, v88
    v_add_f32 v25, v25, v92
    v_add_f32 v26, v26, v89
    v_add_f32 v27, v27, v93
    v_add_f32 v28, v28, v90
    v_add_f32 v29, v29, v94
    v_add_f32 v30, v30, v91
    v_add_f32 v31, v31, v95
L_p2_kernel_q_26:
L_p2_kernel_nof32b_22:
    v_pk_mul_f32 v[88:89], v[24:25], s[84:85] op_sel:[0,0] op_sel_hi:[1,0]
    v_pk_mul_f32 v[90:91], v[24:25], s[84:85] op_sel:[0,1] op_sel_hi:[1,1]
    v_pk_mul_f32 v[92:93], v[24:25], s[86:87] op_sel:[0,0] op_sel_hi:[1,0]
    v_pk_mul_f32 v[94:95], v[24:25], s[86:87] op_sel:[0,1] op_sel_hi:[1,1]
    v_pk_fma_f32 v[88:89], v[26:27], s[88:89], v[88:89] op_sel:[0,0,0] op_sel_hi:[1,0,1]
    v_pk_fma_f32 v[90:91], v[26:27], s[88:89], v[90:91] op_sel:[0,1,0] op_sel_hi:[1,1,1]
    v_pk_fma_f32 v[92:93], v[26:27], s[90:91], v[92:93] op_sel:[0,0,0] op_sel_hi:[1,0,1]
    v_pk_fma_f32 v[94:95], v[26:27], s[90:91], v[94:95] op_sel:[0,1,0] op_sel_hi:[1,1,1]
    v_pk_fma_f32 v[88:89], v[28:29], s[92:93], v[88:89] op_sel:[0,0,0] op_sel_hi:[1,0,1]
    v_pk_fma_f32 v[90:91], v[28:29], s[92:93], v[90:91] op_sel:[0,1,0] op_sel_hi:[1,1,1]
    v_pk_fma_f32 v[92:93], v[28:29], s[94:95], v[92:93] op_sel:[0,0,0] op_sel_hi:[1,0,1]
    v_pk_fma_f32 v[94:95], v[28:29], s[94:95], v[94:95] op_sel:[0,1,0] op_sel_hi:[1,1,1]
    v_pk_fma_f32 v[88:89], v[30:31], s[96:97], v[88:89] op_sel:[0,0,0] op_sel_hi:[1,0,1]
    v_pk_fma_f32 v[90:91], v[30:31], s[96:97], v[90:91] op_sel:[0,1,0] op_sel_hi:[1,1,1]
    v_pk_fma_f32 v[92:93], v[30:31], s[98:99], v[92:93] op_sel:[0,0,0] op_sel_hi:[1,0,1]
    v_pk_fma_f32 v[94:95], v[30:31], s[98:99], v[94:95] op_sel:[0,1,0] op_sel_hi:[1,1,1]
    v_pk_mul_f32 v[88:89], v[88:89], v[112:113]
    v_pk_mul_f32 v[90:91], v[90:91], v[114:115]
    v_pk_mul_f32 v[92:93], v[92:93], v[116:117]
    v_pk_mul_f32 v[94:95], v[94:95], v[118:119]
    v_pk_mul_f32 v[24:25], v[88:89], s[28:29] op_sel:[0,0] op_sel_hi:[1,0]
    v_pk_mul_f32 v[26:27], v[88:89], s[28:29] op_sel:[0,1] op_sel_hi:[1,1]
    v_pk_mul_f32 v[28:29], v[88:89], s[30:31] op_sel:[0,0] op_sel_hi:[1,0]
    v_pk_mul_f32 v[30:31], v[88:89], s[30:31] op_sel:[0,1] op_sel_hi:[1,1]
    v_pk_fma_f32 v[24:25], v[90:91], s[32:33], v[24:25] op_sel:[0,0,0] op_sel_hi:[1,0,1]
    v_pk_fma_f32 v[26:27], v[90:91], s[32:33], v[26:27] op_sel:[0,1,0] op_sel_hi:[1,1,1]
    v_pk_fma_f32 v[28:29], v[90:91], s[34:35], v[28:29] op_sel:[0,0,0] op_sel_hi:[1,0,1]
    v_pk_fma_f32 v[30:31], v[90:91], s[34:35], v[30:31] op_sel:[0,1,0] op_sel_hi:[1,1,1]
    v_pk_fma_f32 v[24:25], v[92:93], s[36:37], v[24:25] op_sel:[0,0,0] op_sel_hi:[1,0,1]
    v_pk_fma_f32 v[26:27], v[92:93], s[36:37], v[26:27] op_sel:[0,1,0] op_sel_hi:[1,1,1]
    v_pk_fma_f32 v[28:29], v[92:93], s[38:39], v[28:29] op_sel:[0,0,0] op_sel_hi:[1,0,1]
    v_pk_fma_f32 v[30:31], v[92:93], s[38:39], v[30:31] op_sel:[0,1,0] op_sel_hi:[1,1,1]
    v_pk_fma_f32 v[24:25], v[94:95], s[40:41], v[24:25] op_sel:[0,0,0] op_sel_hi:[1,0,1]
    v_pk_fma_f32 v[26:27], v[94:95], s[40:41], v[26:27] op_sel:[0,1,0] op_sel_hi:[1,1,1]
    v_pk_fma_f32 v[28:29], v[94:95], s[42:43], v[28:29] op_sel:[0,0,0] op_sel_hi:[1,0,1]
    v_pk_fma_f32 v[30:31], v[94:95], s[42:43], v[30:31] op_sel:[0,1,0] op_sel_hi:[1,1,1]
    v_lshlrev_b32 v88, 16, v68
    v_and_b32 v90, 0xffff0000, v68
    v_lshlrev_b32 v92, 16, v69
    v_and_b32 v94, 0xffff0000, v69
    v_lshlrev_b32 v89, 16, v70
    v_and_b32 v91, 0xffff0000, v70
    v_lshlrev_b32 v93, 16, v71
    v_and_b32 v95, 0xffff0000, v71
    v_pk_fma_f32 v[88:89], v[24:25], v[120:121], v[88:89]
    v_pk_fma_f32 v[90:91], v[26:27], v[122:123], v[90:91]
    v_pk_fma_f32 v[92:93], v[28:29], v[124:125], v[92:93]
    v_pk_fma_f32 v[94:95], v[30:31], v[126:127], v[94:95]
    v_cvt_pk_bf16_f32 v96, v88, v90
    v_cvt_pk_bf16_f32 v97, v92, v94
    v_cvt_pk_bf16_f32 v98, v89, v91
    v_cvt_pk_bf16_f32 v99, v93, v95
    buffer_store_dwordx4 v[96:99], v2, s[16:19], s26 offen
L_p2_f1:
    s_bitset0_b32 s51, s49
    s_cmp_eq_u32 s51, 0
    s_cbranch_scc1 L_p2_done
    s_ff1_i32_b32 s49, s51
    s_lshl2_add_u32 s14, s3, s49
    s_mul_i32 s14, s14, 5000
    s_add_u32 s15, s14, 4096
    v_min_u32 v61, 225, v0
    v_lshl_add_u32 v60, v0, 2, s14
    v_lshl_add_u32 v61, v61, 2, s15
    global_load_dword v60, v60, s[100:101] nt
    global_load_dword v61, v61, s[100:101] nt
    s_waitcnt vmcnt(0)
    v_lshlrev_b32 v30, 16, v60
    v_and_b32 v31, 0xffff0000, v60
    v_lshlrev_b32 v36, 16, v53
    v_and_b32 v37, 0xffff0000, v53
    v_lshlrev_b32 v38, 16, v54
    v_and_b32 v39, 0xffff0000, v54
    v_lshlrev_b32 v40, 16, v56
    v_and_b32 v41, 0xffff0000, v56
    v_lshlrev_b32 v42, 16, v57
    v_and_b32 v43, 0xffff0000, v57
    v_pk_add_f32 v[14:15], v[30:31], v[36:37] op_sel:[0,0] op_sel_hi:[1,0] neg_lo:[0,1] neg_hi:[0,1]
    v_pk_add_f32 v[16:17], v[30:31], v[36:37] op_sel:[0,1] op_sel_hi:[1,1] neg_lo:[0,1] neg_hi:[0,1]
    v_pk_add_f32 v[18:19], v[30:31], v[38:39] op_sel:[0,0] op_sel_hi:[1,0] neg_lo:[0,1] neg_hi:[0,1]
    v_pk_add_f32 v[20:21], v[30:31], v[38:39] op_sel:[0,1] op_sel_hi:[1,1] neg_lo:[0,1] neg_hi:[0,1]
    v_pk_add_f32 v[22:23], v[30:31], v[40:41] op_sel:[0,0] op_sel_hi:[1,0] neg_lo:[0,1] neg_hi:[0,1]
    v_pk_add_f32 v[24:25], v[30:31], v[40:41] op_sel:[0,1] op_sel_hi:[1,1] neg_lo:[0,1] neg_hi:[0,1]
    v_pk_add_f32 v[26:27], v[30:31], v[42:43] op_sel:[0,0] op_sel_hi:[1,0] neg_lo:[0,1] neg_hi:[0,1]
    v_pk_add_f32 v[28:29], v[30:31], v[42:43] op_sel:[0,1] op_sel_hi:[1,1] neg_lo:[0,1] neg_hi:[0,1]
    v_cvt_pk_bf16_f32 v32, v14, v15
    v_lshlrev_b32 v14, 16, v32
    v_and_b32 v15, 0xffff0000, v32
    v_cvt_pk_bf16_f32 v32, v16, v17
    v_lshlrev_b32 v16, 16, v32
    v_and_b32 v17, 0xffff0000, v32
    v_cvt_pk_bf16_f32 v32, v18, v19
    v_lshlrev_b32 v18, 16, v32
    v_and_b32 v19, 0xffff0000, v32
    v_cvt_pk_bf16_f32 v32, v20, v21
    v_lshlrev_b32 v20, 16, v32
    v_and_b32 v21, 0xffff0000, v32
    v_cvt_pk_bf16_f32 v32, v22, v23
    v_lshlrev_b32 v22, 16, v32
    v_and_b32 v23, 0xffff0000, v32
    v_cvt_pk_bf16_f32 v32, v24, v25
    v_lshlrev_b32 v24, 16, v32
    v_and_b32 v25, 0xffff0000, v32
    v_cvt_pk_bf16_f32 v32, v26, v27
    v_lshlrev_b32 v26, 16, v32
    v_and_b32 v27, 0xffff0000, v32
    v_cvt_pk_bf16_f32 v32, v28, v29
    v_lshlrev_b32 v28, 16, v32
    v_and_b32 v29, 0xffff0000, v32
    v_pk_mul_f32 v[14:15], v[14:15], v[14:15]
    v_pk_mul_f32 v[16:17], v[16:17], v[16:17]
    v_pk_mul_f32 v[18:19], v[18:19], v[18:19]
    v_pk_mul_f32 v[20:21], v[20:21], v[20:21]
    v_pk_mul_f32 v[22:23], v[22:23], v[22:23]
    v_pk_mul_f32 v[24:25], v[24:25], v[24:25]
    v_pk_mul_f32 v[26:27], v[26:27], v[26:27]
    v_pk_mul_f32 v[28:29], v[28:29], v[28:29]
    v_cvt_pk_bf16_f32 v32, v14, v15
    v_lshlrev_b32 v14, 16, v32
    v_and_b32 v15, 0xffff0000, v32
    v_cvt_pk_bf16_f32 v32, v16, v17
    v_lshlrev_b32 v16, 16, v32
    v_and_b32 v17, 0xffff0000, v32
    v_cvt_pk_bf16_f32 v32, v18, v19
    v_lshlrev_b32 v18, 16, v32
    v_and_b32 v19, 0xffff0000, v32
    v_cvt_pk_bf16_f32 v32, v20, v21
    v_lshlrev_b32 v20, 16, v32
    v_and_b32 v21, 0xffff0000, v32
    v_cvt_pk_bf16_f32 v32, v22, v23
    v_lshlrev_b32 v22, 16, v32
    v_and_b32 v23, 0xffff0000, v32
    v_cvt_pk_bf16_f32 v32, v24, v25
    v_lshlrev_b32 v24, 16, v32
    v_and_b32 v25, 0xffff0000, v32
    v_cvt_pk_bf16_f32 v32, v26, v27
    v_lshlrev_b32 v26, 16, v32
    v_and_b32 v27, 0xffff0000, v32
    v_cvt_pk_bf16_f32 v32, v28, v29
    v_lshlrev_b32 v28, 16, v32
    v_and_b32 v29, 0xffff0000, v32
    v_mov_b32 v30, 1092616192
    v_mov_b32 v31, 0x3fb8aa3b
    v_pk_mul_f32 v[14:15], v[14:15], v[30:31] op_sel:[0,0] op_sel_hi:[1,0]
    v_pk_mul_f32 v[16:17], v[16:17], v[30:31] op_sel:[0,0] op_sel_hi:[1,0]
    v_pk_mul_f32 v[18:19], v[18:19], v[30:31] op_sel:[0,0] op_sel_hi:[1,0]
    v_pk_mul_f32 v[20:21], v[20:21], v[30:31] op_sel:[0,0] op_sel_hi:[1,0]
    v_pk_mul_f32 v[22:23], v[22:23], v[30:31] op_sel:[0,0] op_sel_hi:[1,0]
    v_pk_mul_f32 v[24:25], v[24:25], v[30:31] op_sel:[0,0] op_sel_hi:[1,0]
    v_pk_mul_f32 v[26:27], v[26:27], v[30:31] op_sel:[0,0] op_sel_hi:[1,0]
    v_pk_mul_f32 v[28:29], v[28:29], v[30:31] op_sel:[0,0] op_sel_hi:[1,0]
    v_cvt_pk_bf16_f32 v32, v14, v15
    v_lshlrev_b32 v14, 16, v32
    v_and_b32 v15, 0xffff0000, v32
    v_cvt_pk_bf16_f32 v32, v16, v17
    v_lshlrev_b32 v16, 16, v32
    v_and_b32 v17, 0xffff0000, v32
    v_cvt_pk_bf16_f32 v32, v18, v19
    v_lshlrev_b32 v18, 16, v32
    v_and_b32 v19, 0xffff0000, v32
    v_cvt_pk_bf16_f32 v32, v20, v21
    v_lshlrev_b32 v20, 16, v32
    v_and_b32 v21, 0xffff0000, v32
    v_cvt_pk_bf16_f32 v32, v22, v23
    v_lshlrev_b32 v22, 16, v32
    v_and_b32 v23, 0xffff0000, v32
    v_cvt_pk_bf16_f32 v32, v24, v25
    v_lshlrev_b32 v24, 16, v32
    v_and_b32 v25, 0xffff0000, v32
    v_cvt_pk_bf16_f32 v32, v26, v27
    v_lshlrev_b32 v26, 16, v32
    v_and_b32 v27, 0xffff0000, v32
    v_cvt_pk_bf16_f32 v32, v28, v29
    v_lshlrev_b32 v28, 16, v32
    v_and_b32 v29, 0xffff0000, v32
    v_pk_mul_f32 v[14:15], v[14:15], v[30:31] op_sel:[0,1] op_sel_hi:[1,1]
    v_pk_mul_f32 v[16:17], v[16:17], v[30:31] op_sel:[0,1] op_sel_hi:[1,1]
    v_pk_mul_f32 v[18:19], v[18:19], v[30:31] op_sel:[0,1] op_sel_hi:[1,1]
    v_pk_mul_f32 v[20:21], v[20:21], v[30:31] op_sel:[0,1] op_sel_hi:[1,1]
    v_pk_mul_f32 v[22:23], v[22:23], v[30:31] op_sel:[0,1] op_sel_hi:[1,1]
    v_pk_mul_f32 v[24:25], v[24:25], v[30:31] op_sel:[0,1] op_sel_hi:[1,1]
    v_pk_mul_f32 v[26:27], v[26:27], v[30:31] op_sel:[0,1] op_sel_hi:[1,1]
    v_pk_mul_f32 v[28:29], v[28:29], v[30:31] op_sel:[0,1] op_sel_hi:[1,1]
    v_exp_f32 v14, -v14
    v_exp_f32 v15, -v15
    v_exp_f32 v16, -v16
    v_exp_f32 v17, -v17
    v_exp_f32 v18, -v18
    v_exp_f32 v19, -v19
    v_exp_f32 v20, -v20
    v_exp_f32 v21, -v21
    v_exp_f32 v22, -v22
    v_exp_f32 v23, -v23
    v_exp_f32 v24, -v24
    v_exp_f32 v25, -v25
    v_exp_f32 v26, -v26
    v_exp_f32 v27, -v27
    v_exp_f32 v28, -v28
    v_exp_f32 v29, -v29
    v_cvt_pk_bf16_f32 v14, v14, v16
    v_cvt_pk_bf16_f32 v15, v15, v17
    v_cvt_pk_bf16_f32 v18, v18, v20
    v_cvt_pk_bf16_f32 v19, v19, v21
    v_cvt_pk_bf16_f32 v22, v22, v24
    v_cvt_pk_bf16_f32 v23, v23, v25
    v_cvt_pk_bf16_f32 v26, v26, v28
    v_cvt_pk_bf16_f32 v27, v27, v29
    v_dot2_f32_bf16 v72, v14, s68, 0
    v_dot2_f32_bf16 v73, v15, s68, 0
    v_dot2_f32_bf16 v74, v14, s69, 0
    v_dot2_f32_bf16 v75, v15, s69, 0
    v_dot2_f32_bf16 v76, v14, s70, 0
    v_dot2_f32_bf16 v77, v15, s70, 0
    v_dot2_f32_bf16 v78, v14, s71, 0
    v_dot2_f32_bf16 v79, v15, s71, 0
    v_dot2_f32_bf16 v80, v14, s52, 0
    v_dot2_f32_bf16 v81, v15, s52, 0
    v_dot2_f32_bf16 v82, v14, s53, 0
    v_dot2_f32_bf16 v83, v15, s53, 0
    v_dot2_f32_bf16 v84, v14, s54, 0
    v_dot2_f32_bf16 v85, v15, s54, 0
    v_dot2_f32_bf16 v86, v14, s55, 0
    v_dot2_f32_bf16 v87, v15, s55, 0
    v_dot2_f32_bf16 v72, v18, s72, v72
    v_dot2_f32_bf16 v73, v19, s72, v73
    v_dot2_f32_bf16 v74, v18, s73, v74
    v_dot2_f32_bf16 v75, v19, s73, v75
    v_dot2_f32_bf16 v76, v18, s74, v76
    v_dot2_f32_bf16 v77, v19, s74, v77
    v_dot2_f32_bf16 v78, v18, s75, v78
    v_dot2_f32_bf16 v79, v19, s75, v79
    v_dot2_f32_bf16 v80, v18, s56, v80
    v_dot2_f32_bf16 v81, v19, s56, v81
    v_dot2_f32_bf16 v82, v18, s57, v82
    v_dot2_f32_bf16 v83, v19, s57, v83
    v_dot2_f32_bf16 v84, v18, s58, v84
    v_dot2_f32_bf16 v85, v19, s58, v85
    v_dot2_f32_bf16 v86, v18, s59, v86
    v_dot2_f32_bf16 v87, v19, s59, v87
    v_dot2_f32_bf16 v72, v22, s76, v72
    v_dot2_f32_bf16 v73, v23, s76, v73
    v_dot2_f32_bf16 v74, v22, s77, v74
    v_dot2_f32_bf16 v75, v23, s77, v75
    v_dot2_f32_bf16 v76, v22, s78, v76
    v_dot2_f32_bf16 v77, v23, s78, v77
    v_dot2_f32_bf16 v78, v22, s79, v78
    v_dot2_f32_bf16 v79, v23, s79, v79
    v_dot2_f32_bf16 v80, v22, s60, v80
    v_dot2_f32_bf16 v81, v23, s60, v81
    v_dot2_f32_bf16 v82, v22, s61, v82
    v_dot2_f32_bf16 v83, v23, s61, v83
    v_dot2_f32_bf16 v84, v22, s62, v84
    v_dot2_f32_bf16 v85, v23, s62, v85
    v_dot2_f32_bf16 v86, v22, s63, v86
    v_dot2_f32_bf16 v87, v23, s63, v87
    v_dot2_f32_bf16 v72, v26, s80, v72
    v_dot2_f32_bf16 v73, v27, s80, v73
    v_dot2_f32_bf16 v74, v26, s81, v74
    v_dot2_f32_bf16 v75, v27, s81, v75
    v_dot2_f32_bf16 v76, v26, s82, v76
    v_dot2_f32_bf16 v77, v27, s82, v77
    v_dot2_f32_bf16 v78, v26, s83, v78
    v_dot2_f32_bf16 v79, v27, s83, v79
    v_dot2_f32_bf16 v80, v26, s64, v80
    v_dot2_f32_bf16 v81, v27, s64, v81
    v_dot2_f32_bf16 v82, v26, s65, v82
    v_dot2_f32_bf16 v83, v27, s65, v83
    v_dot2_f32_bf16 v84, v26, s66, v84
    v_dot2_f32_bf16 v85, v27, s66, v85
    v_dot2_f32_bf16 v86, v26, s67, v86
    v_dot2_f32_bf16 v87, v27, s67, v87
    s_cmp_ge_u32 s13, 4
    s_cbranch_scc1 L_p2_kernel_g1_27
    v_lshlrev_b32 v30, 16, v61
    v_and_b32 v31, 0xffff0000, v61
    v_pk_add_f32 v[14:15], v[30:31], v[36:37] op_sel:[0,0] op_sel_hi:[1,0] neg_lo:[0,1] neg_hi:[0,1]
    v_pk_add_f32 v[16:17], v[30:31], v[36:37] op_sel:[0,1] op_sel_hi:[1,1] neg_lo:[0,1] neg_hi:[0,1]
    v_pk_add_f32 v[18:19], v[30:31], v[38:39] op_sel:[0,0] op_sel_hi:[1,0] neg_lo:[0,1] neg_hi:[0,1]
    v_pk_add_f32 v[20:21], v[30:31], v[38:39] op_sel:[0,1] op_sel_hi:[1,1] neg_lo:[0,1] neg_hi:[0,1]
    v_pk_add_f32 v[22:23], v[30:31], v[40:41] op_sel:[0,0] op_sel_hi:[1,0] neg_lo:[0,1] neg_hi:[0,1]
    v_pk_add_f32 v[24:25], v[30:31], v[40:41] op_sel:[0,1] op_sel_hi:[1,1] neg_lo:[0,1] neg_hi:[0,1]
    v_pk_add_f32 v[26:27], v[30:31], v[42:43] op_sel:[0,0] op_sel_hi:[1,0] neg_lo:[0,1] neg_hi:[0,1]
    v_pk_add_f32 v[28:29], v[30:31], v[42:43] op_sel:[0,1] op_sel_hi:[1,1] neg_lo:[0,1] neg_hi:[0,1]
    v_cvt_pk_bf16_f32 v32, v14, v15
    v_lshlrev_b32 v14, 16, v32
    v_and_b32 v15, 0xffff0000, v32
    v_cvt_pk_bf16_f32 v32, v16, v17
    v_lshlrev_b32 v16, 16, v32
    v_and_b32 v17, 0xffff0000, v32
    v_cvt_pk_bf16_f32 v32, v18, v19
    v_lshlrev_b32 v18, 16, v32
    v_and_b32 v19, 0xffff0000, v32
    v_cvt_pk_bf16_f32 v32, v20, v21
    v_lshlrev_b32 v20, 16, v32
    v_and_b32 v21, 0xffff0000, v32
    v_cvt_pk_bf16_f32 v32, v22, v23
    v_lshlrev_b32 v22, 16, v32
    v_and_b32 v23, 0xffff0000, v32
    v_cvt_pk_bf16_f32 v32, v24, v25
    v_lshlrev_b32 v24, 16, v32
    v_and_b32 v25, 0xffff0000, v32
    v_cvt_pk_bf16_f32 v32, v26, v27
    v_lshlrev_b32 v26, 16, v32
    v_and_b32 v27, 0xffff0000, v32
    v_cvt_pk_bf16_f32 v32, v28, v29
    v_lshlrev_b32 v28, 16, v32
    v_and_b32 v29, 0xffff0000, v32
    v_pk_mul_f32 v[14:15], v[14:15], v[14:15]
    v_pk_mul_f32 v[16:17], v[16:17], v[16:17]
    v_pk_mul_f32 v[18:19], v[18:19], v[18:19]
    v_pk_mul_f32 v[20:21], v[20:21], v[20:21]
    v_pk_mul_f32 v[22:23], v[22:23], v[22:23]
    v_pk_mul_f32 v[24:25], v[24:25], v[24:25]
    v_pk_mul_f32 v[26:27], v[26:27], v[26:27]
    v_pk_mul_f32 v[28:29], v[28:29], v[28:29]
    v_cvt_pk_bf16_f32 v32, v14, v15
    v_lshlrev_b32 v14, 16, v32
    v_and_b32 v15, 0xffff0000, v32
    v_cvt_pk_bf16_f32 v32, v16, v17
    v_lshlrev_b32 v16, 16, v32
    v_and_b32 v17, 0xffff0000, v32
    v_cvt_pk_bf16_f32 v32, v18, v19
    v_lshlrev_b32 v18, 16, v32
    v_and_b32 v19, 0xffff0000, v32
    v_cvt_pk_bf16_f32 v32, v20, v21
    v_lshlrev_b32 v20, 16, v32
    v_and_b32 v21, 0xffff0000, v32
    v_cvt_pk_bf16_f32 v32, v22, v23
    v_lshlrev_b32 v22, 16, v32
    v_and_b32 v23, 0xffff0000, v32
    v_cvt_pk_bf16_f32 v32, v24, v25
    v_lshlrev_b32 v24, 16, v32
    v_and_b32 v25, 0xffff0000, v32
    v_cvt_pk_bf16_f32 v32, v26, v27
    v_lshlrev_b32 v26, 16, v32
    v_and_b32 v27, 0xffff0000, v32
    v_cvt_pk_bf16_f32 v32, v28, v29
    v_lshlrev_b32 v28, 16, v32
    v_and_b32 v29, 0xffff0000, v32
    v_mov_b32 v30, 1092616192
    v_mov_b32 v31, 0x3fb8aa3b
    v_pk_mul_f32 v[14:15], v[14:15], v[30:31] op_sel:[0,0] op_sel_hi:[1,0]
    v_pk_mul_f32 v[16:17], v[16:17], v[30:31] op_sel:[0,0] op_sel_hi:[1,0]
    v_pk_mul_f32 v[18:19], v[18:19], v[30:31] op_sel:[0,0] op_sel_hi:[1,0]
    v_pk_mul_f32 v[20:21], v[20:21], v[30:31] op_sel:[0,0] op_sel_hi:[1,0]
    v_pk_mul_f32 v[22:23], v[22:23], v[30:31] op_sel:[0,0] op_sel_hi:[1,0]
    v_pk_mul_f32 v[24:25], v[24:25], v[30:31] op_sel:[0,0] op_sel_hi:[1,0]
    v_pk_mul_f32 v[26:27], v[26:27], v[30:31] op_sel:[0,0] op_sel_hi:[1,0]
    v_pk_mul_f32 v[28:29], v[28:29], v[30:31] op_sel:[0,0] op_sel_hi:[1,0]
    v_cvt_pk_bf16_f32 v32, v14, v15
    v_lshlrev_b32 v14, 16, v32
    v_and_b32 v15, 0xffff0000, v32
    v_cvt_pk_bf16_f32 v32, v16, v17
    v_lshlrev_b32 v16, 16, v32
    v_and_b32 v17, 0xffff0000, v32
    v_cvt_pk_bf16_f32 v32, v18, v19
    v_lshlrev_b32 v18, 16, v32
    v_and_b32 v19, 0xffff0000, v32
    v_cvt_pk_bf16_f32 v32, v20, v21
    v_lshlrev_b32 v20, 16, v32
    v_and_b32 v21, 0xffff0000, v32
    v_cvt_pk_bf16_f32 v32, v22, v23
    v_lshlrev_b32 v22, 16, v32
    v_and_b32 v23, 0xffff0000, v32
    v_cvt_pk_bf16_f32 v32, v24, v25
    v_lshlrev_b32 v24, 16, v32
    v_and_b32 v25, 0xffff0000, v32
    v_cvt_pk_bf16_f32 v32, v26, v27
    v_lshlrev_b32 v26, 16, v32
    v_and_b32 v27, 0xffff0000, v32
    v_cvt_pk_bf16_f32 v32, v28, v29
    v_lshlrev_b32 v28, 16, v32
    v_and_b32 v29, 0xffff0000, v32
    v_pk_mul_f32 v[14:15], v[14:15], v[30:31] op_sel:[0,1] op_sel_hi:[1,1]
    v_pk_mul_f32 v[16:17], v[16:17], v[30:31] op_sel:[0,1] op_sel_hi:[1,1]
    v_pk_mul_f32 v[18:19], v[18:19], v[30:31] op_sel:[0,1] op_sel_hi:[1,1]
    v_pk_mul_f32 v[20:21], v[20:21], v[30:31] op_sel:[0,1] op_sel_hi:[1,1]
    v_pk_mul_f32 v[22:23], v[22:23], v[30:31] op_sel:[0,1] op_sel_hi:[1,1]
    v_pk_mul_f32 v[24:25], v[24:25], v[30:31] op_sel:[0,1] op_sel_hi:[1,1]
    v_pk_mul_f32 v[26:27], v[26:27], v[30:31] op_sel:[0,1] op_sel_hi:[1,1]
    v_pk_mul_f32 v[28:29], v[28:29], v[30:31] op_sel:[0,1] op_sel_hi:[1,1]
    v_exp_f32 v14, -v14
    v_exp_f32 v15, -v15
    v_exp_f32 v16, -v16
    v_exp_f32 v17, -v17
    v_exp_f32 v18, -v18
    v_exp_f32 v19, -v19
    v_exp_f32 v20, -v20
    v_exp_f32 v21, -v21
    v_exp_f32 v22, -v22
    v_exp_f32 v23, -v23
    v_exp_f32 v24, -v24
    v_exp_f32 v25, -v25
    v_exp_f32 v26, -v26
    v_exp_f32 v27, -v27
    v_exp_f32 v28, -v28
    v_exp_f32 v29, -v29
    v_cvt_pk_bf16_f32 v14, v14, v16
    v_cvt_pk_bf16_f32 v15, v15, v17
    v_cvt_pk_bf16_f32 v18, v18, v20
    v_cvt_pk_bf16_f32 v19, v19, v21
    v_cvt_pk_bf16_f32 v22, v22, v24
    v_cvt_pk_bf16_f32 v23, v23, v25
    v_cvt_pk_bf16_f32 v26, v26, v28
    v_cvt_pk_bf16_f32 v27, v27, v29
    v_dot2_f32_bf16 v112, v14, s68, 0
    v_dot2_f32_bf16 v113, v15, s68, 0
    v_dot2_f32_bf16 v114, v14, s69, 0
    v_dot2_f32_bf16 v115, v15, s69, 0
    v_dot2_f32_bf16 v116, v14, s70, 0
    v_dot2_f32_bf16 v117, v15, s70, 0
    v_dot2_f32_bf16 v118, v14, s71, 0
    v_dot2_f32_bf16 v119, v15, s71, 0
    v_dot2_f32_bf16 v120, v14, s52, 0
    v_dot2_f32_bf16 v121, v15, s52, 0
    v_dot2_f32_bf16 v122, v14, s53, 0
    v_dot2_f32_bf16 v123, v15, s53, 0
    v_dot2_f32_bf16 v124, v14, s54, 0
    v_dot2_f32_bf16 v125, v15, s54, 0
    v_dot2_f32_bf16 v126, v14, s55, 0
    v_dot2_f32_bf16 v127, v15, s55, 0
    v_dot2_f32_bf16 v112, v18, s72, v112
    v_dot2_f32_bf16 v113, v19, s72, v113
    v_dot2_f32_bf16 v114, v18, s73, v114
    v_dot2_f32_bf16 v115, v19, s73, v115
    v_dot2_f32_bf16 v116, v18, s74, v116
    v_dot2_f32_bf16 v117, v19, s74, v117
    v_dot2_f32_bf16 v118, v18, s75, v118
    v_dot2_f32_bf16 v119, v19, s75, v119
    v_dot2_f32_bf16 v120, v18, s56, v120
    v_dot2_f32_bf16 v121, v19, s56, v121
    v_dot2_f32_bf16 v122, v18, s57, v122
    v_dot2_f32_bf16 v123, v19, s57, v123
    v_dot2_f32_bf16 v124, v18, s58, v124
    v_dot2_f32_bf16 v125, v19, s58, v125
    v_dot2_f32_bf16 v126, v18, s59, v126
    v_dot2_f32_bf16 v127, v19, s59, v127
    v_dot2_f32_bf16 v112, v22, s76, v112
    v_dot2_f32_bf16 v113, v23, s76, v113
    v_dot2_f32_bf16 v114, v22, s77, v114
    v_dot2_f32_bf16 v115, v23, s77, v115
    v_dot2_f32_bf16 v116, v22, s78, v116
    v_dot2_f32_bf16 v117, v23, s78, v117
    v_dot2_f32_bf16 v118, v22, s79, v118
    v_dot2_f32_bf16 v119, v23, s79, v119
    v_dot2_f32_bf16 v120, v22, s60, v120
    v_dot2_f32_bf16 v121, v23, s60, v121
    v_dot2_f32_bf16 v122, v22, s61, v122
    v_dot2_f32_bf16 v123, v23, s61, v123
    v_dot2_f32_bf16 v124, v22, s62, v124
    v_dot2_f32_bf16 v125, v23, s62, v125
    v_dot2_f32_bf16 v126, v22, s63, v126
    v_dot2_f32_bf16 v127, v23, s63, v127
    v_dot2_f32_bf16 v112, v26, s80, v112
    v_dot2_f32_bf16 v113, v27, s80, v113
    v_dot2_f32_bf16 v114, v26, s81, v114
    v_dot2_f32_bf16 v115, v27, s81, v115
    v_dot2_f32_bf16 v116, v26, s82, v116
    v_dot2_f32_bf16 v117, v27, s82, v117
    v_dot2_f32_bf16 v118, v26, s83, v118
    v_dot2_f32_bf16 v119, v27, s83, v119
    v_dot2_f32_bf16 v120, v26, s64, v120
    v_dot2_f32_bf16 v121, v27, s64, v121
    v_dot2_f32_bf16 v122, v26, s65, v122
    v_dot2_f32_bf16 v123, v27, s65, v123
    v_dot2_f32_bf16 v124, v26, s66, v124
    v_dot2_f32_bf16 v125, v27, s66, v125
    v_dot2_f32_bf16 v126, v26, s67, v126
    v_dot2_f32_bf16 v127, v27, s67, v127
L_p2_kernel_g1_27:
    s_lshl2_add_u32 s14, s3, s49
    s_mul_i32 s26, s14, 20000
    s_add_u32 s15, s26, 254870016
    buffer_load_dwordx4 v[64:67], v1, s[4:7], s15 offen
    buffer_load_dwordx4 v[68:71], v2, s[4:7], s15 offen
    s_branch L_p2_fin
L_p2_done:
    s_branch L_p2_end
L_p2_slow:
    s_barrier
    v_mov_b32 v8, 0
    v_mov_b32 v9, 0
    v_mov_b32 v10, 0
    v_mov_b32 v11, 0
    v_mov_b32 v12, v1
    ds_write_b128 v12, v[8:11]
    v_add_u32 v12, 16384, v12
    ds_write_b128 v12, v[8:11]
    v_add_u32 v12, 16384, v12
    ds_write_b128 v12, v[8:11]
    v_add_u32 v12, 16384, v12
    ds_write_b128 v12, v[8:11]
    v_add_u32 v12, 16384, v12
    ds_write_b128 v12, v[8:11]
    v_add_u32 v12, 16384, v12
    ds_write_b128 v12, v[8:11]
    v_add_u32 v12, 16384, v12
    ds_write_b128 v12, v[8:11]
    v_add_u32 v12, 16384, v12
    ds_write_b128 v12, v[8:11]
    v_add_u32 v12, 16384, v12
    ds_write_b128 v12, v[8:11]
    v_add_u32 v12, 16384, v12
    ds_write_b128 v12, v[8:11]
    v_add_u32 v12, 16384, v12
    v_lshlrev_b32 v13, 4, v0
    v_add_u32 v28, 32896, v13
    v_mul_lo_u32 v14, v0, s23
    v_add_u32 v14, 8192, v14
    s_mul_i32 s25, s12, 65
    s_add_u32 s25, s25, s3
    s_mul_i32 s25, s25, 32896
    s_add_u32 s25, s25, 246292480
    s_lshl_b32 s50, s50, 1
    s_mul_i32 s22, s12, 1280000
    s_mov_b32 s24, 0
    s_waitcnt lgkmcnt(0)
    s_barrier
L_p2_sstep:
    buffer_load_ushort v15, v13, s[4:7], s25 offen
    buffer_load_ushort v16, v28, s[4:7], s25 offen
    s_waitcnt vmcnt(0)
L_p2_srec:
    v_cmp_lt_u32 vcc, v15, v16
    s_nop 1
    s_and_b64 exec, exec, vcc
    s_cbranch_execz L_p2_sdone
    v_lshrrev_b32 v17, 1, v15
    v_and_b32 v18, 1, v15
    v_mad_u32_u24 v17, v17, 12, v14
    v_lshl_add_u32 v19, v18, 2, v17
    v_lshl_add_u32 v17, v18, 1, v17
    buffer_load_dword v20, v19, s[4:7], 0 offen
    buffer_load_ushort v21, v17, s[4:7], 0 offen offset:8
    v_add_u32 v15, 1, v15
    s_waitcnt vmcnt(0)
    v_lshlrev_b32_sdwa v19, 3, v20 dst_sel:DWORD dst_unused:UNUSED_PAD src0_sel:DWORD src1_sel:WORD_0
    buffer_load_dwordx2 v[22:23], v19, s[8:11], s22 offen
    v_mad_u32_u16 v20, v20, 16, s50 op_sel:[1,0,0,0]
    v_lshlrev_b32 v21, 16, v21
    s_waitcnt vmcnt(0)
    v_lshlrev_b32 v24, 16, v22
    v_and_b32 v25, 0xffff0000, v22
    v_lshlrev_b32 v26, 16, v23
    v_and_b32 v27, 0xffff0000, v23
    v_mul_f32 v24, v21, v24
    v_mul_f32 v25, v21, v25
    v_mul_f32 v26, v21, v26
    v_mul_f32 v27, v21, v27
    ds_add_f32 v20, v24
    ds_add_f32 v20, v25 offset:4
    ds_add_f32 v20, v26 offset:8
    ds_add_f32 v20, v27 offset:12
    s_branch L_p2_srec
L_p2_sdone:
    s_mov_b64 exec, -1
    s_cmp_eq_u32 s24, 7
    s_cselect_b32 s14, 16370, 2
    s_add_u32 s25, s25, s14
    s_add_u32 s22, s22, 80000
    s_add_u32 s24, s24, 1
    s_cmp_lt_u32 s24, 16
    s_cbranch_scc1 L_p2_sstep
    s_waitcnt lgkmcnt(0)
    s_barrier
    s_mul_i32 s14, s12, 10240000
    s_mul_i32 s15, s3, 160000
    s_add_u32 s26, s14, s15
    s_add_u32 s26, s26, 280470016
    v_mov_b32 v12, v1
    s_mov_b32 s24, 0
L_p2_sout:
    v_cmp_gt_u32 vcc, 160000, v12
    ds_read_b128 v[8:11], v12
    s_nop 0
    s_and_b64 exec, exec, vcc
    s_cbranch_execz L_p2_sfin
    s_waitcnt lgkmcnt(0)
    buffer_store_dwordx4 v[8:11], v12, s[4:7], s26 offen sc1
    s_waitcnt vmcnt(0)
    v_add_u32 v12, 16384, v12
    s_branch L_p2_sout
L_p2_sfin:
    s_mov_b64 exec, -1
    s_waitcnt vmcnt(0) lgkmcnt(0)
    s_barrier
    s_branch L_p2_signal
L_p2_end:
    s_endpgm
.section .rodata,"a"
.p2align 6
.amdhsa_kernel p1_kernel
  .amdhsa_next_free_vgpr 128
  .amdhsa_next_free_sgpr 96
  .amdhsa_accum_offset 128
  .amdhsa_group_segment_fixed_size 0
  .amdhsa_kernarg_size 112
  .amdhsa_user_sgpr_count 2
  .amdhsa_user_sgpr_kernarg_segment_ptr 1
  .amdhsa_system_sgpr_workgroup_id_x 1
  .amdhsa_float_denorm_mode_32 0
.end_amdhsa_kernel
.p2align 6
.amdhsa_kernel p2_kernel
  .amdhsa_next_free_vgpr 128
  .amdhsa_next_free_sgpr 102
  .amdhsa_accum_offset 128
  .amdhsa_group_segment_fixed_size 0
  .amdhsa_kernarg_size 112
  .amdhsa_user_sgpr_count 2
  .amdhsa_user_sgpr_kernarg_segment_ptr 1
  .amdhsa_system_sgpr_workgroup_id_x 1
  .amdhsa_float_denorm_mode_32 0
.end_amdhsa_kernel
```

```asm
; @launch kernel=p1_kernel grid=(256,1,1) block=(1024,1,1) lds=163840
; @launch kernel=p2_kernel grid=(256,1,1) block=(1024,1,1) lds=163840
.amdgcn_target "amdgcn-amd-amdhsa--gfx950"
.text
.globl p1_kernel
.p2align 8
.type p1_kernel,@function
p1_kernel:
    s_cmp_ge_u32 s2, 256
    s_cbranch_scc1 L_p1_end
    s_load_dwordx2 s[4:5], s[0:1], 104
    s_load_dwordx2 s[8:9], s[0:1], 8
    s_load_dwordx2 s[12:13], s[0:1], 16
    s_load_dwordx2 s[16:17], s[0:1], 32
    s_load_dwordx2 s[28:29], s[0:1], 0
    s_load_dwordx2 s[6:7], s[0:1], 48
    v_lshlrev_b32 v1, 4, v0
    v_lshlrev_b32 v2, 3, v0
    v_lshrrev_b32 v6, 6, v0
    v_mul_u32_u24 v3, 768, v6
    v_add_lshl_u32 v3, v3, v0, 4
    v_mov_b32 v4, 1
    v_mov_b32 v5, 0
    v_readfirstlane_b32 s39, v6
    v_cmp_gt_u32 vcc, 784, v0
    s_mov_b32 s32, s2
    s_lshl_b32 s33, s2, 14
    s_lshl_b32 s34, s2, 13
    s_mul_i32 s48, s2, 3840
    s_mul_i32 s49, s2, 1920
    s_mov_b64 s[44:45], vcc
    s_waitcnt lgkmcnt(0)
    s_load_dword s3, s[6:7], 0
    s_mov_b32 s10, 163840000
    s_mov_b32 s11, 0x00020000
    s_mov_b32 s14, 163840000
    s_mov_b32 s15, 0x00020000
    s_mov_b32 s18, 81920000
    s_mov_b32 s19, 0x00020000
    s_mul_i32 s36, s2, 20000
    s_add_u32 s30, s36, 20000
    s_mov_b32 s31, 0x00020000
    s_add_u32 s35, s36, 16384
    buffer_load_dwordx4 v[48:51], v1, s[28:31], s36 offen nt
    buffer_load_dwordx4 v[52:55], v1, s[28:31], s35 offen nt
    s_add_u32 s35, s33, 0
    buffer_load_dwordx4 v[16:19], v1, s[8:11], s35 offen nt
    s_add_u32 s35, s33, 0
    buffer_load_dwordx4 v[20:23], v1, s[12:15], s35 offen nt
    s_add_u32 s35, s33, 4194304
    buffer_load_dwordx4 v[24:27], v1, s[8:11], s35 offen nt
    s_add_u32 s35, s33, 4194304
    buffer_load_dwordx4 v[28:31], v1, s[12:15], s35 offen nt
    s_add_u32 s35, s33, 8388608
    buffer_load_dwordx4 v[32:35], v1, s[8:11], s35 offen nt
    s_add_u32 s35, s33, 8388608
    buffer_load_dwordx4 v[36:39], v1, s[12:15], s35 offen nt
    s_add_u32 s35, s33, 12582912
    buffer_load_dwordx4 v[40:43], v1, s[8:11], s35 offen nt
    s_add_u32 s35, s33, 12582912
    buffer_load_dwordx4 v[44:47], v1, s[12:15], s35 offen nt
    s_mov_b32 s20, s4
    s_mov_b32 s21, s5
    s_mov_b32 s22, 0
    s_mov_b32 s23, 0x00020000
    s_add_u32 s24, s4, 219029504
    s_addc_u32 s25, s5, 0
    s_mov_b32 s26, 8577536
    s_mov_b32 s27, 0x00020000
    s_mov_b32 s37, 1492179184
    s_mov_b32 s55, 0
    s_mov_b32 s50, 21845
    s_mov_b32 s38, 262400
    s_mov_b32 s43, 0x05040100
    s_mov_b32 s40, 0
    v_mov_b32 v8, 0
    v_mov_b32 v9, 0
    v_mov_b32 v10, 0
    v_mov_b32 v11, 0
    ds_write_b128 v1, v[8:11] offset:0
    s_waitcnt lgkmcnt(0)
    s_lshl_b32 s3, s3, 16
    v_mov_b32 v12, s3
    v_mul_f32 v12, 0.15915494, v12
    s_nop 0
    v_readfirstlane_b32 s41, v12
    s_waitcnt vmcnt(8)
    s_add_u32 s28, s4, 227607040
    s_addc_u32 s29, s5, 0
    s_mul_i32 s36, s2, 20000
    s_add_u32 s35, s36, 16384
    buffer_store_dwordx4 v[48:51], v1, s[28:31], s36 offen
    buffer_store_dwordx4 v[52:55], v1, s[28:31], s35 offen
    s_nop 0
    v_mov_b32 v12, 0x3f803f80
    v_and_b32 v48, 0x7fff7fff, v48
    v_and_b32 v49, 0x7fff7fff, v49
    v_and_b32 v50, 0x7fff7fff, v50
    v_and_b32 v51, 0x7fff7fff, v51
    v_and_b32 v52, 0x7fff7fff, v52
    v_and_b32 v53, 0x7fff7fff, v53
    v_and_b32 v54, 0x7fff7fff, v54
    v_and_b32 v55, 0x7fff7fff, v55
    v_pk_max_u16 v8, v8, v48
    v_dot2c_f32_bf16 v9, v48, v12
    v_pk_max_u16 v8, v8, v49
    v_dot2c_f32_bf16 v9, v49, v12
    v_pk_max_u16 v8, v8, v50
    v_dot2c_f32_bf16 v9, v50, v12
    v_pk_max_u16 v8, v8, v51
    v_dot2c_f32_bf16 v9, v51, v12
    v_pk_max_u16 v8, v8, v52
    v_dot2c_f32_bf16 v9, v52, v12
    v_pk_max_u16 v8, v8, v53
    v_dot2c_f32_bf16 v9, v53, v12
    v_pk_max_u16 v8, v8, v54
    v_dot2c_f32_bf16 v9, v54, v12
    v_pk_max_u16 v8, v8, v55
    v_dot2c_f32_bf16 v9, v55, v12
    v_lshrrev_b32 v10, 16, v8
    v_and_b32 v8, 0xffff, v8
    v_max_u32 v8, v8, v10
    s_nop 0
    s_nop 1
    v_max_u32_dpp v8, v8, v8 row_shr:1 row_mask:0xf bank_mask:0xf bound_ctrl:0
    s_nop 1
    v_max_u32_dpp v8, v8, v8 row_shr:2 row_mask:0xf bank_mask:0xf bound_ctrl:0
    s_nop 1
    v_max_u32_dpp v8, v8, v8 row_shr:4 row_mask:0xf bank_mask:0xf bound_ctrl:0
    s_nop 1
    v_max_u32_dpp v8, v8, v8 row_shr:8 row_mask:0xf bank_mask:0xf bound_ctrl:0
    s_nop 1
    v_max_u32_dpp v8, v8, v8 row_bcast:15 row_mask:0xa bank_mask:0xf
    s_nop 1
    v_max_u32_dpp v8, v8, v8 row_bcast:31 row_mask:0xc bank_mask:0xf
    s_nop 1
    v_add_f32_dpp v9, v9, v9 row_shr:1 row_mask:0xf bank_mask:0xf bound_ctrl:0
    s_nop 1
    v_add_f32_dpp v9, v9, v9 row_shr:2 row_mask:0xf bank_mask:0xf bound_ctrl:0
    s_nop 1
    v_add_f32_dpp v9, v9, v9 row_shr:4 row_mask:0xf bank_mask:0xf bound_ctrl:0
    s_nop 1
    v_add_f32_dpp v9, v9, v9 row_shr:8 row_mask:0xf bank_mask:0xf bound_ctrl:0
    s_nop 1
    v_add_f32_dpp v9, v9, v9 row_bcast:15 row_mask:0xa bank_mask:0xf
    s_nop 1
    v_add_f32_dpp v9, v9, v9 row_bcast:31 row_mask:0xc bank_mask:0xf
    s_lshl_b32 s35, s39, 4
    s_add_u32 s35, s35, 160320
    v_mov_b32 v10, s35
    s_mov_b32 exec_lo, 0
    s_brev_b32 exec_hi, 1
    ds_write_b64 v10, v[8:9]
    s_mov_b64 exec, -1
    s_waitcnt lgkmcnt(0)
    s_barrier
    s_branch L_p1_first
L_p1_loop:
    s_cmp_lg_u32 s39, 15
    s_cbranch_scc1 L_p1_kernel_nox_1
    s_mov_b32 s36, 13312
    buffer_store_dwordx4 v[12:15], v3, s[20:23], s36 offen sc1
L_p1_kernel_nox_1:
    s_mov_b32 s36, 6144
    buffer_store_dwordx4 v[72:75], v3, s[20:23], s36 offen sc1
    s_mov_b32 s36, 7168
    buffer_store_dwordx4 v[76:79], v3, s[20:23], s36 offen sc1
    s_mov_b32 s36, 0
    buffer_store_dwordx4 v[48:51], v3, s[20:23], s36 offen sc1
    s_add_u32 s35, s33, 16777216
    buffer_load_dwordx4 v[72:75], v1, s[8:11], s35 offen nt
    s_add_u32 s35, s33, 16777216
    buffer_load_dwordx4 v[76:79], v1, s[12:15], s35 offen nt
    s_mov_b32 s36, 8192
    buffer_store_dwordx4 v[80:83], v3, s[20:23], s36 offen sc1
    s_mov_b32 s36, 1024
    buffer_store_dwordx4 v[52:55], v3, s[20:23], s36 offen sc1
    s_add_u32 s35, s33, 20971520
    buffer_load_dwordx4 v[80:83], v1, s[8:11], s35 offen nt
    s_add_u32 s35, s33, 20971520
    buffer_load_dwordx4 v[100:103], v1, s[12:15], s35 offen nt
    s_mov_b32 s36, 9216
    buffer_store_dwordx4 v[84:87], v3, s[20:23], s36 offen sc1
    s_mov_b32 s36, 2048
    buffer_store_dwordx4 v[56:59], v3, s[20:23], s36 offen sc1
    s_add_u32 s35, s33, 25165824
    buffer_load_dwordx4 v[84:87], v1, s[8:11], s35 offen nt
    s_add_u32 s35, s33, 25165824
    buffer_load_dwordx4 v[104:107], v1, s[12:15], s35 offen nt
    s_mov_b32 s36, 10240
    buffer_store_dwordx4 v[88:91], v3, s[20:23], s36 offen sc1
    s_mov_b32 s36, 3072
    buffer_store_dwordx4 v[60:63], v3, s[20:23], s36 offen sc1
    s_add_u32 s35, s33, 29360128
    buffer_load_dwordx4 v[88:91], v1, s[8:11], s35 offen nt
    s_add_u32 s35, s33, 29360128
    buffer_load_dwordx4 v[108:111], v1, s[12:15], s35 offen nt
    s_mov_b32 s36, 11264
    buffer_store_dwordx4 v[92:95], v3, s[20:23], s36 offen sc1
    s_mov_b32 s36, 4096
    buffer_store_dwordx4 v[64:67], v3, s[20:23], s36 offen sc1
    s_add_u32 s35, s33, 33554432
    buffer_load_dwordx4 v[92:95], v1, s[8:11], s35 offen nt
    s_add_u32 s35, s33, 33554432
    buffer_load_dwordx4 v[112:115], v1, s[12:15], s35 offen nt
    s_mov_b32 s36, 12288
    buffer_store_dwordx4 v[96:99], v3, s[20:23], s36 offen sc1
    s_mov_b32 s36, 5120
    buffer_store_dwordx4 v[68:71], v3, s[20:23], s36 offen sc1
    s_add_u32 s35, s33, 37748736
    s_sub_u32 s35, s35, s48
    v_cndmask_b32 v96, 2.0, v1, s[44:45]
    buffer_load_dwordx4 v[96:99], v96, s[8:11], s35 offen nt
    s_add_u32 s35, s33, 37748736
    s_sub_u32 s35, s35, s48
    v_cndmask_b32 v116, 2.0, v1, s[44:45]
    buffer_load_dwordx4 v[116:119], v116, s[12:15], s35 offen nt
    s_branch L_p1_join
L_p1_first:
    s_add_u32 s35, s33, 16777216
    buffer_load_dwordx4 v[72:75], v1, s[8:11], s35 offen nt
    s_add_u32 s35, s33, 16777216
    buffer_load_dwordx4 v[76:79], v1, s[12:15], s35 offen nt
    s_add_u32 s35, s33, 20971520
    buffer_load_dwordx4 v[80:83], v1, s[8:11], s35 offen nt
    s_add_u32 s35, s33, 20971520
    buffer_load_dwordx4 v[100:103], v1, s[12:15], s35 offen nt
    s_add_u32 s35, s33, 25165824
    buffer_load_dwordx4 v[84:87], v1, s[8:11], s35 offen nt
    s_add_u32 s35, s33, 25165824
    buffer_load_dwordx4 v[104:107], v1, s[12:15], s35 offen nt
    s_add_u32 s35, s33, 29360128
    buffer_load_dwordx4 v[88:91], v1, s[8:11], s35 offen nt
    s_add_u32 s35, s33, 29360128
    buffer_load_dwordx4 v[108:111], v1, s[12:15], s35 offen nt
    s_add_u32 s35, s33, 33554432
    buffer_load_dwordx4 v[92:95], v1, s[8:11], s35 offen nt
    s_add_u32 s35, s33, 33554432
    buffer_load_dwordx4 v[112:115], v1, s[12:15], s35 offen nt
    s_add_u32 s35, s33, 37748736
    s_sub_u32 s35, s35, s48
    v_cndmask_b32 v96, 2.0, v1, s[44:45]
    buffer_load_dwordx4 v[96:99], v96, s[8:11], s35 offen nt
    s_add_u32 s35, s33, 37748736
    s_sub_u32 s35, s35, s48
    v_cndmask_b32 v116, 2.0, v1, s[44:45]
    buffer_load_dwordx4 v[116:119], v116, s[12:15], s35 offen nt
L_p1_join:
    s_waitcnt vmcnt(18)
    v_perm_b32 v6, v20, v16, s43
    v_perm_b32 v7, v21, v17, s43
    v_perm_b32 v8, v22, v18, s43
    v_perm_b32 v9, v23, v19, s43
    v_mul_hi_u32_u24 v16, 429497, v16
    v_mul_hi_u32_u24 v20, 429497, v20
    v_mul_hi_u32_u24 v17, 429497, v17
    v_mul_hi_u32_u24 v21, 429497, v21
    v_mul_hi_u32_u24 v18, 429497, v18
    v_mul_hi_u32_u24 v22, 429497, v22
    v_mul_hi_u32_u24 v19, 429497, v19
    v_mul_hi_u32_u24 v23, 429497, v23
    v_lshl_or_b32 v16, v20, 16, v16
    v_lshl_or_b32 v17, v21, 16, v17
    v_lshl_or_b32 v18, v22, 16, v18
    v_lshl_or_b32 v19, v23, 16, v19
    v_dot2_u32_u16 v20, v16, s38, 0
    v_dot2_u32_u16 v21, v17, s38, 0
    v_dot2_u32_u16 v22, v18, s38, 0
    v_dot2_u32_u16 v23, v19, s38, 0
    v_pk_mad_u16 v6, v16, s37, v6
    v_pk_mad_u16 v7, v17, s37, v7
    v_pk_mad_u16 v8, v18, s37, v8
    v_pk_mad_u16 v9, v19, s37, v9
    ds_add_u32 v20, v4 offset:0
    ds_add_u32 v21, v4 offset:0
    ds_add_u32 v22, v4 offset:0
    ds_add_u32 v23, v4 offset:0
    v_perm_b32 v55, v23, v22, s43
    v_perm_b32 v51, v21, v20, s43
    v_or_b32 v48, 0x40000000, v6
    v_or_b32 v49, 0x40000000, v7
    v_or_b32 v50, 0x40000000, v8
    v_or_b32 v52, 0x40000000, v9
    s_waitcnt vmcnt(16)
    v_perm_b32 v6, v28, v24, s43
    v_perm_b32 v7, v29, v25, s43
    v_perm_b32 v8, v30, v26, s43
    v_perm_b32 v9, v31, v27, s43
    v_mul_hi_u32_u24 v24, 429497, v24
    v_mul_hi_u32_u24 v28, 429497, v28
    v_mul_hi_u32_u24 v25, 429497, v25
    v_mul_hi_u32_u24 v29, 429497, v29
    v_mul_hi_u32_u24 v26, 429497, v26
    v_mul_hi_u32_u24 v30, 429497, v30
    v_mul_hi_u32_u24 v27, 429497, v27
    v_mul_hi_u32_u24 v31, 429497, v31
    v_lshl_or_b32 v24, v28, 16, v24
    v_lshl_or_b32 v25, v29, 16, v25
    v_lshl_or_b32 v26, v30, 16, v26
    v_lshl_or_b32 v27, v31, 16, v27
    v_dot2_u32_u16 v28, v24, s38, 0
    v_dot2_u32_u16 v29, v25, s38, 0
    v_dot2_u32_u16 v30, v26, s38, 0
    v_dot2_u32_u16 v31, v27, s38, 0
    v_pk_mad_u16 v6, v24, s37, v6
    v_pk_mad_u16 v7, v25, s37, v7
    v_pk_mad_u16 v8, v26, s37, v8
    v_pk_mad_u16 v9, v27, s37, v9
    ds_add_u32 v28, v4 offset:0
    ds_add_u32 v29, v4 offset:0
    ds_add_u32 v30, v4 offset:0
    ds_add_u32 v31, v4 offset:0
    v_perm_b32 v63, v31, v30, s43
    v_perm_b32 v59, v29, v28, s43
    v_or_b32 v53, 0x40000000, v6
    v_or_b32 v54, 0x40000000, v7
    v_or_b32 v56, 0x40000000, v8
    v_or_b32 v57, 0x40000000, v9
    s_waitcnt vmcnt(14)
    v_perm_b32 v6, v36, v32, s43
    v_perm_b32 v7, v37, v33, s43
    v_perm_b32 v8, v38, v34, s43
    v_perm_b32 v9, v39, v35, s43
    v_mul_hi_u32_u24 v32, 429497, v32
    v_mul_hi_u32_u24 v36, 429497, v36
    v_mul_hi_u32_u24 v33, 429497, v33
    v_mul_hi_u32_u24 v37, 429497, v37
    v_mul_hi_u32_u24 v34, 429497, v34
    v_mul_hi_u32_u24 v38, 429497, v38
    v_mul_hi_u32_u24 v35, 429497, v35
    v_mul_hi_u32_u24 v39, 429497, v39
    v_lshl_or_b32 v32, v36, 16, v32
    v_lshl_or_b32 v33, v37, 16, v33
    v_lshl_or_b32 v34, v38, 16, v34
    v_lshl_or_b32 v35, v39, 16, v35
    v_dot2_u32_u16 v36, v32, s38, 0
    v_dot2_u32_u16 v37, v33, s38, 0
    v_dot2_u32_u16 v38, v34, s38, 0
    v_dot2_u32_u16 v39, v35, s38, 0
    v_pk_mad_u16 v6, v32, s37, v6
    v_pk_mad_u16 v7, v33, s37, v7
    v_pk_mad_u16 v8, v34, s37, v8
    v_pk_mad_u16 v9, v35, s37, v9
    ds_add_u32 v36, v4 offset:0
    ds_add_u32 v37, v4 offset:0
    ds_add_u32 v38, v4 offset:0
    ds_add_u32 v39, v4 offset:0
    v_perm_b32 v71, v39, v38, s43
    v_perm_b32 v67, v37, v36, s43
    v_or_b32 v58, 0x40000000, v6
    v_or_b32 v60, 0x40000000, v7
    v_or_b32 v61, 0x40000000, v8
    v_or_b32 v62, 0x40000000, v9
    s_waitcnt vmcnt(12)
    v_perm_b32 v6, v44, v40, s43
    v_perm_b32 v7, v45, v41, s43
    v_perm_b32 v8, v46, v42, s43
    v_perm_b32 v9, v47, v43, s43
    v_mul_hi_u32_u24 v40, 429497, v40
    v_mul_hi_u32_u24 v44, 429497, v44
    v_mul_hi_u32_u24 v41, 429497, v41
    v_mul_hi_u32_u24 v45, 429497, v45
    v_mul_hi_u32_u24 v42, 429497, v42
    v_mul_hi_u32_u24 v46, 429497, v46
    v_mul_hi_u32_u24 v43, 429497, v43
    v_mul_hi_u32_u24 v47, 429497, v47
    v_lshl_or_b32 v40, v44, 16, v40
    v_lshl_or_b32 v41, v45, 16, v41
    v_lshl_or_b32 v42, v46, 16, v42
    v_lshl_or_b32 v43, v47, 16, v43
    v_dot2_u32_u16 v44, v40, s38, 0
    v_dot2_u32_u16 v45, v41, s38, 0
    v_dot2_u32_u16 v46, v42, s38, 0
    v_dot2_u32_u16 v47, v43, s38, 0
    v_pk_mad_u16 v6, v40, s37, v6
    v_pk_mad_u16 v7, v41, s37, v7
    v_pk_mad_u16 v8, v42, s37, v8
    v_pk_mad_u16 v9, v43, s37, v9
    ds_add_u32 v44, v4 offset:0
    ds_add_u32 v45, v4 offset:0
    ds_add_u32 v46, v4 offset:0
    ds_add_u32 v47, v4 offset:0
    v_perm_b32 v121, v47, v46, s43
    v_perm_b32 v120, v45, v44, s43
    v_or_b32 v64, 0x40000000, v6
    v_or_b32 v65, 0x40000000, v7
    v_or_b32 v66, 0x40000000, v8
    v_or_b32 v68, 0x40000000, v9
    s_waitcnt vmcnt(10)
    v_perm_b32 v6, v76, v72, s43
    v_perm_b32 v7, v77, v73, s43
    v_perm_b32 v8, v78, v74, s43
    v_perm_b32 v9, v79, v75, s43
    v_mul_hi_u32_u24 v72, 429497, v72
    v_mul_hi_u32_u24 v76, 429497, v76
    v_mul_hi_u32_u24 v73, 429497, v73
    v_mul_hi_u32_u24 v77, 429497, v77
    v_mul_hi_u32_u24 v74, 429497, v74
    v_mul_hi_u32_u24 v78, 429497, v78
    v_mul_hi_u32_u24 v75, 429497, v75
    v_mul_hi_u32_u24 v79, 429497, v79
    v_lshl_or_b32 v72, v76, 16, v72
    v_lshl_or_b32 v73, v77, 16, v73
    v_lshl_or_b32 v74, v78, 16, v74
    v_lshl_or_b32 v75, v79, 16, v75
    v_dot2_u32_u16 v76, v72, s38, 0
    v_dot2_u32_u16 v77, v73, s38, 0
    v_dot2_u32_u16 v78, v74, s38, 0
    v_dot2_u32_u16 v79, v75, s38, 0
    v_pk_mad_u16 v6, v72, s37, v6
    v_pk_mad_u16 v7, v73, s37, v7
    v_pk_mad_u16 v8, v74, s37, v8
    v_pk_mad_u16 v9, v75, s37, v9
    ds_add_u32 v76, v4 offset:0
    ds_add_u32 v77, v4 offset:0
    ds_add_u32 v78, v4 offset:0
    ds_add_u32 v79, v4 offset:0
    v_perm_b32 v123, v79, v78, s43
    v_perm_b32 v122, v77, v76, s43
    v_or_b32 v69, 0x40000000, v6
    v_or_b32 v70, 0x40000000, v7
    v_or_b32 v127, 0x40000000, v8
    v_or_b32 v72, 0x40000000, v9
    s_waitcnt vmcnt(8)
    v_perm_b32 v6, v100, v80, s43
    v_perm_b32 v7, v101, v81, s43
    v_perm_b32 v8, v102, v82, s43
    v_perm_b32 v9, v103, v83, s43
    v_mul_hi_u32_u24 v80, 429497, v80
    v_mul_hi_u32_u24 v100, 429497, v100
    v_mul_hi_u32_u24 v81, 429497, v81
    v_mul_hi_u32_u24 v101, 429497, v101
    v_mul_hi_u32_u24 v82, 429497, v82
    v_mul_hi_u32_u24 v102, 429497, v102
    v_mul_hi_u32_u24 v83, 429497, v83
    v_mul_hi_u32_u24 v103, 429497, v103
    v_lshl_or_b32 v80, v100, 16, v80
    v_lshl_or_b32 v81, v101, 16, v81
    v_lshl_or_b32 v82, v102, 16, v82
    v_lshl_or_b32 v83, v103, 16, v83
    v_dot2_u32_u16 v100, v80, s38, 0
    v_dot2_u32_u16 v101, v81, s38, 0
    v_dot2_u32_u16 v102, v82, s38, 0
    v_dot2_u32_u16 v103, v83, s38, 0
    v_pk_mad_u16 v6, v80, s37, v6
    v_pk_mad_u16 v7, v81, s37, v7
    v_pk_mad_u16 v8, v82, s37, v8
    v_pk_mad_u16 v9, v83, s37, v9
    ds_add_u32 v100, v4 offset:0
    ds_add_u32 v101, v4 offset:0
    ds_add_u32 v102, v4 offset:0
    ds_add_u32 v103, v4 offset:0
    v_perm_b32 v125, v103, v102, s43
    v_perm_b32 v124, v101, v100, s43
    v_or_b32 v73, 0x40000000, v6
    v_or_b32 v74, 0x40000000, v7
    v_or_b32 v76, 0x40000000, v8
    v_or_b32 v77, 0x40000000, v9
    s_waitcnt vmcnt(6)
    v_perm_b32 v6, v104, v84, s43
    v_perm_b32 v7, v105, v85, s43
    v_perm_b32 v8, v106, v86, s43
    v_perm_b32 v9, v107, v87, s43
    v_mul_hi_u32_u24 v84, 429497, v84
    v_mul_hi_u32_u24 v104, 429497, v104
    v_mul_hi_u32_u24 v85, 429497, v85
    v_mul_hi_u32_u24 v105, 429497, v105
    v_mul_hi_u32_u24 v86, 429497, v86
    v_mul_hi_u32_u24 v106, 429497, v106
    v_mul_hi_u32_u24 v87, 429497, v87
    v_mul_hi_u32_u24 v107, 429497, v107
    v_lshl_or_b32 v84, v104, 16, v84
    v_lshl_or_b32 v85, v105, 16, v85
    v_lshl_or_b32 v86, v106, 16, v86
    v_lshl_or_b32 v87, v107, 16, v87
    v_dot2_u32_u16 v104, v84, s38, 0
    v_dot2_u32_u16 v105, v85, s38, 0
    v_dot2_u32_u16 v106, v86, s38, 0
    v_dot2_u32_u16 v107, v87, s38, 0
    v_pk_mad_u16 v6, v84, s37, v6
    v_pk_mad_u16 v7, v85, s37, v7
    v_pk_mad_u16 v8, v86, s37, v8
    v_pk_mad_u16 v9, v87, s37, v9
    ds_add_u32 v104, v4 offset:0
    ds_add_u32 v105, v4 offset:0
    ds_add_u32 v106, v4 offset:0
    ds_add_u32 v107, v4 offset:0
    v_perm_b32 v75, v107, v106, s43
    v_perm_b32 v126, v105, v104, s43
    v_or_b32 v78, 0x40000000, v6
    v_or_b32 v80, 0x40000000, v7
    v_or_b32 v81, 0x40000000, v8
    v_or_b32 v82, 0x40000000, v9
    s_waitcnt vmcnt(4)
    v_perm_b32 v6, v108, v88, s43
    v_perm_b32 v7, v109, v89, s43
    v_perm_b32 v8, v110, v90, s43
    v_perm_b32 v9, v111, v91, s43
    v_mul_hi_u32_u24 v88, 429497, v88
    v_mul_hi_u32_u24 v108, 429497, v108
    v_mul_hi_u32_u24 v89, 429497, v89
    v_mul_hi_u32_u24 v109, 429497, v109
    v_mul_hi_u32_u24 v90, 429497, v90
    v_mul_hi_u32_u24 v110, 429497, v110
    v_mul_hi_u32_u24 v91, 429497, v91
    v_mul_hi_u32_u24 v111, 429497, v111
    v_lshl_or_b32 v88, v108, 16, v88
    v_lshl_or_b32 v89, v109, 16, v89
    v_lshl_or_b32 v90, v110, 16, v90
    v_lshl_or_b32 v91, v111, 16, v91
    v_dot2_u32_u16 v108, v88, s38, 0
    v_dot2_u32_u16 v109, v89, s38, 0
    v_dot2_u32_u16 v110, v90, s38, 0
    v_dot2_u32_u16 v111, v91, s38, 0
    v_pk_mad_u16 v6, v88, s37, v6
    v_pk_mad_u16 v7, v89, s37, v7
    v_pk_mad_u16 v8, v90, s37, v8
    v_pk_mad_u16 v9, v91, s37, v9
    ds_add_u32 v108, v4 offset:0
    ds_add_u32 v109, v4 offset:0
    ds_add_u32 v110, v4 offset:0
    ds_add_u32 v111, v4 offset:0
    v_perm_b32 v83, v111, v110, s43
    v_perm_b32 v79, v109, v108, s43
    v_or_b32 v84, 0x40000000, v6
    v_or_b32 v85, 0x40000000, v7
    v_or_b32 v86, 0x40000000, v8
    v_or_b32 v88, 0x40000000, v9
    s_waitcnt vmcnt(2)
    v_perm_b32 v6, v112, v92, s43
    v_perm_b32 v7, v113, v93, s43
    v_perm_b32 v8, v114, v94, s43
    v_perm_b32 v9, v115, v95, s43
    v_mul_hi_u32_u24 v92, 429497, v92
    v_mul_hi_u32_u24 v112, 429497, v112
    v_mul_hi_u32_u24 v93, 429497, v93
    v_mul_hi_u32_u24 v113, 429497, v113
    v_mul_hi_u32_u24 v94, 429497, v94
    v_mul_hi_u32_u24 v114, 429497, v114
    v_mul_hi_u32_u24 v95, 429497, v95
    v_mul_hi_u32_u24 v115, 429497, v115
    v_lshl_or_b32 v92, v112, 16, v92
    v_lshl_or_b32 v93, v113, 16, v93
    v_lshl_or_b32 v94, v114, 16, v94
    v_lshl_or_b32 v95, v115, 16, v95
    v_dot2_u32_u16 v112, v92, s38, 0
    v_dot2_u32_u16 v113, v93, s38, 0
    v_dot2_u32_u16 v114, v94, s38, 0
    v_dot2_u32_u16 v115, v95, s38, 0
    v_pk_mad_u16 v6, v92, s37, v6
    v_pk_mad_u16 v7, v93, s37, v7
    v_pk_mad_u16 v8, v94, s37, v8
    v_pk_mad_u16 v9, v95, s37, v9
    ds_add_u32 v112, v4 offset:0
    ds_add_u32 v113, v4 offset:0
    ds_add_u32 v114, v4 offset:0
    ds_add_u32 v115, v4 offset:0
    v_perm_b32 v91, v115, v114, s43
    v_perm_b32 v87, v113, v112, s43
    v_or_b32 v89, 0x40000000, v6
    v_or_b32 v90, 0x40000000, v7
    v_or_b32 v92, 0x40000000, v8
    v_or_b32 v93, 0x40000000, v9
    s_waitcnt vmcnt(0)
    s_mov_b64 exec, s[44:45]
    v_perm_b32 v6, v116, v96, s43
    v_perm_b32 v7, v117, v97, s43
    v_perm_b32 v8, v118, v98, s43
    v_perm_b32 v9, v119, v99, s43
    v_mul_hi_u32_u24 v96, 429497, v96
    v_mul_hi_u32_u24 v116, 429497, v116
    v_mul_hi_u32_u24 v97, 429497, v97
    v_mul_hi_u32_u24 v117, 429497, v117
    v_mul_hi_u32_u24 v98, 429497, v98
    v_mul_hi_u32_u24 v118, 429497, v118
    v_mul_hi_u32_u24 v99, 429497, v99
    v_mul_hi_u32_u24 v119, 429497, v119
    v_lshl_or_b32 v96, v116, 16, v96
    v_lshl_or_b32 v97, v117, 16, v97
    v_lshl_or_b32 v98, v118, 16, v98
    v_lshl_or_b32 v99, v119, 16, v99
    v_dot2_u32_u16 v116, v96, s38, 0
    v_dot2_u32_u16 v117, v97, s38, 0
    v_dot2_u32_u16 v118, v98, s38, 0
    v_dot2_u32_u16 v119, v99, s38, 0
    v_pk_mad_u16 v6, v96, s37, v6
    v_pk_mad_u16 v7, v97, s37, v7
    v_pk_mad_u16 v8, v98, s37, v8
    v_pk_mad_u16 v9, v99, s37, v9
    ds_add_u32 v116, v4 offset:0
    ds_add_u32 v117, v4 offset:0
    ds_add_u32 v118, v4 offset:0
    ds_add_u32 v119, v4 offset:0
    v_perm_b32 v99, v119, v118, s43
    v_perm_b32 v95, v117, v116, s43
    v_or_b32 v94, 0x40000000, v6
    v_or_b32 v96, 0x40000000, v7
    v_or_b32 v97, 0x40000000, v8
    v_or_b32 v98, 0x40000000, v9
    s_mov_b64 exec, -1
    s_add_u32 s35, s34, 0
    buffer_load_dwordx2 v[100:101], v2, s[16:19], s35 offen nt
    s_add_u32 s35, s34, 2097152
    buffer_load_dwordx2 v[102:103], v2, s[16:19], s35 offen nt
    s_add_u32 s35, s34, 4194304
    buffer_load_dwordx2 v[104:105], v2, s[16:19], s35 offen nt
    s_and_b32 s35, s32, 15
    s_lshl_b32 s35, s35, 6
    s_lshr_b32 s36, s32, 4
    s_add_u32 s35, s35, s36
    s_lshl_b32 s42, s35, 4
    s_mul_i32 s35, s35, 213888
    s_add_u32 s35, s35, 8192
    s_add_u32 s20, s4, s35
    s_addc_u32 s21, s5, 0
    s_waitcnt lgkmcnt(0)
    s_barrier
    ds_read_b128 v[8:11], v1 offset:0
    s_add_u32 s35, s34, 6291456
    buffer_load_dwordx2 v[106:107], v2, s[16:19], s35 offen nt
    s_lshl_b32 s35, s39, 2
    s_add_u32 s35, s35, 160256
    v_mov_b32 v7, s35
    v_and_b32 v14, 15, v0
    v_lshlrev_b32 v14, 2, v14
    v_add_u32 v14, 160256, v14
    s_waitcnt lgkmcnt(0)
    v_cmp_eq_u32 s[56:57], 0, v8
    v_cmp_ge_u32 s[64:65], 1, v8
    v_max_u32 v12, 2, v8
    v_lshl_or_b32 v8, v8, 16, v12
    v_cmp_eq_u32 s[58:59], 0, v9
    v_cmp_ge_u32 s[66:67], 1, v9
    v_max_u32 v12, 2, v9
    v_lshl_or_b32 v9, v9, 16, v12
    v_cmp_eq_u32 s[60:61], 0, v10
    v_cmp_ge_u32 s[68:69], 1, v10
    v_max_u32 v12, 2, v10
    v_lshl_or_b32 v10, v10, 16, v12
    v_cmp_eq_u32 s[62:63], 0, v11
    v_cmp_ge_u32 s[70:71], 1, v11
    v_max_u32 v12, 2, v11
    v_lshl_or_b32 v11, v11, 16, v12
    v_add_u32 v9, v8, v9
    v_add_u32 v10, v9, v10
    v_add_u32 v11, v10, v11
    v_mov_b32 v6, v11
    s_nop 1
    v_add_u32_dpp v6, v6, v6 row_shr:1 row_mask:0xf bank_mask:0xf bound_ctrl:0
    s_nop 1
    v_add_u32_dpp v6, v6, v6 row_shr:2 row_mask:0xf bank_mask:0xf bound_ctrl:0
    s_nop 1
    v_add_u32_dpp v6, v6, v6 row_shr:4 row_mask:0xf bank_mask:0xf bound_ctrl:0
    s_nop 1
    v_add_u32_dpp v6, v6, v6 row_shr:8 row_mask:0xf bank_mask:0xf bound_ctrl:0
    s_nop 1
    v_add_u32_dpp v6, v6, v6 row_bcast:15 row_mask:0xa bank_mask:0xf
    s_nop 1
    v_add_u32_dpp v6, v6, v6 row_bcast:31 row_mask:0xc bank_mask:0xf
    s_mov_b32 exec_lo, 0
    s_brev_b32 exec_hi, 1
    ds_write_b32 v7, v6
    s_mov_b64 exec, -1
    v_sub_u32 v6, v6, v11
    s_or_b64 s[46:47], s[64:65], s[66:67]
    s_or_b64 vcc, s[68:69], s[70:71]
    s_or_b64 s[46:47], s[46:47], vcc
    s_waitcnt lgkmcnt(0)
    s_barrier
    ds_read_b32 v7, v14
    s_add_u32 s35, s34, 8388608
    buffer_load_dwordx2 v[108:109], v2, s[16:19], s35 offen nt
    s_waitcnt lgkmcnt(0)
    v_mov_b32 v15, v7
    s_nop 1
    v_add_u32_dpp v7, v7, v7 row_shr:1 row_mask:0xf bank_mask:0xf bound_ctrl:0
    s_nop 1
    v_add_u32_dpp v7, v7, v7 row_shr:2 row_mask:0xf bank_mask:0xf bound_ctrl:0
    s_nop 1
    v_add_u32_dpp v7, v7, v7 row_shr:4 row_mask:0xf bank_mask:0xf bound_ctrl:0
    s_nop 1
    v_add_u32_dpp v7, v7, v7 row_shr:8 row_mask:0xf bank_mask:0xf bound_ctrl:0
    s_nop 0
    v_readlane_b32 s54, v7, 15
    v_sub_u32 v7, v7, v15
    s_nop 0
    v_readlane_b32 s35, v7, s39
    s_and_b32 s54, s54, 0xffff
    s_cmp_ge_u32 s54, 40063
    s_cselect_b32 s36, 16, 0
    s_cselect_b32 s54, 40000, s54
    s_cselect_b32 s55, 1, s55
    s_cselect_b64 s[46:47], 0, s[46:47]
    v_add_u32 v12, s35, v6
    v_add_u32 v13, v12, v8
    v_add_u32 v14, v12, v9
    v_add_u32 v15, v12, v10
    v_bfe_u32 v12, v12, s36, 16
    v_bfe_u32 v13, v13, s36, 16
    v_bfe_u32 v14, v14, s36, 16
    v_bfe_u32 v15, v15, s36, 16
    ds_write_b128 v1, v[12:15] offset:0
    ds_write_b128 v1, v[12:15] offset:16384
    v_mov_b32 v6, 32768
    v_mov_b32 v7, s54
    s_mov_b64 exec, 1
    ds_write_b32 v6, v7
    s_mov_b64 exec, -1
    s_add_u32 s35, s54, 2
    s_mul_hi_u32 s35, s35, 1431655766
    s_lshl_b32 s35, s35, 4
    s_min_u32 s22, s35, 213888
    v_perm_b32 v15, v15, v14, s43
    v_perm_b32 v14, v13, v12, s43
    s_waitcnt lgkmcnt(0)
    s_barrier
    s_add_u32 s35, s34, 10485760
    buffer_load_dwordx2 v[110:111], v2, s[16:19], s35 offen nt
    v_and_b32 v6, 63, v0
    s_lshl_b32 s35, s39, 10
    v_lshl_add_u32 v7, v6, 2, s35
    v_lshl_add_u32 v12, v6, 8, s35
    ds_read_b32 v8, v7 offset:16384
    ds_read_b32 v9, v7 offset:16640
    ds_read_b32 v10, v7 offset:16896
    ds_read_b32 v11, v7 offset:17152
    s_mov_b64 exec, 15
    ds_read_b32 v12, v12 offset:16640
    s_mov_b64 exec, -1
    s_lshr_b32 s35, s39, 2
    s_mul_i32 s35, s35, 2138240
    s_and_b32 s36, s39, 1
    s_lshl_b32 s36, s36, 3
    s_add_u32 s35, s35, s36
    s_and_b32 s36, s39, 2
    s_lshl_b32 s36, s36, 13
    s_add_u32 s35, s35, s36
    s_add_u32 s35, s35, s42
    s_add_u32 s36, s35, 2105344
    v_mul_u32_u24 v7, 32896, v6
    v_lshlrev_b32 v13, 1, v6
    s_waitcnt lgkmcnt(1)
    v_perm_b32 v8, v9, v8, s43
    v_perm_b32 v9, v11, v10, s43
    buffer_store_dwordx2 v[8:9], v7, s[24:27], s35 offen
    s_waitcnt lgkmcnt(0)
    s_mov_b64 exec, 15
    buffer_store_short v12, v13, s[24:27], s36 offen
    s_mov_b64 exec, -1
    s_nop 0
    v_and_b32 v6, 0xffff, v51
    v_lshrrev_b32 v7, 16, v51
    v_and_b32 v8, 0xffff, v55
    v_lshrrev_b32 v9, 16, v55
    ds_add_rtn_u32 v6, v6, v4 offset:0
    ds_add_rtn_u32 v7, v7, v4 offset:0
    ds_add_rtn_u32 v8, v8, v4 offset:0
    ds_add_rtn_u32 v9, v9, v4 offset:0
    v_and_b32 v10, 0xffff, v59
    v_lshrrev_b32 v11, 16, v59
    v_and_b32 v12, 0xffff, v63
    v_lshrrev_b32 v13, 16, v63
    ds_add_rtn_u32 v10, v10, v4 offset:0
    ds_add_rtn_u32 v11, v11, v4 offset:0
    ds_add_rtn_u32 v12, v12, v4 offset:0
    ds_add_rtn_u32 v13, v13, v4 offset:0
    s_waitcnt lgkmcnt(4)
    v_perm_b32 v51, v7, v6, s43
    v_perm_b32 v55, v9, v8, s43
    v_and_b32 v6, 0xffff, v67
    v_lshrrev_b32 v7, 16, v67
    v_and_b32 v8, 0xffff, v71
    v_lshrrev_b32 v9, 16, v71
    ds_add_rtn_u32 v6, v6, v4 offset:0
    ds_add_rtn_u32 v7, v7, v4 offset:0
    ds_add_rtn_u32 v8, v8, v4 offset:0
    ds_add_rtn_u32 v9, v9, v4 offset:0
    s_waitcnt lgkmcnt(4)
    v_perm_b32 v59, v11, v10, s43
    v_perm_b32 v63, v13, v12, s43
    s_add_u32 s35, s34, 12582912
    buffer_load_dwordx2 v[112:113], v2, s[16:19], s35 offen nt
    s_add_u32 s35, s34, 14680064
    buffer_load_dwordx2 v[114:115], v2, s[16:19], s35 offen nt
    v_and_b32 v10, 0xffff, v120
    v_lshrrev_b32 v11, 16, v120
    v_and_b32 v12, 0xffff, v121
    v_lshrrev_b32 v13, 16, v121
    ds_add_rtn_u32 v10, v10, v4 offset:0
    ds_add_rtn_u32 v11, v11, v4 offset:0
    ds_add_rtn_u32 v12, v12, v4 offset:0
    ds_add_rtn_u32 v13, v13, v4 offset:0
    s_waitcnt lgkmcnt(4)
    v_perm_b32 v67, v7, v6, s43
    v_perm_b32 v71, v9, v8, s43
    v_and_b32 v6, 0xffff, v122
    v_lshrrev_b32 v7, 16, v122
    v_and_b32 v8, 0xffff, v123
    v_lshrrev_b32 v9, 16, v123
    ds_add_rtn_u32 v6, v6, v4 offset:0
    ds_add_rtn_u32 v7, v7, v4 offset:0
    ds_add_rtn_u32 v8, v8, v4 offset:0
    ds_add_rtn_u32 v9, v9, v4 offset:0
    s_waitcnt lgkmcnt(4)
    v_perm_b32 v120, v11, v10, s43
    v_perm_b32 v121, v13, v12, s43
    v_and_b32 v10, 0xffff, v124
    v_lshrrev_b32 v11, 16, v124
    v_and_b32 v12, 0xffff, v125
    v_lshrrev_b32 v13, 16, v125
    ds_add_rtn_u32 v10, v10, v4 offset:0
    ds_add_rtn_u32 v11, v11, v4 offset:0
    ds_add_rtn_u32 v12, v12, v4 offset:0
    ds_add_rtn_u32 v13, v13, v4 offset:0
    s_waitcnt lgkmcnt(4)
    v_perm_b32 v122, v7, v6, s43
    v_perm_b32 v123, v9, v8, s43
    s_add_u32 s35, s34, 16777216
    buffer_load_dwordx2 v[116:117], v2, s[16:19], s35 offen nt
    s_add_u32 s35, s34, 18874368
    s_sub_u32 s35, s35, s49
    v_cndmask_b32 v118, 2.0, v2, s[44:45]
    buffer_load_dwordx2 v[118:119], v118, s[16:19], s35 offen nt
    v_and_b32 v6, 0xffff, v126
    v_lshrrev_b32 v7, 16, v126
    v_and_b32 v8, 0xffff, v75
    v_lshrrev_b32 v9, 16, v75
    ds_add_rtn_u32 v6, v6, v4 offset:0
    ds_add_rtn_u32 v7, v7, v4 offset:0
    ds_add_rtn_u32 v8, v8, v4 offset:0
    ds_add_rtn_u32 v9, v9, v4 offset:0
    s_waitcnt lgkmcnt(4)
    v_perm_b32 v124, v11, v10, s43
    v_perm_b32 v125, v13, v12, s43
    v_and_b32 v10, 0xffff, v79
    v_lshrrev_b32 v11, 16, v79
    v_and_b32 v12, 0xffff, v83
    v_lshrrev_b32 v13, 16, v83
    ds_add_rtn_u32 v10, v10, v4 offset:0
    ds_add_rtn_u32 v11, v11, v4 offset:0
    ds_add_rtn_u32 v12, v12, v4 offset:0
    ds_add_rtn_u32 v13, v13, v4 offset:0
    s_waitcnt lgkmcnt(4)
    v_perm_b32 v126, v7, v6, s43
    v_perm_b32 v75, v9, v8, s43
    v_and_b32 v6, 0xffff, v87
    v_lshrrev_b32 v7, 16, v87
    v_and_b32 v8, 0xffff, v91
    v_lshrrev_b32 v9, 16, v91
    ds_add_rtn_u32 v6, v6, v4 offset:0
    ds_add_rtn_u32 v7, v7, v4 offset:0
    ds_add_rtn_u32 v8, v8, v4 offset:0
    ds_add_rtn_u32 v9, v9, v4 offset:0
    s_waitcnt lgkmcnt(4)
    v_perm_b32 v79, v11, v10, s43
    v_perm_b32 v83, v13, v12, s43
    s_add_u32 s35, s33, 40960000
    buffer_load_dwordx4 v[16:19], v1, s[8:11], s35 offen nt
    s_mov_b64 exec, s[44:45]
    v_and_b32 v10, 0xffff, v95
    v_lshrrev_b32 v11, 16, v95
    v_and_b32 v12, 0xffff, v99
    v_lshrrev_b32 v13, 16, v99
    ds_add_rtn_u32 v10, v10, v4 offset:0
    ds_add_rtn_u32 v11, v11, v4 offset:0
    ds_add_rtn_u32 v12, v12, v4 offset:0
    ds_add_rtn_u32 v13, v13, v4 offset:0
    s_mov_b64 exec, -1
    s_waitcnt lgkmcnt(4)
    v_perm_b32 v87, v7, v6, s43
    v_perm_b32 v91, v9, v8, s43
    s_waitcnt lgkmcnt(0)
    v_perm_b32 v95, v11, v10, s43
    v_perm_b32 v99, v13, v12, s43
    s_barrier
    s_lshl_b32 s35, s54, 2
    v_mov_b32 v6, s35
    v_mov_b32 v7, 0
    v_mov_b32 v12, 1140817920
    s_mov_b64 exec, 1
    ds_write2_b32 v6, v7, v7 offset0:0 offset1:1
    s_cmp_eq_u64 s[46:47], 0
    s_cbranch_scc1 L_p1_kernel_nonull_2
    s_mov_b64 exec, s[64:65]
    v_lshlrev_b32_sdwa v6, 2, v14 dst_sel:DWORD dst_unused:UNUSED_PAD src0_sel:DWORD src1_sel:WORD_0
    ds_write_b32 v6, v7 offset:4
    s_mov_b64 exec, s[56:57]
    ds_write_b32 v6, v7
    s_mov_b64 exec, s[66:67]
    v_lshlrev_b32_sdwa v6, 2, v14 dst_sel:DWORD dst_unused:UNUSED_PAD src0_sel:DWORD src1_sel:WORD_1
    ds_write_b32 v6, v7 offset:4
    s_mov_b64 exec, s[58:59]
    ds_write_b32 v6, v7
    s_mov_b64 exec, s[68:69]
    v_lshlrev_b32_sdwa v6, 2, v15 dst_sel:DWORD dst_unused:UNUSED_PAD src0_sel:DWORD src1_sel:WORD_0
    ds_write_b32 v6, v7 offset:4
    s_mov_b64 exec, s[60:61]
    ds_write_b32 v6, v7
    s_mov_b64 exec, s[70:71]
    v_lshlrev_b32_sdwa v6, 2, v15 dst_sel:DWORD dst_unused:UNUSED_PAD src0_sel:DWORD src1_sel:WORD_1
    ds_write_b32 v6, v7 offset:4
    s_mov_b64 exec, s[62:63]
    ds_write_b32 v6, v7
L_p1_kernel_nonull_2:
    s_mov_b64 exec, -1
    v_lshlrev_b32_sdwa v6, 2, v51 dst_sel:DWORD dst_unused:UNUSED_PAD src0_sel:DWORD src1_sel:WORD_0
    v_lshlrev_b32_sdwa v7, 2, v51 dst_sel:DWORD dst_unused:UNUSED_PAD src0_sel:DWORD src1_sel:WORD_1
    v_lshlrev_b32_sdwa v8, 2, v55 dst_sel:DWORD dst_unused:UNUSED_PAD src0_sel:DWORD src1_sel:WORD_0
    v_lshlrev_b32_sdwa v9, 2, v55 dst_sel:DWORD dst_unused:UNUSED_PAD src0_sel:DWORD src1_sel:WORD_1
    ds_write_b32 v6, v48
    ds_write_b32 v7, v49
    ds_write_b32 v8, v50
    ds_write_b32 v9, v52
    s_waitcnt vmcnt(12)
    v_lshlrev_b32 v10, 16, v100
    v_lshlrev_b32 v11, 16, v101
    v_and_b32 v100, 0xffff0000, v100
    v_and_b32 v101, 0xffff0000, v101
    v_mul_f32 v10, s41, v10
    v_mul_f32 v100, s41, v100
    v_mul_f32 v11, s41, v11
    v_mul_f32 v101, s41, v101
    v_fract_f32 v10, v10
    v_fract_f32 v100, v100
    v_fract_f32 v11, v11
    v_fract_f32 v101, v101
    v_cos_f32 v10, v10
    v_cos_f32 v100, v100
    v_cos_f32 v11, v11
    v_cos_f32 v101, v101
    v_fmaak_f32 v10, v12, v10, 1262486016
    v_fmaak_f32 v100, v12, v100, 1262486016
    v_fmaak_f32 v11, v12, v11, 1262486016
    v_fmaak_f32 v101, v12, v101, 1262486016
    v_or3_b32 v5, v10, v100, v5
    v_or3_b32 v5, v11, v101, v5
    v_perm_b32 v100, v100, v10, s43
    v_perm_b32 v101, v101, v11, s43
    v_lshlrev_b32_sdwa v6, 2, v59 dst_sel:DWORD dst_unused:UNUSED_PAD src0_sel:DWORD src1_sel:WORD_0
    v_lshlrev_b32_sdwa v7, 2, v59 dst_sel:DWORD dst_unused:UNUSED_PAD src0_sel:DWORD src1_sel:WORD_1
    v_lshlrev_b32_sdwa v8, 2, v63 dst_sel:DWORD dst_unused:UNUSED_PAD src0_sel:DWORD src1_sel:WORD_0
    v_lshlrev_b32_sdwa v9, 2, v63 dst_sel:DWORD dst_unused:UNUSED_PAD src0_sel:DWORD src1_sel:WORD_1
    ds_write_b32 v6, v53
    ds_write_b32 v7, v54
    ds_write_b32 v8, v56
    ds_write_b32 v9, v57
    s_waitcnt vmcnt(11)
    v_lshlrev_b32 v10, 16, v102
    v_lshlrev_b32 v11, 16, v103
    v_and_b32 v102, 0xffff0000, v102
    v_and_b32 v103, 0xffff0000, v103
    v_mul_f32 v10, s41, v10
    v_mul_f32 v102, s41, v102
    v_mul_f32 v11, s41, v11
    v_mul_f32 v103, s41, v103
    v_fract_f32 v10, v10
    v_fract_f32 v102, v102
    v_fract_f32 v11, v11
    v_fract_f32 v103, v103
    v_cos_f32 v10, v10
    v_cos_f32 v102, v102
    v_cos_f32 v11, v11
    v_cos_f32 v103, v103
    v_fmaak_f32 v10, v12, v10, 1262486016
    v_fmaak_f32 v102, v12, v102, 1262486016
    v_fmaak_f32 v11, v12, v11, 1262486016
    v_fmaak_f32 v103, v12, v103, 1262486016
    v_or3_b32 v5, v10, v102, v5
    v_or3_b32 v5, v11, v103, v5
    v_perm_b32 v102, v102, v10, s43
    v_perm_b32 v103, v103, v11, s43
    s_add_u32 s35, s33, 40960000
    buffer_load_dwordx4 v[20:23], v1, s[12:15], s35 offen nt
    v_lshlrev_b32_sdwa v6, 2, v67 dst_sel:DWORD dst_unused:UNUSED_PAD src0_sel:DWORD src1_sel:WORD_0
    v_lshlrev_b32_sdwa v7, 2, v67 dst_sel:DWORD dst_unused:UNUSED_PAD src0_sel:DWORD src1_sel:WORD_1
    v_lshlrev_b32_sdwa v8, 2, v71 dst_sel:DWORD dst_unused:UNUSED_PAD src0_sel:DWORD src1_sel:WORD_0
    v_lshlrev_b32_sdwa v9, 2, v71 dst_sel:DWORD dst_unused:UNUSED_PAD src0_sel:DWORD src1_sel:WORD_1
    ds_write_b32 v6, v58
    ds_write_b32 v7, v60
    ds_write_b32 v8, v61
    ds_write_b32 v9, v62
    s_waitcnt vmcnt(11)
    v_lshlrev_b32 v10, 16, v104
    v_lshlrev_b32 v11, 16, v105
    v_and_b32 v104, 0xffff0000, v104
    v_and_b32 v105, 0xffff0000, v105
    v_mul_f32 v10, s41, v10
    v_mul_f32 v104, s41, v104
    v_mul_f32 v11, s41, v11
    v_mul_f32 v105, s41, v105
    v_fract_f32 v10, v10
    v_fract_f32 v104, v104
    v_fract_f32 v11, v11
    v_fract_f32 v105, v105
    v_cos_f32 v10, v10
    v_cos_f32 v104, v104
    v_cos_f32 v11, v11
    v_cos_f32 v105, v105
    v_fmaak_f32 v10, v12, v10, 1262486016
    v_fmaak_f32 v104, v12, v104, 1262486016
    v_fmaak_f32 v11, v12, v11, 1262486016
    v_fmaak_f32 v105, v12, v105, 1262486016
    v_or3_b32 v5, v10, v104, v5
    v_or3_b32 v5, v11, v105, v5
    v_perm_b32 v104, v104, v10, s43
    v_perm_b32 v105, v105, v11, s43
    v_lshlrev_b32_sdwa v6, 2, v120 dst_sel:DWORD dst_unused:UNUSED_PAD src0_sel:DWORD src1_sel:WORD_0
    v_lshlrev_b32_sdwa v7, 2, v120 dst_sel:DWORD dst_unused:UNUSED_PAD src0_sel:DWORD src1_sel:WORD_1
    v_lshlrev_b32_sdwa v8, 2, v121 dst_sel:DWORD dst_unused:UNUSED_PAD src0_sel:DWORD src1_sel:WORD_0
    v_lshlrev_b32_sdwa v9, 2, v121 dst_sel:DWORD dst_unused:UNUSED_PAD src0_sel:DWORD src1_sel:WORD_1
    ds_write_b32 v6, v64
    ds_write_b32 v7, v65
    ds_write_b32 v8, v66
    ds_write_b32 v9, v68
    s_waitcnt vmcnt(10)
    v_lshlrev_b32 v10, 16, v106
    v_lshlrev_b32 v11, 16, v107
    v_and_b32 v106, 0xffff0000, v106
    v_and_b32 v107, 0xffff0000, v107
    v_mul_f32 v10, s41, v10
    v_mul_f32 v106, s41, v106
    v_mul_f32 v11, s41, v11
    v_mul_f32 v107, s41, v107
    v_fract_f32 v10, v10
    v_fract_f32 v106, v106
    v_fract_f32 v11, v11
    v_fract_f32 v107, v107
    v_cos_f32 v10, v10
    v_cos_f32 v106, v106
    v_cos_f32 v11, v11
    v_cos_f32 v107, v107
    v_fmaak_f32 v10, v12, v10, 1262486016
    v_fmaak_f32 v106, v12, v106, 1262486016
    v_fmaak_f32 v11, v12, v11, 1262486016
    v_fmaak_f32 v107, v12, v107, 1262486016
    v_or3_b32 v5, v10, v106, v5
    v_or3_b32 v5, v11, v107, v5
    v_perm_b32 v106, v106, v10, s43
    v_perm_b32 v107, v107, v11, s43
    v_lshlrev_b32_sdwa v6, 2, v122 dst_sel:DWORD dst_unused:UNUSED_PAD src0_sel:DWORD src1_sel:WORD_0
    v_lshlrev_b32_sdwa v7, 2, v122 dst_sel:DWORD dst_unused:UNUSED_PAD src0_sel:DWORD src1_sel:WORD_1
    v_lshlrev_b32_sdwa v8, 2, v123 dst_sel:DWORD dst_unused:UNUSED_PAD src0_sel:DWORD src1_sel:WORD_0
    v_lshlrev_b32_sdwa v9, 2, v123 dst_sel:DWORD dst_unused:UNUSED_PAD src0_sel:DWORD src1_sel:WORD_1
    ds_write_b32 v6, v69
    ds_write_b32 v7, v70
    ds_write_b32 v8, v127
    ds_write_b32 v9, v72
    s_waitcnt vmcnt(9)
    v_lshlrev_b32 v10, 16, v108
    v_lshlrev_b32 v11, 16, v109
    v_and_b32 v108, 0xffff0000, v108
    v_and_b32 v109, 0xffff0000, v109
    v_mul_f32 v10, s41, v10
    v_mul_f32 v108, s41, v108
    v_mul_f32 v11, s41, v11
    v_mul_f32 v109, s41, v109
    v_fract_f32 v10, v10
    v_fract_f32 v108, v108
    v_fract_f32 v11, v11
    v_fract_f32 v109, v109
    v_cos_f32 v10, v10
    v_cos_f32 v108, v108
    v_cos_f32 v11, v11
    v_cos_f32 v109, v109
    v_fmaak_f32 v10, v12, v10, 1262486016
    v_fmaak_f32 v108, v12, v108, 1262486016
    v_fmaak_f32 v11, v12, v11, 1262486016
    v_fmaak_f32 v109, v12, v109, 1262486016
    v_or3_b32 v5, v10, v108, v5
    v_or3_b32 v5, v11, v109, v5
    v_perm_b32 v108, v108, v10, s43
    v_perm_b32 v109, v109, v11, s43
    s_add_u32 s35, s33, 45154304
    buffer_load_dwordx4 v[24:27], v1, s[8:11], s35 offen nt
    v_lshlrev_b32_sdwa v6, 2, v124 dst_sel:DWORD dst_unused:UNUSED_PAD src0_sel:DWORD src1_sel:WORD_0
    v_lshlrev_b32_sdwa v7, 2, v124 dst_sel:DWORD dst_unused:UNUSED_PAD src0_sel:DWORD src1_sel:WORD_1
    v_lshlrev_b32_sdwa v8, 2, v125 dst_sel:DWORD dst_unused:UNUSED_PAD src0_sel:DWORD src1_sel:WORD_0
    v_lshlrev_b32_sdwa v9, 2, v125 dst_sel:DWORD dst_unused:UNUSED_PAD src0_sel:DWORD src1_sel:WORD_1
    ds_write_b32 v6, v73
    ds_write_b32 v7, v74
    ds_write_b32 v8, v76
    ds_write_b32 v9, v77
    s_waitcnt vmcnt(9)
    v_lshlrev_b32 v10, 16, v110
    v_lshlrev_b32 v11, 16, v111
    v_and_b32 v110, 0xffff0000, v110
    v_and_b32 v111, 0xffff0000, v111
    v_mul_f32 v10, s41, v10
    v_mul_f32 v110, s41, v110
    v_mul_f32 v11, s41, v11
    v_mul_f32 v111, s41, v111
    v_fract_f32 v10, v10
    v_fract_f32 v110, v110
    v_fract_f32 v11, v11
    v_fract_f32 v111, v111
    v_cos_f32 v10, v10
    v_cos_f32 v110, v110
    v_cos_f32 v11, v11
    v_cos_f32 v111, v111
    v_fmaak_f32 v10, v12, v10, 1262486016
    v_fmaak_f32 v110, v12, v110, 1262486016
    v_fmaak_f32 v11, v12, v11, 1262486016
    v_fmaak_f32 v111, v12, v111, 1262486016
    v_or3_b32 v5, v10, v110, v5
    v_or3_b32 v5, v11, v111, v5
    v_perm_b32 v110, v110, v10, s43
    v_perm_b32 v111, v111, v11, s43
    v_lshlrev_b32_sdwa v6, 2, v126 dst_sel:DWORD dst_unused:UNUSED_PAD src0_sel:DWORD src1_sel:WORD_0
    v_lshlrev_b32_sdwa v7, 2, v126 dst_sel:DWORD dst_unused:UNUSED_PAD src0_sel:DWORD src1_sel:WORD_1
    v_lshlrev_b32_sdwa v8, 2, v75 dst_sel:DWORD dst_unused:UNUSED_PAD src0_sel:DWORD src1_sel:WORD_0
    v_lshlrev_b32_sdwa v9, 2, v75 dst_sel:DWORD dst_unused:UNUSED_PAD src0_sel:DWORD src1_sel:WORD_1
    ds_write_b32 v6, v78
    ds_write_b32 v7, v80
    ds_write_b32 v8, v81
    ds_write_b32 v9, v82
    s_waitcnt vmcnt(6)
    v_lshlrev_b32 v10, 16, v112
    v_lshlrev_b32 v11, 16, v113
    v_and_b32 v112, 0xffff0000, v112
    v_and_b32 v113, 0xffff0000, v113
    v_mul_f32 v10, s41, v10
    v_mul_f32 v112, s41, v112
    v_mul_f32 v11, s41, v11
    v_mul_f32 v113, s41, v113
    v_fract_f32 v10, v10
    v_fract_f32 v112, v112
    v_fract_f32 v11, v11
    v_fract_f32 v113, v113
    v_cos_f32 v10, v10
    v_cos_f32 v112, v112
    v_cos_f32 v11, v11
    v_cos_f32 v113, v113
    v_fmaak_f32 v10, v12, v10, 1262486016
    v_fmaak_f32 v112, v12, v112, 1262486016
    v_fmaak_f32 v11, v12, v11, 1262486016
    v_fmaak_f32 v113, v12, v113, 1262486016
    v_or3_b32 v5, v10, v112, v5
    v_or3_b32 v5, v11, v113, v5
    v_perm_b32 v112, v112, v10, s43
    v_perm_b32 v113, v113, v11, s43
    v_lshlrev_b32_sdwa v6, 2, v79 dst_sel:DWORD dst_unused:UNUSED_PAD src0_sel:DWORD src1_sel:WORD_0
    v_lshlrev_b32_sdwa v7, 2, v79 dst_sel:DWORD dst_unused:UNUSED_PAD src0_sel:DWORD src1_sel:WORD_1
    v_lshlrev_b32_sdwa v8, 2, v83 dst_sel:DWORD dst_unused:UNUSED_PAD src0_sel:DWORD src1_sel:WORD_0
    v_lshlrev_b32_sdwa v9, 2, v83 dst_sel:DWORD dst_unused:UNUSED_PAD src0_sel:DWORD src1_sel:WORD_1
    ds_write_b32 v6, v84
    ds_write_b32 v7, v85
    ds_write_b32 v8, v86
    ds_write_b32 v9, v88
    s_waitcnt vmcnt(5)
    v_lshlrev_b32 v10, 16, v114
    v_lshlrev_b32 v11, 16, v115
    v_and_b32 v114, 0xffff0000, v114
    v_and_b32 v115, 0xffff0000, v115
    v_mul_f32 v10, s41, v10
    v_mul_f32 v114, s41, v114
    v_mul_f32 v11, s41, v11
    v_mul_f32 v115, s41, v115
    v_fract_f32 v10, v10
    v_fract_f32 v114, v114
    v_fract_f32 v11, v11
    v_fract_f32 v115, v115
    v_cos_f32 v10, v10
    v_cos_f32 v114, v114
    v_cos_f32 v11, v11
    v_cos_f32 v115, v115
    v_fmaak_f32 v10, v12, v10, 1262486016
    v_fmaak_f32 v114, v12, v114, 1262486016
    v_fmaak_f32 v11, v12, v11, 1262486016
    v_fmaak_f32 v115, v12, v115, 1262486016
    v_or3_b32 v5, v10, v114, v5
    v_or3_b32 v5, v11, v115, v5
    v_perm_b32 v114, v114, v10, s43
    v_perm_b32 v115, v115, v11, s43
    s_add_u32 s35, s33, 45154304
    buffer_load_dwordx4 v[28:31], v1, s[12:15], s35 offen nt
    v_lshlrev_b32_sdwa v6, 2, v87 dst_sel:DWORD dst_unused:UNUSED_PAD src0_sel:DWORD src1_sel:WORD_0
    v_lshlrev_b32_sdwa v7, 2, v87 dst_sel:DWORD dst_unused:UNUSED_PAD src0_sel:DWORD src1_sel:WORD_1
    v_lshlrev_b32_sdwa v8, 2, v91 dst_sel:DWORD dst_unused:UNUSED_PAD src0_sel:DWORD src1_sel:WORD_0
    v_lshlrev_b32_sdwa v9, 2, v91 dst_sel:DWORD dst_unused:UNUSED_PAD src0_sel:DWORD src1_sel:WORD_1
    ds_write_b32 v6, v89
    ds_write_b32 v7, v90
    ds_write_b32 v8, v92
    ds_write_b32 v9, v93
    s_waitcnt vmcnt(5)
    v_lshlrev_b32 v10, 16, v116
    v_lshlrev_b32 v11, 16, v117
    v_and_b32 v116, 0xffff0000, v116
    v_and_b32 v117, 0xffff0000, v117
    v_mul_f32 v10, s41, v10
    v_mul_f32 v116, s41, v116
    v_mul_f32 v11, s41, v11
    v_mul_f32 v117, s41, v117
    v_fract_f32 v10, v10
    v_fract_f32 v116, v116
    v_fract_f32 v11, v11
    v_fract_f32 v117, v117
    v_cos_f32 v10, v10
    v_cos_f32 v116, v116
    v_cos_f32 v11, v11
    v_cos_f32 v117, v117
    v_fmaak_f32 v10, v12, v10, 1262486016
    v_fmaak_f32 v116, v12, v116, 1262486016
    v_fmaak_f32 v11, v12, v11, 1262486016
    v_fmaak_f32 v117, v12, v117, 1262486016
    v_or3_b32 v5, v10, v116, v5
    v_or3_b32 v5, v11, v117, v5
    v_perm_b32 v116, v116, v10, s43
    v_perm_b32 v117, v117, v11, s43
    s_mov_b64 exec, s[44:45]
    v_lshlrev_b32_sdwa v6, 2, v95 dst_sel:DWORD dst_unused:UNUSED_PAD src0_sel:DWORD src1_sel:WORD_0
    v_lshlrev_b32_sdwa v7, 2, v95 dst_sel:DWORD dst_unused:UNUSED_PAD src0_sel:DWORD src1_sel:WORD_1
    v_lshlrev_b32_sdwa v8, 2, v99 dst_sel:DWORD dst_unused:UNUSED_PAD src0_sel:DWORD src1_sel:WORD_0
    v_lshlrev_b32_sdwa v9, 2, v99 dst_sel:DWORD dst_unused:UNUSED_PAD src0_sel:DWORD src1_sel:WORD_1
    ds_write_b32 v6, v94
    ds_write_b32 v7, v96
    ds_write_b32 v8, v97
    ds_write_b32 v9, v98
    s_waitcnt vmcnt(4)
    v_lshlrev_b32 v10, 16, v118
    v_lshlrev_b32 v11, 16, v119
    v_and_b32 v118, 0xffff0000, v118
    v_and_b32 v119, 0xffff0000, v119
    v_mul_f32 v10, s41, v10
    v_mul_f32 v118, s41, v118
    v_mul_f32 v11, s41, v11
    v_mul_f32 v119, s41, v119
    v_fract_f32 v10, v10
    v_fract_f32 v118, v118
    v_fract_f32 v11, v11
    v_fract_f32 v119, v119
    v_cos_f32 v10, v10
    v_cos_f32 v118, v118
    v_cos_f32 v11, v11
    v_cos_f32 v119, v119
    v_fmaak_f32 v10, v12, v10, 1262486016
    v_fmaak_f32 v118, v12, v118, 1262486016
    v_fmaak_f32 v11, v12, v11, 1262486016
    v_fmaak_f32 v119, v12, v119, 1262486016
    v_or3_b32 v5, v10, v118, v5
    v_or3_b32 v5, v11, v119, v5
    v_perm_b32 v118, v118, v10, s43
    v_perm_b32 v119, v119, v11, s43
    s_mov_b64 exec, -1
    v_lshrrev_b32 v6, 2, v3
    v_sub_u32 v6, v3, v6
    s_waitcnt lgkmcnt(0)
    s_barrier
    s_cmp_lg_u32 s39, 15
    s_cbranch_scc1 L_p1_kernel_nox_3
    ds_read_b32 v12, v6 offset:9984
    ds_read_b32 v13, v6 offset:9988
    ds_read_b32 v14, v6 offset:9992
L_p1_kernel_nox_3:
    ds_read_b32 v48, v6 offset:0
    ds_read_b32 v49, v6 offset:4
    ds_read_b32 v50, v6 offset:8
    ds_read_b32 v52, v6 offset:768
    ds_read_b32 v53, v6 offset:772
    ds_read_b32 v54, v6 offset:776
    ds_read_b32 v56, v6 offset:1536
    ds_read_b32 v57, v6 offset:1540
    ds_read_b32 v58, v6 offset:1544
    ds_read_b32 v60, v6 offset:2304
    ds_read_b32 v61, v6 offset:2308
    ds_read_b32 v62, v6 offset:2312
    ds_read_b32 v64, v6 offset:3072
    ds_read_b32 v65, v6 offset:3076
    ds_read_b32 v66, v6 offset:3080
    ds_read_b32 v68, v6 offset:3840
    ds_read_b32 v69, v6 offset:3844
    ds_read_b32 v70, v6 offset:3848
    ds_read_b32 v72, v6 offset:4608
    ds_read_b32 v73, v6 offset:4612
    ds_read_b32 v74, v6 offset:4616
    ds_read_b32 v76, v6 offset:5376
    ds_read_b32 v77, v6 offset:5380
    ds_read_b32 v78, v6 offset:5384
    ds_read_b32 v80, v6 offset:6144
    ds_read_b32 v81, v6 offset:6148
    ds_read_b32 v82, v6 offset:6152
    ds_read_b32 v84, v6 offset:6912
    ds_read_b32 v85, v6 offset:6916
    ds_read_b32 v86, v6 offset:6920
    ds_read_b32 v88, v6 offset:7680
    ds_read_b32 v89, v6 offset:7684
    ds_read_b32 v90, v6 offset:7688
    ds_read_b32 v92, v6 offset:8448
    ds_read_b32 v93, v6 offset:8452
    ds_read_b32 v94, v6 offset:8456
    ds_read_b32 v96, v6 offset:9216
    ds_read_b32 v97, v6 offset:9220
    ds_read_b32 v98, v6 offset:9224
    s_add_u32 s35, s33, 49348608
    buffer_load_dwordx4 v[32:35], v1, s[8:11], s35 offen nt
    v_mov_b32 v8, 0
    v_mov_b32 v9, 0
    v_mov_b32 v10, 0
    v_mov_b32 v11, 0
    v_mov_b32 v15, 16384
    s_waitcnt lgkmcnt(0)
    s_barrier
    ds_write_b128 v1, v[8:11] offset:0
    s_nop 1
    v_mad_u32_u16 v6, v51, s50, v15 op_sel:[0,0,0,0]
    v_mad_u32_u16 v7, v51, s50, v15 op_sel:[1,0,0,0]
    v_mad_u32_u16 v8, v55, s50, v15 op_sel:[0,0,0,0]
    v_mad_u32_u16 v9, v55, s50, v15 op_sel:[1,0,0,0]
    v_add_u32_sdwa v6, v6, v51 dst_sel:DWORD dst_unused:UNUSED_PAD src0_sel:WORD_1 src1_sel:WORD_0
    v_add_u32_sdwa v7, v7, v51 dst_sel:DWORD dst_unused:UNUSED_PAD src0_sel:WORD_1 src1_sel:WORD_1
    v_add_u32_sdwa v8, v8, v55 dst_sel:DWORD dst_unused:UNUSED_PAD src0_sel:WORD_1 src1_sel:WORD_0
    v_add_u32_sdwa v9, v9, v55 dst_sel:DWORD dst_unused:UNUSED_PAD src0_sel:WORD_1 src1_sel:WORD_1
    v_add_u32 v6, v6, v6
    v_add_u32 v7, v7, v7
    v_add_u32 v8, v8, v8
    v_add_u32 v9, v9, v9
    ds_write_b16 v6, v100 offset:16384
    ds_write_b16_d16_hi v7, v100 offset:16384
    ds_write_b16 v8, v101 offset:16384
    ds_write_b16_d16_hi v9, v101 offset:16384
    v_mad_u32_u16 v6, v59, s50, v15 op_sel:[0,0,0,0]
    v_mad_u32_u16 v7, v59, s50, v15 op_sel:[1,0,0,0]
    v_mad_u32_u16 v8, v63, s50, v15 op_sel:[0,0,0,0]
    v_mad_u32_u16 v9, v63, s50, v15 op_sel:[1,0,0,0]
    v_add_u32_sdwa v6, v6, v59 dst_sel:DWORD dst_unused:UNUSED_PAD src0_sel:WORD_1 src1_sel:WORD_0
    v_add_u32_sdwa v7, v7, v59 dst_sel:DWORD dst_unused:UNUSED_PAD src0_sel:WORD_1 src1_sel:WORD_1
    v_add_u32_sdwa v8, v8, v63 dst_sel:DWORD dst_unused:UNUSED_PAD src0_sel:WORD_1 src1_sel:WORD_0
    v_add_u32_sdwa v9, v9, v63 dst_sel:DWORD dst_unused:UNUSED_PAD src0_sel:WORD_1 src1_sel:WORD_1
    v_add_u32 v6, v6, v6
    v_add_u32 v7, v7, v7
    v_add_u32 v8, v8, v8
    v_add_u32 v9, v9, v9
    ds_write_b16 v6, v102 offset:16384
    ds_write_b16_d16_hi v7, v102 offset:16384
    ds_write_b16 v8, v103 offset:16384
    ds_write_b16_d16_hi v9, v103 offset:16384
    s_add_u32 s35, s33, 49348608
    buffer_load_dwordx4 v[36:39], v1, s[12:15], s35 offen nt
    v_mad_u32_u16 v6, v67, s50, v15 op_sel:[0,0,0,0]
    v_mad_u32_u16 v7, v67, s50, v15 op_sel:[1,0,0,0]
    v_mad_u32_u16 v8, v71, s50, v15 op_sel:[0,0,0,0]
    v_mad_u32_u16 v9, v71, s50, v15 op_sel:[1,0,0,0]
    v_add_u32_sdwa v6, v6, v67 dst_sel:DWORD dst_unused:UNUSED_PAD src0_sel:WORD_1 src1_sel:WORD_0
    v_add_u32_sdwa v7, v7, v67 dst_sel:DWORD dst_unused:UNUSED_PAD src0_sel:WORD_1 src1_sel:WORD_1
    v_add_u32_sdwa v8, v8, v71 dst_sel:DWORD dst_unused:UNUSED_PAD src0_sel:WORD_1 src1_sel:WORD_0
    v_add_u32_sdwa v9, v9, v71 dst_sel:DWORD dst_unused:UNUSED_PAD src0_sel:WORD_1 src1_sel:WORD_1
    v_add_u32 v6, v6, v6
    v_add_u32 v7, v7, v7
    v_add_u32 v8, v8, v8
    v_add_u32 v9, v9, v9
    ds_write_b16 v6, v104 offset:16384
    ds_write_b16_d16_hi v7, v104 offset:16384
    ds_write_b16 v8, v105 offset:16384
    ds_write_b16_d16_hi v9, v105 offset:16384
    v_mad_u32_u16 v6, v120, s50, v15 op_sel:[0,0,0,0]
    v_mad_u32_u16 v7, v120, s50, v15 op_sel:[1,0,0,0]
    v_mad_u32_u16 v8, v121, s50, v15 op_sel:[0,0,0,0]
    v_mad_u32_u16 v9, v121, s50, v15 op_sel:[1,0,0,0]
    v_add_u32_sdwa v6, v6, v120 dst_sel:DWORD dst_unused:UNUSED_PAD src0_sel:WORD_1 src1_sel:WORD_0
    v_add_u32_sdwa v7, v7, v120 dst_sel:DWORD dst_unused:UNUSED_PAD src0_sel:WORD_1 src1_sel:WORD_1
    v_add_u32_sdwa v8, v8, v121 dst_sel:DWORD dst_unused:UNUSED_PAD src0_sel:WORD_1 src1_sel:WORD_0
    v_add_u32_sdwa v9, v9, v121 dst_sel:DWORD dst_unused:UNUSED_PAD src0_sel:WORD_1 src1_sel:WORD_1
    v_add_u32 v6, v6, v6
    v_add_u32 v7, v7, v7
    v_add_u32 v8, v8, v8
    v_add_u32 v9, v9, v9
    ds_write_b16 v6, v106 offset:16384
    ds_write_b16_d16_hi v7, v106 offset:16384
    ds_write_b16 v8, v107 offset:16384
    ds_write_b16_d16_hi v9, v107 offset:16384
    v_mad_u32_u16 v6, v122, s50, v15 op_sel:[0,0,0,0]
    v_mad_u32_u16 v7, v122, s50, v15 op_sel:[1,0,0,0]
    v_mad_u32_u16 v8, v123, s50, v15 op_sel:[0,0,0,0]
    v_mad_u32_u16 v9, v123, s50, v15 op_sel:[1,0,0,0]
    v_add_u32_sdwa v6, v6, v122 dst_sel:DWORD dst_unused:UNUSED_PAD src0_sel:WORD_1 src1_sel:WORD_0
    v_add_u32_sdwa v7, v7, v122 dst_sel:DWORD dst_unused:UNUSED_PAD src0_sel:WORD_1 src1_sel:WORD_1
    v_add_u32_sdwa v8, v8, v123 dst_sel:DWORD dst_unused:UNUSED_PAD src0_sel:WORD_1 src1_sel:WORD_0
    v_add_u32_sdwa v9, v9, v123 dst_sel:DWORD dst_unused:UNUSED_PAD src0_sel:WORD_1 src1_sel:WORD_1
    v_add_u32 v6, v6, v6
    v_add_u32 v7, v7, v7
    v_add_u32 v8, v8, v8
    v_add_u32 v9, v9, v9
    ds_write_b16 v6, v108 offset:16384
    ds_write_b16_d16_hi v7, v108 offset:16384
    ds_write_b16 v8, v109 offset:16384
    ds_write_b16_d16_hi v9, v109 offset:16384
    s_add_u32 s35, s33, 53542912
    buffer_load_dwordx4 v[40:43], v1, s[8:11], s35 offen nt
    v_mad_u32_u16 v6, v124, s50, v15 op_sel:[0,0,0,0]
    v_mad_u32_u16 v7, v124, s50, v15 op_sel:[1,0,0,0]
    v_mad_u32_u16 v8, v125, s50, v15 op_sel:[0,0,0,0]
    v_mad_u32_u16 v9, v125, s50, v15 op_sel:[1,0,0,0]
    v_add_u32_sdwa v6, v6, v124 dst_sel:DWORD dst_unused:UNUSED_PAD src0_sel:WORD_1 src1_sel:WORD_0
    v_add_u32_sdwa v7, v7, v124 dst_sel:DWORD dst_unused:UNUSED_PAD src0_sel:WORD_1 src1_sel:WORD_1
    v_add_u32_sdwa v8, v8, v125 dst_sel:DWORD dst_unused:UNUSED_PAD src0_sel:WORD_1 src1_sel:WORD_0
    v_add_u32_sdwa v9, v9, v125 dst_sel:DWORD dst_unused:UNUSED_PAD src0_sel:WORD_1 src1_sel:WORD_1
    v_add_u32 v6, v6, v6
    v_add_u32 v7, v7, v7
    v_add_u32 v8, v8, v8
    v_add_u32 v9, v9, v9
    ds_write_b16 v6, v110 offset:16384
    ds_write_b16_d16_hi v7, v110 offset:16384
    ds_write_b16 v8, v111 offset:16384
    ds_write_b16_d16_hi v9, v111 offset:16384
    v_mad_u32_u16 v6, v126, s50, v15 op_sel:[0,0,0,0]
    v_mad_u32_u16 v7, v126, s50, v15 op_sel:[1,0,0,0]
    v_mad_u32_u16 v8, v75, s50, v15 op_sel:[0,0,0,0]
    v_mad_u32_u16 v9, v75, s50, v15 op_sel:[1,0,0,0]
    v_add_u32_sdwa v6, v6, v126 dst_sel:DWORD dst_unused:UNUSED_PAD src0_sel:WORD_1 src1_sel:WORD_0
    v_add_u32_sdwa v7, v7, v126 dst_sel:DWORD dst_unused:UNUSED_PAD src0_sel:WORD_1 src1_sel:WORD_1
    v_add_u32_sdwa v8, v8, v75 dst_sel:DWORD dst_unused:UNUSED_PAD src0_sel:WORD_1 src1_sel:WORD_0
    v_add_u32_sdwa v9, v9, v75 dst_sel:DWORD dst_unused:UNUSED_PAD src0_sel:WORD_1 src1_sel:WORD_1
    v_add_u32 v6, v6, v6
    v_add_u32 v7, v7, v7
    v_add_u32 v8, v8, v8
    v_add_u32 v9, v9, v9
    ds_write_b16 v6, v112 offset:16384
    ds_write_b16_d16_hi v7, v112 offset:16384
    ds_write_b16 v8, v113 offset:16384
    ds_write_b16_d16_hi v9, v113 offset:16384
    v_mad_u32_u16 v6, v79, s50, v15 op_sel:[0,0,0,0]
    v_mad_u32_u16 v7, v79, s50, v15 op_sel:[1,0,0,0]
    v_mad_u32_u16 v8, v83, s50, v15 op_sel:[0,0,0,0]
    v_mad_u32_u16 v9, v83, s50, v15 op_sel:[1,0,0,0]
    v_add_u32_sdwa v6, v6, v79 dst_sel:DWORD dst_unused:UNUSED_PAD src0_sel:WORD_1 src1_sel:WORD_0
    v_add_u32_sdwa v7, v7, v79 dst_sel:DWORD dst_unused:UNUSED_PAD src0_sel:WORD_1 src1_sel:WORD_1
    v_add_u32_sdwa v8, v8, v83 dst_sel:DWORD dst_unused:UNUSED_PAD src0_sel:WORD_1 src1_sel:WORD_0
    v_add_u32_sdwa v9, v9, v83 dst_sel:DWORD dst_unused:UNUSED_PAD src0_sel:WORD_1 src1_sel:WORD_1
    v_add_u32 v6, v6, v6
    v_add_u32 v7, v7, v7
    v_add_u32 v8, v8, v8
    v_add_u32 v9, v9, v9
    ds_write_b16 v6, v114 offset:16384
    ds_write_b16_d16_hi v7, v114 offset:16384
    ds_write_b16 v8, v115 offset:16384
    ds_write_b16_d16_hi v9, v115 offset:16384
    s_add_u32 s35, s33, 53542912
    buffer_load_dwordx4 v[44:47], v1, s[12:15], s35 offen nt
    v_mad_u32_u16 v6, v87, s50, v15 op_sel:[0,0,0,0]
    v_mad_u32_u16 v7, v87, s50, v15 op_sel:[1,0,0,0]
    v_mad_u32_u16 v8, v91, s50, v15 op_sel:[0,0,0,0]
    v_mad_u32_u16 v9, v91, s50, v15 op_sel:[1,0,0,0]
    v_add_u32_sdwa v6, v6, v87 dst_sel:DWORD dst_unused:UNUSED_PAD src0_sel:WORD_1 src1_sel:WORD_0
    v_add_u32_sdwa v7, v7, v87 dst_sel:DWORD dst_unused:UNUSED_PAD src0_sel:WORD_1 src1_sel:WORD_1
    v_add_u32_sdwa v8, v8, v91 dst_sel:DWORD dst_unused:UNUSED_PAD src0_sel:WORD_1 src1_sel:WORD_0
    v_add_u32_sdwa v9, v9, v91 dst_sel:DWORD dst_unused:UNUSED_PAD src0_sel:WORD_1 src1_sel:WORD_1
    v_add_u32 v6, v6, v6
    v_add_u32 v7, v7, v7
    v_add_u32 v8, v8, v8
    v_add_u32 v9, v9, v9
    ds_write_b16 v6, v116 offset:16384
    ds_write_b16_d16_hi v7, v116 offset:16384
    ds_write_b16 v8, v117 offset:16384
    ds_write_b16_d16_hi v9, v117 offset:16384
    s_mov_b64 exec, s[44:45]
    v_mad_u32_u16 v6, v95, s50, v15 op_sel:[0,0,0,0]
    v_mad_u32_u16 v7, v95, s50, v15 op_sel:[1,0,0,0]
    v_mad_u32_u16 v8, v99, s50, v15 op_sel:[0,0,0,0]
    v_mad_u32_u16 v9, v99, s50, v15 op_sel:[1,0,0,0]
    v_add_u32_sdwa v6, v6, v95 dst_sel:DWORD dst_unused:UNUSED_PAD src0_sel:WORD_1 src1_sel:WORD_0
    v_add_u32_sdwa v7, v7, v95 dst_sel:DWORD dst_unused:UNUSED_PAD src0_sel:WORD_1 src1_sel:WORD_1
    v_add_u32_sdwa v8, v8, v99 dst_sel:DWORD dst_unused:UNUSED_PAD src0_sel:WORD_1 src1_sel:WORD_0
    v_add_u32_sdwa v9, v9, v99 dst_sel:DWORD dst_unused:UNUSED_PAD src0_sel:WORD_1 src1_sel:WORD_1
    v_add_u32 v6, v6, v6
    v_add_u32 v7, v7, v7
    v_add_u32 v8, v8, v8
    v_add_u32 v9, v9, v9
    ds_write_b16 v6, v118 offset:16384
    ds_write_b16_d16_hi v7, v118 offset:16384
    ds_write_b16 v8, v119 offset:16384
    ds_write_b16_d16_hi v9, v119 offset:16384
    s_mov_b64 exec, -1
    v_lshrrev_b32 v6, 1, v3
    s_waitcnt lgkmcnt(0)
    s_barrier
    ds_read_b64 v[100:101], v6 offset:16384
    ds_read_b64 v[102:103], v6 offset:16896
    ds_read_b64 v[104:105], v6 offset:17408
    ds_read_b64 v[106:107], v6 offset:17920
    ds_read_b64 v[108:109], v6 offset:18432
    ds_read_b64 v[110:111], v6 offset:18944
    ds_read_b64 v[112:113], v6 offset:19456
    ds_read_b64 v[114:115], v6 offset:19968
    ds_read_b64 v[116:117], v6 offset:20480
    ds_read_b64 v[118:119], v6 offset:20992
    ds_read_b64 v[120:121], v6 offset:21504
    ds_read_b64 v[122:123], v6 offset:22016
    ds_read_b64 v[124:125], v6 offset:22528
    ds_read_b64 v[126:127], v6 offset:23040
    s_waitcnt lgkmcnt(13)
    v_lshlrev_b32 v51, 22, v100
    v_lshrrev_b32 v100, 16, v100
    v_alignbit_b32 v51, v100, v51, 10
    v_alignbit_b32 v51, v101, v51, 10
    v_xor_b32 v51, 0x80200800, v51
    s_waitcnt lgkmcnt(12)
    v_lshlrev_b32 v55, 22, v102
    v_lshrrev_b32 v102, 16, v102
    v_alignbit_b32 v55, v102, v55, 10
    v_alignbit_b32 v55, v103, v55, 10
    v_xor_b32 v55, 0x80200800, v55
    s_waitcnt lgkmcnt(11)
    v_lshlrev_b32 v59, 22, v104
    v_lshrrev_b32 v104, 16, v104
    v_alignbit_b32 v59, v104, v59, 10
    v_alignbit_b32 v59, v105, v59, 10
    v_xor_b32 v59, 0x80200800, v59
    s_waitcnt lgkmcnt(10)
    v_lshlrev_b32 v63, 22, v106
    v_lshrrev_b32 v106, 16, v106
    v_alignbit_b32 v63, v106, v63, 10
    v_alignbit_b32 v63, v107, v63, 10
    v_xor_b32 v63, 0x80200800, v63
    s_waitcnt lgkmcnt(9)
    v_lshlrev_b32 v67, 22, v108
    v_lshrrev_b32 v108, 16, v108
    v_alignbit_b32 v67, v108, v67, 10
    v_alignbit_b32 v67, v109, v67, 10
    v_xor_b32 v67, 0x80200800, v67
    s_waitcnt lgkmcnt(8)
    v_lshlrev_b32 v71, 22, v110
    v_lshrrev_b32 v110, 16, v110
    v_alignbit_b32 v71, v110, v71, 10
    v_alignbit_b32 v71, v111, v71, 10
    v_xor_b32 v71, 0x80200800, v71
    s_waitcnt lgkmcnt(7)
    v_lshlrev_b32 v75, 22, v112
    v_lshrrev_b32 v112, 16, v112
    v_alignbit_b32 v75, v112, v75, 10
    v_alignbit_b32 v75, v113, v75, 10
    v_xor_b32 v75, 0x80200800, v75
    s_waitcnt lgkmcnt(6)
    v_lshlrev_b32 v79, 22, v114
    v_lshrrev_b32 v114, 16, v114
    v_alignbit_b32 v79, v114, v79, 10
    v_alignbit_b32 v79, v115, v79, 10
    v_xor_b32 v79, 0x80200800, v79
    s_waitcnt lgkmcnt(5)
    v_lshlrev_b32 v83, 22, v116
    v_lshrrev_b32 v116, 16, v116
    v_alignbit_b32 v83, v116, v83, 10
    v_alignbit_b32 v83, v117, v83, 10
    v_xor_b32 v83, 0x80200800, v83
    s_waitcnt lgkmcnt(4)
    v_lshlrev_b32 v87, 22, v118
    v_lshrrev_b32 v118, 16, v118
    v_alignbit_b32 v87, v118, v87, 10
    v_alignbit_b32 v87, v119, v87, 10
    v_xor_b32 v87, 0x80200800, v87
    s_waitcnt lgkmcnt(3)
    v_lshlrev_b32 v91, 22, v120
    v_lshrrev_b32 v120, 16, v120
    v_alignbit_b32 v91, v120, v91, 10
    v_alignbit_b32 v91, v121, v91, 10
    v_xor_b32 v91, 0x80200800, v91
    s_waitcnt lgkmcnt(2)
    v_lshlrev_b32 v95, 22, v122
    v_lshrrev_b32 v122, 16, v122
    v_alignbit_b32 v95, v122, v95, 10
    v_alignbit_b32 v95, v123, v95, 10
    v_xor_b32 v95, 0x80200800, v95
    s_waitcnt lgkmcnt(1)
    v_lshlrev_b32 v99, 22, v124
    v_lshrrev_b32 v124, 16, v124
    v_alignbit_b32 v99, v124, v99, 10
    v_alignbit_b32 v99, v125, v99, 10
    v_xor_b32 v99, 0x80200800, v99
    s_waitcnt lgkmcnt(0)
    v_lshlrev_b32 v15, 22, v126
    v_lshrrev_b32 v126, 16, v126
    v_alignbit_b32 v15, v126, v15, 10
    v_alignbit_b32 v15, v127, v15, 10
    v_xor_b32 v15, 0x80200800, v15
    s_add_u32 s32, s32, 256
    s_add_u32 s33, s33, 40960000
    s_add_u32 s34, s34, 20480000
    s_add_u32 s40, s40, 1
    s_cmp_lt_u32 s40, 4
    s_waitcnt lgkmcnt(0)
    s_cbranch_scc1 L_p1_loop
    s_mov_b32 s36, 0
    buffer_store_dwordx4 v[48:51], v3, s[20:23], s36 offen sc1
    s_mov_b32 s36, 1024
    buffer_store_dwordx4 v[52:55], v3, s[20:23], s36 offen sc1
    s_mov_b32 s36, 2048
    buffer_store_dwordx4 v[56:59], v3, s[20:23], s36 offen sc1
    s_mov_b32 s36, 3072
    buffer_store_dwordx4 v[60:63], v3, s[20:23], s36 offen sc1
    s_mov_b32 s36, 4096
    buffer_store_dwordx4 v[64:67], v3, s[20:23], s36 offen sc1
    s_mov_b32 s36, 5120
    buffer_store_dwordx4 v[68:71], v3, s[20:23], s36 offen sc1
    s_mov_b32 s36, 6144
    buffer_store_dwordx4 v[72:75], v3, s[20:23], s36 offen sc1
    s_mov_b32 s36, 7168
    buffer_store_dwordx4 v[76:79], v3, s[20:23], s36 offen sc1
    s_mov_b32 s36, 8192
    buffer_store_dwordx4 v[80:83], v3, s[20:23], s36 offen sc1
    s_mov_b32 s36, 9216
    buffer_store_dwordx4 v[84:87], v3, s[20:23], s36 offen sc1
    s_mov_b32 s36, 10240
    buffer_store_dwordx4 v[88:91], v3, s[20:23], s36 offen sc1
    s_mov_b32 s36, 11264
    buffer_store_dwordx4 v[92:95], v3, s[20:23], s36 offen sc1
    s_mov_b32 s36, 12288
    buffer_store_dwordx4 v[96:99], v3, s[20:23], s36 offen sc1
    s_cmp_lg_u32 s39, 15
    s_cbranch_scc1 L_p1_kernel_nox_4
    s_mov_b32 s36, 13312
    buffer_store_dwordx4 v[12:15], v3, s[20:23], s36 offen sc1
L_p1_kernel_nox_4:
    v_and_b32 v6, 0x34800000, v5
    v_cmp_ne_u32 vcc, 0, v6
    s_lshl_b32 s35, s39, 4
    s_add_u32 s35, s35, 160328
    v_mov_b32 v10, s35
    s_cmp_lg_u64 vcc, 0
    s_cselect_b32 s36, 1, s55
    v_mov_b32 v11, s36
    ds_write_b32 v10, v11
    s_waitcnt lgkmcnt(0)
    s_barrier
    s_cmp_lg_u32 s39, 0
    s_cbranch_scc1 L_p1_end
    v_and_b32 v6, 15, v0
    v_lshlrev_b32 v6, 4, v6
    v_add_u32 v6, 160320, v6
    ds_read_b128 v[8:11], v6
    s_waitcnt lgkmcnt(0)
    s_nop 1
    v_max_u32_dpp v8, v8, v8 row_shr:1 row_mask:0xf bank_mask:0xf bound_ctrl:0
    s_nop 1
    v_max_u32_dpp v8, v8, v8 row_shr:2 row_mask:0xf bank_mask:0xf bound_ctrl:0
    s_nop 1
    v_max_u32_dpp v8, v8, v8 row_shr:4 row_mask:0xf bank_mask:0xf bound_ctrl:0
    s_nop 1
    v_max_u32_dpp v8, v8, v8 row_shr:8 row_mask:0xf bank_mask:0xf bound_ctrl:0
    s_nop 1
    v_add_f32_dpp v9, v9, v9 row_shr:1 row_mask:0xf bank_mask:0xf bound_ctrl:0
    s_nop 1
    v_add_f32_dpp v9, v9, v9 row_shr:2 row_mask:0xf bank_mask:0xf bound_ctrl:0
    s_nop 1
    v_add_f32_dpp v9, v9, v9 row_shr:4 row_mask:0xf bank_mask:0xf bound_ctrl:0
    s_nop 1
    v_add_f32_dpp v9, v9, v9 row_shr:8 row_mask:0xf bank_mask:0xf bound_ctrl:0
    s_nop 1
    v_or_b32_dpp v10, v10, v10 row_shr:1 row_mask:0xf bank_mask:0xf bound_ctrl:0
    s_nop 1
    v_or_b32_dpp v10, v10, v10 row_shr:2 row_mask:0xf bank_mask:0xf bound_ctrl:0
    s_nop 1
    v_or_b32_dpp v10, v10, v10 row_shr:4 row_mask:0xf bank_mask:0xf bound_ctrl:0
    s_nop 1
    v_or_b32_dpp v10, v10, v10 row_shr:8 row_mask:0xf bank_mask:0xf bound_ctrl:0
    s_lshl_b32 s35, s2, 3
    s_add_u32 s35, s35, 8552960
    v_mov_b32 v6, 0
    v_lshl_or_b32 v8, v10, 16, v8
    s_mov_b64 exec, 0x8000
    buffer_store_dwordx2 v[8:9], v6, s[24:27], s35 offen
    s_lshl_b32 s35, s2, 8
    s_add_u32 s35, s35, 8561152
    buffer_store_dword v6, v6, s[24:27], s35 offen
L_p1_end:
    s_endpgm
.globl p2_kernel
.p2align 8
.type p2_kernel,@function
p2_kernel:
    s_cmp_ge_u32 s2, 256
    s_cbranch_scc1 L_p2_end
    s_load_dwordx2 s[4:5], s[0:1], 104
    s_load_dwordx2 s[100:101], s[0:1], 24
    s_load_dwordx2 s[30:31], s[0:1], 40
    s_load_dwordx4 s[32:35], s[0:1], 56
    s_load_dwordx4 s[36:39], s[0:1], 72
    s_and_b32 s14, s2, 7
    s_lshr_b32 s49, s2, 3
    s_and_b32 s3, s14, 1
    s_lshl_b32 s3, s3, 5
    s_add_u32 s3, s3, s49
    s_lshr_b32 s12, s14, 1
    v_lshrrev_b32 v108, 6, v0
    v_lshlrev_b32 v1, 4, v0
    v_and_b32 v109, 63, v0
    v_readfirstlane_b32 s13, v108
    v_lshlrev_b32 v111, 4, v109
    s_mul_i32 s14, s12, 65
    s_add_u32 s14, s14, s3
    s_mul_i32 s14, s14, 32896
    s_add_u32 s25, s14, 219029504
    s_mul_i32 s22, s12, 1280000
    s_mov_b32 s2, 0
    s_waitcnt lgkmcnt(0)
    s_mov_b32 s6, 655360000
    s_mov_b32 s7, 0x00020000
    s_add_u32 s8, s4, 227607040
    s_addc_u32 s9, s5, 0
    s_add_u32 s10, s22, 1280000
    s_mov_b32 s11, 0x00020000
    s_add_u32 s15, s25, 0
    buffer_load_dwordx4 v[28:31], v1, s[4:7], s15 offen
    s_add_u32 s15, s25, 32896
    buffer_load_dwordx4 v[36:39], v1, s[4:7], s15 offen
    s_load_dwordx4 s[40:43], s[30:31], 0
    s_load_dwordx16 s[52:67], s[32:33], 0
    s_load_dwordx16 s[68:83], s[34:35], 0
    s_load_dwordx8 s[84:91], s[36:37], 0
    s_load_dwordx8 s[92:99], s[38:39], 0
    v_mov_b32 v52, 0x100
    s_cmp_lg_u32 s13, 0
    s_cbranch_scc1 L_p2_noann
    s_lshl_b32 s14, s3, 8
    s_add_u32 s14, s14, 227590656
    s_mov_b64 exec, 1
    buffer_atomic_add v52, off, s[4:7], s14
    s_mov_b64 exec, -1
L_p2_noann:
    s_add_u32 s14, s22, 0
    buffer_load_dwordx4 v[88:91], v1, s[8:11], s14 offen
    s_add_u32 s14, s22, 16384
    buffer_load_dwordx4 v[92:95], v1, s[8:11], s14 offen
    s_add_u32 s14, s22, 32768
    buffer_load_dwordx4 v[96:99], v1, s[8:11], s14 offen
    s_add_u32 s14, s22, 49152
    buffer_load_dwordx4 v[100:103], v1, s[8:11], s14 offen
    s_add_u32 s14, s22, 65536
    buffer_load_dwordx4 v[104:107], v1, s[8:11], s14 offen
    s_mov_b32 s15, 227582464
    buffer_load_dwordx4 v[80:83], v111, s[4:7], s15 offen offset:0
    buffer_load_dwordx4 v[84:87], v111, s[4:7], s15 offen offset:1024
    s_add_u32 s15, s25, 16384
    buffer_load_dwordx4 v[32:35], v1, s[4:7], s15 offen
    s_add_u32 s15, s25, 49280
    buffer_load_dwordx4 v[40:43], v1, s[4:7], s15 offen
    v_add_u32 v2, 3072, v111
    v_mov_b32 v50, 21845
    v_add_u32 v3, 80000, v1
    v_add_u32 v124, 145536, v1
    v_add_u32 v113, 65536, v1
    v_mov_b32 v112, 0x7f000000
    v_cmp_gt_u32 vcc, 904, v0
    s_mul_i32 s19, s13, 240
    s_add_u32 s19, s19, 160000
    v_cndmask_b32 v124, v112, v124, vcc
    v_cndmask_b32 v113, v112, v113, vcc
    v_lshl_add_u32 v6, v109, 2, s19
    v_lshl_add_u32 v126, v109, 1, s19
    v_cmp_gt_u32 vcc, 10, v109
    s_mul_i32 s27, s13, 13688832
    s_mov_b32 s23, 213888
    v_cndmask_b32 v6, v112, v6, vcc
    s_mov_b32 s44, s4
    s_mov_b32 s45, s5
    s_add_u32 s46, s27, 13697024
    s_mov_b32 s47, 0x00020000
    s_mov_b32 s17, 0x05040100
    s_mov_b32 s18, 80000
    s_and_b32 s50, s3, 1
    s_lshl_b32 s50, s50, 18
    s_sub_u32 s50, 4294836224, s50
    s_mov_b32 s20, 3221209088
    s_mov_b32 s21, 3221209087
    v_mov_b32 v4, 0
    v_mov_b32 v5, 0
    v_mov_b32 v114, 320
    ds_write_b32 v6, v5 offset:160
    ds_write_b16 v126, v114 offset:2
    v_mov_b32 v44, 1073758208
    v_mov_b32 v45, 1073758208
    v_mov_b32 v46, 1073758208
    v_mov_b32 v47, 1073758208
    v_mov_b32 v48, 1073758208
    v_mov_b32 v49, 1073758208
    ds_write_b128 v1, v[44:47] offset:0
    ds_write_b128 v1, v[44:47] offset:16384
    ds_write_b128 v1, v[44:47] offset:32768
    ds_write_b128 v1, v[44:47] offset:49152
    ds_write_b128 v113, v[44:47]
    s_waitcnt lgkmcnt(0)
    v_mov_b32 v53, s40
    v_mov_b32 v54, s41
    v_mov_b32 v56, s42
    v_mov_b32 v57, s43
    s_mov_b32 s40, 20987904
    s_mov_b32 s41, 21031594
    s_pack_ll_b32_b16 s14, s52, s54
    s_pack_hh_b32_b16 s15, s52, s54
    s_pack_ll_b32_b16 s54, s53, s55
    s_pack_hh_b32_b16 s55, s53, s55
    s_mov_b32 s52, s14
    s_mov_b32 s53, s15
    s_pack_ll_b32_b16 s14, s56, s58
    s_pack_hh_b32_b16 s15, s56, s58
    s_pack_ll_b32_b16 s58, s57, s59
    s_pack_hh_b32_b16 s59, s57, s59
    s_mov_b32 s56, s14
    s_mov_b32 s57, s15
    s_pack_ll_b32_b16 s14, s60, s62
    s_pack_hh_b32_b16 s15, s60, s62
    s_pack_ll_b32_b16 s62, s61, s63
    s_pack_hh_b32_b16 s63, s61, s63
    s_mov_b32 s60, s14
    s_mov_b32 s61, s15
    s_pack_ll_b32_b16 s14, s64, s66
    s_pack_hh_b32_b16 s15, s64, s66
    s_pack_ll_b32_b16 s66, s65, s67
    s_pack_hh_b32_b16 s67, s65, s67
    s_mov_b32 s64, s14
    s_mov_b32 s65, s15
    s_pack_ll_b32_b16 s14, s68, s70
    s_pack_hh_b32_b16 s15, s68, s70
    s_pack_ll_b32_b16 s70, s69, s71
    s_pack_hh_b32_b16 s71, s69, s71
    s_mov_b32 s68, s14
    s_mov_b32 s69, s15
    s_pack_ll_b32_b16 s14, s72, s74
    s_pack_hh_b32_b16 s15, s72, s74
    s_pack_ll_b32_b16 s74, s73, s75
    s_pack_hh_b32_b16 s75, s73, s75
    s_mov_b32 s72, s14
    s_mov_b32 s73, s15
    s_pack_ll_b32_b16 s14, s76, s78
    s_pack_hh_b32_b16 s15, s76, s78
    s_pack_ll_b32_b16 s78, s77, s79
    s_pack_hh_b32_b16 s79, s77, s79
    s_mov_b32 s76, s14
    s_mov_b32 s77, s15
    s_pack_ll_b32_b16 s14, s80, s82
    s_pack_hh_b32_b16 s15, s80, s82
    s_pack_ll_b32_b16 s82, s81, s83
    s_pack_hh_b32_b16 s83, s81, s83
    s_mov_b32 s80, s14
    s_mov_b32 s81, s15
    s_waitcnt vmcnt(9)
    v_mad_u32_u16 v108, v28, v50, s40 op_sel:[0,0,0,0]
    v_mad_u32_u16 v109, v36, v50, s41 op_sel:[0,0,0,0]
    v_sub_u32_sdwa v110, v109, v108 dst_sel:DWORD dst_unused:UNUSED_PAD src0_sel:WORD_1 src1_sel:WORD_1
    s_nop 1
    v_add_u32_dpp v110, v110, v110 row_shr:1 row_mask:0xf bank_mask:0xf bound_ctrl:0
    s_nop 1
    v_add_u32_dpp v110, v110, v110 row_shr:2 row_mask:0xf bank_mask:0xf bound_ctrl:0
    s_nop 1
    v_add_u32_dpp v110, v110, v110 row_shr:4 row_mask:0xf bank_mask:0xf bound_ctrl:0
    s_nop 1
    v_add_u32_dpp v110, v110, v110 row_shr:8 row_mask:0xf bank_mask:0xf bound_ctrl:0
    s_nop 1
    v_add_u32_dpp v110, v110, v110 row_bcast:15 row_mask:0xa bank_mask:0xf
    s_nop 1
    v_add_u32_dpp v110, v110, v110 row_bcast:31 row_mask:0xc bank_mask:0xf
    v_sub_u32_sdwa v109, v109, v110 dst_sel:DWORD dst_unused:UNUSED_PAD src0_sel:WORD_1 src1_sel:DWORD
    v_readlane_b32 s29, v110, 63
    v_add_u32 v110, -1, v110
    ds_write_b16 v126, v109
    v_lshlrev_b32_e64 v111, v110, 1
    v_lshrrev_b32 v110, 5, v110
    v_lshl_add_u32 v110, v110, 2, s19
    s_cmp_gt_u32 s29, 320
    s_cselect_b32 s2, 1, s2
    s_cselect_b64 exec, 0, -1
    ds_or_b32 v110, v111 offset:160
    s_mov_b64 exec, -1
    ds_wrxchg_rtn_b32 v7, v6, v5 offset:160
    s_waitcnt lgkmcnt(0)
    v_readlane_b32 s30, v7, 0
    v_readlane_b32 s31, v7, 1
    v_readlane_b32 s32, v7, 2
    v_readlane_b32 s33, v7, 3
    v_readlane_b32 s34, v7, 4
    v_readlane_b32 s35, v7, 5
    v_readlane_b32 s36, v7, 6
    v_readlane_b32 s37, v7, 7
    s_mov_b32 s25, s19
    s_mov_b32 s26, s27
    s_mov_b32 s51, s28
    s_mov_b32 s28, s29
    v_mbcnt_lo_u32_b32 v8, s30, 0
    v_mbcnt_hi_u32_b32 v8, s31, v8
    s_bcnt1_i32_b64 s14, s[30:31]
    v_lshl_add_u32 v9, v8, 1, s25
    ds_read_u16 v9, v9
    v_mad_u32_u24 v8, v8, s23, v2
    s_mov_b32 s30, s26
    s_lshl1_add_u32 s25, s14, s25
    s_mul_i32 s14, s14, s23
    s_add_u32 s26, s26, s14
    v_mbcnt_lo_u32_b32 v12, s32, 0
    v_mbcnt_hi_u32_b32 v12, s33, v12
    s_bcnt1_i32_b64 s14, s[32:33]
    v_lshl_add_u32 v13, v12, 1, s25
    ds_read_u16 v13, v13
    v_mad_u32_u24 v12, v12, s23, v2
    s_mov_b32 s32, s26
    s_lshl1_add_u32 s25, s14, s25
    s_mul_i32 s14, s14, s23
    s_add_u32 s26, s26, s14
    v_mbcnt_lo_u32_b32 v16, s34, 0
    v_mbcnt_hi_u32_b32 v16, s35, v16
    s_bcnt1_i32_b64 s14, s[34:35]
    v_lshl_add_u32 v17, v16, 1, s25
    ds_read_u16 v17, v17
    v_mad_u32_u24 v16, v16, s23, v2
    s_mov_b32 s34, s26
    s_lshl1_add_u32 s25, s14, s25
    s_mul_i32 s14, s14, s23
    s_add_u32 s26, s26, s14
    v_mbcnt_lo_u32_b32 v20, s36, 0
    v_mbcnt_hi_u32_b32 v20, s37, v20
    s_bcnt1_i32_b64 s14, s[36:37]
    v_lshl_add_u32 v21, v20, 1, s25
    ds_read_u16 v21, v21
    v_mad_u32_u24 v20, v20, s23, v2
    s_mov_b32 s36, s26
    s_lshl1_add_u32 s25, s14, s25
    s_mul_i32 s14, s14, s23
    s_add_u32 s26, s26, s14
    s_waitcnt lgkmcnt(3)
    v_lshl_add_u32 v8, v9, 4, v8
    buffer_load_dwordx4 v[8:11], v8, s[44:47], s30 offen offset:0
    s_waitcnt lgkmcnt(2)
    v_lshl_add_u32 v12, v13, 4, v12
    buffer_load_dwordx4 v[12:15], v12, s[44:47], s32 offen offset:1024
    s_waitcnt lgkmcnt(1)
    v_lshl_add_u32 v16, v17, 4, v16
    buffer_load_dwordx4 v[16:19], v16, s[44:47], s34 offen offset:2048
    s_waitcnt lgkmcnt(0)
    v_lshl_add_u32 v20, v21, 4, v20
    buffer_load_dwordx4 v[20:23], v20, s[44:47], s36 offen offset:3072
    s_cmp_le_u32 s28, 256
    s_cbranch_scc1 L_p2_kernel_noopt_1
    v_readlane_b32 s38, v7, 8
    v_readlane_b32 s39, v7, 9
    s_nop 1
    v_mbcnt_lo_u32_b32 v118, s38, 0
    v_mbcnt_hi_u32_b32 v118, s39, v118
    s_bcnt1_i32_b64 s14, s[38:39]
    v_lshl_add_u32 v119, v118, 1, s25
    ds_read_u16 v119, v119
    v_mad_u32_u24 v118, v118, s23, v2
    s_mov_b32 s38, s26
    s_lshl1_add_u32 s25, s14, s25
    s_mul_i32 s14, s14, s23
    s_add_u32 s26, s26, s14
    s_waitcnt lgkmcnt(0)
    s_add_u32 s38, s38, 4096
    v_lshl_add_u32 v118, v119, 4, v118
    buffer_load_dwordx4 v[24:27], v118, s[44:47], s38 offen offset:0
L_p2_kernel_noopt_1:
    s_waitcnt vmcnt(8)
    ds_write_b128 v3, v[88:91] offset:0
    ds_write_b128 v3, v[92:95] offset:16384
    ds_write_b128 v3, v[96:99] offset:32768
    ds_write_b128 v3, v[100:103] offset:49152
    ds_write_b128 v124, v[104:107]
    s_waitcnt vmcnt(4)
    v_max3_u32 v64, v80, v82, v84
    v_add_f32 v65, v81, v83
    v_add_f32 v66, v85, v87
    v_max_u32 v64, v64, v86
    v_add_f32 v65, v65, v66
    v_cmp_lt_u32 vcc, 0xffff, v64
    s_nop 1
    v_max_u32_dpp v64, v64, v64 row_shr:1 row_mask:0xf bank_mask:0xf bound_ctrl:0
    s_nop 1
    v_max_u32_dpp v64, v64, v64 row_shr:2 row_mask:0xf bank_mask:0xf bound_ctrl:0
    s_nop 1
    v_max_u32_dpp v64, v64, v64 row_shr:4 row_mask:0xf bank_mask:0xf bound_ctrl:0
    s_nop 1
    v_max_u32_dpp v64, v64, v64 row_shr:8 row_mask:0xf bank_mask:0xf bound_ctrl:0
    s_nop 1
    v_max_u32_dpp v64, v64, v64 row_bcast:15 row_mask:0xa bank_mask:0xf
    s_nop 1
    v_max_u32_dpp v64, v64, v64 row_bcast:31 row_mask:0xc bank_mask:0xf
    s_nop 1
    v_add_f32_dpp v65, v65, v65 row_shr:1 row_mask:0xf bank_mask:0xf bound_ctrl:0
    s_nop 1
    v_add_f32_dpp v65, v65, v65 row_shr:2 row_mask:0xf bank_mask:0xf bound_ctrl:0
    s_nop 1
    v_add_f32_dpp v65, v65, v65 row_shr:4 row_mask:0xf bank_mask:0xf bound_ctrl:0
    s_nop 1
    v_add_f32_dpp v65, v65, v65 row_shr:8 row_mask:0xf bank_mask:0xf bound_ctrl:0
    s_nop 1
    v_add_f32_dpp v65, v65, v65 row_bcast:15 row_mask:0xa bank_mask:0xf
    s_nop 1
    v_add_f32_dpp v65, v65, v65 row_bcast:31 row_mask:0xc bank_mask:0xf
    s_cmp_lg_u64 vcc, 0
    s_cselect_b32 s2, 1, s2
    v_lshlrev_b32 v64, 16, v64
    v_mul_f32 v66, 936490775, v65
    v_mul_f32 v65, 928531664, v65
    v_cmp_nle_f32 vcc, v64, v66
    v_max_u32 v64, v64, v65
    s_nop 0
    v_readlane_b32 s14, v64, 63
    s_bitcmp1_b32 vcc_hi, 31
    s_cselect_b32 s2, 1, s2
    s_lshr_b32 s14, s14, 23
    s_add_u32 s14, s14, 1
    s_cmp_lt_u32 s14, 40
    s_cselect_b32 s2, 1, s2
    s_cmp_gt_u32 s14, 230
    s_cselect_b32 s2, 1, s2
    s_sub_u32 s48, s14, 14
    s_lshl_b32 s48, s48, 23
    s_add_u32 s16, s48, 272646144
    s_or_b32 s48, s48, 16416
    s_sub_u32 s14, s14, 40
    s_cmp_gt_u32 s14, 190
    s_cselect_b32 s48, 0, s48
    s_waitcnt lgkmcnt(0)
    s_barrier
    s_add_u32 s14, s22, 80000
    buffer_load_dwordx4 v[88:91], v1, s[8:11], s14 offen
    s_add_u32 s14, s22, 96384
    buffer_load_dwordx4 v[92:95], v1, s[8:11], s14 offen
    s_add_u32 s14, s22, 112768
    buffer_load_dwordx4 v[96:99], v1, s[8:11], s14 offen
    v_mad_u32_u16 v108, v28, v50, s40 op_sel:[1,0,0,0]
    v_mad_u32_u16 v109, v36, v50, s41 op_sel:[1,0,0,0]
    v_sub_u32_sdwa v110, v109, v108 dst_sel:DWORD dst_unused:UNUSED_PAD src0_sel:WORD_1 src1_sel:WORD_1
    s_nop 1
    v_add_u32_dpp v110, v110, v110 row_shr:1 row_mask:0xf bank_mask:0xf bound_ctrl:0
    s_nop 1
    v_add_u32_dpp v110, v110, v110 row_shr:2 row_mask:0xf bank_mask:0xf bound_ctrl:0
    s_nop 1
    v_add_u32_dpp v110, v110, v110 row_shr:4 row_mask:0xf bank_mask:0xf bound_ctrl:0
    s_nop 1
    v_add_u32_dpp v110, v110, v110 row_shr:8 row_mask:0xf bank_mask:0xf bound_ctrl:0
    s_nop 1
    v_add_u32_dpp v110, v110, v110 row_bcast:15 row_mask:0xa bank_mask:0xf
    s_nop 1
    v_add_u32_dpp v110, v110, v110 row_bcast:31 row_mask:0xc bank_mask:0xf
    v_sub_u32_sdwa v109, v109, v110 dst_sel:DWORD dst_unused:UNUSED_PAD src0_sel:WORD_1 src1_sel:DWORD
    v_readlane_b32 s29, v110, 63
    v_add_u32 v110, -1, v110
    ds_write_b16 v126, v109
    v_lshlrev_b32_e64 v111, v110, 1
    v_lshrrev_b32 v110, 5, v110
    v_lshl_add_u32 v110, v110, 2, s19
    s_cmp_gt_u32 s29, 320
    s_cselect_b32 s2, 1, s2
    s_cselect_b64 exec, 0, -1
    ds_or_b32 v110, v111 offset:160
    s_mov_b64 exec, -1
    ds_wrxchg_rtn_b32 v7, v6, v5 offset:160
    s_mov_b32 s24, 0
L_p2_loop:
    s_add_u32 s22, s22, 80000
    s_lshl_b32 s14, s13, 4
    s_or_b32 s14, s14, s24
    s_cmp_lg_u32 s14, 5
    s_cbranch_scc1 L_p2_nost
    v_mov_b32 v52, 0
    s_lshl_b32 s14, s3, 8
    s_add_u32 s14, s14, 227590656
    s_mov_b64 exec, 1
    buffer_atomic_add v52, off, s[4:7], s14 sc0
    s_mov_b64 exec, -1
L_p2_nost:
    s_waitcnt vmcnt(6)
    v_mad_u32_u16 v64, v8, 8, s18
    v_mad_u32_u16 v66, v9, 8, s18
    v_mad_u32_u16 v68, v10, 8, s18
    ds_read_b64 v[64:65], v64
    ds_read_b64 v[66:67], v66
    ds_read_b64 v[68:69], v68
    s_add_u32 s14, s22, 49152
    buffer_load_dwordx4 v[100:103], v1, s[8:11], s14 offen
    s_waitcnt vmcnt(6)
    v_mad_u32_u16 v70, v12, 8, s18
    v_mad_u32_u16 v72, v13, 8, s18
    v_mad_u32_u16 v74, v14, 8, s18
    ds_read_b64 v[70:71], v70
    ds_read_b64 v[72:73], v72
    ds_read_b64 v[74:75], v74
    s_add_u32 s14, s22, 65536
    buffer_load_dwordx4 v[104:107], v1, s[8:11], s14 offen
    s_waitcnt lgkmcnt(6)
    v_readlane_b32 s30, v7, 0
    v_readlane_b32 s31, v7, 1
    v_readlane_b32 s32, v7, 2
    v_readlane_b32 s33, v7, 3
    v_readlane_b32 s34, v7, 4
    v_readlane_b32 s35, v7, 5
    v_readlane_b32 s36, v7, 6
    v_readlane_b32 s37, v7, 7
    s_mov_b32 s25, s19
    s_mov_b32 s26, s27
    s_mov_b32 s51, s28
    s_mov_b32 s28, s29
    v_mbcnt_lo_u32_b32 v118, s30, 0
    v_mbcnt_hi_u32_b32 v118, s31, v118
    s_bcnt1_i32_b64 s14, s[30:31]
    v_lshl_add_u32 v119, v118, 1, s25
    ds_read_u16 v119, v119
    v_mad_u32_u24 v118, v118, s23, v2
    s_mov_b32 s30, s26
    s_lshl1_add_u32 s25, s14, s25
    s_mul_i32 s14, s14, s23
    s_add_u32 s26, s26, s14
    v_bfe_i32 v108, v11, 2, 10
    v_bfe_i32 v109, v11, 12, 10
    v_ashrrev_i32 v110, 22, v11
    v_cvt_f32_i32 v108, v108
    v_cvt_f32_i32 v109, v109
    v_cvt_f32_i32 v110, v110
    v_mad_u32_u16 v8, v8, 8, s50 op_sel:[1,0,0,0]
    v_mad_u32_u16 v9, v9, 8, s50 op_sel:[1,0,0,0]
    v_mad_u32_u16 v10, v10, 8, s50 op_sel:[1,0,0,0]
    s_waitcnt lgkmcnt(4)
    v_lshlrev_b32 v112, 16, v64
    v_and_b32 v113, 0xffff0000, v64
    v_lshlrev_b32 v64, 16, v65
    v_and_b32 v65, 0xffff0000, v65
    v_lshlrev_b32 v114, 16, v66
    v_and_b32 v115, 0xffff0000, v66
    v_lshlrev_b32 v66, 16, v67
    v_and_b32 v67, 0xffff0000, v67
    v_lshlrev_b32 v116, 16, v68
    v_and_b32 v117, 0xffff0000, v68
    v_lshlrev_b32 v68, 16, v69
    v_and_b32 v69, 0xffff0000, v69
    v_pk_fma_f32 v[112:113], v[112:113], v[108:109], s[16:17] op_sel:[0,0,0] op_sel_hi:[1,0,0]
    v_pk_fma_f32 v[64:65], v[64:65], v[108:109], s[16:17] op_sel:[0,0,0] op_sel_hi:[1,0,0]
    v_pk_fma_f32 v[114:115], v[114:115], v[108:109], s[16:17] op_sel:[0,1,0] op_sel_hi:[1,1,0]
    v_pk_fma_f32 v[66:67], v[66:67], v[108:109], s[16:17] op_sel:[0,1,0] op_sel_hi:[1,1,0]
    v_pk_fma_f32 v[116:117], v[116:117], v[110:111], s[16:17] op_sel:[0,0,0] op_sel_hi:[1,0,0]
    v_pk_fma_f32 v[68:69], v[68:69], v[110:111], s[16:17] op_sel:[0,0,0] op_sel_hi:[1,0,0]
    v_perm_b32 v65, v65, v64, s17
    v_perm_b32 v64, v113, v112, s17
    v_perm_b32 v67, v67, v66, s17
    v_perm_b32 v66, v115, v114, s17
    v_perm_b32 v69, v69, v68, s17
    v_perm_b32 v68, v117, v116, s17
    v_lshl_add_u64 v[64:65], v[64:65], 0, s[20:21]
    v_lshl_add_u64 v[66:67], v[66:67], 0, s[20:21]
    v_lshl_add_u64 v[68:69], v[68:69], 0, s[20:21]
    v_or3_b32 v4, v44, v45, v4
    v_or3_b32 v4, v46, v47, v4
    v_or3_b32 v4, v48, v49, v4
    ds_add_rtn_u64 v[44:45], v8, v[64:65]
    ds_add_rtn_u64 v[46:47], v9, v[66:67]
    ds_add_rtn_u64 v[48:49], v10, v[68:69]
    s_waitcnt lgkmcnt(3)
    v_lshl_add_u32 v118, v119, 4, v118
    buffer_load_dwordx4 v[8:11], v118, s[44:47], s30 offen offset:0
    s_waitcnt vmcnt(7)
    v_mad_u32_u16 v76, v16, 8, s18
    v_mad_u32_u16 v78, v17, 8, s18
    v_mad_u32_u16 v80, v18, 8, s18
    ds_read_b64 v[76:77], v76
    ds_read_b64 v[78:79], v78
    ds_read_b64 v[80:81], v80
    s_waitcnt vmcnt(6)
    v_mad_u32_u16 v82, v20, 8, s18
    v_mad_u32_u16 v84, v21, 8, s18
    v_mad_u32_u16 v86, v22, 8, s18
    ds_read_b64 v[82:83], v82
    ds_read_b64 v[84:85], v84
    ds_read_b64 v[86:87], v86
    v_mbcnt_lo_u32_b32 v118, s32, 0
    v_mbcnt_hi_u32_b32 v118, s33, v118
    s_bcnt1_i32_b64 s14, s[32:33]
    v_lshl_add_u32 v119, v118, 1, s25
    ds_read_u16 v119, v119
    v_mad_u32_u24 v118, v118, s23, v2
    s_mov_b32 s32, s26
    s_lshl1_add_u32 s25, s14, s25
    s_mul_i32 s14, s14, s23
    s_add_u32 s26, s26, s14
    v_bfe_i32 v108, v15, 2, 10
    v_bfe_i32 v109, v15, 12, 10
    v_ashrrev_i32 v110, 22, v15
    v_cvt_f32_i32 v108, v108
    v_cvt_f32_i32 v109, v109
    v_cvt_f32_i32 v110, v110
    v_mad_u32_u16 v12, v12, 8, s50 op_sel:[1,0,0,0]
    v_mad_u32_u16 v13, v13, 8, s50 op_sel:[1,0,0,0]
    v_mad_u32_u16 v14, v14, 8, s50 op_sel:[1,0,0,0]
    v_lshlrev_b32 v112, 16, v70
    v_and_b32 v113, 0xffff0000, v70
    v_lshlrev_b32 v70, 16, v71
    v_and_b32 v71, 0xffff0000, v71
    v_lshlrev_b32 v114, 16, v72
    v_and_b32 v115, 0xffff0000, v72
    v_lshlrev_b32 v72, 16, v73
    v_and_b32 v73, 0xffff0000, v73
    v_lshlrev_b32 v116, 16, v74
    v_and_b32 v117, 0xffff0000, v74
    v_lshlrev_b32 v74, 16, v75
    v_and_b32 v75, 0xffff0000, v75
    v_pk_fma_f32 v[112:113], v[112:113], v[108:109], s[16:17] op_sel:[0,0,0] op_sel_hi:[1,0,0]
    v_pk_fma_f32 v[70:71], v[70:71], v[108:109], s[16:17] op_sel:[0,0,0] op_sel_hi:[1,0,0]
    v_pk_fma_f32 v[114:115], v[114:115], v[108:109], s[16:17] op_sel:[0,1,0] op_sel_hi:[1,1,0]
    v_pk_fma_f32 v[72:73], v[72:73], v[108:109], s[16:17] op_sel:[0,1,0] op_sel_hi:[1,1,0]
    v_pk_fma_f32 v[116:117], v[116:117], v[110:111], s[16:17] op_sel:[0,0,0] op_sel_hi:[1,0,0]
    v_pk_fma_f32 v[74:75], v[74:75], v[110:111], s[16:17] op_sel:[0,0,0] op_sel_hi:[1,0,0]
    v_perm_b32 v71, v71, v70, s17
    v_perm_b32 v70, v113, v112, s17
    v_perm_b32 v73, v73, v72, s17
    v_perm_b32 v72, v115, v114, s17
    v_perm_b32 v75, v75, v74, s17
    v_perm_b32 v74, v117, v116, s17
    v_lshl_add_u64 v[70:71], v[70:71], 0, s[20:21]
    v_lshl_add_u64 v[72:73], v[72:73], 0, s[20:21]
    v_lshl_add_u64 v[74:75], v[74:75], 0, s[20:21]
    s_waitcnt lgkmcnt(7)
    v_or3_b32 v4, v44, v45, v4
    v_or3_b32 v4, v46, v47, v4
    v_or3_b32 v4, v48, v49, v4
    ds_add_rtn_u64 v[44:45], v12, v[70:71]
    ds_add_rtn_u64 v[46:47], v13, v[72:73]
    ds_add_rtn_u64 v[48:49], v14, v[74:75]
    s_waitcnt lgkmcnt(3)
    v_lshl_add_u32 v118, v119, 4, v118
    buffer_load_dwordx4 v[12:15], v118, s[44:47], s32 offen offset:1024
    s_cmp_le_u32 s51, 256
    s_cbranch_scc1 L_p2_kernel_noopt2_2
    v_mad_u32_u16 v64, v24, 8, s18
    v_mad_u32_u16 v66, v25, 8, s18
    v_mad_u32_u16 v68, v26, 8, s18
    ds_read_b64 v[64:65], v64
    ds_read_b64 v[66:67], v66
    ds_read_b64 v[68:69], v68
    v_bfe_i32 v108, v27, 2, 10
    v_bfe_i32 v109, v27, 12, 10
    v_ashrrev_i32 v110, 22, v27
    v_cvt_f32_i32 v108, v108
    v_cvt_f32_i32 v109, v109
    v_cvt_f32_i32 v110, v110
    v_mad_u32_u16 v24, v24, 8, s50 op_sel:[1,0,0,0]
    v_mad_u32_u16 v25, v25, 8, s50 op_sel:[1,0,0,0]
    v_mad_u32_u16 v26, v26, 8, s50 op_sel:[1,0,0,0]
    s_waitcnt lgkmcnt(0)
    v_lshlrev_b32 v112, 16, v64
    v_and_b32 v113, 0xffff0000, v64
    v_lshlrev_b32 v64, 16, v65
    v_and_b32 v65, 0xffff0000, v65
    v_lshlrev_b32 v114, 16, v66
    v_and_b32 v115, 0xffff0000, v66
    v_lshlrev_b32 v66, 16, v67
    v_and_b32 v67, 0xffff0000, v67
    v_lshlrev_b32 v116, 16, v68
    v_and_b32 v117, 0xffff0000, v68
    v_lshlrev_b32 v68, 16, v69
    v_and_b32 v69, 0xffff0000, v69
    v_pk_fma_f32 v[112:113], v[112:113], v[108:109], s[16:17] op_sel:[0,0,0] op_sel_hi:[1,0,0]
    v_pk_fma_f32 v[64:65], v[64:65], v[108:109], s[16:17] op_sel:[0,0,0] op_sel_hi:[1,0,0]
    v_pk_fma_f32 v[114:115], v[114:115], v[108:109], s[16:17] op_sel:[0,1,0] op_sel_hi:[1,1,0]
    v_pk_fma_f32 v[66:67], v[66:67], v[108:109], s[16:17] op_sel:[0,1,0] op_sel_hi:[1,1,0]
    v_pk_fma_f32 v[116:117], v[116:117], v[110:111], s[16:17] op_sel:[0,0,0] op_sel_hi:[1,0,0]
    v_pk_fma_f32 v[68:69], v[68:69], v[110:111], s[16:17] op_sel:[0,0,0] op_sel_hi:[1,0,0]
    v_perm_b32 v65, v65, v64, s17
    v_perm_b32 v64, v113, v112, s17
    v_perm_b32 v67, v67, v66, s17
    v_perm_b32 v66, v115, v114, s17
    v_perm_b32 v69, v69, v68, s17
    v_perm_b32 v68, v117, v116, s17
    v_lshl_add_u64 v[64:65], v[64:65], 0, s[20:21]
    v_lshl_add_u64 v[66:67], v[66:67], 0, s[20:21]
    v_lshl_add_u64 v[68:69], v[68:69], 0, s[20:21]
    v_or3_b32 v4, v44, v45, v4
    v_or3_b32 v4, v46, v47, v4
    v_or3_b32 v4, v48, v49, v4
    ds_add_rtn_u64 v[44:45], v24, v[64:65]
    ds_add_rtn_u64 v[46:47], v25, v[66:67]
    ds_add_rtn_u64 v[48:49], v26, v[68:69]
L_p2_kernel_noopt2_2:
    s_barrier
    s_waitcnt vmcnt(2)
    ds_write_b128 v3, v[88:91] offset:0
    ds_write_b128 v3, v[92:95] offset:16384
    ds_write_b128 v3, v[96:99] offset:32768
    ds_write_b128 v3, v[100:103] offset:49152
    ds_write_b128 v124, v[104:107]
    v_mbcnt_lo_u32_b32 v118, s34, 0
    v_mbcnt_hi_u32_b32 v118, s35, v118
    s_bcnt1_i32_b64 s14, s[34:35]
    v_lshl_add_u32 v119, v118, 1, s25
    ds_read_u16 v119, v119
    v_mad_u32_u24 v118, v118, s23, v2
    s_mov_b32 s34, s26
    s_lshl1_add_u32 s25, s14, s25
    s_mul_i32 s14, s14, s23
    s_add_u32 s26, s26, s14
    v_bfe_i32 v108, v19, 2, 10
    v_bfe_i32 v109, v19, 12, 10
    v_ashrrev_i32 v110, 22, v19
    v_cvt_f32_i32 v108, v108
    v_cvt_f32_i32 v109, v109
    v_cvt_f32_i32 v110, v110
    v_mad_u32_u16 v16, v16, 8, s50 op_sel:[1,0,0,0]
    v_mad_u32_u16 v17, v17, 8, s50 op_sel:[1,0,0,0]
    v_mad_u32_u16 v18, v18, 8, s50 op_sel:[1,0,0,0]
    v_lshlrev_b32 v112, 16, v76
    v_and_b32 v113, 0xffff0000, v76
    v_lshlrev_b32 v76, 16, v77
    v_and_b32 v77, 0xffff0000, v77
    v_lshlrev_b32 v114, 16, v78
    v_and_b32 v115, 0xffff0000, v78
    v_lshlrev_b32 v78, 16, v79
    v_and_b32 v79, 0xffff0000, v79
    v_lshlrev_b32 v116, 16, v80
    v_and_b32 v117, 0xffff0000, v80
    v_lshlrev_b32 v80, 16, v81
    v_and_b32 v81, 0xffff0000, v81
    v_pk_fma_f32 v[112:113], v[112:113], v[108:109], s[16:17] op_sel:[0,0,0] op_sel_hi:[1,0,0]
    v_pk_fma_f32 v[76:77], v[76:77], v[108:109], s[16:17] op_sel:[0,0,0] op_sel_hi:[1,0,0]
    v_pk_fma_f32 v[114:115], v[114:115], v[108:109], s[16:17] op_sel:[0,1,0] op_sel_hi:[1,1,0]
    v_pk_fma_f32 v[78:79], v[78:79], v[108:109], s[16:17] op_sel:[0,1,0] op_sel_hi:[1,1,0]
    v_pk_fma_f32 v[116:117], v[116:117], v[110:111], s[16:17] op_sel:[0,0,0] op_sel_hi:[1,0,0]
    v_pk_fma_f32 v[80:81], v[80:81], v[110:111], s[16:17] op_sel:[0,0,0] op_sel_hi:[1,0,0]
    v_perm_b32 v77, v77, v76, s17
    v_perm_b32 v76, v113, v112, s17
    v_perm_b32 v79, v79, v78, s17
    v_perm_b32 v78, v115, v114, s17
    v_perm_b32 v81, v81, v80, s17
    v_perm_b32 v80, v117, v116, s17
    v_lshl_add_u64 v[76:77], v[76:77], 0, s[20:21]
    v_lshl_add_u64 v[78:79], v[78:79], 0, s[20:21]
    v_lshl_add_u64 v[80:81], v[80:81], 0, s[20:21]
    s_waitcnt lgkmcnt(6)
    v_or3_b32 v4, v44, v45, v4
    v_or3_b32 v4, v46, v47, v4
    v_or3_b32 v4, v48, v49, v4
    ds_add_rtn_u64 v[44:45], v16, v[76:77]
    ds_add_rtn_u64 v[46:47], v17, v[78:79]
    ds_add_rtn_u64 v[48:49], v18, v[80:81]
    s_waitcnt lgkmcnt(3)
    v_lshl_add_u32 v118, v119, 4, v118
    buffer_load_dwordx4 v[16:19], v118, s[44:47], s34 offen offset:2048
    v_mbcnt_lo_u32_b32 v118, s36, 0
    v_mbcnt_hi_u32_b32 v118, s37, v118
    s_bcnt1_i32_b64 s14, s[36:37]
    v_lshl_add_u32 v119, v118, 1, s25
    ds_read_u16 v119, v119
    v_mad_u32_u24 v118, v118, s23, v2
    s_mov_b32 s36, s26
    s_lshl1_add_u32 s25, s14, s25
    s_mul_i32 s14, s14, s23
    s_add_u32 s26, s26, s14
    v_bfe_i32 v108, v23, 2, 10
    v_bfe_i32 v109, v23, 12, 10
    v_ashrrev_i32 v110, 22, v23
    v_cvt_f32_i32 v108, v108
    v_cvt_f32_i32 v109, v109
    v_cvt_f32_i32 v110, v110
    v_mad_u32_u16 v20, v20, 8, s50 op_sel:[1,0,0,0]
    v_mad_u32_u16 v21, v21, 8, s50 op_sel:[1,0,0,0]
    v_mad_u32_u16 v22, v22, 8, s50 op_sel:[1,0,0,0]
    v_lshlrev_b32 v112, 16, v82
    v_and_b32 v113, 0xffff0000, v82
    v_lshlrev_b32 v82, 16, v83
    v_and_b32 v83, 0xffff0000, v83
    v_lshlrev_b32 v114, 16, v84
    v_and_b32 v115, 0xffff0000, v84
    v_lshlrev_b32 v84, 16, v85
    v_and_b32 v85, 0xffff0000, v85
    v_lshlrev_b32 v116, 16, v86
    v_and_b32 v117, 0xffff0000, v86
    v_lshlrev_b32 v86, 16, v87
    v_and_b32 v87, 0xffff0000, v87
    v_pk_fma_f32 v[112:113], v[112:113], v[108:109], s[16:17] op_sel:[0,0,0] op_sel_hi:[1,0,0]
    v_pk_fma_f32 v[82:83], v[82:83], v[108:109], s[16:17] op_sel:[0,0,0] op_sel_hi:[1,0,0]
    v_pk_fma_f32 v[114:115], v[114:115], v[108:109], s[16:17] op_sel:[0,1,0] op_sel_hi:[1,1,0]
    v_pk_fma_f32 v[84:85], v[84:85], v[108:109], s[16:17] op_sel:[0,1,0] op_sel_hi:[1,1,0]
    v_pk_fma_f32 v[116:117], v[116:117], v[110:111], s[16:17] op_sel:[0,0,0] op_sel_hi:[1,0,0]
    v_pk_fma_f32 v[86:87], v[86:87], v[110:111], s[16:17] op_sel:[0,0,0] op_sel_hi:[1,0,0]
    v_perm_b32 v83, v83, v82, s17
    v_perm_b32 v82, v113, v112, s17
    v_perm_b32 v85, v85, v84, s17
    v_perm_b32 v84, v115, v114, s17
    v_perm_b32 v87, v87, v86, s17
    v_perm_b32 v86, v117, v116, s17
    v_lshl_add_u64 v[82:83], v[82:83], 0, s[20:21]
    v_lshl_add_u64 v[84:85], v[84:85], 0, s[20:21]
    v_lshl_add_u64 v[86:87], v[86:87], 0, s[20:21]
    s_waitcnt lgkmcnt(1)
    v_or3_b32 v4, v44, v45, v4
    v_or3_b32 v4, v46, v47, v4
    v_or3_b32 v4, v48, v49, v4
    ds_add_rtn_u64 v[44:45], v20, v[82:83]
    ds_add_rtn_u64 v[46:47], v21, v[84:85]
    ds_add_rtn_u64 v[48:49], v22, v[86:87]
    s_waitcnt lgkmcnt(3)
    v_lshl_add_u32 v118, v119, 4, v118
    buffer_load_dwordx4 v[20:23], v118, s[44:47], s36 offen offset:3072
    s_cmp_le_u32 s28, 256
    s_cbranch_scc1 L_p2_kernel_noopt_3
    v_readlane_b32 s38, v7, 8
    v_readlane_b32 s39, v7, 9
    s_nop 1
    v_mbcnt_lo_u32_b32 v118, s38, 0
    v_mbcnt_hi_u32_b32 v118, s39, v118
    s_bcnt1_i32_b64 s14, s[38:39]
    v_lshl_add_u32 v119, v118, 1, s25
    ds_read_u16 v119, v119
    v_mad_u32_u24 v118, v118, s23, v2
    s_mov_b32 s38, s26
    s_lshl1_add_u32 s25, s14, s25
    s_mul_i32 s14, s14, s23
    s_add_u32 s26, s26, s14
    s_waitcnt lgkmcnt(0)
    s_add_u32 s38, s38, 4096
    v_lshl_add_u32 v118, v119, 4, v118
    buffer_load_dwordx4 v[24:27], v118, s[44:47], s38 offen offset:0
L_p2_kernel_noopt_3:
    v_pk_mov_b32 v[28:29], v[28:29], v[30:31] op_sel:[1,0]
    v_pk_mov_b32 v[30:31], v[30:31], v[32:33] op_sel:[1,0]
    v_pk_mov_b32 v[32:33], v[32:33], v[34:35] op_sel:[1,0]
    v_pk_mov_b32 v[34:35], v[34:35], v[4:5] op_sel:[1,1]
    v_pk_mov_b32 v[36:37], v[36:37], v[38:39] op_sel:[1,0]
    v_pk_mov_b32 v[38:39], v[38:39], v[40:41] op_sel:[1,0]
    v_pk_mov_b32 v[40:41], v[40:41], v[42:43] op_sel:[1,0]
    v_pk_mov_b32 v[42:43], v[42:43], v[4:5] op_sel:[1,1]
    v_mad_u32_u16 v108, v28, v50, s40 op_sel:[0,0,0,0]
    v_mad_u32_u16 v109, v36, v50, s41 op_sel:[0,0,0,0]
    v_sub_u32_sdwa v110, v109, v108 dst_sel:DWORD dst_unused:UNUSED_PAD src0_sel:WORD_1 src1_sel:WORD_1
    s_nop 1
    v_add_u32_dpp v110, v110, v110 row_shr:1 row_mask:0xf bank_mask:0xf bound_ctrl:0
    s_nop 1
    v_add_u32_dpp v110, v110, v110 row_shr:2 row_mask:0xf bank_mask:0xf bound_ctrl:0
    s_nop 1
    v_add_u32_dpp v110, v110, v110 row_shr:4 row_mask:0xf bank_mask:0xf bound_ctrl:0
    s_nop 1
    v_add_u32_dpp v110, v110, v110 row_shr:8 row_mask:0xf bank_mask:0xf bound_ctrl:0
    s_nop 1
    v_add_u32_dpp v110, v110, v110 row_bcast:15 row_mask:0xa bank_mask:0xf
    s_nop 1
    v_add_u32_dpp v110, v110, v110 row_bcast:31 row_mask:0xc bank_mask:0xf
    v_sub_u32_sdwa v109, v109, v110 dst_sel:DWORD dst_unused:UNUSED_PAD src0_sel:WORD_1 src1_sel:DWORD
    v_readlane_b32 s29, v110, 63
    v_add_u32 v110, -1, v110
    ds_write_b16 v126, v109
    v_lshlrev_b32_e64 v111, v110, 1
    v_lshrrev_b32 v110, 5, v110
    v_lshl_add_u32 v110, v110, 2, s19
    s_cmp_gt_u32 s29, 320
    s_cselect_b32 s2, 1, s2
    s_cselect_b64 exec, 0, -1
    ds_or_b32 v110, v111 offset:160
    s_mov_b64 exec, -1
    ds_wrxchg_rtn_b32 v7, v6, v5 offset:160
    s_add_u32 s14, s22, 80000
    buffer_load_dwordx4 v[88:91], v1, s[8:11], s14 offen
    s_add_u32 s14, s22, 96384
    buffer_load_dwordx4 v[92:95], v1, s[8:11], s14 offen
    s_add_u32 s14, s22, 112768
    buffer_load_dwordx4 v[96:99], v1, s[8:11], s14 offen
    s_barrier
    s_add_u32 s22, s22, 80000
    s_cmp_lg_u32 s24, 7
    s_cbranch_scc1 L_p2_nodist
    s_mov_b32 s46, 0
    s_lshl2_add_u32 s14, s3, s12
    s_mul_i32 s14, s14, 5000
    s_add_u32 s15, s14, 4096
    v_min_u32 v61, 225, v0
    v_lshl_add_u32 v60, v0, 2, s14
    v_lshl_add_u32 v61, v61, 2, s15
    global_load_dword v60, v60, s[100:101] nt
    global_load_dword v61, v61, s[100:101] nt
L_p2_nodist:
    s_waitcnt vmcnt(6)
    v_mad_u32_u16 v64, v8, 8, s18
    v_mad_u32_u16 v66, v9, 8, s18
    v_mad_u32_u16 v68, v10, 8, s18
    ds_read_b64 v[64:65], v64
    ds_read_b64 v[66:67], v66
    ds_read_b64 v[68:69], v68
    s_add_u32 s14, s22, 49152
    buffer_load_dwordx4 v[100:103], v1, s[8:11], s14 offen
    s_waitcnt vmcnt(6)
    v_mad_u32_u16 v70, v12, 8, s18
    v_mad_u32_u16 v72, v13, 8, s18
    v_mad_u32_u16 v74, v14, 8, s18
    ds_read_b64 v[70:71], v70
    ds_read_b64 v[72:73], v72
    ds_read_b64 v[74:75], v74
    s_add_u32 s14, s22, 65536
    buffer_load_dwordx4 v[104:107], v1, s[8:11], s14 offen
    s_waitcnt lgkmcnt(6)
    v_readlane_b32 s30, v7, 0
    v_readlane_b32 s31, v7, 1
    v_readlane_b32 s32, v7, 2
    v_readlane_b32 s33, v7, 3
    v_readlane_b32 s34, v7, 4
    v_readlane_b32 s35, v7, 5
    v_readlane_b32 s36, v7, 6
    v_readlane_b32 s37, v7, 7
    s_mov_b32 s25, s19
    s_mov_b32 s26, s27
    s_mov_b32 s51, s28
    s_mov_b32 s28, s29
    v_mbcnt_lo_u32_b32 v118, s30, 0
    v_mbcnt_hi_u32_b32 v118, s31, v118
    s_bcnt1_i32_b64 s14, s[30:31]
    v_lshl_add_u32 v119, v118, 1, s25
    ds_read_u16 v119, v119
    v_mad_u32_u24 v118, v118, s23, v2
    s_mov_b32 s30, s26
    s_lshl1_add_u32 s25, s14, s25
    s_mul_i32 s14, s14, s23
    s_add_u32 s26, s26, s14
    v_bfe_i32 v108, v11, 2, 10
    v_bfe_i32 v109, v11, 12, 10
    v_ashrrev_i32 v110, 22, v11
    v_cvt_f32_i32 v108, v108
    v_cvt_f32_i32 v109, v109
    v_cvt_f32_i32 v110, v110
    v_mad_u32_u16 v8, v8, 8, s50 op_sel:[1,0,0,0]
    v_mad_u32_u16 v9, v9, 8, s50 op_sel:[1,0,0,0]
    v_mad_u32_u16 v10, v10, 8, s50 op_sel:[1,0,0,0]
    s_waitcnt lgkmcnt(4)
    v_lshlrev_b32 v112, 16, v64
    v_and_b32 v113, 0xffff0000, v64
    v_lshlrev_b32 v64, 16, v65
    v_and_b32 v65, 0xffff0000, v65
    v_lshlrev_b32 v114, 16, v66
    v_and_b32 v115, 0xffff0000, v66
    v_lshlrev_b32 v66, 16, v67
    v_and_b32 v67, 0xffff0000, v67
    v_lshlrev_b32 v116, 16, v68
    v_and_b32 v117, 0xffff0000, v68
    v_lshlrev_b32 v68, 16, v69
    v_and_b32 v69, 0xffff0000, v69
    v_pk_fma_f32 v[112:113], v[112:113], v[108:109], s[16:17] op_sel:[0,0,0] op_sel_hi:[1,0,0]
    v_pk_fma_f32 v[64:65], v[64:65], v[108:109], s[16:17] op_sel:[0,0,0] op_sel_hi:[1,0,0]
    v_pk_fma_f32 v[114:115], v[114:115], v[108:109], s[16:17] op_sel:[0,1,0] op_sel_hi:[1,1,0]
    v_pk_fma_f32 v[66:67], v[66:67], v[108:109], s[16:17] op_sel:[0,1,0] op_sel_hi:[1,1,0]
    v_pk_fma_f32 v[116:117], v[116:117], v[110:111], s[16:17] op_sel:[0,0,0] op_sel_hi:[1,0,0]
    v_pk_fma_f32 v[68:69], v[68:69], v[110:111], s[16:17] op_sel:[0,0,0] op_sel_hi:[1,0,0]
    v_perm_b32 v65, v65, v64, s17
    v_perm_b32 v64, v113, v112, s17
    v_perm_b32 v67, v67, v66, s17
    v_perm_b32 v66, v115, v114, s17
    v_perm_b32 v69, v69, v68, s17
    v_perm_b32 v68, v117, v116, s17
    v_lshl_add_u64 v[64:65], v[64:65], 0, s[20:21]
    v_lshl_add_u64 v[66:67], v[66:67], 0, s[20:21]
    v_lshl_add_u64 v[68:69], v[68:69], 0, s[20:21]
    v_or3_b32 v4, v44, v45, v4
    v_or3_b32 v4, v46, v47, v4
    v_or3_b32 v4, v48, v49, v4
    ds_add_rtn_u64 v[44:45], v8, v[64:65]
    ds_add_rtn_u64 v[46:47], v9, v[66:67]
    ds_add_rtn_u64 v[48:49], v10, v[68:69]
    s_waitcnt lgkmcnt(3)
    v_lshl_add_u32 v118, v119, 4, v118
    buffer_load_dwordx4 v[8:11], v118, s[44:47], s30 offen offset:0
    s_waitcnt vmcnt(7)
    v_mad_u32_u16 v76, v16, 8, s18
    v_mad_u32_u16 v78, v17, 8, s18
    v_mad_u32_u16 v80, v18, 8, s18
    ds_read_b64 v[76:77], v76
    ds_read_b64 v[78:79], v78
    ds_read_b64 v[80:81], v80
    s_waitcnt vmcnt(6)
    v_mad_u32_u16 v82, v20, 8, s18
    v_mad_u32_u16 v84, v21, 8, s18
    v_mad_u32_u16 v86, v22, 8, s18
    ds_read_b64 v[82:83], v82
    ds_read_b64 v[84:85], v84
    ds_read_b64 v[86:87], v86
    v_mbcnt_lo_u32_b32 v118, s32, 0
    v_mbcnt_hi_u32_b32 v118, s33, v118
    s_bcnt1_i32_b64 s14, s[32:33]
    v_lshl_add_u32 v119, v118, 1, s25
    ds_read_u16 v119, v119
    v_mad_u32_u24 v118, v118, s23, v2
    s_mov_b32 s32, s26
    s_lshl1_add_u32 s25, s14, s25
    s_mul_i32 s14, s14, s23
    s_add_u32 s26, s26, s14
    v_bfe_i32 v108, v15, 2, 10
    v_bfe_i32 v109, v15, 12, 10
    v_ashrrev_i32 v110, 22, v15
    v_cvt_f32_i32 v108, v108
    v_cvt_f32_i32 v109, v109
    v_cvt_f32_i32 v110, v110
    v_mad_u32_u16 v12, v12, 8, s50 op_sel:[1,0,0,0]
    v_mad_u32_u16 v13, v13, 8, s50 op_sel:[1,0,0,0]
    v_mad_u32_u16 v14, v14, 8, s50 op_sel:[1,0,0,0]
    v_lshlrev_b32 v112, 16, v70
    v_and_b32 v113, 0xffff0000, v70
    v_lshlrev_b32 v70, 16, v71
    v_and_b32 v71, 0xffff0000, v71
    v_lshlrev_b32 v114, 16, v72
    v_and_b32 v115, 0xffff0000, v72
    v_lshlrev_b32 v72, 16, v73
    v_and_b32 v73, 0xffff0000, v73
    v_lshlrev_b32 v116, 16, v74
    v_and_b32 v117, 0xffff0000, v74
    v_lshlrev_b32 v74, 16, v75
    v_and_b32 v75, 0xffff0000, v75
    v_pk_fma_f32 v[112:113], v[112:113], v[108:109], s[16:17] op_sel:[0,0,0] op_sel_hi:[1,0,0]
    v_pk_fma_f32 v[70:71], v[70:71], v[108:109], s[16:17] op_sel:[0,0,0] op_sel_hi:[1,0,0]
    v_pk_fma_f32 v[114:115], v[114:115], v[108:109], s[16:17] op_sel:[0,1,0] op_sel_hi:[1,1,0]
    v_pk_fma_f32 v[72:73], v[72:73], v[108:109], s[16:17] op_sel:[0,1,0] op_sel_hi:[1,1,0]
    v_pk_fma_f32 v[116:117], v[116:117], v[110:111], s[16:17] op_sel:[0,0,0] op_sel_hi:[1,0,0]
    v_pk_fma_f32 v[74:75], v[74:75], v[110:111], s[16:17] op_sel:[0,0,0] op_sel_hi:[1,0,0]
    v_perm_b32 v71, v71, v70, s17
    v_perm_b32 v70, v113, v112, s17
    v_perm_b32 v73, v73, v72, s17
    v_perm_b32 v72, v115, v114, s17
    v_perm_b32 v75, v75, v74, s17
    v_perm_b32 v74, v117, v116, s17
    v_lshl_add_u64 v[70:71], v[70:71], 0, s[20:21]
    v_lshl_add_u64 v[72:73], v[72:73], 0, s[20:21]
    v_lshl_add_u64 v[74:75], v[74:75], 0, s[20:21]
    s_waitcnt lgkmcnt(7)
    v_or3_b32 v4, v44, v45, v4
    v_or3_b32 v4, v46, v47, v4
    v_or3_b32 v4, v48, v49, v4
    ds_add_rtn_u64 v[44:45], v12, v[70:71]
    ds_add_rtn_u64 v[46:47], v13, v[72:73]
    ds_add_rtn_u64 v[48:49], v14, v[74:75]
    s_waitcnt lgkmcnt(3)
    v_lshl_add_u32 v118, v119, 4, v118
    buffer_load_dwordx4 v[12:15], v118, s[44:47], s32 offen offset:1024
    s_cmp_le_u32 s51, 256
    s_cbranch_scc1 L_p2_kernel_noopt2_4
    v_mad_u32_u16 v64, v24, 8, s18
    v_mad_u32_u16 v66, v25, 8, s18
    v_mad_u32_u16 v68, v26, 8, s18
    ds_read_b64 v[64:65], v64
    ds_read_b64 v[66:67], v66
    ds_read_b64 v[68:69], v68
    v_bfe_i32 v108, v27, 2, 10
    v_bfe_i32 v109, v27, 12, 10
    v_ashrrev_i32 v110, 22, v27
    v_cvt_f32_i32 v108, v108
    v_cvt_f32_i32 v109, v109
    v_cvt_f32_i32 v110, v110
    v_mad_u32_u16 v24, v24, 8, s50 op_sel:[1,0,0,0]
    v_mad_u32_u16 v25, v25, 8, s50 op_sel:[1,0,0,0]
    v_mad_u32_u16 v26, v26, 8, s50 op_sel:[1,0,0,0]
    s_waitcnt lgkmcnt(0)
    v_lshlrev_b32 v112, 16, v64
    v_and_b32 v113, 0xffff0000, v64
    v_lshlrev_b32 v64, 16, v65
    v_and_b32 v65, 0xffff0000, v65
    v_lshlrev_b32 v114, 16, v66
    v_and_b32 v115, 0xffff0000, v66
    v_lshlrev_b32 v66, 16, v67
    v_and_b32 v67, 0xffff0000, v67
    v_lshlrev_b32 v116, 16, v68
    v_and_b32 v117, 0xffff0000, v68
    v_lshlrev_b32 v68, 16, v69
    v_and_b32 v69, 0xffff0000, v69
    v_pk_fma_f32 v[112:113], v[112:113], v[108:109], s[16:17] op_sel:[0,0,0] op_sel_hi:[1,0,0]
    v_pk_fma_f32 v[64:65], v[64:65], v[108:109], s[16:17] op_sel:[0,0,0] op_sel_hi:[1,0,0]
    v_pk_fma_f32 v[114:115], v[114:115], v[108:109], s[16:17] op_sel:[0,1,0] op_sel_hi:[1,1,0]
    v_pk_fma_f32 v[66:67], v[66:67], v[108:109], s[16:17] op_sel:[0,1,0] op_sel_hi:[1,1,0]
    v_pk_fma_f32 v[116:117], v[116:117], v[110:111], s[16:17] op_sel:[0,0,0] op_sel_hi:[1,0,0]
    v_pk_fma_f32 v[68:69], v[68:69], v[110:111], s[16:17] op_sel:[0,0,0] op_sel_hi:[1,0,0]
    v_perm_b32 v65, v65, v64, s17
    v_perm_b32 v64, v113, v112, s17
    v_perm_b32 v67, v67, v66, s17
    v_perm_b32 v66, v115, v114, s17
    v_perm_b32 v69, v69, v68, s17
    v_perm_b32 v68, v117, v116, s17
    v_lshl_add_u64 v[64:65], v[64:65], 0, s[20:21]
    v_lshl_add_u64 v[66:67], v[66:67], 0, s[20:21]
    v_lshl_add_u64 v[68:69], v[68:69], 0, s[20:21]
    v_or3_b32 v4, v44, v45, v4
    v_or3_b32 v4, v46, v47, v4
    v_or3_b32 v4, v48, v49, v4
    ds_add_rtn_u64 v[44:45], v24, v[64:65]
    ds_add_rtn_u64 v[46:47], v25, v[66:67]
    ds_add_rtn_u64 v[48:49], v26, v[68:69]
L_p2_kernel_noopt2_4:
    s_barrier
    s_waitcnt vmcnt(2)
    ds_write_b128 v3, v[88:91] offset:0
    ds_write_b128 v3, v[92:95] offset:16384
    ds_write_b128 v3, v[96:99] offset:32768
    ds_write_b128 v3, v[100:103] offset:49152
    ds_write_b128 v124, v[104:107]
    v_mbcnt_lo_u32_b32 v118, s34, 0
    v_mbcnt_hi_u32_b32 v118, s35, v118
    s_bcnt1_i32_b64 s14, s[34:35]
    v_lshl_add_u32 v119, v118, 1, s25
    ds_read_u16 v119, v119
    v_mad_u32_u24 v118, v118, s23, v2
    s_mov_b32 s34, s26
    s_lshl1_add_u32 s25, s14, s25
    s_mul_i32 s14, s14, s23
    s_add_u32 s26, s26, s14
    v_bfe_i32 v108, v19, 2, 10
    v_bfe_i32 v109, v19, 12, 10
    v_ashrrev_i32 v110, 22, v19
    v_cvt_f32_i32 v108, v108
    v_cvt_f32_i32 v109, v109
    v_cvt_f32_i32 v110, v110
    v_mad_u32_u16 v16, v16, 8, s50 op_sel:[1,0,0,0]
    v_mad_u32_u16 v17, v17, 8, s50 op_sel:[1,0,0,0]
    v_mad_u32_u16 v18, v18, 8, s50 op_sel:[1,0,0,0]
    v_lshlrev_b32 v112, 16, v76
    v_and_b32 v113, 0xffff0000, v76
    v_lshlrev_b32 v76, 16, v77
    v_and_b32 v77, 0xffff0000, v77
    v_lshlrev_b32 v114, 16, v78
    v_and_b32 v115, 0xffff0000, v78
    v_lshlrev_b32 v78, 16, v79
    v_and_b32 v79, 0xffff0000, v79
    v_lshlrev_b32 v116, 16, v80
    v_and_b32 v117, 0xffff0000, v80
    v_lshlrev_b32 v80, 16, v81
    v_and_b32 v81, 0xffff0000, v81
    v_pk_fma_f32 v[112:113], v[112:113], v[108:109], s[16:17] op_sel:[0,0,0] op_sel_hi:[1,0,0]
    v_pk_fma_f32 v[76:77], v[76:77], v[108:109], s[16:17] op_sel:[0,0,0] op_sel_hi:[1,0,0]
    v_pk_fma_f32 v[114:115], v[114:115], v[108:109], s[16:17] op_sel:[0,1,0] op_sel_hi:[1,1,0]
    v_pk_fma_f32 v[78:79], v[78:79], v[108:109], s[16:17] op_sel:[0,1,0] op_sel_hi:[1,1,0]
    v_pk_fma_f32 v[116:117], v[116:117], v[110:111], s[16:17] op_sel:[0,0,0] op_sel_hi:[1,0,0]
    v_pk_fma_f32 v[80:81], v[80:81], v[110:111], s[16:17] op_sel:[0,0,0] op_sel_hi:[1,0,0]
    v_perm_b32 v77, v77, v76, s17
    v_perm_b32 v76, v113, v112, s17
    v_perm_b32 v79, v79, v78, s17
    v_perm_b32 v78, v115, v114, s17
    v_perm_b32 v81, v81, v80, s17
    v_perm_b32 v80, v117, v116, s17
    v_lshl_add_u64 v[76:77], v[76:77], 0, s[20:21]
    v_lshl_add_u64 v[78:79], v[78:79], 0, s[20:21]
    v_lshl_add_u64 v[80:81], v[80:81], 0, s[20:21]
    s_waitcnt lgkmcnt(6)
    v_or3_b32 v4, v44, v45, v4
    v_or3_b32 v4, v46, v47, v4
    v_or3_b32 v4, v48, v49, v4
    ds_add_rtn_u64 v[44:45], v16, v[76:77]
    ds_add_rtn_u64 v[46:47], v17, v[78:79]
    ds_add_rtn_u64 v[48:49], v18, v[80:81]
    s_waitcnt lgkmcnt(3)
    v_lshl_add_u32 v118, v119, 4, v118
    buffer_load_dwordx4 v[16:19], v118, s[44:47], s34 offen offset:2048
    v_mbcnt_lo_u32_b32 v118, s36, 0
    v_mbcnt_hi_u32_b32 v118, s37, v118
    s_bcnt1_i32_b64 s14, s[36:37]
    v_lshl_add_u32 v119, v118, 1, s25
    ds_read_u16 v119, v119
    v_mad_u32_u24 v118, v118, s23, v2
    s_mov_b32 s36, s26
    s_lshl1_add_u32 s25, s14, s25
    s_mul_i32 s14, s14, s23
    s_add_u32 s26, s26, s14
    v_bfe_i32 v108, v23, 2, 10
    v_bfe_i32 v109, v23, 12, 10
    v_ashrrev_i32 v110, 22, v23
    v_cvt_f32_i32 v108, v108
    v_cvt_f32_i32 v109, v109
    v_cvt_f32_i32 v110, v110
    v_mad_u32_u16 v20, v20, 8, s50 op_sel:[1,0,0,0]
    v_mad_u32_u16 v21, v21, 8, s50 op_sel:[1,0,0,0]
    v_mad_u32_u16 v22, v22, 8, s50 op_sel:[1,0,0,0]
    v_lshlrev_b32 v112, 16, v82
    v_and_b32 v113, 0xffff0000, v82
    v_lshlrev_b32 v82, 16, v83
    v_and_b32 v83, 0xffff0000, v83
    v_lshlrev_b32 v114, 16, v84
    v_and_b32 v115, 0xffff0000, v84
    v_lshlrev_b32 v84, 16, v85
    v_and_b32 v85, 0xffff0000, v85
    v_lshlrev_b32 v116, 16, v86
    v_and_b32 v117, 0xffff0000, v86
    v_lshlrev_b32 v86, 16, v87
    v_and_b32 v87, 0xffff0000, v87
    v_pk_fma_f32 v[112:113], v[112:113], v[108:109], s[16:17] op_sel:[0,0,0] op_sel_hi:[1,0,0]
    v_pk_fma_f32 v[82:83], v[82:83], v[108:109], s[16:17] op_sel:[0,0,0] op_sel_hi:[1,0,0]
    v_pk_fma_f32 v[114:115], v[114:115], v[108:109], s[16:17] op_sel:[0,1,0] op_sel_hi:[1,1,0]
    v_pk_fma_f32 v[84:85], v[84:85], v[108:109], s[16:17] op_sel:[0,1,0] op_sel_hi:[1,1,0]
    v_pk_fma_f32 v[116:117], v[116:117], v[110:111], s[16:17] op_sel:[0,0,0] op_sel_hi:[1,0,0]
    v_pk_fma_f32 v[86:87], v[86:87], v[110:111], s[16:17] op_sel:[0,0,0] op_sel_hi:[1,0,0]
    v_perm_b32 v83, v83, v82, s17
    v_perm_b32 v82, v113, v112, s17
    v_perm_b32 v85, v85, v84, s17
    v_perm_b32 v84, v115, v114, s17
    v_perm_b32 v87, v87, v86, s17
    v_perm_b32 v86, v117, v116, s17
    v_lshl_add_u64 v[82:83], v[82:83], 0, s[20:21]
    v_lshl_add_u64 v[84:85], v[84:85], 0, s[20:21]
    v_lshl_add_u64 v[86:87], v[86:87], 0, s[20:21]
    s_waitcnt lgkmcnt(1)
    v_or3_b32 v4, v44, v45, v4
    v_or3_b32 v4, v46, v47, v4
    v_or3_b32 v4, v48, v49, v4
    ds_add_rtn_u64 v[44:45], v20, v[82:83]
    ds_add_rtn_u64 v[46:47], v21, v[84:85]
    ds_add_rtn_u64 v[48:49], v22, v[86:87]
    s_waitcnt lgkmcnt(3)
    v_lshl_add_u32 v118, v119, 4, v118
    buffer_load_dwordx4 v[20:23], v118, s[44:47], s36 offen offset:3072
    s_cmp_le_u32 s28, 256
    s_cbranch_scc1 L_p2_kernel_noopt_5
    v_readlane_b32 s38, v7, 8
    v_readlane_b32 s39, v7, 9
    s_nop 1
    v_mbcnt_lo_u32_b32 v118, s38, 0
    v_mbcnt_hi_u32_b32 v118, s39, v118
    s_bcnt1_i32_b64 s14, s[38:39]
    v_lshl_add_u32 v119, v118, 1, s25
    ds_read_u16 v119, v119
    v_mad_u32_u24 v118, v118, s23, v2
    s_mov_b32 s38, s26
    s_lshl1_add_u32 s25, s14, s25
    s_mul_i32 s14, s14, s23
    s_add_u32 s26, s26, s14
    s_waitcnt lgkmcnt(0)
    s_add_u32 s38, s38, 4096
    v_lshl_add_u32 v118, v119, 4, v118
    buffer_load_dwordx4 v[24:27], v118, s[44:47], s38 offen offset:0
L_p2_kernel_noopt_5:
    v_mad_u32_u16 v108, v28, v50, s40 op_sel:[1,0,0,0]
    v_mad_u32_u16 v109, v36, v50, s41 op_sel:[1,0,0,0]
    v_sub_u32_sdwa v110, v109, v108 dst_sel:DWORD dst_unused:UNUSED_PAD src0_sel:WORD_1 src1_sel:WORD_1
    s_nop 1
    v_add_u32_dpp v110, v110, v110 row_shr:1 row_mask:0xf bank_mask:0xf bound_ctrl:0
    s_nop 1
    v_add_u32_dpp v110, v110, v110 row_shr:2 row_mask:0xf bank_mask:0xf bound_ctrl:0
    s_nop 1
    v_add_u32_dpp v110, v110, v110 row_shr:4 row_mask:0xf bank_mask:0xf bound_ctrl:0
    s_nop 1
    v_add_u32_dpp v110, v110, v110 row_shr:8 row_mask:0xf bank_mask:0xf bound_ctrl:0
    s_nop 1
    v_add_u32_dpp v110, v110, v110 row_bcast:15 row_mask:0xa bank_mask:0xf
    s_nop 1
    v_add_u32_dpp v110, v110, v110 row_bcast:31 row_mask:0xc bank_mask:0xf
    v_sub_u32_sdwa v109, v109, v110 dst_sel:DWORD dst_unused:UNUSED_PAD src0_sel:WORD_1 src1_sel:DWORD
    v_readlane_b32 s29, v110, 63
    v_add_u32 v110, -1, v110
    ds_write_b16 v126, v109
    v_lshlrev_b32_e64 v111, v110, 1
    v_lshrrev_b32 v110, 5, v110
    v_lshl_add_u32 v110, v110, 2, s19
    s_cmp_gt_u32 s29, 320
    s_cselect_b32 s2, 1, s2
    s_cselect_b64 exec, 0, -1
    ds_or_b32 v110, v111 offset:160
    s_mov_b64 exec, -1
    ds_wrxchg_rtn_b32 v7, v6, v5 offset:160
    s_add_u32 s14, s22, 80000
    buffer_load_dwordx4 v[88:91], v1, s[8:11], s14 offen
    s_add_u32 s14, s22, 96384
    buffer_load_dwordx4 v[92:95], v1, s[8:11], s14 offen
    s_add_u32 s14, s22, 112768
    buffer_load_dwordx4 v[96:99], v1, s[8:11], s14 offen
    s_add_u32 s24, s24, 1
    s_cmp_lt_u32 s24, 8
    s_barrier
    s_cbranch_scc1 L_p2_loop
    s_waitcnt lgkmcnt(3)
    v_or3_b32 v4, v44, v45, v4
    v_or3_b32 v4, v46, v47, v4
    v_or3_b32 v4, v48, v49, v4
    s_mov_b32 s27, s19
    s_waitcnt vmcnt(0)
    v_mov_b32 v8, 160232
    s_cmp_lg_u32 s13, 0
    s_cselect_b64 exec, 0, 1
    ds_write_b32 v8, v52
    s_mov_b64 exec, -1
    v_subrev_u32 v6, 80000, v124
    s_mul_i32 s24, s12, 20000
    v_subrev_u32 v10, s24, v1
    v_mov_b32 v11, 0x7f000000
    s_waitcnt vmcnt(0) lgkmcnt(0)
    s_barrier
    s_cmp_lt_u32 s13, 4
    s_cbranch_scc1 L_p2_ga
    v_lshlrev_b32 v30, 16, v60
    v_and_b32 v31, 0xffff0000, v60
    v_lshlrev_b32 v36, 16, v53
    v_and_b32 v37, 0xffff0000, v53
    v_lshlrev_b32 v38, 16, v54
    v_and_b32 v39, 0xffff0000, v54
    v_lshlrev_b32 v40, 16, v56
    v_and_b32 v41, 0xffff0000, v56
    v_lshlrev_b32 v42, 16, v57
    v_and_b32 v43, 0xffff0000, v57
    v_pk_add_f32 v[14:15], v[30:31], v[36:37] op_sel:[0,0] op_sel_hi:[1,0] neg_lo:[0,1] neg_hi:[0,1]
    v_pk_add_f32 v[16:17], v[30:31], v[36:37] op_sel:[0,1] op_sel_hi:[1,1] neg_lo:[0,1] neg_hi:[0,1]
    v_pk_add_f32 v[18:19], v[30:31], v[38:39] op_sel:[0,0] op_sel_hi:[1,0] neg_lo:[0,1] neg_hi:[0,1]
    v_pk_add_f32 v[20:21], v[30:31], v[38:39] op_sel:[0,1] op_sel_hi:[1,1] neg_lo:[0,1] neg_hi:[0,1]
    v_pk_add_f32 v[22:23], v[30:31], v[40:41] op_sel:[0,0] op_sel_hi:[1,0] neg_lo:[0,1] neg_hi:[0,1]
    v_pk_add_f32 v[24:25], v[30:31], v[40:41] op_sel:[0,1] op_sel_hi:[1,1] neg_lo:[0,1] neg_hi:[0,1]
    v_pk_add_f32 v[26:27], v[30:31], v[42:43] op_sel:[0,0] op_sel_hi:[1,0] neg_lo:[0,1] neg_hi:[0,1]
    v_pk_add_f32 v[28:29], v[30:31], v[42:43] op_sel:[0,1] op_sel_hi:[1,1] neg_lo:[0,1] neg_hi:[0,1]
    v_cvt_pk_bf16_f32 v32, v14, v15
    v_lshlrev_b32 v14, 16, v32
    v_and_b32 v15, 0xffff0000, v32
    v_cvt_pk_bf16_f32 v32, v16, v17
    v_lshlrev_b32 v16, 16, v32
    v_and_b32 v17, 0xffff0000, v32
    v_cvt_pk_bf16_f32 v32, v18, v19
    v_lshlrev_b32 v18, 16, v32
    v_and_b32 v19, 0xffff0000, v32
    v_cvt_pk_bf16_f32 v32, v20, v21
    v_lshlrev_b32 v20, 16, v32
    v_and_b32 v21, 0xffff0000, v32
    v_cvt_pk_bf16_f32 v32, v22, v23
    v_lshlrev_b32 v22, 16, v32
    v_and_b32 v23, 0xffff0000, v32
    v_cvt_pk_bf16_f32 v32, v24, v25
    v_lshlrev_b32 v24, 16, v32
    v_and_b32 v25, 0xffff0000, v32
    v_cvt_pk_bf16_f32 v32, v26, v27
    v_lshlrev_b32 v26, 16, v32
    v_and_b32 v27, 0xffff0000, v32
    v_cvt_pk_bf16_f32 v32, v28, v29
    v_lshlrev_b32 v28, 16, v32
    v_and_b32 v29, 0xffff0000, v32
    v_pk_mul_f32 v[14:15], v[14:15], v[14:15]
    v_pk_mul_f32 v[16:17], v[16:17], v[16:17]
    v_pk_mul_f32 v[18:19], v[18:19], v[18:19]
    v_pk_mul_f32 v[20:21], v[20:21], v[20:21]
    v_pk_mul_f32 v[22:23], v[22:23], v[22:23]
    v_pk_mul_f32 v[24:25], v[24:25], v[24:25]
    v_pk_mul_f32 v[26:27], v[26:27], v[26:27]
    v_pk_mul_f32 v[28:29], v[28:29], v[28:29]
    v_cvt_pk_bf16_f32 v32, v14, v15
    v_lshlrev_b32 v14, 16, v32
    v_and_b32 v15, 0xffff0000, v32
    v_cvt_pk_bf16_f32 v32, v16, v17
    v_lshlrev_b32 v16, 16, v32
    v_and_b32 v17, 0xffff0000, v32
    v_cvt_pk_bf16_f32 v32, v18, v19
    v_lshlrev_b32 v18, 16, v32
    v_and_b32 v19, 0xffff0000, v32
    v_cvt_pk_bf16_f32 v32, v20, v21
    v_lshlrev_b32 v20, 16, v32
    v_and_b32 v21, 0xffff0000, v32
    v_cvt_pk_bf16_f32 v32, v22, v23
    v_lshlrev_b32 v22, 16, v32
    v_and_b32 v23, 0xffff0000, v32
    v_cvt_pk_bf16_f32 v32, v24, v25
    v_lshlrev_b32 v24, 16, v32
    v_and_b32 v25, 0xffff0000, v32
    v_cvt_pk_bf16_f32 v32, v26, v27
    v_lshlrev_b32 v26, 16, v32
    v_and_b32 v27, 0xffff0000, v32
    v_cvt_pk_bf16_f32 v32, v28, v29
    v_lshlrev_b32 v28, 16, v32
    v_and_b32 v29, 0xffff0000, v32
    v_mov_b32 v30, 1092616192
    v_mov_b32 v31, 0x3fb8aa3b
    v_pk_mul_f32 v[14:15], v[14:15], v[30:31] op_sel:[0,0] op_sel_hi:[1,0]
    v_pk_mul_f32 v[16:17], v[16:17], v[30:31] op_sel:[0,0] op_sel_hi:[1,0]
    v_pk_mul_f32 v[18:19], v[18:19], v[30:31] op_sel:[0,0] op_sel_hi:[1,0]
    v_pk_mul_f32 v[20:21], v[20:21], v[30:31] op_sel:[0,0] op_sel_hi:[1,0]
    v_pk_mul_f32 v[22:23], v[22:23], v[30:31] op_sel:[0,0] op_sel_hi:[1,0]
    v_pk_mul_f32 v[24:25], v[24:25], v[30:31] op_sel:[0,0] op_sel_hi:[1,0]
    v_pk_mul_f32 v[26:27], v[26:27], v[30:31] op_sel:[0,0] op_sel_hi:[1,0]
    v_pk_mul_f32 v[28:29], v[28:29], v[30:31] op_sel:[0,0] op_sel_hi:[1,0]
    v_cvt_pk_bf16_f32 v32, v14, v15
    v_lshlrev_b32 v14, 16, v32
    v_and_b32 v15, 0xffff0000, v32
    v_cvt_pk_bf16_f32 v32, v16, v17
    v_lshlrev_b32 v16, 16, v32
    v_and_b32 v17, 0xffff0000, v32
    v_cvt_pk_bf16_f32 v32, v18, v19
    v_lshlrev_b32 v18, 16, v32
    v_and_b32 v19, 0xffff0000, v32
    v_cvt_pk_bf16_f32 v32, v20, v21
    v_lshlrev_b32 v20, 16, v32
    v_and_b32 v21, 0xffff0000, v32
    v_cvt_pk_bf16_f32 v32, v22, v23
    v_lshlrev_b32 v22, 16, v32
    v_and_b32 v23, 0xffff0000, v32
    v_cvt_pk_bf16_f32 v32, v24, v25
    v_lshlrev_b32 v24, 16, v32
    v_and_b32 v25, 0xffff0000, v32
    v_cvt_pk_bf16_f32 v32, v26, v27
    v_lshlrev_b32 v26, 16, v32
    v_and_b32 v27, 0xffff0000, v32
    v_cvt_pk_bf16_f32 v32, v28, v29
    v_lshlrev_b32 v28, 16, v32
    v_and_b32 v29, 0xffff0000, v32
    v_pk_mul_f32 v[14:15], v[14:15], v[30:31] op_sel:[0,1] op_sel_hi:[1,1]
    v_pk_mul_f32 v[16:17], v[16:17], v[30:31] op_sel:[0,1] op_sel_hi:[1,1]
    v_pk_mul_f32 v[18:19], v[18:19], v[30:31] op_sel:[0,1] op_sel_hi:[1,1]
    v_pk_mul_f32 v[20:21], v[20:21], v[30:31] op_sel:[0,1] op_sel_hi:[1,1]
    v_pk_mul_f32 v[22:23], v[22:23], v[30:31] op_sel:[0,1] op_sel_hi:[1,1]
    v_pk_mul_f32 v[24:25], v[24:25], v[30:31] op_sel:[0,1] op_sel_hi:[1,1]
    v_pk_mul_f32 v[26:27], v[26:27], v[30:31] op_sel:[0,1] op_sel_hi:[1,1]
    v_pk_mul_f32 v[28:29], v[28:29], v[30:31] op_sel:[0,1] op_sel_hi:[1,1]
    v_exp_f32 v14, -v14
    v_exp_f32 v15, -v15
    v_exp_f32 v16, -v16
    v_exp_f32 v17, -v17
    v_exp_f32 v18, -v18
    v_exp_f32 v19, -v19
    v_exp_f32 v20, -v20
    v_exp_f32 v21, -v21
    v_exp_f32 v22, -v22
    v_exp_f32 v23, -v23
    v_exp_f32 v24, -v24
    v_exp_f32 v25, -v25
    v_exp_f32 v26, -v26
    v_exp_f32 v27, -v27
    v_exp_f32 v28, -v28
    v_exp_f32 v29, -v29
    v_cvt_pk_bf16_f32 v14, v14, v16
    v_cvt_pk_bf16_f32 v15, v15, v17
    v_cvt_pk_bf16_f32 v18, v18, v20
    v_cvt_pk_bf16_f32 v19, v19, v21
    v_cvt_pk_bf16_f32 v22, v22, v24
    v_cvt_pk_bf16_f32 v23, v23, v25
    v_cvt_pk_bf16_f32 v26, v26, v28
    v_cvt_pk_bf16_f32 v27, v27, v29
    v_dot2_f32_bf16 v72, v14, s68, 0
    v_dot2_f32_bf16 v73, v15, s68, 0
    v_dot2_f32_bf16 v74, v14, s69, 0
    v_dot2_f32_bf16 v75, v15, s69, 0
    v_dot2_f32_bf16 v76, v14, s70, 0
    v_dot2_f32_bf16 v77, v15, s70, 0
    v_dot2_f32_bf16 v78, v14, s71, 0
    v_dot2_f32_bf16 v79, v15, s71, 0
    v_dot2_f32_bf16 v80, v14, s52, 0
    v_dot2_f32_bf16 v81, v15, s52, 0
    v_dot2_f32_bf16 v82, v14, s53, 0
    v_dot2_f32_bf16 v83, v15, s53, 0
    v_dot2_f32_bf16 v84, v14, s54, 0
    v_dot2_f32_bf16 v85, v15, s54, 0
    v_dot2_f32_bf16 v86, v14, s55, 0
    v_dot2_f32_bf16 v87, v15, s55, 0
    v_dot2_f32_bf16 v72, v18, s72, v72
    v_dot2_f32_bf16 v73, v19, s72, v73
    v_dot2_f32_bf16 v74, v18, s73, v74
    v_dot2_f32_bf16 v75, v19, s73, v75
    v_dot2_f32_bf16 v76, v18, s74, v76
    v_dot2_f32_bf16 v77, v19, s74, v77
    v_dot2_f32_bf16 v78, v18, s75, v78
    v_dot2_f32_bf16 v79, v19, s75, v79
    v_dot2_f32_bf16 v80, v18, s56, v80
    v_dot2_f32_bf16 v81, v19, s56, v81
    v_dot2_f32_bf16 v82, v18, s57, v82
    v_dot2_f32_bf16 v83, v19, s57, v83
    v_dot2_f32_bf16 v84, v18, s58, v84
    v_dot2_f32_bf16 v85, v19, s58, v85
    v_dot2_f32_bf16 v86, v18, s59, v86
    v_dot2_f32_bf16 v87, v19, s59, v87
    v_dot2_f32_bf16 v72, v22, s76, v72
    v_dot2_f32_bf16 v73, v23, s76, v73
    v_dot2_f32_bf16 v74, v22, s77, v74
    v_dot2_f32_bf16 v75, v23, s77, v75
    v_dot2_f32_bf16 v76, v22, s78, v76
    v_dot2_f32_bf16 v77, v23, s78, v77
    v_dot2_f32_bf16 v78, v22, s79, v78
    v_dot2_f32_bf16 v79, v23, s79, v79
    v_dot2_f32_bf16 v80, v22, s60, v80
    v_dot2_f32_bf16 v81, v23, s60, v81
    v_dot2_f32_bf16 v82, v22, s61, v82
    v_dot2_f32_bf16 v83, v23, s61, v83
    v_dot2_f32_bf16 v84, v22, s62, v84
    v_dot2_f32_bf16 v85, v23, s62, v85
    v_dot2_f32_bf16 v86, v22, s63, v86
    v_dot2_f32_bf16 v87, v23, s63, v87
    v_dot2_f32_bf16 v72, v26, s80, v72
    v_dot2_f32_bf16 v73, v27, s80, v73
    v_dot2_f32_bf16 v74, v26, s81, v74
    v_dot2_f32_bf16 v75, v27, s81, v75
    v_dot2_f32_bf16 v76, v26, s82, v76
    v_dot2_f32_bf16 v77, v27, s82, v77
    v_dot2_f32_bf16 v78, v26, s83, v78
    v_dot2_f32_bf16 v79, v27, s83, v79
    v_dot2_f32_bf16 v80, v26, s64, v80
    v_dot2_f32_bf16 v81, v27, s64, v81
    v_dot2_f32_bf16 v82, v26, s65, v82
    v_dot2_f32_bf16 v83, v27, s65, v83
    v_dot2_f32_bf16 v84, v26, s66, v84
    v_dot2_f32_bf16 v85, v27, s66, v85
    v_dot2_f32_bf16 v86, v26, s67, v86
    v_dot2_f32_bf16 v87, v27, s67, v87
L_p2_ga:
    ds_read_b32 v9, v8
    ds_read_b128 v[88:91], v1 offset:0
    ds_read_b128 v[92:95], v1 offset:16384
    ds_read_b128 v[96:99], v1 offset:32768
    ds_read_b128 v[100:103], v1 offset:49152
    ds_read_b128 v[104:107], v6
    s_mul_i32 s14, s12, 5120000
    s_mul_i32 s15, s3, 80000
    s_add_u32 s25, s14, s15
    s_add_u32 s25, s25, 232727040
    s_waitcnt lgkmcnt(5)
    v_readfirstlane_b32 s21, v9
    s_nop 0
    s_bfe_u32 s21, s21, 524296
    s_cmp_lg_u32 s21, 4
    s_cselect_b32 s21, 1, 0
    s_cselect_b32 s24, 0, 20000
    v_cmp_le_u32 vcc, s24, v10
    v_add_u32 v10, 16384, v10
    s_add_u32 s14, s25, 0
    v_cndmask_b32 v12, v11, v1, vcc
    s_waitcnt lgkmcnt(4)
    buffer_store_dwordx4 v[88:91], v12, s[4:7], s14 offen sc1
    v_or3_b32 v4, v88, v89, v4
    v_or3_b32 v4, v90, v91, v4
    v_cmp_le_u32 vcc, s24, v10
    v_add_u32 v10, 16384, v10
    s_add_u32 s14, s25, 16384
    v_cndmask_b32 v12, v11, v1, vcc
    s_waitcnt lgkmcnt(3)
    buffer_store_dwordx4 v[92:95], v12, s[4:7], s14 offen sc1
    v_or3_b32 v4, v92, v93, v4
    v_or3_b32 v4, v94, v95, v4
    v_cmp_le_u32 vcc, s24, v10
    v_add_u32 v10, 16384, v10
    s_add_u32 s14, s25, 32768
    v_cndmask_b32 v12, v11, v1, vcc
    s_waitcnt lgkmcnt(2)
    buffer_store_dwordx4 v[96:99], v12, s[4:7], s14 offen sc1
    v_or3_b32 v4, v96, v97, v4
    v_or3_b32 v4, v98, v99, v4
    v_cmp_le_u32 vcc, s24, v10
    v_add_u32 v10, 16384, v10
    s_add_u32 s14, s25, 49152
    v_cndmask_b32 v12, v11, v1, vcc
    s_waitcnt lgkmcnt(1)
    buffer_store_dwordx4 v[100:103], v12, s[4:7], s14 offen sc1
    v_or3_b32 v4, v100, v101, v4
    v_or3_b32 v4, v102, v103, v4
    v_cmp_le_u32 vcc, s24, v10
    v_add_u32 v10, 16384, v10
    s_add_u32 s14, s25, 0
    v_cndmask_b32 v12, v11, v6, vcc
    s_waitcnt lgkmcnt(0)
    buffer_store_dwordx4 v[104:107], v12, s[4:7], s14 offen sc1
    v_or3_b32 v4, v104, v105, v4
    v_or3_b32 v4, v106, v107, v4
    s_load_dwordx2 s[16:17], s[0:1], 88
    s_cmp_ge_u32 s13, 4
    s_cbranch_scc1 L_p2_gb
    v_lshlrev_b32 v30, 16, v60
    v_and_b32 v31, 0xffff0000, v60
    v_lshlrev_b32 v36, 16, v53
    v_and_b32 v37, 0xffff0000, v53
    v_lshlrev_b32 v38, 16, v54
    v_and_b32 v39, 0xffff0000, v54
    v_lshlrev_b32 v40, 16, v56
    v_and_b32 v41, 0xffff0000, v56
    v_lshlrev_b32 v42, 16, v57
    v_and_b32 v43, 0xffff0000, v57
    v_pk_add_f32 v[14:15], v[30:31], v[36:37] op_sel:[0,0] op_sel_hi:[1,0] neg_lo:[0,1] neg_hi:[0,1]
    v_pk_add_f32 v[16:17], v[30:31], v[36:37] op_sel:[0,1] op_sel_hi:[1,1] neg_lo:[0,1] neg_hi:[0,1]
    v_pk_add_f32 v[18:19], v[30:31], v[38:39] op_sel:[0,0] op_sel_hi:[1,0] neg_lo:[0,1] neg_hi:[0,1]
    v_pk_add_f32 v[20:21], v[30:31], v[38:39] op_sel:[0,1] op_sel_hi:[1,1] neg_lo:[0,1] neg_hi:[0,1]
    v_pk_add_f32 v[22:23], v[30:31], v[40:41] op_sel:[0,0] op_sel_hi:[1,0] neg_lo:[0,1] neg_hi:[0,1]
    v_pk_add_f32 v[24:25], v[30:31], v[40:41] op_sel:[0,1] op_sel_hi:[1,1] neg_lo:[0,1] neg_hi:[0,1]
    v_pk_add_f32 v[26:27], v[30:31], v[42:43] op_sel:[0,0] op_sel_hi:[1,0] neg_lo:[0,1] neg_hi:[0,1]
    v_pk_add_f32 v[28:29], v[30:31], v[42:43] op_sel:[0,1] op_sel_hi:[1,1] neg_lo:[0,1] neg_hi:[0,1]
    v_cvt_pk_bf16_f32 v32, v14, v15
    v_lshlrev_b32 v14, 16, v32
    v_and_b32 v15, 0xffff0000, v32
    v_cvt_pk_bf16_f32 v32, v16, v17
    v_lshlrev_b32 v16, 16, v32
    v_and_b32 v17, 0xffff0000, v32
    v_cvt_pk_bf16_f32 v32, v18, v19
    v_lshlrev_b32 v18, 16, v32
    v_and_b32 v19, 0xffff0000, v32
    v_cvt_pk_bf16_f32 v32, v20, v21
    v_lshlrev_b32 v20, 16, v32
    v_and_b32 v21, 0xffff0000, v32
    v_cvt_pk_bf16_f32 v32, v22, v23
    v_lshlrev_b32 v22, 16, v32
    v_and_b32 v23, 0xffff0000, v32
    v_cvt_pk_bf16_f32 v32, v24, v25
    v_lshlrev_b32 v24, 16, v32
    v_and_b32 v25, 0xffff0000, v32
    v_cvt_pk_bf16_f32 v32, v26, v27
    v_lshlrev_b32 v26, 16, v32
    v_and_b32 v27, 0xffff0000, v32
    v_cvt_pk_bf16_f32 v32, v28, v29
    v_lshlrev_b32 v28, 16, v32
    v_and_b32 v29, 0xffff0000, v32
    v_pk_mul_f32 v[14:15], v[14:15], v[14:15]
    v_pk_mul_f32 v[16:17], v[16:17], v[16:17]
    v_pk_mul_f32 v[18:19], v[18:19], v[18:19]
    v_pk_mul_f32 v[20:21], v[20:21], v[20:21]
    v_pk_mul_f32 v[22:23], v[22:23], v[22:23]
    v_pk_mul_f32 v[24:25], v[24:25], v[24:25]
    v_pk_mul_f32 v[26:27], v[26:27], v[26:27]
    v_pk_mul_f32 v[28:29], v[28:29], v[28:29]
    v_cvt_pk_bf16_f32 v32, v14, v15
    v_lshlrev_b32 v14, 16, v32
    v_and_b32 v15, 0xffff0000, v32
    v_cvt_pk_bf16_f32 v32, v16, v17
    v_lshlrev_b32 v16, 16, v32
    v_and_b32 v17, 0xffff0000, v32
    v_cvt_pk_bf16_f32 v32, v18, v19
    v_lshlrev_b32 v18, 16, v32
    v_and_b32 v19, 0xffff0000, v32
    v_cvt_pk_bf16_f32 v32, v20, v21
    v_lshlrev_b32 v20, 16, v32
    v_and_b32 v21, 0xffff0000, v32
    v_cvt_pk_bf16_f32 v32, v22, v23
    v_lshlrev_b32 v22, 16, v32
    v_and_b32 v23, 0xffff0000, v32
    v_cvt_pk_bf16_f32 v32, v24, v25
    v_lshlrev_b32 v24, 16, v32
    v_and_b32 v25, 0xffff0000, v32
    v_cvt_pk_bf16_f32 v32, v26, v27
    v_lshlrev_b32 v26, 16, v32
    v_and_b32 v27, 0xffff0000, v32
    v_cvt_pk_bf16_f32 v32, v28, v29
    v_lshlrev_b32 v28, 16, v32
    v_and_b32 v29, 0xffff0000, v32
    v_mov_b32 v30, 1092616192
    v_mov_b32 v31, 0x3fb8aa3b
    v_pk_mul_f32 v[14:15], v[14:15], v[30:31] op_sel:[0,0] op_sel_hi:[1,0]
    v_pk_mul_f32 v[16:17], v[16:17], v[30:31] op_sel:[0,0] op_sel_hi:[1,0]
    v_pk_mul_f32 v[18:19], v[18:19], v[30:31] op_sel:[0,0] op_sel_hi:[1,0]
    v_pk_mul_f32 v[20:21], v[20:21], v[30:31] op_sel:[0,0] op_sel_hi:[1,0]
    v_pk_mul_f32 v[22:23], v[22:23], v[30:31] op_sel:[0,0] op_sel_hi:[1,0]
    v_pk_mul_f32 v[24:25], v[24:25], v[30:31] op_sel:[0,0] op_sel_hi:[1,0]
    v_pk_mul_f32 v[26:27], v[26:27], v[30:31] op_sel:[0,0] op_sel_hi:[1,0]
    v_pk_mul_f32 v[28:29], v[28:29], v[30:31] op_sel:[0,0] op_sel_hi:[1,0]
    v_cvt_pk_bf16_f32 v32, v14, v15
    v_lshlrev_b32 v14, 16, v32
    v_and_b32 v15, 0xffff0000, v32
    v_cvt_pk_bf16_f32 v32, v16, v17
    v_lshlrev_b32 v16, 16, v32
    v_and_b32 v17, 0xffff0000, v32
    v_cvt_pk_bf16_f32 v32, v18, v19
    v_lshlrev_b32 v18, 16, v32
    v_and_b32 v19, 0xffff0000, v32
    v_cvt_pk_bf16_f32 v32, v20, v21
    v_lshlrev_b32 v20, 16, v32
    v_and_b32 v21, 0xffff0000, v32
    v_cvt_pk_bf16_f32 v32, v22, v23
    v_lshlrev_b32 v22, 16, v32
    v_and_b32 v23, 0xffff0000, v32
    v_cvt_pk_bf16_f32 v32, v24, v25
    v_lshlrev_b32 v24, 16, v32
    v_and_b32 v25, 0xffff0000, v32
    v_cvt_pk_bf16_f32 v32, v26, v27
    v_lshlrev_b32 v26, 16, v32
    v_and_b32 v27, 0xffff0000, v32
    v_cvt_pk_bf16_f32 v32, v28, v29
    v_lshlrev_b32 v28, 16, v32
    v_and_b32 v29, 0xffff0000, v32
    v_pk_mul_f32 v[14:15], v[14:15], v[30:31] op_sel:[0,1] op_sel_hi:[1,1]
    v_pk_mul_f32 v[16:17], v[16:17], v[30:31] op_sel:[0,1] op_sel_hi:[1,1]
    v_pk_mul_f32 v[18:19], v[18:19], v[30:31] op_sel:[0,1] op_sel_hi:[1,1]
    v_pk_mul_f32 v[20:21], v[20:21], v[30:31] op_sel:[0,1] op_sel_hi:[1,1]
    v_pk_mul_f32 v[22:23], v[22:23], v[30:31] op_sel:[0,1] op_sel_hi:[1,1]
    v_pk_mul_f32 v[24:25], v[24:25], v[30:31] op_sel:[0,1] op_sel_hi:[1,1]
    v_pk_mul_f32 v[26:27], v[26:27], v[30:31] op_sel:[0,1] op_sel_hi:[1,1]
    v_pk_mul_f32 v[28:29], v[28:29], v[30:31] op_sel:[0,1] op_sel_hi:[1,1]
    v_exp_f32 v14, -v14
    v_exp_f32 v15, -v15
    v_exp_f32 v16, -v16
    v_exp_f32 v17, -v17
    v_exp_f32 v18, -v18
    v_exp_f32 v19, -v19
    v_exp_f32 v20, -v20
    v_exp_f32 v21, -v21
    v_exp_f32 v22, -v22
    v_exp_f32 v23, -v23
    v_exp_f32 v24, -v24
    v_exp_f32 v25, -v25
    v_exp_f32 v26, -v26
    v_exp_f32 v27, -v27
    v_exp_f32 v28, -v28
    v_exp_f32 v29, -v29
    v_cvt_pk_bf16_f32 v14, v14, v16
    v_cvt_pk_bf16_f32 v15, v15, v17
    v_cvt_pk_bf16_f32 v18, v18, v20
    v_cvt_pk_bf16_f32 v19, v19, v21
    v_cvt_pk_bf16_f32 v22, v22, v24
    v_cvt_pk_bf16_f32 v23, v23, v25
    v_cvt_pk_bf16_f32 v26, v26, v28
    v_cvt_pk_bf16_f32 v27, v27, v29
    v_dot2_f32_bf16 v72, v14, s68, 0
    v_dot2_f32_bf16 v73, v15, s68, 0
    v_dot2_f32_bf16 v74, v14, s69, 0
    v_dot2_f32_bf16 v75, v15, s69, 0
    v_dot2_f32_bf16 v76, v14, s70, 0
    v_dot2_f32_bf16 v77, v15, s70, 0
    v_dot2_f32_bf16 v78, v14, s71, 0
    v_dot2_f32_bf16 v79, v15, s71, 0
    v_dot2_f32_bf16 v80, v14, s52, 0
    v_dot2_f32_bf16 v81, v15, s52, 0
    v_dot2_f32_bf16 v82, v14, s53, 0
    v_dot2_f32_bf16 v83, v15, s53, 0
    v_dot2_f32_bf16 v84, v14, s54, 0
    v_dot2_f32_bf16 v85, v15, s54, 0
    v_dot2_f32_bf16 v86, v14, s55, 0
    v_dot2_f32_bf16 v87, v15, s55, 0
    v_dot2_f32_bf16 v72, v18, s72, v72
    v_dot2_f32_bf16 v73, v19, s72, v73
    v_dot2_f32_bf16 v74, v18, s73, v74
    v_dot2_f32_bf16 v75, v19, s73, v75
    v_dot2_f32_bf16 v76, v18, s74, v76
    v_dot2_f32_bf16 v77, v19, s74, v77
    v_dot2_f32_bf16 v78, v18, s75, v78
    v_dot2_f32_bf16 v79, v19, s75, v79
    v_dot2_f32_bf16 v80, v18, s56, v80
    v_dot2_f32_bf16 v81, v19, s56, v81
    v_dot2_f32_bf16 v82, v18, s57, v82
    v_dot2_f32_bf16 v83, v19, s57, v83
    v_dot2_f32_bf16 v84, v18, s58, v84
    v_dot2_f32_bf16 v85, v19, s58, v85
    v_dot2_f32_bf16 v86, v18, s59, v86
    v_dot2_f32_bf16 v87, v19, s59, v87
    v_dot2_f32_bf16 v72, v22, s76, v72
    v_dot2_f32_bf16 v73, v23, s76, v73
    v_dot2_f32_bf16 v74, v22, s77, v74
    v_dot2_f32_bf16 v75, v23, s77, v75
    v_dot2_f32_bf16 v76, v22, s78, v76
    v_dot2_f32_bf16 v77, v23, s78, v77
    v_dot2_f32_bf16 v78, v22, s79, v78
    v_dot2_f32_bf16 v79, v23, s79, v79
    v_dot2_f32_bf16 v80, v22, s60, v80
    v_dot2_f32_bf16 v81, v23, s60, v81
    v_dot2_f32_bf16 v82, v22, s61, v82
    v_dot2_f32_bf16 v83, v23, s61, v83
    v_dot2_f32_bf16 v84, v22, s62, v84
    v_dot2_f32_bf16 v85, v23, s62, v85
    v_dot2_f32_bf16 v86, v22, s63, v86
    v_dot2_f32_bf16 v87, v23, s63, v87
    v_dot2_f32_bf16 v72, v26, s80, v72
    v_dot2_f32_bf16 v73, v27, s80, v73
    v_dot2_f32_bf16 v74, v26, s81, v74
    v_dot2_f32_bf16 v75, v27, s81, v75
    v_dot2_f32_bf16 v76, v26, s82, v76
    v_dot2_f32_bf16 v77, v27, s82, v77
    v_dot2_f32_bf16 v78, v26, s83, v78
    v_dot2_f32_bf16 v79, v27, s83, v79
    v_dot2_f32_bf16 v80, v26, s64, v80
    v_dot2_f32_bf16 v81, v27, s64, v81
    v_dot2_f32_bf16 v82, v26, s65, v82
    v_dot2_f32_bf16 v83, v27, s65, v83
    v_dot2_f32_bf16 v84, v26, s66, v84
    v_dot2_f32_bf16 v85, v27, s66, v85
    v_dot2_f32_bf16 v86, v26, s67, v86
    v_dot2_f32_bf16 v87, v27, s67, v87
    s_cmp_ge_u32 s13, 4
    s_cbranch_scc1 L_p2_kernel_g1_6
    v_lshlrev_b32 v30, 16, v61
    v_and_b32 v31, 0xffff0000, v61
    v_pk_add_f32 v[14:15], v[30:31], v[36:37] op_sel:[0,0] op_sel_hi:[1,0] neg_lo:[0,1] neg_hi:[0,1]
    v_pk_add_f32 v[16:17], v[30:31], v[36:37] op_sel:[0,1] op_sel_hi:[1,1] neg_lo:[0,1] neg_hi:[0,1]
    v_pk_add_f32 v[18:19], v[30:31], v[38:39] op_sel:[0,0] op_sel_hi:[1,0] neg_lo:[0,1] neg_hi:[0,1]
    v_pk_add_f32 v[20:21], v[30:31], v[38:39] op_sel:[0,1] op_sel_hi:[1,1] neg_lo:[0,1] neg_hi:[0,1]
    v_pk_add_f32 v[22:23], v[30:31], v[40:41] op_sel:[0,0] op_sel_hi:[1,0] neg_lo:[0,1] neg_hi:[0,1]
    v_pk_add_f32 v[24:25], v[30:31], v[40:41] op_sel:[0,1] op_sel_hi:[1,1] neg_lo:[0,1] neg_hi:[0,1]
    v_pk_add_f32 v[26:27], v[30:31], v[42:43] op_sel:[0,0] op_sel_hi:[1,0] neg_lo:[0,1] neg_hi:[0,1]
    v_pk_add_f32 v[28:29], v[30:31], v[42:43] op_sel:[0,1] op_sel_hi:[1,1] neg_lo:[0,1] neg_hi:[0,1]
    v_cvt_pk_bf16_f32 v32, v14, v15
    v_lshlrev_b32 v14, 16, v32
    v_and_b32 v15, 0xffff0000, v32
    v_cvt_pk_bf16_f32 v32, v16, v17
    v_lshlrev_b32 v16, 16, v32
    v_and_b32 v17, 0xffff0000, v32
    v_cvt_pk_bf16_f32 v32, v18, v19
    v_lshlrev_b32 v18, 16, v32
    v_and_b32 v19, 0xffff0000, v32
    v_cvt_pk_bf16_f32 v32, v20, v21
    v_lshlrev_b32 v20, 16, v32
    v_and_b32 v21, 0xffff0000, v32
    v_cvt_pk_bf16_f32 v32, v22, v23
    v_lshlrev_b32 v22, 16, v32
    v_and_b32 v23, 0xffff0000, v32
    v_cvt_pk_bf16_f32 v32, v24, v25
    v_lshlrev_b32 v24, 16, v32
    v_and_b32 v25, 0xffff0000, v32
    v_cvt_pk_bf16_f32 v32, v26, v27
    v_lshlrev_b32 v26, 16, v32
    v_and_b32 v27, 0xffff0000, v32
    v_cvt_pk_bf16_f32 v32, v28, v29
    v_lshlrev_b32 v28, 16, v32
    v_and_b32 v29, 0xffff0000, v32
    v_pk_mul_f32 v[14:15], v[14:15], v[14:15]
    v_pk_mul_f32 v[16:17], v[16:17], v[16:17]
    v_pk_mul_f32 v[18:19], v[18:19], v[18:19]
    v_pk_mul_f32 v[20:21], v[20:21], v[20:21]
    v_pk_mul_f32 v[22:23], v[22:23], v[22:23]
    v_pk_mul_f32 v[24:25], v[24:25], v[24:25]
    v_pk_mul_f32 v[26:27], v[26:27], v[26:27]
    v_pk_mul_f32 v[28:29], v[28:29], v[28:29]
    v_cvt_pk_bf16_f32 v32, v14, v15
    v_lshlrev_b32 v14, 16, v32
    v_and_b32 v15, 0xffff0000, v32
    v_cvt_pk_bf16_f32 v32, v16, v17
    v_lshlrev_b32 v16, 16, v32
    v_and_b32 v17, 0xffff0000, v32
    v_cvt_pk_bf16_f32 v32, v18, v19
    v_lshlrev_b32 v18, 16, v32
    v_and_b32 v19, 0xffff0000, v32
    v_cvt_pk_bf16_f32 v32, v20, v21
    v_lshlrev_b32 v20, 16, v32
    v_and_b32 v21, 0xffff0000, v32
    v_cvt_pk_bf16_f32 v32, v22, v23
    v_lshlrev_b32 v22, 16, v32
    v_and_b32 v23, 0xffff0000, v32
    v_cvt_pk_bf16_f32 v32, v24, v25
    v_lshlrev_b32 v24, 16, v32
    v_and_b32 v25, 0xffff0000, v32
    v_cvt_pk_bf16_f32 v32, v26, v27
    v_lshlrev_b32 v26, 16, v32
    v_and_b32 v27, 0xffff0000, v32
    v_cvt_pk_bf16_f32 v32, v28, v29
    v_lshlrev_b32 v28, 16, v32
    v_and_b32 v29, 0xffff0000, v32
    v_mov_b32 v30, 1092616192
    v_mov_b32 v31, 0x3fb8aa3b
    v_pk_mul_f32 v[14:15], v[14:15], v[30:31] op_sel:[0,0] op_sel_hi:[1,0]
    v_pk_mul_f32 v[16:17], v[16:17], v[30:31] op_sel:[0,0] op_sel_hi:[1,0]
    v_pk_mul_f32 v[18:19], v[18:19], v[30:31] op_sel:[0,0] op_sel_hi:[1,0]
    v_pk_mul_f32 v[20:21], v[20:21], v[30:31] op_sel:[0,0] op_sel_hi:[1,0]
    v_pk_mul_f32 v[22:23], v[22:23], v[30:31] op_sel:[0,0] op_sel_hi:[1,0]
    v_pk_mul_f32 v[24:25], v[24:25], v[30:31] op_sel:[0,0] op_sel_hi:[1,0]
    v_pk_mul_f32 v[26:27], v[26:27], v[30:31] op_sel:[0,0] op_sel_hi:[1,0]
    v_pk_mul_f32 v[28:29], v[28:29], v[30:31] op_sel:[0,0] op_sel_hi:[1,0]
    v_cvt_pk_bf16_f32 v32, v14, v15
    v_lshlrev_b32 v14, 16, v32
    v_and_b32 v15, 0xffff0000, v32
    v_cvt_pk_bf16_f32 v32, v16, v17
    v_lshlrev_b32 v16, 16, v32
    v_and_b32 v17, 0xffff0000, v32
    v_cvt_pk_bf16_f32 v32, v18, v19
    v_lshlrev_b32 v18, 16, v32
    v_and_b32 v19, 0xffff0000, v32
    v_cvt_pk_bf16_f32 v32, v20, v21
    v_lshlrev_b32 v20, 16, v32
    v_and_b32 v21, 0xffff0000, v32
    v_cvt_pk_bf16_f32 v32, v22, v23
    v_lshlrev_b32 v22, 16, v32
    v_and_b32 v23, 0xffff0000, v32
    v_cvt_pk_bf16_f32 v32, v24, v25
    v_lshlrev_b32 v24, 16, v32
    v_and_b32 v25, 0xffff0000, v32
    v_cvt_pk_bf16_f32 v32, v26, v27
    v_lshlrev_b32 v26, 16, v32
    v_and_b32 v27, 0xffff0000, v32
    v_cvt_pk_bf16_f32 v32, v28, v29
    v_lshlrev_b32 v28, 16, v32
    v_and_b32 v29, 0xffff0000, v32
    v_pk_mul_f32 v[14:15], v[14:15], v[30:31] op_sel:[0,1] op_sel_hi:[1,1]
    v_pk_mul_f32 v[16:17], v[16:17], v[30:31] op_sel:[0,1] op_sel_hi:[1,1]
    v_pk_mul_f32 v[18:19], v[18:19], v[30:31] op_sel:[0,1] op_sel_hi:[1,1]
    v_pk_mul_f32 v[20:21], v[20:21], v[30:31] op_sel:[0,1] op_sel_hi:[1,1]
    v_pk_mul_f32 v[22:23], v[22:23], v[30:31] op_sel:[0,1] op_sel_hi:[1,1]
    v_pk_mul_f32 v[24:25], v[24:25], v[30:31] op_sel:[0,1] op_sel_hi:[1,1]
    v_pk_mul_f32 v[26:27], v[26:27], v[30:31] op_sel:[0,1] op_sel_hi:[1,1]
    v_pk_mul_f32 v[28:29], v[28:29], v[30:31] op_sel:[0,1] op_sel_hi:[1,1]
    v_exp_f32 v14, -v14
    v_exp_f32 v15, -v15
    v_exp_f32 v16, -v16
    v_exp_f32 v17, -v17
    v_exp_f32 v18, -v18
    v_exp_f32 v19, -v19
    v_exp_f32 v20, -v20
    v_exp_f32 v21, -v21
    v_exp_f32 v22, -v22
    v_exp_f32 v23, -v23
    v_exp_f32 v24, -v24
    v_exp_f32 v25, -v25
    v_exp_f32 v26, -v26
    v_exp_f32 v27, -v27
    v_exp_f32 v28, -v28
    v_exp_f32 v29, -v29
    v_cvt_pk_bf16_f32 v14, v14, v16
    v_cvt_pk_bf16_f32 v15, v15, v17
    v_cvt_pk_bf16_f32 v18, v18, v20
    v_cvt_pk_bf16_f32 v19, v19, v21
    v_cvt_pk_bf16_f32 v22, v22, v24
    v_cvt_pk_bf16_f32 v23, v23, v25
    v_cvt_pk_bf16_f32 v26, v26, v28
    v_cvt_pk_bf16_f32 v27, v27, v29
    v_dot2_f32_bf16 v112, v14, s68, 0
    v_dot2_f32_bf16 v113, v15, s68, 0
    v_dot2_f32_bf16 v114, v14, s69, 0
    v_dot2_f32_bf16 v115, v15, s69, 0
    v_dot2_f32_bf16 v116, v14, s70, 0
    v_dot2_f32_bf16 v117, v15, s70, 0
    v_dot2_f32_bf16 v118, v14, s71, 0
    v_dot2_f32_bf16 v119, v15, s71, 0
    v_dot2_f32_bf16 v120, v14, s52, 0
    v_dot2_f32_bf16 v121, v15, s52, 0
    v_dot2_f32_bf16 v122, v14, s53, 0
    v_dot2_f32_bf16 v123, v15, s53, 0
    v_dot2_f32_bf16 v124, v14, s54, 0
    v_dot2_f32_bf16 v125, v15, s54, 0
    v_dot2_f32_bf16 v126, v14, s55, 0
    v_dot2_f32_bf16 v127, v15, s55, 0
    v_dot2_f32_bf16 v112, v18, s72, v112
    v_dot2_f32_bf16 v113, v19, s72, v113
    v_dot2_f32_bf16 v114, v18, s73, v114
    v_dot2_f32_bf16 v115, v19, s73, v115
    v_dot2_f32_bf16 v116, v18, s74, v116
    v_dot2_f32_bf16 v117, v19, s74, v117
    v_dot2_f32_bf16 v118, v18, s75, v118
    v_dot2_f32_bf16 v119, v19, s75, v119
    v_dot2_f32_bf16 v120, v18, s56, v120
    v_dot2_f32_bf16 v121, v19, s56, v121
    v_dot2_f32_bf16 v122, v18, s57, v122
    v_dot2_f32_bf16 v123, v19, s57, v123
    v_dot2_f32_bf16 v124, v18, s58, v124
    v_dot2_f32_bf16 v125, v19, s58, v125
    v_dot2_f32_bf16 v126, v18, s59, v126
    v_dot2_f32_bf16 v127, v19, s59, v127
    v_dot2_f32_bf16 v112, v22, s76, v112
    v_dot2_f32_bf16 v113, v23, s76, v113
    v_dot2_f32_bf16 v114, v22, s77, v114
    v_dot2_f32_bf16 v115, v23, s77, v115
    v_dot2_f32_bf16 v116, v22, s78, v116
    v_dot2_f32_bf16 v117, v23, s78, v117
    v_dot2_f32_bf16 v118, v22, s79, v118
    v_dot2_f32_bf16 v119, v23, s79, v119
    v_dot2_f32_bf16 v120, v22, s60, v120
    v_dot2_f32_bf16 v121, v23, s60, v121
    v_dot2_f32_bf16 v122, v22, s61, v122
    v_dot2_f32_bf16 v123, v23, s61, v123
    v_dot2_f32_bf16 v124, v22, s62, v124
    v_dot2_f32_bf16 v125, v23, s62, v125
    v_dot2_f32_bf16 v126, v22, s63, v126
    v_dot2_f32_bf16 v127, v23, s63, v127
    v_dot2_f32_bf16 v112, v26, s80, v112
    v_dot2_f32_bf16 v113, v27, s80, v113
    v_dot2_f32_bf16 v114, v26, s81, v114
    v_dot2_f32_bf16 v115, v27, s81, v115
    v_dot2_f32_bf16 v116, v26, s82, v116
    v_dot2_f32_bf16 v117, v27, s82, v117
    v_dot2_f32_bf16 v118, v26, s83, v118
    v_dot2_f32_bf16 v119, v27, s83, v119
    v_dot2_f32_bf16 v120, v26, s64, v120
    v_dot2_f32_bf16 v121, v27, s64, v121
    v_dot2_f32_bf16 v122, v26, s65, v122
    v_dot2_f32_bf16 v123, v27, s65, v123
    v_dot2_f32_bf16 v124, v26, s66, v124
    v_dot2_f32_bf16 v125, v27, s66, v125
    v_dot2_f32_bf16 v126, v26, s67, v126
    v_dot2_f32_bf16 v127, v27, s67, v127
L_p2_kernel_g1_6:
L_p2_gb:
    v_and_b32 v4, 0x80008000, v4
    v_cmp_ne_u32 vcc, 0, v4
    v_mov_b32 v8, s27
    v_and_b32 v10, 15, v0
    v_mul_u32_u24 v10, 240, v10
    v_add_u32 v10, 160000, v10
    s_cmp_lg_u64 vcc, 0
    s_cselect_b32 s2, 1, s2
    v_mov_b32 v9, s2
    s_mov_b64 exec, 1
    ds_write_b32 v8, v9
    s_mov_b64 exec, -1
    v_add_u32 v2, 16384, v1
    v_mov_b32 v9, 0x3f000000
    v_cmp_gt_u32 vcc, 226, v0
    s_mov_b32 s49, s12
    s_mov_b32 s51, 0
    v_cndmask_b32 v2, v9, v2, vcc
    s_waitcnt vmcnt(0) lgkmcnt(0)
    s_barrier
    ds_read_b32 v9, v10
    s_mov_b32 s18, 5120000
    s_mov_b32 s19, 0x00020000
    s_waitcnt lgkmcnt(0)
    v_cmp_ne_u32 vcc, 0, v9
    s_nop 1
    s_cmp_lg_u64 vcc, 0
    s_cselect_b32 s2, 1, 0
    s_cbranch_scc1 L_p2_slow
L_p2_signal:
    v_mov_b32 v8, 160228
    s_lshl_b32 s15, s2, 4
    s_or_b32 s15, s15, s21
    s_add_u32 s14, s12, 16
    s_lshl_b32 s20, s15, s14
    s_add_u32 s20, s20, 1
    v_mov_b32 v9, s20
    s_cmp_lg_u32 s13, 15
    s_cbranch_scc1 L_p2_nosig0
    s_lshl_b32 s14, s3, 8
    s_add_u32 s14, s14, 227590656
    s_mov_b64 exec, 1
    buffer_atomic_add v9, off, s[4:7], s14 sc0
    s_mov_b64 exec, -1
L_p2_nosig0:
    s_lshl2_add_u32 s14, s3, s49
    s_mul_i32 s26, s14, 20000
    s_add_u32 s15, s26, 227607040
    buffer_load_dwordx4 v[64:67], v1, s[4:7], s15 offen
    buffer_load_dwordx4 v[68:71], v2, s[4:7], s15 offen
    s_lshl_b32 s28, s92, 16
    s_and_b32 s29, s92, 0xffff0000
    s_lshl_b32 s30, s93, 16
    s_and_b32 s31, s93, 0xffff0000
    s_lshl_b32 s32, s94, 16
    s_and_b32 s33, s94, 0xffff0000
    s_lshl_b32 s34, s95, 16
    s_and_b32 s35, s95, 0xffff0000
    s_lshl_b32 s36, s96, 16
    s_and_b32 s37, s96, 0xffff0000
    s_lshl_b32 s38, s97, 16
    s_and_b32 s39, s97, 0xffff0000
    s_lshl_b32 s40, s98, 16
    s_and_b32 s41, s98, 0xffff0000
    s_lshl_b32 s42, s99, 16
    s_and_b32 s43, s99, 0xffff0000
    s_and_b32 s99, s91, 0xffff0000
    s_lshl_b32 s98, s91, 16
    s_and_b32 s97, s90, 0xffff0000
    s_lshl_b32 s96, s90, 16
    s_and_b32 s95, s89, 0xffff0000
    s_lshl_b32 s94, s89, 16
    s_and_b32 s93, s88, 0xffff0000
    s_lshl_b32 s92, s88, 16
    s_and_b32 s91, s87, 0xffff0000
    s_lshl_b32 s90, s87, 16
    s_and_b32 s89, s86, 0xffff0000
    s_lshl_b32 s88, s86, 16
    s_and_b32 s87, s85, 0xffff0000
    s_lshl_b32 s86, s85, 16
    s_and_b32 s85, s84, 0xffff0000
    s_lshl_b32 s84, s84, 16
    s_mov_b32 s44, s48
    s_add_u32 s45, s48, 2281701376
    s_cmp_eq_u32 s48, 0
    s_cselect_b32 s45, 0, s45
    s_cmp_lg_u32 s13, 15
    s_cbranch_scc1 L_p2_nosig
    s_waitcnt vmcnt(2)
    v_readfirstlane_b32 s15, v9
    s_lshl_b32 s51, 1, s12
    s_add_u32 s20, s20, s15
    s_and_b32 s15, s20, 0xff
    s_cmp_eq_u32 s15, 4
    s_cbranch_scc0 L_p2_notlast
    s_bfe_u32 s15, s20, 262160
    s_or_b32 s51, s51, s15
    s_branch L_p2_pub
L_p2_notlast:
    s_cmp_lg_u32 s21, 0
    s_cselect_b32 s51, 0, s51
    s_cbranch_scc1 L_p2_pub
L_p2_poll:
    v_mov_b32 v9, 0
    s_lshl_b32 s14, s3, 8
    s_add_u32 s14, s14, 227590656
    s_mov_b64 exec, 1
    buffer_atomic_add v9, off, s[4:7], s14 sc0
    s_mov_b64 exec, -1
    s_waitcnt vmcnt(0)
    v_readfirstlane_b32 s20, v9
    s_nop 0
    s_and_b32 s15, s20, 0xff
    s_cmp_lt_u32 s15, 4
    s_cbranch_scc1 L_p2_poll
L_p2_pub:
    s_lshl_b32 s15, s51, 24
    s_or_b32 s15, s15, s20
    v_mov_b32 v9, s15
    s_mov_b64 exec, 1
    ds_write_b32 v8, v9
    s_mov_b64 exec, -1
    s_waitcnt lgkmcnt(0)
L_p2_nosig:
    s_barrier
    ds_read_b32 v9, v8
    s_waitcnt lgkmcnt(0)
    v_readfirstlane_b32 s20, v9
    s_nop 0
    s_lshr_b32 s51, s20, 24
    s_cbranch_scc0 L_p2_end
L_p2_fin:
    s_mul_i32 s24, s49, 20000
    s_add_u32 s14, s12, 1
    s_and_b32 s14, s14, 3
    s_mul_i32 s15, s14, 5120000
    s_add_u32 s15, s15, 232727040
    s_add_u32 s15, s15, s26
    buffer_load_dwordx4 v[12:15], v1, s[4:7], s15 offen sc1
    buffer_load_dwordx4 v[92:95], v2, s[4:7], s15 offen sc1
    s_add_u32 s14, s12, 2
    s_and_b32 s14, s14, 3
    s_mul_i32 s15, s14, 5120000
    s_add_u32 s15, s15, 232727040
    s_add_u32 s15, s15, s26
    buffer_load_dwordx4 v[16:19], v1, s[4:7], s15 offen sc1
    buffer_load_dwordx4 v[96:99], v2, s[4:7], s15 offen sc1
    s_add_u32 s14, s12, 3
    s_and_b32 s14, s14, 3
    s_mul_i32 s15, s14, 5120000
    s_add_u32 s15, s15, 232727040
    s_add_u32 s15, s15, s26
    buffer_load_dwordx4 v[20:23], v1, s[4:7], s15 offen sc1
    buffer_load_dwordx4 v[100:103], v2, s[4:7], s15 offen sc1
    v_add_u32 v24, s24, v1
    ds_read_b128 v[8:11], v24
    v_add_u32 v25, s24, v2
    ds_read_b128 v[88:91], v25
    s_waitcnt vmcnt(0) lgkmcnt(0)
    s_bfe_u32 s14, s20, 262164
    s_cbranch_scc0 L_p2_kernel_nof32a_7
    s_add_u32 s14, s12, 0
    s_and_b32 s14, s14, 3
    s_add_u32 s14, s14, 20
    s_bitcmp1_b32 s20, s14
    s_cbranch_scc0 L_p2_kernel_q_8
    v_mov_b32 v8, 1073758208
    v_mov_b32 v9, 1073758208
    v_mov_b32 v10, 1073758208
    v_mov_b32 v11, 1073758208
L_p2_kernel_q_8:
    s_add_u32 s14, s12, 1
    s_and_b32 s14, s14, 3
    s_add_u32 s14, s14, 20
    s_bitcmp1_b32 s20, s14
    s_cbranch_scc0 L_p2_kernel_q_9
    v_mov_b32 v12, 1073758208
    v_mov_b32 v13, 1073758208
    v_mov_b32 v14, 1073758208
    v_mov_b32 v15, 1073758208
L_p2_kernel_q_9:
    s_add_u32 s14, s12, 2
    s_and_b32 s14, s14, 3
    s_add_u32 s14, s14, 20
    s_bitcmp1_b32 s20, s14
    s_cbranch_scc0 L_p2_kernel_q_10
    v_mov_b32 v16, 1073758208
    v_mov_b32 v17, 1073758208
    v_mov_b32 v18, 1073758208
    v_mov_b32 v19, 1073758208
L_p2_kernel_q_10:
    s_add_u32 s14, s12, 3
    s_and_b32 s14, s14, 3
    s_add_u32 s14, s14, 20
    s_bitcmp1_b32 s20, s14
    s_cbranch_scc0 L_p2_kernel_q_11
    v_mov_b32 v20, 1073758208
    v_mov_b32 v21, 1073758208
    v_mov_b32 v22, 1073758208
    v_mov_b32 v23, 1073758208
L_p2_kernel_q_11:
L_p2_kernel_nof32a_7:
    v_pk_add_u16 v8, v8, v12
    v_pk_add_u16 v16, v16, v20
    v_pk_add_u16 v9, v9, v13
    v_pk_add_u16 v17, v17, v21
    v_pk_add_u16 v10, v10, v14
    v_pk_add_u16 v18, v18, v22
    v_pk_add_u16 v11, v11, v15
    v_pk_add_u16 v19, v19, v23
    v_add_u32_sdwa v24, v8, v16 dst_sel:DWORD dst_unused:UNUSED_PAD src0_sel:WORD_0 src1_sel:WORD_0
    v_add_u32_sdwa v25, v10, v18 dst_sel:DWORD dst_unused:UNUSED_PAD src0_sel:WORD_0 src1_sel:WORD_0
    v_add_u32_sdwa v26, v8, v16 dst_sel:DWORD dst_unused:UNUSED_PAD src0_sel:WORD_1 src1_sel:WORD_1
    v_add_u32_sdwa v27, v10, v18 dst_sel:DWORD dst_unused:UNUSED_PAD src0_sel:WORD_1 src1_sel:WORD_1
    v_add_u32_sdwa v28, v9, v17 dst_sel:DWORD dst_unused:UNUSED_PAD src0_sel:WORD_0 src1_sel:WORD_0
    v_add_u32_sdwa v29, v11, v19 dst_sel:DWORD dst_unused:UNUSED_PAD src0_sel:WORD_0 src1_sel:WORD_0
    v_add_u32_sdwa v30, v9, v17 dst_sel:DWORD dst_unused:UNUSED_PAD src0_sel:WORD_1 src1_sel:WORD_1
    v_add_u32_sdwa v31, v11, v19 dst_sel:DWORD dst_unused:UNUSED_PAD src0_sel:WORD_1 src1_sel:WORD_1
    v_cvt_f32_u32 v24, v24
    v_cvt_f32_u32 v25, v25
    v_cvt_f32_u32 v26, v26
    v_cvt_f32_u32 v27, v27
    v_cvt_f32_u32 v28, v28
    v_cvt_f32_u32 v29, v29
    v_cvt_f32_u32 v30, v30
    v_cvt_f32_u32 v31, v31
    v_pk_fma_f32 v[24:25], v[24:25], s[44:45], s[44:45] op_sel:[0,0,1] op_sel_hi:[1,0,1]
    v_pk_fma_f32 v[26:27], v[26:27], s[44:45], s[44:45] op_sel:[0,0,1] op_sel_hi:[1,0,1]
    v_pk_fma_f32 v[28:29], v[28:29], s[44:45], s[44:45] op_sel:[0,0,1] op_sel_hi:[1,0,1]
    v_pk_fma_f32 v[30:31], v[30:31], s[44:45], s[44:45] op_sel:[0,0,1] op_sel_hi:[1,0,1]
    s_bfe_u32 s14, s20, 262164
    s_cbranch_scc0 L_p2_kernel_nof32b_12
    v_lshlrev_b32 v32, 1, v1
    s_bitcmp1_b32 s20, 20
    s_cbranch_scc0 L_p2_kernel_q_13
    s_lshl_b32 s15, s26, 1
    s_add_u32 s15, s15, 253207040
    buffer_load_dwordx4 v[8:11], v32, s[4:7], s15 offen sc1
    buffer_load_dwordx4 v[12:15], v32, s[4:7], s15 offen offset:16 sc1
    s_waitcnt vmcnt(0)
    v_add_f32 v24, v24, v8
    v_add_f32 v25, v25, v12
    v_add_f32 v26, v26, v9
    v_add_f32 v27, v27, v13
    v_add_f32 v28, v28, v10
    v_add_f32 v29, v29, v14
    v_add_f32 v30, v30, v11
    v_add_f32 v31, v31, v15
L_p2_kernel_q_13:
    s_bitcmp1_b32 s20, 21
    s_cbranch_scc0 L_p2_kernel_q_14
    s_lshl_b32 s15, s26, 1
    s_add_u32 s15, s15, 263447040
    buffer_load_dwordx4 v[8:11], v32, s[4:7], s15 offen sc1
    buffer_load_dwordx4 v[12:15], v32, s[4:7], s15 offen offset:16 sc1
    s_waitcnt vmcnt(0)
    v_add_f32 v24, v24, v8
    v_add_f32 v25, v25, v12
    v_add_f32 v26, v26, v9
    v_add_f32 v27, v27, v13
    v_add_f32 v28, v28, v10
    v_add_f32 v29, v29, v14
    v_add_f32 v30, v30, v11
    v_add_f32 v31, v31, v15
L_p2_kernel_q_14:
    s_bitcmp1_b32 s20, 22
    s_cbranch_scc0 L_p2_kernel_q_15
    s_lshl_b32 s15, s26, 1
    s_add_u32 s15, s15, 273687040
    buffer_load_dwordx4 v[8:11], v32, s[4:7], s15 offen sc1
    buffer_load_dwordx4 v[12:15], v32, s[4:7], s15 offen offset:16 sc1
    s_waitcnt vmcnt(0)
    v_add_f32 v24, v24, v8
    v_add_f32 v25, v25, v12
    v_add_f32 v26, v26, v9
    v_add_f32 v27, v27, v13
    v_add_f32 v28, v28, v10
    v_add_f32 v29, v29, v14
    v_add_f32 v30, v30, v11
    v_add_f32 v31, v31, v15
L_p2_kernel_q_15:
    s_bitcmp1_b32 s20, 23
    s_cbranch_scc0 L_p2_kernel_q_16
    s_lshl_b32 s15, s26, 1
    s_add_u32 s15, s15, 283927040
    buffer_load_dwordx4 v[8:11], v32, s[4:7], s15 offen sc1
    buffer_load_dwordx4 v[12:15], v32, s[4:7], s15 offen offset:16 sc1
    s_waitcnt vmcnt(0)
    v_add_f32 v24, v24, v8
    v_add_f32 v25, v25, v12
    v_add_f32 v26, v26, v9
    v_add_f32 v27, v27, v13
    v_add_f32 v28, v28, v10
    v_add_f32 v29, v29, v14
    v_add_f32 v30, v30, v11
    v_add_f32 v31, v31, v15
L_p2_kernel_q_16:
L_p2_kernel_nof32b_12:
    v_pk_mul_f32 v[8:9], v[24:25], s[84:85] op_sel:[0,0] op_sel_hi:[1,0]
    v_pk_mul_f32 v[10:11], v[24:25], s[84:85] op_sel:[0,1] op_sel_hi:[1,1]
    v_pk_mul_f32 v[12:13], v[24:25], s[86:87] op_sel:[0,0] op_sel_hi:[1,0]
    v_pk_mul_f32 v[14:15], v[24:25], s[86:87] op_sel:[0,1] op_sel_hi:[1,1]
    v_pk_fma_f32 v[8:9], v[26:27], s[88:89], v[8:9] op_sel:[0,0,0] op_sel_hi:[1,0,1]
    v_pk_fma_f32 v[10:11], v[26:27], s[88:89], v[10:11] op_sel:[0,1,0] op_sel_hi:[1,1,1]
    v_pk_fma_f32 v[12:13], v[26:27], s[90:91], v[12:13] op_sel:[0,0,0] op_sel_hi:[1,0,1]
    v_pk_fma_f32 v[14:15], v[26:27], s[90:91], v[14:15] op_sel:[0,1,0] op_sel_hi:[1,1,1]
    v_pk_fma_f32 v[8:9], v[28:29], s[92:93], v[8:9] op_sel:[0,0,0] op_sel_hi:[1,0,1]
    v_pk_fma_f32 v[10:11], v[28:29], s[92:93], v[10:11] op_sel:[0,1,0] op_sel_hi:[1,1,1]
    v_pk_fma_f32 v[12:13], v[28:29], s[94:95], v[12:13] op_sel:[0,0,0] op_sel_hi:[1,0,1]
    v_pk_fma_f32 v[14:15], v[28:29], s[94:95], v[14:15] op_sel:[0,1,0] op_sel_hi:[1,1,1]
    v_pk_fma_f32 v[8:9], v[30:31], s[96:97], v[8:9] op_sel:[0,0,0] op_sel_hi:[1,0,1]
    v_pk_fma_f32 v[10:11], v[30:31], s[96:97], v[10:11] op_sel:[0,1,0] op_sel_hi:[1,1,1]
    v_pk_fma_f32 v[12:13], v[30:31], s[98:99], v[12:13] op_sel:[0,0,0] op_sel_hi:[1,0,1]
    v_pk_fma_f32 v[14:15], v[30:31], s[98:99], v[14:15] op_sel:[0,1,0] op_sel_hi:[1,1,1]
    v_pk_mul_f32 v[8:9], v[8:9], v[72:73]
    v_pk_mul_f32 v[10:11], v[10:11], v[74:75]
    v_pk_mul_f32 v[12:13], v[12:13], v[76:77]
    v_pk_mul_f32 v[14:15], v[14:15], v[78:79]
    v_pk_mul_f32 v[24:25], v[8:9], s[28:29] op_sel:[0,0] op_sel_hi:[1,0]
    v_pk_mul_f32 v[26:27], v[8:9], s[28:29] op_sel:[0,1] op_sel_hi:[1,1]
    v_pk_mul_f32 v[28:29], v[8:9], s[30:31] op_sel:[0,0] op_sel_hi:[1,0]
    v_pk_mul_f32 v[30:31], v[8:9], s[30:31] op_sel:[0,1] op_sel_hi:[1,1]
    v_pk_fma_f32 v[24:25], v[10:11], s[32:33], v[24:25] op_sel:[0,0,0] op_sel_hi:[1,0,1]
    v_pk_fma_f32 v[26:27], v[10:11], s[32:33], v[26:27] op_sel:[0,1,0] op_sel_hi:[1,1,1]
    v_pk_fma_f32 v[28:29], v[10:11], s[34:35], v[28:29] op_sel:[0,0,0] op_sel_hi:[1,0,1]
    v_pk_fma_f32 v[30:31], v[10:11], s[34:35], v[30:31] op_sel:[0,1,0] op_sel_hi:[1,1,1]
    v_pk_fma_f32 v[24:25], v[12:13], s[36:37], v[24:25] op_sel:[0,0,0] op_sel_hi:[1,0,1]
    v_pk_fma_f32 v[26:27], v[12:13], s[36:37], v[26:27] op_sel:[0,1,0] op_sel_hi:[1,1,1]
    v_pk_fma_f32 v[28:29], v[12:13], s[38:39], v[28:29] op_sel:[0,0,0] op_sel_hi:[1,0,1]
    v_pk_fma_f32 v[30:31], v[12:13], s[38:39], v[30:31] op_sel:[0,1,0] op_sel_hi:[1,1,1]
    v_pk_fma_f32 v[24:25], v[14:15], s[40:41], v[24:25] op_sel:[0,0,0] op_sel_hi:[1,0,1]
    v_pk_fma_f32 v[26:27], v[14:15], s[40:41], v[26:27] op_sel:[0,1,0] op_sel_hi:[1,1,1]
    v_pk_fma_f32 v[28:29], v[14:15], s[42:43], v[28:29] op_sel:[0,0,0] op_sel_hi:[1,0,1]
    v_pk_fma_f32 v[30:31], v[14:15], s[42:43], v[30:31] op_sel:[0,1,0] op_sel_hi:[1,1,1]
    v_lshlrev_b32 v8, 16, v64
    v_and_b32 v10, 0xffff0000, v64
    v_lshlrev_b32 v12, 16, v65
    v_and_b32 v14, 0xffff0000, v65
    v_lshlrev_b32 v9, 16, v66
    v_and_b32 v11, 0xffff0000, v66
    v_lshlrev_b32 v13, 16, v67
    v_and_b32 v15, 0xffff0000, v67
    v_pk_fma_f32 v[8:9], v[24:25], v[80:81], v[8:9]
    v_pk_fma_f32 v[10:11], v[26:27], v[82:83], v[10:11]
    v_pk_fma_f32 v[12:13], v[28:29], v[84:85], v[12:13]
    v_pk_fma_f32 v[14:15], v[30:31], v[86:87], v[14:15]
    v_cvt_pk_bf16_f32 v16, v8, v10
    v_cvt_pk_bf16_f32 v17, v12, v14
    v_cvt_pk_bf16_f32 v18, v9, v11
    v_cvt_pk_bf16_f32 v19, v13, v15
    buffer_store_dwordx4 v[16:19], v1, s[16:19], s26 offen
    s_cmp_ge_u32 s13, 4
    s_cbranch_scc1 L_p2_f1
    s_bfe_u32 s14, s20, 262164
    s_cbranch_scc0 L_p2_kernel_nof32a_17
    s_add_u32 s14, s12, 0
    s_and_b32 s14, s14, 3
    s_add_u32 s14, s14, 20
    s_bitcmp1_b32 s20, s14
    s_cbranch_scc0 L_p2_kernel_q_18
    v_mov_b32 v88, 1073758208
    v_mov_b32 v89, 1073758208
    v_mov_b32 v90, 1073758208
    v_mov_b32 v91, 1073758208
L_p2_kernel_q_18:
    s_add_u32 s14, s12, 1
    s_and_b32 s14, s14, 3
    s_add_u32 s14, s14, 20
    s_bitcmp1_b32 s20, s14
    s_cbranch_scc0 L_p2_kernel_q_19
    v_mov_b32 v92, 1073758208
    v_mov_b32 v93, 1073758208
    v_mov_b32 v94, 1073758208
    v_mov_b32 v95, 1073758208
L_p2_kernel_q_19:
    s_add_u32 s14, s12, 2
    s_and_b32 s14, s14, 3
    s_add_u32 s14, s14, 20
    s_bitcmp1_b32 s20, s14
    s_cbranch_scc0 L_p2_kernel_q_20
    v_mov_b32 v96, 1073758208
    v_mov_b32 v97, 1073758208
    v_mov_b32 v98, 1073758208
    v_mov_b32 v99, 1073758208
L_p2_kernel_q_20:
    s_add_u32 s14, s12, 3
    s_and_b32 s14, s14, 3
    s_add_u32 s14, s14, 20
    s_bitcmp1_b32 s20, s14
    s_cbranch_scc0 L_p2_kernel_q_21
    v_mov_b32 v100, 1073758208
    v_mov_b32 v101, 1073758208
    v_mov_b32 v102, 1073758208
    v_mov_b32 v103, 1073758208
L_p2_kernel_q_21:
L_p2_kernel_nof32a_17:
    v_pk_add_u16 v88, v88, v92
    v_pk_add_u16 v96, v96, v100
    v_pk_add_u16 v89, v89, v93
    v_pk_add_u16 v97, v97, v101
    v_pk_add_u16 v90, v90, v94
    v_pk_add_u16 v98, v98, v102
    v_pk_add_u16 v91, v91, v95
    v_pk_add_u16 v99, v99, v103
    v_add_u32_sdwa v24, v88, v96 dst_sel:DWORD dst_unused:UNUSED_PAD src0_sel:WORD_0 src1_sel:WORD_0
    v_add_u32_sdwa v25, v90, v98 dst_sel:DWORD dst_unused:UNUSED_PAD src0_sel:WORD_0 src1_sel:WORD_0
    v_add_u32_sdwa v26, v88, v96 dst_sel:DWORD dst_unused:UNUSED_PAD src0_sel:WORD_1 src1_sel:WORD_1
    v_add_u32_sdwa v27, v90, v98 dst_sel:DWORD dst_unused:UNUSED_PAD src0_sel:WORD_1 src1_sel:WORD_1
    v_add_u32_sdwa v28, v89, v97 dst_sel:DWORD dst_unused:UNUSED_PAD src0_sel:WORD_0 src1_sel:WORD_0
    v_add_u32_sdwa v29, v91, v99 dst_sel:DWORD dst_unused:UNUSED_PAD src0_sel:WORD_0 src1_sel:WORD_0
    v_add_u32_sdwa v30, v89, v97 dst_sel:DWORD dst_unused:UNUSED_PAD src0_sel:WORD_1 src1_sel:WORD_1
    v_add_u32_sdwa v31, v91, v99 dst_sel:DWORD dst_unused:UNUSED_PAD src0_sel:WORD_1 src1_sel:WORD_1
    v_cvt_f32_u32 v24, v24
    v_cvt_f32_u32 v25, v25
    v_cvt_f32_u32 v26, v26
    v_cvt_f32_u32 v27, v27
    v_cvt_f32_u32 v28, v28
    v_cvt_f32_u32 v29, v29
    v_cvt_f32_u32 v30, v30
    v_cvt_f32_u32 v31, v31
    v_pk_fma_f32 v[24:25], v[24:25], s[44:45], s[44:45] op_sel:[0,0,1] op_sel_hi:[1,0,1]
    v_pk_fma_f32 v[26:27], v[26:27], s[44:45], s[44:45] op_sel:[0,0,1] op_sel_hi:[1,0,1]
    v_pk_fma_f32 v[28:29], v[28:29], s[44:45], s[44:45] op_sel:[0,0,1] op_sel_hi:[1,0,1]
    v_pk_fma_f32 v[30:31], v[30:31], s[44:45], s[44:45] op_sel:[0,0,1] op_sel_hi:[1,0,1]
    s_bfe_u32 s14, s20, 262164
    s_cbranch_scc0 L_p2_kernel_nof32b_22
    v_lshlrev_b32 v32, 1, v2
    s_bitcmp1_b32 s20, 20
    s_cbranch_scc0 L_p2_kernel_q_23
    s_lshl_b32 s15, s26, 1
    s_add_u32 s15, s15, 253207040
    buffer_load_dwordx4 v[88:91], v32, s[4:7], s15 offen sc1
    buffer_load_dwordx4 v[92:95], v32, s[4:7], s15 offen offset:16 sc1
    s_waitcnt vmcnt(0)
    v_add_f32 v24, v24, v88
    v_add_f32 v25, v25, v92
    v_add_f32 v26, v26, v89
    v_add_f32 v27, v27, v93
    v_add_f32 v28, v28, v90
    v_add_f32 v29, v29, v94
    v_add_f32 v30, v30, v91
    v_add_f32 v31, v31, v95
L_p2_kernel_q_23:
    s_bitcmp1_b32 s20, 21
    s_cbranch_scc0 L_p2_kernel_q_24
    s_lshl_b32 s15, s26, 1
    s_add_u32 s15, s15, 263447040
    buffer_load_dwordx4 v[88:91], v32, s[4:7], s15 offen sc1
    buffer_load_dwordx4 v[92:95], v32, s[4:7], s15 offen offset:16 sc1
    s_waitcnt vmcnt(0)
    v_add_f32 v24, v24, v88
    v_add_f32 v25, v25, v92
    v_add_f32 v26, v26, v89
    v_add_f32 v27, v27, v93
    v_add_f32 v28, v28, v90
    v_add_f32 v29, v29, v94
    v_add_f32 v30, v30, v91
    v_add_f32 v31, v31, v95
L_p2_kernel_q_24:
    s_bitcmp1_b32 s20, 22
    s_cbranch_scc0 L_p2_kernel_q_25
    s_lshl_b32 s15, s26, 1
    s_add_u32 s15, s15, 273687040
    buffer_load_dwordx4 v[88:91], v32, s[4:7], s15 offen sc1
    buffer_load_dwordx4 v[92:95], v32, s[4:7], s15 offen offset:16 sc1
    s_waitcnt vmcnt(0)
    v_add_f32 v24, v24, v88
    v_add_f32 v25, v25, v92
    v_add_f32 v26, v26, v89
    v_add_f32 v27, v27, v93
    v_add_f32 v28, v28, v90
    v_add_f32 v29, v29, v94
    v_add_f32 v30, v30, v91
    v_add_f32 v31, v31, v95
L_p2_kernel_q_25:
    s_bitcmp1_b32 s20, 23
    s_cbranch_scc0 L_p2_kernel_q_26
    s_lshl_b32 s15, s26, 1
    s_add_u32 s15, s15, 283927040
    buffer_load_dwordx4 v[88:91], v32, s[4:7], s15 offen sc1
    buffer_load_dwordx4 v[92:95], v32, s[4:7], s15 offen offset:16 sc1
    s_waitcnt vmcnt(0)
    v_add_f32 v24, v24, v88
    v_add_f32 v25, v25, v92
    v_add_f32 v26, v26, v89
    v_add_f32 v27, v27, v93
    v_add_f32 v28, v28, v90
    v_add_f32 v29, v29, v94
    v_add_f32 v30, v30, v91
    v_add_f32 v31, v31, v95
L_p2_kernel_q_26:
L_p2_kernel_nof32b_22:
    v_pk_mul_f32 v[88:89], v[24:25], s[84:85] op_sel:[0,0] op_sel_hi:[1,0]
    v_pk_mul_f32 v[90:91], v[24:25], s[84:85] op_sel:[0,1] op_sel_hi:[1,1]
    v_pk_mul_f32 v[92:93], v[24:25], s[86:87] op_sel:[0,0] op_sel_hi:[1,0]
    v_pk_mul_f32 v[94:95], v[24:25], s[86:87] op_sel:[0,1] op_sel_hi:[1,1]
    v_pk_fma_f32 v[88:89], v[26:27], s[88:89], v[88:89] op_sel:[0,0,0] op_sel_hi:[1,0,1]
    v_pk_fma_f32 v[90:91], v[26:27], s[88:89], v[90:91] op_sel:[0,1,0] op_sel_hi:[1,1,1]
    v_pk_fma_f32 v[92:93], v[26:27], s[90:91], v[92:93] op_sel:[0,0,0] op_sel_hi:[1,0,1]
    v_pk_fma_f32 v[94:95], v[26:27], s[90:91], v[94:95] op_sel:[0,1,0] op_sel_hi:[1,1,1]
    v_pk_fma_f32 v[88:89], v[28:29], s[92:93], v[88:89] op_sel:[0,0,0] op_sel_hi:[1,0,1]
    v_pk_fma_f32 v[90:91], v[28:29], s[92:93], v[90:91] op_sel:[0,1,0] op_sel_hi:[1,1,1]
    v_pk_fma_f32 v[92:93], v[28:29], s[94:95], v[92:93] op_sel:[0,0,0] op_sel_hi:[1,0,1]
    v_pk_fma_f32 v[94:95], v[28:29], s[94:95], v[94:95] op_sel:[0,1,0] op_sel_hi:[1,1,1]
    v_pk_fma_f32 v[88:89], v[30:31], s[96:97], v[88:89] op_sel:[0,0,0] op_sel_hi:[1,0,1]
    v_pk_fma_f32 v[90:91], v[30:31], s[96:97], v[90:91] op_sel:[0,1,0] op_sel_hi:[1,1,1]
    v_pk_fma_f32 v[92:93], v[30:31], s[98:99], v[92:93] op_sel:[0,0,0] op_sel_hi:[1,0,1]
    v_pk_fma_f32 v[94:95], v[30:31], s[98:99], v[94:95] op_sel:[0,1,0] op_sel_hi:[1,1,1]
    v_pk_mul_f32 v[88:89], v[88:89], v[112:113]
    v_pk_mul_f32 v[90:91], v[90:91], v[114:115]
    v_pk_mul_f32 v[92:93], v[92:93], v[116:117]
    v_pk_mul_f32 v[94:95], v[94:95], v[118:119]
    v_pk_mul_f32 v[24:25], v[88:89], s[28:29] op_sel:[0,0] op_sel_hi:[1,0]
    v_pk_mul_f32 v[26:27], v[88:89], s[28:29] op_sel:[0,1] op_sel_hi:[1,1]
    v_pk_mul_f32 v[28:29], v[88:89], s[30:31] op_sel:[0,0] op_sel_hi:[1,0]
    v_pk_mul_f32 v[30:31], v[88:89], s[30:31] op_sel:[0,1] op_sel_hi:[1,1]
    v_pk_fma_f32 v[24:25], v[90:91], s[32:33], v[24:25] op_sel:[0,0,0] op_sel_hi:[1,0,1]
    v_pk_fma_f32 v[26:27], v[90:91], s[32:33], v[26:27] op_sel:[0,1,0] op_sel_hi:[1,1,1]
    v_pk_fma_f32 v[28:29], v[90:91], s[34:35], v[28:29] op_sel:[0,0,0] op_sel_hi:[1,0,1]
    v_pk_fma_f32 v[30:31], v[90:91], s[34:35], v[30:31] op_sel:[0,1,0] op_sel_hi:[1,1,1]
    v_pk_fma_f32 v[24:25], v[92:93], s[36:37], v[24:25] op_sel:[0,0,0] op_sel_hi:[1,0,1]
    v_pk_fma_f32 v[26:27], v[92:93], s[36:37], v[26:27] op_sel:[0,1,0] op_sel_hi:[1,1,1]
    v_pk_fma_f32 v[28:29], v[92:93], s[38:39], v[28:29] op_sel:[0,0,0] op_sel_hi:[1,0,1]
    v_pk_fma_f32 v[30:31], v[92:93], s[38:39], v[30:31] op_sel:[0,1,0] op_sel_hi:[1,1,1]
    v_pk_fma_f32 v[24:25], v[94:95], s[40:41], v[24:25] op_sel:[0,0,0] op_sel_hi:[1,0,1]
    v_pk_fma_f32 v[26:27], v[94:95], s[40:41], v[26:27] op_sel:[0,1,0] op_sel_hi:[1,1,1]
    v_pk_fma_f32 v[28:29], v[94:95], s[42:43], v[28:29] op_sel:[0,0,0] op_sel_hi:[1,0,1]
    v_pk_fma_f32 v[30:31], v[94:95], s[42:43], v[30:31] op_sel:[0,1,0] op_sel_hi:[1,1,1]
    v_lshlrev_b32 v88, 16, v68
    v_and_b32 v90, 0xffff0000, v68
    v_lshlrev_b32 v92, 16, v69
    v_and_b32 v94, 0xffff0000, v69
    v_lshlrev_b32 v89, 16, v70
    v_and_b32 v91, 0xffff0000, v70
    v_lshlrev_b32 v93, 16, v71
    v_and_b32 v95, 0xffff0000, v71
    v_pk_fma_f32 v[88:89], v[24:25], v[120:121], v[88:89]
    v_pk_fma_f32 v[90:91], v[26:27], v[122:123], v[90:91]
    v_pk_fma_f32 v[92:93], v[28:29], v[124:125], v[92:93]
    v_pk_fma_f32 v[94:95], v[30:31], v[126:127], v[94:95]
    v_cvt_pk_bf16_f32 v96, v88, v90
    v_cvt_pk_bf16_f32 v97, v92, v94
    v_cvt_pk_bf16_f32 v98, v89, v91
    v_cvt_pk_bf16_f32 v99, v93, v95
    buffer_store_dwordx4 v[96:99], v2, s[16:19], s26 offen
L_p2_f1:
    s_bitset0_b32 s51, s49
    s_cmp_eq_u32 s51, 0
    s_cbranch_scc1 L_p2_done
    s_ff1_i32_b32 s49, s51
    s_lshl2_add_u32 s14, s3, s49
    s_mul_i32 s14, s14, 5000
    s_add_u32 s15, s14, 4096
    v_min_u32 v61, 225, v0
    v_lshl_add_u32 v60, v0, 2, s14
    v_lshl_add_u32 v61, v61, 2, s15
    global_load_dword v60, v60, s[100:101] nt
    global_load_dword v61, v61, s[100:101] nt
    s_waitcnt vmcnt(0)
    v_lshlrev_b32 v30, 16, v60
    v_and_b32 v31, 0xffff0000, v60
    v_lshlrev_b32 v36, 16, v53
    v_and_b32 v37, 0xffff0000, v53
    v_lshlrev_b32 v38, 16, v54
    v_and_b32 v39, 0xffff0000, v54
    v_lshlrev_b32 v40, 16, v56
    v_and_b32 v41, 0xffff0000, v56
    v_lshlrev_b32 v42, 16, v57
    v_and_b32 v43, 0xffff0000, v57
    v_pk_add_f32 v[14:15], v[30:31], v[36:37] op_sel:[0,0] op_sel_hi:[1,0] neg_lo:[0,1] neg_hi:[0,1]
    v_pk_add_f32 v[16:17], v[30:31], v[36:37] op_sel:[0,1] op_sel_hi:[1,1] neg_lo:[0,1] neg_hi:[0,1]
    v_pk_add_f32 v[18:19], v[30:31], v[38:39] op_sel:[0,0] op_sel_hi:[1,0] neg_lo:[0,1] neg_hi:[0,1]
    v_pk_add_f32 v[20:21], v[30:31], v[38:39] op_sel:[0,1] op_sel_hi:[1,1] neg_lo:[0,1] neg_hi:[0,1]
    v_pk_add_f32 v[22:23], v[30:31], v[40:41] op_sel:[0,0] op_sel_hi:[1,0] neg_lo:[0,1] neg_hi:[0,1]
    v_pk_add_f32 v[24:25], v[30:31], v[40:41] op_sel:[0,1] op_sel_hi:[1,1] neg_lo:[0,1] neg_hi:[0,1]
    v_pk_add_f32 v[26:27], v[30:31], v[42:43] op_sel:[0,0] op_sel_hi:[1,0] neg_lo:[0,1] neg_hi:[0,1]
    v_pk_add_f32 v[28:29], v[30:31], v[42:43] op_sel:[0,1] op_sel_hi:[1,1] neg_lo:[0,1] neg_hi:[0,1]
    v_cvt_pk_bf16_f32 v32, v14, v15
    v_lshlrev_b32 v14, 16, v32
    v_and_b32 v15, 0xffff0000, v32
    v_cvt_pk_bf16_f32 v32, v16, v17
    v_lshlrev_b32 v16, 16, v32
    v_and_b32 v17, 0xffff0000, v32
    v_cvt_pk_bf16_f32 v32, v18, v19
    v_lshlrev_b32 v18, 16, v32
    v_and_b32 v19, 0xffff0000, v32
    v_cvt_pk_bf16_f32 v32, v20, v21
    v_lshlrev_b32 v20, 16, v32
    v_and_b32 v21, 0xffff0000, v32
    v_cvt_pk_bf16_f32 v32, v22, v23
    v_lshlrev_b32 v22, 16, v32
    v_and_b32 v23, 0xffff0000, v32
    v_cvt_pk_bf16_f32 v32, v24, v25
    v_lshlrev_b32 v24, 16, v32
    v_and_b32 v25, 0xffff0000, v32
    v_cvt_pk_bf16_f32 v32, v26, v27
    v_lshlrev_b32 v26, 16, v32
    v_and_b32 v27, 0xffff0000, v32
    v_cvt_pk_bf16_f32 v32, v28, v29
    v_lshlrev_b32 v28, 16, v32
    v_and_b32 v29, 0xffff0000, v32
    v_pk_mul_f32 v[14:15], v[14:15], v[14:15]
    v_pk_mul_f32 v[16:17], v[16:17], v[16:17]
    v_pk_mul_f32 v[18:19], v[18:19], v[18:19]
    v_pk_mul_f32 v[20:21], v[20:21], v[20:21]
    v_pk_mul_f32 v[22:23], v[22:23], v[22:23]
    v_pk_mul_f32 v[24:25], v[24:25], v[24:25]
    v_pk_mul_f32 v[26:27], v[26:27], v[26:27]
    v_pk_mul_f32 v[28:29], v[28:29], v[28:29]
    v_cvt_pk_bf16_f32 v32, v14, v15
    v_lshlrev_b32 v14, 16, v32
    v_and_b32 v15, 0xffff0000, v32
    v_cvt_pk_bf16_f32 v32, v16, v17
    v_lshlrev_b32 v16, 16, v32
    v_and_b32 v17, 0xffff0000, v32
    v_cvt_pk_bf16_f32 v32, v18, v19
    v_lshlrev_b32 v18, 16, v32
    v_and_b32 v19, 0xffff0000, v32
    v_cvt_pk_bf16_f32 v32, v20, v21
    v_lshlrev_b32 v20, 16, v32
    v_and_b32 v21, 0xffff0000, v32
    v_cvt_pk_bf16_f32 v32, v22, v23
    v_lshlrev_b32 v22, 16, v32
    v_and_b32 v23, 0xffff0000, v32
    v_cvt_pk_bf16_f32 v32, v24, v25
    v_lshlrev_b32 v24, 16, v32
    v_and_b32 v25, 0xffff0000, v32
    v_cvt_pk_bf16_f32 v32, v26, v27
    v_lshlrev_b32 v26, 16, v32
    v_and_b32 v27, 0xffff0000, v32
    v_cvt_pk_bf16_f32 v32, v28, v29
    v_lshlrev_b32 v28, 16, v32
    v_and_b32 v29, 0xffff0000, v32
    v_mov_b32 v30, 1092616192
    v_mov_b32 v31, 0x3fb8aa3b
    v_pk_mul_f32 v[14:15], v[14:15], v[30:31] op_sel:[0,0] op_sel_hi:[1,0]
    v_pk_mul_f32 v[16:17], v[16:17], v[30:31] op_sel:[0,0] op_sel_hi:[1,0]
    v_pk_mul_f32 v[18:19], v[18:19], v[30:31] op_sel:[0,0] op_sel_hi:[1,0]
    v_pk_mul_f32 v[20:21], v[20:21], v[30:31] op_sel:[0,0] op_sel_hi:[1,0]
    v_pk_mul_f32 v[22:23], v[22:23], v[30:31] op_sel:[0,0] op_sel_hi:[1,0]
    v_pk_mul_f32 v[24:25], v[24:25], v[30:31] op_sel:[0,0] op_sel_hi:[1,0]
    v_pk_mul_f32 v[26:27], v[26:27], v[30:31] op_sel:[0,0] op_sel_hi:[1,0]
    v_pk_mul_f32 v[28:29], v[28:29], v[30:31] op_sel:[0,0] op_sel_hi:[1,0]
    v_cvt_pk_bf16_f32 v32, v14, v15
    v_lshlrev_b32 v14, 16, v32
    v_and_b32 v15, 0xffff0000, v32
    v_cvt_pk_bf16_f32 v32, v16, v17
    v_lshlrev_b32 v16, 16, v32
    v_and_b32 v17, 0xffff0000, v32
    v_cvt_pk_bf16_f32 v32, v18, v19
    v_lshlrev_b32 v18, 16, v32
    v_and_b32 v19, 0xffff0000, v32
    v_cvt_pk_bf16_f32 v32, v20, v21
    v_lshlrev_b32 v20, 16, v32
    v_and_b32 v21, 0xffff0000, v32
    v_cvt_pk_bf16_f32 v32, v22, v23
    v_lshlrev_b32 v22, 16, v32
    v_and_b32 v23, 0xffff0000, v32
    v_cvt_pk_bf16_f32 v32, v24, v25
    v_lshlrev_b32 v24, 16, v32
    v_and_b32 v25, 0xffff0000, v32
    v_cvt_pk_bf16_f32 v32, v26, v27
    v_lshlrev_b32 v26, 16, v32
    v_and_b32 v27, 0xffff0000, v32
    v_cvt_pk_bf16_f32 v32, v28, v29
    v_lshlrev_b32 v28, 16, v32
    v_and_b32 v29, 0xffff0000, v32
    v_pk_mul_f32 v[14:15], v[14:15], v[30:31] op_sel:[0,1] op_sel_hi:[1,1]
    v_pk_mul_f32 v[16:17], v[16:17], v[30:31] op_sel:[0,1] op_sel_hi:[1,1]
    v_pk_mul_f32 v[18:19], v[18:19], v[30:31] op_sel:[0,1] op_sel_hi:[1,1]
    v_pk_mul_f32 v[20:21], v[20:21], v[30:31] op_sel:[0,1] op_sel_hi:[1,1]
    v_pk_mul_f32 v[22:23], v[22:23], v[30:31] op_sel:[0,1] op_sel_hi:[1,1]
    v_pk_mul_f32 v[24:25], v[24:25], v[30:31] op_sel:[0,1] op_sel_hi:[1,1]
    v_pk_mul_f32 v[26:27], v[26:27], v[30:31] op_sel:[0,1] op_sel_hi:[1,1]
    v_pk_mul_f32 v[28:29], v[28:29], v[30:31] op_sel:[0,1] op_sel_hi:[1,1]
    v_exp_f32 v14, -v14
    v_exp_f32 v15, -v15
    v_exp_f32 v16, -v16
    v_exp_f32 v17, -v17
    v_exp_f32 v18, -v18
    v_exp_f32 v19, -v19
    v_exp_f32 v20, -v20
    v_exp_f32 v21, -v21
    v_exp_f32 v22, -v22
    v_exp_f32 v23, -v23
    v_exp_f32 v24, -v24
    v_exp_f32 v25, -v25
    v_exp_f32 v26, -v26
    v_exp_f32 v27, -v27
    v_exp_f32 v28, -v28
    v_exp_f32 v29, -v29
    v_cvt_pk_bf16_f32 v14, v14, v16
    v_cvt_pk_bf16_f32 v15, v15, v17
    v_cvt_pk_bf16_f32 v18, v18, v20
    v_cvt_pk_bf16_f32 v19, v19, v21
    v_cvt_pk_bf16_f32 v22, v22, v24
    v_cvt_pk_bf16_f32 v23, v23, v25
    v_cvt_pk_bf16_f32 v26, v26, v28
    v_cvt_pk_bf16_f32 v27, v27, v29
    v_dot2_f32_bf16 v72, v14, s68, 0
    v_dot2_f32_bf16 v73, v15, s68, 0
    v_dot2_f32_bf16 v74, v14, s69, 0
    v_dot2_f32_bf16 v75, v15, s69, 0
    v_dot2_f32_bf16 v76, v14, s70, 0
    v_dot2_f32_bf16 v77, v15, s70, 0
    v_dot2_f32_bf16 v78, v14, s71, 0
    v_dot2_f32_bf16 v79, v15, s71, 0
    v_dot2_f32_bf16 v80, v14, s52, 0
    v_dot2_f32_bf16 v81, v15, s52, 0
    v_dot2_f32_bf16 v82, v14, s53, 0
    v_dot2_f32_bf16 v83, v15, s53, 0
    v_dot2_f32_bf16 v84, v14, s54, 0
    v_dot2_f32_bf16 v85, v15, s54, 0
    v_dot2_f32_bf16 v86, v14, s55, 0
    v_dot2_f32_bf16 v87, v15, s55, 0
    v_dot2_f32_bf16 v72, v18, s72, v72
    v_dot2_f32_bf16 v73, v19, s72, v73
    v_dot2_f32_bf16 v74, v18, s73, v74
    v_dot2_f32_bf16 v75, v19, s73, v75
    v_dot2_f32_bf16 v76, v18, s74, v76
    v_dot2_f32_bf16 v77, v19, s74, v77
    v_dot2_f32_bf16 v78, v18, s75, v78
    v_dot2_f32_bf16 v79, v19, s75, v79
    v_dot2_f32_bf16 v80, v18, s56, v80
    v_dot2_f32_bf16 v81, v19, s56, v81
    v_dot2_f32_bf16 v82, v18, s57, v82
    v_dot2_f32_bf16 v83, v19, s57, v83
    v_dot2_f32_bf16 v84, v18, s58, v84
    v_dot2_f32_bf16 v85, v19, s58, v85
    v_dot2_f32_bf16 v86, v18, s59, v86
    v_dot2_f32_bf16 v87, v19, s59, v87
    v_dot2_f32_bf16 v72, v22, s76, v72
    v_dot2_f32_bf16 v73, v23, s76, v73
    v_dot2_f32_bf16 v74, v22, s77, v74
    v_dot2_f32_bf16 v75, v23, s77, v75
    v_dot2_f32_bf16 v76, v22, s78, v76
    v_dot2_f32_bf16 v77, v23, s78, v77
    v_dot2_f32_bf16 v78, v22, s79, v78
    v_dot2_f32_bf16 v79, v23, s79, v79
    v_dot2_f32_bf16 v80, v22, s60, v80
    v_dot2_f32_bf16 v81, v23, s60, v81
    v_dot2_f32_bf16 v82, v22, s61, v82
    v_dot2_f32_bf16 v83, v23, s61, v83
    v_dot2_f32_bf16 v84, v22, s62, v84
    v_dot2_f32_bf16 v85, v23, s62, v85
    v_dot2_f32_bf16 v86, v22, s63, v86
    v_dot2_f32_bf16 v87, v23, s63, v87
    v_dot2_f32_bf16 v72, v26, s80, v72
    v_dot2_f32_bf16 v73, v27, s80, v73
    v_dot2_f32_bf16 v74, v26, s81, v74
    v_dot2_f32_bf16 v75, v27, s81, v75
    v_dot2_f32_bf16 v76, v26, s82, v76
    v_dot2_f32_bf16 v77, v27, s82, v77
    v_dot2_f32_bf16 v78, v26, s83, v78
    v_dot2_f32_bf16 v79, v27, s83, v79
    v_dot2_f32_bf16 v80, v26, s64, v80
    v_dot2_f32_bf16 v81, v27, s64, v81
    v_dot2_f32_bf16 v82, v26, s65, v82
    v_dot2_f32_bf16 v83, v27, s65, v83
    v_dot2_f32_bf16 v84, v26, s66, v84
    v_dot2_f32_bf16 v85, v27, s66, v85
    v_dot2_f32_bf16 v86, v26, s67, v86
    v_dot2_f32_bf16 v87, v27, s67, v87
    s_cmp_ge_u32 s13, 4
    s_cbranch_scc1 L_p2_kernel_g1_27
    v_lshlrev_b32 v30, 16, v61
    v_and_b32 v31, 0xffff0000, v61
    v_pk_add_f32 v[14:15], v[30:31], v[36:37] op_sel:[0,0] op_sel_hi:[1,0] neg_lo:[0,1] neg_hi:[0,1]
    v_pk_add_f32 v[16:17], v[30:31], v[36:37] op_sel:[0,1] op_sel_hi:[1,1] neg_lo:[0,1] neg_hi:[0,1]
    v_pk_add_f32 v[18:19], v[30:31], v[38:39] op_sel:[0,0] op_sel_hi:[1,0] neg_lo:[0,1] neg_hi:[0,1]
    v_pk_add_f32 v[20:21], v[30:31], v[38:39] op_sel:[0,1] op_sel_hi:[1,1] neg_lo:[0,1] neg_hi:[0,1]
    v_pk_add_f32 v[22:23], v[30:31], v[40:41] op_sel:[0,0] op_sel_hi:[1,0] neg_lo:[0,1] neg_hi:[0,1]
    v_pk_add_f32 v[24:25], v[30:31], v[40:41] op_sel:[0,1] op_sel_hi:[1,1] neg_lo:[0,1] neg_hi:[0,1]
    v_pk_add_f32 v[26:27], v[30:31], v[42:43] op_sel:[0,0] op_sel_hi:[1,0] neg_lo:[0,1] neg_hi:[0,1]
    v_pk_add_f32 v[28:29], v[30:31], v[42:43] op_sel:[0,1] op_sel_hi:[1,1] neg_lo:[0,1] neg_hi:[0,1]
    v_cvt_pk_bf16_f32 v32, v14, v15
    v_lshlrev_b32 v14, 16, v32
    v_and_b32 v15, 0xffff0000, v32
    v_cvt_pk_bf16_f32 v32, v16, v17
    v_lshlrev_b32 v16, 16, v32
    v_and_b32 v17, 0xffff0000, v32
    v_cvt_pk_bf16_f32 v32, v18, v19
    v_lshlrev_b32 v18, 16, v32
    v_and_b32 v19, 0xffff0000, v32
    v_cvt_pk_bf16_f32 v32, v20, v21
    v_lshlrev_b32 v20, 16, v32
    v_and_b32 v21, 0xffff0000, v32
    v_cvt_pk_bf16_f32 v32, v22, v23
    v_lshlrev_b32 v22, 16, v32
    v_and_b32 v23, 0xffff0000, v32
    v_cvt_pk_bf16_f32 v32, v24, v25
    v_lshlrev_b32 v24, 16, v32
    v_and_b32 v25, 0xffff0000, v32
    v_cvt_pk_bf16_f32 v32, v26, v27
    v_lshlrev_b32 v26, 16, v32
    v_and_b32 v27, 0xffff0000, v32
    v_cvt_pk_bf16_f32 v32, v28, v29
    v_lshlrev_b32 v28, 16, v32
    v_and_b32 v29, 0xffff0000, v32
    v_pk_mul_f32 v[14:15], v[14:15], v[14:15]
    v_pk_mul_f32 v[16:17], v[16:17], v[16:17]
    v_pk_mul_f32 v[18:19], v[18:19], v[18:19]
    v_pk_mul_f32 v[20:21], v[20:21], v[20:21]
    v_pk_mul_f32 v[22:23], v[22:23], v[22:23]
    v_pk_mul_f32 v[24:25], v[24:25], v[24:25]
    v_pk_mul_f32 v[26:27], v[26:27], v[26:27]
    v_pk_mul_f32 v[28:29], v[28:29], v[28:29]
    v_cvt_pk_bf16_f32 v32, v14, v15
    v_lshlrev_b32 v14, 16, v32
    v_and_b32 v15, 0xffff0000, v32
    v_cvt_pk_bf16_f32 v32, v16, v17
    v_lshlrev_b32 v16, 16, v32
    v_and_b32 v17, 0xffff0000, v32
    v_cvt_pk_bf16_f32 v32, v18, v19
    v_lshlrev_b32 v18, 16, v32
    v_and_b32 v19, 0xffff0000, v32
    v_cvt_pk_bf16_f32 v32, v20, v21
    v_lshlrev_b32 v20, 16, v32
    v_and_b32 v21, 0xffff0000, v32
    v_cvt_pk_bf16_f32 v32, v22, v23
    v_lshlrev_b32 v22, 16, v32
    v_and_b32 v23, 0xffff0000, v32
    v_cvt_pk_bf16_f32 v32, v24, v25
    v_lshlrev_b32 v24, 16, v32
    v_and_b32 v25, 0xffff0000, v32
    v_cvt_pk_bf16_f32 v32, v26, v27
    v_lshlrev_b32 v26, 16, v32
    v_and_b32 v27, 0xffff0000, v32
    v_cvt_pk_bf16_f32 v32, v28, v29
    v_lshlrev_b32 v28, 16, v32
    v_and_b32 v29, 0xffff0000, v32
    v_mov_b32 v30, 1092616192
    v_mov_b32 v31, 0x3fb8aa3b
    v_pk_mul_f32 v[14:15], v[14:15], v[30:31] op_sel:[0,0] op_sel_hi:[1,0]
    v_pk_mul_f32 v[16:17], v[16:17], v[30:31] op_sel:[0,0] op_sel_hi:[1,0]
    v_pk_mul_f32 v[18:19], v[18:19], v[30:31] op_sel:[0,0] op_sel_hi:[1,0]
    v_pk_mul_f32 v[20:21], v[20:21], v[30:31] op_sel:[0,0] op_sel_hi:[1,0]
    v_pk_mul_f32 v[22:23], v[22:23], v[30:31] op_sel:[0,0] op_sel_hi:[1,0]
    v_pk_mul_f32 v[24:25], v[24:25], v[30:31] op_sel:[0,0] op_sel_hi:[1,0]
    v_pk_mul_f32 v[26:27], v[26:27], v[30:31] op_sel:[0,0] op_sel_hi:[1,0]
    v_pk_mul_f32 v[28:29], v[28:29], v[30:31] op_sel:[0,0] op_sel_hi:[1,0]
    v_cvt_pk_bf16_f32 v32, v14, v15
    v_lshlrev_b32 v14, 16, v32
    v_and_b32 v15, 0xffff0000, v32
    v_cvt_pk_bf16_f32 v32, v16, v17
    v_lshlrev_b32 v16, 16, v32
    v_and_b32 v17, 0xffff0000, v32
    v_cvt_pk_bf16_f32 v32, v18, v19
    v_lshlrev_b32 v18, 16, v32
    v_and_b32 v19, 0xffff0000, v32
    v_cvt_pk_bf16_f32 v32, v20, v21
    v_lshlrev_b32 v20, 16, v32
    v_and_b32 v21, 0xffff0000, v32
    v_cvt_pk_bf16_f32 v32, v22, v23
    v_lshlrev_b32 v22, 16, v32
    v_and_b32 v23, 0xffff0000, v32
    v_cvt_pk_bf16_f32 v32, v24, v25
    v_lshlrev_b32 v24, 16, v32
    v_and_b32 v25, 0xffff0000, v32
    v_cvt_pk_bf16_f32 v32, v26, v27
    v_lshlrev_b32 v26, 16, v32
    v_and_b32 v27, 0xffff0000, v32
    v_cvt_pk_bf16_f32 v32, v28, v29
    v_lshlrev_b32 v28, 16, v32
    v_and_b32 v29, 0xffff0000, v32
    v_pk_mul_f32 v[14:15], v[14:15], v[30:31] op_sel:[0,1] op_sel_hi:[1,1]
    v_pk_mul_f32 v[16:17], v[16:17], v[30:31] op_sel:[0,1] op_sel_hi:[1,1]
    v_pk_mul_f32 v[18:19], v[18:19], v[30:31] op_sel:[0,1] op_sel_hi:[1,1]
    v_pk_mul_f32 v[20:21], v[20:21], v[30:31] op_sel:[0,1] op_sel_hi:[1,1]
    v_pk_mul_f32 v[22:23], v[22:23], v[30:31] op_sel:[0,1] op_sel_hi:[1,1]
    v_pk_mul_f32 v[24:25], v[24:25], v[30:31] op_sel:[0,1] op_sel_hi:[1,1]
    v_pk_mul_f32 v[26:27], v[26:27], v[30:31] op_sel:[0,1] op_sel_hi:[1,1]
    v_pk_mul_f32 v[28:29], v[28:29], v[30:31] op_sel:[0,1] op_sel_hi:[1,1]
    v_exp_f32 v14, -v14
    v_exp_f32 v15, -v15
    v_exp_f32 v16, -v16
    v_exp_f32 v17, -v17
    v_exp_f32 v18, -v18
    v_exp_f32 v19, -v19
    v_exp_f32 v20, -v20
    v_exp_f32 v21, -v21
    v_exp_f32 v22, -v22
    v_exp_f32 v23, -v23
    v_exp_f32 v24, -v24
    v_exp_f32 v25, -v25
    v_exp_f32 v26, -v26
    v_exp_f32 v27, -v27
    v_exp_f32 v28, -v28
    v_exp_f32 v29, -v29
    v_cvt_pk_bf16_f32 v14, v14, v16
    v_cvt_pk_bf16_f32 v15, v15, v17
    v_cvt_pk_bf16_f32 v18, v18, v20
    v_cvt_pk_bf16_f32 v19, v19, v21
    v_cvt_pk_bf16_f32 v22, v22, v24
    v_cvt_pk_bf16_f32 v23, v23, v25
    v_cvt_pk_bf16_f32 v26, v26, v28
    v_cvt_pk_bf16_f32 v27, v27, v29
    v_dot2_f32_bf16 v112, v14, s68, 0
    v_dot2_f32_bf16 v113, v15, s68, 0
    v_dot2_f32_bf16 v114, v14, s69, 0
    v_dot2_f32_bf16 v115, v15, s69, 0
    v_dot2_f32_bf16 v116, v14, s70, 0
    v_dot2_f32_bf16 v117, v15, s70, 0
    v_dot2_f32_bf16 v118, v14, s71, 0
    v_dot2_f32_bf16 v119, v15, s71, 0
    v_dot2_f32_bf16 v120, v14, s52, 0
    v_dot2_f32_bf16 v121, v15, s52, 0
    v_dot2_f32_bf16 v122, v14, s53, 0
    v_dot2_f32_bf16 v123, v15, s53, 0
    v_dot2_f32_bf16 v124, v14, s54, 0
    v_dot2_f32_bf16 v125, v15, s54, 0
    v_dot2_f32_bf16 v126, v14, s55, 0
    v_dot2_f32_bf16 v127, v15, s55, 0
    v_dot2_f32_bf16 v112, v18, s72, v112
    v_dot2_f32_bf16 v113, v19, s72, v113
    v_dot2_f32_bf16 v114, v18, s73, v114
    v_dot2_f32_bf16 v115, v19, s73, v115
    v_dot2_f32_bf16 v116, v18, s74, v116
    v_dot2_f32_bf16 v117, v19, s74, v117
    v_dot2_f32_bf16 v118, v18, s75, v118
    v_dot2_f32_bf16 v119, v19, s75, v119
    v_dot2_f32_bf16 v120, v18, s56, v120
    v_dot2_f32_bf16 v121, v19, s56, v121
    v_dot2_f32_bf16 v122, v18, s57, v122
    v_dot2_f32_bf16 v123, v19, s57, v123
    v_dot2_f32_bf16 v124, v18, s58, v124
    v_dot2_f32_bf16 v125, v19, s58, v125
    v_dot2_f32_bf16 v126, v18, s59, v126
    v_dot2_f32_bf16 v127, v19, s59, v127
    v_dot2_f32_bf16 v112, v22, s76, v112
    v_dot2_f32_bf16 v113, v23, s76, v113
    v_dot2_f32_bf16 v114, v22, s77, v114
    v_dot2_f32_bf16 v115, v23, s77, v115
    v_dot2_f32_bf16 v116, v22, s78, v116
    v_dot2_f32_bf16 v117, v23, s78, v117
    v_dot2_f32_bf16 v118, v22, s79, v118
    v_dot2_f32_bf16 v119, v23, s79, v119
    v_dot2_f32_bf16 v120, v22, s60, v120
    v_dot2_f32_bf16 v121, v23, s60, v121
    v_dot2_f32_bf16 v122, v22, s61, v122
    v_dot2_f32_bf16 v123, v23, s61, v123
    v_dot2_f32_bf16 v124, v22, s62, v124
    v_dot2_f32_bf16 v125, v23, s62, v125
    v_dot2_f32_bf16 v126, v22, s63, v126
    v_dot2_f32_bf16 v127, v23, s63, v127
    v_dot2_f32_bf16 v112, v26, s80, v112
    v_dot2_f32_bf16 v113, v27, s80, v113
    v_dot2_f32_bf16 v114, v26, s81, v114
    v_dot2_f32_bf16 v115, v27, s81, v115
    v_dot2_f32_bf16 v116, v26, s82, v116
    v_dot2_f32_bf16 v117, v27, s82, v117
    v_dot2_f32_bf16 v118, v26, s83, v118
    v_dot2_f32_bf16 v119, v27, s83, v119
    v_dot2_f32_bf16 v120, v26, s64, v120
    v_dot2_f32_bf16 v121, v27, s64, v121
    v_dot2_f32_bf16 v122, v26, s65, v122
    v_dot2_f32_bf16 v123, v27, s65, v123
    v_dot2_f32_bf16 v124, v26, s66, v124
    v_dot2_f32_bf16 v125, v27, s66, v125
    v_dot2_f32_bf16 v126, v26, s67, v126
    v_dot2_f32_bf16 v127, v27, s67, v127
L_p2_kernel_g1_27:
    s_lshl2_add_u32 s14, s3, s49
    s_mul_i32 s26, s14, 20000
    s_add_u32 s15, s26, 227607040
    buffer_load_dwordx4 v[64:67], v1, s[4:7], s15 offen
    buffer_load_dwordx4 v[68:71], v2, s[4:7], s15 offen
    s_branch L_p2_fin
L_p2_done:
    s_branch L_p2_end
L_p2_slow:
    s_barrier
    v_mov_b32 v8, 0
    v_mov_b32 v9, 0
    v_mov_b32 v10, 0
    v_mov_b32 v11, 0
    v_mov_b32 v12, v1
    ds_write_b128 v12, v[8:11]
    v_add_u32 v12, 16384, v12
    ds_write_b128 v12, v[8:11]
    v_add_u32 v12, 16384, v12
    ds_write_b128 v12, v[8:11]
    v_add_u32 v12, 16384, v12
    ds_write_b128 v12, v[8:11]
    v_add_u32 v12, 16384, v12
    ds_write_b128 v12, v[8:11]
    v_add_u32 v12, 16384, v12
    ds_write_b128 v12, v[8:11]
    v_add_u32 v12, 16384, v12
    ds_write_b128 v12, v[8:11]
    v_add_u32 v12, 16384, v12
    ds_write_b128 v12, v[8:11]
    v_add_u32 v12, 16384, v12
    ds_write_b128 v12, v[8:11]
    v_add_u32 v12, 16384, v12
    ds_write_b128 v12, v[8:11]
    v_add_u32 v12, 16384, v12
    v_lshlrev_b32 v13, 4, v0
    v_mov_b32 v29, 0x7fc00000
    v_add_u32 v28, 32896, v13
    v_mul_lo_u32 v14, v0, s23
    v_add_u32 v14, 8192, v14
    s_mul_i32 s25, s12, 65
    s_add_u32 s25, s25, s3
    s_mul_i32 s25, s25, 32896
    s_add_u32 s25, s25, 219029504
    s_lshl_b32 s50, s50, 1
    s_mul_i32 s22, s12, 1280000
    s_mov_b32 s24, 0
    s_waitcnt lgkmcnt(0)
    s_barrier
L_p2_sstep:
    buffer_load_ushort v15, v13, s[4:7], s25 offen
    buffer_load_ushort v16, v28, s[4:7], s25 offen
    s_waitcnt vmcnt(0)
L_p2_srec:
    v_cmp_lt_u32 vcc, v15, v16
    s_nop 1
    s_and_b64 exec, exec, vcc
    s_cbranch_execz L_p2_sdone
    v_mul_u32_u24 v17, 43691, v15
    v_lshrrev_b32 v17, 17, v17
    v_mad_i32_i24 v18, v17, -3, v15
    v_lshl_add_u32 v17, v17, 4, v14
    v_lshl_add_u32 v19, v18, 2, v17
    buffer_load_dword v20, v19, s[4:7], 0 offen
    buffer_load_dword v21, v17, s[4:7], 0 offen offset:12
    v_add_u32 v15, 1, v15
    v_mad_u32_u24 v18, v18, 10, 2
    s_waitcnt vmcnt(0)
    v_lshlrev_b32_sdwa v19, 3, v20 dst_sel:DWORD dst_unused:UNUSED_PAD src0_sel:DWORD src1_sel:WORD_0
    buffer_load_dwordx2 v[22:23], v19, s[8:11], s22 offen
    v_mad_u32_u16 v20, v20, 16, s50 op_sel:[1,0,0,0]
    v_bfe_i32 v21, v21, v18, 10
    v_cmp_eq_i32 vcc, -512, v21
    v_cvt_f32_i32 v21, v21
    v_mul_f32 v21, 989872160, v21
    v_cndmask_b32 v21, v21, v29, vcc
    s_waitcnt vmcnt(0)
    v_lshlrev_b32 v24, 16, v22
    v_and_b32 v25, 0xffff0000, v22
    v_lshlrev_b32 v26, 16, v23
    v_and_b32 v27, 0xffff0000, v23
    v_mul_f32 v24, v21, v24
    v_mul_f32 v25, v21, v25
    v_mul_f32 v26, v21, v26
    v_mul_f32 v27, v21, v27
    ds_add_f32 v20, v24
    ds_add_f32 v20, v25 offset:4
    ds_add_f32 v20, v26 offset:8
    ds_add_f32 v20, v27 offset:12
    s_branch L_p2_srec
L_p2_sdone:
    s_mov_b64 exec, -1
    s_cmp_eq_u32 s24, 7
    s_cselect_b32 s14, 16370, 2
    s_add_u32 s25, s25, s14
    s_add_u32 s22, s22, 80000
    s_add_u32 s24, s24, 1
    s_cmp_lt_u32 s24, 16
    s_cbranch_scc1 L_p2_sstep
    s_waitcnt lgkmcnt(0)
    s_barrier
    s_mul_i32 s14, s12, 10240000
    s_mul_i32 s15, s3, 160000
    s_add_u32 s26, s14, s15
    s_add_u32 s26, s26, 253207040
    v_mov_b32 v12, v1
    s_mov_b32 s24, 0
L_p2_sout:
    v_cmp_gt_u32 vcc, 160000, v12
    ds_read_b128 v[8:11], v12
    s_nop 0
    s_and_b64 exec, exec, vcc
    s_cbranch_execz L_p2_sfin
    s_waitcnt lgkmcnt(0)
    buffer_store_dwordx4 v[8:11], v12, s[4:7], s26 offen sc1
    s_waitcnt vmcnt(0)
    v_add_u32 v12, 16384, v12
    s_branch L_p2_sout
L_p2_sfin:
    s_mov_b64 exec, -1
    s_waitcnt vmcnt(0) lgkmcnt(0)
    s_barrier
    s_branch L_p2_signal
L_p2_end:
    s_endpgm
.section .rodata,"a"
.p2align 6
.amdhsa_kernel p1_kernel
  .amdhsa_next_free_vgpr 128
  .amdhsa_next_free_sgpr 96
  .amdhsa_accum_offset 128
  .amdhsa_group_segment_fixed_size 0
  .amdhsa_kernarg_size 112
  .amdhsa_user_sgpr_count 2
  .amdhsa_user_sgpr_kernarg_segment_ptr 1
  .amdhsa_system_sgpr_workgroup_id_x 1
  .amdhsa_float_denorm_mode_32 0
.end_amdhsa_kernel
.p2align 6
.amdhsa_kernel p2_kernel
  .amdhsa_next_free_vgpr 128
  .amdhsa_next_free_sgpr 102
  .amdhsa_accum_offset 128
  .amdhsa_group_segment_fixed_size 0
  .amdhsa_kernarg_size 112
  .amdhsa_user_sgpr_count 2
  .amdhsa_user_sgpr_kernarg_segment_ptr 1
  .amdhsa_system_sgpr_workgroup_id_x 1
  .amdhsa_float_denorm_mode_32 0
.end_amdhsa_kernel
```

```asm
; @launch kernel=p1_kernel grid=(256,1,1) block=(1024,1,1) lds=163840
; @launch kernel=p2_kernel grid=(256,1,1) block=(1024,1,1) lds=163840
.amdgcn_target "amdgcn-amd-amdhsa--gfx950"
.text
.globl p1_kernel
.p2align 8
.type p1_kernel,@function
p1_kernel:
    s_cmp_ge_u32 s2, 256
    s_cbranch_scc1 L_p1_end
    s_load_dwordx2 s[4:5], s[0:1], 104
    s_load_dwordx2 s[8:9], s[0:1], 8
    s_load_dwordx2 s[12:13], s[0:1], 16
    s_load_dwordx2 s[16:17], s[0:1], 32
    s_load_dwordx2 s[28:29], s[0:1], 0
    s_load_dwordx2 s[6:7], s[0:1], 48
    v_lshlrev_b32 v1, 4, v0
    v_lshlrev_b32 v2, 3, v0
    v_lshrrev_b32 v6, 6, v0
    v_mul_u32_u24 v3, 768, v6
    v_add_lshl_u32 v3, v3, v0, 4
    v_mov_b32 v4, 1
    v_mov_b32 v5, 0
    v_readfirstlane_b32 s39, v6
    v_cmp_gt_u32 vcc, 784, v0
    s_mov_b32 s32, s2
    s_lshl_b32 s33, s2, 14
    s_lshl_b32 s34, s2, 13
    s_mul_i32 s48, s2, 3840
    s_mul_i32 s49, s2, 1920
    s_mov_b64 s[44:45], vcc
    s_waitcnt lgkmcnt(0)
    s_load_dword s3, s[6:7], 0
    s_mov_b32 s10, 163840000
    s_mov_b32 s11, 0x00020000
    s_mov_b32 s14, 163840000
    s_mov_b32 s15, 0x00020000
    s_mov_b32 s18, 81920000
    s_mov_b32 s19, 0x00020000
    s_mul_i32 s36, s2, 20000
    s_add_u32 s30, s36, 20000
    s_mov_b32 s31, 0x00020000
    s_add_u32 s35, s36, 16384
    buffer_load_dwordx4 v[48:51], v1, s[28:31], s36 offen nt
    buffer_load_dwordx4 v[52:55], v1, s[28:31], s35 offen nt
    s_add_u32 s35, s33, 0
    buffer_load_dwordx4 v[16:19], v1, s[8:11], s35 offen nt
    s_add_u32 s35, s33, 0
    buffer_load_dwordx4 v[20:23], v1, s[12:15], s35 offen nt
    s_add_u32 s35, s33, 4194304
    buffer_load_dwordx4 v[24:27], v1, s[8:11], s35 offen nt
    s_add_u32 s35, s33, 4194304
    buffer_load_dwordx4 v[28:31], v1, s[12:15], s35 offen nt
    s_add_u32 s35, s33, 8388608
    buffer_load_dwordx4 v[32:35], v1, s[8:11], s35 offen nt
    s_add_u32 s35, s33, 8388608
    buffer_load_dwordx4 v[36:39], v1, s[12:15], s35 offen nt
    s_add_u32 s35, s33, 12582912
    buffer_load_dwordx4 v[40:43], v1, s[8:11], s35 offen nt
    s_add_u32 s35, s33, 12582912
    buffer_load_dwordx4 v[44:47], v1, s[12:15], s35 offen nt
    s_mov_b32 s20, s4
    s_mov_b32 s21, s5
    s_mov_b32 s22, 0
    s_mov_b32 s23, 0x00020000
    s_add_u32 s24, s4, 219029504
    s_addc_u32 s25, s5, 0
    s_mov_b32 s26, 8577536
    s_mov_b32 s27, 0x00020000
    s_mov_b32 s37, 1492179184
    s_mov_b32 s55, 0
    s_mov_b32 s50, 21845
    s_mov_b32 s38, 262400
    s_mov_b32 s43, 0x05040100
    s_mov_b32 s40, 0
    v_mov_b32 v8, 0
    v_mov_b32 v9, 0
    v_mov_b32 v10, 0
    v_mov_b32 v11, 0
    ds_write_b128 v1, v[8:11] offset:0
    s_waitcnt lgkmcnt(0)
    s_lshl_b32 s3, s3, 16
    v_mov_b32 v12, s3
    v_mul_f32 v12, 0.15915494, v12
    s_nop 0
    v_readfirstlane_b32 s41, v12
    s_waitcnt vmcnt(8)
    s_add_u32 s28, s4, 227607040
    s_addc_u32 s29, s5, 0
    s_mul_i32 s36, s2, 20000
    s_add_u32 s35, s36, 16384
    buffer_store_dwordx4 v[48:51], v1, s[28:31], s36 offen
    buffer_store_dwordx4 v[52:55], v1, s[28:31], s35 offen
    s_nop 0
    v_mov_b32 v12, 0x3f803f80
    v_and_b32 v48, 0x7fff7fff, v48
    v_and_b32 v49, 0x7fff7fff, v49
    v_and_b32 v50, 0x7fff7fff, v50
    v_and_b32 v51, 0x7fff7fff, v51
    v_and_b32 v52, 0x7fff7fff, v52
    v_and_b32 v53, 0x7fff7fff, v53
    v_and_b32 v54, 0x7fff7fff, v54
    v_and_b32 v55, 0x7fff7fff, v55
    v_pk_max_u16 v8, v8, v48
    v_dot2c_f32_bf16 v9, v48, v12
    v_pk_max_u16 v8, v8, v49
    v_dot2c_f32_bf16 v9, v49, v12
    v_pk_max_u16 v8, v8, v50
    v_dot2c_f32_bf16 v9, v50, v12
    v_pk_max_u16 v8, v8, v51
    v_dot2c_f32_bf16 v9, v51, v12
    v_pk_max_u16 v8, v8, v52
    v_dot2c_f32_bf16 v9, v52, v12
    v_pk_max_u16 v8, v8, v53
    v_dot2c_f32_bf16 v9, v53, v12
    v_pk_max_u16 v8, v8, v54
    v_dot2c_f32_bf16 v9, v54, v12
    v_pk_max_u16 v8, v8, v55
    v_dot2c_f32_bf16 v9, v55, v12
    v_lshrrev_b32 v10, 16, v8
    v_and_b32 v8, 0xffff, v8
    v_max_u32 v8, v8, v10
    s_nop 0
    s_nop 1
    v_max_u32_dpp v8, v8, v8 row_shr:1 row_mask:0xf bank_mask:0xf bound_ctrl:0
    s_nop 1
    v_max_u32_dpp v8, v8, v8 row_shr:2 row_mask:0xf bank_mask:0xf bound_ctrl:0
    s_nop 1
    v_max_u32_dpp v8, v8, v8 row_shr:4 row_mask:0xf bank_mask:0xf bound_ctrl:0
    s_nop 1
    v_max_u32_dpp v8, v8, v8 row_shr:8 row_mask:0xf bank_mask:0xf bound_ctrl:0
    s_nop 1
    v_max_u32_dpp v8, v8, v8 row_bcast:15 row_mask:0xa bank_mask:0xf
    s_nop 1
    v_max_u32_dpp v8, v8, v8 row_bcast:31 row_mask:0xc bank_mask:0xf
    s_nop 1
    v_add_f32_dpp v9, v9, v9 row_shr:1 row_mask:0xf bank_mask:0xf bound_ctrl:0
    s_nop 1
    v_add_f32_dpp v9, v9, v9 row_shr:2 row_mask:0xf bank_mask:0xf bound_ctrl:0
    s_nop 1
    v_add_f32_dpp v9, v9, v9 row_shr:4 row_mask:0xf bank_mask:0xf bound_ctrl:0
    s_nop 1
    v_add_f32_dpp v9, v9, v9 row_shr:8 row_mask:0xf bank_mask:0xf bound_ctrl:0
    s_nop 1
    v_add_f32_dpp v9, v9, v9 row_bcast:15 row_mask:0xa bank_mask:0xf
    s_nop 1
    v_add_f32_dpp v9, v9, v9 row_bcast:31 row_mask:0xc bank_mask:0xf
    s_lshl_b32 s35, s39, 4
    s_add_u32 s35, s35, 160320
    v_mov_b32 v10, s35
    s_mov_b32 exec_lo, 0
    s_brev_b32 exec_hi, 1
    ds_write_b64 v10, v[8:9]
    s_mov_b64 exec, -1
    s_waitcnt lgkmcnt(0)
    s_barrier
    s_branch L_p1_first
L_p1_loop:
    s_waitcnt lgkmcnt(13)
    v_lshlrev_b32 v15, 22, v100
    v_lshrrev_b32 v100, 16, v100
    v_alignbit_b32 v15, v100, v15, 10
    v_alignbit_b32 v15, v101, v15, 10
    v_xor_b32 v15, 0x80200800, v15
    s_cmp_lg_u32 s39, 15
    s_cbranch_scc1 L_p1_kernel_nox_1
    s_mov_b32 s36, 13312
    buffer_store_dwordx4 v[12:15], v3, s[20:23], s36 offen sc1
L_p1_kernel_nox_1:
    s_waitcnt lgkmcnt(12)
    v_lshlrev_b32 v75, 22, v102
    v_lshrrev_b32 v102, 16, v102
    v_alignbit_b32 v75, v102, v75, 10
    v_alignbit_b32 v75, v103, v75, 10
    v_xor_b32 v75, 0x80200800, v75
    s_mov_b32 s36, 6144
    buffer_store_dwordx4 v[72:75], v3, s[20:23], s36 offen sc1
    s_waitcnt lgkmcnt(11)
    v_lshlrev_b32 v79, 22, v104
    v_lshrrev_b32 v104, 16, v104
    v_alignbit_b32 v79, v104, v79, 10
    v_alignbit_b32 v79, v105, v79, 10
    v_xor_b32 v79, 0x80200800, v79
    s_mov_b32 s36, 7168
    buffer_store_dwordx4 v[76:79], v3, s[20:23], s36 offen sc1
    s_waitcnt lgkmcnt(10)
    v_lshlrev_b32 v51, 22, v106
    v_lshrrev_b32 v106, 16, v106
    v_alignbit_b32 v51, v106, v51, 10
    v_alignbit_b32 v51, v107, v51, 10
    v_xor_b32 v51, 0x80200800, v51
    s_mov_b32 s36, 0
    buffer_store_dwordx4 v[48:51], v3, s[20:23], s36 offen sc1
    s_add_u32 s35, s33, 16777216
    buffer_load_dwordx4 v[72:75], v1, s[8:11], s35 offen nt
    s_add_u32 s35, s33, 16777216
    buffer_load_dwordx4 v[76:79], v1, s[12:15], s35 offen nt
    s_waitcnt lgkmcnt(9)
    v_lshlrev_b32 v83, 22, v108
    v_lshrrev_b32 v108, 16, v108
    v_alignbit_b32 v83, v108, v83, 10
    v_alignbit_b32 v83, v109, v83, 10
    v_xor_b32 v83, 0x80200800, v83
    s_mov_b32 s36, 8192
    buffer_store_dwordx4 v[80:83], v3, s[20:23], s36 offen sc1
    s_waitcnt lgkmcnt(8)
    v_lshlrev_b32 v55, 22, v110
    v_lshrrev_b32 v110, 16, v110
    v_alignbit_b32 v55, v110, v55, 10
    v_alignbit_b32 v55, v111, v55, 10
    v_xor_b32 v55, 0x80200800, v55
    s_mov_b32 s36, 1024
    buffer_store_dwordx4 v[52:55], v3, s[20:23], s36 offen sc1
    s_add_u32 s35, s33, 20971520
    buffer_load_dwordx4 v[80:83], v1, s[8:11], s35 offen nt
    s_add_u32 s35, s33, 20971520
    buffer_load_dwordx4 v[100:103], v1, s[12:15], s35 offen nt
    s_waitcnt lgkmcnt(7)
    v_lshlrev_b32 v87, 22, v112
    v_lshrrev_b32 v112, 16, v112
    v_alignbit_b32 v87, v112, v87, 10
    v_alignbit_b32 v87, v113, v87, 10
    v_xor_b32 v87, 0x80200800, v87
    s_mov_b32 s36, 9216
    buffer_store_dwordx4 v[84:87], v3, s[20:23], s36 offen sc1
    s_waitcnt lgkmcnt(6)
    v_lshlrev_b32 v59, 22, v114
    v_lshrrev_b32 v114, 16, v114
    v_alignbit_b32 v59, v114, v59, 10
    v_alignbit_b32 v59, v115, v59, 10
    v_xor_b32 v59, 0x80200800, v59
    s_mov_b32 s36, 2048
    buffer_store_dwordx4 v[56:59], v3, s[20:23], s36 offen sc1
    s_add_u32 s35, s33, 25165824
    buffer_load_dwordx4 v[84:87], v1, s[8:11], s35 offen nt
    s_add_u32 s35, s33, 25165824
    buffer_load_dwordx4 v[104:107], v1, s[12:15], s35 offen nt
    s_waitcnt lgkmcnt(5)
    v_lshlrev_b32 v91, 22, v116
    v_lshrrev_b32 v116, 16, v116
    v_alignbit_b32 v91, v116, v91, 10
    v_alignbit_b32 v91, v117, v91, 10
    v_xor_b32 v91, 0x80200800, v91
    s_mov_b32 s36, 10240
    buffer_store_dwordx4 v[88:91], v3, s[20:23], s36 offen sc1
    s_waitcnt lgkmcnt(4)
    v_lshlrev_b32 v63, 22, v118
    v_lshrrev_b32 v118, 16, v118
    v_alignbit_b32 v63, v118, v63, 10
    v_alignbit_b32 v63, v119, v63, 10
    v_xor_b32 v63, 0x80200800, v63
    s_mov_b32 s36, 3072
    buffer_store_dwordx4 v[60:63], v3, s[20:23], s36 offen sc1
    s_add_u32 s35, s33, 29360128
    buffer_load_dwordx4 v[88:91], v1, s[8:11], s35 offen nt
    s_add_u32 s35, s33, 29360128
    buffer_load_dwordx4 v[108:111], v1, s[12:15], s35 offen nt
    s_waitcnt lgkmcnt(3)
    v_lshlrev_b32 v95, 22, v120
    v_lshrrev_b32 v120, 16, v120
    v_alignbit_b32 v95, v120, v95, 10
    v_alignbit_b32 v95, v121, v95, 10
    v_xor_b32 v95, 0x80200800, v95
    s_mov_b32 s36, 11264
    buffer_store_dwordx4 v[92:95], v3, s[20:23], s36 offen sc1
    s_waitcnt lgkmcnt(2)
    v_lshlrev_b32 v67, 22, v122
    v_lshrrev_b32 v122, 16, v122
    v_alignbit_b32 v67, v122, v67, 10
    v_alignbit_b32 v67, v123, v67, 10
    v_xor_b32 v67, 0x80200800, v67
    s_mov_b32 s36, 4096
    buffer_store_dwordx4 v[64:67], v3, s[20:23], s36 offen sc1
    s_add_u32 s35, s33, 33554432
    buffer_load_dwordx4 v[92:95], v1, s[8:11], s35 offen nt
    s_add_u32 s35, s33, 33554432
    buffer_load_dwordx4 v[112:115], v1, s[12:15], s35 offen nt
    s_waitcnt lgkmcnt(1)
    v_lshlrev_b32 v99, 22, v124
    v_lshrrev_b32 v124, 16, v124
    v_alignbit_b32 v99, v124, v99, 10
    v_alignbit_b32 v99, v125, v99, 10
    v_xor_b32 v99, 0x80200800, v99
    s_mov_b32 s36, 12288
    buffer_store_dwordx4 v[96:99], v3, s[20:23], s36 offen sc1
    s_waitcnt lgkmcnt(0)
    v_lshlrev_b32 v71, 22, v126
    v_lshrrev_b32 v126, 16, v126
    v_alignbit_b32 v71, v126, v71, 10
    v_alignbit_b32 v71, v127, v71, 10
    v_xor_b32 v71, 0x80200800, v71
    s_mov_b32 s36, 5120
    buffer_store_dwordx4 v[68:71], v3, s[20:23], s36 offen sc1
    s_add_u32 s35, s33, 37748736
    s_sub_u32 s35, s35, s48
    v_cndmask_b32 v96, 2.0, v1, s[44:45]
    buffer_load_dwordx4 v[96:99], v96, s[8:11], s35 offen nt
    s_add_u32 s35, s33, 37748736
    s_sub_u32 s35, s35, s48
    v_cndmask_b32 v116, 2.0, v1, s[44:45]
    buffer_load_dwordx4 v[116:119], v116, s[12:15], s35 offen nt
    s_branch L_p1_join
L_p1_first:
    s_add_u32 s35, s33, 16777216
    buffer_load_dwordx4 v[72:75], v1, s[8:11], s35 offen nt
    s_add_u32 s35, s33, 16777216
    buffer_load_dwordx4 v[76:79], v1, s[12:15], s35 offen nt
    s_add_u32 s35, s33, 20971520
    buffer_load_dwordx4 v[80:83], v1, s[8:11], s35 offen nt
    s_add_u32 s35, s33, 20971520
    buffer_load_dwordx4 v[100:103], v1, s[12:15], s35 offen nt
    s_add_u32 s35, s33, 25165824
    buffer_load_dwordx4 v[84:87], v1, s[8:11], s35 offen nt
    s_add_u32 s35, s33, 25165824
    buffer_load_dwordx4 v[104:107], v1, s[12:15], s35 offen nt
    s_add_u32 s35, s33, 29360128
    buffer_load_dwordx4 v[88:91], v1, s[8:11], s35 offen nt
    s_add_u32 s35, s33, 29360128
    buffer_load_dwordx4 v[108:111], v1, s[12:15], s35 offen nt
    s_add_u32 s35, s33, 33554432
    buffer_load_dwordx4 v[92:95], v1, s[8:11], s35 offen nt
    s_add_u32 s35, s33, 33554432
    buffer_load_dwordx4 v[112:115], v1, s[12:15], s35 offen nt
    s_add_u32 s35, s33, 37748736
    s_sub_u32 s35, s35, s48
    v_cndmask_b32 v96, 2.0, v1, s[44:45]
    buffer_load_dwordx4 v[96:99], v96, s[8:11], s35 offen nt
    s_add_u32 s35, s33, 37748736
    s_sub_u32 s35, s35, s48
    v_cndmask_b32 v116, 2.0, v1, s[44:45]
    buffer_load_dwordx4 v[116:119], v116, s[12:15], s35 offen nt
L_p1_join:
    s_waitcnt vmcnt(18)
    v_perm_b32 v6, v20, v16, s43
    v_perm_b32 v7, v21, v17, s43
    v_perm_b32 v8, v22, v18, s43
    v_perm_b32 v9, v23, v19, s43
    v_mul_hi_u32_u24 v16, 429497, v16
    v_mul_hi_u32_u24 v20, 429497, v20
    v_mul_hi_u32_u24 v17, 429497, v17
    v_mul_hi_u32_u24 v21, 429497, v21
    v_mul_hi_u32_u24 v18, 429497, v18
    v_mul_hi_u32_u24 v22, 429497, v22
    v_mul_hi_u32_u24 v19, 429497, v19
    v_mul_hi_u32_u24 v23, 429497, v23
    v_lshl_or_b32 v16, v20, 16, v16
    v_lshl_or_b32 v17, v21, 16, v17
    v_lshl_or_b32 v18, v22, 16, v18
    v_lshl_or_b32 v19, v23, 16, v19
    v_dot2_u32_u16 v20, v16, s38, 0
    v_dot2_u32_u16 v21, v17, s38, 0
    v_dot2_u32_u16 v22, v18, s38, 0
    v_dot2_u32_u16 v23, v19, s38, 0
    v_pk_mad_u16 v6, v16, s37, v6
    v_pk_mad_u16 v7, v17, s37, v7
    v_pk_mad_u16 v8, v18, s37, v8
    v_pk_mad_u16 v9, v19, s37, v9
    ds_add_u32 v20, v4 offset:0
    ds_add_u32 v21, v4 offset:0
    ds_add_u32 v22, v4 offset:0
    ds_add_u32 v23, v4 offset:0
    v_perm_b32 v55, v23, v22, s43
    v_perm_b32 v51, v21, v20, s43
    v_or_b32 v48, 0x40000000, v6
    v_or_b32 v49, 0x40000000, v7
    v_or_b32 v50, 0x40000000, v8
    v_or_b32 v52, 0x40000000, v9
    s_waitcnt vmcnt(16)
    v_perm_b32 v6, v28, v24, s43
    v_perm_b32 v7, v29, v25, s43
    v_perm_b32 v8, v30, v26, s43
    v_perm_b32 v9, v31, v27, s43
    v_mul_hi_u32_u24 v24, 429497, v24
    v_mul_hi_u32_u24 v28, 429497, v28
    v_mul_hi_u32_u24 v25, 429497, v25
    v_mul_hi_u32_u24 v29, 429497, v29
    v_mul_hi_u32_u24 v26, 429497, v26
    v_mul_hi_u32_u24 v30, 429497, v30
    v_mul_hi_u32_u24 v27, 429497, v27
    v_mul_hi_u32_u24 v31, 429497, v31
    v_lshl_or_b32 v24, v28, 16, v24
    v_lshl_or_b32 v25, v29, 16, v25
    v_lshl_or_b32 v26, v30, 16, v26
    v_lshl_or_b32 v27, v31, 16, v27
    v_dot2_u32_u16 v28, v24, s38, 0
    v_dot2_u32_u16 v29, v25, s38, 0
    v_dot2_u32_u16 v30, v26, s38, 0
    v_dot2_u32_u16 v31, v27, s38, 0
    v_pk_mad_u16 v6, v24, s37, v6
    v_pk_mad_u16 v7, v25, s37, v7
    v_pk_mad_u16 v8, v26, s37, v8
    v_pk_mad_u16 v9, v27, s37, v9
    ds_add_u32 v28, v4 offset:0
    ds_add_u32 v29, v4 offset:0
    ds_add_u32 v30, v4 offset:0
    ds_add_u32 v31, v4 offset:0
    v_perm_b32 v63, v31, v30, s43
    v_perm_b32 v59, v29, v28, s43
    v_or_b32 v53, 0x40000000, v6
    v_or_b32 v54, 0x40000000, v7
    v_or_b32 v56, 0x40000000, v8
    v_or_b32 v57, 0x40000000, v9
    s_waitcnt vmcnt(14)
    v_perm_b32 v6, v36, v32, s43
    v_perm_b32 v7, v37, v33, s43
    v_perm_b32 v8, v38, v34, s43
    v_perm_b32 v9, v39, v35, s43
    v_mul_hi_u32_u24 v32, 429497, v32
    v_mul_hi_u32_u24 v36, 429497, v36
    v_mul_hi_u32_u24 v33, 429497, v33
    v_mul_hi_u32_u24 v37, 429497, v37
    v_mul_hi_u32_u24 v34, 429497, v34
    v_mul_hi_u32_u24 v38, 429497, v38
    v_mul_hi_u32_u24 v35, 429497, v35
    v_mul_hi_u32_u24 v39, 429497, v39
    v_lshl_or_b32 v32, v36, 16, v32
    v_lshl_or_b32 v33, v37, 16, v33
    v_lshl_or_b32 v34, v38, 16, v34
    v_lshl_or_b32 v35, v39, 16, v35
    v_dot2_u32_u16 v36, v32, s38, 0
    v_dot2_u32_u16 v37, v33, s38, 0
    v_dot2_u32_u16 v38, v34, s38, 0
    v_dot2_u32_u16 v39, v35, s38, 0
    v_pk_mad_u16 v6, v32, s37, v6
    v_pk_mad_u16 v7, v33, s37, v7
    v_pk_mad_u16 v8, v34, s37, v8
    v_pk_mad_u16 v9, v35, s37, v9
    ds_add_u32 v36, v4 offset:0
    ds_add_u32 v37, v4 offset:0
    ds_add_u32 v38, v4 offset:0
    ds_add_u32 v39, v4 offset:0
    v_perm_b32 v71, v39, v38, s43
    v_perm_b32 v67, v37, v36, s43
    v_or_b32 v58, 0x40000000, v6
    v_or_b32 v60, 0x40000000, v7
    v_or_b32 v61, 0x40000000, v8
    v_or_b32 v62, 0x40000000, v9
    s_waitcnt vmcnt(12)
    v_perm_b32 v6, v44, v40, s43
    v_perm_b32 v7, v45, v41, s43
    v_perm_b32 v8, v46, v42, s43
    v_perm_b32 v9, v47, v43, s43
    v_mul_hi_u32_u24 v40, 429497, v40
    v_mul_hi_u32_u24 v44, 429497, v44
    v_mul_hi_u32_u24 v41, 429497, v41
    v_mul_hi_u32_u24 v45, 429497, v45
    v_mul_hi_u32_u24 v42, 429497, v42
    v_mul_hi_u32_u24 v46, 429497, v46
    v_mul_hi_u32_u24 v43, 429497, v43
    v_mul_hi_u32_u24 v47, 429497, v47
    v_lshl_or_b32 v40, v44, 16, v40
    v_lshl_or_b32 v41, v45, 16, v41
    v_lshl_or_b32 v42, v46, 16, v42
    v_lshl_or_b32 v43, v47, 16, v43
    v_dot2_u32_u16 v44, v40, s38, 0
    v_dot2_u32_u16 v45, v41, s38, 0
    v_dot2_u32_u16 v46, v42, s38, 0
    v_dot2_u32_u16 v47, v43, s38, 0
    v_pk_mad_u16 v6, v40, s37, v6
    v_pk_mad_u16 v7, v41, s37, v7
    v_pk_mad_u16 v8, v42, s37, v8
    v_pk_mad_u16 v9, v43, s37, v9
    ds_add_u32 v44, v4 offset:0
    ds_add_u32 v45, v4 offset:0
    ds_add_u32 v46, v4 offset:0
    ds_add_u32 v47, v4 offset:0
    v_perm_b32 v121, v47, v46, s43
    v_perm_b32 v120, v45, v44, s43
    v_or_b32 v64, 0x40000000, v6
    v_or_b32 v65, 0x40000000, v7
    v_or_b32 v66, 0x40000000, v8
    v_or_b32 v68, 0x40000000, v9
    s_waitcnt vmcnt(10)
    v_perm_b32 v6, v76, v72, s43
    v_perm_b32 v7, v77, v73, s43
    v_perm_b32 v8, v78, v74, s43
    v_perm_b32 v9, v79, v75, s43
    v_mul_hi_u32_u24 v72, 429497, v72
    v_mul_hi_u32_u24 v76, 429497, v76
    v_mul_hi_u32_u24 v73, 429497, v73
    v_mul_hi_u32_u24 v77, 429497, v77
    v_mul_hi_u32_u24 v74, 429497, v74
    v_mul_hi_u32_u24 v78, 429497, v78
    v_mul_hi_u32_u24 v75, 429497, v75
    v_mul_hi_u32_u24 v79, 429497, v79
    v_lshl_or_b32 v72, v76, 16, v72
    v_lshl_or_b32 v73, v77, 16, v73
    v_lshl_or_b32 v74, v78, 16, v74
    v_lshl_or_b32 v75, v79, 16, v75
    v_dot2_u32_u16 v76, v72, s38, 0
    v_dot2_u32_u16 v77, v73, s38, 0
    v_dot2_u32_u16 v78, v74, s38, 0
    v_dot2_u32_u16 v79, v75, s38, 0
    v_pk_mad_u16 v6, v72, s37, v6
    v_pk_mad_u16 v7, v73, s37, v7
    v_pk_mad_u16 v8, v74, s37, v8
    v_pk_mad_u16 v9, v75, s37, v9
    ds_add_u32 v76, v4 offset:0
    ds_add_u32 v77, v4 offset:0
    ds_add_u32 v78, v4 offset:0
    ds_add_u32 v79, v4 offset:0
    v_perm_b32 v123, v79, v78, s43
    v_perm_b32 v122, v77, v76, s43
    v_or_b32 v69, 0x40000000, v6
    v_or_b32 v70, 0x40000000, v7
    v_or_b32 v127, 0x40000000, v8
    v_or_b32 v72, 0x40000000, v9
    s_waitcnt vmcnt(8)
    v_perm_b32 v6, v100, v80, s43
    v_perm_b32 v7, v101, v81, s43
    v_perm_b32 v8, v102, v82, s43
    v_perm_b32 v9, v103, v83, s43
    v_mul_hi_u32_u24 v80, 429497, v80
    v_mul_hi_u32_u24 v100, 429497, v100
    v_mul_hi_u32_u24 v81, 429497, v81
    v_mul_hi_u32_u24 v101, 429497, v101
    v_mul_hi_u32_u24 v82, 429497, v82
    v_mul_hi_u32_u24 v102, 429497, v102
    v_mul_hi_u32_u24 v83, 429497, v83
    v_mul_hi_u32_u24 v103, 429497, v103
    v_lshl_or_b32 v80, v100, 16, v80
    v_lshl_or_b32 v81, v101, 16, v81
    v_lshl_or_b32 v82, v102, 16, v82
    v_lshl_or_b32 v83, v103, 16, v83
    v_dot2_u32_u16 v100, v80, s38, 0
    v_dot2_u32_u16 v101, v81, s38, 0
    v_dot2_u32_u16 v102, v82, s38, 0
    v_dot2_u32_u16 v103, v83, s38, 0
    v_pk_mad_u16 v6, v80, s37, v6
    v_pk_mad_u16 v7, v81, s37, v7
    v_pk_mad_u16 v8, v82, s37, v8
    v_pk_mad_u16 v9, v83, s37, v9
    ds_add_u32 v100, v4 offset:0
    ds_add_u32 v101, v4 offset:0
    ds_add_u32 v102, v4 offset:0
    ds_add_u32 v103, v4 offset:0
    v_perm_b32 v125, v103, v102, s43
    v_perm_b32 v124, v101, v100, s43
    v_or_b32 v73, 0x40000000, v6
    v_or_b32 v74, 0x40000000, v7
    v_or_b32 v76, 0x40000000, v8
    v_or_b32 v77, 0x40000000, v9
    s_waitcnt vmcnt(6)
    v_perm_b32 v6, v104, v84, s43
    v_perm_b32 v7, v105, v85, s43
    v_perm_b32 v8, v106, v86, s43
    v_perm_b32 v9, v107, v87, s43
    v_mul_hi_u32_u24 v84, 429497, v84
    v_mul_hi_u32_u24 v104, 429497, v104
    v_mul_hi_u32_u24 v85, 429497, v85
    v_mul_hi_u32_u24 v105, 429497, v105
    v_mul_hi_u32_u24 v86, 429497, v86
    v_mul_hi_u32_u24 v106, 429497, v106
    v_mul_hi_u32_u24 v87, 429497, v87
    v_mul_hi_u32_u24 v107, 429497, v107
    v_lshl_or_b32 v84, v104, 16, v84
    v_lshl_or_b32 v85, v105, 16, v85
    v_lshl_or_b32 v86, v106, 16, v86
    v_lshl_or_b32 v87, v107, 16, v87
    v_dot2_u32_u16 v104, v84, s38, 0
    v_dot2_u32_u16 v105, v85, s38, 0
    v_dot2_u32_u16 v106, v86, s38, 0
    v_dot2_u32_u16 v107, v87, s38, 0
    v_pk_mad_u16 v6, v84, s37, v6
    v_pk_mad_u16 v7, v85, s37, v7
    v_pk_mad_u16 v8, v86, s37, v8
    v_pk_mad_u16 v9, v87, s37, v9
    ds_add_u32 v104, v4 offset:0
    ds_add_u32 v105, v4 offset:0
    ds_add_u32 v106, v4 offset:0
    ds_add_u32 v107, v4 offset:0
    v_perm_b32 v75, v107, v106, s43
    v_perm_b32 v126, v105, v104, s43
    v_or_b32 v78, 0x40000000, v6
    v_or_b32 v80, 0x40000000, v7
    v_or_b32 v81, 0x40000000, v8
    v_or_b32 v82, 0x40000000, v9
    s_waitcnt vmcnt(4)
    v_perm_b32 v6, v108, v88, s43
    v_perm_b32 v7, v109, v89, s43
    v_perm_b32 v8, v110, v90, s43
    v_perm_b32 v9, v111, v91, s43
    v_mul_hi_u32_u24 v88, 429497, v88
    v_mul_hi_u32_u24 v108, 429497, v108
    v_mul_hi_u32_u24 v89, 429497, v89
    v_mul_hi_u32_u24 v109, 429497, v109
    v_mul_hi_u32_u24 v90, 429497, v90
    v_mul_hi_u32_u24 v110, 429497, v110
    v_mul_hi_u32_u24 v91, 429497, v91
    v_mul_hi_u32_u24 v111, 429497, v111
    v_lshl_or_b32 v88, v108, 16, v88
    v_lshl_or_b32 v89, v109, 16, v89
    v_lshl_or_b32 v90, v110, 16, v90
    v_lshl_or_b32 v91, v111, 16, v91
    v_dot2_u32_u16 v108, v88, s38, 0
    v_dot2_u32_u16 v109, v89, s38, 0
    v_dot2_u32_u16 v110, v90, s38, 0
    v_dot2_u32_u16 v111, v91, s38, 0
    v_pk_mad_u16 v6, v88, s37, v6
    v_pk_mad_u16 v7, v89, s37, v7
    v_pk_mad_u16 v8, v90, s37, v8
    v_pk_mad_u16 v9, v91, s37, v9
    ds_add_u32 v108, v4 offset:0
    ds_add_u32 v109, v4 offset:0
    ds_add_u32 v110, v4 offset:0
    ds_add_u32 v111, v4 offset:0
    v_perm_b32 v83, v111, v110, s43
    v_perm_b32 v79, v109, v108, s43
    v_or_b32 v84, 0x40000000, v6
    v_or_b32 v85, 0x40000000, v7
    v_or_b32 v86, 0x40000000, v8
    v_or_b32 v88, 0x40000000, v9
    s_waitcnt vmcnt(2)
    v_perm_b32 v6, v112, v92, s43
    v_perm_b32 v7, v113, v93, s43
    v_perm_b32 v8, v114, v94, s43
    v_perm_b32 v9, v115, v95, s43
    v_mul_hi_u32_u24 v92, 429497, v92
    v_mul_hi_u32_u24 v112, 429497, v112
    v_mul_hi_u32_u24 v93, 429497, v93
    v_mul_hi_u32_u24 v113, 429497, v113
    v_mul_hi_u32_u24 v94, 429497, v94
    v_mul_hi_u32_u24 v114, 429497, v114
    v_mul_hi_u32_u24 v95, 429497, v95
    v_mul_hi_u32_u24 v115, 429497, v115
    v_lshl_or_b32 v92, v112, 16, v92
    v_lshl_or_b32 v93, v113, 16, v93
    v_lshl_or_b32 v94, v114, 16, v94
    v_lshl_or_b32 v95, v115, 16, v95
    v_dot2_u32_u16 v112, v92, s38, 0
    v_dot2_u32_u16 v113, v93, s38, 0
    v_dot2_u32_u16 v114, v94, s38, 0
    v_dot2_u32_u16 v115, v95, s38, 0
    v_pk_mad_u16 v6, v92, s37, v6
    v_pk_mad_u16 v7, v93, s37, v7
    v_pk_mad_u16 v8, v94, s37, v8
    v_pk_mad_u16 v9, v95, s37, v9
    ds_add_u32 v112, v4 offset:0
    ds_add_u32 v113, v4 offset:0
    ds_add_u32 v114, v4 offset:0
    ds_add_u32 v115, v4 offset:0
    v_perm_b32 v91, v115, v114, s43
    v_perm_b32 v87, v113, v112, s43
    v_or_b32 v89, 0x40000000, v6
    v_or_b32 v90, 0x40000000, v7
    v_or_b32 v92, 0x40000000, v8
    v_or_b32 v93, 0x40000000, v9
    s_waitcnt vmcnt(0)
    s_mov_b64 exec, s[44:45]
    v_perm_b32 v6, v116, v96, s43
    v_perm_b32 v7, v117, v97, s43
    v_perm_b32 v8, v118, v98, s43
    v_perm_b32 v9, v119, v99, s43
    v_mul_hi_u32_u24 v96, 429497, v96
    v_mul_hi_u32_u24 v116, 429497, v116
    v_mul_hi_u32_u24 v97, 429497, v97
    v_mul_hi_u32_u24 v117, 429497, v117
    v_mul_hi_u32_u24 v98, 429497, v98
    v_mul_hi_u32_u24 v118, 429497, v118
    v_mul_hi_u32_u24 v99, 429497, v99
    v_mul_hi_u32_u24 v119, 429497, v119
    v_lshl_or_b32 v96, v116, 16, v96
    v_lshl_or_b32 v97, v117, 16, v97
    v_lshl_or_b32 v98, v118, 16, v98
    v_lshl_or_b32 v99, v119, 16, v99
    v_dot2_u32_u16 v116, v96, s38, 0
    v_dot2_u32_u16 v117, v97, s38, 0
    v_dot2_u32_u16 v118, v98, s38, 0
    v_dot2_u32_u16 v119, v99, s38, 0
    v_pk_mad_u16 v6, v96, s37, v6
    v_pk_mad_u16 v7, v97, s37, v7
    v_pk_mad_u16 v8, v98, s37, v8
    v_pk_mad_u16 v9, v99, s37, v9
    ds_add_u32 v116, v4 offset:0
    ds_add_u32 v117, v4 offset:0
    ds_add_u32 v118, v4 offset:0
    ds_add_u32 v119, v4 offset:0
    v_perm_b32 v99, v119, v118, s43
    v_perm_b32 v95, v117, v116, s43
    v_or_b32 v94, 0x40000000, v6
    v_or_b32 v96, 0x40000000, v7
    v_or_b32 v97, 0x40000000, v8
    v_or_b32 v98, 0x40000000, v9
    s_mov_b64 exec, -1
    s_add_u32 s35, s34, 0
    buffer_load_dwordx2 v[100:101], v2, s[16:19], s35 offen nt
    s_and_b32 s35, s32, 15
    s_lshl_b32 s35, s35, 6
    s_lshr_b32 s36, s32, 4
    s_add_u32 s35, s35, s36
    s_lshl_b32 s42, s35, 4
    s_mul_i32 s35, s35, 213888
    s_add_u32 s35, s35, 8192
    s_add_u32 s20, s4, s35
    s_addc_u32 s21, s5, 0
    s_waitcnt lgkmcnt(0)
    s_barrier
    ds_read_b128 v[8:11], v1 offset:0
    s_add_u32 s35, s34, 2097152
    buffer_load_dwordx2 v[102:103], v2, s[16:19], s35 offen nt
    s_lshl_b32 s35, s39, 2
    s_add_u32 s35, s35, 160256
    v_mov_b32 v7, s35
    v_and_b32 v14, 15, v0
    v_lshlrev_b32 v14, 2, v14
    v_add_u32 v14, 160256, v14
    s_waitcnt lgkmcnt(0)
    v_cmp_eq_u32 s[56:57], 0, v8
    v_cmp_ge_u32 s[64:65], 1, v8
    v_max_u32 v12, 2, v8
    v_lshl_or_b32 v8, v8, 16, v12
    v_cmp_eq_u32 s[58:59], 0, v9
    v_cmp_ge_u32 s[66:67], 1, v9
    v_max_u32 v12, 2, v9
    v_lshl_or_b32 v9, v9, 16, v12
    v_cmp_eq_u32 s[60:61], 0, v10
    v_cmp_ge_u32 s[68:69], 1, v10
    v_max_u32 v12, 2, v10
    v_lshl_or_b32 v10, v10, 16, v12
    v_cmp_eq_u32 s[62:63], 0, v11
    v_cmp_ge_u32 s[70:71], 1, v11
    v_max_u32 v12, 2, v11
    v_lshl_or_b32 v11, v11, 16, v12
    v_add_u32 v9, v8, v9
    v_add_u32 v10, v9, v10
    v_add_u32 v11, v10, v11
    v_mov_b32 v6, v11
    s_nop 1
    v_add_u32_dpp v6, v6, v6 row_shr:1 row_mask:0xf bank_mask:0xf bound_ctrl:0
    s_nop 1
    v_add_u32_dpp v6, v6, v6 row_shr:2 row_mask:0xf bank_mask:0xf bound_ctrl:0
    s_nop 1
    v_add_u32_dpp v6, v6, v6 row_shr:4 row_mask:0xf bank_mask:0xf bound_ctrl:0
    s_nop 1
    v_add_u32_dpp v6, v6, v6 row_shr:8 row_mask:0xf bank_mask:0xf bound_ctrl:0
    s_nop 1
    v_add_u32_dpp v6, v6, v6 row_bcast:15 row_mask:0xa bank_mask:0xf
    s_nop 1
    v_add_u32_dpp v6, v6, v6 row_bcast:31 row_mask:0xc bank_mask:0xf
    s_mov_b32 exec_lo, 0
    s_brev_b32 exec_hi, 1
    ds_write_b32 v7, v6
    s_mov_b64 exec, -1
    v_sub_u32 v6, v6, v11
    s_or_b64 s[46:47], s[64:65], s[66:67]
    s_or_b64 vcc, s[68:69], s[70:71]
    s_or_b64 s[46:47], s[46:47], vcc
    s_waitcnt lgkmcnt(0)
    s_barrier
    ds_read_b32 v7, v14
    s_add_u32 s35, s34, 4194304
    buffer_load_dwordx2 v[104:105], v2, s[16:19], s35 offen nt
    s_waitcnt lgkmcnt(0)
    v_mov_b32 v15, v7
    s_nop 1
    v_add_u32_dpp v7, v7, v7 row_shr:1 row_mask:0xf bank_mask:0xf bound_ctrl:0
    s_nop 1
    v_add_u32_dpp v7, v7, v7 row_shr:2 row_mask:0xf bank_mask:0xf bound_ctrl:0
    s_nop 1
    v_add_u32_dpp v7, v7, v7 row_shr:4 row_mask:0xf bank_mask:0xf bound_ctrl:0
    s_nop 1
    v_add_u32_dpp v7, v7, v7 row_shr:8 row_mask:0xf bank_mask:0xf bound_ctrl:0
    s_nop 0
    v_readlane_b32 s54, v7, 15
    v_sub_u32 v7, v7, v15
    s_nop 0
    v_readlane_b32 s35, v7, s39
    s_and_b32 s54, s54, 0xffff
    s_cmp_ge_u32 s54, 40063
    s_cselect_b32 s36, 16, 0
    s_cselect_b32 s54, 40000, s54
    s_cselect_b32 s55, 1, s55
    s_cselect_b64 s[46:47], 0, s[46:47]
    v_add_u32 v12, s35, v6
    v_add_u32 v13, v12, v8
    v_add_u32 v14, v12, v9
    v_add_u32 v15, v12, v10
    v_bfe_u32 v12, v12, s36, 16
    v_bfe_u32 v13, v13, s36, 16
    v_bfe_u32 v14, v14, s36, 16
    v_bfe_u32 v15, v15, s36, 16
    ds_write_b128 v1, v[12:15] offset:0
    ds_write_b128 v1, v[12:15] offset:16384
    v_mov_b32 v6, 32768
    v_mov_b32 v7, s54
    s_mov_b64 exec, 1
    ds_write_b32 v6, v7
    s_mov_b64 exec, -1
    s_add_u32 s35, s54, 2
    s_mul_hi_u32 s35, s35, 1431655766
    s_lshl_b32 s35, s35, 4
    s_min_u32 s22, s35, 213888
    v_perm_b32 v15, v15, v14, s43
    v_perm_b32 v14, v13, v12, s43
    s_waitcnt lgkmcnt(0)
    s_barrier
    v_and_b32 v6, 63, v0
    s_lshl_b32 s35, s39, 10
    v_lshl_add_u32 v7, v6, 2, s35
    v_lshl_add_u32 v12, v6, 8, s35
    ds_read_b32 v8, v7 offset:16384
    ds_read_b32 v9, v7 offset:16640
    ds_read_b32 v10, v7 offset:16896
    ds_read_b32 v11, v7 offset:17152
    s_mov_b64 exec, 15
    ds_read_b32 v12, v12 offset:16640
    s_mov_b64 exec, -1
    s_lshr_b32 s35, s39, 2
    s_mul_i32 s35, s35, 2138240
    s_and_b32 s36, s39, 1
    s_lshl_b32 s36, s36, 3
    s_add_u32 s35, s35, s36
    s_and_b32 s36, s39, 2
    s_lshl_b32 s36, s36, 13
    s_add_u32 s35, s35, s36
    s_add_u32 s35, s35, s42
    s_add_u32 s36, s35, 2105344
    v_mul_u32_u24 v7, 32896, v6
    v_lshlrev_b32 v13, 1, v6
    s_waitcnt lgkmcnt(1)
    v_perm_b32 v8, v9, v8, s43
    v_perm_b32 v9, v11, v10, s43
    buffer_store_dwordx2 v[8:9], v7, s[24:27], s35 offen
    s_waitcnt lgkmcnt(0)
    s_mov_b64 exec, 15
    buffer_store_short v12, v13, s[24:27], s36 offen
    s_mov_b64 exec, -1
    s_nop 0
    v_and_b32 v6, 0xffff, v51
    v_lshrrev_b32 v7, 16, v51
    v_and_b32 v8, 0xffff, v55
    v_lshrrev_b32 v9, 16, v55
    ds_add_rtn_u32 v6, v6, v4 offset:0
    ds_add_rtn_u32 v7, v7, v4 offset:0
    ds_add_rtn_u32 v8, v8, v4 offset:0
    ds_add_rtn_u32 v9, v9, v4 offset:0
    v_and_b32 v10, 0xffff, v59
    v_lshrrev_b32 v11, 16, v59
    v_and_b32 v12, 0xffff, v63
    v_lshrrev_b32 v13, 16, v63
    ds_add_rtn_u32 v10, v10, v4 offset:0
    ds_add_rtn_u32 v11, v11, v4 offset:0
    ds_add_rtn_u32 v12, v12, v4 offset:0
    ds_add_rtn_u32 v13, v13, v4 offset:0
    s_waitcnt lgkmcnt(4)
    v_perm_b32 v51, v7, v6, s43
    v_perm_b32 v55, v9, v8, s43
    v_and_b32 v6, 0xffff, v67
    v_lshrrev_b32 v7, 16, v67
    v_and_b32 v8, 0xffff, v71
    v_lshrrev_b32 v9, 16, v71
    ds_add_rtn_u32 v6, v6, v4 offset:0
    ds_add_rtn_u32 v7, v7, v4 offset:0
    ds_add_rtn_u32 v8, v8, v4 offset:0
    ds_add_rtn_u32 v9, v9, v4 offset:0
    s_waitcnt lgkmcnt(4)
    v_perm_b32 v59, v11, v10, s43
    v_perm_b32 v63, v13, v12, s43
    s_add_u32 s35, s34, 6291456
    buffer_load_dwordx2 v[106:107], v2, s[16:19], s35 offen nt
    v_and_b32 v10, 0xffff, v120
    v_lshrrev_b32 v11, 16, v120
    v_and_b32 v12, 0xffff, v121
    v_lshrrev_b32 v13, 16, v121
    ds_add_rtn_u32 v10, v10, v4 offset:0
    ds_add_rtn_u32 v11, v11, v4 offset:0
    ds_add_rtn_u32 v12, v12, v4 offset:0
    ds_add_rtn_u32 v13, v13, v4 offset:0
    s_waitcnt lgkmcnt(4)
    v_perm_b32 v67, v7, v6, s43
    v_perm_b32 v71, v9, v8, s43
    s_add_u32 s35, s34, 8388608
    buffer_load_dwordx2 v[108:109], v2, s[16:19], s35 offen nt
    v_and_b32 v6, 0xffff, v122
    v_lshrrev_b32 v7, 16, v122
    v_and_b32 v8, 0xffff, v123
    v_lshrrev_b32 v9, 16, v123
    ds_add_rtn_u32 v6, v6, v4 offset:0
    ds_add_rtn_u32 v7, v7, v4 offset:0
    ds_add_rtn_u32 v8, v8, v4 offset:0
    ds_add_rtn_u32 v9, v9, v4 offset:0
    s_waitcnt lgkmcnt(4)
    v_perm_b32 v120, v11, v10, s43
    v_perm_b32 v121, v13, v12, s43
    s_add_u32 s35, s34, 10485760
    buffer_load_dwordx2 v[110:111], v2, s[16:19], s35 offen nt
    v_and_b32 v10, 0xffff, v124
    v_lshrrev_b32 v11, 16, v124
    v_and_b32 v12, 0xffff, v125
    v_lshrrev_b32 v13, 16, v125
    ds_add_rtn_u32 v10, v10, v4 offset:0
    ds_add_rtn_u32 v11, v11, v4 offset:0
    ds_add_rtn_u32 v12, v12, v4 offset:0
    ds_add_rtn_u32 v13, v13, v4 offset:0
    s_waitcnt lgkmcnt(4)
    v_perm_b32 v122, v7, v6, s43
    v_perm_b32 v123, v9, v8, s43
    v_and_b32 v6, 0xffff, v126
    v_lshrrev_b32 v7, 16, v126
    v_and_b32 v8, 0xffff, v75
    v_lshrrev_b32 v9, 16, v75
    ds_add_rtn_u32 v6, v6, v4 offset:0
    ds_add_rtn_u32 v7, v7, v4 offset:0
    ds_add_rtn_u32 v8, v8, v4 offset:0
    ds_add_rtn_u32 v9, v9, v4 offset:0
    s_waitcnt lgkmcnt(4)
    v_perm_b32 v124, v11, v10, s43
    v_perm_b32 v125, v13, v12, s43
    s_add_u32 s35, s34, 12582912
    buffer_load_dwordx2 v[112:113], v2, s[16:19], s35 offen nt
    v_and_b32 v10, 0xffff, v79
    v_lshrrev_b32 v11, 16, v79
    v_and_b32 v12, 0xffff, v83
    v_lshrrev_b32 v13, 16, v83
    ds_add_rtn_u32 v10, v10, v4 offset:0
    ds_add_rtn_u32 v11, v11, v4 offset:0
    ds_add_rtn_u32 v12, v12, v4 offset:0
    ds_add_rtn_u32 v13, v13, v4 offset:0
    s_waitcnt lgkmcnt(4)
    v_perm_b32 v126, v7, v6, s43
    v_perm_b32 v75, v9, v8, s43
    s_add_u32 s35, s34, 14680064
    buffer_load_dwordx2 v[114:115], v2, s[16:19], s35 offen nt
    v_and_b32 v6, 0xffff, v87
    v_lshrrev_b32 v7, 16, v87
    v_and_b32 v8, 0xffff, v91
    v_lshrrev_b32 v9, 16, v91
    ds_add_rtn_u32 v6, v6, v4 offset:0
    ds_add_rtn_u32 v7, v7, v4 offset:0
    ds_add_rtn_u32 v8, v8, v4 offset:0
    ds_add_rtn_u32 v9, v9, v4 offset:0
    s_waitcnt lgkmcnt(4)
    v_perm_b32 v79, v11, v10, s43
    v_perm_b32 v83, v13, v12, s43
    s_add_u32 s35, s34, 16777216
    buffer_load_dwordx2 v[116:117], v2, s[16:19], s35 offen nt
    s_mov_b64 exec, s[44:45]
    v_and_b32 v10, 0xffff, v95
    v_lshrrev_b32 v11, 16, v95
    v_and_b32 v12, 0xffff, v99
    v_lshrrev_b32 v13, 16, v99
    ds_add_rtn_u32 v10, v10, v4 offset:0
    ds_add_rtn_u32 v11, v11, v4 offset:0
    ds_add_rtn_u32 v12, v12, v4 offset:0
    ds_add_rtn_u32 v13, v13, v4 offset:0
    s_mov_b64 exec, -1
    s_waitcnt lgkmcnt(4)
    v_perm_b32 v87, v7, v6, s43
    v_perm_b32 v91, v9, v8, s43
    s_add_u32 s35, s34, 18874368
    s_sub_u32 s35, s35, s49
    v_cndmask_b32 v118, 2.0, v2, s[44:45]
    buffer_load_dwordx2 v[118:119], v118, s[16:19], s35 offen nt
    s_waitcnt lgkmcnt(0)
    v_perm_b32 v95, v11, v10, s43
    v_perm_b32 v99, v13, v12, s43
    s_barrier
    s_lshl_b32 s35, s54, 2
    v_mov_b32 v6, s35
    v_mov_b32 v7, 0
    v_mov_b32 v12, 1140817920
    s_mov_b64 exec, 1
    ds_write2_b32 v6, v7, v7 offset0:0 offset1:1
    s_cmp_eq_u64 s[46:47], 0
    s_cbranch_scc1 L_p1_kernel_nonull_2
    s_mov_b64 exec, s[64:65]
    v_lshlrev_b32_sdwa v6, 2, v14 dst_sel:DWORD dst_unused:UNUSED_PAD src0_sel:DWORD src1_sel:WORD_0
    ds_write_b32 v6, v7 offset:4
    s_mov_b64 exec, s[56:57]
    ds_write_b32 v6, v7
    s_mov_b64 exec, s[66:67]
    v_lshlrev_b32_sdwa v6, 2, v14 dst_sel:DWORD dst_unused:UNUSED_PAD src0_sel:DWORD src1_sel:WORD_1
    ds_write_b32 v6, v7 offset:4
    s_mov_b64 exec, s[58:59]
    ds_write_b32 v6, v7
    s_mov_b64 exec, s[68:69]
    v_lshlrev_b32_sdwa v6, 2, v15 dst_sel:DWORD dst_unused:UNUSED_PAD src0_sel:DWORD src1_sel:WORD_0
    ds_write_b32 v6, v7 offset:4
    s_mov_b64 exec, s[60:61]
    ds_write_b32 v6, v7
    s_mov_b64 exec, s[70:71]
    v_lshlrev_b32_sdwa v6, 2, v15 dst_sel:DWORD dst_unused:UNUSED_PAD src0_sel:DWORD src1_sel:WORD_1
    ds_write_b32 v6, v7 offset:4
    s_mov_b64 exec, s[62:63]
    ds_write_b32 v6, v7
L_p1_kernel_nonull_2:
    s_mov_b64 exec, -1
    v_lshlrev_b32_sdwa v6, 2, v51 dst_sel:DWORD dst_unused:UNUSED_PAD src0_sel:DWORD src1_sel:WORD_0
    v_lshlrev_b32_sdwa v7, 2, v51 dst_sel:DWORD dst_unused:UNUSED_PAD src0_sel:DWORD src1_sel:WORD_1
    v_lshlrev_b32_sdwa v8, 2, v55 dst_sel:DWORD dst_unused:UNUSED_PAD src0_sel:DWORD src1_sel:WORD_0
    v_lshlrev_b32_sdwa v9, 2, v55 dst_sel:DWORD dst_unused:UNUSED_PAD src0_sel:DWORD src1_sel:WORD_1
    ds_write_b32 v6, v48
    ds_write_b32 v7, v49
    ds_write_b32 v8, v50
    ds_write_b32 v9, v52
    s_waitcnt vmcnt(11)
    v_lshlrev_b32 v10, 16, v100
    v_lshlrev_b32 v11, 16, v101
    v_and_b32 v100, 0xffff0000, v100
    v_and_b32 v101, 0xffff0000, v101
    v_mul_f32 v10, s41, v10
    v_mul_f32 v100, s41, v100
    v_mul_f32 v11, s41, v11
    v_mul_f32 v101, s41, v101
    v_fract_f32 v10, v10
    v_fract_f32 v100, v100
    v_fract_f32 v11, v11
    v_fract_f32 v101, v101
    v_cos_f32 v10, v10
    v_cos_f32 v100, v100
    v_cos_f32 v11, v11
    v_cos_f32 v101, v101
    v_fmaak_f32 v10, v12, v10, 1262486016
    v_fmaak_f32 v100, v12, v100, 1262486016
    v_fmaak_f32 v11, v12, v11, 1262486016
    v_fmaak_f32 v101, v12, v101, 1262486016
    v_or3_b32 v5, v10, v100, v5
    v_or3_b32 v5, v11, v101, v5
    v_perm_b32 v100, v100, v10, s43
    v_perm_b32 v101, v101, v11, s43
    s_add_u32 s35, s33, 40960000
    buffer_load_dwordx4 v[16:19], v1, s[8:11], s35 offen nt
    v_lshlrev_b32_sdwa v6, 2, v59 dst_sel:DWORD dst_unused:UNUSED_PAD src0_sel:DWORD src1_sel:WORD_0
    v_lshlrev_b32_sdwa v7, 2, v59 dst_sel:DWORD dst_unused:UNUSED_PAD src0_sel:DWORD src1_sel:WORD_1
    v_lshlrev_b32_sdwa v8, 2, v63 dst_sel:DWORD dst_unused:UNUSED_PAD src0_sel:DWORD src1_sel:WORD_0
    v_lshlrev_b32_sdwa v9, 2, v63 dst_sel:DWORD dst_unused:UNUSED_PAD src0_sel:DWORD src1_sel:WORD_1
    ds_write_b32 v6, v53
    ds_write_b32 v7, v54
    ds_write_b32 v8, v56
    ds_write_b32 v9, v57
    s_waitcnt vmcnt(11)
    v_lshlrev_b32 v10, 16, v102
    v_lshlrev_b32 v11, 16, v103
    v_and_b32 v102, 0xffff0000, v102
    v_and_b32 v103, 0xffff0000, v103
    v_mul_f32 v10, s41, v10
    v_mul_f32 v102, s41, v102
    v_mul_f32 v11, s41, v11
    v_mul_f32 v103, s41, v103
    v_fract_f32 v10, v10
    v_fract_f32 v102, v102
    v_fract_f32 v11, v11
    v_fract_f32 v103, v103
    v_cos_f32 v10, v10
    v_cos_f32 v102, v102
    v_cos_f32 v11, v11
    v_cos_f32 v103, v103
    v_fmaak_f32 v10, v12, v10, 1262486016
    v_fmaak_f32 v102, v12, v102, 1262486016
    v_fmaak_f32 v11, v12, v11, 1262486016
    v_fmaak_f32 v103, v12, v103, 1262486016
    v_or3_b32 v5, v10, v102, v5
    v_or3_b32 v5, v11, v103, v5
    v_perm_b32 v102, v102, v10, s43
    v_perm_b32 v103, v103, v11, s43
    v_lshlrev_b32_sdwa v6, 2, v67 dst_sel:DWORD dst_unused:UNUSED_PAD src0_sel:DWORD src1_sel:WORD_0
    v_lshlrev_b32_sdwa v7, 2, v67 dst_sel:DWORD dst_unused:UNUSED_PAD src0_sel:DWORD src1_sel:WORD_1
    v_lshlrev_b32_sdwa v8, 2, v71 dst_sel:DWORD dst_unused:UNUSED_PAD src0_sel:DWORD src1_sel:WORD_0
    v_lshlrev_b32_sdwa v9, 2, v71 dst_sel:DWORD dst_unused:UNUSED_PAD src0_sel:DWORD src1_sel:WORD_1
    ds_write_b32 v6, v58
    ds_write_b32 v7, v60
    ds_write_b32 v8, v61
    ds_write_b32 v9, v62
    v_lshlrev_b32_sdwa v6, 2, v120 dst_sel:DWORD dst_unused:UNUSED_PAD src0_sel:DWORD src1_sel:WORD_0
    v_lshlrev_b32_sdwa v7, 2, v120 dst_sel:DWORD dst_unused:UNUSED_PAD src0_sel:DWORD src1_sel:WORD_1
    v_lshlrev_b32_sdwa v8, 2, v121 dst_sel:DWORD dst_unused:UNUSED_PAD src0_sel:DWORD src1_sel:WORD_0
    v_lshlrev_b32_sdwa v9, 2, v121 dst_sel:DWORD dst_unused:UNUSED_PAD src0_sel:DWORD src1_sel:WORD_1
    ds_write_b32 v6, v64
    ds_write_b32 v7, v65
    ds_write_b32 v8, v66
    ds_write_b32 v9, v68
    s_waitcnt vmcnt(10)
    v_lshlrev_b32 v10, 16, v104
    v_lshlrev_b32 v11, 16, v105
    v_and_b32 v104, 0xffff0000, v104
    v_and_b32 v105, 0xffff0000, v105
    v_mul_f32 v10, s41, v10
    v_mul_f32 v104, s41, v104
    v_mul_f32 v11, s41, v11
    v_mul_f32 v105, s41, v105
    v_fract_f32 v10, v10
    v_fract_f32 v104, v104
    v_fract_f32 v11, v11
    v_fract_f32 v105, v105
    v_cos_f32 v10, v10
    v_cos_f32 v104, v104
    v_cos_f32 v11, v11
    v_cos_f32 v105, v105
    v_fmaak_f32 v10, v12, v10, 1262486016
    v_fmaak_f32 v104, v12, v104, 1262486016
    v_fmaak_f32 v11, v12, v11, 1262486016
    v_fmaak_f32 v105, v12, v105, 1262486016
    v_or3_b32 v5, v10, v104, v5
    v_or3_b32 v5, v11, v105, v5
    v_perm_b32 v104, v104, v10, s43
    v_perm_b32 v105, v105, v11, s43
    s_add_u32 s35, s33, 40960000
    buffer_load_dwordx4 v[20:23], v1, s[12:15], s35 offen nt
    v_lshlrev_b32_sdwa v6, 2, v122 dst_sel:DWORD dst_unused:UNUSED_PAD src0_sel:DWORD src1_sel:WORD_0
    v_lshlrev_b32_sdwa v7, 2, v122 dst_sel:DWORD dst_unused:UNUSED_PAD src0_sel:DWORD src1_sel:WORD_1
    v_lshlrev_b32_sdwa v8, 2, v123 dst_sel:DWORD dst_unused:UNUSED_PAD src0_sel:DWORD src1_sel:WORD_0
    v_lshlrev_b32_sdwa v9, 2, v123 dst_sel:DWORD dst_unused:UNUSED_PAD src0_sel:DWORD src1_sel:WORD_1
    ds_write_b32 v6, v69
    ds_write_b32 v7, v70
    ds_write_b32 v8, v127
    ds_write_b32 v9, v72
    s_waitcnt vmcnt(8)
    v_lshlrev_b32 v10, 16, v106
    v_lshlrev_b32 v11, 16, v107
    v_and_b32 v106, 0xffff0000, v106
    v_and_b32 v107, 0xffff0000, v107
    v_mul_f32 v10, s41, v10
    v_mul_f32 v106, s41, v106
    v_mul_f32 v11, s41, v11
    v_mul_f32 v107, s41, v107
    v_fract_f32 v10, v10
    v_fract_f32 v106, v106
    v_fract_f32 v11, v11
    v_fract_f32 v107, v107
    v_cos_f32 v10, v10
    v_cos_f32 v106, v106
    v_cos_f32 v11, v11
    v_cos_f32 v107, v107
    v_fmaak_f32 v10, v12, v10, 1262486016
    v_fmaak_f32 v106, v12, v106, 1262486016
    v_fmaak_f32 v11, v12, v11, 1262486016
    v_fmaak_f32 v107, v12, v107, 1262486016
    v_or3_b32 v5, v10, v106, v5
    v_or3_b32 v5, v11, v107, v5
    v_perm_b32 v106, v106, v10, s43
    v_perm_b32 v107, v107, v11, s43
    v_lshlrev_b32_sdwa v6, 2, v124 dst_sel:DWORD dst_unused:UNUSED_PAD src0_sel:DWORD src1_sel:WORD_0
    v_lshlrev_b32_sdwa v7, 2, v124 dst_sel:DWORD dst_unused:UNUSED_PAD src0_sel:DWORD src1_sel:WORD_1
    v_lshlrev_b32_sdwa v8, 2, v125 dst_sel:DWORD dst_unused:UNUSED_PAD src0_sel:DWORD src1_sel:WORD_0
    v_lshlrev_b32_sdwa v9, 2, v125 dst_sel:DWORD dst_unused:UNUSED_PAD src0_sel:DWORD src1_sel:WORD_1
    ds_write_b32 v6, v73
    ds_write_b32 v7, v74
    ds_write_b32 v8, v76
    ds_write_b32 v9, v77
    v_lshlrev_b32_sdwa v6, 2, v126 dst_sel:DWORD dst_unused:UNUSED_PAD src0_sel:DWORD src1_sel:WORD_0
    v_lshlrev_b32_sdwa v7, 2, v126 dst_sel:DWORD dst_unused:UNUSED_PAD src0_sel:DWORD src1_sel:WORD_1
    v_lshlrev_b32_sdwa v8, 2, v75 dst_sel:DWORD dst_unused:UNUSED_PAD src0_sel:DWORD src1_sel:WORD_0
    v_lshlrev_b32_sdwa v9, 2, v75 dst_sel:DWORD dst_unused:UNUSED_PAD src0_sel:DWORD src1_sel:WORD_1
    ds_write_b32 v6, v78
    ds_write_b32 v7, v80
    ds_write_b32 v8, v81
    ds_write_b32 v9, v82
    s_waitcnt vmcnt(7)
    v_lshlrev_b32 v10, 16, v108
    v_lshlrev_b32 v11, 16, v109
    v_and_b32 v108, 0xffff0000, v108
    v_and_b32 v109, 0xffff0000, v109
    v_mul_f32 v10, s41, v10
    v_mul_f32 v108, s41, v108
    v_mul_f32 v11, s41, v11
    v_mul_f32 v109, s41, v109
    v_fract_f32 v10, v10
    v_fract_f32 v108, v108
    v_fract_f32 v11, v11
    v_fract_f32 v109, v109
    v_cos_f32 v10, v10
    v_cos_f32 v108, v108
    v_cos_f32 v11, v11
    v_cos_f32 v109, v109
    v_fmaak_f32 v10, v12, v10, 1262486016
    v_fmaak_f32 v108, v12, v108, 1262486016
    v_fmaak_f32 v11, v12, v11, 1262486016
    v_fmaak_f32 v109, v12, v109, 1262486016
    v_or3_b32 v5, v10, v108, v5
    v_or3_b32 v5, v11, v109, v5
    v_perm_b32 v108, v108, v10, s43
    v_perm_b32 v109, v109, v11, s43
    s_add_u32 s35, s33, 45154304
    buffer_load_dwordx4 v[24:27], v1, s[8:11], s35 offen nt
    v_lshlrev_b32_sdwa v6, 2, v79 dst_sel:DWORD dst_unused:UNUSED_PAD src0_sel:DWORD src1_sel:WORD_0
    v_lshlrev_b32_sdwa v7, 2, v79 dst_sel:DWORD dst_unused:UNUSED_PAD src0_sel:DWORD src1_sel:WORD_1
    v_lshlrev_b32_sdwa v8, 2, v83 dst_sel:DWORD dst_unused:UNUSED_PAD src0_sel:DWORD src1_sel:WORD_0
    v_lshlrev_b32_sdwa v9, 2, v83 dst_sel:DWORD dst_unused:UNUSED_PAD src0_sel:DWORD src1_sel:WORD_1
    ds_write_b32 v6, v84
    ds_write_b32 v7, v85
    ds_write_b32 v8, v86
    ds_write_b32 v9, v88
    s_waitcnt vmcnt(7)
    v_lshlrev_b32 v10, 16, v110
    v_lshlrev_b32 v11, 16, v111
    v_and_b32 v110, 0xffff0000, v110
    v_and_b32 v111, 0xffff0000, v111
    v_mul_f32 v10, s41, v10
    v_mul_f32 v110, s41, v110
    v_mul_f32 v11, s41, v11
    v_mul_f32 v111, s41, v111
    v_fract_f32 v10, v10
    v_fract_f32 v110, v110
    v_fract_f32 v11, v11
    v_fract_f32 v111, v111
    v_cos_f32 v10, v10
    v_cos_f32 v110, v110
    v_cos_f32 v11, v11
    v_cos_f32 v111, v111
    v_fmaak_f32 v10, v12, v10, 1262486016
    v_fmaak_f32 v110, v12, v110, 1262486016
    v_fmaak_f32 v11, v12, v11, 1262486016
    v_fmaak_f32 v111, v12, v111, 1262486016
    v_or3_b32 v5, v10, v110, v5
    v_or3_b32 v5, v11, v111, v5
    v_perm_b32 v110, v110, v10, s43
    v_perm_b32 v111, v111, v11, s43
    v_lshlrev_b32_sdwa v6, 2, v87 dst_sel:DWORD dst_unused:UNUSED_PAD src0_sel:DWORD src1_sel:WORD_0
    v_lshlrev_b32_sdwa v7, 2, v87 dst_sel:DWORD dst_unused:UNUSED_PAD src0_sel:DWORD src1_sel:WORD_1
    v_lshlrev_b32_sdwa v8, 2, v91 dst_sel:DWORD dst_unused:UNUSED_PAD src0_sel:DWORD src1_sel:WORD_0
    v_lshlrev_b32_sdwa v9, 2, v91 dst_sel:DWORD dst_unused:UNUSED_PAD src0_sel:DWORD src1_sel:WORD_1
    ds_write_b32 v6, v89
    ds_write_b32 v7, v90
    ds_write_b32 v8, v92
    ds_write_b32 v9, v93
    s_mov_b64 exec, s[44:45]
    v_lshlrev_b32_sdwa v6, 2, v95 dst_sel:DWORD dst_unused:UNUSED_PAD src0_sel:DWORD src1_sel:WORD_0
    v_lshlrev_b32_sdwa v7, 2, v95 dst_sel:DWORD dst_unused:UNUSED_PAD src0_sel:DWORD src1_sel:WORD_1
    v_lshlrev_b32_sdwa v8, 2, v99 dst_sel:DWORD dst_unused:UNUSED_PAD src0_sel:DWORD src1_sel:WORD_0
    v_lshlrev_b32_sdwa v9, 2, v99 dst_sel:DWORD dst_unused:UNUSED_PAD src0_sel:DWORD src1_sel:WORD_1
    ds_write_b32 v6, v94
    ds_write_b32 v7, v96
    ds_write_b32 v8, v97
    ds_write_b32 v9, v98
    s_mov_b64 exec, -1
    s_waitcnt vmcnt(6)
    v_lshlrev_b32 v10, 16, v112
    v_lshlrev_b32 v11, 16, v113
    v_and_b32 v112, 0xffff0000, v112
    v_and_b32 v113, 0xffff0000, v113
    v_mul_f32 v10, s41, v10
    v_mul_f32 v112, s41, v112
    v_mul_f32 v11, s41, v11
    v_mul_f32 v113, s41, v113
    v_fract_f32 v10, v10
    v_fract_f32 v112, v112
    v_fract_f32 v11, v11
    v_fract_f32 v113, v113
    v_cos_f32 v10, v10
    v_cos_f32 v112, v112
    v_cos_f32 v11, v11
    v_cos_f32 v113, v113
    v_fmaak_f32 v10, v12, v10, 1262486016
    v_fmaak_f32 v112, v12, v112, 1262486016
    v_fmaak_f32 v11, v12, v11, 1262486016
    v_fmaak_f32 v113, v12, v113, 1262486016
    v_or3_b32 v5, v10, v112, v5
    v_or3_b32 v5, v11, v113, v5
    v_perm_b32 v112, v112, v10, s43
    v_perm_b32 v113, v113, v11, s43
    s_mov_b64 exec, s[44:45]
    s_mov_b64 exec, -1
    s_add_u32 s35, s33, 45154304
    buffer_load_dwordx4 v[28:31], v1, s[12:15], s35 offen nt
    v_lshrrev_b32 v6, 2, v3
    v_sub_u32 v6, v3, v6
    s_waitcnt lgkmcnt(0)
    s_barrier
    s_cmp_lg_u32 s39, 15
    s_cbranch_scc1 L_p1_kernel_nox_3
    ds_read_b32 v12, v6 offset:9984
    ds_read_b32 v13, v6 offset:9988
    ds_read_b32 v14, v6 offset:9992
L_p1_kernel_nox_3:
    ds_read_b32 v48, v6 offset:0
    ds_read_b32 v49, v6 offset:4
    ds_read_b32 v50, v6 offset:8
    ds_read_b32 v52, v6 offset:768
    ds_read_b32 v53, v6 offset:772
    ds_read_b32 v54, v6 offset:776
    ds_read_b32 v56, v6 offset:1536
    ds_read_b32 v57, v6 offset:1540
    ds_read_b32 v58, v6 offset:1544
    ds_read_b32 v60, v6 offset:2304
    ds_read_b32 v61, v6 offset:2308
    ds_read_b32 v62, v6 offset:2312
    ds_read_b32 v64, v6 offset:3072
    ds_read_b32 v65, v6 offset:3076
    ds_read_b32 v66, v6 offset:3080
    ds_read_b32 v68, v6 offset:3840
    ds_read_b32 v69, v6 offset:3844
    ds_read_b32 v70, v6 offset:3848
    ds_read_b32 v72, v6 offset:4608
    ds_read_b32 v73, v6 offset:4612
    ds_read_b32 v74, v6 offset:4616
    ds_read_b32 v76, v6 offset:5376
    ds_read_b32 v77, v6 offset:5380
    ds_read_b32 v78, v6 offset:5384
    ds_read_b32 v80, v6 offset:6144
    ds_read_b32 v81, v6 offset:6148
    ds_read_b32 v82, v6 offset:6152
    ds_read_b32 v84, v6 offset:6912
    ds_read_b32 v85, v6 offset:6916
    ds_read_b32 v86, v6 offset:6920
    ds_read_b32 v88, v6 offset:7680
    ds_read_b32 v89, v6 offset:7684
    ds_read_b32 v90, v6 offset:7688
    ds_read_b32 v92, v6 offset:8448
    ds_read_b32 v93, v6 offset:8452
    ds_read_b32 v94, v6 offset:8456
    ds_read_b32 v96, v6 offset:9216
    ds_read_b32 v97, v6 offset:9220
    ds_read_b32 v98, v6 offset:9224
    s_add_u32 s35, s33, 49348608
    buffer_load_dwordx4 v[32:35], v1, s[8:11], s35 offen nt
    v_mov_b32 v8, 0
    v_mov_b32 v9, 0
    v_mov_b32 v10, 0
    v_mov_b32 v11, 0
    v_mov_b32 v15, 16384
    s_waitcnt lgkmcnt(0)
    s_barrier
    ds_write_b128 v1, v[8:11] offset:0
    s_nop 1
    v_mad_u32_u16 v6, v51, s50, v15 op_sel:[0,0,0,0]
    v_mad_u32_u16 v7, v51, s50, v15 op_sel:[1,0,0,0]
    v_mad_u32_u16 v8, v55, s50, v15 op_sel:[0,0,0,0]
    v_mad_u32_u16 v9, v55, s50, v15 op_sel:[1,0,0,0]
    v_add_u32_sdwa v6, v6, v51 dst_sel:DWORD dst_unused:UNUSED_PAD src0_sel:WORD_1 src1_sel:WORD_0
    v_add_u32_sdwa v7, v7, v51 dst_sel:DWORD dst_unused:UNUSED_PAD src0_sel:WORD_1 src1_sel:WORD_1
    v_add_u32_sdwa v8, v8, v55 dst_sel:DWORD dst_unused:UNUSED_PAD src0_sel:WORD_1 src1_sel:WORD_0
    v_add_u32_sdwa v9, v9, v55 dst_sel:DWORD dst_unused:UNUSED_PAD src0_sel:WORD_1 src1_sel:WORD_1
    v_add_u32 v6, v6, v6
    v_add_u32 v7, v7, v7
    v_add_u32 v8, v8, v8
    v_add_u32 v9, v9, v9
    ds_write_b16 v6, v100 offset:16384
    ds_write_b16_d16_hi v7, v100 offset:16384
    ds_write_b16 v8, v101 offset:16384
    ds_write_b16_d16_hi v9, v101 offset:16384
    v_mov_b32 v6, 1140817920
    s_waitcnt vmcnt(7)
    v_lshlrev_b32 v10, 16, v114
    v_lshlrev_b32 v11, 16, v115
    v_and_b32 v114, 0xffff0000, v114
    v_and_b32 v115, 0xffff0000, v115
    v_mul_f32 v10, s41, v10
    v_mul_f32 v114, s41, v114
    v_mul_f32 v11, s41, v11
    v_mul_f32 v115, s41, v115
    v_fract_f32 v10, v10
    v_fract_f32 v114, v114
    v_fract_f32 v11, v11
    v_fract_f32 v115, v115
    v_cos_f32 v10, v10
    v_cos_f32 v114, v114
    v_cos_f32 v11, v11
    v_cos_f32 v115, v115
    v_fmaak_f32 v10, v6, v10, 1262486016
    v_fmaak_f32 v114, v6, v114, 1262486016
    v_fmaak_f32 v11, v6, v11, 1262486016
    v_fmaak_f32 v115, v6, v115, 1262486016
    v_or3_b32 v5, v10, v114, v5
    v_or3_b32 v5, v11, v115, v5
    v_perm_b32 v114, v114, v10, s43
    v_perm_b32 v115, v115, v11, s43
    v_mad_u32_u16 v6, v59, s50, v15 op_sel:[0,0,0,0]
    v_mad_u32_u16 v7, v59, s50, v15 op_sel:[1,0,0,0]
    v_mad_u32_u16 v8, v63, s50, v15 op_sel:[0,0,0,0]
    v_mad_u32_u16 v9, v63, s50, v15 op_sel:[1,0,0,0]
    v_add_u32_sdwa v6, v6, v59 dst_sel:DWORD dst_unused:UNUSED_PAD src0_sel:WORD_1 src1_sel:WORD_0
    v_add_u32_sdwa v7, v7, v59 dst_sel:DWORD dst_unused:UNUSED_PAD src0_sel:WORD_1 src1_sel:WORD_1
    v_add_u32_sdwa v8, v8, v63 dst_sel:DWORD dst_unused:UNUSED_PAD src0_sel:WORD_1 src1_sel:WORD_0
    v_add_u32_sdwa v9, v9, v63 dst_sel:DWORD dst_unused:UNUSED_PAD src0_sel:WORD_1 src1_sel:WORD_1
    v_add_u32 v6, v6, v6
    v_add_u32 v7, v7, v7
    v_add_u32 v8, v8, v8
    v_add_u32 v9, v9, v9
    ds_write_b16 v6, v102 offset:16384
    ds_write_b16_d16_hi v7, v102 offset:16384
    ds_write_b16 v8, v103 offset:16384
    ds_write_b16_d16_hi v9, v103 offset:16384
    v_mad_u32_u16 v6, v67, s50, v15 op_sel:[0,0,0,0]
    v_mad_u32_u16 v7, v67, s50, v15 op_sel:[1,0,0,0]
    v_mad_u32_u16 v8, v71, s50, v15 op_sel:[0,0,0,0]
    v_mad_u32_u16 v9, v71, s50, v15 op_sel:[1,0,0,0]
    v_add_u32_sdwa v6, v6, v67 dst_sel:DWORD dst_unused:UNUSED_PAD src0_sel:WORD_1 src1_sel:WORD_0
    v_add_u32_sdwa v7, v7, v67 dst_sel:DWORD dst_unused:UNUSED_PAD src0_sel:WORD_1 src1_sel:WORD_1
    v_add_u32_sdwa v8, v8, v71 dst_sel:DWORD dst_unused:UNUSED_PAD src0_sel:WORD_1 src1_sel:WORD_0
    v_add_u32_sdwa v9, v9, v71 dst_sel:DWORD dst_unused:UNUSED_PAD src0_sel:WORD_1 src1_sel:WORD_1
    v_add_u32 v6, v6, v6
    v_add_u32 v7, v7, v7
    v_add_u32 v8, v8, v8
    v_add_u32 v9, v9, v9
    ds_write_b16 v6, v104 offset:16384
    ds_write_b16_d16_hi v7, v104 offset:16384
    ds_write_b16 v8, v105 offset:16384
    ds_write_b16_d16_hi v9, v105 offset:16384
    s_add_u32 s35, s33, 49348608
    buffer_load_dwordx4 v[36:39], v1, s[12:15], s35 offen nt
    v_mad_u32_u16 v6, v120, s50, v15 op_sel:[0,0,0,0]
    v_mad_u32_u16 v7, v120, s50, v15 op_sel:[1,0,0,0]
    v_mad_u32_u16 v8, v121, s50, v15 op_sel:[0,0,0,0]
    v_mad_u32_u16 v9, v121, s50, v15 op_sel:[1,0,0,0]
    v_add_u32_sdwa v6, v6, v120 dst_sel:DWORD dst_unused:UNUSED_PAD src0_sel:WORD_1 src1_sel:WORD_0
    v_add_u32_sdwa v7, v7, v120 dst_sel:DWORD dst_unused:UNUSED_PAD src0_sel:WORD_1 src1_sel:WORD_1
    v_add_u32_sdwa v8, v8, v121 dst_sel:DWORD dst_unused:UNUSED_PAD src0_sel:WORD_1 src1_sel:WORD_0
    v_add_u32_sdwa v9, v9, v121 dst_sel:DWORD dst_unused:UNUSED_PAD src0_sel:WORD_1 src1_sel:WORD_1
    v_add_u32 v6, v6, v6
    v_add_u32 v7, v7, v7
    v_add_u32 v8, v8, v8
    v_add_u32 v9, v9, v9
    ds_write_b16 v6, v106 offset:16384
    ds_write_b16_d16_hi v7, v106 offset:16384
    ds_write_b16 v8, v107 offset:16384
    ds_write_b16_d16_hi v9, v107 offset:16384
    v_mov_b32 v6, 1140817920
    s_waitcnt vmcnt(7)
    v_lshlrev_b32 v10, 16, v116
    v_lshlrev_b32 v11, 16, v117
    v_and_b32 v116, 0xffff0000, v116
    v_and_b32 v117, 0xffff0000, v117
    v_mul_f32 v10, s41, v10
    v_mul_f32 v116, s41, v116
    v_mul_f32 v11, s41, v11
    v_mul_f32 v117, s41, v117
    v_fract_f32 v10, v10
    v_fract_f32 v116, v116
    v_fract_f32 v11, v11
    v_fract_f32 v117, v117
    v_cos_f32 v10, v10
    v_cos_f32 v116, v116
    v_cos_f32 v11, v11
    v_cos_f32 v117, v117
    v_fmaak_f32 v10, v6, v10, 1262486016
    v_fmaak_f32 v116, v6, v116, 1262486016
    v_fmaak_f32 v11, v6, v11, 1262486016
    v_fmaak_f32 v117, v6, v117, 1262486016
    v_or3_b32 v5, v10, v116, v5
    v_or3_b32 v5, v11, v117, v5
    v_perm_b32 v116, v116, v10, s43
    v_perm_b32 v117, v117, v11, s43
    v_mad_u32_u16 v6, v122, s50, v15 op_sel:[0,0,0,0]
    v_mad_u32_u16 v7, v122, s50, v15 op_sel:[1,0,0,0]
    v_mad_u32_u16 v8, v123, s50, v15 op_sel:[0,0,0,0]
    v_mad_u32_u16 v9, v123, s50, v15 op_sel:[1,0,0,0]
    v_add_u32_sdwa v6, v6, v122 dst_sel:DWORD dst_unused:UNUSED_PAD src0_sel:WORD_1 src1_sel:WORD_0
    v_add_u32_sdwa v7, v7, v122 dst_sel:DWORD dst_unused:UNUSED_PAD src0_sel:WORD_1 src1_sel:WORD_1
    v_add_u32_sdwa v8, v8, v123 dst_sel:DWORD dst_unused:UNUSED_PAD src0_sel:WORD_1 src1_sel:WORD_0
    v_add_u32_sdwa v9, v9, v123 dst_sel:DWORD dst_unused:UNUSED_PAD src0_sel:WORD_1 src1_sel:WORD_1
    v_add_u32 v6, v6, v6
    v_add_u32 v7, v7, v7
    v_add_u32 v8, v8, v8
    v_add_u32 v9, v9, v9
    ds_write_b16 v6, v108 offset:16384
    ds_write_b16_d16_hi v7, v108 offset:16384
    ds_write_b16 v8, v109 offset:16384
    ds_write_b16_d16_hi v9, v109 offset:16384
    v_mad_u32_u16 v6, v124, s50, v15 op_sel:[0,0,0,0]
    v_mad_u32_u16 v7, v124, s50, v15 op_sel:[1,0,0,0]
    v_mad_u32_u16 v8, v125, s50, v15 op_sel:[0,0,0,0]
    v_mad_u32_u16 v9, v125, s50, v15 op_sel:[1,0,0,0]
    v_add_u32_sdwa v6, v6, v124 dst_sel:DWORD dst_unused:UNUSED_PAD src0_sel:WORD_1 src1_sel:WORD_0
    v_add_u32_sdwa v7, v7, v124 dst_sel:DWORD dst_unused:UNUSED_PAD src0_sel:WORD_1 src1_sel:WORD_1
    v_add_u32_sdwa v8, v8, v125 dst_sel:DWORD dst_unused:UNUSED_PAD src0_sel:WORD_1 src1_sel:WORD_0
    v_add_u32_sdwa v9, v9, v125 dst_sel:DWORD dst_unused:UNUSED_PAD src0_sel:WORD_1 src1_sel:WORD_1
    v_add_u32 v6, v6, v6
    v_add_u32 v7, v7, v7
    v_add_u32 v8, v8, v8
    v_add_u32 v9, v9, v9
    ds_write_b16 v6, v110 offset:16384
    ds_write_b16_d16_hi v7, v110 offset:16384
    ds_write_b16 v8, v111 offset:16384
    ds_write_b16_d16_hi v9, v111 offset:16384
    s_add_u32 s35, s33, 53542912
    buffer_load_dwordx4 v[40:43], v1, s[8:11], s35 offen nt
    v_mad_u32_u16 v6, v126, s50, v15 op_sel:[0,0,0,0]
    v_mad_u32_u16 v7, v126, s50, v15 op_sel:[1,0,0,0]
    v_mad_u32_u16 v8, v75, s50, v15 op_sel:[0,0,0,0]
    v_mad_u32_u16 v9, v75, s50, v15 op_sel:[1,0,0,0]
    v_add_u32_sdwa v6, v6, v126 dst_sel:DWORD dst_unused:UNUSED_PAD src0_sel:WORD_1 src1_sel:WORD_0
    v_add_u32_sdwa v7, v7, v126 dst_sel:DWORD dst_unused:UNUSED_PAD src0_sel:WORD_1 src1_sel:WORD_1
    v_add_u32_sdwa v8, v8, v75 dst_sel:DWORD dst_unused:UNUSED_PAD src0_sel:WORD_1 src1_sel:WORD_0
    v_add_u32_sdwa v9, v9, v75 dst_sel:DWORD dst_unused:UNUSED_PAD src0_sel:WORD_1 src1_sel:WORD_1
    v_add_u32 v6, v6, v6
    v_add_u32 v7, v7, v7
    v_add_u32 v8, v8, v8
    v_add_u32 v9, v9, v9
    ds_write_b16 v6, v112 offset:16384
    ds_write_b16_d16_hi v7, v112 offset:16384
    ds_write_b16 v8, v113 offset:16384
    ds_write_b16_d16_hi v9, v113 offset:16384
    v_mov_b32 v6, 1140817920
    s_mov_b64 exec, s[44:45]
    s_waitcnt vmcnt(7)
    v_lshlrev_b32 v10, 16, v118
    v_lshlrev_b32 v11, 16, v119
    v_and_b32 v118, 0xffff0000, v118
    v_and_b32 v119, 0xffff0000, v119
    v_mul_f32 v10, s41, v10
    v_mul_f32 v118, s41, v118
    v_mul_f32 v11, s41, v11
    v_mul_f32 v119, s41, v119
    v_fract_f32 v10, v10
    v_fract_f32 v118, v118
    v_fract_f32 v11, v11
    v_fract_f32 v119, v119
    v_cos_f32 v10, v10
    v_cos_f32 v118, v118
    v_cos_f32 v11, v11
    v_cos_f32 v119, v119
    v_fmaak_f32 v10, v6, v10, 1262486016
    v_fmaak_f32 v118, v6, v118, 1262486016
    v_fmaak_f32 v11, v6, v11, 1262486016
    v_fmaak_f32 v119, v6, v119, 1262486016
    v_or3_b32 v5, v10, v118, v5
    v_or3_b32 v5, v11, v119, v5
    v_perm_b32 v118, v118, v10, s43
    v_perm_b32 v119, v119, v11, s43
    s_mov_b64 exec, -1
    v_mad_u32_u16 v6, v79, s50, v15 op_sel:[0,0,0,0]
    v_mad_u32_u16 v7, v79, s50, v15 op_sel:[1,0,0,0]
    v_mad_u32_u16 v8, v83, s50, v15 op_sel:[0,0,0,0]
    v_mad_u32_u16 v9, v83, s50, v15 op_sel:[1,0,0,0]
    v_add_u32_sdwa v6, v6, v79 dst_sel:DWORD dst_unused:UNUSED_PAD src0_sel:WORD_1 src1_sel:WORD_0
    v_add_u32_sdwa v7, v7, v79 dst_sel:DWORD dst_unused:UNUSED_PAD src0_sel:WORD_1 src1_sel:WORD_1
    v_add_u32_sdwa v8, v8, v83 dst_sel:DWORD dst_unused:UNUSED_PAD src0_sel:WORD_1 src1_sel:WORD_0
    v_add_u32_sdwa v9, v9, v83 dst_sel:DWORD dst_unused:UNUSED_PAD src0_sel:WORD_1 src1_sel:WORD_1
    v_add_u32 v6, v6, v6
    v_add_u32 v7, v7, v7
    v_add_u32 v8, v8, v8
    v_add_u32 v9, v9, v9
    ds_write_b16 v6, v114 offset:16384
    ds_write_b16_d16_hi v7, v114 offset:16384
    ds_write_b16 v8, v115 offset:16384
    ds_write_b16_d16_hi v9, v115 offset:16384
    v_mad_u32_u16 v6, v87, s50, v15 op_sel:[0,0,0,0]
    v_mad_u32_u16 v7, v87, s50, v15 op_sel:[1,0,0,0]
    v_mad_u32_u16 v8, v91, s50, v15 op_sel:[0,0,0,0]
    v_mad_u32_u16 v9, v91, s50, v15 op_sel:[1,0,0,0]
    v_add_u32_sdwa v6, v6, v87 dst_sel:DWORD dst_unused:UNUSED_PAD src0_sel:WORD_1 src1_sel:WORD_0
    v_add_u32_sdwa v7, v7, v87 dst_sel:DWORD dst_unused:UNUSED_PAD src0_sel:WORD_1 src1_sel:WORD_1
    v_add_u32_sdwa v8, v8, v91 dst_sel:DWORD dst_unused:UNUSED_PAD src0_sel:WORD_1 src1_sel:WORD_0
    v_add_u32_sdwa v9, v9, v91 dst_sel:DWORD dst_unused:UNUSED_PAD src0_sel:WORD_1 src1_sel:WORD_1
    v_add_u32 v6, v6, v6
    v_add_u32 v7, v7, v7
    v_add_u32 v8, v8, v8
    v_add_u32 v9, v9, v9
    ds_write_b16 v6, v116 offset:16384
    ds_write_b16_d16_hi v7, v116 offset:16384
    ds_write_b16 v8, v117 offset:16384
    ds_write_b16_d16_hi v9, v117 offset:16384
    s_add_u32 s35, s33, 53542912
    buffer_load_dwordx4 v[44:47], v1, s[12:15], s35 offen nt
    s_mov_b64 exec, s[44:45]
    v_mad_u32_u16 v6, v95, s50, v15 op_sel:[0,0,0,0]
    v_mad_u32_u16 v7, v95, s50, v15 op_sel:[1,0,0,0]
    v_mad_u32_u16 v8, v99, s50, v15 op_sel:[0,0,0,0]
    v_mad_u32_u16 v9, v99, s50, v15 op_sel:[1,0,0,0]
    v_add_u32_sdwa v6, v6, v95 dst_sel:DWORD dst_unused:UNUSED_PAD src0_sel:WORD_1 src1_sel:WORD_0
    v_add_u32_sdwa v7, v7, v95 dst_sel:DWORD dst_unused:UNUSED_PAD src0_sel:WORD_1 src1_sel:WORD_1
    v_add_u32_sdwa v8, v8, v99 dst_sel:DWORD dst_unused:UNUSED_PAD src0_sel:WORD_1 src1_sel:WORD_0
    v_add_u32_sdwa v9, v9, v99 dst_sel:DWORD dst_unused:UNUSED_PAD src0_sel:WORD_1 src1_sel:WORD_1
    v_add_u32 v6, v6, v6
    v_add_u32 v7, v7, v7
    v_add_u32 v8, v8, v8
    v_add_u32 v9, v9, v9
    ds_write_b16 v6, v118 offset:16384
    ds_write_b16_d16_hi v7, v118 offset:16384
    ds_write_b16 v8, v119 offset:16384
    ds_write_b16_d16_hi v9, v119 offset:16384
    s_mov_b64 exec, -1
    v_lshrrev_b32 v6, 1, v3
    s_waitcnt lgkmcnt(0)
    s_barrier
    ds_read_b64 v[100:101], v6 offset:23040
    ds_read_b64 v[102:103], v6 offset:19456
    ds_read_b64 v[104:105], v6 offset:19968
    ds_read_b64 v[106:107], v6 offset:16384
    ds_read_b64 v[108:109], v6 offset:20480
    ds_read_b64 v[110:111], v6 offset:16896
    ds_read_b64 v[112:113], v6 offset:20992
    ds_read_b64 v[114:115], v6 offset:17408
    ds_read_b64 v[116:117], v6 offset:21504
    ds_read_b64 v[118:119], v6 offset:17920
    ds_read_b64 v[120:121], v6 offset:22016
    ds_read_b64 v[122:123], v6 offset:18432
    ds_read_b64 v[124:125], v6 offset:22528
    ds_read_b64 v[126:127], v6 offset:18944
    s_add_u32 s32, s32, 256
    s_add_u32 s33, s33, 40960000
    s_add_u32 s34, s34, 20480000
    s_add_u32 s40, s40, 1
    s_cmp_lt_u32 s40, 4
    s_cbranch_scc1 L_p1_loop
    s_waitcnt lgkmcnt(13)
    v_lshlrev_b32 v15, 22, v100
    v_lshrrev_b32 v100, 16, v100
    v_alignbit_b32 v15, v100, v15, 10
    v_alignbit_b32 v15, v101, v15, 10
    v_xor_b32 v15, 0x80200800, v15
    s_cmp_lg_u32 s39, 15
    s_cbranch_scc1 L_p1_kernel_nox_4
    s_mov_b32 s36, 13312
    buffer_store_dwordx4 v[12:15], v3, s[20:23], s36 offen sc1
L_p1_kernel_nox_4:
    s_waitcnt lgkmcnt(12)
    v_lshlrev_b32 v75, 22, v102
    v_lshrrev_b32 v102, 16, v102
    v_alignbit_b32 v75, v102, v75, 10
    v_alignbit_b32 v75, v103, v75, 10
    v_xor_b32 v75, 0x80200800, v75
    s_mov_b32 s36, 6144
    buffer_store_dwordx4 v[72:75], v3, s[20:23], s36 offen sc1
    s_waitcnt lgkmcnt(11)
    v_lshlrev_b32 v79, 22, v104
    v_lshrrev_b32 v104, 16, v104
    v_alignbit_b32 v79, v104, v79, 10
    v_alignbit_b32 v79, v105, v79, 10
    v_xor_b32 v79, 0x80200800, v79
    s_mov_b32 s36, 7168
    buffer_store_dwordx4 v[76:79], v3, s[20:23], s36 offen sc1
    s_waitcnt lgkmcnt(10)
    v_lshlrev_b32 v51, 22, v106
    v_lshrrev_b32 v106, 16, v106
    v_alignbit_b32 v51, v106, v51, 10
    v_alignbit_b32 v51, v107, v51, 10
    v_xor_b32 v51, 0x80200800, v51
    s_mov_b32 s36, 0
    buffer_store_dwordx4 v[48:51], v3, s[20:23], s36 offen sc1
    s_waitcnt lgkmcnt(9)
    v_lshlrev_b32 v83, 22, v108
    v_lshrrev_b32 v108, 16, v108
    v_alignbit_b32 v83, v108, v83, 10
    v_alignbit_b32 v83, v109, v83, 10
    v_xor_b32 v83, 0x80200800, v83
    s_mov_b32 s36, 8192
    buffer_store_dwordx4 v[80:83], v3, s[20:23], s36 offen sc1
    s_waitcnt lgkmcnt(8)
    v_lshlrev_b32 v55, 22, v110
    v_lshrrev_b32 v110, 16, v110
    v_alignbit_b32 v55, v110, v55, 10
    v_alignbit_b32 v55, v111, v55, 10
    v_xor_b32 v55, 0x80200800, v55
    s_mov_b32 s36, 1024
    buffer_store_dwordx4 v[52:55], v3, s[20:23], s36 offen sc1
    s_waitcnt lgkmcnt(7)
    v_lshlrev_b32 v87, 22, v112
    v_lshrrev_b32 v112, 16, v112
    v_alignbit_b32 v87, v112, v87, 10
    v_alignbit_b32 v87, v113, v87, 10
    v_xor_b32 v87, 0x80200800, v87
    s_mov_b32 s36, 9216
    buffer_store_dwordx4 v[84:87], v3, s[20:23], s36 offen sc1
    s_waitcnt lgkmcnt(6)
    v_lshlrev_b32 v59, 22, v114
    v_lshrrev_b32 v114, 16, v114
    v_alignbit_b32 v59, v114, v59, 10
    v_alignbit_b32 v59, v115, v59, 10
    v_xor_b32 v59, 0x80200800, v59
    s_mov_b32 s36, 2048
    buffer_store_dwordx4 v[56:59], v3, s[20:23], s36 offen sc1
    s_waitcnt lgkmcnt(5)
    v_lshlrev_b32 v91, 22, v116
    v_lshrrev_b32 v116, 16, v116
    v_alignbit_b32 v91, v116, v91, 10
    v_alignbit_b32 v91, v117, v91, 10
    v_xor_b32 v91, 0x80200800, v91
    s_mov_b32 s36, 10240
    buffer_store_dwordx4 v[88:91], v3, s[20:23], s36 offen sc1
    s_waitcnt lgkmcnt(4)
    v_lshlrev_b32 v63, 22, v118
    v_lshrrev_b32 v118, 16, v118
    v_alignbit_b32 v63, v118, v63, 10
    v_alignbit_b32 v63, v119, v63, 10
    v_xor_b32 v63, 0x80200800, v63
    s_mov_b32 s36, 3072
    buffer_store_dwordx4 v[60:63], v3, s[20:23], s36 offen sc1
    s_waitcnt lgkmcnt(3)
    v_lshlrev_b32 v95, 22, v120
    v_lshrrev_b32 v120, 16, v120
    v_alignbit_b32 v95, v120, v95, 10
    v_alignbit_b32 v95, v121, v95, 10
    v_xor_b32 v95, 0x80200800, v95
    s_mov_b32 s36, 11264
    buffer_store_dwordx4 v[92:95], v3, s[20:23], s36 offen sc1
    s_waitcnt lgkmcnt(2)
    v_lshlrev_b32 v67, 22, v122
    v_lshrrev_b32 v122, 16, v122
    v_alignbit_b32 v67, v122, v67, 10
    v_alignbit_b32 v67, v123, v67, 10
    v_xor_b32 v67, 0x80200800, v67
    s_mov_b32 s36, 4096
    buffer_store_dwordx4 v[64:67], v3, s[20:23], s36 offen sc1
    s_waitcnt lgkmcnt(1)
    v_lshlrev_b32 v99, 22, v124
    v_lshrrev_b32 v124, 16, v124
    v_alignbit_b32 v99, v124, v99, 10
    v_alignbit_b32 v99, v125, v99, 10
    v_xor_b32 v99, 0x80200800, v99
    s_mov_b32 s36, 12288
    buffer_store_dwordx4 v[96:99], v3, s[20:23], s36 offen sc1
    s_waitcnt lgkmcnt(0)
    v_lshlrev_b32 v71, 22, v126
    v_lshrrev_b32 v126, 16, v126
    v_alignbit_b32 v71, v126, v71, 10
    v_alignbit_b32 v71, v127, v71, 10
    v_xor_b32 v71, 0x80200800, v71
    s_mov_b32 s36, 5120
    buffer_store_dwordx4 v[68:71], v3, s[20:23], s36 offen sc1
    v_and_b32 v6, 0x34800000, v5
    v_cmp_ne_u32 vcc, 0, v6
    s_lshl_b32 s35, s39, 4
    s_add_u32 s35, s35, 160328
    v_mov_b32 v10, s35
    s_cmp_lg_u64 vcc, 0
    s_cselect_b32 s36, 1, s55
    v_mov_b32 v11, s36
    ds_write_b32 v10, v11
    s_waitcnt lgkmcnt(0)
    s_barrier
    s_cmp_lg_u32 s39, 0
    s_cbranch_scc1 L_p1_end
    v_and_b32 v6, 15, v0
    v_lshlrev_b32 v6, 4, v6
    v_add_u32 v6, 160320, v6
    ds_read_b128 v[8:11], v6
    s_waitcnt lgkmcnt(0)
    s_nop 1
    v_max_u32_dpp v8, v8, v8 row_shr:1 row_mask:0xf bank_mask:0xf bound_ctrl:0
    s_nop 1
    v_max_u32_dpp v8, v8, v8 row_shr:2 row_mask:0xf bank_mask:0xf bound_ctrl:0
    s_nop 1
    v_max_u32_dpp v8, v8, v8 row_shr:4 row_mask:0xf bank_mask:0xf bound_ctrl:0
    s_nop 1
    v_max_u32_dpp v8, v8, v8 row_shr:8 row_mask:0xf bank_mask:0xf bound_ctrl:0
    s_nop 1
    v_add_f32_dpp v9, v9, v9 row_shr:1 row_mask:0xf bank_mask:0xf bound_ctrl:0
    s_nop 1
    v_add_f32_dpp v9, v9, v9 row_shr:2 row_mask:0xf bank_mask:0xf bound_ctrl:0
    s_nop 1
    v_add_f32_dpp v9, v9, v9 row_shr:4 row_mask:0xf bank_mask:0xf bound_ctrl:0
    s_nop 1
    v_add_f32_dpp v9, v9, v9 row_shr:8 row_mask:0xf bank_mask:0xf bound_ctrl:0
    s_nop 1
    v_or_b32_dpp v10, v10, v10 row_shr:1 row_mask:0xf bank_mask:0xf bound_ctrl:0
    s_nop 1
    v_or_b32_dpp v10, v10, v10 row_shr:2 row_mask:0xf bank_mask:0xf bound_ctrl:0
    s_nop 1
    v_or_b32_dpp v10, v10, v10 row_shr:4 row_mask:0xf bank_mask:0xf bound_ctrl:0
    s_nop 1
    v_or_b32_dpp v10, v10, v10 row_shr:8 row_mask:0xf bank_mask:0xf bound_ctrl:0
    s_lshl_b32 s35, s2, 3
    s_add_u32 s35, s35, 8552960
    v_mov_b32 v6, 0
    v_lshl_or_b32 v8, v10, 16, v8
    s_mov_b64 exec, 0x8000
    buffer_store_dwordx2 v[8:9], v6, s[24:27], s35 offen
    s_lshl_b32 s35, s2, 8
    s_add_u32 s35, s35, 8561152
    buffer_store_dword v6, v6, s[24:27], s35 offen
L_p1_end:
    s_endpgm
.globl p2_kernel
.p2align 8
.type p2_kernel,@function
p2_kernel:
    s_cmp_ge_u32 s2, 256
    s_cbranch_scc1 L_p2_end
    s_load_dwordx2 s[4:5], s[0:1], 104
    s_load_dwordx2 s[100:101], s[0:1], 24
    s_load_dwordx2 s[30:31], s[0:1], 40
    s_load_dwordx4 s[32:35], s[0:1], 56
    s_load_dwordx4 s[36:39], s[0:1], 72
    s_and_b32 s14, s2, 7
    s_lshr_b32 s49, s2, 3
    s_and_b32 s3, s14, 1
    s_lshl_b32 s3, s3, 5
    s_add_u32 s3, s3, s49
    s_lshr_b32 s12, s14, 1
    v_lshrrev_b32 v108, 6, v0
    v_lshlrev_b32 v1, 4, v0
    v_and_b32 v109, 63, v0
    v_readfirstlane_b32 s13, v108
    v_lshlrev_b32 v111, 4, v109
    s_mul_i32 s14, s12, 65
    s_add_u32 s14, s14, s3
    s_mul_i32 s14, s14, 32896
    s_add_u32 s25, s14, 219029504
    s_mul_i32 s22, s12, 1280000
    s_mov_b32 s2, 0
    s_waitcnt lgkmcnt(0)
    s_mov_b32 s6, 655360000
    s_mov_b32 s7, 0x00020000
    s_add_u32 s8, s4, 227607040
    s_addc_u32 s9, s5, 0
    s_add_u32 s10, s22, 1280000
    s_mov_b32 s11, 0x00020000
    s_add_u32 s15, s25, 0
    buffer_load_dwordx4 v[28:31], v1, s[4:7], s15 offen
    s_add_u32 s15, s25, 32896
    buffer_load_dwordx4 v[36:39], v1, s[4:7], s15 offen
    s_load_dwordx4 s[40:43], s[30:31], 0
    s_load_dwordx16 s[52:67], s[32:33], 0
    s_load_dwordx16 s[68:83], s[34:35], 0
    s_load_dwordx8 s[84:91], s[36:37], 0
    s_load_dwordx8 s[92:99], s[38:39], 0
    v_mov_b32 v52, 0x100
    s_cmp_lg_u32 s13, 0
    s_cbranch_scc1 L_p2_noann
    s_lshl_b32 s14, s3, 8
    s_add_u32 s14, s14, 227590656
    s_mov_b64 exec, 1
    buffer_atomic_add v52, off, s[4:7], s14
    s_mov_b64 exec, -1
L_p2_noann:
    s_add_u32 s14, s22, 0
    buffer_load_dwordx4 v[88:91], v1, s[8:11], s14 offen
    s_add_u32 s14, s22, 16384
    buffer_load_dwordx4 v[92:95], v1, s[8:11], s14 offen
    s_add_u32 s14, s22, 32768
    buffer_load_dwordx4 v[96:99], v1, s[8:11], s14 offen
    s_add_u32 s14, s22, 49152
    buffer_load_dwordx4 v[100:103], v1, s[8:11], s14 offen
    s_add_u32 s14, s22, 65536
    buffer_load_dwordx4 v[104:107], v1, s[8:11], s14 offen
    s_mov_b32 s15, 227582464
    buffer_load_dwordx4 v[80:83], v111, s[4:7], s15 offen offset:0
    buffer_load_dwordx4 v[84:87], v111, s[4:7], s15 offen offset:1024
    s_add_u32 s15, s25, 16384
    buffer_load_dwordx4 v[32:35], v1, s[4:7], s15 offen
    s_add_u32 s15, s25, 49280
    buffer_load_dwordx4 v[40:43], v1, s[4:7], s15 offen
    v_add_u32 v2, 3072, v111
    v_mov_b32 v50, 21845
    v_add_u32 v3, 80000, v1
    v_add_u32 v124, 145536, v1
    v_add_u32 v113, 65536, v1
    v_mov_b32 v112, 0x7f000000
    v_cmp_gt_u32 vcc, 904, v0
    s_mul_i32 s19, s13, 240
    s_add_u32 s19, s19, 160000
    v_cndmask_b32 v124, v112, v124, vcc
    v_cndmask_b32 v113, v112, v113, vcc
    v_lshl_add_u32 v6, v109, 2, s19
    v_lshl_add_u32 v126, v109, 1, s19
    v_cmp_gt_u32 vcc, 10, v109
    s_mul_i32 s27, s13, 13688832
    s_mov_b32 s23, 213888
    v_cndmask_b32 v6, v112, v6, vcc
    s_mov_b32 s44, s4
    s_mov_b32 s45, s5
    s_add_u32 s46, s27, 13697024
    s_mov_b32 s47, 0x00020000
    s_mov_b32 s17, 0x05040100
    s_mov_b32 s18, 80000
    s_and_b32 s50, s3, 1
    s_lshl_b32 s50, s50, 18
    s_sub_u32 s50, 4294836224, s50
    s_mov_b32 s20, 3221209088
    s_mov_b32 s21, 3221209087
    v_mov_b32 v4, 0
    v_mov_b32 v5, 0
    v_mov_b32 v114, 320
    ds_write_b32 v6, v5 offset:160
    ds_write_b16 v126, v114 offset:2
    v_mov_b32 v44, 1073758208
    v_mov_b32 v45, 1073758208
    v_mov_b32 v46, 1073758208
    v_mov_b32 v47, 1073758208
    v_mov_b32 v48, 1073758208
    v_mov_b32 v49, 1073758208
    ds_write_b128 v1, v[44:47] offset:0
    ds_write_b128 v1, v[44:47] offset:16384
    ds_write_b128 v1, v[44:47] offset:32768
    ds_write_b128 v1, v[44:47] offset:49152
    ds_write_b128 v113, v[44:47]
    s_waitcnt lgkmcnt(0)
    v_mov_b32 v53, s40
    v_mov_b32 v54, s41
    v_mov_b32 v56, s42
    v_mov_b32 v57, s43
    s_mov_b32 s40, 20987904
    s_mov_b32 s41, 21031594
    s_pack_ll_b32_b16 s14, s52, s54
    s_pack_hh_b32_b16 s15, s52, s54
    s_pack_ll_b32_b16 s54, s53, s55
    s_pack_hh_b32_b16 s55, s53, s55
    s_mov_b32 s52, s14
    s_mov_b32 s53, s15
    s_pack_ll_b32_b16 s14, s56, s58
    s_pack_hh_b32_b16 s15, s56, s58
    s_pack_ll_b32_b16 s58, s57, s59
    s_pack_hh_b32_b16 s59, s57, s59
    s_mov_b32 s56, s14
    s_mov_b32 s57, s15
    s_pack_ll_b32_b16 s14, s60, s62
    s_pack_hh_b32_b16 s15, s60, s62
    s_pack_ll_b32_b16 s62, s61, s63
    s_pack_hh_b32_b16 s63, s61, s63
    s_mov_b32 s60, s14
    s_mov_b32 s61, s15
    s_pack_ll_b32_b16 s14, s64, s66
    s_pack_hh_b32_b16 s15, s64, s66
    s_pack_ll_b32_b16 s66, s65, s67
    s_pack_hh_b32_b16 s67, s65, s67
    s_mov_b32 s64, s14
    s_mov_b32 s65, s15
    s_pack_ll_b32_b16 s14, s68, s70
    s_pack_hh_b32_b16 s15, s68, s70
    s_pack_ll_b32_b16 s70, s69, s71
    s_pack_hh_b32_b16 s71, s69, s71
    s_mov_b32 s68, s14
    s_mov_b32 s69, s15
    s_pack_ll_b32_b16 s14, s72, s74
    s_pack_hh_b32_b16 s15, s72, s74
    s_pack_ll_b32_b16 s74, s73, s75
    s_pack_hh_b32_b16 s75, s73, s75
    s_mov_b32 s72, s14
    s_mov_b32 s73, s15
    s_pack_ll_b32_b16 s14, s76, s78
    s_pack_hh_b32_b16 s15, s76, s78
    s_pack_ll_b32_b16 s78, s77, s79
    s_pack_hh_b32_b16 s79, s77, s79
    s_mov_b32 s76, s14
    s_mov_b32 s77, s15
    s_pack_ll_b32_b16 s14, s80, s82
    s_pack_hh_b32_b16 s15, s80, s82
    s_pack_ll_b32_b16 s82, s81, s83
    s_pack_hh_b32_b16 s83, s81, s83
    s_mov_b32 s80, s14
    s_mov_b32 s81, s15
    s_waitcnt vmcnt(9)
    v_mad_u32_u16 v108, v28, v50, s40 op_sel:[0,0,0,0]
    v_mad_u32_u16 v109, v36, v50, s41 op_sel:[0,0,0,0]
    v_sub_u32_sdwa v110, v109, v108 dst_sel:DWORD dst_unused:UNUSED_PAD src0_sel:WORD_1 src1_sel:WORD_1
    s_nop 1
    v_add_u32_dpp v110, v110, v110 row_shr:1 row_mask:0xf bank_mask:0xf bound_ctrl:0
    s_nop 1
    v_add_u32_dpp v110, v110, v110 row_shr:2 row_mask:0xf bank_mask:0xf bound_ctrl:0
    s_nop 1
    v_add_u32_dpp v110, v110, v110 row_shr:4 row_mask:0xf bank_mask:0xf bound_ctrl:0
    s_nop 1
    v_add_u32_dpp v110, v110, v110 row_shr:8 row_mask:0xf bank_mask:0xf bound_ctrl:0
    s_nop 1
    v_add_u32_dpp v110, v110, v110 row_bcast:15 row_mask:0xa bank_mask:0xf
    s_nop 1
    v_add_u32_dpp v110, v110, v110 row_bcast:31 row_mask:0xc bank_mask:0xf
    v_sub_u32_sdwa v109, v109, v110 dst_sel:DWORD dst_unused:UNUSED_PAD src0_sel:WORD_1 src1_sel:DWORD
    v_readlane_b32 s29, v110, 63
    v_add_u32 v110, -1, v110
    ds_write_b16 v126, v109
    v_lshlrev_b32_e64 v111, v110, 1
    v_lshrrev_b32 v110, 5, v110
    v_lshl_add_u32 v110, v110, 2, s19
    s_cmp_gt_u32 s29, 320
    s_cselect_b32 s2, 1, s2
    s_cselect_b64 exec, 0, -1
    ds_or_b32 v110, v111 offset:160
    s_mov_b64 exec, -1
    ds_wrxchg_rtn_b32 v7, v6, v5 offset:160
    s_waitcnt lgkmcnt(0)
    v_readlane_b32 s30, v7, 0
    v_readlane_b32 s31, v7, 1
    v_readlane_b32 s32, v7, 2
    v_readlane_b32 s33, v7, 3
    v_readlane_b32 s34, v7, 4
    v_readlane_b32 s35, v7, 5
    v_readlane_b32 s36, v7, 6
    v_readlane_b32 s37, v7, 7
    s_mov_b32 s25, s19
    s_mov_b32 s26, s27
    s_mov_b32 s51, s28
    s_mov_b32 s28, s29
    v_mbcnt_lo_u32_b32 v8, s30, 0
    v_mbcnt_hi_u32_b32 v8, s31, v8
    s_bcnt1_i32_b64 s14, s[30:31]
    v_lshl_add_u32 v9, v8, 1, s25
    ds_read_u16 v9, v9
    v_mad_u32_u24 v8, v8, s23, v2
    s_mov_b32 s30, s26
    s_lshl1_add_u32 s25, s14, s25
    s_mul_i32 s14, s14, s23
    s_add_u32 s26, s26, s14
    v_mbcnt_lo_u32_b32 v12, s32, 0
    v_mbcnt_hi_u32_b32 v12, s33, v12
    s_bcnt1_i32_b64 s14, s[32:33]
    v_lshl_add_u32 v13, v12, 1, s25
    ds_read_u16 v13, v13
    v_mad_u32_u24 v12, v12, s23, v2
    s_mov_b32 s32, s26
    s_lshl1_add_u32 s25, s14, s25
    s_mul_i32 s14, s14, s23
    s_add_u32 s26, s26, s14
    v_mbcnt_lo_u32_b32 v16, s34, 0
    v_mbcnt_hi_u32_b32 v16, s35, v16
    s_bcnt1_i32_b64 s14, s[34:35]
    v_lshl_add_u32 v17, v16, 1, s25
    ds_read_u16 v17, v17
    v_mad_u32_u24 v16, v16, s23, v2
    s_mov_b32 s34, s26
    s_lshl1_add_u32 s25, s14, s25
    s_mul_i32 s14, s14, s23
    s_add_u32 s26, s26, s14
    v_mbcnt_lo_u32_b32 v20, s36, 0
    v_mbcnt_hi_u32_b32 v20, s37, v20
    s_bcnt1_i32_b64 s14, s[36:37]
    v_lshl_add_u32 v21, v20, 1, s25
    ds_read_u16 v21, v21
    v_mad_u32_u24 v20, v20, s23, v2
    s_mov_b32 s36, s26
    s_lshl1_add_u32 s25, s14, s25
    s_mul_i32 s14, s14, s23
    s_add_u32 s26, s26, s14
    s_waitcnt lgkmcnt(3)
    v_lshl_add_u32 v8, v9, 4, v8
    buffer_load_dwordx4 v[8:11], v8, s[44:47], s30 offen offset:0
    s_waitcnt lgkmcnt(2)
    v_lshl_add_u32 v12, v13, 4, v12
    buffer_load_dwordx4 v[12:15], v12, s[44:47], s32 offen offset:1024
    s_waitcnt lgkmcnt(1)
    v_lshl_add_u32 v16, v17, 4, v16
    buffer_load_dwordx4 v[16:19], v16, s[44:47], s34 offen offset:2048
    s_waitcnt lgkmcnt(0)
    v_lshl_add_u32 v20, v21, 4, v20
    buffer_load_dwordx4 v[20:23], v20, s[44:47], s36 offen offset:3072
    s_cmp_le_u32 s28, 256
    s_cbranch_scc1 L_p2_kernel_noopt_1
    v_readlane_b32 s38, v7, 8
    v_readlane_b32 s39, v7, 9
    s_nop 1
    v_mbcnt_lo_u32_b32 v118, s38, 0
    v_mbcnt_hi_u32_b32 v118, s39, v118
    s_bcnt1_i32_b64 s14, s[38:39]
    v_lshl_add_u32 v119, v118, 1, s25
    ds_read_u16 v119, v119
    v_mad_u32_u24 v118, v118, s23, v2
    s_mov_b32 s38, s26
    s_lshl1_add_u32 s25, s14, s25
    s_mul_i32 s14, s14, s23
    s_add_u32 s26, s26, s14
    s_waitcnt lgkmcnt(0)
    s_add_u32 s38, s38, 4096
    v_lshl_add_u32 v118, v119, 4, v118
    buffer_load_dwordx4 v[24:27], v118, s[44:47], s38 offen offset:0
L_p2_kernel_noopt_1:
    s_waitcnt vmcnt(8)
    ds_write_b128 v3, v[88:91] offset:0
    ds_write_b128 v3, v[92:95] offset:16384
    ds_write_b128 v3, v[96:99] offset:32768
    ds_write_b128 v3, v[100:103] offset:49152
    ds_write_b128 v124, v[104:107]
    s_waitcnt vmcnt(4)
    v_max3_u32 v64, v80, v82, v84
    v_add_f32 v65, v81, v83
    v_add_f32 v66, v85, v87
    v_max_u32 v64, v64, v86
    v_add_f32 v65, v65, v66
    v_cmp_lt_u32 vcc, 0xffff, v64
    s_nop 1
    v_max_u32_dpp v64, v64, v64 row_shr:1 row_mask:0xf bank_mask:0xf bound_ctrl:0
    s_nop 1
    v_max_u32_dpp v64, v64, v64 row_shr:2 row_mask:0xf bank_mask:0xf bound_ctrl:0
    s_nop 1
    v_max_u32_dpp v64, v64, v64 row_shr:4 row_mask:0xf bank_mask:0xf bound_ctrl:0
    s_nop 1
    v_max_u32_dpp v64, v64, v64 row_shr:8 row_mask:0xf bank_mask:0xf bound_ctrl:0
    s_nop 1
    v_max_u32_dpp v64, v64, v64 row_bcast:15 row_mask:0xa bank_mask:0xf
    s_nop 1
    v_max_u32_dpp v64, v64, v64 row_bcast:31 row_mask:0xc bank_mask:0xf
    s_nop 1
    v_add_f32_dpp v65, v65, v65 row_shr:1 row_mask:0xf bank_mask:0xf bound_ctrl:0
    s_nop 1
    v_add_f32_dpp v65, v65, v65 row_shr:2 row_mask:0xf bank_mask:0xf bound_ctrl:0
    s_nop 1
    v_add_f32_dpp v65, v65, v65 row_shr:4 row_mask:0xf bank_mask:0xf bound_ctrl:0
    s_nop 1
    v_add_f32_dpp v65, v65, v65 row_shr:8 row_mask:0xf bank_mask:0xf bound_ctrl:0
    s_nop 1
    v_add_f32_dpp v65, v65, v65 row_bcast:15 row_mask:0xa bank_mask:0xf
    s_nop 1
    v_add_f32_dpp v65, v65, v65 row_bcast:31 row_mask:0xc bank_mask:0xf
    s_cmp_lg_u64 vcc, 0
    s_cselect_b32 s2, 1, s2
    v_lshlrev_b32 v64, 16, v64
    v_mul_f32 v66, 936490775, v65
    v_mul_f32 v65, 928531664, v65
    v_cmp_nle_f32 vcc, v64, v66
    v_max_u32 v64, v64, v65
    s_nop 0
    v_readlane_b32 s14, v64, 63
    s_bitcmp1_b32 vcc_hi, 31
    s_cselect_b32 s2, 1, s2
    s_lshr_b32 s14, s14, 23
    s_add_u32 s14, s14, 1
    s_cmp_lt_u32 s14, 40
    s_cselect_b32 s2, 1, s2
    s_cmp_gt_u32 s14, 230
    s_cselect_b32 s2, 1, s2
    s_sub_u32 s48, s14, 14
    s_lshl_b32 s48, s48, 23
    s_add_u32 s16, s48, 272646144
    s_or_b32 s48, s48, 16416
    s_sub_u32 s14, s14, 40
    s_cmp_gt_u32 s14, 190
    s_cselect_b32 s48, 0, s48
    s_waitcnt lgkmcnt(0)
    s_barrier
    s_add_u32 s14, s22, 80000
    buffer_load_dwordx4 v[88:91], v1, s[8:11], s14 offen
    s_add_u32 s14, s22, 96384
    buffer_load_dwordx4 v[92:95], v1, s[8:11], s14 offen
    s_add_u32 s14, s22, 112768
    buffer_load_dwordx4 v[96:99], v1, s[8:11], s14 offen
    v_mad_u32_u16 v108, v28, v50, s40 op_sel:[1,0,0,0]
    v_mad_u32_u16 v109, v36, v50, s41 op_sel:[1,0,0,0]
    v_sub_u32_sdwa v110, v109, v108 dst_sel:DWORD dst_unused:UNUSED_PAD src0_sel:WORD_1 src1_sel:WORD_1
    s_nop 1
    v_add_u32_dpp v110, v110, v110 row_shr:1 row_mask:0xf bank_mask:0xf bound_ctrl:0
    s_nop 1
    v_add_u32_dpp v110, v110, v110 row_shr:2 row_mask:0xf bank_mask:0xf bound_ctrl:0
    s_nop 1
    v_add_u32_dpp v110, v110, v110 row_shr:4 row_mask:0xf bank_mask:0xf bound_ctrl:0
    s_nop 1
    v_add_u32_dpp v110, v110, v110 row_shr:8 row_mask:0xf bank_mask:0xf bound_ctrl:0
    s_nop 1
    v_add_u32_dpp v110, v110, v110 row_bcast:15 row_mask:0xa bank_mask:0xf
    s_nop 1
    v_add_u32_dpp v110, v110, v110 row_bcast:31 row_mask:0xc bank_mask:0xf
    v_sub_u32_sdwa v109, v109, v110 dst_sel:DWORD dst_unused:UNUSED_PAD src0_sel:WORD_1 src1_sel:DWORD
    v_readlane_b32 s29, v110, 63
    v_add_u32 v110, -1, v110
    ds_write_b16 v126, v109
    v_lshlrev_b32_e64 v111, v110, 1
    v_lshrrev_b32 v110, 5, v110
    v_lshl_add_u32 v110, v110, 2, s19
    s_cmp_gt_u32 s29, 320
    s_cselect_b32 s2, 1, s2
    s_cselect_b64 exec, 0, -1
    ds_or_b32 v110, v111 offset:160
    s_mov_b64 exec, -1
    ds_wrxchg_rtn_b32 v7, v6, v5 offset:160
    s_mov_b32 s24, 0
L_p2_loop:
    s_add_u32 s22, s22, 80000
    s_lshl_b32 s14, s13, 4
    s_or_b32 s14, s14, s24
    s_cmp_lg_u32 s14, 5
    s_cbranch_scc1 L_p2_nost
    v_mov_b32 v52, 0
    s_lshl_b32 s14, s3, 8
    s_add_u32 s14, s14, 227590656
    s_mov_b64 exec, 1
    buffer_atomic_add v52, off, s[4:7], s14 sc0
    s_mov_b64 exec, -1
L_p2_nost:
    s_waitcnt vmcnt(6)
    v_mad_u32_u16 v64, v8, 8, s18
    v_mad_u32_u16 v66, v9, 8, s18
    v_mad_u32_u16 v68, v10, 8, s18
    ds_read_b64 v[64:65], v64
    ds_read_b64 v[66:67], v66
    ds_read_b64 v[68:69], v68
    s_add_u32 s14, s22, 49152
    buffer_load_dwordx4 v[100:103], v1, s[8:11], s14 offen
    s_waitcnt vmcnt(6)
    v_mad_u32_u16 v70, v12, 8, s18
    v_mad_u32_u16 v72, v13, 8, s18
    v_mad_u32_u16 v74, v14, 8, s18
    ds_read_b64 v[70:71], v70
    ds_read_b64 v[72:73], v72
    ds_read_b64 v[74:75], v74
    s_add_u32 s14, s22, 65536
    buffer_load_dwordx4 v[104:107], v1, s[8:11], s14 offen
    s_waitcnt lgkmcnt(6)
    v_readlane_b32 s30, v7, 0
    v_readlane_b32 s31, v7, 1
    v_readlane_b32 s32, v7, 2
    v_readlane_b32 s33, v7, 3
    v_readlane_b32 s34, v7, 4
    v_readlane_b32 s35, v7, 5
    v_readlane_b32 s36, v7, 6
    v_readlane_b32 s37, v7, 7
    s_mov_b32 s25, s19
    s_mov_b32 s26, s27
    s_mov_b32 s51, s28
    s_mov_b32 s28, s29
    v_mbcnt_lo_u32_b32 v118, s30, 0
    v_mbcnt_hi_u32_b32 v118, s31, v118
    s_bcnt1_i32_b64 s14, s[30:31]
    v_lshl_add_u32 v119, v118, 1, s25
    ds_read_u16 v119, v119
    v_mad_u32_u24 v118, v118, s23, v2
    s_mov_b32 s30, s26
    s_lshl1_add_u32 s25, s14, s25
    s_mul_i32 s14, s14, s23
    s_add_u32 s26, s26, s14
    v_bfe_i32 v108, v11, 2, 10
    v_bfe_i32 v109, v11, 12, 10
    v_ashrrev_i32 v110, 22, v11
    v_cvt_f32_i32 v108, v108
    v_cvt_f32_i32 v109, v109
    v_cvt_f32_i32 v110, v110
    v_mad_u32_u16 v8, v8, 8, s50 op_sel:[1,0,0,0]
    v_mad_u32_u16 v9, v9, 8, s50 op_sel:[1,0,0,0]
    v_mad_u32_u16 v10, v10, 8, s50 op_sel:[1,0,0,0]
    s_waitcnt lgkmcnt(4)
    v_lshlrev_b32 v112, 16, v64
    v_and_b32 v113, 0xffff0000, v64
    v_lshlrev_b32 v64, 16, v65
    v_and_b32 v65, 0xffff0000, v65
    v_lshlrev_b32 v114, 16, v66
    v_and_b32 v115, 0xffff0000, v66
    v_lshlrev_b32 v66, 16, v67
    v_and_b32 v67, 0xffff0000, v67
    v_lshlrev_b32 v116, 16, v68
    v_and_b32 v117, 0xffff0000, v68
    v_lshlrev_b32 v68, 16, v69
    v_and_b32 v69, 0xffff0000, v69
    v_pk_fma_f32 v[112:113], v[112:113], v[108:109], s[16:17] op_sel:[0,0,0] op_sel_hi:[1,0,0]
    v_pk_fma_f32 v[64:65], v[64:65], v[108:109], s[16:17] op_sel:[0,0,0] op_sel_hi:[1,0,0]
    v_pk_fma_f32 v[114:115], v[114:115], v[108:109], s[16:17] op_sel:[0,1,0] op_sel_hi:[1,1,0]
    v_pk_fma_f32 v[66:67], v[66:67], v[108:109], s[16:17] op_sel:[0,1,0] op_sel_hi:[1,1,0]
    v_pk_fma_f32 v[116:117], v[116:117], v[110:111], s[16:17] op_sel:[0,0,0] op_sel_hi:[1,0,0]
    v_pk_fma_f32 v[68:69], v[68:69], v[110:111], s[16:17] op_sel:[0,0,0] op_sel_hi:[1,0,0]
    v_perm_b32 v65, v65, v64, s17
    v_perm_b32 v64, v113, v112, s17
    v_perm_b32 v67, v67, v66, s17
    v_perm_b32 v66, v115, v114, s17
    v_perm_b32 v69, v69, v68, s17
    v_perm_b32 v68, v117, v116, s17
    v_lshl_add_u64 v[64:65], v[64:65], 0, s[20:21]
    v_lshl_add_u64 v[66:67], v[66:67], 0, s[20:21]
    v_lshl_add_u64 v[68:69], v[68:69], 0, s[20:21]
    v_or3_b32 v4, v44, v45, v4
    v_or3_b32 v4, v46, v47, v4
    v_or3_b32 v4, v48, v49, v4
    ds_add_rtn_u64 v[44:45], v8, v[64:65]
    ds_add_rtn_u64 v[46:47], v9, v[66:67]
    ds_add_rtn_u64 v[48:49], v10, v[68:69]
    s_waitcnt lgkmcnt(3)
    v_lshl_add_u32 v118, v119, 4, v118
    buffer_load_dwordx4 v[8:11], v118, s[44:47], s30 offen offset:0
    s_waitcnt vmcnt(7)
    v_mad_u32_u16 v76, v16, 8, s18
    v_mad_u32_u16 v78, v17, 8, s18
    v_mad_u32_u16 v80, v18, 8, s18
    ds_read_b64 v[76:77], v76
    ds_read_b64 v[78:79], v78
    ds_read_b64 v[80:81], v80
    s_waitcnt vmcnt(6)
    v_mad_u32_u16 v82, v20, 8, s18
    v_mad_u32_u16 v84, v21, 8, s18
    v_mad_u32_u16 v86, v22, 8, s18
    ds_read_b64 v[82:83], v82
    ds_read_b64 v[84:85], v84
    ds_read_b64 v[86:87], v86
    v_mbcnt_lo_u32_b32 v118, s32, 0
    v_mbcnt_hi_u32_b32 v118, s33, v118
    s_bcnt1_i32_b64 s14, s[32:33]
    v_lshl_add_u32 v119, v118, 1, s25
    ds_read_u16 v119, v119
    v_mad_u32_u24 v118, v118, s23, v2
    s_mov_b32 s32, s26
    s_lshl1_add_u32 s25, s14, s25
    s_mul_i32 s14, s14, s23
    s_add_u32 s26, s26, s14
    v_bfe_i32 v108, v15, 2, 10
    v_bfe_i32 v109, v15, 12, 10
    v_ashrrev_i32 v110, 22, v15
    v_cvt_f32_i32 v108, v108
    v_cvt_f32_i32 v109, v109
    v_cvt_f32_i32 v110, v110
    v_mad_u32_u16 v12, v12, 8, s50 op_sel:[1,0,0,0]
    v_mad_u32_u16 v13, v13, 8, s50 op_sel:[1,0,0,0]
    v_mad_u32_u16 v14, v14, 8, s50 op_sel:[1,0,0,0]
    v_lshlrev_b32 v112, 16, v70
    v_and_b32 v113, 0xffff0000, v70
    v_lshlrev_b32 v70, 16, v71
    v_and_b32 v71, 0xffff0000, v71
    v_lshlrev_b32 v114, 16, v72
    v_and_b32 v115, 0xffff0000, v72
    v_lshlrev_b32 v72, 16, v73
    v_and_b32 v73, 0xffff0000, v73
    v_lshlrev_b32 v116, 16, v74
    v_and_b32 v117, 0xffff0000, v74
    v_lshlrev_b32 v74, 16, v75
    v_and_b32 v75, 0xffff0000, v75
    v_pk_fma_f32 v[112:113], v[112:113], v[108:109], s[16:17] op_sel:[0,0,0] op_sel_hi:[1,0,0]
    v_pk_fma_f32 v[70:71], v[70:71], v[108:109], s[16:17] op_sel:[0,0,0] op_sel_hi:[1,0,0]
    v_pk_fma_f32 v[114:115], v[114:115], v[108:109], s[16:17] op_sel:[0,1,0] op_sel_hi:[1,1,0]
    v_pk_fma_f32 v[72:73], v[72:73], v[108:109], s[16:17] op_sel:[0,1,0] op_sel_hi:[1,1,0]
    v_pk_fma_f32 v[116:117], v[116:117], v[110:111], s[16:17] op_sel:[0,0,0] op_sel_hi:[1,0,0]
    v_pk_fma_f32 v[74:75], v[74:75], v[110:111], s[16:17] op_sel:[0,0,0] op_sel_hi:[1,0,0]
    v_perm_b32 v71, v71, v70, s17
    v_perm_b32 v70, v113, v112, s17
    v_perm_b32 v73, v73, v72, s17
    v_perm_b32 v72, v115, v114, s17
    v_perm_b32 v75, v75, v74, s17
    v_perm_b32 v74, v117, v116, s17
    v_lshl_add_u64 v[70:71], v[70:71], 0, s[20:21]
    v_lshl_add_u64 v[72:73], v[72:73], 0, s[20:21]
    v_lshl_add_u64 v[74:75], v[74:75], 0, s[20:21]
    s_waitcnt lgkmcnt(7)
    v_or3_b32 v4, v44, v45, v4
    v_or3_b32 v4, v46, v47, v4
    v_or3_b32 v4, v48, v49, v4
    ds_add_rtn_u64 v[44:45], v12, v[70:71]
    ds_add_rtn_u64 v[46:47], v13, v[72:73]
    ds_add_rtn_u64 v[48:49], v14, v[74:75]
    s_waitcnt lgkmcnt(3)
    v_lshl_add_u32 v118, v119, 4, v118
    buffer_load_dwordx4 v[12:15], v118, s[44:47], s32 offen offset:1024
    s_cmp_le_u32 s51, 256
    s_cbranch_scc1 L_p2_kernel_noopt2_2
    v_mad_u32_u16 v64, v24, 8, s18
    v_mad_u32_u16 v66, v25, 8, s18
    v_mad_u32_u16 v68, v26, 8, s18
    ds_read_b64 v[64:65], v64
    ds_read_b64 v[66:67], v66
    ds_read_b64 v[68:69], v68
    v_bfe_i32 v108, v27, 2, 10
    v_bfe_i32 v109, v27, 12, 10
    v_ashrrev_i32 v110, 22, v27
    v_cvt_f32_i32 v108, v108
    v_cvt_f32_i32 v109, v109
    v_cvt_f32_i32 v110, v110
    v_mad_u32_u16 v24, v24, 8, s50 op_sel:[1,0,0,0]
    v_mad_u32_u16 v25, v25, 8, s50 op_sel:[1,0,0,0]
    v_mad_u32_u16 v26, v26, 8, s50 op_sel:[1,0,0,0]
    s_waitcnt lgkmcnt(0)
    v_lshlrev_b32 v112, 16, v64
    v_and_b32 v113, 0xffff0000, v64
    v_lshlrev_b32 v64, 16, v65
    v_and_b32 v65, 0xffff0000, v65
    v_lshlrev_b32 v114, 16, v66
    v_and_b32 v115, 0xffff0000, v66
    v_lshlrev_b32 v66, 16, v67
    v_and_b32 v67, 0xffff0000, v67
    v_lshlrev_b32 v116, 16, v68
    v_and_b32 v117, 0xffff0000, v68
    v_lshlrev_b32 v68, 16, v69
    v_and_b32 v69, 0xffff0000, v69
    v_pk_fma_f32 v[112:113], v[112:113], v[108:109], s[16:17] op_sel:[0,0,0] op_sel_hi:[1,0,0]
    v_pk_fma_f32 v[64:65], v[64:65], v[108:109], s[16:17] op_sel:[0,0,0] op_sel_hi:[1,0,0]
    v_pk_fma_f32 v[114:115], v[114:115], v[108:109], s[16:17] op_sel:[0,1,0] op_sel_hi:[1,1,0]
    v_pk_fma_f32 v[66:67], v[66:67], v[108:109], s[16:17] op_sel:[0,1,0] op_sel_hi:[1,1,0]
    v_pk_fma_f32 v[116:117], v[116:117], v[110:111], s[16:17] op_sel:[0,0,0] op_sel_hi:[1,0,0]
    v_pk_fma_f32 v[68:69], v[68:69], v[110:111], s[16:17] op_sel:[0,0,0] op_sel_hi:[1,0,0]
    v_perm_b32 v65, v65, v64, s17
    v_perm_b32 v64, v113, v112, s17
    v_perm_b32 v67, v67, v66, s17
    v_perm_b32 v66, v115, v114, s17
    v_perm_b32 v69, v69, v68, s17
    v_perm_b32 v68, v117, v116, s17
    v_lshl_add_u64 v[64:65], v[64:65], 0, s[20:21]
    v_lshl_add_u64 v[66:67], v[66:67], 0, s[20:21]
    v_lshl_add_u64 v[68:69], v[68:69], 0, s[20:21]
    v_or3_b32 v4, v44, v45, v4
    v_or3_b32 v4, v46, v47, v4
    v_or3_b32 v4, v48, v49, v4
    ds_add_rtn_u64 v[44:45], v24, v[64:65]
    ds_add_rtn_u64 v[46:47], v25, v[66:67]
    ds_add_rtn_u64 v[48:49], v26, v[68:69]
L_p2_kernel_noopt2_2:
    s_barrier
    s_waitcnt vmcnt(2)
    ds_write_b128 v3, v[88:91] offset:0
    ds_write_b128 v3, v[92:95] offset:16384
    ds_write_b128 v3, v[96:99] offset:32768
    ds_write_b128 v3, v[100:103] offset:49152
    ds_write_b128 v124, v[104:107]
    v_mbcnt_lo_u32_b32 v118, s34, 0
    v_mbcnt_hi_u32_b32 v118, s35, v118
    s_bcnt1_i32_b64 s14, s[34:35]
    v_lshl_add_u32 v119, v118, 1, s25
    ds_read_u16 v119, v119
    v_mad_u32_u24 v118, v118, s23, v2
    s_mov_b32 s34, s26
    s_lshl1_add_u32 s25, s14, s25
    s_mul_i32 s14, s14, s23
    s_add_u32 s26, s26, s14
    v_bfe_i32 v108, v19, 2, 10
    v_bfe_i32 v109, v19, 12, 10
    v_ashrrev_i32 v110, 22, v19
    v_cvt_f32_i32 v108, v108
    v_cvt_f32_i32 v109, v109
    v_cvt_f32_i32 v110, v110
    v_mad_u32_u16 v16, v16, 8, s50 op_sel:[1,0,0,0]
    v_mad_u32_u16 v17, v17, 8, s50 op_sel:[1,0,0,0]
    v_mad_u32_u16 v18, v18, 8, s50 op_sel:[1,0,0,0]
    v_lshlrev_b32 v112, 16, v76
    v_and_b32 v113, 0xffff0000, v76
    v_lshlrev_b32 v76, 16, v77
    v_and_b32 v77, 0xffff0000, v77
    v_lshlrev_b32 v114, 16, v78
    v_and_b32 v115, 0xffff0000, v78
    v_lshlrev_b32 v78, 16, v79
    v_and_b32 v79, 0xffff0000, v79
    v_lshlrev_b32 v116, 16, v80
    v_and_b32 v117, 0xffff0000, v80
    v_lshlrev_b32 v80, 16, v81
    v_and_b32 v81, 0xffff0000, v81
    v_pk_fma_f32 v[112:113], v[112:113], v[108:109], s[16:17] op_sel:[0,0,0] op_sel_hi:[1,0,0]
    v_pk_fma_f32 v[76:77], v[76:77], v[108:109], s[16:17] op_sel:[0,0,0] op_sel_hi:[1,0,0]
    v_pk_fma_f32 v[114:115], v[114:115], v[108:109], s[16:17] op_sel:[0,1,0] op_sel_hi:[1,1,0]
    v_pk_fma_f32 v[78:79], v[78:79], v[108:109], s[16:17] op_sel:[0,1,0] op_sel_hi:[1,1,0]
    v_pk_fma_f32 v[116:117], v[116:117], v[110:111], s[16:17] op_sel:[0,0,0] op_sel_hi:[1,0,0]
    v_pk_fma_f32 v[80:81], v[80:81], v[110:111], s[16:17] op_sel:[0,0,0] op_sel_hi:[1,0,0]
    v_perm_b32 v77, v77, v76, s17
    v_perm_b32 v76, v113, v112, s17
    v_perm_b32 v79, v79, v78, s17
    v_perm_b32 v78, v115, v114, s17
    v_perm_b32 v81, v81, v80, s17
    v_perm_b32 v80, v117, v116, s17
    v_lshl_add_u64 v[76:77], v[76:77], 0, s[20:21]
    v_lshl_add_u64 v[78:79], v[78:79], 0, s[20:21]
    v_lshl_add_u64 v[80:81], v[80:81], 0, s[20:21]
    s_waitcnt lgkmcnt(6)
    v_or3_b32 v4, v44, v45, v4
    v_or3_b32 v4, v46, v47, v4
    v_or3_b32 v4, v48, v49, v4
    ds_add_rtn_u64 v[44:45], v16, v[76:77]
    ds_add_rtn_u64 v[46:47], v17, v[78:79]
    ds_add_rtn_u64 v[48:49], v18, v[80:81]
    s_waitcnt lgkmcnt(3)
    v_lshl_add_u32 v118, v119, 4, v118
    buffer_load_dwordx4 v[16:19], v118, s[44:47], s34 offen offset:2048
    v_mbcnt_lo_u32_b32 v118, s36, 0
    v_mbcnt_hi_u32_b32 v118, s37, v118
    s_bcnt1_i32_b64 s14, s[36:37]
    v_lshl_add_u32 v119, v118, 1, s25
    ds_read_u16 v119, v119
    v_mad_u32_u24 v118, v118, s23, v2
    s_mov_b32 s36, s26
    s_lshl1_add_u32 s25, s14, s25
    s_mul_i32 s14, s14, s23
    s_add_u32 s26, s26, s14
    v_bfe_i32 v108, v23, 2, 10
    v_bfe_i32 v109, v23, 12, 10
    v_ashrrev_i32 v110, 22, v23
    v_cvt_f32_i32 v108, v108
    v_cvt_f32_i32 v109, v109
    v_cvt_f32_i32 v110, v110
    v_mad_u32_u16 v20, v20, 8, s50 op_sel:[1,0,0,0]
    v_mad_u32_u16 v21, v21, 8, s50 op_sel:[1,0,0,0]
    v_mad_u32_u16 v22, v22, 8, s50 op_sel:[1,0,0,0]
    v_lshlrev_b32 v112, 16, v82
    v_and_b32 v113, 0xffff0000, v82
    v_lshlrev_b32 v82, 16, v83
    v_and_b32 v83, 0xffff0000, v83
    v_lshlrev_b32 v114, 16, v84
    v_and_b32 v115, 0xffff0000, v84
    v_lshlrev_b32 v84, 16, v85
    v_and_b32 v85, 0xffff0000, v85
    v_lshlrev_b32 v116, 16, v86
    v_and_b32 v117, 0xffff0000, v86
    v_lshlrev_b32 v86, 16, v87
    v_and_b32 v87, 0xffff0000, v87
    v_pk_fma_f32 v[112:113], v[112:113], v[108:109], s[16:17] op_sel:[0,0,0] op_sel_hi:[1,0,0]
    v_pk_fma_f32 v[82:83], v[82:83], v[108:109], s[16:17] op_sel:[0,0,0] op_sel_hi:[1,0,0]
    v_pk_fma_f32 v[114:115], v[114:115], v[108:109], s[16:17] op_sel:[0,1,0] op_sel_hi:[1,1,0]
    v_pk_fma_f32 v[84:85], v[84:85], v[108:109], s[16:17] op_sel:[0,1,0] op_sel_hi:[1,1,0]
    v_pk_fma_f32 v[116:117], v[116:117], v[110:111], s[16:17] op_sel:[0,0,0] op_sel_hi:[1,0,0]
    v_pk_fma_f32 v[86:87], v[86:87], v[110:111], s[16:17] op_sel:[0,0,0] op_sel_hi:[1,0,0]
    v_perm_b32 v83, v83, v82, s17
    v_perm_b32 v82, v113, v112, s17
    v_perm_b32 v85, v85, v84, s17
    v_perm_b32 v84, v115, v114, s17
    v_perm_b32 v87, v87, v86, s17
    v_perm_b32 v86, v117, v116, s17
    v_lshl_add_u64 v[82:83], v[82:83], 0, s[20:21]
    v_lshl_add_u64 v[84:85], v[84:85], 0, s[20:21]
    v_lshl_add_u64 v[86:87], v[86:87], 0, s[20:21]
    s_waitcnt lgkmcnt(1)
    v_or3_b32 v4, v44, v45, v4
    v_or3_b32 v4, v46, v47, v4
    v_or3_b32 v4, v48, v49, v4
    ds_add_rtn_u64 v[44:45], v20, v[82:83]
    ds_add_rtn_u64 v[46:47], v21, v[84:85]
    ds_add_rtn_u64 v[48:49], v22, v[86:87]
    s_waitcnt lgkmcnt(3)
    v_lshl_add_u32 v118, v119, 4, v118
    buffer_load_dwordx4 v[20:23], v118, s[44:47], s36 offen offset:3072
    s_cmp_le_u32 s28, 256
    s_cbranch_scc1 L_p2_kernel_noopt_3
    v_readlane_b32 s38, v7, 8
    v_readlane_b32 s39, v7, 9
    s_nop 1
    v_mbcnt_lo_u32_b32 v118, s38, 0
    v_mbcnt_hi_u32_b32 v118, s39, v118
    s_bcnt1_i32_b64 s14, s[38:39]
    v_lshl_add_u32 v119, v118, 1, s25
    ds_read_u16 v119, v119
    v_mad_u32_u24 v118, v118, s23, v2
    s_mov_b32 s38, s26
    s_lshl1_add_u32 s25, s14, s25
    s_mul_i32 s14, s14, s23
    s_add_u32 s26, s26, s14
    s_waitcnt lgkmcnt(0)
    s_add_u32 s38, s38, 4096
    v_lshl_add_u32 v118, v119, 4, v118
    buffer_load_dwordx4 v[24:27], v118, s[44:47], s38 offen offset:0
L_p2_kernel_noopt_3:
    v_pk_mov_b32 v[28:29], v[28:29], v[30:31] op_sel:[1,0]
    v_pk_mov_b32 v[30:31], v[30:31], v[32:33] op_sel:[1,0]
    v_pk_mov_b32 v[32:33], v[32:33], v[34:35] op_sel:[1,0]
    v_pk_mov_b32 v[34:35], v[34:35], v[4:5] op_sel:[1,1]
    v_pk_mov_b32 v[36:37], v[36:37], v[38:39] op_sel:[1,0]
    v_pk_mov_b32 v[38:39], v[38:39], v[40:41] op_sel:[1,0]
    v_pk_mov_b32 v[40:41], v[40:41], v[42:43] op_sel:[1,0]
    v_pk_mov_b32 v[42:43], v[42:43], v[4:5] op_sel:[1,1]
    v_mad_u32_u16 v108, v28, v50, s40 op_sel:[0,0,0,0]
    v_mad_u32_u16 v109, v36, v50, s41 op_sel:[0,0,0,0]
    v_sub_u32_sdwa v110, v109, v108 dst_sel:DWORD dst_unused:UNUSED_PAD src0_sel:WORD_1 src1_sel:WORD_1
    s_nop 1
    v_add_u32_dpp v110, v110, v110 row_shr:1 row_mask:0xf bank_mask:0xf bound_ctrl:0
    s_nop 1
    v_add_u32_dpp v110, v110, v110 row_shr:2 row_mask:0xf bank_mask:0xf bound_ctrl:0
    s_nop 1
    v_add_u32_dpp v110, v110, v110 row_shr:4 row_mask:0xf bank_mask:0xf bound_ctrl:0
    s_nop 1
    v_add_u32_dpp v110, v110, v110 row_shr:8 row_mask:0xf bank_mask:0xf bound_ctrl:0
    s_nop 1
    v_add_u32_dpp v110, v110, v110 row_bcast:15 row_mask:0xa bank_mask:0xf
    s_nop 1
    v_add_u32_dpp v110, v110, v110 row_bcast:31 row_mask:0xc bank_mask:0xf
    v_sub_u32_sdwa v109, v109, v110 dst_sel:DWORD dst_unused:UNUSED_PAD src0_sel:WORD_1 src1_sel:DWORD
    v_readlane_b32 s29, v110, 63
    v_add_u32 v110, -1, v110
    ds_write_b16 v126, v109
    v_lshlrev_b32_e64 v111, v110, 1
    v_lshrrev_b32 v110, 5, v110
    v_lshl_add_u32 v110, v110, 2, s19
    s_cmp_gt_u32 s29, 320
    s_cselect_b32 s2, 1, s2
    s_cselect_b64 exec, 0, -1
    ds_or_b32 v110, v111 offset:160
    s_mov_b64 exec, -1
    ds_wrxchg_rtn_b32 v7, v6, v5 offset:160
    s_add_u32 s14, s22, 80000
    buffer_load_dwordx4 v[88:91], v1, s[8:11], s14 offen
    s_add_u32 s14, s22, 96384
    buffer_load_dwordx4 v[92:95], v1, s[8:11], s14 offen
    s_add_u32 s14, s22, 112768
    buffer_load_dwordx4 v[96:99], v1, s[8:11], s14 offen
    s_barrier
    s_add_u32 s22, s22, 80000
    s_cmp_lg_u32 s24, 7
    s_cbranch_scc1 L_p2_nodist
    s_mov_b32 s46, 0
    s_lshl2_add_u32 s14, s3, s12
    s_mul_i32 s14, s14, 5000
    s_add_u32 s15, s14, 4096
    v_min_u32 v61, 225, v0
    v_lshl_add_u32 v60, v0, 2, s14
    v_lshl_add_u32 v61, v61, 2, s15
    global_load_dword v60, v60, s[100:101] nt
    global_load_dword v61, v61, s[100:101] nt
L_p2_nodist:
    s_waitcnt vmcnt(6)
    v_mad_u32_u16 v64, v8, 8, s18
    v_mad_u32_u16 v66, v9, 8, s18
    v_mad_u32_u16 v68, v10, 8, s18
    ds_read_b64 v[64:65], v64
    ds_read_b64 v[66:67], v66
    ds_read_b64 v[68:69], v68
    s_add_u32 s14, s22, 49152
    buffer_load_dwordx4 v[100:103], v1, s[8:11], s14 offen
    s_waitcnt vmcnt(6)
    v_mad_u32_u16 v70, v12, 8, s18
    v_mad_u32_u16 v72, v13, 8, s18
    v_mad_u32_u16 v74, v14, 8, s18
    ds_read_b64 v[70:71], v70
    ds_read_b64 v[72:73], v72
    ds_read_b64 v[74:75], v74
    s_add_u32 s14, s22, 65536
    buffer_load_dwordx4 v[104:107], v1, s[8:11], s14 offen
    s_waitcnt lgkmcnt(6)
    v_readlane_b32 s30, v7, 0
    v_readlane_b32 s31, v7, 1
    v_readlane_b32 s32, v7, 2
    v_readlane_b32 s33, v7, 3
    v_readlane_b32 s34, v7, 4
    v_readlane_b32 s35, v7, 5
    v_readlane_b32 s36, v7, 6
    v_readlane_b32 s37, v7, 7
    s_mov_b32 s25, s19
    s_mov_b32 s26, s27
    s_mov_b32 s51, s28
    s_mov_b32 s28, s29
    v_mbcnt_lo_u32_b32 v118, s30, 0
    v_mbcnt_hi_u32_b32 v118, s31, v118
    s_bcnt1_i32_b64 s14, s[30:31]
    v_lshl_add_u32 v119, v118, 1, s25
    ds_read_u16 v119, v119
    v_mad_u32_u24 v118, v118, s23, v2
    s_mov_b32 s30, s26
    s_lshl1_add_u32 s25, s14, s25
    s_mul_i32 s14, s14, s23
    s_add_u32 s26, s26, s14
    v_bfe_i32 v108, v11, 2, 10
    v_bfe_i32 v109, v11, 12, 10
    v_ashrrev_i32 v110, 22, v11
    v_cvt_f32_i32 v108, v108
    v_cvt_f32_i32 v109, v109
    v_cvt_f32_i32 v110, v110
    v_mad_u32_u16 v8, v8, 8, s50 op_sel:[1,0,0,0]
    v_mad_u32_u16 v9, v9, 8, s50 op_sel:[1,0,0,0]
    v_mad_u32_u16 v10, v10, 8, s50 op_sel:[1,0,0,0]
    s_waitcnt lgkmcnt(4)
    v_lshlrev_b32 v112, 16, v64
    v_and_b32 v113, 0xffff0000, v64
    v_lshlrev_b32 v64, 16, v65
    v_and_b32 v65, 0xffff0000, v65
    v_lshlrev_b32 v114, 16, v66
    v_and_b32 v115, 0xffff0000, v66
    v_lshlrev_b32 v66, 16, v67
    v_and_b32 v67, 0xffff0000, v67
    v_lshlrev_b32 v116, 16, v68
    v_and_b32 v117, 0xffff0000, v68
    v_lshlrev_b32 v68, 16, v69
    v_and_b32 v69, 0xffff0000, v69
    v_pk_fma_f32 v[112:113], v[112:113], v[108:109], s[16:17] op_sel:[0,0,0] op_sel_hi:[1,0,0]
    v_pk_fma_f32 v[64:65], v[64:65], v[108:109], s[16:17] op_sel:[0,0,0] op_sel_hi:[1,0,0]
    v_pk_fma_f32 v[114:115], v[114:115], v[108:109], s[16:17] op_sel:[0,1,0] op_sel_hi:[1,1,0]
    v_pk_fma_f32 v[66:67], v[66:67], v[108:109], s[16:17] op_sel:[0,1,0] op_sel_hi:[1,1,0]
    v_pk_fma_f32 v[116:117], v[116:117], v[110:111], s[16:17] op_sel:[0,0,0] op_sel_hi:[1,0,0]
    v_pk_fma_f32 v[68:69], v[68:69], v[110:111], s[16:17] op_sel:[0,0,0] op_sel_hi:[1,0,0]
    v_perm_b32 v65, v65, v64, s17
    v_perm_b32 v64, v113, v112, s17
    v_perm_b32 v67, v67, v66, s17
    v_perm_b32 v66, v115, v114, s17
    v_perm_b32 v69, v69, v68, s17
    v_perm_b32 v68, v117, v116, s17
    v_lshl_add_u64 v[64:65], v[64:65], 0, s[20:21]
    v_lshl_add_u64 v[66:67], v[66:67], 0, s[20:21]
    v_lshl_add_u64 v[68:69], v[68:69], 0, s[20:21]
    v_or3_b32 v4, v44, v45, v4
    v_or3_b32 v4, v46, v47, v4
    v_or3_b32 v4, v48, v49, v4
    ds_add_rtn_u64 v[44:45], v8, v[64:65]
    ds_add_rtn_u64 v[46:47], v9, v[66:67]
    ds_add_rtn_u64 v[48:49], v10, v[68:69]
    s_waitcnt lgkmcnt(3)
    v_lshl_add_u32 v118, v119, 4, v118
    buffer_load_dwordx4 v[8:11], v118, s[44:47], s30 offen offset:0
    s_waitcnt vmcnt(7)
    v_mad_u32_u16 v76, v16, 8, s18
    v_mad_u32_u16 v78, v17, 8, s18
    v_mad_u32_u16 v80, v18, 8, s18
    ds_read_b64 v[76:77], v76
    ds_read_b64 v[78:79], v78
    ds_read_b64 v[80:81], v80
    s_waitcnt vmcnt(6)
    v_mad_u32_u16 v82, v20, 8, s18
    v_mad_u32_u16 v84, v21, 8, s18
    v_mad_u32_u16 v86, v22, 8, s18
    ds_read_b64 v[82:83], v82
    ds_read_b64 v[84:85], v84
    ds_read_b64 v[86:87], v86
    v_mbcnt_lo_u32_b32 v118, s32, 0
    v_mbcnt_hi_u32_b32 v118, s33, v118
    s_bcnt1_i32_b64 s14, s[32:33]
    v_lshl_add_u32 v119, v118, 1, s25
    ds_read_u16 v119, v119
    v_mad_u32_u24 v118, v118, s23, v2
    s_mov_b32 s32, s26
    s_lshl1_add_u32 s25, s14, s25
    s_mul_i32 s14, s14, s23
    s_add_u32 s26, s26, s14
    v_bfe_i32 v108, v15, 2, 10
    v_bfe_i32 v109, v15, 12, 10
    v_ashrrev_i32 v110, 22, v15
    v_cvt_f32_i32 v108, v108
    v_cvt_f32_i32 v109, v109
    v_cvt_f32_i32 v110, v110
    v_mad_u32_u16 v12, v12, 8, s50 op_sel:[1,0,0,0]
    v_mad_u32_u16 v13, v13, 8, s50 op_sel:[1,0,0,0]
    v_mad_u32_u16 v14, v14, 8, s50 op_sel:[1,0,0,0]
    v_lshlrev_b32 v112, 16, v70
    v_and_b32 v113, 0xffff0000, v70
    v_lshlrev_b32 v70, 16, v71
    v_and_b32 v71, 0xffff0000, v71
    v_lshlrev_b32 v114, 16, v72
    v_and_b32 v115, 0xffff0000, v72
    v_lshlrev_b32 v72, 16, v73
    v_and_b32 v73, 0xffff0000, v73
    v_lshlrev_b32 v116, 16, v74
    v_and_b32 v117, 0xffff0000, v74
    v_lshlrev_b32 v74, 16, v75
    v_and_b32 v75, 0xffff0000, v75
    v_pk_fma_f32 v[112:113], v[112:113], v[108:109], s[16:17] op_sel:[0,0,0] op_sel_hi:[1,0,0]
    v_pk_fma_f32 v[70:71], v[70:71], v[108:109], s[16:17] op_sel:[0,0,0] op_sel_hi:[1,0,0]
    v_pk_fma_f32 v[114:115], v[114:115], v[108:109], s[16:17] op_sel:[0,1,0] op_sel_hi:[1,1,0]
    v_pk_fma_f32 v[72:73], v[72:73], v[108:109], s[16:17] op_sel:[0,1,0] op_sel_hi:[1,1,0]
    v_pk_fma_f32 v[116:117], v[116:117], v[110:111], s[16:17] op_sel:[0,0,0] op_sel_hi:[1,0,0]
    v_pk_fma_f32 v[74:75], v[74:75], v[110:111], s[16:17] op_sel:[0,0,0] op_sel_hi:[1,0,0]
    v_perm_b32 v71, v71, v70, s17
    v_perm_b32 v70, v113, v112, s17
    v_perm_b32 v73, v73, v72, s17
    v_perm_b32 v72, v115, v114, s17
    v_perm_b32 v75, v75, v74, s17
    v_perm_b32 v74, v117, v116, s17
    v_lshl_add_u64 v[70:71], v[70:71], 0, s[20:21]
    v_lshl_add_u64 v[72:73], v[72:73], 0, s[20:21]
    v_lshl_add_u64 v[74:75], v[74:75], 0, s[20:21]
    s_waitcnt lgkmcnt(7)
    v_or3_b32 v4, v44, v45, v4
    v_or3_b32 v4, v46, v47, v4
    v_or3_b32 v4, v48, v49, v4
    ds_add_rtn_u64 v[44:45], v12, v[70:71]
    ds_add_rtn_u64 v[46:47], v13, v[72:73]
    ds_add_rtn_u64 v[48:49], v14, v[74:75]
    s_waitcnt lgkmcnt(3)
    v_lshl_add_u32 v118, v119, 4, v118
    buffer_load_dwordx4 v[12:15], v118, s[44:47], s32 offen offset:1024
    s_cmp_le_u32 s51, 256
    s_cbranch_scc1 L_p2_kernel_noopt2_4
    v_mad_u32_u16 v64, v24, 8, s18
    v_mad_u32_u16 v66, v25, 8, s18
    v_mad_u32_u16 v68, v26, 8, s18
    ds_read_b64 v[64:65], v64
    ds_read_b64 v[66:67], v66
    ds_read_b64 v[68:69], v68
    v_bfe_i32 v108, v27, 2, 10
    v_bfe_i32 v109, v27, 12, 10
    v_ashrrev_i32 v110, 22, v27
    v_cvt_f32_i32 v108, v108
    v_cvt_f32_i32 v109, v109
    v_cvt_f32_i32 v110, v110
    v_mad_u32_u16 v24, v24, 8, s50 op_sel:[1,0,0,0]
    v_mad_u32_u16 v25, v25, 8, s50 op_sel:[1,0,0,0]
    v_mad_u32_u16 v26, v26, 8, s50 op_sel:[1,0,0,0]
    s_waitcnt lgkmcnt(0)
    v_lshlrev_b32 v112, 16, v64
    v_and_b32 v113, 0xffff0000, v64
    v_lshlrev_b32 v64, 16, v65
    v_and_b32 v65, 0xffff0000, v65
    v_lshlrev_b32 v114, 16, v66
    v_and_b32 v115, 0xffff0000, v66
    v_lshlrev_b32 v66, 16, v67
    v_and_b32 v67, 0xffff0000, v67
    v_lshlrev_b32 v116, 16, v68
    v_and_b32 v117, 0xffff0000, v68
    v_lshlrev_b32 v68, 16, v69
    v_and_b32 v69, 0xffff0000, v69
    v_pk_fma_f32 v[112:113], v[112:113], v[108:109], s[16:17] op_sel:[0,0,0] op_sel_hi:[1,0,0]
    v_pk_fma_f32 v[64:65], v[64:65], v[108:109], s[16:17] op_sel:[0,0,0] op_sel_hi:[1,0,0]
    v_pk_fma_f32 v[114:115], v[114:115], v[108:109], s[16:17] op_sel:[0,1,0] op_sel_hi:[1,1,0]
    v_pk_fma_f32 v[66:67], v[66:67], v[108:109], s[16:17] op_sel:[0,1,0] op_sel_hi:[1,1,0]
    v_pk_fma_f32 v[116:117], v[116:117], v[110:111], s[16:17] op_sel:[0,0,0] op_sel_hi:[1,0,0]
    v_pk_fma_f32 v[68:69], v[68:69], v[110:111], s[16:17] op_sel:[0,0,0] op_sel_hi:[1,0,0]
    v_perm_b32 v65, v65, v64, s17
    v_perm_b32 v64, v113, v112, s17
    v_perm_b32 v67, v67, v66, s17
    v_perm_b32 v66, v115, v114, s17
    v_perm_b32 v69, v69, v68, s17
    v_perm_b32 v68, v117, v116, s17
    v_lshl_add_u64 v[64:65], v[64:65], 0, s[20:21]
    v_lshl_add_u64 v[66:67], v[66:67], 0, s[20:21]
    v_lshl_add_u64 v[68:69], v[68:69], 0, s[20:21]
    v_or3_b32 v4, v44, v45, v4
    v_or3_b32 v4, v46, v47, v4
    v_or3_b32 v4, v48, v49, v4
    ds_add_rtn_u64 v[44:45], v24, v[64:65]
    ds_add_rtn_u64 v[46:47], v25, v[66:67]
    ds_add_rtn_u64 v[48:49], v26, v[68:69]
L_p2_kernel_noopt2_4:
    s_barrier
    s_waitcnt vmcnt(2)
    ds_write_b128 v3, v[88:91] offset:0
    ds_write_b128 v3, v[92:95] offset:16384
    ds_write_b128 v3, v[96:99] offset:32768
    ds_write_b128 v3, v[100:103] offset:49152
    ds_write_b128 v124, v[104:107]
    v_mbcnt_lo_u32_b32 v118, s34, 0
    v_mbcnt_hi_u32_b32 v118, s35, v118
    s_bcnt1_i32_b64 s14, s[34:35]
    v_lshl_add_u32 v119, v118, 1, s25
    ds_read_u16 v119, v119
    v_mad_u32_u24 v118, v118, s23, v2
    s_mov_b32 s34, s26
    s_lshl1_add_u32 s25, s14, s25
    s_mul_i32 s14, s14, s23
    s_add_u32 s26, s26, s14
    v_bfe_i32 v108, v19, 2, 10
    v_bfe_i32 v109, v19, 12, 10
    v_ashrrev_i32 v110, 22, v19
    v_cvt_f32_i32 v108, v108
    v_cvt_f32_i32 v109, v109
    v_cvt_f32_i32 v110, v110
    v_mad_u32_u16 v16, v16, 8, s50 op_sel:[1,0,0,0]
    v_mad_u32_u16 v17, v17, 8, s50 op_sel:[1,0,0,0]
    v_mad_u32_u16 v18, v18, 8, s50 op_sel:[1,0,0,0]
    v_lshlrev_b32 v112, 16, v76
    v_and_b32 v113, 0xffff0000, v76
    v_lshlrev_b32 v76, 16, v77
    v_and_b32 v77, 0xffff0000, v77
    v_lshlrev_b32 v114, 16, v78
    v_and_b32 v115, 0xffff0000, v78
    v_lshlrev_b32 v78, 16, v79
    v_and_b32 v79, 0xffff0000, v79
    v_lshlrev_b32 v116, 16, v80
    v_and_b32 v117, 0xffff0000, v80
    v_lshlrev_b32 v80, 16, v81
    v_and_b32 v81, 0xffff0000, v81
    v_pk_fma_f32 v[112:113], v[112:113], v[108:109], s[16:17] op_sel:[0,0,0] op_sel_hi:[1,0,0]
    v_pk_fma_f32 v[76:77], v[76:77], v[108:109], s[16:17] op_sel:[0,0,0] op_sel_hi:[1,0,0]
    v_pk_fma_f32 v[114:115], v[114:115], v[108:109], s[16:17] op_sel:[0,1,0] op_sel_hi:[1,1,0]
    v_pk_fma_f32 v[78:79], v[78:79], v[108:109], s[16:17] op_sel:[0,1,0] op_sel_hi:[1,1,0]
    v_pk_fma_f32 v[116:117], v[116:117], v[110:111], s[16:17] op_sel:[0,0,0] op_sel_hi:[1,0,0]
    v_pk_fma_f32 v[80:81], v[80:81], v[110:111], s[16:17] op_sel:[0,0,0] op_sel_hi:[1,0,0]
    v_perm_b32 v77, v77, v76, s17
    v_perm_b32 v76, v113, v112, s17
    v_perm_b32 v79, v79, v78, s17
    v_perm_b32 v78, v115, v114, s17
    v_perm_b32 v81, v81, v80, s17
    v_perm_b32 v80, v117, v116, s17
    v_lshl_add_u64 v[76:77], v[76:77], 0, s[20:21]
    v_lshl_add_u64 v[78:79], v[78:79], 0, s[20:21]
    v_lshl_add_u64 v[80:81], v[80:81], 0, s[20:21]
    s_waitcnt lgkmcnt(6)
    v_or3_b32 v4, v44, v45, v4
    v_or3_b32 v4, v46, v47, v4
    v_or3_b32 v4, v48, v49, v4
    ds_add_rtn_u64 v[44:45], v16, v[76:77]
    ds_add_rtn_u64 v[46:47], v17, v[78:79]
    ds_add_rtn_u64 v[48:49], v18, v[80:81]
    s_waitcnt lgkmcnt(3)
    v_lshl_add_u32 v118, v119, 4, v118
    buffer_load_dwordx4 v[16:19], v118, s[44:47], s34 offen offset:2048
    v_mbcnt_lo_u32_b32 v118, s36, 0
    v_mbcnt_hi_u32_b32 v118, s37, v118
    s_bcnt1_i32_b64 s14, s[36:37]
    v_lshl_add_u32 v119, v118, 1, s25
    ds_read_u16 v119, v119
    v_mad_u32_u24 v118, v118, s23, v2
    s_mov_b32 s36, s26
    s_lshl1_add_u32 s25, s14, s25
    s_mul_i32 s14, s14, s23
    s_add_u32 s26, s26, s14
    v_bfe_i32 v108, v23, 2, 10
    v_bfe_i32 v109, v23, 12, 10
    v_ashrrev_i32 v110, 22, v23
    v_cvt_f32_i32 v108, v108
    v_cvt_f32_i32 v109, v109
    v_cvt_f32_i32 v110, v110
    v_mad_u32_u16 v20, v20, 8, s50 op_sel:[1,0,0,0]
    v_mad_u32_u16 v21, v21, 8, s50 op_sel:[1,0,0,0]
    v_mad_u32_u16 v22, v22, 8, s50 op_sel:[1,0,0,0]
    v_lshlrev_b32 v112, 16, v82
    v_and_b32 v113, 0xffff0000, v82
    v_lshlrev_b32 v82, 16, v83
    v_and_b32 v83, 0xffff0000, v83
    v_lshlrev_b32 v114, 16, v84
    v_and_b32 v115, 0xffff0000, v84
    v_lshlrev_b32 v84, 16, v85
    v_and_b32 v85, 0xffff0000, v85
    v_lshlrev_b32 v116, 16, v86
    v_and_b32 v117, 0xffff0000, v86
    v_lshlrev_b32 v86, 16, v87
    v_and_b32 v87, 0xffff0000, v87
    v_pk_fma_f32 v[112:113], v[112:113], v[108:109], s[16:17] op_sel:[0,0,0] op_sel_hi:[1,0,0]
    v_pk_fma_f32 v[82:83], v[82:83], v[108:109], s[16:17] op_sel:[0,0,0] op_sel_hi:[1,0,0]
    v_pk_fma_f32 v[114:115], v[114:115], v[108:109], s[16:17] op_sel:[0,1,0] op_sel_hi:[1,1,0]
    v_pk_fma_f32 v[84:85], v[84:85], v[108:109], s[16:17] op_sel:[0,1,0] op_sel_hi:[1,1,0]
    v_pk_fma_f32 v[116:117], v[116:117], v[110:111], s[16:17] op_sel:[0,0,0] op_sel_hi:[1,0,0]
    v_pk_fma_f32 v[86:87], v[86:87], v[110:111], s[16:17] op_sel:[0,0,0] op_sel_hi:[1,0,0]
    v_perm_b32 v83, v83, v82, s17
    v_perm_b32 v82, v113, v112, s17
    v_perm_b32 v85, v85, v84, s17
    v_perm_b32 v84, v115, v114, s17
    v_perm_b32 v87, v87, v86, s17
    v_perm_b32 v86, v117, v116, s17
    v_lshl_add_u64 v[82:83], v[82:83], 0, s[20:21]
    v_lshl_add_u64 v[84:85], v[84:85], 0, s[20:21]
    v_lshl_add_u64 v[86:87], v[86:87], 0, s[20:21]
    s_waitcnt lgkmcnt(1)
    v_or3_b32 v4, v44, v45, v4
    v_or3_b32 v4, v46, v47, v4
    v_or3_b32 v4, v48, v49, v4
    ds_add_rtn_u64 v[44:45], v20, v[82:83]
    ds_add_rtn_u64 v[46:47], v21, v[84:85]
    ds_add_rtn_u64 v[48:49], v22, v[86:87]
    s_waitcnt lgkmcnt(3)
    v_lshl_add_u32 v118, v119, 4, v118
    buffer_load_dwordx4 v[20:23], v118, s[44:47], s36 offen offset:3072
    s_cmp_le_u32 s28, 256
    s_cbranch_scc1 L_p2_kernel_noopt_5
    v_readlane_b32 s38, v7, 8
    v_readlane_b32 s39, v7, 9
    s_nop 1
    v_mbcnt_lo_u32_b32 v118, s38, 0
    v_mbcnt_hi_u32_b32 v118, s39, v118
    s_bcnt1_i32_b64 s14, s[38:39]
    v_lshl_add_u32 v119, v118, 1, s25
    ds_read_u16 v119, v119
    v_mad_u32_u24 v118, v118, s23, v2
    s_mov_b32 s38, s26
    s_lshl1_add_u32 s25, s14, s25
    s_mul_i32 s14, s14, s23
    s_add_u32 s26, s26, s14
    s_waitcnt lgkmcnt(0)
    s_add_u32 s38, s38, 4096
    v_lshl_add_u32 v118, v119, 4, v118
    buffer_load_dwordx4 v[24:27], v118, s[44:47], s38 offen offset:0
L_p2_kernel_noopt_5:
    v_mad_u32_u16 v108, v28, v50, s40 op_sel:[1,0,0,0]
    v_mad_u32_u16 v109, v36, v50, s41 op_sel:[1,0,0,0]
    v_sub_u32_sdwa v110, v109, v108 dst_sel:DWORD dst_unused:UNUSED_PAD src0_sel:WORD_1 src1_sel:WORD_1
    s_nop 1
    v_add_u32_dpp v110, v110, v110 row_shr:1 row_mask:0xf bank_mask:0xf bound_ctrl:0
    s_nop 1
    v_add_u32_dpp v110, v110, v110 row_shr:2 row_mask:0xf bank_mask:0xf bound_ctrl:0
    s_nop 1
    v_add_u32_dpp v110, v110, v110 row_shr:4 row_mask:0xf bank_mask:0xf bound_ctrl:0
    s_nop 1
    v_add_u32_dpp v110, v110, v110 row_shr:8 row_mask:0xf bank_mask:0xf bound_ctrl:0
    s_nop 1
    v_add_u32_dpp v110, v110, v110 row_bcast:15 row_mask:0xa bank_mask:0xf
    s_nop 1
    v_add_u32_dpp v110, v110, v110 row_bcast:31 row_mask:0xc bank_mask:0xf
    v_sub_u32_sdwa v109, v109, v110 dst_sel:DWORD dst_unused:UNUSED_PAD src0_sel:WORD_1 src1_sel:DWORD
    v_readlane_b32 s29, v110, 63
    v_add_u32 v110, -1, v110
    ds_write_b16 v126, v109
    v_lshlrev_b32_e64 v111, v110, 1
    v_lshrrev_b32 v110, 5, v110
    v_lshl_add_u32 v110, v110, 2, s19
    s_cmp_gt_u32 s29, 320
    s_cselect_b32 s2, 1, s2
    s_cselect_b64 exec, 0, -1
    ds_or_b32 v110, v111 offset:160
    s_mov_b64 exec, -1
    ds_wrxchg_rtn_b32 v7, v6, v5 offset:160
    s_add_u32 s14, s22, 80000
    buffer_load_dwordx4 v[88:91], v1, s[8:11], s14 offen
    s_add_u32 s14, s22, 96384
    buffer_load_dwordx4 v[92:95], v1, s[8:11], s14 offen
    s_add_u32 s14, s22, 112768
    buffer_load_dwordx4 v[96:99], v1, s[8:11], s14 offen
    s_add_u32 s24, s24, 1
    s_cmp_lt_u32 s24, 8
    s_barrier
    s_cbranch_scc1 L_p2_loop
    s_waitcnt lgkmcnt(3)
    v_or3_b32 v4, v44, v45, v4
    v_or3_b32 v4, v46, v47, v4
    v_or3_b32 v4, v48, v49, v4
    s_mov_b32 s27, s19
    s_waitcnt vmcnt(0)
    v_mov_b32 v8, 160232
    s_cmp_lg_u32 s13, 0
    s_cselect_b64 exec, 0, 1
    ds_write_b32 v8, v52
    s_mov_b64 exec, -1
    v_subrev_u32 v6, 80000, v124
    s_mul_i32 s24, s12, 20000
    v_subrev_u32 v10, s24, v1
    v_mov_b32 v11, 0x7f000000
    s_waitcnt vmcnt(0) lgkmcnt(0)
    s_barrier
    s_cmp_lt_u32 s13, 4
    s_cbranch_scc1 L_p2_ga
    v_lshlrev_b32 v30, 16, v60
    v_and_b32 v31, 0xffff0000, v60
    v_lshlrev_b32 v36, 16, v53
    v_and_b32 v37, 0xffff0000, v53
    v_lshlrev_b32 v38, 16, v54
    v_and_b32 v39, 0xffff0000, v54
    v_lshlrev_b32 v40, 16, v56
    v_and_b32 v41, 0xffff0000, v56
    v_lshlrev_b32 v42, 16, v57
    v_and_b32 v43, 0xffff0000, v57
    v_pk_add_f32 v[14:15], v[30:31], v[36:37] op_sel:[0,0] op_sel_hi:[1,0] neg_lo:[0,1] neg_hi:[0,1]
    v_pk_add_f32 v[16:17], v[30:31], v[36:37] op_sel:[0,1] op_sel_hi:[1,1] neg_lo:[0,1] neg_hi:[0,1]
    v_pk_add_f32 v[18:19], v[30:31], v[38:39] op_sel:[0,0] op_sel_hi:[1,0] neg_lo:[0,1] neg_hi:[0,1]
    v_pk_add_f32 v[20:21], v[30:31], v[38:39] op_sel:[0,1] op_sel_hi:[1,1] neg_lo:[0,1] neg_hi:[0,1]
    v_pk_add_f32 v[22:23], v[30:31], v[40:41] op_sel:[0,0] op_sel_hi:[1,0] neg_lo:[0,1] neg_hi:[0,1]
    v_pk_add_f32 v[24:25], v[30:31], v[40:41] op_sel:[0,1] op_sel_hi:[1,1] neg_lo:[0,1] neg_hi:[0,1]
    v_pk_add_f32 v[26:27], v[30:31], v[42:43] op_sel:[0,0] op_sel_hi:[1,0] neg_lo:[0,1] neg_hi:[0,1]
    v_pk_add_f32 v[28:29], v[30:31], v[42:43] op_sel:[0,1] op_sel_hi:[1,1] neg_lo:[0,1] neg_hi:[0,1]
    v_cvt_pk_bf16_f32 v32, v14, v15
    v_lshlrev_b32 v14, 16, v32
    v_and_b32 v15, 0xffff0000, v32
    v_cvt_pk_bf16_f32 v32, v16, v17
    v_lshlrev_b32 v16, 16, v32
    v_and_b32 v17, 0xffff0000, v32
    v_cvt_pk_bf16_f32 v32, v18, v19
    v_lshlrev_b32 v18, 16, v32
    v_and_b32 v19, 0xffff0000, v32
    v_cvt_pk_bf16_f32 v32, v20, v21
    v_lshlrev_b32 v20, 16, v32
    v_and_b32 v21, 0xffff0000, v32
    v_cvt_pk_bf16_f32 v32, v22, v23
    v_lshlrev_b32 v22, 16, v32
    v_and_b32 v23, 0xffff0000, v32
    v_cvt_pk_bf16_f32 v32, v24, v25
    v_lshlrev_b32 v24, 16, v32
    v_and_b32 v25, 0xffff0000, v32
    v_cvt_pk_bf16_f32 v32, v26, v27
    v_lshlrev_b32 v26, 16, v32
    v_and_b32 v27, 0xffff0000, v32
    v_cvt_pk_bf16_f32 v32, v28, v29
    v_lshlrev_b32 v28, 16, v32
    v_and_b32 v29, 0xffff0000, v32
    v_pk_mul_f32 v[14:15], v[14:15], v[14:15]
    v_pk_mul_f32 v[16:17], v[16:17], v[16:17]
    v_pk_mul_f32 v[18:19], v[18:19], v[18:19]
    v_pk_mul_f32 v[20:21], v[20:21], v[20:21]
    v_pk_mul_f32 v[22:23], v[22:23], v[22:23]
    v_pk_mul_f32 v[24:25], v[24:25], v[24:25]
    v_pk_mul_f32 v[26:27], v[26:27], v[26:27]
    v_pk_mul_f32 v[28:29], v[28:29], v[28:29]
    v_cvt_pk_bf16_f32 v32, v14, v15
    v_lshlrev_b32 v14, 16, v32
    v_and_b32 v15, 0xffff0000, v32
    v_cvt_pk_bf16_f32 v32, v16, v17
    v_lshlrev_b32 v16, 16, v32
    v_and_b32 v17, 0xffff0000, v32
    v_cvt_pk_bf16_f32 v32, v18, v19
    v_lshlrev_b32 v18, 16, v32
    v_and_b32 v19, 0xffff0000, v32
    v_cvt_pk_bf16_f32 v32, v20, v21
    v_lshlrev_b32 v20, 16, v32
    v_and_b32 v21, 0xffff0000, v32
    v_cvt_pk_bf16_f32 v32, v22, v23
    v_lshlrev_b32 v22, 16, v32
    v_and_b32 v23, 0xffff0000, v32
    v_cvt_pk_bf16_f32 v32, v24, v25
    v_lshlrev_b32 v24, 16, v32
    v_and_b32 v25, 0xffff0000, v32
    v_cvt_pk_bf16_f32 v32, v26, v27
    v_lshlrev_b32 v26, 16, v32
    v_and_b32 v27, 0xffff0000, v32
    v_cvt_pk_bf16_f32 v32, v28, v29
    v_lshlrev_b32 v28, 16, v32
    v_and_b32 v29, 0xffff0000, v32
    v_mov_b32 v30, 1092616192
    v_mov_b32 v31, 0x3fb8aa3b
    v_pk_mul_f32 v[14:15], v[14:15], v[30:31] op_sel:[0,0] op_sel_hi:[1,0]
    v_pk_mul_f32 v[16:17], v[16:17], v[30:31] op_sel:[0,0] op_sel_hi:[1,0]
    v_pk_mul_f32 v[18:19], v[18:19], v[30:31] op_sel:[0,0] op_sel_hi:[1,0]
    v_pk_mul_f32 v[20:21], v[20:21], v[30:31] op_sel:[0,0] op_sel_hi:[1,0]
    v_pk_mul_f32 v[22:23], v[22:23], v[30:31] op_sel:[0,0] op_sel_hi:[1,0]
    v_pk_mul_f32 v[24:25], v[24:25], v[30:31] op_sel:[0,0] op_sel_hi:[1,0]
    v_pk_mul_f32 v[26:27], v[26:27], v[30:31] op_sel:[0,0] op_sel_hi:[1,0]
    v_pk_mul_f32 v[28:29], v[28:29], v[30:31] op_sel:[0,0] op_sel_hi:[1,0]
    v_cvt_pk_bf16_f32 v32, v14, v15
    v_lshlrev_b32 v14, 16, v32
    v_and_b32 v15, 0xffff0000, v32
    v_cvt_pk_bf16_f32 v32, v16, v17
    v_lshlrev_b32 v16, 16, v32
    v_and_b32 v17, 0xffff0000, v32
    v_cvt_pk_bf16_f32 v32, v18, v19
    v_lshlrev_b32 v18, 16, v32
    v_and_b32 v19, 0xffff0000, v32
    v_cvt_pk_bf16_f32 v32, v20, v21
    v_lshlrev_b32 v20, 16, v32
    v_and_b32 v21, 0xffff0000, v32
    v_cvt_pk_bf16_f32 v32, v22, v23
    v_lshlrev_b32 v22, 16, v32
    v_and_b32 v23, 0xffff0000, v32
    v_cvt_pk_bf16_f32 v32, v24, v25
    v_lshlrev_b32 v24, 16, v32
    v_and_b32 v25, 0xffff0000, v32
    v_cvt_pk_bf16_f32 v32, v26, v27
    v_lshlrev_b32 v26, 16, v32
    v_and_b32 v27, 0xffff0000, v32
    v_cvt_pk_bf16_f32 v32, v28, v29
    v_lshlrev_b32 v28, 16, v32
    v_and_b32 v29, 0xffff0000, v32
    v_pk_mul_f32 v[14:15], v[14:15], v[30:31] op_sel:[0,1] op_sel_hi:[1,1]
    v_pk_mul_f32 v[16:17], v[16:17], v[30:31] op_sel:[0,1] op_sel_hi:[1,1]
    v_pk_mul_f32 v[18:19], v[18:19], v[30:31] op_sel:[0,1] op_sel_hi:[1,1]
    v_pk_mul_f32 v[20:21], v[20:21], v[30:31] op_sel:[0,1] op_sel_hi:[1,1]
    v_pk_mul_f32 v[22:23], v[22:23], v[30:31] op_sel:[0,1] op_sel_hi:[1,1]
    v_pk_mul_f32 v[24:25], v[24:25], v[30:31] op_sel:[0,1] op_sel_hi:[1,1]
    v_pk_mul_f32 v[26:27], v[26:27], v[30:31] op_sel:[0,1] op_sel_hi:[1,1]
    v_pk_mul_f32 v[28:29], v[28:29], v[30:31] op_sel:[0,1] op_sel_hi:[1,1]
    v_exp_f32 v14, -v14
    v_exp_f32 v15, -v15
    v_exp_f32 v16, -v16
    v_exp_f32 v17, -v17
    v_exp_f32 v18, -v18
    v_exp_f32 v19, -v19
    v_exp_f32 v20, -v20
    v_exp_f32 v21, -v21
    v_exp_f32 v22, -v22
    v_exp_f32 v23, -v23
    v_exp_f32 v24, -v24
    v_exp_f32 v25, -v25
    v_exp_f32 v26, -v26
    v_exp_f32 v27, -v27
    v_exp_f32 v28, -v28
    v_exp_f32 v29, -v29
    v_cvt_pk_bf16_f32 v14, v14, v16
    v_cvt_pk_bf16_f32 v15, v15, v17
    v_cvt_pk_bf16_f32 v18, v18, v20
    v_cvt_pk_bf16_f32 v19, v19, v21
    v_cvt_pk_bf16_f32 v22, v22, v24
    v_cvt_pk_bf16_f32 v23, v23, v25
    v_cvt_pk_bf16_f32 v26, v26, v28
    v_cvt_pk_bf16_f32 v27, v27, v29
    v_dot2_f32_bf16 v72, v14, s68, 0
    v_dot2_f32_bf16 v73, v15, s68, 0
    v_dot2_f32_bf16 v74, v14, s69, 0
    v_dot2_f32_bf16 v75, v15, s69, 0
    v_dot2_f32_bf16 v76, v14, s70, 0
    v_dot2_f32_bf16 v77, v15, s70, 0
    v_dot2_f32_bf16 v78, v14, s71, 0
    v_dot2_f32_bf16 v79, v15, s71, 0
    v_dot2_f32_bf16 v80, v14, s52, 0
    v_dot2_f32_bf16 v81, v15, s52, 0
    v_dot2_f32_bf16 v82, v14, s53, 0
    v_dot2_f32_bf16 v83, v15, s53, 0
    v_dot2_f32_bf16 v84, v14, s54, 0
    v_dot2_f32_bf16 v85, v15, s54, 0
    v_dot2_f32_bf16 v86, v14, s55, 0
    v_dot2_f32_bf16 v87, v15, s55, 0
    v_dot2_f32_bf16 v72, v18, s72, v72
    v_dot2_f32_bf16 v73, v19, s72, v73
    v_dot2_f32_bf16 v74, v18, s73, v74
    v_dot2_f32_bf16 v75, v19, s73, v75
    v_dot2_f32_bf16 v76, v18, s74, v76
    v_dot2_f32_bf16 v77, v19, s74, v77
    v_dot2_f32_bf16 v78, v18, s75, v78
    v_dot2_f32_bf16 v79, v19, s75, v79
    v_dot2_f32_bf16 v80, v18, s56, v80
    v_dot2_f32_bf16 v81, v19, s56, v81
    v_dot2_f32_bf16 v82, v18, s57, v82
    v_dot2_f32_bf16 v83, v19, s57, v83
    v_dot2_f32_bf16 v84, v18, s58, v84
    v_dot2_f32_bf16 v85, v19, s58, v85
    v_dot2_f32_bf16 v86, v18, s59, v86
    v_dot2_f32_bf16 v87, v19, s59, v87
    v_dot2_f32_bf16 v72, v22, s76, v72
    v_dot2_f32_bf16 v73, v23, s76, v73
    v_dot2_f32_bf16 v74, v22, s77, v74
    v_dot2_f32_bf16 v75, v23, s77, v75
    v_dot2_f32_bf16 v76, v22, s78, v76
    v_dot2_f32_bf16 v77, v23, s78, v77
    v_dot2_f32_bf16 v78, v22, s79, v78
    v_dot2_f32_bf16 v79, v23, s79, v79
    v_dot2_f32_bf16 v80, v22, s60, v80
    v_dot2_f32_bf16 v81, v23, s60, v81
    v_dot2_f32_bf16 v82, v22, s61, v82
    v_dot2_f32_bf16 v83, v23, s61, v83
    v_dot2_f32_bf16 v84, v22, s62, v84
    v_dot2_f32_bf16 v85, v23, s62, v85
    v_dot2_f32_bf16 v86, v22, s63, v86
    v_dot2_f32_bf16 v87, v23, s63, v87
    v_dot2_f32_bf16 v72, v26, s80, v72
    v_dot2_f32_bf16 v73, v27, s80, v73
    v_dot2_f32_bf16 v74, v26, s81, v74
    v_dot2_f32_bf16 v75, v27, s81, v75
    v_dot2_f32_bf16 v76, v26, s82, v76
    v_dot2_f32_bf16 v77, v27, s82, v77
    v_dot2_f32_bf16 v78, v26, s83, v78
    v_dot2_f32_bf16 v79, v27, s83, v79
    v_dot2_f32_bf16 v80, v26, s64, v80
    v_dot2_f32_bf16 v81, v27, s64, v81
    v_dot2_f32_bf16 v82, v26, s65, v82
    v_dot2_f32_bf16 v83, v27, s65, v83
    v_dot2_f32_bf16 v84, v26, s66, v84
    v_dot2_f32_bf16 v85, v27, s66, v85
    v_dot2_f32_bf16 v86, v26, s67, v86
    v_dot2_f32_bf16 v87, v27, s67, v87
L_p2_ga:
    ds_read_b32 v9, v8
    ds_read_b128 v[88:91], v1 offset:0
    ds_read_b128 v[92:95], v1 offset:16384
    ds_read_b128 v[96:99], v1 offset:32768
    ds_read_b128 v[100:103], v1 offset:49152
    ds_read_b128 v[104:107], v6
    s_mul_i32 s14, s12, 5120000
    s_mul_i32 s15, s3, 80000
    s_add_u32 s25, s14, s15
    s_add_u32 s25, s25, 232727040
    s_waitcnt lgkmcnt(5)
    v_readfirstlane_b32 s21, v9
    s_nop 0
    s_bfe_u32 s21, s21, 524296
    s_cmp_lg_u32 s21, 4
    s_cselect_b32 s21, 1, 0
    s_cselect_b32 s24, 0, 20000
    v_cmp_le_u32 vcc, s24, v10
    v_add_u32 v10, 16384, v10
    s_add_u32 s14, s25, 0
    v_cndmask_b32 v12, v11, v1, vcc
    s_waitcnt lgkmcnt(4)
    buffer_store_dwordx4 v[88:91], v12, s[4:7], s14 offen sc1
    v_or3_b32 v4, v88, v89, v4
    v_or3_b32 v4, v90, v91, v4
    v_cmp_le_u32 vcc, s24, v10
    v_add_u32 v10, 16384, v10
    s_add_u32 s14, s25, 16384
    v_cndmask_b32 v12, v11, v1, vcc
    s_waitcnt lgkmcnt(3)
    buffer_store_dwordx4 v[92:95], v12, s[4:7], s14 offen sc1
    v_or3_b32 v4, v92, v93, v4
    v_or3_b32 v4, v94, v95, v4
    v_cmp_le_u32 vcc, s24, v10
    v_add_u32 v10, 16384, v10
    s_add_u32 s14, s25, 32768
    v_cndmask_b32 v12, v11, v1, vcc
    s_waitcnt lgkmcnt(2)
    buffer_store_dwordx4 v[96:99], v12, s[4:7], s14 offen sc1
    v_or3_b32 v4, v96, v97, v4
    v_or3_b32 v4, v98, v99, v4
    v_cmp_le_u32 vcc, s24, v10
    v_add_u32 v10, 16384, v10
    s_add_u32 s14, s25, 49152
    v_cndmask_b32 v12, v11, v1, vcc
    s_waitcnt lgkmcnt(1)
    buffer_store_dwordx4 v[100:103], v12, s[4:7], s14 offen sc1
    v_or3_b32 v4, v100, v101, v4
    v_or3_b32 v4, v102, v103, v4
    v_cmp_le_u32 vcc, s24, v10
    v_add_u32 v10, 16384, v10
    s_add_u32 s14, s25, 0
    v_cndmask_b32 v12, v11, v6, vcc
    s_waitcnt lgkmcnt(0)
    buffer_store_dwordx4 v[104:107], v12, s[4:7], s14 offen sc1
    v_or3_b32 v4, v104, v105, v4
    v_or3_b32 v4, v106, v107, v4
    s_load_dwordx2 s[16:17], s[0:1], 88
    s_cmp_ge_u32 s13, 4
    s_cbranch_scc1 L_p2_gb
    v_lshlrev_b32 v30, 16, v60
    v_and_b32 v31, 0xffff0000, v60
    v_lshlrev_b32 v36, 16, v53
    v_and_b32 v37, 0xffff0000, v53
    v_lshlrev_b32 v38, 16, v54
    v_and_b32 v39, 0xffff0000, v54
    v_lshlrev_b32 v40, 16, v56
    v_and_b32 v41, 0xffff0000, v56
    v_lshlrev_b32 v42, 16, v57
    v_and_b32 v43, 0xffff0000, v57
    v_pk_add_f32 v[14:15], v[30:31], v[36:37] op_sel:[0,0] op_sel_hi:[1,0] neg_lo:[0,1] neg_hi:[0,1]
    v_pk_add_f32 v[16:17], v[30:31], v[36:37] op_sel:[0,1] op_sel_hi:[1,1] neg_lo:[0,1] neg_hi:[0,1]
    v_pk_add_f32 v[18:19], v[30:31], v[38:39] op_sel:[0,0] op_sel_hi:[1,0] neg_lo:[0,1] neg_hi:[0,1]
    v_pk_add_f32 v[20:21], v[30:31], v[38:39] op_sel:[0,1] op_sel_hi:[1,1] neg_lo:[0,1] neg_hi:[0,1]
    v_pk_add_f32 v[22:23], v[30:31], v[40:41] op_sel:[0,0] op_sel_hi:[1,0] neg_lo:[0,1] neg_hi:[0,1]
    v_pk_add_f32 v[24:25], v[30:31], v[40:41] op_sel:[0,1] op_sel_hi:[1,1] neg_lo:[0,1] neg_hi:[0,1]
    v_pk_add_f32 v[26:27], v[30:31], v[42:43] op_sel:[0,0] op_sel_hi:[1,0] neg_lo:[0,1] neg_hi:[0,1]
    v_pk_add_f32 v[28:29], v[30:31], v[42:43] op_sel:[0,1] op_sel_hi:[1,1] neg_lo:[0,1] neg_hi:[0,1]
    v_cvt_pk_bf16_f32 v32, v14, v15
    v_lshlrev_b32 v14, 16, v32
    v_and_b32 v15, 0xffff0000, v32
    v_cvt_pk_bf16_f32 v32, v16, v17
    v_lshlrev_b32 v16, 16, v32
    v_and_b32 v17, 0xffff0000, v32
    v_cvt_pk_bf16_f32 v32, v18, v19
    v_lshlrev_b32 v18, 16, v32
    v_and_b32 v19, 0xffff0000, v32
    v_cvt_pk_bf16_f32 v32, v20, v21
    v_lshlrev_b32 v20, 16, v32
    v_and_b32 v21, 0xffff0000, v32
    v_cvt_pk_bf16_f32 v32, v22, v23
    v_lshlrev_b32 v22, 16, v32
    v_and_b32 v23, 0xffff0000, v32
    v_cvt_pk_bf16_f32 v32, v24, v25
    v_lshlrev_b32 v24, 16, v32
    v_and_b32 v25, 0xffff0000, v32
    v_cvt_pk_bf16_f32 v32, v26, v27
    v_lshlrev_b32 v26, 16, v32
    v_and_b32 v27, 0xffff0000, v32
    v_cvt_pk_bf16_f32 v32, v28, v29
    v_lshlrev_b32 v28, 16, v32
    v_and_b32 v29, 0xffff0000, v32
    v_pk_mul_f32 v[14:15], v[14:15], v[14:15]
    v_pk_mul_f32 v[16:17], v[16:17], v[16:17]
    v_pk_mul_f32 v[18:19], v[18:19], v[18:19]
    v_pk_mul_f32 v[20:21], v[20:21], v[20:21]
    v_pk_mul_f32 v[22:23], v[22:23], v[22:23]
    v_pk_mul_f32 v[24:25], v[24:25], v[24:25]
    v_pk_mul_f32 v[26:27], v[26:27], v[26:27]
    v_pk_mul_f32 v[28:29], v[28:29], v[28:29]
    v_cvt_pk_bf16_f32 v32, v14, v15
    v_lshlrev_b32 v14, 16, v32
    v_and_b32 v15, 0xffff0000, v32
    v_cvt_pk_bf16_f32 v32, v16, v17
    v_lshlrev_b32 v16, 16, v32
    v_and_b32 v17, 0xffff0000, v32
    v_cvt_pk_bf16_f32 v32, v18, v19
    v_lshlrev_b32 v18, 16, v32
    v_and_b32 v19, 0xffff0000, v32
    v_cvt_pk_bf16_f32 v32, v20, v21
    v_lshlrev_b32 v20, 16, v32
    v_and_b32 v21, 0xffff0000, v32
    v_cvt_pk_bf16_f32 v32, v22, v23
    v_lshlrev_b32 v22, 16, v32
    v_and_b32 v23, 0xffff0000, v32
    v_cvt_pk_bf16_f32 v32, v24, v25
    v_lshlrev_b32 v24, 16, v32
    v_and_b32 v25, 0xffff0000, v32
    v_cvt_pk_bf16_f32 v32, v26, v27
    v_lshlrev_b32 v26, 16, v32
    v_and_b32 v27, 0xffff0000, v32
    v_cvt_pk_bf16_f32 v32, v28, v29
    v_lshlrev_b32 v28, 16, v32
    v_and_b32 v29, 0xffff0000, v32
    v_mov_b32 v30, 1092616192
    v_mov_b32 v31, 0x3fb8aa3b
    v_pk_mul_f32 v[14:15], v[14:15], v[30:31] op_sel:[0,0] op_sel_hi:[1,0]
    v_pk_mul_f32 v[16:17], v[16:17], v[30:31] op_sel:[0,0] op_sel_hi:[1,0]
    v_pk_mul_f32 v[18:19], v[18:19], v[30:31] op_sel:[0,0] op_sel_hi:[1,0]
    v_pk_mul_f32 v[20:21], v[20:21], v[30:31] op_sel:[0,0] op_sel_hi:[1,0]
    v_pk_mul_f32 v[22:23], v[22:23], v[30:31] op_sel:[0,0] op_sel_hi:[1,0]
    v_pk_mul_f32 v[24:25], v[24:25], v[30:31] op_sel:[0,0] op_sel_hi:[1,0]
    v_pk_mul_f32 v[26:27], v[26:27], v[30:31] op_sel:[0,0] op_sel_hi:[1,0]
    v_pk_mul_f32 v[28:29], v[28:29], v[30:31] op_sel:[0,0] op_sel_hi:[1,0]
    v_cvt_pk_bf16_f32 v32, v14, v15
    v_lshlrev_b32 v14, 16, v32
    v_and_b32 v15, 0xffff0000, v32
    v_cvt_pk_bf16_f32 v32, v16, v17
    v_lshlrev_b32 v16, 16, v32
    v_and_b32 v17, 0xffff0000, v32
    v_cvt_pk_bf16_f32 v32, v18, v19
    v_lshlrev_b32 v18, 16, v32
    v_and_b32 v19, 0xffff0000, v32
    v_cvt_pk_bf16_f32 v32, v20, v21
    v_lshlrev_b32 v20, 16, v32
    v_and_b32 v21, 0xffff0000, v32
    v_cvt_pk_bf16_f32 v32, v22, v23
    v_lshlrev_b32 v22, 16, v32
    v_and_b32 v23, 0xffff0000, v32
    v_cvt_pk_bf16_f32 v32, v24, v25
    v_lshlrev_b32 v24, 16, v32
    v_and_b32 v25, 0xffff0000, v32
    v_cvt_pk_bf16_f32 v32, v26, v27
    v_lshlrev_b32 v26, 16, v32
    v_and_b32 v27, 0xffff0000, v32
    v_cvt_pk_bf16_f32 v32, v28, v29
    v_lshlrev_b32 v28, 16, v32
    v_and_b32 v29, 0xffff0000, v32
    v_pk_mul_f32 v[14:15], v[14:15], v[30:31] op_sel:[0,1] op_sel_hi:[1,1]
    v_pk_mul_f32 v[16:17], v[16:17], v[30:31] op_sel:[0,1] op_sel_hi:[1,1]
    v_pk_mul_f32 v[18:19], v[18:19], v[30:31] op_sel:[0,1] op_sel_hi:[1,1]
    v_pk_mul_f32 v[20:21], v[20:21], v[30:31] op_sel:[0,1] op_sel_hi:[1,1]
    v_pk_mul_f32 v[22:23], v[22:23], v[30:31] op_sel:[0,1] op_sel_hi:[1,1]
    v_pk_mul_f32 v[24:25], v[24:25], v[30:31] op_sel:[0,1] op_sel_hi:[1,1]
    v_pk_mul_f32 v[26:27], v[26:27], v[30:31] op_sel:[0,1] op_sel_hi:[1,1]
    v_pk_mul_f32 v[28:29], v[28:29], v[30:31] op_sel:[0,1] op_sel_hi:[1,1]
    v_exp_f32 v14, -v14
    v_exp_f32 v15, -v15
    v_exp_f32 v16, -v16
    v_exp_f32 v17, -v17
    v_exp_f32 v18, -v18
    v_exp_f32 v19, -v19
    v_exp_f32 v20, -v20
    v_exp_f32 v21, -v21
    v_exp_f32 v22, -v22
    v_exp_f32 v23, -v23
    v_exp_f32 v24, -v24
    v_exp_f32 v25, -v25
    v_exp_f32 v26, -v26
    v_exp_f32 v27, -v27
    v_exp_f32 v28, -v28
    v_exp_f32 v29, -v29
    v_cvt_pk_bf16_f32 v14, v14, v16
    v_cvt_pk_bf16_f32 v15, v15, v17
    v_cvt_pk_bf16_f32 v18, v18, v20
    v_cvt_pk_bf16_f32 v19, v19, v21
    v_cvt_pk_bf16_f32 v22, v22, v24
    v_cvt_pk_bf16_f32 v23, v23, v25
    v_cvt_pk_bf16_f32 v26, v26, v28
    v_cvt_pk_bf16_f32 v27, v27, v29
    v_dot2_f32_bf16 v72, v14, s68, 0
    v_dot2_f32_bf16 v73, v15, s68, 0
    v_dot2_f32_bf16 v74, v14, s69, 0
    v_dot2_f32_bf16 v75, v15, s69, 0
    v_dot2_f32_bf16 v76, v14, s70, 0
    v_dot2_f32_bf16 v77, v15, s70, 0
    v_dot2_f32_bf16 v78, v14, s71, 0
    v_dot2_f32_bf16 v79, v15, s71, 0
    v_dot2_f32_bf16 v80, v14, s52, 0
    v_dot2_f32_bf16 v81, v15, s52, 0
    v_dot2_f32_bf16 v82, v14, s53, 0
    v_dot2_f32_bf16 v83, v15, s53, 0
    v_dot2_f32_bf16 v84, v14, s54, 0
    v_dot2_f32_bf16 v85, v15, s54, 0
    v_dot2_f32_bf16 v86, v14, s55, 0
    v_dot2_f32_bf16 v87, v15, s55, 0
    v_dot2_f32_bf16 v72, v18, s72, v72
    v_dot2_f32_bf16 v73, v19, s72, v73
    v_dot2_f32_bf16 v74, v18, s73, v74
    v_dot2_f32_bf16 v75, v19, s73, v75
    v_dot2_f32_bf16 v76, v18, s74, v76
    v_dot2_f32_bf16 v77, v19, s74, v77
    v_dot2_f32_bf16 v78, v18, s75, v78
    v_dot2_f32_bf16 v79, v19, s75, v79
    v_dot2_f32_bf16 v80, v18, s56, v80
    v_dot2_f32_bf16 v81, v19, s56, v81
    v_dot2_f32_bf16 v82, v18, s57, v82
    v_dot2_f32_bf16 v83, v19, s57, v83
    v_dot2_f32_bf16 v84, v18, s58, v84
    v_dot2_f32_bf16 v85, v19, s58, v85
    v_dot2_f32_bf16 v86, v18, s59, v86
    v_dot2_f32_bf16 v87, v19, s59, v87
    v_dot2_f32_bf16 v72, v22, s76, v72
    v_dot2_f32_bf16 v73, v23, s76, v73
    v_dot2_f32_bf16 v74, v22, s77, v74
    v_dot2_f32_bf16 v75, v23, s77, v75
    v_dot2_f32_bf16 v76, v22, s78, v76
    v_dot2_f32_bf16 v77, v23, s78, v77
    v_dot2_f32_bf16 v78, v22, s79, v78
    v_dot2_f32_bf16 v79, v23, s79, v79
    v_dot2_f32_bf16 v80, v22, s60, v80
    v_dot2_f32_bf16 v81, v23, s60, v81
    v_dot2_f32_bf16 v82, v22, s61, v82
    v_dot2_f32_bf16 v83, v23, s61, v83
    v_dot2_f32_bf16 v84, v22, s62, v84
    v_dot2_f32_bf16 v85, v23, s62, v85
    v_dot2_f32_bf16 v86, v22, s63, v86
    v_dot2_f32_bf16 v87, v23, s63, v87
    v_dot2_f32_bf16 v72, v26, s80, v72
    v_dot2_f32_bf16 v73, v27, s80, v73
    v_dot2_f32_bf16 v74, v26, s81, v74
    v_dot2_f32_bf16 v75, v27, s81, v75
    v_dot2_f32_bf16 v76, v26, s82, v76
    v_dot2_f32_bf16 v77, v27, s82, v77
    v_dot2_f32_bf16 v78, v26, s83, v78
    v_dot2_f32_bf16 v79, v27, s83, v79
    v_dot2_f32_bf16 v80, v26, s64, v80
    v_dot2_f32_bf16 v81, v27, s64, v81
    v_dot2_f32_bf16 v82, v26, s65, v82
    v_dot2_f32_bf16 v83, v27, s65, v83
    v_dot2_f32_bf16 v84, v26, s66, v84
    v_dot2_f32_bf16 v85, v27, s66, v85
    v_dot2_f32_bf16 v86, v26, s67, v86
    v_dot2_f32_bf16 v87, v27, s67, v87
    s_cmp_ge_u32 s13, 4
    s_cbranch_scc1 L_p2_kernel_g1_6
    v_lshlrev_b32 v30, 16, v61
    v_and_b32 v31, 0xffff0000, v61
    v_pk_add_f32 v[14:15], v[30:31], v[36:37] op_sel:[0,0] op_sel_hi:[1,0] neg_lo:[0,1] neg_hi:[0,1]
    v_pk_add_f32 v[16:17], v[30:31], v[36:37] op_sel:[0,1] op_sel_hi:[1,1] neg_lo:[0,1] neg_hi:[0,1]
    v_pk_add_f32 v[18:19], v[30:31], v[38:39] op_sel:[0,0] op_sel_hi:[1,0] neg_lo:[0,1] neg_hi:[0,1]
    v_pk_add_f32 v[20:21], v[30:31], v[38:39] op_sel:[0,1] op_sel_hi:[1,1] neg_lo:[0,1] neg_hi:[0,1]
    v_pk_add_f32 v[22:23], v[30:31], v[40:41] op_sel:[0,0] op_sel_hi:[1,0] neg_lo:[0,1] neg_hi:[0,1]
    v_pk_add_f32 v[24:25], v[30:31], v[40:41] op_sel:[0,1] op_sel_hi:[1,1] neg_lo:[0,1] neg_hi:[0,1]
    v_pk_add_f32 v[26:27], v[30:31], v[42:43] op_sel:[0,0] op_sel_hi:[1,0] neg_lo:[0,1] neg_hi:[0,1]
    v_pk_add_f32 v[28:29], v[30:31], v[42:43] op_sel:[0,1] op_sel_hi:[1,1] neg_lo:[0,1] neg_hi:[0,1]
    v_cvt_pk_bf16_f32 v32, v14, v15
    v_lshlrev_b32 v14, 16, v32
    v_and_b32 v15, 0xffff0000, v32
    v_cvt_pk_bf16_f32 v32, v16, v17
    v_lshlrev_b32 v16, 16, v32
    v_and_b32 v17, 0xffff0000, v32
    v_cvt_pk_bf16_f32 v32, v18, v19
    v_lshlrev_b32 v18, 16, v32
    v_and_b32 v19, 0xffff0000, v32
    v_cvt_pk_bf16_f32 v32, v20, v21
    v_lshlrev_b32 v20, 16, v32
    v_and_b32 v21, 0xffff0000, v32
    v_cvt_pk_bf16_f32 v32, v22, v23
    v_lshlrev_b32 v22, 16, v32
    v_and_b32 v23, 0xffff0000, v32
    v_cvt_pk_bf16_f32 v32, v24, v25
    v_lshlrev_b32 v24, 16, v32
    v_and_b32 v25, 0xffff0000, v32
    v_cvt_pk_bf16_f32 v32, v26, v27
    v_lshlrev_b32 v26, 16, v32
    v_and_b32 v27, 0xffff0000, v32
    v_cvt_pk_bf16_f32 v32, v28, v29
    v_lshlrev_b32 v28, 16, v32
    v_and_b32 v29, 0xffff0000, v32
    v_pk_mul_f32 v[14:15], v[14:15], v[14:15]
    v_pk_mul_f32 v[16:17], v[16:17], v[16:17]
    v_pk_mul_f32 v[18:19], v[18:19], v[18:19]
    v_pk_mul_f32 v[20:21], v[20:21], v[20:21]
    v_pk_mul_f32 v[22:23], v[22:23], v[22:23]
    v_pk_mul_f32 v[24:25], v[24:25], v[24:25]
    v_pk_mul_f32 v[26:27], v[26:27], v[26:27]
    v_pk_mul_f32 v[28:29], v[28:29], v[28:29]
    v_cvt_pk_bf16_f32 v32, v14, v15
    v_lshlrev_b32 v14, 16, v32
    v_and_b32 v15, 0xffff0000, v32
    v_cvt_pk_bf16_f32 v32, v16, v17
    v_lshlrev_b32 v16, 16, v32
    v_and_b32 v17, 0xffff0000, v32
    v_cvt_pk_bf16_f32 v32, v18, v19
    v_lshlrev_b32 v18, 16, v32
    v_and_b32 v19, 0xffff0000, v32
    v_cvt_pk_bf16_f32 v32, v20, v21
    v_lshlrev_b32 v20, 16, v32
    v_and_b32 v21, 0xffff0000, v32
    v_cvt_pk_bf16_f32 v32, v22, v23
    v_lshlrev_b32 v22, 16, v32
    v_and_b32 v23, 0xffff0000, v32
    v_cvt_pk_bf16_f32 v32, v24, v25
    v_lshlrev_b32 v24, 16, v32
    v_and_b32 v25, 0xffff0000, v32
    v_cvt_pk_bf16_f32 v32, v26, v27
    v_lshlrev_b32 v26, 16, v32
    v_and_b32 v27, 0xffff0000, v32
    v_cvt_pk_bf16_f32 v32, v28, v29
    v_lshlrev_b32 v28, 16, v32
    v_and_b32 v29, 0xffff0000, v32
    v_mov_b32 v30, 1092616192
    v_mov_b32 v31, 0x3fb8aa3b
    v_pk_mul_f32 v[14:15], v[14:15], v[30:31] op_sel:[0,0] op_sel_hi:[1,0]
    v_pk_mul_f32 v[16:17], v[16:17], v[30:31] op_sel:[0,0] op_sel_hi:[1,0]
    v_pk_mul_f32 v[18:19], v[18:19], v[30:31] op_sel:[0,0] op_sel_hi:[1,0]
    v_pk_mul_f32 v[20:21], v[20:21], v[30:31] op_sel:[0,0] op_sel_hi:[1,0]
    v_pk_mul_f32 v[22:23], v[22:23], v[30:31] op_sel:[0,0] op_sel_hi:[1,0]
    v_pk_mul_f32 v[24:25], v[24:25], v[30:31] op_sel:[0,0] op_sel_hi:[1,0]
    v_pk_mul_f32 v[26:27], v[26:27], v[30:31] op_sel:[0,0] op_sel_hi:[1,0]
    v_pk_mul_f32 v[28:29], v[28:29], v[30:31] op_sel:[0,0] op_sel_hi:[1,0]
    v_cvt_pk_bf16_f32 v32, v14, v15
    v_lshlrev_b32 v14, 16, v32
    v_and_b32 v15, 0xffff0000, v32
    v_cvt_pk_bf16_f32 v32, v16, v17
    v_lshlrev_b32 v16, 16, v32
    v_and_b32 v17, 0xffff0000, v32
    v_cvt_pk_bf16_f32 v32, v18, v19
    v_lshlrev_b32 v18, 16, v32
    v_and_b32 v19, 0xffff0000, v32
    v_cvt_pk_bf16_f32 v32, v20, v21
    v_lshlrev_b32 v20, 16, v32
    v_and_b32 v21, 0xffff0000, v32
    v_cvt_pk_bf16_f32 v32, v22, v23
    v_lshlrev_b32 v22, 16, v32
    v_and_b32 v23, 0xffff0000, v32
    v_cvt_pk_bf16_f32 v32, v24, v25
    v_lshlrev_b32 v24, 16, v32
    v_and_b32 v25, 0xffff0000, v32
    v_cvt_pk_bf16_f32 v32, v26, v27
    v_lshlrev_b32 v26, 16, v32
    v_and_b32 v27, 0xffff0000, v32
    v_cvt_pk_bf16_f32 v32, v28, v29
    v_lshlrev_b32 v28, 16, v32
    v_and_b32 v29, 0xffff0000, v32
    v_pk_mul_f32 v[14:15], v[14:15], v[30:31] op_sel:[0,1] op_sel_hi:[1,1]
    v_pk_mul_f32 v[16:17], v[16:17], v[30:31] op_sel:[0,1] op_sel_hi:[1,1]
    v_pk_mul_f32 v[18:19], v[18:19], v[30:31] op_sel:[0,1] op_sel_hi:[1,1]
    v_pk_mul_f32 v[20:21], v[20:21], v[30:31] op_sel:[0,1] op_sel_hi:[1,1]
    v_pk_mul_f32 v[22:23], v[22:23], v[30:31] op_sel:[0,1] op_sel_hi:[1,1]
    v_pk_mul_f32 v[24:25], v[24:25], v[30:31] op_sel:[0,1] op_sel_hi:[1,1]
    v_pk_mul_f32 v[26:27], v[26:27], v[30:31] op_sel:[0,1] op_sel_hi:[1,1]
    v_pk_mul_f32 v[28:29], v[28:29], v[30:31] op_sel:[0,1] op_sel_hi:[1,1]
    v_exp_f32 v14, -v14
    v_exp_f32 v15, -v15
    v_exp_f32 v16, -v16
    v_exp_f32 v17, -v17
    v_exp_f32 v18, -v18
    v_exp_f32 v19, -v19
    v_exp_f32 v20, -v20
    v_exp_f32 v21, -v21
    v_exp_f32 v22, -v22
    v_exp_f32 v23, -v23
    v_exp_f32 v24, -v24
    v_exp_f32 v25, -v25
    v_exp_f32 v26, -v26
    v_exp_f32 v27, -v27
    v_exp_f32 v28, -v28
    v_exp_f32 v29, -v29
    v_cvt_pk_bf16_f32 v14, v14, v16
    v_cvt_pk_bf16_f32 v15, v15, v17
    v_cvt_pk_bf16_f32 v18, v18, v20
    v_cvt_pk_bf16_f32 v19, v19, v21
    v_cvt_pk_bf16_f32 v22, v22, v24
    v_cvt_pk_bf16_f32 v23, v23, v25
    v_cvt_pk_bf16_f32 v26, v26, v28
    v_cvt_pk_bf16_f32 v27, v27, v29
    v_dot2_f32_bf16 v112, v14, s68, 0
    v_dot2_f32_bf16 v113, v15, s68, 0
    v_dot2_f32_bf16 v114, v14, s69, 0
    v_dot2_f32_bf16 v115, v15, s69, 0
    v_dot2_f32_bf16 v116, v14, s70, 0
    v_dot2_f32_bf16 v117, v15, s70, 0
    v_dot2_f32_bf16 v118, v14, s71, 0
    v_dot2_f32_bf16 v119, v15, s71, 0
    v_dot2_f32_bf16 v120, v14, s52, 0
    v_dot2_f32_bf16 v121, v15, s52, 0
    v_dot2_f32_bf16 v122, v14, s53, 0
    v_dot2_f32_bf16 v123, v15, s53, 0
    v_dot2_f32_bf16 v124, v14, s54, 0
    v_dot2_f32_bf16 v125, v15, s54, 0
    v_dot2_f32_bf16 v126, v14, s55, 0
    v_dot2_f32_bf16 v127, v15, s55, 0
    v_dot2_f32_bf16 v112, v18, s72, v112
    v_dot2_f32_bf16 v113, v19, s72, v113
    v_dot2_f32_bf16 v114, v18, s73, v114
    v_dot2_f32_bf16 v115, v19, s73, v115
    v_dot2_f32_bf16 v116, v18, s74, v116
    v_dot2_f32_bf16 v117, v19, s74, v117
    v_dot2_f32_bf16 v118, v18, s75, v118
    v_dot2_f32_bf16 v119, v19, s75, v119
    v_dot2_f32_bf16 v120, v18, s56, v120
    v_dot2_f32_bf16 v121, v19, s56, v121
    v_dot2_f32_bf16 v122, v18, s57, v122
    v_dot2_f32_bf16 v123, v19, s57, v123
    v_dot2_f32_bf16 v124, v18, s58, v124
    v_dot2_f32_bf16 v125, v19, s58, v125
    v_dot2_f32_bf16 v126, v18, s59, v126
    v_dot2_f32_bf16 v127, v19, s59, v127
    v_dot2_f32_bf16 v112, v22, s76, v112
    v_dot2_f32_bf16 v113, v23, s76, v113
    v_dot2_f32_bf16 v114, v22, s77, v114
    v_dot2_f32_bf16 v115, v23, s77, v115
    v_dot2_f32_bf16 v116, v22, s78, v116
    v_dot2_f32_bf16 v117, v23, s78, v117
    v_dot2_f32_bf16 v118, v22, s79, v118
    v_dot2_f32_bf16 v119, v23, s79, v119
    v_dot2_f32_bf16 v120, v22, s60, v120
    v_dot2_f32_bf16 v121, v23, s60, v121
    v_dot2_f32_bf16 v122, v22, s61, v122
    v_dot2_f32_bf16 v123, v23, s61, v123
    v_dot2_f32_bf16 v124, v22, s62, v124
    v_dot2_f32_bf16 v125, v23, s62, v125
    v_dot2_f32_bf16 v126, v22, s63, v126
    v_dot2_f32_bf16 v127, v23, s63, v127
    v_dot2_f32_bf16 v112, v26, s80, v112
    v_dot2_f32_bf16 v113, v27, s80, v113
    v_dot2_f32_bf16 v114, v26, s81, v114
    v_dot2_f32_bf16 v115, v27, s81, v115
    v_dot2_f32_bf16 v116, v26, s82, v116
    v_dot2_f32_bf16 v117, v27, s82, v117
    v_dot2_f32_bf16 v118, v26, s83, v118
    v_dot2_f32_bf16 v119, v27, s83, v119
    v_dot2_f32_bf16 v120, v26, s64, v120
    v_dot2_f32_bf16 v121, v27, s64, v121
    v_dot2_f32_bf16 v122, v26, s65, v122
    v_dot2_f32_bf16 v123, v27, s65, v123
    v_dot2_f32_bf16 v124, v26, s66, v124
    v_dot2_f32_bf16 v125, v27, s66, v125
    v_dot2_f32_bf16 v126, v26, s67, v126
    v_dot2_f32_bf16 v127, v27, s67, v127
L_p2_kernel_g1_6:
L_p2_gb:
    v_and_b32 v4, 0x80008000, v4
    v_cmp_ne_u32 vcc, 0, v4
    v_mov_b32 v8, s27
    v_and_b32 v10, 15, v0
    v_mul_u32_u24 v10, 240, v10
    v_add_u32 v10, 160000, v10
    s_cmp_lg_u64 vcc, 0
    s_cselect_b32 s2, 1, s2
    v_mov_b32 v9, s2
    s_mov_b64 exec, 1
    ds_write_b32 v8, v9
    s_mov_b64 exec, -1
    v_add_u32 v2, 16384, v1
    v_mov_b32 v9, 0x3f000000
    v_cmp_gt_u32 vcc, 226, v0
    s_mov_b32 s49, s12
    s_mov_b32 s51, 0
    v_cndmask_b32 v2, v9, v2, vcc
    s_waitcnt vmcnt(0) lgkmcnt(0)
    s_barrier
    ds_read_b32 v9, v10
    s_mov_b32 s18, 5120000
    s_mov_b32 s19, 0x00020000
    s_waitcnt lgkmcnt(0)
    v_cmp_ne_u32 vcc, 0, v9
    s_nop 1
    s_cmp_lg_u64 vcc, 0
    s_cselect_b32 s2, 1, 0
    s_cbranch_scc1 L_p2_slow
L_p2_signal:
    v_mov_b32 v8, 160228
    s_lshl_b32 s15, s2, 4
    s_or_b32 s15, s15, s21
    s_add_u32 s14, s12, 16
    s_lshl_b32 s20, s15, s14
    s_add_u32 s20, s20, 1
    v_mov_b32 v9, s20
    s_cmp_lg_u32 s13, 15
    s_cbranch_scc1 L_p2_nosig0
    s_lshl_b32 s14, s3, 8
    s_add_u32 s14, s14, 227590656
    s_mov_b64 exec, 1
    buffer_atomic_add v9, off, s[4:7], s14 sc0
    s_mov_b64 exec, -1
L_p2_nosig0:
    s_lshl2_add_u32 s14, s3, s49
    s_mul_i32 s26, s14, 20000
    s_add_u32 s15, s26, 227607040
    buffer_load_dwordx4 v[64:67], v1, s[4:7], s15 offen
    buffer_load_dwordx4 v[68:71], v2, s[4:7], s15 offen
    s_lshl_b32 s28, s92, 16
    s_and_b32 s29, s92, 0xffff0000
    s_lshl_b32 s30, s93, 16
    s_and_b32 s31, s93, 0xffff0000
    s_lshl_b32 s32, s94, 16
    s_and_b32 s33, s94, 0xffff0000
    s_lshl_b32 s34, s95, 16
    s_and_b32 s35, s95, 0xffff0000
    s_lshl_b32 s36, s96, 16
    s_and_b32 s37, s96, 0xffff0000
    s_lshl_b32 s38, s97, 16
    s_and_b32 s39, s97, 0xffff0000
    s_lshl_b32 s40, s98, 16
    s_and_b32 s41, s98, 0xffff0000
    s_lshl_b32 s42, s99, 16
    s_and_b32 s43, s99, 0xffff0000
    s_and_b32 s99, s91, 0xffff0000
    s_lshl_b32 s98, s91, 16
    s_and_b32 s97, s90, 0xffff0000
    s_lshl_b32 s96, s90, 16
    s_and_b32 s95, s89, 0xffff0000
    s_lshl_b32 s94, s89, 16
    s_and_b32 s93, s88, 0xffff0000
    s_lshl_b32 s92, s88, 16
    s_and_b32 s91, s87, 0xffff0000
    s_lshl_b32 s90, s87, 16
    s_and_b32 s89, s86, 0xffff0000
    s_lshl_b32 s88, s86, 16
    s_and_b32 s87, s85, 0xffff0000
    s_lshl_b32 s86, s85, 16
    s_and_b32 s85, s84, 0xffff0000
    s_lshl_b32 s84, s84, 16
    s_mov_b32 s44, s48
    s_add_u32 s45, s48, 2281701376
    s_cmp_eq_u32 s48, 0
    s_cselect_b32 s45, 0, s45
    s_cmp_lg_u32 s13, 15
    s_cbranch_scc1 L_p2_nosig
    s_waitcnt vmcnt(2)
    v_readfirstlane_b32 s15, v9
    s_lshl_b32 s51, 1, s12
    s_add_u32 s20, s20, s15
    s_and_b32 s15, s20, 0xff
    s_cmp_eq_u32 s15, 4
    s_cbranch_scc0 L_p2_notlast
    s_bfe_u32 s15, s20, 262160
    s_or_b32 s51, s51, s15
    s_branch L_p2_pub
L_p2_notlast:
    s_cmp_lg_u32 s21, 0
    s_cselect_b32 s51, 0, s51
    s_cbranch_scc1 L_p2_pub
L_p2_poll:
    v_mov_b32 v9, 0
    s_lshl_b32 s14, s3, 8
    s_add_u32 s14, s14, 227590656
    s_mov_b64 exec, 1
    buffer_atomic_add v9, off, s[4:7], s14 sc0
    s_mov_b64 exec, -1
    s_waitcnt vmcnt(0)
    v_readfirstlane_b32 s20, v9
    s_nop 0
    s_and_b32 s15, s20, 0xff
    s_cmp_lt_u32 s15, 4
    s_cbranch_scc1 L_p2_poll
L_p2_pub:
    s_lshl_b32 s15, s51, 24
    s_or_b32 s15, s15, s20
    v_mov_b32 v9, s15
    s_mov_b64 exec, 1
    ds_write_b32 v8, v9
    s_mov_b64 exec, -1
    s_waitcnt lgkmcnt(0)
L_p2_nosig:
    s_barrier
    ds_read_b32 v9, v8
    s_waitcnt lgkmcnt(0)
    v_readfirstlane_b32 s20, v9
    s_nop 0
    s_lshr_b32 s51, s20, 24
    s_cbranch_scc0 L_p2_end
L_p2_fin:
    s_mul_i32 s24, s49, 20000
    s_add_u32 s14, s12, 1
    s_and_b32 s14, s14, 3
    s_mul_i32 s15, s14, 5120000
    s_add_u32 s15, s15, 232727040
    s_add_u32 s15, s15, s26
    buffer_load_dwordx4 v[12:15], v1, s[4:7], s15 offen sc1
    buffer_load_dwordx4 v[92:95], v2, s[4:7], s15 offen sc1
    s_add_u32 s14, s12, 2
    s_and_b32 s14, s14, 3
    s_mul_i32 s15, s14, 5120000
    s_add_u32 s15, s15, 232727040
    s_add_u32 s15, s15, s26
    buffer_load_dwordx4 v[16:19], v1, s[4:7], s15 offen sc1
    buffer_load_dwordx4 v[96:99], v2, s[4:7], s15 offen sc1
    s_add_u32 s14, s12, 3
    s_and_b32 s14, s14, 3
    s_mul_i32 s15, s14, 5120000
    s_add_u32 s15, s15, 232727040
    s_add_u32 s15, s15, s26
    buffer_load_dwordx4 v[20:23], v1, s[4:7], s15 offen sc1
    buffer_load_dwordx4 v[100:103], v2, s[4:7], s15 offen sc1
    v_add_u32 v24, s24, v1
    ds_read_b128 v[8:11], v24
    v_add_u32 v25, s24, v2
    ds_read_b128 v[88:91], v25
    s_waitcnt vmcnt(0) lgkmcnt(0)
    s_bfe_u32 s14, s20, 262164
    s_cbranch_scc0 L_p2_kernel_nof32a_7
    s_add_u32 s14, s12, 0
    s_and_b32 s14, s14, 3
    s_add_u32 s14, s14, 20
    s_bitcmp1_b32 s20, s14
    s_cbranch_scc0 L_p2_kernel_q_8
    v_mov_b32 v8, 1073758208
    v_mov_b32 v9, 1073758208
    v_mov_b32 v10, 1073758208
    v_mov_b32 v11, 1073758208
L_p2_kernel_q_8:
    s_add_u32 s14, s12, 1
    s_and_b32 s14, s14, 3
    s_add_u32 s14, s14, 20
    s_bitcmp1_b32 s20, s14
    s_cbranch_scc0 L_p2_kernel_q_9
    v_mov_b32 v12, 1073758208
    v_mov_b32 v13, 1073758208
    v_mov_b32 v14, 1073758208
    v_mov_b32 v15, 1073758208
L_p2_kernel_q_9:
    s_add_u32 s14, s12, 2
    s_and_b32 s14, s14, 3
    s_add_u32 s14, s14, 20
    s_bitcmp1_b32 s20, s14
    s_cbranch_scc0 L_p2_kernel_q_10
    v_mov_b32 v16, 1073758208
    v_mov_b32 v17, 1073758208
    v_mov_b32 v18, 1073758208
    v_mov_b32 v19, 1073758208
L_p2_kernel_q_10:
    s_add_u32 s14, s12, 3
    s_and_b32 s14, s14, 3
    s_add_u32 s14, s14, 20
    s_bitcmp1_b32 s20, s14
    s_cbranch_scc0 L_p2_kernel_q_11
    v_mov_b32 v20, 1073758208
    v_mov_b32 v21, 1073758208
    v_mov_b32 v22, 1073758208
    v_mov_b32 v23, 1073758208
L_p2_kernel_q_11:
L_p2_kernel_nof32a_7:
    v_pk_add_u16 v8, v8, v12
    v_pk_add_u16 v16, v16, v20
    v_pk_add_u16 v9, v9, v13
    v_pk_add_u16 v17, v17, v21
    v_pk_add_u16 v10, v10, v14
    v_pk_add_u16 v18, v18, v22
    v_pk_add_u16 v11, v11, v15
    v_pk_add_u16 v19, v19, v23
    v_add_u32_sdwa v24, v8, v16 dst_sel:DWORD dst_unused:UNUSED_PAD src0_sel:WORD_0 src1_sel:WORD_0
    v_add_u32_sdwa v25, v10, v18 dst_sel:DWORD dst_unused:UNUSED_PAD src0_sel:WORD_0 src1_sel:WORD_0
    v_add_u32_sdwa v26, v8, v16 dst_sel:DWORD dst_unused:UNUSED_PAD src0_sel:WORD_1 src1_sel:WORD_1
    v_add_u32_sdwa v27, v10, v18 dst_sel:DWORD dst_unused:UNUSED_PAD src0_sel:WORD_1 src1_sel:WORD_1
    v_add_u32_sdwa v28, v9, v17 dst_sel:DWORD dst_unused:UNUSED_PAD src0_sel:WORD_0 src1_sel:WORD_0
    v_add_u32_sdwa v29, v11, v19 dst_sel:DWORD dst_unused:UNUSED_PAD src0_sel:WORD_0 src1_sel:WORD_0
    v_add_u32_sdwa v30, v9, v17 dst_sel:DWORD dst_unused:UNUSED_PAD src0_sel:WORD_1 src1_sel:WORD_1
    v_add_u32_sdwa v31, v11, v19 dst_sel:DWORD dst_unused:UNUSED_PAD src0_sel:WORD_1 src1_sel:WORD_1
    v_cvt_f32_u32 v24, v24
    v_cvt_f32_u32 v25, v25
    v_cvt_f32_u32 v26, v26
    v_cvt_f32_u32 v27, v27
    v_cvt_f32_u32 v28, v28
    v_cvt_f32_u32 v29, v29
    v_cvt_f32_u32 v30, v30
    v_cvt_f32_u32 v31, v31
    v_pk_fma_f32 v[24:25], v[24:25], s[44:45], s[44:45] op_sel:[0,0,1] op_sel_hi:[1,0,1]
    v_pk_fma_f32 v[26:27], v[26:27], s[44:45], s[44:45] op_sel:[0,0,1] op_sel_hi:[1,0,1]
    v_pk_fma_f32 v[28:29], v[28:29], s[44:45], s[44:45] op_sel:[0,0,1] op_sel_hi:[1,0,1]
    v_pk_fma_f32 v[30:31], v[30:31], s[44:45], s[44:45] op_sel:[0,0,1] op_sel_hi:[1,0,1]
    s_bfe_u32 s14, s20, 262164
    s_cbranch_scc0 L_p2_kernel_nof32b_12
    v_lshlrev_b32 v32, 1, v1
    s_bitcmp1_b32 s20, 20
    s_cbranch_scc0 L_p2_kernel_q_13
    s_lshl_b32 s15, s26, 1
    s_add_u32 s15, s15, 253207040
    buffer_load_dwordx4 v[8:11], v32, s[4:7], s15 offen sc1
    buffer_load_dwordx4 v[12:15], v32, s[4:7], s15 offen offset:16 sc1
    s_waitcnt vmcnt(0)
    v_add_f32 v24, v24, v8
    v_add_f32 v25, v25, v12
    v_add_f32 v26, v26, v9
    v_add_f32 v27, v27, v13
    v_add_f32 v28, v28, v10
    v_add_f32 v29, v29, v14
    v_add_f32 v30, v30, v11
    v_add_f32 v31, v31, v15
L_p2_kernel_q_13:
    s_bitcmp1_b32 s20, 21
    s_cbranch_scc0 L_p2_kernel_q_14
    s_lshl_b32 s15, s26, 1
    s_add_u32 s15, s15, 263447040
    buffer_load_dwordx4 v[8:11], v32, s[4:7], s15 offen sc1
    buffer_load_dwordx4 v[12:15], v32, s[4:7], s15 offen offset:16 sc1
    s_waitcnt vmcnt(0)
    v_add_f32 v24, v24, v8
    v_add_f32 v25, v25, v12
    v_add_f32 v26, v26, v9
    v_add_f32 v27, v27, v13
    v_add_f32 v28, v28, v10
    v_add_f32 v29, v29, v14
    v_add_f32 v30, v30, v11
    v_add_f32 v31, v31, v15
L_p2_kernel_q_14:
    s_bitcmp1_b32 s20, 22
    s_cbranch_scc0 L_p2_kernel_q_15
    s_lshl_b32 s15, s26, 1
    s_add_u32 s15, s15, 273687040
    buffer_load_dwordx4 v[8:11], v32, s[4:7], s15 offen sc1
    buffer_load_dwordx4 v[12:15], v32, s[4:7], s15 offen offset:16 sc1
    s_waitcnt vmcnt(0)
    v_add_f32 v24, v24, v8
    v_add_f32 v25, v25, v12
    v_add_f32 v26, v26, v9
    v_add_f32 v27, v27, v13
    v_add_f32 v28, v28, v10
    v_add_f32 v29, v29, v14
    v_add_f32 v30, v30, v11
    v_add_f32 v31, v31, v15
L_p2_kernel_q_15:
    s_bitcmp1_b32 s20, 23
    s_cbranch_scc0 L_p2_kernel_q_16
    s_lshl_b32 s15, s26, 1
    s_add_u32 s15, s15, 283927040
    buffer_load_dwordx4 v[8:11], v32, s[4:7], s15 offen sc1
    buffer_load_dwordx4 v[12:15], v32, s[4:7], s15 offen offset:16 sc1
    s_waitcnt vmcnt(0)
    v_add_f32 v24, v24, v8
    v_add_f32 v25, v25, v12
    v_add_f32 v26, v26, v9
    v_add_f32 v27, v27, v13
    v_add_f32 v28, v28, v10
    v_add_f32 v29, v29, v14
    v_add_f32 v30, v30, v11
    v_add_f32 v31, v31, v15
L_p2_kernel_q_16:
L_p2_kernel_nof32b_12:
    v_pk_mul_f32 v[8:9], v[24:25], s[84:85] op_sel:[0,0] op_sel_hi:[1,0]
    v_pk_mul_f32 v[10:11], v[24:25], s[84:85] op_sel:[0,1] op_sel_hi:[1,1]
    v_pk_mul_f32 v[12:13], v[24:25], s[86:87] op_sel:[0,0] op_sel_hi:[1,0]
    v_pk_mul_f32 v[14:15], v[24:25], s[86:87] op_sel:[0,1] op_sel_hi:[1,1]
    v_pk_fma_f32 v[8:9], v[26:27], s[88:89], v[8:9] op_sel:[0,0,0] op_sel_hi:[1,0,1]
    v_pk_fma_f32 v[10:11], v[26:27], s[88:89], v[10:11] op_sel:[0,1,0] op_sel_hi:[1,1,1]
    v_pk_fma_f32 v[12:13], v[26:27], s[90:91], v[12:13] op_sel:[0,0,0] op_sel_hi:[1,0,1]
    v_pk_fma_f32 v[14:15], v[26:27], s[90:91], v[14:15] op_sel:[0,1,0] op_sel_hi:[1,1,1]
    v_pk_fma_f32 v[8:9], v[28:29], s[92:93], v[8:9] op_sel:[0,0,0] op_sel_hi:[1,0,1]
    v_pk_fma_f32 v[10:11], v[28:29], s[92:93], v[10:11] op_sel:[0,1,0] op_sel_hi:[1,1,1]
    v_pk_fma_f32 v[12:13], v[28:29], s[94:95], v[12:13] op_sel:[0,0,0] op_sel_hi:[1,0,1]
    v_pk_fma_f32 v[14:15], v[28:29], s[94:95], v[14:15] op_sel:[0,1,0] op_sel_hi:[1,1,1]
    v_pk_fma_f32 v[8:9], v[30:31], s[96:97], v[8:9] op_sel:[0,0,0] op_sel_hi:[1,0,1]
    v_pk_fma_f32 v[10:11], v[30:31], s[96:97], v[10:11] op_sel:[0,1,0] op_sel_hi:[1,1,1]
    v_pk_fma_f32 v[12:13], v[30:31], s[98:99], v[12:13] op_sel:[0,0,0] op_sel_hi:[1,0,1]
    v_pk_fma_f32 v[14:15], v[30:31], s[98:99], v[14:15] op_sel:[0,1,0] op_sel_hi:[1,1,1]
    v_pk_mul_f32 v[8:9], v[8:9], v[72:73]
    v_pk_mul_f32 v[10:11], v[10:11], v[74:75]
    v_pk_mul_f32 v[12:13], v[12:13], v[76:77]
    v_pk_mul_f32 v[14:15], v[14:15], v[78:79]
    v_pk_mul_f32 v[24:25], v[8:9], s[28:29] op_sel:[0,0] op_sel_hi:[1,0]
    v_pk_mul_f32 v[26:27], v[8:9], s[28:29] op_sel:[0,1] op_sel_hi:[1,1]
    v_pk_mul_f32 v[28:29], v[8:9], s[30:31] op_sel:[0,0] op_sel_hi:[1,0]
    v_pk_mul_f32 v[30:31], v[8:9], s[30:31] op_sel:[0,1] op_sel_hi:[1,1]
    v_pk_fma_f32 v[24:25], v[10:11], s[32:33], v[24:25] op_sel:[0,0,0] op_sel_hi:[1,0,1]
    v_pk_fma_f32 v[26:27], v[10:11], s[32:33], v[26:27] op_sel:[0,1,0] op_sel_hi:[1,1,1]
    v_pk_fma_f32 v[28:29], v[10:11], s[34:35], v[28:29] op_sel:[0,0,0] op_sel_hi:[1,0,1]
    v_pk_fma_f32 v[30:31], v[10:11], s[34:35], v[30:31] op_sel:[0,1,0] op_sel_hi:[1,1,1]
    v_pk_fma_f32 v[24:25], v[12:13], s[36:37], v[24:25] op_sel:[0,0,0] op_sel_hi:[1,0,1]
    v_pk_fma_f32 v[26:27], v[12:13], s[36:37], v[26:27] op_sel:[0,1,0] op_sel_hi:[1,1,1]
    v_pk_fma_f32 v[28:29], v[12:13], s[38:39], v[28:29] op_sel:[0,0,0] op_sel_hi:[1,0,1]
    v_pk_fma_f32 v[30:31], v[12:13], s[38:39], v[30:31] op_sel:[0,1,0] op_sel_hi:[1,1,1]
    v_pk_fma_f32 v[24:25], v[14:15], s[40:41], v[24:25] op_sel:[0,0,0] op_sel_hi:[1,0,1]
    v_pk_fma_f32 v[26:27], v[14:15], s[40:41], v[26:27] op_sel:[0,1,0] op_sel_hi:[1,1,1]
    v_pk_fma_f32 v[28:29], v[14:15], s[42:43], v[28:29] op_sel:[0,0,0] op_sel_hi:[1,0,1]
    v_pk_fma_f32 v[30:31], v[14:15], s[42:43], v[30:31] op_sel:[0,1,0] op_sel_hi:[1,1,1]
    v_lshlrev_b32 v8, 16, v64
    v_and_b32 v10, 0xffff0000, v64
    v_lshlrev_b32 v12, 16, v65
    v_and_b32 v14, 0xffff0000, v65
    v_lshlrev_b32 v9, 16, v66
    v_and_b32 v11, 0xffff0000, v66
    v_lshlrev_b32 v13, 16, v67
    v_and_b32 v15, 0xffff0000, v67
    v_pk_fma_f32 v[8:9], v[24:25], v[80:81], v[8:9]
    v_pk_fma_f32 v[10:11], v[26:27], v[82:83], v[10:11]
    v_pk_fma_f32 v[12:13], v[28:29], v[84:85], v[12:13]
    v_pk_fma_f32 v[14:15], v[30:31], v[86:87], v[14:15]
    v_cvt_pk_bf16_f32 v16, v8, v10
    v_cvt_pk_bf16_f32 v17, v12, v14
    v_cvt_pk_bf16_f32 v18, v9, v11
    v_cvt_pk_bf16_f32 v19, v13, v15
    buffer_store_dwordx4 v[16:19], v1, s[16:19], s26 offen
    s_cmp_ge_u32 s13, 4
    s_cbranch_scc1 L_p2_f1
    s_bfe_u32 s14, s20, 262164
    s_cbranch_scc0 L_p2_kernel_nof32a_17
    s_add_u32 s14, s12, 0
    s_and_b32 s14, s14, 3
    s_add_u32 s14, s14, 20
    s_bitcmp1_b32 s20, s14
    s_cbranch_scc0 L_p2_kernel_q_18
    v_mov_b32 v88, 1073758208
    v_mov_b32 v89, 1073758208
    v_mov_b32 v90, 1073758208
    v_mov_b32 v91, 1073758208
L_p2_kernel_q_18:
    s_add_u32 s14, s12, 1
    s_and_b32 s14, s14, 3
    s_add_u32 s14, s14, 20
    s_bitcmp1_b32 s20, s14
    s_cbranch_scc0 L_p2_kernel_q_19
    v_mov_b32 v92, 1073758208
    v_mov_b32 v93, 1073758208
    v_mov_b32 v94, 1073758208
    v_mov_b32 v95, 1073758208
L_p2_kernel_q_19:
    s_add_u32 s14, s12, 2
    s_and_b32 s14, s14, 3
    s_add_u32 s14, s14, 20
    s_bitcmp1_b32 s20, s14
    s_cbranch_scc0 L_p2_kernel_q_20
    v_mov_b32 v96, 1073758208
    v_mov_b32 v97, 1073758208
    v_mov_b32 v98, 1073758208
    v_mov_b32 v99, 1073758208
L_p2_kernel_q_20:
    s_add_u32 s14, s12, 3
    s_and_b32 s14, s14, 3
    s_add_u32 s14, s14, 20
    s_bitcmp1_b32 s20, s14
    s_cbranch_scc0 L_p2_kernel_q_21
    v_mov_b32 v100, 1073758208
    v_mov_b32 v101, 1073758208
    v_mov_b32 v102, 1073758208
    v_mov_b32 v103, 1073758208
L_p2_kernel_q_21:
L_p2_kernel_nof32a_17:
    v_pk_add_u16 v88, v88, v92
    v_pk_add_u16 v96, v96, v100
    v_pk_add_u16 v89, v89, v93
    v_pk_add_u16 v97, v97, v101
    v_pk_add_u16 v90, v90, v94
    v_pk_add_u16 v98, v98, v102
    v_pk_add_u16 v91, v91, v95
    v_pk_add_u16 v99, v99, v103
    v_add_u32_sdwa v24, v88, v96 dst_sel:DWORD dst_unused:UNUSED_PAD src0_sel:WORD_0 src1_sel:WORD_0
    v_add_u32_sdwa v25, v90, v98 dst_sel:DWORD dst_unused:UNUSED_PAD src0_sel:WORD_0 src1_sel:WORD_0
    v_add_u32_sdwa v26, v88, v96 dst_sel:DWORD dst_unused:UNUSED_PAD src0_sel:WORD_1 src1_sel:WORD_1
    v_add_u32_sdwa v27, v90, v98 dst_sel:DWORD dst_unused:UNUSED_PAD src0_sel:WORD_1 src1_sel:WORD_1
    v_add_u32_sdwa v28, v89, v97 dst_sel:DWORD dst_unused:UNUSED_PAD src0_sel:WORD_0 src1_sel:WORD_0
    v_add_u32_sdwa v29, v91, v99 dst_sel:DWORD dst_unused:UNUSED_PAD src0_sel:WORD_0 src1_sel:WORD_0
    v_add_u32_sdwa v30, v89, v97 dst_sel:DWORD dst_unused:UNUSED_PAD src0_sel:WORD_1 src1_sel:WORD_1
    v_add_u32_sdwa v31, v91, v99 dst_sel:DWORD dst_unused:UNUSED_PAD src0_sel:WORD_1 src1_sel:WORD_1
    v_cvt_f32_u32 v24, v24
    v_cvt_f32_u32 v25, v25
    v_cvt_f32_u32 v26, v26
    v_cvt_f32_u32 v27, v27
    v_cvt_f32_u32 v28, v28
    v_cvt_f32_u32 v29, v29
    v_cvt_f32_u32 v30, v30
    v_cvt_f32_u32 v31, v31
    v_pk_fma_f32 v[24:25], v[24:25], s[44:45], s[44:45] op_sel:[0,0,1] op_sel_hi:[1,0,1]
    v_pk_fma_f32 v[26:27], v[26:27], s[44:45], s[44:45] op_sel:[0,0,1] op_sel_hi:[1,0,1]
    v_pk_fma_f32 v[28:29], v[28:29], s[44:45], s[44:45] op_sel:[0,0,1] op_sel_hi:[1,0,1]
    v_pk_fma_f32 v[30:31], v[30:31], s[44:45], s[44:45] op_sel:[0,0,1] op_sel_hi:[1,0,1]
    s_bfe_u32 s14, s20, 262164
    s_cbranch_scc0 L_p2_kernel_nof32b_22
    v_lshlrev_b32 v32, 1, v2
    s_bitcmp1_b32 s20, 20
    s_cbranch_scc0 L_p2_kernel_q_23
    s_lshl_b32 s15, s26, 1
    s_add_u32 s15, s15, 253207040
    buffer_load_dwordx4 v[88:91], v32, s[4:7], s15 offen sc1
    buffer_load_dwordx4 v[92:95], v32, s[4:7], s15 offen offset:16 sc1
    s_waitcnt vmcnt(0)
    v_add_f32 v24, v24, v88
    v_add_f32 v25, v25, v92
    v_add_f32 v26, v26, v89
    v_add_f32 v27, v27, v93
    v_add_f32 v28, v28, v90
    v_add_f32 v29, v29, v94
    v_add_f32 v30, v30, v91
    v_add_f32 v31, v31, v95
L_p2_kernel_q_23:
    s_bitcmp1_b32 s20, 21
    s_cbranch_scc0 L_p2_kernel_q_24
    s_lshl_b32 s15, s26, 1
    s_add_u32 s15, s15, 263447040
    buffer_load_dwordx4 v[88:91], v32, s[4:7], s15 offen sc1
    buffer_load_dwordx4 v[92:95], v32, s[4:7], s15 offen offset:16 sc1
    s_waitcnt vmcnt(0)
    v_add_f32 v24, v24, v88
    v_add_f32 v25, v25, v92
    v_add_f32 v26, v26, v89
    v_add_f32 v27, v27, v93
    v_add_f32 v28, v28, v90
    v_add_f32 v29, v29, v94
    v_add_f32 v30, v30, v91
    v_add_f32 v31, v31, v95
L_p2_kernel_q_24:
    s_bitcmp1_b32 s20, 22
    s_cbranch_scc0 L_p2_kernel_q_25
    s_lshl_b32 s15, s26, 1
    s_add_u32 s15, s15, 273687040
    buffer_load_dwordx4 v[88:91], v32, s[4:7], s15 offen sc1
    buffer_load_dwordx4 v[92:95], v32, s[4:7], s15 offen offset:16 sc1
    s_waitcnt vmcnt(0)
    v_add_f32 v24, v24, v88
    v_add_f32 v25, v25, v92
    v_add_f32 v26, v26, v89
    v_add_f32 v27, v27, v93
    v_add_f32 v28, v28, v90
    v_add_f32 v29, v29, v94
    v_add_f32 v30, v30, v91
    v_add_f32 v31, v31, v95
L_p2_kernel_q_25:
    s_bitcmp1_b32 s20, 23
    s_cbranch_scc0 L_p2_kernel_q_26
    s_lshl_b32 s15, s26, 1
    s_add_u32 s15, s15, 283927040
    buffer_load_dwordx4 v[88:91], v32, s[4:7], s15 offen sc1
    buffer_load_dwordx4 v[92:95], v32, s[4:7], s15 offen offset:16 sc1
    s_waitcnt vmcnt(0)
    v_add_f32 v24, v24, v88
    v_add_f32 v25, v25, v92
    v_add_f32 v26, v26, v89
    v_add_f32 v27, v27, v93
    v_add_f32 v28, v28, v90
    v_add_f32 v29, v29, v94
    v_add_f32 v30, v30, v91
    v_add_f32 v31, v31, v95
L_p2_kernel_q_26:
L_p2_kernel_nof32b_22:
    v_pk_mul_f32 v[88:89], v[24:25], s[84:85] op_sel:[0,0] op_sel_hi:[1,0]
    v_pk_mul_f32 v[90:91], v[24:25], s[84:85] op_sel:[0,1] op_sel_hi:[1,1]
    v_pk_mul_f32 v[92:93], v[24:25], s[86:87] op_sel:[0,0] op_sel_hi:[1,0]
    v_pk_mul_f32 v[94:95], v[24:25], s[86:87] op_sel:[0,1] op_sel_hi:[1,1]
    v_pk_fma_f32 v[88:89], v[26:27], s[88:89], v[88:89] op_sel:[0,0,0] op_sel_hi:[1,0,1]
    v_pk_fma_f32 v[90:91], v[26:27], s[88:89], v[90:91] op_sel:[0,1,0] op_sel_hi:[1,1,1]
    v_pk_fma_f32 v[92:93], v[26:27], s[90:91], v[92:93] op_sel:[0,0,0] op_sel_hi:[1,0,1]
    v_pk_fma_f32 v[94:95], v[26:27], s[90:91], v[94:95] op_sel:[0,1,0] op_sel_hi:[1,1,1]
    v_pk_fma_f32 v[88:89], v[28:29], s[92:93], v[88:89] op_sel:[0,0,0] op_sel_hi:[1,0,1]
    v_pk_fma_f32 v[90:91], v[28:29], s[92:93], v[90:91] op_sel:[0,1,0] op_sel_hi:[1,1,1]
    v_pk_fma_f32 v[92:93], v[28:29], s[94:95], v[92:93] op_sel:[0,0,0] op_sel_hi:[1,0,1]
    v_pk_fma_f32 v[94:95], v[28:29], s[94:95], v[94:95] op_sel:[0,1,0] op_sel_hi:[1,1,1]
    v_pk_fma_f32 v[88:89], v[30:31], s[96:97], v[88:89] op_sel:[0,0,0] op_sel_hi:[1,0,1]
    v_pk_fma_f32 v[90:91], v[30:31], s[96:97], v[90:91] op_sel:[0,1,0] op_sel_hi:[1,1,1]
    v_pk_fma_f32 v[92:93], v[30:31], s[98:99], v[92:93] op_sel:[0,0,0] op_sel_hi:[1,0,1]
    v_pk_fma_f32 v[94:95], v[30:31], s[98:99], v[94:95] op_sel:[0,1,0] op_sel_hi:[1,1,1]
    v_pk_mul_f32 v[88:89], v[88:89], v[112:113]
    v_pk_mul_f32 v[90:91], v[90:91], v[114:115]
    v_pk_mul_f32 v[92:93], v[92:93], v[116:117]
    v_pk_mul_f32 v[94:95], v[94:95], v[118:119]
    v_pk_mul_f32 v[24:25], v[88:89], s[28:29] op_sel:[0,0] op_sel_hi:[1,0]
    v_pk_mul_f32 v[26:27], v[88:89], s[28:29] op_sel:[0,1] op_sel_hi:[1,1]
    v_pk_mul_f32 v[28:29], v[88:89], s[30:31] op_sel:[0,0] op_sel_hi:[1,0]
    v_pk_mul_f32 v[30:31], v[88:89], s[30:31] op_sel:[0,1] op_sel_hi:[1,1]
    v_pk_fma_f32 v[24:25], v[90:91], s[32:33], v[24:25] op_sel:[0,0,0] op_sel_hi:[1,0,1]
    v_pk_fma_f32 v[26:27], v[90:91], s[32:33], v[26:27] op_sel:[0,1,0] op_sel_hi:[1,1,1]
    v_pk_fma_f32 v[28:29], v[90:91], s[34:35], v[28:29] op_sel:[0,0,0] op_sel_hi:[1,0,1]
    v_pk_fma_f32 v[30:31], v[90:91], s[34:35], v[30:31] op_sel:[0,1,0] op_sel_hi:[1,1,1]
    v_pk_fma_f32 v[24:25], v[92:93], s[36:37], v[24:25] op_sel:[0,0,0] op_sel_hi:[1,0,1]
    v_pk_fma_f32 v[26:27], v[92:93], s[36:37], v[26:27] op_sel:[0,1,0] op_sel_hi:[1,1,1]
    v_pk_fma_f32 v[28:29], v[92:93], s[38:39], v[28:29] op_sel:[0,0,0] op_sel_hi:[1,0,1]
    v_pk_fma_f32 v[30:31], v[92:93], s[38:39], v[30:31] op_sel:[0,1,0] op_sel_hi:[1,1,1]
    v_pk_fma_f32 v[24:25], v[94:95], s[40:41], v[24:25] op_sel:[0,0,0] op_sel_hi:[1,0,1]
    v_pk_fma_f32 v[26:27], v[94:95], s[40:41], v[26:27] op_sel:[0,1,0] op_sel_hi:[1,1,1]
    v_pk_fma_f32 v[28:29], v[94:95], s[42:43], v[28:29] op_sel:[0,0,0] op_sel_hi:[1,0,1]
    v_pk_fma_f32 v[30:31], v[94:95], s[42:43], v[30:31] op_sel:[0,1,0] op_sel_hi:[1,1,1]
    v_lshlrev_b32 v88, 16, v68
    v_and_b32 v90, 0xffff0000, v68
    v_lshlrev_b32 v92, 16, v69
    v_and_b32 v94, 0xffff0000, v69
    v_lshlrev_b32 v89, 16, v70
    v_and_b32 v91, 0xffff0000, v70
    v_lshlrev_b32 v93, 16, v71
    v_and_b32 v95, 0xffff0000, v71
    v_pk_fma_f32 v[88:89], v[24:25], v[120:121], v[88:89]
    v_pk_fma_f32 v[90:91], v[26:27], v[122:123], v[90:91]
    v_pk_fma_f32 v[92:93], v[28:29], v[124:125], v[92:93]
    v_pk_fma_f32 v[94:95], v[30:31], v[126:127], v[94:95]
    v_cvt_pk_bf16_f32 v96, v88, v90
    v_cvt_pk_bf16_f32 v97, v92, v94
    v_cvt_pk_bf16_f32 v98, v89, v91
    v_cvt_pk_bf16_f32 v99, v93, v95
    buffer_store_dwordx4 v[96:99], v2, s[16:19], s26 offen
L_p2_f1:
    s_bitset0_b32 s51, s49
    s_cmp_eq_u32 s51, 0
    s_cbranch_scc1 L_p2_done
    s_ff1_i32_b32 s49, s51
    s_lshl2_add_u32 s14, s3, s49
    s_mul_i32 s14, s14, 5000
    s_add_u32 s15, s14, 4096
    v_min_u32 v61, 225, v0
    v_lshl_add_u32 v60, v0, 2, s14
    v_lshl_add_u32 v61, v61, 2, s15
    global_load_dword v60, v60, s[100:101] nt
    global_load_dword v61, v61, s[100:101] nt
    s_waitcnt vmcnt(0)
    v_lshlrev_b32 v30, 16, v60
    v_and_b32 v31, 0xffff0000, v60
    v_lshlrev_b32 v36, 16, v53
    v_and_b32 v37, 0xffff0000, v53
    v_lshlrev_b32 v38, 16, v54
    v_and_b32 v39, 0xffff0000, v54
    v_lshlrev_b32 v40, 16, v56
    v_and_b32 v41, 0xffff0000, v56
    v_lshlrev_b32 v42, 16, v57
    v_and_b32 v43, 0xffff0000, v57
    v_pk_add_f32 v[14:15], v[30:31], v[36:37] op_sel:[0,0] op_sel_hi:[1,0] neg_lo:[0,1] neg_hi:[0,1]
    v_pk_add_f32 v[16:17], v[30:31], v[36:37] op_sel:[0,1] op_sel_hi:[1,1] neg_lo:[0,1] neg_hi:[0,1]
    v_pk_add_f32 v[18:19], v[30:31], v[38:39] op_sel:[0,0] op_sel_hi:[1,0] neg_lo:[0,1] neg_hi:[0,1]
    v_pk_add_f32 v[20:21], v[30:31], v[38:39] op_sel:[0,1] op_sel_hi:[1,1] neg_lo:[0,1] neg_hi:[0,1]
    v_pk_add_f32 v[22:23], v[30:31], v[40:41] op_sel:[0,0] op_sel_hi:[1,0] neg_lo:[0,1] neg_hi:[0,1]
    v_pk_add_f32 v[24:25], v[30:31], v[40:41] op_sel:[0,1] op_sel_hi:[1,1] neg_lo:[0,1] neg_hi:[0,1]
    v_pk_add_f32 v[26:27], v[30:31], v[42:43] op_sel:[0,0] op_sel_hi:[1,0] neg_lo:[0,1] neg_hi:[0,1]
    v_pk_add_f32 v[28:29], v[30:31], v[42:43] op_sel:[0,1] op_sel_hi:[1,1] neg_lo:[0,1] neg_hi:[0,1]
    v_cvt_pk_bf16_f32 v32, v14, v15
    v_lshlrev_b32 v14, 16, v32
    v_and_b32 v15, 0xffff0000, v32
    v_cvt_pk_bf16_f32 v32, v16, v17
    v_lshlrev_b32 v16, 16, v32
    v_and_b32 v17, 0xffff0000, v32
    v_cvt_pk_bf16_f32 v32, v18, v19
    v_lshlrev_b32 v18, 16, v32
    v_and_b32 v19, 0xffff0000, v32
    v_cvt_pk_bf16_f32 v32, v20, v21
    v_lshlrev_b32 v20, 16, v32
    v_and_b32 v21, 0xffff0000, v32
    v_cvt_pk_bf16_f32 v32, v22, v23
    v_lshlrev_b32 v22, 16, v32
    v_and_b32 v23, 0xffff0000, v32
    v_cvt_pk_bf16_f32 v32, v24, v25
    v_lshlrev_b32 v24, 16, v32
    v_and_b32 v25, 0xffff0000, v32
    v_cvt_pk_bf16_f32 v32, v26, v27
    v_lshlrev_b32 v26, 16, v32
    v_and_b32 v27, 0xffff0000, v32
    v_cvt_pk_bf16_f32 v32, v28, v29
    v_lshlrev_b32 v28, 16, v32
    v_and_b32 v29, 0xffff0000, v32
    v_pk_mul_f32 v[14:15], v[14:15], v[14:15]
    v_pk_mul_f32 v[16:17], v[16:17], v[16:17]
    v_pk_mul_f32 v[18:19], v[18:19], v[18:19]
    v_pk_mul_f32 v[20:21], v[20:21], v[20:21]
    v_pk_mul_f32 v[22:23], v[22:23], v[22:23]
    v_pk_mul_f32 v[24:25], v[24:25], v[24:25]
    v_pk_mul_f32 v[26:27], v[26:27], v[26:27]
    v_pk_mul_f32 v[28:29], v[28:29], v[28:29]
    v_cvt_pk_bf16_f32 v32, v14, v15
    v_lshlrev_b32 v14, 16, v32
    v_and_b32 v15, 0xffff0000, v32
    v_cvt_pk_bf16_f32 v32, v16, v17
    v_lshlrev_b32 v16, 16, v32
    v_and_b32 v17, 0xffff0000, v32
    v_cvt_pk_bf16_f32 v32, v18, v19
    v_lshlrev_b32 v18, 16, v32
    v_and_b32 v19, 0xffff0000, v32
    v_cvt_pk_bf16_f32 v32, v20, v21
    v_lshlrev_b32 v20, 16, v32
    v_and_b32 v21, 0xffff0000, v32
    v_cvt_pk_bf16_f32 v32, v22, v23
    v_lshlrev_b32 v22, 16, v32
    v_and_b32 v23, 0xffff0000, v32
    v_cvt_pk_bf16_f32 v32, v24, v25
    v_lshlrev_b32 v24, 16, v32
    v_and_b32 v25, 0xffff0000, v32
    v_cvt_pk_bf16_f32 v32, v26, v27
    v_lshlrev_b32 v26, 16, v32
    v_and_b32 v27, 0xffff0000, v32
    v_cvt_pk_bf16_f32 v32, v28, v29
    v_lshlrev_b32 v28, 16, v32
    v_and_b32 v29, 0xffff0000, v32
    v_mov_b32 v30, 1092616192
    v_mov_b32 v31, 0x3fb8aa3b
    v_pk_mul_f32 v[14:15], v[14:15], v[30:31] op_sel:[0,0] op_sel_hi:[1,0]
    v_pk_mul_f32 v[16:17], v[16:17], v[30:31] op_sel:[0,0] op_sel_hi:[1,0]
    v_pk_mul_f32 v[18:19], v[18:19], v[30:31] op_sel:[0,0] op_sel_hi:[1,0]
    v_pk_mul_f32 v[20:21], v[20:21], v[30:31] op_sel:[0,0] op_sel_hi:[1,0]
    v_pk_mul_f32 v[22:23], v[22:23], v[30:31] op_sel:[0,0] op_sel_hi:[1,0]
    v_pk_mul_f32 v[24:25], v[24:25], v[30:31] op_sel:[0,0] op_sel_hi:[1,0]
    v_pk_mul_f32 v[26:27], v[26:27], v[30:31] op_sel:[0,0] op_sel_hi:[1,0]
    v_pk_mul_f32 v[28:29], v[28:29], v[30:31] op_sel:[0,0] op_sel_hi:[1,0]
    v_cvt_pk_bf16_f32 v32, v14, v15
    v_lshlrev_b32 v14, 16, v32
    v_and_b32 v15, 0xffff0000, v32
    v_cvt_pk_bf16_f32 v32, v16, v17
    v_lshlrev_b32 v16, 16, v32
    v_and_b32 v17, 0xffff0000, v32
    v_cvt_pk_bf16_f32 v32, v18, v19
    v_lshlrev_b32 v18, 16, v32
    v_and_b32 v19, 0xffff0000, v32
    v_cvt_pk_bf16_f32 v32, v20, v21
    v_lshlrev_b32 v20, 16, v32
    v_and_b32 v21, 0xffff0000, v32
    v_cvt_pk_bf16_f32 v32, v22, v23
    v_lshlrev_b32 v22, 16, v32
    v_and_b32 v23, 0xffff0000, v32
    v_cvt_pk_bf16_f32 v32, v24, v25
    v_lshlrev_b32 v24, 16, v32
    v_and_b32 v25, 0xffff0000, v32
    v_cvt_pk_bf16_f32 v32, v26, v27
    v_lshlrev_b32 v26, 16, v32
    v_and_b32 v27, 0xffff0000, v32
    v_cvt_pk_bf16_f32 v32, v28, v29
    v_lshlrev_b32 v28, 16, v32
    v_and_b32 v29, 0xffff0000, v32
    v_pk_mul_f32 v[14:15], v[14:15], v[30:31] op_sel:[0,1] op_sel_hi:[1,1]
    v_pk_mul_f32 v[16:17], v[16:17], v[30:31] op_sel:[0,1] op_sel_hi:[1,1]
    v_pk_mul_f32 v[18:19], v[18:19], v[30:31] op_sel:[0,1] op_sel_hi:[1,1]
    v_pk_mul_f32 v[20:21], v[20:21], v[30:31] op_sel:[0,1] op_sel_hi:[1,1]
    v_pk_mul_f32 v[22:23], v[22:23], v[30:31] op_sel:[0,1] op_sel_hi:[1,1]
    v_pk_mul_f32 v[24:25], v[24:25], v[30:31] op_sel:[0,1] op_sel_hi:[1,1]
    v_pk_mul_f32 v[26:27], v[26:27], v[30:31] op_sel:[0,1] op_sel_hi:[1,1]
    v_pk_mul_f32 v[28:29], v[28:29], v[30:31] op_sel:[0,1] op_sel_hi:[1,1]
    v_exp_f32 v14, -v14
    v_exp_f32 v15, -v15
    v_exp_f32 v16, -v16
    v_exp_f32 v17, -v17
    v_exp_f32 v18, -v18
    v_exp_f32 v19, -v19
    v_exp_f32 v20, -v20
    v_exp_f32 v21, -v21
    v_exp_f32 v22, -v22
    v_exp_f32 v23, -v23
    v_exp_f32 v24, -v24
    v_exp_f32 v25, -v25
    v_exp_f32 v26, -v26
    v_exp_f32 v27, -v27
    v_exp_f32 v28, -v28
    v_exp_f32 v29, -v29
    v_cvt_pk_bf16_f32 v14, v14, v16
    v_cvt_pk_bf16_f32 v15, v15, v17
    v_cvt_pk_bf16_f32 v18, v18, v20
    v_cvt_pk_bf16_f32 v19, v19, v21
    v_cvt_pk_bf16_f32 v22, v22, v24
    v_cvt_pk_bf16_f32 v23, v23, v25
    v_cvt_pk_bf16_f32 v26, v26, v28
    v_cvt_pk_bf16_f32 v27, v27, v29
    v_dot2_f32_bf16 v72, v14, s68, 0
    v_dot2_f32_bf16 v73, v15, s68, 0
    v_dot2_f32_bf16 v74, v14, s69, 0
    v_dot2_f32_bf16 v75, v15, s69, 0
    v_dot2_f32_bf16 v76, v14, s70, 0
    v_dot2_f32_bf16 v77, v15, s70, 0
    v_dot2_f32_bf16 v78, v14, s71, 0
    v_dot2_f32_bf16 v79, v15, s71, 0
    v_dot2_f32_bf16 v80, v14, s52, 0
    v_dot2_f32_bf16 v81, v15, s52, 0
    v_dot2_f32_bf16 v82, v14, s53, 0
    v_dot2_f32_bf16 v83, v15, s53, 0
    v_dot2_f32_bf16 v84, v14, s54, 0
    v_dot2_f32_bf16 v85, v15, s54, 0
    v_dot2_f32_bf16 v86, v14, s55, 0
    v_dot2_f32_bf16 v87, v15, s55, 0
    v_dot2_f32_bf16 v72, v18, s72, v72
    v_dot2_f32_bf16 v73, v19, s72, v73
    v_dot2_f32_bf16 v74, v18, s73, v74
    v_dot2_f32_bf16 v75, v19, s73, v75
    v_dot2_f32_bf16 v76, v18, s74, v76
    v_dot2_f32_bf16 v77, v19, s74, v77
    v_dot2_f32_bf16 v78, v18, s75, v78
    v_dot2_f32_bf16 v79, v19, s75, v79
    v_dot2_f32_bf16 v80, v18, s56, v80
    v_dot2_f32_bf16 v81, v19, s56, v81
    v_dot2_f32_bf16 v82, v18, s57, v82
    v_dot2_f32_bf16 v83, v19, s57, v83
    v_dot2_f32_bf16 v84, v18, s58, v84
    v_dot2_f32_bf16 v85, v19, s58, v85
    v_dot2_f32_bf16 v86, v18, s59, v86
    v_dot2_f32_bf16 v87, v19, s59, v87
    v_dot2_f32_bf16 v72, v22, s76, v72
    v_dot2_f32_bf16 v73, v23, s76, v73
    v_dot2_f32_bf16 v74, v22, s77, v74
    v_dot2_f32_bf16 v75, v23, s77, v75
    v_dot2_f32_bf16 v76, v22, s78, v76
    v_dot2_f32_bf16 v77, v23, s78, v77
    v_dot2_f32_bf16 v78, v22, s79, v78
    v_dot2_f32_bf16 v79, v23, s79, v79
    v_dot2_f32_bf16 v80, v22, s60, v80
    v_dot2_f32_bf16 v81, v23, s60, v81
    v_dot2_f32_bf16 v82, v22, s61, v82
    v_dot2_f32_bf16 v83, v23, s61, v83
    v_dot2_f32_bf16 v84, v22, s62, v84
    v_dot2_f32_bf16 v85, v23, s62, v85
    v_dot2_f32_bf16 v86, v22, s63, v86
    v_dot2_f32_bf16 v87, v23, s63, v87
    v_dot2_f32_bf16 v72, v26, s80, v72
    v_dot2_f32_bf16 v73, v27, s80, v73
    v_dot2_f32_bf16 v74, v26, s81, v74
    v_dot2_f32_bf16 v75, v27, s81, v75
    v_dot2_f32_bf16 v76, v26, s82, v76
    v_dot2_f32_bf16 v77, v27, s82, v77
    v_dot2_f32_bf16 v78, v26, s83, v78
    v_dot2_f32_bf16 v79, v27, s83, v79
    v_dot2_f32_bf16 v80, v26, s64, v80
    v_dot2_f32_bf16 v81, v27, s64, v81
    v_dot2_f32_bf16 v82, v26, s65, v82
    v_dot2_f32_bf16 v83, v27, s65, v83
    v_dot2_f32_bf16 v84, v26, s66, v84
    v_dot2_f32_bf16 v85, v27, s66, v85
    v_dot2_f32_bf16 v86, v26, s67, v86
    v_dot2_f32_bf16 v87, v27, s67, v87
    s_cmp_ge_u32 s13, 4
    s_cbranch_scc1 L_p2_kernel_g1_27
    v_lshlrev_b32 v30, 16, v61
    v_and_b32 v31, 0xffff0000, v61
    v_pk_add_f32 v[14:15], v[30:31], v[36:37] op_sel:[0,0] op_sel_hi:[1,0] neg_lo:[0,1] neg_hi:[0,1]
    v_pk_add_f32 v[16:17], v[30:31], v[36:37] op_sel:[0,1] op_sel_hi:[1,1] neg_lo:[0,1] neg_hi:[0,1]
    v_pk_add_f32 v[18:19], v[30:31], v[38:39] op_sel:[0,0] op_sel_hi:[1,0] neg_lo:[0,1] neg_hi:[0,1]
    v_pk_add_f32 v[20:21], v[30:31], v[38:39] op_sel:[0,1] op_sel_hi:[1,1] neg_lo:[0,1] neg_hi:[0,1]
    v_pk_add_f32 v[22:23], v[30:31], v[40:41] op_sel:[0,0] op_sel_hi:[1,0] neg_lo:[0,1] neg_hi:[0,1]
    v_pk_add_f32 v[24:25], v[30:31], v[40:41] op_sel:[0,1] op_sel_hi:[1,1] neg_lo:[0,1] neg_hi:[0,1]
    v_pk_add_f32 v[26:27], v[30:31], v[42:43] op_sel:[0,0] op_sel_hi:[1,0] neg_lo:[0,1] neg_hi:[0,1]
    v_pk_add_f32 v[28:29], v[30:31], v[42:43] op_sel:[0,1] op_sel_hi:[1,1] neg_lo:[0,1] neg_hi:[0,1]
    v_cvt_pk_bf16_f32 v32, v14, v15
    v_lshlrev_b32 v14, 16, v32
    v_and_b32 v15, 0xffff0000, v32
    v_cvt_pk_bf16_f32 v32, v16, v17
    v_lshlrev_b32 v16, 16, v32
    v_and_b32 v17, 0xffff0000, v32
    v_cvt_pk_bf16_f32 v32, v18, v19
    v_lshlrev_b32 v18, 16, v32
    v_and_b32 v19, 0xffff0000, v32
    v_cvt_pk_bf16_f32 v32, v20, v21
    v_lshlrev_b32 v20, 16, v32
    v_and_b32 v21, 0xffff0000, v32
    v_cvt_pk_bf16_f32 v32, v22, v23
    v_lshlrev_b32 v22, 16, v32
    v_and_b32 v23, 0xffff0000, v32
    v_cvt_pk_bf16_f32 v32, v24, v25
    v_lshlrev_b32 v24, 16, v32
    v_and_b32 v25, 0xffff0000, v32
    v_cvt_pk_bf16_f32 v32, v26, v27
    v_lshlrev_b32 v26, 16, v32
    v_and_b32 v27, 0xffff0000, v32
    v_cvt_pk_bf16_f32 v32, v28, v29
    v_lshlrev_b32 v28, 16, v32
    v_and_b32 v29, 0xffff0000, v32
    v_pk_mul_f32 v[14:15], v[14:15], v[14:15]
    v_pk_mul_f32 v[16:17], v[16:17], v[16:17]
    v_pk_mul_f32 v[18:19], v[18:19], v[18:19]
    v_pk_mul_f32 v[20:21], v[20:21], v[20:21]
    v_pk_mul_f32 v[22:23], v[22:23], v[22:23]
    v_pk_mul_f32 v[24:25], v[24:25], v[24:25]
    v_pk_mul_f32 v[26:27], v[26:27], v[26:27]
    v_pk_mul_f32 v[28:29], v[28:29], v[28:29]
    v_cvt_pk_bf16_f32 v32, v14, v15
    v_lshlrev_b32 v14, 16, v32
    v_and_b32 v15, 0xffff0000, v32
    v_cvt_pk_bf16_f32 v32, v16, v17
    v_lshlrev_b32 v16, 16, v32
    v_and_b32 v17, 0xffff0000, v32
    v_cvt_pk_bf16_f32 v32, v18, v19
    v_lshlrev_b32 v18, 16, v32
    v_and_b32 v19, 0xffff0000, v32
    v_cvt_pk_bf16_f32 v32, v20, v21
    v_lshlrev_b32 v20, 16, v32
    v_and_b32 v21, 0xffff0000, v32
    v_cvt_pk_bf16_f32 v32, v22, v23
    v_lshlrev_b32 v22, 16, v32
    v_and_b32 v23, 0xffff0000, v32
    v_cvt_pk_bf16_f32 v32, v24, v25
    v_lshlrev_b32 v24, 16, v32
    v_and_b32 v25, 0xffff0000, v32
    v_cvt_pk_bf16_f32 v32, v26, v27
    v_lshlrev_b32 v26, 16, v32
    v_and_b32 v27, 0xffff0000, v32
    v_cvt_pk_bf16_f32 v32, v28, v29
    v_lshlrev_b32 v28, 16, v32
    v_and_b32 v29, 0xffff0000, v32
    v_mov_b32 v30, 1092616192
    v_mov_b32 v31, 0x3fb8aa3b
    v_pk_mul_f32 v[14:15], v[14:15], v[30:31] op_sel:[0,0] op_sel_hi:[1,0]
    v_pk_mul_f32 v[16:17], v[16:17], v[30:31] op_sel:[0,0] op_sel_hi:[1,0]
    v_pk_mul_f32 v[18:19], v[18:19], v[30:31] op_sel:[0,0] op_sel_hi:[1,0]
    v_pk_mul_f32 v[20:21], v[20:21], v[30:31] op_sel:[0,0] op_sel_hi:[1,0]
    v_pk_mul_f32 v[22:23], v[22:23], v[30:31] op_sel:[0,0] op_sel_hi:[1,0]
    v_pk_mul_f32 v[24:25], v[24:25], v[30:31] op_sel:[0,0] op_sel_hi:[1,0]
    v_pk_mul_f32 v[26:27], v[26:27], v[30:31] op_sel:[0,0] op_sel_hi:[1,0]
    v_pk_mul_f32 v[28:29], v[28:29], v[30:31] op_sel:[0,0] op_sel_hi:[1,0]
    v_cvt_pk_bf16_f32 v32, v14, v15
    v_lshlrev_b32 v14, 16, v32
    v_and_b32 v15, 0xffff0000, v32
    v_cvt_pk_bf16_f32 v32, v16, v17
    v_lshlrev_b32 v16, 16, v32
    v_and_b32 v17, 0xffff0000, v32
    v_cvt_pk_bf16_f32 v32, v18, v19
    v_lshlrev_b32 v18, 16, v32
    v_and_b32 v19, 0xffff0000, v32
    v_cvt_pk_bf16_f32 v32, v20, v21
    v_lshlrev_b32 v20, 16, v32
    v_and_b32 v21, 0xffff0000, v32
    v_cvt_pk_bf16_f32 v32, v22, v23
    v_lshlrev_b32 v22, 16, v32
    v_and_b32 v23, 0xffff0000, v32
    v_cvt_pk_bf16_f32 v32, v24, v25
    v_lshlrev_b32 v24, 16, v32
    v_and_b32 v25, 0xffff0000, v32
    v_cvt_pk_bf16_f32 v32, v26, v27
    v_lshlrev_b32 v26, 16, v32
    v_and_b32 v27, 0xffff0000, v32
    v_cvt_pk_bf16_f32 v32, v28, v29
    v_lshlrev_b32 v28, 16, v32
    v_and_b32 v29, 0xffff0000, v32
    v_pk_mul_f32 v[14:15], v[14:15], v[30:31] op_sel:[0,1] op_sel_hi:[1,1]
    v_pk_mul_f32 v[16:17], v[16:17], v[30:31] op_sel:[0,1] op_sel_hi:[1,1]
    v_pk_mul_f32 v[18:19], v[18:19], v[30:31] op_sel:[0,1] op_sel_hi:[1,1]
    v_pk_mul_f32 v[20:21], v[20:21], v[30:31] op_sel:[0,1] op_sel_hi:[1,1]
    v_pk_mul_f32 v[22:23], v[22:23], v[30:31] op_sel:[0,1] op_sel_hi:[1,1]
    v_pk_mul_f32 v[24:25], v[24:25], v[30:31] op_sel:[0,1] op_sel_hi:[1,1]
    v_pk_mul_f32 v[26:27], v[26:27], v[30:31] op_sel:[0,1] op_sel_hi:[1,1]
    v_pk_mul_f32 v[28:29], v[28:29], v[30:31] op_sel:[0,1] op_sel_hi:[1,1]
    v_exp_f32 v14, -v14
    v_exp_f32 v15, -v15
    v_exp_f32 v16, -v16
    v_exp_f32 v17, -v17
    v_exp_f32 v18, -v18
    v_exp_f32 v19, -v19
    v_exp_f32 v20, -v20
    v_exp_f32 v21, -v21
    v_exp_f32 v22, -v22
    v_exp_f32 v23, -v23
    v_exp_f32 v24, -v24
    v_exp_f32 v25, -v25
    v_exp_f32 v26, -v26
    v_exp_f32 v27, -v27
    v_exp_f32 v28, -v28
    v_exp_f32 v29, -v29
    v_cvt_pk_bf16_f32 v14, v14, v16
    v_cvt_pk_bf16_f32 v15, v15, v17
    v_cvt_pk_bf16_f32 v18, v18, v20
    v_cvt_pk_bf16_f32 v19, v19, v21
    v_cvt_pk_bf16_f32 v22, v22, v24
    v_cvt_pk_bf16_f32 v23, v23, v25
    v_cvt_pk_bf16_f32 v26, v26, v28
    v_cvt_pk_bf16_f32 v27, v27, v29
    v_dot2_f32_bf16 v112, v14, s68, 0
    v_dot2_f32_bf16 v113, v15, s68, 0
    v_dot2_f32_bf16 v114, v14, s69, 0
    v_dot2_f32_bf16 v115, v15, s69, 0
    v_dot2_f32_bf16 v116, v14, s70, 0
    v_dot2_f32_bf16 v117, v15, s70, 0
    v_dot2_f32_bf16 v118, v14, s71, 0
    v_dot2_f32_bf16 v119, v15, s71, 0
    v_dot2_f32_bf16 v120, v14, s52, 0
    v_dot2_f32_bf16 v121, v15, s52, 0
    v_dot2_f32_bf16 v122, v14, s53, 0
    v_dot2_f32_bf16 v123, v15, s53, 0
    v_dot2_f32_bf16 v124, v14, s54, 0
    v_dot2_f32_bf16 v125, v15, s54, 0
    v_dot2_f32_bf16 v126, v14, s55, 0
    v_dot2_f32_bf16 v127, v15, s55, 0
    v_dot2_f32_bf16 v112, v18, s72, v112
    v_dot2_f32_bf16 v113, v19, s72, v113
    v_dot2_f32_bf16 v114, v18, s73, v114
    v_dot2_f32_bf16 v115, v19, s73, v115
    v_dot2_f32_bf16 v116, v18, s74, v116
    v_dot2_f32_bf16 v117, v19, s74, v117
    v_dot2_f32_bf16 v118, v18, s75, v118
    v_dot2_f32_bf16 v119, v19, s75, v119
    v_dot2_f32_bf16 v120, v18, s56, v120
    v_dot2_f32_bf16 v121, v19, s56, v121
    v_dot2_f32_bf16 v122, v18, s57, v122
    v_dot2_f32_bf16 v123, v19, s57, v123
    v_dot2_f32_bf16 v124, v18, s58, v124
    v_dot2_f32_bf16 v125, v19, s58, v125
    v_dot2_f32_bf16 v126, v18, s59, v126
    v_dot2_f32_bf16 v127, v19, s59, v127
    v_dot2_f32_bf16 v112, v22, s76, v112
    v_dot2_f32_bf16 v113, v23, s76, v113
    v_dot2_f32_bf16 v114, v22, s77, v114
    v_dot2_f32_bf16 v115, v23, s77, v115
    v_dot2_f32_bf16 v116, v22, s78, v116
    v_dot2_f32_bf16 v117, v23, s78, v117
    v_dot2_f32_bf16 v118, v22, s79, v118
    v_dot2_f32_bf16 v119, v23, s79, v119
    v_dot2_f32_bf16 v120, v22, s60, v120
    v_dot2_f32_bf16 v121, v23, s60, v121
    v_dot2_f32_bf16 v122, v22, s61, v122
    v_dot2_f32_bf16 v123, v23, s61, v123
    v_dot2_f32_bf16 v124, v22, s62, v124
    v_dot2_f32_bf16 v125, v23, s62, v125
    v_dot2_f32_bf16 v126, v22, s63, v126
    v_dot2_f32_bf16 v127, v23, s63, v127
    v_dot2_f32_bf16 v112, v26, s80, v112
    v_dot2_f32_bf16 v113, v27, s80, v113
    v_dot2_f32_bf16 v114, v26, s81, v114
    v_dot2_f32_bf16 v115, v27, s81, v115
    v_dot2_f32_bf16 v116, v26, s82, v116
    v_dot2_f32_bf16 v117, v27, s82, v117
    v_dot2_f32_bf16 v118, v26, s83, v118
    v_dot2_f32_bf16 v119, v27, s83, v119
    v_dot2_f32_bf16 v120, v26, s64, v120
    v_dot2_f32_bf16 v121, v27, s64, v121
    v_dot2_f32_bf16 v122, v26, s65, v122
    v_dot2_f32_bf16 v123, v27, s65, v123
    v_dot2_f32_bf16 v124, v26, s66, v124
    v_dot2_f32_bf16 v125, v27, s66, v125
    v_dot2_f32_bf16 v126, v26, s67, v126
    v_dot2_f32_bf16 v127, v27, s67, v127
L_p2_kernel_g1_27:
    s_lshl2_add_u32 s14, s3, s49
    s_mul_i32 s26, s14, 20000
    s_add_u32 s15, s26, 227607040
    buffer_load_dwordx4 v[64:67], v1, s[4:7], s15 offen
    buffer_load_dwordx4 v[68:71], v2, s[4:7], s15 offen
    s_branch L_p2_fin
L_p2_done:
    s_branch L_p2_end
L_p2_slow:
    s_barrier
    v_mov_b32 v8, 0
    v_mov_b32 v9, 0
    v_mov_b32 v10, 0
    v_mov_b32 v11, 0
    v_mov_b32 v12, v1
    ds_write_b128 v12, v[8:11]
    v_add_u32 v12, 16384, v12
    ds_write_b128 v12, v[8:11]
    v_add_u32 v12, 16384, v12
    ds_write_b128 v12, v[8:11]
    v_add_u32 v12, 16384, v12
    ds_write_b128 v12, v[8:11]
    v_add_u32 v12, 16384, v12
    ds_write_b128 v12, v[8:11]
    v_add_u32 v12, 16384, v12
    ds_write_b128 v12, v[8:11]
    v_add_u32 v12, 16384, v12
    ds_write_b128 v12, v[8:11]
    v_add_u32 v12, 16384, v12
    ds_write_b128 v12, v[8:11]
    v_add_u32 v12, 16384, v12
    ds_write_b128 v12, v[8:11]
    v_add_u32 v12, 16384, v12
    ds_write_b128 v12, v[8:11]
    v_add_u32 v12, 16384, v12
    v_lshlrev_b32 v13, 4, v0
    v_mov_b32 v29, 0x7fc00000
    v_add_u32 v28, 32896, v13
    v_mul_lo_u32 v14, v0, s23
    v_add_u32 v14, 8192, v14
    s_mul_i32 s25, s12, 65
    s_add_u32 s25, s25, s3
    s_mul_i32 s25, s25, 32896
    s_add_u32 s25, s25, 219029504
    s_lshl_b32 s50, s50, 1
    s_mul_i32 s22, s12, 1280000
    s_mov_b32 s24, 0
    s_waitcnt lgkmcnt(0)
    s_barrier
L_p2_sstep:
    buffer_load_ushort v15, v13, s[4:7], s25 offen
    buffer_load_ushort v16, v28, s[4:7], s25 offen
    s_waitcnt vmcnt(0)
L_p2_srec:
    v_cmp_lt_u32 vcc, v15, v16
    s_nop 1
    s_and_b64 exec, exec, vcc
    s_cbranch_execz L_p2_sdone
    v_mul_u32_u24 v17, 43691, v15
    v_lshrrev_b32 v17, 17, v17
    v_mad_i32_i24 v18, v17, -3, v15
    v_lshl_add_u32 v17, v17, 4, v14
    v_lshl_add_u32 v19, v18, 2, v17
    buffer_load_dword v20, v19, s[4:7], 0 offen
    buffer_load_dword v21, v17, s[4:7], 0 offen offset:12
    v_add_u32 v15, 1, v15
    v_mad_u32_u24 v18, v18, 10, 2
    s_waitcnt vmcnt(0)
    v_lshlrev_b32_sdwa v19, 3, v20 dst_sel:DWORD dst_unused:UNUSED_PAD src0_sel:DWORD src1_sel:WORD_0
    buffer_load_dwordx2 v[22:23], v19, s[8:11], s22 offen
    v_mad_u32_u16 v20, v20, 16, s50 op_sel:[1,0,0,0]
    v_bfe_i32 v21, v21, v18, 10
    v_cmp_eq_i32 vcc, -512, v21
    v_cvt_f32_i32 v21, v21
    v_mul_f32 v21, 989872160, v21
    v_cndmask_b32 v21, v21, v29, vcc
    s_waitcnt vmcnt(0)
    v_lshlrev_b32 v24, 16, v22
    v_and_b32 v25, 0xffff0000, v22
    v_lshlrev_b32 v26, 16, v23
    v_and_b32 v27, 0xffff0000, v23
    v_mul_f32 v24, v21, v24
    v_mul_f32 v25, v21, v25
    v_mul_f32 v26, v21, v26
    v_mul_f32 v27, v21, v27
    ds_add_f32 v20, v24
    ds_add_f32 v20, v25 offset:4
    ds_add_f32 v20, v26 offset:8
    ds_add_f32 v20, v27 offset:12
    s_branch L_p2_srec
L_p2_sdone:
    s_mov_b64 exec, -1
    s_cmp_eq_u32 s24, 7
    s_cselect_b32 s14, 16370, 2
    s_add_u32 s25, s25, s14
    s_add_u32 s22, s22, 80000
    s_add_u32 s24, s24, 1
    s_cmp_lt_u32 s24, 16
    s_cbranch_scc1 L_p2_sstep
    s_waitcnt lgkmcnt(0)
    s_barrier
    s_mul_i32 s14, s12, 10240000
    s_mul_i32 s15, s3, 160000
    s_add_u32 s26, s14, s15
    s_add_u32 s26, s26, 253207040
    v_mov_b32 v12, v1
    s_mov_b32 s24, 0
L_p2_sout:
    v_cmp_gt_u32 vcc, 160000, v12
    ds_read_b128 v[8:11], v12
    s_nop 0
    s_and_b64 exec, exec, vcc
    s_cbranch_execz L_p2_sfin
    s_waitcnt lgkmcnt(0)
    buffer_store_dwordx4 v[8:11], v12, s[4:7], s26 offen sc1
    s_waitcnt vmcnt(0)
    v_add_u32 v12, 16384, v12
    s_branch L_p2_sout
L_p2_sfin:
    s_mov_b64 exec, -1
    s_waitcnt vmcnt(0) lgkmcnt(0)
    s_barrier
    s_branch L_p2_signal
L_p2_end:
    s_endpgm
.section .rodata,"a"
.p2align 6
.amdhsa_kernel p1_kernel
  .amdhsa_next_free_vgpr 128
  .amdhsa_next_free_sgpr 96
  .amdhsa_accum_offset 128
  .amdhsa_group_segment_fixed_size 0
  .amdhsa_kernarg_size 112
  .amdhsa_user_sgpr_count 2
  .amdhsa_user_sgpr_kernarg_segment_ptr 1
  .amdhsa_system_sgpr_workgroup_id_x 1
  .amdhsa_float_denorm_mode_32 0
.end_amdhsa_kernel
.p2align 6
.amdhsa_kernel p2_kernel
  .amdhsa_next_free_vgpr 128
  .amdhsa_next_free_sgpr 102
  .amdhsa_accum_offset 128
  .amdhsa_group_segment_fixed_size 0
  .amdhsa_kernarg_size 112
  .amdhsa_user_sgpr_count 2
  .amdhsa_user_sgpr_kernarg_segment_ptr 1
  .amdhsa_system_sgpr_workgroup_id_x 1
  .amdhsa_float_denorm_mode_32 0
.end_amdhsa_kernel
```

```asm
; @launch kernel=p1_kernel grid=(256,1,1) block=(1024,1,1) lds=163840
; @launch kernel=p2_kernel grid=(256,1,1) block=(1024,1,1) lds=163840
.amdgcn_target "amdgcn-amd-amdhsa--gfx950"
.text
.globl p1_kernel
.p2align 8
.type p1_kernel,@function
p1_kernel:
    s_cmp_ge_u32 s2, 256
    s_cbranch_scc1 L_p1_end
    s_load_dwordx2 s[4:5], s[0:1], 104
    s_load_dwordx2 s[8:9], s[0:1], 8
    s_load_dwordx2 s[12:13], s[0:1], 16
    s_load_dwordx2 s[16:17], s[0:1], 32
    s_load_dwordx2 s[28:29], s[0:1], 0
    s_load_dwordx2 s[6:7], s[0:1], 48
    v_lshlrev_b32 v1, 4, v0
    v_lshlrev_b32 v2, 3, v0
    v_lshrrev_b32 v6, 6, v0
    v_mul_u32_u24 v3, 768, v6
    v_add_lshl_u32 v3, v3, v0, 4
    v_mov_b32 v4, 1
    v_mov_b32 v5, 0
    v_readfirstlane_b32 s39, v6
    v_cmp_gt_u32 vcc, 784, v0
    s_mov_b32 s32, s2
    s_lshl_b32 s33, s2, 14
    s_lshl_b32 s34, s2, 13
    s_mul_i32 s48, s2, 3840
    s_mul_i32 s49, s2, 1920
    s_mov_b64 s[44:45], vcc
    s_waitcnt lgkmcnt(0)
    s_load_dword s3, s[6:7], 0
    s_mov_b32 s10, 163840000
    s_mov_b32 s11, 0x00020000
    s_mov_b32 s14, 163840000
    s_mov_b32 s15, 0x00020000
    s_mov_b32 s18, 81920000
    s_mov_b32 s19, 0x00020000
    s_mul_i32 s36, s2, 20000
    s_add_u32 s30, s36, 20000
    s_mov_b32 s31, 0x00020000
    s_add_u32 s35, s36, 16384
    buffer_load_dwordx4 v[48:51], v1, s[28:31], s36 offen nt
    buffer_load_dwordx4 v[52:55], v1, s[28:31], s35 offen nt
    s_add_u32 s35, s33, 0
    buffer_load_dwordx4 v[16:19], v1, s[8:11], s35 offen nt
    s_add_u32 s35, s33, 0
    buffer_load_dwordx4 v[20:23], v1, s[12:15], s35 offen nt
    s_add_u32 s35, s33, 4194304
    buffer_load_dwordx4 v[24:27], v1, s[8:11], s35 offen nt
    s_add_u32 s35, s33, 4194304
    buffer_load_dwordx4 v[28:31], v1, s[12:15], s35 offen nt
    s_add_u32 s35, s33, 8388608
    buffer_load_dwordx4 v[32:35], v1, s[8:11], s35 offen nt
    s_add_u32 s35, s33, 8388608
    buffer_load_dwordx4 v[36:39], v1, s[12:15], s35 offen nt
    s_add_u32 s35, s33, 12582912
    buffer_load_dwordx4 v[40:43], v1, s[8:11], s35 offen nt
    s_add_u32 s35, s33, 12582912
    buffer_load_dwordx4 v[44:47], v1, s[12:15], s35 offen nt
    s_mov_b32 s20, s4
    s_mov_b32 s21, s5
    s_mov_b32 s22, 0
    s_mov_b32 s23, 0x00020000
    s_add_u32 s24, s4, 219029504
    s_addc_u32 s25, s5, 0
    s_mov_b32 s26, 8577536
    s_mov_b32 s27, 0x00020000
    s_mov_b32 s37, 1492179184
    s_mov_b32 s55, 0
    s_mov_b32 s50, 21845
    s_mov_b32 s38, 262400
    s_mov_b32 s43, 0x05040100
    s_mov_b32 s40, 0
    v_mov_b32 v8, 0
    v_mov_b32 v9, 0
    v_mov_b32 v10, 0
    v_mov_b32 v11, 0
    ds_write_b128 v1, v[8:11] offset:0
    s_waitcnt lgkmcnt(0)
    s_lshl_b32 s3, s3, 16
    v_mov_b32 v12, s3
    v_mul_f32 v12, 0.15915494, v12
    s_nop 0
    v_readfirstlane_b32 s41, v12
    s_waitcnt vmcnt(8)
    s_add_u32 s28, s4, 227607040
    s_addc_u32 s29, s5, 0
    s_mul_i32 s36, s2, 20000
    s_add_u32 s35, s36, 16384
    buffer_store_dwordx4 v[48:51], v1, s[28:31], s36 offen
    buffer_store_dwordx4 v[52:55], v1, s[28:31], s35 offen
    s_nop 0
    v_mov_b32 v12, 0x3f803f80
    v_and_b32 v48, 0x7fff7fff, v48
    v_and_b32 v49, 0x7fff7fff, v49
    v_and_b32 v50, 0x7fff7fff, v50
    v_and_b32 v51, 0x7fff7fff, v51
    v_and_b32 v52, 0x7fff7fff, v52
    v_and_b32 v53, 0x7fff7fff, v53
    v_and_b32 v54, 0x7fff7fff, v54
    v_and_b32 v55, 0x7fff7fff, v55
    v_pk_max_u16 v8, v8, v48
    v_dot2c_f32_bf16 v9, v48, v12
    v_pk_max_u16 v8, v8, v49
    v_dot2c_f32_bf16 v9, v49, v12
    v_pk_max_u16 v8, v8, v50
    v_dot2c_f32_bf16 v9, v50, v12
    v_pk_max_u16 v8, v8, v51
    v_dot2c_f32_bf16 v9, v51, v12
    v_pk_max_u16 v8, v8, v52
    v_dot2c_f32_bf16 v9, v52, v12
    v_pk_max_u16 v8, v8, v53
    v_dot2c_f32_bf16 v9, v53, v12
    v_pk_max_u16 v8, v8, v54
    v_dot2c_f32_bf16 v9, v54, v12
    v_pk_max_u16 v8, v8, v55
    v_dot2c_f32_bf16 v9, v55, v12
    v_lshrrev_b32 v10, 16, v8
    v_and_b32 v8, 0xffff, v8
    v_max_u32 v8, v8, v10
    s_nop 0
    s_nop 1
    v_max_u32_dpp v8, v8, v8 row_shr:1 row_mask:0xf bank_mask:0xf bound_ctrl:0
    s_nop 1
    v_max_u32_dpp v8, v8, v8 row_shr:2 row_mask:0xf bank_mask:0xf bound_ctrl:0
    s_nop 1
    v_max_u32_dpp v8, v8, v8 row_shr:4 row_mask:0xf bank_mask:0xf bound_ctrl:0
    s_nop 1
    v_max_u32_dpp v8, v8, v8 row_shr:8 row_mask:0xf bank_mask:0xf bound_ctrl:0
    s_nop 1
    v_max_u32_dpp v8, v8, v8 row_bcast:15 row_mask:0xa bank_mask:0xf
    s_nop 1
    v_max_u32_dpp v8, v8, v8 row_bcast:31 row_mask:0xc bank_mask:0xf
    s_nop 1
    v_add_f32_dpp v9, v9, v9 row_shr:1 row_mask:0xf bank_mask:0xf bound_ctrl:0
    s_nop 1
    v_add_f32_dpp v9, v9, v9 row_shr:2 row_mask:0xf bank_mask:0xf bound_ctrl:0
    s_nop 1
    v_add_f32_dpp v9, v9, v9 row_shr:4 row_mask:0xf bank_mask:0xf bound_ctrl:0
    s_nop 1
    v_add_f32_dpp v9, v9, v9 row_shr:8 row_mask:0xf bank_mask:0xf bound_ctrl:0
    s_nop 1
    v_add_f32_dpp v9, v9, v9 row_bcast:15 row_mask:0xa bank_mask:0xf
    s_nop 1
    v_add_f32_dpp v9, v9, v9 row_bcast:31 row_mask:0xc bank_mask:0xf
    s_lshl_b32 s35, s39, 4
    s_add_u32 s35, s35, 160320
    v_mov_b32 v10, s35
    s_mov_b32 exec_lo, 0
    s_brev_b32 exec_hi, 1
    ds_write_b64 v10, v[8:9]
    s_mov_b64 exec, -1
    s_waitcnt lgkmcnt(0)
    s_barrier
    s_branch L_p1_first
L_p1_loop:
    s_waitcnt lgkmcnt(13)
    v_lshlrev_b32 v15, 22, v100
    v_lshrrev_b32 v100, 16, v100
    v_alignbit_b32 v15, v100, v15, 10
    v_alignbit_b32 v15, v101, v15, 10
    v_xor_b32 v15, 0x80200800, v15
    s_cmp_lg_u32 s39, 15
    s_cbranch_scc1 L_p1_kernel_nox_1
    s_mov_b32 s36, 13312
    buffer_store_dwordx4 v[12:15], v3, s[20:23], s36 offen sc1
L_p1_kernel_nox_1:
    s_waitcnt lgkmcnt(12)
    v_lshlrev_b32 v75, 22, v102
    v_lshrrev_b32 v102, 16, v102
    v_alignbit_b32 v75, v102, v75, 10
    v_alignbit_b32 v75, v103, v75, 10
    v_xor_b32 v75, 0x80200800, v75
    s_mov_b32 s36, 6144
    buffer_store_dwordx4 v[72:75], v3, s[20:23], s36 offen sc1
    s_waitcnt lgkmcnt(11)
    v_lshlrev_b32 v79, 22, v104
    v_lshrrev_b32 v104, 16, v104
    v_alignbit_b32 v79, v104, v79, 10
    v_alignbit_b32 v79, v105, v79, 10
    v_xor_b32 v79, 0x80200800, v79
    s_mov_b32 s36, 7168
    buffer_store_dwordx4 v[76:79], v3, s[20:23], s36 offen sc1
    s_waitcnt lgkmcnt(10)
    v_lshlrev_b32 v51, 22, v106
    v_lshrrev_b32 v106, 16, v106
    v_alignbit_b32 v51, v106, v51, 10
    v_alignbit_b32 v51, v107, v51, 10
    v_xor_b32 v51, 0x80200800, v51
    s_mov_b32 s36, 0
    buffer_store_dwordx4 v[48:51], v3, s[20:23], s36 offen sc1
    s_add_u32 s35, s33, 16777216
    buffer_load_dwordx4 v[72:75], v1, s[8:11], s35 offen nt
    s_add_u32 s35, s33, 16777216
    buffer_load_dwordx4 v[76:79], v1, s[12:15], s35 offen nt
    s_waitcnt lgkmcnt(9)
    v_lshlrev_b32 v83, 22, v108
    v_lshrrev_b32 v108, 16, v108
    v_alignbit_b32 v83, v108, v83, 10
    v_alignbit_b32 v83, v109, v83, 10
    v_xor_b32 v83, 0x80200800, v83
    s_mov_b32 s36, 8192
    buffer_store_dwordx4 v[80:83], v3, s[20:23], s36 offen sc1
    s_waitcnt lgkmcnt(8)
    v_lshlrev_b32 v55, 22, v110
    v_lshrrev_b32 v110, 16, v110
    v_alignbit_b32 v55, v110, v55, 10
    v_alignbit_b32 v55, v111, v55, 10
    v_xor_b32 v55, 0x80200800, v55
    s_mov_b32 s36, 1024
    buffer_store_dwordx4 v[52:55], v3, s[20:23], s36 offen sc1
    s_add_u32 s35, s33, 20971520
    buffer_load_dwordx4 v[80:83], v1, s[8:11], s35 offen nt
    s_add_u32 s35, s33, 20971520
    buffer_load_dwordx4 v[100:103], v1, s[12:15], s35 offen nt
    s_waitcnt lgkmcnt(7)
    v_lshlrev_b32 v87, 22, v112
    v_lshrrev_b32 v112, 16, v112
    v_alignbit_b32 v87, v112, v87, 10
    v_alignbit_b32 v87, v113, v87, 10
    v_xor_b32 v87, 0x80200800, v87
    s_mov_b32 s36, 9216
    buffer_store_dwordx4 v[84:87], v3, s[20:23], s36 offen sc1
    s_waitcnt lgkmcnt(6)
    v_lshlrev_b32 v59, 22, v114
    v_lshrrev_b32 v114, 16, v114
    v_alignbit_b32 v59, v114, v59, 10
    v_alignbit_b32 v59, v115, v59, 10
    v_xor_b32 v59, 0x80200800, v59
    s_mov_b32 s36, 2048
    buffer_store_dwordx4 v[56:59], v3, s[20:23], s36 offen sc1
    s_add_u32 s35, s33, 25165824
    buffer_load_dwordx4 v[84:87], v1, s[8:11], s35 offen nt
    s_add_u32 s35, s33, 25165824
    buffer_load_dwordx4 v[104:107], v1, s[12:15], s35 offen nt
    s_waitcnt lgkmcnt(5)
    v_lshlrev_b32 v91, 22, v116
    v_lshrrev_b32 v116, 16, v116
    v_alignbit_b32 v91, v116, v91, 10
    v_alignbit_b32 v91, v117, v91, 10
    v_xor_b32 v91, 0x80200800, v91
    s_mov_b32 s36, 10240
    buffer_store_dwordx4 v[88:91], v3, s[20:23], s36 offen sc1
    s_waitcnt lgkmcnt(4)
    v_lshlrev_b32 v63, 22, v118
    v_lshrrev_b32 v118, 16, v118
    v_alignbit_b32 v63, v118, v63, 10
    v_alignbit_b32 v63, v119, v63, 10
    v_xor_b32 v63, 0x80200800, v63
    s_mov_b32 s36, 3072
    buffer_store_dwordx4 v[60:63], v3, s[20:23], s36 offen sc1
    s_add_u32 s35, s33, 29360128
    buffer_load_dwordx4 v[88:91], v1, s[8:11], s35 offen nt
    s_add_u32 s35, s33, 29360128
    buffer_load_dwordx4 v[108:111], v1, s[12:15], s35 offen nt
    s_waitcnt lgkmcnt(3)
    v_lshlrev_b32 v95, 22, v120
    v_lshrrev_b32 v120, 16, v120
    v_alignbit_b32 v95, v120, v95, 10
    v_alignbit_b32 v95, v121, v95, 10
    v_xor_b32 v95, 0x80200800, v95
    s_mov_b32 s36, 11264
    buffer_store_dwordx4 v[92:95], v3, s[20:23], s36 offen sc1
    s_waitcnt lgkmcnt(2)
    v_lshlrev_b32 v67, 22, v122
    v_lshrrev_b32 v122, 16, v122
    v_alignbit_b32 v67, v122, v67, 10
    v_alignbit_b32 v67, v123, v67, 10
    v_xor_b32 v67, 0x80200800, v67
    s_mov_b32 s36, 4096
    buffer_store_dwordx4 v[64:67], v3, s[20:23], s36 offen sc1
    s_add_u32 s35, s33, 33554432
    buffer_load_dwordx4 v[92:95], v1, s[8:11], s35 offen nt
    s_add_u32 s35, s33, 33554432
    buffer_load_dwordx4 v[112:115], v1, s[12:15], s35 offen nt
    s_waitcnt lgkmcnt(1)
    v_lshlrev_b32 v99, 22, v124
    v_lshrrev_b32 v124, 16, v124
    v_alignbit_b32 v99, v124, v99, 10
    v_alignbit_b32 v99, v125, v99, 10
    v_xor_b32 v99, 0x80200800, v99
    s_mov_b32 s36, 12288
    buffer_store_dwordx4 v[96:99], v3, s[20:23], s36 offen sc1
    s_waitcnt lgkmcnt(0)
    v_lshlrev_b32 v71, 22, v126
    v_lshrrev_b32 v126, 16, v126
    v_alignbit_b32 v71, v126, v71, 10
    v_alignbit_b32 v71, v127, v71, 10
    v_xor_b32 v71, 0x80200800, v71
    s_mov_b32 s36, 5120
    buffer_store_dwordx4 v[68:71], v3, s[20:23], s36 offen sc1
    s_add_u32 s35, s33, 37748736
    s_sub_u32 s35, s35, s48
    v_cndmask_b32 v96, 2.0, v1, s[44:45]
    buffer_load_dwordx4 v[96:99], v96, s[8:11], s35 offen nt
    s_add_u32 s35, s33, 37748736
    s_sub_u32 s35, s35, s48
    v_cndmask_b32 v116, 2.0, v1, s[44:45]
    buffer_load_dwordx4 v[116:119], v116, s[12:15], s35 offen nt
    s_branch L_p1_join
L_p1_first:
    s_add_u32 s35, s33, 16777216
    buffer_load_dwordx4 v[72:75], v1, s[8:11], s35 offen nt
    s_add_u32 s35, s33, 16777216
    buffer_load_dwordx4 v[76:79], v1, s[12:15], s35 offen nt
    s_add_u32 s35, s33, 20971520
    buffer_load_dwordx4 v[80:83], v1, s[8:11], s35 offen nt
    s_add_u32 s35, s33, 20971520
    buffer_load_dwordx4 v[100:103], v1, s[12:15], s35 offen nt
    s_add_u32 s35, s33, 25165824
    buffer_load_dwordx4 v[84:87], v1, s[8:11], s35 offen nt
    s_add_u32 s35, s33, 25165824
    buffer_load_dwordx4 v[104:107], v1, s[12:15], s35 offen nt
    s_add_u32 s35, s33, 29360128
    buffer_load_dwordx4 v[88:91], v1, s[8:11], s35 offen nt
    s_add_u32 s35, s33, 29360128
    buffer_load_dwordx4 v[108:111], v1, s[12:15], s35 offen nt
    s_add_u32 s35, s33, 33554432
    buffer_load_dwordx4 v[92:95], v1, s[8:11], s35 offen nt
    s_add_u32 s35, s33, 33554432
    buffer_load_dwordx4 v[112:115], v1, s[12:15], s35 offen nt
    s_add_u32 s35, s33, 37748736
    s_sub_u32 s35, s35, s48
    v_cndmask_b32 v96, 2.0, v1, s[44:45]
    buffer_load_dwordx4 v[96:99], v96, s[8:11], s35 offen nt
    s_add_u32 s35, s33, 37748736
    s_sub_u32 s35, s35, s48
    v_cndmask_b32 v116, 2.0, v1, s[44:45]
    buffer_load_dwordx4 v[116:119], v116, s[12:15], s35 offen nt
L_p1_join:
    s_waitcnt vmcnt(18)
    v_perm_b32 v6, v20, v16, s43
    v_perm_b32 v7, v21, v17, s43
    v_perm_b32 v8, v22, v18, s43
    v_perm_b32 v9, v23, v19, s43
    v_mul_hi_u32_u24 v16, 429497, v16
    v_mul_hi_u32_u24 v20, 429497, v20
    v_mul_hi_u32_u24 v17, 429497, v17
    v_mul_hi_u32_u24 v21, 429497, v21
    v_mul_hi_u32_u24 v18, 429497, v18
    v_mul_hi_u32_u24 v22, 429497, v22
    v_mul_hi_u32_u24 v19, 429497, v19
    v_mul_hi_u32_u24 v23, 429497, v23
    v_lshl_or_b32 v16, v20, 16, v16
    v_lshl_or_b32 v17, v21, 16, v17
    v_lshl_or_b32 v18, v22, 16, v18
    v_lshl_or_b32 v19, v23, 16, v19
    v_dot2_u32_u16 v20, v16, s38, 0
    v_dot2_u32_u16 v21, v17, s38, 0
    v_dot2_u32_u16 v22, v18, s38, 0
    v_dot2_u32_u16 v23, v19, s38, 0
    v_pk_mad_u16 v6, v16, s37, v6
    v_pk_mad_u16 v7, v17, s37, v7
    v_pk_mad_u16 v8, v18, s37, v8
    v_pk_mad_u16 v9, v19, s37, v9
    ds_add_u32 v20, v4 offset:0
    ds_add_u32 v21, v4 offset:0
    ds_add_u32 v22, v4 offset:0
    ds_add_u32 v23, v4 offset:0
    v_perm_b32 v55, v23, v22, s43
    v_perm_b32 v51, v21, v20, s43
    v_or_b32 v48, 0x40000000, v6
    v_or_b32 v49, 0x40000000, v7
    v_or_b32 v50, 0x40000000, v8
    v_or_b32 v52, 0x40000000, v9
    s_waitcnt vmcnt(16)
    v_perm_b32 v6, v28, v24, s43
    v_perm_b32 v7, v29, v25, s43
    v_perm_b32 v8, v30, v26, s43
    v_perm_b32 v9, v31, v27, s43
    v_mul_hi_u32_u24 v24, 429497, v24
    v_mul_hi_u32_u24 v28, 429497, v28
    v_mul_hi_u32_u24 v25, 429497, v25
    v_mul_hi_u32_u24 v29, 429497, v29
    v_mul_hi_u32_u24 v26, 429497, v26
    v_mul_hi_u32_u24 v30, 429497, v30
    v_mul_hi_u32_u24 v27, 429497, v27
    v_mul_hi_u32_u24 v31, 429497, v31
    v_lshl_or_b32 v24, v28, 16, v24
    v_lshl_or_b32 v25, v29, 16, v25
    v_lshl_or_b32 v26, v30, 16, v26
    v_lshl_or_b32 v27, v31, 16, v27
    v_dot2_u32_u16 v28, v24, s38, 0
    v_dot2_u32_u16 v29, v25, s38, 0
    v_dot2_u32_u16 v30, v26, s38, 0
    v_dot2_u32_u16 v31, v27, s38, 0
    v_pk_mad_u16 v6, v24, s37, v6
    v_pk_mad_u16 v7, v25, s37, v7
    v_pk_mad_u16 v8, v26, s37, v8
    v_pk_mad_u16 v9, v27, s37, v9
    ds_add_u32 v28, v4 offset:0
    ds_add_u32 v29, v4 offset:0
    ds_add_u32 v30, v4 offset:0
    ds_add_u32 v31, v4 offset:0
    v_perm_b32 v63, v31, v30, s43
    v_perm_b32 v59, v29, v28, s43
    v_or_b32 v53, 0x40000000, v6
    v_or_b32 v54, 0x40000000, v7
    v_or_b32 v56, 0x40000000, v8
    v_or_b32 v57, 0x40000000, v9
    s_waitcnt vmcnt(14)
    v_perm_b32 v6, v36, v32, s43
    v_perm_b32 v7, v37, v33, s43
    v_perm_b32 v8, v38, v34, s43
    v_perm_b32 v9, v39, v35, s43
    v_mul_hi_u32_u24 v32, 429497, v32
    v_mul_hi_u32_u24 v36, 429497, v36
    v_mul_hi_u32_u24 v33, 429497, v33
    v_mul_hi_u32_u24 v37, 429497, v37
    v_mul_hi_u32_u24 v34, 429497, v34
    v_mul_hi_u32_u24 v38, 429497, v38
    v_mul_hi_u32_u24 v35, 429497, v35
    v_mul_hi_u32_u24 v39, 429497, v39
    v_lshl_or_b32 v32, v36, 16, v32
    v_lshl_or_b32 v33, v37, 16, v33
    v_lshl_or_b32 v34, v38, 16, v34
    v_lshl_or_b32 v35, v39, 16, v35
    v_dot2_u32_u16 v36, v32, s38, 0
    v_dot2_u32_u16 v37, v33, s38, 0
    v_dot2_u32_u16 v38, v34, s38, 0
    v_dot2_u32_u16 v39, v35, s38, 0
    v_pk_mad_u16 v6, v32, s37, v6
    v_pk_mad_u16 v7, v33, s37, v7
    v_pk_mad_u16 v8, v34, s37, v8
    v_pk_mad_u16 v9, v35, s37, v9
    ds_add_u32 v36, v4 offset:0
    ds_add_u32 v37, v4 offset:0
    ds_add_u32 v38, v4 offset:0
    ds_add_u32 v39, v4 offset:0
    v_perm_b32 v71, v39, v38, s43
    v_perm_b32 v67, v37, v36, s43
    v_or_b32 v58, 0x40000000, v6
    v_or_b32 v60, 0x40000000, v7
    v_or_b32 v61, 0x40000000, v8
    v_or_b32 v62, 0x40000000, v9
    s_waitcnt vmcnt(12)
    v_perm_b32 v6, v44, v40, s43
    v_perm_b32 v7, v45, v41, s43
    v_perm_b32 v8, v46, v42, s43
    v_perm_b32 v9, v47, v43, s43
    v_mul_hi_u32_u24 v40, 429497, v40
    v_mul_hi_u32_u24 v44, 429497, v44
    v_mul_hi_u32_u24 v41, 429497, v41
    v_mul_hi_u32_u24 v45, 429497, v45
    v_mul_hi_u32_u24 v42, 429497, v42
    v_mul_hi_u32_u24 v46, 429497, v46
    v_mul_hi_u32_u24 v43, 429497, v43
    v_mul_hi_u32_u24 v47, 429497, v47
    v_lshl_or_b32 v40, v44, 16, v40
    v_lshl_or_b32 v41, v45, 16, v41
    v_lshl_or_b32 v42, v46, 16, v42
    v_lshl_or_b32 v43, v47, 16, v43
    v_dot2_u32_u16 v44, v40, s38, 0
    v_dot2_u32_u16 v45, v41, s38, 0
    v_dot2_u32_u16 v46, v42, s38, 0
    v_dot2_u32_u16 v47, v43, s38, 0
    v_pk_mad_u16 v6, v40, s37, v6
    v_pk_mad_u16 v7, v41, s37, v7
    v_pk_mad_u16 v8, v42, s37, v8
    v_pk_mad_u16 v9, v43, s37, v9
    ds_add_u32 v44, v4 offset:0
    ds_add_u32 v45, v4 offset:0
    ds_add_u32 v46, v4 offset:0
    ds_add_u32 v47, v4 offset:0
    v_perm_b32 v121, v47, v46, s43
    v_perm_b32 v120, v45, v44, s43
    v_or_b32 v64, 0x40000000, v6
    v_or_b32 v65, 0x40000000, v7
    v_or_b32 v66, 0x40000000, v8
    v_or_b32 v68, 0x40000000, v9
    s_waitcnt vmcnt(10)
    v_perm_b32 v6, v76, v72, s43
    v_perm_b32 v7, v77, v73, s43
    v_perm_b32 v8, v78, v74, s43
    v_perm_b32 v9, v79, v75, s43
    v_mul_hi_u32_u24 v72, 429497, v72
    v_mul_hi_u32_u24 v76, 429497, v76
    v_mul_hi_u32_u24 v73, 429497, v73
    v_mul_hi_u32_u24 v77, 429497, v77
    v_mul_hi_u32_u24 v74, 429497, v74
    v_mul_hi_u32_u24 v78, 429497, v78
    v_mul_hi_u32_u24 v75, 429497, v75
    v_mul_hi_u32_u24 v79, 429497, v79
    v_lshl_or_b32 v72, v76, 16, v72
    v_lshl_or_b32 v73, v77, 16, v73
    v_lshl_or_b32 v74, v78, 16, v74
    v_lshl_or_b32 v75, v79, 16, v75
    v_dot2_u32_u16 v76, v72, s38, 0
    v_dot2_u32_u16 v77, v73, s38, 0
    v_dot2_u32_u16 v78, v74, s38, 0
    v_dot2_u32_u16 v79, v75, s38, 0
    v_pk_mad_u16 v6, v72, s37, v6
    v_pk_mad_u16 v7, v73, s37, v7
    v_pk_mad_u16 v8, v74, s37, v8
    v_pk_mad_u16 v9, v75, s37, v9
    ds_add_u32 v76, v4 offset:0
    ds_add_u32 v77, v4 offset:0
    ds_add_u32 v78, v4 offset:0
    ds_add_u32 v79, v4 offset:0
    v_perm_b32 v123, v79, v78, s43
    v_perm_b32 v122, v77, v76, s43
    v_or_b32 v69, 0x40000000, v6
    v_or_b32 v70, 0x40000000, v7
    v_or_b32 v127, 0x40000000, v8
    v_or_b32 v72, 0x40000000, v9
    s_waitcnt vmcnt(8)
    v_perm_b32 v6, v100, v80, s43
    v_perm_b32 v7, v101, v81, s43
    v_perm_b32 v8, v102, v82, s43
    v_perm_b32 v9, v103, v83, s43
    v_mul_hi_u32_u24 v80, 429497, v80
    v_mul_hi_u32_u24 v100, 429497, v100
    v_mul_hi_u32_u24 v81, 429497, v81
    v_mul_hi_u32_u24 v101, 429497, v101
    v_mul_hi_u32_u24 v82, 429497, v82
    v_mul_hi_u32_u24 v102, 429497, v102
    v_mul_hi_u32_u24 v83, 429497, v83
    v_mul_hi_u32_u24 v103, 429497, v103
    v_lshl_or_b32 v80, v100, 16, v80
    v_lshl_or_b32 v81, v101, 16, v81
    v_lshl_or_b32 v82, v102, 16, v82
    v_lshl_or_b32 v83, v103, 16, v83
    v_dot2_u32_u16 v100, v80, s38, 0
    v_dot2_u32_u16 v101, v81, s38, 0
    v_dot2_u32_u16 v102, v82, s38, 0
    v_dot2_u32_u16 v103, v83, s38, 0
    v_pk_mad_u16 v6, v80, s37, v6
    v_pk_mad_u16 v7, v81, s37, v7
    v_pk_mad_u16 v8, v82, s37, v8
    v_pk_mad_u16 v9, v83, s37, v9
    ds_add_u32 v100, v4 offset:0
    ds_add_u32 v101, v4 offset:0
    ds_add_u32 v102, v4 offset:0
    ds_add_u32 v103, v4 offset:0
    v_perm_b32 v125, v103, v102, s43
    v_perm_b32 v124, v101, v100, s43
    v_or_b32 v73, 0x40000000, v6
    v_or_b32 v74, 0x40000000, v7
    v_or_b32 v76, 0x40000000, v8
    v_or_b32 v77, 0x40000000, v9
    s_waitcnt vmcnt(6)
    v_perm_b32 v6, v104, v84, s43
    v_perm_b32 v7, v105, v85, s43
    v_perm_b32 v8, v106, v86, s43
    v_perm_b32 v9, v107, v87, s43
    v_mul_hi_u32_u24 v84, 429497, v84
    v_mul_hi_u32_u24 v104, 429497, v104
    v_mul_hi_u32_u24 v85, 429497, v85
    v_mul_hi_u32_u24 v105, 429497, v105
    v_mul_hi_u32_u24 v86, 429497, v86
    v_mul_hi_u32_u24 v106, 429497, v106
    v_mul_hi_u32_u24 v87, 429497, v87
    v_mul_hi_u32_u24 v107, 429497, v107
    v_lshl_or_b32 v84, v104, 16, v84
    v_lshl_or_b32 v85, v105, 16, v85
    v_lshl_or_b32 v86, v106, 16, v86
    v_lshl_or_b32 v87, v107, 16, v87
    v_dot2_u32_u16 v104, v84, s38, 0
    v_dot2_u32_u16 v105, v85, s38, 0
    v_dot2_u32_u16 v106, v86, s38, 0
    v_dot2_u32_u16 v107, v87, s38, 0
    v_pk_mad_u16 v6, v84, s37, v6
    v_pk_mad_u16 v7, v85, s37, v7
    v_pk_mad_u16 v8, v86, s37, v8
    v_pk_mad_u16 v9, v87, s37, v9
    ds_add_u32 v104, v4 offset:0
    ds_add_u32 v105, v4 offset:0
    ds_add_u32 v106, v4 offset:0
    ds_add_u32 v107, v4 offset:0
    v_perm_b32 v75, v107, v106, s43
    v_perm_b32 v126, v105, v104, s43
    v_or_b32 v78, 0x40000000, v6
    v_or_b32 v80, 0x40000000, v7
    v_or_b32 v81, 0x40000000, v8
    v_or_b32 v82, 0x40000000, v9
    s_waitcnt vmcnt(4)
    v_perm_b32 v6, v108, v88, s43
    v_perm_b32 v7, v109, v89, s43
    v_perm_b32 v8, v110, v90, s43
    v_perm_b32 v9, v111, v91, s43
    v_mul_hi_u32_u24 v88, 429497, v88
    v_mul_hi_u32_u24 v108, 429497, v108
    v_mul_hi_u32_u24 v89, 429497, v89
    v_mul_hi_u32_u24 v109, 429497, v109
    v_mul_hi_u32_u24 v90, 429497, v90
    v_mul_hi_u32_u24 v110, 429497, v110
    v_mul_hi_u32_u24 v91, 429497, v91
    v_mul_hi_u32_u24 v111, 429497, v111
    v_lshl_or_b32 v88, v108, 16, v88
    v_lshl_or_b32 v89, v109, 16, v89
    v_lshl_or_b32 v90, v110, 16, v90
    v_lshl_or_b32 v91, v111, 16, v91
    v_dot2_u32_u16 v108, v88, s38, 0
    v_dot2_u32_u16 v109, v89, s38, 0
    v_dot2_u32_u16 v110, v90, s38, 0
    v_dot2_u32_u16 v111, v91, s38, 0
    v_pk_mad_u16 v6, v88, s37, v6
    v_pk_mad_u16 v7, v89, s37, v7
    v_pk_mad_u16 v8, v90, s37, v8
    v_pk_mad_u16 v9, v91, s37, v9
    ds_add_u32 v108, v4 offset:0
    ds_add_u32 v109, v4 offset:0
    ds_add_u32 v110, v4 offset:0
    ds_add_u32 v111, v4 offset:0
    v_perm_b32 v83, v111, v110, s43
    v_perm_b32 v79, v109, v108, s43
    v_or_b32 v84, 0x40000000, v6
    v_or_b32 v85, 0x40000000, v7
    v_or_b32 v86, 0x40000000, v8
    v_or_b32 v88, 0x40000000, v9
    s_waitcnt vmcnt(2)
    v_perm_b32 v6, v112, v92, s43
    v_perm_b32 v7, v113, v93, s43
    v_perm_b32 v8, v114, v94, s43
    v_perm_b32 v9, v115, v95, s43
    v_mul_hi_u32_u24 v92, 429497, v92
    v_mul_hi_u32_u24 v112, 429497, v112
    v_mul_hi_u32_u24 v93, 429497, v93
    v_mul_hi_u32_u24 v113, 429497, v113
    v_mul_hi_u32_u24 v94, 429497, v94
    v_mul_hi_u32_u24 v114, 429497, v114
    v_mul_hi_u32_u24 v95, 429497, v95
    v_mul_hi_u32_u24 v115, 429497, v115
    v_lshl_or_b32 v92, v112, 16, v92
    v_lshl_or_b32 v93, v113, 16, v93
    v_lshl_or_b32 v94, v114, 16, v94
    v_lshl_or_b32 v95, v115, 16, v95
    v_dot2_u32_u16 v112, v92, s38, 0
    v_dot2_u32_u16 v113, v93, s38, 0
    v_dot2_u32_u16 v114, v94, s38, 0
    v_dot2_u32_u16 v115, v95, s38, 0
    v_pk_mad_u16 v6, v92, s37, v6
    v_pk_mad_u16 v7, v93, s37, v7
    v_pk_mad_u16 v8, v94, s37, v8
    v_pk_mad_u16 v9, v95, s37, v9
    ds_add_u32 v112, v4 offset:0
    ds_add_u32 v113, v4 offset:0
    ds_add_u32 v114, v4 offset:0
    ds_add_u32 v115, v4 offset:0
    v_perm_b32 v91, v115, v114, s43
    v_perm_b32 v87, v113, v112, s43
    v_or_b32 v89, 0x40000000, v6
    v_or_b32 v90, 0x40000000, v7
    v_or_b32 v92, 0x40000000, v8
    v_or_b32 v93, 0x40000000, v9
    s_waitcnt vmcnt(0)
    s_mov_b64 exec, s[44:45]
    v_perm_b32 v6, v116, v96, s43
    v_perm_b32 v7, v117, v97, s43
    v_perm_b32 v8, v118, v98, s43
    v_perm_b32 v9, v119, v99, s43
    v_mul_hi_u32_u24 v96, 429497, v96
    v_mul_hi_u32_u24 v116, 429497, v116
    v_mul_hi_u32_u24 v97, 429497, v97
    v_mul_hi_u32_u24 v117, 429497, v117
    v_mul_hi_u32_u24 v98, 429497, v98
    v_mul_hi_u32_u24 v118, 429497, v118
    v_mul_hi_u32_u24 v99, 429497, v99
    v_mul_hi_u32_u24 v119, 429497, v119
    v_lshl_or_b32 v96, v116, 16, v96
    v_lshl_or_b32 v97, v117, 16, v97
    v_lshl_or_b32 v98, v118, 16, v98
    v_lshl_or_b32 v99, v119, 16, v99
    v_dot2_u32_u16 v116, v96, s38, 0
    v_dot2_u32_u16 v117, v97, s38, 0
    v_dot2_u32_u16 v118, v98, s38, 0
    v_dot2_u32_u16 v119, v99, s38, 0
    v_pk_mad_u16 v6, v96, s37, v6
    v_pk_mad_u16 v7, v97, s37, v7
    v_pk_mad_u16 v8, v98, s37, v8
    v_pk_mad_u16 v9, v99, s37, v9
    ds_add_u32 v116, v4 offset:0
    ds_add_u32 v117, v4 offset:0
    ds_add_u32 v118, v4 offset:0
    ds_add_u32 v119, v4 offset:0
    v_perm_b32 v99, v119, v118, s43
    v_perm_b32 v95, v117, v116, s43
    v_or_b32 v94, 0x40000000, v6
    v_or_b32 v96, 0x40000000, v7
    v_or_b32 v97, 0x40000000, v8
    v_or_b32 v98, 0x40000000, v9
    s_mov_b64 exec, -1
    s_add_u32 s35, s34, 0
    buffer_load_dwordx2 v[100:101], v2, s[16:19], s35 offen nt
    s_and_b32 s35, s32, 15
    s_lshl_b32 s35, s35, 6
    s_lshr_b32 s36, s32, 4
    s_add_u32 s35, s35, s36
    s_lshl_b32 s42, s35, 4
    s_mul_i32 s35, s35, 213888
    s_add_u32 s35, s35, 8192
    s_add_u32 s20, s4, s35
    s_addc_u32 s21, s5, 0
    s_waitcnt lgkmcnt(0)
    s_barrier
    ds_read_b128 v[8:11], v1 offset:0
    s_add_u32 s35, s34, 2097152
    buffer_load_dwordx2 v[102:103], v2, s[16:19], s35 offen nt
    s_lshl_b32 s35, s39, 2
    s_add_u32 s35, s35, 160256
    v_mov_b32 v7, s35
    v_and_b32 v14, 15, v0
    v_lshlrev_b32 v14, 2, v14
    v_add_u32 v14, 160256, v14
    s_waitcnt lgkmcnt(0)
    v_cmp_eq_u32 s[56:57], 0, v8
    v_cmp_ge_u32 s[64:65], 1, v8
    v_max_u32 v12, 2, v8
    v_lshl_or_b32 v8, v8, 16, v12
    v_cmp_eq_u32 s[58:59], 0, v9
    v_cmp_ge_u32 s[66:67], 1, v9
    v_max_u32 v12, 2, v9
    v_lshl_or_b32 v9, v9, 16, v12
    v_cmp_eq_u32 s[60:61], 0, v10
    v_cmp_ge_u32 s[68:69], 1, v10
    v_max_u32 v12, 2, v10
    v_lshl_or_b32 v10, v10, 16, v12
    v_cmp_eq_u32 s[62:63], 0, v11
    v_cmp_ge_u32 s[70:71], 1, v11
    v_max_u32 v12, 2, v11
    v_lshl_or_b32 v11, v11, 16, v12
    v_add_u32 v9, v8, v9
    v_add_u32 v10, v9, v10
    v_add_u32 v11, v10, v11
    v_mov_b32 v6, v11
    s_nop 1
    v_add_u32_dpp v6, v6, v6 row_shr:1 row_mask:0xf bank_mask:0xf bound_ctrl:0
    s_nop 1
    v_add_u32_dpp v6, v6, v6 row_shr:2 row_mask:0xf bank_mask:0xf bound_ctrl:0
    s_nop 1
    v_add_u32_dpp v6, v6, v6 row_shr:4 row_mask:0xf bank_mask:0xf bound_ctrl:0
    s_nop 1
    v_add_u32_dpp v6, v6, v6 row_shr:8 row_mask:0xf bank_mask:0xf bound_ctrl:0
    s_nop 1
    v_add_u32_dpp v6, v6, v6 row_bcast:15 row_mask:0xa bank_mask:0xf
    s_nop 1
    v_add_u32_dpp v6, v6, v6 row_bcast:31 row_mask:0xc bank_mask:0xf
    s_mov_b32 exec_lo, 0
    s_brev_b32 exec_hi, 1
    ds_write_b32 v7, v6
    s_mov_b64 exec, -1
    v_sub_u32 v6, v6, v11
    s_or_b64 s[46:47], s[64:65], s[66:67]
    s_or_b64 vcc, s[68:69], s[70:71]
    s_or_b64 s[46:47], s[46:47], vcc
    s_waitcnt lgkmcnt(0)
    s_barrier
    ds_read_b32 v7, v14
    s_add_u32 s35, s34, 4194304
    buffer_load_dwordx2 v[104:105], v2, s[16:19], s35 offen nt
    s_waitcnt lgkmcnt(0)
    v_mov_b32 v15, v7
    s_nop 1
    v_add_u32_dpp v7, v7, v7 row_shr:1 row_mask:0xf bank_mask:0xf bound_ctrl:0
    s_nop 1
    v_add_u32_dpp v7, v7, v7 row_shr:2 row_mask:0xf bank_mask:0xf bound_ctrl:0
    s_nop 1
    v_add_u32_dpp v7, v7, v7 row_shr:4 row_mask:0xf bank_mask:0xf bound_ctrl:0
    s_nop 1
    v_add_u32_dpp v7, v7, v7 row_shr:8 row_mask:0xf bank_mask:0xf bound_ctrl:0
    s_nop 0
    v_readlane_b32 s54, v7, 15
    v_sub_u32 v7, v7, v15
    s_nop 0
    v_readlane_b32 s35, v7, s39
    s_and_b32 s54, s54, 0xffff
    s_cmp_ge_u32 s54, 40063
    s_cselect_b32 s36, 16, 0
    s_cselect_b32 s54, 40000, s54
    s_cselect_b32 s55, 1, s55
    s_cselect_b64 s[46:47], 0, s[46:47]
    v_add_u32 v12, s35, v6
    v_add_u32 v13, v12, v8
    v_add_u32 v14, v12, v9
    v_add_u32 v15, v12, v10
    v_bfe_u32 v12, v12, s36, 16
    v_bfe_u32 v13, v13, s36, 16
    v_bfe_u32 v14, v14, s36, 16
    v_bfe_u32 v15, v15, s36, 16
    ds_write_b128 v1, v[12:15] offset:0
    ds_write_b128 v1, v[12:15] offset:16384
    v_mov_b32 v6, 32768
    v_mov_b32 v7, s54
    s_mov_b64 exec, 1
    ds_write_b32 v6, v7
    s_mov_b64 exec, -1
    s_add_u32 s35, s54, 2
    s_mul_hi_u32 s35, s35, 1431655766
    s_lshl_b32 s35, s35, 4
    s_min_u32 s22, s35, 213888
    v_perm_b32 v15, v15, v14, s43
    v_perm_b32 v14, v13, v12, s43
    s_waitcnt lgkmcnt(0)
    s_barrier
    v_and_b32 v6, 63, v0
    s_lshl_b32 s35, s39, 10
    v_lshl_add_u32 v7, v6, 2, s35
    v_lshl_add_u32 v12, v6, 8, s35
    ds_read_b32 v8, v7 offset:16384
    ds_read_b32 v9, v7 offset:16640
    ds_read_b32 v10, v7 offset:16896
    ds_read_b32 v11, v7 offset:17152
    s_mov_b64 exec, 15
    ds_read_b32 v12, v12 offset:16640
    s_mov_b64 exec, -1
    s_lshr_b32 s35, s39, 2
    s_mul_i32 s35, s35, 2138240
    s_and_b32 s36, s39, 1
    s_lshl_b32 s36, s36, 3
    s_add_u32 s35, s35, s36
    s_and_b32 s36, s39, 2
    s_lshl_b32 s36, s36, 13
    s_add_u32 s35, s35, s36
    s_add_u32 s35, s35, s42
    s_add_u32 s36, s35, 2105344
    v_mul_u32_u24 v7, 32896, v6
    v_lshlrev_b32 v13, 1, v6
    s_waitcnt lgkmcnt(1)
    v_perm_b32 v8, v9, v8, s43
    v_perm_b32 v9, v11, v10, s43
    buffer_store_dwordx2 v[8:9], v7, s[24:27], s35 offen
    s_waitcnt lgkmcnt(0)
    s_mov_b64 exec, 15
    buffer_store_short v12, v13, s[24:27], s36 offen
    s_mov_b64 exec, -1
    s_nop 0
    v_and_b32 v6, 0xffff, v51
    v_lshrrev_b32 v7, 16, v51
    v_and_b32 v8, 0xffff, v55
    v_lshrrev_b32 v9, 16, v55
    ds_add_rtn_u32 v6, v6, v4 offset:0
    ds_add_rtn_u32 v7, v7, v4 offset:0
    ds_add_rtn_u32 v8, v8, v4 offset:0
    ds_add_rtn_u32 v9, v9, v4 offset:0
    v_and_b32 v10, 0xffff, v59
    v_lshrrev_b32 v11, 16, v59
    v_and_b32 v12, 0xffff, v63
    v_lshrrev_b32 v13, 16, v63
    ds_add_rtn_u32 v10, v10, v4 offset:0
    ds_add_rtn_u32 v11, v11, v4 offset:0
    ds_add_rtn_u32 v12, v12, v4 offset:0
    ds_add_rtn_u32 v13, v13, v4 offset:0
    s_waitcnt lgkmcnt(4)
    v_perm_b32 v51, v7, v6, s43
    v_perm_b32 v55, v9, v8, s43
    v_and_b32 v6, 0xffff, v67
    v_lshrrev_b32 v7, 16, v67
    v_and_b32 v8, 0xffff, v71
    v_lshrrev_b32 v9, 16, v71
    ds_add_rtn_u32 v6, v6, v4 offset:0
    ds_add_rtn_u32 v7, v7, v4 offset:0
    ds_add_rtn_u32 v8, v8, v4 offset:0
    ds_add_rtn_u32 v9, v9, v4 offset:0
    s_waitcnt lgkmcnt(4)
    v_perm_b32 v59, v11, v10, s43
    v_perm_b32 v63, v13, v12, s43
    s_add_u32 s35, s34, 6291456
    buffer_load_dwordx2 v[106:107], v2, s[16:19], s35 offen nt
    v_and_b32 v10, 0xffff, v120
    v_lshrrev_b32 v11, 16, v120
    v_and_b32 v12, 0xffff, v121
    v_lshrrev_b32 v13, 16, v121
    ds_add_rtn_u32 v10, v10, v4 offset:0
    ds_add_rtn_u32 v11, v11, v4 offset:0
    ds_add_rtn_u32 v12, v12, v4 offset:0
    ds_add_rtn_u32 v13, v13, v4 offset:0
    s_waitcnt lgkmcnt(4)
    v_perm_b32 v67, v7, v6, s43
    v_perm_b32 v71, v9, v8, s43
    s_add_u32 s35, s34, 8388608
    buffer_load_dwordx2 v[108:109], v2, s[16:19], s35 offen nt
    v_and_b32 v6, 0xffff, v122
    v_lshrrev_b32 v7, 16, v122
    v_and_b32 v8, 0xffff, v123
    v_lshrrev_b32 v9, 16, v123
    ds_add_rtn_u32 v6, v6, v4 offset:0
    ds_add_rtn_u32 v7, v7, v4 offset:0
    ds_add_rtn_u32 v8, v8, v4 offset:0
    ds_add_rtn_u32 v9, v9, v4 offset:0
    s_waitcnt lgkmcnt(4)
    v_perm_b32 v120, v11, v10, s43
    v_perm_b32 v121, v13, v12, s43
    s_add_u32 s35, s34, 10485760
    buffer_load_dwordx2 v[110:111], v2, s[16:19], s35 offen nt
    v_and_b32 v10, 0xffff, v124
    v_lshrrev_b32 v11, 16, v124
    v_and_b32 v12, 0xffff, v125
    v_lshrrev_b32 v13, 16, v125
    ds_add_rtn_u32 v10, v10, v4 offset:0
    ds_add_rtn_u32 v11, v11, v4 offset:0
    ds_add_rtn_u32 v12, v12, v4 offset:0
    ds_add_rtn_u32 v13, v13, v4 offset:0
    s_waitcnt lgkmcnt(4)
    v_perm_b32 v122, v7, v6, s43
    v_perm_b32 v123, v9, v8, s43
    v_and_b32 v6, 0xffff, v126
    v_lshrrev_b32 v7, 16, v126
    v_and_b32 v8, 0xffff, v75
    v_lshrrev_b32 v9, 16, v75
    ds_add_rtn_u32 v6, v6, v4 offset:0
    ds_add_rtn_u32 v7, v7, v4 offset:0
    ds_add_rtn_u32 v8, v8, v4 offset:0
    ds_add_rtn_u32 v9, v9, v4 offset:0
    s_waitcnt lgkmcnt(4)
    v_perm_b32 v124, v11, v10, s43
    v_perm_b32 v125, v13, v12, s43
    s_add_u32 s35, s34, 12582912
    buffer_load_dwordx2 v[112:113], v2, s[16:19], s35 offen nt
    v_and_b32 v10, 0xffff, v79
    v_lshrrev_b32 v11, 16, v79
    v_and_b32 v12, 0xffff, v83
    v_lshrrev_b32 v13, 16, v83
    ds_add_rtn_u32 v10, v10, v4 offset:0
    ds_add_rtn_u32 v11, v11, v4 offset:0
    ds_add_rtn_u32 v12, v12, v4 offset:0
    ds_add_rtn_u32 v13, v13, v4 offset:0
    s_waitcnt lgkmcnt(4)
    v_perm_b32 v126, v7, v6, s43
    v_perm_b32 v75, v9, v8, s43
    s_add_u32 s35, s34, 14680064
    buffer_load_dwordx2 v[114:115], v2, s[16:19], s35 offen nt
    v_and_b32 v6, 0xffff, v87
    v_lshrrev_b32 v7, 16, v87
    v_and_b32 v8, 0xffff, v91
    v_lshrrev_b32 v9, 16, v91
    ds_add_rtn_u32 v6, v6, v4 offset:0
    ds_add_rtn_u32 v7, v7, v4 offset:0
    ds_add_rtn_u32 v8, v8, v4 offset:0
    ds_add_rtn_u32 v9, v9, v4 offset:0
    s_waitcnt lgkmcnt(4)
    v_perm_b32 v79, v11, v10, s43
    v_perm_b32 v83, v13, v12, s43
    s_add_u32 s35, s34, 16777216
    buffer_load_dwordx2 v[116:117], v2, s[16:19], s35 offen nt
    s_mov_b64 exec, s[44:45]
    v_and_b32 v10, 0xffff, v95
    v_lshrrev_b32 v11, 16, v95
    v_and_b32 v12, 0xffff, v99
    v_lshrrev_b32 v13, 16, v99
    ds_add_rtn_u32 v10, v10, v4 offset:0
    ds_add_rtn_u32 v11, v11, v4 offset:0
    ds_add_rtn_u32 v12, v12, v4 offset:0
    ds_add_rtn_u32 v13, v13, v4 offset:0
    s_mov_b64 exec, -1
    s_waitcnt lgkmcnt(4)
    v_perm_b32 v87, v7, v6, s43
    v_perm_b32 v91, v9, v8, s43
    s_add_u32 s35, s34, 18874368
    s_sub_u32 s35, s35, s49
    v_cndmask_b32 v118, 2.0, v2, s[44:45]
    buffer_load_dwordx2 v[118:119], v118, s[16:19], s35 offen nt
    s_waitcnt lgkmcnt(0)
    v_perm_b32 v95, v11, v10, s43
    v_perm_b32 v99, v13, v12, s43
    s_barrier
    s_lshl_b32 s35, s54, 2
    v_mov_b32 v6, s35
    v_mov_b32 v7, 0
    v_mov_b32 v12, 1140817920
    s_mov_b64 exec, 1
    ds_write2_b32 v6, v7, v7 offset0:0 offset1:1
    s_cmp_eq_u64 s[46:47], 0
    s_cbranch_scc1 L_p1_kernel_nonull_2
    s_mov_b64 exec, s[64:65]
    v_lshlrev_b32_sdwa v6, 2, v14 dst_sel:DWORD dst_unused:UNUSED_PAD src0_sel:DWORD src1_sel:WORD_0
    ds_write_b32 v6, v7 offset:4
    s_mov_b64 exec, s[56:57]
    ds_write_b32 v6, v7
    s_mov_b64 exec, s[66:67]
    v_lshlrev_b32_sdwa v6, 2, v14 dst_sel:DWORD dst_unused:UNUSED_PAD src0_sel:DWORD src1_sel:WORD_1
    ds_write_b32 v6, v7 offset:4
    s_mov_b64 exec, s[58:59]
    ds_write_b32 v6, v7
    s_mov_b64 exec, s[68:69]
    v_lshlrev_b32_sdwa v6, 2, v15 dst_sel:DWORD dst_unused:UNUSED_PAD src0_sel:DWORD src1_sel:WORD_0
    ds_write_b32 v6, v7 offset:4
    s_mov_b64 exec, s[60:61]
    ds_write_b32 v6, v7
    s_mov_b64 exec, s[70:71]
    v_lshlrev_b32_sdwa v6, 2, v15 dst_sel:DWORD dst_unused:UNUSED_PAD src0_sel:DWORD src1_sel:WORD_1
    ds_write_b32 v6, v7 offset:4
    s_mov_b64 exec, s[62:63]
    ds_write_b32 v6, v7
L_p1_kernel_nonull_2:
    s_mov_b64 exec, -1
    v_lshlrev_b32_sdwa v6, 2, v51 dst_sel:DWORD dst_unused:UNUSED_PAD src0_sel:DWORD src1_sel:WORD_0
    v_lshlrev_b32_sdwa v7, 2, v51 dst_sel:DWORD dst_unused:UNUSED_PAD src0_sel:DWORD src1_sel:WORD_1
    v_lshlrev_b32_sdwa v8, 2, v55 dst_sel:DWORD dst_unused:UNUSED_PAD src0_sel:DWORD src1_sel:WORD_0
    v_lshlrev_b32_sdwa v9, 2, v55 dst_sel:DWORD dst_unused:UNUSED_PAD src0_sel:DWORD src1_sel:WORD_1
    ds_write_b32 v6, v48
    ds_write_b32 v7, v49
    ds_write_b32 v8, v50
    ds_write_b32 v9, v52
    s_waitcnt vmcnt(11)
    v_lshlrev_b32 v10, 16, v100
    v_lshlrev_b32 v11, 16, v101
    v_and_b32 v100, 0xffff0000, v100
    v_and_b32 v101, 0xffff0000, v101
    v_mul_f32 v10, s41, v10
    v_mul_f32 v100, s41, v100
    v_mul_f32 v11, s41, v11
    v_mul_f32 v101, s41, v101
    v_fract_f32 v10, v10
    v_fract_f32 v100, v100
    v_fract_f32 v11, v11
    v_fract_f32 v101, v101
    v_cos_f32 v10, v10
    v_cos_f32 v100, v100
    v_cos_f32 v11, v11
    v_cos_f32 v101, v101
    v_fmaak_f32 v10, v12, v10, 1262486016
    v_fmaak_f32 v100, v12, v100, 1262486016
    v_fmaak_f32 v11, v12, v11, 1262486016
    v_fmaak_f32 v101, v12, v101, 1262486016
    v_or3_b32 v5, v10, v100, v5
    v_or3_b32 v5, v11, v101, v5
    v_perm_b32 v100, v100, v10, s43
    v_perm_b32 v101, v101, v11, s43
    s_add_u32 s35, s33, 40960000
    buffer_load_dwordx4 v[16:19], v1, s[8:11], s35 offen nt
    v_lshlrev_b32_sdwa v6, 2, v59 dst_sel:DWORD dst_unused:UNUSED_PAD src0_sel:DWORD src1_sel:WORD_0
    v_lshlrev_b32_sdwa v7, 2, v59 dst_sel:DWORD dst_unused:UNUSED_PAD src0_sel:DWORD src1_sel:WORD_1
    v_lshlrev_b32_sdwa v8, 2, v63 dst_sel:DWORD dst_unused:UNUSED_PAD src0_sel:DWORD src1_sel:WORD_0
    v_lshlrev_b32_sdwa v9, 2, v63 dst_sel:DWORD dst_unused:UNUSED_PAD src0_sel:DWORD src1_sel:WORD_1
    ds_write_b32 v6, v53
    ds_write_b32 v7, v54
    ds_write_b32 v8, v56
    ds_write_b32 v9, v57
    s_waitcnt vmcnt(11)
    v_lshlrev_b32 v10, 16, v102
    v_lshlrev_b32 v11, 16, v103
    v_and_b32 v102, 0xffff0000, v102
    v_and_b32 v103, 0xffff0000, v103
    v_mul_f32 v10, s41, v10
    v_mul_f32 v102, s41, v102
    v_mul_f32 v11, s41, v11
    v_mul_f32 v103, s41, v103
    v_fract_f32 v10, v10
    v_fract_f32 v102, v102
    v_fract_f32 v11, v11
    v_fract_f32 v103, v103
    v_cos_f32 v10, v10
    v_cos_f32 v102, v102
    v_cos_f32 v11, v11
    v_cos_f32 v103, v103
    v_fmaak_f32 v10, v12, v10, 1262486016
    v_fmaak_f32 v102, v12, v102, 1262486016
    v_fmaak_f32 v11, v12, v11, 1262486016
    v_fmaak_f32 v103, v12, v103, 1262486016
    v_or3_b32 v5, v10, v102, v5
    v_or3_b32 v5, v11, v103, v5
    v_perm_b32 v102, v102, v10, s43
    v_perm_b32 v103, v103, v11, s43
    v_lshlrev_b32_sdwa v6, 2, v67 dst_sel:DWORD dst_unused:UNUSED_PAD src0_sel:DWORD src1_sel:WORD_0
    v_lshlrev_b32_sdwa v7, 2, v67 dst_sel:DWORD dst_unused:UNUSED_PAD src0_sel:DWORD src1_sel:WORD_1
    v_lshlrev_b32_sdwa v8, 2, v71 dst_sel:DWORD dst_unused:UNUSED_PAD src0_sel:DWORD src1_sel:WORD_0
    v_lshlrev_b32_sdwa v9, 2, v71 dst_sel:DWORD dst_unused:UNUSED_PAD src0_sel:DWORD src1_sel:WORD_1
    ds_write_b32 v6, v58
    ds_write_b32 v7, v60
    ds_write_b32 v8, v61
    ds_write_b32 v9, v62
    v_lshlrev_b32_sdwa v6, 2, v120 dst_sel:DWORD dst_unused:UNUSED_PAD src0_sel:DWORD src1_sel:WORD_0
    v_lshlrev_b32_sdwa v7, 2, v120 dst_sel:DWORD dst_unused:UNUSED_PAD src0_sel:DWORD src1_sel:WORD_1
    v_lshlrev_b32_sdwa v8, 2, v121 dst_sel:DWORD dst_unused:UNUSED_PAD src0_sel:DWORD src1_sel:WORD_0
    v_lshlrev_b32_sdwa v9, 2, v121 dst_sel:DWORD dst_unused:UNUSED_PAD src0_sel:DWORD src1_sel:WORD_1
    ds_write_b32 v6, v64
    ds_write_b32 v7, v65
    ds_write_b32 v8, v66
    ds_write_b32 v9, v68
    s_waitcnt vmcnt(10)
    v_lshlrev_b32 v10, 16, v104
    v_lshlrev_b32 v11, 16, v105
    v_and_b32 v104, 0xffff0000, v104
    v_and_b32 v105, 0xffff0000, v105
    v_mul_f32 v10, s41, v10
    v_mul_f32 v104, s41, v104
    v_mul_f32 v11, s41, v11
    v_mul_f32 v105, s41, v105
    v_fract_f32 v10, v10
    v_fract_f32 v104, v104
    v_fract_f32 v11, v11
    v_fract_f32 v105, v105
    v_cos_f32 v10, v10
    v_cos_f32 v104, v104
    v_cos_f32 v11, v11
    v_cos_f32 v105, v105
    v_fmaak_f32 v10, v12, v10, 1262486016
    v_fmaak_f32 v104, v12, v104, 1262486016
    v_fmaak_f32 v11, v12, v11, 1262486016
    v_fmaak_f32 v105, v12, v105, 1262486016
    v_or3_b32 v5, v10, v104, v5
    v_or3_b32 v5, v11, v105, v5
    v_perm_b32 v104, v104, v10, s43
    v_perm_b32 v105, v105, v11, s43
    s_add_u32 s35, s33, 40960000
    buffer_load_dwordx4 v[20:23], v1, s[12:15], s35 offen nt
    v_lshlrev_b32_sdwa v6, 2, v122 dst_sel:DWORD dst_unused:UNUSED_PAD src0_sel:DWORD src1_sel:WORD_0
    v_lshlrev_b32_sdwa v7, 2, v122 dst_sel:DWORD dst_unused:UNUSED_PAD src0_sel:DWORD src1_sel:WORD_1
    v_lshlrev_b32_sdwa v8, 2, v123 dst_sel:DWORD dst_unused:UNUSED_PAD src0_sel:DWORD src1_sel:WORD_0
    v_lshlrev_b32_sdwa v9, 2, v123 dst_sel:DWORD dst_unused:UNUSED_PAD src0_sel:DWORD src1_sel:WORD_1
    ds_write_b32 v6, v69
    ds_write_b32 v7, v70
    ds_write_b32 v8, v127
    ds_write_b32 v9, v72
    s_waitcnt vmcnt(8)
    v_lshlrev_b32 v10, 16, v106
    v_lshlrev_b32 v11, 16, v107
    v_and_b32 v106, 0xffff0000, v106
    v_and_b32 v107, 0xffff0000, v107
    v_mul_f32 v10, s41, v10
    v_mul_f32 v106, s41, v106
    v_mul_f32 v11, s41, v11
    v_mul_f32 v107, s41, v107
    v_fract_f32 v10, v10
    v_fract_f32 v106, v106
    v_fract_f32 v11, v11
    v_fract_f32 v107, v107
    v_cos_f32 v10, v10
    v_cos_f32 v106, v106
    v_cos_f32 v11, v11
    v_cos_f32 v107, v107
    v_fmaak_f32 v10, v12, v10, 1262486016
    v_fmaak_f32 v106, v12, v106, 1262486016
    v_fmaak_f32 v11, v12, v11, 1262486016
    v_fmaak_f32 v107, v12, v107, 1262486016
    v_or3_b32 v5, v10, v106, v5
    v_or3_b32 v5, v11, v107, v5
    v_perm_b32 v106, v106, v10, s43
    v_perm_b32 v107, v107, v11, s43
    v_lshlrev_b32_sdwa v6, 2, v124 dst_sel:DWORD dst_unused:UNUSED_PAD src0_sel:DWORD src1_sel:WORD_0
    v_lshlrev_b32_sdwa v7, 2, v124 dst_sel:DWORD dst_unused:UNUSED_PAD src0_sel:DWORD src1_sel:WORD_1
    v_lshlrev_b32_sdwa v8, 2, v125 dst_sel:DWORD dst_unused:UNUSED_PAD src0_sel:DWORD src1_sel:WORD_0
    v_lshlrev_b32_sdwa v9, 2, v125 dst_sel:DWORD dst_unused:UNUSED_PAD src0_sel:DWORD src1_sel:WORD_1
    ds_write_b32 v6, v73
    ds_write_b32 v7, v74
    ds_write_b32 v8, v76
    ds_write_b32 v9, v77
    v_lshlrev_b32_sdwa v6, 2, v126 dst_sel:DWORD dst_unused:UNUSED_PAD src0_sel:DWORD src1_sel:WORD_0
    v_lshlrev_b32_sdwa v7, 2, v126 dst_sel:DWORD dst_unused:UNUSED_PAD src0_sel:DWORD src1_sel:WORD_1
    v_lshlrev_b32_sdwa v8, 2, v75 dst_sel:DWORD dst_unused:UNUSED_PAD src0_sel:DWORD src1_sel:WORD_0
    v_lshlrev_b32_sdwa v9, 2, v75 dst_sel:DWORD dst_unused:UNUSED_PAD src0_sel:DWORD src1_sel:WORD_1
    ds_write_b32 v6, v78
    ds_write_b32 v7, v80
    ds_write_b32 v8, v81
    ds_write_b32 v9, v82
    s_waitcnt vmcnt(7)
    v_lshlrev_b32 v10, 16, v108
    v_lshlrev_b32 v11, 16, v109
    v_and_b32 v108, 0xffff0000, v108
    v_and_b32 v109, 0xffff0000, v109
    v_mul_f32 v10, s41, v10
    v_mul_f32 v108, s41, v108
    v_mul_f32 v11, s41, v11
    v_mul_f32 v109, s41, v109
    v_fract_f32 v10, v10
    v_fract_f32 v108, v108
    v_fract_f32 v11, v11
    v_fract_f32 v109, v109
    v_cos_f32 v10, v10
    v_cos_f32 v108, v108
    v_cos_f32 v11, v11
    v_cos_f32 v109, v109
    v_fmaak_f32 v10, v12, v10, 1262486016
    v_fmaak_f32 v108, v12, v108, 1262486016
    v_fmaak_f32 v11, v12, v11, 1262486016
    v_fmaak_f32 v109, v12, v109, 1262486016
    v_or3_b32 v5, v10, v108, v5
    v_or3_b32 v5, v11, v109, v5
    v_perm_b32 v108, v108, v10, s43
    v_perm_b32 v109, v109, v11, s43
    s_add_u32 s35, s33, 45154304
    buffer_load_dwordx4 v[24:27], v1, s[8:11], s35 offen nt
    v_lshlrev_b32_sdwa v6, 2, v79 dst_sel:DWORD dst_unused:UNUSED_PAD src0_sel:DWORD src1_sel:WORD_0
    v_lshlrev_b32_sdwa v7, 2, v79 dst_sel:DWORD dst_unused:UNUSED_PAD src0_sel:DWORD src1_sel:WORD_1
    v_lshlrev_b32_sdwa v8, 2, v83 dst_sel:DWORD dst_unused:UNUSED_PAD src0_sel:DWORD src1_sel:WORD_0
    v_lshlrev_b32_sdwa v9, 2, v83 dst_sel:DWORD dst_unused:UNUSED_PAD src0_sel:DWORD src1_sel:WORD_1
    ds_write_b32 v6, v84
    ds_write_b32 v7, v85
    ds_write_b32 v8, v86
    ds_write_b32 v9, v88
    s_waitcnt vmcnt(7)
    v_lshlrev_b32 v10, 16, v110
    v_lshlrev_b32 v11, 16, v111
    v_and_b32 v110, 0xffff0000, v110
    v_and_b32 v111, 0xffff0000, v111
    v_mul_f32 v10, s41, v10
    v_mul_f32 v110, s41, v110
    v_mul_f32 v11, s41, v11
    v_mul_f32 v111, s41, v111
    v_fract_f32 v10, v10
    v_fract_f32 v110, v110
    v_fract_f32 v11, v11
    v_fract_f32 v111, v111
    v_cos_f32 v10, v10
    v_cos_f32 v110, v110
    v_cos_f32 v11, v11
    v_cos_f32 v111, v111
    v_fmaak_f32 v10, v12, v10, 1262486016
    v_fmaak_f32 v110, v12, v110, 1262486016
    v_fmaak_f32 v11, v12, v11, 1262486016
    v_fmaak_f32 v111, v12, v111, 1262486016
    v_or3_b32 v5, v10, v110, v5
    v_or3_b32 v5, v11, v111, v5
    v_perm_b32 v110, v110, v10, s43
    v_perm_b32 v111, v111, v11, s43
    v_lshlrev_b32_sdwa v6, 2, v87 dst_sel:DWORD dst_unused:UNUSED_PAD src0_sel:DWORD src1_sel:WORD_0
    v_lshlrev_b32_sdwa v7, 2, v87 dst_sel:DWORD dst_unused:UNUSED_PAD src0_sel:DWORD src1_sel:WORD_1
    v_lshlrev_b32_sdwa v8, 2, v91 dst_sel:DWORD dst_unused:UNUSED_PAD src0_sel:DWORD src1_sel:WORD_0
    v_lshlrev_b32_sdwa v9, 2, v91 dst_sel:DWORD dst_unused:UNUSED_PAD src0_sel:DWORD src1_sel:WORD_1
    ds_write_b32 v6, v89
    ds_write_b32 v7, v90
    ds_write_b32 v8, v92
    ds_write_b32 v9, v93
    s_mov_b64 exec, s[44:45]
    v_lshlrev_b32_sdwa v6, 2, v95 dst_sel:DWORD dst_unused:UNUSED_PAD src0_sel:DWORD src1_sel:WORD_0
    v_lshlrev_b32_sdwa v7, 2, v95 dst_sel:DWORD dst_unused:UNUSED_PAD src0_sel:DWORD src1_sel:WORD_1
    v_lshlrev_b32_sdwa v8, 2, v99 dst_sel:DWORD dst_unused:UNUSED_PAD src0_sel:DWORD src1_sel:WORD_0
    v_lshlrev_b32_sdwa v9, 2, v99 dst_sel:DWORD dst_unused:UNUSED_PAD src0_sel:DWORD src1_sel:WORD_1
    ds_write_b32 v6, v94
    ds_write_b32 v7, v96
    ds_write_b32 v8, v97
    ds_write_b32 v9, v98
    s_mov_b64 exec, -1
    s_waitcnt vmcnt(6)
    v_lshlrev_b32 v10, 16, v112
    v_lshlrev_b32 v11, 16, v113
    v_and_b32 v112, 0xffff0000, v112
    v_and_b32 v113, 0xffff0000, v113
    v_mul_f32 v10, s41, v10
    v_mul_f32 v112, s41, v112
    v_mul_f32 v11, s41, v11
    v_mul_f32 v113, s41, v113
    v_fract_f32 v10, v10
    v_fract_f32 v112, v112
    v_fract_f32 v11, v11
    v_fract_f32 v113, v113
    v_cos_f32 v10, v10
    v_cos_f32 v112, v112
    v_cos_f32 v11, v11
    v_cos_f32 v113, v113
    v_fmaak_f32 v10, v12, v10, 1262486016
    v_fmaak_f32 v112, v12, v112, 1262486016
    v_fmaak_f32 v11, v12, v11, 1262486016
    v_fmaak_f32 v113, v12, v113, 1262486016
    v_or3_b32 v5, v10, v112, v5
    v_or3_b32 v5, v11, v113, v5
    v_perm_b32 v112, v112, v10, s43
    v_perm_b32 v113, v113, v11, s43
    s_mov_b64 exec, s[44:45]
    s_mov_b64 exec, -1
    s_add_u32 s35, s33, 45154304
    buffer_load_dwordx4 v[28:31], v1, s[12:15], s35 offen nt
    v_lshrrev_b32 v6, 2, v3
    v_sub_u32 v6, v3, v6
    s_waitcnt lgkmcnt(0)
    s_barrier
    s_cmp_lg_u32 s39, 15
    s_cbranch_scc1 L_p1_kernel_nox_3
    ds_read_b32 v12, v6 offset:9984
    ds_read_b32 v13, v6 offset:9988
    ds_read_b32 v14, v6 offset:9992
L_p1_kernel_nox_3:
    ds_read_b32 v48, v6 offset:0
    ds_read_b32 v49, v6 offset:4
    ds_read_b32 v50, v6 offset:8
    ds_read_b32 v52, v6 offset:768
    ds_read_b32 v53, v6 offset:772
    ds_read_b32 v54, v6 offset:776
    ds_read_b32 v56, v6 offset:1536
    ds_read_b32 v57, v6 offset:1540
    ds_read_b32 v58, v6 offset:1544
    ds_read_b32 v60, v6 offset:2304
    ds_read_b32 v61, v6 offset:2308
    ds_read_b32 v62, v6 offset:2312
    ds_read_b32 v64, v6 offset:3072
    ds_read_b32 v65, v6 offset:3076
    ds_read_b32 v66, v6 offset:3080
    ds_read_b32 v68, v6 offset:3840
    ds_read_b32 v69, v6 offset:3844
    ds_read_b32 v70, v6 offset:3848
    ds_read_b32 v72, v6 offset:4608
    ds_read_b32 v73, v6 offset:4612
    ds_read_b32 v74, v6 offset:4616
    ds_read_b32 v76, v6 offset:5376
    ds_read_b32 v77, v6 offset:5380
    ds_read_b32 v78, v6 offset:5384
    ds_read_b32 v80, v6 offset:6144
    ds_read_b32 v81, v6 offset:6148
    ds_read_b32 v82, v6 offset:6152
    ds_read_b32 v84, v6 offset:6912
    ds_read_b32 v85, v6 offset:6916
    ds_read_b32 v86, v6 offset:6920
    ds_read_b32 v88, v6 offset:7680
    ds_read_b32 v89, v6 offset:7684
    ds_read_b32 v90, v6 offset:7688
    ds_read_b32 v92, v6 offset:8448
    ds_read_b32 v93, v6 offset:8452
    ds_read_b32 v94, v6 offset:8456
    ds_read_b32 v96, v6 offset:9216
    ds_read_b32 v97, v6 offset:9220
    ds_read_b32 v98, v6 offset:9224
    s_add_u32 s35, s33, 49348608
    buffer_load_dwordx4 v[32:35], v1, s[8:11], s35 offen nt
    v_mov_b32 v8, 0
    v_mov_b32 v9, 0
    v_mov_b32 v10, 0
    v_mov_b32 v11, 0
    v_mov_b32 v15, 16384
    s_waitcnt lgkmcnt(0)
    s_barrier
    ds_write_b128 v1, v[8:11] offset:0
    s_nop 1
    v_mad_u32_u16 v6, v51, s50, v15 op_sel:[0,0,0,0]
    v_mad_u32_u16 v7, v51, s50, v15 op_sel:[1,0,0,0]
    v_mad_u32_u16 v8, v55, s50, v15 op_sel:[0,0,0,0]
    v_mad_u32_u16 v9, v55, s50, v15 op_sel:[1,0,0,0]
    v_add_u32_sdwa v6, v6, v51 dst_sel:DWORD dst_unused:UNUSED_PAD src0_sel:WORD_1 src1_sel:WORD_0
    v_add_u32_sdwa v7, v7, v51 dst_sel:DWORD dst_unused:UNUSED_PAD src0_sel:WORD_1 src1_sel:WORD_1
    v_add_u32_sdwa v8, v8, v55 dst_sel:DWORD dst_unused:UNUSED_PAD src0_sel:WORD_1 src1_sel:WORD_0
    v_add_u32_sdwa v9, v9, v55 dst_sel:DWORD dst_unused:UNUSED_PAD src0_sel:WORD_1 src1_sel:WORD_1
    v_add_u32 v6, v6, v6
    v_add_u32 v7, v7, v7
    v_add_u32 v8, v8, v8
    v_add_u32 v9, v9, v9
    ds_write_b16 v6, v100 offset:16384
    ds_write_b16_d16_hi v7, v100 offset:16384
    ds_write_b16 v8, v101 offset:16384
    ds_write_b16_d16_hi v9, v101 offset:16384
    v_mov_b32 v6, 1140817920
    s_waitcnt vmcnt(7)
    v_lshlrev_b32 v10, 16, v114
    v_lshlrev_b32 v11, 16, v115
    v_and_b32 v114, 0xffff0000, v114
    v_and_b32 v115, 0xffff0000, v115
    v_mul_f32 v10, s41, v10
    v_mul_f32 v114, s41, v114
    v_mul_f32 v11, s41, v11
    v_mul_f32 v115, s41, v115
    v_fract_f32 v10, v10
    v_fract_f32 v114, v114
    v_fract_f32 v11, v11
    v_fract_f32 v115, v115
    v_cos_f32 v10, v10
    v_cos_f32 v114, v114
    v_cos_f32 v11, v11
    v_cos_f32 v115, v115
    v_fmaak_f32 v10, v6, v10, 1262486016
    v_fmaak_f32 v114, v6, v114, 1262486016
    v_fmaak_f32 v11, v6, v11, 1262486016
    v_fmaak_f32 v115, v6, v115, 1262486016
    v_or3_b32 v5, v10, v114, v5
    v_or3_b32 v5, v11, v115, v5
    v_perm_b32 v114, v114, v10, s43
    v_perm_b32 v115, v115, v11, s43
    v_mad_u32_u16 v6, v59, s50, v15 op_sel:[0,0,0,0]
    v_mad_u32_u16 v7, v59, s50, v15 op_sel:[1,0,0,0]
    v_mad_u32_u16 v8, v63, s50, v15 op_sel:[0,0,0,0]
    v_mad_u32_u16 v9, v63, s50, v15 op_sel:[1,0,0,0]
    v_add_u32_sdwa v6, v6, v59 dst_sel:DWORD dst_unused:UNUSED_PAD src0_sel:WORD_1 src1_sel:WORD_0
    v_add_u32_sdwa v7, v7, v59 dst_sel:DWORD dst_unused:UNUSED_PAD src0_sel:WORD_1 src1_sel:WORD_1
    v_add_u32_sdwa v8, v8, v63 dst_sel:DWORD dst_unused:UNUSED_PAD src0_sel:WORD_1 src1_sel:WORD_0
    v_add_u32_sdwa v9, v9, v63 dst_sel:DWORD dst_unused:UNUSED_PAD src0_sel:WORD_1 src1_sel:WORD_1
    v_add_u32 v6, v6, v6
    v_add_u32 v7, v7, v7
    v_add_u32 v8, v8, v8
    v_add_u32 v9, v9, v9
    ds_write_b16 v6, v102 offset:16384
    ds_write_b16_d16_hi v7, v102 offset:16384
    ds_write_b16 v8, v103 offset:16384
    ds_write_b16_d16_hi v9, v103 offset:16384
    v_mad_u32_u16 v6, v67, s50, v15 op_sel:[0,0,0,0]
    v_mad_u32_u16 v7, v67, s50, v15 op_sel:[1,0,0,0]
    v_mad_u32_u16 v8, v71, s50, v15 op_sel:[0,0,0,0]
    v_mad_u32_u16 v9, v71, s50, v15 op_sel:[1,0,0,0]
    v_add_u32_sdwa v6, v6, v67 dst_sel:DWORD dst_unused:UNUSED_PAD src0_sel:WORD_1 src1_sel:WORD_0
    v_add_u32_sdwa v7, v7, v67 dst_sel:DWORD dst_unused:UNUSED_PAD src0_sel:WORD_1 src1_sel:WORD_1
    v_add_u32_sdwa v8, v8, v71 dst_sel:DWORD dst_unused:UNUSED_PAD src0_sel:WORD_1 src1_sel:WORD_0
    v_add_u32_sdwa v9, v9, v71 dst_sel:DWORD dst_unused:UNUSED_PAD src0_sel:WORD_1 src1_sel:WORD_1
    v_add_u32 v6, v6, v6
    v_add_u32 v7, v7, v7
    v_add_u32 v8, v8, v8
    v_add_u32 v9, v9, v9
    ds_write_b16 v6, v104 offset:16384
    ds_write_b16_d16_hi v7, v104 offset:16384
    ds_write_b16 v8, v105 offset:16384
    ds_write_b16_d16_hi v9, v105 offset:16384
    s_add_u32 s35, s33, 49348608
    buffer_load_dwordx4 v[36:39], v1, s[12:15], s35 offen nt
    v_mad_u32_u16 v6, v120, s50, v15 op_sel:[0,0,0,0]
    v_mad_u32_u16 v7, v120, s50, v15 op_sel:[1,0,0,0]
    v_mad_u32_u16 v8, v121, s50, v15 op_sel:[0,0,0,0]
    v_mad_u32_u16 v9, v121, s50, v15 op_sel:[1,0,0,0]
    v_add_u32_sdwa v6, v6, v120 dst_sel:DWORD dst_unused:UNUSED_PAD src0_sel:WORD_1 src1_sel:WORD_0
    v_add_u32_sdwa v7, v7, v120 dst_sel:DWORD dst_unused:UNUSED_PAD src0_sel:WORD_1 src1_sel:WORD_1
    v_add_u32_sdwa v8, v8, v121 dst_sel:DWORD dst_unused:UNUSED_PAD src0_sel:WORD_1 src1_sel:WORD_0
    v_add_u32_sdwa v9, v9, v121 dst_sel:DWORD dst_unused:UNUSED_PAD src0_sel:WORD_1 src1_sel:WORD_1
    v_add_u32 v6, v6, v6
    v_add_u32 v7, v7, v7
    v_add_u32 v8, v8, v8
    v_add_u32 v9, v9, v9
    ds_write_b16 v6, v106 offset:16384
    ds_write_b16_d16_hi v7, v106 offset:16384
    ds_write_b16 v8, v107 offset:16384
    ds_write_b16_d16_hi v9, v107 offset:16384
    v_mov_b32 v6, 1140817920
    s_waitcnt vmcnt(7)
    v_lshlrev_b32 v10, 16, v116
    v_lshlrev_b32 v11, 16, v117
    v_and_b32 v116, 0xffff0000, v116
    v_and_b32 v117, 0xffff0000, v117
    v_mul_f32 v10, s41, v10
    v_mul_f32 v116, s41, v116
    v_mul_f32 v11, s41, v11
    v_mul_f32 v117, s41, v117
    v_fract_f32 v10, v10
    v_fract_f32 v116, v116
    v_fract_f32 v11, v11
    v_fract_f32 v117, v117
    v_cos_f32 v10, v10
    v_cos_f32 v116, v116
    v_cos_f32 v11, v11
    v_cos_f32 v117, v117
    v_fmaak_f32 v10, v6, v10, 1262486016
    v_fmaak_f32 v116, v6, v116, 1262486016
    v_fmaak_f32 v11, v6, v11, 1262486016
    v_fmaak_f32 v117, v6, v117, 1262486016
    v_or3_b32 v5, v10, v116, v5
    v_or3_b32 v5, v11, v117, v5
    v_perm_b32 v116, v116, v10, s43
    v_perm_b32 v117, v117, v11, s43
    v_mad_u32_u16 v6, v122, s50, v15 op_sel:[0,0,0,0]
    v_mad_u32_u16 v7, v122, s50, v15 op_sel:[1,0,0,0]
    v_mad_u32_u16 v8, v123, s50, v15 op_sel:[0,0,0,0]
    v_mad_u32_u16 v9, v123, s50, v15 op_sel:[1,0,0,0]
    v_add_u32_sdwa v6, v6, v122 dst_sel:DWORD dst_unused:UNUSED_PAD src0_sel:WORD_1 src1_sel:WORD_0
    v_add_u32_sdwa v7, v7, v122 dst_sel:DWORD dst_unused:UNUSED_PAD src0_sel:WORD_1 src1_sel:WORD_1
    v_add_u32_sdwa v8, v8, v123 dst_sel:DWORD dst_unused:UNUSED_PAD src0_sel:WORD_1 src1_sel:WORD_0
    v_add_u32_sdwa v9, v9, v123 dst_sel:DWORD dst_unused:UNUSED_PAD src0_sel:WORD_1 src1_sel:WORD_1
    v_add_u32 v6, v6, v6
    v_add_u32 v7, v7, v7
    v_add_u32 v8, v8, v8
    v_add_u32 v9, v9, v9
    ds_write_b16 v6, v108 offset:16384
    ds_write_b16_d16_hi v7, v108 offset:16384
    ds_write_b16 v8, v109 offset:16384
    ds_write_b16_d16_hi v9, v109 offset:16384
    v_mad_u32_u16 v6, v124, s50, v15 op_sel:[0,0,0,0]
    v_mad_u32_u16 v7, v124, s50, v15 op_sel:[1,0,0,0]
    v_mad_u32_u16 v8, v125, s50, v15 op_sel:[0,0,0,0]
    v_mad_u32_u16 v9, v125, s50, v15 op_sel:[1,0,0,0]
    v_add_u32_sdwa v6, v6, v124 dst_sel:DWORD dst_unused:UNUSED_PAD src0_sel:WORD_1 src1_sel:WORD_0
    v_add_u32_sdwa v7, v7, v124 dst_sel:DWORD dst_unused:UNUSED_PAD src0_sel:WORD_1 src1_sel:WORD_1
    v_add_u32_sdwa v8, v8, v125 dst_sel:DWORD dst_unused:UNUSED_PAD src0_sel:WORD_1 src1_sel:WORD_0
    v_add_u32_sdwa v9, v9, v125 dst_sel:DWORD dst_unused:UNUSED_PAD src0_sel:WORD_1 src1_sel:WORD_1
    v_add_u32 v6, v6, v6
    v_add_u32 v7, v7, v7
    v_add_u32 v8, v8, v8
    v_add_u32 v9, v9, v9
    ds_write_b16 v6, v110 offset:16384
    ds_write_b16_d16_hi v7, v110 offset:16384
    ds_write_b16 v8, v111 offset:16384
    ds_write_b16_d16_hi v9, v111 offset:16384
    s_add_u32 s35, s33, 53542912
    buffer_load_dwordx4 v[40:43], v1, s[8:11], s35 offen nt
    v_mad_u32_u16 v6, v126, s50, v15 op_sel:[0,0,0,0]
    v_mad_u32_u16 v7, v126, s50, v15 op_sel:[1,0,0,0]
    v_mad_u32_u16 v8, v75, s50, v15 op_sel:[0,0,0,0]
    v_mad_u32_u16 v9, v75, s50, v15 op_sel:[1,0,0,0]
    v_add_u32_sdwa v6, v6, v126 dst_sel:DWORD dst_unused:UNUSED_PAD src0_sel:WORD_1 src1_sel:WORD_0
    v_add_u32_sdwa v7, v7, v126 dst_sel:DWORD dst_unused:UNUSED_PAD src0_sel:WORD_1 src1_sel:WORD_1
    v_add_u32_sdwa v8, v8, v75 dst_sel:DWORD dst_unused:UNUSED_PAD src0_sel:WORD_1 src1_sel:WORD_0
    v_add_u32_sdwa v9, v9, v75 dst_sel:DWORD dst_unused:UNUSED_PAD src0_sel:WORD_1 src1_sel:WORD_1
    v_add_u32 v6, v6, v6
    v_add_u32 v7, v7, v7
    v_add_u32 v8, v8, v8
    v_add_u32 v9, v9, v9
    ds_write_b16 v6, v112 offset:16384
    ds_write_b16_d16_hi v7, v112 offset:16384
    ds_write_b16 v8, v113 offset:16384
    ds_write_b16_d16_hi v9, v113 offset:16384
    v_mov_b32 v6, 1140817920
    s_mov_b64 exec, s[44:45]
    s_waitcnt vmcnt(7)
    v_lshlrev_b32 v10, 16, v118
    v_lshlrev_b32 v11, 16, v119
    v_and_b32 v118, 0xffff0000, v118
    v_and_b32 v119, 0xffff0000, v119
    v_mul_f32 v10, s41, v10
    v_mul_f32 v118, s41, v118
    v_mul_f32 v11, s41, v11
    v_mul_f32 v119, s41, v119
    v_fract_f32 v10, v10
    v_fract_f32 v118, v118
    v_fract_f32 v11, v11
    v_fract_f32 v119, v119
    v_cos_f32 v10, v10
    v_cos_f32 v118, v118
    v_cos_f32 v11, v11
    v_cos_f32 v119, v119
    v_fmaak_f32 v10, v6, v10, 1262486016
    v_fmaak_f32 v118, v6, v118, 1262486016
    v_fmaak_f32 v11, v6, v11, 1262486016
    v_fmaak_f32 v119, v6, v119, 1262486016
    v_or3_b32 v5, v10, v118, v5
    v_or3_b32 v5, v11, v119, v5
    v_perm_b32 v118, v118, v10, s43
    v_perm_b32 v119, v119, v11, s43
    s_mov_b64 exec, -1
    v_mad_u32_u16 v6, v79, s50, v15 op_sel:[0,0,0,0]
    v_mad_u32_u16 v7, v79, s50, v15 op_sel:[1,0,0,0]
    v_mad_u32_u16 v8, v83, s50, v15 op_sel:[0,0,0,0]
    v_mad_u32_u16 v9, v83, s50, v15 op_sel:[1,0,0,0]
    v_add_u32_sdwa v6, v6, v79 dst_sel:DWORD dst_unused:UNUSED_PAD src0_sel:WORD_1 src1_sel:WORD_0
    v_add_u32_sdwa v7, v7, v79 dst_sel:DWORD dst_unused:UNUSED_PAD src0_sel:WORD_1 src1_sel:WORD_1
    v_add_u32_sdwa v8, v8, v83 dst_sel:DWORD dst_unused:UNUSED_PAD src0_sel:WORD_1 src1_sel:WORD_0
    v_add_u32_sdwa v9, v9, v83 dst_sel:DWORD dst_unused:UNUSED_PAD src0_sel:WORD_1 src1_sel:WORD_1
    v_add_u32 v6, v6, v6
    v_add_u32 v7, v7, v7
    v_add_u32 v8, v8, v8
    v_add_u32 v9, v9, v9
    ds_write_b16 v6, v114 offset:16384
    ds_write_b16_d16_hi v7, v114 offset:16384
    ds_write_b16 v8, v115 offset:16384
    ds_write_b16_d16_hi v9, v115 offset:16384
    v_mad_u32_u16 v6, v87, s50, v15 op_sel:[0,0,0,0]
    v_mad_u32_u16 v7, v87, s50, v15 op_sel:[1,0,0,0]
    v_mad_u32_u16 v8, v91, s50, v15 op_sel:[0,0,0,0]
    v_mad_u32_u16 v9, v91, s50, v15 op_sel:[1,0,0,0]
    v_add_u32_sdwa v6, v6, v87 dst_sel:DWORD dst_unused:UNUSED_PAD src0_sel:WORD_1 src1_sel:WORD_0
    v_add_u32_sdwa v7, v7, v87 dst_sel:DWORD dst_unused:UNUSED_PAD src0_sel:WORD_1 src1_sel:WORD_1
    v_add_u32_sdwa v8, v8, v91 dst_sel:DWORD dst_unused:UNUSED_PAD src0_sel:WORD_1 src1_sel:WORD_0
    v_add_u32_sdwa v9, v9, v91 dst_sel:DWORD dst_unused:UNUSED_PAD src0_sel:WORD_1 src1_sel:WORD_1
    v_add_u32 v6, v6, v6
    v_add_u32 v7, v7, v7
    v_add_u32 v8, v8, v8
    v_add_u32 v9, v9, v9
    ds_write_b16 v6, v116 offset:16384
    ds_write_b16_d16_hi v7, v116 offset:16384
    ds_write_b16 v8, v117 offset:16384
    ds_write_b16_d16_hi v9, v117 offset:16384
    s_add_u32 s35, s33, 53542912
    buffer_load_dwordx4 v[44:47], v1, s[12:15], s35 offen nt
    s_mov_b64 exec, s[44:45]
    v_mad_u32_u16 v6, v95, s50, v15 op_sel:[0,0,0,0]
    v_mad_u32_u16 v7, v95, s50, v15 op_sel:[1,0,0,0]
    v_mad_u32_u16 v8, v99, s50, v15 op_sel:[0,0,0,0]
    v_mad_u32_u16 v9, v99, s50, v15 op_sel:[1,0,0,0]
    v_add_u32_sdwa v6, v6, v95 dst_sel:DWORD dst_unused:UNUSED_PAD src0_sel:WORD_1 src1_sel:WORD_0
    v_add_u32_sdwa v7, v7, v95 dst_sel:DWORD dst_unused:UNUSED_PAD src0_sel:WORD_1 src1_sel:WORD_1
    v_add_u32_sdwa v8, v8, v99 dst_sel:DWORD dst_unused:UNUSED_PAD src0_sel:WORD_1 src1_sel:WORD_0
    v_add_u32_sdwa v9, v9, v99 dst_sel:DWORD dst_unused:UNUSED_PAD src0_sel:WORD_1 src1_sel:WORD_1
    v_add_u32 v6, v6, v6
    v_add_u32 v7, v7, v7
    v_add_u32 v8, v8, v8
    v_add_u32 v9, v9, v9
    ds_write_b16 v6, v118 offset:16384
    ds_write_b16_d16_hi v7, v118 offset:16384
    ds_write_b16 v8, v119 offset:16384
    ds_write_b16_d16_hi v9, v119 offset:16384
    s_mov_b64 exec, -1
    v_lshrrev_b32 v6, 1, v3
    s_waitcnt lgkmcnt(0)
    s_barrier
    ds_read_b64 v[100:101], v6 offset:23040
    ds_read_b64 v[102:103], v6 offset:19456
    ds_read_b64 v[104:105], v6 offset:19968
    ds_read_b64 v[106:107], v6 offset:16384
    ds_read_b64 v[108:109], v6 offset:20480
    ds_read_b64 v[110:111], v6 offset:16896
    ds_read_b64 v[112:113], v6 offset:20992
    ds_read_b64 v[114:115], v6 offset:17408
    ds_read_b64 v[116:117], v6 offset:21504
    ds_read_b64 v[118:119], v6 offset:17920
    ds_read_b64 v[120:121], v6 offset:22016
    ds_read_b64 v[122:123], v6 offset:18432
    ds_read_b64 v[124:125], v6 offset:22528
    ds_read_b64 v[126:127], v6 offset:18944
    s_add_u32 s32, s32, 256
    s_add_u32 s33, s33, 40960000
    s_add_u32 s34, s34, 20480000
    s_add_u32 s40, s40, 1
    s_cmp_lt_u32 s40, 4
    s_cbranch_scc1 L_p1_loop
    s_waitcnt lgkmcnt(13)
    v_lshlrev_b32 v15, 22, v100
    v_lshrrev_b32 v100, 16, v100
    v_alignbit_b32 v15, v100, v15, 10
    v_alignbit_b32 v15, v101, v15, 10
    v_xor_b32 v15, 0x80200800, v15
    s_cmp_lg_u32 s39, 15
    s_cbranch_scc1 L_p1_kernel_nox_4
    s_mov_b32 s36, 13312
    buffer_store_dwordx4 v[12:15], v3, s[20:23], s36 offen sc1
L_p1_kernel_nox_4:
    s_waitcnt lgkmcnt(12)
    v_lshlrev_b32 v75, 22, v102
    v_lshrrev_b32 v102, 16, v102
    v_alignbit_b32 v75, v102, v75, 10
    v_alignbit_b32 v75, v103, v75, 10
    v_xor_b32 v75, 0x80200800, v75
    s_mov_b32 s36, 6144
    buffer_store_dwordx4 v[72:75], v3, s[20:23], s36 offen sc1
    s_waitcnt lgkmcnt(11)
    v_lshlrev_b32 v79, 22, v104
    v_lshrrev_b32 v104, 16, v104
    v_alignbit_b32 v79, v104, v79, 10
    v_alignbit_b32 v79, v105, v79, 10
    v_xor_b32 v79, 0x80200800, v79
    s_mov_b32 s36, 7168
    buffer_store_dwordx4 v[76:79], v3, s[20:23], s36 offen sc1
    s_waitcnt lgkmcnt(10)
    v_lshlrev_b32 v51, 22, v106
    v_lshrrev_b32 v106, 16, v106
    v_alignbit_b32 v51, v106, v51, 10
    v_alignbit_b32 v51, v107, v51, 10
    v_xor_b32 v51, 0x80200800, v51
    s_mov_b32 s36, 0
    buffer_store_dwordx4 v[48:51], v3, s[20:23], s36 offen sc1
    s_waitcnt lgkmcnt(9)
    v_lshlrev_b32 v83, 22, v108
    v_lshrrev_b32 v108, 16, v108
    v_alignbit_b32 v83, v108, v83, 10
    v_alignbit_b32 v83, v109, v83, 10
    v_xor_b32 v83, 0x80200800, v83
    s_mov_b32 s36, 8192
    buffer_store_dwordx4 v[80:83], v3, s[20:23], s36 offen sc1
    s_waitcnt lgkmcnt(8)
    v_lshlrev_b32 v55, 22, v110
    v_lshrrev_b32 v110, 16, v110
    v_alignbit_b32 v55, v110, v55, 10
    v_alignbit_b32 v55, v111, v55, 10
    v_xor_b32 v55, 0x80200800, v55
    s_mov_b32 s36, 1024
    buffer_store_dwordx4 v[52:55], v3, s[20:23], s36 offen sc1
    s_waitcnt lgkmcnt(7)
    v_lshlrev_b32 v87, 22, v112
    v_lshrrev_b32 v112, 16, v112
    v_alignbit_b32 v87, v112, v87, 10
    v_alignbit_b32 v87, v113, v87, 10
    v_xor_b32 v87, 0x80200800, v87
    s_mov_b32 s36, 9216
    buffer_store_dwordx4 v[84:87], v3, s[20:23], s36 offen sc1
    s_waitcnt lgkmcnt(6)
    v_lshlrev_b32 v59, 22, v114
    v_lshrrev_b32 v114, 16, v114
    v_alignbit_b32 v59, v114, v59, 10
    v_alignbit_b32 v59, v115, v59, 10
    v_xor_b32 v59, 0x80200800, v59
    s_mov_b32 s36, 2048
    buffer_store_dwordx4 v[56:59], v3, s[20:23], s36 offen sc1
    s_waitcnt lgkmcnt(5)
    v_lshlrev_b32 v91, 22, v116
    v_lshrrev_b32 v116, 16, v116
    v_alignbit_b32 v91, v116, v91, 10
    v_alignbit_b32 v91, v117, v91, 10
    v_xor_b32 v91, 0x80200800, v91
    s_mov_b32 s36, 10240
    buffer_store_dwordx4 v[88:91], v3, s[20:23], s36 offen sc1
    s_waitcnt lgkmcnt(4)
    v_lshlrev_b32 v63, 22, v118
    v_lshrrev_b32 v118, 16, v118
    v_alignbit_b32 v63, v118, v63, 10
    v_alignbit_b32 v63, v119, v63, 10
    v_xor_b32 v63, 0x80200800, v63
    s_mov_b32 s36, 3072
    buffer_store_dwordx4 v[60:63], v3, s[20:23], s36 offen sc1
    s_waitcnt lgkmcnt(3)
    v_lshlrev_b32 v95, 22, v120
    v_lshrrev_b32 v120, 16, v120
    v_alignbit_b32 v95, v120, v95, 10
    v_alignbit_b32 v95, v121, v95, 10
    v_xor_b32 v95, 0x80200800, v95
    s_mov_b32 s36, 11264
    buffer_store_dwordx4 v[92:95], v3, s[20:23], s36 offen sc1
    s_waitcnt lgkmcnt(2)
    v_lshlrev_b32 v67, 22, v122
    v_lshrrev_b32 v122, 16, v122
    v_alignbit_b32 v67, v122, v67, 10
    v_alignbit_b32 v67, v123, v67, 10
    v_xor_b32 v67, 0x80200800, v67
    s_mov_b32 s36, 4096
    buffer_store_dwordx4 v[64:67], v3, s[20:23], s36 offen sc1
    s_waitcnt lgkmcnt(1)
    v_lshlrev_b32 v99, 22, v124
    v_lshrrev_b32 v124, 16, v124
    v_alignbit_b32 v99, v124, v99, 10
    v_alignbit_b32 v99, v125, v99, 10
    v_xor_b32 v99, 0x80200800, v99
    s_mov_b32 s36, 12288
    buffer_store_dwordx4 v[96:99], v3, s[20:23], s36 offen sc1
    s_waitcnt lgkmcnt(0)
    v_lshlrev_b32 v71, 22, v126
    v_lshrrev_b32 v126, 16, v126
    v_alignbit_b32 v71, v126, v71, 10
    v_alignbit_b32 v71, v127, v71, 10
    v_xor_b32 v71, 0x80200800, v71
    s_mov_b32 s36, 5120
    buffer_store_dwordx4 v[68:71], v3, s[20:23], s36 offen sc1
    v_and_b32 v6, 0x34800000, v5
    v_cmp_ne_u32 vcc, 0, v6
    s_lshl_b32 s35, s39, 4
    s_add_u32 s35, s35, 160328
    v_mov_b32 v10, s35
    s_cmp_lg_u64 vcc, 0
    s_cselect_b32 s36, 1, s55
    v_mov_b32 v11, s36
    ds_write_b32 v10, v11
    s_waitcnt lgkmcnt(0)
    s_barrier
    s_cmp_lg_u32 s39, 0
    s_cbranch_scc1 L_p1_end
    v_and_b32 v6, 15, v0
    v_lshlrev_b32 v6, 4, v6
    v_add_u32 v6, 160320, v6
    ds_read_b128 v[8:11], v6
    s_waitcnt lgkmcnt(0)
    s_nop 1
    v_max_u32_dpp v8, v8, v8 row_shr:1 row_mask:0xf bank_mask:0xf bound_ctrl:0
    s_nop 1
    v_max_u32_dpp v8, v8, v8 row_shr:2 row_mask:0xf bank_mask:0xf bound_ctrl:0
    s_nop 1
    v_max_u32_dpp v8, v8, v8 row_shr:4 row_mask:0xf bank_mask:0xf bound_ctrl:0
    s_nop 1
    v_max_u32_dpp v8, v8, v8 row_shr:8 row_mask:0xf bank_mask:0xf bound_ctrl:0
    s_nop 1
    v_add_f32_dpp v9, v9, v9 row_shr:1 row_mask:0xf bank_mask:0xf bound_ctrl:0
    s_nop 1
    v_add_f32_dpp v9, v9, v9 row_shr:2 row_mask:0xf bank_mask:0xf bound_ctrl:0
    s_nop 1
    v_add_f32_dpp v9, v9, v9 row_shr:4 row_mask:0xf bank_mask:0xf bound_ctrl:0
    s_nop 1
    v_add_f32_dpp v9, v9, v9 row_shr:8 row_mask:0xf bank_mask:0xf bound_ctrl:0
    s_nop 1
    v_or_b32_dpp v10, v10, v10 row_shr:1 row_mask:0xf bank_mask:0xf bound_ctrl:0
    s_nop 1
    v_or_b32_dpp v10, v10, v10 row_shr:2 row_mask:0xf bank_mask:0xf bound_ctrl:0
    s_nop 1
    v_or_b32_dpp v10, v10, v10 row_shr:4 row_mask:0xf bank_mask:0xf bound_ctrl:0
    s_nop 1
    v_or_b32_dpp v10, v10, v10 row_shr:8 row_mask:0xf bank_mask:0xf bound_ctrl:0
    s_lshl_b32 s35, s2, 3
    s_add_u32 s35, s35, 8552960
    v_mov_b32 v6, 0
    v_lshl_or_b32 v8, v10, 16, v8
    s_mov_b64 exec, 0x8000
    buffer_store_dwordx2 v[8:9], v6, s[24:27], s35 offen
    s_lshl_b32 s35, s2, 8
    s_add_u32 s35, s35, 8561152
    buffer_store_dword v6, v6, s[24:27], s35 offen
L_p1_end:
    s_endpgm
.globl p2_kernel
.p2align 8
.type p2_kernel,@function
p2_kernel:
    s_cmp_ge_u32 s2, 256
    s_cbranch_scc1 L_p2_end
    s_load_dwordx2 s[4:5], s[0:1], 104
    s_load_dwordx2 s[100:101], s[0:1], 24
    s_load_dwordx2 s[30:31], s[0:1], 40
    s_load_dwordx4 s[32:35], s[0:1], 56
    s_load_dwordx4 s[36:39], s[0:1], 72
    s_and_b32 s14, s2, 7
    s_lshr_b32 s49, s2, 3
    s_and_b32 s3, s14, 1
    s_lshl_b32 s3, s3, 5
    s_add_u32 s3, s3, s49
    s_lshr_b32 s12, s14, 1
    v_lshrrev_b32 v108, 6, v0
    v_lshlrev_b32 v1, 4, v0
    v_and_b32 v109, 63, v0
    v_readfirstlane_b32 s13, v108
    v_lshlrev_b32 v111, 4, v109
    s_mul_i32 s14, s12, 65
    s_add_u32 s14, s14, s3
    s_mul_i32 s14, s14, 32896
    s_add_u32 s25, s14, 219029504
    s_mul_i32 s22, s12, 1280000
    s_mov_b32 s2, 0
    s_waitcnt lgkmcnt(0)
    s_mov_b32 s6, 655360000
    s_mov_b32 s7, 0x00020000
    s_add_u32 s8, s4, 227607040
    s_addc_u32 s9, s5, 0
    s_add_u32 s10, s22, 1280000
    s_mov_b32 s11, 0x00020000
    s_add_u32 s15, s25, 0
    buffer_load_dwordx4 v[28:31], v1, s[4:7], s15 offen
    s_add_u32 s15, s25, 32896
    buffer_load_dwordx4 v[36:39], v1, s[4:7], s15 offen
    s_load_dwordx4 s[40:43], s[30:31], 0
    s_load_dwordx16 s[52:67], s[32:33], 0
    s_load_dwordx16 s[68:83], s[34:35], 0
    s_load_dwordx8 s[84:91], s[36:37], 0
    s_load_dwordx8 s[92:99], s[38:39], 0
    v_mov_b32 v52, 0x100
    s_cmp_lg_u32 s13, 0
    s_cbranch_scc1 L_p2_noann
    s_lshl_b32 s14, s3, 8
    s_add_u32 s14, s14, 227590656
    s_mov_b64 exec, 1
    buffer_atomic_add v52, off, s[4:7], s14
    s_mov_b64 exec, -1
L_p2_noann:
    s_add_u32 s14, s22, 0
    buffer_load_dwordx4 v[88:91], v1, s[8:11], s14 offen
    s_add_u32 s14, s22, 16384
    buffer_load_dwordx4 v[92:95], v1, s[8:11], s14 offen
    s_add_u32 s14, s22, 32768
    buffer_load_dwordx4 v[96:99], v1, s[8:11], s14 offen
    s_add_u32 s14, s22, 49152
    buffer_load_dwordx4 v[100:103], v1, s[8:11], s14 offen
    s_add_u32 s14, s22, 65536
    buffer_load_dwordx4 v[104:107], v1, s[8:11], s14 offen
    s_mov_b32 s15, 227582464
    buffer_load_dwordx4 v[80:83], v111, s[4:7], s15 offen offset:0
    buffer_load_dwordx4 v[84:87], v111, s[4:7], s15 offen offset:1024
    s_add_u32 s15, s25, 16384
    buffer_load_dwordx4 v[32:35], v1, s[4:7], s15 offen
    s_add_u32 s15, s25, 49280
    buffer_load_dwordx4 v[40:43], v1, s[4:7], s15 offen
    v_add_u32 v2, 3072, v111
    v_mov_b32 v50, 21845
    v_add_u32 v3, 80000, v1
    v_add_u32 v124, 145536, v1
    v_add_u32 v113, 65536, v1
    v_mov_b32 v112, 0x7f000000
    v_cmp_gt_u32 vcc, 904, v0
    s_mul_i32 s19, s13, 240
    s_add_u32 s19, s19, 160000
    v_cndmask_b32 v124, v112, v124, vcc
    v_cndmask_b32 v113, v112, v113, vcc
    v_lshl_add_u32 v6, v109, 2, s19
    v_lshl_add_u32 v126, v109, 1, s19
    v_cmp_gt_u32 vcc, 10, v109
    s_mul_i32 s27, s13, 13688832
    s_mov_b32 s23, 213888
    v_cndmask_b32 v6, v112, v6, vcc
    s_mov_b32 s44, s4
    s_mov_b32 s45, s5
    s_add_u32 s46, s27, 13697024
    s_mov_b32 s47, 0x00020000
    s_mov_b32 s17, 0x05040100
    s_mov_b32 s18, 80000
    s_and_b32 s50, s3, 1
    s_lshl_b32 s50, s50, 18
    s_sub_u32 s50, 4294836224, s50
    s_mov_b32 s20, 3221209088
    s_mov_b32 s21, 3221209087
    v_mov_b32 v4, 0
    v_mov_b32 v5, 0
    v_mov_b32 v114, 320
    ds_write_b32 v6, v5 offset:160
    ds_write_b16 v126, v114 offset:2
    v_mov_b32 v44, 1073758208
    v_mov_b32 v45, 1073758208
    v_mov_b32 v46, 1073758208
    v_mov_b32 v47, 1073758208
    v_mov_b32 v48, 1073758208
    v_mov_b32 v49, 1073758208
    ds_write_b128 v1, v[44:47] offset:0
    ds_write_b128 v1, v[44:47] offset:16384
    ds_write_b128 v1, v[44:47] offset:32768
    ds_write_b128 v1, v[44:47] offset:49152
    ds_write_b128 v113, v[44:47]
    s_waitcnt lgkmcnt(0)
    v_mov_b32 v53, s40
    v_mov_b32 v54, s41
    v_mov_b32 v56, s42
    v_mov_b32 v57, s43
    s_mov_b32 s40, 20987904
    s_mov_b32 s41, 21031594
    s_pack_ll_b32_b16 s14, s52, s54
    s_pack_hh_b32_b16 s15, s52, s54
    s_pack_ll_b32_b16 s54, s53, s55
    s_pack_hh_b32_b16 s55, s53, s55
    s_mov_b32 s52, s14
    s_mov_b32 s53, s15
    s_pack_ll_b32_b16 s14, s56, s58
    s_pack_hh_b32_b16 s15, s56, s58
    s_pack_ll_b32_b16 s58, s57, s59
    s_pack_hh_b32_b16 s59, s57, s59
    s_mov_b32 s56, s14
    s_mov_b32 s57, s15
    s_pack_ll_b32_b16 s14, s60, s62
    s_pack_hh_b32_b16 s15, s60, s62
    s_pack_ll_b32_b16 s62, s61, s63
    s_pack_hh_b32_b16 s63, s61, s63
    s_mov_b32 s60, s14
    s_mov_b32 s61, s15
    s_pack_ll_b32_b16 s14, s64, s66
    s_pack_hh_b32_b16 s15, s64, s66
    s_pack_ll_b32_b16 s66, s65, s67
    s_pack_hh_b32_b16 s67, s65, s67
    s_mov_b32 s64, s14
    s_mov_b32 s65, s15
    s_pack_ll_b32_b16 s14, s68, s70
    s_pack_hh_b32_b16 s15, s68, s70
    s_pack_ll_b32_b16 s70, s69, s71
    s_pack_hh_b32_b16 s71, s69, s71
    s_mov_b32 s68, s14
    s_mov_b32 s69, s15
    s_pack_ll_b32_b16 s14, s72, s74
    s_pack_hh_b32_b16 s15, s72, s74
    s_pack_ll_b32_b16 s74, s73, s75
    s_pack_hh_b32_b16 s75, s73, s75
    s_mov_b32 s72, s14
    s_mov_b32 s73, s15
    s_pack_ll_b32_b16 s14, s76, s78
    s_pack_hh_b32_b16 s15, s76, s78
    s_pack_ll_b32_b16 s78, s77, s79
    s_pack_hh_b32_b16 s79, s77, s79
    s_mov_b32 s76, s14
    s_mov_b32 s77, s15
    s_pack_ll_b32_b16 s14, s80, s82
    s_pack_hh_b32_b16 s15, s80, s82
    s_pack_ll_b32_b16 s82, s81, s83
    s_pack_hh_b32_b16 s83, s81, s83
    s_mov_b32 s80, s14
    s_mov_b32 s81, s15
    s_waitcnt vmcnt(9)
    v_mad_u32_u16 v108, v28, v50, s40 op_sel:[0,0,0,0]
    v_mad_u32_u16 v109, v36, v50, s41 op_sel:[0,0,0,0]
    v_sub_u32_sdwa v110, v109, v108 dst_sel:DWORD dst_unused:UNUSED_PAD src0_sel:WORD_1 src1_sel:WORD_1
    s_nop 1
    v_add_u32_dpp v110, v110, v110 row_shr:1 row_mask:0xf bank_mask:0xf bound_ctrl:0
    s_nop 1
    v_add_u32_dpp v110, v110, v110 row_shr:2 row_mask:0xf bank_mask:0xf bound_ctrl:0
    s_nop 1
    v_add_u32_dpp v110, v110, v110 row_shr:4 row_mask:0xf bank_mask:0xf bound_ctrl:0
    s_nop 1
    v_add_u32_dpp v110, v110, v110 row_shr:8 row_mask:0xf bank_mask:0xf bound_ctrl:0
    s_nop 1
    v_add_u32_dpp v110, v110, v110 row_bcast:15 row_mask:0xa bank_mask:0xf
    s_nop 1
    v_add_u32_dpp v110, v110, v110 row_bcast:31 row_mask:0xc bank_mask:0xf
    v_sub_u32_sdwa v109, v109, v110 dst_sel:DWORD dst_unused:UNUSED_PAD src0_sel:WORD_1 src1_sel:DWORD
    v_readlane_b32 s29, v110, 63
    v_add_u32 v110, -1, v110
    ds_write_b16 v126, v109
    v_lshlrev_b32_e64 v111, v110, 1
    v_lshrrev_b32 v110, 5, v110
    v_lshl_add_u32 v110, v110, 2, s19
    s_cmp_gt_u32 s29, 320
    s_cselect_b32 s2, 1, s2
    s_cselect_b64 exec, 0, -1
    ds_or_b32 v110, v111 offset:160
    s_mov_b64 exec, -1
    ds_wrxchg_rtn_b32 v7, v6, v5 offset:160
    s_waitcnt lgkmcnt(0)
    v_readlane_b32 s30, v7, 0
    v_readlane_b32 s31, v7, 1
    v_readlane_b32 s32, v7, 2
    v_readlane_b32 s33, v7, 3
    v_readlane_b32 s34, v7, 4
    v_readlane_b32 s35, v7, 5
    v_readlane_b32 s36, v7, 6
    v_readlane_b32 s37, v7, 7
    s_mov_b32 s25, s19
    s_mov_b32 s26, s27
    s_mov_b32 s51, s28
    s_mov_b32 s28, s29
    v_mbcnt_lo_u32_b32 v8, s30, 0
    v_mbcnt_hi_u32_b32 v8, s31, v8
    s_bcnt1_i32_b64 s14, s[30:31]
    v_lshl_add_u32 v9, v8, 1, s25
    ds_read_u16 v9, v9
    v_mad_u32_u24 v8, v8, s23, v2
    s_mov_b32 s30, s26
    s_lshl1_add_u32 s25, s14, s25
    s_mul_i32 s14, s14, s23
    s_add_u32 s26, s26, s14
    v_mbcnt_lo_u32_b32 v12, s32, 0
    v_mbcnt_hi_u32_b32 v12, s33, v12
    s_bcnt1_i32_b64 s14, s[32:33]
    v_lshl_add_u32 v13, v12, 1, s25
    ds_read_u16 v13, v13
    v_mad_u32_u24 v12, v12, s23, v2
    s_mov_b32 s32, s26
    s_lshl1_add_u32 s25, s14, s25
    s_mul_i32 s14, s14, s23
    s_add_u32 s26, s26, s14
    v_mbcnt_lo_u32_b32 v16, s34, 0
    v_mbcnt_hi_u32_b32 v16, s35, v16
    s_bcnt1_i32_b64 s14, s[34:35]
    v_lshl_add_u32 v17, v16, 1, s25
    ds_read_u16 v17, v17
    v_mad_u32_u24 v16, v16, s23, v2
    s_mov_b32 s34, s26
    s_lshl1_add_u32 s25, s14, s25
    s_mul_i32 s14, s14, s23
    s_add_u32 s26, s26, s14
    v_mbcnt_lo_u32_b32 v20, s36, 0
    v_mbcnt_hi_u32_b32 v20, s37, v20
    s_bcnt1_i32_b64 s14, s[36:37]
    v_lshl_add_u32 v21, v20, 1, s25
    ds_read_u16 v21, v21
    v_mad_u32_u24 v20, v20, s23, v2
    s_mov_b32 s36, s26
    s_lshl1_add_u32 s25, s14, s25
    s_mul_i32 s14, s14, s23
    s_add_u32 s26, s26, s14
    s_waitcnt lgkmcnt(3)
    v_lshl_add_u32 v8, v9, 4, v8
    buffer_load_dwordx4 v[8:11], v8, s[44:47], s30 offen offset:0
    s_waitcnt lgkmcnt(2)
    v_lshl_add_u32 v12, v13, 4, v12
    buffer_load_dwordx4 v[12:15], v12, s[44:47], s32 offen offset:1024
    s_waitcnt lgkmcnt(1)
    v_lshl_add_u32 v16, v17, 4, v16
    buffer_load_dwordx4 v[16:19], v16, s[44:47], s34 offen offset:2048
    s_waitcnt lgkmcnt(0)
    v_lshl_add_u32 v20, v21, 4, v20
    buffer_load_dwordx4 v[20:23], v20, s[44:47], s36 offen offset:3072
    s_cmp_le_u32 s28, 256
    s_cbranch_scc1 L_p2_kernel_noopt_1
    v_readlane_b32 s38, v7, 8
    v_readlane_b32 s39, v7, 9
    s_nop 1
    v_mbcnt_lo_u32_b32 v118, s38, 0
    v_mbcnt_hi_u32_b32 v118, s39, v118
    s_bcnt1_i32_b64 s14, s[38:39]
    v_lshl_add_u32 v119, v118, 1, s25
    ds_read_u16 v119, v119
    v_mad_u32_u24 v118, v118, s23, v2
    s_mov_b32 s38, s26
    s_lshl1_add_u32 s25, s14, s25
    s_mul_i32 s14, s14, s23
    s_add_u32 s26, s26, s14
    s_waitcnt lgkmcnt(0)
    s_add_u32 s38, s38, 4096
    v_lshl_add_u32 v118, v119, 4, v118
    buffer_load_dwordx4 v[24:27], v118, s[44:47], s38 offen offset:0
L_p2_kernel_noopt_1:
    s_waitcnt vmcnt(8)
    ds_write_b128 v3, v[88:91] offset:0
    ds_write_b128 v3, v[92:95] offset:16384
    ds_write_b128 v3, v[96:99] offset:32768
    ds_write_b128 v3, v[100:103] offset:49152
    ds_write_b128 v124, v[104:107] offset:0
    s_waitcnt vmcnt(4)
    v_max3_u32 v64, v80, v82, v84
    v_add_f32 v65, v81, v83
    v_add_f32 v66, v85, v87
    v_max_u32 v64, v64, v86
    v_add_f32 v65, v65, v66
    v_cmp_lt_u32 vcc, 0xffff, v64
    s_nop 1
    v_max_u32_dpp v64, v64, v64 row_shr:1 row_mask:0xf bank_mask:0xf bound_ctrl:0
    s_nop 1
    v_max_u32_dpp v64, v64, v64 row_shr:2 row_mask:0xf bank_mask:0xf bound_ctrl:0
    s_nop 1
    v_max_u32_dpp v64, v64, v64 row_shr:4 row_mask:0xf bank_mask:0xf bound_ctrl:0
    s_nop 1
    v_max_u32_dpp v64, v64, v64 row_shr:8 row_mask:0xf bank_mask:0xf bound_ctrl:0
    s_nop 1
    v_max_u32_dpp v64, v64, v64 row_bcast:15 row_mask:0xa bank_mask:0xf
    s_nop 1
    v_max_u32_dpp v64, v64, v64 row_bcast:31 row_mask:0xc bank_mask:0xf
    s_nop 1
    v_add_f32_dpp v65, v65, v65 row_shr:1 row_mask:0xf bank_mask:0xf bound_ctrl:0
    s_nop 1
    v_add_f32_dpp v65, v65, v65 row_shr:2 row_mask:0xf bank_mask:0xf bound_ctrl:0
    s_nop 1
    v_add_f32_dpp v65, v65, v65 row_shr:4 row_mask:0xf bank_mask:0xf bound_ctrl:0
    s_nop 1
    v_add_f32_dpp v65, v65, v65 row_shr:8 row_mask:0xf bank_mask:0xf bound_ctrl:0
    s_nop 1
    v_add_f32_dpp v65, v65, v65 row_bcast:15 row_mask:0xa bank_mask:0xf
    s_nop 1
    v_add_f32_dpp v65, v65, v65 row_bcast:31 row_mask:0xc bank_mask:0xf
    s_cmp_lg_u64 vcc, 0
    s_cselect_b32 s2, 1, s2
    v_lshlrev_b32 v64, 16, v64
    v_mul_f32 v66, 936490775, v65
    v_mul_f32 v65, 928531664, v65
    v_cmp_nle_f32 vcc, v64, v66
    v_max_u32 v64, v64, v65
    s_nop 0
    v_readlane_b32 s14, v64, 63
    s_bitcmp1_b32 vcc_hi, 31
    s_cselect_b32 s2, 1, s2
    s_lshr_b32 s14, s14, 23
    s_add_u32 s14, s14, 1
    s_cmp_lt_u32 s14, 40
    s_cselect_b32 s2, 1, s2
    s_cmp_gt_u32 s14, 230
    s_cselect_b32 s2, 1, s2
    s_sub_u32 s48, s14, 14
    s_lshl_b32 s48, s48, 23
    s_add_u32 s16, s48, 272646144
    s_or_b32 s48, s48, 16416
    s_sub_u32 s14, s14, 40
    s_cmp_gt_u32 s14, 190
    s_cselect_b32 s48, 0, s48
    s_waitcnt lgkmcnt(0)
    s_barrier
    s_add_u32 s14, s22, 80000
    buffer_load_dwordx4 v[88:91], v1, s[8:11], s14 offen
    s_add_u32 s14, s22, 96384
    buffer_load_dwordx4 v[92:95], v1, s[8:11], s14 offen
    v_mad_u32_u16 v108, v28, v50, s40 op_sel:[1,0,0,0]
    v_mad_u32_u16 v109, v36, v50, s41 op_sel:[1,0,0,0]
    v_sub_u32_sdwa v110, v109, v108 dst_sel:DWORD dst_unused:UNUSED_PAD src0_sel:WORD_1 src1_sel:WORD_1
    s_nop 1
    v_add_u32_dpp v110, v110, v110 row_shr:1 row_mask:0xf bank_mask:0xf bound_ctrl:0
    s_nop 1
    v_add_u32_dpp v110, v110, v110 row_shr:2 row_mask:0xf bank_mask:0xf bound_ctrl:0
    s_nop 1
    v_add_u32_dpp v110, v110, v110 row_shr:4 row_mask:0xf bank_mask:0xf bound_ctrl:0
    s_nop 1
    v_add_u32_dpp v110, v110, v110 row_shr:8 row_mask:0xf bank_mask:0xf bound_ctrl:0
    s_nop 1
    v_add_u32_dpp v110, v110, v110 row_bcast:15 row_mask:0xa bank_mask:0xf
    s_nop 1
    v_add_u32_dpp v110, v110, v110 row_bcast:31 row_mask:0xc bank_mask:0xf
    v_sub_u32_sdwa v109, v109, v110 dst_sel:DWORD dst_unused:UNUSED_PAD src0_sel:WORD_1 src1_sel:DWORD
    v_readlane_b32 s29, v110, 63
    v_add_u32 v110, -1, v110
    ds_write_b16 v126, v109
    v_lshlrev_b32_e64 v111, v110, 1
    v_lshrrev_b32 v110, 5, v110
    v_lshl_add_u32 v110, v110, 2, s19
    s_cmp_gt_u32 s29, 320
    s_cselect_b32 s2, 1, s2
    s_cselect_b64 exec, 0, -1
    ds_or_b32 v110, v111 offset:160
    s_mov_b64 exec, -1
    ds_wrxchg_rtn_b32 v7, v6, v5 offset:160
    s_mov_b32 s24, 0
L_p2_loop:
    s_add_u32 s22, s22, 80000
    s_lshl_b32 s14, s13, 4
    s_or_b32 s14, s14, s24
    s_cmp_lg_u32 s14, 5
    s_cbranch_scc1 L_p2_nost
    v_mov_b32 v52, 0
    s_lshl_b32 s14, s3, 8
    s_add_u32 s14, s14, 227590656
    s_mov_b64 exec, 1
    buffer_atomic_add v52, off, s[4:7], s14 sc0
    s_mov_b64 exec, -1
L_p2_nost:
    s_waitcnt vmcnt(5)
    v_mad_u32_u16 v64, v8, 8, s18
    v_mad_u32_u16 v66, v9, 8, s18
    v_mad_u32_u16 v68, v10, 8, s18
    ds_read_b64 v[64:65], v64
    ds_read_b64 v[66:67], v66
    ds_read_b64 v[68:69], v68
    s_add_u32 s14, s22, 32768
    buffer_load_dwordx4 v[96:99], v1, s[8:11], s14 offen
    s_waitcnt vmcnt(5)
    v_mad_u32_u16 v70, v12, 8, s18
    v_mad_u32_u16 v72, v13, 8, s18
    v_mad_u32_u16 v74, v14, 8, s18
    ds_read_b64 v[70:71], v70
    ds_read_b64 v[72:73], v72
    ds_read_b64 v[74:75], v74
    s_add_u32 s14, s22, 49152
    buffer_load_dwordx4 v[100:103], v1, s[8:11], s14 offen
    s_waitcnt lgkmcnt(6)
    v_readlane_b32 s30, v7, 0
    v_readlane_b32 s31, v7, 1
    v_readlane_b32 s32, v7, 2
    v_readlane_b32 s33, v7, 3
    v_readlane_b32 s34, v7, 4
    v_readlane_b32 s35, v7, 5
    v_readlane_b32 s36, v7, 6
    v_readlane_b32 s37, v7, 7
    s_mov_b32 s25, s19
    s_mov_b32 s26, s27
    s_mov_b32 s51, s28
    s_mov_b32 s28, s29
    v_mbcnt_lo_u32_b32 v118, s30, 0
    v_mbcnt_hi_u32_b32 v118, s31, v118
    s_bcnt1_i32_b64 s14, s[30:31]
    v_lshl_add_u32 v119, v118, 1, s25
    ds_read_u16 v119, v119
    v_mad_u32_u24 v118, v118, s23, v2
    s_mov_b32 s30, s26
    s_lshl1_add_u32 s25, s14, s25
    s_mul_i32 s14, s14, s23
    s_add_u32 s26, s26, s14
    v_bfe_i32 v108, v11, 2, 10
    v_bfe_i32 v109, v11, 12, 10
    v_ashrrev_i32 v110, 22, v11
    v_cvt_f32_i32 v108, v108
    v_cvt_f32_i32 v109, v109
    v_cvt_f32_i32 v110, v110
    v_mad_u32_u16 v8, v8, 8, s50 op_sel:[1,0,0,0]
    v_mad_u32_u16 v9, v9, 8, s50 op_sel:[1,0,0,0]
    v_mad_u32_u16 v10, v10, 8, s50 op_sel:[1,0,0,0]
    s_waitcnt lgkmcnt(4)
    v_lshlrev_b32 v112, 16, v64
    v_and_b32 v113, 0xffff0000, v64
    v_lshlrev_b32 v64, 16, v65
    v_and_b32 v65, 0xffff0000, v65
    v_lshlrev_b32 v114, 16, v66
    v_and_b32 v115, 0xffff0000, v66
    v_lshlrev_b32 v66, 16, v67
    v_and_b32 v67, 0xffff0000, v67
    v_lshlrev_b32 v116, 16, v68
    v_and_b32 v117, 0xffff0000, v68
    v_lshlrev_b32 v68, 16, v69
    v_and_b32 v69, 0xffff0000, v69
    v_pk_fma_f32 v[112:113], v[112:113], v[108:109], s[16:17] op_sel:[0,0,0] op_sel_hi:[1,0,0]
    v_pk_fma_f32 v[64:65], v[64:65], v[108:109], s[16:17] op_sel:[0,0,0] op_sel_hi:[1,0,0]
    v_pk_fma_f32 v[114:115], v[114:115], v[108:109], s[16:17] op_sel:[0,1,0] op_sel_hi:[1,1,0]
    v_pk_fma_f32 v[66:67], v[66:67], v[108:109], s[16:17] op_sel:[0,1,0] op_sel_hi:[1,1,0]
    v_pk_fma_f32 v[116:117], v[116:117], v[110:111], s[16:17] op_sel:[0,0,0] op_sel_hi:[1,0,0]
    v_pk_fma_f32 v[68:69], v[68:69], v[110:111], s[16:17] op_sel:[0,0,0] op_sel_hi:[1,0,0]
    v_perm_b32 v65, v65, v64, s17
    v_perm_b32 v64, v113, v112, s17
    v_perm_b32 v67, v67, v66, s17
    v_perm_b32 v66, v115, v114, s17
    v_perm_b32 v69, v69, v68, s17
    v_perm_b32 v68, v117, v116, s17
    v_lshl_add_u64 v[64:65], v[64:65], 0, s[20:21]
    v_lshl_add_u64 v[66:67], v[66:67], 0, s[20:21]
    v_lshl_add_u64 v[68:69], v[68:69], 0, s[20:21]
    v_or3_b32 v4, v44, v45, v4
    v_or3_b32 v4, v46, v47, v4
    v_or3_b32 v4, v48, v49, v4
    ds_add_rtn_u64 v[44:45], v8, v[64:65]
    ds_add_rtn_u64 v[46:47], v9, v[66:67]
    ds_add_rtn_u64 v[48:49], v10, v[68:69]
    s_waitcnt lgkmcnt(3)
    v_lshl_add_u32 v118, v119, 4, v118
    buffer_load_dwordx4 v[8:11], v118, s[44:47], s30 offen offset:0
    s_add_u32 s14, s22, 65536
    buffer_load_dwordx4 v[104:107], v1, s[8:11], s14 offen
    s_waitcnt vmcnt(7)
    v_mad_u32_u16 v76, v16, 8, s18
    v_mad_u32_u16 v78, v17, 8, s18
    v_mad_u32_u16 v80, v18, 8, s18
    ds_read_b64 v[76:77], v76
    ds_read_b64 v[78:79], v78
    ds_read_b64 v[80:81], v80
    s_waitcnt vmcnt(6)
    v_mad_u32_u16 v82, v20, 8, s18
    v_mad_u32_u16 v84, v21, 8, s18
    v_mad_u32_u16 v86, v22, 8, s18
    ds_read_b64 v[82:83], v82
    ds_read_b64 v[84:85], v84
    ds_read_b64 v[86:87], v86
    v_mbcnt_lo_u32_b32 v118, s32, 0
    v_mbcnt_hi_u32_b32 v118, s33, v118
    s_bcnt1_i32_b64 s14, s[32:33]
    v_lshl_add_u32 v119, v118, 1, s25
    ds_read_u16 v119, v119
    v_mad_u32_u24 v118, v118, s23, v2
    s_mov_b32 s32, s26
    s_lshl1_add_u32 s25, s14, s25
    s_mul_i32 s14, s14, s23
    s_add_u32 s26, s26, s14
    v_bfe_i32 v108, v15, 2, 10
    v_bfe_i32 v109, v15, 12, 10
    v_ashrrev_i32 v110, 22, v15
    v_cvt_f32_i32 v108, v108
    v_cvt_f32_i32 v109, v109
    v_cvt_f32_i32 v110, v110
    v_mad_u32_u16 v12, v12, 8, s50 op_sel:[1,0,0,0]
    v_mad_u32_u16 v13, v13, 8, s50 op_sel:[1,0,0,0]
    v_mad_u32_u16 v14, v14, 8, s50 op_sel:[1,0,0,0]
    v_lshlrev_b32 v112, 16, v70
    v_and_b32 v113, 0xffff0000, v70
    v_lshlrev_b32 v70, 16, v71
    v_and_b32 v71, 0xffff0000, v71
    v_lshlrev_b32 v114, 16, v72
    v_and_b32 v115, 0xffff0000, v72
    v_lshlrev_b32 v72, 16, v73
    v_and_b32 v73, 0xffff0000, v73
    v_lshlrev_b32 v116, 16, v74
    v_and_b32 v117, 0xffff0000, v74
    v_lshlrev_b32 v74, 16, v75
    v_and_b32 v75, 0xffff0000, v75
    v_pk_fma_f32 v[112:113], v[112:113], v[108:109], s[16:17] op_sel:[0,0,0] op_sel_hi:[1,0,0]
    v_pk_fma_f32 v[70:71], v[70:71], v[108:109], s[16:17] op_sel:[0,0,0] op_sel_hi:[1,0,0]
    v_pk_fma_f32 v[114:115], v[114:115], v[108:109], s[16:17] op_sel:[0,1,0] op_sel_hi:[1,1,0]
    v_pk_fma_f32 v[72:73], v[72:73], v[108:109], s[16:17] op_sel:[0,1,0] op_sel_hi:[1,1,0]
    v_pk_fma_f32 v[116:117], v[116:117], v[110:111], s[16:17] op_sel:[0,0,0] op_sel_hi:[1,0,0]
    v_pk_fma_f32 v[74:75], v[74:75], v[110:111], s[16:17] op_sel:[0,0,0] op_sel_hi:[1,0,0]
    v_perm_b32 v71, v71, v70, s17
    v_perm_b32 v70, v113, v112, s17
    v_perm_b32 v73, v73, v72, s17
    v_perm_b32 v72, v115, v114, s17
    v_perm_b32 v75, v75, v74, s17
    v_perm_b32 v74, v117, v116, s17
    v_lshl_add_u64 v[70:71], v[70:71], 0, s[20:21]
    v_lshl_add_u64 v[72:73], v[72:73], 0, s[20:21]
    v_lshl_add_u64 v[74:75], v[74:75], 0, s[20:21]
    s_waitcnt lgkmcnt(7)
    v_or3_b32 v4, v44, v45, v4
    v_or3_b32 v4, v46, v47, v4
    v_or3_b32 v4, v48, v49, v4
    ds_add_rtn_u64 v[44:45], v12, v[70:71]
    ds_add_rtn_u64 v[46:47], v13, v[72:73]
    ds_add_rtn_u64 v[48:49], v14, v[74:75]
    s_waitcnt lgkmcnt(3)
    v_lshl_add_u32 v118, v119, 4, v118
    buffer_load_dwordx4 v[12:15], v118, s[44:47], s32 offen offset:1024
    s_cmp_le_u32 s51, 256
    s_cbranch_scc1 L_p2_kernel_noopt2_2
    v_mad_u32_u16 v64, v24, 8, s18
    v_mad_u32_u16 v66, v25, 8, s18
    v_mad_u32_u16 v68, v26, 8, s18
    ds_read_b64 v[64:65], v64
    ds_read_b64 v[66:67], v66
    ds_read_b64 v[68:69], v68
    v_bfe_i32 v108, v27, 2, 10
    v_bfe_i32 v109, v27, 12, 10
    v_ashrrev_i32 v110, 22, v27
    v_cvt_f32_i32 v108, v108
    v_cvt_f32_i32 v109, v109
    v_cvt_f32_i32 v110, v110
    v_mad_u32_u16 v24, v24, 8, s50 op_sel:[1,0,0,0]
    v_mad_u32_u16 v25, v25, 8, s50 op_sel:[1,0,0,0]
    v_mad_u32_u16 v26, v26, 8, s50 op_sel:[1,0,0,0]
    s_waitcnt lgkmcnt(0)
    v_lshlrev_b32 v112, 16, v64
    v_and_b32 v113, 0xffff0000, v64
    v_lshlrev_b32 v64, 16, v65
    v_and_b32 v65, 0xffff0000, v65
    v_lshlrev_b32 v114, 16, v66
    v_and_b32 v115, 0xffff0000, v66
    v_lshlrev_b32 v66, 16, v67
    v_and_b32 v67, 0xffff0000, v67
    v_lshlrev_b32 v116, 16, v68
    v_and_b32 v117, 0xffff0000, v68
    v_lshlrev_b32 v68, 16, v69
    v_and_b32 v69, 0xffff0000, v69
    v_pk_fma_f32 v[112:113], v[112:113], v[108:109], s[16:17] op_sel:[0,0,0] op_sel_hi:[1,0,0]
    v_pk_fma_f32 v[64:65], v[64:65], v[108:109], s[16:17] op_sel:[0,0,0] op_sel_hi:[1,0,0]
    v_pk_fma_f32 v[114:115], v[114:115], v[108:109], s[16:17] op_sel:[0,1,0] op_sel_hi:[1,1,0]
    v_pk_fma_f32 v[66:67], v[66:67], v[108:109], s[16:17] op_sel:[0,1,0] op_sel_hi:[1,1,0]
    v_pk_fma_f32 v[116:117], v[116:117], v[110:111], s[16:17] op_sel:[0,0,0] op_sel_hi:[1,0,0]
    v_pk_fma_f32 v[68:69], v[68:69], v[110:111], s[16:17] op_sel:[0,0,0] op_sel_hi:[1,0,0]
    v_perm_b32 v65, v65, v64, s17
    v_perm_b32 v64, v113, v112, s17
    v_perm_b32 v67, v67, v66, s17
    v_perm_b32 v66, v115, v114, s17
    v_perm_b32 v69, v69, v68, s17
    v_perm_b32 v68, v117, v116, s17
    v_lshl_add_u64 v[64:65], v[64:65], 0, s[20:21]
    v_lshl_add_u64 v[66:67], v[66:67], 0, s[20:21]
    v_lshl_add_u64 v[68:69], v[68:69], 0, s[20:21]
    v_or3_b32 v4, v44, v45, v4
    v_or3_b32 v4, v46, v47, v4
    v_or3_b32 v4, v48, v49, v4
    ds_add_rtn_u64 v[44:45], v24, v[64:65]
    ds_add_rtn_u64 v[46:47], v25, v[66:67]
    ds_add_rtn_u64 v[48:49], v26, v[68:69]
L_p2_kernel_noopt2_2:
    s_barrier
    s_waitcnt vmcnt(1)
    ds_write_b128 v3, v[88:91] offset:0
    ds_write_b128 v3, v[92:95] offset:16384
    ds_write_b128 v3, v[96:99] offset:32768
    ds_write_b128 v3, v[100:103] offset:49152
    ds_write_b128 v124, v[104:107] offset:0
    v_mbcnt_lo_u32_b32 v118, s34, 0
    v_mbcnt_hi_u32_b32 v118, s35, v118
    s_bcnt1_i32_b64 s14, s[34:35]
    v_lshl_add_u32 v119, v118, 1, s25
    ds_read_u16 v119, v119
    v_mad_u32_u24 v118, v118, s23, v2
    s_mov_b32 s34, s26
    s_lshl1_add_u32 s25, s14, s25
    s_mul_i32 s14, s14, s23
    s_add_u32 s26, s26, s14
    v_bfe_i32 v108, v19, 2, 10
    v_bfe_i32 v109, v19, 12, 10
    v_ashrrev_i32 v110, 22, v19
    v_cvt_f32_i32 v108, v108
    v_cvt_f32_i32 v109, v109
    v_cvt_f32_i32 v110, v110
    v_mad_u32_u16 v16, v16, 8, s50 op_sel:[1,0,0,0]
    v_mad_u32_u16 v17, v17, 8, s50 op_sel:[1,0,0,0]
    v_mad_u32_u16 v18, v18, 8, s50 op_sel:[1,0,0,0]
    v_lshlrev_b32 v112, 16, v76
    v_and_b32 v113, 0xffff0000, v76
    v_lshlrev_b32 v76, 16, v77
    v_and_b32 v77, 0xffff0000, v77
    v_lshlrev_b32 v114, 16, v78
    v_and_b32 v115, 0xffff0000, v78
    v_lshlrev_b32 v78, 16, v79
    v_and_b32 v79, 0xffff0000, v79
    v_lshlrev_b32 v116, 16, v80
    v_and_b32 v117, 0xffff0000, v80
    v_lshlrev_b32 v80, 16, v81
    v_and_b32 v81, 0xffff0000, v81
    v_pk_fma_f32 v[112:113], v[112:113], v[108:109], s[16:17] op_sel:[0,0,0] op_sel_hi:[1,0,0]
    v_pk_fma_f32 v[76:77], v[76:77], v[108:109], s[16:17] op_sel:[0,0,0] op_sel_hi:[1,0,0]
    v_pk_fma_f32 v[114:115], v[114:115], v[108:109], s[16:17] op_sel:[0,1,0] op_sel_hi:[1,1,0]
    v_pk_fma_f32 v[78:79], v[78:79], v[108:109], s[16:17] op_sel:[0,1,0] op_sel_hi:[1,1,0]
    v_pk_fma_f32 v[116:117], v[116:117], v[110:111], s[16:17] op_sel:[0,0,0] op_sel_hi:[1,0,0]
    v_pk_fma_f32 v[80:81], v[80:81], v[110:111], s[16:17] op_sel:[0,0,0] op_sel_hi:[1,0,0]
    v_perm_b32 v77, v77, v76, s17
    v_perm_b32 v76, v113, v112, s17
    v_perm_b32 v79, v79, v78, s17
    v_perm_b32 v78, v115, v114, s17
    v_perm_b32 v81, v81, v80, s17
    v_perm_b32 v80, v117, v116, s17
    v_lshl_add_u64 v[76:77], v[76:77], 0, s[20:21]
    v_lshl_add_u64 v[78:79], v[78:79], 0, s[20:21]
    v_lshl_add_u64 v[80:81], v[80:81], 0, s[20:21]
    s_waitcnt lgkmcnt(6)
    v_or3_b32 v4, v44, v45, v4
    v_or3_b32 v4, v46, v47, v4
    v_or3_b32 v4, v48, v49, v4
    ds_add_rtn_u64 v[44:45], v16, v[76:77]
    ds_add_rtn_u64 v[46:47], v17, v[78:79]
    ds_add_rtn_u64 v[48:49], v18, v[80:81]
    s_waitcnt lgkmcnt(3)
    v_lshl_add_u32 v118, v119, 4, v118
    buffer_load_dwordx4 v[16:19], v118, s[44:47], s34 offen offset:2048
    v_mbcnt_lo_u32_b32 v118, s36, 0
    v_mbcnt_hi_u32_b32 v118, s37, v118
    s_bcnt1_i32_b64 s14, s[36:37]
    v_lshl_add_u32 v119, v118, 1, s25
    ds_read_u16 v119, v119
    v_mad_u32_u24 v118, v118, s23, v2
    s_mov_b32 s36, s26
    s_lshl1_add_u32 s25, s14, s25
    s_mul_i32 s14, s14, s23
    s_add_u32 s26, s26, s14
    v_bfe_i32 v108, v23, 2, 10
    v_bfe_i32 v109, v23, 12, 10
    v_ashrrev_i32 v110, 22, v23
    v_cvt_f32_i32 v108, v108
    v_cvt_f32_i32 v109, v109
    v_cvt_f32_i32 v110, v110
    v_mad_u32_u16 v20, v20, 8, s50 op_sel:[1,0,0,0]
    v_mad_u32_u16 v21, v21, 8, s50 op_sel:[1,0,0,0]
    v_mad_u32_u16 v22, v22, 8, s50 op_sel:[1,0,0,0]
    v_lshlrev_b32 v112, 16, v82
    v_and_b32 v113, 0xffff0000, v82
    v_lshlrev_b32 v82, 16, v83
    v_and_b32 v83, 0xffff0000, v83
    v_lshlrev_b32 v114, 16, v84
    v_and_b32 v115, 0xffff0000, v84
    v_lshlrev_b32 v84, 16, v85
    v_and_b32 v85, 0xffff0000, v85
    v_lshlrev_b32 v116, 16, v86
    v_and_b32 v117, 0xffff0000, v86
    v_lshlrev_b32 v86, 16, v87
    v_and_b32 v87, 0xffff0000, v87
    v_pk_fma_f32 v[112:113], v[112:113], v[108:109], s[16:17] op_sel:[0,0,0] op_sel_hi:[1,0,0]
    v_pk_fma_f32 v[82:83], v[82:83], v[108:109], s[16:17] op_sel:[0,0,0] op_sel_hi:[1,0,0]
    v_pk_fma_f32 v[114:115], v[114:115], v[108:109], s[16:17] op_sel:[0,1,0] op_sel_hi:[1,1,0]
    v_pk_fma_f32 v[84:85], v[84:85], v[108:109], s[16:17] op_sel:[0,1,0] op_sel_hi:[1,1,0]
    v_pk_fma_f32 v[116:117], v[116:117], v[110:111], s[16:17] op_sel:[0,0,0] op_sel_hi:[1,0,0]
    v_pk_fma_f32 v[86:87], v[86:87], v[110:111], s[16:17] op_sel:[0,0,0] op_sel_hi:[1,0,0]
    v_perm_b32 v83, v83, v82, s17
    v_perm_b32 v82, v113, v112, s17
    v_perm_b32 v85, v85, v84, s17
    v_perm_b32 v84, v115, v114, s17
    v_perm_b32 v87, v87, v86, s17
    v_perm_b32 v86, v117, v116, s17
    v_lshl_add_u64 v[82:83], v[82:83], 0, s[20:21]
    v_lshl_add_u64 v[84:85], v[84:85], 0, s[20:21]
    v_lshl_add_u64 v[86:87], v[86:87], 0, s[20:21]
    s_waitcnt lgkmcnt(1)
    v_or3_b32 v4, v44, v45, v4
    v_or3_b32 v4, v46, v47, v4
    v_or3_b32 v4, v48, v49, v4
    ds_add_rtn_u64 v[44:45], v20, v[82:83]
    ds_add_rtn_u64 v[46:47], v21, v[84:85]
    ds_add_rtn_u64 v[48:49], v22, v[86:87]
    s_waitcnt lgkmcnt(3)
    v_lshl_add_u32 v118, v119, 4, v118
    buffer_load_dwordx4 v[20:23], v118, s[44:47], s36 offen offset:3072
    s_cmp_le_u32 s28, 256
    s_cbranch_scc1 L_p2_kernel_noopt_3
    v_readlane_b32 s38, v7, 8
    v_readlane_b32 s39, v7, 9
    s_nop 1
    v_mbcnt_lo_u32_b32 v118, s38, 0
    v_mbcnt_hi_u32_b32 v118, s39, v118
    s_bcnt1_i32_b64 s14, s[38:39]
    v_lshl_add_u32 v119, v118, 1, s25
    ds_read_u16 v119, v119
    v_mad_u32_u24 v118, v118, s23, v2
    s_mov_b32 s38, s26
    s_lshl1_add_u32 s25, s14, s25
    s_mul_i32 s14, s14, s23
    s_add_u32 s26, s26, s14
    s_waitcnt lgkmcnt(0)
    s_add_u32 s38, s38, 4096
    v_lshl_add_u32 v118, v119, 4, v118
    buffer_load_dwordx4 v[24:27], v118, s[44:47], s38 offen offset:0
L_p2_kernel_noopt_3:
    v_pk_mov_b32 v[28:29], v[28:29], v[30:31] op_sel:[1,0]
    v_pk_mov_b32 v[30:31], v[30:31], v[32:33] op_sel:[1,0]
    v_pk_mov_b32 v[32:33], v[32:33], v[34:35] op_sel:[1,0]
    v_pk_mov_b32 v[34:35], v[34:35], v[4:5] op_sel:[1,1]
    v_pk_mov_b32 v[36:37], v[36:37], v[38:39] op_sel:[1,0]
    v_pk_mov_b32 v[38:39], v[38:39], v[40:41] op_sel:[1,0]
    v_pk_mov_b32 v[40:41], v[40:41], v[42:43] op_sel:[1,0]
    v_pk_mov_b32 v[42:43], v[42:43], v[4:5] op_sel:[1,1]
    v_mad_u32_u16 v108, v28, v50, s40 op_sel:[0,0,0,0]
    v_mad_u32_u16 v109, v36, v50, s41 op_sel:[0,0,0,0]
    v_sub_u32_sdwa v110, v109, v108 dst_sel:DWORD dst_unused:UNUSED_PAD src0_sel:WORD_1 src1_sel:WORD_1
    s_nop 1
    v_add_u32_dpp v110, v110, v110 row_shr:1 row_mask:0xf bank_mask:0xf bound_ctrl:0
    s_nop 1
    v_add_u32_dpp v110, v110, v110 row_shr:2 row_mask:0xf bank_mask:0xf bound_ctrl:0
    s_nop 1
    v_add_u32_dpp v110, v110, v110 row_shr:4 row_mask:0xf bank_mask:0xf bound_ctrl:0
    s_nop 1
    v_add_u32_dpp v110, v110, v110 row_shr:8 row_mask:0xf bank_mask:0xf bound_ctrl:0
    s_nop 1
    v_add_u32_dpp v110, v110, v110 row_bcast:15 row_mask:0xa bank_mask:0xf
    s_nop 1
    v_add_u32_dpp v110, v110, v110 row_bcast:31 row_mask:0xc bank_mask:0xf
    v_sub_u32_sdwa v109, v109, v110 dst_sel:DWORD dst_unused:UNUSED_PAD src0_sel:WORD_1 src1_sel:DWORD
    v_readlane_b32 s29, v110, 63
    v_add_u32 v110, -1, v110
    ds_write_b16 v126, v109
    v_lshlrev_b32_e64 v111, v110, 1
    v_lshrrev_b32 v110, 5, v110
    v_lshl_add_u32 v110, v110, 2, s19
    s_cmp_gt_u32 s29, 320
    s_cselect_b32 s2, 1, s2
    s_cselect_b64 exec, 0, -1
    ds_or_b32 v110, v111 offset:160
    s_mov_b64 exec, -1
    ds_wrxchg_rtn_b32 v7, v6, v5 offset:160
    s_add_u32 s14, s22, 80000
    buffer_load_dwordx4 v[88:91], v1, s[8:11], s14 offen
    s_add_u32 s14, s22, 96384
    buffer_load_dwordx4 v[92:95], v1, s[8:11], s14 offen
    s_barrier
    s_add_u32 s22, s22, 80000
    s_cmp_lg_u32 s24, 7
    s_cbranch_scc1 L_p2_nodist
    s_mov_b32 s46, 0
    s_lshl2_add_u32 s14, s3, s12
    s_mul_i32 s14, s14, 5000
    s_add_u32 s15, s14, 4096
    v_min_u32 v61, 225, v0
    v_lshl_add_u32 v60, v0, 2, s14
    v_lshl_add_u32 v61, v61, 2, s15
    global_load_dword v60, v60, s[100:101] nt
    global_load_dword v61, v61, s[100:101] nt
L_p2_nodist:
    v_mad_u32_u16 v64, v8, 8, s18
    v_mad_u32_u16 v66, v9, 8, s18
    v_mad_u32_u16 v68, v10, 8, s18
    ds_read_b64 v[64:65], v64
    ds_read_b64 v[66:67], v66
    ds_read_b64 v[68:69], v68
    s_add_u32 s14, s22, 32768
    buffer_load_dwordx4 v[96:99], v1, s[8:11], s14 offen
    s_waitcnt vmcnt(5)
    v_mad_u32_u16 v70, v12, 8, s18
    v_mad_u32_u16 v72, v13, 8, s18
    v_mad_u32_u16 v74, v14, 8, s18
    ds_read_b64 v[70:71], v70
    ds_read_b64 v[72:73], v72
    ds_read_b64 v[74:75], v74
    s_add_u32 s14, s22, 49152
    buffer_load_dwordx4 v[100:103], v1, s[8:11], s14 offen
    s_waitcnt lgkmcnt(6)
    v_readlane_b32 s30, v7, 0
    v_readlane_b32 s31, v7, 1
    v_readlane_b32 s32, v7, 2
    v_readlane_b32 s33, v7, 3
    v_readlane_b32 s34, v7, 4
    v_readlane_b32 s35, v7, 5
    v_readlane_b32 s36, v7, 6
    v_readlane_b32 s37, v7, 7
    s_mov_b32 s25, s19
    s_mov_b32 s26, s27
    s_mov_b32 s51, s28
    s_mov_b32 s28, s29
    v_mbcnt_lo_u32_b32 v118, s30, 0
    v_mbcnt_hi_u32_b32 v118, s31, v118
    s_bcnt1_i32_b64 s14, s[30:31]
    v_lshl_add_u32 v119, v118, 1, s25
    ds_read_u16 v119, v119
    v_mad_u32_u24 v118, v118, s23, v2
    s_mov_b32 s30, s26
    s_lshl1_add_u32 s25, s14, s25
    s_mul_i32 s14, s14, s23
    s_add_u32 s26, s26, s14
    v_bfe_i32 v108, v11, 2, 10
    v_bfe_i32 v109, v11, 12, 10
    v_ashrrev_i32 v110, 22, v11
    v_cvt_f32_i32 v108, v108
    v_cvt_f32_i32 v109, v109
    v_cvt_f32_i32 v110, v110
    v_mad_u32_u16 v8, v8, 8, s50 op_sel:[1,0,0,0]
    v_mad_u32_u16 v9, v9, 8, s50 op_sel:[1,0,0,0]
    v_mad_u32_u16 v10, v10, 8, s50 op_sel:[1,0,0,0]
    s_waitcnt lgkmcnt(4)
    v_lshlrev_b32 v112, 16, v64
    v_and_b32 v113, 0xffff0000, v64
    v_lshlrev_b32 v64, 16, v65
    v_and_b32 v65, 0xffff0000, v65
    v_lshlrev_b32 v114, 16, v66
    v_and_b32 v115, 0xffff0000, v66
    v_lshlrev_b32 v66, 16, v67
    v_and_b32 v67, 0xffff0000, v67
    v_lshlrev_b32 v116, 16, v68
    v_and_b32 v117, 0xffff0000, v68
    v_lshlrev_b32 v68, 16, v69
    v_and_b32 v69, 0xffff0000, v69
    v_pk_fma_f32 v[112:113], v[112:113], v[108:109], s[16:17] op_sel:[0,0,0] op_sel_hi:[1,0,0]
    v_pk_fma_f32 v[64:65], v[64:65], v[108:109], s[16:17] op_sel:[0,0,0] op_sel_hi:[1,0,0]
    v_pk_fma_f32 v[114:115], v[114:115], v[108:109], s[16:17] op_sel:[0,1,0] op_sel_hi:[1,1,0]
    v_pk_fma_f32 v[66:67], v[66:67], v[108:109], s[16:17] op_sel:[0,1,0] op_sel_hi:[1,1,0]
    v_pk_fma_f32 v[116:117], v[116:117], v[110:111], s[16:17] op_sel:[0,0,0] op_sel_hi:[1,0,0]
    v_pk_fma_f32 v[68:69], v[68:69], v[110:111], s[16:17] op_sel:[0,0,0] op_sel_hi:[1,0,0]
    v_perm_b32 v65, v65, v64, s17
    v_perm_b32 v64, v113, v112, s17
    v_perm_b32 v67, v67, v66, s17
    v_perm_b32 v66, v115, v114, s17
    v_perm_b32 v69, v69, v68, s17
    v_perm_b32 v68, v117, v116, s17
    v_lshl_add_u64 v[64:65], v[64:65], 0, s[20:21]
    v_lshl_add_u64 v[66:67], v[66:67], 0, s[20:21]
    v_lshl_add_u64 v[68:69], v[68:69], 0, s[20:21]
    v_or3_b32 v4, v44, v45, v4
    v_or3_b32 v4, v46, v47, v4
    v_or3_b32 v4, v48, v49, v4
    ds_add_rtn_u64 v[44:45], v8, v[64:65]
    ds_add_rtn_u64 v[46:47], v9, v[66:67]
    ds_add_rtn_u64 v[48:49], v10, v[68:69]
    s_waitcnt lgkmcnt(3)
    v_lshl_add_u32 v118, v119, 4, v118
    buffer_load_dwordx4 v[8:11], v118, s[44:47], s30 offen offset:0
    s_add_u32 s14, s22, 65536
    buffer_load_dwordx4 v[104:107], v1, s[8:11], s14 offen
    s_waitcnt vmcnt(7)
    v_mad_u32_u16 v76, v16, 8, s18
    v_mad_u32_u16 v78, v17, 8, s18
    v_mad_u32_u16 v80, v18, 8, s18
    ds_read_b64 v[76:77], v76
    ds_read_b64 v[78:79], v78
    ds_read_b64 v[80:81], v80
    s_waitcnt vmcnt(6)
    v_mad_u32_u16 v82, v20, 8, s18
    v_mad_u32_u16 v84, v21, 8, s18
    v_mad_u32_u16 v86, v22, 8, s18
    ds_read_b64 v[82:83], v82
    ds_read_b64 v[84:85], v84
    ds_read_b64 v[86:87], v86
    v_mbcnt_lo_u32_b32 v118, s32, 0
    v_mbcnt_hi_u32_b32 v118, s33, v118
    s_bcnt1_i32_b64 s14, s[32:33]
    v_lshl_add_u32 v119, v118, 1, s25
    ds_read_u16 v119, v119
    v_mad_u32_u24 v118, v118, s23, v2
    s_mov_b32 s32, s26
    s_lshl1_add_u32 s25, s14, s25
    s_mul_i32 s14, s14, s23
    s_add_u32 s26, s26, s14
    v_bfe_i32 v108, v15, 2, 10
    v_bfe_i32 v109, v15, 12, 10
    v_ashrrev_i32 v110, 22, v15
    v_cvt_f32_i32 v108, v108
    v_cvt_f32_i32 v109, v109
    v_cvt_f32_i32 v110, v110
    v_mad_u32_u16 v12, v12, 8, s50 op_sel:[1,0,0,0]
    v_mad_u32_u16 v13, v13, 8, s50 op_sel:[1,0,0,0]
    v_mad_u32_u16 v14, v14, 8, s50 op_sel:[1,0,0,0]
    v_lshlrev_b32 v112, 16, v70
    v_and_b32 v113, 0xffff0000, v70
    v_lshlrev_b32 v70, 16, v71
    v_and_b32 v71, 0xffff0000, v71
    v_lshlrev_b32 v114, 16, v72
    v_and_b32 v115, 0xffff0000, v72
    v_lshlrev_b32 v72, 16, v73
    v_and_b32 v73, 0xffff0000, v73
    v_lshlrev_b32 v116, 16, v74
    v_and_b32 v117, 0xffff0000, v74
    v_lshlrev_b32 v74, 16, v75
    v_and_b32 v75, 0xffff0000, v75
    v_pk_fma_f32 v[112:113], v[112:113], v[108:109], s[16:17] op_sel:[0,0,0] op_sel_hi:[1,0,0]
    v_pk_fma_f32 v[70:71], v[70:71], v[108:109], s[16:17] op_sel:[0,0,0] op_sel_hi:[1,0,0]
    v_pk_fma_f32 v[114:115], v[114:115], v[108:109], s[16:17] op_sel:[0,1,0] op_sel_hi:[1,1,0]
    v_pk_fma_f32 v[72:73], v[72:73], v[108:109], s[16:17] op_sel:[0,1,0] op_sel_hi:[1,1,0]
    v_pk_fma_f32 v[116:117], v[116:117], v[110:111], s[16:17] op_sel:[0,0,0] op_sel_hi:[1,0,0]
    v_pk_fma_f32 v[74:75], v[74:75], v[110:111], s[16:17] op_sel:[0,0,0] op_sel_hi:[1,0,0]
    v_perm_b32 v71, v71, v70, s17
    v_perm_b32 v70, v113, v112, s17
    v_perm_b32 v73, v73, v72, s17
    v_perm_b32 v72, v115, v114, s17
    v_perm_b32 v75, v75, v74, s17
    v_perm_b32 v74, v117, v116, s17
    v_lshl_add_u64 v[70:71], v[70:71], 0, s[20:21]
    v_lshl_add_u64 v[72:73], v[72:73], 0, s[20:21]
    v_lshl_add_u64 v[74:75], v[74:75], 0, s[20:21]
    s_waitcnt lgkmcnt(7)
    v_or3_b32 v4, v44, v45, v4
    v_or3_b32 v4, v46, v47, v4
    v_or3_b32 v4, v48, v49, v4
    ds_add_rtn_u64 v[44:45], v12, v[70:71]
    ds_add_rtn_u64 v[46:47], v13, v[72:73]
    ds_add_rtn_u64 v[48:49], v14, v[74:75]
    s_waitcnt lgkmcnt(3)
    v_lshl_add_u32 v118, v119, 4, v118
    buffer_load_dwordx4 v[12:15], v118, s[44:47], s32 offen offset:1024
    s_cmp_le_u32 s51, 256
    s_cbranch_scc1 L_p2_kernel_noopt2_4
    v_mad_u32_u16 v64, v24, 8, s18
    v_mad_u32_u16 v66, v25, 8, s18
    v_mad_u32_u16 v68, v26, 8, s18
    ds_read_b64 v[64:65], v64
    ds_read_b64 v[66:67], v66
    ds_read_b64 v[68:69], v68
    v_bfe_i32 v108, v27, 2, 10
    v_bfe_i32 v109, v27, 12, 10
    v_ashrrev_i32 v110, 22, v27
    v_cvt_f32_i32 v108, v108
    v_cvt_f32_i32 v109, v109
    v_cvt_f32_i32 v110, v110
    v_mad_u32_u16 v24, v24, 8, s50 op_sel:[1,0,0,0]
    v_mad_u32_u16 v25, v25, 8, s50 op_sel:[1,0,0,0]
    v_mad_u32_u16 v26, v26, 8, s50 op_sel:[1,0,0,0]
    s_waitcnt lgkmcnt(0)
    v_lshlrev_b32 v112, 16, v64
    v_and_b32 v113, 0xffff0000, v64
    v_lshlrev_b32 v64, 16, v65
    v_and_b32 v65, 0xffff0000, v65
    v_lshlrev_b32 v114, 16, v66
    v_and_b32 v115, 0xffff0000, v66
    v_lshlrev_b32 v66, 16, v67
    v_and_b32 v67, 0xffff0000, v67
    v_lshlrev_b32 v116, 16, v68
    v_and_b32 v117, 0xffff0000, v68
    v_lshlrev_b32 v68, 16, v69
    v_and_b32 v69, 0xffff0000, v69
    v_pk_fma_f32 v[112:113], v[112:113], v[108:109], s[16:17] op_sel:[0,0,0] op_sel_hi:[1,0,0]
    v_pk_fma_f32 v[64:65], v[64:65], v[108:109], s[16:17] op_sel:[0,0,0] op_sel_hi:[1,0,0]
    v_pk_fma_f32 v[114:115], v[114:115], v[108:109], s[16:17] op_sel:[0,1,0] op_sel_hi:[1,1,0]
    v_pk_fma_f32 v[66:67], v[66:67], v[108:109], s[16:17] op_sel:[0,1,0] op_sel_hi:[1,1,0]
    v_pk_fma_f32 v[116:117], v[116:117], v[110:111], s[16:17] op_sel:[0,0,0] op_sel_hi:[1,0,0]
    v_pk_fma_f32 v[68:69], v[68:69], v[110:111], s[16:17] op_sel:[0,0,0] op_sel_hi:[1,0,0]
    v_perm_b32 v65, v65, v64, s17
    v_perm_b32 v64, v113, v112, s17
    v_perm_b32 v67, v67, v66, s17
    v_perm_b32 v66, v115, v114, s17
    v_perm_b32 v69, v69, v68, s17
    v_perm_b32 v68, v117, v116, s17
    v_lshl_add_u64 v[64:65], v[64:65], 0, s[20:21]
    v_lshl_add_u64 v[66:67], v[66:67], 0, s[20:21]
    v_lshl_add_u64 v[68:69], v[68:69], 0, s[20:21]
    v_or3_b32 v4, v44, v45, v4
    v_or3_b32 v4, v46, v47, v4
    v_or3_b32 v4, v48, v49, v4
    ds_add_rtn_u64 v[44:45], v24, v[64:65]
    ds_add_rtn_u64 v[46:47], v25, v[66:67]
    ds_add_rtn_u64 v[48:49], v26, v[68:69]
L_p2_kernel_noopt2_4:
    s_barrier
    s_waitcnt vmcnt(1)
    ds_write_b128 v3, v[88:91] offset:0
    ds_write_b128 v3, v[92:95] offset:16384
    ds_write_b128 v3, v[96:99] offset:32768
    ds_write_b128 v3, v[100:103] offset:49152
    ds_write_b128 v124, v[104:107] offset:0
    v_mbcnt_lo_u32_b32 v118, s34, 0
    v_mbcnt_hi_u32_b32 v118, s35, v118
    s_bcnt1_i32_b64 s14, s[34:35]
    v_lshl_add_u32 v119, v118, 1, s25
    ds_read_u16 v119, v119
    v_mad_u32_u24 v118, v118, s23, v2
    s_mov_b32 s34, s26
    s_lshl1_add_u32 s25, s14, s25
    s_mul_i32 s14, s14, s23
    s_add_u32 s26, s26, s14
    v_bfe_i32 v108, v19, 2, 10
    v_bfe_i32 v109, v19, 12, 10
    v_ashrrev_i32 v110, 22, v19
    v_cvt_f32_i32 v108, v108
    v_cvt_f32_i32 v109, v109
    v_cvt_f32_i32 v110, v110
    v_mad_u32_u16 v16, v16, 8, s50 op_sel:[1,0,0,0]
    v_mad_u32_u16 v17, v17, 8, s50 op_sel:[1,0,0,0]
    v_mad_u32_u16 v18, v18, 8, s50 op_sel:[1,0,0,0]
    v_lshlrev_b32 v112, 16, v76
    v_and_b32 v113, 0xffff0000, v76
    v_lshlrev_b32 v76, 16, v77
    v_and_b32 v77, 0xffff0000, v77
    v_lshlrev_b32 v114, 16, v78
    v_and_b32 v115, 0xffff0000, v78
    v_lshlrev_b32 v78, 16, v79
    v_and_b32 v79, 0xffff0000, v79
    v_lshlrev_b32 v116, 16, v80
    v_and_b32 v117, 0xffff0000, v80
    v_lshlrev_b32 v80, 16, v81
    v_and_b32 v81, 0xffff0000, v81
    v_pk_fma_f32 v[112:113], v[112:113], v[108:109], s[16:17] op_sel:[0,0,0] op_sel_hi:[1,0,0]
    v_pk_fma_f32 v[76:77], v[76:77], v[108:109], s[16:17] op_sel:[0,0,0] op_sel_hi:[1,0,0]
    v_pk_fma_f32 v[114:115], v[114:115], v[108:109], s[16:17] op_sel:[0,1,0] op_sel_hi:[1,1,0]
    v_pk_fma_f32 v[78:79], v[78:79], v[108:109], s[16:17] op_sel:[0,1,0] op_sel_hi:[1,1,0]
    v_pk_fma_f32 v[116:117], v[116:117], v[110:111], s[16:17] op_sel:[0,0,0] op_sel_hi:[1,0,0]
    v_pk_fma_f32 v[80:81], v[80:81], v[110:111], s[16:17] op_sel:[0,0,0] op_sel_hi:[1,0,0]
    v_perm_b32 v77, v77, v76, s17
    v_perm_b32 v76, v113, v112, s17
    v_perm_b32 v79, v79, v78, s17
    v_perm_b32 v78, v115, v114, s17
    v_perm_b32 v81, v81, v80, s17
    v_perm_b32 v80, v117, v116, s17
    v_lshl_add_u64 v[76:77], v[76:77], 0, s[20:21]
    v_lshl_add_u64 v[78:79], v[78:79], 0, s[20:21]
    v_lshl_add_u64 v[80:81], v[80:81], 0, s[20:21]
    s_waitcnt lgkmcnt(6)
    v_or3_b32 v4, v44, v45, v4
    v_or3_b32 v4, v46, v47, v4
    v_or3_b32 v4, v48, v49, v4
    ds_add_rtn_u64 v[44:45], v16, v[76:77]
    ds_add_rtn_u64 v[46:47], v17, v[78:79]
    ds_add_rtn_u64 v[48:49], v18, v[80:81]
    s_waitcnt lgkmcnt(3)
    v_lshl_add_u32 v118, v119, 4, v118
    buffer_load_dwordx4 v[16:19], v118, s[44:47], s34 offen offset:2048
    v_mbcnt_lo_u32_b32 v118, s36, 0
    v_mbcnt_hi_u32_b32 v118, s37, v118
    s_bcnt1_i32_b64 s14, s[36:37]
    v_lshl_add_u32 v119, v118, 1, s25
    ds_read_u16 v119, v119
    v_mad_u32_u24 v118, v118, s23, v2
    s_mov_b32 s36, s26
    s_lshl1_add_u32 s25, s14, s25
    s_mul_i32 s14, s14, s23
    s_add_u32 s26, s26, s14
    v_bfe_i32 v108, v23, 2, 10
    v_bfe_i32 v109, v23, 12, 10
    v_ashrrev_i32 v110, 22, v23
    v_cvt_f32_i32 v108, v108
    v_cvt_f32_i32 v109, v109
    v_cvt_f32_i32 v110, v110
    v_mad_u32_u16 v20, v20, 8, s50 op_sel:[1,0,0,0]
    v_mad_u32_u16 v21, v21, 8, s50 op_sel:[1,0,0,0]
    v_mad_u32_u16 v22, v22, 8, s50 op_sel:[1,0,0,0]
    v_lshlrev_b32 v112, 16, v82
    v_and_b32 v113, 0xffff0000, v82
    v_lshlrev_b32 v82, 16, v83
    v_and_b32 v83, 0xffff0000, v83
    v_lshlrev_b32 v114, 16, v84
    v_and_b32 v115, 0xffff0000, v84
    v_lshlrev_b32 v84, 16, v85
    v_and_b32 v85, 0xffff0000, v85
    v_lshlrev_b32 v116, 16, v86
    v_and_b32 v117, 0xffff0000, v86
    v_lshlrev_b32 v86, 16, v87
    v_and_b32 v87, 0xffff0000, v87
    v_pk_fma_f32 v[112:113], v[112:113], v[108:109], s[16:17] op_sel:[0,0,0] op_sel_hi:[1,0,0]
    v_pk_fma_f32 v[82:83], v[82:83], v[108:109], s[16:17] op_sel:[0,0,0] op_sel_hi:[1,0,0]
    v_pk_fma_f32 v[114:115], v[114:115], v[108:109], s[16:17] op_sel:[0,1,0] op_sel_hi:[1,1,0]
    v_pk_fma_f32 v[84:85], v[84:85], v[108:109], s[16:17] op_sel:[0,1,0] op_sel_hi:[1,1,0]
    v_pk_fma_f32 v[116:117], v[116:117], v[110:111], s[16:17] op_sel:[0,0,0] op_sel_hi:[1,0,0]
    v_pk_fma_f32 v[86:87], v[86:87], v[110:111], s[16:17] op_sel:[0,0,0] op_sel_hi:[1,0,0]
    v_perm_b32 v83, v83, v82, s17
    v_perm_b32 v82, v113, v112, s17
    v_perm_b32 v85, v85, v84, s17
    v_perm_b32 v84, v115, v114, s17
    v_perm_b32 v87, v87, v86, s17
    v_perm_b32 v86, v117, v116, s17
    v_lshl_add_u64 v[82:83], v[82:83], 0, s[20:21]
    v_lshl_add_u64 v[84:85], v[84:85], 0, s[20:21]
    v_lshl_add_u64 v[86:87], v[86:87], 0, s[20:21]
    s_waitcnt lgkmcnt(1)
    v_or3_b32 v4, v44, v45, v4
    v_or3_b32 v4, v46, v47, v4
    v_or3_b32 v4, v48, v49, v4
    ds_add_rtn_u64 v[44:45], v20, v[82:83]
    ds_add_rtn_u64 v[46:47], v21, v[84:85]
    ds_add_rtn_u64 v[48:49], v22, v[86:87]
    s_waitcnt lgkmcnt(3)
    v_lshl_add_u32 v118, v119, 4, v118
    buffer_load_dwordx4 v[20:23], v118, s[44:47], s36 offen offset:3072
    s_cmp_le_u32 s28, 256
    s_cbranch_scc1 L_p2_kernel_noopt_5
    v_readlane_b32 s38, v7, 8
    v_readlane_b32 s39, v7, 9
    s_nop 1
    v_mbcnt_lo_u32_b32 v118, s38, 0
    v_mbcnt_hi_u32_b32 v118, s39, v118
    s_bcnt1_i32_b64 s14, s[38:39]
    v_lshl_add_u32 v119, v118, 1, s25
    ds_read_u16 v119, v119
    v_mad_u32_u24 v118, v118, s23, v2
    s_mov_b32 s38, s26
    s_lshl1_add_u32 s25, s14, s25
    s_mul_i32 s14, s14, s23
    s_add_u32 s26, s26, s14
    s_waitcnt lgkmcnt(0)
    s_add_u32 s38, s38, 4096
    v_lshl_add_u32 v118, v119, 4, v118
    buffer_load_dwordx4 v[24:27], v118, s[44:47], s38 offen offset:0
L_p2_kernel_noopt_5:
    v_mad_u32_u16 v108, v28, v50, s40 op_sel:[1,0,0,0]
    v_mad_u32_u16 v109, v36, v50, s41 op_sel:[1,0,0,0]
    v_sub_u32_sdwa v110, v109, v108 dst_sel:DWORD dst_unused:UNUSED_PAD src0_sel:WORD_1 src1_sel:WORD_1
    s_nop 1
    v_add_u32_dpp v110, v110, v110 row_shr:1 row_mask:0xf bank_mask:0xf bound_ctrl:0
    s_nop 1
    v_add_u32_dpp v110, v110, v110 row_shr:2 row_mask:0xf bank_mask:0xf bound_ctrl:0
    s_nop 1
    v_add_u32_dpp v110, v110, v110 row_shr:4 row_mask:0xf bank_mask:0xf bound_ctrl:0
    s_nop 1
    v_add_u32_dpp v110, v110, v110 row_shr:8 row_mask:0xf bank_mask:0xf bound_ctrl:0
    s_nop 1
    v_add_u32_dpp v110, v110, v110 row_bcast:15 row_mask:0xa bank_mask:0xf
    s_nop 1
    v_add_u32_dpp v110, v110, v110 row_bcast:31 row_mask:0xc bank_mask:0xf
    v_sub_u32_sdwa v109, v109, v110 dst_sel:DWORD dst_unused:UNUSED_PAD src0_sel:WORD_1 src1_sel:DWORD
    v_readlane_b32 s29, v110, 63
    v_add_u32 v110, -1, v110
    ds_write_b16 v126, v109
    v_lshlrev_b32_e64 v111, v110, 1
    v_lshrrev_b32 v110, 5, v110
    v_lshl_add_u32 v110, v110, 2, s19
    s_cmp_gt_u32 s29, 320
    s_cselect_b32 s2, 1, s2
    s_cselect_b64 exec, 0, -1
    ds_or_b32 v110, v111 offset:160
    s_mov_b64 exec, -1
    ds_wrxchg_rtn_b32 v7, v6, v5 offset:160
    s_add_u32 s14, s22, 80000
    buffer_load_dwordx4 v[88:91], v1, s[8:11], s14 offen
    s_add_u32 s14, s22, 96384
    buffer_load_dwordx4 v[92:95], v1, s[8:11], s14 offen
    s_add_u32 s24, s24, 1
    s_cmp_lt_u32 s24, 8
    s_barrier
    s_cbranch_scc1 L_p2_loop
    s_waitcnt lgkmcnt(3)
    v_or3_b32 v4, v44, v45, v4
    v_or3_b32 v4, v46, v47, v4
    v_or3_b32 v4, v48, v49, v4
    s_mov_b32 s27, s19
    s_waitcnt vmcnt(0)
    v_mov_b32 v8, 160232
    s_cmp_lg_u32 s13, 0
    s_cselect_b64 exec, 0, 1
    ds_write_b32 v8, v52
    s_mov_b64 exec, -1
    v_subrev_u32 v6, 80000, v124
    s_mul_i32 s24, s12, 20000
    v_subrev_u32 v10, s24, v1
    v_mov_b32 v11, 0x7f000000
    s_waitcnt vmcnt(0) lgkmcnt(0)
    s_barrier
    s_cmp_lt_u32 s13, 4
    s_cbranch_scc1 L_p2_ga
    v_lshlrev_b32 v30, 16, v60
    v_and_b32 v31, 0xffff0000, v60
    v_lshlrev_b32 v36, 16, v53
    v_and_b32 v37, 0xffff0000, v53
    v_lshlrev_b32 v38, 16, v54
    v_and_b32 v39, 0xffff0000, v54
    v_lshlrev_b32 v40, 16, v56
    v_and_b32 v41, 0xffff0000, v56
    v_lshlrev_b32 v42, 16, v57
    v_and_b32 v43, 0xffff0000, v57
    v_pk_add_f32 v[14:15], v[30:31], v[36:37] op_sel:[0,0] op_sel_hi:[1,0] neg_lo:[0,1] neg_hi:[0,1]
    v_pk_add_f32 v[16:17], v[30:31], v[36:37] op_sel:[0,1] op_sel_hi:[1,1] neg_lo:[0,1] neg_hi:[0,1]
    v_pk_add_f32 v[18:19], v[30:31], v[38:39] op_sel:[0,0] op_sel_hi:[1,0] neg_lo:[0,1] neg_hi:[0,1]
    v_pk_add_f32 v[20:21], v[30:31], v[38:39] op_sel:[0,1] op_sel_hi:[1,1] neg_lo:[0,1] neg_hi:[0,1]
    v_pk_add_f32 v[22:23], v[30:31], v[40:41] op_sel:[0,0] op_sel_hi:[1,0] neg_lo:[0,1] neg_hi:[0,1]
    v_pk_add_f32 v[24:25], v[30:31], v[40:41] op_sel:[0,1] op_sel_hi:[1,1] neg_lo:[0,1] neg_hi:[0,1]
    v_pk_add_f32 v[26:27], v[30:31], v[42:43] op_sel:[0,0] op_sel_hi:[1,0] neg_lo:[0,1] neg_hi:[0,1]
    v_pk_add_f32 v[28:29], v[30:31], v[42:43] op_sel:[0,1] op_sel_hi:[1,1] neg_lo:[0,1] neg_hi:[0,1]
    v_cvt_pk_bf16_f32 v32, v14, v15
    v_lshlrev_b32 v14, 16, v32
    v_and_b32 v15, 0xffff0000, v32
    v_cvt_pk_bf16_f32 v32, v16, v17
    v_lshlrev_b32 v16, 16, v32
    v_and_b32 v17, 0xffff0000, v32
    v_cvt_pk_bf16_f32 v32, v18, v19
    v_lshlrev_b32 v18, 16, v32
    v_and_b32 v19, 0xffff0000, v32
    v_cvt_pk_bf16_f32 v32, v20, v21
    v_lshlrev_b32 v20, 16, v32
    v_and_b32 v21, 0xffff0000, v32
    v_cvt_pk_bf16_f32 v32, v22, v23
    v_lshlrev_b32 v22, 16, v32
    v_and_b32 v23, 0xffff0000, v32
    v_cvt_pk_bf16_f32 v32, v24, v25
    v_lshlrev_b32 v24, 16, v32
    v_and_b32 v25, 0xffff0000, v32
    v_cvt_pk_bf16_f32 v32, v26, v27
    v_lshlrev_b32 v26, 16, v32
    v_and_b32 v27, 0xffff0000, v32
    v_cvt_pk_bf16_f32 v32, v28, v29
    v_lshlrev_b32 v28, 16, v32
    v_and_b32 v29, 0xffff0000, v32
    v_pk_mul_f32 v[14:15], v[14:15], v[14:15]
    v_pk_mul_f32 v[16:17], v[16:17], v[16:17]
    v_pk_mul_f32 v[18:19], v[18:19], v[18:19]
    v_pk_mul_f32 v[20:21], v[20:21], v[20:21]
    v_pk_mul_f32 v[22:23], v[22:23], v[22:23]
    v_pk_mul_f32 v[24:25], v[24:25], v[24:25]
    v_pk_mul_f32 v[26:27], v[26:27], v[26:27]
    v_pk_mul_f32 v[28:29], v[28:29], v[28:29]
    v_cvt_pk_bf16_f32 v32, v14, v15
    v_lshlrev_b32 v14, 16, v32
    v_and_b32 v15, 0xffff0000, v32
    v_cvt_pk_bf16_f32 v32, v16, v17
    v_lshlrev_b32 v16, 16, v32
    v_and_b32 v17, 0xffff0000, v32
    v_cvt_pk_bf16_f32 v32, v18, v19
    v_lshlrev_b32 v18, 16, v32
    v_and_b32 v19, 0xffff0000, v32
    v_cvt_pk_bf16_f32 v32, v20, v21
    v_lshlrev_b32 v20, 16, v32
    v_and_b32 v21, 0xffff0000, v32
    v_cvt_pk_bf16_f32 v32, v22, v23
    v_lshlrev_b32 v22, 16, v32
    v_and_b32 v23, 0xffff0000, v32
    v_cvt_pk_bf16_f32 v32, v24, v25
    v_lshlrev_b32 v24, 16, v32
    v_and_b32 v25, 0xffff0000, v32
    v_cvt_pk_bf16_f32 v32, v26, v27
    v_lshlrev_b32 v26, 16, v32
    v_and_b32 v27, 0xffff0000, v32
    v_cvt_pk_bf16_f32 v32, v28, v29
    v_lshlrev_b32 v28, 16, v32
    v_and_b32 v29, 0xffff0000, v32
    v_mov_b32 v30, 1092616192
    v_mov_b32 v31, 0x3fb8aa3b
    v_pk_mul_f32 v[14:15], v[14:15], v[30:31] op_sel:[0,0] op_sel_hi:[1,0]
    v_pk_mul_f32 v[16:17], v[16:17], v[30:31] op_sel:[0,0] op_sel_hi:[1,0]
    v_pk_mul_f32 v[18:19], v[18:19], v[30:31] op_sel:[0,0] op_sel_hi:[1,0]
    v_pk_mul_f32 v[20:21], v[20:21], v[30:31] op_sel:[0,0] op_sel_hi:[1,0]
    v_pk_mul_f32 v[22:23], v[22:23], v[30:31] op_sel:[0,0] op_sel_hi:[1,0]
    v_pk_mul_f32 v[24:25], v[24:25], v[30:31] op_sel:[0,0] op_sel_hi:[1,0]
    v_pk_mul_f32 v[26:27], v[26:27], v[30:31] op_sel:[0,0] op_sel_hi:[1,0]
    v_pk_mul_f32 v[28:29], v[28:29], v[30:31] op_sel:[0,0] op_sel_hi:[1,0]
    v_cvt_pk_bf16_f32 v32, v14, v15
    v_lshlrev_b32 v14, 16, v32
    v_and_b32 v15, 0xffff0000, v32
    v_cvt_pk_bf16_f32 v32, v16, v17
    v_lshlrev_b32 v16, 16, v32
    v_and_b32 v17, 0xffff0000, v32
    v_cvt_pk_bf16_f32 v32, v18, v19
    v_lshlrev_b32 v18, 16, v32
    v_and_b32 v19, 0xffff0000, v32
    v_cvt_pk_bf16_f32 v32, v20, v21
    v_lshlrev_b32 v20, 16, v32
    v_and_b32 v21, 0xffff0000, v32
    v_cvt_pk_bf16_f32 v32, v22, v23
    v_lshlrev_b32 v22, 16, v32
    v_and_b32 v23, 0xffff0000, v32
    v_cvt_pk_bf16_f32 v32, v24, v25
    v_lshlrev_b32 v24, 16, v32
    v_and_b32 v25, 0xffff0000, v32
    v_cvt_pk_bf16_f32 v32, v26, v27
    v_lshlrev_b32 v26, 16, v32
    v_and_b32 v27, 0xffff0000, v32
    v_cvt_pk_bf16_f32 v32, v28, v29
    v_lshlrev_b32 v28, 16, v32
    v_and_b32 v29, 0xffff0000, v32
    v_pk_mul_f32 v[14:15], v[14:15], v[30:31] op_sel:[0,1] op_sel_hi:[1,1]
    v_pk_mul_f32 v[16:17], v[16:17], v[30:31] op_sel:[0,1] op_sel_hi:[1,1]
    v_pk_mul_f32 v[18:19], v[18:19], v[30:31] op_sel:[0,1] op_sel_hi:[1,1]
    v_pk_mul_f32 v[20:21], v[20:21], v[30:31] op_sel:[0,1] op_sel_hi:[1,1]
    v_pk_mul_f32 v[22:23], v[22:23], v[30:31] op_sel:[0,1] op_sel_hi:[1,1]
    v_pk_mul_f32 v[24:25], v[24:25], v[30:31] op_sel:[0,1] op_sel_hi:[1,1]
    v_pk_mul_f32 v[26:27], v[26:27], v[30:31] op_sel:[0,1] op_sel_hi:[1,1]
    v_pk_mul_f32 v[28:29], v[28:29], v[30:31] op_sel:[0,1] op_sel_hi:[1,1]
    v_exp_f32 v14, -v14
    v_exp_f32 v15, -v15
    v_exp_f32 v16, -v16
    v_exp_f32 v17, -v17
    v_exp_f32 v18, -v18
    v_exp_f32 v19, -v19
    v_exp_f32 v20, -v20
    v_exp_f32 v21, -v21
    v_exp_f32 v22, -v22
    v_exp_f32 v23, -v23
    v_exp_f32 v24, -v24
    v_exp_f32 v25, -v25
    v_exp_f32 v26, -v26
    v_exp_f32 v27, -v27
    v_exp_f32 v28, -v28
    v_exp_f32 v29, -v29
    v_cvt_pk_bf16_f32 v14, v14, v16
    v_cvt_pk_bf16_f32 v15, v15, v17
    v_cvt_pk_bf16_f32 v18, v18, v20
    v_cvt_pk_bf16_f32 v19, v19, v21
    v_cvt_pk_bf16_f32 v22, v22, v24
    v_cvt_pk_bf16_f32 v23, v23, v25
    v_cvt_pk_bf16_f32 v26, v26, v28
    v_cvt_pk_bf16_f32 v27, v27, v29
    v_dot2_f32_bf16 v72, v14, s68, 0
    v_dot2_f32_bf16 v73, v15, s68, 0
    v_dot2_f32_bf16 v74, v14, s69, 0
    v_dot2_f32_bf16 v75, v15, s69, 0
    v_dot2_f32_bf16 v76, v14, s70, 0
    v_dot2_f32_bf16 v77, v15, s70, 0
    v_dot2_f32_bf16 v78, v14, s71, 0
    v_dot2_f32_bf16 v79, v15, s71, 0
    v_dot2_f32_bf16 v80, v14, s52, 0
    v_dot2_f32_bf16 v81, v15, s52, 0
    v_dot2_f32_bf16 v82, v14, s53, 0
    v_dot2_f32_bf16 v83, v15, s53, 0
    v_dot2_f32_bf16 v84, v14, s54, 0
    v_dot2_f32_bf16 v85, v15, s54, 0
    v_dot2_f32_bf16 v86, v14, s55, 0
    v_dot2_f32_bf16 v87, v15, s55, 0
    v_dot2_f32_bf16 v72, v18, s72, v72
    v_dot2_f32_bf16 v73, v19, s72, v73
    v_dot2_f32_bf16 v74, v18, s73, v74
    v_dot2_f32_bf16 v75, v19, s73, v75
    v_dot2_f32_bf16 v76, v18, s74, v76
    v_dot2_f32_bf16 v77, v19, s74, v77
    v_dot2_f32_bf16 v78, v18, s75, v78
    v_dot2_f32_bf16 v79, v19, s75, v79
    v_dot2_f32_bf16 v80, v18, s56, v80
    v_dot2_f32_bf16 v81, v19, s56, v81
    v_dot2_f32_bf16 v82, v18, s57, v82
    v_dot2_f32_bf16 v83, v19, s57, v83
    v_dot2_f32_bf16 v84, v18, s58, v84
    v_dot2_f32_bf16 v85, v19, s58, v85
    v_dot2_f32_bf16 v86, v18, s59, v86
    v_dot2_f32_bf16 v87, v19, s59, v87
    v_dot2_f32_bf16 v72, v22, s76, v72
    v_dot2_f32_bf16 v73, v23, s76, v73
    v_dot2_f32_bf16 v74, v22, s77, v74
    v_dot2_f32_bf16 v75, v23, s77, v75
    v_dot2_f32_bf16 v76, v22, s78, v76
    v_dot2_f32_bf16 v77, v23, s78, v77
    v_dot2_f32_bf16 v78, v22, s79, v78
    v_dot2_f32_bf16 v79, v23, s79, v79
    v_dot2_f32_bf16 v80, v22, s60, v80
    v_dot2_f32_bf16 v81, v23, s60, v81
    v_dot2_f32_bf16 v82, v22, s61, v82
    v_dot2_f32_bf16 v83, v23, s61, v83
    v_dot2_f32_bf16 v84, v22, s62, v84
    v_dot2_f32_bf16 v85, v23, s62, v85
    v_dot2_f32_bf16 v86, v22, s63, v86
    v_dot2_f32_bf16 v87, v23, s63, v87
    v_dot2_f32_bf16 v72, v26, s80, v72
    v_dot2_f32_bf16 v73, v27, s80, v73
    v_dot2_f32_bf16 v74, v26, s81, v74
    v_dot2_f32_bf16 v75, v27, s81, v75
    v_dot2_f32_bf16 v76, v26, s82, v76
    v_dot2_f32_bf16 v77, v27, s82, v77
    v_dot2_f32_bf16 v78, v26, s83, v78
    v_dot2_f32_bf16 v79, v27, s83, v79
    v_dot2_f32_bf16 v80, v26, s64, v80
    v_dot2_f32_bf16 v81, v27, s64, v81
    v_dot2_f32_bf16 v82, v26, s65, v82
    v_dot2_f32_bf16 v83, v27, s65, v83
    v_dot2_f32_bf16 v84, v26, s66, v84
    v_dot2_f32_bf16 v85, v27, s66, v85
    v_dot2_f32_bf16 v86, v26, s67, v86
    v_dot2_f32_bf16 v87, v27, s67, v87
L_p2_ga:
    ds_read_b32 v9, v8
    ds_read_b128 v[88:91], v1 offset:0
    ds_read_b128 v[92:95], v1 offset:16384
    ds_read_b128 v[96:99], v1 offset:32768
    ds_read_b128 v[100:103], v1 offset:49152
    ds_read_b128 v[104:107], v6
    s_mul_i32 s14, s12, 5120000
    s_mul_i32 s15, s3, 80000
    s_add_u32 s25, s14, s15
    s_add_u32 s25, s25, 232727040
    s_waitcnt lgkmcnt(5)
    v_readfirstlane_b32 s21, v9
    s_nop 0
    s_bfe_u32 s21, s21, 524296
    s_cmp_lg_u32 s21, 4
    s_cselect_b32 s21, 1, 0
    s_cselect_b32 s24, 0, 20000
    v_cmp_le_u32 vcc, s24, v10
    v_add_u32 v10, 16384, v10
    s_add_u32 s14, s25, 0
    v_cndmask_b32 v12, v11, v1, vcc
    s_waitcnt lgkmcnt(4)
    buffer_store_dwordx4 v[88:91], v12, s[4:7], s14 offen sc1
    v_or3_b32 v4, v88, v89, v4
    v_or3_b32 v4, v90, v91, v4
    v_cmp_le_u32 vcc, s24, v10
    v_add_u32 v10, 16384, v10
    s_add_u32 s14, s25, 16384
    v_cndmask_b32 v12, v11, v1, vcc
    s_waitcnt lgkmcnt(3)
    buffer_store_dwordx4 v[92:95], v12, s[4:7], s14 offen sc1
    v_or3_b32 v4, v92, v93, v4
    v_or3_b32 v4, v94, v95, v4
    v_cmp_le_u32 vcc, s24, v10
    v_add_u32 v10, 16384, v10
    s_add_u32 s14, s25, 32768
    v_cndmask_b32 v12, v11, v1, vcc
    s_waitcnt lgkmcnt(2)
    buffer_store_dwordx4 v[96:99], v12, s[4:7], s14 offen sc1
    v_or3_b32 v4, v96, v97, v4
    v_or3_b32 v4, v98, v99, v4
    v_cmp_le_u32 vcc, s24, v10
    v_add_u32 v10, 16384, v10
    s_add_u32 s14, s25, 49152
    v_cndmask_b32 v12, v11, v1, vcc
    s_waitcnt lgkmcnt(1)
    buffer_store_dwordx4 v[100:103], v12, s[4:7], s14 offen sc1
    v_or3_b32 v4, v100, v101, v4
    v_or3_b32 v4, v102, v103, v4
    v_cmp_le_u32 vcc, s24, v10
    v_add_u32 v10, 16384, v10
    s_add_u32 s14, s25, 0
    v_cndmask_b32 v12, v11, v6, vcc
    s_waitcnt lgkmcnt(0)
    buffer_store_dwordx4 v[104:107], v12, s[4:7], s14 offen sc1
    v_or3_b32 v4, v104, v105, v4
    v_or3_b32 v4, v106, v107, v4
    s_load_dwordx2 s[16:17], s[0:1], 88
    s_cmp_ge_u32 s13, 4
    s_cbranch_scc1 L_p2_gb
    v_lshlrev_b32 v30, 16, v60
    v_and_b32 v31, 0xffff0000, v60
    v_lshlrev_b32 v36, 16, v53
    v_and_b32 v37, 0xffff0000, v53
    v_lshlrev_b32 v38, 16, v54
    v_and_b32 v39, 0xffff0000, v54
    v_lshlrev_b32 v40, 16, v56
    v_and_b32 v41, 0xffff0000, v56
    v_lshlrev_b32 v42, 16, v57
    v_and_b32 v43, 0xffff0000, v57
    v_pk_add_f32 v[14:15], v[30:31], v[36:37] op_sel:[0,0] op_sel_hi:[1,0] neg_lo:[0,1] neg_hi:[0,1]
    v_pk_add_f32 v[16:17], v[30:31], v[36:37] op_sel:[0,1] op_sel_hi:[1,1] neg_lo:[0,1] neg_hi:[0,1]
    v_pk_add_f32 v[18:19], v[30:31], v[38:39] op_sel:[0,0] op_sel_hi:[1,0] neg_lo:[0,1] neg_hi:[0,1]
    v_pk_add_f32 v[20:21], v[30:31], v[38:39] op_sel:[0,1] op_sel_hi:[1,1] neg_lo:[0,1] neg_hi:[0,1]
    v_pk_add_f32 v[22:23], v[30:31], v[40:41] op_sel:[0,0] op_sel_hi:[1,0] neg_lo:[0,1] neg_hi:[0,1]
    v_pk_add_f32 v[24:25], v[30:31], v[40:41] op_sel:[0,1] op_sel_hi:[1,1] neg_lo:[0,1] neg_hi:[0,1]
    v_pk_add_f32 v[26:27], v[30:31], v[42:43] op_sel:[0,0] op_sel_hi:[1,0] neg_lo:[0,1] neg_hi:[0,1]
    v_pk_add_f32 v[28:29], v[30:31], v[42:43] op_sel:[0,1] op_sel_hi:[1,1] neg_lo:[0,1] neg_hi:[0,1]
    v_cvt_pk_bf16_f32 v32, v14, v15
    v_lshlrev_b32 v14, 16, v32
    v_and_b32 v15, 0xffff0000, v32
    v_cvt_pk_bf16_f32 v32, v16, v17
    v_lshlrev_b32 v16, 16, v32
    v_and_b32 v17, 0xffff0000, v32
    v_cvt_pk_bf16_f32 v32, v18, v19
    v_lshlrev_b32 v18, 16, v32
    v_and_b32 v19, 0xffff0000, v32
    v_cvt_pk_bf16_f32 v32, v20, v21
    v_lshlrev_b32 v20, 16, v32
    v_and_b32 v21, 0xffff0000, v32
    v_cvt_pk_bf16_f32 v32, v22, v23
    v_lshlrev_b32 v22, 16, v32
    v_and_b32 v23, 0xffff0000, v32
    v_cvt_pk_bf16_f32 v32, v24, v25
    v_lshlrev_b32 v24, 16, v32
    v_and_b32 v25, 0xffff0000, v32
    v_cvt_pk_bf16_f32 v32, v26, v27
    v_lshlrev_b32 v26, 16, v32
    v_and_b32 v27, 0xffff0000, v32
    v_cvt_pk_bf16_f32 v32, v28, v29
    v_lshlrev_b32 v28, 16, v32
    v_and_b32 v29, 0xffff0000, v32
    v_pk_mul_f32 v[14:15], v[14:15], v[14:15]
    v_pk_mul_f32 v[16:17], v[16:17], v[16:17]
    v_pk_mul_f32 v[18:19], v[18:19], v[18:19]
    v_pk_mul_f32 v[20:21], v[20:21], v[20:21]
    v_pk_mul_f32 v[22:23], v[22:23], v[22:23]
    v_pk_mul_f32 v[24:25], v[24:25], v[24:25]
    v_pk_mul_f32 v[26:27], v[26:27], v[26:27]
    v_pk_mul_f32 v[28:29], v[28:29], v[28:29]
    v_cvt_pk_bf16_f32 v32, v14, v15
    v_lshlrev_b32 v14, 16, v32
    v_and_b32 v15, 0xffff0000, v32
    v_cvt_pk_bf16_f32 v32, v16, v17
    v_lshlrev_b32 v16, 16, v32
    v_and_b32 v17, 0xffff0000, v32
    v_cvt_pk_bf16_f32 v32, v18, v19
    v_lshlrev_b32 v18, 16, v32
    v_and_b32 v19, 0xffff0000, v32
    v_cvt_pk_bf16_f32 v32, v20, v21
    v_lshlrev_b32 v20, 16, v32
    v_and_b32 v21, 0xffff0000, v32
    v_cvt_pk_bf16_f32 v32, v22, v23
    v_lshlrev_b32 v22, 16, v32
    v_and_b32 v23, 0xffff0000, v32
    v_cvt_pk_bf16_f32 v32, v24, v25
    v_lshlrev_b32 v24, 16, v32
    v_and_b32 v25, 0xffff0000, v32
    v_cvt_pk_bf16_f32 v32, v26, v27
    v_lshlrev_b32 v26, 16, v32
    v_and_b32 v27, 0xffff0000, v32
    v_cvt_pk_bf16_f32 v32, v28, v29
    v_lshlrev_b32 v28, 16, v32
    v_and_b32 v29, 0xffff0000, v32
    v_mov_b32 v30, 1092616192
    v_mov_b32 v31, 0x3fb8aa3b
    v_pk_mul_f32 v[14:15], v[14:15], v[30:31] op_sel:[0,0] op_sel_hi:[1,0]
    v_pk_mul_f32 v[16:17], v[16:17], v[30:31] op_sel:[0,0] op_sel_hi:[1,0]
    v_pk_mul_f32 v[18:19], v[18:19], v[30:31] op_sel:[0,0] op_sel_hi:[1,0]
    v_pk_mul_f32 v[20:21], v[20:21], v[30:31] op_sel:[0,0] op_sel_hi:[1,0]
    v_pk_mul_f32 v[22:23], v[22:23], v[30:31] op_sel:[0,0] op_sel_hi:[1,0]
    v_pk_mul_f32 v[24:25], v[24:25], v[30:31] op_sel:[0,0] op_sel_hi:[1,0]
    v_pk_mul_f32 v[26:27], v[26:27], v[30:31] op_sel:[0,0] op_sel_hi:[1,0]
    v_pk_mul_f32 v[28:29], v[28:29], v[30:31] op_sel:[0,0] op_sel_hi:[1,0]
    v_cvt_pk_bf16_f32 v32, v14, v15
    v_lshlrev_b32 v14, 16, v32
    v_and_b32 v15, 0xffff0000, v32
    v_cvt_pk_bf16_f32 v32, v16, v17
    v_lshlrev_b32 v16, 16, v32
    v_and_b32 v17, 0xffff0000, v32
    v_cvt_pk_bf16_f32 v32, v18, v19
    v_lshlrev_b32 v18, 16, v32
    v_and_b32 v19, 0xffff0000, v32
    v_cvt_pk_bf16_f32 v32, v20, v21
    v_lshlrev_b32 v20, 16, v32
    v_and_b32 v21, 0xffff0000, v32
    v_cvt_pk_bf16_f32 v32, v22, v23
    v_lshlrev_b32 v22, 16, v32
    v_and_b32 v23, 0xffff0000, v32
    v_cvt_pk_bf16_f32 v32, v24, v25
    v_lshlrev_b32 v24, 16, v32
    v_and_b32 v25, 0xffff0000, v32
    v_cvt_pk_bf16_f32 v32, v26, v27
    v_lshlrev_b32 v26, 16, v32
    v_and_b32 v27, 0xffff0000, v32
    v_cvt_pk_bf16_f32 v32, v28, v29
    v_lshlrev_b32 v28, 16, v32
    v_and_b32 v29, 0xffff0000, v32
    v_pk_mul_f32 v[14:15], v[14:15], v[30:31] op_sel:[0,1] op_sel_hi:[1,1]
    v_pk_mul_f32 v[16:17], v[16:17], v[30:31] op_sel:[0,1] op_sel_hi:[1,1]
    v_pk_mul_f32 v[18:19], v[18:19], v[30:31] op_sel:[0,1] op_sel_hi:[1,1]
    v_pk_mul_f32 v[20:21], v[20:21], v[30:31] op_sel:[0,1] op_sel_hi:[1,1]
    v_pk_mul_f32 v[22:23], v[22:23], v[30:31] op_sel:[0,1] op_sel_hi:[1,1]
    v_pk_mul_f32 v[24:25], v[24:25], v[30:31] op_sel:[0,1] op_sel_hi:[1,1]
    v_pk_mul_f32 v[26:27], v[26:27], v[30:31] op_sel:[0,1] op_sel_hi:[1,1]
    v_pk_mul_f32 v[28:29], v[28:29], v[30:31] op_sel:[0,1] op_sel_hi:[1,1]
    v_exp_f32 v14, -v14
    v_exp_f32 v15, -v15
    v_exp_f32 v16, -v16
    v_exp_f32 v17, -v17
    v_exp_f32 v18, -v18
    v_exp_f32 v19, -v19
    v_exp_f32 v20, -v20
    v_exp_f32 v21, -v21
    v_exp_f32 v22, -v22
    v_exp_f32 v23, -v23
    v_exp_f32 v24, -v24
    v_exp_f32 v25, -v25
    v_exp_f32 v26, -v26
    v_exp_f32 v27, -v27
    v_exp_f32 v28, -v28
    v_exp_f32 v29, -v29
    v_cvt_pk_bf16_f32 v14, v14, v16
    v_cvt_pk_bf16_f32 v15, v15, v17
    v_cvt_pk_bf16_f32 v18, v18, v20
    v_cvt_pk_bf16_f32 v19, v19, v21
    v_cvt_pk_bf16_f32 v22, v22, v24
    v_cvt_pk_bf16_f32 v23, v23, v25
    v_cvt_pk_bf16_f32 v26, v26, v28
    v_cvt_pk_bf16_f32 v27, v27, v29
    v_dot2_f32_bf16 v72, v14, s68, 0
    v_dot2_f32_bf16 v73, v15, s68, 0
    v_dot2_f32_bf16 v74, v14, s69, 0
    v_dot2_f32_bf16 v75, v15, s69, 0
    v_dot2_f32_bf16 v76, v14, s70, 0
    v_dot2_f32_bf16 v77, v15, s70, 0
    v_dot2_f32_bf16 v78, v14, s71, 0
    v_dot2_f32_bf16 v79, v15, s71, 0
    v_dot2_f32_bf16 v80, v14, s52, 0
    v_dot2_f32_bf16 v81, v15, s52, 0
    v_dot2_f32_bf16 v82, v14, s53, 0
    v_dot2_f32_bf16 v83, v15, s53, 0
    v_dot2_f32_bf16 v84, v14, s54, 0
    v_dot2_f32_bf16 v85, v15, s54, 0
    v_dot2_f32_bf16 v86, v14, s55, 0
    v_dot2_f32_bf16 v87, v15, s55, 0
    v_dot2_f32_bf16 v72, v18, s72, v72
    v_dot2_f32_bf16 v73, v19, s72, v73
    v_dot2_f32_bf16 v74, v18, s73, v74
    v_dot2_f32_bf16 v75, v19, s73, v75
    v_dot2_f32_bf16 v76, v18, s74, v76
    v_dot2_f32_bf16 v77, v19, s74, v77
    v_dot2_f32_bf16 v78, v18, s75, v78
    v_dot2_f32_bf16 v79, v19, s75, v79
    v_dot2_f32_bf16 v80, v18, s56, v80
    v_dot2_f32_bf16 v81, v19, s56, v81
    v_dot2_f32_bf16 v82, v18, s57, v82
    v_dot2_f32_bf16 v83, v19, s57, v83
    v_dot2_f32_bf16 v84, v18, s58, v84
    v_dot2_f32_bf16 v85, v19, s58, v85
    v_dot2_f32_bf16 v86, v18, s59, v86
    v_dot2_f32_bf16 v87, v19, s59, v87
    v_dot2_f32_bf16 v72, v22, s76, v72
    v_dot2_f32_bf16 v73, v23, s76, v73
    v_dot2_f32_bf16 v74, v22, s77, v74
    v_dot2_f32_bf16 v75, v23, s77, v75
    v_dot2_f32_bf16 v76, v22, s78, v76
    v_dot2_f32_bf16 v77, v23, s78, v77
    v_dot2_f32_bf16 v78, v22, s79, v78
    v_dot2_f32_bf16 v79, v23, s79, v79
    v_dot2_f32_bf16 v80, v22, s60, v80
    v_dot2_f32_bf16 v81, v23, s60, v81
    v_dot2_f32_bf16 v82, v22, s61, v82
    v_dot2_f32_bf16 v83, v23, s61, v83
    v_dot2_f32_bf16 v84, v22, s62, v84
    v_dot2_f32_bf16 v85, v23, s62, v85
    v_dot2_f32_bf16 v86, v22, s63, v86
    v_dot2_f32_bf16 v87, v23, s63, v87
    v_dot2_f32_bf16 v72, v26, s80, v72
    v_dot2_f32_bf16 v73, v27, s80, v73
    v_dot2_f32_bf16 v74, v26, s81, v74
    v_dot2_f32_bf16 v75, v27, s81, v75
    v_dot2_f32_bf16 v76, v26, s82, v76
    v_dot2_f32_bf16 v77, v27, s82, v77
    v_dot2_f32_bf16 v78, v26, s83, v78
    v_dot2_f32_bf16 v79, v27, s83, v79
    v_dot2_f32_bf16 v80, v26, s64, v80
    v_dot2_f32_bf16 v81, v27, s64, v81
    v_dot2_f32_bf16 v82, v26, s65, v82
    v_dot2_f32_bf16 v83, v27, s65, v83
    v_dot2_f32_bf16 v84, v26, s66, v84
    v_dot2_f32_bf16 v85, v27, s66, v85
    v_dot2_f32_bf16 v86, v26, s67, v86
    v_dot2_f32_bf16 v87, v27, s67, v87
    s_cmp_ge_u32 s13, 4
    s_cbranch_scc1 L_p2_kernel_g1_6
    v_lshlrev_b32 v30, 16, v61
    v_and_b32 v31, 0xffff0000, v61
    v_pk_add_f32 v[14:15], v[30:31], v[36:37] op_sel:[0,0] op_sel_hi:[1,0] neg_lo:[0,1] neg_hi:[0,1]
    v_pk_add_f32 v[16:17], v[30:31], v[36:37] op_sel:[0,1] op_sel_hi:[1,1] neg_lo:[0,1] neg_hi:[0,1]
    v_pk_add_f32 v[18:19], v[30:31], v[38:39] op_sel:[0,0] op_sel_hi:[1,0] neg_lo:[0,1] neg_hi:[0,1]
    v_pk_add_f32 v[20:21], v[30:31], v[38:39] op_sel:[0,1] op_sel_hi:[1,1] neg_lo:[0,1] neg_hi:[0,1]
    v_pk_add_f32 v[22:23], v[30:31], v[40:41] op_sel:[0,0] op_sel_hi:[1,0] neg_lo:[0,1] neg_hi:[0,1]
    v_pk_add_f32 v[24:25], v[30:31], v[40:41] op_sel:[0,1] op_sel_hi:[1,1] neg_lo:[0,1] neg_hi:[0,1]
    v_pk_add_f32 v[26:27], v[30:31], v[42:43] op_sel:[0,0] op_sel_hi:[1,0] neg_lo:[0,1] neg_hi:[0,1]
    v_pk_add_f32 v[28:29], v[30:31], v[42:43] op_sel:[0,1] op_sel_hi:[1,1] neg_lo:[0,1] neg_hi:[0,1]
    v_cvt_pk_bf16_f32 v32, v14, v15
    v_lshlrev_b32 v14, 16, v32
    v_and_b32 v15, 0xffff0000, v32
    v_cvt_pk_bf16_f32 v32, v16, v17
    v_lshlrev_b32 v16, 16, v32
    v_and_b32 v17, 0xffff0000, v32
    v_cvt_pk_bf16_f32 v32, v18, v19
    v_lshlrev_b32 v18, 16, v32
    v_and_b32 v19, 0xffff0000, v32
    v_cvt_pk_bf16_f32 v32, v20, v21
    v_lshlrev_b32 v20, 16, v32
    v_and_b32 v21, 0xffff0000, v32
    v_cvt_pk_bf16_f32 v32, v22, v23
    v_lshlrev_b32 v22, 16, v32
    v_and_b32 v23, 0xffff0000, v32
    v_cvt_pk_bf16_f32 v32, v24, v25
    v_lshlrev_b32 v24, 16, v32
    v_and_b32 v25, 0xffff0000, v32
    v_cvt_pk_bf16_f32 v32, v26, v27
    v_lshlrev_b32 v26, 16, v32
    v_and_b32 v27, 0xffff0000, v32
    v_cvt_pk_bf16_f32 v32, v28, v29
    v_lshlrev_b32 v28, 16, v32
    v_and_b32 v29, 0xffff0000, v32
    v_pk_mul_f32 v[14:15], v[14:15], v[14:15]
    v_pk_mul_f32 v[16:17], v[16:17], v[16:17]
    v_pk_mul_f32 v[18:19], v[18:19], v[18:19]
    v_pk_mul_f32 v[20:21], v[20:21], v[20:21]
    v_pk_mul_f32 v[22:23], v[22:23], v[22:23]
    v_pk_mul_f32 v[24:25], v[24:25], v[24:25]
    v_pk_mul_f32 v[26:27], v[26:27], v[26:27]
    v_pk_mul_f32 v[28:29], v[28:29], v[28:29]
    v_cvt_pk_bf16_f32 v32, v14, v15
    v_lshlrev_b32 v14, 16, v32
    v_and_b32 v15, 0xffff0000, v32
    v_cvt_pk_bf16_f32 v32, v16, v17
    v_lshlrev_b32 v16, 16, v32
    v_and_b32 v17, 0xffff0000, v32
    v_cvt_pk_bf16_f32 v32, v18, v19
    v_lshlrev_b32 v18, 16, v32
    v_and_b32 v19, 0xffff0000, v32
    v_cvt_pk_bf16_f32 v32, v20, v21
    v_lshlrev_b32 v20, 16, v32
    v_and_b32 v21, 0xffff0000, v32
    v_cvt_pk_bf16_f32 v32, v22, v23
    v_lshlrev_b32 v22, 16, v32
    v_and_b32 v23, 0xffff0000, v32
    v_cvt_pk_bf16_f32 v32, v24, v25
    v_lshlrev_b32 v24, 16, v32
    v_and_b32 v25, 0xffff0000, v32
    v_cvt_pk_bf16_f32 v32, v26, v27
    v_lshlrev_b32 v26, 16, v32
    v_and_b32 v27, 0xffff0000, v32
    v_cvt_pk_bf16_f32 v32, v28, v29
    v_lshlrev_b32 v28, 16, v32
    v_and_b32 v29, 0xffff0000, v32
    v_mov_b32 v30, 1092616192
    v_mov_b32 v31, 0x3fb8aa3b
    v_pk_mul_f32 v[14:15], v[14:15], v[30:31] op_sel:[0,0] op_sel_hi:[1,0]
    v_pk_mul_f32 v[16:17], v[16:17], v[30:31] op_sel:[0,0] op_sel_hi:[1,0]
    v_pk_mul_f32 v[18:19], v[18:19], v[30:31] op_sel:[0,0] op_sel_hi:[1,0]
    v_pk_mul_f32 v[20:21], v[20:21], v[30:31] op_sel:[0,0] op_sel_hi:[1,0]
    v_pk_mul_f32 v[22:23], v[22:23], v[30:31] op_sel:[0,0] op_sel_hi:[1,0]
    v_pk_mul_f32 v[24:25], v[24:25], v[30:31] op_sel:[0,0] op_sel_hi:[1,0]
    v_pk_mul_f32 v[26:27], v[26:27], v[30:31] op_sel:[0,0] op_sel_hi:[1,0]
    v_pk_mul_f32 v[28:29], v[28:29], v[30:31] op_sel:[0,0] op_sel_hi:[1,0]
    v_cvt_pk_bf16_f32 v32, v14, v15
    v_lshlrev_b32 v14, 16, v32
    v_and_b32 v15, 0xffff0000, v32
    v_cvt_pk_bf16_f32 v32, v16, v17
    v_lshlrev_b32 v16, 16, v32
    v_and_b32 v17, 0xffff0000, v32
    v_cvt_pk_bf16_f32 v32, v18, v19
    v_lshlrev_b32 v18, 16, v32
    v_and_b32 v19, 0xffff0000, v32
    v_cvt_pk_bf16_f32 v32, v20, v21
    v_lshlrev_b32 v20, 16, v32
    v_and_b32 v21, 0xffff0000, v32
    v_cvt_pk_bf16_f32 v32, v22, v23
    v_lshlrev_b32 v22, 16, v32
    v_and_b32 v23, 0xffff0000, v32
    v_cvt_pk_bf16_f32 v32, v24, v25
    v_lshlrev_b32 v24, 16, v32
    v_and_b32 v25, 0xffff0000, v32
    v_cvt_pk_bf16_f32 v32, v26, v27
    v_lshlrev_b32 v26, 16, v32
    v_and_b32 v27, 0xffff0000, v32
    v_cvt_pk_bf16_f32 v32, v28, v29
    v_lshlrev_b32 v28, 16, v32
    v_and_b32 v29, 0xffff0000, v32
    v_pk_mul_f32 v[14:15], v[14:15], v[30:31] op_sel:[0,1] op_sel_hi:[1,1]
    v_pk_mul_f32 v[16:17], v[16:17], v[30:31] op_sel:[0,1] op_sel_hi:[1,1]
    v_pk_mul_f32 v[18:19], v[18:19], v[30:31] op_sel:[0,1] op_sel_hi:[1,1]
    v_pk_mul_f32 v[20:21], v[20:21], v[30:31] op_sel:[0,1] op_sel_hi:[1,1]
    v_pk_mul_f32 v[22:23], v[22:23], v[30:31] op_sel:[0,1] op_sel_hi:[1,1]
    v_pk_mul_f32 v[24:25], v[24:25], v[30:31] op_sel:[0,1] op_sel_hi:[1,1]
    v_pk_mul_f32 v[26:27], v[26:27], v[30:31] op_sel:[0,1] op_sel_hi:[1,1]
    v_pk_mul_f32 v[28:29], v[28:29], v[30:31] op_sel:[0,1] op_sel_hi:[1,1]
    v_exp_f32 v14, -v14
    v_exp_f32 v15, -v15
    v_exp_f32 v16, -v16
    v_exp_f32 v17, -v17
    v_exp_f32 v18, -v18
    v_exp_f32 v19, -v19
    v_exp_f32 v20, -v20
    v_exp_f32 v21, -v21
    v_exp_f32 v22, -v22
    v_exp_f32 v23, -v23
    v_exp_f32 v24, -v24
    v_exp_f32 v25, -v25
    v_exp_f32 v26, -v26
    v_exp_f32 v27, -v27
    v_exp_f32 v28, -v28
    v_exp_f32 v29, -v29
    v_cvt_pk_bf16_f32 v14, v14, v16
    v_cvt_pk_bf16_f32 v15, v15, v17
    v_cvt_pk_bf16_f32 v18, v18, v20
    v_cvt_pk_bf16_f32 v19, v19, v21
    v_cvt_pk_bf16_f32 v22, v22, v24
    v_cvt_pk_bf16_f32 v23, v23, v25
    v_cvt_pk_bf16_f32 v26, v26, v28
    v_cvt_pk_bf16_f32 v27, v27, v29
    v_dot2_f32_bf16 v112, v14, s68, 0
    v_dot2_f32_bf16 v113, v15, s68, 0
    v_dot2_f32_bf16 v114, v14, s69, 0
    v_dot2_f32_bf16 v115, v15, s69, 0
    v_dot2_f32_bf16 v116, v14, s70, 0
    v_dot2_f32_bf16 v117, v15, s70, 0
    v_dot2_f32_bf16 v118, v14, s71, 0
    v_dot2_f32_bf16 v119, v15, s71, 0
    v_dot2_f32_bf16 v120, v14, s52, 0
    v_dot2_f32_bf16 v121, v15, s52, 0
    v_dot2_f32_bf16 v122, v14, s53, 0
    v_dot2_f32_bf16 v123, v15, s53, 0
    v_dot2_f32_bf16 v124, v14, s54, 0
    v_dot2_f32_bf16 v125, v15, s54, 0
    v_dot2_f32_bf16 v126, v14, s55, 0
    v_dot2_f32_bf16 v127, v15, s55, 0
    v_dot2_f32_bf16 v112, v18, s72, v112
    v_dot2_f32_bf16 v113, v19, s72, v113
    v_dot2_f32_bf16 v114, v18, s73, v114
    v_dot2_f32_bf16 v115, v19, s73, v115
    v_dot2_f32_bf16 v116, v18, s74, v116
    v_dot2_f32_bf16 v117, v19, s74, v117
    v_dot2_f32_bf16 v118, v18, s75, v118
    v_dot2_f32_bf16 v119, v19, s75, v119
    v_dot2_f32_bf16 v120, v18, s56, v120
    v_dot2_f32_bf16 v121, v19, s56, v121
    v_dot2_f32_bf16 v122, v18, s57, v122
    v_dot2_f32_bf16 v123, v19, s57, v123
    v_dot2_f32_bf16 v124, v18, s58, v124
    v_dot2_f32_bf16 v125, v19, s58, v125
    v_dot2_f32_bf16 v126, v18, s59, v126
    v_dot2_f32_bf16 v127, v19, s59, v127
    v_dot2_f32_bf16 v112, v22, s76, v112
    v_dot2_f32_bf16 v113, v23, s76, v113
    v_dot2_f32_bf16 v114, v22, s77, v114
    v_dot2_f32_bf16 v115, v23, s77, v115
    v_dot2_f32_bf16 v116, v22, s78, v116
    v_dot2_f32_bf16 v117, v23, s78, v117
    v_dot2_f32_bf16 v118, v22, s79, v118
    v_dot2_f32_bf16 v119, v23, s79, v119
    v_dot2_f32_bf16 v120, v22, s60, v120
    v_dot2_f32_bf16 v121, v23, s60, v121
    v_dot2_f32_bf16 v122, v22, s61, v122
    v_dot2_f32_bf16 v123, v23, s61, v123
    v_dot2_f32_bf16 v124, v22, s62, v124
    v_dot2_f32_bf16 v125, v23, s62, v125
    v_dot2_f32_bf16 v126, v22, s63, v126
    v_dot2_f32_bf16 v127, v23, s63, v127
    v_dot2_f32_bf16 v112, v26, s80, v112
    v_dot2_f32_bf16 v113, v27, s80, v113
    v_dot2_f32_bf16 v114, v26, s81, v114
    v_dot2_f32_bf16 v115, v27, s81, v115
    v_dot2_f32_bf16 v116, v26, s82, v116
    v_dot2_f32_bf16 v117, v27, s82, v117
    v_dot2_f32_bf16 v118, v26, s83, v118
    v_dot2_f32_bf16 v119, v27, s83, v119
    v_dot2_f32_bf16 v120, v26, s64, v120
    v_dot2_f32_bf16 v121, v27, s64, v121
    v_dot2_f32_bf16 v122, v26, s65, v122
    v_dot2_f32_bf16 v123, v27, s65, v123
    v_dot2_f32_bf16 v124, v26, s66, v124
    v_dot2_f32_bf16 v125, v27, s66, v125
    v_dot2_f32_bf16 v126, v26, s67, v126
    v_dot2_f32_bf16 v127, v27, s67, v127
L_p2_kernel_g1_6:
L_p2_gb:
    v_and_b32 v4, 0x80008000, v4
    v_cmp_ne_u32 vcc, 0, v4
    v_mov_b32 v8, s27
    v_and_b32 v10, 15, v0
    v_mul_u32_u24 v10, 240, v10
    v_add_u32 v10, 160000, v10
    s_cmp_lg_u64 vcc, 0
    s_cselect_b32 s2, 1, s2
    v_mov_b32 v9, s2
    s_mov_b64 exec, 1
    ds_write_b32 v8, v9
    s_mov_b64 exec, -1
    v_add_u32 v2, 16384, v1
    v_mov_b32 v9, 0x3f000000
    v_cmp_gt_u32 vcc, 226, v0
    s_mov_b32 s49, s12
    s_mov_b32 s51, 0
    v_cndmask_b32 v2, v9, v2, vcc
    s_waitcnt vmcnt(0) lgkmcnt(0)
    s_barrier
    ds_read_b32 v9, v10
    s_mov_b32 s18, 5120000
    s_mov_b32 s19, 0x00020000
    s_waitcnt lgkmcnt(0)
    v_cmp_ne_u32 vcc, 0, v9
    s_nop 1
    s_cmp_lg_u64 vcc, 0
    s_cselect_b32 s2, 1, 0
    s_cbranch_scc1 L_p2_slow
L_p2_signal:
    v_mov_b32 v8, 160228
    s_lshl_b32 s15, s2, 4
    s_or_b32 s15, s15, s21
    s_add_u32 s14, s12, 16
    s_lshl_b32 s20, s15, s14
    s_add_u32 s20, s20, 1
    v_mov_b32 v9, s20
    s_cmp_lg_u32 s13, 15
    s_cbranch_scc1 L_p2_nosig0
    s_lshl_b32 s14, s3, 8
    s_add_u32 s14, s14, 227590656
    s_mov_b64 exec, 1
    buffer_atomic_add v9, off, s[4:7], s14 sc0
    s_mov_b64 exec, -1
L_p2_nosig0:
    s_lshl2_add_u32 s14, s3, s49
    s_mul_i32 s26, s14, 20000
    s_add_u32 s15, s26, 227607040
    buffer_load_dwordx4 v[64:67], v1, s[4:7], s15 offen
    buffer_load_dwordx4 v[68:71], v2, s[4:7], s15 offen
    s_lshl_b32 s28, s92, 16
    s_and_b32 s29, s92, 0xffff0000
    s_lshl_b32 s30, s93, 16
    s_and_b32 s31, s93, 0xffff0000
    s_lshl_b32 s32, s94, 16
    s_and_b32 s33, s94, 0xffff0000
    s_lshl_b32 s34, s95, 16
    s_and_b32 s35, s95, 0xffff0000
    s_lshl_b32 s36, s96, 16
    s_and_b32 s37, s96, 0xffff0000
    s_lshl_b32 s38, s97, 16
    s_and_b32 s39, s97, 0xffff0000
    s_lshl_b32 s40, s98, 16
    s_and_b32 s41, s98, 0xffff0000
    s_lshl_b32 s42, s99, 16
    s_and_b32 s43, s99, 0xffff0000
    s_and_b32 s99, s91, 0xffff0000
    s_lshl_b32 s98, s91, 16
    s_and_b32 s97, s90, 0xffff0000
    s_lshl_b32 s96, s90, 16
    s_and_b32 s95, s89, 0xffff0000
    s_lshl_b32 s94, s89, 16
    s_and_b32 s93, s88, 0xffff0000
    s_lshl_b32 s92, s88, 16
    s_and_b32 s91, s87, 0xffff0000
    s_lshl_b32 s90, s87, 16
    s_and_b32 s89, s86, 0xffff0000
    s_lshl_b32 s88, s86, 16
    s_and_b32 s87, s85, 0xffff0000
    s_lshl_b32 s86, s85, 16
    s_and_b32 s85, s84, 0xffff0000
    s_lshl_b32 s84, s84, 16
    s_mov_b32 s44, s48
    s_add_u32 s45, s48, 2281701376
    s_cmp_eq_u32 s48, 0
    s_cselect_b32 s45, 0, s45
    s_cmp_lg_u32 s13, 15
    s_cbranch_scc1 L_p2_nosig
    s_waitcnt vmcnt(2)
    v_readfirstlane_b32 s15, v9
    s_lshl_b32 s51, 1, s12
    s_add_u32 s20, s20, s15
    s_and_b32 s15, s20, 0xff
    s_cmp_eq_u32 s15, 4
    s_cbranch_scc0 L_p2_notlast
    s_bfe_u32 s15, s20, 262160
    s_or_b32 s51, s51, s15
    s_branch L_p2_pub
L_p2_notlast:
    s_cmp_lg_u32 s21, 0
    s_cselect_b32 s51, 0, s51
    s_cbranch_scc1 L_p2_pub
L_p2_poll:
    v_mov_b32 v9, 0
    s_lshl_b32 s14, s3, 8
    s_add_u32 s14, s14, 227590656
    s_mov_b64 exec, 1
    buffer_atomic_add v9, off, s[4:7], s14 sc0
    s_mov_b64 exec, -1
    s_waitcnt vmcnt(0)
    v_readfirstlane_b32 s20, v9
    s_nop 0
    s_and_b32 s15, s20, 0xff
    s_cmp_lt_u32 s15, 4
    s_cbranch_scc1 L_p2_poll
L_p2_pub:
    s_lshl_b32 s15, s51, 24
    s_or_b32 s15, s15, s20
    v_mov_b32 v9, s15
    s_mov_b64 exec, 1
    ds_write_b32 v8, v9
    s_mov_b64 exec, -1
    s_waitcnt lgkmcnt(0)
L_p2_nosig:
    s_barrier
    ds_read_b32 v9, v8
    s_waitcnt lgkmcnt(0)
    v_readfirstlane_b32 s20, v9
    s_nop 0
    s_lshr_b32 s51, s20, 24
    s_cbranch_scc0 L_p2_end
L_p2_fin:
    s_mul_i32 s24, s49, 20000
    s_add_u32 s14, s12, 1
    s_and_b32 s14, s14, 3
    s_mul_i32 s15, s14, 5120000
    s_add_u32 s15, s15, 232727040
    s_add_u32 s15, s15, s26
    buffer_load_dwordx4 v[12:15], v1, s[4:7], s15 offen sc1
    buffer_load_dwordx4 v[92:95], v2, s[4:7], s15 offen sc1
    s_add_u32 s14, s12, 2
    s_and_b32 s14, s14, 3
    s_mul_i32 s15, s14, 5120000
    s_add_u32 s15, s15, 232727040
    s_add_u32 s15, s15, s26
    buffer_load_dwordx4 v[16:19], v1, s[4:7], s15 offen sc1
    buffer_load_dwordx4 v[96:99], v2, s[4:7], s15 offen sc1
    s_add_u32 s14, s12, 3
    s_and_b32 s14, s14, 3
    s_mul_i32 s15, s14, 5120000
    s_add_u32 s15, s15, 232727040
    s_add_u32 s15, s15, s26
    buffer_load_dwordx4 v[20:23], v1, s[4:7], s15 offen sc1
    buffer_load_dwordx4 v[100:103], v2, s[4:7], s15 offen sc1
    v_add_u32 v24, s24, v1
    ds_read_b128 v[8:11], v24
    v_add_u32 v25, s24, v2
    ds_read_b128 v[88:91], v25
    s_waitcnt vmcnt(0) lgkmcnt(0)
    s_bfe_u32 s14, s20, 262164
    s_cbranch_scc0 L_p2_kernel_nof32a_7
    s_add_u32 s14, s12, 0
    s_and_b32 s14, s14, 3
    s_add_u32 s14, s14, 20
    s_bitcmp1_b32 s20, s14
    s_cbranch_scc0 L_p2_kernel_q_8
    v_mov_b32 v8, 1073758208
    v_mov_b32 v9, 1073758208
    v_mov_b32 v10, 1073758208
    v_mov_b32 v11, 1073758208
L_p2_kernel_q_8:
    s_add_u32 s14, s12, 1
    s_and_b32 s14, s14, 3
    s_add_u32 s14, s14, 20
    s_bitcmp1_b32 s20, s14
    s_cbranch_scc0 L_p2_kernel_q_9
    v_mov_b32 v12, 1073758208
    v_mov_b32 v13, 1073758208
    v_mov_b32 v14, 1073758208
    v_mov_b32 v15, 1073758208
L_p2_kernel_q_9:
    s_add_u32 s14, s12, 2
    s_and_b32 s14, s14, 3
    s_add_u32 s14, s14, 20
    s_bitcmp1_b32 s20, s14
    s_cbranch_scc0 L_p2_kernel_q_10
    v_mov_b32 v16, 1073758208
    v_mov_b32 v17, 1073758208
    v_mov_b32 v18, 1073758208
    v_mov_b32 v19, 1073758208
L_p2_kernel_q_10:
    s_add_u32 s14, s12, 3
    s_and_b32 s14, s14, 3
    s_add_u32 s14, s14, 20
    s_bitcmp1_b32 s20, s14
    s_cbranch_scc0 L_p2_kernel_q_11
    v_mov_b32 v20, 1073758208
    v_mov_b32 v21, 1073758208
    v_mov_b32 v22, 1073758208
    v_mov_b32 v23, 1073758208
L_p2_kernel_q_11:
L_p2_kernel_nof32a_7:
    v_pk_add_u16 v8, v8, v12
    v_pk_add_u16 v16, v16, v20
    v_pk_add_u16 v9, v9, v13
    v_pk_add_u16 v17, v17, v21
    v_pk_add_u16 v10, v10, v14
    v_pk_add_u16 v18, v18, v22
    v_pk_add_u16 v11, v11, v15
    v_pk_add_u16 v19, v19, v23
    v_add_u32_sdwa v24, v8, v16 dst_sel:DWORD dst_unused:UNUSED_PAD src0_sel:WORD_0 src1_sel:WORD_0
    v_add_u32_sdwa v25, v10, v18 dst_sel:DWORD dst_unused:UNUSED_PAD src0_sel:WORD_0 src1_sel:WORD_0
    v_add_u32_sdwa v26, v8, v16 dst_sel:DWORD dst_unused:UNUSED_PAD src0_sel:WORD_1 src1_sel:WORD_1
    v_add_u32_sdwa v27, v10, v18 dst_sel:DWORD dst_unused:UNUSED_PAD src0_sel:WORD_1 src1_sel:WORD_1
    v_add_u32_sdwa v28, v9, v17 dst_sel:DWORD dst_unused:UNUSED_PAD src0_sel:WORD_0 src1_sel:WORD_0
    v_add_u32_sdwa v29, v11, v19 dst_sel:DWORD dst_unused:UNUSED_PAD src0_sel:WORD_0 src1_sel:WORD_0
    v_add_u32_sdwa v30, v9, v17 dst_sel:DWORD dst_unused:UNUSED_PAD src0_sel:WORD_1 src1_sel:WORD_1
    v_add_u32_sdwa v31, v11, v19 dst_sel:DWORD dst_unused:UNUSED_PAD src0_sel:WORD_1 src1_sel:WORD_1
    v_cvt_f32_u32 v24, v24
    v_cvt_f32_u32 v25, v25
    v_cvt_f32_u32 v26, v26
    v_cvt_f32_u32 v27, v27
    v_cvt_f32_u32 v28, v28
    v_cvt_f32_u32 v29, v29
    v_cvt_f32_u32 v30, v30
    v_cvt_f32_u32 v31, v31
    v_pk_fma_f32 v[24:25], v[24:25], s[44:45], s[44:45] op_sel:[0,0,1] op_sel_hi:[1,0,1]
    v_pk_fma_f32 v[26:27], v[26:27], s[44:45], s[44:45] op_sel:[0,0,1] op_sel_hi:[1,0,1]
    v_pk_fma_f32 v[28:29], v[28:29], s[44:45], s[44:45] op_sel:[0,0,1] op_sel_hi:[1,0,1]
    v_pk_fma_f32 v[30:31], v[30:31], s[44:45], s[44:45] op_sel:[0,0,1] op_sel_hi:[1,0,1]
    s_bfe_u32 s14, s20, 262164
    s_cbranch_scc0 L_p2_kernel_nof32b_12
    v_lshlrev_b32 v32, 1, v1
    s_bitcmp1_b32 s20, 20
    s_cbranch_scc0 L_p2_kernel_q_13
    s_lshl_b32 s15, s26, 1
    s_add_u32 s15, s15, 253207040
    buffer_load_dwordx4 v[8:11], v32, s[4:7], s15 offen sc1
    buffer_load_dwordx4 v[12:15], v32, s[4:7], s15 offen offset:16 sc1
    s_waitcnt vmcnt(0)
    v_add_f32 v24, v24, v8
    v_add_f32 v25, v25, v12
    v_add_f32 v26, v26, v9
    v_add_f32 v27, v27, v13
    v_add_f32 v28, v28, v10
    v_add_f32 v29, v29, v14
    v_add_f32 v30, v30, v11
    v_add_f32 v31, v31, v15
L_p2_kernel_q_13:
    s_bitcmp1_b32 s20, 21
    s_cbranch_scc0 L_p2_kernel_q_14
    s_lshl_b32 s15, s26, 1
    s_add_u32 s15, s15, 263447040
    buffer_load_dwordx4 v[8:11], v32, s[4:7], s15 offen sc1
    buffer_load_dwordx4 v[12:15], v32, s[4:7], s15 offen offset:16 sc1
    s_waitcnt vmcnt(0)
    v_add_f32 v24, v24, v8
    v_add_f32 v25, v25, v12
    v_add_f32 v26, v26, v9
    v_add_f32 v27, v27, v13
    v_add_f32 v28, v28, v10
    v_add_f32 v29, v29, v14
    v_add_f32 v30, v30, v11
    v_add_f32 v31, v31, v15
L_p2_kernel_q_14:
    s_bitcmp1_b32 s20, 22
    s_cbranch_scc0 L_p2_kernel_q_15
    s_lshl_b32 s15, s26, 1
    s_add_u32 s15, s15, 273687040
    buffer_load_dwordx4 v[8:11], v32, s[4:7], s15 offen sc1
    buffer_load_dwordx4 v[12:15], v32, s[4:7], s15 offen offset:16 sc1
    s_waitcnt vmcnt(0)
    v_add_f32 v24, v24, v8
    v_add_f32 v25, v25, v12
    v_add_f32 v26, v26, v9
    v_add_f32 v27, v27, v13
    v_add_f32 v28, v28, v10
    v_add_f32 v29, v29, v14
    v_add_f32 v30, v30, v11
    v_add_f32 v31, v31, v15
L_p2_kernel_q_15:
    s_bitcmp1_b32 s20, 23
    s_cbranch_scc0 L_p2_kernel_q_16
    s_lshl_b32 s15, s26, 1
    s_add_u32 s15, s15, 283927040
    buffer_load_dwordx4 v[8:11], v32, s[4:7], s15 offen sc1
    buffer_load_dwordx4 v[12:15], v32, s[4:7], s15 offen offset:16 sc1
    s_waitcnt vmcnt(0)
    v_add_f32 v24, v24, v8
    v_add_f32 v25, v25, v12
    v_add_f32 v26, v26, v9
    v_add_f32 v27, v27, v13
    v_add_f32 v28, v28, v10
    v_add_f32 v29, v29, v14
    v_add_f32 v30, v30, v11
    v_add_f32 v31, v31, v15
L_p2_kernel_q_16:
L_p2_kernel_nof32b_12:
    v_pk_mul_f32 v[8:9], v[24:25], s[84:85] op_sel:[0,0] op_sel_hi:[1,0]
    v_pk_mul_f32 v[10:11], v[24:25], s[84:85] op_sel:[0,1] op_sel_hi:[1,1]
    v_pk_mul_f32 v[12:13], v[24:25], s[86:87] op_sel:[0,0] op_sel_hi:[1,0]
    v_pk_mul_f32 v[14:15], v[24:25], s[86:87] op_sel:[0,1] op_sel_hi:[1,1]
    v_pk_fma_f32 v[8:9], v[26:27], s[88:89], v[8:9] op_sel:[0,0,0] op_sel_hi:[1,0,1]
    v_pk_fma_f32 v[10:11], v[26:27], s[88:89], v[10:11] op_sel:[0,1,0] op_sel_hi:[1,1,1]
    v_pk_fma_f32 v[12:13], v[26:27], s[90:91], v[12:13] op_sel:[0,0,0] op_sel_hi:[1,0,1]
    v_pk_fma_f32 v[14:15], v[26:27], s[90:91], v[14:15] op_sel:[0,1,0] op_sel_hi:[1,1,1]
    v_pk_fma_f32 v[8:9], v[28:29], s[92:93], v[8:9] op_sel:[0,0,0] op_sel_hi:[1,0,1]
    v_pk_fma_f32 v[10:11], v[28:29], s[92:93], v[10:11] op_sel:[0,1,0] op_sel_hi:[1,1,1]
    v_pk_fma_f32 v[12:13], v[28:29], s[94:95], v[12:13] op_sel:[0,0,0] op_sel_hi:[1,0,1]
    v_pk_fma_f32 v[14:15], v[28:29], s[94:95], v[14:15] op_sel:[0,1,0] op_sel_hi:[1,1,1]
    v_pk_fma_f32 v[8:9], v[30:31], s[96:97], v[8:9] op_sel:[0,0,0] op_sel_hi:[1,0,1]
    v_pk_fma_f32 v[10:11], v[30:31], s[96:97], v[10:11] op_sel:[0,1,0] op_sel_hi:[1,1,1]
    v_pk_fma_f32 v[12:13], v[30:31], s[98:99], v[12:13] op_sel:[0,0,0] op_sel_hi:[1,0,1]
    v_pk_fma_f32 v[14:15], v[30:31], s[98:99], v[14:15] op_sel:[0,1,0] op_sel_hi:[1,1,1]
    v_pk_mul_f32 v[8:9], v[8:9], v[72:73]
    v_pk_mul_f32 v[10:11], v[10:11], v[74:75]
    v_pk_mul_f32 v[12:13], v[12:13], v[76:77]
    v_pk_mul_f32 v[14:15], v[14:15], v[78:79]
    v_pk_mul_f32 v[24:25], v[8:9], s[28:29] op_sel:[0,0] op_sel_hi:[1,0]
    v_pk_mul_f32 v[26:27], v[8:9], s[28:29] op_sel:[0,1] op_sel_hi:[1,1]
    v_pk_mul_f32 v[28:29], v[8:9], s[30:31] op_sel:[0,0] op_sel_hi:[1,0]
    v_pk_mul_f32 v[30:31], v[8:9], s[30:31] op_sel:[0,1] op_sel_hi:[1,1]
    v_pk_fma_f32 v[24:25], v[10:11], s[32:33], v[24:25] op_sel:[0,0,0] op_sel_hi:[1,0,1]
    v_pk_fma_f32 v[26:27], v[10:11], s[32:33], v[26:27] op_sel:[0,1,0] op_sel_hi:[1,1,1]
    v_pk_fma_f32 v[28:29], v[10:11], s[34:35], v[28:29] op_sel:[0,0,0] op_sel_hi:[1,0,1]
    v_pk_fma_f32 v[30:31], v[10:11], s[34:35], v[30:31] op_sel:[0,1,0] op_sel_hi:[1,1,1]
    v_pk_fma_f32 v[24:25], v[12:13], s[36:37], v[24:25] op_sel:[0,0,0] op_sel_hi:[1,0,1]
    v_pk_fma_f32 v[26:27], v[12:13], s[36:37], v[26:27] op_sel:[0,1,0] op_sel_hi:[1,1,1]
    v_pk_fma_f32 v[28:29], v[12:13], s[38:39], v[28:29] op_sel:[0,0,0] op_sel_hi:[1,0,1]
    v_pk_fma_f32 v[30:31], v[12:13], s[38:39], v[30:31] op_sel:[0,1,0] op_sel_hi:[1,1,1]
    v_pk_fma_f32 v[24:25], v[14:15], s[40:41], v[24:25] op_sel:[0,0,0] op_sel_hi:[1,0,1]
    v_pk_fma_f32 v[26:27], v[14:15], s[40:41], v[26:27] op_sel:[0,1,0] op_sel_hi:[1,1,1]
    v_pk_fma_f32 v[28:29], v[14:15], s[42:43], v[28:29] op_sel:[0,0,0] op_sel_hi:[1,0,1]
    v_pk_fma_f32 v[30:31], v[14:15], s[42:43], v[30:31] op_sel:[0,1,0] op_sel_hi:[1,1,1]
    v_lshlrev_b32 v8, 16, v64
    v_and_b32 v10, 0xffff0000, v64
    v_lshlrev_b32 v12, 16, v65
    v_and_b32 v14, 0xffff0000, v65
    v_lshlrev_b32 v9, 16, v66
    v_and_b32 v11, 0xffff0000, v66
    v_lshlrev_b32 v13, 16, v67
    v_and_b32 v15, 0xffff0000, v67
    v_pk_fma_f32 v[8:9], v[24:25], v[80:81], v[8:9]
    v_pk_fma_f32 v[10:11], v[26:27], v[82:83], v[10:11]
    v_pk_fma_f32 v[12:13], v[28:29], v[84:85], v[12:13]
    v_pk_fma_f32 v[14:15], v[30:31], v[86:87], v[14:15]
    v_cvt_pk_bf16_f32 v16, v8, v10
    v_cvt_pk_bf16_f32 v17, v12, v14
    v_cvt_pk_bf16_f32 v18, v9, v11
    v_cvt_pk_bf16_f32 v19, v13, v15
    buffer_store_dwordx4 v[16:19], v1, s[16:19], s26 offen
    s_cmp_ge_u32 s13, 4
    s_cbranch_scc1 L_p2_f1
    s_bfe_u32 s14, s20, 262164
    s_cbranch_scc0 L_p2_kernel_nof32a_17
    s_add_u32 s14, s12, 0
    s_and_b32 s14, s14, 3
    s_add_u32 s14, s14, 20
    s_bitcmp1_b32 s20, s14
    s_cbranch_scc0 L_p2_kernel_q_18
    v_mov_b32 v88, 1073758208
    v_mov_b32 v89, 1073758208
    v_mov_b32 v90, 1073758208
    v_mov_b32 v91, 1073758208
L_p2_kernel_q_18:
    s_add_u32 s14, s12, 1
    s_and_b32 s14, s14, 3
    s_add_u32 s14, s14, 20
    s_bitcmp1_b32 s20, s14
    s_cbranch_scc0 L_p2_kernel_q_19
    v_mov_b32 v92, 1073758208
    v_mov_b32 v93, 1073758208
    v_mov_b32 v94, 1073758208
    v_mov_b32 v95, 1073758208
L_p2_kernel_q_19:
    s_add_u32 s14, s12, 2
    s_and_b32 s14, s14, 3
    s_add_u32 s14, s14, 20
    s_bitcmp1_b32 s20, s14
    s_cbranch_scc0 L_p2_kernel_q_20
    v_mov_b32 v96, 1073758208
    v_mov_b32 v97, 1073758208
    v_mov_b32 v98, 1073758208
    v_mov_b32 v99, 1073758208
L_p2_kernel_q_20:
    s_add_u32 s14, s12, 3
    s_and_b32 s14, s14, 3
    s_add_u32 s14, s14, 20
    s_bitcmp1_b32 s20, s14
    s_cbranch_scc0 L_p2_kernel_q_21
    v_mov_b32 v100, 1073758208
    v_mov_b32 v101, 1073758208
    v_mov_b32 v102, 1073758208
    v_mov_b32 v103, 1073758208
L_p2_kernel_q_21:
L_p2_kernel_nof32a_17:
    v_pk_add_u16 v88, v88, v92
    v_pk_add_u16 v96, v96, v100
    v_pk_add_u16 v89, v89, v93
    v_pk_add_u16 v97, v97, v101
    v_pk_add_u16 v90, v90, v94
    v_pk_add_u16 v98, v98, v102
    v_pk_add_u16 v91, v91, v95
    v_pk_add_u16 v99, v99, v103
    v_add_u32_sdwa v24, v88, v96 dst_sel:DWORD dst_unused:UNUSED_PAD src0_sel:WORD_0 src1_sel:WORD_0
    v_add_u32_sdwa v25, v90, v98 dst_sel:DWORD dst_unused:UNUSED_PAD src0_sel:WORD_0 src1_sel:WORD_0
    v_add_u32_sdwa v26, v88, v96 dst_sel:DWORD dst_unused:UNUSED_PAD src0_sel:WORD_1 src1_sel:WORD_1
    v_add_u32_sdwa v27, v90, v98 dst_sel:DWORD dst_unused:UNUSED_PAD src0_sel:WORD_1 src1_sel:WORD_1
    v_add_u32_sdwa v28, v89, v97 dst_sel:DWORD dst_unused:UNUSED_PAD src0_sel:WORD_0 src1_sel:WORD_0
    v_add_u32_sdwa v29, v91, v99 dst_sel:DWORD dst_unused:UNUSED_PAD src0_sel:WORD_0 src1_sel:WORD_0
    v_add_u32_sdwa v30, v89, v97 dst_sel:DWORD dst_unused:UNUSED_PAD src0_sel:WORD_1 src1_sel:WORD_1
    v_add_u32_sdwa v31, v91, v99 dst_sel:DWORD dst_unused:UNUSED_PAD src0_sel:WORD_1 src1_sel:WORD_1
    v_cvt_f32_u32 v24, v24
    v_cvt_f32_u32 v25, v25
    v_cvt_f32_u32 v26, v26
    v_cvt_f32_u32 v27, v27
    v_cvt_f32_u32 v28, v28
    v_cvt_f32_u32 v29, v29
    v_cvt_f32_u32 v30, v30
    v_cvt_f32_u32 v31, v31
    v_pk_fma_f32 v[24:25], v[24:25], s[44:45], s[44:45] op_sel:[0,0,1] op_sel_hi:[1,0,1]
    v_pk_fma_f32 v[26:27], v[26:27], s[44:45], s[44:45] op_sel:[0,0,1] op_sel_hi:[1,0,1]
    v_pk_fma_f32 v[28:29], v[28:29], s[44:45], s[44:45] op_sel:[0,0,1] op_sel_hi:[1,0,1]
    v_pk_fma_f32 v[30:31], v[30:31], s[44:45], s[44:45] op_sel:[0,0,1] op_sel_hi:[1,0,1]
    s_bfe_u32 s14, s20, 262164
    s_cbranch_scc0 L_p2_kernel_nof32b_22
    v_lshlrev_b32 v32, 1, v2
    s_bitcmp1_b32 s20, 20
    s_cbranch_scc0 L_p2_kernel_q_23
    s_lshl_b32 s15, s26, 1
    s_add_u32 s15, s15, 253207040
    buffer_load_dwordx4 v[88:91], v32, s[4:7], s15 offen sc1
    buffer_load_dwordx4 v[92:95], v32, s[4:7], s15 offen offset:16 sc1
    s_waitcnt vmcnt(0)
    v_add_f32 v24, v24, v88
    v_add_f32 v25, v25, v92
    v_add_f32 v26, v26, v89
    v_add_f32 v27, v27, v93
    v_add_f32 v28, v28, v90
    v_add_f32 v29, v29, v94
    v_add_f32 v30, v30, v91
    v_add_f32 v31, v31, v95
L_p2_kernel_q_23:
    s_bitcmp1_b32 s20, 21
    s_cbranch_scc0 L_p2_kernel_q_24
    s_lshl_b32 s15, s26, 1
    s_add_u32 s15, s15, 263447040
    buffer_load_dwordx4 v[88:91], v32, s[4:7], s15 offen sc1
    buffer_load_dwordx4 v[92:95], v32, s[4:7], s15 offen offset:16 sc1
    s_waitcnt vmcnt(0)
    v_add_f32 v24, v24, v88
    v_add_f32 v25, v25, v92
    v_add_f32 v26, v26, v89
    v_add_f32 v27, v27, v93
    v_add_f32 v28, v28, v90
    v_add_f32 v29, v29, v94
    v_add_f32 v30, v30, v91
    v_add_f32 v31, v31, v95
L_p2_kernel_q_24:
    s_bitcmp1_b32 s20, 22
    s_cbranch_scc0 L_p2_kernel_q_25
    s_lshl_b32 s15, s26, 1
    s_add_u32 s15, s15, 273687040
    buffer_load_dwordx4 v[88:91], v32, s[4:7], s15 offen sc1
    buffer_load_dwordx4 v[92:95], v32, s[4:7], s15 offen offset:16 sc1
    s_waitcnt vmcnt(0)
    v_add_f32 v24, v24, v88
    v_add_f32 v25, v25, v92
    v_add_f32 v26, v26, v89
    v_add_f32 v27, v27, v93
    v_add_f32 v28, v28, v90
    v_add_f32 v29, v29, v94
    v_add_f32 v30, v30, v91
    v_add_f32 v31, v31, v95
L_p2_kernel_q_25:
    s_bitcmp1_b32 s20, 23
    s_cbranch_scc0 L_p2_kernel_q_26
    s_lshl_b32 s15, s26, 1
    s_add_u32 s15, s15, 283927040
    buffer_load_dwordx4 v[88:91], v32, s[4:7], s15 offen sc1
    buffer_load_dwordx4 v[92:95], v32, s[4:7], s15 offen offset:16 sc1
    s_waitcnt vmcnt(0)
    v_add_f32 v24, v24, v88
    v_add_f32 v25, v25, v92
    v_add_f32 v26, v26, v89
    v_add_f32 v27, v27, v93
    v_add_f32 v28, v28, v90
    v_add_f32 v29, v29, v94
    v_add_f32 v30, v30, v91
    v_add_f32 v31, v31, v95
L_p2_kernel_q_26:
L_p2_kernel_nof32b_22:
    v_pk_mul_f32 v[88:89], v[24:25], s[84:85] op_sel:[0,0] op_sel_hi:[1,0]
    v_pk_mul_f32 v[90:91], v[24:25], s[84:85] op_sel:[0,1] op_sel_hi:[1,1]
    v_pk_mul_f32 v[92:93], v[24:25], s[86:87] op_sel:[0,0] op_sel_hi:[1,0]
    v_pk_mul_f32 v[94:95], v[24:25], s[86:87] op_sel:[0,1] op_sel_hi:[1,1]
    v_pk_fma_f32 v[88:89], v[26:27], s[88:89], v[88:89] op_sel:[0,0,0] op_sel_hi:[1,0,1]
    v_pk_fma_f32 v[90:91], v[26:27], s[88:89], v[90:91] op_sel:[0,1,0] op_sel_hi:[1,1,1]
    v_pk_fma_f32 v[92:93], v[26:27], s[90:91], v[92:93] op_sel:[0,0,0] op_sel_hi:[1,0,1]
    v_pk_fma_f32 v[94:95], v[26:27], s[90:91], v[94:95] op_sel:[0,1,0] op_sel_hi:[1,1,1]
    v_pk_fma_f32 v[88:89], v[28:29], s[92:93], v[88:89] op_sel:[0,0,0] op_sel_hi:[1,0,1]
    v_pk_fma_f32 v[90:91], v[28:29], s[92:93], v[90:91] op_sel:[0,1,0] op_sel_hi:[1,1,1]
    v_pk_fma_f32 v[92:93], v[28:29], s[94:95], v[92:93] op_sel:[0,0,0] op_sel_hi:[1,0,1]
    v_pk_fma_f32 v[94:95], v[28:29], s[94:95], v[94:95] op_sel:[0,1,0] op_sel_hi:[1,1,1]
    v_pk_fma_f32 v[88:89], v[30:31], s[96:97], v[88:89] op_sel:[0,0,0] op_sel_hi:[1,0,1]
    v_pk_fma_f32 v[90:91], v[30:31], s[96:97], v[90:91] op_sel:[0,1,0] op_sel_hi:[1,1,1]
    v_pk_fma_f32 v[92:93], v[30:31], s[98:99], v[92:93] op_sel:[0,0,0] op_sel_hi:[1,0,1]
    v_pk_fma_f32 v[94:95], v[30:31], s[98:99], v[94:95] op_sel:[0,1,0] op_sel_hi:[1,1,1]
    v_pk_mul_f32 v[88:89], v[88:89], v[112:113]
    v_pk_mul_f32 v[90:91], v[90:91], v[114:115]
    v_pk_mul_f32 v[92:93], v[92:93], v[116:117]
    v_pk_mul_f32 v[94:95], v[94:95], v[118:119]
    v_pk_mul_f32 v[24:25], v[88:89], s[28:29] op_sel:[0,0] op_sel_hi:[1,0]
    v_pk_mul_f32 v[26:27], v[88:89], s[28:29] op_sel:[0,1] op_sel_hi:[1,1]
    v_pk_mul_f32 v[28:29], v[88:89], s[30:31] op_sel:[0,0] op_sel_hi:[1,0]
    v_pk_mul_f32 v[30:31], v[88:89], s[30:31] op_sel:[0,1] op_sel_hi:[1,1]
    v_pk_fma_f32 v[24:25], v[90:91], s[32:33], v[24:25] op_sel:[0,0,0] op_sel_hi:[1,0,1]
    v_pk_fma_f32 v[26:27], v[90:91], s[32:33], v[26:27] op_sel:[0,1,0] op_sel_hi:[1,1,1]
    v_pk_fma_f32 v[28:29], v[90:91], s[34:35], v[28:29] op_sel:[0,0,0] op_sel_hi:[1,0,1]
    v_pk_fma_f32 v[30:31], v[90:91], s[34:35], v[30:31] op_sel:[0,1,0] op_sel_hi:[1,1,1]
    v_pk_fma_f32 v[24:25], v[92:93], s[36:37], v[24:25] op_sel:[0,0,0] op_sel_hi:[1,0,1]
    v_pk_fma_f32 v[26:27], v[92:93], s[36:37], v[26:27] op_sel:[0,1,0] op_sel_hi:[1,1,1]
    v_pk_fma_f32 v[28:29], v[92:93], s[38:39], v[28:29] op_sel:[0,0,0] op_sel_hi:[1,0,1]
    v_pk_fma_f32 v[30:31], v[92:93], s[38:39], v[30:31] op_sel:[0,1,0] op_sel_hi:[1,1,1]
    v_pk_fma_f32 v[24:25], v[94:95], s[40:41], v[24:25] op_sel:[0,0,0] op_sel_hi:[1,0,1]
    v_pk_fma_f32 v[26:27], v[94:95], s[40:41], v[26:27] op_sel:[0,1,0] op_sel_hi:[1,1,1]
    v_pk_fma_f32 v[28:29], v[94:95], s[42:43], v[28:29] op_sel:[0,0,0] op_sel_hi:[1,0,1]
    v_pk_fma_f32 v[30:31], v[94:95], s[42:43], v[30:31] op_sel:[0,1,0] op_sel_hi:[1,1,1]
    v_lshlrev_b32 v88, 16, v68
    v_and_b32 v90, 0xffff0000, v68
    v_lshlrev_b32 v92, 16, v69
    v_and_b32 v94, 0xffff0000, v69
    v_lshlrev_b32 v89, 16, v70
    v_and_b32 v91, 0xffff0000, v70
    v_lshlrev_b32 v93, 16, v71
    v_and_b32 v95, 0xffff0000, v71
    v_pk_fma_f32 v[88:89], v[24:25], v[120:121], v[88:89]
    v_pk_fma_f32 v[90:91], v[26:27], v[122:123], v[90:91]
    v_pk_fma_f32 v[92:93], v[28:29], v[124:125], v[92:93]
    v_pk_fma_f32 v[94:95], v[30:31], v[126:127], v[94:95]
    v_cvt_pk_bf16_f32 v96, v88, v90
    v_cvt_pk_bf16_f32 v97, v92, v94
    v_cvt_pk_bf16_f32 v98, v89, v91
    v_cvt_pk_bf16_f32 v99, v93, v95
    buffer_store_dwordx4 v[96:99], v2, s[16:19], s26 offen
L_p2_f1:
    s_bitset0_b32 s51, s49
    s_cmp_eq_u32 s51, 0
    s_cbranch_scc1 L_p2_done
    s_ff1_i32_b32 s49, s51
    s_lshl2_add_u32 s14, s3, s49
    s_mul_i32 s14, s14, 5000
    s_add_u32 s15, s14, 4096
    v_min_u32 v61, 225, v0
    v_lshl_add_u32 v60, v0, 2, s14
    v_lshl_add_u32 v61, v61, 2, s15
    global_load_dword v60, v60, s[100:101] nt
    global_load_dword v61, v61, s[100:101] nt
    s_waitcnt vmcnt(0)
    v_lshlrev_b32 v30, 16, v60
    v_and_b32 v31, 0xffff0000, v60
    v_lshlrev_b32 v36, 16, v53
    v_and_b32 v37, 0xffff0000, v53
    v_lshlrev_b32 v38, 16, v54
    v_and_b32 v39, 0xffff0000, v54
    v_lshlrev_b32 v40, 16, v56
    v_and_b32 v41, 0xffff0000, v56
    v_lshlrev_b32 v42, 16, v57
    v_and_b32 v43, 0xffff0000, v57
    v_pk_add_f32 v[14:15], v[30:31], v[36:37] op_sel:[0,0] op_sel_hi:[1,0] neg_lo:[0,1] neg_hi:[0,1]
    v_pk_add_f32 v[16:17], v[30:31], v[36:37] op_sel:[0,1] op_sel_hi:[1,1] neg_lo:[0,1] neg_hi:[0,1]
    v_pk_add_f32 v[18:19], v[30:31], v[38:39] op_sel:[0,0] op_sel_hi:[1,0] neg_lo:[0,1] neg_hi:[0,1]
    v_pk_add_f32 v[20:21], v[30:31], v[38:39] op_sel:[0,1] op_sel_hi:[1,1] neg_lo:[0,1] neg_hi:[0,1]
    v_pk_add_f32 v[22:23], v[30:31], v[40:41] op_sel:[0,0] op_sel_hi:[1,0] neg_lo:[0,1] neg_hi:[0,1]
    v_pk_add_f32 v[24:25], v[30:31], v[40:41] op_sel:[0,1] op_sel_hi:[1,1] neg_lo:[0,1] neg_hi:[0,1]
    v_pk_add_f32 v[26:27], v[30:31], v[42:43] op_sel:[0,0] op_sel_hi:[1,0] neg_lo:[0,1] neg_hi:[0,1]
    v_pk_add_f32 v[28:29], v[30:31], v[42:43] op_sel:[0,1] op_sel_hi:[1,1] neg_lo:[0,1] neg_hi:[0,1]
    v_cvt_pk_bf16_f32 v32, v14, v15
    v_lshlrev_b32 v14, 16, v32
    v_and_b32 v15, 0xffff0000, v32
    v_cvt_pk_bf16_f32 v32, v16, v17
    v_lshlrev_b32 v16, 16, v32
    v_and_b32 v17, 0xffff0000, v32
    v_cvt_pk_bf16_f32 v32, v18, v19
    v_lshlrev_b32 v18, 16, v32
    v_and_b32 v19, 0xffff0000, v32
    v_cvt_pk_bf16_f32 v32, v20, v21
    v_lshlrev_b32 v20, 16, v32
    v_and_b32 v21, 0xffff0000, v32
    v_cvt_pk_bf16_f32 v32, v22, v23
    v_lshlrev_b32 v22, 16, v32
    v_and_b32 v23, 0xffff0000, v32
    v_cvt_pk_bf16_f32 v32, v24, v25
    v_lshlrev_b32 v24, 16, v32
    v_and_b32 v25, 0xffff0000, v32
    v_cvt_pk_bf16_f32 v32, v26, v27
    v_lshlrev_b32 v26, 16, v32
    v_and_b32 v27, 0xffff0000, v32
    v_cvt_pk_bf16_f32 v32, v28, v29
    v_lshlrev_b32 v28, 16, v32
    v_and_b32 v29, 0xffff0000, v32
    v_pk_mul_f32 v[14:15], v[14:15], v[14:15]
    v_pk_mul_f32 v[16:17], v[16:17], v[16:17]
    v_pk_mul_f32 v[18:19], v[18:19], v[18:19]
    v_pk_mul_f32 v[20:21], v[20:21], v[20:21]
    v_pk_mul_f32 v[22:23], v[22:23], v[22:23]
    v_pk_mul_f32 v[24:25], v[24:25], v[24:25]
    v_pk_mul_f32 v[26:27], v[26:27], v[26:27]
    v_pk_mul_f32 v[28:29], v[28:29], v[28:29]
    v_cvt_pk_bf16_f32 v32, v14, v15
    v_lshlrev_b32 v14, 16, v32
    v_and_b32 v15, 0xffff0000, v32
    v_cvt_pk_bf16_f32 v32, v16, v17
    v_lshlrev_b32 v16, 16, v32
    v_and_b32 v17, 0xffff0000, v32
    v_cvt_pk_bf16_f32 v32, v18, v19
    v_lshlrev_b32 v18, 16, v32
    v_and_b32 v19, 0xffff0000, v32
    v_cvt_pk_bf16_f32 v32, v20, v21
    v_lshlrev_b32 v20, 16, v32
    v_and_b32 v21, 0xffff0000, v32
    v_cvt_pk_bf16_f32 v32, v22, v23
    v_lshlrev_b32 v22, 16, v32
    v_and_b32 v23, 0xffff0000, v32
    v_cvt_pk_bf16_f32 v32, v24, v25
    v_lshlrev_b32 v24, 16, v32
    v_and_b32 v25, 0xffff0000, v32
    v_cvt_pk_bf16_f32 v32, v26, v27
    v_lshlrev_b32 v26, 16, v32
    v_and_b32 v27, 0xffff0000, v32
    v_cvt_pk_bf16_f32 v32, v28, v29
    v_lshlrev_b32 v28, 16, v32
    v_and_b32 v29, 0xffff0000, v32
    v_mov_b32 v30, 1092616192
    v_mov_b32 v31, 0x3fb8aa3b
    v_pk_mul_f32 v[14:15], v[14:15], v[30:31] op_sel:[0,0] op_sel_hi:[1,0]
    v_pk_mul_f32 v[16:17], v[16:17], v[30:31] op_sel:[0,0] op_sel_hi:[1,0]
    v_pk_mul_f32 v[18:19], v[18:19], v[30:31] op_sel:[0,0] op_sel_hi:[1,0]
    v_pk_mul_f32 v[20:21], v[20:21], v[30:31] op_sel:[0,0] op_sel_hi:[1,0]
    v_pk_mul_f32 v[22:23], v[22:23], v[30:31] op_sel:[0,0] op_sel_hi:[1,0]
    v_pk_mul_f32 v[24:25], v[24:25], v[30:31] op_sel:[0,0] op_sel_hi:[1,0]
    v_pk_mul_f32 v[26:27], v[26:27], v[30:31] op_sel:[0,0] op_sel_hi:[1,0]
    v_pk_mul_f32 v[28:29], v[28:29], v[30:31] op_sel:[0,0] op_sel_hi:[1,0]
    v_cvt_pk_bf16_f32 v32, v14, v15
    v_lshlrev_b32 v14, 16, v32
    v_and_b32 v15, 0xffff0000, v32
    v_cvt_pk_bf16_f32 v32, v16, v17
    v_lshlrev_b32 v16, 16, v32
    v_and_b32 v17, 0xffff0000, v32
    v_cvt_pk_bf16_f32 v32, v18, v19
    v_lshlrev_b32 v18, 16, v32
    v_and_b32 v19, 0xffff0000, v32
    v_cvt_pk_bf16_f32 v32, v20, v21
    v_lshlrev_b32 v20, 16, v32
    v_and_b32 v21, 0xffff0000, v32
    v_cvt_pk_bf16_f32 v32, v22, v23
    v_lshlrev_b32 v22, 16, v32
    v_and_b32 v23, 0xffff0000, v32
    v_cvt_pk_bf16_f32 v32, v24, v25
    v_lshlrev_b32 v24, 16, v32
    v_and_b32 v25, 0xffff0000, v32
    v_cvt_pk_bf16_f32 v32, v26, v27
    v_lshlrev_b32 v26, 16, v32
    v_and_b32 v27, 0xffff0000, v32
    v_cvt_pk_bf16_f32 v32, v28, v29
    v_lshlrev_b32 v28, 16, v32
    v_and_b32 v29, 0xffff0000, v32
    v_pk_mul_f32 v[14:15], v[14:15], v[30:31] op_sel:[0,1] op_sel_hi:[1,1]
    v_pk_mul_f32 v[16:17], v[16:17], v[30:31] op_sel:[0,1] op_sel_hi:[1,1]
    v_pk_mul_f32 v[18:19], v[18:19], v[30:31] op_sel:[0,1] op_sel_hi:[1,1]
    v_pk_mul_f32 v[20:21], v[20:21], v[30:31] op_sel:[0,1] op_sel_hi:[1,1]
    v_pk_mul_f32 v[22:23], v[22:23], v[30:31] op_sel:[0,1] op_sel_hi:[1,1]
    v_pk_mul_f32 v[24:25], v[24:25], v[30:31] op_sel:[0,1] op_sel_hi:[1,1]
    v_pk_mul_f32 v[26:27], v[26:27], v[30:31] op_sel:[0,1] op_sel_hi:[1,1]
    v_pk_mul_f32 v[28:29], v[28:29], v[30:31] op_sel:[0,1] op_sel_hi:[1,1]
    v_exp_f32 v14, -v14
    v_exp_f32 v15, -v15
    v_exp_f32 v16, -v16
    v_exp_f32 v17, -v17
    v_exp_f32 v18, -v18
    v_exp_f32 v19, -v19
    v_exp_f32 v20, -v20
    v_exp_f32 v21, -v21
    v_exp_f32 v22, -v22
    v_exp_f32 v23, -v23
    v_exp_f32 v24, -v24
    v_exp_f32 v25, -v25
    v_exp_f32 v26, -v26
    v_exp_f32 v27, -v27
    v_exp_f32 v28, -v28
    v_exp_f32 v29, -v29
    v_cvt_pk_bf16_f32 v14, v14, v16
    v_cvt_pk_bf16_f32 v15, v15, v17
    v_cvt_pk_bf16_f32 v18, v18, v20
    v_cvt_pk_bf16_f32 v19, v19, v21
    v_cvt_pk_bf16_f32 v22, v22, v24
    v_cvt_pk_bf16_f32 v23, v23, v25
    v_cvt_pk_bf16_f32 v26, v26, v28
    v_cvt_pk_bf16_f32 v27, v27, v29
    v_dot2_f32_bf16 v72, v14, s68, 0
    v_dot2_f32_bf16 v73, v15, s68, 0
    v_dot2_f32_bf16 v74, v14, s69, 0
    v_dot2_f32_bf16 v75, v15, s69, 0
    v_dot2_f32_bf16 v76, v14, s70, 0
    v_dot2_f32_bf16 v77, v15, s70, 0
    v_dot2_f32_bf16 v78, v14, s71, 0
    v_dot2_f32_bf16 v79, v15, s71, 0
    v_dot2_f32_bf16 v80, v14, s52, 0
    v_dot2_f32_bf16 v81, v15, s52, 0
    v_dot2_f32_bf16 v82, v14, s53, 0
    v_dot2_f32_bf16 v83, v15, s53, 0
    v_dot2_f32_bf16 v84, v14, s54, 0
    v_dot2_f32_bf16 v85, v15, s54, 0
    v_dot2_f32_bf16 v86, v14, s55, 0
    v_dot2_f32_bf16 v87, v15, s55, 0
    v_dot2_f32_bf16 v72, v18, s72, v72
    v_dot2_f32_bf16 v73, v19, s72, v73
    v_dot2_f32_bf16 v74, v18, s73, v74
    v_dot2_f32_bf16 v75, v19, s73, v75
    v_dot2_f32_bf16 v76, v18, s74, v76
    v_dot2_f32_bf16 v77, v19, s74, v77
    v_dot2_f32_bf16 v78, v18, s75, v78
    v_dot2_f32_bf16 v79, v19, s75, v79
    v_dot2_f32_bf16 v80, v18, s56, v80
    v_dot2_f32_bf16 v81, v19, s56, v81
    v_dot2_f32_bf16 v82, v18, s57, v82
    v_dot2_f32_bf16 v83, v19, s57, v83
    v_dot2_f32_bf16 v84, v18, s58, v84
    v_dot2_f32_bf16 v85, v19, s58, v85
    v_dot2_f32_bf16 v86, v18, s59, v86
    v_dot2_f32_bf16 v87, v19, s59, v87
    v_dot2_f32_bf16 v72, v22, s76, v72
    v_dot2_f32_bf16 v73, v23, s76, v73
    v_dot2_f32_bf16 v74, v22, s77, v74
    v_dot2_f32_bf16 v75, v23, s77, v75
    v_dot2_f32_bf16 v76, v22, s78, v76
    v_dot2_f32_bf16 v77, v23, s78, v77
    v_dot2_f32_bf16 v78, v22, s79, v78
    v_dot2_f32_bf16 v79, v23, s79, v79
    v_dot2_f32_bf16 v80, v22, s60, v80
    v_dot2_f32_bf16 v81, v23, s60, v81
    v_dot2_f32_bf16 v82, v22, s61, v82
    v_dot2_f32_bf16 v83, v23, s61, v83
    v_dot2_f32_bf16 v84, v22, s62, v84
    v_dot2_f32_bf16 v85, v23, s62, v85
    v_dot2_f32_bf16 v86, v22, s63, v86
    v_dot2_f32_bf16 v87, v23, s63, v87
    v_dot2_f32_bf16 v72, v26, s80, v72
    v_dot2_f32_bf16 v73, v27, s80, v73
    v_dot2_f32_bf16 v74, v26, s81, v74
    v_dot2_f32_bf16 v75, v27, s81, v75
    v_dot2_f32_bf16 v76, v26, s82, v76
    v_dot2_f32_bf16 v77, v27, s82, v77
    v_dot2_f32_bf16 v78, v26, s83, v78
    v_dot2_f32_bf16 v79, v27, s83, v79
    v_dot2_f32_bf16 v80, v26, s64, v80
    v_dot2_f32_bf16 v81, v27, s64, v81
    v_dot2_f32_bf16 v82, v26, s65, v82
    v_dot2_f32_bf16 v83, v27, s65, v83
    v_dot2_f32_bf16 v84, v26, s66, v84
    v_dot2_f32_bf16 v85, v27, s66, v85
    v_dot2_f32_bf16 v86, v26, s67, v86
    v_dot2_f32_bf16 v87, v27, s67, v87
    s_cmp_ge_u32 s13, 4
    s_cbranch_scc1 L_p2_kernel_g1_27
    v_lshlrev_b32 v30, 16, v61
    v_and_b32 v31, 0xffff0000, v61
    v_pk_add_f32 v[14:15], v[30:31], v[36:37] op_sel:[0,0] op_sel_hi:[1,0] neg_lo:[0,1] neg_hi:[0,1]
    v_pk_add_f32 v[16:17], v[30:31], v[36:37] op_sel:[0,1] op_sel_hi:[1,1] neg_lo:[0,1] neg_hi:[0,1]
    v_pk_add_f32 v[18:19], v[30:31], v[38:39] op_sel:[0,0] op_sel_hi:[1,0] neg_lo:[0,1] neg_hi:[0,1]
    v_pk_add_f32 v[20:21], v[30:31], v[38:39] op_sel:[0,1] op_sel_hi:[1,1] neg_lo:[0,1] neg_hi:[0,1]
    v_pk_add_f32 v[22:23], v[30:31], v[40:41] op_sel:[0,0] op_sel_hi:[1,0] neg_lo:[0,1] neg_hi:[0,1]
    v_pk_add_f32 v[24:25], v[30:31], v[40:41] op_sel:[0,1] op_sel_hi:[1,1] neg_lo:[0,1] neg_hi:[0,1]
    v_pk_add_f32 v[26:27], v[30:31], v[42:43] op_sel:[0,0] op_sel_hi:[1,0] neg_lo:[0,1] neg_hi:[0,1]
    v_pk_add_f32 v[28:29], v[30:31], v[42:43] op_sel:[0,1] op_sel_hi:[1,1] neg_lo:[0,1] neg_hi:[0,1]
    v_cvt_pk_bf16_f32 v32, v14, v15
    v_lshlrev_b32 v14, 16, v32
    v_and_b32 v15, 0xffff0000, v32
    v_cvt_pk_bf16_f32 v32, v16, v17
    v_lshlrev_b32 v16, 16, v32
    v_and_b32 v17, 0xffff0000, v32
    v_cvt_pk_bf16_f32 v32, v18, v19
    v_lshlrev_b32 v18, 16, v32
    v_and_b32 v19, 0xffff0000, v32
    v_cvt_pk_bf16_f32 v32, v20, v21
    v_lshlrev_b32 v20, 16, v32
    v_and_b32 v21, 0xffff0000, v32
    v_cvt_pk_bf16_f32 v32, v22, v23
    v_lshlrev_b32 v22, 16, v32
    v_and_b32 v23, 0xffff0000, v32
    v_cvt_pk_bf16_f32 v32, v24, v25
    v_lshlrev_b32 v24, 16, v32
    v_and_b32 v25, 0xffff0000, v32
    v_cvt_pk_bf16_f32 v32, v26, v27
    v_lshlrev_b32 v26, 16, v32
    v_and_b32 v27, 0xffff0000, v32
    v_cvt_pk_bf16_f32 v32, v28, v29
    v_lshlrev_b32 v28, 16, v32
    v_and_b32 v29, 0xffff0000, v32
    v_pk_mul_f32 v[14:15], v[14:15], v[14:15]
    v_pk_mul_f32 v[16:17], v[16:17], v[16:17]
    v_pk_mul_f32 v[18:19], v[18:19], v[18:19]
    v_pk_mul_f32 v[20:21], v[20:21], v[20:21]
    v_pk_mul_f32 v[22:23], v[22:23], v[22:23]
    v_pk_mul_f32 v[24:25], v[24:25], v[24:25]
    v_pk_mul_f32 v[26:27], v[26:27], v[26:27]
    v_pk_mul_f32 v[28:29], v[28:29], v[28:29]
    v_cvt_pk_bf16_f32 v32, v14, v15
    v_lshlrev_b32 v14, 16, v32
    v_and_b32 v15, 0xffff0000, v32
    v_cvt_pk_bf16_f32 v32, v16, v17
    v_lshlrev_b32 v16, 16, v32
    v_and_b32 v17, 0xffff0000, v32
    v_cvt_pk_bf16_f32 v32, v18, v19
    v_lshlrev_b32 v18, 16, v32
    v_and_b32 v19, 0xffff0000, v32
    v_cvt_pk_bf16_f32 v32, v20, v21
    v_lshlrev_b32 v20, 16, v32
    v_and_b32 v21, 0xffff0000, v32
    v_cvt_pk_bf16_f32 v32, v22, v23
    v_lshlrev_b32 v22, 16, v32
    v_and_b32 v23, 0xffff0000, v32
    v_cvt_pk_bf16_f32 v32, v24, v25
    v_lshlrev_b32 v24, 16, v32
    v_and_b32 v25, 0xffff0000, v32
    v_cvt_pk_bf16_f32 v32, v26, v27
    v_lshlrev_b32 v26, 16, v32
    v_and_b32 v27, 0xffff0000, v32
    v_cvt_pk_bf16_f32 v32, v28, v29
    v_lshlrev_b32 v28, 16, v32
    v_and_b32 v29, 0xffff0000, v32
    v_mov_b32 v30, 1092616192
    v_mov_b32 v31, 0x3fb8aa3b
    v_pk_mul_f32 v[14:15], v[14:15], v[30:31] op_sel:[0,0] op_sel_hi:[1,0]
    v_pk_mul_f32 v[16:17], v[16:17], v[30:31] op_sel:[0,0] op_sel_hi:[1,0]
    v_pk_mul_f32 v[18:19], v[18:19], v[30:31] op_sel:[0,0] op_sel_hi:[1,0]
    v_pk_mul_f32 v[20:21], v[20:21], v[30:31] op_sel:[0,0] op_sel_hi:[1,0]
    v_pk_mul_f32 v[22:23], v[22:23], v[30:31] op_sel:[0,0] op_sel_hi:[1,0]
    v_pk_mul_f32 v[24:25], v[24:25], v[30:31] op_sel:[0,0] op_sel_hi:[1,0]
    v_pk_mul_f32 v[26:27], v[26:27], v[30:31] op_sel:[0,0] op_sel_hi:[1,0]
    v_pk_mul_f32 v[28:29], v[28:29], v[30:31] op_sel:[0,0] op_sel_hi:[1,0]
    v_cvt_pk_bf16_f32 v32, v14, v15
    v_lshlrev_b32 v14, 16, v32
    v_and_b32 v15, 0xffff0000, v32
    v_cvt_pk_bf16_f32 v32, v16, v17
    v_lshlrev_b32 v16, 16, v32
    v_and_b32 v17, 0xffff0000, v32
    v_cvt_pk_bf16_f32 v32, v18, v19
    v_lshlrev_b32 v18, 16, v32
    v_and_b32 v19, 0xffff0000, v32
    v_cvt_pk_bf16_f32 v32, v20, v21
    v_lshlrev_b32 v20, 16, v32
    v_and_b32 v21, 0xffff0000, v32
    v_cvt_pk_bf16_f32 v32, v22, v23
    v_lshlrev_b32 v22, 16, v32
    v_and_b32 v23, 0xffff0000, v32
    v_cvt_pk_bf16_f32 v32, v24, v25
    v_lshlrev_b32 v24, 16, v32
    v_and_b32 v25, 0xffff0000, v32
    v_cvt_pk_bf16_f32 v32, v26, v27
    v_lshlrev_b32 v26, 16, v32
    v_and_b32 v27, 0xffff0000, v32
    v_cvt_pk_bf16_f32 v32, v28, v29
    v_lshlrev_b32 v28, 16, v32
    v_and_b32 v29, 0xffff0000, v32
    v_pk_mul_f32 v[14:15], v[14:15], v[30:31] op_sel:[0,1] op_sel_hi:[1,1]
    v_pk_mul_f32 v[16:17], v[16:17], v[30:31] op_sel:[0,1] op_sel_hi:[1,1]
    v_pk_mul_f32 v[18:19], v[18:19], v[30:31] op_sel:[0,1] op_sel_hi:[1,1]
    v_pk_mul_f32 v[20:21], v[20:21], v[30:31] op_sel:[0,1] op_sel_hi:[1,1]
    v_pk_mul_f32 v[22:23], v[22:23], v[30:31] op_sel:[0,1] op_sel_hi:[1,1]
    v_pk_mul_f32 v[24:25], v[24:25], v[30:31] op_sel:[0,1] op_sel_hi:[1,1]
    v_pk_mul_f32 v[26:27], v[26:27], v[30:31] op_sel:[0,1] op_sel_hi:[1,1]
    v_pk_mul_f32 v[28:29], v[28:29], v[30:31] op_sel:[0,1] op_sel_hi:[1,1]
    v_exp_f32 v14, -v14
    v_exp_f32 v15, -v15
    v_exp_f32 v16, -v16
    v_exp_f32 v17, -v17
    v_exp_f32 v18, -v18
    v_exp_f32 v19, -v19
    v_exp_f32 v20, -v20
    v_exp_f32 v21, -v21
    v_exp_f32 v22, -v22
    v_exp_f32 v23, -v23
    v_exp_f32 v24, -v24
    v_exp_f32 v25, -v25
    v_exp_f32 v26, -v26
    v_exp_f32 v27, -v27
    v_exp_f32 v28, -v28
    v_exp_f32 v29, -v29
    v_cvt_pk_bf16_f32 v14, v14, v16
    v_cvt_pk_bf16_f32 v15, v15, v17
    v_cvt_pk_bf16_f32 v18, v18, v20
    v_cvt_pk_bf16_f32 v19, v19, v21
    v_cvt_pk_bf16_f32 v22, v22, v24
    v_cvt_pk_bf16_f32 v23, v23, v25
    v_cvt_pk_bf16_f32 v26, v26, v28
    v_cvt_pk_bf16_f32 v27, v27, v29
    v_dot2_f32_bf16 v112, v14, s68, 0
    v_dot2_f32_bf16 v113, v15, s68, 0
    v_dot2_f32_bf16 v114, v14, s69, 0
    v_dot2_f32_bf16 v115, v15, s69, 0
    v_dot2_f32_bf16 v116, v14, s70, 0
    v_dot2_f32_bf16 v117, v15, s70, 0
    v_dot2_f32_bf16 v118, v14, s71, 0
    v_dot2_f32_bf16 v119, v15, s71, 0
    v_dot2_f32_bf16 v120, v14, s52, 0
    v_dot2_f32_bf16 v121, v15, s52, 0
    v_dot2_f32_bf16 v122, v14, s53, 0
    v_dot2_f32_bf16 v123, v15, s53, 0
    v_dot2_f32_bf16 v124, v14, s54, 0
    v_dot2_f32_bf16 v125, v15, s54, 0
    v_dot2_f32_bf16 v126, v14, s55, 0
    v_dot2_f32_bf16 v127, v15, s55, 0
    v_dot2_f32_bf16 v112, v18, s72, v112
    v_dot2_f32_bf16 v113, v19, s72, v113
    v_dot2_f32_bf16 v114, v18, s73, v114
    v_dot2_f32_bf16 v115, v19, s73, v115
    v_dot2_f32_bf16 v116, v18, s74, v116
    v_dot2_f32_bf16 v117, v19, s74, v117
    v_dot2_f32_bf16 v118, v18, s75, v118
    v_dot2_f32_bf16 v119, v19, s75, v119
    v_dot2_f32_bf16 v120, v18, s56, v120
    v_dot2_f32_bf16 v121, v19, s56, v121
    v_dot2_f32_bf16 v122, v18, s57, v122
    v_dot2_f32_bf16 v123, v19, s57, v123
    v_dot2_f32_bf16 v124, v18, s58, v124
    v_dot2_f32_bf16 v125, v19, s58, v125
    v_dot2_f32_bf16 v126, v18, s59, v126
    v_dot2_f32_bf16 v127, v19, s59, v127
    v_dot2_f32_bf16 v112, v22, s76, v112
    v_dot2_f32_bf16 v113, v23, s76, v113
    v_dot2_f32_bf16 v114, v22, s77, v114
    v_dot2_f32_bf16 v115, v23, s77, v115
    v_dot2_f32_bf16 v116, v22, s78, v116
    v_dot2_f32_bf16 v117, v23, s78, v117
    v_dot2_f32_bf16 v118, v22, s79, v118
    v_dot2_f32_bf16 v119, v23, s79, v119
    v_dot2_f32_bf16 v120, v22, s60, v120
    v_dot2_f32_bf16 v121, v23, s60, v121
    v_dot2_f32_bf16 v122, v22, s61, v122
    v_dot2_f32_bf16 v123, v23, s61, v123
    v_dot2_f32_bf16 v124, v22, s62, v124
    v_dot2_f32_bf16 v125, v23, s62, v125
    v_dot2_f32_bf16 v126, v22, s63, v126
    v_dot2_f32_bf16 v127, v23, s63, v127
    v_dot2_f32_bf16 v112, v26, s80, v112
    v_dot2_f32_bf16 v113, v27, s80, v113
    v_dot2_f32_bf16 v114, v26, s81, v114
    v_dot2_f32_bf16 v115, v27, s81, v115
    v_dot2_f32_bf16 v116, v26, s82, v116
    v_dot2_f32_bf16 v117, v27, s82, v117
    v_dot2_f32_bf16 v118, v26, s83, v118
    v_dot2_f32_bf16 v119, v27, s83, v119
    v_dot2_f32_bf16 v120, v26, s64, v120
    v_dot2_f32_bf16 v121, v27, s64, v121
    v_dot2_f32_bf16 v122, v26, s65, v122
    v_dot2_f32_bf16 v123, v27, s65, v123
    v_dot2_f32_bf16 v124, v26, s66, v124
    v_dot2_f32_bf16 v125, v27, s66, v125
    v_dot2_f32_bf16 v126, v26, s67, v126
    v_dot2_f32_bf16 v127, v27, s67, v127
L_p2_kernel_g1_27:
    s_lshl2_add_u32 s14, s3, s49
    s_mul_i32 s26, s14, 20000
    s_add_u32 s15, s26, 227607040
    buffer_load_dwordx4 v[64:67], v1, s[4:7], s15 offen
    buffer_load_dwordx4 v[68:71], v2, s[4:7], s15 offen
    s_branch L_p2_fin
L_p2_done:
    s_branch L_p2_end
L_p2_slow:
    s_barrier
    v_mov_b32 v8, 0
    v_mov_b32 v9, 0
    v_mov_b32 v10, 0
    v_mov_b32 v11, 0
    v_mov_b32 v12, v1
    ds_write_b128 v12, v[8:11]
    v_add_u32 v12, 16384, v12
    ds_write_b128 v12, v[8:11]
    v_add_u32 v12, 16384, v12
    ds_write_b128 v12, v[8:11]
    v_add_u32 v12, 16384, v12
    ds_write_b128 v12, v[8:11]
    v_add_u32 v12, 16384, v12
    ds_write_b128 v12, v[8:11]
    v_add_u32 v12, 16384, v12
    ds_write_b128 v12, v[8:11]
    v_add_u32 v12, 16384, v12
    ds_write_b128 v12, v[8:11]
    v_add_u32 v12, 16384, v12
    ds_write_b128 v12, v[8:11]
    v_add_u32 v12, 16384, v12
    ds_write_b128 v12, v[8:11]
    v_add_u32 v12, 16384, v12
    ds_write_b128 v12, v[8:11]
    v_add_u32 v12, 16384, v12
    v_lshlrev_b32 v13, 4, v0
    v_mov_b32 v29, 0x7fc00000
    v_add_u32 v28, 32896, v13
    v_mul_lo_u32 v14, v0, s23
    v_add_u32 v14, 8192, v14
    s_mul_i32 s25, s12, 65
    s_add_u32 s25, s25, s3
    s_mul_i32 s25, s25, 32896
    s_add_u32 s25, s25, 219029504
    s_lshl_b32 s50, s50, 1
    s_mul_i32 s22, s12, 1280000
    s_mov_b32 s24, 0
    s_waitcnt lgkmcnt(0)
    s_barrier
L_p2_sstep:
    buffer_load_ushort v15, v13, s[4:7], s25 offen
    buffer_load_ushort v16, v28, s[4:7], s25 offen
    s_waitcnt vmcnt(0)
L_p2_srec:
    v_cmp_lt_u32 vcc, v15, v16
    s_nop 1
    s_and_b64 exec, exec, vcc
    s_cbranch_execz L_p2_sdone
    v_mul_u32_u24 v17, 43691, v15
    v_lshrrev_b32 v17, 17, v17
    v_mad_i32_i24 v18, v17, -3, v15
    v_lshl_add_u32 v17, v17, 4, v14
    v_lshl_add_u32 v19, v18, 2, v17
    buffer_load_dword v20, v19, s[4:7], 0 offen
    buffer_load_dword v21, v17, s[4:7], 0 offen offset:12
    v_add_u32 v15, 1, v15
    v_mad_u32_u24 v18, v18, 10, 2
    s_waitcnt vmcnt(0)
    v_lshlrev_b32_sdwa v19, 3, v20 dst_sel:DWORD dst_unused:UNUSED_PAD src0_sel:DWORD src1_sel:WORD_0
    buffer_load_dwordx2 v[22:23], v19, s[8:11], s22 offen
    v_mad_u32_u16 v20, v20, 16, s50 op_sel:[1,0,0,0]
    v_bfe_i32 v21, v21, v18, 10
    v_cmp_eq_i32 vcc, -512, v21
    v_cvt_f32_i32 v21, v21
    v_mul_f32 v21, 989872160, v21
    v_cndmask_b32 v21, v21, v29, vcc
    s_waitcnt vmcnt(0)
    v_lshlrev_b32 v24, 16, v22
    v_and_b32 v25, 0xffff0000, v22
    v_lshlrev_b32 v26, 16, v23
    v_and_b32 v27, 0xffff0000, v23
    v_mul_f32 v24, v21, v24
    v_mul_f32 v25, v21, v25
    v_mul_f32 v26, v21, v26
    v_mul_f32 v27, v21, v27
    ds_add_f32 v20, v24
    ds_add_f32 v20, v25 offset:4
    ds_add_f32 v20, v26 offset:8
    ds_add_f32 v20, v27 offset:12
    s_branch L_p2_srec
L_p2_sdone:
    s_mov_b64 exec, -1
    s_cmp_eq_u32 s24, 7
    s_cselect_b32 s14, 16370, 2
    s_add_u32 s25, s25, s14
    s_add_u32 s22, s22, 80000
    s_add_u32 s24, s24, 1
    s_cmp_lt_u32 s24, 16
    s_cbranch_scc1 L_p2_sstep
    s_waitcnt lgkmcnt(0)
    s_barrier
    s_mul_i32 s14, s12, 10240000
    s_mul_i32 s15, s3, 160000
    s_add_u32 s26, s14, s15
    s_add_u32 s26, s26, 253207040
    v_mov_b32 v12, v1
    s_mov_b32 s24, 0
L_p2_sout:
    v_cmp_gt_u32 vcc, 160000, v12
    ds_read_b128 v[8:11], v12
    s_nop 0
    s_and_b64 exec, exec, vcc
    s_cbranch_execz L_p2_sfin
    s_waitcnt lgkmcnt(0)
    buffer_store_dwordx4 v[8:11], v12, s[4:7], s26 offen sc1
    s_waitcnt vmcnt(0)
    v_add_u32 v12, 16384, v12
    s_branch L_p2_sout
L_p2_sfin:
    s_mov_b64 exec, -1
    s_waitcnt vmcnt(0) lgkmcnt(0)
    s_barrier
    s_branch L_p2_signal
L_p2_end:
    s_endpgm
.section .rodata,"a"
.p2align 6
.amdhsa_kernel p1_kernel
  .amdhsa_next_free_vgpr 128
  .amdhsa_next_free_sgpr 96
  .amdhsa_accum_offset 128
  .amdhsa_group_segment_fixed_size 0
  .amdhsa_kernarg_size 112
  .amdhsa_user_sgpr_count 2
  .amdhsa_user_sgpr_kernarg_segment_ptr 1
  .amdhsa_system_sgpr_workgroup_id_x 1
  .amdhsa_float_denorm_mode_32 0
.end_amdhsa_kernel
.p2align 6
.amdhsa_kernel p2_kernel
  .amdhsa_next_free_vgpr 128
  .amdhsa_next_free_sgpr 102
  .amdhsa_accum_offset 128
  .amdhsa_group_segment_fixed_size 0
  .amdhsa_kernarg_size 112
  .amdhsa_user_sgpr_count 2
  .amdhsa_user_sgpr_kernarg_segment_ptr 1
  .amdhsa_system_sgpr_workgroup_id_x 1
  .amdhsa_float_denorm_mode_32 0
.end_amdhsa_kernel
```

```asm
; @launch kernel=p1_kernel grid=(256,1,1) block=(1024,1,1) lds=163840
; @launch kernel=p2_kernel grid=(256,1,1) block=(1024,1,1) lds=163840
.amdgcn_target "amdgcn-amd-amdhsa--gfx950"
.text
.globl p1_kernel
.p2align 8
.type p1_kernel,@function
p1_kernel:
    s_cmp_ge_u32 s2, 256
    s_cbranch_scc1 L_p1_end
    s_load_dwordx2 s[4:5], s[0:1], 104
    s_load_dwordx2 s[8:9], s[0:1], 8
    s_load_dwordx2 s[12:13], s[0:1], 16
    s_load_dwordx2 s[16:17], s[0:1], 32
    s_load_dwordx2 s[28:29], s[0:1], 0
    s_load_dwordx2 s[6:7], s[0:1], 48
    v_lshlrev_b32 v1, 4, v0
    v_lshlrev_b32 v2, 3, v0
    v_lshrrev_b32 v6, 6, v0
    v_mul_u32_u24 v3, 65472, v6
    v_add_lshl_u32 v3, v3, v0, 4
    v_mov_b32 v4, 1
    v_mov_b32 v5, 0
    v_readfirstlane_b32 s39, v6
    v_cmp_gt_u32 vcc, 784, v0
    s_and_b32 s51, s2, 7
    s_lshl_b32 s51, s51, 0
    s_bfe_u32 s35, s2, 3
    s_add_u32 s51, s51, s35
    s_and_b32 s35, s2, 248
    s_add_u32 s51, s51, s35
    s_and_b32 s32, s2, 7
    s_lshl_b32 s32, s32, 2
    s_bfe_u32 s35, s2, 131075
    s_add_u32 s32, s32, s35
    s_and_b32 s35, s2, 224
    s_add_u32 s32, s32, s35
    s_lshr_b32 s35, s39, 4
    s_mul_i32 s36, s35, 4177920
    s_lshl_b32 s33, s51, 14
    s_add_u32 s33, s33, s36
    s_lshr_b32 s34, s33, 1
    s_mul_i32 s48, s51, 3840
    s_cmp_ge_u32 s35, 0
    s_cselect_b32 s48, s48, 0
    s_lshr_b32 s49, s48, 1
    s_mov_b64 s[44:45], vcc
    s_waitcnt lgkmcnt(0)
    s_load_dword s3, s[6:7], 0
    s_mov_b32 s10, 163840000
    s_mov_b32 s11, 0x00020000
    s_mov_b32 s14, 163840000
    s_mov_b32 s15, 0x00020000
    s_mov_b32 s18, 81920000
    s_mov_b32 s19, 0x00020000
    s_mul_i32 s36, s2, 20000
    s_add_u32 s30, s36, 20000
    s_mov_b32 s31, 0x00020000
    s_add_u32 s35, s36, 16384
    buffer_load_dwordx4 v[48:51], v1, s[28:31], s36 offen nt
    buffer_load_dwordx4 v[52:55], v1, s[28:31], s35 offen nt
    s_add_u32 s35, s33, 0
    buffer_load_dwordx4 v[16:19], v1, s[8:11], s35 offen nt
    s_add_u32 s35, s33, 0
    buffer_load_dwordx4 v[20:23], v1, s[12:15], s35 offen nt
    s_add_u32 s35, s33, 4194304
    buffer_load_dwordx4 v[24:27], v1, s[8:11], s35 offen nt
    s_add_u32 s35, s33, 4194304
    buffer_load_dwordx4 v[28:31], v1, s[12:15], s35 offen nt
    s_add_u32 s35, s33, 8388608
    buffer_load_dwordx4 v[32:35], v1, s[8:11], s35 offen nt
    s_add_u32 s35, s33, 8388608
    buffer_load_dwordx4 v[36:39], v1, s[12:15], s35 offen nt
    s_add_u32 s35, s33, 12582912
    buffer_load_dwordx4 v[40:43], v1, s[8:11], s35 offen nt
    s_add_u32 s35, s33, 12582912
    buffer_load_dwordx4 v[44:47], v1, s[12:15], s35 offen nt
    s_mov_b32 s20, s4
    s_mov_b32 s21, s5
    s_mov_b32 s22, 0
    s_mov_b32 s23, 0x00020000
    s_add_u32 s24, s4, 0
    s_addc_u32 s25, s5, 0
    s_mov_b32 s26, 8573440
    s_mov_b32 s27, 0x00020000
    s_mov_b32 s37, 1492179184
    s_mov_b32 s55, 0
    s_mov_b32 s50, 21845
    s_mov_b32 s38, 262400
    s_mov_b32 s43, 0x05040100
    s_mov_b32 s40, 0
    v_mov_b32 v8, 0
    v_mov_b32 v9, 0
    v_mov_b32 v10, 0
    v_mov_b32 v11, 0
    ds_write_b128 v1, v[8:11] offset:0
    s_waitcnt lgkmcnt(0)
    s_lshl_b32 s3, s3, 16
    v_mov_b32 v12, s3
    v_mul_f32 v12, 0.15915494, v12
    s_nop 0
    v_readfirstlane_b32 s41, v12
    s_waitcnt vmcnt(8)
    s_add_u32 s28, s4, 8573440
    s_addc_u32 s29, s5, 0
    s_mul_i32 s36, s2, 20000
    s_add_u32 s35, s36, 16384
    buffer_store_dwordx4 v[48:51], v1, s[28:31], s36 offen
    buffer_store_dwordx4 v[52:55], v1, s[28:31], s35 offen
    s_nop 0
    v_mov_b32 v12, 0x3f803f80
    v_and_b32 v48, 0x7fff7fff, v48
    v_and_b32 v49, 0x7fff7fff, v49
    v_and_b32 v50, 0x7fff7fff, v50
    v_and_b32 v51, 0x7fff7fff, v51
    v_and_b32 v52, 0x7fff7fff, v52
    v_and_b32 v53, 0x7fff7fff, v53
    v_and_b32 v54, 0x7fff7fff, v54
    v_and_b32 v55, 0x7fff7fff, v55
    v_pk_max_u16 v8, v8, v48
    v_dot2c_f32_bf16 v9, v48, v12
    v_pk_max_u16 v8, v8, v49
    v_dot2c_f32_bf16 v9, v49, v12
    v_pk_max_u16 v8, v8, v50
    v_dot2c_f32_bf16 v9, v50, v12
    v_pk_max_u16 v8, v8, v51
    v_dot2c_f32_bf16 v9, v51, v12
    v_pk_max_u16 v8, v8, v52
    v_dot2c_f32_bf16 v9, v52, v12
    v_pk_max_u16 v8, v8, v53
    v_dot2c_f32_bf16 v9, v53, v12
    v_pk_max_u16 v8, v8, v54
    v_dot2c_f32_bf16 v9, v54, v12
    v_pk_max_u16 v8, v8, v55
    v_dot2c_f32_bf16 v9, v55, v12
    v_lshrrev_b32 v10, 16, v8
    v_and_b32 v8, 0xffff, v8
    v_max_u32 v8, v8, v10
    s_nop 0
    s_nop 1
    v_max_u32_dpp v8, v8, v8 row_shr:1 row_mask:0xf bank_mask:0xf bound_ctrl:0
    s_nop 1
    v_max_u32_dpp v8, v8, v8 row_shr:2 row_mask:0xf bank_mask:0xf bound_ctrl:0
    s_nop 1
    v_max_u32_dpp v8, v8, v8 row_shr:4 row_mask:0xf bank_mask:0xf bound_ctrl:0
    s_nop 1
    v_max_u32_dpp v8, v8, v8 row_shr:8 row_mask:0xf bank_mask:0xf bound_ctrl:0
    s_nop 1
    v_max_u32_dpp v8, v8, v8 row_bcast:15 row_mask:0xa bank_mask:0xf
    s_nop 1
    v_max_u32_dpp v8, v8, v8 row_bcast:31 row_mask:0xc bank_mask:0xf
    s_nop 1
    v_add_f32_dpp v9, v9, v9 row_shr:1 row_mask:0xf bank_mask:0xf bound_ctrl:0
    s_nop 1
    v_add_f32_dpp v9, v9, v9 row_shr:2 row_mask:0xf bank_mask:0xf bound_ctrl:0
    s_nop 1
    v_add_f32_dpp v9, v9, v9 row_shr:4 row_mask:0xf bank_mask:0xf bound_ctrl:0
    s_nop 1
    v_add_f32_dpp v9, v9, v9 row_shr:8 row_mask:0xf bank_mask:0xf bound_ctrl:0
    s_nop 1
    v_add_f32_dpp v9, v9, v9 row_bcast:15 row_mask:0xa bank_mask:0xf
    s_nop 1
    v_add_f32_dpp v9, v9, v9 row_bcast:31 row_mask:0xc bank_mask:0xf
    s_lshl_b32 s35, s39, 4
    s_add_u32 s35, s35, 160320
    v_mov_b32 v10, s35
    s_mov_b32 exec_lo, 0
    s_brev_b32 exec_hi, 1
    ds_write_b64 v10, v[8:9]
    s_mov_b64 exec, -1
    s_waitcnt lgkmcnt(0)
    s_barrier
    s_branch L_p1_first
L_p1_loop:
    s_waitcnt lgkmcnt(13)
    v_lshlrev_b32 v15, 22, v100
    v_lshrrev_b32 v100, 16, v100
    v_alignbit_b32 v15, v100, v15, 10
    v_alignbit_b32 v15, v101, v15, 10
    v_xor_b32 v15, 0x80200800, v15
    s_cmp_lg_u32 s39, 0
    s_cbranch_scc1 L_p1_kernel_nox_1
    s_mov_b32 s36, 218103808
    buffer_store_dwordx4 v[12:15], v3, s[20:23], s36 offen sc1
L_p1_kernel_nox_1:
    s_waitcnt lgkmcnt(12)
    v_lshlrev_b32 v75, 22, v102
    v_lshrrev_b32 v102, 16, v102
    v_alignbit_b32 v75, v102, v75, 10
    v_alignbit_b32 v75, v103, v75, 10
    v_xor_b32 v75, 0x80200800, v75
    s_mov_b32 s36, 0
    buffer_store_dwordx4 v[72:75], v3, s[20:23], s36 offen sc1
    s_waitcnt lgkmcnt(11)
    v_lshlrev_b32 v79, 22, v104
    v_lshrrev_b32 v104, 16, v104
    v_alignbit_b32 v79, v104, v79, 10
    v_alignbit_b32 v79, v105, v79, 10
    v_xor_b32 v79, 0x80200800, v79
    s_mov_b32 s36, 16777216
    buffer_store_dwordx4 v[76:79], v3, s[20:23], s36 offen sc1
    s_waitcnt lgkmcnt(10)
    v_lshlrev_b32 v51, 22, v106
    v_lshrrev_b32 v106, 16, v106
    v_alignbit_b32 v51, v106, v51, 10
    v_alignbit_b32 v51, v107, v51, 10
    v_xor_b32 v51, 0x80200800, v51
    s_mov_b32 s36, 33554432
    buffer_store_dwordx4 v[48:51], v3, s[20:23], s36 offen sc1
    s_add_u32 s35, s33, 16777216
    buffer_load_dwordx4 v[72:75], v1, s[8:11], s35 offen nt
    s_add_u32 s35, s33, 16777216
    buffer_load_dwordx4 v[76:79], v1, s[12:15], s35 offen nt
    s_waitcnt lgkmcnt(9)
    v_lshlrev_b32 v83, 22, v108
    v_lshrrev_b32 v108, 16, v108
    v_alignbit_b32 v83, v108, v83, 10
    v_alignbit_b32 v83, v109, v83, 10
    v_xor_b32 v83, 0x80200800, v83
    s_mov_b32 s36, 50331648
    buffer_store_dwordx4 v[80:83], v3, s[20:23], s36 offen sc1
    s_waitcnt lgkmcnt(8)
    v_lshlrev_b32 v55, 22, v110
    v_lshrrev_b32 v110, 16, v110
    v_alignbit_b32 v55, v110, v55, 10
    v_alignbit_b32 v55, v111, v55, 10
    v_xor_b32 v55, 0x80200800, v55
    s_mov_b32 s36, 67108864
    buffer_store_dwordx4 v[52:55], v3, s[20:23], s36 offen sc1
    s_add_u32 s35, s33, 20971520
    buffer_load_dwordx4 v[80:83], v1, s[8:11], s35 offen nt
    s_add_u32 s35, s33, 20971520
    buffer_load_dwordx4 v[100:103], v1, s[12:15], s35 offen nt
    s_waitcnt lgkmcnt(7)
    v_lshlrev_b32 v87, 22, v112
    v_lshrrev_b32 v112, 16, v112
    v_alignbit_b32 v87, v112, v87, 10
    v_alignbit_b32 v87, v113, v87, 10
    v_xor_b32 v87, 0x80200800, v87
    s_mov_b32 s36, 83886080
    buffer_store_dwordx4 v[84:87], v3, s[20:23], s36 offen sc1
    s_waitcnt lgkmcnt(6)
    v_lshlrev_b32 v59, 22, v114
    v_lshrrev_b32 v114, 16, v114
    v_alignbit_b32 v59, v114, v59, 10
    v_alignbit_b32 v59, v115, v59, 10
    v_xor_b32 v59, 0x80200800, v59
    s_mov_b32 s36, 100663296
    buffer_store_dwordx4 v[56:59], v3, s[20:23], s36 offen sc1
    s_add_u32 s35, s33, 25165824
    buffer_load_dwordx4 v[84:87], v1, s[8:11], s35 offen nt
    s_add_u32 s35, s33, 25165824
    buffer_load_dwordx4 v[104:107], v1, s[12:15], s35 offen nt
    s_waitcnt lgkmcnt(5)
    v_lshlrev_b32 v91, 22, v116
    v_lshrrev_b32 v116, 16, v116
    v_alignbit_b32 v91, v116, v91, 10
    v_alignbit_b32 v91, v117, v91, 10
    v_xor_b32 v91, 0x80200800, v91
    s_mov_b32 s36, 117440512
    buffer_store_dwordx4 v[88:91], v3, s[20:23], s36 offen sc1
    s_waitcnt lgkmcnt(4)
    v_lshlrev_b32 v63, 22, v118
    v_lshrrev_b32 v118, 16, v118
    v_alignbit_b32 v63, v118, v63, 10
    v_alignbit_b32 v63, v119, v63, 10
    v_xor_b32 v63, 0x80200800, v63
    s_mov_b32 s36, 134217728
    buffer_store_dwordx4 v[60:63], v3, s[20:23], s36 offen sc1
    s_add_u32 s35, s33, 29360128
    buffer_load_dwordx4 v[88:91], v1, s[8:11], s35 offen nt
    s_add_u32 s35, s33, 29360128
    buffer_load_dwordx4 v[108:111], v1, s[12:15], s35 offen nt
    s_waitcnt lgkmcnt(3)
    v_lshlrev_b32 v95, 22, v120
    v_lshrrev_b32 v120, 16, v120
    v_alignbit_b32 v95, v120, v95, 10
    v_alignbit_b32 v95, v121, v95, 10
    v_xor_b32 v95, 0x80200800, v95
    s_mov_b32 s36, 150994944
    buffer_store_dwordx4 v[92:95], v3, s[20:23], s36 offen sc1
    s_waitcnt lgkmcnt(2)
    v_lshlrev_b32 v67, 22, v122
    v_lshrrev_b32 v122, 16, v122
    v_alignbit_b32 v67, v122, v67, 10
    v_alignbit_b32 v67, v123, v67, 10
    v_xor_b32 v67, 0x80200800, v67
    s_mov_b32 s36, 167772160
    buffer_store_dwordx4 v[64:67], v3, s[20:23], s36 offen sc1
    s_add_u32 s35, s33, 33554432
    buffer_load_dwordx4 v[92:95], v1, s[8:11], s35 offen nt
    s_add_u32 s35, s33, 33554432
    buffer_load_dwordx4 v[112:115], v1, s[12:15], s35 offen nt
    s_waitcnt lgkmcnt(1)
    v_lshlrev_b32 v99, 22, v124
    v_lshrrev_b32 v124, 16, v124
    v_alignbit_b32 v99, v124, v99, 10
    v_alignbit_b32 v99, v125, v99, 10
    v_xor_b32 v99, 0x80200800, v99
    s_mov_b32 s36, 184549376
    buffer_store_dwordx4 v[96:99], v3, s[20:23], s36 offen sc1
    s_waitcnt lgkmcnt(0)
    v_lshlrev_b32 v71, 22, v126
    v_lshrrev_b32 v126, 16, v126
    v_alignbit_b32 v71, v126, v71, 10
    v_alignbit_b32 v71, v127, v71, 10
    v_xor_b32 v71, 0x80200800, v71
    s_mov_b32 s36, 201326592
    buffer_store_dwordx4 v[68:71], v3, s[20:23], s36 offen sc1
    s_add_u32 s35, s33, 37748736
    s_sub_u32 s35, s35, s48
    v_cndmask_b32 v96, 2.0, v1, s[44:45]
    buffer_load_dwordx4 v[96:99], v96, s[8:11], s35 offen nt
    s_add_u32 s35, s33, 37748736
    s_sub_u32 s35, s35, s48
    v_cndmask_b32 v116, 2.0, v1, s[44:45]
    buffer_load_dwordx4 v[116:119], v116, s[12:15], s35 offen nt
    s_branch L_p1_join
L_p1_first:
    s_add_u32 s35, s33, 16777216
    buffer_load_dwordx4 v[72:75], v1, s[8:11], s35 offen nt
    s_add_u32 s35, s33, 16777216
    buffer_load_dwordx4 v[76:79], v1, s[12:15], s35 offen nt
    s_add_u32 s35, s33, 20971520
    buffer_load_dwordx4 v[80:83], v1, s[8:11], s35 offen nt
    s_add_u32 s35, s33, 20971520
    buffer_load_dwordx4 v[100:103], v1, s[12:15], s35 offen nt
    s_add_u32 s35, s33, 25165824
    buffer_load_dwordx4 v[84:87], v1, s[8:11], s35 offen nt
    s_add_u32 s35, s33, 25165824
    buffer_load_dwordx4 v[104:107], v1, s[12:15], s35 offen nt
    s_add_u32 s35, s33, 29360128
    buffer_load_dwordx4 v[88:91], v1, s[8:11], s35 offen nt
    s_add_u32 s35, s33, 29360128
    buffer_load_dwordx4 v[108:111], v1, s[12:15], s35 offen nt
    s_add_u32 s35, s33, 33554432
    buffer_load_dwordx4 v[92:95], v1, s[8:11], s35 offen nt
    s_add_u32 s35, s33, 33554432
    buffer_load_dwordx4 v[112:115], v1, s[12:15], s35 offen nt
    s_add_u32 s35, s33, 37748736
    s_sub_u32 s35, s35, s48
    v_cndmask_b32 v96, 2.0, v1, s[44:45]
    buffer_load_dwordx4 v[96:99], v96, s[8:11], s35 offen nt
    s_add_u32 s35, s33, 37748736
    s_sub_u32 s35, s35, s48
    v_cndmask_b32 v116, 2.0, v1, s[44:45]
    buffer_load_dwordx4 v[116:119], v116, s[12:15], s35 offen nt
L_p1_join:
    s_waitcnt vmcnt(18)
    v_perm_b32 v6, v20, v16, s43
    v_perm_b32 v7, v21, v17, s43
    v_perm_b32 v8, v22, v18, s43
    v_perm_b32 v9, v23, v19, s43
    v_mul_hi_u32_u24 v16, 429497, v16
    v_mul_hi_u32_u24 v20, 429497, v20
    v_mul_hi_u32_u24 v17, 429497, v17
    v_mul_hi_u32_u24 v21, 429497, v21
    v_mul_hi_u32_u24 v18, 429497, v18
    v_mul_hi_u32_u24 v22, 429497, v22
    v_mul_hi_u32_u24 v19, 429497, v19
    v_mul_hi_u32_u24 v23, 429497, v23
    v_lshl_or_b32 v16, v20, 16, v16
    v_lshl_or_b32 v17, v21, 16, v17
    v_lshl_or_b32 v18, v22, 16, v18
    v_lshl_or_b32 v19, v23, 16, v19
    v_dot2_u32_u16 v20, v16, s38, 0
    v_dot2_u32_u16 v21, v17, s38, 0
    v_dot2_u32_u16 v22, v18, s38, 0
    v_dot2_u32_u16 v23, v19, s38, 0
    v_pk_mad_u16 v6, v16, s37, v6
    v_pk_mad_u16 v7, v17, s37, v7
    v_pk_mad_u16 v8, v18, s37, v8
    v_pk_mad_u16 v9, v19, s37, v9
    ds_add_u32 v20, v4 offset:0
    ds_add_u32 v21, v4 offset:0
    ds_add_u32 v22, v4 offset:0
    ds_add_u32 v23, v4 offset:0
    v_perm_b32 v55, v23, v22, s43
    v_perm_b32 v51, v21, v20, s43
    v_or_b32 v48, 0x40000000, v6
    v_or_b32 v49, 0x40000000, v7
    v_or_b32 v50, 0x40000000, v8
    v_or_b32 v52, 0x40000000, v9
    s_waitcnt vmcnt(16)
    v_perm_b32 v6, v28, v24, s43
    v_perm_b32 v7, v29, v25, s43
    v_perm_b32 v8, v30, v26, s43
    v_perm_b32 v9, v31, v27, s43
    v_mul_hi_u32_u24 v24, 429497, v24
    v_mul_hi_u32_u24 v28, 429497, v28
    v_mul_hi_u32_u24 v25, 429497, v25
    v_mul_hi_u32_u24 v29, 429497, v29
    v_mul_hi_u32_u24 v26, 429497, v26
    v_mul_hi_u32_u24 v30, 429497, v30
    v_mul_hi_u32_u24 v27, 429497, v27
    v_mul_hi_u32_u24 v31, 429497, v31
    v_lshl_or_b32 v24, v28, 16, v24
    v_lshl_or_b32 v25, v29, 16, v25
    v_lshl_or_b32 v26, v30, 16, v26
    v_lshl_or_b32 v27, v31, 16, v27
    v_dot2_u32_u16 v28, v24, s38, 0
    v_dot2_u32_u16 v29, v25, s38, 0
    v_dot2_u32_u16 v30, v26, s38, 0
    v_dot2_u32_u16 v31, v27, s38, 0
    v_pk_mad_u16 v6, v24, s37, v6
    v_pk_mad_u16 v7, v25, s37, v7
    v_pk_mad_u16 v8, v26, s37, v8
    v_pk_mad_u16 v9, v27, s37, v9
    ds_add_u32 v28, v4 offset:0
    ds_add_u32 v29, v4 offset:0
    ds_add_u32 v30, v4 offset:0
    ds_add_u32 v31, v4 offset:0
    v_perm_b32 v63, v31, v30, s43
    v_perm_b32 v59, v29, v28, s43
    v_or_b32 v53, 0x40000000, v6
    v_or_b32 v54, 0x40000000, v7
    v_or_b32 v56, 0x40000000, v8
    v_or_b32 v57, 0x40000000, v9
    s_waitcnt vmcnt(14)
    v_perm_b32 v6, v36, v32, s43
    v_perm_b32 v7, v37, v33, s43
    v_perm_b32 v8, v38, v34, s43
    v_perm_b32 v9, v39, v35, s43
    v_mul_hi_u32_u24 v32, 429497, v32
    v_mul_hi_u32_u24 v36, 429497, v36
    v_mul_hi_u32_u24 v33, 429497, v33
    v_mul_hi_u32_u24 v37, 429497, v37
    v_mul_hi_u32_u24 v34, 429497, v34
    v_mul_hi_u32_u24 v38, 429497, v38
    v_mul_hi_u32_u24 v35, 429497, v35
    v_mul_hi_u32_u24 v39, 429497, v39
    v_lshl_or_b32 v32, v36, 16, v32
    v_lshl_or_b32 v33, v37, 16, v33
    v_lshl_or_b32 v34, v38, 16, v34
    v_lshl_or_b32 v35, v39, 16, v35
    v_dot2_u32_u16 v36, v32, s38, 0
    v_dot2_u32_u16 v37, v33, s38, 0
    v_dot2_u32_u16 v38, v34, s38, 0
    v_dot2_u32_u16 v39, v35, s38, 0
    v_pk_mad_u16 v6, v32, s37, v6
    v_pk_mad_u16 v7, v33, s37, v7
    v_pk_mad_u16 v8, v34, s37, v8
    v_pk_mad_u16 v9, v35, s37, v9
    ds_add_u32 v36, v4 offset:0
    ds_add_u32 v37, v4 offset:0
    ds_add_u32 v38, v4 offset:0
    ds_add_u32 v39, v4 offset:0
    v_perm_b32 v71, v39, v38, s43
    v_perm_b32 v67, v37, v36, s43
    v_or_b32 v58, 0x40000000, v6
    v_or_b32 v60, 0x40000000, v7
    v_or_b32 v61, 0x40000000, v8
    v_or_b32 v62, 0x40000000, v9
    s_waitcnt vmcnt(12)
    v_perm_b32 v6, v44, v40, s43
    v_perm_b32 v7, v45, v41, s43
    v_perm_b32 v8, v46, v42, s43
    v_perm_b32 v9, v47, v43, s43
    v_mul_hi_u32_u24 v40, 429497, v40
    v_mul_hi_u32_u24 v44, 429497, v44
    v_mul_hi_u32_u24 v41, 429497, v41
    v_mul_hi_u32_u24 v45, 429497, v45
    v_mul_hi_u32_u24 v42, 429497, v42
    v_mul_hi_u32_u24 v46, 429497, v46
    v_mul_hi_u32_u24 v43, 429497, v43
    v_mul_hi_u32_u24 v47, 429497, v47
    v_lshl_or_b32 v40, v44, 16, v40
    v_lshl_or_b32 v41, v45, 16, v41
    v_lshl_or_b32 v42, v46, 16, v42
    v_lshl_or_b32 v43, v47, 16, v43
    v_dot2_u32_u16 v44, v40, s38, 0
    v_dot2_u32_u16 v45, v41, s38, 0
    v_dot2_u32_u16 v46, v42, s38, 0
    v_dot2_u32_u16 v47, v43, s38, 0
    v_pk_mad_u16 v6, v40, s37, v6
    v_pk_mad_u16 v7, v41, s37, v7
    v_pk_mad_u16 v8, v42, s37, v8
    v_pk_mad_u16 v9, v43, s37, v9
    ds_add_u32 v44, v4 offset:0
    ds_add_u32 v45, v4 offset:0
    ds_add_u32 v46, v4 offset:0
    ds_add_u32 v47, v4 offset:0
    v_perm_b32 v121, v47, v46, s43
    v_perm_b32 v120, v45, v44, s43
    v_or_b32 v64, 0x40000000, v6
    v_or_b32 v65, 0x40000000, v7
    v_or_b32 v66, 0x40000000, v8
    v_or_b32 v68, 0x40000000, v9
    s_waitcnt vmcnt(10)
    v_perm_b32 v6, v76, v72, s43
    v_perm_b32 v7, v77, v73, s43
    v_perm_b32 v8, v78, v74, s43
    v_perm_b32 v9, v79, v75, s43
    v_mul_hi_u32_u24 v72, 429497, v72
    v_mul_hi_u32_u24 v76, 429497, v76
    v_mul_hi_u32_u24 v73, 429497, v73
    v_mul_hi_u32_u24 v77, 429497, v77
    v_mul_hi_u32_u24 v74, 429497, v74
    v_mul_hi_u32_u24 v78, 429497, v78
    v_mul_hi_u32_u24 v75, 429497, v75
    v_mul_hi_u32_u24 v79, 429497, v79
    v_lshl_or_b32 v72, v76, 16, v72
    v_lshl_or_b32 v73, v77, 16, v73
    v_lshl_or_b32 v74, v78, 16, v74
    v_lshl_or_b32 v75, v79, 16, v75
    v_dot2_u32_u16 v76, v72, s38, 0
    v_dot2_u32_u16 v77, v73, s38, 0
    v_dot2_u32_u16 v78, v74, s38, 0
    v_dot2_u32_u16 v79, v75, s38, 0
    v_pk_mad_u16 v6, v72, s37, v6
    v_pk_mad_u16 v7, v73, s37, v7
    v_pk_mad_u16 v8, v74, s37, v8
    v_pk_mad_u16 v9, v75, s37, v9
    ds_add_u32 v76, v4 offset:0
    ds_add_u32 v77, v4 offset:0
    ds_add_u32 v78, v4 offset:0
    ds_add_u32 v79, v4 offset:0
    v_perm_b32 v123, v79, v78, s43
    v_perm_b32 v122, v77, v76, s43
    v_or_b32 v69, 0x40000000, v6
    v_or_b32 v70, 0x40000000, v7
    v_or_b32 v127, 0x40000000, v8
    v_or_b32 v72, 0x40000000, v9
    s_waitcnt vmcnt(8)
    v_perm_b32 v6, v100, v80, s43
    v_perm_b32 v7, v101, v81, s43
    v_perm_b32 v8, v102, v82, s43
    v_perm_b32 v9, v103, v83, s43
    v_mul_hi_u32_u24 v80, 429497, v80
    v_mul_hi_u32_u24 v100, 429497, v100
    v_mul_hi_u32_u24 v81, 429497, v81
    v_mul_hi_u32_u24 v101, 429497, v101
    v_mul_hi_u32_u24 v82, 429497, v82
    v_mul_hi_u32_u24 v102, 429497, v102
    v_mul_hi_u32_u24 v83, 429497, v83
    v_mul_hi_u32_u24 v103, 429497, v103
    v_lshl_or_b32 v80, v100, 16, v80
    v_lshl_or_b32 v81, v101, 16, v81
    v_lshl_or_b32 v82, v102, 16, v82
    v_lshl_or_b32 v83, v103, 16, v83
    v_dot2_u32_u16 v100, v80, s38, 0
    v_dot2_u32_u16 v101, v81, s38, 0
    v_dot2_u32_u16 v102, v82, s38, 0
    v_dot2_u32_u16 v103, v83, s38, 0
    v_pk_mad_u16 v6, v80, s37, v6
    v_pk_mad_u16 v7, v81, s37, v7
    v_pk_mad_u16 v8, v82, s37, v8
    v_pk_mad_u16 v9, v83, s37, v9
    ds_add_u32 v100, v4 offset:0
    ds_add_u32 v101, v4 offset:0
    ds_add_u32 v102, v4 offset:0
    ds_add_u32 v103, v4 offset:0
    v_perm_b32 v125, v103, v102, s43
    v_perm_b32 v124, v101, v100, s43
    v_or_b32 v73, 0x40000000, v6
    v_or_b32 v74, 0x40000000, v7
    v_or_b32 v76, 0x40000000, v8
    v_or_b32 v77, 0x40000000, v9
    s_waitcnt vmcnt(6)
    v_perm_b32 v6, v104, v84, s43
    v_perm_b32 v7, v105, v85, s43
    v_perm_b32 v8, v106, v86, s43
    v_perm_b32 v9, v107, v87, s43
    v_mul_hi_u32_u24 v84, 429497, v84
    v_mul_hi_u32_u24 v104, 429497, v104
    v_mul_hi_u32_u24 v85, 429497, v85
    v_mul_hi_u32_u24 v105, 429497, v105
    v_mul_hi_u32_u24 v86, 429497, v86
    v_mul_hi_u32_u24 v106, 429497, v106
    v_mul_hi_u32_u24 v87, 429497, v87
    v_mul_hi_u32_u24 v107, 429497, v107
    v_lshl_or_b32 v84, v104, 16, v84
    v_lshl_or_b32 v85, v105, 16, v85
    v_lshl_or_b32 v86, v106, 16, v86
    v_lshl_or_b32 v87, v107, 16, v87
    v_dot2_u32_u16 v104, v84, s38, 0
    v_dot2_u32_u16 v105, v85, s38, 0
    v_dot2_u32_u16 v106, v86, s38, 0
    v_dot2_u32_u16 v107, v87, s38, 0
    v_pk_mad_u16 v6, v84, s37, v6
    v_pk_mad_u16 v7, v85, s37, v7
    v_pk_mad_u16 v8, v86, s37, v8
    v_pk_mad_u16 v9, v87, s37, v9
    ds_add_u32 v104, v4 offset:0
    ds_add_u32 v105, v4 offset:0
    ds_add_u32 v106, v4 offset:0
    ds_add_u32 v107, v4 offset:0
    v_perm_b32 v75, v107, v106, s43
    v_perm_b32 v126, v105, v104, s43
    v_or_b32 v78, 0x40000000, v6
    v_or_b32 v80, 0x40000000, v7
    v_or_b32 v81, 0x40000000, v8
    v_or_b32 v82, 0x40000000, v9
    s_waitcnt vmcnt(4)
    v_perm_b32 v6, v108, v88, s43
    v_perm_b32 v7, v109, v89, s43
    v_perm_b32 v8, v110, v90, s43
    v_perm_b32 v9, v111, v91, s43
    v_mul_hi_u32_u24 v88, 429497, v88
    v_mul_hi_u32_u24 v108, 429497, v108
    v_mul_hi_u32_u24 v89, 429497, v89
    v_mul_hi_u32_u24 v109, 429497, v109
    v_mul_hi_u32_u24 v90, 429497, v90
    v_mul_hi_u32_u24 v110, 429497, v110
    v_mul_hi_u32_u24 v91, 429497, v91
    v_mul_hi_u32_u24 v111, 429497, v111
    v_lshl_or_b32 v88, v108, 16, v88
    v_lshl_or_b32 v89, v109, 16, v89
    v_lshl_or_b32 v90, v110, 16, v90
    v_lshl_or_b32 v91, v111, 16, v91
    v_dot2_u32_u16 v108, v88, s38, 0
    v_dot2_u32_u16 v109, v89, s38, 0
    v_dot2_u32_u16 v110, v90, s38, 0
    v_dot2_u32_u16 v111, v91, s38, 0
    v_pk_mad_u16 v6, v88, s37, v6
    v_pk_mad_u16 v7, v89, s37, v7
    v_pk_mad_u16 v8, v90, s37, v8
    v_pk_mad_u16 v9, v91, s37, v9
    ds_add_u32 v108, v4 offset:0
    ds_add_u32 v109, v4 offset:0
    ds_add_u32 v110, v4 offset:0
    ds_add_u32 v111, v4 offset:0
    v_perm_b32 v83, v111, v110, s43
    v_perm_b32 v79, v109, v108, s43
    v_or_b32 v84, 0x40000000, v6
    v_or_b32 v85, 0x40000000, v7
    v_or_b32 v86, 0x40000000, v8
    v_or_b32 v88, 0x40000000, v9
    s_waitcnt vmcnt(2)
    v_perm_b32 v6, v112, v92, s43
    v_perm_b32 v7, v113, v93, s43
    v_perm_b32 v8, v114, v94, s43
    v_perm_b32 v9, v115, v95, s43
    v_mul_hi_u32_u24 v92, 429497, v92
    v_mul_hi_u32_u24 v112, 429497, v112
    v_mul_hi_u32_u24 v93, 429497, v93
    v_mul_hi_u32_u24 v113, 429497, v113
    v_mul_hi_u32_u24 v94, 429497, v94
    v_mul_hi_u32_u24 v114, 429497, v114
    v_mul_hi_u32_u24 v95, 429497, v95
    v_mul_hi_u32_u24 v115, 429497, v115
    v_lshl_or_b32 v92, v112, 16, v92
    v_lshl_or_b32 v93, v113, 16, v93
    v_lshl_or_b32 v94, v114, 16, v94
    v_lshl_or_b32 v95, v115, 16, v95
    v_dot2_u32_u16 v112, v92, s38, 0
    v_dot2_u32_u16 v113, v93, s38, 0
    v_dot2_u32_u16 v114, v94, s38, 0
    v_dot2_u32_u16 v115, v95, s38, 0
    v_pk_mad_u16 v6, v92, s37, v6
    v_pk_mad_u16 v7, v93, s37, v7
    v_pk_mad_u16 v8, v94, s37, v8
    v_pk_mad_u16 v9, v95, s37, v9
    ds_add_u32 v112, v4 offset:0
    ds_add_u32 v113, v4 offset:0
    ds_add_u32 v114, v4 offset:0
    ds_add_u32 v115, v4 offset:0
    v_perm_b32 v91, v115, v114, s43
    v_perm_b32 v87, v113, v112, s43
    v_or_b32 v89, 0x40000000, v6
    v_or_b32 v90, 0x40000000, v7
    v_or_b32 v92, 0x40000000, v8
    v_or_b32 v93, 0x40000000, v9
    s_waitcnt vmcnt(0)
    s_mov_b64 exec, s[44:45]
    v_perm_b32 v6, v116, v96, s43
    v_perm_b32 v7, v117, v97, s43
    v_perm_b32 v8, v118, v98, s43
    v_perm_b32 v9, v119, v99, s43
    v_mul_hi_u32_u24 v96, 429497, v96
    v_mul_hi_u32_u24 v116, 429497, v116
    v_mul_hi_u32_u24 v97, 429497, v97
    v_mul_hi_u32_u24 v117, 429497, v117
    v_mul_hi_u32_u24 v98, 429497, v98
    v_mul_hi_u32_u24 v118, 429497, v118
    v_mul_hi_u32_u24 v99, 429497, v99
    v_mul_hi_u32_u24 v119, 429497, v119
    v_lshl_or_b32 v96, v116, 16, v96
    v_lshl_or_b32 v97, v117, 16, v97
    v_lshl_or_b32 v98, v118, 16, v98
    v_lshl_or_b32 v99, v119, 16, v99
    v_dot2_u32_u16 v116, v96, s38, 0
    v_dot2_u32_u16 v117, v97, s38, 0
    v_dot2_u32_u16 v118, v98, s38, 0
    v_dot2_u32_u16 v119, v99, s38, 0
    v_pk_mad_u16 v6, v96, s37, v6
    v_pk_mad_u16 v7, v97, s37, v7
    v_pk_mad_u16 v8, v98, s37, v8
    v_pk_mad_u16 v9, v99, s37, v9
    ds_add_u32 v116, v4 offset:0
    ds_add_u32 v117, v4 offset:0
    ds_add_u32 v118, v4 offset:0
    ds_add_u32 v119, v4 offset:0
    v_perm_b32 v99, v119, v118, s43
    v_perm_b32 v95, v117, v116, s43
    v_or_b32 v94, 0x40000000, v6
    v_or_b32 v96, 0x40000000, v7
    v_or_b32 v97, 0x40000000, v8
    v_or_b32 v98, 0x40000000, v9
    s_mov_b64 exec, -1
    s_add_u32 s35, s34, 0
    buffer_load_dwordx2 v[100:101], v2, s[16:19], s35 offen nt
    s_lshl_b32 s42, s32, 5
    s_lshl_b32 s35, s32, 10
    s_add_u32 s35, s35, 14680064
    s_add_u32 s20, s4, s35
    s_addc_u32 s21, s5, 0
    s_waitcnt lgkmcnt(0)
    s_barrier
    ds_read_b128 v[8:11], v1 offset:0
    s_add_u32 s35, s34, 2097152
    buffer_load_dwordx2 v[102:103], v2, s[16:19], s35 offen nt
    s_lshl_b32 s35, s39, 2
    s_add_u32 s35, s35, 160256
    v_mov_b32 v7, s35
    v_and_b32 v14, 15, v0
    v_lshlrev_b32 v14, 2, v14
    v_add_u32 v14, 160256, v14
    s_waitcnt lgkmcnt(0)
    v_cmp_eq_u32 s[56:57], 0, v8
    v_cmp_ge_u32 s[64:65], 1, v8
    v_max_u32 v12, 2, v8
    v_lshl_or_b32 v8, v8, 16, v12
    v_cmp_eq_u32 s[58:59], 0, v9
    v_cmp_ge_u32 s[66:67], 1, v9
    v_max_u32 v12, 2, v9
    v_lshl_or_b32 v9, v9, 16, v12
    v_cmp_eq_u32 s[60:61], 0, v10
    v_cmp_ge_u32 s[68:69], 1, v10
    v_max_u32 v12, 2, v10
    v_lshl_or_b32 v10, v10, 16, v12
    v_cmp_eq_u32 s[62:63], 0, v11
    v_cmp_ge_u32 s[70:71], 1, v11
    v_max_u32 v12, 2, v11
    v_lshl_or_b32 v11, v11, 16, v12
    v_add_u32 v9, v8, v9
    v_add_u32 v10, v9, v10
    v_add_u32 v11, v10, v11
    v_mov_b32 v6, v11
    s_nop 1
    v_add_u32_dpp v6, v6, v6 row_shr:1 row_mask:0xf bank_mask:0xf bound_ctrl:0
    s_nop 1
    v_add_u32_dpp v6, v6, v6 row_shr:2 row_mask:0xf bank_mask:0xf bound_ctrl:0
    s_nop 1
    v_add_u32_dpp v6, v6, v6 row_shr:4 row_mask:0xf bank_mask:0xf bound_ctrl:0
    s_nop 1
    v_add_u32_dpp v6, v6, v6 row_shr:8 row_mask:0xf bank_mask:0xf bound_ctrl:0
    s_nop 1
    v_add_u32_dpp v6, v6, v6 row_bcast:15 row_mask:0xa bank_mask:0xf
    s_nop 1
    v_add_u32_dpp v6, v6, v6 row_bcast:31 row_mask:0xc bank_mask:0xf
    s_mov_b32 exec_lo, 0
    s_brev_b32 exec_hi, 1
    ds_write_b32 v7, v6
    s_mov_b64 exec, -1
    v_sub_u32 v6, v6, v11
    s_or_b64 s[46:47], s[64:65], s[66:67]
    s_or_b64 vcc, s[68:69], s[70:71]
    s_or_b64 s[46:47], s[46:47], vcc
    s_waitcnt lgkmcnt(0)
    s_barrier
    ds_read_b32 v7, v14
    s_add_u32 s35, s34, 4194304
    buffer_load_dwordx2 v[104:105], v2, s[16:19], s35 offen nt
    s_waitcnt lgkmcnt(0)
    v_mov_b32 v15, v7
    s_nop 1
    v_add_u32_dpp v7, v7, v7 row_shr:1 row_mask:0xf bank_mask:0xf bound_ctrl:0
    s_nop 1
    v_add_u32_dpp v7, v7, v7 row_shr:2 row_mask:0xf bank_mask:0xf bound_ctrl:0
    s_nop 1
    v_add_u32_dpp v7, v7, v7 row_shr:4 row_mask:0xf bank_mask:0xf bound_ctrl:0
    s_nop 1
    v_add_u32_dpp v7, v7, v7 row_shr:8 row_mask:0xf bank_mask:0xf bound_ctrl:0
    s_nop 0
    v_readlane_b32 s54, v7, 15
    v_sub_u32 v7, v7, v15
    s_nop 0
    v_readlane_b32 s35, v7, s39
    s_and_b32 s54, s54, 0xffff
    s_cmp_ge_u32 s54, 40063
    s_cselect_b32 s36, 16, 0
    s_cselect_b32 s54, 40000, s54
    s_cselect_b32 s55, 1, s55
    s_cselect_b64 s[46:47], 0, s[46:47]
    v_add_u32 v12, s35, v6
    v_add_u32 v13, v12, v8
    v_add_u32 v14, v12, v9
    v_add_u32 v15, v12, v10
    v_bfe_u32 v12, v12, s36, 16
    v_bfe_u32 v13, v13, s36, 16
    v_bfe_u32 v14, v14, s36, 16
    v_bfe_u32 v15, v15, s36, 16
    ds_write_b128 v1, v[12:15] offset:0
    ds_write_b128 v1, v[12:15] offset:16384
    v_mov_b32 v6, 32768
    v_mov_b32 v7, s54
    s_mov_b64 exec, 1
    ds_write_b32 v6, v7
    s_mov_b64 exec, -1
    s_add_u32 s35, s54, 2
    s_mul_hi_u32 s35, s35, 1431655766
    s_lshl_b32 s35, s35, 4
    s_add_u32 s35, s35, 217890816
    s_min_u32 s22, s35, 218104832
    v_perm_b32 v15, v15, v14, s43
    v_perm_b32 v14, v13, v12, s43
    s_waitcnt lgkmcnt(0)
    s_barrier
    v_and_b32 v6, 63, v0
    s_lshl_b32 s35, s39, 10
    v_lshl_add_u32 v7, v6, 2, s35
    v_lshl_add_u32 v12, v6, 8, s35
    ds_read_b32 v8, v7 offset:16384
    ds_read_b32 v9, v7 offset:16640
    ds_read_b32 v10, v7 offset:16896
    ds_read_b32 v11, v7 offset:17152
    s_mov_b64 exec, 15
    ds_read_b32 v12, v12 offset:16640
    s_mov_b64 exec, -1
    s_lshr_b32 s35, s39, 2
    s_mul_i32 s35, s35, 2138240
    s_and_b32 s36, s39, 1
    s_lshl_b32 s36, s36, 3
    s_add_u32 s35, s35, s36
    s_and_b32 s36, s39, 2
    s_lshl_b32 s36, s36, 3
    s_add_u32 s35, s35, s36
    s_add_u32 s35, s35, s42
    s_add_u32 s36, s35, 2105344
    v_mul_u32_u24 v7, 32896, v6
    v_lshlrev_b32 v13, 1, v6
    s_waitcnt lgkmcnt(1)
    v_perm_b32 v8, v9, v8, s43
    v_perm_b32 v9, v11, v10, s43
    buffer_store_dwordx2 v[8:9], v7, s[24:27], s35 offen
    s_waitcnt lgkmcnt(0)
    s_mov_b64 exec, 15
    buffer_store_short v12, v13, s[24:27], s36 offen
    s_mov_b64 exec, -1
    s_nop 0
    v_and_b32 v6, 0xffff, v51
    v_lshrrev_b32 v7, 16, v51
    v_and_b32 v8, 0xffff, v55
    v_lshrrev_b32 v9, 16, v55
    ds_add_rtn_u32 v6, v6, v4 offset:0
    ds_add_rtn_u32 v7, v7, v4 offset:0
    ds_add_rtn_u32 v8, v8, v4 offset:0
    ds_add_rtn_u32 v9, v9, v4 offset:0
    v_and_b32 v10, 0xffff, v59
    v_lshrrev_b32 v11, 16, v59
    v_and_b32 v12, 0xffff, v63
    v_lshrrev_b32 v13, 16, v63
    ds_add_rtn_u32 v10, v10, v4 offset:0
    ds_add_rtn_u32 v11, v11, v4 offset:0
    ds_add_rtn_u32 v12, v12, v4 offset:0
    ds_add_rtn_u32 v13, v13, v4 offset:0
    s_waitcnt lgkmcnt(4)
    v_perm_b32 v51, v7, v6, s43
    v_perm_b32 v55, v9, v8, s43
    v_and_b32 v6, 0xffff, v67
    v_lshrrev_b32 v7, 16, v67
    v_and_b32 v8, 0xffff, v71
    v_lshrrev_b32 v9, 16, v71
    ds_add_rtn_u32 v6, v6, v4 offset:0
    ds_add_rtn_u32 v7, v7, v4 offset:0
    ds_add_rtn_u32 v8, v8, v4 offset:0
    ds_add_rtn_u32 v9, v9, v4 offset:0
    s_waitcnt lgkmcnt(4)
    v_perm_b32 v59, v11, v10, s43
    v_perm_b32 v63, v13, v12, s43
    s_add_u32 s35, s34, 6291456
    buffer_load_dwordx2 v[106:107], v2, s[16:19], s35 offen nt
    v_and_b32 v10, 0xffff, v120
    v_lshrrev_b32 v11, 16, v120
    v_and_b32 v12, 0xffff, v121
    v_lshrrev_b32 v13, 16, v121
    ds_add_rtn_u32 v10, v10, v4 offset:0
    ds_add_rtn_u32 v11, v11, v4 offset:0
    ds_add_rtn_u32 v12, v12, v4 offset:0
    ds_add_rtn_u32 v13, v13, v4 offset:0
    s_waitcnt lgkmcnt(4)
    v_perm_b32 v67, v7, v6, s43
    v_perm_b32 v71, v9, v8, s43
    s_add_u32 s35, s34, 8388608
    buffer_load_dwordx2 v[108:109], v2, s[16:19], s35 offen nt
    v_and_b32 v6, 0xffff, v122
    v_lshrrev_b32 v7, 16, v122
    v_and_b32 v8, 0xffff, v123
    v_lshrrev_b32 v9, 16, v123
    ds_add_rtn_u32 v6, v6, v4 offset:0
    ds_add_rtn_u32 v7, v7, v4 offset:0
    ds_add_rtn_u32 v8, v8, v4 offset:0
    ds_add_rtn_u32 v9, v9, v4 offset:0
    s_waitcnt lgkmcnt(4)
    v_perm_b32 v120, v11, v10, s43
    v_perm_b32 v121, v13, v12, s43
    s_add_u32 s35, s34, 10485760
    buffer_load_dwordx2 v[110:111], v2, s[16:19], s35 offen nt
    v_and_b32 v10, 0xffff, v124
    v_lshrrev_b32 v11, 16, v124
    v_and_b32 v12, 0xffff, v125
    v_lshrrev_b32 v13, 16, v125
    ds_add_rtn_u32 v10, v10, v4 offset:0
    ds_add_rtn_u32 v11, v11, v4 offset:0
    ds_add_rtn_u32 v12, v12, v4 offset:0
    ds_add_rtn_u32 v13, v13, v4 offset:0
    s_waitcnt lgkmcnt(4)
    v_perm_b32 v122, v7, v6, s43
    v_perm_b32 v123, v9, v8, s43
    v_and_b32 v6, 0xffff, v126
    v_lshrrev_b32 v7, 16, v126
    v_and_b32 v8, 0xffff, v75
    v_lshrrev_b32 v9, 16, v75
    ds_add_rtn_u32 v6, v6, v4 offset:0
    ds_add_rtn_u32 v7, v7, v4 offset:0
    ds_add_rtn_u32 v8, v8, v4 offset:0
    ds_add_rtn_u32 v9, v9, v4 offset:0
    s_waitcnt lgkmcnt(4)
    v_perm_b32 v124, v11, v10, s43
    v_perm_b32 v125, v13, v12, s43
    s_add_u32 s35, s34, 12582912
    buffer_load_dwordx2 v[112:113], v2, s[16:19], s35 offen nt
    v_and_b32 v10, 0xffff, v79
    v_lshrrev_b32 v11, 16, v79
    v_and_b32 v12, 0xffff, v83
    v_lshrrev_b32 v13, 16, v83
    ds_add_rtn_u32 v10, v10, v4 offset:0
    ds_add_rtn_u32 v11, v11, v4 offset:0
    ds_add_rtn_u32 v12, v12, v4 offset:0
    ds_add_rtn_u32 v13, v13, v4 offset:0
    s_waitcnt lgkmcnt(4)
    v_perm_b32 v126, v7, v6, s43
    v_perm_b32 v75, v9, v8, s43
    s_add_u32 s35, s34, 14680064
    buffer_load_dwordx2 v[114:115], v2, s[16:19], s35 offen nt
    v_and_b32 v6, 0xffff, v87
    v_lshrrev_b32 v7, 16, v87
    v_and_b32 v8, 0xffff, v91
    v_lshrrev_b32 v9, 16, v91
    ds_add_rtn_u32 v6, v6, v4 offset:0
    ds_add_rtn_u32 v7, v7, v4 offset:0
    ds_add_rtn_u32 v8, v8, v4 offset:0
    ds_add_rtn_u32 v9, v9, v4 offset:0
    s_waitcnt lgkmcnt(4)
    v_perm_b32 v79, v11, v10, s43
    v_perm_b32 v83, v13, v12, s43
    s_add_u32 s35, s34, 16777216
    buffer_load_dwordx2 v[116:117], v2, s[16:19], s35 offen nt
    s_mov_b64 exec, s[44:45]
    v_and_b32 v10, 0xffff, v95
    v_lshrrev_b32 v11, 16, v95
    v_and_b32 v12, 0xffff, v99
    v_lshrrev_b32 v13, 16, v99
    ds_add_rtn_u32 v10, v10, v4 offset:0
    ds_add_rtn_u32 v11, v11, v4 offset:0
    ds_add_rtn_u32 v12, v12, v4 offset:0
    ds_add_rtn_u32 v13, v13, v4 offset:0
    s_mov_b64 exec, -1
    s_waitcnt lgkmcnt(4)
    v_perm_b32 v87, v7, v6, s43
    v_perm_b32 v91, v9, v8, s43
    s_add_u32 s35, s34, 18874368
    s_sub_u32 s35, s35, s49
    v_cndmask_b32 v118, 2.0, v2, s[44:45]
    buffer_load_dwordx2 v[118:119], v118, s[16:19], s35 offen nt
    s_waitcnt lgkmcnt(0)
    v_perm_b32 v95, v11, v10, s43
    v_perm_b32 v99, v13, v12, s43
    s_barrier
    s_lshl_b32 s35, s54, 2
    v_mov_b32 v6, s35
    v_mov_b32 v7, 0
    v_mov_b32 v12, 1140817920
    s_mov_b64 exec, 1
    ds_write2_b32 v6, v7, v7 offset0:0 offset1:1
    s_cmp_eq_u64 s[46:47], 0
    s_cbranch_scc1 L_p1_kernel_nonull_2
    s_mov_b64 exec, s[64:65]
    v_lshlrev_b32_sdwa v6, 2, v14 dst_sel:DWORD dst_unused:UNUSED_PAD src0_sel:DWORD src1_sel:WORD_0
    ds_write_b32 v6, v7 offset:4
    s_mov_b64 exec, s[56:57]
    ds_write_b32 v6, v7
    s_mov_b64 exec, s[66:67]
    v_lshlrev_b32_sdwa v6, 2, v14 dst_sel:DWORD dst_unused:UNUSED_PAD src0_sel:DWORD src1_sel:WORD_1
    ds_write_b32 v6, v7 offset:4
    s_mov_b64 exec, s[58:59]
    ds_write_b32 v6, v7
    s_mov_b64 exec, s[68:69]
    v_lshlrev_b32_sdwa v6, 2, v15 dst_sel:DWORD dst_unused:UNUSED_PAD src0_sel:DWORD src1_sel:WORD_0
    ds_write_b32 v6, v7 offset:4
    s_mov_b64 exec, s[60:61]
    ds_write_b32 v6, v7
    s_mov_b64 exec, s[70:71]
    v_lshlrev_b32_sdwa v6, 2, v15 dst_sel:DWORD dst_unused:UNUSED_PAD src0_sel:DWORD src1_sel:WORD_1
    ds_write_b32 v6, v7 offset:4
    s_mov_b64 exec, s[62:63]
    ds_write_b32 v6, v7
L_p1_kernel_nonull_2:
    s_mov_b64 exec, -1
    v_lshlrev_b32_sdwa v6, 2, v51 dst_sel:DWORD dst_unused:UNUSED_PAD src0_sel:DWORD src1_sel:WORD_0
    v_lshlrev_b32_sdwa v7, 2, v51 dst_sel:DWORD dst_unused:UNUSED_PAD src0_sel:DWORD src1_sel:WORD_1
    v_lshlrev_b32_sdwa v8, 2, v55 dst_sel:DWORD dst_unused:UNUSED_PAD src0_sel:DWORD src1_sel:WORD_0
    v_lshlrev_b32_sdwa v9, 2, v55 dst_sel:DWORD dst_unused:UNUSED_PAD src0_sel:DWORD src1_sel:WORD_1
    ds_write_b32 v6, v48
    ds_write_b32 v7, v49
    ds_write_b32 v8, v50
    ds_write_b32 v9, v52
    s_waitcnt vmcnt(11)
    v_lshlrev_b32 v10, 16, v100
    v_lshlrev_b32 v11, 16, v101
    v_and_b32 v100, 0xffff0000, v100
    v_and_b32 v101, 0xffff0000, v101
    v_mul_f32 v10, s41, v10
    v_mul_f32 v100, s41, v100
    v_mul_f32 v11, s41, v11
    v_mul_f32 v101, s41, v101
    v_fract_f32 v10, v10
    v_fract_f32 v100, v100
    v_fract_f32 v11, v11
    v_fract_f32 v101, v101
    v_cos_f32 v10, v10
    v_cos_f32 v100, v100
    v_cos_f32 v11, v11
    v_cos_f32 v101, v101
    v_fmaak_f32 v10, v12, v10, 1262486016
    v_fmaak_f32 v100, v12, v100, 1262486016
    v_fmaak_f32 v11, v12, v11, 1262486016
    v_fmaak_f32 v101, v12, v101, 1262486016
    v_or3_b32 v5, v10, v100, v5
    v_or3_b32 v5, v11, v101, v5
    v_perm_b32 v100, v100, v10, s43
    v_perm_b32 v101, v101, v11, s43
    s_add_u32 s35, s33, 40960000
    buffer_load_dwordx4 v[16:19], v1, s[8:11], s35 offen nt
    v_lshlrev_b32_sdwa v6, 2, v59 dst_sel:DWORD dst_unused:UNUSED_PAD src0_sel:DWORD src1_sel:WORD_0
    v_lshlrev_b32_sdwa v7, 2, v59 dst_sel:DWORD dst_unused:UNUSED_PAD src0_sel:DWORD src1_sel:WORD_1
    v_lshlrev_b32_sdwa v8, 2, v63 dst_sel:DWORD dst_unused:UNUSED_PAD src0_sel:DWORD src1_sel:WORD_0
    v_lshlrev_b32_sdwa v9, 2, v63 dst_sel:DWORD dst_unused:UNUSED_PAD src0_sel:DWORD src1_sel:WORD_1
    ds_write_b32 v6, v53
    ds_write_b32 v7, v54
    ds_write_b32 v8, v56
    ds_write_b32 v9, v57
    s_waitcnt vmcnt(11)
    v_lshlrev_b32 v10, 16, v102
    v_lshlrev_b32 v11, 16, v103
    v_and_b32 v102, 0xffff0000, v102
    v_and_b32 v103, 0xffff0000, v103
    v_mul_f32 v10, s41, v10
    v_mul_f32 v102, s41, v102
    v_mul_f32 v11, s41, v11
    v_mul_f32 v103, s41, v103
    v_fract_f32 v10, v10
    v_fract_f32 v102, v102
    v_fract_f32 v11, v11
    v_fract_f32 v103, v103
    v_cos_f32 v10, v10
    v_cos_f32 v102, v102
    v_cos_f32 v11, v11
    v_cos_f32 v103, v103
    v_fmaak_f32 v10, v12, v10, 1262486016
    v_fmaak_f32 v102, v12, v102, 1262486016
    v_fmaak_f32 v11, v12, v11, 1262486016
    v_fmaak_f32 v103, v12, v103, 1262486016
    v_or3_b32 v5, v10, v102, v5
    v_or3_b32 v5, v11, v103, v5
    v_perm_b32 v102, v102, v10, s43
    v_perm_b32 v103, v103, v11, s43
    v_lshlrev_b32_sdwa v6, 2, v67 dst_sel:DWORD dst_unused:UNUSED_PAD src0_sel:DWORD src1_sel:WORD_0
    v_lshlrev_b32_sdwa v7, 2, v67 dst_sel:DWORD dst_unused:UNUSED_PAD src0_sel:DWORD src1_sel:WORD_1
    v_lshlrev_b32_sdwa v8, 2, v71 dst_sel:DWORD dst_unused:UNUSED_PAD src0_sel:DWORD src1_sel:WORD_0
    v_lshlrev_b32_sdwa v9, 2, v71 dst_sel:DWORD dst_unused:UNUSED_PAD src0_sel:DWORD src1_sel:WORD_1
    ds_write_b32 v6, v58
    ds_write_b32 v7, v60
    ds_write_b32 v8, v61
    ds_write_b32 v9, v62
    v_lshlrev_b32_sdwa v6, 2, v120 dst_sel:DWORD dst_unused:UNUSED_PAD src0_sel:DWORD src1_sel:WORD_0
    v_lshlrev_b32_sdwa v7, 2, v120 dst_sel:DWORD dst_unused:UNUSED_PAD src0_sel:DWORD src1_sel:WORD_1
    v_lshlrev_b32_sdwa v8, 2, v121 dst_sel:DWORD dst_unused:UNUSED_PAD src0_sel:DWORD src1_sel:WORD_0
    v_lshlrev_b32_sdwa v9, 2, v121 dst_sel:DWORD dst_unused:UNUSED_PAD src0_sel:DWORD src1_sel:WORD_1
    ds_write_b32 v6, v64
    ds_write_b32 v7, v65
    ds_write_b32 v8, v66
    ds_write_b32 v9, v68
    s_waitcnt vmcnt(10)
    v_lshlrev_b32 v10, 16, v104
    v_lshlrev_b32 v11, 16, v105
    v_and_b32 v104, 0xffff0000, v104
    v_and_b32 v105, 0xffff0000, v105
    v_mul_f32 v10, s41, v10
    v_mul_f32 v104, s41, v104
    v_mul_f32 v11, s41, v11
    v_mul_f32 v105, s41, v105
    v_fract_f32 v10, v10
    v_fract_f32 v104, v104
    v_fract_f32 v11, v11
    v_fract_f32 v105, v105
    v_cos_f32 v10, v10
    v_cos_f32 v104, v104
    v_cos_f32 v11, v11
    v_cos_f32 v105, v105
    v_fmaak_f32 v10, v12, v10, 1262486016
    v_fmaak_f32 v104, v12, v104, 1262486016
    v_fmaak_f32 v11, v12, v11, 1262486016
    v_fmaak_f32 v105, v12, v105, 1262486016
    v_or3_b32 v5, v10, v104, v5
    v_or3_b32 v5, v11, v105, v5
    v_perm_b32 v104, v104, v10, s43
    v_perm_b32 v105, v105, v11, s43
    s_add_u32 s35, s33, 40960000
    buffer_load_dwordx4 v[20:23], v1, s[12:15], s35 offen nt
    v_lshlrev_b32_sdwa v6, 2, v122 dst_sel:DWORD dst_unused:UNUSED_PAD src0_sel:DWORD src1_sel:WORD_0
    v_lshlrev_b32_sdwa v7, 2, v122 dst_sel:DWORD dst_unused:UNUSED_PAD src0_sel:DWORD src1_sel:WORD_1
    v_lshlrev_b32_sdwa v8, 2, v123 dst_sel:DWORD dst_unused:UNUSED_PAD src0_sel:DWORD src1_sel:WORD_0
    v_lshlrev_b32_sdwa v9, 2, v123 dst_sel:DWORD dst_unused:UNUSED_PAD src0_sel:DWORD src1_sel:WORD_1
    ds_write_b32 v6, v69
    ds_write_b32 v7, v70
    ds_write_b32 v8, v127
    ds_write_b32 v9, v72
    s_waitcnt vmcnt(8)
    v_lshlrev_b32 v10, 16, v106
    v_lshlrev_b32 v11, 16, v107
    v_and_b32 v106, 0xffff0000, v106
    v_and_b32 v107, 0xffff0000, v107
    v_mul_f32 v10, s41, v10
    v_mul_f32 v106, s41, v106
    v_mul_f32 v11, s41, v11
    v_mul_f32 v107, s41, v107
    v_fract_f32 v10, v10
    v_fract_f32 v106, v106
    v_fract_f32 v11, v11
    v_fract_f32 v107, v107
    v_cos_f32 v10, v10
    v_cos_f32 v106, v106
    v_cos_f32 v11, v11
    v_cos_f32 v107, v107
    v_fmaak_f32 v10, v12, v10, 1262486016
    v_fmaak_f32 v106, v12, v106, 1262486016
    v_fmaak_f32 v11, v12, v11, 1262486016
    v_fmaak_f32 v107, v12, v107, 1262486016
    v_or3_b32 v5, v10, v106, v5
    v_or3_b32 v5, v11, v107, v5
    v_perm_b32 v106, v106, v10, s43
    v_perm_b32 v107, v107, v11, s43
    v_lshlrev_b32_sdwa v6, 2, v124 dst_sel:DWORD dst_unused:UNUSED_PAD src0_sel:DWORD src1_sel:WORD_0
    v_lshlrev_b32_sdwa v7, 2, v124 dst_sel:DWORD dst_unused:UNUSED_PAD src0_sel:DWORD src1_sel:WORD_1
    v_lshlrev_b32_sdwa v8, 2, v125 dst_sel:DWORD dst_unused:UNUSED_PAD src0_sel:DWORD src1_sel:WORD_0
    v_lshlrev_b32_sdwa v9, 2, v125 dst_sel:DWORD dst_unused:UNUSED_PAD src0_sel:DWORD src1_sel:WORD_1
    ds_write_b32 v6, v73
    ds_write_b32 v7, v74
    ds_write_b32 v8, v76
    ds_write_b32 v9, v77
    v_lshlrev_b32_sdwa v6, 2, v126 dst_sel:DWORD dst_unused:UNUSED_PAD src0_sel:DWORD src1_sel:WORD_0
    v_lshlrev_b32_sdwa v7, 2, v126 dst_sel:DWORD dst_unused:UNUSED_PAD src0_sel:DWORD src1_sel:WORD_1
    v_lshlrev_b32_sdwa v8, 2, v75 dst_sel:DWORD dst_unused:UNUSED_PAD src0_sel:DWORD src1_sel:WORD_0
    v_lshlrev_b32_sdwa v9, 2, v75 dst_sel:DWORD dst_unused:UNUSED_PAD src0_sel:DWORD src1_sel:WORD_1
    ds_write_b32 v6, v78
    ds_write_b32 v7, v80
    ds_write_b32 v8, v81
    ds_write_b32 v9, v82
    s_waitcnt vmcnt(7)
    v_lshlrev_b32 v10, 16, v108
    v_lshlrev_b32 v11, 16, v109
    v_and_b32 v108, 0xffff0000, v108
    v_and_b32 v109, 0xffff0000, v109
    v_mul_f32 v10, s41, v10
    v_mul_f32 v108, s41, v108
    v_mul_f32 v11, s41, v11
    v_mul_f32 v109, s41, v109
    v_fract_f32 v10, v10
    v_fract_f32 v108, v108
    v_fract_f32 v11, v11
    v_fract_f32 v109, v109
    v_cos_f32 v10, v10
    v_cos_f32 v108, v108
    v_cos_f32 v11, v11
    v_cos_f32 v109, v109
    v_fmaak_f32 v10, v12, v10, 1262486016
    v_fmaak_f32 v108, v12, v108, 1262486016
    v_fmaak_f32 v11, v12, v11, 1262486016
    v_fmaak_f32 v109, v12, v109, 1262486016
    v_or3_b32 v5, v10, v108, v5
    v_or3_b32 v5, v11, v109, v5
    v_perm_b32 v108, v108, v10, s43
    v_perm_b32 v109, v109, v11, s43
    s_add_u32 s35, s33, 45154304
    buffer_load_dwordx4 v[24:27], v1, s[8:11], s35 offen nt
    v_lshlrev_b32_sdwa v6, 2, v79 dst_sel:DWORD dst_unused:UNUSED_PAD src0_sel:DWORD src1_sel:WORD_0
    v_lshlrev_b32_sdwa v7, 2, v79 dst_sel:DWORD dst_unused:UNUSED_PAD src0_sel:DWORD src1_sel:WORD_1
    v_lshlrev_b32_sdwa v8, 2, v83 dst_sel:DWORD dst_unused:UNUSED_PAD src0_sel:DWORD src1_sel:WORD_0
    v_lshlrev_b32_sdwa v9, 2, v83 dst_sel:DWORD dst_unused:UNUSED_PAD src0_sel:DWORD src1_sel:WORD_1
    ds_write_b32 v6, v84
    ds_write_b32 v7, v85
    ds_write_b32 v8, v86
    ds_write_b32 v9, v88
    s_waitcnt vmcnt(7)
    v_lshlrev_b32 v10, 16, v110
    v_lshlrev_b32 v11, 16, v111
    v_and_b32 v110, 0xffff0000, v110
    v_and_b32 v111, 0xffff0000, v111
    v_mul_f32 v10, s41, v10
    v_mul_f32 v110, s41, v110
    v_mul_f32 v11, s41, v11
    v_mul_f32 v111, s41, v111
    v_fract_f32 v10, v10
    v_fract_f32 v110, v110
    v_fract_f32 v11, v11
    v_fract_f32 v111, v111
    v_cos_f32 v10, v10
    v_cos_f32 v110, v110
    v_cos_f32 v11, v11
    v_cos_f32 v111, v111
    v_fmaak_f32 v10, v12, v10, 1262486016
    v_fmaak_f32 v110, v12, v110, 1262486016
    v_fmaak_f32 v11, v12, v11, 1262486016
    v_fmaak_f32 v111, v12, v111, 1262486016
    v_or3_b32 v5, v10, v110, v5
    v_or3_b32 v5, v11, v111, v5
    v_perm_b32 v110, v110, v10, s43
    v_perm_b32 v111, v111, v11, s43
    v_lshlrev_b32_sdwa v6, 2, v87 dst_sel:DWORD dst_unused:UNUSED_PAD src0_sel:DWORD src1_sel:WORD_0
    v_lshlrev_b32_sdwa v7, 2, v87 dst_sel:DWORD dst_unused:UNUSED_PAD src0_sel:DWORD src1_sel:WORD_1
    v_lshlrev_b32_sdwa v8, 2, v91 dst_sel:DWORD dst_unused:UNUSED_PAD src0_sel:DWORD src1_sel:WORD_0
    v_lshlrev_b32_sdwa v9, 2, v91 dst_sel:DWORD dst_unused:UNUSED_PAD src0_sel:DWORD src1_sel:WORD_1
    ds_write_b32 v6, v89
    ds_write_b32 v7, v90
    ds_write_b32 v8, v92
    ds_write_b32 v9, v93
    s_mov_b64 exec, s[44:45]
    v_lshlrev_b32_sdwa v6, 2, v95 dst_sel:DWORD dst_unused:UNUSED_PAD src0_sel:DWORD src1_sel:WORD_0
    v_lshlrev_b32_sdwa v7, 2, v95 dst_sel:DWORD dst_unused:UNUSED_PAD src0_sel:DWORD src1_sel:WORD_1
    v_lshlrev_b32_sdwa v8, 2, v99 dst_sel:DWORD dst_unused:UNUSED_PAD src0_sel:DWORD src1_sel:WORD_0
    v_lshlrev_b32_sdwa v9, 2, v99 dst_sel:DWORD dst_unused:UNUSED_PAD src0_sel:DWORD src1_sel:WORD_1
    ds_write_b32 v6, v94
    ds_write_b32 v7, v96
    ds_write_b32 v8, v97
    ds_write_b32 v9, v98
    s_mov_b64 exec, -1
    s_waitcnt vmcnt(6)
    v_lshlrev_b32 v10, 16, v112
    v_lshlrev_b32 v11, 16, v113
    v_and_b32 v112, 0xffff0000, v112
    v_and_b32 v113, 0xffff0000, v113
    v_mul_f32 v10, s41, v10
    v_mul_f32 v112, s41, v112
    v_mul_f32 v11, s41, v11
    v_mul_f32 v113, s41, v113
    v_fract_f32 v10, v10
    v_fract_f32 v112, v112
    v_fract_f32 v11, v11
    v_fract_f32 v113, v113
    v_cos_f32 v10, v10
    v_cos_f32 v112, v112
    v_cos_f32 v11, v11
    v_cos_f32 v113, v113
    v_fmaak_f32 v10, v12, v10, 1262486016
    v_fmaak_f32 v112, v12, v112, 1262486016
    v_fmaak_f32 v11, v12, v11, 1262486016
    v_fmaak_f32 v113, v12, v113, 1262486016
    v_or3_b32 v5, v10, v112, v5
    v_or3_b32 v5, v11, v113, v5
    v_perm_b32 v112, v112, v10, s43
    v_perm_b32 v113, v113, v11, s43
    s_mov_b64 exec, s[44:45]
    s_mov_b64 exec, -1
    s_add_u32 s35, s33, 45154304
    buffer_load_dwordx4 v[28:31], v1, s[12:15], s35 offen nt
    v_mul_u32_u24 v6, 12, v0
    v_add_u32 v7, 61440, v6
    v_add_u32 v8, 122880, v6
    s_waitcnt lgkmcnt(0)
    s_barrier
    s_cmp_lg_u32 s39, 0
    s_cbranch_scc1 L_p1_kernel_nox_3
    ds_read_b32 v12, v8 offset:36864
    ds_read_b32 v13, v8 offset:36868
    ds_read_b32 v14, v8 offset:36872
L_p1_kernel_nox_3:
    ds_read_b32 v48, v6 offset:24576
    ds_read_b32 v49, v6 offset:24580
    ds_read_b32 v50, v6 offset:24584
    ds_read_b32 v52, v6 offset:49152
    ds_read_b32 v53, v6 offset:49156
    ds_read_b32 v54, v6 offset:49160
    ds_read_b32 v56, v7 offset:12288
    ds_read_b32 v57, v7 offset:12292
    ds_read_b32 v58, v7 offset:12296
    ds_read_b32 v60, v7 offset:36864
    ds_read_b32 v61, v7 offset:36868
    ds_read_b32 v62, v7 offset:36872
    ds_read_b32 v64, v8 offset:0
    ds_read_b32 v65, v8 offset:4
    ds_read_b32 v66, v8 offset:8
    ds_read_b32 v68, v8 offset:24576
    ds_read_b32 v69, v8 offset:24580
    ds_read_b32 v70, v8 offset:24584
    ds_read_b32 v72, v6 offset:0
    ds_read_b32 v73, v6 offset:4
    ds_read_b32 v74, v6 offset:8
    ds_read_b32 v76, v6 offset:12288
    ds_read_b32 v77, v6 offset:12292
    ds_read_b32 v78, v6 offset:12296
    ds_read_b32 v80, v6 offset:36864
    ds_read_b32 v81, v6 offset:36868
    ds_read_b32 v82, v6 offset:36872
    ds_read_b32 v84, v7 offset:0
    ds_read_b32 v85, v7 offset:4
    ds_read_b32 v86, v7 offset:8
    ds_read_b32 v88, v7 offset:24576
    ds_read_b32 v89, v7 offset:24580
    ds_read_b32 v90, v7 offset:24584
    ds_read_b32 v92, v7 offset:49152
    ds_read_b32 v93, v7 offset:49156
    ds_read_b32 v94, v7 offset:49160
    ds_read_b32 v96, v8 offset:12288
    ds_read_b32 v97, v8 offset:12292
    ds_read_b32 v98, v8 offset:12296
    s_add_u32 s35, s33, 49348608
    buffer_load_dwordx4 v[32:35], v1, s[8:11], s35 offen nt
    v_mov_b32 v8, 0
    v_mov_b32 v9, 0
    v_mov_b32 v10, 0
    v_mov_b32 v11, 0
    v_mov_b32 v15, 16384
    s_waitcnt lgkmcnt(0)
    s_barrier
    ds_write_b128 v1, v[8:11] offset:0
    s_nop 1
    v_mad_u32_u16 v6, v51, s50, v15 op_sel:[0,0,0,0]
    v_mad_u32_u16 v7, v51, s50, v15 op_sel:[1,0,0,0]
    v_mad_u32_u16 v8, v55, s50, v15 op_sel:[0,0,0,0]
    v_mad_u32_u16 v9, v55, s50, v15 op_sel:[1,0,0,0]
    v_add_u32_sdwa v6, v6, v51 dst_sel:DWORD dst_unused:UNUSED_PAD src0_sel:WORD_1 src1_sel:WORD_0
    v_add_u32_sdwa v7, v7, v51 dst_sel:DWORD dst_unused:UNUSED_PAD src0_sel:WORD_1 src1_sel:WORD_1
    v_add_u32_sdwa v8, v8, v55 dst_sel:DWORD dst_unused:UNUSED_PAD src0_sel:WORD_1 src1_sel:WORD_0
    v_add_u32_sdwa v9, v9, v55 dst_sel:DWORD dst_unused:UNUSED_PAD src0_sel:WORD_1 src1_sel:WORD_1
    v_add_u32 v6, v6, v6
    v_add_u32 v7, v7, v7
    v_add_u32 v8, v8, v8
    v_add_u32 v9, v9, v9
    ds_write_b16 v6, v100 offset:16384
    ds_write_b16_d16_hi v7, v100 offset:16384
    ds_write_b16 v8, v101 offset:16384
    ds_write_b16_d16_hi v9, v101 offset:16384
    v_mov_b32 v6, 1140817920
    s_waitcnt vmcnt(7)
    v_lshlrev_b32 v10, 16, v114
    v_lshlrev_b32 v11, 16, v115
    v_and_b32 v114, 0xffff0000, v114
    v_and_b32 v115, 0xffff0000, v115
    v_mul_f32 v10, s41, v10
    v_mul_f32 v114, s41, v114
    v_mul_f32 v11, s41, v11
    v_mul_f32 v115, s41, v115
    v_fract_f32 v10, v10
    v_fract_f32 v114, v114
    v_fract_f32 v11, v11
    v_fract_f32 v115, v115
    v_cos_f32 v10, v10
    v_cos_f32 v114, v114
    v_cos_f32 v11, v11
    v_cos_f32 v115, v115
    v_fmaak_f32 v10, v6, v10, 1262486016
    v_fmaak_f32 v114, v6, v114, 1262486016
    v_fmaak_f32 v11, v6, v11, 1262486016
    v_fmaak_f32 v115, v6, v115, 1262486016
    v_or3_b32 v5, v10, v114, v5
    v_or3_b32 v5, v11, v115, v5
    v_perm_b32 v114, v114, v10, s43
    v_perm_b32 v115, v115, v11, s43
    v_mad_u32_u16 v6, v59, s50, v15 op_sel:[0,0,0,0]
    v_mad_u32_u16 v7, v59, s50, v15 op_sel:[1,0,0,0]
    v_mad_u32_u16 v8, v63, s50, v15 op_sel:[0,0,0,0]
    v_mad_u32_u16 v9, v63, s50, v15 op_sel:[1,0,0,0]
    v_add_u32_sdwa v6, v6, v59 dst_sel:DWORD dst_unused:UNUSED_PAD src0_sel:WORD_1 src1_sel:WORD_0
    v_add_u32_sdwa v7, v7, v59 dst_sel:DWORD dst_unused:UNUSED_PAD src0_sel:WORD_1 src1_sel:WORD_1
    v_add_u32_sdwa v8, v8, v63 dst_sel:DWORD dst_unused:UNUSED_PAD src0_sel:WORD_1 src1_sel:WORD_0
    v_add_u32_sdwa v9, v9, v63 dst_sel:DWORD dst_unused:UNUSED_PAD src0_sel:WORD_1 src1_sel:WORD_1
    v_add_u32 v6, v6, v6
    v_add_u32 v7, v7, v7
    v_add_u32 v8, v8, v8
    v_add_u32 v9, v9, v9
    ds_write_b16 v6, v102 offset:16384
    ds_write_b16_d16_hi v7, v102 offset:16384
    ds_write_b16 v8, v103 offset:16384
    ds_write_b16_d16_hi v9, v103 offset:16384
    v_mad_u32_u16 v6, v67, s50, v15 op_sel:[0,0,0,0]
    v_mad_u32_u16 v7, v67, s50, v15 op_sel:[1,0,0,0]
    v_mad_u32_u16 v8, v71, s50, v15 op_sel:[0,0,0,0]
    v_mad_u32_u16 v9, v71, s50, v15 op_sel:[1,0,0,0]
    v_add_u32_sdwa v6, v6, v67 dst_sel:DWORD dst_unused:UNUSED_PAD src0_sel:WORD_1 src1_sel:WORD_0
    v_add_u32_sdwa v7, v7, v67 dst_sel:DWORD dst_unused:UNUSED_PAD src0_sel:WORD_1 src1_sel:WORD_1
    v_add_u32_sdwa v8, v8, v71 dst_sel:DWORD dst_unused:UNUSED_PAD src0_sel:WORD_1 src1_sel:WORD_0
    v_add_u32_sdwa v9, v9, v71 dst_sel:DWORD dst_unused:UNUSED_PAD src0_sel:WORD_1 src1_sel:WORD_1
    v_add_u32 v6, v6, v6
    v_add_u32 v7, v7, v7
    v_add_u32 v8, v8, v8
    v_add_u32 v9, v9, v9
    ds_write_b16 v6, v104 offset:16384
    ds_write_b16_d16_hi v7, v104 offset:16384
    ds_write_b16 v8, v105 offset:16384
    ds_write_b16_d16_hi v9, v105 offset:16384
    s_add_u32 s35, s33, 49348608
    buffer_load_dwordx4 v[36:39], v1, s[12:15], s35 offen nt
    v_mad_u32_u16 v6, v120, s50, v15 op_sel:[0,0,0,0]
    v_mad_u32_u16 v7, v120, s50, v15 op_sel:[1,0,0,0]
    v_mad_u32_u16 v8, v121, s50, v15 op_sel:[0,0,0,0]
    v_mad_u32_u16 v9, v121, s50, v15 op_sel:[1,0,0,0]
    v_add_u32_sdwa v6, v6, v120 dst_sel:DWORD dst_unused:UNUSED_PAD src0_sel:WORD_1 src1_sel:WORD_0
    v_add_u32_sdwa v7, v7, v120 dst_sel:DWORD dst_unused:UNUSED_PAD src0_sel:WORD_1 src1_sel:WORD_1
    v_add_u32_sdwa v8, v8, v121 dst_sel:DWORD dst_unused:UNUSED_PAD src0_sel:WORD_1 src1_sel:WORD_0
    v_add_u32_sdwa v9, v9, v121 dst_sel:DWORD dst_unused:UNUSED_PAD src0_sel:WORD_1 src1_sel:WORD_1
    v_add_u32 v6, v6, v6
    v_add_u32 v7, v7, v7
    v_add_u32 v8, v8, v8
    v_add_u32 v9, v9, v9
    ds_write_b16 v6, v106 offset:16384
    ds_write_b16_d16_hi v7, v106 offset:16384
    ds_write_b16 v8, v107 offset:16384
    ds_write_b16_d16_hi v9, v107 offset:16384
    v_mov_b32 v6, 1140817920
    s_waitcnt vmcnt(7)
    v_lshlrev_b32 v10, 16, v116
    v_lshlrev_b32 v11, 16, v117
    v_and_b32 v116, 0xffff0000, v116
    v_and_b32 v117, 0xffff0000, v117
    v_mul_f32 v10, s41, v10
    v_mul_f32 v116, s41, v116
    v_mul_f32 v11, s41, v11
    v_mul_f32 v117, s41, v117
    v_fract_f32 v10, v10
    v_fract_f32 v116, v116
    v_fract_f32 v11, v11
    v_fract_f32 v117, v117
    v_cos_f32 v10, v10
    v_cos_f32 v116, v116
    v_cos_f32 v11, v11
    v_cos_f32 v117, v117
    v_fmaak_f32 v10, v6, v10, 1262486016
    v_fmaak_f32 v116, v6, v116, 1262486016
    v_fmaak_f32 v11, v6, v11, 1262486016
    v_fmaak_f32 v117, v6, v117, 1262486016
    v_or3_b32 v5, v10, v116, v5
    v_or3_b32 v5, v11, v117, v5
    v_perm_b32 v116, v116, v10, s43
    v_perm_b32 v117, v117, v11, s43
    v_mad_u32_u16 v6, v122, s50, v15 op_sel:[0,0,0,0]
    v_mad_u32_u16 v7, v122, s50, v15 op_sel:[1,0,0,0]
    v_mad_u32_u16 v8, v123, s50, v15 op_sel:[0,0,0,0]
    v_mad_u32_u16 v9, v123, s50, v15 op_sel:[1,0,0,0]
    v_add_u32_sdwa v6, v6, v122 dst_sel:DWORD dst_unused:UNUSED_PAD src0_sel:WORD_1 src1_sel:WORD_0
    v_add_u32_sdwa v7, v7, v122 dst_sel:DWORD dst_unused:UNUSED_PAD src0_sel:WORD_1 src1_sel:WORD_1
    v_add_u32_sdwa v8, v8, v123 dst_sel:DWORD dst_unused:UNUSED_PAD src0_sel:WORD_1 src1_sel:WORD_0
    v_add_u32_sdwa v9, v9, v123 dst_sel:DWORD dst_unused:UNUSED_PAD src0_sel:WORD_1 src1_sel:WORD_1
    v_add_u32 v6, v6, v6
    v_add_u32 v7, v7, v7
    v_add_u32 v8, v8, v8
    v_add_u32 v9, v9, v9
    ds_write_b16 v6, v108 offset:16384
    ds_write_b16_d16_hi v7, v108 offset:16384
    ds_write_b16 v8, v109 offset:16384
    ds_write_b16_d16_hi v9, v109 offset:16384
    v_mad_u32_u16 v6, v124, s50, v15 op_sel:[0,0,0,0]
    v_mad_u32_u16 v7, v124, s50, v15 op_sel:[1,0,0,0]
    v_mad_u32_u16 v8, v125, s50, v15 op_sel:[0,0,0,0]
    v_mad_u32_u16 v9, v125, s50, v15 op_sel:[1,0,0,0]
    v_add_u32_sdwa v6, v6, v124 dst_sel:DWORD dst_unused:UNUSED_PAD src0_sel:WORD_1 src1_sel:WORD_0
    v_add_u32_sdwa v7, v7, v124 dst_sel:DWORD dst_unused:UNUSED_PAD src0_sel:WORD_1 src1_sel:WORD_1
    v_add_u32_sdwa v8, v8, v125 dst_sel:DWORD dst_unused:UNUSED_PAD src0_sel:WORD_1 src1_sel:WORD_0
    v_add_u32_sdwa v9, v9, v125 dst_sel:DWORD dst_unused:UNUSED_PAD src0_sel:WORD_1 src1_sel:WORD_1
    v_add_u32 v6, v6, v6
    v_add_u32 v7, v7, v7
    v_add_u32 v8, v8, v8
    v_add_u32 v9, v9, v9
    ds_write_b16 v6, v110 offset:16384
    ds_write_b16_d16_hi v7, v110 offset:16384
    ds_write_b16 v8, v111 offset:16384
    ds_write_b16_d16_hi v9, v111 offset:16384
    s_add_u32 s35, s33, 53542912
    buffer_load_dwordx4 v[40:43], v1, s[8:11], s35 offen nt
    v_mad_u32_u16 v6, v126, s50, v15 op_sel:[0,0,0,0]
    v_mad_u32_u16 v7, v126, s50, v15 op_sel:[1,0,0,0]
    v_mad_u32_u16 v8, v75, s50, v15 op_sel:[0,0,0,0]
    v_mad_u32_u16 v9, v75, s50, v15 op_sel:[1,0,0,0]
    v_add_u32_sdwa v6, v6, v126 dst_sel:DWORD dst_unused:UNUSED_PAD src0_sel:WORD_1 src1_sel:WORD_0
    v_add_u32_sdwa v7, v7, v126 dst_sel:DWORD dst_unused:UNUSED_PAD src0_sel:WORD_1 src1_sel:WORD_1
    v_add_u32_sdwa v8, v8, v75 dst_sel:DWORD dst_unused:UNUSED_PAD src0_sel:WORD_1 src1_sel:WORD_0
    v_add_u32_sdwa v9, v9, v75 dst_sel:DWORD dst_unused:UNUSED_PAD src0_sel:WORD_1 src1_sel:WORD_1
    v_add_u32 v6, v6, v6
    v_add_u32 v7, v7, v7
    v_add_u32 v8, v8, v8
    v_add_u32 v9, v9, v9
    ds_write_b16 v6, v112 offset:16384
    ds_write_b16_d16_hi v7, v112 offset:16384
    ds_write_b16 v8, v113 offset:16384
    ds_write_b16_d16_hi v9, v113 offset:16384
    v_mov_b32 v6, 1140817920
    s_mov_b64 exec, s[44:45]
    s_waitcnt vmcnt(7)
    v_lshlrev_b32 v10, 16, v118
    v_lshlrev_b32 v11, 16, v119
    v_and_b32 v118, 0xffff0000, v118
    v_and_b32 v119, 0xffff0000, v119
    v_mul_f32 v10, s41, v10
    v_mul_f32 v118, s41, v118
    v_mul_f32 v11, s41, v11
    v_mul_f32 v119, s41, v119
    v_fract_f32 v10, v10
    v_fract_f32 v118, v118
    v_fract_f32 v11, v11
    v_fract_f32 v119, v119
    v_cos_f32 v10, v10
    v_cos_f32 v118, v118
    v_cos_f32 v11, v11
    v_cos_f32 v119, v119
    v_fmaak_f32 v10, v6, v10, 1262486016
    v_fmaak_f32 v118, v6, v118, 1262486016
    v_fmaak_f32 v11, v6, v11, 1262486016
    v_fmaak_f32 v119, v6, v119, 1262486016
    v_or3_b32 v5, v10, v118, v5
    v_or3_b32 v5, v11, v119, v5
    v_perm_b32 v118, v118, v10, s43
    v_perm_b32 v119, v119, v11, s43
    s_mov_b64 exec, -1
    v_mad_u32_u16 v6, v79, s50, v15 op_sel:[0,0,0,0]
    v_mad_u32_u16 v7, v79, s50, v15 op_sel:[1,0,0,0]
    v_mad_u32_u16 v8, v83, s50, v15 op_sel:[0,0,0,0]
    v_mad_u32_u16 v9, v83, s50, v15 op_sel:[1,0,0,0]
    v_add_u32_sdwa v6, v6, v79 dst_sel:DWORD dst_unused:UNUSED_PAD src0_sel:WORD_1 src1_sel:WORD_0
    v_add_u32_sdwa v7, v7, v79 dst_sel:DWORD dst_unused:UNUSED_PAD src0_sel:WORD_1 src1_sel:WORD_1
    v_add_u32_sdwa v8, v8, v83 dst_sel:DWORD dst_unused:UNUSED_PAD src0_sel:WORD_1 src1_sel:WORD_0
    v_add_u32_sdwa v9, v9, v83 dst_sel:DWORD dst_unused:UNUSED_PAD src0_sel:WORD_1 src1_sel:WORD_1
    v_add_u32 v6, v6, v6
    v_add_u32 v7, v7, v7
    v_add_u32 v8, v8, v8
    v_add_u32 v9, v9, v9
    ds_write_b16 v6, v114 offset:16384
    ds_write_b16_d16_hi v7, v114 offset:16384
    ds_write_b16 v8, v115 offset:16384
    ds_write_b16_d16_hi v9, v115 offset:16384
    v_mad_u32_u16 v6, v87, s50, v15 op_sel:[0,0,0,0]
    v_mad_u32_u16 v7, v87, s50, v15 op_sel:[1,0,0,0]
    v_mad_u32_u16 v8, v91, s50, v15 op_sel:[0,0,0,0]
    v_mad_u32_u16 v9, v91, s50, v15 op_sel:[1,0,0,0]
    v_add_u32_sdwa v6, v6, v87 dst_sel:DWORD dst_unused:UNUSED_PAD src0_sel:WORD_1 src1_sel:WORD_0
    v_add_u32_sdwa v7, v7, v87 dst_sel:DWORD dst_unused:UNUSED_PAD src0_sel:WORD_1 src1_sel:WORD_1
    v_add_u32_sdwa v8, v8, v91 dst_sel:DWORD dst_unused:UNUSED_PAD src0_sel:WORD_1 src1_sel:WORD_0
    v_add_u32_sdwa v9, v9, v91 dst_sel:DWORD dst_unused:UNUSED_PAD src0_sel:WORD_1 src1_sel:WORD_1
    v_add_u32 v6, v6, v6
    v_add_u32 v7, v7, v7
    v_add_u32 v8, v8, v8
    v_add_u32 v9, v9, v9
    ds_write_b16 v6, v116 offset:16384
    ds_write_b16_d16_hi v7, v116 offset:16384
    ds_write_b16 v8, v117 offset:16384
    ds_write_b16_d16_hi v9, v117 offset:16384
    s_add_u32 s35, s33, 53542912
    buffer_load_dwordx4 v[44:47], v1, s[12:15], s35 offen nt
    s_mov_b64 exec, s[44:45]
    v_mad_u32_u16 v6, v95, s50, v15 op_sel:[0,0,0,0]
    v_mad_u32_u16 v7, v95, s50, v15 op_sel:[1,0,0,0]
    v_mad_u32_u16 v8, v99, s50, v15 op_sel:[0,0,0,0]
    v_mad_u32_u16 v9, v99, s50, v15 op_sel:[1,0,0,0]
    v_add_u32_sdwa v6, v6, v95 dst_sel:DWORD dst_unused:UNUSED_PAD src0_sel:WORD_1 src1_sel:WORD_0
    v_add_u32_sdwa v7, v7, v95 dst_sel:DWORD dst_unused:UNUSED_PAD src0_sel:WORD_1 src1_sel:WORD_1
    v_add_u32_sdwa v8, v8, v99 dst_sel:DWORD dst_unused:UNUSED_PAD src0_sel:WORD_1 src1_sel:WORD_0
    v_add_u32_sdwa v9, v9, v99 dst_sel:DWORD dst_unused:UNUSED_PAD src0_sel:WORD_1 src1_sel:WORD_1
    v_add_u32 v6, v6, v6
    v_add_u32 v7, v7, v7
    v_add_u32 v8, v8, v8
    v_add_u32 v9, v9, v9
    ds_write_b16 v6, v118 offset:16384
    ds_write_b16_d16_hi v7, v118 offset:16384
    ds_write_b16 v8, v119 offset:16384
    ds_write_b16_d16_hi v9, v119 offset:16384
    s_mov_b64 exec, -1
    v_add_u32 v6, 65536, v2
    s_waitcnt lgkmcnt(0)
    s_barrier
    ds_read_b64 v[100:101], v6 offset:57344
    ds_read_b64 v[102:103], v2 offset:16384
    ds_read_b64 v[104:105], v2 offset:24576
    ds_read_b64 v[106:107], v2 offset:32768
    ds_read_b64 v[108:109], v2 offset:40960
    ds_read_b64 v[110:111], v2 offset:49152
    ds_read_b64 v[112:113], v2 offset:57344
    ds_read_b64 v[114:115], v6 offset:0
    ds_read_b64 v[116:117], v6 offset:8192
    ds_read_b64 v[118:119], v6 offset:16384
    ds_read_b64 v[120:121], v6 offset:24576
    ds_read_b64 v[122:123], v6 offset:32768
    ds_read_b64 v[124:125], v6 offset:40960
    ds_read_b64 v[126:127], v6 offset:49152
    s_add_u32 s32, s32, 256
    s_add_u32 s33, s33, 40960000
    s_add_u32 s34, s34, 20480000
    s_add_u32 s40, s40, 1
    s_cmp_lt_u32 s40, 4
    s_cbranch_scc1 L_p1_loop
    s_waitcnt lgkmcnt(13)
    v_lshlrev_b32 v15, 22, v100
    v_lshrrev_b32 v100, 16, v100
    v_alignbit_b32 v15, v100, v15, 10
    v_alignbit_b32 v15, v101, v15, 10
    v_xor_b32 v15, 0x80200800, v15
    s_cmp_lg_u32 s39, 0
    s_cbranch_scc1 L_p1_kernel_nox_4
    s_mov_b32 s36, 218103808
    buffer_store_dwordx4 v[12:15], v3, s[20:23], s36 offen sc1
L_p1_kernel_nox_4:
    s_waitcnt lgkmcnt(12)
    v_lshlrev_b32 v75, 22, v102
    v_lshrrev_b32 v102, 16, v102
    v_alignbit_b32 v75, v102, v75, 10
    v_alignbit_b32 v75, v103, v75, 10
    v_xor_b32 v75, 0x80200800, v75
    s_mov_b32 s36, 0
    buffer_store_dwordx4 v[72:75], v3, s[20:23], s36 offen sc1
    s_waitcnt lgkmcnt(11)
    v_lshlrev_b32 v79, 22, v104
    v_lshrrev_b32 v104, 16, v104
    v_alignbit_b32 v79, v104, v79, 10
    v_alignbit_b32 v79, v105, v79, 10
    v_xor_b32 v79, 0x80200800, v79
    s_mov_b32 s36, 16777216
    buffer_store_dwordx4 v[76:79], v3, s[20:23], s36 offen sc1
    s_waitcnt lgkmcnt(10)
    v_lshlrev_b32 v51, 22, v106
    v_lshrrev_b32 v106, 16, v106
    v_alignbit_b32 v51, v106, v51, 10
    v_alignbit_b32 v51, v107, v51, 10
    v_xor_b32 v51, 0x80200800, v51
    s_mov_b32 s36, 33554432
    buffer_store_dwordx4 v[48:51], v3, s[20:23], s36 offen sc1
    s_waitcnt lgkmcnt(9)
    v_lshlrev_b32 v83, 22, v108
    v_lshrrev_b32 v108, 16, v108
    v_alignbit_b32 v83, v108, v83, 10
    v_alignbit_b32 v83, v109, v83, 10
    v_xor_b32 v83, 0x80200800, v83
    s_mov_b32 s36, 50331648
    buffer_store_dwordx4 v[80:83], v3, s[20:23], s36 offen sc1
    s_waitcnt lgkmcnt(8)
    v_lshlrev_b32 v55, 22, v110
    v_lshrrev_b32 v110, 16, v110
    v_alignbit_b32 v55, v110, v55, 10
    v_alignbit_b32 v55, v111, v55, 10
    v_xor_b32 v55, 0x80200800, v55
    s_mov_b32 s36, 67108864
    buffer_store_dwordx4 v[52:55], v3, s[20:23], s36 offen sc1
    s_waitcnt lgkmcnt(7)
    v_lshlrev_b32 v87, 22, v112
    v_lshrrev_b32 v112, 16, v112
    v_alignbit_b32 v87, v112, v87, 10
    v_alignbit_b32 v87, v113, v87, 10
    v_xor_b32 v87, 0x80200800, v87
    s_mov_b32 s36, 83886080
    buffer_store_dwordx4 v[84:87], v3, s[20:23], s36 offen sc1
    s_waitcnt lgkmcnt(6)
    v_lshlrev_b32 v59, 22, v114
    v_lshrrev_b32 v114, 16, v114
    v_alignbit_b32 v59, v114, v59, 10
    v_alignbit_b32 v59, v115, v59, 10
    v_xor_b32 v59, 0x80200800, v59
    s_mov_b32 s36, 100663296
    buffer_store_dwordx4 v[56:59], v3, s[20:23], s36 offen sc1
    s_waitcnt lgkmcnt(5)
    v_lshlrev_b32 v91, 22, v116
    v_lshrrev_b32 v116, 16, v116
    v_alignbit_b32 v91, v116, v91, 10
    v_alignbit_b32 v91, v117, v91, 10
    v_xor_b32 v91, 0x80200800, v91
    s_mov_b32 s36, 117440512
    buffer_store_dwordx4 v[88:91], v3, s[20:23], s36 offen sc1
    s_waitcnt lgkmcnt(4)
    v_lshlrev_b32 v63, 22, v118
    v_lshrrev_b32 v118, 16, v118
    v_alignbit_b32 v63, v118, v63, 10
    v_alignbit_b32 v63, v119, v63, 10
    v_xor_b32 v63, 0x80200800, v63
    s_mov_b32 s36, 134217728
    buffer_store_dwordx4 v[60:63], v3, s[20:23], s36 offen sc1
    s_waitcnt lgkmcnt(3)
    v_lshlrev_b32 v95, 22, v120
    v_lshrrev_b32 v120, 16, v120
    v_alignbit_b32 v95, v120, v95, 10
    v_alignbit_b32 v95, v121, v95, 10
    v_xor_b32 v95, 0x80200800, v95
    s_mov_b32 s36, 150994944
    buffer_store_dwordx4 v[92:95], v3, s[20:23], s36 offen sc1
    s_waitcnt lgkmcnt(2)
    v_lshlrev_b32 v67, 22, v122
    v_lshrrev_b32 v122, 16, v122
    v_alignbit_b32 v67, v122, v67, 10
    v_alignbit_b32 v67, v123, v67, 10
    v_xor_b32 v67, 0x80200800, v67
    s_mov_b32 s36, 167772160
    buffer_store_dwordx4 v[64:67], v3, s[20:23], s36 offen sc1
    s_waitcnt lgkmcnt(1)
    v_lshlrev_b32 v99, 22, v124
    v_lshrrev_b32 v124, 16, v124
    v_alignbit_b32 v99, v124, v99, 10
    v_alignbit_b32 v99, v125, v99, 10
    v_xor_b32 v99, 0x80200800, v99
    s_mov_b32 s36, 184549376
    buffer_store_dwordx4 v[96:99], v3, s[20:23], s36 offen sc1
    s_waitcnt lgkmcnt(0)
    v_lshlrev_b32 v71, 22, v126
    v_lshrrev_b32 v126, 16, v126
    v_alignbit_b32 v71, v126, v71, 10
    v_alignbit_b32 v71, v127, v71, 10
    v_xor_b32 v71, 0x80200800, v71
    s_mov_b32 s36, 201326592
    buffer_store_dwordx4 v[68:71], v3, s[20:23], s36 offen sc1
    v_and_b32 v6, 0x34800000, v5
    v_cmp_ne_u32 vcc, 0, v6
    s_lshl_b32 s35, s39, 4
    s_add_u32 s35, s35, 160328
    v_mov_b32 v10, s35
    s_cmp_lg_u64 vcc, 0
    s_cselect_b32 s36, 1, s55
    v_mov_b32 v11, s36
    ds_write_b32 v10, v11
    s_waitcnt lgkmcnt(0)
    s_barrier
    s_cmp_lg_u32 s39, 0
    s_cbranch_scc1 L_p1_end
    v_and_b32 v6, 15, v0
    v_lshlrev_b32 v6, 4, v6
    v_add_u32 v6, 160320, v6
    ds_read_b128 v[8:11], v6
    s_waitcnt lgkmcnt(0)
    s_nop 1
    v_max_u32_dpp v8, v8, v8 row_shr:1 row_mask:0xf bank_mask:0xf bound_ctrl:0
    s_nop 1
    v_max_u32_dpp v8, v8, v8 row_shr:2 row_mask:0xf bank_mask:0xf bound_ctrl:0
    s_nop 1
    v_max_u32_dpp v8, v8, v8 row_shr:4 row_mask:0xf bank_mask:0xf bound_ctrl:0
    s_nop 1
    v_max_u32_dpp v8, v8, v8 row_shr:8 row_mask:0xf bank_mask:0xf bound_ctrl:0
    s_nop 1
    v_add_f32_dpp v9, v9, v9 row_shr:1 row_mask:0xf bank_mask:0xf bound_ctrl:0
    s_nop 1
    v_add_f32_dpp v9, v9, v9 row_shr:2 row_mask:0xf bank_mask:0xf bound_ctrl:0
    s_nop 1
    v_add_f32_dpp v9, v9, v9 row_shr:4 row_mask:0xf bank_mask:0xf bound_ctrl:0
    s_nop 1
    v_add_f32_dpp v9, v9, v9 row_shr:8 row_mask:0xf bank_mask:0xf bound_ctrl:0
    s_nop 1
    v_or_b32_dpp v10, v10, v10 row_shr:1 row_mask:0xf bank_mask:0xf bound_ctrl:0
    s_nop 1
    v_or_b32_dpp v10, v10, v10 row_shr:2 row_mask:0xf bank_mask:0xf bound_ctrl:0
    s_nop 1
    v_or_b32_dpp v10, v10, v10 row_shr:4 row_mask:0xf bank_mask:0xf bound_ctrl:0
    s_nop 1
    v_or_b32_dpp v10, v10, v10 row_shr:8 row_mask:0xf bank_mask:0xf bound_ctrl:0
    s_lshl_b32 s35, s2, 3
    s_add_u32 s35, s35, 8552960
    v_mov_b32 v6, 0
    v_lshl_or_b32 v8, v10, 16, v8
    s_mov_b64 exec, 0x8000
    buffer_store_dwordx2 v[8:9], v6, s[24:27], s35 offen
    s_lshl_b32 s35, s2, 8
    s_add_u32 s35, s35, 8557056
    buffer_store_dword v6, v6, s[24:27], s35 offen
L_p1_end:
    s_endpgm
.globl p2_kernel
.p2align 8
.type p2_kernel,@function
p2_kernel:
    s_cmp_ge_u32 s2, 256
    s_cbranch_scc1 L_p2_end
    s_load_dwordx2 s[4:5], s[0:1], 104
    s_load_dwordx2 s[100:101], s[0:1], 24
    s_load_dwordx2 s[30:31], s[0:1], 40
    s_load_dwordx4 s[32:35], s[0:1], 56
    s_load_dwordx4 s[36:39], s[0:1], 72
    s_and_b32 s14, s2, 7
    s_lshr_b32 s49, s2, 3
    s_and_b32 s3, s14, 1
    s_lshl_b32 s3, s3, 5
    s_add_u32 s3, s3, s49
    s_lshr_b32 s12, s14, 1
    v_lshrrev_b32 v108, 6, v0
    v_lshlrev_b32 v1, 4, v0
    v_and_b32 v109, 63, v0
    v_readfirstlane_b32 s13, v108
    v_lshlrev_b32 v111, 4, v109
    v_lshlrev_b32 v110, 5, v0
    s_mul_i32 s14, s12, 65
    s_add_u32 s14, s14, s3
    s_mul_i32 s14, s14, 32896
    s_add_u32 s25, s14, 0
    s_mul_i32 s22, s12, 1280000
    s_mov_b32 s2, 0
    s_waitcnt lgkmcnt(0)
    s_mov_b32 s6, 655360000
    s_mov_b32 s7, 0x00020000
    s_add_u32 s8, s4, 8573440
    s_addc_u32 s9, s5, 0
    s_add_u32 s10, s22, 1280000
    s_mov_b32 s11, 0x00020000
    s_add_u32 s15, s25, 0
    buffer_load_dwordx4 v[28:31], v110, s[4:7], s15 offen
    s_add_u32 s15, s25, 32896
    buffer_load_dwordx4 v[36:39], v110, s[4:7], s15 offen
    s_add_u32 s15, s25, 16
    buffer_load_dwordx4 v[32:35], v110, s[4:7], s15 offen
    s_add_u32 s15, s25, 32912
    buffer_load_dwordx4 v[40:43], v110, s[4:7], s15 offen
    s_load_dwordx4 s[40:43], s[30:31], 0
    s_load_dwordx16 s[52:67], s[32:33], 0
    s_load_dwordx16 s[68:83], s[34:35], 0
    s_load_dwordx8 s[84:91], s[36:37], 0
    s_load_dwordx8 s[92:99], s[38:39], 0
    v_mov_b32 v52, 0x100
    s_cmp_lg_u32 s13, 0
    s_cbranch_scc1 L_p2_noann
    s_lshl_b32 s14, s3, 8
    s_add_u32 s14, s14, 8557056
    s_mov_b64 exec, 1
    buffer_atomic_add v52, off, s[4:7], s14
    s_mov_b64 exec, -1
L_p2_noann:
    s_add_u32 s14, s22, 0
    buffer_load_dwordx4 v[88:91], v1, s[8:11], s14 offen
    s_add_u32 s14, s22, 16384
    buffer_load_dwordx4 v[92:95], v1, s[8:11], s14 offen
    s_add_u32 s14, s22, 32768
    buffer_load_dwordx4 v[96:99], v1, s[8:11], s14 offen
    s_add_u32 s14, s22, 49152
    buffer_load_dwordx4 v[100:103], v1, s[8:11], s14 offen
    s_add_u32 s14, s22, 65536
    buffer_load_dwordx4 v[104:107], v1, s[8:11], s14 offen
    s_mov_b32 s15, 8552960
    buffer_load_dwordx4 v[80:83], v111, s[4:7], s15 offen offset:0
    buffer_load_dwordx4 v[84:87], v111, s[4:7], s15 offen offset:1024
    v_lshlrev_b32 v2, 10, v109
    v_mov_b32 v50, 21845
    v_add_u32 v3, 80000, v1
    v_add_u32 v124, 145536, v1
    v_add_u32 v113, 65536, v1
    v_mov_b32 v112, 0x7f000000
    v_cmp_gt_u32 vcc, 904, v0
    s_mul_i32 s19, s13, 240
    s_add_u32 s19, s19, 160000
    v_cndmask_b32 v124, v112, v124, vcc
    v_cndmask_b32 v113, v112, v113, vcc
    v_lshl_add_u32 v6, v109, 2, s19
    v_lshl_add_u32 v126, v109, 1, s19
    v_cmp_gt_u32 vcc, 10, v109
    s_lshl_b32 s27, s13, 16
    s_mov_b32 s23, 1024
    v_cndmask_b32 v6, v112, v6, vcc
    s_add_u32 s44, s4, 9437184
    s_addc_u32 s45, s5, 1048576
    s_mov_b32 s46, 14024704
    s_mov_b32 s47, 0x00020000
    s_mov_b32 s17, 0x05040100
    s_mov_b32 s18, 80000
    s_and_b32 s50, s3, 1
    s_lshl_b32 s50, s50, 18
    s_sub_u32 s50, 4294836224, s50
    s_mov_b32 s20, 3221209088
    s_mov_b32 s21, 3221209087
    v_mov_b32 v4, 0
    v_mov_b32 v5, 0
    v_mov_b32 v114, 0xff00
    ds_write_b32 v6, v5 offset:160
    ds_write_b16 v126, v114 offset:2
    v_mov_b32 v44, 1073758208
    v_mov_b32 v45, 1073758208
    v_mov_b32 v46, 1073758208
    v_mov_b32 v47, 1073758208
    v_mov_b32 v48, 1073758208
    v_mov_b32 v49, 1073758208
    ds_write_b128 v1, v[44:47] offset:0
    ds_write_b128 v1, v[44:47] offset:16384
    ds_write_b128 v1, v[44:47] offset:32768
    ds_write_b128 v1, v[44:47] offset:49152
    ds_write_b128 v113, v[44:47]
    s_waitcnt lgkmcnt(0)
    v_mov_b32 v53, s40
    v_mov_b32 v54, s41
    v_mov_b32 v56, s42
    v_mov_b32 v57, s43
    s_mov_b32 s40, 20987904
    s_mov_b32 s41, 21031594
    s_pack_ll_b32_b16 s14, s52, s54
    s_pack_hh_b32_b16 s15, s52, s54
    s_pack_ll_b32_b16 s54, s53, s55
    s_pack_hh_b32_b16 s55, s53, s55
    s_mov_b32 s52, s14
    s_mov_b32 s53, s15
    s_pack_ll_b32_b16 s14, s56, s58
    s_pack_hh_b32_b16 s15, s56, s58
    s_pack_ll_b32_b16 s58, s57, s59
    s_pack_hh_b32_b16 s59, s57, s59
    s_mov_b32 s56, s14
    s_mov_b32 s57, s15
    s_pack_ll_b32_b16 s14, s60, s62
    s_pack_hh_b32_b16 s15, s60, s62
    s_pack_ll_b32_b16 s62, s61, s63
    s_pack_hh_b32_b16 s63, s61, s63
    s_mov_b32 s60, s14
    s_mov_b32 s61, s15
    s_pack_ll_b32_b16 s14, s64, s66
    s_pack_hh_b32_b16 s15, s64, s66
    s_pack_ll_b32_b16 s66, s65, s67
    s_pack_hh_b32_b16 s67, s65, s67
    s_mov_b32 s64, s14
    s_mov_b32 s65, s15
    s_pack_ll_b32_b16 s14, s68, s70
    s_pack_hh_b32_b16 s15, s68, s70
    s_pack_ll_b32_b16 s70, s69, s71
    s_pack_hh_b32_b16 s71, s69, s71
    s_mov_b32 s68, s14
    s_mov_b32 s69, s15
    s_pack_ll_b32_b16 s14, s72, s74
    s_pack_hh_b32_b16 s15, s72, s74
    s_pack_ll_b32_b16 s74, s73, s75
    s_pack_hh_b32_b16 s75, s73, s75
    s_mov_b32 s72, s14
    s_mov_b32 s73, s15
    s_pack_ll_b32_b16 s14, s76, s78
    s_pack_hh_b32_b16 s15, s76, s78
    s_pack_ll_b32_b16 s78, s77, s79
    s_pack_hh_b32_b16 s79, s77, s79
    s_mov_b32 s76, s14
    s_mov_b32 s77, s15
    s_pack_ll_b32_b16 s14, s80, s82
    s_pack_hh_b32_b16 s15, s80, s82
    s_pack_ll_b32_b16 s82, s81, s83
    s_pack_hh_b32_b16 s83, s81, s83
    s_mov_b32 s80, s14
    s_mov_b32 s81, s15
    s_waitcnt vmcnt(9)
    v_mad_u32_u16 v108, v28, v50, s40 op_sel:[0,0,0,0]
    v_mad_u32_u16 v109, v36, v50, s41 op_sel:[0,0,0,0]
    v_sub_u32_sdwa v110, v109, v108 dst_sel:DWORD dst_unused:UNUSED_PAD src0_sel:WORD_1 src1_sel:WORD_1
    s_nop 1
    v_add_u32_dpp v110, v110, v110 row_shr:1 row_mask:0xf bank_mask:0xf bound_ctrl:0
    s_nop 1
    v_add_u32_dpp v110, v110, v110 row_shr:2 row_mask:0xf bank_mask:0xf bound_ctrl:0
    s_nop 1
    v_add_u32_dpp v110, v110, v110 row_shr:4 row_mask:0xf bank_mask:0xf bound_ctrl:0
    s_nop 1
    v_add_u32_dpp v110, v110, v110 row_shr:8 row_mask:0xf bank_mask:0xf bound_ctrl:0
    s_nop 1
    v_add_u32_dpp v110, v110, v110 row_bcast:15 row_mask:0xa bank_mask:0xf
    s_nop 1
    v_add_u32_dpp v110, v110, v110 row_bcast:31 row_mask:0xc bank_mask:0xf
    v_sub_u32_sdwa v109, v109, v110 dst_sel:DWORD dst_unused:UNUSED_PAD src0_sel:WORD_1 src1_sel:DWORD
    v_readlane_b32 s29, v110, 63
    v_add_u32 v110, -1, v110
    ds_write_b16 v126, v109
    v_lshlrev_b32_e64 v111, v110, 1
    v_lshrrev_b32 v110, 5, v110
    v_lshl_add_u32 v110, v110, 2, s19
    s_cmp_gt_u32 s29, 320
    s_cselect_b32 s2, 1, s2
    s_cselect_b64 exec, 0, -1
    ds_or_b32 v110, v111 offset:160
    s_mov_b64 exec, -1
    ds_wrxchg_rtn_b32 v7, v6, v5 offset:160
    s_waitcnt lgkmcnt(0)
    v_readlane_b32 s30, v7, 0
    v_readlane_b32 s31, v7, 1
    v_readlane_b32 s32, v7, 2
    v_readlane_b32 s33, v7, 3
    v_readlane_b32 s34, v7, 4
    v_readlane_b32 s35, v7, 5
    v_readlane_b32 s36, v7, 6
    v_readlane_b32 s37, v7, 7
    s_mov_b32 s25, s19
    s_mov_b32 s26, s27
    s_mov_b32 s51, s28
    s_mov_b32 s28, s29
    v_mbcnt_lo_u32_b32 v8, s30, 0
    v_mbcnt_hi_u32_b32 v8, s31, v8
    s_bcnt1_i32_b64 s14, s[30:31]
    v_lshl_add_u32 v9, v8, 1, s25
    ds_read_u16 v9, v9
    s_add_u32 s30, s26, 0
    s_lshl1_add_u32 s25, s14, s25
    s_lshl_b32 s14, s14, 10
    s_add_u32 s26, s26, s14
    v_mbcnt_lo_u32_b32 v12, s32, 0
    v_mbcnt_hi_u32_b32 v12, s33, v12
    s_bcnt1_i32_b64 s14, s[32:33]
    v_lshl_add_u32 v13, v12, 1, s25
    ds_read_u16 v13, v13
    s_add_u32 s32, s26, 1048576
    s_lshl1_add_u32 s25, s14, s25
    s_lshl_b32 s14, s14, 10
    s_add_u32 s26, s26, s14
    v_mbcnt_lo_u32_b32 v16, s34, 0
    v_mbcnt_hi_u32_b32 v16, s35, v16
    s_bcnt1_i32_b64 s14, s[34:35]
    v_lshl_add_u32 v17, v16, 1, s25
    ds_read_u16 v17, v17
    s_add_u32 s34, s26, 2097152
    s_lshl1_add_u32 s25, s14, s25
    s_lshl_b32 s14, s14, 10
    s_add_u32 s26, s26, s14
    v_mbcnt_lo_u32_b32 v20, s36, 0
    v_mbcnt_hi_u32_b32 v20, s37, v20
    s_bcnt1_i32_b64 s14, s[36:37]
    v_lshl_add_u32 v21, v20, 1, s25
    ds_read_u16 v21, v21
    s_add_u32 s36, s26, 3145728
    s_lshl1_add_u32 s25, s14, s25
    s_lshl_b32 s14, s14, 10
    s_add_u32 s26, s26, s14
    s_waitcnt lgkmcnt(3)
    v_mad_u32_u16 v9, v9, s23, v2
    v_pk_lshrrev_b16 v9, 10, v9 op_sel_hi:[1,1]
    v_lshl_add_u32 v8, v8, 6, v9
    buffer_load_dwordx4 v[8:11], v8, s[44:47], s30 idxen
    s_waitcnt lgkmcnt(2)
    v_mad_u32_u16 v13, v13, s23, v2
    v_pk_lshrrev_b16 v13, 10, v13 op_sel_hi:[1,1]
    v_lshl_add_u32 v12, v12, 6, v13
    buffer_load_dwordx4 v[12:15], v12, s[44:47], s32 idxen
    s_waitcnt lgkmcnt(1)
    v_mad_u32_u16 v17, v17, s23, v2
    v_pk_lshrrev_b16 v17, 10, v17 op_sel_hi:[1,1]
    v_lshl_add_u32 v16, v16, 6, v17
    buffer_load_dwordx4 v[16:19], v16, s[44:47], s34 idxen
    s_waitcnt lgkmcnt(0)
    v_mad_u32_u16 v21, v21, s23, v2
    v_pk_lshrrev_b16 v21, 10, v21 op_sel_hi:[1,1]
    v_lshl_add_u32 v20, v20, 6, v21
    buffer_load_dwordx4 v[20:23], v20, s[44:47], s36 idxen
    s_cmp_le_u32 s28, 256
    s_cbranch_scc1 L_p2_kernel_noopt_1
    v_readlane_b32 s38, v7, 8
    v_readlane_b32 s39, v7, 9
    s_nop 1
    v_mbcnt_lo_u32_b32 v118, s38, 0
    v_mbcnt_hi_u32_b32 v118, s39, v118
    s_bcnt1_i32_b64 s14, s[38:39]
    v_lshl_add_u32 v119, v118, 1, s25
    ds_read_u16 v119, v119
    s_add_u32 s38, s26, 4194304
    s_lshl1_add_u32 s25, s14, s25
    s_lshl_b32 s14, s14, 10
    s_add_u32 s26, s26, s14
    s_waitcnt lgkmcnt(0)
    v_mad_u32_u16 v119, v119, s23, v2
    v_pk_lshrrev_b16 v119, 10, v119 op_sel_hi:[1,1]
    v_lshl_add_u32 v118, v118, 6, v119
    buffer_load_dwordx4 v[24:27], v118, s[44:47], s38 idxen
L_p2_kernel_noopt_1:
    s_waitcnt vmcnt(6)
    ds_write_b128 v3, v[88:91] offset:0
    ds_write_b128 v3, v[92:95] offset:16384
    ds_write_b128 v3, v[96:99] offset:32768
    ds_write_b128 v3, v[100:103] offset:49152
    ds_write_b128 v124, v[104:107] offset:0
    s_waitcnt vmcnt(4)
    v_max3_u32 v64, v80, v82, v84
    v_add_f32 v65, v81, v83
    v_add_f32 v66, v85, v87
    v_max_u32 v64, v64, v86
    v_add_f32 v65, v65, v66
    v_cmp_lt_u32 vcc, 0xffff, v64
    s_nop 1
    v_max_u32_dpp v64, v64, v64 row_shr:1 row_mask:0xf bank_mask:0xf bound_ctrl:0
    s_nop 1
    v_max_u32_dpp v64, v64, v64 row_shr:2 row_mask:0xf bank_mask:0xf bound_ctrl:0
    s_nop 1
    v_max_u32_dpp v64, v64, v64 row_shr:4 row_mask:0xf bank_mask:0xf bound_ctrl:0
    s_nop 1
    v_max_u32_dpp v64, v64, v64 row_shr:8 row_mask:0xf bank_mask:0xf bound_ctrl:0
    s_nop 1
    v_max_u32_dpp v64, v64, v64 row_bcast:15 row_mask:0xa bank_mask:0xf
    s_nop 1
    v_max_u32_dpp v64, v64, v64 row_bcast:31 row_mask:0xc bank_mask:0xf
    s_nop 1
    v_add_f32_dpp v65, v65, v65 row_shr:1 row_mask:0xf bank_mask:0xf bound_ctrl:0
    s_nop 1
    v_add_f32_dpp v65, v65, v65 row_shr:2 row_mask:0xf bank_mask:0xf bound_ctrl:0
    s_nop 1
    v_add_f32_dpp v65, v65, v65 row_shr:4 row_mask:0xf bank_mask:0xf bound_ctrl:0
    s_nop 1
    v_add_f32_dpp v65, v65, v65 row_shr:8 row_mask:0xf bank_mask:0xf bound_ctrl:0
    s_nop 1
    v_add_f32_dpp v65, v65, v65 row_bcast:15 row_mask:0xa bank_mask:0xf
    s_nop 1
    v_add_f32_dpp v65, v65, v65 row_bcast:31 row_mask:0xc bank_mask:0xf
    s_cmp_lg_u64 vcc, 0
    s_cselect_b32 s2, 1, s2
    v_lshlrev_b32 v64, 16, v64
    v_mul_f32 v66, 936490775, v65
    v_mul_f32 v65, 928531664, v65
    v_cmp_nle_f32 vcc, v64, v66
    v_max_u32 v64, v64, v65
    s_nop 0
    v_readlane_b32 s14, v64, 63
    s_bitcmp1_b32 vcc_hi, 31
    s_cselect_b32 s2, 1, s2
    s_lshr_b32 s14, s14, 23
    s_add_u32 s14, s14, 1
    s_cmp_lt_u32 s14, 40
    s_cselect_b32 s2, 1, s2
    s_cmp_gt_u32 s14, 230
    s_cselect_b32 s2, 1, s2
    s_sub_u32 s48, s14, 14
    s_lshl_b32 s48, s48, 23
    s_add_u32 s16, s48, 272646144
    s_or_b32 s48, s48, 16416
    s_sub_u32 s14, s14, 40
    s_cmp_gt_u32 s14, 190
    s_cselect_b32 s48, 0, s48
    s_waitcnt lgkmcnt(0)
    s_barrier
    s_add_u32 s14, s22, 80000
    buffer_load_dwordx4 v[88:91], v1, s[8:11], s14 offen
    s_add_u32 s14, s22, 96384
    buffer_load_dwordx4 v[92:95], v1, s[8:11], s14 offen
    v_mad_u32_u16 v108, v28, v50, s40 op_sel:[1,0,0,0]
    v_mad_u32_u16 v109, v36, v50, s41 op_sel:[1,0,0,0]
    v_sub_u32_sdwa v110, v109, v108 dst_sel:DWORD dst_unused:UNUSED_PAD src0_sel:WORD_1 src1_sel:WORD_1
    s_nop 1
    v_add_u32_dpp v110, v110, v110 row_shr:1 row_mask:0xf bank_mask:0xf bound_ctrl:0
    s_nop 1
    v_add_u32_dpp v110, v110, v110 row_shr:2 row_mask:0xf bank_mask:0xf bound_ctrl:0
    s_nop 1
    v_add_u32_dpp v110, v110, v110 row_shr:4 row_mask:0xf bank_mask:0xf bound_ctrl:0
    s_nop 1
    v_add_u32_dpp v110, v110, v110 row_shr:8 row_mask:0xf bank_mask:0xf bound_ctrl:0
    s_nop 1
    v_add_u32_dpp v110, v110, v110 row_bcast:15 row_mask:0xa bank_mask:0xf
    s_nop 1
    v_add_u32_dpp v110, v110, v110 row_bcast:31 row_mask:0xc bank_mask:0xf
    v_sub_u32_sdwa v109, v109, v110 dst_sel:DWORD dst_unused:UNUSED_PAD src0_sel:WORD_1 src1_sel:DWORD
    v_readlane_b32 s29, v110, 63
    v_add_u32 v110, -1, v110
    ds_write_b16 v126, v109
    v_lshlrev_b32_e64 v111, v110, 1
    v_lshrrev_b32 v110, 5, v110
    v_lshl_add_u32 v110, v110, 2, s19
    s_cmp_gt_u32 s29, 320
    s_cselect_b32 s2, 1, s2
    s_cselect_b64 exec, 0, -1
    ds_or_b32 v110, v111 offset:160
    s_mov_b64 exec, -1
    ds_wrxchg_rtn_b32 v7, v6, v5 offset:160
    s_mov_b32 s24, 0
L_p2_loop:
    s_add_u32 s22, s22, 80000
    s_lshl_b32 s14, s13, 4
    s_or_b32 s14, s14, s24
    s_cmp_lg_u32 s14, 5
    s_cbranch_scc1 L_p2_nost
    v_mov_b32 v52, 0
    s_lshl_b32 s14, s3, 8
    s_add_u32 s14, s14, 8557056
    s_mov_b64 exec, 1
    buffer_atomic_add v52, off, s[4:7], s14 sc0
    s_mov_b64 exec, -1
L_p2_nost:
    s_waitcnt vmcnt(5)
    v_mad_u32_u16 v64, v8, 8, s18
    v_mad_u32_u16 v66, v9, 8, s18
    v_mad_u32_u16 v68, v10, 8, s18
    ds_read_b64 v[64:65], v64
    ds_read_b64 v[66:67], v66
    ds_read_b64 v[68:69], v68
    s_add_u32 s14, s22, 32768
    buffer_load_dwordx4 v[96:99], v1, s[8:11], s14 offen
    s_waitcnt vmcnt(5)
    v_mad_u32_u16 v70, v12, 8, s18
    v_mad_u32_u16 v72, v13, 8, s18
    v_mad_u32_u16 v74, v14, 8, s18
    ds_read_b64 v[70:71], v70
    ds_read_b64 v[72:73], v72
    ds_read_b64 v[74:75], v74
    s_add_u32 s14, s22, 49152
    buffer_load_dwordx4 v[100:103], v1, s[8:11], s14 offen
    s_waitcnt lgkmcnt(6)
    v_readlane_b32 s30, v7, 0
    v_readlane_b32 s31, v7, 1
    v_readlane_b32 s32, v7, 2
    v_readlane_b32 s33, v7, 3
    v_readlane_b32 s34, v7, 4
    v_readlane_b32 s35, v7, 5
    v_readlane_b32 s36, v7, 6
    v_readlane_b32 s37, v7, 7
    s_mov_b32 s25, s19
    s_mov_b32 s26, s27
    s_mov_b32 s51, s28
    s_mov_b32 s28, s29
    v_mbcnt_lo_u32_b32 v118, s30, 0
    v_mbcnt_hi_u32_b32 v118, s31, v118
    s_bcnt1_i32_b64 s14, s[30:31]
    v_lshl_add_u32 v119, v118, 1, s25
    ds_read_u16 v119, v119
    s_add_u32 s30, s26, 0
    s_lshl1_add_u32 s25, s14, s25
    s_lshl_b32 s14, s14, 10
    s_add_u32 s26, s26, s14
    v_bfe_i32 v108, v11, 2, 10
    v_bfe_i32 v109, v11, 12, 10
    v_ashrrev_i32 v110, 22, v11
    v_cvt_f32_i32 v108, v108
    v_cvt_f32_i32 v109, v109
    v_cvt_f32_i32 v110, v110
    v_mad_u32_u16 v8, v8, 8, s50 op_sel:[1,0,0,0]
    v_mad_u32_u16 v9, v9, 8, s50 op_sel:[1,0,0,0]
    v_mad_u32_u16 v10, v10, 8, s50 op_sel:[1,0,0,0]
    s_waitcnt lgkmcnt(4)
    v_lshlrev_b32 v112, 16, v64
    v_and_b32 v113, 0xffff0000, v64
    v_lshlrev_b32 v64, 16, v65
    v_and_b32 v65, 0xffff0000, v65
    v_lshlrev_b32 v114, 16, v66
    v_and_b32 v115, 0xffff0000, v66
    v_lshlrev_b32 v66, 16, v67
    v_and_b32 v67, 0xffff0000, v67
    v_lshlrev_b32 v116, 16, v68
    v_and_b32 v117, 0xffff0000, v68
    v_lshlrev_b32 v68, 16, v69
    v_and_b32 v69, 0xffff0000, v69
    v_pk_fma_f32 v[112:113], v[112:113], v[108:109], s[16:17] op_sel:[0,0,0] op_sel_hi:[1,0,0]
    v_pk_fma_f32 v[64:65], v[64:65], v[108:109], s[16:17] op_sel:[0,0,0] op_sel_hi:[1,0,0]
    v_pk_fma_f32 v[114:115], v[114:115], v[108:109], s[16:17] op_sel:[0,1,0] op_sel_hi:[1,1,0]
    v_pk_fma_f32 v[66:67], v[66:67], v[108:109], s[16:17] op_sel:[0,1,0] op_sel_hi:[1,1,0]
    v_pk_fma_f32 v[116:117], v[116:117], v[110:111], s[16:17] op_sel:[0,0,0] op_sel_hi:[1,0,0]
    v_pk_fma_f32 v[68:69], v[68:69], v[110:111], s[16:17] op_sel:[0,0,0] op_sel_hi:[1,0,0]
    v_perm_b32 v65, v65, v64, s17
    v_perm_b32 v64, v113, v112, s17
    v_perm_b32 v67, v67, v66, s17
    v_perm_b32 v66, v115, v114, s17
    v_perm_b32 v69, v69, v68, s17
    v_perm_b32 v68, v117, v116, s17
    v_lshl_add_u64 v[64:65], v[64:65], 0, s[20:21]
    v_lshl_add_u64 v[66:67], v[66:67], 0, s[20:21]
    v_lshl_add_u64 v[68:69], v[68:69], 0, s[20:21]
    v_or3_b32 v4, v44, v45, v4
    v_or3_b32 v4, v46, v47, v4
    v_or3_b32 v4, v48, v49, v4
    ds_add_rtn_u64 v[44:45], v8, v[64:65]
    ds_add_rtn_u64 v[46:47], v9, v[66:67]
    ds_add_rtn_u64 v[48:49], v10, v[68:69]
    s_waitcnt lgkmcnt(3)
    v_mad_u32_u16 v119, v119, s23, v2
    v_pk_lshrrev_b16 v119, 10, v119 op_sel_hi:[1,1]
    v_lshl_add_u32 v118, v118, 6, v119
    buffer_load_dwordx4 v[8:11], v118, s[44:47], s30 idxen
    s_add_u32 s14, s22, 65536
    buffer_load_dwordx4 v[104:107], v1, s[8:11], s14 offen
    s_waitcnt vmcnt(7)
    v_mad_u32_u16 v76, v16, 8, s18
    v_mad_u32_u16 v78, v17, 8, s18
    v_mad_u32_u16 v80, v18, 8, s18
    ds_read_b64 v[76:77], v76
    ds_read_b64 v[78:79], v78
    ds_read_b64 v[80:81], v80
    s_waitcnt vmcnt(6)
    v_mad_u32_u16 v82, v20, 8, s18
    v_mad_u32_u16 v84, v21, 8, s18
    v_mad_u32_u16 v86, v22, 8, s18
    ds_read_b64 v[82:83], v82
    ds_read_b64 v[84:85], v84
    ds_read_b64 v[86:87], v86
    v_mbcnt_lo_u32_b32 v118, s32, 0
    v_mbcnt_hi_u32_b32 v118, s33, v118
    s_bcnt1_i32_b64 s14, s[32:33]
    v_lshl_add_u32 v119, v118, 1, s25
    ds_read_u16 v119, v119
    s_add_u32 s32, s26, 1048576
    s_lshl1_add_u32 s25, s14, s25
    s_lshl_b32 s14, s14, 10
    s_add_u32 s26, s26, s14
    v_bfe_i32 v108, v15, 2, 10
    v_bfe_i32 v109, v15, 12, 10
    v_ashrrev_i32 v110, 22, v15
    v_cvt_f32_i32 v108, v108
    v_cvt_f32_i32 v109, v109
    v_cvt_f32_i32 v110, v110
    v_mad_u32_u16 v12, v12, 8, s50 op_sel:[1,0,0,0]
    v_mad_u32_u16 v13, v13, 8, s50 op_sel:[1,0,0,0]
    v_mad_u32_u16 v14, v14, 8, s50 op_sel:[1,0,0,0]
    v_lshlrev_b32 v112, 16, v70
    v_and_b32 v113, 0xffff0000, v70
    v_lshlrev_b32 v70, 16, v71
    v_and_b32 v71, 0xffff0000, v71
    v_lshlrev_b32 v114, 16, v72
    v_and_b32 v115, 0xffff0000, v72
    v_lshlrev_b32 v72, 16, v73
    v_and_b32 v73, 0xffff0000, v73
    v_lshlrev_b32 v116, 16, v74
    v_and_b32 v117, 0xffff0000, v74
    v_lshlrev_b32 v74, 16, v75
    v_and_b32 v75, 0xffff0000, v75
    v_pk_fma_f32 v[112:113], v[112:113], v[108:109], s[16:17] op_sel:[0,0,0] op_sel_hi:[1,0,0]
    v_pk_fma_f32 v[70:71], v[70:71], v[108:109], s[16:17] op_sel:[0,0,0] op_sel_hi:[1,0,0]
    v_pk_fma_f32 v[114:115], v[114:115], v[108:109], s[16:17] op_sel:[0,1,0] op_sel_hi:[1,1,0]
    v_pk_fma_f32 v[72:73], v[72:73], v[108:109], s[16:17] op_sel:[0,1,0] op_sel_hi:[1,1,0]
    v_pk_fma_f32 v[116:117], v[116:117], v[110:111], s[16:17] op_sel:[0,0,0] op_sel_hi:[1,0,0]
    v_pk_fma_f32 v[74:75], v[74:75], v[110:111], s[16:17] op_sel:[0,0,0] op_sel_hi:[1,0,0]
    v_perm_b32 v71, v71, v70, s17
    v_perm_b32 v70, v113, v112, s17
    v_perm_b32 v73, v73, v72, s17
    v_perm_b32 v72, v115, v114, s17
    v_perm_b32 v75, v75, v74, s17
    v_perm_b32 v74, v117, v116, s17
    v_lshl_add_u64 v[70:71], v[70:71], 0, s[20:21]
    v_lshl_add_u64 v[72:73], v[72:73], 0, s[20:21]
    v_lshl_add_u64 v[74:75], v[74:75], 0, s[20:21]
    s_waitcnt lgkmcnt(7)
    v_or3_b32 v4, v44, v45, v4
    v_or3_b32 v4, v46, v47, v4
    v_or3_b32 v4, v48, v49, v4
    ds_add_rtn_u64 v[44:45], v12, v[70:71]
    ds_add_rtn_u64 v[46:47], v13, v[72:73]
    ds_add_rtn_u64 v[48:49], v14, v[74:75]
    s_waitcnt lgkmcnt(3)
    v_mad_u32_u16 v119, v119, s23, v2
    v_pk_lshrrev_b16 v119, 10, v119 op_sel_hi:[1,1]
    v_lshl_add_u32 v118, v118, 6, v119
    buffer_load_dwordx4 v[12:15], v118, s[44:47], s32 idxen
    s_cmp_le_u32 s51, 256
    s_cbranch_scc1 L_p2_kernel_noopt2_2
    v_mad_u32_u16 v64, v24, 8, s18
    v_mad_u32_u16 v66, v25, 8, s18
    v_mad_u32_u16 v68, v26, 8, s18
    ds_read_b64 v[64:65], v64
    ds_read_b64 v[66:67], v66
    ds_read_b64 v[68:69], v68
    v_bfe_i32 v108, v27, 2, 10
    v_bfe_i32 v109, v27, 12, 10
    v_ashrrev_i32 v110, 22, v27
    v_cvt_f32_i32 v108, v108
    v_cvt_f32_i32 v109, v109
    v_cvt_f32_i32 v110, v110
    v_mad_u32_u16 v24, v24, 8, s50 op_sel:[1,0,0,0]
    v_mad_u32_u16 v25, v25, 8, s50 op_sel:[1,0,0,0]
    v_mad_u32_u16 v26, v26, 8, s50 op_sel:[1,0,0,0]
    s_waitcnt lgkmcnt(0)
    v_lshlrev_b32 v112, 16, v64
    v_and_b32 v113, 0xffff0000, v64
    v_lshlrev_b32 v64, 16, v65
    v_and_b32 v65, 0xffff0000, v65
    v_lshlrev_b32 v114, 16, v66
    v_and_b32 v115, 0xffff0000, v66
    v_lshlrev_b32 v66, 16, v67
    v_and_b32 v67, 0xffff0000, v67
    v_lshlrev_b32 v116, 16, v68
    v_and_b32 v117, 0xffff0000, v68
    v_lshlrev_b32 v68, 16, v69
    v_and_b32 v69, 0xffff0000, v69
    v_pk_fma_f32 v[112:113], v[112:113], v[108:109], s[16:17] op_sel:[0,0,0] op_sel_hi:[1,0,0]
    v_pk_fma_f32 v[64:65], v[64:65], v[108:109], s[16:17] op_sel:[0,0,0] op_sel_hi:[1,0,0]
    v_pk_fma_f32 v[114:115], v[114:115], v[108:109], s[16:17] op_sel:[0,1,0] op_sel_hi:[1,1,0]
    v_pk_fma_f32 v[66:67], v[66:67], v[108:109], s[16:17] op_sel:[0,1,0] op_sel_hi:[1,1,0]
    v_pk_fma_f32 v[116:117], v[116:117], v[110:111], s[16:17] op_sel:[0,0,0] op_sel_hi:[1,0,0]
    v_pk_fma_f32 v[68:69], v[68:69], v[110:111], s[16:17] op_sel:[0,0,0] op_sel_hi:[1,0,0]
    v_perm_b32 v65, v65, v64, s17
    v_perm_b32 v64, v113, v112, s17
    v_perm_b32 v67, v67, v66, s17
    v_perm_b32 v66, v115, v114, s17
    v_perm_b32 v69, v69, v68, s17
    v_perm_b32 v68, v117, v116, s17
    v_lshl_add_u64 v[64:65], v[64:65], 0, s[20:21]
    v_lshl_add_u64 v[66:67], v[66:67], 0, s[20:21]
    v_lshl_add_u64 v[68:69], v[68:69], 0, s[20:21]
    v_or3_b32 v4, v44, v45, v4
    v_or3_b32 v4, v46, v47, v4
    v_or3_b32 v4, v48, v49, v4
    ds_add_rtn_u64 v[44:45], v24, v[64:65]
    ds_add_rtn_u64 v[46:47], v25, v[66:67]
    ds_add_rtn_u64 v[48:49], v26, v[68:69]
L_p2_kernel_noopt2_2:
    s_barrier
    s_waitcnt vmcnt(1)
    ds_write_b128 v3, v[88:91] offset:0
    ds_write_b128 v3, v[92:95] offset:16384
    ds_write_b128 v3, v[96:99] offset:32768
    ds_write_b128 v3, v[100:103] offset:49152
    ds_write_b128 v124, v[104:107] offset:0
    v_mbcnt_lo_u32_b32 v118, s34, 0
    v_mbcnt_hi_u32_b32 v118, s35, v118
    s_bcnt1_i32_b64 s14, s[34:35]
    v_lshl_add_u32 v119, v118, 1, s25
    ds_read_u16 v119, v119
    s_add_u32 s34, s26, 2097152
    s_lshl1_add_u32 s25, s14, s25
    s_lshl_b32 s14, s14, 10
    s_add_u32 s26, s26, s14
    v_bfe_i32 v108, v19, 2, 10
    v_bfe_i32 v109, v19, 12, 10
    v_ashrrev_i32 v110, 22, v19
    v_cvt_f32_i32 v108, v108
    v_cvt_f32_i32 v109, v109
    v_cvt_f32_i32 v110, v110
    v_mad_u32_u16 v16, v16, 8, s50 op_sel:[1,0,0,0]
    v_mad_u32_u16 v17, v17, 8, s50 op_sel:[1,0,0,0]
    v_mad_u32_u16 v18, v18, 8, s50 op_sel:[1,0,0,0]
    v_lshlrev_b32 v112, 16, v76
    v_and_b32 v113, 0xffff0000, v76
    v_lshlrev_b32 v76, 16, v77
    v_and_b32 v77, 0xffff0000, v77
    v_lshlrev_b32 v114, 16, v78
    v_and_b32 v115, 0xffff0000, v78
    v_lshlrev_b32 v78, 16, v79
    v_and_b32 v79, 0xffff0000, v79
    v_lshlrev_b32 v116, 16, v80
    v_and_b32 v117, 0xffff0000, v80
    v_lshlrev_b32 v80, 16, v81
    v_and_b32 v81, 0xffff0000, v81
    v_pk_fma_f32 v[112:113], v[112:113], v[108:109], s[16:17] op_sel:[0,0,0] op_sel_hi:[1,0,0]
    v_pk_fma_f32 v[76:77], v[76:77], v[108:109], s[16:17] op_sel:[0,0,0] op_sel_hi:[1,0,0]
    v_pk_fma_f32 v[114:115], v[114:115], v[108:109], s[16:17] op_sel:[0,1,0] op_sel_hi:[1,1,0]
    v_pk_fma_f32 v[78:79], v[78:79], v[108:109], s[16:17] op_sel:[0,1,0] op_sel_hi:[1,1,0]
    v_pk_fma_f32 v[116:117], v[116:117], v[110:111], s[16:17] op_sel:[0,0,0] op_sel_hi:[1,0,0]
    v_pk_fma_f32 v[80:81], v[80:81], v[110:111], s[16:17] op_sel:[0,0,0] op_sel_hi:[1,0,0]
    v_perm_b32 v77, v77, v76, s17
    v_perm_b32 v76, v113, v112, s17
    v_perm_b32 v79, v79, v78, s17
    v_perm_b32 v78, v115, v114, s17
    v_perm_b32 v81, v81, v80, s17
    v_perm_b32 v80, v117, v116, s17
    v_lshl_add_u64 v[76:77], v[76:77], 0, s[20:21]
    v_lshl_add_u64 v[78:79], v[78:79], 0, s[20:21]
    v_lshl_add_u64 v[80:81], v[80:81], 0, s[20:21]
    s_waitcnt lgkmcnt(6)
    v_or3_b32 v4, v44, v45, v4
    v_or3_b32 v4, v46, v47, v4
    v_or3_b32 v4, v48, v49, v4
    ds_add_rtn_u64 v[44:45], v16, v[76:77]
    ds_add_rtn_u64 v[46:47], v17, v[78:79]
    ds_add_rtn_u64 v[48:49], v18, v[80:81]
    s_waitcnt lgkmcnt(3)
    v_mad_u32_u16 v119, v119, s23, v2
    v_pk_lshrrev_b16 v119, 10, v119 op_sel_hi:[1,1]
    v_lshl_add_u32 v118, v118, 6, v119
    buffer_load_dwordx4 v[16:19], v118, s[44:47], s34 idxen
    v_mbcnt_lo_u32_b32 v118, s36, 0
    v_mbcnt_hi_u32_b32 v118, s37, v118
    s_bcnt1_i32_b64 s14, s[36:37]
    v_lshl_add_u32 v119, v118, 1, s25
    ds_read_u16 v119, v119
    s_add_u32 s36, s26, 3145728
    s_lshl1_add_u32 s25, s14, s25
    s_lshl_b32 s14, s14, 10
    s_add_u32 s26, s26, s14
    v_bfe_i32 v108, v23, 2, 10
    v_bfe_i32 v109, v23, 12, 10
    v_ashrrev_i32 v110, 22, v23
    v_cvt_f32_i32 v108, v108
    v_cvt_f32_i32 v109, v109
    v_cvt_f32_i32 v110, v110
    v_mad_u32_u16 v20, v20, 8, s50 op_sel:[1,0,0,0]
    v_mad_u32_u16 v21, v21, 8, s50 op_sel:[1,0,0,0]
    v_mad_u32_u16 v22, v22, 8, s50 op_sel:[1,0,0,0]
    v_lshlrev_b32 v112, 16, v82
    v_and_b32 v113, 0xffff0000, v82
    v_lshlrev_b32 v82, 16, v83
    v_and_b32 v83, 0xffff0000, v83
    v_lshlrev_b32 v114, 16, v84
    v_and_b32 v115, 0xffff0000, v84
    v_lshlrev_b32 v84, 16, v85
    v_and_b32 v85, 0xffff0000, v85
    v_lshlrev_b32 v116, 16, v86
    v_and_b32 v117, 0xffff0000, v86
    v_lshlrev_b32 v86, 16, v87
    v_and_b32 v87, 0xffff0000, v87
    v_pk_fma_f32 v[112:113], v[112:113], v[108:109], s[16:17] op_sel:[0,0,0] op_sel_hi:[1,0,0]
    v_pk_fma_f32 v[82:83], v[82:83], v[108:109], s[16:17] op_sel:[0,0,0] op_sel_hi:[1,0,0]
    v_pk_fma_f32 v[114:115], v[114:115], v[108:109], s[16:17] op_sel:[0,1,0] op_sel_hi:[1,1,0]
    v_pk_fma_f32 v[84:85], v[84:85], v[108:109], s[16:17] op_sel:[0,1,0] op_sel_hi:[1,1,0]
    v_pk_fma_f32 v[116:117], v[116:117], v[110:111], s[16:17] op_sel:[0,0,0] op_sel_hi:[1,0,0]
    v_pk_fma_f32 v[86:87], v[86:87], v[110:111], s[16:17] op_sel:[0,0,0] op_sel_hi:[1,0,0]
    v_perm_b32 v83, v83, v82, s17
    v_perm_b32 v82, v113, v112, s17
    v_perm_b32 v85, v85, v84, s17
    v_perm_b32 v84, v115, v114, s17
    v_perm_b32 v87, v87, v86, s17
    v_perm_b32 v86, v117, v116, s17
    v_lshl_add_u64 v[82:83], v[82:83], 0, s[20:21]
    v_lshl_add_u64 v[84:85], v[84:85], 0, s[20:21]
    v_lshl_add_u64 v[86:87], v[86:87], 0, s[20:21]
    s_waitcnt lgkmcnt(1)
    v_or3_b32 v4, v44, v45, v4
    v_or3_b32 v4, v46, v47, v4
    v_or3_b32 v4, v48, v49, v4
    ds_add_rtn_u64 v[44:45], v20, v[82:83]
    ds_add_rtn_u64 v[46:47], v21, v[84:85]
    ds_add_rtn_u64 v[48:49], v22, v[86:87]
    s_waitcnt lgkmcnt(3)
    v_mad_u32_u16 v119, v119, s23, v2
    v_pk_lshrrev_b16 v119, 10, v119 op_sel_hi:[1,1]
    v_lshl_add_u32 v118, v118, 6, v119
    buffer_load_dwordx4 v[20:23], v118, s[44:47], s36 idxen
    s_cmp_le_u32 s28, 256
    s_cbranch_scc1 L_p2_kernel_noopt_3
    v_readlane_b32 s38, v7, 8
    v_readlane_b32 s39, v7, 9
    s_nop 1
    v_mbcnt_lo_u32_b32 v118, s38, 0
    v_mbcnt_hi_u32_b32 v118, s39, v118
    s_bcnt1_i32_b64 s14, s[38:39]
    v_lshl_add_u32 v119, v118, 1, s25
    ds_read_u16 v119, v119
    s_add_u32 s38, s26, 4194304
    s_lshl1_add_u32 s25, s14, s25
    s_lshl_b32 s14, s14, 10
    s_add_u32 s26, s26, s14
    s_waitcnt lgkmcnt(0)
    v_mad_u32_u16 v119, v119, s23, v2
    v_pk_lshrrev_b16 v119, 10, v119 op_sel_hi:[1,1]
    v_lshl_add_u32 v118, v118, 6, v119
    buffer_load_dwordx4 v[24:27], v118, s[44:47], s38 idxen
L_p2_kernel_noopt_3:
    v_pk_mov_b32 v[28:29], v[28:29], v[30:31] op_sel:[1,0]
    v_pk_mov_b32 v[30:31], v[30:31], v[32:33] op_sel:[1,0]
    v_pk_mov_b32 v[32:33], v[32:33], v[34:35] op_sel:[1,0]
    v_pk_mov_b32 v[34:35], v[34:35], v[4:5] op_sel:[1,1]
    v_pk_mov_b32 v[36:37], v[36:37], v[38:39] op_sel:[1,0]
    v_pk_mov_b32 v[38:39], v[38:39], v[40:41] op_sel:[1,0]
    v_pk_mov_b32 v[40:41], v[40:41], v[42:43] op_sel:[1,0]
    v_pk_mov_b32 v[42:43], v[42:43], v[4:5] op_sel:[1,1]
    v_mad_u32_u16 v108, v28, v50, s40 op_sel:[0,0,0,0]
    v_mad_u32_u16 v109, v36, v50, s41 op_sel:[0,0,0,0]
    v_sub_u32_sdwa v110, v109, v108 dst_sel:DWORD dst_unused:UNUSED_PAD src0_sel:WORD_1 src1_sel:WORD_1
    s_nop 1
    v_add_u32_dpp v110, v110, v110 row_shr:1 row_mask:0xf bank_mask:0xf bound_ctrl:0
    s_nop 1
    v_add_u32_dpp v110, v110, v110 row_shr:2 row_mask:0xf bank_mask:0xf bound_ctrl:0
    s_nop 1
    v_add_u32_dpp v110, v110, v110 row_shr:4 row_mask:0xf bank_mask:0xf bound_ctrl:0
    s_nop 1
    v_add_u32_dpp v110, v110, v110 row_shr:8 row_mask:0xf bank_mask:0xf bound_ctrl:0
    s_nop 1
    v_add_u32_dpp v110, v110, v110 row_bcast:15 row_mask:0xa bank_mask:0xf
    s_nop 1
    v_add_u32_dpp v110, v110, v110 row_bcast:31 row_mask:0xc bank_mask:0xf
    v_sub_u32_sdwa v109, v109, v110 dst_sel:DWORD dst_unused:UNUSED_PAD src0_sel:WORD_1 src1_sel:DWORD
    v_readlane_b32 s29, v110, 63
    v_add_u32 v110, -1, v110
    ds_write_b16 v126, v109
    v_lshlrev_b32_e64 v111, v110, 1
    v_lshrrev_b32 v110, 5, v110
    v_lshl_add_u32 v110, v110, 2, s19
    s_cmp_gt_u32 s29, 320
    s_cselect_b32 s2, 1, s2
    s_cselect_b64 exec, 0, -1
    ds_or_b32 v110, v111 offset:160
    s_mov_b64 exec, -1
    ds_wrxchg_rtn_b32 v7, v6, v5 offset:160
    s_add_u32 s14, s22, 80000
    buffer_load_dwordx4 v[88:91], v1, s[8:11], s14 offen
    s_add_u32 s14, s22, 96384
    buffer_load_dwordx4 v[92:95], v1, s[8:11], s14 offen
    s_barrier
    s_add_u32 s22, s22, 80000
    s_cmp_lg_u32 s24, 7
    s_cbranch_scc1 L_p2_nodist
    s_mov_b32 s46, 0
    s_lshl2_add_u32 s14, s3, s12
    s_mul_i32 s14, s14, 5000
    s_add_u32 s15, s14, 4096
    v_min_u32 v61, 225, v0
    v_lshl_add_u32 v60, v0, 2, s14
    v_lshl_add_u32 v61, v61, 2, s15
    global_load_dword v60, v60, s[100:101] nt
    global_load_dword v61, v61, s[100:101] nt
L_p2_nodist:
    v_mad_u32_u16 v64, v8, 8, s18
    v_mad_u32_u16 v66, v9, 8, s18
    v_mad_u32_u16 v68, v10, 8, s18
    ds_read_b64 v[64:65], v64
    ds_read_b64 v[66:67], v66
    ds_read_b64 v[68:69], v68
    s_add_u32 s14, s22, 32768
    buffer_load_dwordx4 v[96:99], v1, s[8:11], s14 offen
    s_waitcnt vmcnt(5)
    v_mad_u32_u16 v70, v12, 8, s18
    v_mad_u32_u16 v72, v13, 8, s18
    v_mad_u32_u16 v74, v14, 8, s18
    ds_read_b64 v[70:71], v70
    ds_read_b64 v[72:73], v72
    ds_read_b64 v[74:75], v74
    s_add_u32 s14, s22, 49152
    buffer_load_dwordx4 v[100:103], v1, s[8:11], s14 offen
    s_waitcnt lgkmcnt(6)
    v_readlane_b32 s30, v7, 0
    v_readlane_b32 s31, v7, 1
    v_readlane_b32 s32, v7, 2
    v_readlane_b32 s33, v7, 3
    v_readlane_b32 s34, v7, 4
    v_readlane_b32 s35, v7, 5
    v_readlane_b32 s36, v7, 6
    v_readlane_b32 s37, v7, 7
    s_mov_b32 s25, s19
    s_mov_b32 s26, s27
    s_mov_b32 s51, s28
    s_mov_b32 s28, s29
    v_mbcnt_lo_u32_b32 v118, s30, 0
    v_mbcnt_hi_u32_b32 v118, s31, v118
    s_bcnt1_i32_b64 s14, s[30:31]
    v_lshl_add_u32 v119, v118, 1, s25
    ds_read_u16 v119, v119
    s_add_u32 s30, s26, 0
    s_lshl1_add_u32 s25, s14, s25
    s_lshl_b32 s14, s14, 10
    s_add_u32 s26, s26, s14
    v_bfe_i32 v108, v11, 2, 10
    v_bfe_i32 v109, v11, 12, 10
    v_ashrrev_i32 v110, 22, v11
    v_cvt_f32_i32 v108, v108
    v_cvt_f32_i32 v109, v109
    v_cvt_f32_i32 v110, v110
    v_mad_u32_u16 v8, v8, 8, s50 op_sel:[1,0,0,0]
    v_mad_u32_u16 v9, v9, 8, s50 op_sel:[1,0,0,0]
    v_mad_u32_u16 v10, v10, 8, s50 op_sel:[1,0,0,0]
    s_waitcnt lgkmcnt(4)
    v_lshlrev_b32 v112, 16, v64
    v_and_b32 v113, 0xffff0000, v64
    v_lshlrev_b32 v64, 16, v65
    v_and_b32 v65, 0xffff0000, v65
    v_lshlrev_b32 v114, 16, v66
    v_and_b32 v115, 0xffff0000, v66
    v_lshlrev_b32 v66, 16, v67
    v_and_b32 v67, 0xffff0000, v67
    v_lshlrev_b32 v116, 16, v68
    v_and_b32 v117, 0xffff0000, v68
    v_lshlrev_b32 v68, 16, v69
    v_and_b32 v69, 0xffff0000, v69
    v_pk_fma_f32 v[112:113], v[112:113], v[108:109], s[16:17] op_sel:[0,0,0] op_sel_hi:[1,0,0]
    v_pk_fma_f32 v[64:65], v[64:65], v[108:109], s[16:17] op_sel:[0,0,0] op_sel_hi:[1,0,0]
    v_pk_fma_f32 v[114:115], v[114:115], v[108:109], s[16:17] op_sel:[0,1,0] op_sel_hi:[1,1,0]
    v_pk_fma_f32 v[66:67], v[66:67], v[108:109], s[16:17] op_sel:[0,1,0] op_sel_hi:[1,1,0]
    v_pk_fma_f32 v[116:117], v[116:117], v[110:111], s[16:17] op_sel:[0,0,0] op_sel_hi:[1,0,0]
    v_pk_fma_f32 v[68:69], v[68:69], v[110:111], s[16:17] op_sel:[0,0,0] op_sel_hi:[1,0,0]
    v_perm_b32 v65, v65, v64, s17
    v_perm_b32 v64, v113, v112, s17
    v_perm_b32 v67, v67, v66, s17
    v_perm_b32 v66, v115, v114, s17
    v_perm_b32 v69, v69, v68, s17
    v_perm_b32 v68, v117, v116, s17
    v_lshl_add_u64 v[64:65], v[64:65], 0, s[20:21]
    v_lshl_add_u64 v[66:67], v[66:67], 0, s[20:21]
    v_lshl_add_u64 v[68:69], v[68:69], 0, s[20:21]
    v_or3_b32 v4, v44, v45, v4
    v_or3_b32 v4, v46, v47, v4
    v_or3_b32 v4, v48, v49, v4
    ds_add_rtn_u64 v[44:45], v8, v[64:65]
    ds_add_rtn_u64 v[46:47], v9, v[66:67]
    ds_add_rtn_u64 v[48:49], v10, v[68:69]
    s_waitcnt lgkmcnt(3)
    v_mad_u32_u16 v119, v119, s23, v2
    v_pk_lshrrev_b16 v119, 10, v119 op_sel_hi:[1,1]
    v_lshl_add_u32 v118, v118, 6, v119
    buffer_load_dwordx4 v[8:11], v118, s[44:47], s30 idxen
    s_add_u32 s14, s22, 65536
    buffer_load_dwordx4 v[104:107], v1, s[8:11], s14 offen
    s_waitcnt vmcnt(7)
    v_mad_u32_u16 v76, v16, 8, s18
    v_mad_u32_u16 v78, v17, 8, s18
    v_mad_u32_u16 v80, v18, 8, s18
    ds_read_b64 v[76:77], v76
    ds_read_b64 v[78:79], v78
    ds_read_b64 v[80:81], v80
    s_waitcnt vmcnt(6)
    v_mad_u32_u16 v82, v20, 8, s18
    v_mad_u32_u16 v84, v21, 8, s18
    v_mad_u32_u16 v86, v22, 8, s18
    ds_read_b64 v[82:83], v82
    ds_read_b64 v[84:85], v84
    ds_read_b64 v[86:87], v86
    v_mbcnt_lo_u32_b32 v118, s32, 0
    v_mbcnt_hi_u32_b32 v118, s33, v118
    s_bcnt1_i32_b64 s14, s[32:33]
    v_lshl_add_u32 v119, v118, 1, s25
    ds_read_u16 v119, v119
    s_add_u32 s32, s26, 1048576
    s_lshl1_add_u32 s25, s14, s25
    s_lshl_b32 s14, s14, 10
    s_add_u32 s26, s26, s14
    v_bfe_i32 v108, v15, 2, 10
    v_bfe_i32 v109, v15, 12, 10
    v_ashrrev_i32 v110, 22, v15
    v_cvt_f32_i32 v108, v108
    v_cvt_f32_i32 v109, v109
    v_cvt_f32_i32 v110, v110
    v_mad_u32_u16 v12, v12, 8, s50 op_sel:[1,0,0,0]
    v_mad_u32_u16 v13, v13, 8, s50 op_sel:[1,0,0,0]
    v_mad_u32_u16 v14, v14, 8, s50 op_sel:[1,0,0,0]
    v_lshlrev_b32 v112, 16, v70
    v_and_b32 v113, 0xffff0000, v70
    v_lshlrev_b32 v70, 16, v71
    v_and_b32 v71, 0xffff0000, v71
    v_lshlrev_b32 v114, 16, v72
    v_and_b32 v115, 0xffff0000, v72
    v_lshlrev_b32 v72, 16, v73
    v_and_b32 v73, 0xffff0000, v73
    v_lshlrev_b32 v116, 16, v74
    v_and_b32 v117, 0xffff0000, v74
    v_lshlrev_b32 v74, 16, v75
    v_and_b32 v75, 0xffff0000, v75
    v_pk_fma_f32 v[112:113], v[112:113], v[108:109], s[16:17] op_sel:[0,0,0] op_sel_hi:[1,0,0]
    v_pk_fma_f32 v[70:71], v[70:71], v[108:109], s[16:17] op_sel:[0,0,0] op_sel_hi:[1,0,0]
    v_pk_fma_f32 v[114:115], v[114:115], v[108:109], s[16:17] op_sel:[0,1,0] op_sel_hi:[1,1,0]
    v_pk_fma_f32 v[72:73], v[72:73], v[108:109], s[16:17] op_sel:[0,1,0] op_sel_hi:[1,1,0]
    v_pk_fma_f32 v[116:117], v[116:117], v[110:111], s[16:17] op_sel:[0,0,0] op_sel_hi:[1,0,0]
    v_pk_fma_f32 v[74:75], v[74:75], v[110:111], s[16:17] op_sel:[0,0,0] op_sel_hi:[1,0,0]
    v_perm_b32 v71, v71, v70, s17
    v_perm_b32 v70, v113, v112, s17
    v_perm_b32 v73, v73, v72, s17
    v_perm_b32 v72, v115, v114, s17
    v_perm_b32 v75, v75, v74, s17
    v_perm_b32 v74, v117, v116, s17
    v_lshl_add_u64 v[70:71], v[70:71], 0, s[20:21]
    v_lshl_add_u64 v[72:73], v[72:73], 0, s[20:21]
    v_lshl_add_u64 v[74:75], v[74:75], 0, s[20:21]
    s_waitcnt lgkmcnt(7)
    v_or3_b32 v4, v44, v45, v4
    v_or3_b32 v4, v46, v47, v4
    v_or3_b32 v4, v48, v49, v4
    ds_add_rtn_u64 v[44:45], v12, v[70:71]
    ds_add_rtn_u64 v[46:47], v13, v[72:73]
    ds_add_rtn_u64 v[48:49], v14, v[74:75]
    s_waitcnt lgkmcnt(3)
    v_mad_u32_u16 v119, v119, s23, v2
    v_pk_lshrrev_b16 v119, 10, v119 op_sel_hi:[1,1]
    v_lshl_add_u32 v118, v118, 6, v119
    buffer_load_dwordx4 v[12:15], v118, s[44:47], s32 idxen
    s_cmp_le_u32 s51, 256
    s_cbranch_scc1 L_p2_kernel_noopt2_4
    v_mad_u32_u16 v64, v24, 8, s18
    v_mad_u32_u16 v66, v25, 8, s18
    v_mad_u32_u16 v68, v26, 8, s18
    ds_read_b64 v[64:65], v64
    ds_read_b64 v[66:67], v66
    ds_read_b64 v[68:69], v68
    v_bfe_i32 v108, v27, 2, 10
    v_bfe_i32 v109, v27, 12, 10
    v_ashrrev_i32 v110, 22, v27
    v_cvt_f32_i32 v108, v108
    v_cvt_f32_i32 v109, v109
    v_cvt_f32_i32 v110, v110
    v_mad_u32_u16 v24, v24, 8, s50 op_sel:[1,0,0,0]
    v_mad_u32_u16 v25, v25, 8, s50 op_sel:[1,0,0,0]
    v_mad_u32_u16 v26, v26, 8, s50 op_sel:[1,0,0,0]
    s_waitcnt lgkmcnt(0)
    v_lshlrev_b32 v112, 16, v64
    v_and_b32 v113, 0xffff0000, v64
    v_lshlrev_b32 v64, 16, v65
    v_and_b32 v65, 0xffff0000, v65
    v_lshlrev_b32 v114, 16, v66
    v_and_b32 v115, 0xffff0000, v66
    v_lshlrev_b32 v66, 16, v67
    v_and_b32 v67, 0xffff0000, v67
    v_lshlrev_b32 v116, 16, v68
    v_and_b32 v117, 0xffff0000, v68
    v_lshlrev_b32 v68, 16, v69
    v_and_b32 v69, 0xffff0000, v69
    v_pk_fma_f32 v[112:113], v[112:113], v[108:109], s[16:17] op_sel:[0,0,0] op_sel_hi:[1,0,0]
    v_pk_fma_f32 v[64:65], v[64:65], v[108:109], s[16:17] op_sel:[0,0,0] op_sel_hi:[1,0,0]
    v_pk_fma_f32 v[114:115], v[114:115], v[108:109], s[16:17] op_sel:[0,1,0] op_sel_hi:[1,1,0]
    v_pk_fma_f32 v[66:67], v[66:67], v[108:109], s[16:17] op_sel:[0,1,0] op_sel_hi:[1,1,0]
    v_pk_fma_f32 v[116:117], v[116:117], v[110:111], s[16:17] op_sel:[0,0,0] op_sel_hi:[1,0,0]
    v_pk_fma_f32 v[68:69], v[68:69], v[110:111], s[16:17] op_sel:[0,0,0] op_sel_hi:[1,0,0]
    v_perm_b32 v65, v65, v64, s17
    v_perm_b32 v64, v113, v112, s17
    v_perm_b32 v67, v67, v66, s17
    v_perm_b32 v66, v115, v114, s17
    v_perm_b32 v69, v69, v68, s17
    v_perm_b32 v68, v117, v116, s17
    v_lshl_add_u64 v[64:65], v[64:65], 0, s[20:21]
    v_lshl_add_u64 v[66:67], v[66:67], 0, s[20:21]
    v_lshl_add_u64 v[68:69], v[68:69], 0, s[20:21]
    v_or3_b32 v4, v44, v45, v4
    v_or3_b32 v4, v46, v47, v4
    v_or3_b32 v4, v48, v49, v4
    ds_add_rtn_u64 v[44:45], v24, v[64:65]
    ds_add_rtn_u64 v[46:47], v25, v[66:67]
    ds_add_rtn_u64 v[48:49], v26, v[68:69]
L_p2_kernel_noopt2_4:
    s_barrier
    s_waitcnt vmcnt(1)
    ds_write_b128 v3, v[88:91] offset:0
    ds_write_b128 v3, v[92:95] offset:16384
    ds_write_b128 v3, v[96:99] offset:32768
    ds_write_b128 v3, v[100:103] offset:49152
    ds_write_b128 v124, v[104:107] offset:0
    v_mbcnt_lo_u32_b32 v118, s34, 0
    v_mbcnt_hi_u32_b32 v118, s35, v118
    s_bcnt1_i32_b64 s14, s[34:35]
    v_lshl_add_u32 v119, v118, 1, s25
    ds_read_u16 v119, v119
    s_add_u32 s34, s26, 2097152
    s_lshl1_add_u32 s25, s14, s25
    s_lshl_b32 s14, s14, 10
    s_add_u32 s26, s26, s14
    v_bfe_i32 v108, v19, 2, 10
    v_bfe_i32 v109, v19, 12, 10
    v_ashrrev_i32 v110, 22, v19
    v_cvt_f32_i32 v108, v108
    v_cvt_f32_i32 v109, v109
    v_cvt_f32_i32 v110, v110
    v_mad_u32_u16 v16, v16, 8, s50 op_sel:[1,0,0,0]
    v_mad_u32_u16 v17, v17, 8, s50 op_sel:[1,0,0,0]
    v_mad_u32_u16 v18, v18, 8, s50 op_sel:[1,0,0,0]
    v_lshlrev_b32 v112, 16, v76
    v_and_b32 v113, 0xffff0000, v76
    v_lshlrev_b32 v76, 16, v77
    v_and_b32 v77, 0xffff0000, v77
    v_lshlrev_b32 v114, 16, v78
    v_and_b32 v115, 0xffff0000, v78
    v_lshlrev_b32 v78, 16, v79
    v_and_b32 v79, 0xffff0000, v79
    v_lshlrev_b32 v116, 16, v80
    v_and_b32 v117, 0xffff0000, v80
    v_lshlrev_b32 v80, 16, v81
    v_and_b32 v81, 0xffff0000, v81
    v_pk_fma_f32 v[112:113], v[112:113], v[108:109], s[16:17] op_sel:[0,0,0] op_sel_hi:[1,0,0]
    v_pk_fma_f32 v[76:77], v[76:77], v[108:109], s[16:17] op_sel:[0,0,0] op_sel_hi:[1,0,0]
    v_pk_fma_f32 v[114:115], v[114:115], v[108:109], s[16:17] op_sel:[0,1,0] op_sel_hi:[1,1,0]
    v_pk_fma_f32 v[78:79], v[78:79], v[108:109], s[16:17] op_sel:[0,1,0] op_sel_hi:[1,1,0]
    v_pk_fma_f32 v[116:117], v[116:117], v[110:111], s[16:17] op_sel:[0,0,0] op_sel_hi:[1,0,0]
    v_pk_fma_f32 v[80:81], v[80:81], v[110:111], s[16:17] op_sel:[0,0,0] op_sel_hi:[1,0,0]
    v_perm_b32 v77, v77, v76, s17
    v_perm_b32 v76, v113, v112, s17
    v_perm_b32 v79, v79, v78, s17
    v_perm_b32 v78, v115, v114, s17
    v_perm_b32 v81, v81, v80, s17
    v_perm_b32 v80, v117, v116, s17
    v_lshl_add_u64 v[76:77], v[76:77], 0, s[20:21]
    v_lshl_add_u64 v[78:79], v[78:79], 0, s[20:21]
    v_lshl_add_u64 v[80:81], v[80:81], 0, s[20:21]
    s_waitcnt lgkmcnt(6)
    v_or3_b32 v4, v44, v45, v4
    v_or3_b32 v4, v46, v47, v4
    v_or3_b32 v4, v48, v49, v4
    ds_add_rtn_u64 v[44:45], v16, v[76:77]
    ds_add_rtn_u64 v[46:47], v17, v[78:79]
    ds_add_rtn_u64 v[48:49], v18, v[80:81]
    s_waitcnt lgkmcnt(3)
    v_mad_u32_u16 v119, v119, s23, v2
    v_pk_lshrrev_b16 v119, 10, v119 op_sel_hi:[1,1]
    v_lshl_add_u32 v118, v118, 6, v119
    buffer_load_dwordx4 v[16:19], v118, s[44:47], s34 idxen
    v_mbcnt_lo_u32_b32 v118, s36, 0
    v_mbcnt_hi_u32_b32 v118, s37, v118
    s_bcnt1_i32_b64 s14, s[36:37]
    v_lshl_add_u32 v119, v118, 1, s25
    ds_read_u16 v119, v119
    s_add_u32 s36, s26, 3145728
    s_lshl1_add_u32 s25, s14, s25
    s_lshl_b32 s14, s14, 10
    s_add_u32 s26, s26, s14
    v_bfe_i32 v108, v23, 2, 10
    v_bfe_i32 v109, v23, 12, 10
    v_ashrrev_i32 v110, 22, v23
    v_cvt_f32_i32 v108, v108
    v_cvt_f32_i32 v109, v109
    v_cvt_f32_i32 v110, v110
    v_mad_u32_u16 v20, v20, 8, s50 op_sel:[1,0,0,0]
    v_mad_u32_u16 v21, v21, 8, s50 op_sel:[1,0,0,0]
    v_mad_u32_u16 v22, v22, 8, s50 op_sel:[1,0,0,0]
    v_lshlrev_b32 v112, 16, v82
    v_and_b32 v113, 0xffff0000, v82
    v_lshlrev_b32 v82, 16, v83
    v_and_b32 v83, 0xffff0000, v83
    v_lshlrev_b32 v114, 16, v84
    v_and_b32 v115, 0xffff0000, v84
    v_lshlrev_b32 v84, 16, v85
    v_and_b32 v85, 0xffff0000, v85
    v_lshlrev_b32 v116, 16, v86
    v_and_b32 v117, 0xffff0000, v86
    v_lshlrev_b32 v86, 16, v87
    v_and_b32 v87, 0xffff0000, v87
    v_pk_fma_f32 v[112:113], v[112:113], v[108:109], s[16:17] op_sel:[0,0,0] op_sel_hi:[1,0,0]
    v_pk_fma_f32 v[82:83], v[82:83], v[108:109], s[16:17] op_sel:[0,0,0] op_sel_hi:[1,0,0]
    v_pk_fma_f32 v[114:115], v[114:115], v[108:109], s[16:17] op_sel:[0,1,0] op_sel_hi:[1,1,0]
    v_pk_fma_f32 v[84:85], v[84:85], v[108:109], s[16:17] op_sel:[0,1,0] op_sel_hi:[1,1,0]
    v_pk_fma_f32 v[116:117], v[116:117], v[110:111], s[16:17] op_sel:[0,0,0] op_sel_hi:[1,0,0]
    v_pk_fma_f32 v[86:87], v[86:87], v[110:111], s[16:17] op_sel:[0,0,0] op_sel_hi:[1,0,0]
    v_perm_b32 v83, v83, v82, s17
    v_perm_b32 v82, v113, v112, s17
    v_perm_b32 v85, v85, v84, s17
    v_perm_b32 v84, v115, v114, s17
    v_perm_b32 v87, v87, v86, s17
    v_perm_b32 v86, v117, v116, s17
    v_lshl_add_u64 v[82:83], v[82:83], 0, s[20:21]
    v_lshl_add_u64 v[84:85], v[84:85], 0, s[20:21]
    v_lshl_add_u64 v[86:87], v[86:87], 0, s[20:21]
    s_waitcnt lgkmcnt(1)
    v_or3_b32 v4, v44, v45, v4
    v_or3_b32 v4, v46, v47, v4
    v_or3_b32 v4, v48, v49, v4
    ds_add_rtn_u64 v[44:45], v20, v[82:83]
    ds_add_rtn_u64 v[46:47], v21, v[84:85]
    ds_add_rtn_u64 v[48:49], v22, v[86:87]
    s_waitcnt lgkmcnt(3)
    v_mad_u32_u16 v119, v119, s23, v2
    v_pk_lshrrev_b16 v119, 10, v119 op_sel_hi:[1,1]
    v_lshl_add_u32 v118, v118, 6, v119
    buffer_load_dwordx4 v[20:23], v118, s[44:47], s36 idxen
    s_cmp_le_u32 s28, 256
    s_cbranch_scc1 L_p2_kernel_noopt_5
    v_readlane_b32 s38, v7, 8
    v_readlane_b32 s39, v7, 9
    s_nop 1
    v_mbcnt_lo_u32_b32 v118, s38, 0
    v_mbcnt_hi_u32_b32 v118, s39, v118
    s_bcnt1_i32_b64 s14, s[38:39]
    v_lshl_add_u32 v119, v118, 1, s25
    ds_read_u16 v119, v119
    s_add_u32 s38, s26, 4194304
    s_lshl1_add_u32 s25, s14, s25
    s_lshl_b32 s14, s14, 10
    s_add_u32 s26, s26, s14
    s_waitcnt lgkmcnt(0)
    v_mad_u32_u16 v119, v119, s23, v2
    v_pk_lshrrev_b16 v119, 10, v119 op_sel_hi:[1,1]
    v_lshl_add_u32 v118, v118, 6, v119
    buffer_load_dwordx4 v[24:27], v118, s[44:47], s38 idxen
L_p2_kernel_noopt_5:
    v_mad_u32_u16 v108, v28, v50, s40 op_sel:[1,0,0,0]
    v_mad_u32_u16 v109, v36, v50, s41 op_sel:[1,0,0,0]
    v_sub_u32_sdwa v110, v109, v108 dst_sel:DWORD dst_unused:UNUSED_PAD src0_sel:WORD_1 src1_sel:WORD_1
    s_nop 1
    v_add_u32_dpp v110, v110, v110 row_shr:1 row_mask:0xf bank_mask:0xf bound_ctrl:0
    s_nop 1
    v_add_u32_dpp v110, v110, v110 row_shr:2 row_mask:0xf bank_mask:0xf bound_ctrl:0
    s_nop 1
    v_add_u32_dpp v110, v110, v110 row_shr:4 row_mask:0xf bank_mask:0xf bound_ctrl:0
    s_nop 1
    v_add_u32_dpp v110, v110, v110 row_shr:8 row_mask:0xf bank_mask:0xf bound_ctrl:0
    s_nop 1
    v_add_u32_dpp v110, v110, v110 row_bcast:15 row_mask:0xa bank_mask:0xf
    s_nop 1
    v_add_u32_dpp v110, v110, v110 row_bcast:31 row_mask:0xc bank_mask:0xf
    v_sub_u32_sdwa v109, v109, v110 dst_sel:DWORD dst_unused:UNUSED_PAD src0_sel:WORD_1 src1_sel:DWORD
    v_readlane_b32 s29, v110, 63
    v_add_u32 v110, -1, v110
    ds_write_b16 v126, v109
    v_lshlrev_b32_e64 v111, v110, 1
    v_lshrrev_b32 v110, 5, v110
    v_lshl_add_u32 v110, v110, 2, s19
    s_cmp_gt_u32 s29, 320
    s_cselect_b32 s2, 1, s2
    s_cselect_b64 exec, 0, -1
    ds_or_b32 v110, v111 offset:160
    s_mov_b64 exec, -1
    ds_wrxchg_rtn_b32 v7, v6, v5 offset:160
    s_add_u32 s14, s22, 80000
    buffer_load_dwordx4 v[88:91], v1, s[8:11], s14 offen
    s_add_u32 s14, s22, 96384
    buffer_load_dwordx4 v[92:95], v1, s[8:11], s14 offen
    s_add_u32 s24, s24, 1
    s_cmp_lt_u32 s24, 8
    s_barrier
    s_cbranch_scc1 L_p2_loop
    s_waitcnt lgkmcnt(3)
    v_or3_b32 v4, v44, v45, v4
    v_or3_b32 v4, v46, v47, v4
    v_or3_b32 v4, v48, v49, v4
    s_mov_b32 s27, s19
    s_waitcnt vmcnt(0)
    v_mov_b32 v8, 160232
    s_cmp_lg_u32 s13, 0
    s_cselect_b64 exec, 0, 1
    ds_write_b32 v8, v52
    s_mov_b64 exec, -1
    v_subrev_u32 v6, 80000, v124
    s_mul_i32 s24, s12, 20000
    v_subrev_u32 v10, s24, v1
    v_mov_b32 v11, 0x7f000000
    s_waitcnt vmcnt(0) lgkmcnt(0)
    s_barrier
    s_cmp_lt_u32 s13, 4
    s_cbranch_scc1 L_p2_ga
    v_lshlrev_b32 v30, 16, v60
    v_and_b32 v31, 0xffff0000, v60
    v_lshlrev_b32 v36, 16, v53
    v_and_b32 v37, 0xffff0000, v53
    v_lshlrev_b32 v38, 16, v54
    v_and_b32 v39, 0xffff0000, v54
    v_lshlrev_b32 v40, 16, v56
    v_and_b32 v41, 0xffff0000, v56
    v_lshlrev_b32 v42, 16, v57
    v_and_b32 v43, 0xffff0000, v57
    v_pk_add_f32 v[14:15], v[30:31], v[36:37] op_sel:[0,0] op_sel_hi:[1,0] neg_lo:[0,1] neg_hi:[0,1]
    v_pk_add_f32 v[16:17], v[30:31], v[36:37] op_sel:[0,1] op_sel_hi:[1,1] neg_lo:[0,1] neg_hi:[0,1]
    v_pk_add_f32 v[18:19], v[30:31], v[38:39] op_sel:[0,0] op_sel_hi:[1,0] neg_lo:[0,1] neg_hi:[0,1]
    v_pk_add_f32 v[20:21], v[30:31], v[38:39] op_sel:[0,1] op_sel_hi:[1,1] neg_lo:[0,1] neg_hi:[0,1]
    v_pk_add_f32 v[22:23], v[30:31], v[40:41] op_sel:[0,0] op_sel_hi:[1,0] neg_lo:[0,1] neg_hi:[0,1]
    v_pk_add_f32 v[24:25], v[30:31], v[40:41] op_sel:[0,1] op_sel_hi:[1,1] neg_lo:[0,1] neg_hi:[0,1]
    v_pk_add_f32 v[26:27], v[30:31], v[42:43] op_sel:[0,0] op_sel_hi:[1,0] neg_lo:[0,1] neg_hi:[0,1]
    v_pk_add_f32 v[28:29], v[30:31], v[42:43] op_sel:[0,1] op_sel_hi:[1,1] neg_lo:[0,1] neg_hi:[0,1]
    v_cvt_pk_bf16_f32 v32, v14, v15
    v_lshlrev_b32 v14, 16, v32
    v_and_b32 v15, 0xffff0000, v32
    v_cvt_pk_bf16_f32 v32, v16, v17
    v_lshlrev_b32 v16, 16, v32
    v_and_b32 v17, 0xffff0000, v32
    v_cvt_pk_bf16_f32 v32, v18, v19
    v_lshlrev_b32 v18, 16, v32
    v_and_b32 v19, 0xffff0000, v32
    v_cvt_pk_bf16_f32 v32, v20, v21
    v_lshlrev_b32 v20, 16, v32
    v_and_b32 v21, 0xffff0000, v32
    v_cvt_pk_bf16_f32 v32, v22, v23
    v_lshlrev_b32 v22, 16, v32
    v_and_b32 v23, 0xffff0000, v32
    v_cvt_pk_bf16_f32 v32, v24, v25
    v_lshlrev_b32 v24, 16, v32
    v_and_b32 v25, 0xffff0000, v32
    v_cvt_pk_bf16_f32 v32, v26, v27
    v_lshlrev_b32 v26, 16, v32
    v_and_b32 v27, 0xffff0000, v32
    v_cvt_pk_bf16_f32 v32, v28, v29
    v_lshlrev_b32 v28, 16, v32
    v_and_b32 v29, 0xffff0000, v32
    v_pk_mul_f32 v[14:15], v[14:15], v[14:15]
    v_pk_mul_f32 v[16:17], v[16:17], v[16:17]
    v_pk_mul_f32 v[18:19], v[18:19], v[18:19]
    v_pk_mul_f32 v[20:21], v[20:21], v[20:21]
    v_pk_mul_f32 v[22:23], v[22:23], v[22:23]
    v_pk_mul_f32 v[24:25], v[24:25], v[24:25]
    v_pk_mul_f32 v[26:27], v[26:27], v[26:27]
    v_pk_mul_f32 v[28:29], v[28:29], v[28:29]
    v_cvt_pk_bf16_f32 v32, v14, v15
    v_lshlrev_b32 v14, 16, v32
    v_and_b32 v15, 0xffff0000, v32
    v_cvt_pk_bf16_f32 v32, v16, v17
    v_lshlrev_b32 v16, 16, v32
    v_and_b32 v17, 0xffff0000, v32
    v_cvt_pk_bf16_f32 v32, v18, v19
    v_lshlrev_b32 v18, 16, v32
    v_and_b32 v19, 0xffff0000, v32
    v_cvt_pk_bf16_f32 v32, v20, v21
    v_lshlrev_b32 v20, 16, v32
    v_and_b32 v21, 0xffff0000, v32
    v_cvt_pk_bf16_f32 v32, v22, v23
    v_lshlrev_b32 v22, 16, v32
    v_and_b32 v23, 0xffff0000, v32
    v_cvt_pk_bf16_f32 v32, v24, v25
    v_lshlrev_b32 v24, 16, v32
    v_and_b32 v25, 0xffff0000, v32
    v_cvt_pk_bf16_f32 v32, v26, v27
    v_lshlrev_b32 v26, 16, v32
    v_and_b32 v27, 0xffff0000, v32
    v_cvt_pk_bf16_f32 v32, v28, v29
    v_lshlrev_b32 v28, 16, v32
    v_and_b32 v29, 0xffff0000, v32
    v_mov_b32 v30, 1092616192
    v_mov_b32 v31, 0x3fb8aa3b
    v_pk_mul_f32 v[14:15], v[14:15], v[30:31] op_sel:[0,0] op_sel_hi:[1,0]
    v_pk_mul_f32 v[16:17], v[16:17], v[30:31] op_sel:[0,0] op_sel_hi:[1,0]
    v_pk_mul_f32 v[18:19], v[18:19], v[30:31] op_sel:[0,0] op_sel_hi:[1,0]
    v_pk_mul_f32 v[20:21], v[20:21], v[30:31] op_sel:[0,0] op_sel_hi:[1,0]
    v_pk_mul_f32 v[22:23], v[22:23], v[30:31] op_sel:[0,0] op_sel_hi:[1,0]
    v_pk_mul_f32 v[24:25], v[24:25], v[30:31] op_sel:[0,0] op_sel_hi:[1,0]
    v_pk_mul_f32 v[26:27], v[26:27], v[30:31] op_sel:[0,0] op_sel_hi:[1,0]
    v_pk_mul_f32 v[28:29], v[28:29], v[30:31] op_sel:[0,0] op_sel_hi:[1,0]
    v_cvt_pk_bf16_f32 v32, v14, v15
    v_lshlrev_b32 v14, 16, v32
    v_and_b32 v15, 0xffff0000, v32
    v_cvt_pk_bf16_f32 v32, v16, v17
    v_lshlrev_b32 v16, 16, v32
    v_and_b32 v17, 0xffff0000, v32
    v_cvt_pk_bf16_f32 v32, v18, v19
    v_lshlrev_b32 v18, 16, v32
    v_and_b32 v19, 0xffff0000, v32
    v_cvt_pk_bf16_f32 v32, v20, v21
    v_lshlrev_b32 v20, 16, v32
    v_and_b32 v21, 0xffff0000, v32
    v_cvt_pk_bf16_f32 v32, v22, v23
    v_lshlrev_b32 v22, 16, v32
    v_and_b32 v23, 0xffff0000, v32
    v_cvt_pk_bf16_f32 v32, v24, v25
    v_lshlrev_b32 v24, 16, v32
    v_and_b32 v25, 0xffff0000, v32
    v_cvt_pk_bf16_f32 v32, v26, v27
    v_lshlrev_b32 v26, 16, v32
    v_and_b32 v27, 0xffff0000, v32
    v_cvt_pk_bf16_f32 v32, v28, v29
    v_lshlrev_b32 v28, 16, v32
    v_and_b32 v29, 0xffff0000, v32
    v_pk_mul_f32 v[14:15], v[14:15], v[30:31] op_sel:[0,1] op_sel_hi:[1,1]
    v_pk_mul_f32 v[16:17], v[16:17], v[30:31] op_sel:[0,1] op_sel_hi:[1,1]
    v_pk_mul_f32 v[18:19], v[18:19], v[30:31] op_sel:[0,1] op_sel_hi:[1,1]
    v_pk_mul_f32 v[20:21], v[20:21], v[30:31] op_sel:[0,1] op_sel_hi:[1,1]
    v_pk_mul_f32 v[22:23], v[22:23], v[30:31] op_sel:[0,1] op_sel_hi:[1,1]
    v_pk_mul_f32 v[24:25], v[24:25], v[30:31] op_sel:[0,1] op_sel_hi:[1,1]
    v_pk_mul_f32 v[26:27], v[26:27], v[30:31] op_sel:[0,1] op_sel_hi:[1,1]
    v_pk_mul_f32 v[28:29], v[28:29], v[30:31] op_sel:[0,1] op_sel_hi:[1,1]
    v_exp_f32 v14, -v14
    v_exp_f32 v15, -v15
    v_exp_f32 v16, -v16
    v_exp_f32 v17, -v17
    v_exp_f32 v18, -v18
    v_exp_f32 v19, -v19
    v_exp_f32 v20, -v20
    v_exp_f32 v21, -v21
    v_exp_f32 v22, -v22
    v_exp_f32 v23, -v23
    v_exp_f32 v24, -v24
    v_exp_f32 v25, -v25
    v_exp_f32 v26, -v26
    v_exp_f32 v27, -v27
    v_exp_f32 v28, -v28
    v_exp_f32 v29, -v29
    v_cvt_pk_bf16_f32 v14, v14, v16
    v_cvt_pk_bf16_f32 v15, v15, v17
    v_cvt_pk_bf16_f32 v18, v18, v20
    v_cvt_pk_bf16_f32 v19, v19, v21
    v_cvt_pk_bf16_f32 v22, v22, v24
    v_cvt_pk_bf16_f32 v23, v23, v25
    v_cvt_pk_bf16_f32 v26, v26, v28
    v_cvt_pk_bf16_f32 v27, v27, v29
    v_dot2_f32_bf16 v72, v14, s68, 0
    v_dot2_f32_bf16 v73, v15, s68, 0
    v_dot2_f32_bf16 v74, v14, s69, 0
    v_dot2_f32_bf16 v75, v15, s69, 0
    v_dot2_f32_bf16 v76, v14, s70, 0
    v_dot2_f32_bf16 v77, v15, s70, 0
    v_dot2_f32_bf16 v78, v14, s71, 0
    v_dot2_f32_bf16 v79, v15, s71, 0
    v_dot2_f32_bf16 v80, v14, s52, 0
    v_dot2_f32_bf16 v81, v15, s52, 0
    v_dot2_f32_bf16 v82, v14, s53, 0
    v_dot2_f32_bf16 v83, v15, s53, 0
    v_dot2_f32_bf16 v84, v14, s54, 0
    v_dot2_f32_bf16 v85, v15, s54, 0
    v_dot2_f32_bf16 v86, v14, s55, 0
    v_dot2_f32_bf16 v87, v15, s55, 0
    v_dot2_f32_bf16 v72, v18, s72, v72
    v_dot2_f32_bf16 v73, v19, s72, v73
    v_dot2_f32_bf16 v74, v18, s73, v74
    v_dot2_f32_bf16 v75, v19, s73, v75
    v_dot2_f32_bf16 v76, v18, s74, v76
    v_dot2_f32_bf16 v77, v19, s74, v77
    v_dot2_f32_bf16 v78, v18, s75, v78
    v_dot2_f32_bf16 v79, v19, s75, v79
    v_dot2_f32_bf16 v80, v18, s56, v80
    v_dot2_f32_bf16 v81, v19, s56, v81
    v_dot2_f32_bf16 v82, v18, s57, v82
    v_dot2_f32_bf16 v83, v19, s57, v83
    v_dot2_f32_bf16 v84, v18, s58, v84
    v_dot2_f32_bf16 v85, v19, s58, v85
    v_dot2_f32_bf16 v86, v18, s59, v86
    v_dot2_f32_bf16 v87, v19, s59, v87
    v_dot2_f32_bf16 v72, v22, s76, v72
    v_dot2_f32_bf16 v73, v23, s76, v73
    v_dot2_f32_bf16 v74, v22, s77, v74
    v_dot2_f32_bf16 v75, v23, s77, v75
    v_dot2_f32_bf16 v76, v22, s78, v76
    v_dot2_f32_bf16 v77, v23, s78, v77
    v_dot2_f32_bf16 v78, v22, s79, v78
    v_dot2_f32_bf16 v79, v23, s79, v79
    v_dot2_f32_bf16 v80, v22, s60, v80
    v_dot2_f32_bf16 v81, v23, s60, v81
    v_dot2_f32_bf16 v82, v22, s61, v82
    v_dot2_f32_bf16 v83, v23, s61, v83
    v_dot2_f32_bf16 v84, v22, s62, v84
    v_dot2_f32_bf16 v85, v23, s62, v85
    v_dot2_f32_bf16 v86, v22, s63, v86
    v_dot2_f32_bf16 v87, v23, s63, v87
    v_dot2_f32_bf16 v72, v26, s80, v72
    v_dot2_f32_bf16 v73, v27, s80, v73
    v_dot2_f32_bf16 v74, v26, s81, v74
    v_dot2_f32_bf16 v75, v27, s81, v75
    v_dot2_f32_bf16 v76, v26, s82, v76
    v_dot2_f32_bf16 v77, v27, s82, v77
    v_dot2_f32_bf16 v78, v26, s83, v78
    v_dot2_f32_bf16 v79, v27, s83, v79
    v_dot2_f32_bf16 v80, v26, s64, v80
    v_dot2_f32_bf16 v81, v27, s64, v81
    v_dot2_f32_bf16 v82, v26, s65, v82
    v_dot2_f32_bf16 v83, v27, s65, v83
    v_dot2_f32_bf16 v84, v26, s66, v84
    v_dot2_f32_bf16 v85, v27, s66, v85
    v_dot2_f32_bf16 v86, v26, s67, v86
    v_dot2_f32_bf16 v87, v27, s67, v87
L_p2_ga:
    ds_read_b32 v9, v8
    ds_read_b128 v[88:91], v1 offset:0
    ds_read_b128 v[92:95], v1 offset:16384
    ds_read_b128 v[96:99], v1 offset:32768
    ds_read_b128 v[100:103], v1 offset:49152
    ds_read_b128 v[104:107], v6
    s_mul_i32 s14, s12, 5120000
    s_mul_i32 s15, s3, 80000
    s_add_u32 s25, s14, s15
    s_add_u32 s25, s25, 233832448
    s_waitcnt lgkmcnt(5)
    v_readfirstlane_b32 s21, v9
    s_nop 0
    s_bfe_u32 s21, s21, 524296
    s_cmp_lg_u32 s21, 4
    s_cselect_b32 s21, 1, 0
    s_cselect_b32 s24, 0, 20000
    v_cmp_le_u32 vcc, s24, v10
    v_add_u32 v10, 16384, v10
    s_add_u32 s14, s25, 0
    v_cndmask_b32 v12, v11, v1, vcc
    s_waitcnt lgkmcnt(4)
    buffer_store_dwordx4 v[88:91], v12, s[4:7], s14 offen sc1
    v_or3_b32 v4, v88, v89, v4
    v_or3_b32 v4, v90, v91, v4
    v_cmp_le_u32 vcc, s24, v10
    v_add_u32 v10, 16384, v10
    s_add_u32 s14, s25, 16384
    v_cndmask_b32 v12, v11, v1, vcc
    s_waitcnt lgkmcnt(3)
    buffer_store_dwordx4 v[92:95], v12, s[4:7], s14 offen sc1
    v_or3_b32 v4, v92, v93, v4
    v_or3_b32 v4, v94, v95, v4
    v_cmp_le_u32 vcc, s24, v10
    v_add_u32 v10, 16384, v10
    s_add_u32 s14, s25, 32768
    v_cndmask_b32 v12, v11, v1, vcc
    s_waitcnt lgkmcnt(2)
    buffer_store_dwordx4 v[96:99], v12, s[4:7], s14 offen sc1
    v_or3_b32 v4, v96, v97, v4
    v_or3_b32 v4, v98, v99, v4
    v_cmp_le_u32 vcc, s24, v10
    v_add_u32 v10, 16384, v10
    s_add_u32 s14, s25, 49152
    v_cndmask_b32 v12, v11, v1, vcc
    s_waitcnt lgkmcnt(1)
    buffer_store_dwordx4 v[100:103], v12, s[4:7], s14 offen sc1
    v_or3_b32 v4, v100, v101, v4
    v_or3_b32 v4, v102, v103, v4
    v_cmp_le_u32 vcc, s24, v10
    v_add_u32 v10, 16384, v10
    s_add_u32 s14, s25, 0
    v_cndmask_b32 v12, v11, v6, vcc
    s_waitcnt lgkmcnt(0)
    buffer_store_dwordx4 v[104:107], v12, s[4:7], s14 offen sc1
    v_or3_b32 v4, v104, v105, v4
    v_or3_b32 v4, v106, v107, v4
    s_load_dwordx2 s[16:17], s[0:1], 88
    s_cmp_ge_u32 s13, 4
    s_cbranch_scc1 L_p2_gb
    v_lshlrev_b32 v30, 16, v60
    v_and_b32 v31, 0xffff0000, v60
    v_lshlrev_b32 v36, 16, v53
    v_and_b32 v37, 0xffff0000, v53
    v_lshlrev_b32 v38, 16, v54
    v_and_b32 v39, 0xffff0000, v54
    v_lshlrev_b32 v40, 16, v56
    v_and_b32 v41, 0xffff0000, v56
    v_lshlrev_b32 v42, 16, v57
    v_and_b32 v43, 0xffff0000, v57
    v_pk_add_f32 v[14:15], v[30:31], v[36:37] op_sel:[0,0] op_sel_hi:[1,0] neg_lo:[0,1] neg_hi:[0,1]
    v_pk_add_f32 v[16:17], v[30:31], v[36:37] op_sel:[0,1] op_sel_hi:[1,1] neg_lo:[0,1] neg_hi:[0,1]
    v_pk_add_f32 v[18:19], v[30:31], v[38:39] op_sel:[0,0] op_sel_hi:[1,0] neg_lo:[0,1] neg_hi:[0,1]
    v_pk_add_f32 v[20:21], v[30:31], v[38:39] op_sel:[0,1] op_sel_hi:[1,1] neg_lo:[0,1] neg_hi:[0,1]
    v_pk_add_f32 v[22:23], v[30:31], v[40:41] op_sel:[0,0] op_sel_hi:[1,0] neg_lo:[0,1] neg_hi:[0,1]
    v_pk_add_f32 v[24:25], v[30:31], v[40:41] op_sel:[0,1] op_sel_hi:[1,1] neg_lo:[0,1] neg_hi:[0,1]
    v_pk_add_f32 v[26:27], v[30:31], v[42:43] op_sel:[0,0] op_sel_hi:[1,0] neg_lo:[0,1] neg_hi:[0,1]
    v_pk_add_f32 v[28:29], v[30:31], v[42:43] op_sel:[0,1] op_sel_hi:[1,1] neg_lo:[0,1] neg_hi:[0,1]
    v_cvt_pk_bf16_f32 v32, v14, v15
    v_lshlrev_b32 v14, 16, v32
    v_and_b32 v15, 0xffff0000, v32
    v_cvt_pk_bf16_f32 v32, v16, v17
    v_lshlrev_b32 v16, 16, v32
    v_and_b32 v17, 0xffff0000, v32
    v_cvt_pk_bf16_f32 v32, v18, v19
    v_lshlrev_b32 v18, 16, v32
    v_and_b32 v19, 0xffff0000, v32
    v_cvt_pk_bf16_f32 v32, v20, v21
    v_lshlrev_b32 v20, 16, v32
    v_and_b32 v21, 0xffff0000, v32
    v_cvt_pk_bf16_f32 v32, v22, v23
    v_lshlrev_b32 v22, 16, v32
    v_and_b32 v23, 0xffff0000, v32
    v_cvt_pk_bf16_f32 v32, v24, v25
    v_lshlrev_b32 v24, 16, v32
    v_and_b32 v25, 0xffff0000, v32
    v_cvt_pk_bf16_f32 v32, v26, v27
    v_lshlrev_b32 v26, 16, v32
    v_and_b32 v27, 0xffff0000, v32
    v_cvt_pk_bf16_f32 v32, v28, v29
    v_lshlrev_b32 v28, 16, v32
    v_and_b32 v29, 0xffff0000, v32
    v_pk_mul_f32 v[14:15], v[14:15], v[14:15]
    v_pk_mul_f32 v[16:17], v[16:17], v[16:17]
    v_pk_mul_f32 v[18:19], v[18:19], v[18:19]
    v_pk_mul_f32 v[20:21], v[20:21], v[20:21]
    v_pk_mul_f32 v[22:23], v[22:23], v[22:23]
    v_pk_mul_f32 v[24:25], v[24:25], v[24:25]
    v_pk_mul_f32 v[26:27], v[26:27], v[26:27]
    v_pk_mul_f32 v[28:29], v[28:29], v[28:29]
    v_cvt_pk_bf16_f32 v32, v14, v15
    v_lshlrev_b32 v14, 16, v32
    v_and_b32 v15, 0xffff0000, v32
    v_cvt_pk_bf16_f32 v32, v16, v17
    v_lshlrev_b32 v16, 16, v32
    v_and_b32 v17, 0xffff0000, v32
    v_cvt_pk_bf16_f32 v32, v18, v19
    v_lshlrev_b32 v18, 16, v32
    v_and_b32 v19, 0xffff0000, v32
    v_cvt_pk_bf16_f32 v32, v20, v21
    v_lshlrev_b32 v20, 16, v32
    v_and_b32 v21, 0xffff0000, v32
    v_cvt_pk_bf16_f32 v32, v22, v23
    v_lshlrev_b32 v22, 16, v32
    v_and_b32 v23, 0xffff0000, v32
    v_cvt_pk_bf16_f32 v32, v24, v25
    v_lshlrev_b32 v24, 16, v32
    v_and_b32 v25, 0xffff0000, v32
    v_cvt_pk_bf16_f32 v32, v26, v27
    v_lshlrev_b32 v26, 16, v32
    v_and_b32 v27, 0xffff0000, v32
    v_cvt_pk_bf16_f32 v32, v28, v29
    v_lshlrev_b32 v28, 16, v32
    v_and_b32 v29, 0xffff0000, v32
    v_mov_b32 v30, 1092616192
    v_mov_b32 v31, 0x3fb8aa3b
    v_pk_mul_f32 v[14:15], v[14:15], v[30:31] op_sel:[0,0] op_sel_hi:[1,0]
    v_pk_mul_f32 v[16:17], v[16:17], v[30:31] op_sel:[0,0] op_sel_hi:[1,0]
    v_pk_mul_f32 v[18:19], v[18:19], v[30:31] op_sel:[0,0] op_sel_hi:[1,0]
    v_pk_mul_f32 v[20:21], v[20:21], v[30:31] op_sel:[0,0] op_sel_hi:[1,0]
    v_pk_mul_f32 v[22:23], v[22:23], v[30:31] op_sel:[0,0] op_sel_hi:[1,0]
    v_pk_mul_f32 v[24:25], v[24:25], v[30:31] op_sel:[0,0] op_sel_hi:[1,0]
    v_pk_mul_f32 v[26:27], v[26:27], v[30:31] op_sel:[0,0] op_sel_hi:[1,0]
    v_pk_mul_f32 v[28:29], v[28:29], v[30:31] op_sel:[0,0] op_sel_hi:[1,0]
    v_cvt_pk_bf16_f32 v32, v14, v15
    v_lshlrev_b32 v14, 16, v32
    v_and_b32 v15, 0xffff0000, v32
    v_cvt_pk_bf16_f32 v32, v16, v17
    v_lshlrev_b32 v16, 16, v32
    v_and_b32 v17, 0xffff0000, v32
    v_cvt_pk_bf16_f32 v32, v18, v19
    v_lshlrev_b32 v18, 16, v32
    v_and_b32 v19, 0xffff0000, v32
    v_cvt_pk_bf16_f32 v32, v20, v21
    v_lshlrev_b32 v20, 16, v32
    v_and_b32 v21, 0xffff0000, v32
    v_cvt_pk_bf16_f32 v32, v22, v23
    v_lshlrev_b32 v22, 16, v32
    v_and_b32 v23, 0xffff0000, v32
    v_cvt_pk_bf16_f32 v32, v24, v25
    v_lshlrev_b32 v24, 16, v32
    v_and_b32 v25, 0xffff0000, v32
    v_cvt_pk_bf16_f32 v32, v26, v27
    v_lshlrev_b32 v26, 16, v32
    v_and_b32 v27, 0xffff0000, v32
    v_cvt_pk_bf16_f32 v32, v28, v29
    v_lshlrev_b32 v28, 16, v32
    v_and_b32 v29, 0xffff0000, v32
    v_pk_mul_f32 v[14:15], v[14:15], v[30:31] op_sel:[0,1] op_sel_hi:[1,1]
    v_pk_mul_f32 v[16:17], v[16:17], v[30:31] op_sel:[0,1] op_sel_hi:[1,1]
    v_pk_mul_f32 v[18:19], v[18:19], v[30:31] op_sel:[0,1] op_sel_hi:[1,1]
    v_pk_mul_f32 v[20:21], v[20:21], v[30:31] op_sel:[0,1] op_sel_hi:[1,1]
    v_pk_mul_f32 v[22:23], v[22:23], v[30:31] op_sel:[0,1] op_sel_hi:[1,1]
    v_pk_mul_f32 v[24:25], v[24:25], v[30:31] op_sel:[0,1] op_sel_hi:[1,1]
    v_pk_mul_f32 v[26:27], v[26:27], v[30:31] op_sel:[0,1] op_sel_hi:[1,1]
    v_pk_mul_f32 v[28:29], v[28:29], v[30:31] op_sel:[0,1] op_sel_hi:[1,1]
    v_exp_f32 v14, -v14
    v_exp_f32 v15, -v15
    v_exp_f32 v16, -v16
    v_exp_f32 v17, -v17
    v_exp_f32 v18, -v18
    v_exp_f32 v19, -v19
    v_exp_f32 v20, -v20
    v_exp_f32 v21, -v21
    v_exp_f32 v22, -v22
    v_exp_f32 v23, -v23
    v_exp_f32 v24, -v24
    v_exp_f32 v25, -v25
    v_exp_f32 v26, -v26
    v_exp_f32 v27, -v27
    v_exp_f32 v28, -v28
    v_exp_f32 v29, -v29
    v_cvt_pk_bf16_f32 v14, v14, v16
    v_cvt_pk_bf16_f32 v15, v15, v17
    v_cvt_pk_bf16_f32 v18, v18, v20
    v_cvt_pk_bf16_f32 v19, v19, v21
    v_cvt_pk_bf16_f32 v22, v22, v24
    v_cvt_pk_bf16_f32 v23, v23, v25
    v_cvt_pk_bf16_f32 v26, v26, v28
    v_cvt_pk_bf16_f32 v27, v27, v29
    v_dot2_f32_bf16 v72, v14, s68, 0
    v_dot2_f32_bf16 v73, v15, s68, 0
    v_dot2_f32_bf16 v74, v14, s69, 0
    v_dot2_f32_bf16 v75, v15, s69, 0
    v_dot2_f32_bf16 v76, v14, s70, 0
    v_dot2_f32_bf16 v77, v15, s70, 0
    v_dot2_f32_bf16 v78, v14, s71, 0
    v_dot2_f32_bf16 v79, v15, s71, 0
    v_dot2_f32_bf16 v80, v14, s52, 0
    v_dot2_f32_bf16 v81, v15, s52, 0
    v_dot2_f32_bf16 v82, v14, s53, 0
    v_dot2_f32_bf16 v83, v15, s53, 0
    v_dot2_f32_bf16 v84, v14, s54, 0
    v_dot2_f32_bf16 v85, v15, s54, 0
    v_dot2_f32_bf16 v86, v14, s55, 0
    v_dot2_f32_bf16 v87, v15, s55, 0
    v_dot2_f32_bf16 v72, v18, s72, v72
    v_dot2_f32_bf16 v73, v19, s72, v73
    v_dot2_f32_bf16 v74, v18, s73, v74
    v_dot2_f32_bf16 v75, v19, s73, v75
    v_dot2_f32_bf16 v76, v18, s74, v76
    v_dot2_f32_bf16 v77, v19, s74, v77
    v_dot2_f32_bf16 v78, v18, s75, v78
    v_dot2_f32_bf16 v79, v19, s75, v79
    v_dot2_f32_bf16 v80, v18, s56, v80
    v_dot2_f32_bf16 v81, v19, s56, v81
    v_dot2_f32_bf16 v82, v18, s57, v82
    v_dot2_f32_bf16 v83, v19, s57, v83
    v_dot2_f32_bf16 v84, v18, s58, v84
    v_dot2_f32_bf16 v85, v19, s58, v85
    v_dot2_f32_bf16 v86, v18, s59, v86
    v_dot2_f32_bf16 v87, v19, s59, v87
    v_dot2_f32_bf16 v72, v22, s76, v72
    v_dot2_f32_bf16 v73, v23, s76, v73
    v_dot2_f32_bf16 v74, v22, s77, v74
    v_dot2_f32_bf16 v75, v23, s77, v75
    v_dot2_f32_bf16 v76, v22, s78, v76
    v_dot2_f32_bf16 v77, v23, s78, v77
    v_dot2_f32_bf16 v78, v22, s79, v78
    v_dot2_f32_bf16 v79, v23, s79, v79
    v_dot2_f32_bf16 v80, v22, s60, v80
    v_dot2_f32_bf16 v81, v23, s60, v81
    v_dot2_f32_bf16 v82, v22, s61, v82
    v_dot2_f32_bf16 v83, v23, s61, v83
    v_dot2_f32_bf16 v84, v22, s62, v84
    v_dot2_f32_bf16 v85, v23, s62, v85
    v_dot2_f32_bf16 v86, v22, s63, v86
    v_dot2_f32_bf16 v87, v23, s63, v87
    v_dot2_f32_bf16 v72, v26, s80, v72
    v_dot2_f32_bf16 v73, v27, s80, v73
    v_dot2_f32_bf16 v74, v26, s81, v74
    v_dot2_f32_bf16 v75, v27, s81, v75
    v_dot2_f32_bf16 v76, v26, s82, v76
    v_dot2_f32_bf16 v77, v27, s82, v77
    v_dot2_f32_bf16 v78, v26, s83, v78
    v_dot2_f32_bf16 v79, v27, s83, v79
    v_dot2_f32_bf16 v80, v26, s64, v80
    v_dot2_f32_bf16 v81, v27, s64, v81
    v_dot2_f32_bf16 v82, v26, s65, v82
    v_dot2_f32_bf16 v83, v27, s65, v83
    v_dot2_f32_bf16 v84, v26, s66, v84
    v_dot2_f32_bf16 v85, v27, s66, v85
    v_dot2_f32_bf16 v86, v26, s67, v86
    v_dot2_f32_bf16 v87, v27, s67, v87
    s_cmp_ge_u32 s13, 4
    s_cbranch_scc1 L_p2_kernel_g1_6
    v_lshlrev_b32 v30, 16, v61
    v_and_b32 v31, 0xffff0000, v61
    v_pk_add_f32 v[14:15], v[30:31], v[36:37] op_sel:[0,0] op_sel_hi:[1,0] neg_lo:[0,1] neg_hi:[0,1]
    v_pk_add_f32 v[16:17], v[30:31], v[36:37] op_sel:[0,1] op_sel_hi:[1,1] neg_lo:[0,1] neg_hi:[0,1]
    v_pk_add_f32 v[18:19], v[30:31], v[38:39] op_sel:[0,0] op_sel_hi:[1,0] neg_lo:[0,1] neg_hi:[0,1]
    v_pk_add_f32 v[20:21], v[30:31], v[38:39] op_sel:[0,1] op_sel_hi:[1,1] neg_lo:[0,1] neg_hi:[0,1]
    v_pk_add_f32 v[22:23], v[30:31], v[40:41] op_sel:[0,0] op_sel_hi:[1,0] neg_lo:[0,1] neg_hi:[0,1]
    v_pk_add_f32 v[24:25], v[30:31], v[40:41] op_sel:[0,1] op_sel_hi:[1,1] neg_lo:[0,1] neg_hi:[0,1]
    v_pk_add_f32 v[26:27], v[30:31], v[42:43] op_sel:[0,0] op_sel_hi:[1,0] neg_lo:[0,1] neg_hi:[0,1]
    v_pk_add_f32 v[28:29], v[30:31], v[42:43] op_sel:[0,1] op_sel_hi:[1,1] neg_lo:[0,1] neg_hi:[0,1]
    v_cvt_pk_bf16_f32 v32, v14, v15
    v_lshlrev_b32 v14, 16, v32
    v_and_b32 v15, 0xffff0000, v32
    v_cvt_pk_bf16_f32 v32, v16, v17
    v_lshlrev_b32 v16, 16, v32
    v_and_b32 v17, 0xffff0000, v32
    v_cvt_pk_bf16_f32 v32, v18, v19
    v_lshlrev_b32 v18, 16, v32
    v_and_b32 v19, 0xffff0000, v32
    v_cvt_pk_bf16_f32 v32, v20, v21
    v_lshlrev_b32 v20, 16, v32
    v_and_b32 v21, 0xffff0000, v32
    v_cvt_pk_bf16_f32 v32, v22, v23
    v_lshlrev_b32 v22, 16, v32
    v_and_b32 v23, 0xffff0000, v32
    v_cvt_pk_bf16_f32 v32, v24, v25
    v_lshlrev_b32 v24, 16, v32
    v_and_b32 v25, 0xffff0000, v32
    v_cvt_pk_bf16_f32 v32, v26, v27
    v_lshlrev_b32 v26, 16, v32
    v_and_b32 v27, 0xffff0000, v32
    v_cvt_pk_bf16_f32 v32, v28, v29
    v_lshlrev_b32 v28, 16, v32
    v_and_b32 v29, 0xffff0000, v32
    v_pk_mul_f32 v[14:15], v[14:15], v[14:15]
    v_pk_mul_f32 v[16:17], v[16:17], v[16:17]
    v_pk_mul_f32 v[18:19], v[18:19], v[18:19]
    v_pk_mul_f32 v[20:21], v[20:21], v[20:21]
    v_pk_mul_f32 v[22:23], v[22:23], v[22:23]
    v_pk_mul_f32 v[24:25], v[24:25], v[24:25]
    v_pk_mul_f32 v[26:27], v[26:27], v[26:27]
    v_pk_mul_f32 v[28:29], v[28:29], v[28:29]
    v_cvt_pk_bf16_f32 v32, v14, v15
    v_lshlrev_b32 v14, 16, v32
    v_and_b32 v15, 0xffff0000, v32
    v_cvt_pk_bf16_f32 v32, v16, v17
    v_lshlrev_b32 v16, 16, v32
    v_and_b32 v17, 0xffff0000, v32
    v_cvt_pk_bf16_f32 v32, v18, v19
    v_lshlrev_b32 v18, 16, v32
    v_and_b32 v19, 0xffff0000, v32
    v_cvt_pk_bf16_f32 v32, v20, v21
    v_lshlrev_b32 v20, 16, v32
    v_and_b32 v21, 0xffff0000, v32
    v_cvt_pk_bf16_f32 v32, v22, v23
    v_lshlrev_b32 v22, 16, v32
    v_and_b32 v23, 0xffff0000, v32
    v_cvt_pk_bf16_f32 v32, v24, v25
    v_lshlrev_b32 v24, 16, v32
    v_and_b32 v25, 0xffff0000, v32
    v_cvt_pk_bf16_f32 v32, v26, v27
    v_lshlrev_b32 v26, 16, v32
    v_and_b32 v27, 0xffff0000, v32
    v_cvt_pk_bf16_f32 v32, v28, v29
    v_lshlrev_b32 v28, 16, v32
    v_and_b32 v29, 0xffff0000, v32
    v_mov_b32 v30, 1092616192
    v_mov_b32 v31, 0x3fb8aa3b
    v_pk_mul_f32 v[14:15], v[14:15], v[30:31] op_sel:[0,0] op_sel_hi:[1,0]
    v_pk_mul_f32 v[16:17], v[16:17], v[30:31] op_sel:[0,0] op_sel_hi:[1,0]
    v_pk_mul_f32 v[18:19], v[18:19], v[30:31] op_sel:[0,0] op_sel_hi:[1,0]
    v_pk_mul_f32 v[20:21], v[20:21], v[30:31] op_sel:[0,0] op_sel_hi:[1,0]
    v_pk_mul_f32 v[22:23], v[22:23], v[30:31] op_sel:[0,0] op_sel_hi:[1,0]
    v_pk_mul_f32 v[24:25], v[24:25], v[30:31] op_sel:[0,0] op_sel_hi:[1,0]
    v_pk_mul_f32 v[26:27], v[26:27], v[30:31] op_sel:[0,0] op_sel_hi:[1,0]
    v_pk_mul_f32 v[28:29], v[28:29], v[30:31] op_sel:[0,0] op_sel_hi:[1,0]
    v_cvt_pk_bf16_f32 v32, v14, v15
    v_lshlrev_b32 v14, 16, v32
    v_and_b32 v15, 0xffff0000, v32
    v_cvt_pk_bf16_f32 v32, v16, v17
    v_lshlrev_b32 v16, 16, v32
    v_and_b32 v17, 0xffff0000, v32
    v_cvt_pk_bf16_f32 v32, v18, v19
    v_lshlrev_b32 v18, 16, v32
    v_and_b32 v19, 0xffff0000, v32
    v_cvt_pk_bf16_f32 v32, v20, v21
    v_lshlrev_b32 v20, 16, v32
    v_and_b32 v21, 0xffff0000, v32
    v_cvt_pk_bf16_f32 v32, v22, v23
    v_lshlrev_b32 v22, 16, v32
    v_and_b32 v23, 0xffff0000, v32
    v_cvt_pk_bf16_f32 v32, v24, v25
    v_lshlrev_b32 v24, 16, v32
    v_and_b32 v25, 0xffff0000, v32
    v_cvt_pk_bf16_f32 v32, v26, v27
    v_lshlrev_b32 v26, 16, v32
    v_and_b32 v27, 0xffff0000, v32
    v_cvt_pk_bf16_f32 v32, v28, v29
    v_lshlrev_b32 v28, 16, v32
    v_and_b32 v29, 0xffff0000, v32
    v_pk_mul_f32 v[14:15], v[14:15], v[30:31] op_sel:[0,1] op_sel_hi:[1,1]
    v_pk_mul_f32 v[16:17], v[16:17], v[30:31] op_sel:[0,1] op_sel_hi:[1,1]
    v_pk_mul_f32 v[18:19], v[18:19], v[30:31] op_sel:[0,1] op_sel_hi:[1,1]
    v_pk_mul_f32 v[20:21], v[20:21], v[30:31] op_sel:[0,1] op_sel_hi:[1,1]
    v_pk_mul_f32 v[22:23], v[22:23], v[30:31] op_sel:[0,1] op_sel_hi:[1,1]
    v_pk_mul_f32 v[24:25], v[24:25], v[30:31] op_sel:[0,1] op_sel_hi:[1,1]
    v_pk_mul_f32 v[26:27], v[26:27], v[30:31] op_sel:[0,1] op_sel_hi:[1,1]
    v_pk_mul_f32 v[28:29], v[28:29], v[30:31] op_sel:[0,1] op_sel_hi:[1,1]
    v_exp_f32 v14, -v14
    v_exp_f32 v15, -v15
    v_exp_f32 v16, -v16
    v_exp_f32 v17, -v17
    v_exp_f32 v18, -v18
    v_exp_f32 v19, -v19
    v_exp_f32 v20, -v20
    v_exp_f32 v21, -v21
    v_exp_f32 v22, -v22
    v_exp_f32 v23, -v23
    v_exp_f32 v24, -v24
    v_exp_f32 v25, -v25
    v_exp_f32 v26, -v26
    v_exp_f32 v27, -v27
    v_exp_f32 v28, -v28
    v_exp_f32 v29, -v29
    v_cvt_pk_bf16_f32 v14, v14, v16
    v_cvt_pk_bf16_f32 v15, v15, v17
    v_cvt_pk_bf16_f32 v18, v18, v20
    v_cvt_pk_bf16_f32 v19, v19, v21
    v_cvt_pk_bf16_f32 v22, v22, v24
    v_cvt_pk_bf16_f32 v23, v23, v25
    v_cvt_pk_bf16_f32 v26, v26, v28
    v_cvt_pk_bf16_f32 v27, v27, v29
    v_dot2_f32_bf16 v112, v14, s68, 0
    v_dot2_f32_bf16 v113, v15, s68, 0
    v_dot2_f32_bf16 v114, v14, s69, 0
    v_dot2_f32_bf16 v115, v15, s69, 0
    v_dot2_f32_bf16 v116, v14, s70, 0
    v_dot2_f32_bf16 v117, v15, s70, 0
    v_dot2_f32_bf16 v118, v14, s71, 0
    v_dot2_f32_bf16 v119, v15, s71, 0
    v_dot2_f32_bf16 v120, v14, s52, 0
    v_dot2_f32_bf16 v121, v15, s52, 0
    v_dot2_f32_bf16 v122, v14, s53, 0
    v_dot2_f32_bf16 v123, v15, s53, 0
    v_dot2_f32_bf16 v124, v14, s54, 0
    v_dot2_f32_bf16 v125, v15, s54, 0
    v_dot2_f32_bf16 v126, v14, s55, 0
    v_dot2_f32_bf16 v127, v15, s55, 0
    v_dot2_f32_bf16 v112, v18, s72, v112
    v_dot2_f32_bf16 v113, v19, s72, v113
    v_dot2_f32_bf16 v114, v18, s73, v114
    v_dot2_f32_bf16 v115, v19, s73, v115
    v_dot2_f32_bf16 v116, v18, s74, v116
    v_dot2_f32_bf16 v117, v19, s74, v117
    v_dot2_f32_bf16 v118, v18, s75, v118
    v_dot2_f32_bf16 v119, v19, s75, v119
    v_dot2_f32_bf16 v120, v18, s56, v120
    v_dot2_f32_bf16 v121, v19, s56, v121
    v_dot2_f32_bf16 v122, v18, s57, v122
    v_dot2_f32_bf16 v123, v19, s57, v123
    v_dot2_f32_bf16 v124, v18, s58, v124
    v_dot2_f32_bf16 v125, v19, s58, v125
    v_dot2_f32_bf16 v126, v18, s59, v126
    v_dot2_f32_bf16 v127, v19, s59, v127
    v_dot2_f32_bf16 v112, v22, s76, v112
    v_dot2_f32_bf16 v113, v23, s76, v113
    v_dot2_f32_bf16 v114, v22, s77, v114
    v_dot2_f32_bf16 v115, v23, s77, v115
    v_dot2_f32_bf16 v116, v22, s78, v116
    v_dot2_f32_bf16 v117, v23, s78, v117
    v_dot2_f32_bf16 v118, v22, s79, v118
    v_dot2_f32_bf16 v119, v23, s79, v119
    v_dot2_f32_bf16 v120, v22, s60, v120
    v_dot2_f32_bf16 v121, v23, s60, v121
    v_dot2_f32_bf16 v122, v22, s61, v122
    v_dot2_f32_bf16 v123, v23, s61, v123
    v_dot2_f32_bf16 v124, v22, s62, v124
    v_dot2_f32_bf16 v125, v23, s62, v125
    v_dot2_f32_bf16 v126, v22, s63, v126
    v_dot2_f32_bf16 v127, v23, s63, v127
    v_dot2_f32_bf16 v112, v26, s80, v112
    v_dot2_f32_bf16 v113, v27, s80, v113
    v_dot2_f32_bf16 v114, v26, s81, v114
    v_dot2_f32_bf16 v115, v27, s81, v115
    v_dot2_f32_bf16 v116, v26, s82, v116
    v_dot2_f32_bf16 v117, v27, s82, v117
    v_dot2_f32_bf16 v118, v26, s83, v118
    v_dot2_f32_bf16 v119, v27, s83, v119
    v_dot2_f32_bf16 v120, v26, s64, v120
    v_dot2_f32_bf16 v121, v27, s64, v121
    v_dot2_f32_bf16 v122, v26, s65, v122
    v_dot2_f32_bf16 v123, v27, s65, v123
    v_dot2_f32_bf16 v124, v26, s66, v124
    v_dot2_f32_bf16 v125, v27, s66, v125
    v_dot2_f32_bf16 v126, v26, s67, v126
    v_dot2_f32_bf16 v127, v27, s67, v127
L_p2_kernel_g1_6:
L_p2_gb:
    v_and_b32 v4, 0x80008000, v4
    v_cmp_ne_u32 vcc, 0, v4
    v_mov_b32 v8, s27
    v_and_b32 v10, 15, v0
    v_mul_u32_u24 v10, 240, v10
    v_add_u32 v10, 160000, v10
    s_cmp_lg_u64 vcc, 0
    s_cselect_b32 s2, 1, s2
    v_mov_b32 v9, s2
    s_mov_b64 exec, 1
    ds_write_b32 v8, v9
    s_mov_b64 exec, -1
    v_add_u32 v2, 16384, v1
    v_mov_b32 v9, 0x3f000000
    v_cmp_gt_u32 vcc, 226, v0
    s_mov_b32 s49, s12
    s_mov_b32 s51, 0
    v_cndmask_b32 v2, v9, v2, vcc
    s_waitcnt vmcnt(0) lgkmcnt(0)
    s_barrier
    ds_read_b32 v9, v10
    s_mov_b32 s18, 5120000
    s_mov_b32 s19, 0x00020000
    s_waitcnt lgkmcnt(0)
    v_cmp_ne_u32 vcc, 0, v9
    s_nop 1
    s_cmp_lg_u64 vcc, 0
    s_cselect_b32 s2, 1, 0
    s_cbranch_scc1 L_p2_slow
L_p2_signal:
    v_mov_b32 v8, 160228
    s_lshl_b32 s15, s2, 4
    s_or_b32 s15, s15, s21
    s_add_u32 s14, s12, 16
    s_lshl_b32 s20, s15, s14
    s_add_u32 s20, s20, 1
    v_mov_b32 v9, s20
    s_cmp_lg_u32 s13, 15
    s_cbranch_scc1 L_p2_nosig0
    s_lshl_b32 s14, s3, 8
    s_add_u32 s14, s14, 8557056
    s_mov_b64 exec, 1
    buffer_atomic_add v9, off, s[4:7], s14 sc0
    s_mov_b64 exec, -1
L_p2_nosig0:
    s_lshl2_add_u32 s14, s3, s49
    s_mul_i32 s26, s14, 20000
    s_add_u32 s15, s26, 8573440
    buffer_load_dwordx4 v[64:67], v1, s[4:7], s15 offen
    buffer_load_dwordx4 v[68:71], v2, s[4:7], s15 offen
    s_lshl_b32 s28, s92, 16
    s_and_b32 s29, s92, 0xffff0000
    s_lshl_b32 s30, s93, 16
    s_and_b32 s31, s93, 0xffff0000
    s_lshl_b32 s32, s94, 16
    s_and_b32 s33, s94, 0xffff0000
    s_lshl_b32 s34, s95, 16
    s_and_b32 s35, s95, 0xffff0000
    s_lshl_b32 s36, s96, 16
    s_and_b32 s37, s96, 0xffff0000
    s_lshl_b32 s38, s97, 16
    s_and_b32 s39, s97, 0xffff0000
    s_lshl_b32 s40, s98, 16
    s_and_b32 s41, s98, 0xffff0000
    s_lshl_b32 s42, s99, 16
    s_and_b32 s43, s99, 0xffff0000
    s_and_b32 s99, s91, 0xffff0000
    s_lshl_b32 s98, s91, 16
    s_and_b32 s97, s90, 0xffff0000
    s_lshl_b32 s96, s90, 16
    s_and_b32 s95, s89, 0xffff0000
    s_lshl_b32 s94, s89, 16
    s_and_b32 s93, s88, 0xffff0000
    s_lshl_b32 s92, s88, 16
    s_and_b32 s91, s87, 0xffff0000
    s_lshl_b32 s90, s87, 16
    s_and_b32 s89, s86, 0xffff0000
    s_lshl_b32 s88, s86, 16
    s_and_b32 s87, s85, 0xffff0000
    s_lshl_b32 s86, s85, 16
    s_and_b32 s85, s84, 0xffff0000
    s_lshl_b32 s84, s84, 16
    s_mov_b32 s44, s48
    s_add_u32 s45, s48, 2281701376
    s_cmp_eq_u32 s48, 0
    s_cselect_b32 s45, 0, s45
    s_cmp_lg_u32 s13, 15
    s_cbranch_scc1 L_p2_nosig
    s_waitcnt vmcnt(2)
    v_readfirstlane_b32 s15, v9
    s_lshl_b32 s51, 1, s12
    s_add_u32 s20, s20, s15
    s_and_b32 s15, s20, 0xff
    s_cmp_eq_u32 s15, 4
    s_cbranch_scc0 L_p2_notlast
    s_bfe_u32 s15, s20, 262160
    s_or_b32 s51, s51, s15
    s_branch L_p2_pub
L_p2_notlast:
    s_cmp_lg_u32 s21, 0
    s_cselect_b32 s51, 0, s51
    s_cbranch_scc1 L_p2_pub
L_p2_poll:
    v_mov_b32 v9, 0
    s_lshl_b32 s14, s3, 8
    s_add_u32 s14, s14, 8557056
    s_mov_b64 exec, 1
    buffer_atomic_add v9, off, s[4:7], s14 sc0
    s_mov_b64 exec, -1
    s_waitcnt vmcnt(0)
    v_readfirstlane_b32 s20, v9
    s_nop 0
    s_and_b32 s15, s20, 0xff
    s_cmp_lt_u32 s15, 4
    s_cbranch_scc1 L_p2_poll
L_p2_pub:
    s_lshl_b32 s15, s51, 24
    s_or_b32 s15, s15, s20
    v_mov_b32 v9, s15
    s_mov_b64 exec, 1
    ds_write_b32 v8, v9
    s_mov_b64 exec, -1
    s_waitcnt lgkmcnt(0)
L_p2_nosig:
    s_barrier
    ds_read_b32 v9, v8
    s_waitcnt lgkmcnt(0)
    v_readfirstlane_b32 s20, v9
    s_nop 0
    s_lshr_b32 s51, s20, 24
    s_cbranch_scc0 L_p2_end
L_p2_fin:
    s_mul_i32 s24, s49, 20000
    s_add_u32 s14, s12, 1
    s_and_b32 s14, s14, 3
    s_mul_i32 s15, s14, 5120000
    s_add_u32 s15, s15, 233832448
    s_add_u32 s15, s15, s26
    buffer_load_dwordx4 v[12:15], v1, s[4:7], s15 offen sc1
    buffer_load_dwordx4 v[92:95], v2, s[4:7], s15 offen sc1
    s_add_u32 s14, s12, 2
    s_and_b32 s14, s14, 3
    s_mul_i32 s15, s14, 5120000
    s_add_u32 s15, s15, 233832448
    s_add_u32 s15, s15, s26
    buffer_load_dwordx4 v[16:19], v1, s[4:7], s15 offen sc1
    buffer_load_dwordx4 v[96:99], v2, s[4:7], s15 offen sc1
    s_add_u32 s14, s12, 3
    s_and_b32 s14, s14, 3
    s_mul_i32 s15, s14, 5120000
    s_add_u32 s15, s15, 233832448
    s_add_u32 s15, s15, s26
    buffer_load_dwordx4 v[20:23], v1, s[4:7], s15 offen sc1
    buffer_load_dwordx4 v[100:103], v2, s[4:7], s15 offen sc1
    v_add_u32 v24, s24, v1
    ds_read_b128 v[8:11], v24
    v_add_u32 v25, s24, v2
    ds_read_b128 v[88:91], v25
    s_waitcnt vmcnt(0) lgkmcnt(0)
    s_bfe_u32 s14, s20, 262164
    s_cbranch_scc0 L_p2_kernel_nof32a_7
    s_add_u32 s14, s12, 0
    s_and_b32 s14, s14, 3
    s_add_u32 s14, s14, 20
    s_bitcmp1_b32 s20, s14
    s_cbranch_scc0 L_p2_kernel_q_8
    v_mov_b32 v8, 1073758208
    v_mov_b32 v9, 1073758208
    v_mov_b32 v10, 1073758208
    v_mov_b32 v11, 1073758208
L_p2_kernel_q_8:
    s_add_u32 s14, s12, 1
    s_and_b32 s14, s14, 3
    s_add_u32 s14, s14, 20
    s_bitcmp1_b32 s20, s14
    s_cbranch_scc0 L_p2_kernel_q_9
    v_mov_b32 v12, 1073758208
    v_mov_b32 v13, 1073758208
    v_mov_b32 v14, 1073758208
    v_mov_b32 v15, 1073758208
L_p2_kernel_q_9:
    s_add_u32 s14, s12, 2
    s_and_b32 s14, s14, 3
    s_add_u32 s14, s14, 20
    s_bitcmp1_b32 s20, s14
    s_cbranch_scc0 L_p2_kernel_q_10
    v_mov_b32 v16, 1073758208
    v_mov_b32 v17, 1073758208
    v_mov_b32 v18, 1073758208
    v_mov_b32 v19, 1073758208
L_p2_kernel_q_10:
    s_add_u32 s14, s12, 3
    s_and_b32 s14, s14, 3
    s_add_u32 s14, s14, 20
    s_bitcmp1_b32 s20, s14
    s_cbranch_scc0 L_p2_kernel_q_11
    v_mov_b32 v20, 1073758208
    v_mov_b32 v21, 1073758208
    v_mov_b32 v22, 1073758208
    v_mov_b32 v23, 1073758208
L_p2_kernel_q_11:
L_p2_kernel_nof32a_7:
    v_pk_add_u16 v8, v8, v12
    v_pk_add_u16 v16, v16, v20
    v_pk_add_u16 v9, v9, v13
    v_pk_add_u16 v17, v17, v21
    v_pk_add_u16 v10, v10, v14
    v_pk_add_u16 v18, v18, v22
    v_pk_add_u16 v11, v11, v15
    v_pk_add_u16 v19, v19, v23
    v_add_u32_sdwa v24, v8, v16 dst_sel:DWORD dst_unused:UNUSED_PAD src0_sel:WORD_0 src1_sel:WORD_0
    v_add_u32_sdwa v25, v10, v18 dst_sel:DWORD dst_unused:UNUSED_PAD src0_sel:WORD_0 src1_sel:WORD_0
    v_add_u32_sdwa v26, v8, v16 dst_sel:DWORD dst_unused:UNUSED_PAD src0_sel:WORD_1 src1_sel:WORD_1
    v_add_u32_sdwa v27, v10, v18 dst_sel:DWORD dst_unused:UNUSED_PAD src0_sel:WORD_1 src1_sel:WORD_1
    v_add_u32_sdwa v28, v9, v17 dst_sel:DWORD dst_unused:UNUSED_PAD src0_sel:WORD_0 src1_sel:WORD_0
    v_add_u32_sdwa v29, v11, v19 dst_sel:DWORD dst_unused:UNUSED_PAD src0_sel:WORD_0 src1_sel:WORD_0
    v_add_u32_sdwa v30, v9, v17 dst_sel:DWORD dst_unused:UNUSED_PAD src0_sel:WORD_1 src1_sel:WORD_1
    v_add_u32_sdwa v31, v11, v19 dst_sel:DWORD dst_unused:UNUSED_PAD src0_sel:WORD_1 src1_sel:WORD_1
    v_cvt_f32_u32 v24, v24
    v_cvt_f32_u32 v25, v25
    v_cvt_f32_u32 v26, v26
    v_cvt_f32_u32 v27, v27
    v_cvt_f32_u32 v28, v28
    v_cvt_f32_u32 v29, v29
    v_cvt_f32_u32 v30, v30
    v_cvt_f32_u32 v31, v31
    v_pk_fma_f32 v[24:25], v[24:25], s[44:45], s[44:45] op_sel:[0,0,1] op_sel_hi:[1,0,1]
    v_pk_fma_f32 v[26:27], v[26:27], s[44:45], s[44:45] op_sel:[0,0,1] op_sel_hi:[1,0,1]
    v_pk_fma_f32 v[28:29], v[28:29], s[44:45], s[44:45] op_sel:[0,0,1] op_sel_hi:[1,0,1]
    v_pk_fma_f32 v[30:31], v[30:31], s[44:45], s[44:45] op_sel:[0,0,1] op_sel_hi:[1,0,1]
    s_bfe_u32 s14, s20, 262164
    s_cbranch_scc0 L_p2_kernel_nof32b_12
    v_lshlrev_b32 v32, 1, v1
    s_bitcmp1_b32 s20, 20
    s_cbranch_scc0 L_p2_kernel_q_13
    s_lshl_b32 s15, s26, 1
    s_add_u32 s15, s15, 254312448
    buffer_load_dwordx4 v[8:11], v32, s[4:7], s15 offen sc1
    buffer_load_dwordx4 v[12:15], v32, s[4:7], s15 offen offset:16 sc1
    s_waitcnt vmcnt(0)
    v_add_f32 v24, v24, v8
    v_add_f32 v25, v25, v12
    v_add_f32 v26, v26, v9
    v_add_f32 v27, v27, v13
    v_add_f32 v28, v28, v10
    v_add_f32 v29, v29, v14
    v_add_f32 v30, v30, v11
    v_add_f32 v31, v31, v15
L_p2_kernel_q_13:
    s_bitcmp1_b32 s20, 21
    s_cbranch_scc0 L_p2_kernel_q_14
    s_lshl_b32 s15, s26, 1
    s_add_u32 s15, s15, 264552448
    buffer_load_dwordx4 v[8:11], v32, s[4:7], s15 offen sc1
    buffer_load_dwordx4 v[12:15], v32, s[4:7], s15 offen offset:16 sc1
    s_waitcnt vmcnt(0)
    v_add_f32 v24, v24, v8
    v_add_f32 v25, v25, v12
    v_add_f32 v26, v26, v9
    v_add_f32 v27, v27, v13
    v_add_f32 v28, v28, v10
    v_add_f32 v29, v29, v14
    v_add_f32 v30, v30, v11
    v_add_f32 v31, v31, v15
L_p2_kernel_q_14:
    s_bitcmp1_b32 s20, 22
    s_cbranch_scc0 L_p2_kernel_q_15
    s_lshl_b32 s15, s26, 1
    s_add_u32 s15, s15, 274792448
    buffer_load_dwordx4 v[8:11], v32, s[4:7], s15 offen sc1
    buffer_load_dwordx4 v[12:15], v32, s[4:7], s15 offen offset:16 sc1
    s_waitcnt vmcnt(0)
    v_add_f32 v24, v24, v8
    v_add_f32 v25, v25, v12
    v_add_f32 v26, v26, v9
    v_add_f32 v27, v27, v13
    v_add_f32 v28, v28, v10
    v_add_f32 v29, v29, v14
    v_add_f32 v30, v30, v11
    v_add_f32 v31, v31, v15
L_p2_kernel_q_15:
    s_bitcmp1_b32 s20, 23
    s_cbranch_scc0 L_p2_kernel_q_16
    s_lshl_b32 s15, s26, 1
    s_add_u32 s15, s15, 285032448
    buffer_load_dwordx4 v[8:11], v32, s[4:7], s15 offen sc1
    buffer_load_dwordx4 v[12:15], v32, s[4:7], s15 offen offset:16 sc1
    s_waitcnt vmcnt(0)
    v_add_f32 v24, v24, v8
    v_add_f32 v25, v25, v12
    v_add_f32 v26, v26, v9
    v_add_f32 v27, v27, v13
    v_add_f32 v28, v28, v10
    v_add_f32 v29, v29, v14
    v_add_f32 v30, v30, v11
    v_add_f32 v31, v31, v15
L_p2_kernel_q_16:
L_p2_kernel_nof32b_12:
    v_pk_mul_f32 v[8:9], v[24:25], s[84:85] op_sel:[0,0] op_sel_hi:[1,0]
    v_pk_mul_f32 v[10:11], v[24:25], s[84:85] op_sel:[0,1] op_sel_hi:[1,1]
    v_pk_mul_f32 v[12:13], v[24:25], s[86:87] op_sel:[0,0] op_sel_hi:[1,0]
    v_pk_mul_f32 v[14:15], v[24:25], s[86:87] op_sel:[0,1] op_sel_hi:[1,1]
    v_pk_fma_f32 v[8:9], v[26:27], s[88:89], v[8:9] op_sel:[0,0,0] op_sel_hi:[1,0,1]
    v_pk_fma_f32 v[10:11], v[26:27], s[88:89], v[10:11] op_sel:[0,1,0] op_sel_hi:[1,1,1]
    v_pk_fma_f32 v[12:13], v[26:27], s[90:91], v[12:13] op_sel:[0,0,0] op_sel_hi:[1,0,1]
    v_pk_fma_f32 v[14:15], v[26:27], s[90:91], v[14:15] op_sel:[0,1,0] op_sel_hi:[1,1,1]
    v_pk_fma_f32 v[8:9], v[28:29], s[92:93], v[8:9] op_sel:[0,0,0] op_sel_hi:[1,0,1]
    v_pk_fma_f32 v[10:11], v[28:29], s[92:93], v[10:11] op_sel:[0,1,0] op_sel_hi:[1,1,1]
    v_pk_fma_f32 v[12:13], v[28:29], s[94:95], v[12:13] op_sel:[0,0,0] op_sel_hi:[1,0,1]
    v_pk_fma_f32 v[14:15], v[28:29], s[94:95], v[14:15] op_sel:[0,1,0] op_sel_hi:[1,1,1]
    v_pk_fma_f32 v[8:9], v[30:31], s[96:97], v[8:9] op_sel:[0,0,0] op_sel_hi:[1,0,1]
    v_pk_fma_f32 v[10:11], v[30:31], s[96:97], v[10:11] op_sel:[0,1,0] op_sel_hi:[1,1,1]
    v_pk_fma_f32 v[12:13], v[30:31], s[98:99], v[12:13] op_sel:[0,0,0] op_sel_hi:[1,0,1]
    v_pk_fma_f32 v[14:15], v[30:31], s[98:99], v[14:15] op_sel:[0,1,0] op_sel_hi:[1,1,1]
    v_pk_mul_f32 v[8:9], v[8:9], v[72:73]
    v_pk_mul_f32 v[10:11], v[10:11], v[74:75]
    v_pk_mul_f32 v[12:13], v[12:13], v[76:77]
    v_pk_mul_f32 v[14:15], v[14:15], v[78:79]
    v_pk_mul_f32 v[24:25], v[8:9], s[28:29] op_sel:[0,0] op_sel_hi:[1,0]
    v_pk_mul_f32 v[26:27], v[8:9], s[28:29] op_sel:[0,1] op_sel_hi:[1,1]
    v_pk_mul_f32 v[28:29], v[8:9], s[30:31] op_sel:[0,0] op_sel_hi:[1,0]
    v_pk_mul_f32 v[30:31], v[8:9], s[30:31] op_sel:[0,1] op_sel_hi:[1,1]
    v_pk_fma_f32 v[24:25], v[10:11], s[32:33], v[24:25] op_sel:[0,0,0] op_sel_hi:[1,0,1]
    v_pk_fma_f32 v[26:27], v[10:11], s[32:33], v[26:27] op_sel:[0,1,0] op_sel_hi:[1,1,1]
    v_pk_fma_f32 v[28:29], v[10:11], s[34:35], v[28:29] op_sel:[0,0,0] op_sel_hi:[1,0,1]
    v_pk_fma_f32 v[30:31], v[10:11], s[34:35], v[30:31] op_sel:[0,1,0] op_sel_hi:[1,1,1]
    v_pk_fma_f32 v[24:25], v[12:13], s[36:37], v[24:25] op_sel:[0,0,0] op_sel_hi:[1,0,1]
    v_pk_fma_f32 v[26:27], v[12:13], s[36:37], v[26:27] op_sel:[0,1,0] op_sel_hi:[1,1,1]
    v_pk_fma_f32 v[28:29], v[12:13], s[38:39], v[28:29] op_sel:[0,0,0] op_sel_hi:[1,0,1]
    v_pk_fma_f32 v[30:31], v[12:13], s[38:39], v[30:31] op_sel:[0,1,0] op_sel_hi:[1,1,1]
    v_pk_fma_f32 v[24:25], v[14:15], s[40:41], v[24:25] op_sel:[0,0,0] op_sel_hi:[1,0,1]
    v_pk_fma_f32 v[26:27], v[14:15], s[40:41], v[26:27] op_sel:[0,1,0] op_sel_hi:[1,1,1]
    v_pk_fma_f32 v[28:29], v[14:15], s[42:43], v[28:29] op_sel:[0,0,0] op_sel_hi:[1,0,1]
    v_pk_fma_f32 v[30:31], v[14:15], s[42:43], v[30:31] op_sel:[0,1,0] op_sel_hi:[1,1,1]
    v_lshlrev_b32 v8, 16, v64
    v_and_b32 v10, 0xffff0000, v64
    v_lshlrev_b32 v12, 16, v65
    v_and_b32 v14, 0xffff0000, v65
    v_lshlrev_b32 v9, 16, v66
    v_and_b32 v11, 0xffff0000, v66
    v_lshlrev_b32 v13, 16, v67
    v_and_b32 v15, 0xffff0000, v67
    v_pk_fma_f32 v[8:9], v[24:25], v[80:81], v[8:9]
    v_pk_fma_f32 v[10:11], v[26:27], v[82:83], v[10:11]
    v_pk_fma_f32 v[12:13], v[28:29], v[84:85], v[12:13]
    v_pk_fma_f32 v[14:15], v[30:31], v[86:87], v[14:15]
    v_cvt_pk_bf16_f32 v16, v8, v10
    v_cvt_pk_bf16_f32 v17, v12, v14
    v_cvt_pk_bf16_f32 v18, v9, v11
    v_cvt_pk_bf16_f32 v19, v13, v15
    buffer_store_dwordx4 v[16:19], v1, s[16:19], s26 offen
    s_cmp_ge_u32 s13, 4
    s_cbranch_scc1 L_p2_f1
    s_bfe_u32 s14, s20, 262164
    s_cbranch_scc0 L_p2_kernel_nof32a_17
    s_add_u32 s14, s12, 0
    s_and_b32 s14, s14, 3
    s_add_u32 s14, s14, 20
    s_bitcmp1_b32 s20, s14
    s_cbranch_scc0 L_p2_kernel_q_18
    v_mov_b32 v88, 1073758208
    v_mov_b32 v89, 1073758208
    v_mov_b32 v90, 1073758208
    v_mov_b32 v91, 1073758208
L_p2_kernel_q_18:
    s_add_u32 s14, s12, 1
    s_and_b32 s14, s14, 3
    s_add_u32 s14, s14, 20
    s_bitcmp1_b32 s20, s14
    s_cbranch_scc0 L_p2_kernel_q_19
    v_mov_b32 v92, 1073758208
    v_mov_b32 v93, 1073758208
    v_mov_b32 v94, 1073758208
    v_mov_b32 v95, 1073758208
L_p2_kernel_q_19:
    s_add_u32 s14, s12, 2
    s_and_b32 s14, s14, 3
    s_add_u32 s14, s14, 20
    s_bitcmp1_b32 s20, s14
    s_cbranch_scc0 L_p2_kernel_q_20
    v_mov_b32 v96, 1073758208
    v_mov_b32 v97, 1073758208
    v_mov_b32 v98, 1073758208
    v_mov_b32 v99, 1073758208
L_p2_kernel_q_20:
    s_add_u32 s14, s12, 3
    s_and_b32 s14, s14, 3
    s_add_u32 s14, s14, 20
    s_bitcmp1_b32 s20, s14
    s_cbranch_scc0 L_p2_kernel_q_21
    v_mov_b32 v100, 1073758208
    v_mov_b32 v101, 1073758208
    v_mov_b32 v102, 1073758208
    v_mov_b32 v103, 1073758208
L_p2_kernel_q_21:
L_p2_kernel_nof32a_17:
    v_pk_add_u16 v88, v88, v92
    v_pk_add_u16 v96, v96, v100
    v_pk_add_u16 v89, v89, v93
    v_pk_add_u16 v97, v97, v101
    v_pk_add_u16 v90, v90, v94
    v_pk_add_u16 v98, v98, v102
    v_pk_add_u16 v91, v91, v95
    v_pk_add_u16 v99, v99, v103
    v_add_u32_sdwa v24, v88, v96 dst_sel:DWORD dst_unused:UNUSED_PAD src0_sel:WORD_0 src1_sel:WORD_0
    v_add_u32_sdwa v25, v90, v98 dst_sel:DWORD dst_unused:UNUSED_PAD src0_sel:WORD_0 src1_sel:WORD_0
    v_add_u32_sdwa v26, v88, v96 dst_sel:DWORD dst_unused:UNUSED_PAD src0_sel:WORD_1 src1_sel:WORD_1
    v_add_u32_sdwa v27, v90, v98 dst_sel:DWORD dst_unused:UNUSED_PAD src0_sel:WORD_1 src1_sel:WORD_1
    v_add_u32_sdwa v28, v89, v97 dst_sel:DWORD dst_unused:UNUSED_PAD src0_sel:WORD_0 src1_sel:WORD_0
    v_add_u32_sdwa v29, v91, v99 dst_sel:DWORD dst_unused:UNUSED_PAD src0_sel:WORD_0 src1_sel:WORD_0
    v_add_u32_sdwa v30, v89, v97 dst_sel:DWORD dst_unused:UNUSED_PAD src0_sel:WORD_1 src1_sel:WORD_1
    v_add_u32_sdwa v31, v91, v99 dst_sel:DWORD dst_unused:UNUSED_PAD src0_sel:WORD_1 src1_sel:WORD_1
    v_cvt_f32_u32 v24, v24
    v_cvt_f32_u32 v25, v25
    v_cvt_f32_u32 v26, v26
    v_cvt_f32_u32 v27, v27
    v_cvt_f32_u32 v28, v28
    v_cvt_f32_u32 v29, v29
    v_cvt_f32_u32 v30, v30
    v_cvt_f32_u32 v31, v31
    v_pk_fma_f32 v[24:25], v[24:25], s[44:45], s[44:45] op_sel:[0,0,1] op_sel_hi:[1,0,1]
    v_pk_fma_f32 v[26:27], v[26:27], s[44:45], s[44:45] op_sel:[0,0,1] op_sel_hi:[1,0,1]
    v_pk_fma_f32 v[28:29], v[28:29], s[44:45], s[44:45] op_sel:[0,0,1] op_sel_hi:[1,0,1]
    v_pk_fma_f32 v[30:31], v[30:31], s[44:45], s[44:45] op_sel:[0,0,1] op_sel_hi:[1,0,1]
    s_bfe_u32 s14, s20, 262164
    s_cbranch_scc0 L_p2_kernel_nof32b_22
    v_lshlrev_b32 v32, 1, v2
    s_bitcmp1_b32 s20, 20
    s_cbranch_scc0 L_p2_kernel_q_23
    s_lshl_b32 s15, s26, 1
    s_add_u32 s15, s15, 254312448
    buffer_load_dwordx4 v[88:91], v32, s[4:7], s15 offen sc1
    buffer_load_dwordx4 v[92:95], v32, s[4:7], s15 offen offset:16 sc1
    s_waitcnt vmcnt(0)
    v_add_f32 v24, v24, v88
    v_add_f32 v25, v25, v92
    v_add_f32 v26, v26, v89
    v_add_f32 v27, v27, v93
    v_add_f32 v28, v28, v90
    v_add_f32 v29, v29, v94
    v_add_f32 v30, v30, v91
    v_add_f32 v31, v31, v95
L_p2_kernel_q_23:
    s_bitcmp1_b32 s20, 21
    s_cbranch_scc0 L_p2_kernel_q_24
    s_lshl_b32 s15, s26, 1
    s_add_u32 s15, s15, 264552448
    buffer_load_dwordx4 v[88:91], v32, s[4:7], s15 offen sc1
    buffer_load_dwordx4 v[92:95], v32, s[4:7], s15 offen offset:16 sc1
    s_waitcnt vmcnt(0)
    v_add_f32 v24, v24, v88
    v_add_f32 v25, v25, v92
    v_add_f32 v26, v26, v89
    v_add_f32 v27, v27, v93
    v_add_f32 v28, v28, v90
    v_add_f32 v29, v29, v94
    v_add_f32 v30, v30, v91
    v_add_f32 v31, v31, v95
L_p2_kernel_q_24:
    s_bitcmp1_b32 s20, 22
    s_cbranch_scc0 L_p2_kernel_q_25
    s_lshl_b32 s15, s26, 1
    s_add_u32 s15, s15, 274792448
    buffer_load_dwordx4 v[88:91], v32, s[4:7], s15 offen sc1
    buffer_load_dwordx4 v[92:95], v32, s[4:7], s15 offen offset:16 sc1
    s_waitcnt vmcnt(0)
    v_add_f32 v24, v24, v88
    v_add_f32 v25, v25, v92
    v_add_f32 v26, v26, v89
    v_add_f32 v27, v27, v93
    v_add_f32 v28, v28, v90
    v_add_f32 v29, v29, v94
    v_add_f32 v30, v30, v91
    v_add_f32 v31, v31, v95
L_p2_kernel_q_25:
    s_bitcmp1_b32 s20, 23
    s_cbranch_scc0 L_p2_kernel_q_26
    s_lshl_b32 s15, s26, 1
    s_add_u32 s15, s15, 285032448
    buffer_load_dwordx4 v[88:91], v32, s[4:7], s15 offen sc1
    buffer_load_dwordx4 v[92:95], v32, s[4:7], s15 offen offset:16 sc1
    s_waitcnt vmcnt(0)
    v_add_f32 v24, v24, v88
    v_add_f32 v25, v25, v92
    v_add_f32 v26, v26, v89
    v_add_f32 v27, v27, v93
    v_add_f32 v28, v28, v90
    v_add_f32 v29, v29, v94
    v_add_f32 v30, v30, v91
    v_add_f32 v31, v31, v95
L_p2_kernel_q_26:
L_p2_kernel_nof32b_22:
    v_pk_mul_f32 v[88:89], v[24:25], s[84:85] op_sel:[0,0] op_sel_hi:[1,0]
    v_pk_mul_f32 v[90:91], v[24:25], s[84:85] op_sel:[0,1] op_sel_hi:[1,1]
    v_pk_mul_f32 v[92:93], v[24:25], s[86:87] op_sel:[0,0] op_sel_hi:[1,0]
    v_pk_mul_f32 v[94:95], v[24:25], s[86:87] op_sel:[0,1] op_sel_hi:[1,1]
    v_pk_fma_f32 v[88:89], v[26:27], s[88:89], v[88:89] op_sel:[0,0,0] op_sel_hi:[1,0,1]
    v_pk_fma_f32 v[90:91], v[26:27], s[88:89], v[90:91] op_sel:[0,1,0] op_sel_hi:[1,1,1]
    v_pk_fma_f32 v[92:93], v[26:27], s[90:91], v[92:93] op_sel:[0,0,0] op_sel_hi:[1,0,1]
    v_pk_fma_f32 v[94:95], v[26:27], s[90:91], v[94:95] op_sel:[0,1,0] op_sel_hi:[1,1,1]
    v_pk_fma_f32 v[88:89], v[28:29], s[92:93], v[88:89] op_sel:[0,0,0] op_sel_hi:[1,0,1]
    v_pk_fma_f32 v[90:91], v[28:29], s[92:93], v[90:91] op_sel:[0,1,0] op_sel_hi:[1,1,1]
    v_pk_fma_f32 v[92:93], v[28:29], s[94:95], v[92:93] op_sel:[0,0,0] op_sel_hi:[1,0,1]
    v_pk_fma_f32 v[94:95], v[28:29], s[94:95], v[94:95] op_sel:[0,1,0] op_sel_hi:[1,1,1]
    v_pk_fma_f32 v[88:89], v[30:31], s[96:97], v[88:89] op_sel:[0,0,0] op_sel_hi:[1,0,1]
    v_pk_fma_f32 v[90:91], v[30:31], s[96:97], v[90:91] op_sel:[0,1,0] op_sel_hi:[1,1,1]
    v_pk_fma_f32 v[92:93], v[30:31], s[98:99], v[92:93] op_sel:[0,0,0] op_sel_hi:[1,0,1]
    v_pk_fma_f32 v[94:95], v[30:31], s[98:99], v[94:95] op_sel:[0,1,0] op_sel_hi:[1,1,1]
    v_pk_mul_f32 v[88:89], v[88:89], v[112:113]
    v_pk_mul_f32 v[90:91], v[90:91], v[114:115]
    v_pk_mul_f32 v[92:93], v[92:93], v[116:117]
    v_pk_mul_f32 v[94:95], v[94:95], v[118:119]
    v_pk_mul_f32 v[24:25], v[88:89], s[28:29] op_sel:[0,0] op_sel_hi:[1,0]
    v_pk_mul_f32 v[26:27], v[88:89], s[28:29] op_sel:[0,1] op_sel_hi:[1,1]
    v_pk_mul_f32 v[28:29], v[88:89], s[30:31] op_sel:[0,0] op_sel_hi:[1,0]
    v_pk_mul_f32 v[30:31], v[88:89], s[30:31] op_sel:[0,1] op_sel_hi:[1,1]
    v_pk_fma_f32 v[24:25], v[90:91], s[32:33], v[24:25] op_sel:[0,0,0] op_sel_hi:[1,0,1]
    v_pk_fma_f32 v[26:27], v[90:91], s[32:33], v[26:27] op_sel:[0,1,0] op_sel_hi:[1,1,1]
    v_pk_fma_f32 v[28:29], v[90:91], s[34:35], v[28:29] op_sel:[0,0,0] op_sel_hi:[1,0,1]
    v_pk_fma_f32 v[30:31], v[90:91], s[34:35], v[30:31] op_sel:[0,1,0] op_sel_hi:[1,1,1]
    v_pk_fma_f32 v[24:25], v[92:93], s[36:37], v[24:25] op_sel:[0,0,0] op_sel_hi:[1,0,1]
    v_pk_fma_f32 v[26:27], v[92:93], s[36:37], v[26:27] op_sel:[0,1,0] op_sel_hi:[1,1,1]
    v_pk_fma_f32 v[28:29], v[92:93], s[38:39], v[28:29] op_sel:[0,0,0] op_sel_hi:[1,0,1]
    v_pk_fma_f32 v[30:31], v[92:93], s[38:39], v[30:31] op_sel:[0,1,0] op_sel_hi:[1,1,1]
    v_pk_fma_f32 v[24:25], v[94:95], s[40:41], v[24:25] op_sel:[0,0,0] op_sel_hi:[1,0,1]
    v_pk_fma_f32 v[26:27], v[94:95], s[40:41], v[26:27] op_sel:[0,1,0] op_sel_hi:[1,1,1]
    v_pk_fma_f32 v[28:29], v[94:95], s[42:43], v[28:29] op_sel:[0,0,0] op_sel_hi:[1,0,1]
    v_pk_fma_f32 v[30:31], v[94:95], s[42:43], v[30:31] op_sel:[0,1,0] op_sel_hi:[1,1,1]
    v_lshlrev_b32 v88, 16, v68
    v_and_b32 v90, 0xffff0000, v68
    v_lshlrev_b32 v92, 16, v69
    v_and_b32 v94, 0xffff0000, v69
    v_lshlrev_b32 v89, 16, v70
    v_and_b32 v91, 0xffff0000, v70
    v_lshlrev_b32 v93, 16, v71
    v_and_b32 v95, 0xffff0000, v71
    v_pk_fma_f32 v[88:89], v[24:25], v[120:121], v[88:89]
    v_pk_fma_f32 v[90:91], v[26:27], v[122:123], v[90:91]
    v_pk_fma_f32 v[92:93], v[28:29], v[124:125], v[92:93]
    v_pk_fma_f32 v[94:95], v[30:31], v[126:127], v[94:95]
    v_cvt_pk_bf16_f32 v96, v88, v90
    v_cvt_pk_bf16_f32 v97, v92, v94
    v_cvt_pk_bf16_f32 v98, v89, v91
    v_cvt_pk_bf16_f32 v99, v93, v95
    buffer_store_dwordx4 v[96:99], v2, s[16:19], s26 offen
L_p2_f1:
    s_bitset0_b32 s51, s49
    s_cmp_eq_u32 s51, 0
    s_cbranch_scc1 L_p2_done
    s_ff1_i32_b32 s49, s51
    s_lshl2_add_u32 s14, s3, s49
    s_mul_i32 s14, s14, 5000
    s_add_u32 s15, s14, 4096
    v_min_u32 v61, 225, v0
    v_lshl_add_u32 v60, v0, 2, s14
    v_lshl_add_u32 v61, v61, 2, s15
    global_load_dword v60, v60, s[100:101] nt
    global_load_dword v61, v61, s[100:101] nt
    s_waitcnt vmcnt(0)
    v_lshlrev_b32 v30, 16, v60
    v_and_b32 v31, 0xffff0000, v60
    v_lshlrev_b32 v36, 16, v53
    v_and_b32 v37, 0xffff0000, v53
    v_lshlrev_b32 v38, 16, v54
    v_and_b32 v39, 0xffff0000, v54
    v_lshlrev_b32 v40, 16, v56
    v_and_b32 v41, 0xffff0000, v56
    v_lshlrev_b32 v42, 16, v57
    v_and_b32 v43, 0xffff0000, v57
    v_pk_add_f32 v[14:15], v[30:31], v[36:37] op_sel:[0,0] op_sel_hi:[1,0] neg_lo:[0,1] neg_hi:[0,1]
    v_pk_add_f32 v[16:17], v[30:31], v[36:37] op_sel:[0,1] op_sel_hi:[1,1] neg_lo:[0,1] neg_hi:[0,1]
    v_pk_add_f32 v[18:19], v[30:31], v[38:39] op_sel:[0,0] op_sel_hi:[1,0] neg_lo:[0,1] neg_hi:[0,1]
    v_pk_add_f32 v[20:21], v[30:31], v[38:39] op_sel:[0,1] op_sel_hi:[1,1] neg_lo:[0,1] neg_hi:[0,1]
    v_pk_add_f32 v[22:23], v[30:31], v[40:41] op_sel:[0,0] op_sel_hi:[1,0] neg_lo:[0,1] neg_hi:[0,1]
    v_pk_add_f32 v[24:25], v[30:31], v[40:41] op_sel:[0,1] op_sel_hi:[1,1] neg_lo:[0,1] neg_hi:[0,1]
    v_pk_add_f32 v[26:27], v[30:31], v[42:43] op_sel:[0,0] op_sel_hi:[1,0] neg_lo:[0,1] neg_hi:[0,1]
    v_pk_add_f32 v[28:29], v[30:31], v[42:43] op_sel:[0,1] op_sel_hi:[1,1] neg_lo:[0,1] neg_hi:[0,1]
    v_cvt_pk_bf16_f32 v32, v14, v15
    v_lshlrev_b32 v14, 16, v32
    v_and_b32 v15, 0xffff0000, v32
    v_cvt_pk_bf16_f32 v32, v16, v17
    v_lshlrev_b32 v16, 16, v32
    v_and_b32 v17, 0xffff0000, v32
    v_cvt_pk_bf16_f32 v32, v18, v19
    v_lshlrev_b32 v18, 16, v32
    v_and_b32 v19, 0xffff0000, v32
    v_cvt_pk_bf16_f32 v32, v20, v21
    v_lshlrev_b32 v20, 16, v32
    v_and_b32 v21, 0xffff0000, v32
    v_cvt_pk_bf16_f32 v32, v22, v23
    v_lshlrev_b32 v22, 16, v32
    v_and_b32 v23, 0xffff0000, v32
    v_cvt_pk_bf16_f32 v32, v24, v25
    v_lshlrev_b32 v24, 16, v32
    v_and_b32 v25, 0xffff0000, v32
    v_cvt_pk_bf16_f32 v32, v26, v27
    v_lshlrev_b32 v26, 16, v32
    v_and_b32 v27, 0xffff0000, v32
    v_cvt_pk_bf16_f32 v32, v28, v29
    v_lshlrev_b32 v28, 16, v32
    v_and_b32 v29, 0xffff0000, v32
    v_pk_mul_f32 v[14:15], v[14:15], v[14:15]
    v_pk_mul_f32 v[16:17], v[16:17], v[16:17]
    v_pk_mul_f32 v[18:19], v[18:19], v[18:19]
    v_pk_mul_f32 v[20:21], v[20:21], v[20:21]
    v_pk_mul_f32 v[22:23], v[22:23], v[22:23]
    v_pk_mul_f32 v[24:25], v[24:25], v[24:25]
    v_pk_mul_f32 v[26:27], v[26:27], v[26:27]
    v_pk_mul_f32 v[28:29], v[28:29], v[28:29]
    v_cvt_pk_bf16_f32 v32, v14, v15
    v_lshlrev_b32 v14, 16, v32
    v_and_b32 v15, 0xffff0000, v32
    v_cvt_pk_bf16_f32 v32, v16, v17
    v_lshlrev_b32 v16, 16, v32
    v_and_b32 v17, 0xffff0000, v32
    v_cvt_pk_bf16_f32 v32, v18, v19
    v_lshlrev_b32 v18, 16, v32
    v_and_b32 v19, 0xffff0000, v32
    v_cvt_pk_bf16_f32 v32, v20, v21
    v_lshlrev_b32 v20, 16, v32
    v_and_b32 v21, 0xffff0000, v32
    v_cvt_pk_bf16_f32 v32, v22, v23
    v_lshlrev_b32 v22, 16, v32
    v_and_b32 v23, 0xffff0000, v32
    v_cvt_pk_bf16_f32 v32, v24, v25
    v_lshlrev_b32 v24, 16, v32
    v_and_b32 v25, 0xffff0000, v32
    v_cvt_pk_bf16_f32 v32, v26, v27
    v_lshlrev_b32 v26, 16, v32
    v_and_b32 v27, 0xffff0000, v32
    v_cvt_pk_bf16_f32 v32, v28, v29
    v_lshlrev_b32 v28, 16, v32
    v_and_b32 v29, 0xffff0000, v32
    v_mov_b32 v30, 1092616192
    v_mov_b32 v31, 0x3fb8aa3b
    v_pk_mul_f32 v[14:15], v[14:15], v[30:31] op_sel:[0,0] op_sel_hi:[1,0]
    v_pk_mul_f32 v[16:17], v[16:17], v[30:31] op_sel:[0,0] op_sel_hi:[1,0]
    v_pk_mul_f32 v[18:19], v[18:19], v[30:31] op_sel:[0,0] op_sel_hi:[1,0]
    v_pk_mul_f32 v[20:21], v[20:21], v[30:31] op_sel:[0,0] op_sel_hi:[1,0]
    v_pk_mul_f32 v[22:23], v[22:23], v[30:31] op_sel:[0,0] op_sel_hi:[1,0]
    v_pk_mul_f32 v[24:25], v[24:25], v[30:31] op_sel:[0,0] op_sel_hi:[1,0]
    v_pk_mul_f32 v[26:27], v[26:27], v[30:31] op_sel:[0,0] op_sel_hi:[1,0]
    v_pk_mul_f32 v[28:29], v[28:29], v[30:31] op_sel:[0,0] op_sel_hi:[1,0]
    v_cvt_pk_bf16_f32 v32, v14, v15
    v_lshlrev_b32 v14, 16, v32
    v_and_b32 v15, 0xffff0000, v32
    v_cvt_pk_bf16_f32 v32, v16, v17
    v_lshlrev_b32 v16, 16, v32
    v_and_b32 v17, 0xffff0000, v32
    v_cvt_pk_bf16_f32 v32, v18, v19
    v_lshlrev_b32 v18, 16, v32
    v_and_b32 v19, 0xffff0000, v32
    v_cvt_pk_bf16_f32 v32, v20, v21
    v_lshlrev_b32 v20, 16, v32
    v_and_b32 v21, 0xffff0000, v32
    v_cvt_pk_bf16_f32 v32, v22, v23
    v_lshlrev_b32 v22, 16, v32
    v_and_b32 v23, 0xffff0000, v32
    v_cvt_pk_bf16_f32 v32, v24, v25
    v_lshlrev_b32 v24, 16, v32
    v_and_b32 v25, 0xffff0000, v32
    v_cvt_pk_bf16_f32 v32, v26, v27
    v_lshlrev_b32 v26, 16, v32
    v_and_b32 v27, 0xffff0000, v32
    v_cvt_pk_bf16_f32 v32, v28, v29
    v_lshlrev_b32 v28, 16, v32
    v_and_b32 v29, 0xffff0000, v32
    v_pk_mul_f32 v[14:15], v[14:15], v[30:31] op_sel:[0,1] op_sel_hi:[1,1]
    v_pk_mul_f32 v[16:17], v[16:17], v[30:31] op_sel:[0,1] op_sel_hi:[1,1]
    v_pk_mul_f32 v[18:19], v[18:19], v[30:31] op_sel:[0,1] op_sel_hi:[1,1]
    v_pk_mul_f32 v[20:21], v[20:21], v[30:31] op_sel:[0,1] op_sel_hi:[1,1]
    v_pk_mul_f32 v[22:23], v[22:23], v[30:31] op_sel:[0,1] op_sel_hi:[1,1]
    v_pk_mul_f32 v[24:25], v[24:25], v[30:31] op_sel:[0,1] op_sel_hi:[1,1]
    v_pk_mul_f32 v[26:27], v[26:27], v[30:31] op_sel:[0,1] op_sel_hi:[1,1]
    v_pk_mul_f32 v[28:29], v[28:29], v[30:31] op_sel:[0,1] op_sel_hi:[1,1]
    v_exp_f32 v14, -v14
    v_exp_f32 v15, -v15
    v_exp_f32 v16, -v16
    v_exp_f32 v17, -v17
    v_exp_f32 v18, -v18
    v_exp_f32 v19, -v19
    v_exp_f32 v20, -v20
    v_exp_f32 v21, -v21
    v_exp_f32 v22, -v22
    v_exp_f32 v23, -v23
    v_exp_f32 v24, -v24
    v_exp_f32 v25, -v25
    v_exp_f32 v26, -v26
    v_exp_f32 v27, -v27
    v_exp_f32 v28, -v28
    v_exp_f32 v29, -v29
    v_cvt_pk_bf16_f32 v14, v14, v16
    v_cvt_pk_bf16_f32 v15, v15, v17
    v_cvt_pk_bf16_f32 v18, v18, v20
    v_cvt_pk_bf16_f32 v19, v19, v21
    v_cvt_pk_bf16_f32 v22, v22, v24
    v_cvt_pk_bf16_f32 v23, v23, v25
    v_cvt_pk_bf16_f32 v26, v26, v28
    v_cvt_pk_bf16_f32 v27, v27, v29
    v_dot2_f32_bf16 v72, v14, s68, 0
    v_dot2_f32_bf16 v73, v15, s68, 0
    v_dot2_f32_bf16 v74, v14, s69, 0
    v_dot2_f32_bf16 v75, v15, s69, 0
    v_dot2_f32_bf16 v76, v14, s70, 0
    v_dot2_f32_bf16 v77, v15, s70, 0
    v_dot2_f32_bf16 v78, v14, s71, 0
    v_dot2_f32_bf16 v79, v15, s71, 0
    v_dot2_f32_bf16 v80, v14, s52, 0
    v_dot2_f32_bf16 v81, v15, s52, 0
    v_dot2_f32_bf16 v82, v14, s53, 0
    v_dot2_f32_bf16 v83, v15, s53, 0
    v_dot2_f32_bf16 v84, v14, s54, 0
    v_dot2_f32_bf16 v85, v15, s54, 0
    v_dot2_f32_bf16 v86, v14, s55, 0
    v_dot2_f32_bf16 v87, v15, s55, 0
    v_dot2_f32_bf16 v72, v18, s72, v72
    v_dot2_f32_bf16 v73, v19, s72, v73
    v_dot2_f32_bf16 v74, v18, s73, v74
    v_dot2_f32_bf16 v75, v19, s73, v75
    v_dot2_f32_bf16 v76, v18, s74, v76
    v_dot2_f32_bf16 v77, v19, s74, v77
    v_dot2_f32_bf16 v78, v18, s75, v78
    v_dot2_f32_bf16 v79, v19, s75, v79
    v_dot2_f32_bf16 v80, v18, s56, v80
    v_dot2_f32_bf16 v81, v19, s56, v81
    v_dot2_f32_bf16 v82, v18, s57, v82
    v_dot2_f32_bf16 v83, v19, s57, v83
    v_dot2_f32_bf16 v84, v18, s58, v84
    v_dot2_f32_bf16 v85, v19, s58, v85
    v_dot2_f32_bf16 v86, v18, s59, v86
    v_dot2_f32_bf16 v87, v19, s59, v87
    v_dot2_f32_bf16 v72, v22, s76, v72
    v_dot2_f32_bf16 v73, v23, s76, v73
    v_dot2_f32_bf16 v74, v22, s77, v74
    v_dot2_f32_bf16 v75, v23, s77, v75
    v_dot2_f32_bf16 v76, v22, s78, v76
    v_dot2_f32_bf16 v77, v23, s78, v77
    v_dot2_f32_bf16 v78, v22, s79, v78
    v_dot2_f32_bf16 v79, v23, s79, v79
    v_dot2_f32_bf16 v80, v22, s60, v80
    v_dot2_f32_bf16 v81, v23, s60, v81
    v_dot2_f32_bf16 v82, v22, s61, v82
    v_dot2_f32_bf16 v83, v23, s61, v83
    v_dot2_f32_bf16 v84, v22, s62, v84
    v_dot2_f32_bf16 v85, v23, s62, v85
    v_dot2_f32_bf16 v86, v22, s63, v86
    v_dot2_f32_bf16 v87, v23, s63, v87
    v_dot2_f32_bf16 v72, v26, s80, v72
    v_dot2_f32_bf16 v73, v27, s80, v73
    v_dot2_f32_bf16 v74, v26, s81, v74
    v_dot2_f32_bf16 v75, v27, s81, v75
    v_dot2_f32_bf16 v76, v26, s82, v76
    v_dot2_f32_bf16 v77, v27, s82, v77
    v_dot2_f32_bf16 v78, v26, s83, v78
    v_dot2_f32_bf16 v79, v27, s83, v79
    v_dot2_f32_bf16 v80, v26, s64, v80
    v_dot2_f32_bf16 v81, v27, s64, v81
    v_dot2_f32_bf16 v82, v26, s65, v82
    v_dot2_f32_bf16 v83, v27, s65, v83
    v_dot2_f32_bf16 v84, v26, s66, v84
    v_dot2_f32_bf16 v85, v27, s66, v85
    v_dot2_f32_bf16 v86, v26, s67, v86
    v_dot2_f32_bf16 v87, v27, s67, v87
    s_cmp_ge_u32 s13, 4
    s_cbranch_scc1 L_p2_kernel_g1_27
    v_lshlrev_b32 v30, 16, v61
    v_and_b32 v31, 0xffff0000, v61
    v_pk_add_f32 v[14:15], v[30:31], v[36:37] op_sel:[0,0] op_sel_hi:[1,0] neg_lo:[0,1] neg_hi:[0,1]
    v_pk_add_f32 v[16:17], v[30:31], v[36:37] op_sel:[0,1] op_sel_hi:[1,1] neg_lo:[0,1] neg_hi:[0,1]
    v_pk_add_f32 v[18:19], v[30:31], v[38:39] op_sel:[0,0] op_sel_hi:[1,0] neg_lo:[0,1] neg_hi:[0,1]
    v_pk_add_f32 v[20:21], v[30:31], v[38:39] op_sel:[0,1] op_sel_hi:[1,1] neg_lo:[0,1] neg_hi:[0,1]
    v_pk_add_f32 v[22:23], v[30:31], v[40:41] op_sel:[0,0] op_sel_hi:[1,0] neg_lo:[0,1] neg_hi:[0,1]
    v_pk_add_f32 v[24:25], v[30:31], v[40:41] op_sel:[0,1] op_sel_hi:[1,1] neg_lo:[0,1] neg_hi:[0,1]
    v_pk_add_f32 v[26:27], v[30:31], v[42:43] op_sel:[0,0] op_sel_hi:[1,0] neg_lo:[0,1] neg_hi:[0,1]
    v_pk_add_f32 v[28:29], v[30:31], v[42:43] op_sel:[0,1] op_sel_hi:[1,1] neg_lo:[0,1] neg_hi:[0,1]
    v_cvt_pk_bf16_f32 v32, v14, v15
    v_lshlrev_b32 v14, 16, v32
    v_and_b32 v15, 0xffff0000, v32
    v_cvt_pk_bf16_f32 v32, v16, v17
    v_lshlrev_b32 v16, 16, v32
    v_and_b32 v17, 0xffff0000, v32
    v_cvt_pk_bf16_f32 v32, v18, v19
    v_lshlrev_b32 v18, 16, v32
    v_and_b32 v19, 0xffff0000, v32
    v_cvt_pk_bf16_f32 v32, v20, v21
    v_lshlrev_b32 v20, 16, v32
    v_and_b32 v21, 0xffff0000, v32
    v_cvt_pk_bf16_f32 v32, v22, v23
    v_lshlrev_b32 v22, 16, v32
    v_and_b32 v23, 0xffff0000, v32
    v_cvt_pk_bf16_f32 v32, v24, v25
    v_lshlrev_b32 v24, 16, v32
    v_and_b32 v25, 0xffff0000, v32
    v_cvt_pk_bf16_f32 v32, v26, v27
    v_lshlrev_b32 v26, 16, v32
    v_and_b32 v27, 0xffff0000, v32
    v_cvt_pk_bf16_f32 v32, v28, v29
    v_lshlrev_b32 v28, 16, v32
    v_and_b32 v29, 0xffff0000, v32
    v_pk_mul_f32 v[14:15], v[14:15], v[14:15]
    v_pk_mul_f32 v[16:17], v[16:17], v[16:17]
    v_pk_mul_f32 v[18:19], v[18:19], v[18:19]
    v_pk_mul_f32 v[20:21], v[20:21], v[20:21]
    v_pk_mul_f32 v[22:23], v[22:23], v[22:23]
    v_pk_mul_f32 v[24:25], v[24:25], v[24:25]
    v_pk_mul_f32 v[26:27], v[26:27], v[26:27]
    v_pk_mul_f32 v[28:29], v[28:29], v[28:29]
    v_cvt_pk_bf16_f32 v32, v14, v15
    v_lshlrev_b32 v14, 16, v32
    v_and_b32 v15, 0xffff0000, v32
    v_cvt_pk_bf16_f32 v32, v16, v17
    v_lshlrev_b32 v16, 16, v32
    v_and_b32 v17, 0xffff0000, v32
    v_cvt_pk_bf16_f32 v32, v18, v19
    v_lshlrev_b32 v18, 16, v32
    v_and_b32 v19, 0xffff0000, v32
    v_cvt_pk_bf16_f32 v32, v20, v21
    v_lshlrev_b32 v20, 16, v32
    v_and_b32 v21, 0xffff0000, v32
    v_cvt_pk_bf16_f32 v32, v22, v23
    v_lshlrev_b32 v22, 16, v32
    v_and_b32 v23, 0xffff0000, v32
    v_cvt_pk_bf16_f32 v32, v24, v25
    v_lshlrev_b32 v24, 16, v32
    v_and_b32 v25, 0xffff0000, v32
    v_cvt_pk_bf16_f32 v32, v26, v27
    v_lshlrev_b32 v26, 16, v32
    v_and_b32 v27, 0xffff0000, v32
    v_cvt_pk_bf16_f32 v32, v28, v29
    v_lshlrev_b32 v28, 16, v32
    v_and_b32 v29, 0xffff0000, v32
    v_mov_b32 v30, 1092616192
    v_mov_b32 v31, 0x3fb8aa3b
    v_pk_mul_f32 v[14:15], v[14:15], v[30:31] op_sel:[0,0] op_sel_hi:[1,0]
    v_pk_mul_f32 v[16:17], v[16:17], v[30:31] op_sel:[0,0] op_sel_hi:[1,0]
    v_pk_mul_f32 v[18:19], v[18:19], v[30:31] op_sel:[0,0] op_sel_hi:[1,0]
    v_pk_mul_f32 v[20:21], v[20:21], v[30:31] op_sel:[0,0] op_sel_hi:[1,0]
    v_pk_mul_f32 v[22:23], v[22:23], v[30:31] op_sel:[0,0] op_sel_hi:[1,0]
    v_pk_mul_f32 v[24:25], v[24:25], v[30:31] op_sel:[0,0] op_sel_hi:[1,0]
    v_pk_mul_f32 v[26:27], v[26:27], v[30:31] op_sel:[0,0] op_sel_hi:[1,0]
    v_pk_mul_f32 v[28:29], v[28:29], v[30:31] op_sel:[0,0] op_sel_hi:[1,0]
    v_cvt_pk_bf16_f32 v32, v14, v15
    v_lshlrev_b32 v14, 16, v32
    v_and_b32 v15, 0xffff0000, v32
    v_cvt_pk_bf16_f32 v32, v16, v17
    v_lshlrev_b32 v16, 16, v32
    v_and_b32 v17, 0xffff0000, v32
    v_cvt_pk_bf16_f32 v32, v18, v19
    v_lshlrev_b32 v18, 16, v32
    v_and_b32 v19, 0xffff0000, v32
    v_cvt_pk_bf16_f32 v32, v20, v21
    v_lshlrev_b32 v20, 16, v32
    v_and_b32 v21, 0xffff0000, v32
    v_cvt_pk_bf16_f32 v32, v22, v23
    v_lshlrev_b32 v22, 16, v32
    v_and_b32 v23, 0xffff0000, v32
    v_cvt_pk_bf16_f32 v32, v24, v25
    v_lshlrev_b32 v24, 16, v32
    v_and_b32 v25, 0xffff0000, v32
    v_cvt_pk_bf16_f32 v32, v26, v27
    v_lshlrev_b32 v26, 16, v32
    v_and_b32 v27, 0xffff0000, v32
    v_cvt_pk_bf16_f32 v32, v28, v29
    v_lshlrev_b32 v28, 16, v32
    v_and_b32 v29, 0xffff0000, v32
    v_pk_mul_f32 v[14:15], v[14:15], v[30:31] op_sel:[0,1] op_sel_hi:[1,1]
    v_pk_mul_f32 v[16:17], v[16:17], v[30:31] op_sel:[0,1] op_sel_hi:[1,1]
    v_pk_mul_f32 v[18:19], v[18:19], v[30:31] op_sel:[0,1] op_sel_hi:[1,1]
    v_pk_mul_f32 v[20:21], v[20:21], v[30:31] op_sel:[0,1] op_sel_hi:[1,1]
    v_pk_mul_f32 v[22:23], v[22:23], v[30:31] op_sel:[0,1] op_sel_hi:[1,1]
    v_pk_mul_f32 v[24:25], v[24:25], v[30:31] op_sel:[0,1] op_sel_hi:[1,1]
    v_pk_mul_f32 v[26:27], v[26:27], v[30:31] op_sel:[0,1] op_sel_hi:[1,1]
    v_pk_mul_f32 v[28:29], v[28:29], v[30:31] op_sel:[0,1] op_sel_hi:[1,1]
    v_exp_f32 v14, -v14
    v_exp_f32 v15, -v15
    v_exp_f32 v16, -v16
    v_exp_f32 v17, -v17
    v_exp_f32 v18, -v18
    v_exp_f32 v19, -v19
    v_exp_f32 v20, -v20
    v_exp_f32 v21, -v21
    v_exp_f32 v22, -v22
    v_exp_f32 v23, -v23
    v_exp_f32 v24, -v24
    v_exp_f32 v25, -v25
    v_exp_f32 v26, -v26
    v_exp_f32 v27, -v27
    v_exp_f32 v28, -v28
    v_exp_f32 v29, -v29
    v_cvt_pk_bf16_f32 v14, v14, v16
    v_cvt_pk_bf16_f32 v15, v15, v17
    v_cvt_pk_bf16_f32 v18, v18, v20
    v_cvt_pk_bf16_f32 v19, v19, v21
    v_cvt_pk_bf16_f32 v22, v22, v24
    v_cvt_pk_bf16_f32 v23, v23, v25
    v_cvt_pk_bf16_f32 v26, v26, v28
    v_cvt_pk_bf16_f32 v27, v27, v29
    v_dot2_f32_bf16 v112, v14, s68, 0
    v_dot2_f32_bf16 v113, v15, s68, 0
    v_dot2_f32_bf16 v114, v14, s69, 0
    v_dot2_f32_bf16 v115, v15, s69, 0
    v_dot2_f32_bf16 v116, v14, s70, 0
    v_dot2_f32_bf16 v117, v15, s70, 0
    v_dot2_f32_bf16 v118, v14, s71, 0
    v_dot2_f32_bf16 v119, v15, s71, 0
    v_dot2_f32_bf16 v120, v14, s52, 0
    v_dot2_f32_bf16 v121, v15, s52, 0
    v_dot2_f32_bf16 v122, v14, s53, 0
    v_dot2_f32_bf16 v123, v15, s53, 0
    v_dot2_f32_bf16 v124, v14, s54, 0
    v_dot2_f32_bf16 v125, v15, s54, 0
    v_dot2_f32_bf16 v126, v14, s55, 0
    v_dot2_f32_bf16 v127, v15, s55, 0
    v_dot2_f32_bf16 v112, v18, s72, v112
    v_dot2_f32_bf16 v113, v19, s72, v113
    v_dot2_f32_bf16 v114, v18, s73, v114
    v_dot2_f32_bf16 v115, v19, s73, v115
    v_dot2_f32_bf16 v116, v18, s74, v116
    v_dot2_f32_bf16 v117, v19, s74, v117
    v_dot2_f32_bf16 v118, v18, s75, v118
    v_dot2_f32_bf16 v119, v19, s75, v119
    v_dot2_f32_bf16 v120, v18, s56, v120
    v_dot2_f32_bf16 v121, v19, s56, v121
    v_dot2_f32_bf16 v122, v18, s57, v122
    v_dot2_f32_bf16 v123, v19, s57, v123
    v_dot2_f32_bf16 v124, v18, s58, v124
    v_dot2_f32_bf16 v125, v19, s58, v125
    v_dot2_f32_bf16 v126, v18, s59, v126
    v_dot2_f32_bf16 v127, v19, s59, v127
    v_dot2_f32_bf16 v112, v22, s76, v112
    v_dot2_f32_bf16 v113, v23, s76, v113
    v_dot2_f32_bf16 v114, v22, s77, v114
    v_dot2_f32_bf16 v115, v23, s77, v115
    v_dot2_f32_bf16 v116, v22, s78, v116
    v_dot2_f32_bf16 v117, v23, s78, v117
    v_dot2_f32_bf16 v118, v22, s79, v118
    v_dot2_f32_bf16 v119, v23, s79, v119
    v_dot2_f32_bf16 v120, v22, s60, v120
    v_dot2_f32_bf16 v121, v23, s60, v121
    v_dot2_f32_bf16 v122, v22, s61, v122
    v_dot2_f32_bf16 v123, v23, s61, v123
    v_dot2_f32_bf16 v124, v22, s62, v124
    v_dot2_f32_bf16 v125, v23, s62, v125
    v_dot2_f32_bf16 v126, v22, s63, v126
    v_dot2_f32_bf16 v127, v23, s63, v127
    v_dot2_f32_bf16 v112, v26, s80, v112
    v_dot2_f32_bf16 v113, v27, s80, v113
    v_dot2_f32_bf16 v114, v26, s81, v114
    v_dot2_f32_bf16 v115, v27, s81, v115
    v_dot2_f32_bf16 v116, v26, s82, v116
    v_dot2_f32_bf16 v117, v27, s82, v117
    v_dot2_f32_bf16 v118, v26, s83, v118
    v_dot2_f32_bf16 v119, v27, s83, v119
    v_dot2_f32_bf16 v120, v26, s64, v120
    v_dot2_f32_bf16 v121, v27, s64, v121
    v_dot2_f32_bf16 v122, v26, s65, v122
    v_dot2_f32_bf16 v123, v27, s65, v123
    v_dot2_f32_bf16 v124, v26, s66, v124
    v_dot2_f32_bf16 v125, v27, s66, v125
    v_dot2_f32_bf16 v126, v26, s67, v126
    v_dot2_f32_bf16 v127, v27, s67, v127
L_p2_kernel_g1_27:
    s_lshl2_add_u32 s14, s3, s49
    s_mul_i32 s26, s14, 20000
    s_add_u32 s15, s26, 8573440
    buffer_load_dwordx4 v[64:67], v1, s[4:7], s15 offen
    buffer_load_dwordx4 v[68:71], v2, s[4:7], s15 offen
    s_branch L_p2_fin
L_p2_done:
    s_branch L_p2_end
L_p2_slow:
    s_barrier
    v_mov_b32 v8, 0
    v_mov_b32 v9, 0
    v_mov_b32 v10, 0
    v_mov_b32 v11, 0
    v_mov_b32 v12, v1
    ds_write_b128 v12, v[8:11]
    v_add_u32 v12, 16384, v12
    ds_write_b128 v12, v[8:11]
    v_add_u32 v12, 16384, v12
    ds_write_b128 v12, v[8:11]
    v_add_u32 v12, 16384, v12
    ds_write_b128 v12, v[8:11]
    v_add_u32 v12, 16384, v12
    ds_write_b128 v12, v[8:11]
    v_add_u32 v12, 16384, v12
    ds_write_b128 v12, v[8:11]
    v_add_u32 v12, 16384, v12
    ds_write_b128 v12, v[8:11]
    v_add_u32 v12, 16384, v12
    ds_write_b128 v12, v[8:11]
    v_add_u32 v12, 16384, v12
    ds_write_b128 v12, v[8:11]
    v_add_u32 v12, 16384, v12
    ds_write_b128 v12, v[8:11]
    v_add_u32 v12, 16384, v12
    v_lshlrev_b32 v13, 5, v0
    v_mov_b32 v29, 0x7fc00000
    v_add_u32 v28, 32896, v13
    v_lshlrev_b32 v14, 10, v0
    v_add_u32 v14, 14680064, v14
    s_mul_i32 s25, s12, 65
    s_add_u32 s25, s25, s3
    s_mul_i32 s25, s25, 32896
    s_add_u32 s25, s25, 0
    s_lshl_b32 s50, s50, 1
    s_mul_i32 s22, s12, 1280000
    s_mov_b32 s24, 0
    s_waitcnt lgkmcnt(0)
    s_barrier
L_p2_sstep:
    buffer_load_ushort v15, v13, s[4:7], s25 offen
    buffer_load_ushort v16, v28, s[4:7], s25 offen
    s_waitcnt vmcnt(0)
L_p2_srec:
    v_cmp_lt_u32 vcc, v15, v16
    s_nop 1
    s_and_b64 exec, exec, vcc
    s_cbranch_execz L_p2_sdone
    v_mul_u32_u24 v17, 43691, v15
    v_lshrrev_b32 v17, 17, v17
    v_mad_i32_i24 v18, v17, -3, v15
    v_lshrrev_b32 v19, 6, v17
    v_lshl_add_u32 v19, v19, 20, v14
    v_and_b32 v17, 63, v17
    v_lshl_add_u32 v17, v17, 4, v19
    v_lshl_add_u32 v19, v18, 2, v17
    buffer_load_dword v20, v19, s[4:7], 0 offen
    buffer_load_dword v21, v17, s[4:7], 0 offen offset:12
    v_add_u32 v15, 1, v15
    v_mad_u32_u24 v18, v18, 10, 2
    s_waitcnt vmcnt(0)
    v_lshlrev_b32_sdwa v19, 3, v20 dst_sel:DWORD dst_unused:UNUSED_PAD src0_sel:DWORD src1_sel:WORD_0
    buffer_load_dwordx2 v[22:23], v19, s[8:11], s22 offen
    v_mad_u32_u16 v20, v20, 16, s50 op_sel:[1,0,0,0]
    v_bfe_i32 v21, v21, v18, 10
    v_cmp_eq_i32 vcc, -512, v21
    v_cvt_f32_i32 v21, v21
    v_mul_f32 v21, 989872160, v21
    v_cndmask_b32 v21, v21, v29, vcc
    s_waitcnt vmcnt(0)
    v_lshlrev_b32 v24, 16, v22
    v_and_b32 v25, 0xffff0000, v22
    v_lshlrev_b32 v26, 16, v23
    v_and_b32 v27, 0xffff0000, v23
    v_mul_f32 v24, v21, v24
    v_mul_f32 v25, v21, v25
    v_mul_f32 v26, v21, v26
    v_mul_f32 v27, v21, v27
    ds_add_f32 v20, v24
    ds_add_f32 v20, v25 offset:4
    ds_add_f32 v20, v26 offset:8
    ds_add_f32 v20, v27 offset:12
    s_branch L_p2_srec
L_p2_sdone:
    s_mov_b64 exec, -1
    s_cmp_eq_u32 s24, 7
    s_cselect_b32 s14, 2, 2
    s_add_u32 s25, s25, s14
    s_add_u32 s22, s22, 80000
    s_add_u32 s24, s24, 1
    s_cmp_lt_u32 s24, 16
    s_cbranch_scc1 L_p2_sstep
    s_waitcnt lgkmcnt(0)
    s_barrier
    s_mul_i32 s14, s12, 10240000
    s_mul_i32 s15, s3, 160000
    s_add_u32 s26, s14, s15
    s_add_u32 s26, s26, 254312448
    v_mov_b32 v12, v1
    s_mov_b32 s24, 0
L_p2_sout:
    v_cmp_gt_u32 vcc, 160000, v12
    ds_read_b128 v[8:11], v12
    s_nop 0
    s_and_b64 exec, exec, vcc
    s_cbranch_execz L_p2_sfin
    s_waitcnt lgkmcnt(0)
    buffer_store_dwordx4 v[8:11], v12, s[4:7], s26 offen sc1
    s_waitcnt vmcnt(0)
    v_add_u32 v12, 16384, v12
    s_branch L_p2_sout
L_p2_sfin:
    s_mov_b64 exec, -1
    s_waitcnt vmcnt(0) lgkmcnt(0)
    s_barrier
    s_branch L_p2_signal
L_p2_end:
    s_endpgm
.section .rodata,"a"
.p2align 6
.amdhsa_kernel p1_kernel
  .amdhsa_next_free_vgpr 128
  .amdhsa_next_free_sgpr 96
  .amdhsa_accum_offset 128
  .amdhsa_group_segment_fixed_size 0
  .amdhsa_kernarg_size 112
  .amdhsa_user_sgpr_count 2
  .amdhsa_user_sgpr_kernarg_segment_ptr 1
  .amdhsa_system_sgpr_workgroup_id_x 1
  .amdhsa_float_denorm_mode_32 0
.end_amdhsa_kernel
.p2align 6
.amdhsa_kernel p2_kernel
  .amdhsa_next_free_vgpr 128
  .amdhsa_next_free_sgpr 102
  .amdhsa_accum_offset 128
  .amdhsa_group_segment_fixed_size 0
  .amdhsa_kernarg_size 112
  .amdhsa_user_sgpr_count 2
  .amdhsa_user_sgpr_kernarg_segment_ptr 1
  .amdhsa_system_sgpr_workgroup_id_x 1
  .amdhsa_float_denorm_mode_32 0
.end_amdhsa_kernel
```

```asm
; @launch kernel=p1_kernel grid=(256,1,1) block=(1024,1,1) lds=163840
; @launch kernel=p2_kernel grid=(256,1,1) block=(1024,1,1) lds=163840
.amdgcn_target "amdgcn-amd-amdhsa--gfx950"
.text
.globl p1_kernel
.p2align 8
.type p1_kernel,@function
p1_kernel:
    s_cmp_ge_u32 s2, 256
    s_cbranch_scc1 L_p1_end
    s_load_dwordx2 s[4:5], s[0:1], 104
    s_load_dwordx2 s[8:9], s[0:1], 8
    s_load_dwordx2 s[12:13], s[0:1], 16
    s_load_dwordx2 s[16:17], s[0:1], 32
    s_load_dwordx2 s[28:29], s[0:1], 0
    s_load_dwordx2 s[6:7], s[0:1], 48
    v_lshlrev_b32 v1, 4, v0
    v_lshlrev_b32 v2, 3, v0
    v_lshrrev_b32 v6, 6, v0
    v_mul_u32_u24 v3, 851904, v6
    v_add_lshl_u32 v3, v3, v0, 4
    v_mov_b32 v4, 1
    v_mov_b32 v5, 0
    v_readfirstlane_b32 s39, v6
    v_cmp_gt_u32 vcc, 784, v0
    s_and_b32 s51, s2, 7
    s_lshl_b32 s51, s51, 0
    s_bfe_u32 s35, s2, 3
    s_add_u32 s51, s51, s35
    s_and_b32 s35, s2, 248
    s_add_u32 s51, s51, s35
    s_and_b32 s32, s2, 7
    s_lshl_b32 s32, s32, 2
    s_bfe_u32 s35, s2, 131075
    s_add_u32 s32, s32, s35
    s_and_b32 s35, s2, 224
    s_add_u32 s32, s32, s35
    s_lshr_b32 s35, s39, 4
    s_mul_i32 s36, s35, 4177920
    s_lshl_b32 s33, s51, 14
    s_add_u32 s33, s33, s36
    s_lshr_b32 s34, s33, 1
    s_mul_i32 s48, s51, 3840
    s_cmp_ge_u32 s35, 0
    s_cselect_b32 s48, s48, 0
    s_lshr_b32 s49, s48, 1
    s_mov_b64 s[44:45], vcc
    s_waitcnt lgkmcnt(0)
    s_load_dword s3, s[6:7], 0
    s_mov_b32 s10, 163840000
    s_mov_b32 s11, 0x00020000
    s_mov_b32 s14, 163840000
    s_mov_b32 s15, 0x00020000
    s_mov_b32 s18, 81920000
    s_mov_b32 s19, 0x00020000
    s_mul_i32 s36, s2, 20000
    s_add_u32 s30, s36, 20000
    s_mov_b32 s31, 0x00020000
    s_add_u32 s35, s36, 16384
    buffer_load_dwordx4 v[48:51], v1, s[28:31], s36 offen nt
    buffer_load_dwordx4 v[52:55], v1, s[28:31], s35 offen nt
    s_add_u32 s35, s33, 0
    buffer_load_dwordx4 v[16:19], v1, s[8:11], s35 offen nt
    s_add_u32 s35, s33, 0
    buffer_load_dwordx4 v[20:23], v1, s[12:15], s35 offen nt
    s_add_u32 s35, s33, 4194304
    buffer_load_dwordx4 v[24:27], v1, s[8:11], s35 offen nt
    s_add_u32 s35, s33, 4194304
    buffer_load_dwordx4 v[28:31], v1, s[12:15], s35 offen nt
    s_add_u32 s35, s33, 8388608
    buffer_load_dwordx4 v[32:35], v1, s[8:11], s35 offen nt
    s_add_u32 s35, s33, 8388608
    buffer_load_dwordx4 v[36:39], v1, s[12:15], s35 offen nt
    s_add_u32 s35, s33, 12582912
    buffer_load_dwordx4 v[40:43], v1, s[8:11], s35 offen nt
    s_add_u32 s35, s33, 12582912
    buffer_load_dwordx4 v[44:47], v1, s[12:15], s35 offen nt
    s_mov_b32 s20, s4
    s_mov_b32 s21, s5
    s_mov_b32 s22, 0
    s_mov_b32 s23, 0x00020000
    s_add_u32 s24, s4, 0
    s_addc_u32 s25, s5, 0
    s_mov_b32 s26, 8573440
    s_mov_b32 s27, 0x00020000
    s_mov_b32 s37, 1492179184
    s_mov_b32 s55, 0
    s_mov_b32 s50, 21845
    s_mov_b32 s38, 262400
    s_mov_b32 s43, 0x05040100
    s_mov_b32 s40, 0
    v_mov_b32 v8, 0
    v_mov_b32 v9, 0
    v_mov_b32 v10, 0
    v_mov_b32 v11, 0
    ds_write_b128 v1, v[8:11] offset:0
    s_waitcnt lgkmcnt(0)
    s_lshl_b32 s3, s3, 16
    v_mov_b32 v12, s3
    v_mul_f32 v12, 0.15915494, v12
    s_nop 0
    v_readfirstlane_b32 s41, v12
    s_waitcnt vmcnt(8)
    s_add_u32 s28, s4, 8573440
    s_addc_u32 s29, s5, 0
    s_mul_i32 s36, s2, 20000
    s_add_u32 s35, s36, 16384
    buffer_store_dwordx4 v[48:51], v1, s[28:31], s36 offen
    buffer_store_dwordx4 v[52:55], v1, s[28:31], s35 offen
    s_nop 0
    v_mov_b32 v12, 0x3f803f80
    v_and_b32 v48, 0x7fff7fff, v48
    v_and_b32 v49, 0x7fff7fff, v49
    v_and_b32 v50, 0x7fff7fff, v50
    v_and_b32 v51, 0x7fff7fff, v51
    v_and_b32 v52, 0x7fff7fff, v52
    v_and_b32 v53, 0x7fff7fff, v53
    v_and_b32 v54, 0x7fff7fff, v54
    v_and_b32 v55, 0x7fff7fff, v55
    v_pk_max_u16 v8, v8, v48
    v_dot2c_f32_bf16 v9, v48, v12
    v_pk_max_u16 v8, v8, v49
    v_dot2c_f32_bf16 v9, v49, v12
    v_pk_max_u16 v8, v8, v50
    v_dot2c_f32_bf16 v9, v50, v12
    v_pk_max_u16 v8, v8, v51
    v_dot2c_f32_bf16 v9, v51, v12
    v_pk_max_u16 v8, v8, v52
    v_dot2c_f32_bf16 v9, v52, v12
    v_pk_max_u16 v8, v8, v53
    v_dot2c_f32_bf16 v9, v53, v12
    v_pk_max_u16 v8, v8, v54
    v_dot2c_f32_bf16 v9, v54, v12
    v_pk_max_u16 v8, v8, v55
    v_dot2c_f32_bf16 v9, v55, v12
    v_lshrrev_b32 v10, 16, v8
    v_and_b32 v8, 0xffff, v8
    v_max_u32 v8, v8, v10
    s_nop 0
    s_nop 1
    v_max_u32_dpp v8, v8, v8 row_shr:1 row_mask:0xf bank_mask:0xf bound_ctrl:0
    s_nop 1
    v_max_u32_dpp v8, v8, v8 row_shr:2 row_mask:0xf bank_mask:0xf bound_ctrl:0
    s_nop 1
    v_max_u32_dpp v8, v8, v8 row_shr:4 row_mask:0xf bank_mask:0xf bound_ctrl:0
    s_nop 1
    v_max_u32_dpp v8, v8, v8 row_shr:8 row_mask:0xf bank_mask:0xf bound_ctrl:0
    s_nop 1
    v_max_u32_dpp v8, v8, v8 row_bcast:15 row_mask:0xa bank_mask:0xf
    s_nop 1
    v_max_u32_dpp v8, v8, v8 row_bcast:31 row_mask:0xc bank_mask:0xf
    s_nop 1
    v_add_f32_dpp v9, v9, v9 row_shr:1 row_mask:0xf bank_mask:0xf bound_ctrl:0
    s_nop 1
    v_add_f32_dpp v9, v9, v9 row_shr:2 row_mask:0xf bank_mask:0xf bound_ctrl:0
    s_nop 1
    v_add_f32_dpp v9, v9, v9 row_shr:4 row_mask:0xf bank_mask:0xf bound_ctrl:0
    s_nop 1
    v_add_f32_dpp v9, v9, v9 row_shr:8 row_mask:0xf bank_mask:0xf bound_ctrl:0
    s_nop 1
    v_add_f32_dpp v9, v9, v9 row_bcast:15 row_mask:0xa bank_mask:0xf
    s_nop 1
    v_add_f32_dpp v9, v9, v9 row_bcast:31 row_mask:0xc bank_mask:0xf
    s_lshl_b32 s35, s39, 4
    s_add_u32 s35, s35, 160320
    v_mov_b32 v10, s35
    s_mov_b32 exec_lo, 0
    s_brev_b32 exec_hi, 1
    ds_write_b64 v10, v[8:9]
    s_mov_b64 exec, -1
    s_waitcnt lgkmcnt(0)
    s_barrier
    s_branch L_p1_first
L_p1_loop:
    s_waitcnt lgkmcnt(13)
    v_lshlrev_b32 v15, 22, v100
    v_lshrrev_b32 v100, 16, v100
    v_alignbit_b32 v15, v100, v15, 10
    v_alignbit_b32 v15, v101, v15, 10
    v_xor_b32 v15, 0x80200800, v15
    s_cmp_lg_u32 s39, 15
    s_cbranch_scc1 L_p1_kernel_nox_1
    s_mov_b32 s36, 13631488
    buffer_store_dwordx4 v[12:15], v3, s[20:23], s36 offen sc1
L_p1_kernel_nox_1:
    s_waitcnt lgkmcnt(12)
    v_lshlrev_b32 v75, 22, v102
    v_lshrrev_b32 v102, 16, v102
    v_alignbit_b32 v75, v102, v75, 10
    v_alignbit_b32 v75, v103, v75, 10
    v_xor_b32 v75, 0x80200800, v75
    s_mov_b32 s36, 0
    buffer_store_dwordx4 v[72:75], v3, s[20:23], s36 offen sc1
    s_waitcnt lgkmcnt(11)
    v_lshlrev_b32 v79, 22, v104
    v_lshrrev_b32 v104, 16, v104
    v_alignbit_b32 v79, v104, v79, 10
    v_alignbit_b32 v79, v105, v79, 10
    v_xor_b32 v79, 0x80200800, v79
    s_mov_b32 s36, 1048576
    buffer_store_dwordx4 v[76:79], v3, s[20:23], s36 offen sc1
    s_waitcnt lgkmcnt(10)
    v_lshlrev_b32 v51, 22, v106
    v_lshrrev_b32 v106, 16, v106
    v_alignbit_b32 v51, v106, v51, 10
    v_alignbit_b32 v51, v107, v51, 10
    v_xor_b32 v51, 0x80200800, v51
    s_mov_b32 s36, 2097152
    buffer_store_dwordx4 v[48:51], v3, s[20:23], s36 offen sc1
    s_add_u32 s35, s33, 16777216
    buffer_load_dwordx4 v[72:75], v1, s[8:11], s35 offen nt
    s_add_u32 s35, s33, 16777216
    buffer_load_dwordx4 v[76:79], v1, s[12:15], s35 offen nt
    s_waitcnt lgkmcnt(9)
    v_lshlrev_b32 v83, 22, v108
    v_lshrrev_b32 v108, 16, v108
    v_alignbit_b32 v83, v108, v83, 10
    v_alignbit_b32 v83, v109, v83, 10
    v_xor_b32 v83, 0x80200800, v83
    s_mov_b32 s36, 3145728
    buffer_store_dwordx4 v[80:83], v3, s[20:23], s36 offen sc1
    s_waitcnt lgkmcnt(8)
    v_lshlrev_b32 v55, 22, v110
    v_lshrrev_b32 v110, 16, v110
    v_alignbit_b32 v55, v110, v55, 10
    v_alignbit_b32 v55, v111, v55, 10
    v_xor_b32 v55, 0x80200800, v55
    s_mov_b32 s36, 4194304
    buffer_store_dwordx4 v[52:55], v3, s[20:23], s36 offen sc1
    s_add_u32 s35, s33, 20971520
    buffer_load_dwordx4 v[80:83], v1, s[8:11], s35 offen nt
    s_add_u32 s35, s33, 20971520
    buffer_load_dwordx4 v[100:103], v1, s[12:15], s35 offen nt
    s_waitcnt lgkmcnt(7)
    v_lshlrev_b32 v87, 22, v112
    v_lshrrev_b32 v112, 16, v112
    v_alignbit_b32 v87, v112, v87, 10
    v_alignbit_b32 v87, v113, v87, 10
    v_xor_b32 v87, 0x80200800, v87
    s_mov_b32 s36, 5242880
    buffer_store_dwordx4 v[84:87], v3, s[20:23], s36 offen sc1
    s_waitcnt lgkmcnt(6)
    v_lshlrev_b32 v59, 22, v114
    v_lshrrev_b32 v114, 16, v114
    v_alignbit_b32 v59, v114, v59, 10
    v_alignbit_b32 v59, v115, v59, 10
    v_xor_b32 v59, 0x80200800, v59
    s_mov_b32 s36, 6291456
    buffer_store_dwordx4 v[56:59], v3, s[20:23], s36 offen sc1
    s_add_u32 s35, s33, 25165824
    buffer_load_dwordx4 v[84:87], v1, s[8:11], s35 offen nt
    s_add_u32 s35, s33, 25165824
    buffer_load_dwordx4 v[104:107], v1, s[12:15], s35 offen nt
    s_waitcnt lgkmcnt(5)
    v_lshlrev_b32 v91, 22, v116
    v_lshrrev_b32 v116, 16, v116
    v_alignbit_b32 v91, v116, v91, 10
    v_alignbit_b32 v91, v117, v91, 10
    v_xor_b32 v91, 0x80200800, v91
    s_mov_b32 s36, 7340032
    buffer_store_dwordx4 v[88:91], v3, s[20:23], s36 offen sc1
    s_waitcnt lgkmcnt(4)
    v_lshlrev_b32 v63, 22, v118
    v_lshrrev_b32 v118, 16, v118
    v_alignbit_b32 v63, v118, v63, 10
    v_alignbit_b32 v63, v119, v63, 10
    v_xor_b32 v63, 0x80200800, v63
    s_mov_b32 s36, 8388608
    buffer_store_dwordx4 v[60:63], v3, s[20:23], s36 offen sc1
    s_add_u32 s35, s33, 29360128
    buffer_load_dwordx4 v[88:91], v1, s[8:11], s35 offen nt
    s_add_u32 s35, s33, 29360128
    buffer_load_dwordx4 v[108:111], v1, s[12:15], s35 offen nt
    s_waitcnt lgkmcnt(3)
    v_lshlrev_b32 v95, 22, v120
    v_lshrrev_b32 v120, 16, v120
    v_alignbit_b32 v95, v120, v95, 10
    v_alignbit_b32 v95, v121, v95, 10
    v_xor_b32 v95, 0x80200800, v95
    s_mov_b32 s36, 9437184
    buffer_store_dwordx4 v[92:95], v3, s[20:23], s36 offen sc1
    s_waitcnt lgkmcnt(2)
    v_lshlrev_b32 v67, 22, v122
    v_lshrrev_b32 v122, 16, v122
    v_alignbit_b32 v67, v122, v67, 10
    v_alignbit_b32 v67, v123, v67, 10
    v_xor_b32 v67, 0x80200800, v67
    s_mov_b32 s36, 10485760
    buffer_store_dwordx4 v[64:67], v3, s[20:23], s36 offen sc1
    s_add_u32 s35, s33, 33554432
    buffer_load_dwordx4 v[92:95], v1, s[8:11], s35 offen nt
    s_add_u32 s35, s33, 33554432
    buffer_load_dwordx4 v[112:115], v1, s[12:15], s35 offen nt
    s_waitcnt lgkmcnt(1)
    v_lshlrev_b32 v99, 22, v124
    v_lshrrev_b32 v124, 16, v124
    v_alignbit_b32 v99, v124, v99, 10
    v_alignbit_b32 v99, v125, v99, 10
    v_xor_b32 v99, 0x80200800, v99
    s_mov_b32 s36, 11534336
    buffer_store_dwordx4 v[96:99], v3, s[20:23], s36 offen sc1
    s_waitcnt lgkmcnt(0)
    v_lshlrev_b32 v71, 22, v126
    v_lshrrev_b32 v126, 16, v126
    v_alignbit_b32 v71, v126, v71, 10
    v_alignbit_b32 v71, v127, v71, 10
    v_xor_b32 v71, 0x80200800, v71
    s_mov_b32 s36, 12582912
    buffer_store_dwordx4 v[68:71], v3, s[20:23], s36 offen sc1
    s_add_u32 s35, s33, 37748736
    s_sub_u32 s35, s35, s48
    v_cndmask_b32 v96, 2.0, v1, s[44:45]
    buffer_load_dwordx4 v[96:99], v96, s[8:11], s35 offen nt
    s_add_u32 s35, s33, 37748736
    s_sub_u32 s35, s35, s48
    v_cndmask_b32 v116, 2.0, v1, s[44:45]
    buffer_load_dwordx4 v[116:119], v116, s[12:15], s35 offen nt
    s_branch L_p1_join
L_p1_first:
    s_add_u32 s35, s33, 16777216
    buffer_load_dwordx4 v[72:75], v1, s[8:11], s35 offen nt
    s_add_u32 s35, s33, 16777216
    buffer_load_dwordx4 v[76:79], v1, s[12:15], s35 offen nt
    s_add_u32 s35, s33, 20971520
    buffer_load_dwordx4 v[80:83], v1, s[8:11], s35 offen nt
    s_add_u32 s35, s33, 20971520
    buffer_load_dwordx4 v[100:103], v1, s[12:15], s35 offen nt
    s_add_u32 s35, s33, 25165824
    buffer_load_dwordx4 v[84:87], v1, s[8:11], s35 offen nt
    s_add_u32 s35, s33, 25165824
    buffer_load_dwordx4 v[104:107], v1, s[12:15], s35 offen nt
    s_add_u32 s35, s33, 29360128
    buffer_load_dwordx4 v[88:91], v1, s[8:11], s35 offen nt
    s_add_u32 s35, s33, 29360128
    buffer_load_dwordx4 v[108:111], v1, s[12:15], s35 offen nt
    s_add_u32 s35, s33, 33554432
    buffer_load_dwordx4 v[92:95], v1, s[8:11], s35 offen nt
    s_add_u32 s35, s33, 33554432
    buffer_load_dwordx4 v[112:115], v1, s[12:15], s35 offen nt
    s_add_u32 s35, s33, 37748736
    s_sub_u32 s35, s35, s48
    v_cndmask_b32 v96, 2.0, v1, s[44:45]
    buffer_load_dwordx4 v[96:99], v96, s[8:11], s35 offen nt
    s_add_u32 s35, s33, 37748736
    s_sub_u32 s35, s35, s48
    v_cndmask_b32 v116, 2.0, v1, s[44:45]
    buffer_load_dwordx4 v[116:119], v116, s[12:15], s35 offen nt
L_p1_join:
    s_waitcnt vmcnt(18)
    v_perm_b32 v6, v20, v16, s43
    v_perm_b32 v7, v21, v17, s43
    v_perm_b32 v8, v22, v18, s43
    v_perm_b32 v9, v23, v19, s43
    v_mul_hi_u32_u24 v16, 429497, v16
    v_mul_hi_u32_u24 v20, 429497, v20
    v_mul_hi_u32_u24 v17, 429497, v17
    v_mul_hi_u32_u24 v21, 429497, v21
    v_mul_hi_u32_u24 v18, 429497, v18
    v_mul_hi_u32_u24 v22, 429497, v22
    v_mul_hi_u32_u24 v19, 429497, v19
    v_mul_hi_u32_u24 v23, 429497, v23
    v_lshl_or_b32 v16, v20, 16, v16
    v_lshl_or_b32 v17, v21, 16, v17
    v_lshl_or_b32 v18, v22, 16, v18
    v_lshl_or_b32 v19, v23, 16, v19
    v_dot2_u32_u16 v20, v16, s38, 0
    v_dot2_u32_u16 v21, v17, s38, 0
    v_dot2_u32_u16 v22, v18, s38, 0
    v_dot2_u32_u16 v23, v19, s38, 0
    v_pk_mad_u16 v6, v16, s37, v6
    v_pk_mad_u16 v7, v17, s37, v7
    v_pk_mad_u16 v8, v18, s37, v8
    v_pk_mad_u16 v9, v19, s37, v9
    ds_add_u32 v20, v4 offset:0
    ds_add_u32 v21, v4 offset:0
    ds_add_u32 v22, v4 offset:0
    ds_add_u32 v23, v4 offset:0
    v_perm_b32 v55, v23, v22, s43
    v_perm_b32 v51, v21, v20, s43
    v_or_b32 v48, 0x40000000, v6
    v_or_b32 v49, 0x40000000, v7
    v_or_b32 v50, 0x40000000, v8
    v_or_b32 v52, 0x40000000, v9
    s_waitcnt vmcnt(16)
    v_perm_b32 v6, v28, v24, s43
    v_perm_b32 v7, v29, v25, s43
    v_perm_b32 v8, v30, v26, s43
    v_perm_b32 v9, v31, v27, s43
    v_mul_hi_u32_u24 v24, 429497, v24
    v_mul_hi_u32_u24 v28, 429497, v28
    v_mul_hi_u32_u24 v25, 429497, v25
    v_mul_hi_u32_u24 v29, 429497, v29
    v_mul_hi_u32_u24 v26, 429497, v26
    v_mul_hi_u32_u24 v30, 429497, v30
    v_mul_hi_u32_u24 v27, 429497, v27
    v_mul_hi_u32_u24 v31, 429497, v31
    v_lshl_or_b32 v24, v28, 16, v24
    v_lshl_or_b32 v25, v29, 16, v25
    v_lshl_or_b32 v26, v30, 16, v26
    v_lshl_or_b32 v27, v31, 16, v27
    v_dot2_u32_u16 v28, v24, s38, 0
    v_dot2_u32_u16 v29, v25, s38, 0
    v_dot2_u32_u16 v30, v26, s38, 0
    v_dot2_u32_u16 v31, v27, s38, 0
    v_pk_mad_u16 v6, v24, s37, v6
    v_pk_mad_u16 v7, v25, s37, v7
    v_pk_mad_u16 v8, v26, s37, v8
    v_pk_mad_u16 v9, v27, s37, v9
    ds_add_u32 v28, v4 offset:0
    ds_add_u32 v29, v4 offset:0
    ds_add_u32 v30, v4 offset:0
    ds_add_u32 v31, v4 offset:0
    v_perm_b32 v63, v31, v30, s43
    v_perm_b32 v59, v29, v28, s43
    v_or_b32 v53, 0x40000000, v6
    v_or_b32 v54, 0x40000000, v7
    v_or_b32 v56, 0x40000000, v8
    v_or_b32 v57, 0x40000000, v9
    s_waitcnt vmcnt(14)
    v_perm_b32 v6, v36, v32, s43
    v_perm_b32 v7, v37, v33, s43
    v_perm_b32 v8, v38, v34, s43
    v_perm_b32 v9, v39, v35, s43
    v_mul_hi_u32_u24 v32, 429497, v32
    v_mul_hi_u32_u24 v36, 429497, v36
    v_mul_hi_u32_u24 v33, 429497, v33
    v_mul_hi_u32_u24 v37, 429497, v37
    v_mul_hi_u32_u24 v34, 429497, v34
    v_mul_hi_u32_u24 v38, 429497, v38
    v_mul_hi_u32_u24 v35, 429497, v35
    v_mul_hi_u32_u24 v39, 429497, v39
    v_lshl_or_b32 v32, v36, 16, v32
    v_lshl_or_b32 v33, v37, 16, v33
    v_lshl_or_b32 v34, v38, 16, v34
    v_lshl_or_b32 v35, v39, 16, v35
    v_dot2_u32_u16 v36, v32, s38, 0
    v_dot2_u32_u16 v37, v33, s38, 0
    v_dot2_u32_u16 v38, v34, s38, 0
    v_dot2_u32_u16 v39, v35, s38, 0
    v_pk_mad_u16 v6, v32, s37, v6
    v_pk_mad_u16 v7, v33, s37, v7
    v_pk_mad_u16 v8, v34, s37, v8
    v_pk_mad_u16 v9, v35, s37, v9
    ds_add_u32 v36, v4 offset:0
    ds_add_u32 v37, v4 offset:0
    ds_add_u32 v38, v4 offset:0
    ds_add_u32 v39, v4 offset:0
    v_perm_b32 v71, v39, v38, s43
    v_perm_b32 v67, v37, v36, s43
    v_or_b32 v58, 0x40000000, v6
    v_or_b32 v60, 0x40000000, v7
    v_or_b32 v61, 0x40000000, v8
    v_or_b32 v62, 0x40000000, v9
    s_waitcnt vmcnt(12)
    v_perm_b32 v6, v44, v40, s43
    v_perm_b32 v7, v45, v41, s43
    v_perm_b32 v8, v46, v42, s43
    v_perm_b32 v9, v47, v43, s43
    v_mul_hi_u32_u24 v40, 429497, v40
    v_mul_hi_u32_u24 v44, 429497, v44
    v_mul_hi_u32_u24 v41, 429497, v41
    v_mul_hi_u32_u24 v45, 429497, v45
    v_mul_hi_u32_u24 v42, 429497, v42
    v_mul_hi_u32_u24 v46, 429497, v46
    v_mul_hi_u32_u24 v43, 429497, v43
    v_mul_hi_u32_u24 v47, 429497, v47
    v_lshl_or_b32 v40, v44, 16, v40
    v_lshl_or_b32 v41, v45, 16, v41
    v_lshl_or_b32 v42, v46, 16, v42
    v_lshl_or_b32 v43, v47, 16, v43
    v_dot2_u32_u16 v44, v40, s38, 0
    v_dot2_u32_u16 v45, v41, s38, 0
    v_dot2_u32_u16 v46, v42, s38, 0
    v_dot2_u32_u16 v47, v43, s38, 0
    v_pk_mad_u16 v6, v40, s37, v6
    v_pk_mad_u16 v7, v41, s37, v7
    v_pk_mad_u16 v8, v42, s37, v8
    v_pk_mad_u16 v9, v43, s37, v9
    ds_add_u32 v44, v4 offset:0
    ds_add_u32 v45, v4 offset:0
    ds_add_u32 v46, v4 offset:0
    ds_add_u32 v47, v4 offset:0
    v_perm_b32 v121, v47, v46, s43
    v_perm_b32 v120, v45, v44, s43
    v_or_b32 v64, 0x40000000, v6
    v_or_b32 v65, 0x40000000, v7
    v_or_b32 v66, 0x40000000, v8
    v_or_b32 v68, 0x40000000, v9
    s_waitcnt vmcnt(10)
    v_perm_b32 v6, v76, v72, s43
    v_perm_b32 v7, v77, v73, s43
    v_perm_b32 v8, v78, v74, s43
    v_perm_b32 v9, v79, v75, s43
    v_mul_hi_u32_u24 v72, 429497, v72
    v_mul_hi_u32_u24 v76, 429497, v76
    v_mul_hi_u32_u24 v73, 429497, v73
    v_mul_hi_u32_u24 v77, 429497, v77
    v_mul_hi_u32_u24 v74, 429497, v74
    v_mul_hi_u32_u24 v78, 429497, v78
    v_mul_hi_u32_u24 v75, 429497, v75
    v_mul_hi_u32_u24 v79, 429497, v79
    v_lshl_or_b32 v72, v76, 16, v72
    v_lshl_or_b32 v73, v77, 16, v73
    v_lshl_or_b32 v74, v78, 16, v74
    v_lshl_or_b32 v75, v79, 16, v75
    v_dot2_u32_u16 v76, v72, s38, 0
    v_dot2_u32_u16 v77, v73, s38, 0
    v_dot2_u32_u16 v78, v74, s38, 0
    v_dot2_u32_u16 v79, v75, s38, 0
    v_pk_mad_u16 v6, v72, s37, v6
    v_pk_mad_u16 v7, v73, s37, v7
    v_pk_mad_u16 v8, v74, s37, v8
    v_pk_mad_u16 v9, v75, s37, v9
    ds_add_u32 v76, v4 offset:0
    ds_add_u32 v77, v4 offset:0
    ds_add_u32 v78, v4 offset:0
    ds_add_u32 v79, v4 offset:0
    v_perm_b32 v123, v79, v78, s43
    v_perm_b32 v122, v77, v76, s43
    v_or_b32 v69, 0x40000000, v6
    v_or_b32 v70, 0x40000000, v7
    v_or_b32 v127, 0x40000000, v8
    v_or_b32 v72, 0x40000000, v9
    s_waitcnt vmcnt(8)
    v_perm_b32 v6, v100, v80, s43
    v_perm_b32 v7, v101, v81, s43
    v_perm_b32 v8, v102, v82, s43
    v_perm_b32 v9, v103, v83, s43
    v_mul_hi_u32_u24 v80, 429497, v80
    v_mul_hi_u32_u24 v100, 429497, v100
    v_mul_hi_u32_u24 v81, 429497, v81
    v_mul_hi_u32_u24 v101, 429497, v101
    v_mul_hi_u32_u24 v82, 429497, v82
    v_mul_hi_u32_u24 v102, 429497, v102
    v_mul_hi_u32_u24 v83, 429497, v83
    v_mul_hi_u32_u24 v103, 429497, v103
    v_lshl_or_b32 v80, v100, 16, v80
    v_lshl_or_b32 v81, v101, 16, v81
    v_lshl_or_b32 v82, v102, 16, v82
    v_lshl_or_b32 v83, v103, 16, v83
    v_dot2_u32_u16 v100, v80, s38, 0
    v_dot2_u32_u16 v101, v81, s38, 0
    v_dot2_u32_u16 v102, v82, s38, 0
    v_dot2_u32_u16 v103, v83, s38, 0
    v_pk_mad_u16 v6, v80, s37, v6
    v_pk_mad_u16 v7, v81, s37, v7
    v_pk_mad_u16 v8, v82, s37, v8
    v_pk_mad_u16 v9, v83, s37, v9
    ds_add_u32 v100, v4 offset:0
    ds_add_u32 v101, v4 offset:0
    ds_add_u32 v102, v4 offset:0
    ds_add_u32 v103, v4 offset:0
    v_perm_b32 v125, v103, v102, s43
    v_perm_b32 v124, v101, v100, s43
    v_or_b32 v73, 0x40000000, v6
    v_or_b32 v74, 0x40000000, v7
    v_or_b32 v76, 0x40000000, v8
    v_or_b32 v77, 0x40000000, v9
    s_waitcnt vmcnt(6)
    v_perm_b32 v6, v104, v84, s43
    v_perm_b32 v7, v105, v85, s43
    v_perm_b32 v8, v106, v86, s43
    v_perm_b32 v9, v107, v87, s43
    v_mul_hi_u32_u24 v84, 429497, v84
    v_mul_hi_u32_u24 v104, 429497, v104
    v_mul_hi_u32_u24 v85, 429497, v85
    v_mul_hi_u32_u24 v105, 429497, v105
    v_mul_hi_u32_u24 v86, 429497, v86
    v_mul_hi_u32_u24 v106, 429497, v106
    v_mul_hi_u32_u24 v87, 429497, v87
    v_mul_hi_u32_u24 v107, 429497, v107
    v_lshl_or_b32 v84, v104, 16, v84
    v_lshl_or_b32 v85, v105, 16, v85
    v_lshl_or_b32 v86, v106, 16, v86
    v_lshl_or_b32 v87, v107, 16, v87
    v_dot2_u32_u16 v104, v84, s38, 0
    v_dot2_u32_u16 v105, v85, s38, 0
    v_dot2_u32_u16 v106, v86, s38, 0
    v_dot2_u32_u16 v107, v87, s38, 0
    v_pk_mad_u16 v6, v84, s37, v6
    v_pk_mad_u16 v7, v85, s37, v7
    v_pk_mad_u16 v8, v86, s37, v8
    v_pk_mad_u16 v9, v87, s37, v9
    ds_add_u32 v104, v4 offset:0
    ds_add_u32 v105, v4 offset:0
    ds_add_u32 v106, v4 offset:0
    ds_add_u32 v107, v4 offset:0
    v_perm_b32 v75, v107, v106, s43
    v_perm_b32 v126, v105, v104, s43
    v_or_b32 v78, 0x40000000, v6
    v_or_b32 v80, 0x40000000, v7
    v_or_b32 v81, 0x40000000, v8
    v_or_b32 v82, 0x40000000, v9
    s_waitcnt vmcnt(4)
    v_perm_b32 v6, v108, v88, s43
    v_perm_b32 v7, v109, v89, s43
    v_perm_b32 v8, v110, v90, s43
    v_perm_b32 v9, v111, v91, s43
    v_mul_hi_u32_u24 v88, 429497, v88
    v_mul_hi_u32_u24 v108, 429497, v108
    v_mul_hi_u32_u24 v89, 429497, v89
    v_mul_hi_u32_u24 v109, 429497, v109
    v_mul_hi_u32_u24 v90, 429497, v90
    v_mul_hi_u32_u24 v110, 429497, v110
    v_mul_hi_u32_u24 v91, 429497, v91
    v_mul_hi_u32_u24 v111, 429497, v111
    v_lshl_or_b32 v88, v108, 16, v88
    v_lshl_or_b32 v89, v109, 16, v89
    v_lshl_or_b32 v90, v110, 16, v90
    v_lshl_or_b32 v91, v111, 16, v91
    v_dot2_u32_u16 v108, v88, s38, 0
    v_dot2_u32_u16 v109, v89, s38, 0
    v_dot2_u32_u16 v110, v90, s38, 0
    v_dot2_u32_u16 v111, v91, s38, 0
    v_pk_mad_u16 v6, v88, s37, v6
    v_pk_mad_u16 v7, v89, s37, v7
    v_pk_mad_u16 v8, v90, s37, v8
    v_pk_mad_u16 v9, v91, s37, v9
    ds_add_u32 v108, v4 offset:0
    ds_add_u32 v109, v4 offset:0
    ds_add_u32 v110, v4 offset:0
    ds_add_u32 v111, v4 offset:0
    v_perm_b32 v83, v111, v110, s43
    v_perm_b32 v79, v109, v108, s43
    v_or_b32 v84, 0x40000000, v6
    v_or_b32 v85, 0x40000000, v7
    v_or_b32 v86, 0x40000000, v8
    v_or_b32 v88, 0x40000000, v9
    s_waitcnt vmcnt(2)
    v_perm_b32 v6, v112, v92, s43
    v_perm_b32 v7, v113, v93, s43
    v_perm_b32 v8, v114, v94, s43
    v_perm_b32 v9, v115, v95, s43
    v_mul_hi_u32_u24 v92, 429497, v92
    v_mul_hi_u32_u24 v112, 429497, v112
    v_mul_hi_u32_u24 v93, 429497, v93
    v_mul_hi_u32_u24 v113, 429497, v113
    v_mul_hi_u32_u24 v94, 429497, v94
    v_mul_hi_u32_u24 v114, 429497, v114
    v_mul_hi_u32_u24 v95, 429497, v95
    v_mul_hi_u32_u24 v115, 429497, v115
    v_lshl_or_b32 v92, v112, 16, v92
    v_lshl_or_b32 v93, v113, 16, v93
    v_lshl_or_b32 v94, v114, 16, v94
    v_lshl_or_b32 v95, v115, 16, v95
    v_dot2_u32_u16 v112, v92, s38, 0
    v_dot2_u32_u16 v113, v93, s38, 0
    v_dot2_u32_u16 v114, v94, s38, 0
    v_dot2_u32_u16 v115, v95, s38, 0
    v_pk_mad_u16 v6, v92, s37, v6
    v_pk_mad_u16 v7, v93, s37, v7
    v_pk_mad_u16 v8, v94, s37, v8
    v_pk_mad_u16 v9, v95, s37, v9
    ds_add_u32 v112, v4 offset:0
    ds_add_u32 v113, v4 offset:0
    ds_add_u32 v114, v4 offset:0
    ds_add_u32 v115, v4 offset:0
    v_perm_b32 v91, v115, v114, s43
    v_perm_b32 v87, v113, v112, s43
    v_or_b32 v89, 0x40000000, v6
    v_or_b32 v90, 0x40000000, v7
    v_or_b32 v92, 0x40000000, v8
    v_or_b32 v93, 0x40000000, v9
    s_waitcnt vmcnt(0)
    s_mov_b64 exec, s[44:45]
    v_perm_b32 v6, v116, v96, s43
    v_perm_b32 v7, v117, v97, s43
    v_perm_b32 v8, v118, v98, s43
    v_perm_b32 v9, v119, v99, s43
    v_mul_hi_u32_u24 v96, 429497, v96
    v_mul_hi_u32_u24 v116, 429497, v116
    v_mul_hi_u32_u24 v97, 429497, v97
    v_mul_hi_u32_u24 v117, 429497, v117
    v_mul_hi_u32_u24 v98, 429497, v98
    v_mul_hi_u32_u24 v118, 429497, v118
    v_mul_hi_u32_u24 v99, 429497, v99
    v_mul_hi_u32_u24 v119, 429497, v119
    v_lshl_or_b32 v96, v116, 16, v96
    v_lshl_or_b32 v97, v117, 16, v97
    v_lshl_or_b32 v98, v118, 16, v98
    v_lshl_or_b32 v99, v119, 16, v99
    v_dot2_u32_u16 v116, v96, s38, 0
    v_dot2_u32_u16 v117, v97, s38, 0
    v_dot2_u32_u16 v118, v98, s38, 0
    v_dot2_u32_u16 v119, v99, s38, 0
    v_pk_mad_u16 v6, v96, s37, v6
    v_pk_mad_u16 v7, v97, s37, v7
    v_pk_mad_u16 v8, v98, s37, v8
    v_pk_mad_u16 v9, v99, s37, v9
    ds_add_u32 v116, v4 offset:0
    ds_add_u32 v117, v4 offset:0
    ds_add_u32 v118, v4 offset:0
    ds_add_u32 v119, v4 offset:0
    v_perm_b32 v99, v119, v118, s43
    v_perm_b32 v95, v117, v116, s43
    v_or_b32 v94, 0x40000000, v6
    v_or_b32 v96, 0x40000000, v7
    v_or_b32 v97, 0x40000000, v8
    v_or_b32 v98, 0x40000000, v9
    s_mov_b64 exec, -1
    s_add_u32 s35, s34, 0
    buffer_load_dwordx2 v[100:101], v2, s[16:19], s35 offen nt
    s_lshl_b32 s42, s32, 5
    s_lshl_b32 s35, s32, 10
    s_add_u32 s35, s35, 14680064
    s_add_u32 s20, s4, s35
    s_addc_u32 s21, s5, 0
    s_waitcnt lgkmcnt(0)
    s_barrier
    ds_read_b128 v[8:11], v1 offset:0
    s_add_u32 s35, s34, 2097152
    buffer_load_dwordx2 v[102:103], v2, s[16:19], s35 offen nt
    s_lshl_b32 s35, s39, 2
    s_add_u32 s35, s35, 160256
    v_mov_b32 v7, s35
    v_and_b32 v14, 15, v0
    v_lshlrev_b32 v14, 2, v14
    v_add_u32 v14, 160256, v14
    s_waitcnt lgkmcnt(0)
    v_cmp_eq_u32 s[56:57], 0, v8
    v_cmp_ge_u32 s[64:65], 1, v8
    v_max_u32 v12, 2, v8
    v_lshl_or_b32 v8, v8, 16, v12
    v_cmp_eq_u32 s[58:59], 0, v9
    v_cmp_ge_u32 s[66:67], 1, v9
    v_max_u32 v12, 2, v9
    v_lshl_or_b32 v9, v9, 16, v12
    v_cmp_eq_u32 s[60:61], 0, v10
    v_cmp_ge_u32 s[68:69], 1, v10
    v_max_u32 v12, 2, v10
    v_lshl_or_b32 v10, v10, 16, v12
    v_cmp_eq_u32 s[62:63], 0, v11
    v_cmp_ge_u32 s[70:71], 1, v11
    v_max_u32 v12, 2, v11
    v_lshl_or_b32 v11, v11, 16, v12
    v_add_u32 v9, v8, v9
    v_add_u32 v10, v9, v10
    v_add_u32 v11, v10, v11
    v_mov_b32 v6, v11
    s_nop 1
    v_add_u32_dpp v6, v6, v6 row_shr:1 row_mask:0xf bank_mask:0xf bound_ctrl:0
    s_nop 1
    v_add_u32_dpp v6, v6, v6 row_shr:2 row_mask:0xf bank_mask:0xf bound_ctrl:0
    s_nop 1
    v_add_u32_dpp v6, v6, v6 row_shr:4 row_mask:0xf bank_mask:0xf bound_ctrl:0
    s_nop 1
    v_add_u32_dpp v6, v6, v6 row_shr:8 row_mask:0xf bank_mask:0xf bound_ctrl:0
    s_nop 1
    v_add_u32_dpp v6, v6, v6 row_bcast:15 row_mask:0xa bank_mask:0xf
    s_nop 1
    v_add_u32_dpp v6, v6, v6 row_bcast:31 row_mask:0xc bank_mask:0xf
    s_mov_b32 exec_lo, 0
    s_brev_b32 exec_hi, 1
    ds_write_b32 v7, v6
    s_mov_b64 exec, -1
    v_sub_u32 v6, v6, v11
    s_or_b64 s[46:47], s[64:65], s[66:67]
    s_or_b64 vcc, s[68:69], s[70:71]
    s_or_b64 s[46:47], s[46:47], vcc
    s_waitcnt lgkmcnt(0)
    s_barrier
    ds_read_b32 v7, v14
    s_add_u32 s35, s34, 4194304
    buffer_load_dwordx2 v[104:105], v2, s[16:19], s35 offen nt
    s_waitcnt lgkmcnt(0)
    v_mov_b32 v15, v7
    s_nop 1
    v_add_u32_dpp v7, v7, v7 row_shr:1 row_mask:0xf bank_mask:0xf bound_ctrl:0
    s_nop 1
    v_add_u32_dpp v7, v7, v7 row_shr:2 row_mask:0xf bank_mask:0xf bound_ctrl:0
    s_nop 1
    v_add_u32_dpp v7, v7, v7 row_shr:4 row_mask:0xf bank_mask:0xf bound_ctrl:0
    s_nop 1
    v_add_u32_dpp v7, v7, v7 row_shr:8 row_mask:0xf bank_mask:0xf bound_ctrl:0
    s_nop 0
    v_readlane_b32 s54, v7, 15
    v_sub_u32 v7, v7, v15
    s_nop 0
    v_readlane_b32 s35, v7, s39
    s_and_b32 s54, s54, 0xffff
    s_cmp_ge_u32 s54, 40063
    s_cselect_b32 s36, 16, 0
    s_cselect_b32 s54, 40000, s54
    s_cselect_b32 s55, 1, s55
    s_cselect_b64 s[46:47], 0, s[46:47]
    v_add_u32 v12, s35, v6
    v_add_u32 v13, v12, v8
    v_add_u32 v14, v12, v9
    v_add_u32 v15, v12, v10
    v_bfe_u32 v12, v12, s36, 16
    v_bfe_u32 v13, v13, s36, 16
    v_bfe_u32 v14, v14, s36, 16
    v_bfe_u32 v15, v15, s36, 16
    ds_write_b128 v1, v[12:15] offset:0
    ds_write_b128 v1, v[12:15] offset:16384
    v_mov_b32 v6, 32768
    v_mov_b32 v7, s54
    s_mov_b64 exec, 1
    ds_write_b32 v6, v7
    s_mov_b64 exec, -1
    s_add_u32 s35, s54, 2
    s_mul_hi_u32 s35, s35, 1431655766
    s_lshl_b32 s35, s35, 4
    s_add_u32 s35, s35, 217890816
    s_min_u32 s22, s35, 218104832
    v_perm_b32 v15, v15, v14, s43
    v_perm_b32 v14, v13, v12, s43
    s_waitcnt lgkmcnt(0)
    s_barrier
    v_and_b32 v6, 63, v0
    s_lshl_b32 s35, s39, 10
    v_lshl_add_u32 v7, v6, 2, s35
    v_lshl_add_u32 v12, v6, 8, s35
    ds_read_b32 v8, v7 offset:16384
    ds_read_b32 v9, v7 offset:16640
    ds_read_b32 v10, v7 offset:16896
    ds_read_b32 v11, v7 offset:17152
    s_mov_b64 exec, 15
    ds_read_b32 v12, v12 offset:16640
    s_mov_b64 exec, -1
    s_lshr_b32 s35, s39, 2
    s_mul_i32 s35, s35, 2138240
    s_and_b32 s36, s39, 1
    s_lshl_b32 s36, s36, 3
    s_add_u32 s35, s35, s36
    s_and_b32 s36, s39, 2
    s_lshl_b32 s36, s36, 3
    s_add_u32 s35, s35, s36
    s_add_u32 s35, s35, s42
    s_add_u32 s36, s35, 2105344
    v_mul_u32_u24 v7, 32896, v6
    v_lshlrev_b32 v13, 1, v6
    s_waitcnt lgkmcnt(1)
    v_perm_b32 v8, v9, v8, s43
    v_perm_b32 v9, v11, v10, s43
    buffer_store_dwordx2 v[8:9], v7, s[24:27], s35 offen
    s_waitcnt lgkmcnt(0)
    s_mov_b64 exec, 15
    buffer_store_short v12, v13, s[24:27], s36 offen
    s_mov_b64 exec, -1
    s_nop 0
    v_and_b32 v6, 0xffff, v51
    v_lshrrev_b32 v7, 16, v51
    v_and_b32 v8, 0xffff, v55
    v_lshrrev_b32 v9, 16, v55
    ds_add_rtn_u32 v6, v6, v4 offset:0
    ds_add_rtn_u32 v7, v7, v4 offset:0
    ds_add_rtn_u32 v8, v8, v4 offset:0
    ds_add_rtn_u32 v9, v9, v4 offset:0
    v_and_b32 v10, 0xffff, v59
    v_lshrrev_b32 v11, 16, v59
    v_and_b32 v12, 0xffff, v63
    v_lshrrev_b32 v13, 16, v63
    ds_add_rtn_u32 v10, v10, v4 offset:0
    ds_add_rtn_u32 v11, v11, v4 offset:0
    ds_add_rtn_u32 v12, v12, v4 offset:0
    ds_add_rtn_u32 v13, v13, v4 offset:0
    s_waitcnt lgkmcnt(4)
    v_perm_b32 v51, v7, v6, s43
    v_perm_b32 v55, v9, v8, s43
    v_and_b32 v6, 0xffff, v67
    v_lshrrev_b32 v7, 16, v67
    v_and_b32 v8, 0xffff, v71
    v_lshrrev_b32 v9, 16, v71
    ds_add_rtn_u32 v6, v6, v4 offset:0
    ds_add_rtn_u32 v7, v7, v4 offset:0
    ds_add_rtn_u32 v8, v8, v4 offset:0
    ds_add_rtn_u32 v9, v9, v4 offset:0
    s_waitcnt lgkmcnt(4)
    v_perm_b32 v59, v11, v10, s43
    v_perm_b32 v63, v13, v12, s43
    s_add_u32 s35, s34, 6291456
    buffer_load_dwordx2 v[106:107], v2, s[16:19], s35 offen nt
    v_and_b32 v10, 0xffff, v120
    v_lshrrev_b32 v11, 16, v120
    v_and_b32 v12, 0xffff, v121
    v_lshrrev_b32 v13, 16, v121
    ds_add_rtn_u32 v10, v10, v4 offset:0
    ds_add_rtn_u32 v11, v11, v4 offset:0
    ds_add_rtn_u32 v12, v12, v4 offset:0
    ds_add_rtn_u32 v13, v13, v4 offset:0
    s_waitcnt lgkmcnt(4)
    v_perm_b32 v67, v7, v6, s43
    v_perm_b32 v71, v9, v8, s43
    s_add_u32 s35, s34, 8388608
    buffer_load_dwordx2 v[108:109], v2, s[16:19], s35 offen nt
    v_and_b32 v6, 0xffff, v122
    v_lshrrev_b32 v7, 16, v122
    v_and_b32 v8, 0xffff, v123
    v_lshrrev_b32 v9, 16, v123
    ds_add_rtn_u32 v6, v6, v4 offset:0
    ds_add_rtn_u32 v7, v7, v4 offset:0
    ds_add_rtn_u32 v8, v8, v4 offset:0
    ds_add_rtn_u32 v9, v9, v4 offset:0
    s_waitcnt lgkmcnt(4)
    v_perm_b32 v120, v11, v10, s43
    v_perm_b32 v121, v13, v12, s43
    s_add_u32 s35, s34, 10485760
    buffer_load_dwordx2 v[110:111], v2, s[16:19], s35 offen nt
    v_and_b32 v10, 0xffff, v124
    v_lshrrev_b32 v11, 16, v124
    v_and_b32 v12, 0xffff, v125
    v_lshrrev_b32 v13, 16, v125
    ds_add_rtn_u32 v10, v10, v4 offset:0
    ds_add_rtn_u32 v11, v11, v4 offset:0
    ds_add_rtn_u32 v12, v12, v4 offset:0
    ds_add_rtn_u32 v13, v13, v4 offset:0
    s_waitcnt lgkmcnt(4)
    v_perm_b32 v122, v7, v6, s43
    v_perm_b32 v123, v9, v8, s43
    v_and_b32 v6, 0xffff, v126
    v_lshrrev_b32 v7, 16, v126
    v_and_b32 v8, 0xffff, v75
    v_lshrrev_b32 v9, 16, v75
    ds_add_rtn_u32 v6, v6, v4 offset:0
    ds_add_rtn_u32 v7, v7, v4 offset:0
    ds_add_rtn_u32 v8, v8, v4 offset:0
    ds_add_rtn_u32 v9, v9, v4 offset:0
    s_waitcnt lgkmcnt(4)
    v_perm_b32 v124, v11, v10, s43
    v_perm_b32 v125, v13, v12, s43
    s_add_u32 s35, s34, 12582912
    buffer_load_dwordx2 v[112:113], v2, s[16:19], s35 offen nt
    v_and_b32 v10, 0xffff, v79
    v_lshrrev_b32 v11, 16, v79
    v_and_b32 v12, 0xffff, v83
    v_lshrrev_b32 v13, 16, v83
    ds_add_rtn_u32 v10, v10, v4 offset:0
    ds_add_rtn_u32 v11, v11, v4 offset:0
    ds_add_rtn_u32 v12, v12, v4 offset:0
    ds_add_rtn_u32 v13, v13, v4 offset:0
    s_waitcnt lgkmcnt(4)
    v_perm_b32 v126, v7, v6, s43
    v_perm_b32 v75, v9, v8, s43
    s_add_u32 s35, s34, 14680064
    buffer_load_dwordx2 v[114:115], v2, s[16:19], s35 offen nt
    v_and_b32 v6, 0xffff, v87
    v_lshrrev_b32 v7, 16, v87
    v_and_b32 v8, 0xffff, v91
    v_lshrrev_b32 v9, 16, v91
    ds_add_rtn_u32 v6, v6, v4 offset:0
    ds_add_rtn_u32 v7, v7, v4 offset:0
    ds_add_rtn_u32 v8, v8, v4 offset:0
    ds_add_rtn_u32 v9, v9, v4 offset:0
    s_waitcnt lgkmcnt(4)
    v_perm_b32 v79, v11, v10, s43
    v_perm_b32 v83, v13, v12, s43
    s_add_u32 s35, s34, 16777216
    buffer_load_dwordx2 v[116:117], v2, s[16:19], s35 offen nt
    s_mov_b64 exec, s[44:45]
    v_and_b32 v10, 0xffff, v95
    v_lshrrev_b32 v11, 16, v95
    v_and_b32 v12, 0xffff, v99
    v_lshrrev_b32 v13, 16, v99
    ds_add_rtn_u32 v10, v10, v4 offset:0
    ds_add_rtn_u32 v11, v11, v4 offset:0
    ds_add_rtn_u32 v12, v12, v4 offset:0
    ds_add_rtn_u32 v13, v13, v4 offset:0
    s_mov_b64 exec, -1
    s_waitcnt lgkmcnt(4)
    v_perm_b32 v87, v7, v6, s43
    v_perm_b32 v91, v9, v8, s43
    s_add_u32 s35, s34, 18874368
    s_sub_u32 s35, s35, s49
    v_cndmask_b32 v118, 2.0, v2, s[44:45]
    buffer_load_dwordx2 v[118:119], v118, s[16:19], s35 offen nt
    s_waitcnt lgkmcnt(0)
    v_perm_b32 v95, v11, v10, s43
    v_perm_b32 v99, v13, v12, s43
    s_barrier
    s_lshl_b32 s35, s54, 2
    v_mov_b32 v6, s35
    v_mov_b32 v7, 0
    v_mov_b32 v12, 1140817920
    s_mov_b64 exec, 1
    ds_write2_b32 v6, v7, v7 offset0:0 offset1:1
    s_cmp_eq_u64 s[46:47], 0
    s_cbranch_scc1 L_p1_kernel_nonull_2
    s_mov_b64 exec, s[64:65]
    v_lshlrev_b32_sdwa v6, 2, v14 dst_sel:DWORD dst_unused:UNUSED_PAD src0_sel:DWORD src1_sel:WORD_0
    ds_write_b32 v6, v7 offset:4
    s_mov_b64 exec, s[56:57]
    ds_write_b32 v6, v7
    s_mov_b64 exec, s[66:67]
    v_lshlrev_b32_sdwa v6, 2, v14 dst_sel:DWORD dst_unused:UNUSED_PAD src0_sel:DWORD src1_sel:WORD_1
    ds_write_b32 v6, v7 offset:4
    s_mov_b64 exec, s[58:59]
    ds_write_b32 v6, v7
    s_mov_b64 exec, s[68:69]
    v_lshlrev_b32_sdwa v6, 2, v15 dst_sel:DWORD dst_unused:UNUSED_PAD src0_sel:DWORD src1_sel:WORD_0
    ds_write_b32 v6, v7 offset:4
    s_mov_b64 exec, s[60:61]
    ds_write_b32 v6, v7
    s_mov_b64 exec, s[70:71]
    v_lshlrev_b32_sdwa v6, 2, v15 dst_sel:DWORD dst_unused:UNUSED_PAD src0_sel:DWORD src1_sel:WORD_1
    ds_write_b32 v6, v7 offset:4
    s_mov_b64 exec, s[62:63]
    ds_write_b32 v6, v7
L_p1_kernel_nonull_2:
    s_mov_b64 exec, -1
    v_lshlrev_b32_sdwa v6, 2, v51 dst_sel:DWORD dst_unused:UNUSED_PAD src0_sel:DWORD src1_sel:WORD_0
    v_lshlrev_b32_sdwa v7, 2, v51 dst_sel:DWORD dst_unused:UNUSED_PAD src0_sel:DWORD src1_sel:WORD_1
    v_lshlrev_b32_sdwa v8, 2, v55 dst_sel:DWORD dst_unused:UNUSED_PAD src0_sel:DWORD src1_sel:WORD_0
    v_lshlrev_b32_sdwa v9, 2, v55 dst_sel:DWORD dst_unused:UNUSED_PAD src0_sel:DWORD src1_sel:WORD_1
    ds_write_b32 v6, v48
    ds_write_b32 v7, v49
    ds_write_b32 v8, v50
    ds_write_b32 v9, v52
    s_waitcnt vmcnt(11)
    v_lshlrev_b32 v10, 16, v100
    v_lshlrev_b32 v11, 16, v101
    v_and_b32 v100, 0xffff0000, v100
    v_and_b32 v101, 0xffff0000, v101
    v_mul_f32 v10, s41, v10
    v_mul_f32 v100, s41, v100
    v_mul_f32 v11, s41, v11
    v_mul_f32 v101, s41, v101
    v_fract_f32 v10, v10
    v_fract_f32 v100, v100
    v_fract_f32 v11, v11
    v_fract_f32 v101, v101
    v_cos_f32 v10, v10
    v_cos_f32 v100, v100
    v_cos_f32 v11, v11
    v_cos_f32 v101, v101
    v_fmaak_f32 v10, v12, v10, 1262486016
    v_fmaak_f32 v100, v12, v100, 1262486016
    v_fmaak_f32 v11, v12, v11, 1262486016
    v_fmaak_f32 v101, v12, v101, 1262486016
    v_or3_b32 v5, v10, v100, v5
    v_or3_b32 v5, v11, v101, v5
    v_perm_b32 v100, v100, v10, s43
    v_perm_b32 v101, v101, v11, s43
    s_add_u32 s35, s33, 40960000
    buffer_load_dwordx4 v[16:19], v1, s[8:11], s35 offen nt
    v_lshlrev_b32_sdwa v6, 2, v59 dst_sel:DWORD dst_unused:UNUSED_PAD src0_sel:DWORD src1_sel:WORD_0
    v_lshlrev_b32_sdwa v7, 2, v59 dst_sel:DWORD dst_unused:UNUSED_PAD src0_sel:DWORD src1_sel:WORD_1
    v_lshlrev_b32_sdwa v8, 2, v63 dst_sel:DWORD dst_unused:UNUSED_PAD src0_sel:DWORD src1_sel:WORD_0
    v_lshlrev_b32_sdwa v9, 2, v63 dst_sel:DWORD dst_unused:UNUSED_PAD src0_sel:DWORD src1_sel:WORD_1
    ds_write_b32 v6, v53
    ds_write_b32 v7, v54
    ds_write_b32 v8, v56
    ds_write_b32 v9, v57
    s_waitcnt vmcnt(11)
    v_lshlrev_b32 v10, 16, v102
    v_lshlrev_b32 v11, 16, v103
    v_and_b32 v102, 0xffff0000, v102
    v_and_b32 v103, 0xffff0000, v103
    v_mul_f32 v10, s41, v10
    v_mul_f32 v102, s41, v102
    v_mul_f32 v11, s41, v11
    v_mul_f32 v103, s41, v103
    v_fract_f32 v10, v10
    v_fract_f32 v102, v102
    v_fract_f32 v11, v11
    v_fract_f32 v103, v103
    v_cos_f32 v10, v10
    v_cos_f32 v102, v102
    v_cos_f32 v11, v11
    v_cos_f32 v103, v103
    v_fmaak_f32 v10, v12, v10, 1262486016
    v_fmaak_f32 v102, v12, v102, 1262486016
    v_fmaak_f32 v11, v12, v11, 1262486016
    v_fmaak_f32 v103, v12, v103, 1262486016
    v_or3_b32 v5, v10, v102, v5
    v_or3_b32 v5, v11, v103, v5
    v_perm_b32 v102, v102, v10, s43
    v_perm_b32 v103, v103, v11, s43
    v_lshlrev_b32_sdwa v6, 2, v67 dst_sel:DWORD dst_unused:UNUSED_PAD src0_sel:DWORD src1_sel:WORD_0
    v_lshlrev_b32_sdwa v7, 2, v67 dst_sel:DWORD dst_unused:UNUSED_PAD src0_sel:DWORD src1_sel:WORD_1
    v_lshlrev_b32_sdwa v8, 2, v71 dst_sel:DWORD dst_unused:UNUSED_PAD src0_sel:DWORD src1_sel:WORD_0
    v_lshlrev_b32_sdwa v9, 2, v71 dst_sel:DWORD dst_unused:UNUSED_PAD src0_sel:DWORD src1_sel:WORD_1
    ds_write_b32 v6, v58
    ds_write_b32 v7, v60
    ds_write_b32 v8, v61
    ds_write_b32 v9, v62
    v_lshlrev_b32_sdwa v6, 2, v120 dst_sel:DWORD dst_unused:UNUSED_PAD src0_sel:DWORD src1_sel:WORD_0
    v_lshlrev_b32_sdwa v7, 2, v120 dst_sel:DWORD dst_unused:UNUSED_PAD src0_sel:DWORD src1_sel:WORD_1
    v_lshlrev_b32_sdwa v8, 2, v121 dst_sel:DWORD dst_unused:UNUSED_PAD src0_sel:DWORD src1_sel:WORD_0
    v_lshlrev_b32_sdwa v9, 2, v121 dst_sel:DWORD dst_unused:UNUSED_PAD src0_sel:DWORD src1_sel:WORD_1
    ds_write_b32 v6, v64
    ds_write_b32 v7, v65
    ds_write_b32 v8, v66
    ds_write_b32 v9, v68
    s_waitcnt vmcnt(10)
    v_lshlrev_b32 v10, 16, v104
    v_lshlrev_b32 v11, 16, v105
    v_and_b32 v104, 0xffff0000, v104
    v_and_b32 v105, 0xffff0000, v105
    v_mul_f32 v10, s41, v10
    v_mul_f32 v104, s41, v104
    v_mul_f32 v11, s41, v11
    v_mul_f32 v105, s41, v105
    v_fract_f32 v10, v10
    v_fract_f32 v104, v104
    v_fract_f32 v11, v11
    v_fract_f32 v105, v105
    v_cos_f32 v10, v10
    v_cos_f32 v104, v104
    v_cos_f32 v11, v11
    v_cos_f32 v105, v105
    v_fmaak_f32 v10, v12, v10, 1262486016
    v_fmaak_f32 v104, v12, v104, 1262486016
    v_fmaak_f32 v11, v12, v11, 1262486016
    v_fmaak_f32 v105, v12, v105, 1262486016
    v_or3_b32 v5, v10, v104, v5
    v_or3_b32 v5, v11, v105, v5
    v_perm_b32 v104, v104, v10, s43
    v_perm_b32 v105, v105, v11, s43
    s_add_u32 s35, s33, 40960000
    buffer_load_dwordx4 v[20:23], v1, s[12:15], s35 offen nt
    v_lshlrev_b32_sdwa v6, 2, v122 dst_sel:DWORD dst_unused:UNUSED_PAD src0_sel:DWORD src1_sel:WORD_0
    v_lshlrev_b32_sdwa v7, 2, v122 dst_sel:DWORD dst_unused:UNUSED_PAD src0_sel:DWORD src1_sel:WORD_1
    v_lshlrev_b32_sdwa v8, 2, v123 dst_sel:DWORD dst_unused:UNUSED_PAD src0_sel:DWORD src1_sel:WORD_0
    v_lshlrev_b32_sdwa v9, 2, v123 dst_sel:DWORD dst_unused:UNUSED_PAD src0_sel:DWORD src1_sel:WORD_1
    ds_write_b32 v6, v69
    ds_write_b32 v7, v70
    ds_write_b32 v8, v127
    ds_write_b32 v9, v72
    s_waitcnt vmcnt(8)
    v_lshlrev_b32 v10, 16, v106
    v_lshlrev_b32 v11, 16, v107
    v_and_b32 v106, 0xffff0000, v106
    v_and_b32 v107, 0xffff0000, v107
    v_mul_f32 v10, s41, v10
    v_mul_f32 v106, s41, v106
    v_mul_f32 v11, s41, v11
    v_mul_f32 v107, s41, v107
    v_fract_f32 v10, v10
    v_fract_f32 v106, v106
    v_fract_f32 v11, v11
    v_fract_f32 v107, v107
    v_cos_f32 v10, v10
    v_cos_f32 v106, v106
    v_cos_f32 v11, v11
    v_cos_f32 v107, v107
    v_fmaak_f32 v10, v12, v10, 1262486016
    v_fmaak_f32 v106, v12, v106, 1262486016
    v_fmaak_f32 v11, v12, v11, 1262486016
    v_fmaak_f32 v107, v12, v107, 1262486016
    v_or3_b32 v5, v10, v106, v5
    v_or3_b32 v5, v11, v107, v5
    v_perm_b32 v106, v106, v10, s43
    v_perm_b32 v107, v107, v11, s43
    v_lshlrev_b32_sdwa v6, 2, v124 dst_sel:DWORD dst_unused:UNUSED_PAD src0_sel:DWORD src1_sel:WORD_0
    v_lshlrev_b32_sdwa v7, 2, v124 dst_sel:DWORD dst_unused:UNUSED_PAD src0_sel:DWORD src1_sel:WORD_1
    v_lshlrev_b32_sdwa v8, 2, v125 dst_sel:DWORD dst_unused:UNUSED_PAD src0_sel:DWORD src1_sel:WORD_0
    v_lshlrev_b32_sdwa v9, 2, v125 dst_sel:DWORD dst_unused:UNUSED_PAD src0_sel:DWORD src1_sel:WORD_1
    ds_write_b32 v6, v73
    ds_write_b32 v7, v74
    ds_write_b32 v8, v76
    ds_write_b32 v9, v77
    v_lshlrev_b32_sdwa v6, 2, v126 dst_sel:DWORD dst_unused:UNUSED_PAD src0_sel:DWORD src1_sel:WORD_0
    v_lshlrev_b32_sdwa v7, 2, v126 dst_sel:DWORD dst_unused:UNUSED_PAD src0_sel:DWORD src1_sel:WORD_1
    v_lshlrev_b32_sdwa v8, 2, v75 dst_sel:DWORD dst_unused:UNUSED_PAD src0_sel:DWORD src1_sel:WORD_0
    v_lshlrev_b32_sdwa v9, 2, v75 dst_sel:DWORD dst_unused:UNUSED_PAD src0_sel:DWORD src1_sel:WORD_1
    ds_write_b32 v6, v78
    ds_write_b32 v7, v80
    ds_write_b32 v8, v81
    ds_write_b32 v9, v82
    s_waitcnt vmcnt(7)
    v_lshlrev_b32 v10, 16, v108
    v_lshlrev_b32 v11, 16, v109
    v_and_b32 v108, 0xffff0000, v108
    v_and_b32 v109, 0xffff0000, v109
    v_mul_f32 v10, s41, v10
    v_mul_f32 v108, s41, v108
    v_mul_f32 v11, s41, v11
    v_mul_f32 v109, s41, v109
    v_fract_f32 v10, v10
    v_fract_f32 v108, v108
    v_fract_f32 v11, v11
    v_fract_f32 v109, v109
    v_cos_f32 v10, v10
    v_cos_f32 v108, v108
    v_cos_f32 v11, v11
    v_cos_f32 v109, v109
    v_fmaak_f32 v10, v12, v10, 1262486016
    v_fmaak_f32 v108, v12, v108, 1262486016
    v_fmaak_f32 v11, v12, v11, 1262486016
    v_fmaak_f32 v109, v12, v109, 1262486016
    v_or3_b32 v5, v10, v108, v5
    v_or3_b32 v5, v11, v109, v5
    v_perm_b32 v108, v108, v10, s43
    v_perm_b32 v109, v109, v11, s43
    s_add_u32 s35, s33, 45154304
    buffer_load_dwordx4 v[24:27], v1, s[8:11], s35 offen nt
    v_lshlrev_b32_sdwa v6, 2, v79 dst_sel:DWORD dst_unused:UNUSED_PAD src0_sel:DWORD src1_sel:WORD_0
    v_lshlrev_b32_sdwa v7, 2, v79 dst_sel:DWORD dst_unused:UNUSED_PAD src0_sel:DWORD src1_sel:WORD_1
    v_lshlrev_b32_sdwa v8, 2, v83 dst_sel:DWORD dst_unused:UNUSED_PAD src0_sel:DWORD src1_sel:WORD_0
    v_lshlrev_b32_sdwa v9, 2, v83 dst_sel:DWORD dst_unused:UNUSED_PAD src0_sel:DWORD src1_sel:WORD_1
    ds_write_b32 v6, v84
    ds_write_b32 v7, v85
    ds_write_b32 v8, v86
    ds_write_b32 v9, v88
    s_waitcnt vmcnt(7)
    v_lshlrev_b32 v10, 16, v110
    v_lshlrev_b32 v11, 16, v111
    v_and_b32 v110, 0xffff0000, v110
    v_and_b32 v111, 0xffff0000, v111
    v_mul_f32 v10, s41, v10
    v_mul_f32 v110, s41, v110
    v_mul_f32 v11, s41, v11
    v_mul_f32 v111, s41, v111
    v_fract_f32 v10, v10
    v_fract_f32 v110, v110
    v_fract_f32 v11, v11
    v_fract_f32 v111, v111
    v_cos_f32 v10, v10
    v_cos_f32 v110, v110
    v_cos_f32 v11, v11
    v_cos_f32 v111, v111
    v_fmaak_f32 v10, v12, v10, 1262486016
    v_fmaak_f32 v110, v12, v110, 1262486016
    v_fmaak_f32 v11, v12, v11, 1262486016
    v_fmaak_f32 v111, v12, v111, 1262486016
    v_or3_b32 v5, v10, v110, v5
    v_or3_b32 v5, v11, v111, v5
    v_perm_b32 v110, v110, v10, s43
    v_perm_b32 v111, v111, v11, s43
    v_lshlrev_b32_sdwa v6, 2, v87 dst_sel:DWORD dst_unused:UNUSED_PAD src0_sel:DWORD src1_sel:WORD_0
    v_lshlrev_b32_sdwa v7, 2, v87 dst_sel:DWORD dst_unused:UNUSED_PAD src0_sel:DWORD src1_sel:WORD_1
    v_lshlrev_b32_sdwa v8, 2, v91 dst_sel:DWORD dst_unused:UNUSED_PAD src0_sel:DWORD src1_sel:WORD_0
    v_lshlrev_b32_sdwa v9, 2, v91 dst_sel:DWORD dst_unused:UNUSED_PAD src0_sel:DWORD src1_sel:WORD_1
    ds_write_b32 v6, v89
    ds_write_b32 v7, v90
    ds_write_b32 v8, v92
    ds_write_b32 v9, v93
    s_mov_b64 exec, s[44:45]
    v_lshlrev_b32_sdwa v6, 2, v95 dst_sel:DWORD dst_unused:UNUSED_PAD src0_sel:DWORD src1_sel:WORD_0
    v_lshlrev_b32_sdwa v7, 2, v95 dst_sel:DWORD dst_unused:UNUSED_PAD src0_sel:DWORD src1_sel:WORD_1
    v_lshlrev_b32_sdwa v8, 2, v99 dst_sel:DWORD dst_unused:UNUSED_PAD src0_sel:DWORD src1_sel:WORD_0
    v_lshlrev_b32_sdwa v9, 2, v99 dst_sel:DWORD dst_unused:UNUSED_PAD src0_sel:DWORD src1_sel:WORD_1
    ds_write_b32 v6, v94
    ds_write_b32 v7, v96
    ds_write_b32 v8, v97
    ds_write_b32 v9, v98
    s_mov_b64 exec, -1
    s_waitcnt vmcnt(6)
    v_lshlrev_b32 v10, 16, v112
    v_lshlrev_b32 v11, 16, v113
    v_and_b32 v112, 0xffff0000, v112
    v_and_b32 v113, 0xffff0000, v113
    v_mul_f32 v10, s41, v10
    v_mul_f32 v112, s41, v112
    v_mul_f32 v11, s41, v11
    v_mul_f32 v113, s41, v113
    v_fract_f32 v10, v10
    v_fract_f32 v112, v112
    v_fract_f32 v11, v11
    v_fract_f32 v113, v113
    v_cos_f32 v10, v10
    v_cos_f32 v112, v112
    v_cos_f32 v11, v11
    v_cos_f32 v113, v113
    v_fmaak_f32 v10, v12, v10, 1262486016
    v_fmaak_f32 v112, v12, v112, 1262486016
    v_fmaak_f32 v11, v12, v11, 1262486016
    v_fmaak_f32 v113, v12, v113, 1262486016
    v_or3_b32 v5, v10, v112, v5
    v_or3_b32 v5, v11, v113, v5
    v_perm_b32 v112, v112, v10, s43
    v_perm_b32 v113, v113, v11, s43
    s_mov_b64 exec, s[44:45]
    s_mov_b64 exec, -1
    s_add_u32 s35, s33, 45154304
    buffer_load_dwordx4 v[28:31], v1, s[12:15], s35 offen nt
    s_mul_i32 s35, s39, 9216
    v_mad_u32_u24 v6, v0, 12, s35
    s_waitcnt lgkmcnt(0)
    s_barrier
    s_cmp_lg_u32 s39, 15
    s_cbranch_scc1 L_p1_kernel_nox_3
    ds_read_b32 v12, v6 offset:9984
    ds_read_b32 v13, v6 offset:9988
    ds_read_b32 v14, v6 offset:9992
L_p1_kernel_nox_3:
    ds_read_b32 v48, v6 offset:1536
    ds_read_b32 v49, v6 offset:1540
    ds_read_b32 v50, v6 offset:1544
    ds_read_b32 v52, v6 offset:3072
    ds_read_b32 v53, v6 offset:3076
    ds_read_b32 v54, v6 offset:3080
    ds_read_b32 v56, v6 offset:4608
    ds_read_b32 v57, v6 offset:4612
    ds_read_b32 v58, v6 offset:4616
    ds_read_b32 v60, v6 offset:6144
    ds_read_b32 v61, v6 offset:6148
    ds_read_b32 v62, v6 offset:6152
    ds_read_b32 v64, v6 offset:7680
    ds_read_b32 v65, v6 offset:7684
    ds_read_b32 v66, v6 offset:7688
    ds_read_b32 v68, v6 offset:9216
    ds_read_b32 v69, v6 offset:9220
    ds_read_b32 v70, v6 offset:9224
    ds_read_b32 v72, v6 offset:0
    ds_read_b32 v73, v6 offset:4
    ds_read_b32 v74, v6 offset:8
    ds_read_b32 v76, v6 offset:768
    ds_read_b32 v77, v6 offset:772
    ds_read_b32 v78, v6 offset:776
    ds_read_b32 v80, v6 offset:2304
    ds_read_b32 v81, v6 offset:2308
    ds_read_b32 v82, v6 offset:2312
    ds_read_b32 v84, v6 offset:3840
    ds_read_b32 v85, v6 offset:3844
    ds_read_b32 v86, v6 offset:3848
    ds_read_b32 v88, v6 offset:5376
    ds_read_b32 v89, v6 offset:5380
    ds_read_b32 v90, v6 offset:5384
    ds_read_b32 v92, v6 offset:6912
    ds_read_b32 v93, v6 offset:6916
    ds_read_b32 v94, v6 offset:6920
    ds_read_b32 v96, v6 offset:8448
    ds_read_b32 v97, v6 offset:8452
    ds_read_b32 v98, v6 offset:8456
    s_add_u32 s35, s33, 49348608
    buffer_load_dwordx4 v[32:35], v1, s[8:11], s35 offen nt
    v_mov_b32 v8, 0
    v_mov_b32 v9, 0
    v_mov_b32 v10, 0
    v_mov_b32 v11, 0
    v_mov_b32 v15, 16384
    s_waitcnt lgkmcnt(0)
    s_barrier
    ds_write_b128 v1, v[8:11] offset:0
    s_nop 1
    v_mad_u32_u16 v6, v51, s50, v15 op_sel:[0,0,0,0]
    v_mad_u32_u16 v7, v51, s50, v15 op_sel:[1,0,0,0]
    v_mad_u32_u16 v8, v55, s50, v15 op_sel:[0,0,0,0]
    v_mad_u32_u16 v9, v55, s50, v15 op_sel:[1,0,0,0]
    v_add_u32_sdwa v6, v6, v51 dst_sel:DWORD dst_unused:UNUSED_PAD src0_sel:WORD_1 src1_sel:WORD_0
    v_add_u32_sdwa v7, v7, v51 dst_sel:DWORD dst_unused:UNUSED_PAD src0_sel:WORD_1 src1_sel:WORD_1
    v_add_u32_sdwa v8, v8, v55 dst_sel:DWORD dst_unused:UNUSED_PAD src0_sel:WORD_1 src1_sel:WORD_0
    v_add_u32_sdwa v9, v9, v55 dst_sel:DWORD dst_unused:UNUSED_PAD src0_sel:WORD_1 src1_sel:WORD_1
    v_add_u32 v6, v6, v6
    v_add_u32 v7, v7, v7
    v_add_u32 v8, v8, v8
    v_add_u32 v9, v9, v9
    ds_write_b16 v6, v100 offset:16384
    ds_write_b16_d16_hi v7, v100 offset:16384
    ds_write_b16 v8, v101 offset:16384
    ds_write_b16_d16_hi v9, v101 offset:16384
    v_mov_b32 v6, 1140817920
    s_waitcnt vmcnt(7)
    v_lshlrev_b32 v10, 16, v114
    v_lshlrev_b32 v11, 16, v115
    v_and_b32 v114, 0xffff0000, v114
    v_and_b32 v115, 0xffff0000, v115
    v_mul_f32 v10, s41, v10
    v_mul_f32 v114, s41, v114
    v_mul_f32 v11, s41, v11
    v_mul_f32 v115, s41, v115
    v_fract_f32 v10, v10
    v_fract_f32 v114, v114
    v_fract_f32 v11, v11
    v_fract_f32 v115, v115
    v_cos_f32 v10, v10
    v_cos_f32 v114, v114
    v_cos_f32 v11, v11
    v_cos_f32 v115, v115
    v_fmaak_f32 v10, v6, v10, 1262486016
    v_fmaak_f32 v114, v6, v114, 1262486016
    v_fmaak_f32 v11, v6, v11, 1262486016
    v_fmaak_f32 v115, v6, v115, 1262486016
    v_or3_b32 v5, v10, v114, v5
    v_or3_b32 v5, v11, v115, v5
    v_perm_b32 v114, v114, v10, s43
    v_perm_b32 v115, v115, v11, s43
    v_mad_u32_u16 v6, v59, s50, v15 op_sel:[0,0,0,0]
    v_mad_u32_u16 v7, v59, s50, v15 op_sel:[1,0,0,0]
    v_mad_u32_u16 v8, v63, s50, v15 op_sel:[0,0,0,0]
    v_mad_u32_u16 v9, v63, s50, v15 op_sel:[1,0,0,0]
    v_add_u32_sdwa v6, v6, v59 dst_sel:DWORD dst_unused:UNUSED_PAD src0_sel:WORD_1 src1_sel:WORD_0
    v_add_u32_sdwa v7, v7, v59 dst_sel:DWORD dst_unused:UNUSED_PAD src0_sel:WORD_1 src1_sel:WORD_1
    v_add_u32_sdwa v8, v8, v63 dst_sel:DWORD dst_unused:UNUSED_PAD src0_sel:WORD_1 src1_sel:WORD_0
    v_add_u32_sdwa v9, v9, v63 dst_sel:DWORD dst_unused:UNUSED_PAD src0_sel:WORD_1 src1_sel:WORD_1
    v_add_u32 v6, v6, v6
    v_add_u32 v7, v7, v7
    v_add_u32 v8, v8, v8
    v_add_u32 v9, v9, v9
    ds_write_b16 v6, v102 offset:16384
    ds_write_b16_d16_hi v7, v102 offset:16384
    ds_write_b16 v8, v103 offset:16384
    ds_write_b16_d16_hi v9, v103 offset:16384
    v_mad_u32_u16 v6, v67, s50, v15 op_sel:[0,0,0,0]
    v_mad_u32_u16 v7, v67, s50, v15 op_sel:[1,0,0,0]
    v_mad_u32_u16 v8, v71, s50, v15 op_sel:[0,0,0,0]
    v_mad_u32_u16 v9, v71, s50, v15 op_sel:[1,0,0,0]
    v_add_u32_sdwa v6, v6, v67 dst_sel:DWORD dst_unused:UNUSED_PAD src0_sel:WORD_1 src1_sel:WORD_0
    v_add_u32_sdwa v7, v7, v67 dst_sel:DWORD dst_unused:UNUSED_PAD src0_sel:WORD_1 src1_sel:WORD_1
    v_add_u32_sdwa v8, v8, v71 dst_sel:DWORD dst_unused:UNUSED_PAD src0_sel:WORD_1 src1_sel:WORD_0
    v_add_u32_sdwa v9, v9, v71 dst_sel:DWORD dst_unused:UNUSED_PAD src0_sel:WORD_1 src1_sel:WORD_1
    v_add_u32 v6, v6, v6
    v_add_u32 v7, v7, v7
    v_add_u32 v8, v8, v8
    v_add_u32 v9, v9, v9
    ds_write_b16 v6, v104 offset:16384
    ds_write_b16_d16_hi v7, v104 offset:16384
    ds_write_b16 v8, v105 offset:16384
    ds_write_b16_d16_hi v9, v105 offset:16384
    s_add_u32 s35, s33, 49348608
    buffer_load_dwordx4 v[36:39], v1, s[12:15], s35 offen nt
    v_mad_u32_u16 v6, v120, s50, v15 op_sel:[0,0,0,0]
    v_mad_u32_u16 v7, v120, s50, v15 op_sel:[1,0,0,0]
    v_mad_u32_u16 v8, v121, s50, v15 op_sel:[0,0,0,0]
    v_mad_u32_u16 v9, v121, s50, v15 op_sel:[1,0,0,0]
    v_add_u32_sdwa v6, v6, v120 dst_sel:DWORD dst_unused:UNUSED_PAD src0_sel:WORD_1 src1_sel:WORD_0
    v_add_u32_sdwa v7, v7, v120 dst_sel:DWORD dst_unused:UNUSED_PAD src0_sel:WORD_1 src1_sel:WORD_1
    v_add_u32_sdwa v8, v8, v121 dst_sel:DWORD dst_unused:UNUSED_PAD src0_sel:WORD_1 src1_sel:WORD_0
    v_add_u32_sdwa v9, v9, v121 dst_sel:DWORD dst_unused:UNUSED_PAD src0_sel:WORD_1 src1_sel:WORD_1
    v_add_u32 v6, v6, v6
    v_add_u32 v7, v7, v7
    v_add_u32 v8, v8, v8
    v_add_u32 v9, v9, v9
    ds_write_b16 v6, v106 offset:16384
    ds_write_b16_d16_hi v7, v106 offset:16384
    ds_write_b16 v8, v107 offset:16384
    ds_write_b16_d16_hi v9, v107 offset:16384
    v_mov_b32 v6, 1140817920
    s_waitcnt vmcnt(7)
    v_lshlrev_b32 v10, 16, v116
    v_lshlrev_b32 v11, 16, v117
    v_and_b32 v116, 0xffff0000, v116
    v_and_b32 v117, 0xffff0000, v117
    v_mul_f32 v10, s41, v10
    v_mul_f32 v116, s41, v116
    v_mul_f32 v11, s41, v11
    v_mul_f32 v117, s41, v117
    v_fract_f32 v10, v10
    v_fract_f32 v116, v116
    v_fract_f32 v11, v11
    v_fract_f32 v117, v117
    v_cos_f32 v10, v10
    v_cos_f32 v116, v116
    v_cos_f32 v11, v11
    v_cos_f32 v117, v117
    v_fmaak_f32 v10, v6, v10, 1262486016
    v_fmaak_f32 v116, v6, v116, 1262486016
    v_fmaak_f32 v11, v6, v11, 1262486016
    v_fmaak_f32 v117, v6, v117, 1262486016
    v_or3_b32 v5, v10, v116, v5
    v_or3_b32 v5, v11, v117, v5
    v_perm_b32 v116, v116, v10, s43
    v_perm_b32 v117, v117, v11, s43
    v_mad_u32_u16 v6, v122, s50, v15 op_sel:[0,0,0,0]
    v_mad_u32_u16 v7, v122, s50, v15 op_sel:[1,0,0,0]
    v_mad_u32_u16 v8, v123, s50, v15 op_sel:[0,0,0,0]
    v_mad_u32_u16 v9, v123, s50, v15 op_sel:[1,0,0,0]
    v_add_u32_sdwa v6, v6, v122 dst_sel:DWORD dst_unused:UNUSED_PAD src0_sel:WORD_1 src1_sel:WORD_0
    v_add_u32_sdwa v7, v7, v122 dst_sel:DWORD dst_unused:UNUSED_PAD src0_sel:WORD_1 src1_sel:WORD_1
    v_add_u32_sdwa v8, v8, v123 dst_sel:DWORD dst_unused:UNUSED_PAD src0_sel:WORD_1 src1_sel:WORD_0
    v_add_u32_sdwa v9, v9, v123 dst_sel:DWORD dst_unused:UNUSED_PAD src0_sel:WORD_1 src1_sel:WORD_1
    v_add_u32 v6, v6, v6
    v_add_u32 v7, v7, v7
    v_add_u32 v8, v8, v8
    v_add_u32 v9, v9, v9
    ds_write_b16 v6, v108 offset:16384
    ds_write_b16_d16_hi v7, v108 offset:16384
    ds_write_b16 v8, v109 offset:16384
    ds_write_b16_d16_hi v9, v109 offset:16384
    v_mad_u32_u16 v6, v124, s50, v15 op_sel:[0,0,0,0]
    v_mad_u32_u16 v7, v124, s50, v15 op_sel:[1,0,0,0]
    v_mad_u32_u16 v8, v125, s50, v15 op_sel:[0,0,0,0]
    v_mad_u32_u16 v9, v125, s50, v15 op_sel:[1,0,0,0]
    v_add_u32_sdwa v6, v6, v124 dst_sel:DWORD dst_unused:UNUSED_PAD src0_sel:WORD_1 src1_sel:WORD_0
    v_add_u32_sdwa v7, v7, v124 dst_sel:DWORD dst_unused:UNUSED_PAD src0_sel:WORD_1 src1_sel:WORD_1
    v_add_u32_sdwa v8, v8, v125 dst_sel:DWORD dst_unused:UNUSED_PAD src0_sel:WORD_1 src1_sel:WORD_0
    v_add_u32_sdwa v9, v9, v125 dst_sel:DWORD dst_unused:UNUSED_PAD src0_sel:WORD_1 src1_sel:WORD_1
    v_add_u32 v6, v6, v6
    v_add_u32 v7, v7, v7
    v_add_u32 v8, v8, v8
    v_add_u32 v9, v9, v9
    ds_write_b16 v6, v110 offset:16384
    ds_write_b16_d16_hi v7, v110 offset:16384
    ds_write_b16 v8, v111 offset:16384
    ds_write_b16_d16_hi v9, v111 offset:16384
    s_add_u32 s35, s33, 53542912
    buffer_load_dwordx4 v[40:43], v1, s[8:11], s35 offen nt
    v_mad_u32_u16 v6, v126, s50, v15 op_sel:[0,0,0,0]
    v_mad_u32_u16 v7, v126, s50, v15 op_sel:[1,0,0,0]
    v_mad_u32_u16 v8, v75, s50, v15 op_sel:[0,0,0,0]
    v_mad_u32_u16 v9, v75, s50, v15 op_sel:[1,0,0,0]
    v_add_u32_sdwa v6, v6, v126 dst_sel:DWORD dst_unused:UNUSED_PAD src0_sel:WORD_1 src1_sel:WORD_0
    v_add_u32_sdwa v7, v7, v126 dst_sel:DWORD dst_unused:UNUSED_PAD src0_sel:WORD_1 src1_sel:WORD_1
    v_add_u32_sdwa v8, v8, v75 dst_sel:DWORD dst_unused:UNUSED_PAD src0_sel:WORD_1 src1_sel:WORD_0
    v_add_u32_sdwa v9, v9, v75 dst_sel:DWORD dst_unused:UNUSED_PAD src0_sel:WORD_1 src1_sel:WORD_1
    v_add_u32 v6, v6, v6
    v_add_u32 v7, v7, v7
    v_add_u32 v8, v8, v8
    v_add_u32 v9, v9, v9
    ds_write_b16 v6, v112 offset:16384
    ds_write_b16_d16_hi v7, v112 offset:16384
    ds_write_b16 v8, v113 offset:16384
    ds_write_b16_d16_hi v9, v113 offset:16384
    v_mov_b32 v6, 1140817920
    s_mov_b64 exec, s[44:45]
    s_waitcnt vmcnt(7)
    v_lshlrev_b32 v10, 16, v118
    v_lshlrev_b32 v11, 16, v119
    v_and_b32 v118, 0xffff0000, v118
    v_and_b32 v119, 0xffff0000, v119
    v_mul_f32 v10, s41, v10
    v_mul_f32 v118, s41, v118
    v_mul_f32 v11, s41, v11
    v_mul_f32 v119, s41, v119
    v_fract_f32 v10, v10
    v_fract_f32 v118, v118
    v_fract_f32 v11, v11
    v_fract_f32 v119, v119
    v_cos_f32 v10, v10
    v_cos_f32 v118, v118
    v_cos_f32 v11, v11
    v_cos_f32 v119, v119
    v_fmaak_f32 v10, v6, v10, 1262486016
    v_fmaak_f32 v118, v6, v118, 1262486016
    v_fmaak_f32 v11, v6, v11, 1262486016
    v_fmaak_f32 v119, v6, v119, 1262486016
    v_or3_b32 v5, v10, v118, v5
    v_or3_b32 v5, v11, v119, v5
    v_perm_b32 v118, v118, v10, s43
    v_perm_b32 v119, v119, v11, s43
    s_mov_b64 exec, -1
    v_mad_u32_u16 v6, v79, s50, v15 op_sel:[0,0,0,0]
    v_mad_u32_u16 v7, v79, s50, v15 op_sel:[1,0,0,0]
    v_mad_u32_u16 v8, v83, s50, v15 op_sel:[0,0,0,0]
    v_mad_u32_u16 v9, v83, s50, v15 op_sel:[1,0,0,0]
    v_add_u32_sdwa v6, v6, v79 dst_sel:DWORD dst_unused:UNUSED_PAD src0_sel:WORD_1 src1_sel:WORD_0
    v_add_u32_sdwa v7, v7, v79 dst_sel:DWORD dst_unused:UNUSED_PAD src0_sel:WORD_1 src1_sel:WORD_1
    v_add_u32_sdwa v8, v8, v83 dst_sel:DWORD dst_unused:UNUSED_PAD src0_sel:WORD_1 src1_sel:WORD_0
    v_add_u32_sdwa v9, v9, v83 dst_sel:DWORD dst_unused:UNUSED_PAD src0_sel:WORD_1 src1_sel:WORD_1
    v_add_u32 v6, v6, v6
    v_add_u32 v7, v7, v7
    v_add_u32 v8, v8, v8
    v_add_u32 v9, v9, v9
    ds_write_b16 v6, v114 offset:16384
    ds_write_b16_d16_hi v7, v114 offset:16384
    ds_write_b16 v8, v115 offset:16384
    ds_write_b16_d16_hi v9, v115 offset:16384
    v_mad_u32_u16 v6, v87, s50, v15 op_sel:[0,0,0,0]
    v_mad_u32_u16 v7, v87, s50, v15 op_sel:[1,0,0,0]
    v_mad_u32_u16 v8, v91, s50, v15 op_sel:[0,0,0,0]
    v_mad_u32_u16 v9, v91, s50, v15 op_sel:[1,0,0,0]
    v_add_u32_sdwa v6, v6, v87 dst_sel:DWORD dst_unused:UNUSED_PAD src0_sel:WORD_1 src1_sel:WORD_0
    v_add_u32_sdwa v7, v7, v87 dst_sel:DWORD dst_unused:UNUSED_PAD src0_sel:WORD_1 src1_sel:WORD_1
    v_add_u32_sdwa v8, v8, v91 dst_sel:DWORD dst_unused:UNUSED_PAD src0_sel:WORD_1 src1_sel:WORD_0
    v_add_u32_sdwa v9, v9, v91 dst_sel:DWORD dst_unused:UNUSED_PAD src0_sel:WORD_1 src1_sel:WORD_1
    v_add_u32 v6, v6, v6
    v_add_u32 v7, v7, v7
    v_add_u32 v8, v8, v8
    v_add_u32 v9, v9, v9
    ds_write_b16 v6, v116 offset:16384
    ds_write_b16_d16_hi v7, v116 offset:16384
    ds_write_b16 v8, v117 offset:16384
    ds_write_b16_d16_hi v9, v117 offset:16384
    s_add_u32 s35, s33, 53542912
    buffer_load_dwordx4 v[44:47], v1, s[12:15], s35 offen nt
    s_mov_b64 exec, s[44:45]
    v_mad_u32_u16 v6, v95, s50, v15 op_sel:[0,0,0,0]
    v_mad_u32_u16 v7, v95, s50, v15 op_sel:[1,0,0,0]
    v_mad_u32_u16 v8, v99, s50, v15 op_sel:[0,0,0,0]
    v_mad_u32_u16 v9, v99, s50, v15 op_sel:[1,0,0,0]
    v_add_u32_sdwa v6, v6, v95 dst_sel:DWORD dst_unused:UNUSED_PAD src0_sel:WORD_1 src1_sel:WORD_0
    v_add_u32_sdwa v7, v7, v95 dst_sel:DWORD dst_unused:UNUSED_PAD src0_sel:WORD_1 src1_sel:WORD_1
    v_add_u32_sdwa v8, v8, v99 dst_sel:DWORD dst_unused:UNUSED_PAD src0_sel:WORD_1 src1_sel:WORD_0
    v_add_u32_sdwa v9, v9, v99 dst_sel:DWORD dst_unused:UNUSED_PAD src0_sel:WORD_1 src1_sel:WORD_1
    v_add_u32 v6, v6, v6
    v_add_u32 v7, v7, v7
    v_add_u32 v8, v8, v8
    v_add_u32 v9, v9, v9
    ds_write_b16 v6, v118 offset:16384
    ds_write_b16_d16_hi v7, v118 offset:16384
    ds_write_b16 v8, v119 offset:16384
    ds_write_b16_d16_hi v9, v119 offset:16384
    s_mov_b64 exec, -1
    s_mul_i32 s35, s39, 6144
    v_add_u32 v6, s35, v2
    s_waitcnt lgkmcnt(0)
    s_barrier
    ds_read_b64 v[100:101], v6 offset:23040
    ds_read_b64 v[102:103], v6 offset:16384
    ds_read_b64 v[104:105], v6 offset:16896
    ds_read_b64 v[106:107], v6 offset:17408
    ds_read_b64 v[108:109], v6 offset:17920
    ds_read_b64 v[110:111], v6 offset:18432
    ds_read_b64 v[112:113], v6 offset:18944
    ds_read_b64 v[114:115], v6 offset:19456
    ds_read_b64 v[116:117], v6 offset:19968
    ds_read_b64 v[118:119], v6 offset:20480
    ds_read_b64 v[120:121], v6 offset:20992
    ds_read_b64 v[122:123], v6 offset:21504
    ds_read_b64 v[124:125], v6 offset:22016
    ds_read_b64 v[126:127], v6 offset:22528
    s_add_u32 s32, s32, 256
    s_add_u32 s33, s33, 40960000
    s_add_u32 s34, s34, 20480000
    s_add_u32 s40, s40, 1
    s_cmp_lt_u32 s40, 4
    s_cbranch_scc1 L_p1_loop
    s_waitcnt lgkmcnt(13)
    v_lshlrev_b32 v15, 22, v100
    v_lshrrev_b32 v100, 16, v100
    v_alignbit_b32 v15, v100, v15, 10
    v_alignbit_b32 v15, v101, v15, 10
    v_xor_b32 v15, 0x80200800, v15
    s_cmp_lg_u32 s39, 15
    s_cbranch_scc1 L_p1_kernel_nox_4
    s_mov_b32 s36, 13631488
    buffer_store_dwordx4 v[12:15], v3, s[20:23], s36 offen sc1
L_p1_kernel_nox_4:
    s_waitcnt lgkmcnt(12)
    v_lshlrev_b32 v75, 22, v102
    v_lshrrev_b32 v102, 16, v102
    v_alignbit_b32 v75, v102, v75, 10
    v_alignbit_b32 v75, v103, v75, 10
    v_xor_b32 v75, 0x80200800, v75
    s_mov_b32 s36, 0
    buffer_store_dwordx4 v[72:75], v3, s[20:23], s36 offen sc1
    s_waitcnt lgkmcnt(11)
    v_lshlrev_b32 v79, 22, v104
    v_lshrrev_b32 v104, 16, v104
    v_alignbit_b32 v79, v104, v79, 10
    v_alignbit_b32 v79, v105, v79, 10
    v_xor_b32 v79, 0x80200800, v79
    s_mov_b32 s36, 1048576
    buffer_store_dwordx4 v[76:79], v3, s[20:23], s36 offen sc1
    s_waitcnt lgkmcnt(10)
    v_lshlrev_b32 v51, 22, v106
    v_lshrrev_b32 v106, 16, v106
    v_alignbit_b32 v51, v106, v51, 10
    v_alignbit_b32 v51, v107, v51, 10
    v_xor_b32 v51, 0x80200800, v51
    s_mov_b32 s36, 2097152
    buffer_store_dwordx4 v[48:51], v3, s[20:23], s36 offen sc1
    s_waitcnt lgkmcnt(9)
    v_lshlrev_b32 v83, 22, v108
    v_lshrrev_b32 v108, 16, v108
    v_alignbit_b32 v83, v108, v83, 10
    v_alignbit_b32 v83, v109, v83, 10
    v_xor_b32 v83, 0x80200800, v83
    s_mov_b32 s36, 3145728
    buffer_store_dwordx4 v[80:83], v3, s[20:23], s36 offen sc1
    s_waitcnt lgkmcnt(8)
    v_lshlrev_b32 v55, 22, v110
    v_lshrrev_b32 v110, 16, v110
    v_alignbit_b32 v55, v110, v55, 10
    v_alignbit_b32 v55, v111, v55, 10
    v_xor_b32 v55, 0x80200800, v55
    s_mov_b32 s36, 4194304
    buffer_store_dwordx4 v[52:55], v3, s[20:23], s36 offen sc1
    s_waitcnt lgkmcnt(7)
    v_lshlrev_b32 v87, 22, v112
    v_lshrrev_b32 v112, 16, v112
    v_alignbit_b32 v87, v112, v87, 10
    v_alignbit_b32 v87, v113, v87, 10
    v_xor_b32 v87, 0x80200800, v87
    s_mov_b32 s36, 5242880
    buffer_store_dwordx4 v[84:87], v3, s[20:23], s36 offen sc1
    s_waitcnt lgkmcnt(6)
    v_lshlrev_b32 v59, 22, v114
    v_lshrrev_b32 v114, 16, v114
    v_alignbit_b32 v59, v114, v59, 10
    v_alignbit_b32 v59, v115, v59, 10
    v_xor_b32 v59, 0x80200800, v59
    s_mov_b32 s36, 6291456
    buffer_store_dwordx4 v[56:59], v3, s[20:23], s36 offen sc1
    s_waitcnt lgkmcnt(5)
    v_lshlrev_b32 v91, 22, v116
    v_lshrrev_b32 v116, 16, v116
    v_alignbit_b32 v91, v116, v91, 10
    v_alignbit_b32 v91, v117, v91, 10
    v_xor_b32 v91, 0x80200800, v91
    s_mov_b32 s36, 7340032
    buffer_store_dwordx4 v[88:91], v3, s[20:23], s36 offen sc1
    s_waitcnt lgkmcnt(4)
    v_lshlrev_b32 v63, 22, v118
    v_lshrrev_b32 v118, 16, v118
    v_alignbit_b32 v63, v118, v63, 10
    v_alignbit_b32 v63, v119, v63, 10
    v_xor_b32 v63, 0x80200800, v63
    s_mov_b32 s36, 8388608
    buffer_store_dwordx4 v[60:63], v3, s[20:23], s36 offen sc1
    s_waitcnt lgkmcnt(3)
    v_lshlrev_b32 v95, 22, v120
    v_lshrrev_b32 v120, 16, v120
    v_alignbit_b32 v95, v120, v95, 10
    v_alignbit_b32 v95, v121, v95, 10
    v_xor_b32 v95, 0x80200800, v95
    s_mov_b32 s36, 9437184
    buffer_store_dwordx4 v[92:95], v3, s[20:23], s36 offen sc1
    s_waitcnt lgkmcnt(2)
    v_lshlrev_b32 v67, 22, v122
    v_lshrrev_b32 v122, 16, v122
    v_alignbit_b32 v67, v122, v67, 10
    v_alignbit_b32 v67, v123, v67, 10
    v_xor_b32 v67, 0x80200800, v67
    s_mov_b32 s36, 10485760
    buffer_store_dwordx4 v[64:67], v3, s[20:23], s36 offen sc1
    s_waitcnt lgkmcnt(1)
    v_lshlrev_b32 v99, 22, v124
    v_lshrrev_b32 v124, 16, v124
    v_alignbit_b32 v99, v124, v99, 10
    v_alignbit_b32 v99, v125, v99, 10
    v_xor_b32 v99, 0x80200800, v99
    s_mov_b32 s36, 11534336
    buffer_store_dwordx4 v[96:99], v3, s[20:23], s36 offen sc1
    s_waitcnt lgkmcnt(0)
    v_lshlrev_b32 v71, 22, v126
    v_lshrrev_b32 v126, 16, v126
    v_alignbit_b32 v71, v126, v71, 10
    v_alignbit_b32 v71, v127, v71, 10
    v_xor_b32 v71, 0x80200800, v71
    s_mov_b32 s36, 12582912
    buffer_store_dwordx4 v[68:71], v3, s[20:23], s36 offen sc1
    v_and_b32 v6, 0x34800000, v5
    v_cmp_ne_u32 vcc, 0, v6
    s_lshl_b32 s35, s39, 4
    s_add_u32 s35, s35, 160328
    v_mov_b32 v10, s35
    s_cmp_lg_u64 vcc, 0
    s_cselect_b32 s36, 1, s55
    v_mov_b32 v11, s36
    ds_write_b32 v10, v11
    s_waitcnt lgkmcnt(0)
    s_barrier
    s_cmp_lg_u32 s39, 0
    s_cbranch_scc1 L_p1_end
    v_and_b32 v6, 15, v0
    v_lshlrev_b32 v6, 4, v6
    v_add_u32 v6, 160320, v6
    ds_read_b128 v[8:11], v6
    s_waitcnt lgkmcnt(0)
    s_nop 1
    v_max_u32_dpp v8, v8, v8 row_shr:1 row_mask:0xf bank_mask:0xf bound_ctrl:0
    s_nop 1
    v_max_u32_dpp v8, v8, v8 row_shr:2 row_mask:0xf bank_mask:0xf bound_ctrl:0
    s_nop 1
    v_max_u32_dpp v8, v8, v8 row_shr:4 row_mask:0xf bank_mask:0xf bound_ctrl:0
    s_nop 1
    v_max_u32_dpp v8, v8, v8 row_shr:8 row_mask:0xf bank_mask:0xf bound_ctrl:0
    s_nop 1
    v_add_f32_dpp v9, v9, v9 row_shr:1 row_mask:0xf bank_mask:0xf bound_ctrl:0
    s_nop 1
    v_add_f32_dpp v9, v9, v9 row_shr:2 row_mask:0xf bank_mask:0xf bound_ctrl:0
    s_nop 1
    v_add_f32_dpp v9, v9, v9 row_shr:4 row_mask:0xf bank_mask:0xf bound_ctrl:0
    s_nop 1
    v_add_f32_dpp v9, v9, v9 row_shr:8 row_mask:0xf bank_mask:0xf bound_ctrl:0
    s_nop 1
    v_or_b32_dpp v10, v10, v10 row_shr:1 row_mask:0xf bank_mask:0xf bound_ctrl:0
    s_nop 1
    v_or_b32_dpp v10, v10, v10 row_shr:2 row_mask:0xf bank_mask:0xf bound_ctrl:0
    s_nop 1
    v_or_b32_dpp v10, v10, v10 row_shr:4 row_mask:0xf bank_mask:0xf bound_ctrl:0
    s_nop 1
    v_or_b32_dpp v10, v10, v10 row_shr:8 row_mask:0xf bank_mask:0xf bound_ctrl:0
    s_lshl_b32 s35, s2, 3
    s_add_u32 s35, s35, 8552960
    v_mov_b32 v6, 0
    v_lshl_or_b32 v8, v10, 16, v8
    s_mov_b64 exec, 0x8000
    buffer_store_dwordx2 v[8:9], v6, s[24:27], s35 offen
    s_lshl_b32 s35, s2, 8
    s_add_u32 s35, s35, 8557056
    buffer_store_dword v6, v6, s[24:27], s35 offen
L_p1_end:
    s_endpgm
.globl p2_kernel
.p2align 8
.type p2_kernel,@function
p2_kernel:
    s_cmp_ge_u32 s2, 256
    s_cbranch_scc1 L_p2_end
    s_load_dwordx2 s[4:5], s[0:1], 104
    s_load_dwordx2 s[100:101], s[0:1], 24
    s_load_dwordx2 s[30:31], s[0:1], 40
    s_load_dwordx4 s[32:35], s[0:1], 56
    s_load_dwordx4 s[36:39], s[0:1], 72
    s_and_b32 s14, s2, 7
    s_lshr_b32 s49, s2, 3
    s_and_b32 s3, s14, 1
    s_lshl_b32 s3, s3, 5
    s_add_u32 s3, s3, s49
    s_lshr_b32 s12, s14, 1
    v_lshrrev_b32 v108, 6, v0
    v_lshlrev_b32 v1, 4, v0
    v_and_b32 v109, 63, v0
    v_readfirstlane_b32 s13, v108
    v_lshlrev_b32 v111, 4, v109
    v_lshlrev_b32 v110, 5, v0
    s_mul_i32 s14, s12, 65
    s_add_u32 s14, s14, s3
    s_mul_i32 s14, s14, 32896
    s_add_u32 s25, s14, 0
    s_mul_i32 s22, s12, 1280000
    s_mov_b32 s2, 0
    s_waitcnt lgkmcnt(0)
    s_mov_b32 s6, 655360000
    s_mov_b32 s7, 0x00020000
    s_add_u32 s8, s4, 8573440
    s_addc_u32 s9, s5, 0
    s_add_u32 s10, s22, 1280000
    s_mov_b32 s11, 0x00020000
    s_add_u32 s15, s25, 0
    buffer_load_dwordx4 v[28:31], v110, s[4:7], s15 offen
    s_add_u32 s15, s25, 32896
    buffer_load_dwordx4 v[36:39], v110, s[4:7], s15 offen
    s_add_u32 s15, s25, 16
    buffer_load_dwordx4 v[32:35], v110, s[4:7], s15 offen
    s_add_u32 s15, s25, 32912
    buffer_load_dwordx4 v[40:43], v110, s[4:7], s15 offen
    s_load_dwordx4 s[40:43], s[30:31], 0
    s_load_dwordx16 s[52:67], s[32:33], 0
    s_load_dwordx16 s[68:83], s[34:35], 0
    s_load_dwordx8 s[84:91], s[36:37], 0
    s_load_dwordx8 s[92:99], s[38:39], 0
    v_mov_b32 v52, 0x100
    s_cmp_lg_u32 s13, 0
    s_cbranch_scc1 L_p2_noann
    s_lshl_b32 s14, s3, 8
    s_add_u32 s14, s14, 8557056
    s_mov_b64 exec, 1
    buffer_atomic_add v52, off, s[4:7], s14
    s_mov_b64 exec, -1
L_p2_noann:
    s_add_u32 s14, s22, 0
    buffer_load_dwordx4 v[88:91], v1, s[8:11], s14 offen
    s_add_u32 s14, s22, 16384
    buffer_load_dwordx4 v[92:95], v1, s[8:11], s14 offen
    s_add_u32 s14, s22, 32768
    buffer_load_dwordx4 v[96:99], v1, s[8:11], s14 offen
    s_add_u32 s14, s22, 49152
    buffer_load_dwordx4 v[100:103], v1, s[8:11], s14 offen
    s_add_u32 s14, s22, 65536
    buffer_load_dwordx4 v[104:107], v1, s[8:11], s14 offen
    s_mov_b32 s15, 8552960
    buffer_load_dwordx4 v[80:83], v111, s[4:7], s15 offen offset:0
    buffer_load_dwordx4 v[84:87], v111, s[4:7], s15 offen offset:1024
    v_lshlrev_b32 v2, 10, v109
    v_mov_b32 v50, 21845
    v_add_u32 v3, 80000, v1
    v_add_u32 v124, 145536, v1
    v_add_u32 v113, 65536, v1
    v_mov_b32 v112, 0x7f000000
    v_cmp_gt_u32 vcc, 904, v0
    s_mul_i32 s19, s13, 240
    s_add_u32 s19, s19, 160000
    v_cndmask_b32 v124, v112, v124, vcc
    v_cndmask_b32 v113, v112, v113, vcc
    v_lshl_add_u32 v6, v109, 2, s19
    v_lshl_add_u32 v126, v109, 1, s19
    v_cmp_gt_u32 vcc, 10, v109
    s_lshl_b32 s27, s13, 16
    s_mov_b32 s23, 1024
    v_cndmask_b32 v6, v112, v6, vcc
    s_add_u32 s44, s4, 9437184
    s_addc_u32 s45, s5, 1048576
    s_mov_b32 s46, 14024704
    s_mov_b32 s47, 0x00020000
    s_mov_b32 s17, 0x05040100
    s_mov_b32 s18, 80000
    s_and_b32 s50, s3, 1
    s_lshl_b32 s50, s50, 18
    s_sub_u32 s50, 4294836224, s50
    s_mov_b32 s20, 3221209088
    s_mov_b32 s21, 3221209087
    v_mov_b32 v4, 0
    v_mov_b32 v5, 0
    v_mov_b32 v114, 0xff00
    ds_write_b32 v6, v5 offset:160
    ds_write_b16 v126, v114 offset:2
    v_mov_b32 v44, 1073758208
    v_mov_b32 v45, 1073758208
    v_mov_b32 v46, 1073758208
    v_mov_b32 v47, 1073758208
    v_mov_b32 v48, 1073758208
    v_mov_b32 v49, 1073758208
    ds_write_b128 v1, v[44:47] offset:0
    ds_write_b128 v1, v[44:47] offset:16384
    ds_write_b128 v1, v[44:47] offset:32768
    ds_write_b128 v1, v[44:47] offset:49152
    ds_write_b128 v113, v[44:47]
    s_waitcnt lgkmcnt(0)
    v_mov_b32 v53, s40
    v_mov_b32 v54, s41
    v_mov_b32 v56, s42
    v_mov_b32 v57, s43
    s_mov_b32 s40, 20987904
    s_mov_b32 s41, 21031594
    s_pack_ll_b32_b16 s14, s52, s54
    s_pack_hh_b32_b16 s15, s52, s54
    s_pack_ll_b32_b16 s54, s53, s55
    s_pack_hh_b32_b16 s55, s53, s55
    s_mov_b32 s52, s14
    s_mov_b32 s53, s15
    s_pack_ll_b32_b16 s14, s56, s58
    s_pack_hh_b32_b16 s15, s56, s58
    s_pack_ll_b32_b16 s58, s57, s59
    s_pack_hh_b32_b16 s59, s57, s59
    s_mov_b32 s56, s14
    s_mov_b32 s57, s15
    s_pack_ll_b32_b16 s14, s60, s62
    s_pack_hh_b32_b16 s15, s60, s62
    s_pack_ll_b32_b16 s62, s61, s63
    s_pack_hh_b32_b16 s63, s61, s63
    s_mov_b32 s60, s14
    s_mov_b32 s61, s15
    s_pack_ll_b32_b16 s14, s64, s66
    s_pack_hh_b32_b16 s15, s64, s66
    s_pack_ll_b32_b16 s66, s65, s67
    s_pack_hh_b32_b16 s67, s65, s67
    s_mov_b32 s64, s14
    s_mov_b32 s65, s15
    s_pack_ll_b32_b16 s14, s68, s70
    s_pack_hh_b32_b16 s15, s68, s70
    s_pack_ll_b32_b16 s70, s69, s71
    s_pack_hh_b32_b16 s71, s69, s71
    s_mov_b32 s68, s14
    s_mov_b32 s69, s15
    s_pack_ll_b32_b16 s14, s72, s74
    s_pack_hh_b32_b16 s15, s72, s74
    s_pack_ll_b32_b16 s74, s73, s75
    s_pack_hh_b32_b16 s75, s73, s75
    s_mov_b32 s72, s14
    s_mov_b32 s73, s15
    s_pack_ll_b32_b16 s14, s76, s78
    s_pack_hh_b32_b16 s15, s76, s78
    s_pack_ll_b32_b16 s78, s77, s79
    s_pack_hh_b32_b16 s79, s77, s79
    s_mov_b32 s76, s14
    s_mov_b32 s77, s15
    s_pack_ll_b32_b16 s14, s80, s82
    s_pack_hh_b32_b16 s15, s80, s82
    s_pack_ll_b32_b16 s82, s81, s83
    s_pack_hh_b32_b16 s83, s81, s83
    s_mov_b32 s80, s14
    s_mov_b32 s81, s15
    s_waitcnt vmcnt(9)
    v_mad_u32_u16 v108, v28, v50, s40 op_sel:[0,0,0,0]
    v_mad_u32_u16 v109, v36, v50, s41 op_sel:[0,0,0,0]
    v_sub_u32_sdwa v110, v109, v108 dst_sel:DWORD dst_unused:UNUSED_PAD src0_sel:WORD_1 src1_sel:WORD_1
    s_nop 1
    v_add_u32_dpp v110, v110, v110 row_shr:1 row_mask:0xf bank_mask:0xf bound_ctrl:0
    s_nop 1
    v_add_u32_dpp v110, v110, v110 row_shr:2 row_mask:0xf bank_mask:0xf bound_ctrl:0
    s_nop 1
    v_add_u32_dpp v110, v110, v110 row_shr:4 row_mask:0xf bank_mask:0xf bound_ctrl:0
    s_nop 1
    v_add_u32_dpp v110, v110, v110 row_shr:8 row_mask:0xf bank_mask:0xf bound_ctrl:0
    s_nop 1
    v_add_u32_dpp v110, v110, v110 row_bcast:15 row_mask:0xa bank_mask:0xf
    s_nop 1
    v_add_u32_dpp v110, v110, v110 row_bcast:31 row_mask:0xc bank_mask:0xf
    v_sub_u32_sdwa v109, v109, v110 dst_sel:DWORD dst_unused:UNUSED_PAD src0_sel:WORD_1 src1_sel:DWORD
    v_readlane_b32 s29, v110, 63
    v_add_u32 v110, -1, v110
    ds_write_b16 v126, v109
    v_lshlrev_b32_e64 v111, v110, 1
    v_lshrrev_b32 v110, 5, v110
    v_lshl_add_u32 v110, v110, 2, s19
    s_cmp_gt_u32 s29, 320
    s_cselect_b32 s2, 1, s2
    s_cselect_b64 exec, 0, -1
    ds_or_b32 v110, v111 offset:160
    s_mov_b64 exec, -1
    ds_wrxchg_rtn_b32 v7, v6, v5 offset:160
    s_waitcnt lgkmcnt(0)
    v_readlane_b32 s30, v7, 0
    v_readlane_b32 s31, v7, 1
    v_readlane_b32 s32, v7, 2
    v_readlane_b32 s33, v7, 3
    v_readlane_b32 s34, v7, 4
    v_readlane_b32 s35, v7, 5
    v_readlane_b32 s36, v7, 6
    v_readlane_b32 s37, v7, 7
    s_mov_b32 s25, s19
    s_mov_b32 s26, s27
    s_mov_b32 s51, s28
    s_mov_b32 s28, s29
    v_mbcnt_lo_u32_b32 v8, s30, 0
    v_mbcnt_hi_u32_b32 v8, s31, v8
    s_bcnt1_i32_b64 s14, s[30:31]
    v_lshl_add_u32 v9, v8, 1, s25
    ds_read_u16 v9, v9
    s_add_u32 s30, s26, 0
    s_lshl1_add_u32 s25, s14, s25
    s_lshl_b32 s14, s14, 10
    s_add_u32 s26, s26, s14
    v_mbcnt_lo_u32_b32 v12, s32, 0
    v_mbcnt_hi_u32_b32 v12, s33, v12
    s_bcnt1_i32_b64 s14, s[32:33]
    v_lshl_add_u32 v13, v12, 1, s25
    ds_read_u16 v13, v13
    s_add_u32 s32, s26, 1048576
    s_lshl1_add_u32 s25, s14, s25
    s_lshl_b32 s14, s14, 10
    s_add_u32 s26, s26, s14
    v_mbcnt_lo_u32_b32 v16, s34, 0
    v_mbcnt_hi_u32_b32 v16, s35, v16
    s_bcnt1_i32_b64 s14, s[34:35]
    v_lshl_add_u32 v17, v16, 1, s25
    ds_read_u16 v17, v17
    s_add_u32 s34, s26, 2097152
    s_lshl1_add_u32 s25, s14, s25
    s_lshl_b32 s14, s14, 10
    s_add_u32 s26, s26, s14
    v_mbcnt_lo_u32_b32 v20, s36, 0
    v_mbcnt_hi_u32_b32 v20, s37, v20
    s_bcnt1_i32_b64 s14, s[36:37]
    v_lshl_add_u32 v21, v20, 1, s25
    ds_read_u16 v21, v21
    s_add_u32 s36, s26, 3145728
    s_lshl1_add_u32 s25, s14, s25
    s_lshl_b32 s14, s14, 10
    s_add_u32 s26, s26, s14
    s_waitcnt lgkmcnt(3)
    v_mad_u32_u16 v9, v9, s23, v2
    v_pk_lshrrev_b16 v9, 10, v9 op_sel_hi:[1,1]
    v_lshl_add_u32 v8, v8, 6, v9
    buffer_load_dwordx4 v[8:11], v8, s[44:47], s30 idxen
    s_waitcnt lgkmcnt(2)
    v_mad_u32_u16 v13, v13, s23, v2
    v_pk_lshrrev_b16 v13, 10, v13 op_sel_hi:[1,1]
    v_lshl_add_u32 v12, v12, 6, v13
    buffer_load_dwordx4 v[12:15], v12, s[44:47], s32 idxen
    s_waitcnt lgkmcnt(1)
    v_mad_u32_u16 v17, v17, s23, v2
    v_pk_lshrrev_b16 v17, 10, v17 op_sel_hi:[1,1]
    v_lshl_add_u32 v16, v16, 6, v17
    buffer_load_dwordx4 v[16:19], v16, s[44:47], s34 idxen
    s_waitcnt lgkmcnt(0)
    v_mad_u32_u16 v21, v21, s23, v2
    v_pk_lshrrev_b16 v21, 10, v21 op_sel_hi:[1,1]
    v_lshl_add_u32 v20, v20, 6, v21
    buffer_load_dwordx4 v[20:23], v20, s[44:47], s36 idxen
    s_cmp_le_u32 s28, 256
    s_cbranch_scc1 L_p2_kernel_noopt_1
    v_readlane_b32 s38, v7, 8
    v_readlane_b32 s39, v7, 9
    s_nop 1
    v_mbcnt_lo_u32_b32 v118, s38, 0
    v_mbcnt_hi_u32_b32 v118, s39, v118
    s_bcnt1_i32_b64 s14, s[38:39]
    v_lshl_add_u32 v119, v118, 1, s25
    ds_read_u16 v119, v119
    s_add_u32 s38, s26, 4194304
    s_lshl1_add_u32 s25, s14, s25
    s_lshl_b32 s14, s14, 10
    s_add_u32 s26, s26, s14
    s_waitcnt lgkmcnt(0)
    v_mad_u32_u16 v119, v119, s23, v2
    v_pk_lshrrev_b16 v119, 10, v119 op_sel_hi:[1,1]
    v_lshl_add_u32 v118, v118, 6, v119
    buffer_load_dwordx4 v[24:27], v118, s[44:47], s38 idxen
L_p2_kernel_noopt_1:
    s_waitcnt vmcnt(6)
    ds_write_b128 v3, v[88:91] offset:0
    ds_write_b128 v3, v[92:95] offset:16384
    ds_write_b128 v3, v[96:99] offset:32768
    ds_write_b128 v3, v[100:103] offset:49152
    ds_write_b128 v124, v[104:107] offset:0
    s_waitcnt vmcnt(4)
    v_max3_u32 v64, v80, v82, v84
    v_add_f32 v65, v81, v83
    v_add_f32 v66, v85, v87
    v_max_u32 v64, v64, v86
    v_add_f32 v65, v65, v66
    v_cmp_lt_u32 vcc, 0xffff, v64
    s_nop 1
    v_max_u32_dpp v64, v64, v64 row_shr:1 row_mask:0xf bank_mask:0xf bound_ctrl:0
    s_nop 1
    v_max_u32_dpp v64, v64, v64 row_shr:2 row_mask:0xf bank_mask:0xf bound_ctrl:0
    s_nop 1
    v_max_u32_dpp v64, v64, v64 row_shr:4 row_mask:0xf bank_mask:0xf bound_ctrl:0
    s_nop 1
    v_max_u32_dpp v64, v64, v64 row_shr:8 row_mask:0xf bank_mask:0xf bound_ctrl:0
    s_nop 1
    v_max_u32_dpp v64, v64, v64 row_bcast:15 row_mask:0xa bank_mask:0xf
    s_nop 1
    v_max_u32_dpp v64, v64, v64 row_bcast:31 row_mask:0xc bank_mask:0xf
    s_nop 1
    v_add_f32_dpp v65, v65, v65 row_shr:1 row_mask:0xf bank_mask:0xf bound_ctrl:0
    s_nop 1
    v_add_f32_dpp v65, v65, v65 row_shr:2 row_mask:0xf bank_mask:0xf bound_ctrl:0
    s_nop 1
    v_add_f32_dpp v65, v65, v65 row_shr:4 row_mask:0xf bank_mask:0xf bound_ctrl:0
    s_nop 1
    v_add_f32_dpp v65, v65, v65 row_shr:8 row_mask:0xf bank_mask:0xf bound_ctrl:0
    s_nop 1
    v_add_f32_dpp v65, v65, v65 row_bcast:15 row_mask:0xa bank_mask:0xf
    s_nop 1
    v_add_f32_dpp v65, v65, v65 row_bcast:31 row_mask:0xc bank_mask:0xf
    s_cmp_lg_u64 vcc, 0
    s_cselect_b32 s2, 1, s2
    v_lshlrev_b32 v64, 16, v64
    v_mul_f32 v66, 936490775, v65
    v_mul_f32 v65, 928531664, v65
    v_cmp_nle_f32 vcc, v64, v66
    v_max_u32 v64, v64, v65
    s_nop 0
    v_readlane_b32 s14, v64, 63
    s_bitcmp1_b32 vcc_hi, 31
    s_cselect_b32 s2, 1, s2
    s_lshr_b32 s14, s14, 23
    s_add_u32 s14, s14, 1
    s_cmp_lt_u32 s14, 40
    s_cselect_b32 s2, 1, s2
    s_cmp_gt_u32 s14, 230
    s_cselect_b32 s2, 1, s2
    s_sub_u32 s48, s14, 14
    s_lshl_b32 s48, s48, 23
    s_add_u32 s16, s48, 272646144
    s_or_b32 s48, s48, 16416
    s_sub_u32 s14, s14, 40
    s_cmp_gt_u32 s14, 190
    s_cselect_b32 s48, 0, s48
    s_waitcnt lgkmcnt(0)
    s_barrier
    s_add_u32 s14, s22, 80000
    buffer_load_dwordx4 v[88:91], v1, s[8:11], s14 offen
    s_add_u32 s14, s22, 96384
    buffer_load_dwordx4 v[92:95], v1, s[8:11], s14 offen
    v_mad_u32_u16 v108, v28, v50, s40 op_sel:[1,0,0,0]
    v_mad_u32_u16 v109, v36, v50, s41 op_sel:[1,0,0,0]
    v_sub_u32_sdwa v110, v109, v108 dst_sel:DWORD dst_unused:UNUSED_PAD src0_sel:WORD_1 src1_sel:WORD_1
    s_nop 1
    v_add_u32_dpp v110, v110, v110 row_shr:1 row_mask:0xf bank_mask:0xf bound_ctrl:0
    s_nop 1
    v_add_u32_dpp v110, v110, v110 row_shr:2 row_mask:0xf bank_mask:0xf bound_ctrl:0
    s_nop 1
    v_add_u32_dpp v110, v110, v110 row_shr:4 row_mask:0xf bank_mask:0xf bound_ctrl:0
    s_nop 1
    v_add_u32_dpp v110, v110, v110 row_shr:8 row_mask:0xf bank_mask:0xf bound_ctrl:0
    s_nop 1
    v_add_u32_dpp v110, v110, v110 row_bcast:15 row_mask:0xa bank_mask:0xf
    s_nop 1
    v_add_u32_dpp v110, v110, v110 row_bcast:31 row_mask:0xc bank_mask:0xf
    v_sub_u32_sdwa v109, v109, v110 dst_sel:DWORD dst_unused:UNUSED_PAD src0_sel:WORD_1 src1_sel:DWORD
    v_readlane_b32 s29, v110, 63
    v_add_u32 v110, -1, v110
    ds_write_b16 v126, v109
    v_lshlrev_b32_e64 v111, v110, 1
    v_lshrrev_b32 v110, 5, v110
    v_lshl_add_u32 v110, v110, 2, s19
    s_cmp_gt_u32 s29, 320
    s_cselect_b32 s2, 1, s2
    s_cselect_b64 exec, 0, -1
    ds_or_b32 v110, v111 offset:160
    s_mov_b64 exec, -1
    ds_wrxchg_rtn_b32 v7, v6, v5 offset:160
    s_mov_b32 s24, 0
L_p2_loop:
    s_add_u32 s22, s22, 80000
    s_lshl_b32 s14, s13, 4
    s_or_b32 s14, s14, s24
    s_cmp_lg_u32 s14, 5
    s_cbranch_scc1 L_p2_nost
    v_mov_b32 v52, 0
    s_lshl_b32 s14, s3, 8
    s_add_u32 s14, s14, 8557056
    s_mov_b64 exec, 1
    buffer_atomic_add v52, off, s[4:7], s14 sc0
    s_mov_b64 exec, -1
L_p2_nost:
    s_waitcnt vmcnt(5)
    v_mad_u32_u16 v64, v8, 8, s18
    v_mad_u32_u16 v66, v9, 8, s18
    v_mad_u32_u16 v68, v10, 8, s18
    ds_read_b64 v[64:65], v64
    ds_read_b64 v[66:67], v66
    ds_read_b64 v[68:69], v68
    s_add_u32 s14, s22, 32768
    buffer_load_dwordx4 v[96:99], v1, s[8:11], s14 offen
    s_waitcnt vmcnt(5)
    v_mad_u32_u16 v70, v12, 8, s18
    v_mad_u32_u16 v72, v13, 8, s18
    v_mad_u32_u16 v74, v14, 8, s18
    ds_read_b64 v[70:71], v70
    ds_read_b64 v[72:73], v72
    ds_read_b64 v[74:75], v74
    s_add_u32 s14, s22, 49152
    buffer_load_dwordx4 v[100:103], v1, s[8:11], s14 offen
    s_waitcnt lgkmcnt(6)
    v_readlane_b32 s30, v7, 0
    v_readlane_b32 s31, v7, 1
    v_readlane_b32 s32, v7, 2
    v_readlane_b32 s33, v7, 3
    v_readlane_b32 s34, v7, 4
    v_readlane_b32 s35, v7, 5
    v_readlane_b32 s36, v7, 6
    v_readlane_b32 s37, v7, 7
    s_mov_b32 s25, s19
    s_mov_b32 s26, s27
    s_mov_b32 s51, s28
    s_mov_b32 s28, s29
    v_mbcnt_lo_u32_b32 v118, s30, 0
    v_mbcnt_hi_u32_b32 v118, s31, v118
    s_bcnt1_i32_b64 s14, s[30:31]
    v_lshl_add_u32 v119, v118, 1, s25
    ds_read_u16 v119, v119
    s_add_u32 s30, s26, 0
    s_lshl1_add_u32 s25, s14, s25
    s_lshl_b32 s14, s14, 10
    s_add_u32 s26, s26, s14
    v_bfe_i32 v108, v11, 2, 10
    v_bfe_i32 v109, v11, 12, 10
    v_ashrrev_i32 v110, 22, v11
    v_cvt_f32_i32 v108, v108
    v_cvt_f32_i32 v109, v109
    v_cvt_f32_i32 v110, v110
    v_mad_u32_u16 v8, v8, 8, s50 op_sel:[1,0,0,0]
    v_mad_u32_u16 v9, v9, 8, s50 op_sel:[1,0,0,0]
    v_mad_u32_u16 v10, v10, 8, s50 op_sel:[1,0,0,0]
    s_waitcnt lgkmcnt(4)
    v_lshlrev_b32 v112, 16, v64
    v_and_b32 v113, 0xffff0000, v64
    v_lshlrev_b32 v64, 16, v65
    v_and_b32 v65, 0xffff0000, v65
    v_lshlrev_b32 v114, 16, v66
    v_and_b32 v115, 0xffff0000, v66
    v_lshlrev_b32 v66, 16, v67
    v_and_b32 v67, 0xffff0000, v67
    v_lshlrev_b32 v116, 16, v68
    v_and_b32 v117, 0xffff0000, v68
    v_lshlrev_b32 v68, 16, v69
    v_and_b32 v69, 0xffff0000, v69
    v_pk_fma_f32 v[112:113], v[112:113], v[108:109], s[16:17] op_sel:[0,0,0] op_sel_hi:[1,0,0]
    v_pk_fma_f32 v[64:65], v[64:65], v[108:109], s[16:17] op_sel:[0,0,0] op_sel_hi:[1,0,0]
    v_pk_fma_f32 v[114:115], v[114:115], v[108:109], s[16:17] op_sel:[0,1,0] op_sel_hi:[1,1,0]
    v_pk_fma_f32 v[66:67], v[66:67], v[108:109], s[16:17] op_sel:[0,1,0] op_sel_hi:[1,1,0]
    v_pk_fma_f32 v[116:117], v[116:117], v[110:111], s[16:17] op_sel:[0,0,0] op_sel_hi:[1,0,0]
    v_pk_fma_f32 v[68:69], v[68:69], v[110:111], s[16:17] op_sel:[0,0,0] op_sel_hi:[1,0,0]
    v_perm_b32 v65, v65, v64, s17
    v_perm_b32 v64, v113, v112, s17
    v_perm_b32 v67, v67, v66, s17
    v_perm_b32 v66, v115, v114, s17
    v_perm_b32 v69, v69, v68, s17
    v_perm_b32 v68, v117, v116, s17
    v_lshl_add_u64 v[64:65], v[64:65], 0, s[20:21]
    v_lshl_add_u64 v[66:67], v[66:67], 0, s[20:21]
    v_lshl_add_u64 v[68:69], v[68:69], 0, s[20:21]
    v_or3_b32 v4, v44, v45, v4
    v_or3_b32 v4, v46, v47, v4
    v_or3_b32 v4, v48, v49, v4
    ds_add_rtn_u64 v[44:45], v8, v[64:65]
    ds_add_rtn_u64 v[46:47], v9, v[66:67]
    ds_add_rtn_u64 v[48:49], v10, v[68:69]
    s_waitcnt lgkmcnt(3)
    v_mad_u32_u16 v119, v119, s23, v2
    v_pk_lshrrev_b16 v119, 10, v119 op_sel_hi:[1,1]
    v_lshl_add_u32 v118, v118, 6, v119
    buffer_load_dwordx4 v[8:11], v118, s[44:47], s30 idxen
    s_add_u32 s14, s22, 65536
    buffer_load_dwordx4 v[104:107], v1, s[8:11], s14 offen
    s_waitcnt vmcnt(7)
    v_mad_u32_u16 v76, v16, 8, s18
    v_mad_u32_u16 v78, v17, 8, s18
    v_mad_u32_u16 v80, v18, 8, s18
    ds_read_b64 v[76:77], v76
    ds_read_b64 v[78:79], v78
    ds_read_b64 v[80:81], v80
    s_waitcnt vmcnt(6)
    v_mad_u32_u16 v82, v20, 8, s18
    v_mad_u32_u16 v84, v21, 8, s18
    v_mad_u32_u16 v86, v22, 8, s18
    ds_read_b64 v[82:83], v82
    ds_read_b64 v[84:85], v84
    ds_read_b64 v[86:87], v86
    v_mbcnt_lo_u32_b32 v118, s32, 0
    v_mbcnt_hi_u32_b32 v118, s33, v118
    s_bcnt1_i32_b64 s14, s[32:33]
    v_lshl_add_u32 v119, v118, 1, s25
    ds_read_u16 v119, v119
    s_add_u32 s32, s26, 1048576
    s_lshl1_add_u32 s25, s14, s25
    s_lshl_b32 s14, s14, 10
    s_add_u32 s26, s26, s14
    v_bfe_i32 v108, v15, 2, 10
    v_bfe_i32 v109, v15, 12, 10
    v_ashrrev_i32 v110, 22, v15
    v_cvt_f32_i32 v108, v108
    v_cvt_f32_i32 v109, v109
    v_cvt_f32_i32 v110, v110
    v_mad_u32_u16 v12, v12, 8, s50 op_sel:[1,0,0,0]
    v_mad_u32_u16 v13, v13, 8, s50 op_sel:[1,0,0,0]
    v_mad_u32_u16 v14, v14, 8, s50 op_sel:[1,0,0,0]
    v_lshlrev_b32 v112, 16, v70
    v_and_b32 v113, 0xffff0000, v70
    v_lshlrev_b32 v70, 16, v71
    v_and_b32 v71, 0xffff0000, v71
    v_lshlrev_b32 v114, 16, v72
    v_and_b32 v115, 0xffff0000, v72
    v_lshlrev_b32 v72, 16, v73
    v_and_b32 v73, 0xffff0000, v73
    v_lshlrev_b32 v116, 16, v74
    v_and_b32 v117, 0xffff0000, v74
    v_lshlrev_b32 v74, 16, v75
    v_and_b32 v75, 0xffff0000, v75
    v_pk_fma_f32 v[112:113], v[112:113], v[108:109], s[16:17] op_sel:[0,0,0] op_sel_hi:[1,0,0]
    v_pk_fma_f32 v[70:71], v[70:71], v[108:109], s[16:17] op_sel:[0,0,0] op_sel_hi:[1,0,0]
    v_pk_fma_f32 v[114:115], v[114:115], v[108:109], s[16:17] op_sel:[0,1,0] op_sel_hi:[1,1,0]
    v_pk_fma_f32 v[72:73], v[72:73], v[108:109], s[16:17] op_sel:[0,1,0] op_sel_hi:[1,1,0]
    v_pk_fma_f32 v[116:117], v[116:117], v[110:111], s[16:17] op_sel:[0,0,0] op_sel_hi:[1,0,0]
    v_pk_fma_f32 v[74:75], v[74:75], v[110:111], s[16:17] op_sel:[0,0,0] op_sel_hi:[1,0,0]
    v_perm_b32 v71, v71, v70, s17
    v_perm_b32 v70, v113, v112, s17
    v_perm_b32 v73, v73, v72, s17
    v_perm_b32 v72, v115, v114, s17
    v_perm_b32 v75, v75, v74, s17
    v_perm_b32 v74, v117, v116, s17
    v_lshl_add_u64 v[70:71], v[70:71], 0, s[20:21]
    v_lshl_add_u64 v[72:73], v[72:73], 0, s[20:21]
    v_lshl_add_u64 v[74:75], v[74:75], 0, s[20:21]
    s_waitcnt lgkmcnt(7)
    v_or3_b32 v4, v44, v45, v4
    v_or3_b32 v4, v46, v47, v4
    v_or3_b32 v4, v48, v49, v4
    ds_add_rtn_u64 v[44:45], v12, v[70:71]
    ds_add_rtn_u64 v[46:47], v13, v[72:73]
    ds_add_rtn_u64 v[48:49], v14, v[74:75]
    s_waitcnt lgkmcnt(3)
    v_mad_u32_u16 v119, v119, s23, v2
    v_pk_lshrrev_b16 v119, 10, v119 op_sel_hi:[1,1]
    v_lshl_add_u32 v118, v118, 6, v119
    buffer_load_dwordx4 v[12:15], v118, s[44:47], s32 idxen
    s_cmp_le_u32 s51, 256
    s_cbranch_scc1 L_p2_kernel_noopt2_2
    v_mad_u32_u16 v64, v24, 8, s18
    v_mad_u32_u16 v66, v25, 8, s18
    v_mad_u32_u16 v68, v26, 8, s18
    ds_read_b64 v[64:65], v64
    ds_read_b64 v[66:67], v66
    ds_read_b64 v[68:69], v68
    v_bfe_i32 v108, v27, 2, 10
    v_bfe_i32 v109, v27, 12, 10
    v_ashrrev_i32 v110, 22, v27
    v_cvt_f32_i32 v108, v108
    v_cvt_f32_i32 v109, v109
    v_cvt_f32_i32 v110, v110
    v_mad_u32_u16 v24, v24, 8, s50 op_sel:[1,0,0,0]
    v_mad_u32_u16 v25, v25, 8, s50 op_sel:[1,0,0,0]
    v_mad_u32_u16 v26, v26, 8, s50 op_sel:[1,0,0,0]
    s_waitcnt lgkmcnt(0)
    v_lshlrev_b32 v112, 16, v64
    v_and_b32 v113, 0xffff0000, v64
    v_lshlrev_b32 v64, 16, v65
    v_and_b32 v65, 0xffff0000, v65
    v_lshlrev_b32 v114, 16, v66
    v_and_b32 v115, 0xffff0000, v66
    v_lshlrev_b32 v66, 16, v67
    v_and_b32 v67, 0xffff0000, v67
    v_lshlrev_b32 v116, 16, v68
    v_and_b32 v117, 0xffff0000, v68
    v_lshlrev_b32 v68, 16, v69
    v_and_b32 v69, 0xffff0000, v69
    v_pk_fma_f32 v[112:113], v[112:113], v[108:109], s[16:17] op_sel:[0,0,0] op_sel_hi:[1,0,0]
    v_pk_fma_f32 v[64:65], v[64:65], v[108:109], s[16:17] op_sel:[0,0,0] op_sel_hi:[1,0,0]
    v_pk_fma_f32 v[114:115], v[114:115], v[108:109], s[16:17] op_sel:[0,1,0] op_sel_hi:[1,1,0]
    v_pk_fma_f32 v[66:67], v[66:67], v[108:109], s[16:17] op_sel:[0,1,0] op_sel_hi:[1,1,0]
    v_pk_fma_f32 v[116:117], v[116:117], v[110:111], s[16:17] op_sel:[0,0,0] op_sel_hi:[1,0,0]
    v_pk_fma_f32 v[68:69], v[68:69], v[110:111], s[16:17] op_sel:[0,0,0] op_sel_hi:[1,0,0]
    v_perm_b32 v65, v65, v64, s17
    v_perm_b32 v64, v113, v112, s17
    v_perm_b32 v67, v67, v66, s17
    v_perm_b32 v66, v115, v114, s17
    v_perm_b32 v69, v69, v68, s17
    v_perm_b32 v68, v117, v116, s17
    v_lshl_add_u64 v[64:65], v[64:65], 0, s[20:21]
    v_lshl_add_u64 v[66:67], v[66:67], 0, s[20:21]
    v_lshl_add_u64 v[68:69], v[68:69], 0, s[20:21]
    v_or3_b32 v4, v44, v45, v4
    v_or3_b32 v4, v46, v47, v4
    v_or3_b32 v4, v48, v49, v4
    ds_add_rtn_u64 v[44:45], v24, v[64:65]
    ds_add_rtn_u64 v[46:47], v25, v[66:67]
    ds_add_rtn_u64 v[48:49], v26, v[68:69]
L_p2_kernel_noopt2_2:
    s_barrier
    s_waitcnt vmcnt(1)
    ds_write_b128 v3, v[88:91] offset:0
    ds_write_b128 v3, v[92:95] offset:16384
    ds_write_b128 v3, v[96:99] offset:32768
    ds_write_b128 v3, v[100:103] offset:49152
    ds_write_b128 v124, v[104:107] offset:0
    v_mbcnt_lo_u32_b32 v118, s34, 0
    v_mbcnt_hi_u32_b32 v118, s35, v118
    s_bcnt1_i32_b64 s14, s[34:35]
    v_lshl_add_u32 v119, v118, 1, s25
    ds_read_u16 v119, v119
    s_add_u32 s34, s26, 2097152
    s_lshl1_add_u32 s25, s14, s25
    s_lshl_b32 s14, s14, 10
    s_add_u32 s26, s26, s14
    v_bfe_i32 v108, v19, 2, 10
    v_bfe_i32 v109, v19, 12, 10
    v_ashrrev_i32 v110, 22, v19
    v_cvt_f32_i32 v108, v108
    v_cvt_f32_i32 v109, v109
    v_cvt_f32_i32 v110, v110
    v_mad_u32_u16 v16, v16, 8, s50 op_sel:[1,0,0,0]
    v_mad_u32_u16 v17, v17, 8, s50 op_sel:[1,0,0,0]
    v_mad_u32_u16 v18, v18, 8, s50 op_sel:[1,0,0,0]
    v_lshlrev_b32 v112, 16, v76
    v_and_b32 v113, 0xffff0000, v76
    v_lshlrev_b32 v76, 16, v77
    v_and_b32 v77, 0xffff0000, v77
    v_lshlrev_b32 v114, 16, v78
    v_and_b32 v115, 0xffff0000, v78
    v_lshlrev_b32 v78, 16, v79
    v_and_b32 v79, 0xffff0000, v79
    v_lshlrev_b32 v116, 16, v80
    v_and_b32 v117, 0xffff0000, v80
    v_lshlrev_b32 v80, 16, v81
    v_and_b32 v81, 0xffff0000, v81
    v_pk_fma_f32 v[112:113], v[112:113], v[108:109], s[16:17] op_sel:[0,0,0] op_sel_hi:[1,0,0]
    v_pk_fma_f32 v[76:77], v[76:77], v[108:109], s[16:17] op_sel:[0,0,0] op_sel_hi:[1,0,0]
    v_pk_fma_f32 v[114:115], v[114:115], v[108:109], s[16:17] op_sel:[0,1,0] op_sel_hi:[1,1,0]
    v_pk_fma_f32 v[78:79], v[78:79], v[108:109], s[16:17] op_sel:[0,1,0] op_sel_hi:[1,1,0]
    v_pk_fma_f32 v[116:117], v[116:117], v[110:111], s[16:17] op_sel:[0,0,0] op_sel_hi:[1,0,0]
    v_pk_fma_f32 v[80:81], v[80:81], v[110:111], s[16:17] op_sel:[0,0,0] op_sel_hi:[1,0,0]
    v_perm_b32 v77, v77, v76, s17
    v_perm_b32 v76, v113, v112, s17
    v_perm_b32 v79, v79, v78, s17
    v_perm_b32 v78, v115, v114, s17
    v_perm_b32 v81, v81, v80, s17
    v_perm_b32 v80, v117, v116, s17
    v_lshl_add_u64 v[76:77], v[76:77], 0, s[20:21]
    v_lshl_add_u64 v[78:79], v[78:79], 0, s[20:21]
    v_lshl_add_u64 v[80:81], v[80:81], 0, s[20:21]
    s_waitcnt lgkmcnt(6)
    v_or3_b32 v4, v44, v45, v4
    v_or3_b32 v4, v46, v47, v4
    v_or3_b32 v4, v48, v49, v4
    ds_add_rtn_u64 v[44:45], v16, v[76:77]
    ds_add_rtn_u64 v[46:47], v17, v[78:79]
    ds_add_rtn_u64 v[48:49], v18, v[80:81]
    s_waitcnt lgkmcnt(3)
    v_mad_u32_u16 v119, v119, s23, v2
    v_pk_lshrrev_b16 v119, 10, v119 op_sel_hi:[1,1]
    v_lshl_add_u32 v118, v118, 6, v119
    buffer_load_dwordx4 v[16:19], v118, s[44:47], s34 idxen
    v_mbcnt_lo_u32_b32 v118, s36, 0
    v_mbcnt_hi_u32_b32 v118, s37, v118
    s_bcnt1_i32_b64 s14, s[36:37]
    v_lshl_add_u32 v119, v118, 1, s25
    ds_read_u16 v119, v119
    s_add_u32 s36, s26, 3145728
    s_lshl1_add_u32 s25, s14, s25
    s_lshl_b32 s14, s14, 10
    s_add_u32 s26, s26, s14
    v_bfe_i32 v108, v23, 2, 10
    v_bfe_i32 v109, v23, 12, 10
    v_ashrrev_i32 v110, 22, v23
    v_cvt_f32_i32 v108, v108
    v_cvt_f32_i32 v109, v109
    v_cvt_f32_i32 v110, v110
    v_mad_u32_u16 v20, v20, 8, s50 op_sel:[1,0,0,0]
    v_mad_u32_u16 v21, v21, 8, s50 op_sel:[1,0,0,0]
    v_mad_u32_u16 v22, v22, 8, s50 op_sel:[1,0,0,0]
    v_lshlrev_b32 v112, 16, v82
    v_and_b32 v113, 0xffff0000, v82
    v_lshlrev_b32 v82, 16, v83
    v_and_b32 v83, 0xffff0000, v83
    v_lshlrev_b32 v114, 16, v84
    v_and_b32 v115, 0xffff0000, v84
    v_lshlrev_b32 v84, 16, v85
    v_and_b32 v85, 0xffff0000, v85
    v_lshlrev_b32 v116, 16, v86
    v_and_b32 v117, 0xffff0000, v86
    v_lshlrev_b32 v86, 16, v87
    v_and_b32 v87, 0xffff0000, v87
    v_pk_fma_f32 v[112:113], v[112:113], v[108:109], s[16:17] op_sel:[0,0,0] op_sel_hi:[1,0,0]
    v_pk_fma_f32 v[82:83], v[82:83], v[108:109], s[16:17] op_sel:[0,0,0] op_sel_hi:[1,0,0]
    v_pk_fma_f32 v[114:115], v[114:115], v[108:109], s[16:17] op_sel:[0,1,0] op_sel_hi:[1,1,0]
    v_pk_fma_f32 v[84:85], v[84:85], v[108:109], s[16:17] op_sel:[0,1,0] op_sel_hi:[1,1,0]
    v_pk_fma_f32 v[116:117], v[116:117], v[110:111], s[16:17] op_sel:[0,0,0] op_sel_hi:[1,0,0]
    v_pk_fma_f32 v[86:87], v[86:87], v[110:111], s[16:17] op_sel:[0,0,0] op_sel_hi:[1,0,0]
    v_perm_b32 v83, v83, v82, s17
    v_perm_b32 v82, v113, v112, s17
    v_perm_b32 v85, v85, v84, s17
    v_perm_b32 v84, v115, v114, s17
    v_perm_b32 v87, v87, v86, s17
    v_perm_b32 v86, v117, v116, s17
    v_lshl_add_u64 v[82:83], v[82:83], 0, s[20:21]
    v_lshl_add_u64 v[84:85], v[84:85], 0, s[20:21]
    v_lshl_add_u64 v[86:87], v[86:87], 0, s[20:21]
    s_waitcnt lgkmcnt(1)
    v_or3_b32 v4, v44, v45, v4
    v_or3_b32 v4, v46, v47, v4
    v_or3_b32 v4, v48, v49, v4
    ds_add_rtn_u64 v[44:45], v20, v[82:83]
    ds_add_rtn_u64 v[46:47], v21, v[84:85]
    ds_add_rtn_u64 v[48:49], v22, v[86:87]
    s_waitcnt lgkmcnt(3)
    v_mad_u32_u16 v119, v119, s23, v2
    v_pk_lshrrev_b16 v119, 10, v119 op_sel_hi:[1,1]
    v_lshl_add_u32 v118, v118, 6, v119
    buffer_load_dwordx4 v[20:23], v118, s[44:47], s36 idxen
    s_cmp_le_u32 s28, 256
    s_cbranch_scc1 L_p2_kernel_noopt_3
    v_readlane_b32 s38, v7, 8
    v_readlane_b32 s39, v7, 9
    s_nop 1
    v_mbcnt_lo_u32_b32 v118, s38, 0
    v_mbcnt_hi_u32_b32 v118, s39, v118
    s_bcnt1_i32_b64 s14, s[38:39]
    v_lshl_add_u32 v119, v118, 1, s25
    ds_read_u16 v119, v119
    s_add_u32 s38, s26, 4194304
    s_lshl1_add_u32 s25, s14, s25
    s_lshl_b32 s14, s14, 10
    s_add_u32 s26, s26, s14
    s_waitcnt lgkmcnt(0)
    v_mad_u32_u16 v119, v119, s23, v2
    v_pk_lshrrev_b16 v119, 10, v119 op_sel_hi:[1,1]
    v_lshl_add_u32 v118, v118, 6, v119
    buffer_load_dwordx4 v[24:27], v118, s[44:47], s38 idxen
L_p2_kernel_noopt_3:
    v_pk_mov_b32 v[28:29], v[28:29], v[30:31] op_sel:[1,0]
    v_pk_mov_b32 v[30:31], v[30:31], v[32:33] op_sel:[1,0]
    v_pk_mov_b32 v[32:33], v[32:33], v[34:35] op_sel:[1,0]
    v_pk_mov_b32 v[34:35], v[34:35], v[4:5] op_sel:[1,1]
    v_pk_mov_b32 v[36:37], v[36:37], v[38:39] op_sel:[1,0]
    v_pk_mov_b32 v[38:39], v[38:39], v[40:41] op_sel:[1,0]
    v_pk_mov_b32 v[40:41], v[40:41], v[42:43] op_sel:[1,0]
    v_pk_mov_b32 v[42:43], v[42:43], v[4:5] op_sel:[1,1]
    v_mad_u32_u16 v108, v28, v50, s40 op_sel:[0,0,0,0]
    v_mad_u32_u16 v109, v36, v50, s41 op_sel:[0,0,0,0]
    v_sub_u32_sdwa v110, v109, v108 dst_sel:DWORD dst_unused:UNUSED_PAD src0_sel:WORD_1 src1_sel:WORD_1
    s_nop 1
    v_add_u32_dpp v110, v110, v110 row_shr:1 row_mask:0xf bank_mask:0xf bound_ctrl:0
    s_nop 1
    v_add_u32_dpp v110, v110, v110 row_shr:2 row_mask:0xf bank_mask:0xf bound_ctrl:0
    s_nop 1
    v_add_u32_dpp v110, v110, v110 row_shr:4 row_mask:0xf bank_mask:0xf bound_ctrl:0
    s_nop 1
    v_add_u32_dpp v110, v110, v110 row_shr:8 row_mask:0xf bank_mask:0xf bound_ctrl:0
    s_nop 1
    v_add_u32_dpp v110, v110, v110 row_bcast:15 row_mask:0xa bank_mask:0xf
    s_nop 1
    v_add_u32_dpp v110, v110, v110 row_bcast:31 row_mask:0xc bank_mask:0xf
    v_sub_u32_sdwa v109, v109, v110 dst_sel:DWORD dst_unused:UNUSED_PAD src0_sel:WORD_1 src1_sel:DWORD
    v_readlane_b32 s29, v110, 63
    v_add_u32 v110, -1, v110
    ds_write_b16 v126, v109
    v_lshlrev_b32_e64 v111, v110, 1
    v_lshrrev_b32 v110, 5, v110
    v_lshl_add_u32 v110, v110, 2, s19
    s_cmp_gt_u32 s29, 320
    s_cselect_b32 s2, 1, s2
    s_cselect_b64 exec, 0, -1
    ds_or_b32 v110, v111 offset:160
    s_mov_b64 exec, -1
    ds_wrxchg_rtn_b32 v7, v6, v5 offset:160
    s_add_u32 s14, s22, 80000
    buffer_load_dwordx4 v[88:91], v1, s[8:11], s14 offen
    s_add_u32 s14, s22, 96384
    buffer_load_dwordx4 v[92:95], v1, s[8:11], s14 offen
    s_barrier
    s_add_u32 s22, s22, 80000
    s_cmp_lg_u32 s24, 7
    s_cbranch_scc1 L_p2_nodist
    s_mov_b32 s46, 0
    s_lshl2_add_u32 s14, s3, s12
    s_mul_i32 s14, s14, 5000
    s_add_u32 s15, s14, 4096
    v_min_u32 v61, 225, v0
    v_lshl_add_u32 v60, v0, 2, s14
    v_lshl_add_u32 v61, v61, 2, s15
    global_load_dword v60, v60, s[100:101] nt
    global_load_dword v61, v61, s[100:101] nt
L_p2_nodist:
    v_mad_u32_u16 v64, v8, 8, s18
    v_mad_u32_u16 v66, v9, 8, s18
    v_mad_u32_u16 v68, v10, 8, s18
    ds_read_b64 v[64:65], v64
    ds_read_b64 v[66:67], v66
    ds_read_b64 v[68:69], v68
    s_add_u32 s14, s22, 32768
    buffer_load_dwordx4 v[96:99], v1, s[8:11], s14 offen
    s_waitcnt vmcnt(5)
    v_mad_u32_u16 v70, v12, 8, s18
    v_mad_u32_u16 v72, v13, 8, s18
    v_mad_u32_u16 v74, v14, 8, s18
    ds_read_b64 v[70:71], v70
    ds_read_b64 v[72:73], v72
    ds_read_b64 v[74:75], v74
    s_add_u32 s14, s22, 49152
    buffer_load_dwordx4 v[100:103], v1, s[8:11], s14 offen
    s_waitcnt lgkmcnt(6)
    v_readlane_b32 s30, v7, 0
    v_readlane_b32 s31, v7, 1
    v_readlane_b32 s32, v7, 2
    v_readlane_b32 s33, v7, 3
    v_readlane_b32 s34, v7, 4
    v_readlane_b32 s35, v7, 5
    v_readlane_b32 s36, v7, 6
    v_readlane_b32 s37, v7, 7
    s_mov_b32 s25, s19
    s_mov_b32 s26, s27
    s_mov_b32 s51, s28
    s_mov_b32 s28, s29
    v_mbcnt_lo_u32_b32 v118, s30, 0
    v_mbcnt_hi_u32_b32 v118, s31, v118
    s_bcnt1_i32_b64 s14, s[30:31]
    v_lshl_add_u32 v119, v118, 1, s25
    ds_read_u16 v119, v119
    s_add_u32 s30, s26, 0
    s_lshl1_add_u32 s25, s14, s25
    s_lshl_b32 s14, s14, 10
    s_add_u32 s26, s26, s14
    v_bfe_i32 v108, v11, 2, 10
    v_bfe_i32 v109, v11, 12, 10
    v_ashrrev_i32 v110, 22, v11
    v_cvt_f32_i32 v108, v108
    v_cvt_f32_i32 v109, v109
    v_cvt_f32_i32 v110, v110
    v_mad_u32_u16 v8, v8, 8, s50 op_sel:[1,0,0,0]
    v_mad_u32_u16 v9, v9, 8, s50 op_sel:[1,0,0,0]
    v_mad_u32_u16 v10, v10, 8, s50 op_sel:[1,0,0,0]
    s_waitcnt lgkmcnt(4)
    v_lshlrev_b32 v112, 16, v64
    v_and_b32 v113, 0xffff0000, v64
    v_lshlrev_b32 v64, 16, v65
    v_and_b32 v65, 0xffff0000, v65
    v_lshlrev_b32 v114, 16, v66
    v_and_b32 v115, 0xffff0000, v66
    v_lshlrev_b32 v66, 16, v67
    v_and_b32 v67, 0xffff0000, v67
    v_lshlrev_b32 v116, 16, v68
    v_and_b32 v117, 0xffff0000, v68
    v_lshlrev_b32 v68, 16, v69
    v_and_b32 v69, 0xffff0000, v69
    v_pk_fma_f32 v[112:113], v[112:113], v[108:109], s[16:17] op_sel:[0,0,0] op_sel_hi:[1,0,0]
    v_pk_fma_f32 v[64:65], v[64:65], v[108:109], s[16:17] op_sel:[0,0,0] op_sel_hi:[1,0,0]
    v_pk_fma_f32 v[114:115], v[114:115], v[108:109], s[16:17] op_sel:[0,1,0] op_sel_hi:[1,1,0]
    v_pk_fma_f32 v[66:67], v[66:67], v[108:109], s[16:17] op_sel:[0,1,0] op_sel_hi:[1,1,0]
    v_pk_fma_f32 v[116:117], v[116:117], v[110:111], s[16:17] op_sel:[0,0,0] op_sel_hi:[1,0,0]
    v_pk_fma_f32 v[68:69], v[68:69], v[110:111], s[16:17] op_sel:[0,0,0] op_sel_hi:[1,0,0]
    v_perm_b32 v65, v65, v64, s17
    v_perm_b32 v64, v113, v112, s17
    v_perm_b32 v67, v67, v66, s17
    v_perm_b32 v66, v115, v114, s17
    v_perm_b32 v69, v69, v68, s17
    v_perm_b32 v68, v117, v116, s17
    v_lshl_add_u64 v[64:65], v[64:65], 0, s[20:21]
    v_lshl_add_u64 v[66:67], v[66:67], 0, s[20:21]
    v_lshl_add_u64 v[68:69], v[68:69], 0, s[20:21]
    v_or3_b32 v4, v44, v45, v4
    v_or3_b32 v4, v46, v47, v4
    v_or3_b32 v4, v48, v49, v4
    ds_add_rtn_u64 v[44:45], v8, v[64:65]
    ds_add_rtn_u64 v[46:47], v9, v[66:67]
    ds_add_rtn_u64 v[48:49], v10, v[68:69]
    s_waitcnt lgkmcnt(3)
    v_mad_u32_u16 v119, v119, s23, v2
    v_pk_lshrrev_b16 v119, 10, v119 op_sel_hi:[1,1]
    v_lshl_add_u32 v118, v118, 6, v119
    buffer_load_dwordx4 v[8:11], v118, s[44:47], s30 idxen
    s_add_u32 s14, s22, 65536
    buffer_load_dwordx4 v[104:107], v1, s[8:11], s14 offen
    s_waitcnt vmcnt(7)
    v_mad_u32_u16 v76, v16, 8, s18
    v_mad_u32_u16 v78, v17, 8, s18
    v_mad_u32_u16 v80, v18, 8, s18
    ds_read_b64 v[76:77], v76
    ds_read_b64 v[78:79], v78
    ds_read_b64 v[80:81], v80
    s_waitcnt vmcnt(6)
    v_mad_u32_u16 v82, v20, 8, s18
    v_mad_u32_u16 v84, v21, 8, s18
    v_mad_u32_u16 v86, v22, 8, s18
    ds_read_b64 v[82:83], v82
    ds_read_b64 v[84:85], v84
    ds_read_b64 v[86:87], v86
    v_mbcnt_lo_u32_b32 v118, s32, 0
    v_mbcnt_hi_u32_b32 v118, s33, v118
    s_bcnt1_i32_b64 s14, s[32:33]
    v_lshl_add_u32 v119, v118, 1, s25
    ds_read_u16 v119, v119
    s_add_u32 s32, s26, 1048576
    s_lshl1_add_u32 s25, s14, s25
    s_lshl_b32 s14, s14, 10
    s_add_u32 s26, s26, s14
    v_bfe_i32 v108, v15, 2, 10
    v_bfe_i32 v109, v15, 12, 10
    v_ashrrev_i32 v110, 22, v15
    v_cvt_f32_i32 v108, v108
    v_cvt_f32_i32 v109, v109
    v_cvt_f32_i32 v110, v110
    v_mad_u32_u16 v12, v12, 8, s50 op_sel:[1,0,0,0]
    v_mad_u32_u16 v13, v13, 8, s50 op_sel:[1,0,0,0]
    v_mad_u32_u16 v14, v14, 8, s50 op_sel:[1,0,0,0]
    v_lshlrev_b32 v112, 16, v70
    v_and_b32 v113, 0xffff0000, v70
    v_lshlrev_b32 v70, 16, v71
    v_and_b32 v71, 0xffff0000, v71
    v_lshlrev_b32 v114, 16, v72
    v_and_b32 v115, 0xffff0000, v72
    v_lshlrev_b32 v72, 16, v73
    v_and_b32 v73, 0xffff0000, v73
    v_lshlrev_b32 v116, 16, v74
    v_and_b32 v117, 0xffff0000, v74
    v_lshlrev_b32 v74, 16, v75
    v_and_b32 v75, 0xffff0000, v75
    v_pk_fma_f32 v[112:113], v[112:113], v[108:109], s[16:17] op_sel:[0,0,0] op_sel_hi:[1,0,0]
    v_pk_fma_f32 v[70:71], v[70:71], v[108:109], s[16:17] op_sel:[0,0,0] op_sel_hi:[1,0,0]
    v_pk_fma_f32 v[114:115], v[114:115], v[108:109], s[16:17] op_sel:[0,1,0] op_sel_hi:[1,1,0]
    v_pk_fma_f32 v[72:73], v[72:73], v[108:109], s[16:17] op_sel:[0,1,0] op_sel_hi:[1,1,0]
    v_pk_fma_f32 v[116:117], v[116:117], v[110:111], s[16:17] op_sel:[0,0,0] op_sel_hi:[1,0,0]
    v_pk_fma_f32 v[74:75], v[74:75], v[110:111], s[16:17] op_sel:[0,0,0] op_sel_hi:[1,0,0]
    v_perm_b32 v71, v71, v70, s17
    v_perm_b32 v70, v113, v112, s17
    v_perm_b32 v73, v73, v72, s17
    v_perm_b32 v72, v115, v114, s17
    v_perm_b32 v75, v75, v74, s17
    v_perm_b32 v74, v117, v116, s17
    v_lshl_add_u64 v[70:71], v[70:71], 0, s[20:21]
    v_lshl_add_u64 v[72:73], v[72:73], 0, s[20:21]
    v_lshl_add_u64 v[74:75], v[74:75], 0, s[20:21]
    s_waitcnt lgkmcnt(7)
    v_or3_b32 v4, v44, v45, v4
    v_or3_b32 v4, v46, v47, v4
    v_or3_b32 v4, v48, v49, v4
    ds_add_rtn_u64 v[44:45], v12, v[70:71]
    ds_add_rtn_u64 v[46:47], v13, v[72:73]
    ds_add_rtn_u64 v[48:49], v14, v[74:75]
    s_waitcnt lgkmcnt(3)
    v_mad_u32_u16 v119, v119, s23, v2
    v_pk_lshrrev_b16 v119, 10, v119 op_sel_hi:[1,1]
    v_lshl_add_u32 v118, v118, 6, v119
    buffer_load_dwordx4 v[12:15], v118, s[44:47], s32 idxen
    s_cmp_le_u32 s51, 256
    s_cbranch_scc1 L_p2_kernel_noopt2_4
    v_mad_u32_u16 v64, v24, 8, s18
    v_mad_u32_u16 v66, v25, 8, s18
    v_mad_u32_u16 v68, v26, 8, s18
    ds_read_b64 v[64:65], v64
    ds_read_b64 v[66:67], v66
    ds_read_b64 v[68:69], v68
    v_bfe_i32 v108, v27, 2, 10
    v_bfe_i32 v109, v27, 12, 10
    v_ashrrev_i32 v110, 22, v27
    v_cvt_f32_i32 v108, v108
    v_cvt_f32_i32 v109, v109
    v_cvt_f32_i32 v110, v110
    v_mad_u32_u16 v24, v24, 8, s50 op_sel:[1,0,0,0]
    v_mad_u32_u16 v25, v25, 8, s50 op_sel:[1,0,0,0]
    v_mad_u32_u16 v26, v26, 8, s50 op_sel:[1,0,0,0]
    s_waitcnt lgkmcnt(0)
    v_lshlrev_b32 v112, 16, v64
    v_and_b32 v113, 0xffff0000, v64
    v_lshlrev_b32 v64, 16, v65
    v_and_b32 v65, 0xffff0000, v65
    v_lshlrev_b32 v114, 16, v66
    v_and_b32 v115, 0xffff0000, v66
    v_lshlrev_b32 v66, 16, v67
    v_and_b32 v67, 0xffff0000, v67
    v_lshlrev_b32 v116, 16, v68
    v_and_b32 v117, 0xffff0000, v68
    v_lshlrev_b32 v68, 16, v69
    v_and_b32 v69, 0xffff0000, v69
    v_pk_fma_f32 v[112:113], v[112:113], v[108:109], s[16:17] op_sel:[0,0,0] op_sel_hi:[1,0,0]
    v_pk_fma_f32 v[64:65], v[64:65], v[108:109], s[16:17] op_sel:[0,0,0] op_sel_hi:[1,0,0]
    v_pk_fma_f32 v[114:115], v[114:115], v[108:109], s[16:17] op_sel:[0,1,0] op_sel_hi:[1,1,0]
    v_pk_fma_f32 v[66:67], v[66:67], v[108:109], s[16:17] op_sel:[0,1,0] op_sel_hi:[1,1,0]
    v_pk_fma_f32 v[116:117], v[116:117], v[110:111], s[16:17] op_sel:[0,0,0] op_sel_hi:[1,0,0]
    v_pk_fma_f32 v[68:69], v[68:69], v[110:111], s[16:17] op_sel:[0,0,0] op_sel_hi:[1,0,0]
    v_perm_b32 v65, v65, v64, s17
    v_perm_b32 v64, v113, v112, s17
    v_perm_b32 v67, v67, v66, s17
    v_perm_b32 v66, v115, v114, s17
    v_perm_b32 v69, v69, v68, s17
    v_perm_b32 v68, v117, v116, s17
    v_lshl_add_u64 v[64:65], v[64:65], 0, s[20:21]
    v_lshl_add_u64 v[66:67], v[66:67], 0, s[20:21]
    v_lshl_add_u64 v[68:69], v[68:69], 0, s[20:21]
    v_or3_b32 v4, v44, v45, v4
    v_or3_b32 v4, v46, v47, v4
    v_or3_b32 v4, v48, v49, v4
    ds_add_rtn_u64 v[44:45], v24, v[64:65]
    ds_add_rtn_u64 v[46:47], v25, v[66:67]
    ds_add_rtn_u64 v[48:49], v26, v[68:69]
L_p2_kernel_noopt2_4:
    s_barrier
    s_waitcnt vmcnt(1)
    ds_write_b128 v3, v[88:91] offset:0
    ds_write_b128 v3, v[92:95] offset:16384
    ds_write_b128 v3, v[96:99] offset:32768
    ds_write_b128 v3, v[100:103] offset:49152
    ds_write_b128 v124, v[104:107] offset:0
    v_mbcnt_lo_u32_b32 v118, s34, 0
    v_mbcnt_hi_u32_b32 v118, s35, v118
    s_bcnt1_i32_b64 s14, s[34:35]
    v_lshl_add_u32 v119, v118, 1, s25
    ds_read_u16 v119, v119
    s_add_u32 s34, s26, 2097152
    s_lshl1_add_u32 s25, s14, s25
    s_lshl_b32 s14, s14, 10
    s_add_u32 s26, s26, s14
    v_bfe_i32 v108, v19, 2, 10
    v_bfe_i32 v109, v19, 12, 10
    v_ashrrev_i32 v110, 22, v19
    v_cvt_f32_i32 v108, v108
    v_cvt_f32_i32 v109, v109
    v_cvt_f32_i32 v110, v110
    v_mad_u32_u16 v16, v16, 8, s50 op_sel:[1,0,0,0]
    v_mad_u32_u16 v17, v17, 8, s50 op_sel:[1,0,0,0]
    v_mad_u32_u16 v18, v18, 8, s50 op_sel:[1,0,0,0]
    v_lshlrev_b32 v112, 16, v76
    v_and_b32 v113, 0xffff0000, v76
    v_lshlrev_b32 v76, 16, v77
    v_and_b32 v77, 0xffff0000, v77
    v_lshlrev_b32 v114, 16, v78
    v_and_b32 v115, 0xffff0000, v78
    v_lshlrev_b32 v78, 16, v79
    v_and_b32 v79, 0xffff0000, v79
    v_lshlrev_b32 v116, 16, v80
    v_and_b32 v117, 0xffff0000, v80
    v_lshlrev_b32 v80, 16, v81
    v_and_b32 v81, 0xffff0000, v81
    v_pk_fma_f32 v[112:113], v[112:113], v[108:109], s[16:17] op_sel:[0,0,0] op_sel_hi:[1,0,0]
    v_pk_fma_f32 v[76:77], v[76:77], v[108:109], s[16:17] op_sel:[0,0,0] op_sel_hi:[1,0,0]
    v_pk_fma_f32 v[114:115], v[114:115], v[108:109], s[16:17] op_sel:[0,1,0] op_sel_hi:[1,1,0]
    v_pk_fma_f32 v[78:79], v[78:79], v[108:109], s[16:17] op_sel:[0,1,0] op_sel_hi:[1,1,0]
    v_pk_fma_f32 v[116:117], v[116:117], v[110:111], s[16:17] op_sel:[0,0,0] op_sel_hi:[1,0,0]
    v_pk_fma_f32 v[80:81], v[80:81], v[110:111], s[16:17] op_sel:[0,0,0] op_sel_hi:[1,0,0]
    v_perm_b32 v77, v77, v76, s17
    v_perm_b32 v76, v113, v112, s17
    v_perm_b32 v79, v79, v78, s17
    v_perm_b32 v78, v115, v114, s17
    v_perm_b32 v81, v81, v80, s17
    v_perm_b32 v80, v117, v116, s17
    v_lshl_add_u64 v[76:77], v[76:77], 0, s[20:21]
    v_lshl_add_u64 v[78:79], v[78:79], 0, s[20:21]
    v_lshl_add_u64 v[80:81], v[80:81], 0, s[20:21]
    s_waitcnt lgkmcnt(6)
    v_or3_b32 v4, v44, v45, v4
    v_or3_b32 v4, v46, v47, v4
    v_or3_b32 v4, v48, v49, v4
    ds_add_rtn_u64 v[44:45], v16, v[76:77]
    ds_add_rtn_u64 v[46:47], v17, v[78:79]
    ds_add_rtn_u64 v[48:49], v18, v[80:81]
    s_waitcnt lgkmcnt(3)
    v_mad_u32_u16 v119, v119, s23, v2
    v_pk_lshrrev_b16 v119, 10, v119 op_sel_hi:[1,1]
    v_lshl_add_u32 v118, v118, 6, v119
    buffer_load_dwordx4 v[16:19], v118, s[44:47], s34 idxen
    v_mbcnt_lo_u32_b32 v118, s36, 0
    v_mbcnt_hi_u32_b32 v118, s37, v118
    s_bcnt1_i32_b64 s14, s[36:37]
    v_lshl_add_u32 v119, v118, 1, s25
    ds_read_u16 v119, v119
    s_add_u32 s36, s26, 3145728
    s_lshl1_add_u32 s25, s14, s25
    s_lshl_b32 s14, s14, 10
    s_add_u32 s26, s26, s14
    v_bfe_i32 v108, v23, 2, 10
    v_bfe_i32 v109, v23, 12, 10
    v_ashrrev_i32 v110, 22, v23
    v_cvt_f32_i32 v108, v108
    v_cvt_f32_i32 v109, v109
    v_cvt_f32_i32 v110, v110
    v_mad_u32_u16 v20, v20, 8, s50 op_sel:[1,0,0,0]
    v_mad_u32_u16 v21, v21, 8, s50 op_sel:[1,0,0,0]
    v_mad_u32_u16 v22, v22, 8, s50 op_sel:[1,0,0,0]
    v_lshlrev_b32 v112, 16, v82
    v_and_b32 v113, 0xffff0000, v82
    v_lshlrev_b32 v82, 16, v83
    v_and_b32 v83, 0xffff0000, v83
    v_lshlrev_b32 v114, 16, v84
    v_and_b32 v115, 0xffff0000, v84
    v_lshlrev_b32 v84, 16, v85
    v_and_b32 v85, 0xffff0000, v85
    v_lshlrev_b32 v116, 16, v86
    v_and_b32 v117, 0xffff0000, v86
    v_lshlrev_b32 v86, 16, v87
    v_and_b32 v87, 0xffff0000, v87
    v_pk_fma_f32 v[112:113], v[112:113], v[108:109], s[16:17] op_sel:[0,0,0] op_sel_hi:[1,0,0]
    v_pk_fma_f32 v[82:83], v[82:83], v[108:109], s[16:17] op_sel:[0,0,0] op_sel_hi:[1,0,0]
    v_pk_fma_f32 v[114:115], v[114:115], v[108:109], s[16:17] op_sel:[0,1,0] op_sel_hi:[1,1,0]
    v_pk_fma_f32 v[84:85], v[84:85], v[108:109], s[16:17] op_sel:[0,1,0] op_sel_hi:[1,1,0]
    v_pk_fma_f32 v[116:117], v[116:117], v[110:111], s[16:17] op_sel:[0,0,0] op_sel_hi:[1,0,0]
    v_pk_fma_f32 v[86:87], v[86:87], v[110:111], s[16:17] op_sel:[0,0,0] op_sel_hi:[1,0,0]
    v_perm_b32 v83, v83, v82, s17
    v_perm_b32 v82, v113, v112, s17
    v_perm_b32 v85, v85, v84, s17
    v_perm_b32 v84, v115, v114, s17
    v_perm_b32 v87, v87, v86, s17
    v_perm_b32 v86, v117, v116, s17
    v_lshl_add_u64 v[82:83], v[82:83], 0, s[20:21]
    v_lshl_add_u64 v[84:85], v[84:85], 0, s[20:21]
    v_lshl_add_u64 v[86:87], v[86:87], 0, s[20:21]
    s_waitcnt lgkmcnt(1)
    v_or3_b32 v4, v44, v45, v4
    v_or3_b32 v4, v46, v47, v4
    v_or3_b32 v4, v48, v49, v4
    ds_add_rtn_u64 v[44:45], v20, v[82:83]
    ds_add_rtn_u64 v[46:47], v21, v[84:85]
    ds_add_rtn_u64 v[48:49], v22, v[86:87]
    s_waitcnt lgkmcnt(3)
    v_mad_u32_u16 v119, v119, s23, v2
    v_pk_lshrrev_b16 v119, 10, v119 op_sel_hi:[1,1]
    v_lshl_add_u32 v118, v118, 6, v119
    buffer_load_dwordx4 v[20:23], v118, s[44:47], s36 idxen
    s_cmp_le_u32 s28, 256
    s_cbranch_scc1 L_p2_kernel_noopt_5
    v_readlane_b32 s38, v7, 8
    v_readlane_b32 s39, v7, 9
    s_nop 1
    v_mbcnt_lo_u32_b32 v118, s38, 0
    v_mbcnt_hi_u32_b32 v118, s39, v118
    s_bcnt1_i32_b64 s14, s[38:39]
    v_lshl_add_u32 v119, v118, 1, s25
    ds_read_u16 v119, v119
    s_add_u32 s38, s26, 4194304
    s_lshl1_add_u32 s25, s14, s25
    s_lshl_b32 s14, s14, 10
    s_add_u32 s26, s26, s14
    s_waitcnt lgkmcnt(0)
    v_mad_u32_u16 v119, v119, s23, v2
    v_pk_lshrrev_b16 v119, 10, v119 op_sel_hi:[1,1]
    v_lshl_add_u32 v118, v118, 6, v119
    buffer_load_dwordx4 v[24:27], v118, s[44:47], s38 idxen
L_p2_kernel_noopt_5:
    v_mad_u32_u16 v108, v28, v50, s40 op_sel:[1,0,0,0]
    v_mad_u32_u16 v109, v36, v50, s41 op_sel:[1,0,0,0]
    v_sub_u32_sdwa v110, v109, v108 dst_sel:DWORD dst_unused:UNUSED_PAD src0_sel:WORD_1 src1_sel:WORD_1
    s_nop 1
    v_add_u32_dpp v110, v110, v110 row_shr:1 row_mask:0xf bank_mask:0xf bound_ctrl:0
    s_nop 1
    v_add_u32_dpp v110, v110, v110 row_shr:2 row_mask:0xf bank_mask:0xf bound_ctrl:0
    s_nop 1
    v_add_u32_dpp v110, v110, v110 row_shr:4 row_mask:0xf bank_mask:0xf bound_ctrl:0
    s_nop 1
    v_add_u32_dpp v110, v110, v110 row_shr:8 row_mask:0xf bank_mask:0xf bound_ctrl:0
    s_nop 1
    v_add_u32_dpp v110, v110, v110 row_bcast:15 row_mask:0xa bank_mask:0xf
    s_nop 1
    v_add_u32_dpp v110, v110, v110 row_bcast:31 row_mask:0xc bank_mask:0xf
    v_sub_u32_sdwa v109, v109, v110 dst_sel:DWORD dst_unused:UNUSED_PAD src0_sel:WORD_1 src1_sel:DWORD
    v_readlane_b32 s29, v110, 63
    v_add_u32 v110, -1, v110
    ds_write_b16 v126, v109
    v_lshlrev_b32_e64 v111, v110, 1
    v_lshrrev_b32 v110, 5, v110
    v_lshl_add_u32 v110, v110, 2, s19
    s_cmp_gt_u32 s29, 320
    s_cselect_b32 s2, 1, s2
    s_cselect_b64 exec, 0, -1
    ds_or_b32 v110, v111 offset:160
    s_mov_b64 exec, -1
    ds_wrxchg_rtn_b32 v7, v6, v5 offset:160
    s_add_u32 s14, s22, 80000
    buffer_load_dwordx4 v[88:91], v1, s[8:11], s14 offen
    s_add_u32 s14, s22, 96384
    buffer_load_dwordx4 v[92:95], v1, s[8:11], s14 offen
    s_add_u32 s24, s24, 1
    s_cmp_lt_u32 s24, 8
    s_barrier
    s_cbranch_scc1 L_p2_loop
    s_waitcnt lgkmcnt(3)
    v_or3_b32 v4, v44, v45, v4
    v_or3_b32 v4, v46, v47, v4
    v_or3_b32 v4, v48, v49, v4
    s_mov_b32 s27, s19
    s_waitcnt vmcnt(0)
    v_mov_b32 v8, 160232
    s_cmp_lg_u32 s13, 0
    s_cselect_b64 exec, 0, 1
    ds_write_b32 v8, v52
    s_mov_b64 exec, -1
    v_subrev_u32 v6, 80000, v124
    s_mul_i32 s24, s12, 20000
    v_subrev_u32 v10, s24, v1
    v_mov_b32 v11, 0x7f000000
    s_waitcnt vmcnt(0) lgkmcnt(0)
    s_barrier
    s_cmp_lt_u32 s13, 4
    s_cbranch_scc1 L_p2_ga
    v_lshlrev_b32 v30, 16, v60
    v_and_b32 v31, 0xffff0000, v60
    v_lshlrev_b32 v36, 16, v53
    v_and_b32 v37, 0xffff0000, v53
    v_lshlrev_b32 v38, 16, v54
    v_and_b32 v39, 0xffff0000, v54
    v_lshlrev_b32 v40, 16, v56
    v_and_b32 v41, 0xffff0000, v56
    v_lshlrev_b32 v42, 16, v57
    v_and_b32 v43, 0xffff0000, v57
    v_pk_add_f32 v[14:15], v[30:31], v[36:37] op_sel:[0,0] op_sel_hi:[1,0] neg_lo:[0,1] neg_hi:[0,1]
    v_pk_add_f32 v[16:17], v[30:31], v[36:37] op_sel:[0,1] op_sel_hi:[1,1] neg_lo:[0,1] neg_hi:[0,1]
    v_pk_add_f32 v[18:19], v[30:31], v[38:39] op_sel:[0,0] op_sel_hi:[1,0] neg_lo:[0,1] neg_hi:[0,1]
    v_pk_add_f32 v[20:21], v[30:31], v[38:39] op_sel:[0,1] op_sel_hi:[1,1] neg_lo:[0,1] neg_hi:[0,1]
    v_pk_add_f32 v[22:23], v[30:31], v[40:41] op_sel:[0,0] op_sel_hi:[1,0] neg_lo:[0,1] neg_hi:[0,1]
    v_pk_add_f32 v[24:25], v[30:31], v[40:41] op_sel:[0,1] op_sel_hi:[1,1] neg_lo:[0,1] neg_hi:[0,1]
    v_pk_add_f32 v[26:27], v[30:31], v[42:43] op_sel:[0,0] op_sel_hi:[1,0] neg_lo:[0,1] neg_hi:[0,1]
    v_pk_add_f32 v[28:29], v[30:31], v[42:43] op_sel:[0,1] op_sel_hi:[1,1] neg_lo:[0,1] neg_hi:[0,1]
    v_cvt_pk_bf16_f32 v32, v14, v15
    v_lshlrev_b32 v14, 16, v32
    v_and_b32 v15, 0xffff0000, v32
    v_cvt_pk_bf16_f32 v32, v16, v17
    v_lshlrev_b32 v16, 16, v32
    v_and_b32 v17, 0xffff0000, v32
    v_cvt_pk_bf16_f32 v32, v18, v19
    v_lshlrev_b32 v18, 16, v32
    v_and_b32 v19, 0xffff0000, v32
    v_cvt_pk_bf16_f32 v32, v20, v21
    v_lshlrev_b32 v20, 16, v32
    v_and_b32 v21, 0xffff0000, v32
    v_cvt_pk_bf16_f32 v32, v22, v23
    v_lshlrev_b32 v22, 16, v32
    v_and_b32 v23, 0xffff0000, v32
    v_cvt_pk_bf16_f32 v32, v24, v25
    v_lshlrev_b32 v24, 16, v32
    v_and_b32 v25, 0xffff0000, v32
    v_cvt_pk_bf16_f32 v32, v26, v27
    v_lshlrev_b32 v26, 16, v32
    v_and_b32 v27, 0xffff0000, v32
    v_cvt_pk_bf16_f32 v32, v28, v29
    v_lshlrev_b32 v28, 16, v32
    v_and_b32 v29, 0xffff0000, v32
    v_pk_mul_f32 v[14:15], v[14:15], v[14:15]
    v_pk_mul_f32 v[16:17], v[16:17], v[16:17]
    v_pk_mul_f32 v[18:19], v[18:19], v[18:19]
    v_pk_mul_f32 v[20:21], v[20:21], v[20:21]
    v_pk_mul_f32 v[22:23], v[22:23], v[22:23]
    v_pk_mul_f32 v[24:25], v[24:25], v[24:25]
    v_pk_mul_f32 v[26:27], v[26:27], v[26:27]
    v_pk_mul_f32 v[28:29], v[28:29], v[28:29]
    v_cvt_pk_bf16_f32 v32, v14, v15
    v_lshlrev_b32 v14, 16, v32
    v_and_b32 v15, 0xffff0000, v32
    v_cvt_pk_bf16_f32 v32, v16, v17
    v_lshlrev_b32 v16, 16, v32
    v_and_b32 v17, 0xffff0000, v32
    v_cvt_pk_bf16_f32 v32, v18, v19
    v_lshlrev_b32 v18, 16, v32
    v_and_b32 v19, 0xffff0000, v32
    v_cvt_pk_bf16_f32 v32, v20, v21
    v_lshlrev_b32 v20, 16, v32
    v_and_b32 v21, 0xffff0000, v32
    v_cvt_pk_bf16_f32 v32, v22, v23
    v_lshlrev_b32 v22, 16, v32
    v_and_b32 v23, 0xffff0000, v32
    v_cvt_pk_bf16_f32 v32, v24, v25
    v_lshlrev_b32 v24, 16, v32
    v_and_b32 v25, 0xffff0000, v32
    v_cvt_pk_bf16_f32 v32, v26, v27
    v_lshlrev_b32 v26, 16, v32
    v_and_b32 v27, 0xffff0000, v32
    v_cvt_pk_bf16_f32 v32, v28, v29
    v_lshlrev_b32 v28, 16, v32
    v_and_b32 v29, 0xffff0000, v32
    v_mov_b32 v30, 1092616192
    v_mov_b32 v31, 0x3fb8aa3b
    v_pk_mul_f32 v[14:15], v[14:15], v[30:31] op_sel:[0,0] op_sel_hi:[1,0]
    v_pk_mul_f32 v[16:17], v[16:17], v[30:31] op_sel:[0,0] op_sel_hi:[1,0]
    v_pk_mul_f32 v[18:19], v[18:19], v[30:31] op_sel:[0,0] op_sel_hi:[1,0]
    v_pk_mul_f32 v[20:21], v[20:21], v[30:31] op_sel:[0,0] op_sel_hi:[1,0]
    v_pk_mul_f32 v[22:23], v[22:23], v[30:31] op_sel:[0,0] op_sel_hi:[1,0]
    v_pk_mul_f32 v[24:25], v[24:25], v[30:31] op_sel:[0,0] op_sel_hi:[1,0]
    v_pk_mul_f32 v[26:27], v[26:27], v[30:31] op_sel:[0,0] op_sel_hi:[1,0]
    v_pk_mul_f32 v[28:29], v[28:29], v[30:31] op_sel:[0,0] op_sel_hi:[1,0]
    v_cvt_pk_bf16_f32 v32, v14, v15
    v_lshlrev_b32 v14, 16, v32
    v_and_b32 v15, 0xffff0000, v32
    v_cvt_pk_bf16_f32 v32, v16, v17
    v_lshlrev_b32 v16, 16, v32
    v_and_b32 v17, 0xffff0000, v32
    v_cvt_pk_bf16_f32 v32, v18, v19
    v_lshlrev_b32 v18, 16, v32
    v_and_b32 v19, 0xffff0000, v32
    v_cvt_pk_bf16_f32 v32, v20, v21
    v_lshlrev_b32 v20, 16, v32
    v_and_b32 v21, 0xffff0000, v32
    v_cvt_pk_bf16_f32 v32, v22, v23
    v_lshlrev_b32 v22, 16, v32
    v_and_b32 v23, 0xffff0000, v32
    v_cvt_pk_bf16_f32 v32, v24, v25
    v_lshlrev_b32 v24, 16, v32
    v_and_b32 v25, 0xffff0000, v32
    v_cvt_pk_bf16_f32 v32, v26, v27
    v_lshlrev_b32 v26, 16, v32
    v_and_b32 v27, 0xffff0000, v32
    v_cvt_pk_bf16_f32 v32, v28, v29
    v_lshlrev_b32 v28, 16, v32
    v_and_b32 v29, 0xffff0000, v32
    v_pk_mul_f32 v[14:15], v[14:15], v[30:31] op_sel:[0,1] op_sel_hi:[1,1]
    v_pk_mul_f32 v[16:17], v[16:17], v[30:31] op_sel:[0,1] op_sel_hi:[1,1]
    v_pk_mul_f32 v[18:19], v[18:19], v[30:31] op_sel:[0,1] op_sel_hi:[1,1]
    v_pk_mul_f32 v[20:21], v[20:21], v[30:31] op_sel:[0,1] op_sel_hi:[1,1]
    v_pk_mul_f32 v[22:23], v[22:23], v[30:31] op_sel:[0,1] op_sel_hi:[1,1]
    v_pk_mul_f32 v[24:25], v[24:25], v[30:31] op_sel:[0,1] op_sel_hi:[1,1]
    v_pk_mul_f32 v[26:27], v[26:27], v[30:31] op_sel:[0,1] op_sel_hi:[1,1]
    v_pk_mul_f32 v[28:29], v[28:29], v[30:31] op_sel:[0,1] op_sel_hi:[1,1]
    v_exp_f32 v14, -v14
    v_exp_f32 v15, -v15
    v_exp_f32 v16, -v16
    v_exp_f32 v17, -v17
    v_exp_f32 v18, -v18
    v_exp_f32 v19, -v19
    v_exp_f32 v20, -v20
    v_exp_f32 v21, -v21
    v_exp_f32 v22, -v22
    v_exp_f32 v23, -v23
    v_exp_f32 v24, -v24
    v_exp_f32 v25, -v25
    v_exp_f32 v26, -v26
    v_exp_f32 v27, -v27
    v_exp_f32 v28, -v28
    v_exp_f32 v29, -v29
    v_cvt_pk_bf16_f32 v14, v14, v16
    v_cvt_pk_bf16_f32 v15, v15, v17
    v_cvt_pk_bf16_f32 v18, v18, v20
    v_cvt_pk_bf16_f32 v19, v19, v21
    v_cvt_pk_bf16_f32 v22, v22, v24
    v_cvt_pk_bf16_f32 v23, v23, v25
    v_cvt_pk_bf16_f32 v26, v26, v28
    v_cvt_pk_bf16_f32 v27, v27, v29
    v_dot2_f32_bf16 v72, v14, s68, 0
    v_dot2_f32_bf16 v73, v15, s68, 0
    v_dot2_f32_bf16 v74, v14, s69, 0
    v_dot2_f32_bf16 v75, v15, s69, 0
    v_dot2_f32_bf16 v76, v14, s70, 0
    v_dot2_f32_bf16 v77, v15, s70, 0
    v_dot2_f32_bf16 v78, v14, s71, 0
    v_dot2_f32_bf16 v79, v15, s71, 0
    v_dot2_f32_bf16 v80, v14, s52, 0
    v_dot2_f32_bf16 v81, v15, s52, 0
    v_dot2_f32_bf16 v82, v14, s53, 0
    v_dot2_f32_bf16 v83, v15, s53, 0
    v_dot2_f32_bf16 v84, v14, s54, 0
    v_dot2_f32_bf16 v85, v15, s54, 0
    v_dot2_f32_bf16 v86, v14, s55, 0
    v_dot2_f32_bf16 v87, v15, s55, 0
    v_dot2_f32_bf16 v72, v18, s72, v72
    v_dot2_f32_bf16 v73, v19, s72, v73
    v_dot2_f32_bf16 v74, v18, s73, v74
    v_dot2_f32_bf16 v75, v19, s73, v75
    v_dot2_f32_bf16 v76, v18, s74, v76
    v_dot2_f32_bf16 v77, v19, s74, v77
    v_dot2_f32_bf16 v78, v18, s75, v78
    v_dot2_f32_bf16 v79, v19, s75, v79
    v_dot2_f32_bf16 v80, v18, s56, v80
    v_dot2_f32_bf16 v81, v19, s56, v81
    v_dot2_f32_bf16 v82, v18, s57, v82
    v_dot2_f32_bf16 v83, v19, s57, v83
    v_dot2_f32_bf16 v84, v18, s58, v84
    v_dot2_f32_bf16 v85, v19, s58, v85
    v_dot2_f32_bf16 v86, v18, s59, v86
    v_dot2_f32_bf16 v87, v19, s59, v87
    v_dot2_f32_bf16 v72, v22, s76, v72
    v_dot2_f32_bf16 v73, v23, s76, v73
    v_dot2_f32_bf16 v74, v22, s77, v74
    v_dot2_f32_bf16 v75, v23, s77, v75
    v_dot2_f32_bf16 v76, v22, s78, v76
    v_dot2_f32_bf16 v77, v23, s78, v77
    v_dot2_f32_bf16 v78, v22, s79, v78
    v_dot2_f32_bf16 v79, v23, s79, v79
    v_dot2_f32_bf16 v80, v22, s60, v80
    v_dot2_f32_bf16 v81, v23, s60, v81
    v_dot2_f32_bf16 v82, v22, s61, v82
    v_dot2_f32_bf16 v83, v23, s61, v83
    v_dot2_f32_bf16 v84, v22, s62, v84
    v_dot2_f32_bf16 v85, v23, s62, v85
    v_dot2_f32_bf16 v86, v22, s63, v86
    v_dot2_f32_bf16 v87, v23, s63, v87
    v_dot2_f32_bf16 v72, v26, s80, v72
    v_dot2_f32_bf16 v73, v27, s80, v73
    v_dot2_f32_bf16 v74, v26, s81, v74
    v_dot2_f32_bf16 v75, v27, s81, v75
    v_dot2_f32_bf16 v76, v26, s82, v76
    v_dot2_f32_bf16 v77, v27, s82, v77
    v_dot2_f32_bf16 v78, v26, s83, v78
    v_dot2_f32_bf16 v79, v27, s83, v79
    v_dot2_f32_bf16 v80, v26, s64, v80
    v_dot2_f32_bf16 v81, v27, s64, v81
    v_dot2_f32_bf16 v82, v26, s65, v82
    v_dot2_f32_bf16 v83, v27, s65, v83
    v_dot2_f32_bf16 v84, v26, s66, v84
    v_dot2_f32_bf16 v85, v27, s66, v85
    v_dot2_f32_bf16 v86, v26, s67, v86
    v_dot2_f32_bf16 v87, v27, s67, v87
L_p2_ga:
    ds_read_b32 v9, v8
    ds_read_b128 v[88:91], v1 offset:0
    ds_read_b128 v[92:95], v1 offset:16384
    ds_read_b128 v[96:99], v1 offset:32768
    ds_read_b128 v[100:103], v1 offset:49152
    ds_read_b128 v[104:107], v6
    s_mul_i32 s14, s12, 5120000
    s_mul_i32 s15, s3, 80000
    s_add_u32 s25, s14, s15
    s_add_u32 s25, s25, 233832448
    s_waitcnt lgkmcnt(5)
    v_readfirstlane_b32 s21, v9
    s_nop 0
    s_bfe_u32 s21, s21, 524296
    s_cmp_lg_u32 s21, 4
    s_cselect_b32 s21, 1, 0
    s_cselect_b32 s24, 0, 20000
    v_cmp_le_u32 vcc, s24, v10
    v_add_u32 v10, 16384, v10
    s_add_u32 s14, s25, 0
    v_cndmask_b32 v12, v11, v1, vcc
    s_waitcnt lgkmcnt(4)
    buffer_store_dwordx4 v[88:91], v12, s[4:7], s14 offen sc1
    v_or3_b32 v4, v88, v89, v4
    v_or3_b32 v4, v90, v91, v4
    v_cmp_le_u32 vcc, s24, v10
    v_add_u32 v10, 16384, v10
    s_add_u32 s14, s25, 16384
    v_cndmask_b32 v12, v11, v1, vcc
    s_waitcnt lgkmcnt(3)
    buffer_store_dwordx4 v[92:95], v12, s[4:7], s14 offen sc1
    v_or3_b32 v4, v92, v93, v4
    v_or3_b32 v4, v94, v95, v4
    v_cmp_le_u32 vcc, s24, v10
    v_add_u32 v10, 16384, v10
    s_add_u32 s14, s25, 32768
    v_cndmask_b32 v12, v11, v1, vcc
    s_waitcnt lgkmcnt(2)
    buffer_store_dwordx4 v[96:99], v12, s[4:7], s14 offen sc1
    v_or3_b32 v4, v96, v97, v4
    v_or3_b32 v4, v98, v99, v4
    v_cmp_le_u32 vcc, s24, v10
    v_add_u32 v10, 16384, v10
    s_add_u32 s14, s25, 49152
    v_cndmask_b32 v12, v11, v1, vcc
    s_waitcnt lgkmcnt(1)
    buffer_store_dwordx4 v[100:103], v12, s[4:7], s14 offen sc1
    v_or3_b32 v4, v100, v101, v4
    v_or3_b32 v4, v102, v103, v4
    v_cmp_le_u32 vcc, s24, v10
    v_add_u32 v10, 16384, v10
    s_add_u32 s14, s25, 0
    v_cndmask_b32 v12, v11, v6, vcc
    s_waitcnt lgkmcnt(0)
    buffer_store_dwordx4 v[104:107], v12, s[4:7], s14 offen sc1
    v_or3_b32 v4, v104, v105, v4
    v_or3_b32 v4, v106, v107, v4
    s_load_dwordx2 s[16:17], s[0:1], 88
    s_cmp_ge_u32 s13, 4
    s_cbranch_scc1 L_p2_gb
    v_lshlrev_b32 v30, 16, v60
    v_and_b32 v31, 0xffff0000, v60
    v_lshlrev_b32 v36, 16, v53
    v_and_b32 v37, 0xffff0000, v53
    v_lshlrev_b32 v38, 16, v54
    v_and_b32 v39, 0xffff0000, v54
    v_lshlrev_b32 v40, 16, v56
    v_and_b32 v41, 0xffff0000, v56
    v_lshlrev_b32 v42, 16, v57
    v_and_b32 v43, 0xffff0000, v57
    v_pk_add_f32 v[14:15], v[30:31], v[36:37] op_sel:[0,0] op_sel_hi:[1,0] neg_lo:[0,1] neg_hi:[0,1]
    v_pk_add_f32 v[16:17], v[30:31], v[36:37] op_sel:[0,1] op_sel_hi:[1,1] neg_lo:[0,1] neg_hi:[0,1]
    v_pk_add_f32 v[18:19], v[30:31], v[38:39] op_sel:[0,0] op_sel_hi:[1,0] neg_lo:[0,1] neg_hi:[0,1]
    v_pk_add_f32 v[20:21], v[30:31], v[38:39] op_sel:[0,1] op_sel_hi:[1,1] neg_lo:[0,1] neg_hi:[0,1]
    v_pk_add_f32 v[22:23], v[30:31], v[40:41] op_sel:[0,0] op_sel_hi:[1,0] neg_lo:[0,1] neg_hi:[0,1]
    v_pk_add_f32 v[24:25], v[30:31], v[40:41] op_sel:[0,1] op_sel_hi:[1,1] neg_lo:[0,1] neg_hi:[0,1]
    v_pk_add_f32 v[26:27], v[30:31], v[42:43] op_sel:[0,0] op_sel_hi:[1,0] neg_lo:[0,1] neg_hi:[0,1]
    v_pk_add_f32 v[28:29], v[30:31], v[42:43] op_sel:[0,1] op_sel_hi:[1,1] neg_lo:[0,1] neg_hi:[0,1]
    v_cvt_pk_bf16_f32 v32, v14, v15
    v_lshlrev_b32 v14, 16, v32
    v_and_b32 v15, 0xffff0000, v32
    v_cvt_pk_bf16_f32 v32, v16, v17
    v_lshlrev_b32 v16, 16, v32
    v_and_b32 v17, 0xffff0000, v32
    v_cvt_pk_bf16_f32 v32, v18, v19
    v_lshlrev_b32 v18, 16, v32
    v_and_b32 v19, 0xffff0000, v32
    v_cvt_pk_bf16_f32 v32, v20, v21
    v_lshlrev_b32 v20, 16, v32
    v_and_b32 v21, 0xffff0000, v32
    v_cvt_pk_bf16_f32 v32, v22, v23
    v_lshlrev_b32 v22, 16, v32
    v_and_b32 v23, 0xffff0000, v32
    v_cvt_pk_bf16_f32 v32, v24, v25
    v_lshlrev_b32 v24, 16, v32
    v_and_b32 v25, 0xffff0000, v32
    v_cvt_pk_bf16_f32 v32, v26, v27
    v_lshlrev_b32 v26, 16, v32
    v_and_b32 v27, 0xffff0000, v32
    v_cvt_pk_bf16_f32 v32, v28, v29
    v_lshlrev_b32 v28, 16, v32
    v_and_b32 v29, 0xffff0000, v32
    v_pk_mul_f32 v[14:15], v[14:15], v[14:15]
    v_pk_mul_f32 v[16:17], v[16:17], v[16:17]
    v_pk_mul_f32 v[18:19], v[18:19], v[18:19]
    v_pk_mul_f32 v[20:21], v[20:21], v[20:21]
    v_pk_mul_f32 v[22:23], v[22:23], v[22:23]
    v_pk_mul_f32 v[24:25], v[24:25], v[24:25]
    v_pk_mul_f32 v[26:27], v[26:27], v[26:27]
    v_pk_mul_f32 v[28:29], v[28:29], v[28:29]
    v_cvt_pk_bf16_f32 v32, v14, v15
    v_lshlrev_b32 v14, 16, v32
    v_and_b32 v15, 0xffff0000, v32
    v_cvt_pk_bf16_f32 v32, v16, v17
    v_lshlrev_b32 v16, 16, v32
    v_and_b32 v17, 0xffff0000, v32
    v_cvt_pk_bf16_f32 v32, v18, v19
    v_lshlrev_b32 v18, 16, v32
    v_and_b32 v19, 0xffff0000, v32
    v_cvt_pk_bf16_f32 v32, v20, v21
    v_lshlrev_b32 v20, 16, v32
    v_and_b32 v21, 0xffff0000, v32
    v_cvt_pk_bf16_f32 v32, v22, v23
    v_lshlrev_b32 v22, 16, v32
    v_and_b32 v23, 0xffff0000, v32
    v_cvt_pk_bf16_f32 v32, v24, v25
    v_lshlrev_b32 v24, 16, v32
    v_and_b32 v25, 0xffff0000, v32
    v_cvt_pk_bf16_f32 v32, v26, v27
    v_lshlrev_b32 v26, 16, v32
    v_and_b32 v27, 0xffff0000, v32
    v_cvt_pk_bf16_f32 v32, v28, v29
    v_lshlrev_b32 v28, 16, v32
    v_and_b32 v29, 0xffff0000, v32
    v_mov_b32 v30, 1092616192
    v_mov_b32 v31, 0x3fb8aa3b
    v_pk_mul_f32 v[14:15], v[14:15], v[30:31] op_sel:[0,0] op_sel_hi:[1,0]
    v_pk_mul_f32 v[16:17], v[16:17], v[30:31] op_sel:[0,0] op_sel_hi:[1,0]
    v_pk_mul_f32 v[18:19], v[18:19], v[30:31] op_sel:[0,0] op_sel_hi:[1,0]
    v_pk_mul_f32 v[20:21], v[20:21], v[30:31] op_sel:[0,0] op_sel_hi:[1,0]
    v_pk_mul_f32 v[22:23], v[22:23], v[30:31] op_sel:[0,0] op_sel_hi:[1,0]
    v_pk_mul_f32 v[24:25], v[24:25], v[30:31] op_sel:[0,0] op_sel_hi:[1,0]
    v_pk_mul_f32 v[26:27], v[26:27], v[30:31] op_sel:[0,0] op_sel_hi:[1,0]
    v_pk_mul_f32 v[28:29], v[28:29], v[30:31] op_sel:[0,0] op_sel_hi:[1,0]
    v_cvt_pk_bf16_f32 v32, v14, v15
    v_lshlrev_b32 v14, 16, v32
    v_and_b32 v15, 0xffff0000, v32
    v_cvt_pk_bf16_f32 v32, v16, v17
    v_lshlrev_b32 v16, 16, v32
    v_and_b32 v17, 0xffff0000, v32
    v_cvt_pk_bf16_f32 v32, v18, v19
    v_lshlrev_b32 v18, 16, v32
    v_and_b32 v19, 0xffff0000, v32
    v_cvt_pk_bf16_f32 v32, v20, v21
    v_lshlrev_b32 v20, 16, v32
    v_and_b32 v21, 0xffff0000, v32
    v_cvt_pk_bf16_f32 v32, v22, v23
    v_lshlrev_b32 v22, 16, v32
    v_and_b32 v23, 0xffff0000, v32
    v_cvt_pk_bf16_f32 v32, v24, v25
    v_lshlrev_b32 v24, 16, v32
    v_and_b32 v25, 0xffff0000, v32
    v_cvt_pk_bf16_f32 v32, v26, v27
    v_lshlrev_b32 v26, 16, v32
    v_and_b32 v27, 0xffff0000, v32
    v_cvt_pk_bf16_f32 v32, v28, v29
    v_lshlrev_b32 v28, 16, v32
    v_and_b32 v29, 0xffff0000, v32
    v_pk_mul_f32 v[14:15], v[14:15], v[30:31] op_sel:[0,1] op_sel_hi:[1,1]
    v_pk_mul_f32 v[16:17], v[16:17], v[30:31] op_sel:[0,1] op_sel_hi:[1,1]
    v_pk_mul_f32 v[18:19], v[18:19], v[30:31] op_sel:[0,1] op_sel_hi:[1,1]
    v_pk_mul_f32 v[20:21], v[20:21], v[30:31] op_sel:[0,1] op_sel_hi:[1,1]
    v_pk_mul_f32 v[22:23], v[22:23], v[30:31] op_sel:[0,1] op_sel_hi:[1,1]
    v_pk_mul_f32 v[24:25], v[24:25], v[30:31] op_sel:[0,1] op_sel_hi:[1,1]
    v_pk_mul_f32 v[26:27], v[26:27], v[30:31] op_sel:[0,1] op_sel_hi:[1,1]
    v_pk_mul_f32 v[28:29], v[28:29], v[30:31] op_sel:[0,1] op_sel_hi:[1,1]
    v_exp_f32 v14, -v14
    v_exp_f32 v15, -v15
    v_exp_f32 v16, -v16
    v_exp_f32 v17, -v17
    v_exp_f32 v18, -v18
    v_exp_f32 v19, -v19
    v_exp_f32 v20, -v20
    v_exp_f32 v21, -v21
    v_exp_f32 v22, -v22
    v_exp_f32 v23, -v23
    v_exp_f32 v24, -v24
    v_exp_f32 v25, -v25
    v_exp_f32 v26, -v26
    v_exp_f32 v27, -v27
    v_exp_f32 v28, -v28
    v_exp_f32 v29, -v29
    v_cvt_pk_bf16_f32 v14, v14, v16
    v_cvt_pk_bf16_f32 v15, v15, v17
    v_cvt_pk_bf16_f32 v18, v18, v20
    v_cvt_pk_bf16_f32 v19, v19, v21
    v_cvt_pk_bf16_f32 v22, v22, v24
    v_cvt_pk_bf16_f32 v23, v23, v25
    v_cvt_pk_bf16_f32 v26, v26, v28
    v_cvt_pk_bf16_f32 v27, v27, v29
    v_dot2_f32_bf16 v72, v14, s68, 0
    v_dot2_f32_bf16 v73, v15, s68, 0
    v_dot2_f32_bf16 v74, v14, s69, 0
    v_dot2_f32_bf16 v75, v15, s69, 0
    v_dot2_f32_bf16 v76, v14, s70, 0
    v_dot2_f32_bf16 v77, v15, s70, 0
    v_dot2_f32_bf16 v78, v14, s71, 0
    v_dot2_f32_bf16 v79, v15, s71, 0
    v_dot2_f32_bf16 v80, v14, s52, 0
    v_dot2_f32_bf16 v81, v15, s52, 0
    v_dot2_f32_bf16 v82, v14, s53, 0
    v_dot2_f32_bf16 v83, v15, s53, 0
    v_dot2_f32_bf16 v84, v14, s54, 0
    v_dot2_f32_bf16 v85, v15, s54, 0
    v_dot2_f32_bf16 v86, v14, s55, 0
    v_dot2_f32_bf16 v87, v15, s55, 0
    v_dot2_f32_bf16 v72, v18, s72, v72
    v_dot2_f32_bf16 v73, v19, s72, v73
    v_dot2_f32_bf16 v74, v18, s73, v74
    v_dot2_f32_bf16 v75, v19, s73, v75
    v_dot2_f32_bf16 v76, v18, s74, v76
    v_dot2_f32_bf16 v77, v19, s74, v77
    v_dot2_f32_bf16 v78, v18, s75, v78
    v_dot2_f32_bf16 v79, v19, s75, v79
    v_dot2_f32_bf16 v80, v18, s56, v80
    v_dot2_f32_bf16 v81, v19, s56, v81
    v_dot2_f32_bf16 v82, v18, s57, v82
    v_dot2_f32_bf16 v83, v19, s57, v83
    v_dot2_f32_bf16 v84, v18, s58, v84
    v_dot2_f32_bf16 v85, v19, s58, v85
    v_dot2_f32_bf16 v86, v18, s59, v86
    v_dot2_f32_bf16 v87, v19, s59, v87
    v_dot2_f32_bf16 v72, v22, s76, v72
    v_dot2_f32_bf16 v73, v23, s76, v73
    v_dot2_f32_bf16 v74, v22, s77, v74
    v_dot2_f32_bf16 v75, v23, s77, v75
    v_dot2_f32_bf16 v76, v22, s78, v76
    v_dot2_f32_bf16 v77, v23, s78, v77
    v_dot2_f32_bf16 v78, v22, s79, v78
    v_dot2_f32_bf16 v79, v23, s79, v79
    v_dot2_f32_bf16 v80, v22, s60, v80
    v_dot2_f32_bf16 v81, v23, s60, v81
    v_dot2_f32_bf16 v82, v22, s61, v82
    v_dot2_f32_bf16 v83, v23, s61, v83
    v_dot2_f32_bf16 v84, v22, s62, v84
    v_dot2_f32_bf16 v85, v23, s62, v85
    v_dot2_f32_bf16 v86, v22, s63, v86
    v_dot2_f32_bf16 v87, v23, s63, v87
    v_dot2_f32_bf16 v72, v26, s80, v72
    v_dot2_f32_bf16 v73, v27, s80, v73
    v_dot2_f32_bf16 v74, v26, s81, v74
    v_dot2_f32_bf16 v75, v27, s81, v75
    v_dot2_f32_bf16 v76, v26, s82, v76
    v_dot2_f32_bf16 v77, v27, s82, v77
    v_dot2_f32_bf16 v78, v26, s83, v78
    v_dot2_f32_bf16 v79, v27, s83, v79
    v_dot2_f32_bf16 v80, v26, s64, v80
    v_dot2_f32_bf16 v81, v27, s64, v81
    v_dot2_f32_bf16 v82, v26, s65, v82
    v_dot2_f32_bf16 v83, v27, s65, v83
    v_dot2_f32_bf16 v84, v26, s66, v84
    v_dot2_f32_bf16 v85, v27, s66, v85
    v_dot2_f32_bf16 v86, v26, s67, v86
    v_dot2_f32_bf16 v87, v27, s67, v87
    s_cmp_ge_u32 s13, 4
    s_cbranch_scc1 L_p2_kernel_g1_6
    v_lshlrev_b32 v30, 16, v61
    v_and_b32 v31, 0xffff0000, v61
    v_pk_add_f32 v[14:15], v[30:31], v[36:37] op_sel:[0,0] op_sel_hi:[1,0] neg_lo:[0,1] neg_hi:[0,1]
    v_pk_add_f32 v[16:17], v[30:31], v[36:37] op_sel:[0,1] op_sel_hi:[1,1] neg_lo:[0,1] neg_hi:[0,1]
    v_pk_add_f32 v[18:19], v[30:31], v[38:39] op_sel:[0,0] op_sel_hi:[1,0] neg_lo:[0,1] neg_hi:[0,1]
    v_pk_add_f32 v[20:21], v[30:31], v[38:39] op_sel:[0,1] op_sel_hi:[1,1] neg_lo:[0,1] neg_hi:[0,1]
    v_pk_add_f32 v[22:23], v[30:31], v[40:41] op_sel:[0,0] op_sel_hi:[1,0] neg_lo:[0,1] neg_hi:[0,1]
    v_pk_add_f32 v[24:25], v[30:31], v[40:41] op_sel:[0,1] op_sel_hi:[1,1] neg_lo:[0,1] neg_hi:[0,1]
    v_pk_add_f32 v[26:27], v[30:31], v[42:43] op_sel:[0,0] op_sel_hi:[1,0] neg_lo:[0,1] neg_hi:[0,1]
    v_pk_add_f32 v[28:29], v[30:31], v[42:43] op_sel:[0,1] op_sel_hi:[1,1] neg_lo:[0,1] neg_hi:[0,1]
    v_cvt_pk_bf16_f32 v32, v14, v15
    v_lshlrev_b32 v14, 16, v32
    v_and_b32 v15, 0xffff0000, v32
    v_cvt_pk_bf16_f32 v32, v16, v17
    v_lshlrev_b32 v16, 16, v32
    v_and_b32 v17, 0xffff0000, v32
    v_cvt_pk_bf16_f32 v32, v18, v19
    v_lshlrev_b32 v18, 16, v32
    v_and_b32 v19, 0xffff0000, v32
    v_cvt_pk_bf16_f32 v32, v20, v21
    v_lshlrev_b32 v20, 16, v32
    v_and_b32 v21, 0xffff0000, v32
    v_cvt_pk_bf16_f32 v32, v22, v23
    v_lshlrev_b32 v22, 16, v32
    v_and_b32 v23, 0xffff0000, v32
    v_cvt_pk_bf16_f32 v32, v24, v25
    v_lshlrev_b32 v24, 16, v32
    v_and_b32 v25, 0xffff0000, v32
    v_cvt_pk_bf16_f32 v32, v26, v27
    v_lshlrev_b32 v26, 16, v32
    v_and_b32 v27, 0xffff0000, v32
    v_cvt_pk_bf16_f32 v32, v28, v29
    v_lshlrev_b32 v28, 16, v32
    v_and_b32 v29, 0xffff0000, v32
    v_pk_mul_f32 v[14:15], v[14:15], v[14:15]
    v_pk_mul_f32 v[16:17], v[16:17], v[16:17]
    v_pk_mul_f32 v[18:19], v[18:19], v[18:19]
    v_pk_mul_f32 v[20:21], v[20:21], v[20:21]
    v_pk_mul_f32 v[22:23], v[22:23], v[22:23]
    v_pk_mul_f32 v[24:25], v[24:25], v[24:25]
    v_pk_mul_f32 v[26:27], v[26:27], v[26:27]
    v_pk_mul_f32 v[28:29], v[28:29], v[28:29]
    v_cvt_pk_bf16_f32 v32, v14, v15
    v_lshlrev_b32 v14, 16, v32
    v_and_b32 v15, 0xffff0000, v32
    v_cvt_pk_bf16_f32 v32, v16, v17
    v_lshlrev_b32 v16, 16, v32
    v_and_b32 v17, 0xffff0000, v32
    v_cvt_pk_bf16_f32 v32, v18, v19
    v_lshlrev_b32 v18, 16, v32
    v_and_b32 v19, 0xffff0000, v32
    v_cvt_pk_bf16_f32 v32, v20, v21
    v_lshlrev_b32 v20, 16, v32
    v_and_b32 v21, 0xffff0000, v32
    v_cvt_pk_bf16_f32 v32, v22, v23
    v_lshlrev_b32 v22, 16, v32
    v_and_b32 v23, 0xffff0000, v32
    v_cvt_pk_bf16_f32 v32, v24, v25
    v_lshlrev_b32 v24, 16, v32
    v_and_b32 v25, 0xffff0000, v32
    v_cvt_pk_bf16_f32 v32, v26, v27
    v_lshlrev_b32 v26, 16, v32
    v_and_b32 v27, 0xffff0000, v32
    v_cvt_pk_bf16_f32 v32, v28, v29
    v_lshlrev_b32 v28, 16, v32
    v_and_b32 v29, 0xffff0000, v32
    v_mov_b32 v30, 1092616192
    v_mov_b32 v31, 0x3fb8aa3b
    v_pk_mul_f32 v[14:15], v[14:15], v[30:31] op_sel:[0,0] op_sel_hi:[1,0]
    v_pk_mul_f32 v[16:17], v[16:17], v[30:31] op_sel:[0,0] op_sel_hi:[1,0]
    v_pk_mul_f32 v[18:19], v[18:19], v[30:31] op_sel:[0,0] op_sel_hi:[1,0]
    v_pk_mul_f32 v[20:21], v[20:21], v[30:31] op_sel:[0,0] op_sel_hi:[1,0]
    v_pk_mul_f32 v[22:23], v[22:23], v[30:31] op_sel:[0,0] op_sel_hi:[1,0]
    v_pk_mul_f32 v[24:25], v[24:25], v[30:31] op_sel:[0,0] op_sel_hi:[1,0]
    v_pk_mul_f32 v[26:27], v[26:27], v[30:31] op_sel:[0,0] op_sel_hi:[1,0]
    v_pk_mul_f32 v[28:29], v[28:29], v[30:31] op_sel:[0,0] op_sel_hi:[1,0]
    v_cvt_pk_bf16_f32 v32, v14, v15
    v_lshlrev_b32 v14, 16, v32
    v_and_b32 v15, 0xffff0000, v32
    v_cvt_pk_bf16_f32 v32, v16, v17
    v_lshlrev_b32 v16, 16, v32
    v_and_b32 v17, 0xffff0000, v32
    v_cvt_pk_bf16_f32 v32, v18, v19
    v_lshlrev_b32 v18, 16, v32
    v_and_b32 v19, 0xffff0000, v32
    v_cvt_pk_bf16_f32 v32, v20, v21
    v_lshlrev_b32 v20, 16, v32
    v_and_b32 v21, 0xffff0000, v32
    v_cvt_pk_bf16_f32 v32, v22, v23
    v_lshlrev_b32 v22, 16, v32
    v_and_b32 v23, 0xffff0000, v32
    v_cvt_pk_bf16_f32 v32, v24, v25
    v_lshlrev_b32 v24, 16, v32
    v_and_b32 v25, 0xffff0000, v32
    v_cvt_pk_bf16_f32 v32, v26, v27
    v_lshlrev_b32 v26, 16, v32
    v_and_b32 v27, 0xffff0000, v32
    v_cvt_pk_bf16_f32 v32, v28, v29
    v_lshlrev_b32 v28, 16, v32
    v_and_b32 v29, 0xffff0000, v32
    v_pk_mul_f32 v[14:15], v[14:15], v[30:31] op_sel:[0,1] op_sel_hi:[1,1]
    v_pk_mul_f32 v[16:17], v[16:17], v[30:31] op_sel:[0,1] op_sel_hi:[1,1]
    v_pk_mul_f32 v[18:19], v[18:19], v[30:31] op_sel:[0,1] op_sel_hi:[1,1]
    v_pk_mul_f32 v[20:21], v[20:21], v[30:31] op_sel:[0,1] op_sel_hi:[1,1]
    v_pk_mul_f32 v[22:23], v[22:23], v[30:31] op_sel:[0,1] op_sel_hi:[1,1]
    v_pk_mul_f32 v[24:25], v[24:25], v[30:31] op_sel:[0,1] op_sel_hi:[1,1]
    v_pk_mul_f32 v[26:27], v[26:27], v[30:31] op_sel:[0,1] op_sel_hi:[1,1]
    v_pk_mul_f32 v[28:29], v[28:29], v[30:31] op_sel:[0,1] op_sel_hi:[1,1]
    v_exp_f32 v14, -v14
    v_exp_f32 v15, -v15
    v_exp_f32 v16, -v16
    v_exp_f32 v17, -v17
    v_exp_f32 v18, -v18
    v_exp_f32 v19, -v19
    v_exp_f32 v20, -v20
    v_exp_f32 v21, -v21
    v_exp_f32 v22, -v22
    v_exp_f32 v23, -v23
    v_exp_f32 v24, -v24
    v_exp_f32 v25, -v25
    v_exp_f32 v26, -v26
    v_exp_f32 v27, -v27
    v_exp_f32 v28, -v28
    v_exp_f32 v29, -v29
    v_cvt_pk_bf16_f32 v14, v14, v16
    v_cvt_pk_bf16_f32 v15, v15, v17
    v_cvt_pk_bf16_f32 v18, v18, v20
    v_cvt_pk_bf16_f32 v19, v19, v21
    v_cvt_pk_bf16_f32 v22, v22, v24
    v_cvt_pk_bf16_f32 v23, v23, v25
    v_cvt_pk_bf16_f32 v26, v26, v28
    v_cvt_pk_bf16_f32 v27, v27, v29
    v_dot2_f32_bf16 v112, v14, s68, 0
    v_dot2_f32_bf16 v113, v15, s68, 0
    v_dot2_f32_bf16 v114, v14, s69, 0
    v_dot2_f32_bf16 v115, v15, s69, 0
    v_dot2_f32_bf16 v116, v14, s70, 0
    v_dot2_f32_bf16 v117, v15, s70, 0
    v_dot2_f32_bf16 v118, v14, s71, 0
    v_dot2_f32_bf16 v119, v15, s71, 0
    v_dot2_f32_bf16 v120, v14, s52, 0
    v_dot2_f32_bf16 v121, v15, s52, 0
    v_dot2_f32_bf16 v122, v14, s53, 0
    v_dot2_f32_bf16 v123, v15, s53, 0
    v_dot2_f32_bf16 v124, v14, s54, 0
    v_dot2_f32_bf16 v125, v15, s54, 0
    v_dot2_f32_bf16 v126, v14, s55, 0
    v_dot2_f32_bf16 v127, v15, s55, 0
    v_dot2_f32_bf16 v112, v18, s72, v112
    v_dot2_f32_bf16 v113, v19, s72, v113
    v_dot2_f32_bf16 v114, v18, s73, v114
    v_dot2_f32_bf16 v115, v19, s73, v115
    v_dot2_f32_bf16 v116, v18, s74, v116
    v_dot2_f32_bf16 v117, v19, s74, v117
    v_dot2_f32_bf16 v118, v18, s75, v118
    v_dot2_f32_bf16 v119, v19, s75, v119
    v_dot2_f32_bf16 v120, v18, s56, v120
    v_dot2_f32_bf16 v121, v19, s56, v121
    v_dot2_f32_bf16 v122, v18, s57, v122
    v_dot2_f32_bf16 v123, v19, s57, v123
    v_dot2_f32_bf16 v124, v18, s58, v124
    v_dot2_f32_bf16 v125, v19, s58, v125
    v_dot2_f32_bf16 v126, v18, s59, v126
    v_dot2_f32_bf16 v127, v19, s59, v127
    v_dot2_f32_bf16 v112, v22, s76, v112
    v_dot2_f32_bf16 v113, v23, s76, v113
    v_dot2_f32_bf16 v114, v22, s77, v114
    v_dot2_f32_bf16 v115, v23, s77, v115
    v_dot2_f32_bf16 v116, v22, s78, v116
    v_dot2_f32_bf16 v117, v23, s78, v117
    v_dot2_f32_bf16 v118, v22, s79, v118
    v_dot2_f32_bf16 v119, v23, s79, v119
    v_dot2_f32_bf16 v120, v22, s60, v120
    v_dot2_f32_bf16 v121, v23, s60, v121
    v_dot2_f32_bf16 v122, v22, s61, v122
    v_dot2_f32_bf16 v123, v23, s61, v123
    v_dot2_f32_bf16 v124, v22, s62, v124
    v_dot2_f32_bf16 v125, v23, s62, v125
    v_dot2_f32_bf16 v126, v22, s63, v126
    v_dot2_f32_bf16 v127, v23, s63, v127
    v_dot2_f32_bf16 v112, v26, s80, v112
    v_dot2_f32_bf16 v113, v27, s80, v113
    v_dot2_f32_bf16 v114, v26, s81, v114
    v_dot2_f32_bf16 v115, v27, s81, v115
    v_dot2_f32_bf16 v116, v26, s82, v116
    v_dot2_f32_bf16 v117, v27, s82, v117
    v_dot2_f32_bf16 v118, v26, s83, v118
    v_dot2_f32_bf16 v119, v27, s83, v119
    v_dot2_f32_bf16 v120, v26, s64, v120
    v_dot2_f32_bf16 v121, v27, s64, v121
    v_dot2_f32_bf16 v122, v26, s65, v122
    v_dot2_f32_bf16 v123, v27, s65, v123
    v_dot2_f32_bf16 v124, v26, s66, v124
    v_dot2_f32_bf16 v125, v27, s66, v125
    v_dot2_f32_bf16 v126, v26, s67, v126
    v_dot2_f32_bf16 v127, v27, s67, v127
L_p2_kernel_g1_6:
L_p2_gb:
    v_and_b32 v4, 0x80008000, v4
    v_cmp_ne_u32 vcc, 0, v4
    v_mov_b32 v8, s27
    v_and_b32 v10, 15, v0
    v_mul_u32_u24 v10, 240, v10
    v_add_u32 v10, 160000, v10
    s_cmp_lg_u64 vcc, 0
    s_cselect_b32 s2, 1, s2
    v_mov_b32 v9, s2
    s_mov_b64 exec, 1
    ds_write_b32 v8, v9
    s_mov_b64 exec, -1
    v_add_u32 v2, 16384, v1
    v_mov_b32 v9, 0x3f000000
    v_cmp_gt_u32 vcc, 226, v0
    s_mov_b32 s49, s12
    s_mov_b32 s51, 0
    v_cndmask_b32 v2, v9, v2, vcc
    s_waitcnt vmcnt(0) lgkmcnt(0)
    s_barrier
    ds_read_b32 v9, v10
    s_mov_b32 s18, 5120000
    s_mov_b32 s19, 0x00020000
    s_waitcnt lgkmcnt(0)
    v_cmp_ne_u32 vcc, 0, v9
    s_nop 1
    s_cmp_lg_u64 vcc, 0
    s_cselect_b32 s2, 1, 0
    s_cbranch_scc1 L_p2_slow
L_p2_signal:
    v_mov_b32 v8, 160228
    s_lshl_b32 s15, s2, 4
    s_or_b32 s15, s15, s21
    s_add_u32 s14, s12, 16
    s_lshl_b32 s20, s15, s14
    s_add_u32 s20, s20, 1
    v_mov_b32 v9, s20
    s_cmp_lg_u32 s13, 15
    s_cbranch_scc1 L_p2_nosig0
    s_lshl_b32 s14, s3, 8
    s_add_u32 s14, s14, 8557056
    s_mov_b64 exec, 1
    buffer_atomic_add v9, off, s[4:7], s14 sc0
    s_mov_b64 exec, -1
L_p2_nosig0:
    s_lshl2_add_u32 s14, s3, s49
    s_mul_i32 s26, s14, 20000
    s_add_u32 s15, s26, 8573440
    buffer_load_dwordx4 v[64:67], v1, s[4:7], s15 offen
    buffer_load_dwordx4 v[68:71], v2, s[4:7], s15 offen
    s_lshl_b32 s28, s92, 16
    s_and_b32 s29, s92, 0xffff0000
    s_lshl_b32 s30, s93, 16
    s_and_b32 s31, s93, 0xffff0000
    s_lshl_b32 s32, s94, 16
    s_and_b32 s33, s94, 0xffff0000
    s_lshl_b32 s34, s95, 16
    s_and_b32 s35, s95, 0xffff0000
    s_lshl_b32 s36, s96, 16
    s_and_b32 s37, s96, 0xffff0000
    s_lshl_b32 s38, s97, 16
    s_and_b32 s39, s97, 0xffff0000
    s_lshl_b32 s40, s98, 16
    s_and_b32 s41, s98, 0xffff0000
    s_lshl_b32 s42, s99, 16
    s_and_b32 s43, s99, 0xffff0000
    s_and_b32 s99, s91, 0xffff0000
    s_lshl_b32 s98, s91, 16
    s_and_b32 s97, s90, 0xffff0000
    s_lshl_b32 s96, s90, 16
    s_and_b32 s95, s89, 0xffff0000
    s_lshl_b32 s94, s89, 16
    s_and_b32 s93, s88, 0xffff0000
    s_lshl_b32 s92, s88, 16
    s_and_b32 s91, s87, 0xffff0000
    s_lshl_b32 s90, s87, 16
    s_and_b32 s89, s86, 0xffff0000
    s_lshl_b32 s88, s86, 16
    s_and_b32 s87, s85, 0xffff0000
    s_lshl_b32 s86, s85, 16
    s_and_b32 s85, s84, 0xffff0000
    s_lshl_b32 s84, s84, 16
    s_mov_b32 s44, s48
    s_add_u32 s45, s48, 2281701376
    s_cmp_eq_u32 s48, 0
    s_cselect_b32 s45, 0, s45
    s_cmp_lg_u32 s13, 15
    s_cbranch_scc1 L_p2_nosig
    s_waitcnt vmcnt(2)
    v_readfirstlane_b32 s15, v9
    s_lshl_b32 s51, 1, s12
    s_add_u32 s20, s20, s15
    s_and_b32 s15, s20, 0xff
    s_cmp_eq_u32 s15, 4
    s_cbranch_scc0 L_p2_notlast
    s_bfe_u32 s15, s20, 262160
    s_or_b32 s51, s51, s15
    s_branch L_p2_pub
L_p2_notlast:
    s_cmp_lg_u32 s21, 0
    s_cselect_b32 s51, 0, s51
    s_cbranch_scc1 L_p2_pub
L_p2_poll:
    v_mov_b32 v9, 0
    s_lshl_b32 s14, s3, 8
    s_add_u32 s14, s14, 8557056
    s_mov_b64 exec, 1
    buffer_atomic_add v9, off, s[4:7], s14 sc0
    s_mov_b64 exec, -1
    s_waitcnt vmcnt(0)
    v_readfirstlane_b32 s20, v9
    s_nop 0
    s_and_b32 s15, s20, 0xff
    s_cmp_lt_u32 s15, 4
    s_cbranch_scc1 L_p2_poll
L_p2_pub:
    s_lshl_b32 s15, s51, 24
    s_or_b32 s15, s15, s20
    v_mov_b32 v9, s15
    s_mov_b64 exec, 1
    ds_write_b32 v8, v9
    s_mov_b64 exec, -1
    s_waitcnt lgkmcnt(0)
L_p2_nosig:
    s_barrier
    ds_read_b32 v9, v8
    s_waitcnt lgkmcnt(0)
    v_readfirstlane_b32 s20, v9
    s_nop 0
    s_lshr_b32 s51, s20, 24
    s_cbranch_scc0 L_p2_end
L_p2_fin:
    s_mul_i32 s24, s49, 20000
    s_add_u32 s14, s12, 1
    s_and_b32 s14, s14, 3
    s_mul_i32 s15, s14, 5120000
    s_add_u32 s15, s15, 233832448
    s_add_u32 s15, s15, s26
    buffer_load_dwordx4 v[12:15], v1, s[4:7], s15 offen sc1
    buffer_load_dwordx4 v[92:95], v2, s[4:7], s15 offen sc1
    s_add_u32 s14, s12, 2
    s_and_b32 s14, s14, 3
    s_mul_i32 s15, s14, 5120000
    s_add_u32 s15, s15, 233832448
    s_add_u32 s15, s15, s26
    buffer_load_dwordx4 v[16:19], v1, s[4:7], s15 offen sc1
    buffer_load_dwordx4 v[96:99], v2, s[4:7], s15 offen sc1
    s_add_u32 s14, s12, 3
    s_and_b32 s14, s14, 3
    s_mul_i32 s15, s14, 5120000
    s_add_u32 s15, s15, 233832448
    s_add_u32 s15, s15, s26
    buffer_load_dwordx4 v[20:23], v1, s[4:7], s15 offen sc1
    buffer_load_dwordx4 v[100:103], v2, s[4:7], s15 offen sc1
    v_add_u32 v24, s24, v1
    ds_read_b128 v[8:11], v24
    v_add_u32 v25, s24, v2
    ds_read_b128 v[88:91], v25
    s_waitcnt vmcnt(0) lgkmcnt(0)
    s_bfe_u32 s14, s20, 262164
    s_cbranch_scc0 L_p2_kernel_nof32a_7
    s_add_u32 s14, s12, 0
    s_and_b32 s14, s14, 3
    s_add_u32 s14, s14, 20
    s_bitcmp1_b32 s20, s14
    s_cbranch_scc0 L_p2_kernel_q_8
    v_mov_b32 v8, 1073758208
    v_mov_b32 v9, 1073758208
    v_mov_b32 v10, 1073758208
    v_mov_b32 v11, 1073758208
L_p2_kernel_q_8:
    s_add_u32 s14, s12, 1
    s_and_b32 s14, s14, 3
    s_add_u32 s14, s14, 20
    s_bitcmp1_b32 s20, s14
    s_cbranch_scc0 L_p2_kernel_q_9
    v_mov_b32 v12, 1073758208
    v_mov_b32 v13, 1073758208
    v_mov_b32 v14, 1073758208
    v_mov_b32 v15, 1073758208
L_p2_kernel_q_9:
    s_add_u32 s14, s12, 2
    s_and_b32 s14, s14, 3
    s_add_u32 s14, s14, 20
    s_bitcmp1_b32 s20, s14
    s_cbranch_scc0 L_p2_kernel_q_10
    v_mov_b32 v16, 1073758208
    v_mov_b32 v17, 1073758208
    v_mov_b32 v18, 1073758208
    v_mov_b32 v19, 1073758208
L_p2_kernel_q_10:
    s_add_u32 s14, s12, 3
    s_and_b32 s14, s14, 3
    s_add_u32 s14, s14, 20
    s_bitcmp1_b32 s20, s14
    s_cbranch_scc0 L_p2_kernel_q_11
    v_mov_b32 v20, 1073758208
    v_mov_b32 v21, 1073758208
    v_mov_b32 v22, 1073758208
    v_mov_b32 v23, 1073758208
L_p2_kernel_q_11:
L_p2_kernel_nof32a_7:
    v_pk_add_u16 v8, v8, v12
    v_pk_add_u16 v16, v16, v20
    v_pk_add_u16 v9, v9, v13
    v_pk_add_u16 v17, v17, v21
    v_pk_add_u16 v10, v10, v14
    v_pk_add_u16 v18, v18, v22
    v_pk_add_u16 v11, v11, v15
    v_pk_add_u16 v19, v19, v23
    v_add_u32_sdwa v24, v8, v16 dst_sel:DWORD dst_unused:UNUSED_PAD src0_sel:WORD_0 src1_sel:WORD_0
    v_add_u32_sdwa v25, v10, v18 dst_sel:DWORD dst_unused:UNUSED_PAD src0_sel:WORD_0 src1_sel:WORD_0
    v_add_u32_sdwa v26, v8, v16 dst_sel:DWORD dst_unused:UNUSED_PAD src0_sel:WORD_1 src1_sel:WORD_1
    v_add_u32_sdwa v27, v10, v18 dst_sel:DWORD dst_unused:UNUSED_PAD src0_sel:WORD_1 src1_sel:WORD_1
    v_add_u32_sdwa v28, v9, v17 dst_sel:DWORD dst_unused:UNUSED_PAD src0_sel:WORD_0 src1_sel:WORD_0
    v_add_u32_sdwa v29, v11, v19 dst_sel:DWORD dst_unused:UNUSED_PAD src0_sel:WORD_0 src1_sel:WORD_0
    v_add_u32_sdwa v30, v9, v17 dst_sel:DWORD dst_unused:UNUSED_PAD src0_sel:WORD_1 src1_sel:WORD_1
    v_add_u32_sdwa v31, v11, v19 dst_sel:DWORD dst_unused:UNUSED_PAD src0_sel:WORD_1 src1_sel:WORD_1
    v_cvt_f32_u32 v24, v24
    v_cvt_f32_u32 v25, v25
    v_cvt_f32_u32 v26, v26
    v_cvt_f32_u32 v27, v27
    v_cvt_f32_u32 v28, v28
    v_cvt_f32_u32 v29, v29
    v_cvt_f32_u32 v30, v30
    v_cvt_f32_u32 v31, v31
    v_pk_fma_f32 v[24:25], v[24:25], s[44:45], s[44:45] op_sel:[0,0,1] op_sel_hi:[1,0,1]
    v_pk_fma_f32 v[26:27], v[26:27], s[44:45], s[44:45] op_sel:[0,0,1] op_sel_hi:[1,0,1]
    v_pk_fma_f32 v[28:29], v[28:29], s[44:45], s[44:45] op_sel:[0,0,1] op_sel_hi:[1,0,1]
    v_pk_fma_f32 v[30:31], v[30:31], s[44:45], s[44:45] op_sel:[0,0,1] op_sel_hi:[1,0,1]
    s_bfe_u32 s14, s20, 262164
    s_cbranch_scc0 L_p2_kernel_nof32b_12
    v_lshlrev_b32 v32, 1, v1
    s_bitcmp1_b32 s20, 20
    s_cbranch_scc0 L_p2_kernel_q_13
    s_lshl_b32 s15, s26, 1
    s_add_u32 s15, s15, 254312448
    buffer_load_dwordx4 v[8:11], v32, s[4:7], s15 offen sc1
    buffer_load_dwordx4 v[12:15], v32, s[4:7], s15 offen offset:16 sc1
    s_waitcnt vmcnt(0)
    v_add_f32 v24, v24, v8
    v_add_f32 v25, v25, v12
    v_add_f32 v26, v26, v9
    v_add_f32 v27, v27, v13
    v_add_f32 v28, v28, v10
    v_add_f32 v29, v29, v14
    v_add_f32 v30, v30, v11
    v_add_f32 v31, v31, v15
L_p2_kernel_q_13:
    s_bitcmp1_b32 s20, 21
    s_cbranch_scc0 L_p2_kernel_q_14
    s_lshl_b32 s15, s26, 1
    s_add_u32 s15, s15, 264552448
    buffer_load_dwordx4 v[8:11], v32, s[4:7], s15 offen sc1
    buffer_load_dwordx4 v[12:15], v32, s[4:7], s15 offen offset:16 sc1
    s_waitcnt vmcnt(0)
    v_add_f32 v24, v24, v8
    v_add_f32 v25, v25, v12
    v_add_f32 v26, v26, v9
    v_add_f32 v27, v27, v13
    v_add_f32 v28, v28, v10
    v_add_f32 v29, v29, v14
    v_add_f32 v30, v30, v11
    v_add_f32 v31, v31, v15
L_p2_kernel_q_14:
    s_bitcmp1_b32 s20, 22
    s_cbranch_scc0 L_p2_kernel_q_15
    s_lshl_b32 s15, s26, 1
    s_add_u32 s15, s15, 274792448
    buffer_load_dwordx4 v[8:11], v32, s[4:7], s15 offen sc1
    buffer_load_dwordx4 v[12:15], v32, s[4:7], s15 offen offset:16 sc1
    s_waitcnt vmcnt(0)
    v_add_f32 v24, v24, v8
    v_add_f32 v25, v25, v12
    v_add_f32 v26, v26, v9
    v_add_f32 v27, v27, v13
    v_add_f32 v28, v28, v10
    v_add_f32 v29, v29, v14
    v_add_f32 v30, v30, v11
    v_add_f32 v31, v31, v15
L_p2_kernel_q_15:
    s_bitcmp1_b32 s20, 23
    s_cbranch_scc0 L_p2_kernel_q_16
    s_lshl_b32 s15, s26, 1
    s_add_u32 s15, s15, 285032448
    buffer_load_dwordx4 v[8:11], v32, s[4:7], s15 offen sc1
    buffer_load_dwordx4 v[12:15], v32, s[4:7], s15 offen offset:16 sc1
    s_waitcnt vmcnt(0)
    v_add_f32 v24, v24, v8
    v_add_f32 v25, v25, v12
    v_add_f32 v26, v26, v9
    v_add_f32 v27, v27, v13
    v_add_f32 v28, v28, v10
    v_add_f32 v29, v29, v14
    v_add_f32 v30, v30, v11
    v_add_f32 v31, v31, v15
L_p2_kernel_q_16:
L_p2_kernel_nof32b_12:
    v_pk_mul_f32 v[8:9], v[24:25], s[84:85] op_sel:[0,0] op_sel_hi:[1,0]
    v_pk_mul_f32 v[10:11], v[24:25], s[84:85] op_sel:[0,1] op_sel_hi:[1,1]
    v_pk_mul_f32 v[12:13], v[24:25], s[86:87] op_sel:[0,0] op_sel_hi:[1,0]
    v_pk_mul_f32 v[14:15], v[24:25], s[86:87] op_sel:[0,1] op_sel_hi:[1,1]
    v_pk_fma_f32 v[8:9], v[26:27], s[88:89], v[8:9] op_sel:[0,0,0] op_sel_hi:[1,0,1]
    v_pk_fma_f32 v[10:11], v[26:27], s[88:89], v[10:11] op_sel:[0,1,0] op_sel_hi:[1,1,1]
    v_pk_fma_f32 v[12:13], v[26:27], s[90:91], v[12:13] op_sel:[0,0,0] op_sel_hi:[1,0,1]
    v_pk_fma_f32 v[14:15], v[26:27], s[90:91], v[14:15] op_sel:[0,1,0] op_sel_hi:[1,1,1]
    v_pk_fma_f32 v[8:9], v[28:29], s[92:93], v[8:9] op_sel:[0,0,0] op_sel_hi:[1,0,1]
    v_pk_fma_f32 v[10:11], v[28:29], s[92:93], v[10:11] op_sel:[0,1,0] op_sel_hi:[1,1,1]
    v_pk_fma_f32 v[12:13], v[28:29], s[94:95], v[12:13] op_sel:[0,0,0] op_sel_hi:[1,0,1]
    v_pk_fma_f32 v[14:15], v[28:29], s[94:95], v[14:15] op_sel:[0,1,0] op_sel_hi:[1,1,1]
    v_pk_fma_f32 v[8:9], v[30:31], s[96:97], v[8:9] op_sel:[0,0,0] op_sel_hi:[1,0,1]
    v_pk_fma_f32 v[10:11], v[30:31], s[96:97], v[10:11] op_sel:[0,1,0] op_sel_hi:[1,1,1]
    v_pk_fma_f32 v[12:13], v[30:31], s[98:99], v[12:13] op_sel:[0,0,0] op_sel_hi:[1,0,1]
    v_pk_fma_f32 v[14:15], v[30:31], s[98:99], v[14:15] op_sel:[0,1,0] op_sel_hi:[1,1,1]
    v_pk_mul_f32 v[8:9], v[8:9], v[72:73]
    v_pk_mul_f32 v[10:11], v[10:11], v[74:75]
    v_pk_mul_f32 v[12:13], v[12:13], v[76:77]
    v_pk_mul_f32 v[14:15], v[14:15], v[78:79]
    v_pk_mul_f32 v[24:25], v[8:9], s[28:29] op_sel:[0,0] op_sel_hi:[1,0]
    v_pk_mul_f32 v[26:27], v[8:9], s[28:29] op_sel:[0,1] op_sel_hi:[1,1]
    v_pk_mul_f32 v[28:29], v[8:9], s[30:31] op_sel:[0,0] op_sel_hi:[1,0]
    v_pk_mul_f32 v[30:31], v[8:9], s[30:31] op_sel:[0,1] op_sel_hi:[1,1]
    v_pk_fma_f32 v[24:25], v[10:11], s[32:33], v[24:25] op_sel:[0,0,0] op_sel_hi:[1,0,1]
    v_pk_fma_f32 v[26:27], v[10:11], s[32:33], v[26:27] op_sel:[0,1,0] op_sel_hi:[1,1,1]
    v_pk_fma_f32 v[28:29], v[10:11], s[34:35], v[28:29] op_sel:[0,0,0] op_sel_hi:[1,0,1]
    v_pk_fma_f32 v[30:31], v[10:11], s[34:35], v[30:31] op_sel:[0,1,0] op_sel_hi:[1,1,1]
    v_pk_fma_f32 v[24:25], v[12:13], s[36:37], v[24:25] op_sel:[0,0,0] op_sel_hi:[1,0,1]
    v_pk_fma_f32 v[26:27], v[12:13], s[36:37], v[26:27] op_sel:[0,1,0] op_sel_hi:[1,1,1]
    v_pk_fma_f32 v[28:29], v[12:13], s[38:39], v[28:29] op_sel:[0,0,0] op_sel_hi:[1,0,1]
    v_pk_fma_f32 v[30:31], v[12:13], s[38:39], v[30:31] op_sel:[0,1,0] op_sel_hi:[1,1,1]
    v_pk_fma_f32 v[24:25], v[14:15], s[40:41], v[24:25] op_sel:[0,0,0] op_sel_hi:[1,0,1]
    v_pk_fma_f32 v[26:27], v[14:15], s[40:41], v[26:27] op_sel:[0,1,0] op_sel_hi:[1,1,1]
    v_pk_fma_f32 v[28:29], v[14:15], s[42:43], v[28:29] op_sel:[0,0,0] op_sel_hi:[1,0,1]
    v_pk_fma_f32 v[30:31], v[14:15], s[42:43], v[30:31] op_sel:[0,1,0] op_sel_hi:[1,1,1]
    v_lshlrev_b32 v8, 16, v64
    v_and_b32 v10, 0xffff0000, v64
    v_lshlrev_b32 v12, 16, v65
    v_and_b32 v14, 0xffff0000, v65
    v_lshlrev_b32 v9, 16, v66
    v_and_b32 v11, 0xffff0000, v66
    v_lshlrev_b32 v13, 16, v67
    v_and_b32 v15, 0xffff0000, v67
    v_pk_fma_f32 v[8:9], v[24:25], v[80:81], v[8:9]
    v_pk_fma_f32 v[10:11], v[26:27], v[82:83], v[10:11]
    v_pk_fma_f32 v[12:13], v[28:29], v[84:85], v[12:13]
    v_pk_fma_f32 v[14:15], v[30:31], v[86:87], v[14:15]
    v_cvt_pk_bf16_f32 v16, v8, v10
    v_cvt_pk_bf16_f32 v17, v12, v14
    v_cvt_pk_bf16_f32 v18, v9, v11
    v_cvt_pk_bf16_f32 v19, v13, v15
    buffer_store_dwordx4 v[16:19], v1, s[16:19], s26 offen
    s_cmp_ge_u32 s13, 4
    s_cbranch_scc1 L_p2_f1
    s_bfe_u32 s14, s20, 262164
    s_cbranch_scc0 L_p2_kernel_nof32a_17
    s_add_u32 s14, s12, 0
    s_and_b32 s14, s14, 3
    s_add_u32 s14, s14, 20
    s_bitcmp1_b32 s20, s14
    s_cbranch_scc0 L_p2_kernel_q_18
    v_mov_b32 v88, 1073758208
    v_mov_b32 v89, 1073758208
    v_mov_b32 v90, 1073758208
    v_mov_b32 v91, 1073758208
L_p2_kernel_q_18:
    s_add_u32 s14, s12, 1
    s_and_b32 s14, s14, 3
    s_add_u32 s14, s14, 20
    s_bitcmp1_b32 s20, s14
    s_cbranch_scc0 L_p2_kernel_q_19
    v_mov_b32 v92, 1073758208
    v_mov_b32 v93, 1073758208
    v_mov_b32 v94, 1073758208
    v_mov_b32 v95, 1073758208
L_p2_kernel_q_19:
    s_add_u32 s14, s12, 2
    s_and_b32 s14, s14, 3
    s_add_u32 s14, s14, 20
    s_bitcmp1_b32 s20, s14
    s_cbranch_scc0 L_p2_kernel_q_20
    v_mov_b32 v96, 1073758208
    v_mov_b32 v97, 1073758208
    v_mov_b32 v98, 1073758208
    v_mov_b32 v99, 1073758208
L_p2_kernel_q_20:
    s_add_u32 s14, s12, 3
    s_and_b32 s14, s14, 3
    s_add_u32 s14, s14, 20
    s_bitcmp1_b32 s20, s14
    s_cbranch_scc0 L_p2_kernel_q_21
    v_mov_b32 v100, 1073758208
    v_mov_b32 v101, 1073758208
    v_mov_b32 v102, 1073758208
    v_mov_b32 v103, 1073758208
L_p2_kernel_q_21:
L_p2_kernel_nof32a_17:
    v_pk_add_u16 v88, v88, v92
    v_pk_add_u16 v96, v96, v100
    v_pk_add_u16 v89, v89, v93
    v_pk_add_u16 v97, v97, v101
    v_pk_add_u16 v90, v90, v94
    v_pk_add_u16 v98, v98, v102
    v_pk_add_u16 v91, v91, v95
    v_pk_add_u16 v99, v99, v103
    v_add_u32_sdwa v24, v88, v96 dst_sel:DWORD dst_unused:UNUSED_PAD src0_sel:WORD_0 src1_sel:WORD_0
    v_add_u32_sdwa v25, v90, v98 dst_sel:DWORD dst_unused:UNUSED_PAD src0_sel:WORD_0 src1_sel:WORD_0
    v_add_u32_sdwa v26, v88, v96 dst_sel:DWORD dst_unused:UNUSED_PAD src0_sel:WORD_1 src1_sel:WORD_1
    v_add_u32_sdwa v27, v90, v98 dst_sel:DWORD dst_unused:UNUSED_PAD src0_sel:WORD_1 src1_sel:WORD_1
    v_add_u32_sdwa v28, v89, v97 dst_sel:DWORD dst_unused:UNUSED_PAD src0_sel:WORD_0 src1_sel:WORD_0
    v_add_u32_sdwa v29, v91, v99 dst_sel:DWORD dst_unused:UNUSED_PAD src0_sel:WORD_0 src1_sel:WORD_0
    v_add_u32_sdwa v30, v89, v97 dst_sel:DWORD dst_unused:UNUSED_PAD src0_sel:WORD_1 src1_sel:WORD_1
    v_add_u32_sdwa v31, v91, v99 dst_sel:DWORD dst_unused:UNUSED_PAD src0_sel:WORD_1 src1_sel:WORD_1
    v_cvt_f32_u32 v24, v24
    v_cvt_f32_u32 v25, v25
    v_cvt_f32_u32 v26, v26
    v_cvt_f32_u32 v27, v27
    v_cvt_f32_u32 v28, v28
    v_cvt_f32_u32 v29, v29
    v_cvt_f32_u32 v30, v30
    v_cvt_f32_u32 v31, v31
    v_pk_fma_f32 v[24:25], v[24:25], s[44:45], s[44:45] op_sel:[0,0,1] op_sel_hi:[1,0,1]
    v_pk_fma_f32 v[26:27], v[26:27], s[44:45], s[44:45] op_sel:[0,0,1] op_sel_hi:[1,0,1]
    v_pk_fma_f32 v[28:29], v[28:29], s[44:45], s[44:45] op_sel:[0,0,1] op_sel_hi:[1,0,1]
    v_pk_fma_f32 v[30:31], v[30:31], s[44:45], s[44:45] op_sel:[0,0,1] op_sel_hi:[1,0,1]
    s_bfe_u32 s14, s20, 262164
    s_cbranch_scc0 L_p2_kernel_nof32b_22
    v_lshlrev_b32 v32, 1, v2
    s_bitcmp1_b32 s20, 20
    s_cbranch_scc0 L_p2_kernel_q_23
    s_lshl_b32 s15, s26, 1
    s_add_u32 s15, s15, 254312448
    buffer_load_dwordx4 v[88:91], v32, s[4:7], s15 offen sc1
    buffer_load_dwordx4 v[92:95], v32, s[4:7], s15 offen offset:16 sc1
    s_waitcnt vmcnt(0)
    v_add_f32 v24, v24, v88
    v_add_f32 v25, v25, v92
    v_add_f32 v26, v26, v89
    v_add_f32 v27, v27, v93
    v_add_f32 v28, v28, v90
    v_add_f32 v29, v29, v94
    v_add_f32 v30, v30, v91
    v_add_f32 v31, v31, v95
L_p2_kernel_q_23:
    s_bitcmp1_b32 s20, 21
    s_cbranch_scc0 L_p2_kernel_q_24
    s_lshl_b32 s15, s26, 1
    s_add_u32 s15, s15, 264552448
    buffer_load_dwordx4 v[88:91], v32, s[4:7], s15 offen sc1
    buffer_load_dwordx4 v[92:95], v32, s[4:7], s15 offen offset:16 sc1
    s_waitcnt vmcnt(0)
    v_add_f32 v24, v24, v88
    v_add_f32 v25, v25, v92
    v_add_f32 v26, v26, v89
    v_add_f32 v27, v27, v93
    v_add_f32 v28, v28, v90
    v_add_f32 v29, v29, v94
    v_add_f32 v30, v30, v91
    v_add_f32 v31, v31, v95
L_p2_kernel_q_24:
    s_bitcmp1_b32 s20, 22
    s_cbranch_scc0 L_p2_kernel_q_25
    s_lshl_b32 s15, s26, 1
    s_add_u32 s15, s15, 274792448
    buffer_load_dwordx4 v[88:91], v32, s[4:7], s15 offen sc1
    buffer_load_dwordx4 v[92:95], v32, s[4:7], s15 offen offset:16 sc1
    s_waitcnt vmcnt(0)
    v_add_f32 v24, v24, v88
    v_add_f32 v25, v25, v92
    v_add_f32 v26, v26, v89
    v_add_f32 v27, v27, v93
    v_add_f32 v28, v28, v90
    v_add_f32 v29, v29, v94
    v_add_f32 v30, v30, v91
    v_add_f32 v31, v31, v95
L_p2_kernel_q_25:
    s_bitcmp1_b32 s20, 23
    s_cbranch_scc0 L_p2_kernel_q_26
    s_lshl_b32 s15, s26, 1
    s_add_u32 s15, s15, 285032448
    buffer_load_dwordx4 v[88:91], v32, s[4:7], s15 offen sc1
    buffer_load_dwordx4 v[92:95], v32, s[4:7], s15 offen offset:16 sc1
    s_waitcnt vmcnt(0)
    v_add_f32 v24, v24, v88
    v_add_f32 v25, v25, v92
    v_add_f32 v26, v26, v89
    v_add_f32 v27, v27, v93
    v_add_f32 v28, v28, v90
    v_add_f32 v29, v29, v94
    v_add_f32 v30, v30, v91
    v_add_f32 v31, v31, v95
L_p2_kernel_q_26:
L_p2_kernel_nof32b_22:
    v_pk_mul_f32 v[88:89], v[24:25], s[84:85] op_sel:[0,0] op_sel_hi:[1,0]
    v_pk_mul_f32 v[90:91], v[24:25], s[84:85] op_sel:[0,1] op_sel_hi:[1,1]
    v_pk_mul_f32 v[92:93], v[24:25], s[86:87] op_sel:[0,0] op_sel_hi:[1,0]
    v_pk_mul_f32 v[94:95], v[24:25], s[86:87] op_sel:[0,1] op_sel_hi:[1,1]
    v_pk_fma_f32 v[88:89], v[26:27], s[88:89], v[88:89] op_sel:[0,0,0] op_sel_hi:[1,0,1]
    v_pk_fma_f32 v[90:91], v[26:27], s[88:89], v[90:91] op_sel:[0,1,0] op_sel_hi:[1,1,1]
    v_pk_fma_f32 v[92:93], v[26:27], s[90:91], v[92:93] op_sel:[0,0,0] op_sel_hi:[1,0,1]
    v_pk_fma_f32 v[94:95], v[26:27], s[90:91], v[94:95] op_sel:[0,1,0] op_sel_hi:[1,1,1]
    v_pk_fma_f32 v[88:89], v[28:29], s[92:93], v[88:89] op_sel:[0,0,0] op_sel_hi:[1,0,1]
    v_pk_fma_f32 v[90:91], v[28:29], s[92:93], v[90:91] op_sel:[0,1,0] op_sel_hi:[1,1,1]
    v_pk_fma_f32 v[92:93], v[28:29], s[94:95], v[92:93] op_sel:[0,0,0] op_sel_hi:[1,0,1]
    v_pk_fma_f32 v[94:95], v[28:29], s[94:95], v[94:95] op_sel:[0,1,0] op_sel_hi:[1,1,1]
    v_pk_fma_f32 v[88:89], v[30:31], s[96:97], v[88:89] op_sel:[0,0,0] op_sel_hi:[1,0,1]
    v_pk_fma_f32 v[90:91], v[30:31], s[96:97], v[90:91] op_sel:[0,1,0] op_sel_hi:[1,1,1]
    v_pk_fma_f32 v[92:93], v[30:31], s[98:99], v[92:93] op_sel:[0,0,0] op_sel_hi:[1,0,1]
    v_pk_fma_f32 v[94:95], v[30:31], s[98:99], v[94:95] op_sel:[0,1,0] op_sel_hi:[1,1,1]
    v_pk_mul_f32 v[88:89], v[88:89], v[112:113]
    v_pk_mul_f32 v[90:91], v[90:91], v[114:115]
    v_pk_mul_f32 v[92:93], v[92:93], v[116:117]
    v_pk_mul_f32 v[94:95], v[94:95], v[118:119]
    v_pk_mul_f32 v[24:25], v[88:89], s[28:29] op_sel:[0,0] op_sel_hi:[1,0]
    v_pk_mul_f32 v[26:27], v[88:89], s[28:29] op_sel:[0,1] op_sel_hi:[1,1]
    v_pk_mul_f32 v[28:29], v[88:89], s[30:31] op_sel:[0,0] op_sel_hi:[1,0]
    v_pk_mul_f32 v[30:31], v[88:89], s[30:31] op_sel:[0,1] op_sel_hi:[1,1]
    v_pk_fma_f32 v[24:25], v[90:91], s[32:33], v[24:25] op_sel:[0,0,0] op_sel_hi:[1,0,1]
    v_pk_fma_f32 v[26:27], v[90:91], s[32:33], v[26:27] op_sel:[0,1,0] op_sel_hi:[1,1,1]
    v_pk_fma_f32 v[28:29], v[90:91], s[34:35], v[28:29] op_sel:[0,0,0] op_sel_hi:[1,0,1]
    v_pk_fma_f32 v[30:31], v[90:91], s[34:35], v[30:31] op_sel:[0,1,0] op_sel_hi:[1,1,1]
    v_pk_fma_f32 v[24:25], v[92:93], s[36:37], v[24:25] op_sel:[0,0,0] op_sel_hi:[1,0,1]
    v_pk_fma_f32 v[26:27], v[92:93], s[36:37], v[26:27] op_sel:[0,1,0] op_sel_hi:[1,1,1]
    v_pk_fma_f32 v[28:29], v[92:93], s[38:39], v[28:29] op_sel:[0,0,0] op_sel_hi:[1,0,1]
    v_pk_fma_f32 v[30:31], v[92:93], s[38:39], v[30:31] op_sel:[0,1,0] op_sel_hi:[1,1,1]
    v_pk_fma_f32 v[24:25], v[94:95], s[40:41], v[24:25] op_sel:[0,0,0] op_sel_hi:[1,0,1]
    v_pk_fma_f32 v[26:27], v[94:95], s[40:41], v[26:27] op_sel:[0,1,0] op_sel_hi:[1,1,1]
    v_pk_fma_f32 v[28:29], v[94:95], s[42:43], v[28:29] op_sel:[0,0,0] op_sel_hi:[1,0,1]
    v_pk_fma_f32 v[30:31], v[94:95], s[42:43], v[30:31] op_sel:[0,1,0] op_sel_hi:[1,1,1]
    v_lshlrev_b32 v88, 16, v68
    v_and_b32 v90, 0xffff0000, v68
    v_lshlrev_b32 v92, 16, v69
    v_and_b32 v94, 0xffff0000, v69
    v_lshlrev_b32 v89, 16, v70
    v_and_b32 v91, 0xffff0000, v70
    v_lshlrev_b32 v93, 16, v71
    v_and_b32 v95, 0xffff0000, v71
    v_pk_fma_f32 v[88:89], v[24:25], v[120:121], v[88:89]
    v_pk_fma_f32 v[90:91], v[26:27], v[122:123], v[90:91]
    v_pk_fma_f32 v[92:93], v[28:29], v[124:125], v[92:93]
    v_pk_fma_f32 v[94:95], v[30:31], v[126:127], v[94:95]
    v_cvt_pk_bf16_f32 v96, v88, v90
    v_cvt_pk_bf16_f32 v97, v92, v94
    v_cvt_pk_bf16_f32 v98, v89, v91
    v_cvt_pk_bf16_f32 v99, v93, v95
    buffer_store_dwordx4 v[96:99], v2, s[16:19], s26 offen
L_p2_f1:
    s_bitset0_b32 s51, s49
    s_cmp_eq_u32 s51, 0
    s_cbranch_scc1 L_p2_done
    s_ff1_i32_b32 s49, s51
    s_lshl2_add_u32 s14, s3, s49
    s_mul_i32 s14, s14, 5000
    s_add_u32 s15, s14, 4096
    v_min_u32 v61, 225, v0
    v_lshl_add_u32 v60, v0, 2, s14
    v_lshl_add_u32 v61, v61, 2, s15
    global_load_dword v60, v60, s[100:101] nt
    global_load_dword v61, v61, s[100:101] nt
    s_waitcnt vmcnt(0)
    v_lshlrev_b32 v30, 16, v60
    v_and_b32 v31, 0xffff0000, v60
    v_lshlrev_b32 v36, 16, v53
    v_and_b32 v37, 0xffff0000, v53
    v_lshlrev_b32 v38, 16, v54
    v_and_b32 v39, 0xffff0000, v54
    v_lshlrev_b32 v40, 16, v56
    v_and_b32 v41, 0xffff0000, v56
    v_lshlrev_b32 v42, 16, v57
    v_and_b32 v43, 0xffff0000, v57
    v_pk_add_f32 v[14:15], v[30:31], v[36:37] op_sel:[0,0] op_sel_hi:[1,0] neg_lo:[0,1] neg_hi:[0,1]
    v_pk_add_f32 v[16:17], v[30:31], v[36:37] op_sel:[0,1] op_sel_hi:[1,1] neg_lo:[0,1] neg_hi:[0,1]
    v_pk_add_f32 v[18:19], v[30:31], v[38:39] op_sel:[0,0] op_sel_hi:[1,0] neg_lo:[0,1] neg_hi:[0,1]
    v_pk_add_f32 v[20:21], v[30:31], v[38:39] op_sel:[0,1] op_sel_hi:[1,1] neg_lo:[0,1] neg_hi:[0,1]
    v_pk_add_f32 v[22:23], v[30:31], v[40:41] op_sel:[0,0] op_sel_hi:[1,0] neg_lo:[0,1] neg_hi:[0,1]
    v_pk_add_f32 v[24:25], v[30:31], v[40:41] op_sel:[0,1] op_sel_hi:[1,1] neg_lo:[0,1] neg_hi:[0,1]
    v_pk_add_f32 v[26:27], v[30:31], v[42:43] op_sel:[0,0] op_sel_hi:[1,0] neg_lo:[0,1] neg_hi:[0,1]
    v_pk_add_f32 v[28:29], v[30:31], v[42:43] op_sel:[0,1] op_sel_hi:[1,1] neg_lo:[0,1] neg_hi:[0,1]
    v_cvt_pk_bf16_f32 v32, v14, v15
    v_lshlrev_b32 v14, 16, v32
    v_and_b32 v15, 0xffff0000, v32
    v_cvt_pk_bf16_f32 v32, v16, v17
    v_lshlrev_b32 v16, 16, v32
    v_and_b32 v17, 0xffff0000, v32
    v_cvt_pk_bf16_f32 v32, v18, v19
    v_lshlrev_b32 v18, 16, v32
    v_and_b32 v19, 0xffff0000, v32
    v_cvt_pk_bf16_f32 v32, v20, v21
    v_lshlrev_b32 v20, 16, v32
    v_and_b32 v21, 0xffff0000, v32
    v_cvt_pk_bf16_f32 v32, v22, v23
    v_lshlrev_b32 v22, 16, v32
    v_and_b32 v23, 0xffff0000, v32
    v_cvt_pk_bf16_f32 v32, v24, v25
    v_lshlrev_b32 v24, 16, v32
    v_and_b32 v25, 0xffff0000, v32
    v_cvt_pk_bf16_f32 v32, v26, v27
    v_lshlrev_b32 v26, 16, v32
    v_and_b32 v27, 0xffff0000, v32
    v_cvt_pk_bf16_f32 v32, v28, v29
    v_lshlrev_b32 v28, 16, v32
    v_and_b32 v29, 0xffff0000, v32
    v_pk_mul_f32 v[14:15], v[14:15], v[14:15]
    v_pk_mul_f32 v[16:17], v[16:17], v[16:17]
    v_pk_mul_f32 v[18:19], v[18:19], v[18:19]
    v_pk_mul_f32 v[20:21], v[20:21], v[20:21]
    v_pk_mul_f32 v[22:23], v[22:23], v[22:23]
    v_pk_mul_f32 v[24:25], v[24:25], v[24:25]
    v_pk_mul_f32 v[26:27], v[26:27], v[26:27]
    v_pk_mul_f32 v[28:29], v[28:29], v[28:29]
    v_cvt_pk_bf16_f32 v32, v14, v15
    v_lshlrev_b32 v14, 16, v32
    v_and_b32 v15, 0xffff0000, v32
    v_cvt_pk_bf16_f32 v32, v16, v17
    v_lshlrev_b32 v16, 16, v32
    v_and_b32 v17, 0xffff0000, v32
    v_cvt_pk_bf16_f32 v32, v18, v19
    v_lshlrev_b32 v18, 16, v32
    v_and_b32 v19, 0xffff0000, v32
    v_cvt_pk_bf16_f32 v32, v20, v21
    v_lshlrev_b32 v20, 16, v32
    v_and_b32 v21, 0xffff0000, v32
    v_cvt_pk_bf16_f32 v32, v22, v23
    v_lshlrev_b32 v22, 16, v32
    v_and_b32 v23, 0xffff0000, v32
    v_cvt_pk_bf16_f32 v32, v24, v25
    v_lshlrev_b32 v24, 16, v32
    v_and_b32 v25, 0xffff0000, v32
    v_cvt_pk_bf16_f32 v32, v26, v27
    v_lshlrev_b32 v26, 16, v32
    v_and_b32 v27, 0xffff0000, v32
    v_cvt_pk_bf16_f32 v32, v28, v29
    v_lshlrev_b32 v28, 16, v32
    v_and_b32 v29, 0xffff0000, v32
    v_mov_b32 v30, 1092616192
    v_mov_b32 v31, 0x3fb8aa3b
    v_pk_mul_f32 v[14:15], v[14:15], v[30:31] op_sel:[0,0] op_sel_hi:[1,0]
    v_pk_mul_f32 v[16:17], v[16:17], v[30:31] op_sel:[0,0] op_sel_hi:[1,0]
    v_pk_mul_f32 v[18:19], v[18:19], v[30:31] op_sel:[0,0] op_sel_hi:[1,0]
    v_pk_mul_f32 v[20:21], v[20:21], v[30:31] op_sel:[0,0] op_sel_hi:[1,0]
    v_pk_mul_f32 v[22:23], v[22:23], v[30:31] op_sel:[0,0] op_sel_hi:[1,0]
    v_pk_mul_f32 v[24:25], v[24:25], v[30:31] op_sel:[0,0] op_sel_hi:[1,0]
    v_pk_mul_f32 v[26:27], v[26:27], v[30:31] op_sel:[0,0] op_sel_hi:[1,0]
    v_pk_mul_f32 v[28:29], v[28:29], v[30:31] op_sel:[0,0] op_sel_hi:[1,0]
    v_cvt_pk_bf16_f32 v32, v14, v15
    v_lshlrev_b32 v14, 16, v32
    v_and_b32 v15, 0xffff0000, v32
    v_cvt_pk_bf16_f32 v32, v16, v17
    v_lshlrev_b32 v16, 16, v32
    v_and_b32 v17, 0xffff0000, v32
    v_cvt_pk_bf16_f32 v32, v18, v19
    v_lshlrev_b32 v18, 16, v32
    v_and_b32 v19, 0xffff0000, v32
    v_cvt_pk_bf16_f32 v32, v20, v21
    v_lshlrev_b32 v20, 16, v32
    v_and_b32 v21, 0xffff0000, v32
    v_cvt_pk_bf16_f32 v32, v22, v23
    v_lshlrev_b32 v22, 16, v32
    v_and_b32 v23, 0xffff0000, v32
    v_cvt_pk_bf16_f32 v32, v24, v25
    v_lshlrev_b32 v24, 16, v32
    v_and_b32 v25, 0xffff0000, v32
    v_cvt_pk_bf16_f32 v32, v26, v27
    v_lshlrev_b32 v26, 16, v32
    v_and_b32 v27, 0xffff0000, v32
    v_cvt_pk_bf16_f32 v32, v28, v29
    v_lshlrev_b32 v28, 16, v32
    v_and_b32 v29, 0xffff0000, v32
    v_pk_mul_f32 v[14:15], v[14:15], v[30:31] op_sel:[0,1] op_sel_hi:[1,1]
    v_pk_mul_f32 v[16:17], v[16:17], v[30:31] op_sel:[0,1] op_sel_hi:[1,1]
    v_pk_mul_f32 v[18:19], v[18:19], v[30:31] op_sel:[0,1] op_sel_hi:[1,1]
    v_pk_mul_f32 v[20:21], v[20:21], v[30:31] op_sel:[0,1] op_sel_hi:[1,1]
    v_pk_mul_f32 v[22:23], v[22:23], v[30:31] op_sel:[0,1] op_sel_hi:[1,1]
    v_pk_mul_f32 v[24:25], v[24:25], v[30:31] op_sel:[0,1] op_sel_hi:[1,1]
    v_pk_mul_f32 v[26:27], v[26:27], v[30:31] op_sel:[0,1] op_sel_hi:[1,1]
    v_pk_mul_f32 v[28:29], v[28:29], v[30:31] op_sel:[0,1] op_sel_hi:[1,1]
    v_exp_f32 v14, -v14
    v_exp_f32 v15, -v15
    v_exp_f32 v16, -v16
    v_exp_f32 v17, -v17
    v_exp_f32 v18, -v18
    v_exp_f32 v19, -v19
    v_exp_f32 v20, -v20
    v_exp_f32 v21, -v21
    v_exp_f32 v22, -v22
    v_exp_f32 v23, -v23
    v_exp_f32 v24, -v24
    v_exp_f32 v25, -v25
    v_exp_f32 v26, -v26
    v_exp_f32 v27, -v27
    v_exp_f32 v28, -v28
    v_exp_f32 v29, -v29
    v_cvt_pk_bf16_f32 v14, v14, v16
    v_cvt_pk_bf16_f32 v15, v15, v17
    v_cvt_pk_bf16_f32 v18, v18, v20
    v_cvt_pk_bf16_f32 v19, v19, v21
    v_cvt_pk_bf16_f32 v22, v22, v24
    v_cvt_pk_bf16_f32 v23, v23, v25
    v_cvt_pk_bf16_f32 v26, v26, v28
    v_cvt_pk_bf16_f32 v27, v27, v29
    v_dot2_f32_bf16 v72, v14, s68, 0
    v_dot2_f32_bf16 v73, v15, s68, 0
    v_dot2_f32_bf16 v74, v14, s69, 0
    v_dot2_f32_bf16 v75, v15, s69, 0
    v_dot2_f32_bf16 v76, v14, s70, 0
    v_dot2_f32_bf16 v77, v15, s70, 0
    v_dot2_f32_bf16 v78, v14, s71, 0
    v_dot2_f32_bf16 v79, v15, s71, 0
    v_dot2_f32_bf16 v80, v14, s52, 0
    v_dot2_f32_bf16 v81, v15, s52, 0
    v_dot2_f32_bf16 v82, v14, s53, 0
    v_dot2_f32_bf16 v83, v15, s53, 0
    v_dot2_f32_bf16 v84, v14, s54, 0
    v_dot2_f32_bf16 v85, v15, s54, 0
    v_dot2_f32_bf16 v86, v14, s55, 0
    v_dot2_f32_bf16 v87, v15, s55, 0
    v_dot2_f32_bf16 v72, v18, s72, v72
    v_dot2_f32_bf16 v73, v19, s72, v73
    v_dot2_f32_bf16 v74, v18, s73, v74
    v_dot2_f32_bf16 v75, v19, s73, v75
    v_dot2_f32_bf16 v76, v18, s74, v76
    v_dot2_f32_bf16 v77, v19, s74, v77
    v_dot2_f32_bf16 v78, v18, s75, v78
    v_dot2_f32_bf16 v79, v19, s75, v79
    v_dot2_f32_bf16 v80, v18, s56, v80
    v_dot2_f32_bf16 v81, v19, s56, v81
    v_dot2_f32_bf16 v82, v18, s57, v82
    v_dot2_f32_bf16 v83, v19, s57, v83
    v_dot2_f32_bf16 v84, v18, s58, v84
    v_dot2_f32_bf16 v85, v19, s58, v85
    v_dot2_f32_bf16 v86, v18, s59, v86
    v_dot2_f32_bf16 v87, v19, s59, v87
    v_dot2_f32_bf16 v72, v22, s76, v72
    v_dot2_f32_bf16 v73, v23, s76, v73
    v_dot2_f32_bf16 v74, v22, s77, v74
    v_dot2_f32_bf16 v75, v23, s77, v75
    v_dot2_f32_bf16 v76, v22, s78, v76
    v_dot2_f32_bf16 v77, v23, s78, v77
    v_dot2_f32_bf16 v78, v22, s79, v78
    v_dot2_f32_bf16 v79, v23, s79, v79
    v_dot2_f32_bf16 v80, v22, s60, v80
    v_dot2_f32_bf16 v81, v23, s60, v81
    v_dot2_f32_bf16 v82, v22, s61, v82
    v_dot2_f32_bf16 v83, v23, s61, v83
    v_dot2_f32_bf16 v84, v22, s62, v84
    v_dot2_f32_bf16 v85, v23, s62, v85
    v_dot2_f32_bf16 v86, v22, s63, v86
    v_dot2_f32_bf16 v87, v23, s63, v87
    v_dot2_f32_bf16 v72, v26, s80, v72
    v_dot2_f32_bf16 v73, v27, s80, v73
    v_dot2_f32_bf16 v74, v26, s81, v74
    v_dot2_f32_bf16 v75, v27, s81, v75
    v_dot2_f32_bf16 v76, v26, s82, v76
    v_dot2_f32_bf16 v77, v27, s82, v77
    v_dot2_f32_bf16 v78, v26, s83, v78
    v_dot2_f32_bf16 v79, v27, s83, v79
    v_dot2_f32_bf16 v80, v26, s64, v80
    v_dot2_f32_bf16 v81, v27, s64, v81
    v_dot2_f32_bf16 v82, v26, s65, v82
    v_dot2_f32_bf16 v83, v27, s65, v83
    v_dot2_f32_bf16 v84, v26, s66, v84
    v_dot2_f32_bf16 v85, v27, s66, v85
    v_dot2_f32_bf16 v86, v26, s67, v86
    v_dot2_f32_bf16 v87, v27, s67, v87
    s_cmp_ge_u32 s13, 4
    s_cbranch_scc1 L_p2_kernel_g1_27
    v_lshlrev_b32 v30, 16, v61
    v_and_b32 v31, 0xffff0000, v61
    v_pk_add_f32 v[14:15], v[30:31], v[36:37] op_sel:[0,0] op_sel_hi:[1,0] neg_lo:[0,1] neg_hi:[0,1]
    v_pk_add_f32 v[16:17], v[30:31], v[36:37] op_sel:[0,1] op_sel_hi:[1,1] neg_lo:[0,1] neg_hi:[0,1]
    v_pk_add_f32 v[18:19], v[30:31], v[38:39] op_sel:[0,0] op_sel_hi:[1,0] neg_lo:[0,1] neg_hi:[0,1]
    v_pk_add_f32 v[20:21], v[30:31], v[38:39] op_sel:[0,1] op_sel_hi:[1,1] neg_lo:[0,1] neg_hi:[0,1]
    v_pk_add_f32 v[22:23], v[30:31], v[40:41] op_sel:[0,0] op_sel_hi:[1,0] neg_lo:[0,1] neg_hi:[0,1]
    v_pk_add_f32 v[24:25], v[30:31], v[40:41] op_sel:[0,1] op_sel_hi:[1,1] neg_lo:[0,1] neg_hi:[0,1]
    v_pk_add_f32 v[26:27], v[30:31], v[42:43] op_sel:[0,0] op_sel_hi:[1,0] neg_lo:[0,1] neg_hi:[0,1]
    v_pk_add_f32 v[28:29], v[30:31], v[42:43] op_sel:[0,1] op_sel_hi:[1,1] neg_lo:[0,1] neg_hi:[0,1]
    v_cvt_pk_bf16_f32 v32, v14, v15
    v_lshlrev_b32 v14, 16, v32
    v_and_b32 v15, 0xffff0000, v32
    v_cvt_pk_bf16_f32 v32, v16, v17
    v_lshlrev_b32 v16, 16, v32
    v_and_b32 v17, 0xffff0000, v32
    v_cvt_pk_bf16_f32 v32, v18, v19
    v_lshlrev_b32 v18, 16, v32
    v_and_b32 v19, 0xffff0000, v32
    v_cvt_pk_bf16_f32 v32, v20, v21
    v_lshlrev_b32 v20, 16, v32
    v_and_b32 v21, 0xffff0000, v32
    v_cvt_pk_bf16_f32 v32, v22, v23
    v_lshlrev_b32 v22, 16, v32
    v_and_b32 v23, 0xffff0000, v32
    v_cvt_pk_bf16_f32 v32, v24, v25
    v_lshlrev_b32 v24, 16, v32
    v_and_b32 v25, 0xffff0000, v32
    v_cvt_pk_bf16_f32 v32, v26, v27
    v_lshlrev_b32 v26, 16, v32
    v_and_b32 v27, 0xffff0000, v32
    v_cvt_pk_bf16_f32 v32, v28, v29
    v_lshlrev_b32 v28, 16, v32
    v_and_b32 v29, 0xffff0000, v32
    v_pk_mul_f32 v[14:15], v[14:15], v[14:15]
    v_pk_mul_f32 v[16:17], v[16:17], v[16:17]
    v_pk_mul_f32 v[18:19], v[18:19], v[18:19]
    v_pk_mul_f32 v[20:21], v[20:21], v[20:21]
    v_pk_mul_f32 v[22:23], v[22:23], v[22:23]
    v_pk_mul_f32 v[24:25], v[24:25], v[24:25]
    v_pk_mul_f32 v[26:27], v[26:27], v[26:27]
    v_pk_mul_f32 v[28:29], v[28:29], v[28:29]
    v_cvt_pk_bf16_f32 v32, v14, v15
    v_lshlrev_b32 v14, 16, v32
    v_and_b32 v15, 0xffff0000, v32
    v_cvt_pk_bf16_f32 v32, v16, v17
    v_lshlrev_b32 v16, 16, v32
    v_and_b32 v17, 0xffff0000, v32
    v_cvt_pk_bf16_f32 v32, v18, v19
    v_lshlrev_b32 v18, 16, v32
    v_and_b32 v19, 0xffff0000, v32
    v_cvt_pk_bf16_f32 v32, v20, v21
    v_lshlrev_b32 v20, 16, v32
    v_and_b32 v21, 0xffff0000, v32
    v_cvt_pk_bf16_f32 v32, v22, v23
    v_lshlrev_b32 v22, 16, v32
    v_and_b32 v23, 0xffff0000, v32
    v_cvt_pk_bf16_f32 v32, v24, v25
    v_lshlrev_b32 v24, 16, v32
    v_and_b32 v25, 0xffff0000, v32
    v_cvt_pk_bf16_f32 v32, v26, v27
    v_lshlrev_b32 v26, 16, v32
    v_and_b32 v27, 0xffff0000, v32
    v_cvt_pk_bf16_f32 v32, v28, v29
    v_lshlrev_b32 v28, 16, v32
    v_and_b32 v29, 0xffff0000, v32
    v_mov_b32 v30, 1092616192
    v_mov_b32 v31, 0x3fb8aa3b
    v_pk_mul_f32 v[14:15], v[14:15], v[30:31] op_sel:[0,0] op_sel_hi:[1,0]
    v_pk_mul_f32 v[16:17], v[16:17], v[30:31] op_sel:[0,0] op_sel_hi:[1,0]
    v_pk_mul_f32 v[18:19], v[18:19], v[30:31] op_sel:[0,0] op_sel_hi:[1,0]
    v_pk_mul_f32 v[20:21], v[20:21], v[30:31] op_sel:[0,0] op_sel_hi:[1,0]
    v_pk_mul_f32 v[22:23], v[22:23], v[30:31] op_sel:[0,0] op_sel_hi:[1,0]
    v_pk_mul_f32 v[24:25], v[24:25], v[30:31] op_sel:[0,0] op_sel_hi:[1,0]
    v_pk_mul_f32 v[26:27], v[26:27], v[30:31] op_sel:[0,0] op_sel_hi:[1,0]
    v_pk_mul_f32 v[28:29], v[28:29], v[30:31] op_sel:[0,0] op_sel_hi:[1,0]
    v_cvt_pk_bf16_f32 v32, v14, v15
    v_lshlrev_b32 v14, 16, v32
    v_and_b32 v15, 0xffff0000, v32
    v_cvt_pk_bf16_f32 v32, v16, v17
    v_lshlrev_b32 v16, 16, v32
    v_and_b32 v17, 0xffff0000, v32
    v_cvt_pk_bf16_f32 v32, v18, v19
    v_lshlrev_b32 v18, 16, v32
    v_and_b32 v19, 0xffff0000, v32
    v_cvt_pk_bf16_f32 v32, v20, v21
    v_lshlrev_b32 v20, 16, v32
    v_and_b32 v21, 0xffff0000, v32
    v_cvt_pk_bf16_f32 v32, v22, v23
    v_lshlrev_b32 v22, 16, v32
    v_and_b32 v23, 0xffff0000, v32
    v_cvt_pk_bf16_f32 v32, v24, v25
    v_lshlrev_b32 v24, 16, v32
    v_and_b32 v25, 0xffff0000, v32
    v_cvt_pk_bf16_f32 v32, v26, v27
    v_lshlrev_b32 v26, 16, v32
    v_and_b32 v27, 0xffff0000, v32
    v_cvt_pk_bf16_f32 v32, v28, v29
    v_lshlrev_b32 v28, 16, v32
    v_and_b32 v29, 0xffff0000, v32
    v_pk_mul_f32 v[14:15], v[14:15], v[30:31] op_sel:[0,1] op_sel_hi:[1,1]
    v_pk_mul_f32 v[16:17], v[16:17], v[30:31] op_sel:[0,1] op_sel_hi:[1,1]
    v_pk_mul_f32 v[18:19], v[18:19], v[30:31] op_sel:[0,1] op_sel_hi:[1,1]
    v_pk_mul_f32 v[20:21], v[20:21], v[30:31] op_sel:[0,1] op_sel_hi:[1,1]
    v_pk_mul_f32 v[22:23], v[22:23], v[30:31] op_sel:[0,1] op_sel_hi:[1,1]
    v_pk_mul_f32 v[24:25], v[24:25], v[30:31] op_sel:[0,1] op_sel_hi:[1,1]
    v_pk_mul_f32 v[26:27], v[26:27], v[30:31] op_sel:[0,1] op_sel_hi:[1,1]
    v_pk_mul_f32 v[28:29], v[28:29], v[30:31] op_sel:[0,1] op_sel_hi:[1,1]
    v_exp_f32 v14, -v14
    v_exp_f32 v15, -v15
    v_exp_f32 v16, -v16
    v_exp_f32 v17, -v17
    v_exp_f32 v18, -v18
    v_exp_f32 v19, -v19
    v_exp_f32 v20, -v20
    v_exp_f32 v21, -v21
    v_exp_f32 v22, -v22
    v_exp_f32 v23, -v23
    v_exp_f32 v24, -v24
    v_exp_f32 v25, -v25
    v_exp_f32 v26, -v26
    v_exp_f32 v27, -v27
    v_exp_f32 v28, -v28
    v_exp_f32 v29, -v29
    v_cvt_pk_bf16_f32 v14, v14, v16
    v_cvt_pk_bf16_f32 v15, v15, v17
    v_cvt_pk_bf16_f32 v18, v18, v20
    v_cvt_pk_bf16_f32 v19, v19, v21
    v_cvt_pk_bf16_f32 v22, v22, v24
    v_cvt_pk_bf16_f32 v23, v23, v25
    v_cvt_pk_bf16_f32 v26, v26, v28
    v_cvt_pk_bf16_f32 v27, v27, v29
    v_dot2_f32_bf16 v112, v14, s68, 0
    v_dot2_f32_bf16 v113, v15, s68, 0
    v_dot2_f32_bf16 v114, v14, s69, 0
    v_dot2_f32_bf16 v115, v15, s69, 0
    v_dot2_f32_bf16 v116, v14, s70, 0
    v_dot2_f32_bf16 v117, v15, s70, 0
    v_dot2_f32_bf16 v118, v14, s71, 0
    v_dot2_f32_bf16 v119, v15, s71, 0
    v_dot2_f32_bf16 v120, v14, s52, 0
    v_dot2_f32_bf16 v121, v15, s52, 0
    v_dot2_f32_bf16 v122, v14, s53, 0
    v_dot2_f32_bf16 v123, v15, s53, 0
    v_dot2_f32_bf16 v124, v14, s54, 0
    v_dot2_f32_bf16 v125, v15, s54, 0
    v_dot2_f32_bf16 v126, v14, s55, 0
    v_dot2_f32_bf16 v127, v15, s55, 0
    v_dot2_f32_bf16 v112, v18, s72, v112
    v_dot2_f32_bf16 v113, v19, s72, v113
    v_dot2_f32_bf16 v114, v18, s73, v114
    v_dot2_f32_bf16 v115, v19, s73, v115
    v_dot2_f32_bf16 v116, v18, s74, v116
    v_dot2_f32_bf16 v117, v19, s74, v117
    v_dot2_f32_bf16 v118, v18, s75, v118
    v_dot2_f32_bf16 v119, v19, s75, v119
    v_dot2_f32_bf16 v120, v18, s56, v120
    v_dot2_f32_bf16 v121, v19, s56, v121
    v_dot2_f32_bf16 v122, v18, s57, v122
    v_dot2_f32_bf16 v123, v19, s57, v123
    v_dot2_f32_bf16 v124, v18, s58, v124
    v_dot2_f32_bf16 v125, v19, s58, v125
    v_dot2_f32_bf16 v126, v18, s59, v126
    v_dot2_f32_bf16 v127, v19, s59, v127
    v_dot2_f32_bf16 v112, v22, s76, v112
    v_dot2_f32_bf16 v113, v23, s76, v113
    v_dot2_f32_bf16 v114, v22, s77, v114
    v_dot2_f32_bf16 v115, v23, s77, v115
    v_dot2_f32_bf16 v116, v22, s78, v116
    v_dot2_f32_bf16 v117, v23, s78, v117
    v_dot2_f32_bf16 v118, v22, s79, v118
    v_dot2_f32_bf16 v119, v23, s79, v119
    v_dot2_f32_bf16 v120, v22, s60, v120
    v_dot2_f32_bf16 v121, v23, s60, v121
    v_dot2_f32_bf16 v122, v22, s61, v122
    v_dot2_f32_bf16 v123, v23, s61, v123
    v_dot2_f32_bf16 v124, v22, s62, v124
    v_dot2_f32_bf16 v125, v23, s62, v125
    v_dot2_f32_bf16 v126, v22, s63, v126
    v_dot2_f32_bf16 v127, v23, s63, v127
    v_dot2_f32_bf16 v112, v26, s80, v112
    v_dot2_f32_bf16 v113, v27, s80, v113
    v_dot2_f32_bf16 v114, v26, s81, v114
    v_dot2_f32_bf16 v115, v27, s81, v115
    v_dot2_f32_bf16 v116, v26, s82, v116
    v_dot2_f32_bf16 v117, v27, s82, v117
    v_dot2_f32_bf16 v118, v26, s83, v118
    v_dot2_f32_bf16 v119, v27, s83, v119
    v_dot2_f32_bf16 v120, v26, s64, v120
    v_dot2_f32_bf16 v121, v27, s64, v121
    v_dot2_f32_bf16 v122, v26, s65, v122
    v_dot2_f32_bf16 v123, v27, s65, v123
    v_dot2_f32_bf16 v124, v26, s66, v124
    v_dot2_f32_bf16 v125, v27, s66, v125
    v_dot2_f32_bf16 v126, v26, s67, v126
    v_dot2_f32_bf16 v127, v27, s67, v127
L_p2_kernel_g1_27:
    s_lshl2_add_u32 s14, s3, s49
    s_mul_i32 s26, s14, 20000
    s_add_u32 s15, s26, 8573440
    buffer_load_dwordx4 v[64:67], v1, s[4:7], s15 offen
    buffer_load_dwordx4 v[68:71], v2, s[4:7], s15 offen
    s_branch L_p2_fin
L_p2_done:
    s_branch L_p2_end
L_p2_slow:
    s_barrier
    v_mov_b32 v8, 0
    v_mov_b32 v9, 0
    v_mov_b32 v10, 0
    v_mov_b32 v11, 0
    v_mov_b32 v12, v1
    ds_write_b128 v12, v[8:11]
    v_add_u32 v12, 16384, v12
    ds_write_b128 v12, v[8:11]
    v_add_u32 v12, 16384, v12
    ds_write_b128 v12, v[8:11]
    v_add_u32 v12, 16384, v12
    ds_write_b128 v12, v[8:11]
    v_add_u32 v12, 16384, v12
    ds_write_b128 v12, v[8:11]
    v_add_u32 v12, 16384, v12
    ds_write_b128 v12, v[8:11]
    v_add_u32 v12, 16384, v12
    ds_write_b128 v12, v[8:11]
    v_add_u32 v12, 16384, v12
    ds_write_b128 v12, v[8:11]
    v_add_u32 v12, 16384, v12
    ds_write_b128 v12, v[8:11]
    v_add_u32 v12, 16384, v12
    ds_write_b128 v12, v[8:11]
    v_add_u32 v12, 16384, v12
    v_lshlrev_b32 v13, 5, v0
    v_mov_b32 v29, 0x7fc00000
    v_add_u32 v28, 32896, v13
    v_lshlrev_b32 v14, 10, v0
    v_add_u32 v14, 14680064, v14
    s_mul_i32 s25, s12, 65
    s_add_u32 s25, s25, s3
    s_mul_i32 s25, s25, 32896
    s_add_u32 s25, s25, 0
    s_lshl_b32 s50, s50, 1
    s_mul_i32 s22, s12, 1280000
    s_mov_b32 s24, 0
    s_waitcnt lgkmcnt(0)
    s_barrier
L_p2_sstep:
    buffer_load_ushort v15, v13, s[4:7], s25 offen
    buffer_load_ushort v16, v28, s[4:7], s25 offen
    s_waitcnt vmcnt(0)
L_p2_srec:
    v_cmp_lt_u32 vcc, v15, v16
    s_nop 1
    s_and_b64 exec, exec, vcc
    s_cbranch_execz L_p2_sdone
    v_mul_u32_u24 v17, 43691, v15
    v_lshrrev_b32 v17, 17, v17
    v_mad_i32_i24 v18, v17, -3, v15
    v_lshrrev_b32 v19, 6, v17
    v_lshl_add_u32 v19, v19, 20, v14
    v_and_b32 v17, 63, v17
    v_lshl_add_u32 v17, v17, 4, v19
    v_lshl_add_u32 v19, v18, 2, v17
    buffer_load_dword v20, v19, s[4:7], 0 offen
    buffer_load_dword v21, v17, s[4:7], 0 offen offset:12
    v_add_u32 v15, 1, v15
    v_mad_u32_u24 v18, v18, 10, 2
    s_waitcnt vmcnt(0)
    v_lshlrev_b32_sdwa v19, 3, v20 dst_sel:DWORD dst_unused:UNUSED_PAD src0_sel:DWORD src1_sel:WORD_0
    buffer_load_dwordx2 v[22:23], v19, s[8:11], s22 offen
    v_mad_u32_u16 v20, v20, 16, s50 op_sel:[1,0,0,0]
    v_bfe_i32 v21, v21, v18, 10
    v_cmp_eq_i32 vcc, -512, v21
    v_cvt_f32_i32 v21, v21
    v_mul_f32 v21, 989872160, v21
    v_cndmask_b32 v21, v21, v29, vcc
    s_waitcnt vmcnt(0)
    v_lshlrev_b32 v24, 16, v22
    v_and_b32 v25, 0xffff0000, v22
    v_lshlrev_b32 v26, 16, v23
    v_and_b32 v27, 0xffff0000, v23
    v_mul_f32 v24, v21, v24
    v_mul_f32 v25, v21, v25
    v_mul_f32 v26, v21, v26
    v_mul_f32 v27, v21, v27
    ds_add_f32 v20, v24
    ds_add_f32 v20, v25 offset:4
    ds_add_f32 v20, v26 offset:8
    ds_add_f32 v20, v27 offset:12
    s_branch L_p2_srec
L_p2_sdone:
    s_mov_b64 exec, -1
    s_cmp_eq_u32 s24, 7
    s_cselect_b32 s14, 2, 2
    s_add_u32 s25, s25, s14
    s_add_u32 s22, s22, 80000
    s_add_u32 s24, s24, 1
    s_cmp_lt_u32 s24, 16
    s_cbranch_scc1 L_p2_sstep
    s_waitcnt lgkmcnt(0)
    s_barrier
    s_mul_i32 s14, s12, 10240000
    s_mul_i32 s15, s3, 160000
    s_add_u32 s26, s14, s15
    s_add_u32 s26, s26, 254312448
    v_mov_b32 v12, v1
    s_mov_b32 s24, 0
L_p2_sout:
    v_cmp_gt_u32 vcc, 160000, v12
    ds_read_b128 v[8:11], v12
    s_nop 0
    s_and_b64 exec, exec, vcc
    s_cbranch_execz L_p2_sfin
    s_waitcnt lgkmcnt(0)
    buffer_store_dwordx4 v[8:11], v12, s[4:7], s26 offen sc1
    s_waitcnt vmcnt(0)
    v_add_u32 v12, 16384, v12
    s_branch L_p2_sout
L_p2_sfin:
    s_mov_b64 exec, -1
    s_waitcnt vmcnt(0) lgkmcnt(0)
    s_barrier
    s_branch L_p2_signal
L_p2_end:
    s_endpgm
.section .rodata,"a"
.p2align 6
.amdhsa_kernel p1_kernel
  .amdhsa_next_free_vgpr 128
  .amdhsa_next_free_sgpr 96
  .amdhsa_accum_offset 128
  .amdhsa_group_segment_fixed_size 0
  .amdhsa_kernarg_size 112
  .amdhsa_user_sgpr_count 2
  .amdhsa_user_sgpr_kernarg_segment_ptr 1
  .amdhsa_system_sgpr_workgroup_id_x 1
  .amdhsa_float_denorm_mode_32 0
.end_amdhsa_kernel
.p2align 6
.amdhsa_kernel p2_kernel
  .amdhsa_next_free_vgpr 128
  .amdhsa_next_free_sgpr 102
  .amdhsa_accum_offset 128
  .amdhsa_group_segment_fixed_size 0
  .amdhsa_kernarg_size 112
  .amdhsa_user_sgpr_count 2
  .amdhsa_user_sgpr_kernarg_segment_ptr 1
  .amdhsa_system_sgpr_workgroup_id_x 1
  .amdhsa_float_denorm_mode_32 0
.end_amdhsa_kernel
```

```asm
; @launch kernel=p1_kernel grid=(256,1,1) block=(1024,1,1) lds=163840
; @launch kernel=p2_kernel grid=(256,1,1) block=(1024,1,1) lds=163840
.amdgcn_target "amdgcn-amd-amdhsa--gfx950"
.text
.globl p1_kernel
.p2align 8
.type p1_kernel,@function
p1_kernel:
    s_cmp_ge_u32 s2, 256
    s_cbranch_scc1 L_p1_end
    s_load_dwordx2 s[4:5], s[0:1], 104
    s_load_dwordx2 s[8:9], s[0:1], 8
    s_load_dwordx2 s[12:13], s[0:1], 16
    s_load_dwordx2 s[16:17], s[0:1], 32
    s_load_dwordx2 s[28:29], s[0:1], 0
    s_load_dwordx2 s[6:7], s[0:1], 48
    v_cmp_gt_u32 vcc, 256, v0
    s_nop 1
    s_cbranch_vccz L_p1_nopf
    s_getpc_b64 s[72:73]
L_p1_kernel_pc_1:
    s_add_u32 s72, s72, L_p1_nopf-L_p1_kernel_pc_1
    s_addc_u32 s73, s73, 0
    v_lshlrev_b32 v14, 7, v0
    v_min_u32 v14, L_p2_end-L_p1_nopf, v14
    global_load_dword v15, v14, s[72:73]
L_p1_nopf:
    v_lshlrev_b32 v1, 4, v0
    v_lshlrev_b32 v2, 3, v0
    v_lshrrev_b32 v6, 6, v0
    v_mul_u32_u24 v3, 851904, v6
    v_add_lshl_u32 v3, v3, v0, 4
    v_mov_b32 v4, 1
    v_mov_b32 v5, 0
    v_readfirstlane_b32 s39, v6
    v_cmp_gt_u32 vcc, 784, v0
    s_and_b32 s51, s2, 7
    s_lshl_b32 s51, s51, 0
    s_bfe_u32 s35, s2, 3
    s_add_u32 s51, s51, s35
    s_and_b32 s35, s2, 248
    s_add_u32 s51, s51, s35
    s_and_b32 s32, s2, 7
    s_lshl_b32 s32, s32, 2
    s_bfe_u32 s35, s2, 131075
    s_add_u32 s32, s32, s35
    s_and_b32 s35, s2, 224
    s_add_u32 s32, s32, s35
    s_lshr_b32 s35, s39, 4
    s_mul_i32 s36, s35, 4177920
    s_lshl_b32 s33, s51, 14
    s_add_u32 s33, s33, s36
    s_lshr_b32 s34, s33, 1
    s_mul_i32 s48, s51, 3840
    s_cmp_ge_u32 s35, 0
    s_cselect_b32 s48, s48, 0
    s_lshr_b32 s49, s48, 1
    s_mov_b64 s[44:45], vcc
    s_waitcnt lgkmcnt(0)
    s_load_dword s3, s[6:7], 0
    s_mov_b32 s10, 163840000
    s_mov_b32 s11, 0x00020000
    s_mov_b32 s14, 163840000
    s_mov_b32 s15, 0x00020000
    s_mov_b32 s18, 81920000
    s_mov_b32 s19, 0x00020000
    s_mul_i32 s36, s2, 20000
    s_add_u32 s30, s36, 20000
    s_mov_b32 s31, 0x00020000
    s_add_u32 s35, s36, 16384
    buffer_load_dwordx4 v[48:51], v1, s[28:31], s36 offen nt
    buffer_load_dwordx4 v[52:55], v1, s[28:31], s35 offen nt
    s_add_u32 s35, s33, 0
    buffer_load_dwordx4 v[16:19], v1, s[8:11], s35 offen nt
    s_add_u32 s35, s33, 0
    buffer_load_dwordx4 v[20:23], v1, s[12:15], s35 offen nt
    s_add_u32 s35, s33, 4194304
    buffer_load_dwordx4 v[24:27], v1, s[8:11], s35 offen nt
    s_add_u32 s35, s33, 4194304
    buffer_load_dwordx4 v[28:31], v1, s[12:15], s35 offen nt
    s_add_u32 s35, s33, 8388608
    buffer_load_dwordx4 v[32:35], v1, s[8:11], s35 offen nt
    s_add_u32 s35, s33, 8388608
    buffer_load_dwordx4 v[36:39], v1, s[12:15], s35 offen nt
    s_add_u32 s35, s33, 12582912
    buffer_load_dwordx4 v[40:43], v1, s[8:11], s35 offen nt
    s_add_u32 s35, s33, 12582912
    buffer_load_dwordx4 v[44:47], v1, s[12:15], s35 offen nt
    s_mov_b32 s20, s4
    s_mov_b32 s21, s5
    s_mov_b32 s22, 0
    s_mov_b32 s23, 0x00020000
    s_add_u32 s24, s4, 0
    s_addc_u32 s25, s5, 0
    s_mov_b32 s26, 8573440
    s_mov_b32 s27, 0x00020000
    s_mov_b32 s37, 1492179184
    s_mov_b32 s55, 0
    s_mov_b32 s50, 21845
    s_mov_b32 s38, 262400
    s_mov_b32 s43, 0x05040100
    s_mov_b32 s40, 0
    v_mov_b32 v8, 0
    v_mov_b32 v9, 0
    v_mov_b32 v10, 0
    v_mov_b32 v11, 0
    ds_write_b128 v1, v[8:11] offset:0
    s_waitcnt lgkmcnt(0)
    s_lshl_b32 s3, s3, 16
    v_mov_b32 v12, s3
    v_mul_f32 v12, 0.15915494, v12
    s_nop 0
    v_readfirstlane_b32 s41, v12
    s_waitcnt vmcnt(8)
    s_add_u32 s28, s4, 8573440
    s_addc_u32 s29, s5, 0
    s_mul_i32 s36, s2, 20000
    s_add_u32 s35, s36, 16384
    buffer_store_dwordx4 v[48:51], v1, s[28:31], s36 offen
    buffer_store_dwordx4 v[52:55], v1, s[28:31], s35 offen
    s_nop 0
    v_mov_b32 v12, 0x3f803f80
    v_and_b32 v48, 0x7fff7fff, v48
    v_and_b32 v49, 0x7fff7fff, v49
    v_and_b32 v50, 0x7fff7fff, v50
    v_and_b32 v51, 0x7fff7fff, v51
    v_and_b32 v52, 0x7fff7fff, v52
    v_and_b32 v53, 0x7fff7fff, v53
    v_and_b32 v54, 0x7fff7fff, v54
    v_and_b32 v55, 0x7fff7fff, v55
    v_pk_max_u16 v8, v8, v48
    v_dot2c_f32_bf16 v9, v48, v12
    v_pk_max_u16 v8, v8, v49
    v_dot2c_f32_bf16 v9, v49, v12
    v_pk_max_u16 v8, v8, v50
    v_dot2c_f32_bf16 v9, v50, v12
    v_pk_max_u16 v8, v8, v51
    v_dot2c_f32_bf16 v9, v51, v12
    v_pk_max_u16 v8, v8, v52
    v_dot2c_f32_bf16 v9, v52, v12
    v_pk_max_u16 v8, v8, v53
    v_dot2c_f32_bf16 v9, v53, v12
    v_pk_max_u16 v8, v8, v54
    v_dot2c_f32_bf16 v9, v54, v12
    v_pk_max_u16 v8, v8, v55
    v_dot2c_f32_bf16 v9, v55, v12
    v_lshrrev_b32 v10, 16, v8
    v_and_b32 v8, 0xffff, v8
    v_max_u32 v8, v8, v10
    s_nop 0
    s_nop 1
    v_max_u32_dpp v8, v8, v8 row_shr:1 row_mask:0xf bank_mask:0xf bound_ctrl:0
    s_nop 1
    v_max_u32_dpp v8, v8, v8 row_shr:2 row_mask:0xf bank_mask:0xf bound_ctrl:0
    s_nop 1
    v_max_u32_dpp v8, v8, v8 row_shr:4 row_mask:0xf bank_mask:0xf bound_ctrl:0
    s_nop 1
    v_max_u32_dpp v8, v8, v8 row_shr:8 row_mask:0xf bank_mask:0xf bound_ctrl:0
    s_nop 1
    v_max_u32_dpp v8, v8, v8 row_bcast:15 row_mask:0xa bank_mask:0xf
    s_nop 1
    v_max_u32_dpp v8, v8, v8 row_bcast:31 row_mask:0xc bank_mask:0xf
    s_nop 1
    v_add_f32_dpp v9, v9, v9 row_shr:1 row_mask:0xf bank_mask:0xf bound_ctrl:0
    s_nop 1
    v_add_f32_dpp v9, v9, v9 row_shr:2 row_mask:0xf bank_mask:0xf bound_ctrl:0
    s_nop 1
    v_add_f32_dpp v9, v9, v9 row_shr:4 row_mask:0xf bank_mask:0xf bound_ctrl:0
    s_nop 1
    v_add_f32_dpp v9, v9, v9 row_shr:8 row_mask:0xf bank_mask:0xf bound_ctrl:0
    s_nop 1
    v_add_f32_dpp v9, v9, v9 row_bcast:15 row_mask:0xa bank_mask:0xf
    s_nop 1
    v_add_f32_dpp v9, v9, v9 row_bcast:31 row_mask:0xc bank_mask:0xf
    s_lshl_b32 s35, s39, 4
    s_add_u32 s35, s35, 160320
    v_mov_b32 v10, s35
    s_mov_b32 exec_lo, 0
    s_brev_b32 exec_hi, 1
    ds_write_b64 v10, v[8:9]
    s_mov_b64 exec, -1
    s_waitcnt lgkmcnt(0)
    s_barrier
    s_branch L_p1_first
L_p1_loop:
    s_getreg_b32 s51, hwreg(HW_REG_XCC_ID, 0, 1)
    s_cmp_eq_u32 s51, 0
    s_cselect_b64 vcc, -1, 0
    s_waitcnt lgkmcnt(13)
    v_lshlrev_b32 v15, 22, v100
    v_lshrrev_b32 v100, 16, v100
    v_alignbit_b32 v15, v100, v15, 10
    v_alignbit_b32 v15, v101, v15, 10
    v_xor_b32 v15, 0x80200800, v15
    s_cmp_lg_u32 s39, 15
    s_cbranch_scc1 L_p1_kernel_nox_2
    s_mov_b32 s36, 13631488
    buffer_store_dwordx4 v[12:15], v3, s[20:23], s36 offen sc1
L_p1_kernel_nox_2:
    s_waitcnt lgkmcnt(12)
    v_lshlrev_b32 v75, 22, v102
    v_lshrrev_b32 v102, 16, v102
    v_alignbit_b32 v75, v102, v75, 10
    v_alignbit_b32 v75, v103, v75, 10
    v_xor_b32 v75, 0x80200800, v75
    s_mov_b32 s36, 0
    buffer_store_dwordx4 v[72:75], v3, s[20:23], s36 offen sc1
    s_waitcnt lgkmcnt(11)
    v_lshlrev_b32 v79, 22, v104
    v_lshrrev_b32 v104, 16, v104
    v_alignbit_b32 v79, v104, v79, 10
    v_alignbit_b32 v79, v105, v79, 10
    v_xor_b32 v79, 0x80200800, v79
    s_mov_b32 s36, 1048576
    buffer_store_dwordx4 v[76:79], v3, s[20:23], s36 offen sc1
    s_waitcnt lgkmcnt(10)
    v_lshlrev_b32 v51, 22, v106
    v_lshrrev_b32 v106, 16, v106
    v_alignbit_b32 v51, v106, v51, 10
    v_alignbit_b32 v51, v107, v51, 10
    v_xor_b32 v51, 0x80200800, v51
    s_mov_b32 s36, 2097152
    buffer_store_dwordx4 v[48:51], v3, s[20:23], s36 offen sc1
    s_add_u32 s35, s33, 16777216
    buffer_load_dwordx4 v[72:75], v1, s[8:11], s35 offen nt
    s_add_u32 s35, s33, 16777216
    buffer_load_dwordx4 v[76:79], v1, s[12:15], s35 offen nt
    s_cbranch_vccz L_p1_kernel_thr_3
    s_waitcnt vmcnt(2)
L_p1_kernel_thr_3:
    s_waitcnt lgkmcnt(9)
    v_lshlrev_b32 v83, 22, v108
    v_lshrrev_b32 v108, 16, v108
    v_alignbit_b32 v83, v108, v83, 10
    v_alignbit_b32 v83, v109, v83, 10
    v_xor_b32 v83, 0x80200800, v83
    s_mov_b32 s36, 3145728
    buffer_store_dwordx4 v[80:83], v3, s[20:23], s36 offen sc1
    s_waitcnt lgkmcnt(8)
    v_lshlrev_b32 v55, 22, v110
    v_lshrrev_b32 v110, 16, v110
    v_alignbit_b32 v55, v110, v55, 10
    v_alignbit_b32 v55, v111, v55, 10
    v_xor_b32 v55, 0x80200800, v55
    s_mov_b32 s36, 4194304
    buffer_store_dwordx4 v[52:55], v3, s[20:23], s36 offen sc1
    s_add_u32 s35, s33, 20971520
    buffer_load_dwordx4 v[80:83], v1, s[8:11], s35 offen nt
    s_add_u32 s35, s33, 20971520
    buffer_load_dwordx4 v[100:103], v1, s[12:15], s35 offen nt
    s_cbranch_vccz L_p1_kernel_thr_4
    s_waitcnt vmcnt(2)
L_p1_kernel_thr_4:
    s_waitcnt lgkmcnt(7)
    v_lshlrev_b32 v87, 22, v112
    v_lshrrev_b32 v112, 16, v112
    v_alignbit_b32 v87, v112, v87, 10
    v_alignbit_b32 v87, v113, v87, 10
    v_xor_b32 v87, 0x80200800, v87
    s_mov_b32 s36, 5242880
    buffer_store_dwordx4 v[84:87], v3, s[20:23], s36 offen sc1
    s_waitcnt lgkmcnt(6)
    v_lshlrev_b32 v59, 22, v114
    v_lshrrev_b32 v114, 16, v114
    v_alignbit_b32 v59, v114, v59, 10
    v_alignbit_b32 v59, v115, v59, 10
    v_xor_b32 v59, 0x80200800, v59
    s_mov_b32 s36, 6291456
    buffer_store_dwordx4 v[56:59], v3, s[20:23], s36 offen sc1
    s_add_u32 s35, s33, 25165824
    buffer_load_dwordx4 v[84:87], v1, s[8:11], s35 offen nt
    s_add_u32 s35, s33, 25165824
    buffer_load_dwordx4 v[104:107], v1, s[12:15], s35 offen nt
    s_cbranch_vccz L_p1_kernel_thr_5
    s_waitcnt vmcnt(2)
L_p1_kernel_thr_5:
    s_waitcnt lgkmcnt(5)
    v_lshlrev_b32 v91, 22, v116
    v_lshrrev_b32 v116, 16, v116
    v_alignbit_b32 v91, v116, v91, 10
    v_alignbit_b32 v91, v117, v91, 10
    v_xor_b32 v91, 0x80200800, v91
    s_mov_b32 s36, 7340032
    buffer_store_dwordx4 v[88:91], v3, s[20:23], s36 offen sc1
    s_waitcnt lgkmcnt(4)
    v_lshlrev_b32 v63, 22, v118
    v_lshrrev_b32 v118, 16, v118
    v_alignbit_b32 v63, v118, v63, 10
    v_alignbit_b32 v63, v119, v63, 10
    v_xor_b32 v63, 0x80200800, v63
    s_mov_b32 s36, 8388608
    buffer_store_dwordx4 v[60:63], v3, s[20:23], s36 offen sc1
    s_add_u32 s35, s33, 29360128
    buffer_load_dwordx4 v[88:91], v1, s[8:11], s35 offen nt
    s_add_u32 s35, s33, 29360128
    buffer_load_dwordx4 v[108:111], v1, s[12:15], s35 offen nt
    s_cbranch_vccz L_p1_kernel_thr_6
    s_waitcnt vmcnt(2)
L_p1_kernel_thr_6:
    s_waitcnt lgkmcnt(3)
    v_lshlrev_b32 v95, 22, v120
    v_lshrrev_b32 v120, 16, v120
    v_alignbit_b32 v95, v120, v95, 10
    v_alignbit_b32 v95, v121, v95, 10
    v_xor_b32 v95, 0x80200800, v95
    s_mov_b32 s36, 9437184
    buffer_store_dwordx4 v[92:95], v3, s[20:23], s36 offen sc1
    s_waitcnt lgkmcnt(2)
    v_lshlrev_b32 v67, 22, v122
    v_lshrrev_b32 v122, 16, v122
    v_alignbit_b32 v67, v122, v67, 10
    v_alignbit_b32 v67, v123, v67, 10
    v_xor_b32 v67, 0x80200800, v67
    s_mov_b32 s36, 10485760
    buffer_store_dwordx4 v[64:67], v3, s[20:23], s36 offen sc1
    s_add_u32 s35, s33, 33554432
    buffer_load_dwordx4 v[92:95], v1, s[8:11], s35 offen nt
    s_add_u32 s35, s33, 33554432
    buffer_load_dwordx4 v[112:115], v1, s[12:15], s35 offen nt
    s_cbranch_vccz L_p1_kernel_thr_7
    s_waitcnt vmcnt(2)
L_p1_kernel_thr_7:
    s_waitcnt lgkmcnt(1)
    v_lshlrev_b32 v99, 22, v124
    v_lshrrev_b32 v124, 16, v124
    v_alignbit_b32 v99, v124, v99, 10
    v_alignbit_b32 v99, v125, v99, 10
    v_xor_b32 v99, 0x80200800, v99
    s_mov_b32 s36, 11534336
    buffer_store_dwordx4 v[96:99], v3, s[20:23], s36 offen sc1
    s_waitcnt lgkmcnt(0)
    v_lshlrev_b32 v71, 22, v126
    v_lshrrev_b32 v126, 16, v126
    v_alignbit_b32 v71, v126, v71, 10
    v_alignbit_b32 v71, v127, v71, 10
    v_xor_b32 v71, 0x80200800, v71
    s_mov_b32 s36, 12582912
    buffer_store_dwordx4 v[68:71], v3, s[20:23], s36 offen sc1
    s_add_u32 s35, s33, 37748736
    s_sub_u32 s35, s35, s48
    v_cndmask_b32 v96, 2.0, v1, s[44:45]
    buffer_load_dwordx4 v[96:99], v96, s[8:11], s35 offen nt
    s_add_u32 s35, s33, 37748736
    s_sub_u32 s35, s35, s48
    v_cndmask_b32 v116, 2.0, v1, s[44:45]
    buffer_load_dwordx4 v[116:119], v116, s[12:15], s35 offen nt
    s_cbranch_vccz L_p1_kernel_thr_8
    s_waitcnt vmcnt(2)
L_p1_kernel_thr_8:
    s_branch L_p1_join
L_p1_first:
    s_add_u32 s35, s33, 16777216
    buffer_load_dwordx4 v[72:75], v1, s[8:11], s35 offen nt
    s_add_u32 s35, s33, 16777216
    buffer_load_dwordx4 v[76:79], v1, s[12:15], s35 offen nt
    s_add_u32 s35, s33, 20971520
    buffer_load_dwordx4 v[80:83], v1, s[8:11], s35 offen nt
    s_add_u32 s35, s33, 20971520
    buffer_load_dwordx4 v[100:103], v1, s[12:15], s35 offen nt
    s_add_u32 s35, s33, 25165824
    buffer_load_dwordx4 v[84:87], v1, s[8:11], s35 offen nt
    s_add_u32 s35, s33, 25165824
    buffer_load_dwordx4 v[104:107], v1, s[12:15], s35 offen nt
    s_add_u32 s35, s33, 29360128
    buffer_load_dwordx4 v[88:91], v1, s[8:11], s35 offen nt
    s_add_u32 s35, s33, 29360128
    buffer_load_dwordx4 v[108:111], v1, s[12:15], s35 offen nt
    s_add_u32 s35, s33, 33554432
    buffer_load_dwordx4 v[92:95], v1, s[8:11], s35 offen nt
    s_add_u32 s35, s33, 33554432
    buffer_load_dwordx4 v[112:115], v1, s[12:15], s35 offen nt
    s_add_u32 s35, s33, 37748736
    s_sub_u32 s35, s35, s48
    v_cndmask_b32 v96, 2.0, v1, s[44:45]
    buffer_load_dwordx4 v[96:99], v96, s[8:11], s35 offen nt
    s_add_u32 s35, s33, 37748736
    s_sub_u32 s35, s35, s48
    v_cndmask_b32 v116, 2.0, v1, s[44:45]
    buffer_load_dwordx4 v[116:119], v116, s[12:15], s35 offen nt
L_p1_join:
    s_waitcnt vmcnt(18)
    v_perm_b32 v6, v20, v16, s43
    v_perm_b32 v7, v21, v17, s43
    v_perm_b32 v8, v22, v18, s43
    v_perm_b32 v9, v23, v19, s43
    v_mul_hi_u32_u24 v16, 429497, v16
    v_mul_hi_u32_u24 v20, 429497, v20
    v_mul_hi_u32_u24 v17, 429497, v17
    v_mul_hi_u32_u24 v21, 429497, v21
    v_mul_hi_u32_u24 v18, 429497, v18
    v_mul_hi_u32_u24 v22, 429497, v22
    v_mul_hi_u32_u24 v19, 429497, v19
    v_mul_hi_u32_u24 v23, 429497, v23
    v_lshl_or_b32 v16, v20, 16, v16
    v_lshl_or_b32 v17, v21, 16, v17
    v_lshl_or_b32 v18, v22, 16, v18
    v_lshl_or_b32 v19, v23, 16, v19
    v_dot2_u32_u16 v20, v16, s38, 0
    v_dot2_u32_u16 v21, v17, s38, 0
    v_dot2_u32_u16 v22, v18, s38, 0
    v_dot2_u32_u16 v23, v19, s38, 0
    v_pk_mad_u16 v6, v16, s37, v6
    v_pk_mad_u16 v7, v17, s37, v7
    v_pk_mad_u16 v8, v18, s37, v8
    v_pk_mad_u16 v9, v19, s37, v9
    ds_add_u32 v20, v4 offset:0
    ds_add_u32 v21, v4 offset:0
    ds_add_u32 v22, v4 offset:0
    ds_add_u32 v23, v4 offset:0
    v_perm_b32 v55, v23, v22, s43
    v_perm_b32 v51, v21, v20, s43
    v_or_b32 v48, 0x40000000, v6
    v_or_b32 v49, 0x40000000, v7
    v_or_b32 v50, 0x40000000, v8
    v_or_b32 v52, 0x40000000, v9
    s_waitcnt vmcnt(16)
    v_perm_b32 v6, v28, v24, s43
    v_perm_b32 v7, v29, v25, s43
    v_perm_b32 v8, v30, v26, s43
    v_perm_b32 v9, v31, v27, s43
    v_mul_hi_u32_u24 v24, 429497, v24
    v_mul_hi_u32_u24 v28, 429497, v28
    v_mul_hi_u32_u24 v25, 429497, v25
    v_mul_hi_u32_u24 v29, 429497, v29
    v_mul_hi_u32_u24 v26, 429497, v26
    v_mul_hi_u32_u24 v30, 429497, v30
    v_mul_hi_u32_u24 v27, 429497, v27
    v_mul_hi_u32_u24 v31, 429497, v31
    v_lshl_or_b32 v24, v28, 16, v24
    v_lshl_or_b32 v25, v29, 16, v25
    v_lshl_or_b32 v26, v30, 16, v26
    v_lshl_or_b32 v27, v31, 16, v27
    v_dot2_u32_u16 v28, v24, s38, 0
    v_dot2_u32_u16 v29, v25, s38, 0
    v_dot2_u32_u16 v30, v26, s38, 0
    v_dot2_u32_u16 v31, v27, s38, 0
    v_pk_mad_u16 v6, v24, s37, v6
    v_pk_mad_u16 v7, v25, s37, v7
    v_pk_mad_u16 v8, v26, s37, v8
    v_pk_mad_u16 v9, v27, s37, v9
    ds_add_u32 v28, v4 offset:0
    ds_add_u32 v29, v4 offset:0
    ds_add_u32 v30, v4 offset:0
    ds_add_u32 v31, v4 offset:0
    v_perm_b32 v63, v31, v30, s43
    v_perm_b32 v59, v29, v28, s43
    v_or_b32 v53, 0x40000000, v6
    v_or_b32 v54, 0x40000000, v7
    v_or_b32 v56, 0x40000000, v8
    v_or_b32 v57, 0x40000000, v9
    s_waitcnt vmcnt(14)
    v_perm_b32 v6, v36, v32, s43
    v_perm_b32 v7, v37, v33, s43
    v_perm_b32 v8, v38, v34, s43
    v_perm_b32 v9, v39, v35, s43
    v_mul_hi_u32_u24 v32, 429497, v32
    v_mul_hi_u32_u24 v36, 429497, v36
    v_mul_hi_u32_u24 v33, 429497, v33
    v_mul_hi_u32_u24 v37, 429497, v37
    v_mul_hi_u32_u24 v34, 429497, v34
    v_mul_hi_u32_u24 v38, 429497, v38
    v_mul_hi_u32_u24 v35, 429497, v35
    v_mul_hi_u32_u24 v39, 429497, v39
    v_lshl_or_b32 v32, v36, 16, v32
    v_lshl_or_b32 v33, v37, 16, v33
    v_lshl_or_b32 v34, v38, 16, v34
    v_lshl_or_b32 v35, v39, 16, v35
    v_dot2_u32_u16 v36, v32, s38, 0
    v_dot2_u32_u16 v37, v33, s38, 0
    v_dot2_u32_u16 v38, v34, s38, 0
    v_dot2_u32_u16 v39, v35, s38, 0
    v_pk_mad_u16 v6, v32, s37, v6
    v_pk_mad_u16 v7, v33, s37, v7
    v_pk_mad_u16 v8, v34, s37, v8
    v_pk_mad_u16 v9, v35, s37, v9
    ds_add_u32 v36, v4 offset:0
    ds_add_u32 v37, v4 offset:0
    ds_add_u32 v38, v4 offset:0
    ds_add_u32 v39, v4 offset:0
    v_perm_b32 v71, v39, v38, s43
    v_perm_b32 v67, v37, v36, s43
    v_or_b32 v58, 0x40000000, v6
    v_or_b32 v60, 0x40000000, v7
    v_or_b32 v61, 0x40000000, v8
    v_or_b32 v62, 0x40000000, v9
    s_waitcnt vmcnt(12)
    v_perm_b32 v6, v44, v40, s43
    v_perm_b32 v7, v45, v41, s43
    v_perm_b32 v8, v46, v42, s43
    v_perm_b32 v9, v47, v43, s43
    v_mul_hi_u32_u24 v40, 429497, v40
    v_mul_hi_u32_u24 v44, 429497, v44
    v_mul_hi_u32_u24 v41, 429497, v41
    v_mul_hi_u32_u24 v45, 429497, v45
    v_mul_hi_u32_u24 v42, 429497, v42
    v_mul_hi_u32_u24 v46, 429497, v46
    v_mul_hi_u32_u24 v43, 429497, v43
    v_mul_hi_u32_u24 v47, 429497, v47
    v_lshl_or_b32 v40, v44, 16, v40
    v_lshl_or_b32 v41, v45, 16, v41
    v_lshl_or_b32 v42, v46, 16, v42
    v_lshl_or_b32 v43, v47, 16, v43
    v_dot2_u32_u16 v44, v40, s38, 0
    v_dot2_u32_u16 v45, v41, s38, 0
    v_dot2_u32_u16 v46, v42, s38, 0
    v_dot2_u32_u16 v47, v43, s38, 0
    v_pk_mad_u16 v6, v40, s37, v6
    v_pk_mad_u16 v7, v41, s37, v7
    v_pk_mad_u16 v8, v42, s37, v8
    v_pk_mad_u16 v9, v43, s37, v9
    ds_add_u32 v44, v4 offset:0
    ds_add_u32 v45, v4 offset:0
    ds_add_u32 v46, v4 offset:0
    ds_add_u32 v47, v4 offset:0
    v_perm_b32 v121, v47, v46, s43
    v_perm_b32 v120, v45, v44, s43
    v_or_b32 v64, 0x40000000, v6
    v_or_b32 v65, 0x40000000, v7
    v_or_b32 v66, 0x40000000, v8
    v_or_b32 v68, 0x40000000, v9
    s_waitcnt vmcnt(10)
    v_perm_b32 v6, v76, v72, s43
    v_perm_b32 v7, v77, v73, s43
    v_perm_b32 v8, v78, v74, s43
    v_perm_b32 v9, v79, v75, s43
    v_mul_hi_u32_u24 v72, 429497, v72
    v_mul_hi_u32_u24 v76, 429497, v76
    v_mul_hi_u32_u24 v73, 429497, v73
    v_mul_hi_u32_u24 v77, 429497, v77
    v_mul_hi_u32_u24 v74, 429497, v74
    v_mul_hi_u32_u24 v78, 429497, v78
    v_mul_hi_u32_u24 v75, 429497, v75
    v_mul_hi_u32_u24 v79, 429497, v79
    v_lshl_or_b32 v72, v76, 16, v72
    v_lshl_or_b32 v73, v77, 16, v73
    v_lshl_or_b32 v74, v78, 16, v74
    v_lshl_or_b32 v75, v79, 16, v75
    v_dot2_u32_u16 v76, v72, s38, 0
    v_dot2_u32_u16 v77, v73, s38, 0
    v_dot2_u32_u16 v78, v74, s38, 0
    v_dot2_u32_u16 v79, v75, s38, 0
    v_pk_mad_u16 v6, v72, s37, v6
    v_pk_mad_u16 v7, v73, s37, v7
    v_pk_mad_u16 v8, v74, s37, v8
    v_pk_mad_u16 v9, v75, s37, v9
    ds_add_u32 v76, v4 offset:0
    ds_add_u32 v77, v4 offset:0
    ds_add_u32 v78, v4 offset:0
    ds_add_u32 v79, v4 offset:0
    v_perm_b32 v123, v79, v78, s43
    v_perm_b32 v122, v77, v76, s43
    v_or_b32 v69, 0x40000000, v6
    v_or_b32 v70, 0x40000000, v7
    v_or_b32 v127, 0x40000000, v8
    v_or_b32 v72, 0x40000000, v9
    s_waitcnt vmcnt(8)
    v_perm_b32 v6, v100, v80, s43
    v_perm_b32 v7, v101, v81, s43
    v_perm_b32 v8, v102, v82, s43
    v_perm_b32 v9, v103, v83, s43
    v_mul_hi_u32_u24 v80, 429497, v80
    v_mul_hi_u32_u24 v100, 429497, v100
    v_mul_hi_u32_u24 v81, 429497, v81
    v_mul_hi_u32_u24 v101, 429497, v101
    v_mul_hi_u32_u24 v82, 429497, v82
    v_mul_hi_u32_u24 v102, 429497, v102
    v_mul_hi_u32_u24 v83, 429497, v83
    v_mul_hi_u32_u24 v103, 429497, v103
    v_lshl_or_b32 v80, v100, 16, v80
    v_lshl_or_b32 v81, v101, 16, v81
    v_lshl_or_b32 v82, v102, 16, v82
    v_lshl_or_b32 v83, v103, 16, v83
    v_dot2_u32_u16 v100, v80, s38, 0
    v_dot2_u32_u16 v101, v81, s38, 0
    v_dot2_u32_u16 v102, v82, s38, 0
    v_dot2_u32_u16 v103, v83, s38, 0
    v_pk_mad_u16 v6, v80, s37, v6
    v_pk_mad_u16 v7, v81, s37, v7
    v_pk_mad_u16 v8, v82, s37, v8
    v_pk_mad_u16 v9, v83, s37, v9
    ds_add_u32 v100, v4 offset:0
    ds_add_u32 v101, v4 offset:0
    ds_add_u32 v102, v4 offset:0
    ds_add_u32 v103, v4 offset:0
    v_perm_b32 v125, v103, v102, s43
    v_perm_b32 v124, v101, v100, s43
    v_or_b32 v73, 0x40000000, v6
    v_or_b32 v74, 0x40000000, v7
    v_or_b32 v76, 0x40000000, v8
    v_or_b32 v77, 0x40000000, v9
    s_waitcnt vmcnt(6)
    v_perm_b32 v6, v104, v84, s43
    v_perm_b32 v7, v105, v85, s43
    v_perm_b32 v8, v106, v86, s43
    v_perm_b32 v9, v107, v87, s43
    v_mul_hi_u32_u24 v84, 429497, v84
    v_mul_hi_u32_u24 v104, 429497, v104
    v_mul_hi_u32_u24 v85, 429497, v85
    v_mul_hi_u32_u24 v105, 429497, v105
    v_mul_hi_u32_u24 v86, 429497, v86
    v_mul_hi_u32_u24 v106, 429497, v106
    v_mul_hi_u32_u24 v87, 429497, v87
    v_mul_hi_u32_u24 v107, 429497, v107
    v_lshl_or_b32 v84, v104, 16, v84
    v_lshl_or_b32 v85, v105, 16, v85
    v_lshl_or_b32 v86, v106, 16, v86
    v_lshl_or_b32 v87, v107, 16, v87
    v_dot2_u32_u16 v104, v84, s38, 0
    v_dot2_u32_u16 v105, v85, s38, 0
    v_dot2_u32_u16 v106, v86, s38, 0
    v_dot2_u32_u16 v107, v87, s38, 0
    v_pk_mad_u16 v6, v84, s37, v6
    v_pk_mad_u16 v7, v85, s37, v7
    v_pk_mad_u16 v8, v86, s37, v8
    v_pk_mad_u16 v9, v87, s37, v9
    ds_add_u32 v104, v4 offset:0
    ds_add_u32 v105, v4 offset:0
    ds_add_u32 v106, v4 offset:0
    ds_add_u32 v107, v4 offset:0
    v_perm_b32 v75, v107, v106, s43
    v_perm_b32 v126, v105, v104, s43
    v_or_b32 v78, 0x40000000, v6
    v_or_b32 v80, 0x40000000, v7
    v_or_b32 v81, 0x40000000, v8
    v_or_b32 v82, 0x40000000, v9
    s_waitcnt vmcnt(4)
    v_perm_b32 v6, v108, v88, s43
    v_perm_b32 v7, v109, v89, s43
    v_perm_b32 v8, v110, v90, s43
    v_perm_b32 v9, v111, v91, s43
    v_mul_hi_u32_u24 v88, 429497, v88
    v_mul_hi_u32_u24 v108, 429497, v108
    v_mul_hi_u32_u24 v89, 429497, v89
    v_mul_hi_u32_u24 v109, 429497, v109
    v_mul_hi_u32_u24 v90, 429497, v90
    v_mul_hi_u32_u24 v110, 429497, v110
    v_mul_hi_u32_u24 v91, 429497, v91
    v_mul_hi_u32_u24 v111, 429497, v111
    v_lshl_or_b32 v88, v108, 16, v88
    v_lshl_or_b32 v89, v109, 16, v89
    v_lshl_or_b32 v90, v110, 16, v90
    v_lshl_or_b32 v91, v111, 16, v91
    v_dot2_u32_u16 v108, v88, s38, 0
    v_dot2_u32_u16 v109, v89, s38, 0
    v_dot2_u32_u16 v110, v90, s38, 0
    v_dot2_u32_u16 v111, v91, s38, 0
    v_pk_mad_u16 v6, v88, s37, v6
    v_pk_mad_u16 v7, v89, s37, v7
    v_pk_mad_u16 v8, v90, s37, v8
    v_pk_mad_u16 v9, v91, s37, v9
    ds_add_u32 v108, v4 offset:0
    ds_add_u32 v109, v4 offset:0
    ds_add_u32 v110, v4 offset:0
    ds_add_u32 v111, v4 offset:0
    v_perm_b32 v83, v111, v110, s43
    v_perm_b32 v79, v109, v108, s43
    v_or_b32 v84, 0x40000000, v6
    v_or_b32 v85, 0x40000000, v7
    v_or_b32 v86, 0x40000000, v8
    v_or_b32 v88, 0x40000000, v9
    s_waitcnt vmcnt(2)
    v_perm_b32 v6, v112, v92, s43
    v_perm_b32 v7, v113, v93, s43
    v_perm_b32 v8, v114, v94, s43
    v_perm_b32 v9, v115, v95, s43
    v_mul_hi_u32_u24 v92, 429497, v92
    v_mul_hi_u32_u24 v112, 429497, v112
    v_mul_hi_u32_u24 v93, 429497, v93
    v_mul_hi_u32_u24 v113, 429497, v113
    v_mul_hi_u32_u24 v94, 429497, v94
    v_mul_hi_u32_u24 v114, 429497, v114
    v_mul_hi_u32_u24 v95, 429497, v95
    v_mul_hi_u32_u24 v115, 429497, v115
    v_lshl_or_b32 v92, v112, 16, v92
    v_lshl_or_b32 v93, v113, 16, v93
    v_lshl_or_b32 v94, v114, 16, v94
    v_lshl_or_b32 v95, v115, 16, v95
    v_dot2_u32_u16 v112, v92, s38, 0
    v_dot2_u32_u16 v113, v93, s38, 0
    v_dot2_u32_u16 v114, v94, s38, 0
    v_dot2_u32_u16 v115, v95, s38, 0
    v_pk_mad_u16 v6, v92, s37, v6
    v_pk_mad_u16 v7, v93, s37, v7
    v_pk_mad_u16 v8, v94, s37, v8
    v_pk_mad_u16 v9, v95, s37, v9
    ds_add_u32 v112, v4 offset:0
    ds_add_u32 v113, v4 offset:0
    ds_add_u32 v114, v4 offset:0
    ds_add_u32 v115, v4 offset:0
    v_perm_b32 v91, v115, v114, s43
    v_perm_b32 v87, v113, v112, s43
    v_or_b32 v89, 0x40000000, v6
    v_or_b32 v90, 0x40000000, v7
    v_or_b32 v92, 0x40000000, v8
    v_or_b32 v93, 0x40000000, v9
    s_waitcnt vmcnt(0)
    s_mov_b64 exec, s[44:45]
    v_perm_b32 v6, v116, v96, s43
    v_perm_b32 v7, v117, v97, s43
    v_perm_b32 v8, v118, v98, s43
    v_perm_b32 v9, v119, v99, s43
    v_mul_hi_u32_u24 v96, 429497, v96
    v_mul_hi_u32_u24 v116, 429497, v116
    v_mul_hi_u32_u24 v97, 429497, v97
    v_mul_hi_u32_u24 v117, 429497, v117
    v_mul_hi_u32_u24 v98, 429497, v98
    v_mul_hi_u32_u24 v118, 429497, v118
    v_mul_hi_u32_u24 v99, 429497, v99
    v_mul_hi_u32_u24 v119, 429497, v119
    v_lshl_or_b32 v96, v116, 16, v96
    v_lshl_or_b32 v97, v117, 16, v97
    v_lshl_or_b32 v98, v118, 16, v98
    v_lshl_or_b32 v99, v119, 16, v99
    v_dot2_u32_u16 v116, v96, s38, 0
    v_dot2_u32_u16 v117, v97, s38, 0
    v_dot2_u32_u16 v118, v98, s38, 0
    v_dot2_u32_u16 v119, v99, s38, 0
    v_pk_mad_u16 v6, v96, s37, v6
    v_pk_mad_u16 v7, v97, s37, v7
    v_pk_mad_u16 v8, v98, s37, v8
    v_pk_mad_u16 v9, v99, s37, v9
    ds_add_u32 v116, v4 offset:0
    ds_add_u32 v117, v4 offset:0
    ds_add_u32 v118, v4 offset:0
    ds_add_u32 v119, v4 offset:0
    v_perm_b32 v99, v119, v118, s43
    v_perm_b32 v95, v117, v116, s43
    v_or_b32 v94, 0x40000000, v6
    v_or_b32 v96, 0x40000000, v7
    v_or_b32 v97, 0x40000000, v8
    v_or_b32 v98, 0x40000000, v9
    s_mov_b64 exec, -1
    s_add_u32 s35, s34, 0
    buffer_load_dwordx2 v[100:101], v2, s[16:19], s35 offen nt
    s_lshl_b32 s42, s32, 5
    s_lshl_b32 s35, s32, 10
    s_add_u32 s35, s35, 14680064
    s_add_u32 s20, s4, s35
    s_addc_u32 s21, s5, 0
    s_waitcnt lgkmcnt(0)
    s_barrier
    ds_read_b128 v[8:11], v1 offset:0
    s_add_u32 s35, s34, 2097152
    buffer_load_dwordx2 v[102:103], v2, s[16:19], s35 offen nt
    s_lshl_b32 s35, s39, 2
    s_add_u32 s35, s35, 160256
    v_mov_b32 v7, s35
    v_and_b32 v14, 15, v0
    v_lshlrev_b32 v14, 2, v14
    v_add_u32 v14, 160256, v14
    s_waitcnt lgkmcnt(0)
    v_cmp_eq_u32 s[56:57], 0, v8
    v_cmp_ge_u32 s[64:65], 1, v8
    v_max_u32 v12, 2, v8
    v_lshl_or_b32 v8, v8, 16, v12
    v_cmp_eq_u32 s[58:59], 0, v9
    v_cmp_ge_u32 s[66:67], 1, v9
    v_max_u32 v12, 2, v9
    v_lshl_or_b32 v9, v9, 16, v12
    v_cmp_eq_u32 s[60:61], 0, v10
    v_cmp_ge_u32 s[68:69], 1, v10
    v_max_u32 v12, 2, v10
    v_lshl_or_b32 v10, v10, 16, v12
    v_cmp_eq_u32 s[62:63], 0, v11
    v_cmp_ge_u32 s[70:71], 1, v11
    v_max_u32 v12, 2, v11
    v_lshl_or_b32 v11, v11, 16, v12
    v_add_u32 v9, v8, v9
    v_add_u32 v10, v9, v10
    v_add_u32 v11, v10, v11
    v_mov_b32 v6, v11
    s_nop 1
    v_add_u32_dpp v6, v6, v6 row_shr:1 row_mask:0xf bank_mask:0xf bound_ctrl:0
    s_nop 1
    v_add_u32_dpp v6, v6, v6 row_shr:2 row_mask:0xf bank_mask:0xf bound_ctrl:0
    s_nop 1
    v_add_u32_dpp v6, v6, v6 row_shr:4 row_mask:0xf bank_mask:0xf bound_ctrl:0
    s_nop 1
    v_add_u32_dpp v6, v6, v6 row_shr:8 row_mask:0xf bank_mask:0xf bound_ctrl:0
    s_nop 1
    v_add_u32_dpp v6, v6, v6 row_bcast:15 row_mask:0xa bank_mask:0xf
    s_nop 1
    v_add_u32_dpp v6, v6, v6 row_bcast:31 row_mask:0xc bank_mask:0xf
    s_mov_b32 exec_lo, 0
    s_brev_b32 exec_hi, 1
    ds_write_b32 v7, v6
    s_mov_b64 exec, -1
    v_sub_u32 v6, v6, v11
    s_or_b64 s[46:47], s[64:65], s[66:67]
    s_or_b64 vcc, s[68:69], s[70:71]
    s_or_b64 s[46:47], s[46:47], vcc
    s_waitcnt lgkmcnt(0)
    s_barrier
    ds_read_b32 v7, v14
    s_add_u32 s35, s34, 4194304
    buffer_load_dwordx2 v[104:105], v2, s[16:19], s35 offen nt
    s_waitcnt lgkmcnt(0)
    v_mov_b32 v15, v7
    s_nop 1
    v_add_u32_dpp v7, v7, v7 row_shr:1 row_mask:0xf bank_mask:0xf bound_ctrl:0
    s_nop 1
    v_add_u32_dpp v7, v7, v7 row_shr:2 row_mask:0xf bank_mask:0xf bound_ctrl:0
    s_nop 1
    v_add_u32_dpp v7, v7, v7 row_shr:4 row_mask:0xf bank_mask:0xf bound_ctrl:0
    s_nop 1
    v_add_u32_dpp v7, v7, v7 row_shr:8 row_mask:0xf bank_mask:0xf bound_ctrl:0
    s_nop 0
    v_readlane_b32 s54, v7, 15
    v_sub_u32 v7, v7, v15
    s_nop 0
    v_readlane_b32 s35, v7, s39
    s_and_b32 s54, s54, 0xffff
    s_cmp_ge_u32 s54, 40063
    s_cselect_b32 s36, 16, 0
    s_cselect_b32 s54, 40000, s54
    s_cselect_b32 s55, 1, s55
    s_cselect_b64 s[46:47], 0, s[46:47]
    v_add_u32 v12, s35, v6
    v_add_u32 v13, v12, v8
    v_add_u32 v14, v12, v9
    v_add_u32 v15, v12, v10
    v_bfe_u32 v12, v12, s36, 16
    v_bfe_u32 v13, v13, s36, 16
    v_bfe_u32 v14, v14, s36, 16
    v_bfe_u32 v15, v15, s36, 16
    ds_write_b128 v1, v[12:15] offset:0
    ds_write_b128 v1, v[12:15] offset:16384
    v_mov_b32 v6, 32768
    v_mov_b32 v7, s54
    s_mov_b64 exec, 1
    ds_write_b32 v6, v7
    s_mov_b64 exec, -1
    s_add_u32 s35, s54, 2
    s_mul_hi_u32 s35, s35, 1431655766
    s_lshl_b32 s35, s35, 4
    s_add_u32 s35, s35, 217890816
    s_min_u32 s22, s35, 218104832
    v_perm_b32 v15, v15, v14, s43
    v_perm_b32 v14, v13, v12, s43
    s_waitcnt lgkmcnt(0)
    s_barrier
    v_and_b32 v6, 63, v0
    s_lshl_b32 s35, s39, 10
    v_lshl_add_u32 v7, v6, 2, s35
    v_lshl_add_u32 v12, v6, 8, s35
    ds_read_b32 v8, v7 offset:16384
    ds_read_b32 v9, v7 offset:16640
    ds_read_b32 v10, v7 offset:16896
    ds_read_b32 v11, v7 offset:17152
    s_mov_b64 exec, 15
    ds_read_b32 v12, v12 offset:16640
    s_mov_b64 exec, -1
    s_lshr_b32 s35, s39, 2
    s_mul_i32 s35, s35, 2138240
    s_and_b32 s36, s39, 1
    s_lshl_b32 s36, s36, 3
    s_add_u32 s35, s35, s36
    s_and_b32 s36, s39, 2
    s_lshl_b32 s36, s36, 3
    s_add_u32 s35, s35, s36
    s_add_u32 s35, s35, s42
    s_add_u32 s36, s35, 2105344
    v_mul_u32_u24 v7, 32896, v6
    v_lshlrev_b32 v13, 1, v6
    s_waitcnt lgkmcnt(1)
    v_perm_b32 v8, v9, v8, s43
    v_perm_b32 v9, v11, v10, s43
    buffer_store_dwordx2 v[8:9], v7, s[24:27], s35 offen
    s_waitcnt lgkmcnt(0)
    s_mov_b64 exec, 15
    buffer_store_short v12, v13, s[24:27], s36 offen
    s_mov_b64 exec, -1
    s_nop 0
    v_and_b32 v6, 0xffff, v51
    v_lshrrev_b32 v7, 16, v51
    v_and_b32 v8, 0xffff, v55
    v_lshrrev_b32 v9, 16, v55
    ds_add_rtn_u32 v6, v6, v4 offset:0
    ds_add_rtn_u32 v7, v7, v4 offset:0
    ds_add_rtn_u32 v8, v8, v4 offset:0
    ds_add_rtn_u32 v9, v9, v4 offset:0
    v_and_b32 v10, 0xffff, v59
    v_lshrrev_b32 v11, 16, v59
    v_and_b32 v12, 0xffff, v63
    v_lshrrev_b32 v13, 16, v63
    ds_add_rtn_u32 v10, v10, v4 offset:0
    ds_add_rtn_u32 v11, v11, v4 offset:0
    ds_add_rtn_u32 v12, v12, v4 offset:0
    ds_add_rtn_u32 v13, v13, v4 offset:0
    s_waitcnt lgkmcnt(4)
    v_perm_b32 v51, v7, v6, s43
    v_perm_b32 v55, v9, v8, s43
    v_and_b32 v6, 0xffff, v67
    v_lshrrev_b32 v7, 16, v67
    v_and_b32 v8, 0xffff, v71
    v_lshrrev_b32 v9, 16, v71
    ds_add_rtn_u32 v6, v6, v4 offset:0
    ds_add_rtn_u32 v7, v7, v4 offset:0
    ds_add_rtn_u32 v8, v8, v4 offset:0
    ds_add_rtn_u32 v9, v9, v4 offset:0
    s_waitcnt lgkmcnt(4)
    v_perm_b32 v59, v11, v10, s43
    v_perm_b32 v63, v13, v12, s43
    s_add_u32 s35, s34, 6291456
    buffer_load_dwordx2 v[106:107], v2, s[16:19], s35 offen nt
    v_and_b32 v10, 0xffff, v120
    v_lshrrev_b32 v11, 16, v120
    v_and_b32 v12, 0xffff, v121
    v_lshrrev_b32 v13, 16, v121
    ds_add_rtn_u32 v10, v10, v4 offset:0
    ds_add_rtn_u32 v11, v11, v4 offset:0
    ds_add_rtn_u32 v12, v12, v4 offset:0
    ds_add_rtn_u32 v13, v13, v4 offset:0
    s_waitcnt lgkmcnt(4)
    v_perm_b32 v67, v7, v6, s43
    v_perm_b32 v71, v9, v8, s43
    s_add_u32 s35, s34, 8388608
    buffer_load_dwordx2 v[108:109], v2, s[16:19], s35 offen nt
    v_and_b32 v6, 0xffff, v122
    v_lshrrev_b32 v7, 16, v122
    v_and_b32 v8, 0xffff, v123
    v_lshrrev_b32 v9, 16, v123
    ds_add_rtn_u32 v6, v6, v4 offset:0
    ds_add_rtn_u32 v7, v7, v4 offset:0
    ds_add_rtn_u32 v8, v8, v4 offset:0
    ds_add_rtn_u32 v9, v9, v4 offset:0
    s_waitcnt lgkmcnt(4)
    v_perm_b32 v120, v11, v10, s43
    v_perm_b32 v121, v13, v12, s43
    s_add_u32 s35, s34, 10485760
    buffer_load_dwordx2 v[110:111], v2, s[16:19], s35 offen nt
    v_and_b32 v10, 0xffff, v124
    v_lshrrev_b32 v11, 16, v124
    v_and_b32 v12, 0xffff, v125
    v_lshrrev_b32 v13, 16, v125
    ds_add_rtn_u32 v10, v10, v4 offset:0
    ds_add_rtn_u32 v11, v11, v4 offset:0
    ds_add_rtn_u32 v12, v12, v4 offset:0
    ds_add_rtn_u32 v13, v13, v4 offset:0
    s_waitcnt lgkmcnt(4)
    v_perm_b32 v122, v7, v6, s43
    v_perm_b32 v123, v9, v8, s43
    v_and_b32 v6, 0xffff, v126
    v_lshrrev_b32 v7, 16, v126
    v_and_b32 v8, 0xffff, v75
    v_lshrrev_b32 v9, 16, v75
    ds_add_rtn_u32 v6, v6, v4 offset:0
    ds_add_rtn_u32 v7, v7, v4 offset:0
    ds_add_rtn_u32 v8, v8, v4 offset:0
    ds_add_rtn_u32 v9, v9, v4 offset:0
    s_waitcnt lgkmcnt(4)
    v_perm_b32 v124, v11, v10, s43
    v_perm_b32 v125, v13, v12, s43
    s_add_u32 s35, s34, 12582912
    buffer_load_dwordx2 v[112:113], v2, s[16:19], s35 offen nt
    v_and_b32 v10, 0xffff, v79
    v_lshrrev_b32 v11, 16, v79
    v_and_b32 v12, 0xffff, v83
    v_lshrrev_b32 v13, 16, v83
    ds_add_rtn_u32 v10, v10, v4 offset:0
    ds_add_rtn_u32 v11, v11, v4 offset:0
    ds_add_rtn_u32 v12, v12, v4 offset:0
    ds_add_rtn_u32 v13, v13, v4 offset:0
    s_waitcnt lgkmcnt(4)
    v_perm_b32 v126, v7, v6, s43
    v_perm_b32 v75, v9, v8, s43
    s_add_u32 s35, s34, 14680064
    buffer_load_dwordx2 v[114:115], v2, s[16:19], s35 offen nt
    v_and_b32 v6, 0xffff, v87
    v_lshrrev_b32 v7, 16, v87
    v_and_b32 v8, 0xffff, v91
    v_lshrrev_b32 v9, 16, v91
    ds_add_rtn_u32 v6, v6, v4 offset:0
    ds_add_rtn_u32 v7, v7, v4 offset:0
    ds_add_rtn_u32 v8, v8, v4 offset:0
    ds_add_rtn_u32 v9, v9, v4 offset:0
    s_waitcnt lgkmcnt(4)
    v_perm_b32 v79, v11, v10, s43
    v_perm_b32 v83, v13, v12, s43
    s_add_u32 s35, s34, 16777216
    buffer_load_dwordx2 v[116:117], v2, s[16:19], s35 offen nt
    s_mov_b64 exec, s[44:45]
    v_and_b32 v10, 0xffff, v95
    v_lshrrev_b32 v11, 16, v95
    v_and_b32 v12, 0xffff, v99
    v_lshrrev_b32 v13, 16, v99
    ds_add_rtn_u32 v10, v10, v4 offset:0
    ds_add_rtn_u32 v11, v11, v4 offset:0
    ds_add_rtn_u32 v12, v12, v4 offset:0
    ds_add_rtn_u32 v13, v13, v4 offset:0
    s_mov_b64 exec, -1
    s_waitcnt lgkmcnt(4)
    v_perm_b32 v87, v7, v6, s43
    v_perm_b32 v91, v9, v8, s43
    s_add_u32 s35, s34, 18874368
    s_sub_u32 s35, s35, s49
    v_cndmask_b32 v118, 2.0, v2, s[44:45]
    buffer_load_dwordx2 v[118:119], v118, s[16:19], s35 offen nt
    s_waitcnt lgkmcnt(0)
    v_perm_b32 v95, v11, v10, s43
    v_perm_b32 v99, v13, v12, s43
    s_barrier
    s_lshl_b32 s35, s54, 2
    v_mov_b32 v6, s35
    v_mov_b32 v7, 0
    v_mov_b32 v12, 1140817920
    s_mov_b64 exec, 1
    ds_write2_b32 v6, v7, v7 offset0:0 offset1:1
    s_cmp_eq_u64 s[46:47], 0
    s_cbranch_scc1 L_p1_kernel_nonull_9
    s_mov_b64 exec, s[64:65]
    v_lshlrev_b32_sdwa v6, 2, v14 dst_sel:DWORD dst_unused:UNUSED_PAD src0_sel:DWORD src1_sel:WORD_0
    ds_write_b32 v6, v7 offset:4
    s_mov_b64 exec, s[56:57]
    ds_write_b32 v6, v7
    s_mov_b64 exec, s[66:67]
    v_lshlrev_b32_sdwa v6, 2, v14 dst_sel:DWORD dst_unused:UNUSED_PAD src0_sel:DWORD src1_sel:WORD_1
    ds_write_b32 v6, v7 offset:4
    s_mov_b64 exec, s[58:59]
    ds_write_b32 v6, v7
    s_mov_b64 exec, s[68:69]
    v_lshlrev_b32_sdwa v6, 2, v15 dst_sel:DWORD dst_unused:UNUSED_PAD src0_sel:DWORD src1_sel:WORD_0
    ds_write_b32 v6, v7 offset:4
    s_mov_b64 exec, s[60:61]
    ds_write_b32 v6, v7
    s_mov_b64 exec, s[70:71]
    v_lshlrev_b32_sdwa v6, 2, v15 dst_sel:DWORD dst_unused:UNUSED_PAD src0_sel:DWORD src1_sel:WORD_1
    ds_write_b32 v6, v7 offset:4
    s_mov_b64 exec, s[62:63]
    ds_write_b32 v6, v7
L_p1_kernel_nonull_9:
    s_mov_b64 exec, -1
    v_lshlrev_b32_sdwa v6, 2, v51 dst_sel:DWORD dst_unused:UNUSED_PAD src0_sel:DWORD src1_sel:WORD_0
    v_lshlrev_b32_sdwa v7, 2, v51 dst_sel:DWORD dst_unused:UNUSED_PAD src0_sel:DWORD src1_sel:WORD_1
    v_lshlrev_b32_sdwa v8, 2, v55 dst_sel:DWORD dst_unused:UNUSED_PAD src0_sel:DWORD src1_sel:WORD_0
    v_lshlrev_b32_sdwa v9, 2, v55 dst_sel:DWORD dst_unused:UNUSED_PAD src0_sel:DWORD src1_sel:WORD_1
    ds_write_b32 v6, v48
    ds_write_b32 v7, v49
    ds_write_b32 v8, v50
    ds_write_b32 v9, v52
    s_waitcnt vmcnt(11)
    v_lshlrev_b32 v10, 16, v100
    v_lshlrev_b32 v11, 16, v101
    v_and_b32 v100, 0xffff0000, v100
    v_and_b32 v101, 0xffff0000, v101
    v_mul_f32 v10, s41, v10
    v_mul_f32 v100, s41, v100
    v_mul_f32 v11, s41, v11
    v_mul_f32 v101, s41, v101
    v_fract_f32 v10, v10
    v_fract_f32 v100, v100
    v_fract_f32 v11, v11
    v_fract_f32 v101, v101
    v_cos_f32 v10, v10
    v_cos_f32 v100, v100
    v_cos_f32 v11, v11
    v_cos_f32 v101, v101
    v_fmaak_f32 v10, v12, v10, 1262486016
    v_fmaak_f32 v100, v12, v100, 1262486016
    v_fmaak_f32 v11, v12, v11, 1262486016
    v_fmaak_f32 v101, v12, v101, 1262486016
    v_or3_b32 v5, v10, v100, v5
    v_or3_b32 v5, v11, v101, v5
    v_perm_b32 v100, v100, v10, s43
    v_perm_b32 v101, v101, v11, s43
    s_add_u32 s35, s33, 40960000
    buffer_load_dwordx4 v[16:19], v1, s[8:11], s35 offen nt
    v_lshlrev_b32_sdwa v6, 2, v59 dst_sel:DWORD dst_unused:UNUSED_PAD src0_sel:DWORD src1_sel:WORD_0
    v_lshlrev_b32_sdwa v7, 2, v59 dst_sel:DWORD dst_unused:UNUSED_PAD src0_sel:DWORD src1_sel:WORD_1
    v_lshlrev_b32_sdwa v8, 2, v63 dst_sel:DWORD dst_unused:UNUSED_PAD src0_sel:DWORD src1_sel:WORD_0
    v_lshlrev_b32_sdwa v9, 2, v63 dst_sel:DWORD dst_unused:UNUSED_PAD src0_sel:DWORD src1_sel:WORD_1
    ds_write_b32 v6, v53
    ds_write_b32 v7, v54
    ds_write_b32 v8, v56
    ds_write_b32 v9, v57
    s_waitcnt vmcnt(11)
    v_lshlrev_b32 v10, 16, v102
    v_lshlrev_b32 v11, 16, v103
    v_and_b32 v102, 0xffff0000, v102
    v_and_b32 v103, 0xffff0000, v103
    v_mul_f32 v10, s41, v10
    v_mul_f32 v102, s41, v102
    v_mul_f32 v11, s41, v11
    v_mul_f32 v103, s41, v103
    v_fract_f32 v10, v10
    v_fract_f32 v102, v102
    v_fract_f32 v11, v11
    v_fract_f32 v103, v103
    v_cos_f32 v10, v10
    v_cos_f32 v102, v102
    v_cos_f32 v11, v11
    v_cos_f32 v103, v103
    v_fmaak_f32 v10, v12, v10, 1262486016
    v_fmaak_f32 v102, v12, v102, 1262486016
    v_fmaak_f32 v11, v12, v11, 1262486016
    v_fmaak_f32 v103, v12, v103, 1262486016
    v_or3_b32 v5, v10, v102, v5
    v_or3_b32 v5, v11, v103, v5
    v_perm_b32 v102, v102, v10, s43
    v_perm_b32 v103, v103, v11, s43
    v_lshlrev_b32_sdwa v6, 2, v67 dst_sel:DWORD dst_unused:UNUSED_PAD src0_sel:DWORD src1_sel:WORD_0
    v_lshlrev_b32_sdwa v7, 2, v67 dst_sel:DWORD dst_unused:UNUSED_PAD src0_sel:DWORD src1_sel:WORD_1
    v_lshlrev_b32_sdwa v8, 2, v71 dst_sel:DWORD dst_unused:UNUSED_PAD src0_sel:DWORD src1_sel:WORD_0
    v_lshlrev_b32_sdwa v9, 2, v71 dst_sel:DWORD dst_unused:UNUSED_PAD src0_sel:DWORD src1_sel:WORD_1
    ds_write_b32 v6, v58
    ds_write_b32 v7, v60
    ds_write_b32 v8, v61
    ds_write_b32 v9, v62
    v_lshlrev_b32_sdwa v6, 2, v120 dst_sel:DWORD dst_unused:UNUSED_PAD src0_sel:DWORD src1_sel:WORD_0
    v_lshlrev_b32_sdwa v7, 2, v120 dst_sel:DWORD dst_unused:UNUSED_PAD src0_sel:DWORD src1_sel:WORD_1
    v_lshlrev_b32_sdwa v8, 2, v121 dst_sel:DWORD dst_unused:UNUSED_PAD src0_sel:DWORD src1_sel:WORD_0
    v_lshlrev_b32_sdwa v9, 2, v121 dst_sel:DWORD dst_unused:UNUSED_PAD src0_sel:DWORD src1_sel:WORD_1
    ds_write_b32 v6, v64
    ds_write_b32 v7, v65
    ds_write_b32 v8, v66
    ds_write_b32 v9, v68
    s_waitcnt vmcnt(10)
    v_lshlrev_b32 v10, 16, v104
    v_lshlrev_b32 v11, 16, v105
    v_and_b32 v104, 0xffff0000, v104
    v_and_b32 v105, 0xffff0000, v105
    v_mul_f32 v10, s41, v10
    v_mul_f32 v104, s41, v104
    v_mul_f32 v11, s41, v11
    v_mul_f32 v105, s41, v105
    v_fract_f32 v10, v10
    v_fract_f32 v104, v104
    v_fract_f32 v11, v11
    v_fract_f32 v105, v105
    v_cos_f32 v10, v10
    v_cos_f32 v104, v104
    v_cos_f32 v11, v11
    v_cos_f32 v105, v105
    v_fmaak_f32 v10, v12, v10, 1262486016
    v_fmaak_f32 v104, v12, v104, 1262486016
    v_fmaak_f32 v11, v12, v11, 1262486016
    v_fmaak_f32 v105, v12, v105, 1262486016
    v_or3_b32 v5, v10, v104, v5
    v_or3_b32 v5, v11, v105, v5
    v_perm_b32 v104, v104, v10, s43
    v_perm_b32 v105, v105, v11, s43
    s_add_u32 s35, s33, 40960000
    buffer_load_dwordx4 v[20:23], v1, s[12:15], s35 offen nt
    v_lshlrev_b32_sdwa v6, 2, v122 dst_sel:DWORD dst_unused:UNUSED_PAD src0_sel:DWORD src1_sel:WORD_0
    v_lshlrev_b32_sdwa v7, 2, v122 dst_sel:DWORD dst_unused:UNUSED_PAD src0_sel:DWORD src1_sel:WORD_1
    v_lshlrev_b32_sdwa v8, 2, v123 dst_sel:DWORD dst_unused:UNUSED_PAD src0_sel:DWORD src1_sel:WORD_0
    v_lshlrev_b32_sdwa v9, 2, v123 dst_sel:DWORD dst_unused:UNUSED_PAD src0_sel:DWORD src1_sel:WORD_1
    ds_write_b32 v6, v69
    ds_write_b32 v7, v70
    ds_write_b32 v8, v127
    ds_write_b32 v9, v72
    s_waitcnt vmcnt(8)
    v_lshlrev_b32 v10, 16, v106
    v_lshlrev_b32 v11, 16, v107
    v_and_b32 v106, 0xffff0000, v106
    v_and_b32 v107, 0xffff0000, v107
    v_mul_f32 v10, s41, v10
    v_mul_f32 v106, s41, v106
    v_mul_f32 v11, s41, v11
    v_mul_f32 v107, s41, v107
    v_fract_f32 v10, v10
    v_fract_f32 v106, v106
    v_fract_f32 v11, v11
    v_fract_f32 v107, v107
    v_cos_f32 v10, v10
    v_cos_f32 v106, v106
    v_cos_f32 v11, v11
    v_cos_f32 v107, v107
    v_fmaak_f32 v10, v12, v10, 1262486016
    v_fmaak_f32 v106, v12, v106, 1262486016
    v_fmaak_f32 v11, v12, v11, 1262486016
    v_fmaak_f32 v107, v12, v107, 1262486016
    v_or3_b32 v5, v10, v106, v5
    v_or3_b32 v5, v11, v107, v5
    v_perm_b32 v106, v106, v10, s43
    v_perm_b32 v107, v107, v11, s43
    v_lshlrev_b32_sdwa v6, 2, v124 dst_sel:DWORD dst_unused:UNUSED_PAD src0_sel:DWORD src1_sel:WORD_0
    v_lshlrev_b32_sdwa v7, 2, v124 dst_sel:DWORD dst_unused:UNUSED_PAD src0_sel:DWORD src1_sel:WORD_1
    v_lshlrev_b32_sdwa v8, 2, v125 dst_sel:DWORD dst_unused:UNUSED_PAD src0_sel:DWORD src1_sel:WORD_0
    v_lshlrev_b32_sdwa v9, 2, v125 dst_sel:DWORD dst_unused:UNUSED_PAD src0_sel:DWORD src1_sel:WORD_1
    ds_write_b32 v6, v73
    ds_write_b32 v7, v74
    ds_write_b32 v8, v76
    ds_write_b32 v9, v77
    v_lshlrev_b32_sdwa v6, 2, v126 dst_sel:DWORD dst_unused:UNUSED_PAD src0_sel:DWORD src1_sel:WORD_0
    v_lshlrev_b32_sdwa v7, 2, v126 dst_sel:DWORD dst_unused:UNUSED_PAD src0_sel:DWORD src1_sel:WORD_1
    v_lshlrev_b32_sdwa v8, 2, v75 dst_sel:DWORD dst_unused:UNUSED_PAD src0_sel:DWORD src1_sel:WORD_0
    v_lshlrev_b32_sdwa v9, 2, v75 dst_sel:DWORD dst_unused:UNUSED_PAD src0_sel:DWORD src1_sel:WORD_1
    ds_write_b32 v6, v78
    ds_write_b32 v7, v80
    ds_write_b32 v8, v81
    ds_write_b32 v9, v82
    s_waitcnt vmcnt(7)
    v_lshlrev_b32 v10, 16, v108
    v_lshlrev_b32 v11, 16, v109
    v_and_b32 v108, 0xffff0000, v108
    v_and_b32 v109, 0xffff0000, v109
    v_mul_f32 v10, s41, v10
    v_mul_f32 v108, s41, v108
    v_mul_f32 v11, s41, v11
    v_mul_f32 v109, s41, v109
    v_fract_f32 v10, v10
    v_fract_f32 v108, v108
    v_fract_f32 v11, v11
    v_fract_f32 v109, v109
    v_cos_f32 v10, v10
    v_cos_f32 v108, v108
    v_cos_f32 v11, v11
    v_cos_f32 v109, v109
    v_fmaak_f32 v10, v12, v10, 1262486016
    v_fmaak_f32 v108, v12, v108, 1262486016
    v_fmaak_f32 v11, v12, v11, 1262486016
    v_fmaak_f32 v109, v12, v109, 1262486016
    v_or3_b32 v5, v10, v108, v5
    v_or3_b32 v5, v11, v109, v5
    v_perm_b32 v108, v108, v10, s43
    v_perm_b32 v109, v109, v11, s43
    s_add_u32 s35, s33, 45154304
    buffer_load_dwordx4 v[24:27], v1, s[8:11], s35 offen nt
    v_lshlrev_b32_sdwa v6, 2, v79 dst_sel:DWORD dst_unused:UNUSED_PAD src0_sel:DWORD src1_sel:WORD_0
    v_lshlrev_b32_sdwa v7, 2, v79 dst_sel:DWORD dst_unused:UNUSED_PAD src0_sel:DWORD src1_sel:WORD_1
    v_lshlrev_b32_sdwa v8, 2, v83 dst_sel:DWORD dst_unused:UNUSED_PAD src0_sel:DWORD src1_sel:WORD_0
    v_lshlrev_b32_sdwa v9, 2, v83 dst_sel:DWORD dst_unused:UNUSED_PAD src0_sel:DWORD src1_sel:WORD_1
    ds_write_b32 v6, v84
    ds_write_b32 v7, v85
    ds_write_b32 v8, v86
    ds_write_b32 v9, v88
    s_waitcnt vmcnt(7)
    v_lshlrev_b32 v10, 16, v110
    v_lshlrev_b32 v11, 16, v111
    v_and_b32 v110, 0xffff0000, v110
    v_and_b32 v111, 0xffff0000, v111
    v_mul_f32 v10, s41, v10
    v_mul_f32 v110, s41, v110
    v_mul_f32 v11, s41, v11
    v_mul_f32 v111, s41, v111
    v_fract_f32 v10, v10
    v_fract_f32 v110, v110
    v_fract_f32 v11, v11
    v_fract_f32 v111, v111
    v_cos_f32 v10, v10
    v_cos_f32 v110, v110
    v_cos_f32 v11, v11
    v_cos_f32 v111, v111
    v_fmaak_f32 v10, v12, v10, 1262486016
    v_fmaak_f32 v110, v12, v110, 1262486016
    v_fmaak_f32 v11, v12, v11, 1262486016
    v_fmaak_f32 v111, v12, v111, 1262486016
    v_or3_b32 v5, v10, v110, v5
    v_or3_b32 v5, v11, v111, v5
    v_perm_b32 v110, v110, v10, s43
    v_perm_b32 v111, v111, v11, s43
    v_lshlrev_b32_sdwa v6, 2, v87 dst_sel:DWORD dst_unused:UNUSED_PAD src0_sel:DWORD src1_sel:WORD_0
    v_lshlrev_b32_sdwa v7, 2, v87 dst_sel:DWORD dst_unused:UNUSED_PAD src0_sel:DWORD src1_sel:WORD_1
    v_lshlrev_b32_sdwa v8, 2, v91 dst_sel:DWORD dst_unused:UNUSED_PAD src0_sel:DWORD src1_sel:WORD_0
    v_lshlrev_b32_sdwa v9, 2, v91 dst_sel:DWORD dst_unused:UNUSED_PAD src0_sel:DWORD src1_sel:WORD_1
    ds_write_b32 v6, v89
    ds_write_b32 v7, v90
    ds_write_b32 v8, v92
    ds_write_b32 v9, v93
    s_mov_b64 exec, s[44:45]
    v_lshlrev_b32_sdwa v6, 2, v95 dst_sel:DWORD dst_unused:UNUSED_PAD src0_sel:DWORD src1_sel:WORD_0
    v_lshlrev_b32_sdwa v7, 2, v95 dst_sel:DWORD dst_unused:UNUSED_PAD src0_sel:DWORD src1_sel:WORD_1
    v_lshlrev_b32_sdwa v8, 2, v99 dst_sel:DWORD dst_unused:UNUSED_PAD src0_sel:DWORD src1_sel:WORD_0
    v_lshlrev_b32_sdwa v9, 2, v99 dst_sel:DWORD dst_unused:UNUSED_PAD src0_sel:DWORD src1_sel:WORD_1
    ds_write_b32 v6, v94
    ds_write_b32 v7, v96
    ds_write_b32 v8, v97
    ds_write_b32 v9, v98
    s_mov_b64 exec, -1
    s_waitcnt vmcnt(6)
    v_lshlrev_b32 v10, 16, v112
    v_lshlrev_b32 v11, 16, v113
    v_and_b32 v112, 0xffff0000, v112
    v_and_b32 v113, 0xffff0000, v113
    v_mul_f32 v10, s41, v10
    v_mul_f32 v112, s41, v112
    v_mul_f32 v11, s41, v11
    v_mul_f32 v113, s41, v113
    v_fract_f32 v10, v10
    v_fract_f32 v112, v112
    v_fract_f32 v11, v11
    v_fract_f32 v113, v113
    v_cos_f32 v10, v10
    v_cos_f32 v112, v112
    v_cos_f32 v11, v11
    v_cos_f32 v113, v113
    v_fmaak_f32 v10, v12, v10, 1262486016
    v_fmaak_f32 v112, v12, v112, 1262486016
    v_fmaak_f32 v11, v12, v11, 1262486016
    v_fmaak_f32 v113, v12, v113, 1262486016
    v_or3_b32 v5, v10, v112, v5
    v_or3_b32 v5, v11, v113, v5
    v_perm_b32 v112, v112, v10, s43
    v_perm_b32 v113, v113, v11, s43
    s_mov_b64 exec, s[44:45]
    s_mov_b64 exec, -1
    s_add_u32 s35, s33, 45154304
    buffer_load_dwordx4 v[28:31], v1, s[12:15], s35 offen nt
    s_mul_i32 s35, s39, 9216
    v_mad_u32_u24 v6, v0, 12, s35
    s_waitcnt lgkmcnt(0)
    s_barrier
    s_cmp_lg_u32 s39, 15
    s_cbranch_scc1 L_p1_kernel_nox_10
    ds_read_b32 v12, v6 offset:9984
    ds_read_b32 v13, v6 offset:9988
    ds_read_b32 v14, v6 offset:9992
L_p1_kernel_nox_10:
    ds_read_b32 v48, v6 offset:1536
    ds_read_b32 v49, v6 offset:1540
    ds_read_b32 v50, v6 offset:1544
    ds_read_b32 v52, v6 offset:3072
    ds_read_b32 v53, v6 offset:3076
    ds_read_b32 v54, v6 offset:3080
    ds_read_b32 v56, v6 offset:4608
    ds_read_b32 v57, v6 offset:4612
    ds_read_b32 v58, v6 offset:4616
    ds_read_b32 v60, v6 offset:6144
    ds_read_b32 v61, v6 offset:6148
    ds_read_b32 v62, v6 offset:6152
    ds_read_b32 v64, v6 offset:7680
    ds_read_b32 v65, v6 offset:7684
    ds_read_b32 v66, v6 offset:7688
    ds_read_b32 v68, v6 offset:9216
    ds_read_b32 v69, v6 offset:9220
    ds_read_b32 v70, v6 offset:9224
    ds_read_b32 v72, v6 offset:0
    ds_read_b32 v73, v6 offset:4
    ds_read_b32 v74, v6 offset:8
    ds_read_b32 v76, v6 offset:768
    ds_read_b32 v77, v6 offset:772
    ds_read_b32 v78, v6 offset:776
    ds_read_b32 v80, v6 offset:2304
    ds_read_b32 v81, v6 offset:2308
    ds_read_b32 v82, v6 offset:2312
    ds_read_b32 v84, v6 offset:3840
    ds_read_b32 v85, v6 offset:3844
    ds_read_b32 v86, v6 offset:3848
    ds_read_b32 v88, v6 offset:5376
    ds_read_b32 v89, v6 offset:5380
    ds_read_b32 v90, v6 offset:5384
    ds_read_b32 v92, v6 offset:6912
    ds_read_b32 v93, v6 offset:6916
    ds_read_b32 v94, v6 offset:6920
    ds_read_b32 v96, v6 offset:8448
    ds_read_b32 v97, v6 offset:8452
    ds_read_b32 v98, v6 offset:8456
    s_add_u32 s35, s33, 49348608
    buffer_load_dwordx4 v[32:35], v1, s[8:11], s35 offen nt
    v_mov_b32 v8, 0
    v_mov_b32 v9, 0
    v_mov_b32 v10, 0
    v_mov_b32 v11, 0
    v_mov_b32 v15, 16384
    s_waitcnt lgkmcnt(0)
    s_barrier
    ds_write_b128 v1, v[8:11] offset:0
    s_nop 1
    v_mad_u32_u16 v6, v51, s50, v15 op_sel:[0,0,0,0]
    v_mad_u32_u16 v7, v51, s50, v15 op_sel:[1,0,0,0]
    v_mad_u32_u16 v8, v55, s50, v15 op_sel:[0,0,0,0]
    v_mad_u32_u16 v9, v55, s50, v15 op_sel:[1,0,0,0]
    v_add_u32_sdwa v6, v6, v51 dst_sel:DWORD dst_unused:UNUSED_PAD src0_sel:WORD_1 src1_sel:WORD_0
    v_add_u32_sdwa v7, v7, v51 dst_sel:DWORD dst_unused:UNUSED_PAD src0_sel:WORD_1 src1_sel:WORD_1
    v_add_u32_sdwa v8, v8, v55 dst_sel:DWORD dst_unused:UNUSED_PAD src0_sel:WORD_1 src1_sel:WORD_0
    v_add_u32_sdwa v9, v9, v55 dst_sel:DWORD dst_unused:UNUSED_PAD src0_sel:WORD_1 src1_sel:WORD_1
    v_add_u32 v6, v6, v6
    v_add_u32 v7, v7, v7
    v_add_u32 v8, v8, v8
    v_add_u32 v9, v9, v9
    ds_write_b16 v6, v100 offset:16384
    ds_write_b16_d16_hi v7, v100 offset:16384
    ds_write_b16 v8, v101 offset:16384
    ds_write_b16_d16_hi v9, v101 offset:16384
    v_mov_b32 v6, 1140817920
    s_waitcnt vmcnt(7)
    v_lshlrev_b32 v10, 16, v114
    v_lshlrev_b32 v11, 16, v115
    v_and_b32 v114, 0xffff0000, v114
    v_and_b32 v115, 0xffff0000, v115
    v_mul_f32 v10, s41, v10
    v_mul_f32 v114, s41, v114
    v_mul_f32 v11, s41, v11
    v_mul_f32 v115, s41, v115
    v_fract_f32 v10, v10
    v_fract_f32 v114, v114
    v_fract_f32 v11, v11
    v_fract_f32 v115, v115
    v_cos_f32 v10, v10
    v_cos_f32 v114, v114
    v_cos_f32 v11, v11
    v_cos_f32 v115, v115
    v_fmaak_f32 v10, v6, v10, 1262486016
    v_fmaak_f32 v114, v6, v114, 1262486016
    v_fmaak_f32 v11, v6, v11, 1262486016
    v_fmaak_f32 v115, v6, v115, 1262486016
    v_or3_b32 v5, v10, v114, v5
    v_or3_b32 v5, v11, v115, v5
    v_perm_b32 v114, v114, v10, s43
    v_perm_b32 v115, v115, v11, s43
    v_mad_u32_u16 v6, v59, s50, v15 op_sel:[0,0,0,0]
    v_mad_u32_u16 v7, v59, s50, v15 op_sel:[1,0,0,0]
    v_mad_u32_u16 v8, v63, s50, v15 op_sel:[0,0,0,0]
    v_mad_u32_u16 v9, v63, s50, v15 op_sel:[1,0,0,0]
    v_add_u32_sdwa v6, v6, v59 dst_sel:DWORD dst_unused:UNUSED_PAD src0_sel:WORD_1 src1_sel:WORD_0
    v_add_u32_sdwa v7, v7, v59 dst_sel:DWORD dst_unused:UNUSED_PAD src0_sel:WORD_1 src1_sel:WORD_1
    v_add_u32_sdwa v8, v8, v63 dst_sel:DWORD dst_unused:UNUSED_PAD src0_sel:WORD_1 src1_sel:WORD_0
    v_add_u32_sdwa v9, v9, v63 dst_sel:DWORD dst_unused:UNUSED_PAD src0_sel:WORD_1 src1_sel:WORD_1
    v_add_u32 v6, v6, v6
    v_add_u32 v7, v7, v7
    v_add_u32 v8, v8, v8
    v_add_u32 v9, v9, v9
    ds_write_b16 v6, v102 offset:16384
    ds_write_b16_d16_hi v7, v102 offset:16384
    ds_write_b16 v8, v103 offset:16384
    ds_write_b16_d16_hi v9, v103 offset:16384
    v_mad_u32_u16 v6, v67, s50, v15 op_sel:[0,0,0,0]
    v_mad_u32_u16 v7, v67, s50, v15 op_sel:[1,0,0,0]
    v_mad_u32_u16 v8, v71, s50, v15 op_sel:[0,0,0,0]
    v_mad_u32_u16 v9, v71, s50, v15 op_sel:[1,0,0,0]
    v_add_u32_sdwa v6, v6, v67 dst_sel:DWORD dst_unused:UNUSED_PAD src0_sel:WORD_1 src1_sel:WORD_0
    v_add_u32_sdwa v7, v7, v67 dst_sel:DWORD dst_unused:UNUSED_PAD src0_sel:WORD_1 src1_sel:WORD_1
    v_add_u32_sdwa v8, v8, v71 dst_sel:DWORD dst_unused:UNUSED_PAD src0_sel:WORD_1 src1_sel:WORD_0
    v_add_u32_sdwa v9, v9, v71 dst_sel:DWORD dst_unused:UNUSED_PAD src0_sel:WORD_1 src1_sel:WORD_1
    v_add_u32 v6, v6, v6
    v_add_u32 v7, v7, v7
    v_add_u32 v8, v8, v8
    v_add_u32 v9, v9, v9
    ds_write_b16 v6, v104 offset:16384
    ds_write_b16_d16_hi v7, v104 offset:16384
    ds_write_b16 v8, v105 offset:16384
    ds_write_b16_d16_hi v9, v105 offset:16384
    s_add_u32 s35, s33, 49348608
    buffer_load_dwordx4 v[36:39], v1, s[12:15], s35 offen nt
    v_mad_u32_u16 v6, v120, s50, v15 op_sel:[0,0,0,0]
    v_mad_u32_u16 v7, v120, s50, v15 op_sel:[1,0,0,0]
    v_mad_u32_u16 v8, v121, s50, v15 op_sel:[0,0,0,0]
    v_mad_u32_u16 v9, v121, s50, v15 op_sel:[1,0,0,0]
    v_add_u32_sdwa v6, v6, v120 dst_sel:DWORD dst_unused:UNUSED_PAD src0_sel:WORD_1 src1_sel:WORD_0
    v_add_u32_sdwa v7, v7, v120 dst_sel:DWORD dst_unused:UNUSED_PAD src0_sel:WORD_1 src1_sel:WORD_1
    v_add_u32_sdwa v8, v8, v121 dst_sel:DWORD dst_unused:UNUSED_PAD src0_sel:WORD_1 src1_sel:WORD_0
    v_add_u32_sdwa v9, v9, v121 dst_sel:DWORD dst_unused:UNUSED_PAD src0_sel:WORD_1 src1_sel:WORD_1
    v_add_u32 v6, v6, v6
    v_add_u32 v7, v7, v7
    v_add_u32 v8, v8, v8
    v_add_u32 v9, v9, v9
    ds_write_b16 v6, v106 offset:16384
    ds_write_b16_d16_hi v7, v106 offset:16384
    ds_write_b16 v8, v107 offset:16384
    ds_write_b16_d16_hi v9, v107 offset:16384
    v_mov_b32 v6, 1140817920
    s_waitcnt vmcnt(7)
    v_lshlrev_b32 v10, 16, v116
    v_lshlrev_b32 v11, 16, v117
    v_and_b32 v116, 0xffff0000, v116
    v_and_b32 v117, 0xffff0000, v117
    v_mul_f32 v10, s41, v10
    v_mul_f32 v116, s41, v116
    v_mul_f32 v11, s41, v11
    v_mul_f32 v117, s41, v117
    v_fract_f32 v10, v10
    v_fract_f32 v116, v116
    v_fract_f32 v11, v11
    v_fract_f32 v117, v117
    v_cos_f32 v10, v10
    v_cos_f32 v116, v116
    v_cos_f32 v11, v11
    v_cos_f32 v117, v117
    v_fmaak_f32 v10, v6, v10, 1262486016
    v_fmaak_f32 v116, v6, v116, 1262486016
    v_fmaak_f32 v11, v6, v11, 1262486016
    v_fmaak_f32 v117, v6, v117, 1262486016
    v_or3_b32 v5, v10, v116, v5
    v_or3_b32 v5, v11, v117, v5
    v_perm_b32 v116, v116, v10, s43
    v_perm_b32 v117, v117, v11, s43
    v_mad_u32_u16 v6, v122, s50, v15 op_sel:[0,0,0,0]
    v_mad_u32_u16 v7, v122, s50, v15 op_sel:[1,0,0,0]
    v_mad_u32_u16 v8, v123, s50, v15 op_sel:[0,0,0,0]
    v_mad_u32_u16 v9, v123, s50, v15 op_sel:[1,0,0,0]
    v_add_u32_sdwa v6, v6, v122 dst_sel:DWORD dst_unused:UNUSED_PAD src0_sel:WORD_1 src1_sel:WORD_0
    v_add_u32_sdwa v7, v7, v122 dst_sel:DWORD dst_unused:UNUSED_PAD src0_sel:WORD_1 src1_sel:WORD_1
    v_add_u32_sdwa v8, v8, v123 dst_sel:DWORD dst_unused:UNUSED_PAD src0_sel:WORD_1 src1_sel:WORD_0
    v_add_u32_sdwa v9, v9, v123 dst_sel:DWORD dst_unused:UNUSED_PAD src0_sel:WORD_1 src1_sel:WORD_1
    v_add_u32 v6, v6, v6
    v_add_u32 v7, v7, v7
    v_add_u32 v8, v8, v8
    v_add_u32 v9, v9, v9
    ds_write_b16 v6, v108 offset:16384
    ds_write_b16_d16_hi v7, v108 offset:16384
    ds_write_b16 v8, v109 offset:16384
    ds_write_b16_d16_hi v9, v109 offset:16384
    v_mad_u32_u16 v6, v124, s50, v15 op_sel:[0,0,0,0]
    v_mad_u32_u16 v7, v124, s50, v15 op_sel:[1,0,0,0]
    v_mad_u32_u16 v8, v125, s50, v15 op_sel:[0,0,0,0]
    v_mad_u32_u16 v9, v125, s50, v15 op_sel:[1,0,0,0]
    v_add_u32_sdwa v6, v6, v124 dst_sel:DWORD dst_unused:UNUSED_PAD src0_sel:WORD_1 src1_sel:WORD_0
    v_add_u32_sdwa v7, v7, v124 dst_sel:DWORD dst_unused:UNUSED_PAD src0_sel:WORD_1 src1_sel:WORD_1
    v_add_u32_sdwa v8, v8, v125 dst_sel:DWORD dst_unused:UNUSED_PAD src0_sel:WORD_1 src1_sel:WORD_0
    v_add_u32_sdwa v9, v9, v125 dst_sel:DWORD dst_unused:UNUSED_PAD src0_sel:WORD_1 src1_sel:WORD_1
    v_add_u32 v6, v6, v6
    v_add_u32 v7, v7, v7
    v_add_u32 v8, v8, v8
    v_add_u32 v9, v9, v9
    ds_write_b16 v6, v110 offset:16384
    ds_write_b16_d16_hi v7, v110 offset:16384
    ds_write_b16 v8, v111 offset:16384
    ds_write_b16_d16_hi v9, v111 offset:16384
    s_add_u32 s35, s33, 53542912
    buffer_load_dwordx4 v[40:43], v1, s[8:11], s35 offen nt
    v_mad_u32_u16 v6, v126, s50, v15 op_sel:[0,0,0,0]
    v_mad_u32_u16 v7, v126, s50, v15 op_sel:[1,0,0,0]
    v_mad_u32_u16 v8, v75, s50, v15 op_sel:[0,0,0,0]
    v_mad_u32_u16 v9, v75, s50, v15 op_sel:[1,0,0,0]
    v_add_u32_sdwa v6, v6, v126 dst_sel:DWORD dst_unused:UNUSED_PAD src0_sel:WORD_1 src1_sel:WORD_0
    v_add_u32_sdwa v7, v7, v126 dst_sel:DWORD dst_unused:UNUSED_PAD src0_sel:WORD_1 src1_sel:WORD_1
    v_add_u32_sdwa v8, v8, v75 dst_sel:DWORD dst_unused:UNUSED_PAD src0_sel:WORD_1 src1_sel:WORD_0
    v_add_u32_sdwa v9, v9, v75 dst_sel:DWORD dst_unused:UNUSED_PAD src0_sel:WORD_1 src1_sel:WORD_1
    v_add_u32 v6, v6, v6
    v_add_u32 v7, v7, v7
    v_add_u32 v8, v8, v8
    v_add_u32 v9, v9, v9
    ds_write_b16 v6, v112 offset:16384
    ds_write_b16_d16_hi v7, v112 offset:16384
    ds_write_b16 v8, v113 offset:16384
    ds_write_b16_d16_hi v9, v113 offset:16384
    v_mov_b32 v6, 1140817920
    s_mov_b64 exec, s[44:45]
    s_waitcnt vmcnt(7)
    v_lshlrev_b32 v10, 16, v118
    v_lshlrev_b32 v11, 16, v119
    v_and_b32 v118, 0xffff0000, v118
    v_and_b32 v119, 0xffff0000, v119
    v_mul_f32 v10, s41, v10
    v_mul_f32 v118, s41, v118
    v_mul_f32 v11, s41, v11
    v_mul_f32 v119, s41, v119
    v_fract_f32 v10, v10
    v_fract_f32 v118, v118
    v_fract_f32 v11, v11
    v_fract_f32 v119, v119
    v_cos_f32 v10, v10
    v_cos_f32 v118, v118
    v_cos_f32 v11, v11
    v_cos_f32 v119, v119
    v_fmaak_f32 v10, v6, v10, 1262486016
    v_fmaak_f32 v118, v6, v118, 1262486016
    v_fmaak_f32 v11, v6, v11, 1262486016
    v_fmaak_f32 v119, v6, v119, 1262486016
    v_or3_b32 v5, v10, v118, v5
    v_or3_b32 v5, v11, v119, v5
    v_perm_b32 v118, v118, v10, s43
    v_perm_b32 v119, v119, v11, s43
    s_mov_b64 exec, -1
    v_mad_u32_u16 v6, v79, s50, v15 op_sel:[0,0,0,0]
    v_mad_u32_u16 v7, v79, s50, v15 op_sel:[1,0,0,0]
    v_mad_u32_u16 v8, v83, s50, v15 op_sel:[0,0,0,0]
    v_mad_u32_u16 v9, v83, s50, v15 op_sel:[1,0,0,0]
    v_add_u32_sdwa v6, v6, v79 dst_sel:DWORD dst_unused:UNUSED_PAD src0_sel:WORD_1 src1_sel:WORD_0
    v_add_u32_sdwa v7, v7, v79 dst_sel:DWORD dst_unused:UNUSED_PAD src0_sel:WORD_1 src1_sel:WORD_1
    v_add_u32_sdwa v8, v8, v83 dst_sel:DWORD dst_unused:UNUSED_PAD src0_sel:WORD_1 src1_sel:WORD_0
    v_add_u32_sdwa v9, v9, v83 dst_sel:DWORD dst_unused:UNUSED_PAD src0_sel:WORD_1 src1_sel:WORD_1
    v_add_u32 v6, v6, v6
    v_add_u32 v7, v7, v7
    v_add_u32 v8, v8, v8
    v_add_u32 v9, v9, v9
    ds_write_b16 v6, v114 offset:16384
    ds_write_b16_d16_hi v7, v114 offset:16384
    ds_write_b16 v8, v115 offset:16384
    ds_write_b16_d16_hi v9, v115 offset:16384
    v_mad_u32_u16 v6, v87, s50, v15 op_sel:[0,0,0,0]
    v_mad_u32_u16 v7, v87, s50, v15 op_sel:[1,0,0,0]
    v_mad_u32_u16 v8, v91, s50, v15 op_sel:[0,0,0,0]
    v_mad_u32_u16 v9, v91, s50, v15 op_sel:[1,0,0,0]
    v_add_u32_sdwa v6, v6, v87 dst_sel:DWORD dst_unused:UNUSED_PAD src0_sel:WORD_1 src1_sel:WORD_0
    v_add_u32_sdwa v7, v7, v87 dst_sel:DWORD dst_unused:UNUSED_PAD src0_sel:WORD_1 src1_sel:WORD_1
    v_add_u32_sdwa v8, v8, v91 dst_sel:DWORD dst_unused:UNUSED_PAD src0_sel:WORD_1 src1_sel:WORD_0
    v_add_u32_sdwa v9, v9, v91 dst_sel:DWORD dst_unused:UNUSED_PAD src0_sel:WORD_1 src1_sel:WORD_1
    v_add_u32 v6, v6, v6
    v_add_u32 v7, v7, v7
    v_add_u32 v8, v8, v8
    v_add_u32 v9, v9, v9
    ds_write_b16 v6, v116 offset:16384
    ds_write_b16_d16_hi v7, v116 offset:16384
    ds_write_b16 v8, v117 offset:16384
    ds_write_b16_d16_hi v9, v117 offset:16384
    s_add_u32 s35, s33, 53542912
    buffer_load_dwordx4 v[44:47], v1, s[12:15], s35 offen nt
    s_mov_b64 exec, s[44:45]
    v_mad_u32_u16 v6, v95, s50, v15 op_sel:[0,0,0,0]
    v_mad_u32_u16 v7, v95, s50, v15 op_sel:[1,0,0,0]
    v_mad_u32_u16 v8, v99, s50, v15 op_sel:[0,0,0,0]
    v_mad_u32_u16 v9, v99, s50, v15 op_sel:[1,0,0,0]
    v_add_u32_sdwa v6, v6, v95 dst_sel:DWORD dst_unused:UNUSED_PAD src0_sel:WORD_1 src1_sel:WORD_0
    v_add_u32_sdwa v7, v7, v95 dst_sel:DWORD dst_unused:UNUSED_PAD src0_sel:WORD_1 src1_sel:WORD_1
    v_add_u32_sdwa v8, v8, v99 dst_sel:DWORD dst_unused:UNUSED_PAD src0_sel:WORD_1 src1_sel:WORD_0
    v_add_u32_sdwa v9, v9, v99 dst_sel:DWORD dst_unused:UNUSED_PAD src0_sel:WORD_1 src1_sel:WORD_1
    v_add_u32 v6, v6, v6
    v_add_u32 v7, v7, v7
    v_add_u32 v8, v8, v8
    v_add_u32 v9, v9, v9
    ds_write_b16 v6, v118 offset:16384
    ds_write_b16_d16_hi v7, v118 offset:16384
    ds_write_b16 v8, v119 offset:16384
    ds_write_b16_d16_hi v9, v119 offset:16384
    s_mov_b64 exec, -1
    s_mul_i32 s35, s39, 6144
    v_add_u32 v6, s35, v2
    s_waitcnt lgkmcnt(0)
    s_barrier
    ds_read_b64 v[100:101], v6 offset:23040
    ds_read_b64 v[102:103], v6 offset:16384
    ds_read_b64 v[104:105], v6 offset:16896
    ds_read_b64 v[106:107], v6 offset:17408
    ds_read_b64 v[108:109], v6 offset:17920
    ds_read_b64 v[110:111], v6 offset:18432
    ds_read_b64 v[112:113], v6 offset:18944
    ds_read_b64 v[114:115], v6 offset:19456
    ds_read_b64 v[116:117], v6 offset:19968
    ds_read_b64 v[118:119], v6 offset:20480
    ds_read_b64 v[120:121], v6 offset:20992
    ds_read_b64 v[122:123], v6 offset:21504
    ds_read_b64 v[124:125], v6 offset:22016
    ds_read_b64 v[126:127], v6 offset:22528
    s_add_u32 s32, s32, 256
    s_add_u32 s33, s33, 40960000
    s_add_u32 s34, s34, 20480000
    s_add_u32 s40, s40, 1
    s_cmp_lt_u32 s40, 4
    s_cbranch_scc1 L_p1_loop
    s_waitcnt lgkmcnt(13)
    v_lshlrev_b32 v15, 22, v100
    v_lshrrev_b32 v100, 16, v100
    v_alignbit_b32 v15, v100, v15, 10
    v_alignbit_b32 v15, v101, v15, 10
    v_xor_b32 v15, 0x80200800, v15
    s_cmp_lg_u32 s39, 15
    s_cbranch_scc1 L_p1_kernel_nox_11
    s_mov_b32 s36, 13631488
    buffer_store_dwordx4 v[12:15], v3, s[20:23], s36 offen sc1
L_p1_kernel_nox_11:
    s_waitcnt lgkmcnt(12)
    v_lshlrev_b32 v75, 22, v102
    v_lshrrev_b32 v102, 16, v102
    v_alignbit_b32 v75, v102, v75, 10
    v_alignbit_b32 v75, v103, v75, 10
    v_xor_b32 v75, 0x80200800, v75
    s_mov_b32 s36, 0
    buffer_store_dwordx4 v[72:75], v3, s[20:23], s36 offen sc1
    s_waitcnt lgkmcnt(11)
    v_lshlrev_b32 v79, 22, v104
    v_lshrrev_b32 v104, 16, v104
    v_alignbit_b32 v79, v104, v79, 10
    v_alignbit_b32 v79, v105, v79, 10
    v_xor_b32 v79, 0x80200800, v79
    s_mov_b32 s36, 1048576
    buffer_store_dwordx4 v[76:79], v3, s[20:23], s36 offen sc1
    s_waitcnt lgkmcnt(10)
    v_lshlrev_b32 v51, 22, v106
    v_lshrrev_b32 v106, 16, v106
    v_alignbit_b32 v51, v106, v51, 10
    v_alignbit_b32 v51, v107, v51, 10
    v_xor_b32 v51, 0x80200800, v51
    s_mov_b32 s36, 2097152
    buffer_store_dwordx4 v[48:51], v3, s[20:23], s36 offen sc1
    s_waitcnt lgkmcnt(9)
    v_lshlrev_b32 v83, 22, v108
    v_lshrrev_b32 v108, 16, v108
    v_alignbit_b32 v83, v108, v83, 10
    v_alignbit_b32 v83, v109, v83, 10
    v_xor_b32 v83, 0x80200800, v83
    s_mov_b32 s36, 3145728
    buffer_store_dwordx4 v[80:83], v3, s[20:23], s36 offen sc1
    s_waitcnt lgkmcnt(8)
    v_lshlrev_b32 v55, 22, v110
    v_lshrrev_b32 v110, 16, v110
    v_alignbit_b32 v55, v110, v55, 10
    v_alignbit_b32 v55, v111, v55, 10
    v_xor_b32 v55, 0x80200800, v55
    s_mov_b32 s36, 4194304
    buffer_store_dwordx4 v[52:55], v3, s[20:23], s36 offen sc1
    s_waitcnt lgkmcnt(7)
    v_lshlrev_b32 v87, 22, v112
    v_lshrrev_b32 v112, 16, v112
    v_alignbit_b32 v87, v112, v87, 10
    v_alignbit_b32 v87, v113, v87, 10
    v_xor_b32 v87, 0x80200800, v87
    s_mov_b32 s36, 5242880
    buffer_store_dwordx4 v[84:87], v3, s[20:23], s36 offen sc1
    s_waitcnt lgkmcnt(6)
    v_lshlrev_b32 v59, 22, v114
    v_lshrrev_b32 v114, 16, v114
    v_alignbit_b32 v59, v114, v59, 10
    v_alignbit_b32 v59, v115, v59, 10
    v_xor_b32 v59, 0x80200800, v59
    s_mov_b32 s36, 6291456
    buffer_store_dwordx4 v[56:59], v3, s[20:23], s36 offen sc1
    s_waitcnt lgkmcnt(5)
    v_lshlrev_b32 v91, 22, v116
    v_lshrrev_b32 v116, 16, v116
    v_alignbit_b32 v91, v116, v91, 10
    v_alignbit_b32 v91, v117, v91, 10
    v_xor_b32 v91, 0x80200800, v91
    s_mov_b32 s36, 7340032
    buffer_store_dwordx4 v[88:91], v3, s[20:23], s36 offen sc1
    s_waitcnt lgkmcnt(4)
    v_lshlrev_b32 v63, 22, v118
    v_lshrrev_b32 v118, 16, v118
    v_alignbit_b32 v63, v118, v63, 10
    v_alignbit_b32 v63, v119, v63, 10
    v_xor_b32 v63, 0x80200800, v63
    s_mov_b32 s36, 8388608
    buffer_store_dwordx4 v[60:63], v3, s[20:23], s36 offen sc1
    s_waitcnt lgkmcnt(3)
    v_lshlrev_b32 v95, 22, v120
    v_lshrrev_b32 v120, 16, v120
    v_alignbit_b32 v95, v120, v95, 10
    v_alignbit_b32 v95, v121, v95, 10
    v_xor_b32 v95, 0x80200800, v95
    s_mov_b32 s36, 9437184
    buffer_store_dwordx4 v[92:95], v3, s[20:23], s36 offen sc1
    s_waitcnt lgkmcnt(2)
    v_lshlrev_b32 v67, 22, v122
    v_lshrrev_b32 v122, 16, v122
    v_alignbit_b32 v67, v122, v67, 10
    v_alignbit_b32 v67, v123, v67, 10
    v_xor_b32 v67, 0x80200800, v67
    s_mov_b32 s36, 10485760
    buffer_store_dwordx4 v[64:67], v3, s[20:23], s36 offen sc1
    s_waitcnt lgkmcnt(1)
    v_lshlrev_b32 v99, 22, v124
    v_lshrrev_b32 v124, 16, v124
    v_alignbit_b32 v99, v124, v99, 10
    v_alignbit_b32 v99, v125, v99, 10
    v_xor_b32 v99, 0x80200800, v99
    s_mov_b32 s36, 11534336
    buffer_store_dwordx4 v[96:99], v3, s[20:23], s36 offen sc1
    s_waitcnt lgkmcnt(0)
    v_lshlrev_b32 v71, 22, v126
    v_lshrrev_b32 v126, 16, v126
    v_alignbit_b32 v71, v126, v71, 10
    v_alignbit_b32 v71, v127, v71, 10
    v_xor_b32 v71, 0x80200800, v71
    s_mov_b32 s36, 12582912
    buffer_store_dwordx4 v[68:71], v3, s[20:23], s36 offen sc1
    v_and_b32 v6, 0x34800000, v5
    v_cmp_ne_u32 vcc, 0, v6
    s_lshl_b32 s35, s39, 4
    s_add_u32 s35, s35, 160328
    v_mov_b32 v10, s35
    s_cmp_lg_u64 vcc, 0
    s_cselect_b32 s36, 1, s55
    v_mov_b32 v11, s36
    ds_write_b32 v10, v11
    s_waitcnt lgkmcnt(0)
    s_barrier
    s_cmp_lg_u32 s39, 0
    s_cbranch_scc1 L_p1_end
    v_and_b32 v6, 15, v0
    v_lshlrev_b32 v6, 4, v6
    v_add_u32 v6, 160320, v6
    ds_read_b128 v[8:11], v6
    s_waitcnt lgkmcnt(0)
    s_nop 1
    v_max_u32_dpp v8, v8, v8 row_shr:1 row_mask:0xf bank_mask:0xf bound_ctrl:0
    s_nop 1
    v_max_u32_dpp v8, v8, v8 row_shr:2 row_mask:0xf bank_mask:0xf bound_ctrl:0
    s_nop 1
    v_max_u32_dpp v8, v8, v8 row_shr:4 row_mask:0xf bank_mask:0xf bound_ctrl:0
    s_nop 1
    v_max_u32_dpp v8, v8, v8 row_shr:8 row_mask:0xf bank_mask:0xf bound_ctrl:0
    s_nop 1
    v_add_f32_dpp v9, v9, v9 row_shr:1 row_mask:0xf bank_mask:0xf bound_ctrl:0
    s_nop 1
    v_add_f32_dpp v9, v9, v9 row_shr:2 row_mask:0xf bank_mask:0xf bound_ctrl:0
    s_nop 1
    v_add_f32_dpp v9, v9, v9 row_shr:4 row_mask:0xf bank_mask:0xf bound_ctrl:0
    s_nop 1
    v_add_f32_dpp v9, v9, v9 row_shr:8 row_mask:0xf bank_mask:0xf bound_ctrl:0
    s_nop 1
    v_or_b32_dpp v10, v10, v10 row_shr:1 row_mask:0xf bank_mask:0xf bound_ctrl:0
    s_nop 1
    v_or_b32_dpp v10, v10, v10 row_shr:2 row_mask:0xf bank_mask:0xf bound_ctrl:0
    s_nop 1
    v_or_b32_dpp v10, v10, v10 row_shr:4 row_mask:0xf bank_mask:0xf bound_ctrl:0
    s_nop 1
    v_or_b32_dpp v10, v10, v10 row_shr:8 row_mask:0xf bank_mask:0xf bound_ctrl:0
    s_lshl_b32 s35, s2, 3
    s_add_u32 s35, s35, 8552960
    v_mov_b32 v6, 0
    v_lshl_or_b32 v8, v10, 16, v8
    s_mov_b64 exec, 0x8000
    buffer_store_dwordx2 v[8:9], v6, s[24:27], s35 offen
    s_lshl_b32 s35, s2, 8
    s_add_u32 s35, s35, 8557056
    buffer_store_dword v6, v6, s[24:27], s35 offen
L_p1_end:
    s_endpgm
.globl p2_kernel
.p2align 8
.type p2_kernel,@function
p2_kernel:
    s_cmp_ge_u32 s2, 256
    s_cbranch_scc1 L_p2_end
    s_load_dwordx2 s[4:5], s[0:1], 104
    s_load_dwordx2 s[100:101], s[0:1], 24
    s_load_dwordx2 s[30:31], s[0:1], 40
    s_load_dwordx4 s[32:35], s[0:1], 56
    s_load_dwordx4 s[36:39], s[0:1], 72
    s_and_b32 s14, s2, 7
    s_lshr_b32 s49, s2, 3
    s_and_b32 s3, s14, 1
    s_lshl_b32 s3, s3, 5
    s_add_u32 s3, s3, s49
    s_lshr_b32 s12, s14, 1
    v_lshrrev_b32 v108, 6, v0
    v_lshlrev_b32 v1, 4, v0
    v_and_b32 v109, 63, v0
    v_readfirstlane_b32 s13, v108
    v_lshlrev_b32 v111, 4, v109
    v_lshlrev_b32 v110, 5, v0
    s_mul_i32 s14, s12, 65
    s_add_u32 s14, s14, s3
    s_mul_i32 s14, s14, 32896
    s_add_u32 s25, s14, 0
    s_mul_i32 s22, s12, 1280000
    s_mov_b32 s2, 0
    s_waitcnt lgkmcnt(0)
    s_mov_b32 s6, 655360000
    s_mov_b32 s7, 0x00020000
    s_add_u32 s8, s4, 8573440
    s_addc_u32 s9, s5, 0
    s_add_u32 s10, s22, 1280000
    s_mov_b32 s11, 0x00020000
    s_add_u32 s15, s25, 0
    buffer_load_dwordx4 v[28:31], v110, s[4:7], s15 offen
    s_add_u32 s15, s25, 32896
    buffer_load_dwordx4 v[36:39], v110, s[4:7], s15 offen
    s_add_u32 s15, s25, 16
    buffer_load_dwordx4 v[32:35], v110, s[4:7], s15 offen
    s_add_u32 s15, s25, 32912
    buffer_load_dwordx4 v[40:43], v110, s[4:7], s15 offen
    s_load_dwordx4 s[40:43], s[30:31], 0
    s_load_dwordx16 s[52:67], s[32:33], 0
    s_load_dwordx16 s[68:83], s[34:35], 0
    s_load_dwordx8 s[84:91], s[36:37], 0
    s_load_dwordx8 s[92:99], s[38:39], 0
    v_mov_b32 v52, 0x100
    s_cmp_lg_u32 s13, 0
    s_cbranch_scc1 L_p2_noann
    s_lshl_b32 s14, s3, 8
    s_add_u32 s14, s14, 8557056
    s_mov_b64 exec, 1
    buffer_atomic_add v52, off, s[4:7], s14
    s_mov_b64 exec, -1
L_p2_noann:
    s_add_u32 s14, s22, 0
    buffer_load_dwordx4 v[88:91], v1, s[8:11], s14 offen
    s_add_u32 s14, s22, 16384
    buffer_load_dwordx4 v[92:95], v1, s[8:11], s14 offen
    s_add_u32 s14, s22, 32768
    buffer_load_dwordx4 v[96:99], v1, s[8:11], s14 offen
    s_add_u32 s14, s22, 49152
    buffer_load_dwordx4 v[100:103], v1, s[8:11], s14 offen
    s_add_u32 s14, s22, 65536
    buffer_load_dwordx4 v[104:107], v1, s[8:11], s14 offen
    s_mov_b32 s15, 8552960
    buffer_load_dwordx4 v[80:83], v111, s[4:7], s15 offen offset:0
    buffer_load_dwordx4 v[84:87], v111, s[4:7], s15 offen offset:1024
    v_lshlrev_b32 v2, 10, v109
    v_mov_b32 v50, 21845
    v_add_u32 v3, 80000, v1
    v_add_u32 v124, 145536, v1
    v_add_u32 v113, 65536, v1
    v_mov_b32 v112, 0x7f000000
    v_cmp_gt_u32 vcc, 904, v0
    s_mul_i32 s19, s13, 240
    s_add_u32 s19, s19, 160000
    v_cndmask_b32 v124, v112, v124, vcc
    v_cndmask_b32 v113, v112, v113, vcc
    v_lshl_add_u32 v6, v109, 2, s19
    v_lshl_add_u32 v126, v109, 1, s19
    v_cmp_gt_u32 vcc, 10, v109
    s_lshl_b32 s27, s13, 16
    s_mov_b32 s23, 1024
    v_cndmask_b32 v6, v112, v6, vcc
    s_add_u32 s44, s4, 9437184
    s_addc_u32 s45, s5, 1048576
    s_mov_b32 s46, 14024704
    s_mov_b32 s47, 0x00020000
    s_mov_b32 s17, 0x05040100
    s_mov_b32 s18, 80000
    s_and_b32 s50, s3, 1
    s_lshl_b32 s50, s50, 18
    s_sub_u32 s50, 4294836224, s50
    s_mov_b32 s20, 3221209088
    s_mov_b32 s21, 3221209087
    v_mov_b32 v4, 0
    v_mov_b32 v5, 0
    v_mov_b32 v114, 0xff00
    ds_write_b32 v6, v5 offset:160
    ds_write_b16 v126, v114 offset:2
    v_mov_b32 v44, 1073758208
    v_mov_b32 v45, 1073758208
    v_mov_b32 v46, 1073758208
    v_mov_b32 v47, 1073758208
    v_mov_b32 v48, 1073758208
    v_mov_b32 v49, 1073758208
    ds_write_b128 v1, v[44:47] offset:0
    ds_write_b128 v1, v[44:47] offset:16384
    ds_write_b128 v1, v[44:47] offset:32768
    ds_write_b128 v1, v[44:47] offset:49152
    ds_write_b128 v113, v[44:47]
    s_waitcnt lgkmcnt(0)
    v_mov_b32 v53, s40
    v_mov_b32 v54, s41
    v_mov_b32 v56, s42
    v_mov_b32 v57, s43
    s_mov_b32 s40, 20987904
    s_mov_b32 s41, 21031594
    s_pack_ll_b32_b16 s14, s52, s54
    s_pack_hh_b32_b16 s15, s52, s54
    s_pack_ll_b32_b16 s54, s53, s55
    s_pack_hh_b32_b16 s55, s53, s55
    s_mov_b32 s52, s14
    s_mov_b32 s53, s15
    s_pack_ll_b32_b16 s14, s56, s58
    s_pack_hh_b32_b16 s15, s56, s58
    s_pack_ll_b32_b16 s58, s57, s59
    s_pack_hh_b32_b16 s59, s57, s59
    s_mov_b32 s56, s14
    s_mov_b32 s57, s15
    s_pack_ll_b32_b16 s14, s60, s62
    s_pack_hh_b32_b16 s15, s60, s62
    s_pack_ll_b32_b16 s62, s61, s63
    s_pack_hh_b32_b16 s63, s61, s63
    s_mov_b32 s60, s14
    s_mov_b32 s61, s15
    s_pack_ll_b32_b16 s14, s64, s66
    s_pack_hh_b32_b16 s15, s64, s66
    s_pack_ll_b32_b16 s66, s65, s67
    s_pack_hh_b32_b16 s67, s65, s67
    s_mov_b32 s64, s14
    s_mov_b32 s65, s15
    s_pack_ll_b32_b16 s14, s68, s70
    s_pack_hh_b32_b16 s15, s68, s70
    s_pack_ll_b32_b16 s70, s69, s71
    s_pack_hh_b32_b16 s71, s69, s71
    s_mov_b32 s68, s14
    s_mov_b32 s69, s15
    s_pack_ll_b32_b16 s14, s72, s74
    s_pack_hh_b32_b16 s15, s72, s74
    s_pack_ll_b32_b16 s74, s73, s75
    s_pack_hh_b32_b16 s75, s73, s75
    s_mov_b32 s72, s14
    s_mov_b32 s73, s15
    s_pack_ll_b32_b16 s14, s76, s78
    s_pack_hh_b32_b16 s15, s76, s78
    s_pack_ll_b32_b16 s78, s77, s79
    s_pack_hh_b32_b16 s79, s77, s79
    s_mov_b32 s76, s14
    s_mov_b32 s77, s15
    s_pack_ll_b32_b16 s14, s80, s82
    s_pack_hh_b32_b16 s15, s80, s82
    s_pack_ll_b32_b16 s82, s81, s83
    s_pack_hh_b32_b16 s83, s81, s83
    s_mov_b32 s80, s14
    s_mov_b32 s81, s15
    s_waitcnt vmcnt(9)
    v_mad_u32_u16 v108, v28, v50, s40 op_sel:[0,0,0,0]
    v_mad_u32_u16 v109, v36, v50, s41 op_sel:[0,0,0,0]
    v_sub_u32_sdwa v110, v109, v108 dst_sel:DWORD dst_unused:UNUSED_PAD src0_sel:WORD_1 src1_sel:WORD_1
    s_nop 1
    v_add_u32_dpp v110, v110, v110 row_shr:1 row_mask:0xf bank_mask:0xf bound_ctrl:0
    s_nop 1
    v_add_u32_dpp v110, v110, v110 row_shr:2 row_mask:0xf bank_mask:0xf bound_ctrl:0
    s_nop 1
    v_add_u32_dpp v110, v110, v110 row_shr:4 row_mask:0xf bank_mask:0xf bound_ctrl:0
    s_nop 1
    v_add_u32_dpp v110, v110, v110 row_shr:8 row_mask:0xf bank_mask:0xf bound_ctrl:0
    s_nop 1
    v_add_u32_dpp v110, v110, v110 row_bcast:15 row_mask:0xa bank_mask:0xf
    s_nop 1
    v_add_u32_dpp v110, v110, v110 row_bcast:31 row_mask:0xc bank_mask:0xf
    v_sub_u32_sdwa v109, v109, v110 dst_sel:DWORD dst_unused:UNUSED_PAD src0_sel:WORD_1 src1_sel:DWORD
    v_readlane_b32 s29, v110, 63
    v_add_u32 v110, -1, v110
    ds_write_b16 v126, v109
    v_lshlrev_b32_e64 v111, v110, 1
    v_lshrrev_b32 v110, 5, v110
    v_lshl_add_u32 v110, v110, 2, s19
    s_cmp_gt_u32 s29, 320
    s_cselect_b32 s2, 1, s2
    s_cselect_b64 exec, 0, -1
    ds_or_b32 v110, v111 offset:160
    s_mov_b64 exec, -1
    ds_wrxchg_rtn_b32 v7, v6, v5 offset:160
    s_waitcnt lgkmcnt(0)
    v_readlane_b32 s30, v7, 0
    v_readlane_b32 s31, v7, 1
    v_readlane_b32 s32, v7, 2
    v_readlane_b32 s33, v7, 3
    v_readlane_b32 s34, v7, 4
    v_readlane_b32 s35, v7, 5
    v_readlane_b32 s36, v7, 6
    v_readlane_b32 s37, v7, 7
    s_mov_b32 s25, s19
    s_mov_b32 s26, s27
    s_mov_b32 s51, s28
    s_mov_b32 s28, s29
    v_mbcnt_lo_u32_b32 v8, s30, 0
    v_mbcnt_hi_u32_b32 v8, s31, v8
    s_bcnt1_i32_b64 s14, s[30:31]
    v_lshl_add_u32 v9, v8, 1, s25
    ds_read_u16 v9, v9
    s_add_u32 s30, s26, 0
    s_lshl1_add_u32 s25, s14, s25
    s_lshl_b32 s14, s14, 10
    s_add_u32 s26, s26, s14
    v_mbcnt_lo_u32_b32 v12, s32, 0
    v_mbcnt_hi_u32_b32 v12, s33, v12
    s_bcnt1_i32_b64 s14, s[32:33]
    v_lshl_add_u32 v13, v12, 1, s25
    ds_read_u16 v13, v13
    s_add_u32 s32, s26, 1048576
    s_lshl1_add_u32 s25, s14, s25
    s_lshl_b32 s14, s14, 10
    s_add_u32 s26, s26, s14
    v_mbcnt_lo_u32_b32 v16, s34, 0
    v_mbcnt_hi_u32_b32 v16, s35, v16
    s_bcnt1_i32_b64 s14, s[34:35]
    v_lshl_add_u32 v17, v16, 1, s25
    ds_read_u16 v17, v17
    s_add_u32 s34, s26, 2097152
    s_lshl1_add_u32 s25, s14, s25
    s_lshl_b32 s14, s14, 10
    s_add_u32 s26, s26, s14
    v_mbcnt_lo_u32_b32 v20, s36, 0
    v_mbcnt_hi_u32_b32 v20, s37, v20
    s_bcnt1_i32_b64 s14, s[36:37]
    v_lshl_add_u32 v21, v20, 1, s25
    ds_read_u16 v21, v21
    s_add_u32 s36, s26, 3145728
    s_lshl1_add_u32 s25, s14, s25
    s_lshl_b32 s14, s14, 10
    s_add_u32 s26, s26, s14
    s_waitcnt lgkmcnt(3)
    v_mad_u32_u16 v9, v9, s23, v2
    v_pk_lshrrev_b16 v9, 10, v9 op_sel_hi:[1,1]
    v_lshl_add_u32 v8, v8, 6, v9
    buffer_load_dwordx4 v[8:11], v8, s[44:47], s30 idxen
    s_waitcnt lgkmcnt(2)
    v_mad_u32_u16 v13, v13, s23, v2
    v_pk_lshrrev_b16 v13, 10, v13 op_sel_hi:[1,1]
    v_lshl_add_u32 v12, v12, 6, v13
    buffer_load_dwordx4 v[12:15], v12, s[44:47], s32 idxen
    s_waitcnt lgkmcnt(1)
    v_mad_u32_u16 v17, v17, s23, v2
    v_pk_lshrrev_b16 v17, 10, v17 op_sel_hi:[1,1]
    v_lshl_add_u32 v16, v16, 6, v17
    buffer_load_dwordx4 v[16:19], v16, s[44:47], s34 idxen
    s_waitcnt lgkmcnt(0)
    v_mad_u32_u16 v21, v21, s23, v2
    v_pk_lshrrev_b16 v21, 10, v21 op_sel_hi:[1,1]
    v_lshl_add_u32 v20, v20, 6, v21
    buffer_load_dwordx4 v[20:23], v20, s[44:47], s36 idxen
    s_cmp_le_u32 s28, 256
    s_cbranch_scc1 L_p2_kernel_noopt_1
    v_readlane_b32 s38, v7, 8
    v_readlane_b32 s39, v7, 9
    s_nop 1
    v_mbcnt_lo_u32_b32 v120, s38, 0
    v_mbcnt_hi_u32_b32 v120, s39, v120
    s_bcnt1_i32_b64 s14, s[38:39]
    v_lshl_add_u32 v121, v120, 1, s25
    ds_read_u16 v121, v121
    s_add_u32 s38, s26, 4194304
    s_lshl1_add_u32 s25, s14, s25
    s_lshl_b32 s14, s14, 10
    s_add_u32 s26, s26, s14
    s_waitcnt lgkmcnt(0)
    v_mad_u32_u16 v121, v121, s23, v2
    v_pk_lshrrev_b16 v121, 10, v121 op_sel_hi:[1,1]
    v_lshl_add_u32 v120, v120, 6, v121
    buffer_load_dwordx4 v[24:27], v120, s[44:47], s38 idxen
L_p2_kernel_noopt_1:
    s_waitcnt vmcnt(6)
    ds_write_b128 v3, v[88:91] offset:0
    ds_write_b128 v3, v[92:95] offset:16384
    ds_write_b128 v3, v[96:99] offset:32768
    ds_write_b128 v3, v[100:103] offset:49152
    ds_write_b128 v124, v[104:107] offset:0
    s_waitcnt vmcnt(4)
    v_max3_u32 v64, v80, v82, v84
    v_add_f32 v65, v81, v83
    v_add_f32 v66, v85, v87
    v_max_u32 v64, v64, v86
    v_add_f32 v65, v65, v66
    v_cmp_lt_u32 vcc, 0xffff, v64
    s_nop 1
    v_max_u32_dpp v64, v64, v64 row_shr:1 row_mask:0xf bank_mask:0xf bound_ctrl:0
    s_nop 1
    v_max_u32_dpp v64, v64, v64 row_shr:2 row_mask:0xf bank_mask:0xf bound_ctrl:0
    s_nop 1
    v_max_u32_dpp v64, v64, v64 row_shr:4 row_mask:0xf bank_mask:0xf bound_ctrl:0
    s_nop 1
    v_max_u32_dpp v64, v64, v64 row_shr:8 row_mask:0xf bank_mask:0xf bound_ctrl:0
    s_nop 1
    v_max_u32_dpp v64, v64, v64 row_bcast:15 row_mask:0xa bank_mask:0xf
    s_nop 1
    v_max_u32_dpp v64, v64, v64 row_bcast:31 row_mask:0xc bank_mask:0xf
    s_nop 1
    v_add_f32_dpp v65, v65, v65 row_shr:1 row_mask:0xf bank_mask:0xf bound_ctrl:0
    s_nop 1
    v_add_f32_dpp v65, v65, v65 row_shr:2 row_mask:0xf bank_mask:0xf bound_ctrl:0
    s_nop 1
    v_add_f32_dpp v65, v65, v65 row_shr:4 row_mask:0xf bank_mask:0xf bound_ctrl:0
    s_nop 1
    v_add_f32_dpp v65, v65, v65 row_shr:8 row_mask:0xf bank_mask:0xf bound_ctrl:0
    s_nop 1
    v_add_f32_dpp v65, v65, v65 row_bcast:15 row_mask:0xa bank_mask:0xf
    s_nop 1
    v_add_f32_dpp v65, v65, v65 row_bcast:31 row_mask:0xc bank_mask:0xf
    s_cmp_lg_u64 vcc, 0
    s_cselect_b32 s2, 1, s2
    v_lshlrev_b32 v64, 16, v64
    v_mul_f32 v66, 936490775, v65
    v_mul_f32 v65, 928531664, v65
    v_cmp_nle_f32 vcc, v64, v66
    v_max_u32 v64, v64, v65
    s_nop 0
    v_readlane_b32 s14, v64, 63
    s_bitcmp1_b32 vcc_hi, 31
    s_cselect_b32 s2, 1, s2
    s_lshr_b32 s14, s14, 23
    s_add_u32 s14, s14, 1
    s_cmp_lt_u32 s14, 40
    s_cselect_b32 s2, 1, s2
    s_cmp_gt_u32 s14, 230
    s_cselect_b32 s2, 1, s2
    s_sub_u32 s48, s14, 14
    s_lshl_b32 s48, s48, 23
    s_add_u32 s16, s48, 272646144
    s_or_b32 s48, s48, 16416
    s_sub_u32 s14, s14, 40
    s_cmp_gt_u32 s14, 190
    s_cselect_b32 s48, 0, s48
    s_waitcnt lgkmcnt(0)
    s_barrier
    s_add_u32 s14, s22, 80000
    buffer_load_dwordx4 v[88:91], v1, s[8:11], s14 offen
    s_add_u32 s14, s22, 96384
    buffer_load_dwordx4 v[92:95], v1, s[8:11], s14 offen
    v_mad_u32_u16 v108, v28, v50, s40 op_sel:[1,0,0,0]
    v_mad_u32_u16 v109, v36, v50, s41 op_sel:[1,0,0,0]
    v_sub_u32_sdwa v110, v109, v108 dst_sel:DWORD dst_unused:UNUSED_PAD src0_sel:WORD_1 src1_sel:WORD_1
    s_nop 1
    v_add_u32_dpp v110, v110, v110 row_shr:1 row_mask:0xf bank_mask:0xf bound_ctrl:0
    s_nop 1
    v_add_u32_dpp v110, v110, v110 row_shr:2 row_mask:0xf bank_mask:0xf bound_ctrl:0
    s_nop 1
    v_add_u32_dpp v110, v110, v110 row_shr:4 row_mask:0xf bank_mask:0xf bound_ctrl:0
    s_nop 1
    v_add_u32_dpp v110, v110, v110 row_shr:8 row_mask:0xf bank_mask:0xf bound_ctrl:0
    s_nop 1
    v_add_u32_dpp v110, v110, v110 row_bcast:15 row_mask:0xa bank_mask:0xf
    s_nop 1
    v_add_u32_dpp v110, v110, v110 row_bcast:31 row_mask:0xc bank_mask:0xf
    v_sub_u32_sdwa v109, v109, v110 dst_sel:DWORD dst_unused:UNUSED_PAD src0_sel:WORD_1 src1_sel:DWORD
    v_readlane_b32 s29, v110, 63
    v_add_u32 v110, -1, v110
    ds_write_b16 v126, v109
    v_lshlrev_b32_e64 v111, v110, 1
    v_lshrrev_b32 v110, 5, v110
    v_lshl_add_u32 v110, v110, 2, s19
    s_cmp_gt_u32 s29, 320
    s_cselect_b32 s2, 1, s2
    s_cselect_b64 exec, 0, -1
    ds_or_b32 v110, v111 offset:160
    s_mov_b64 exec, -1
    ds_wrxchg_rtn_b32 v7, v6, v5 offset:160
    s_mov_b32 s24, 0
L_p2_loop:
    s_add_u32 s22, s22, 80000
    s_lshl_b32 s14, s13, 4
    s_or_b32 s14, s14, s24
    s_cmp_lg_u32 s14, 5
    s_cbranch_scc1 L_p2_nost
    v_mov_b32 v52, 0
    s_lshl_b32 s14, s3, 8
    s_add_u32 s14, s14, 8557056
    s_mov_b64 exec, 1
    buffer_atomic_add v52, off, s[4:7], s14 sc0
    s_mov_b64 exec, -1
L_p2_nost:
    s_waitcnt vmcnt(5)
    v_mad_u32_u16 v64, v8, 8, s18
    v_mad_u32_u16 v66, v9, 8, s18
    v_mad_u32_u16 v68, v10, 8, s18
    ds_read_b64 v[64:65], v64
    ds_read_b64 v[66:67], v66
    ds_read_b64 v[68:69], v68
    s_add_u32 s14, s22, 32768
    buffer_load_dwordx4 v[96:99], v1, s[8:11], s14 offen
    s_waitcnt vmcnt(5)
    v_mad_u32_u16 v70, v12, 8, s18
    v_mad_u32_u16 v72, v13, 8, s18
    v_mad_u32_u16 v74, v14, 8, s18
    ds_read_b64 v[70:71], v70
    ds_read_b64 v[72:73], v72
    ds_read_b64 v[74:75], v74
    s_add_u32 s14, s22, 49152
    buffer_load_dwordx4 v[100:103], v1, s[8:11], s14 offen
    s_waitcnt lgkmcnt(6)
    v_readlane_b32 s30, v7, 0
    v_readlane_b32 s31, v7, 1
    v_readlane_b32 s32, v7, 2
    v_readlane_b32 s33, v7, 3
    v_readlane_b32 s34, v7, 4
    v_readlane_b32 s35, v7, 5
    v_readlane_b32 s36, v7, 6
    v_readlane_b32 s37, v7, 7
    s_mov_b32 s25, s19
    s_mov_b32 s26, s27
    s_mov_b32 s51, s28
    s_mov_b32 s28, s29
    v_mbcnt_lo_u32_b32 v118, s30, 0
    v_mbcnt_hi_u32_b32 v118, s31, v118
    s_bcnt1_i32_b64 s14, s[30:31]
    v_lshl_add_u32 v119, v118, 1, s25
    ds_read_u16 v119, v119
    s_add_u32 s30, s26, 0
    s_lshl1_add_u32 s25, s14, s25
    s_lshl_b32 s14, s14, 10
    s_add_u32 s26, s26, s14
    v_bfe_i32 v108, v11, 2, 10
    v_bfe_i32 v109, v11, 12, 10
    v_ashrrev_i32 v110, 22, v11
    v_cvt_f32_i32 v108, v108
    v_cvt_f32_i32 v109, v109
    v_cvt_f32_i32 v110, v110
    v_mad_u32_u16 v8, v8, 8, s50 op_sel:[1,0,0,0]
    v_mad_u32_u16 v9, v9, 8, s50 op_sel:[1,0,0,0]
    v_mad_u32_u16 v10, v10, 8, s50 op_sel:[1,0,0,0]
    s_waitcnt lgkmcnt(4)
    v_lshlrev_b32 v112, 16, v64
    v_and_b32 v113, 0xffff0000, v64
    v_lshlrev_b32 v64, 16, v65
    v_and_b32 v65, 0xffff0000, v65
    v_lshlrev_b32 v114, 16, v66
    v_and_b32 v115, 0xffff0000, v66
    v_lshlrev_b32 v66, 16, v67
    v_and_b32 v67, 0xffff0000, v67
    v_lshlrev_b32 v116, 16, v68
    v_and_b32 v117, 0xffff0000, v68
    v_lshlrev_b32 v68, 16, v69
    v_and_b32 v69, 0xffff0000, v69
    v_pk_fma_f32 v[112:113], v[112:113], v[108:109], s[16:17] op_sel:[0,0,0] op_sel_hi:[1,0,0]
    v_pk_fma_f32 v[64:65], v[64:65], v[108:109], s[16:17] op_sel:[0,0,0] op_sel_hi:[1,0,0]
    v_pk_fma_f32 v[114:115], v[114:115], v[108:109], s[16:17] op_sel:[0,1,0] op_sel_hi:[1,1,0]
    v_pk_fma_f32 v[66:67], v[66:67], v[108:109], s[16:17] op_sel:[0,1,0] op_sel_hi:[1,1,0]
    v_pk_fma_f32 v[116:117], v[116:117], v[110:111], s[16:17] op_sel:[0,0,0] op_sel_hi:[1,0,0]
    v_pk_fma_f32 v[68:69], v[68:69], v[110:111], s[16:17] op_sel:[0,0,0] op_sel_hi:[1,0,0]
    v_perm_b32 v65, v65, v64, s17
    v_perm_b32 v64, v113, v112, s17
    v_perm_b32 v67, v67, v66, s17
    v_perm_b32 v66, v115, v114, s17
    v_perm_b32 v69, v69, v68, s17
    v_perm_b32 v68, v117, v116, s17
    v_lshl_add_u64 v[64:65], v[64:65], 0, s[20:21]
    v_lshl_add_u64 v[66:67], v[66:67], 0, s[20:21]
    v_lshl_add_u64 v[68:69], v[68:69], 0, s[20:21]
    v_or3_b32 v4, v44, v45, v4
    v_or3_b32 v4, v46, v47, v4
    v_or3_b32 v4, v48, v49, v4
    ds_add_rtn_u64 v[44:45], v8, v[64:65]
    ds_add_rtn_u64 v[46:47], v9, v[66:67]
    ds_add_rtn_u64 v[48:49], v10, v[68:69]
    s_waitcnt lgkmcnt(3)
    v_mad_u32_u16 v119, v119, s23, v2
    v_pk_lshrrev_b16 v119, 10, v119 op_sel_hi:[1,1]
    v_lshl_add_u32 v118, v118, 6, v119
    buffer_load_dwordx4 v[8:11], v118, s[44:47], s30 idxen
    s_add_u32 s14, s22, 65536
    buffer_load_dwordx4 v[104:107], v1, s[8:11], s14 offen
    s_waitcnt vmcnt(7)
    v_mad_u32_u16 v76, v16, 8, s18
    v_mad_u32_u16 v78, v17, 8, s18
    v_mad_u32_u16 v80, v18, 8, s18
    ds_read_b64 v[76:77], v76
    ds_read_b64 v[78:79], v78
    ds_read_b64 v[80:81], v80
    s_waitcnt vmcnt(6)
    v_mad_u32_u16 v82, v20, 8, s18
    v_mad_u32_u16 v84, v21, 8, s18
    v_mad_u32_u16 v86, v22, 8, s18
    ds_read_b64 v[82:83], v82
    ds_read_b64 v[84:85], v84
    ds_read_b64 v[86:87], v86
    v_mbcnt_lo_u32_b32 v118, s32, 0
    v_mbcnt_hi_u32_b32 v118, s33, v118
    s_bcnt1_i32_b64 s14, s[32:33]
    v_lshl_add_u32 v119, v118, 1, s25
    ds_read_u16 v119, v119
    s_add_u32 s32, s26, 1048576
    s_lshl1_add_u32 s25, s14, s25
    s_lshl_b32 s14, s14, 10
    s_add_u32 s26, s26, s14
    v_bfe_i32 v108, v15, 2, 10
    v_bfe_i32 v109, v15, 12, 10
    v_ashrrev_i32 v110, 22, v15
    v_cvt_f32_i32 v108, v108
    v_cvt_f32_i32 v109, v109
    v_cvt_f32_i32 v110, v110
    v_mad_u32_u16 v12, v12, 8, s50 op_sel:[1,0,0,0]
    v_mad_u32_u16 v13, v13, 8, s50 op_sel:[1,0,0,0]
    v_mad_u32_u16 v14, v14, 8, s50 op_sel:[1,0,0,0]
    v_lshlrev_b32 v112, 16, v70
    v_and_b32 v113, 0xffff0000, v70
    v_lshlrev_b32 v70, 16, v71
    v_and_b32 v71, 0xffff0000, v71
    v_lshlrev_b32 v114, 16, v72
    v_and_b32 v115, 0xffff0000, v72
    v_lshlrev_b32 v72, 16, v73
    v_and_b32 v73, 0xffff0000, v73
    v_lshlrev_b32 v116, 16, v74
    v_and_b32 v117, 0xffff0000, v74
    v_lshlrev_b32 v74, 16, v75
    v_and_b32 v75, 0xffff0000, v75
    v_pk_fma_f32 v[112:113], v[112:113], v[108:109], s[16:17] op_sel:[0,0,0] op_sel_hi:[1,0,0]
    v_pk_fma_f32 v[70:71], v[70:71], v[108:109], s[16:17] op_sel:[0,0,0] op_sel_hi:[1,0,0]
    v_pk_fma_f32 v[114:115], v[114:115], v[108:109], s[16:17] op_sel:[0,1,0] op_sel_hi:[1,1,0]
    v_pk_fma_f32 v[72:73], v[72:73], v[108:109], s[16:17] op_sel:[0,1,0] op_sel_hi:[1,1,0]
    v_pk_fma_f32 v[116:117], v[116:117], v[110:111], s[16:17] op_sel:[0,0,0] op_sel_hi:[1,0,0]
    v_pk_fma_f32 v[74:75], v[74:75], v[110:111], s[16:17] op_sel:[0,0,0] op_sel_hi:[1,0,0]
    v_perm_b32 v71, v71, v70, s17
    v_perm_b32 v70, v113, v112, s17
    v_perm_b32 v73, v73, v72, s17
    v_perm_b32 v72, v115, v114, s17
    v_perm_b32 v75, v75, v74, s17
    v_perm_b32 v74, v117, v116, s17
    v_lshl_add_u64 v[70:71], v[70:71], 0, s[20:21]
    v_lshl_add_u64 v[72:73], v[72:73], 0, s[20:21]
    v_lshl_add_u64 v[74:75], v[74:75], 0, s[20:21]
    s_waitcnt lgkmcnt(7)
    v_or3_b32 v4, v44, v45, v4
    v_or3_b32 v4, v46, v47, v4
    v_or3_b32 v4, v48, v49, v4
    ds_add_rtn_u64 v[44:45], v12, v[70:71]
    ds_add_rtn_u64 v[46:47], v13, v[72:73]
    ds_add_rtn_u64 v[48:49], v14, v[74:75]
    s_waitcnt lgkmcnt(3)
    v_mad_u32_u16 v119, v119, s23, v2
    v_pk_lshrrev_b16 v119, 10, v119 op_sel_hi:[1,1]
    v_lshl_add_u32 v118, v118, 6, v119
    buffer_load_dwordx4 v[12:15], v118, s[44:47], s32 idxen
    s_cmp_le_u32 s51, 256
    s_cbranch_scc1 L_p2_kernel_noopt2_2
    v_mad_u32_u16 v64, v24, 8, s18
    v_mad_u32_u16 v66, v25, 8, s18
    v_mad_u32_u16 v68, v26, 8, s18
    ds_read_b64 v[64:65], v64
    ds_read_b64 v[66:67], v66
    ds_read_b64 v[68:69], v68
    v_bfe_i32 v108, v27, 2, 10
    v_bfe_i32 v109, v27, 12, 10
    v_ashrrev_i32 v110, 22, v27
    v_cvt_f32_i32 v108, v108
    v_cvt_f32_i32 v109, v109
    v_cvt_f32_i32 v110, v110
    v_mad_u32_u16 v24, v24, 8, s50 op_sel:[1,0,0,0]
    v_mad_u32_u16 v25, v25, 8, s50 op_sel:[1,0,0,0]
    v_mad_u32_u16 v26, v26, 8, s50 op_sel:[1,0,0,0]
    s_waitcnt lgkmcnt(0)
    v_lshlrev_b32 v112, 16, v64
    v_and_b32 v113, 0xffff0000, v64
    v_lshlrev_b32 v64, 16, v65
    v_and_b32 v65, 0xffff0000, v65
    v_lshlrev_b32 v114, 16, v66
    v_and_b32 v115, 0xffff0000, v66
    v_lshlrev_b32 v66, 16, v67
    v_and_b32 v67, 0xffff0000, v67
    v_lshlrev_b32 v116, 16, v68
    v_and_b32 v117, 0xffff0000, v68
    v_lshlrev_b32 v68, 16, v69
    v_and_b32 v69, 0xffff0000, v69
    v_pk_fma_f32 v[112:113], v[112:113], v[108:109], s[16:17] op_sel:[0,0,0] op_sel_hi:[1,0,0]
    v_pk_fma_f32 v[64:65], v[64:65], v[108:109], s[16:17] op_sel:[0,0,0] op_sel_hi:[1,0,0]
    v_pk_fma_f32 v[114:115], v[114:115], v[108:109], s[16:17] op_sel:[0,1,0] op_sel_hi:[1,1,0]
    v_pk_fma_f32 v[66:67], v[66:67], v[108:109], s[16:17] op_sel:[0,1,0] op_sel_hi:[1,1,0]
    v_pk_fma_f32 v[116:117], v[116:117], v[110:111], s[16:17] op_sel:[0,0,0] op_sel_hi:[1,0,0]
    v_pk_fma_f32 v[68:69], v[68:69], v[110:111], s[16:17] op_sel:[0,0,0] op_sel_hi:[1,0,0]
    v_perm_b32 v65, v65, v64, s17
    v_perm_b32 v64, v113, v112, s17
    v_perm_b32 v67, v67, v66, s17
    v_perm_b32 v66, v115, v114, s17
    v_perm_b32 v69, v69, v68, s17
    v_perm_b32 v68, v117, v116, s17
    v_lshl_add_u64 v[64:65], v[64:65], 0, s[20:21]
    v_lshl_add_u64 v[66:67], v[66:67], 0, s[20:21]
    v_lshl_add_u64 v[68:69], v[68:69], 0, s[20:21]
    v_or3_b32 v4, v44, v45, v4
    v_or3_b32 v4, v46, v47, v4
    v_or3_b32 v4, v48, v49, v4
    ds_add_rtn_u64 v[44:45], v24, v[64:65]
    ds_add_rtn_u64 v[46:47], v25, v[66:67]
    ds_add_rtn_u64 v[48:49], v26, v[68:69]
L_p2_kernel_noopt2_2:
    s_barrier
    s_waitcnt vmcnt(1)
    ds_write_b128 v3, v[88:91] offset:0
    ds_write_b128 v3, v[92:95] offset:16384
    ds_write_b128 v3, v[96:99] offset:32768
    ds_write_b128 v3, v[100:103] offset:49152
    ds_write_b128 v124, v[104:107] offset:0
    v_mbcnt_lo_u32_b32 v118, s34, 0
    v_mbcnt_hi_u32_b32 v118, s35, v118
    s_bcnt1_i32_b64 s14, s[34:35]
    v_lshl_add_u32 v119, v118, 1, s25
    ds_read_u16 v119, v119
    s_add_u32 s34, s26, 2097152
    s_lshl1_add_u32 s25, s14, s25
    s_lshl_b32 s14, s14, 10
    s_add_u32 s26, s26, s14
    v_bfe_i32 v108, v19, 2, 10
    v_bfe_i32 v109, v19, 12, 10
    v_ashrrev_i32 v110, 22, v19
    v_cvt_f32_i32 v108, v108
    v_cvt_f32_i32 v109, v109
    v_cvt_f32_i32 v110, v110
    v_mad_u32_u16 v16, v16, 8, s50 op_sel:[1,0,0,0]
    v_mad_u32_u16 v17, v17, 8, s50 op_sel:[1,0,0,0]
    v_mad_u32_u16 v18, v18, 8, s50 op_sel:[1,0,0,0]
    v_lshlrev_b32 v112, 16, v76
    v_and_b32 v113, 0xffff0000, v76
    v_lshlrev_b32 v76, 16, v77
    v_and_b32 v77, 0xffff0000, v77
    v_lshlrev_b32 v114, 16, v78
    v_and_b32 v115, 0xffff0000, v78
    v_lshlrev_b32 v78, 16, v79
    v_and_b32 v79, 0xffff0000, v79
    v_lshlrev_b32 v116, 16, v80
    v_and_b32 v117, 0xffff0000, v80
    v_lshlrev_b32 v80, 16, v81
    v_and_b32 v81, 0xffff0000, v81
    v_pk_fma_f32 v[112:113], v[112:113], v[108:109], s[16:17] op_sel:[0,0,0] op_sel_hi:[1,0,0]
    v_pk_fma_f32 v[76:77], v[76:77], v[108:109], s[16:17] op_sel:[0,0,0] op_sel_hi:[1,0,0]
    v_pk_fma_f32 v[114:115], v[114:115], v[108:109], s[16:17] op_sel:[0,1,0] op_sel_hi:[1,1,0]
    v_pk_fma_f32 v[78:79], v[78:79], v[108:109], s[16:17] op_sel:[0,1,0] op_sel_hi:[1,1,0]
    v_pk_fma_f32 v[116:117], v[116:117], v[110:111], s[16:17] op_sel:[0,0,0] op_sel_hi:[1,0,0]
    v_pk_fma_f32 v[80:81], v[80:81], v[110:111], s[16:17] op_sel:[0,0,0] op_sel_hi:[1,0,0]
    v_perm_b32 v77, v77, v76, s17
    v_perm_b32 v76, v113, v112, s17
    v_perm_b32 v79, v79, v78, s17
    v_perm_b32 v78, v115, v114, s17
    v_perm_b32 v81, v81, v80, s17
    v_perm_b32 v80, v117, v116, s17
    v_lshl_add_u64 v[76:77], v[76:77], 0, s[20:21]
    v_lshl_add_u64 v[78:79], v[78:79], 0, s[20:21]
    v_lshl_add_u64 v[80:81], v[80:81], 0, s[20:21]
    s_waitcnt lgkmcnt(6)
    v_or3_b32 v4, v44, v45, v4
    v_or3_b32 v4, v46, v47, v4
    v_or3_b32 v4, v48, v49, v4
    ds_add_rtn_u64 v[44:45], v16, v[76:77]
    ds_add_rtn_u64 v[46:47], v17, v[78:79]
    ds_add_rtn_u64 v[48:49], v18, v[80:81]
    s_waitcnt lgkmcnt(3)
    v_mad_u32_u16 v119, v119, s23, v2
    v_pk_lshrrev_b16 v119, 10, v119 op_sel_hi:[1,1]
    v_lshl_add_u32 v118, v118, 6, v119
    buffer_load_dwordx4 v[16:19], v118, s[44:47], s34 idxen
    v_mbcnt_lo_u32_b32 v118, s36, 0
    v_mbcnt_hi_u32_b32 v118, s37, v118
    s_bcnt1_i32_b64 s14, s[36:37]
    v_lshl_add_u32 v119, v118, 1, s25
    ds_read_u16 v119, v119
    s_add_u32 s36, s26, 3145728
    s_lshl1_add_u32 s25, s14, s25
    s_lshl_b32 s14, s14, 10
    s_add_u32 s26, s26, s14
    v_bfe_i32 v108, v23, 2, 10
    v_bfe_i32 v109, v23, 12, 10
    v_ashrrev_i32 v110, 22, v23
    v_cvt_f32_i32 v108, v108
    v_cvt_f32_i32 v109, v109
    v_cvt_f32_i32 v110, v110
    v_mad_u32_u16 v20, v20, 8, s50 op_sel:[1,0,0,0]
    v_mad_u32_u16 v21, v21, 8, s50 op_sel:[1,0,0,0]
    v_mad_u32_u16 v22, v22, 8, s50 op_sel:[1,0,0,0]
    v_lshlrev_b32 v112, 16, v82
    v_and_b32 v113, 0xffff0000, v82
    v_lshlrev_b32 v82, 16, v83
    v_and_b32 v83, 0xffff0000, v83
    v_lshlrev_b32 v114, 16, v84
    v_and_b32 v115, 0xffff0000, v84
    v_lshlrev_b32 v84, 16, v85
    v_and_b32 v85, 0xffff0000, v85
    v_lshlrev_b32 v116, 16, v86
    v_and_b32 v117, 0xffff0000, v86
    v_lshlrev_b32 v86, 16, v87
    v_and_b32 v87, 0xffff0000, v87
    v_pk_fma_f32 v[112:113], v[112:113], v[108:109], s[16:17] op_sel:[0,0,0] op_sel_hi:[1,0,0]
    v_pk_fma_f32 v[82:83], v[82:83], v[108:109], s[16:17] op_sel:[0,0,0] op_sel_hi:[1,0,0]
    v_pk_fma_f32 v[114:115], v[114:115], v[108:109], s[16:17] op_sel:[0,1,0] op_sel_hi:[1,1,0]
    v_pk_fma_f32 v[84:85], v[84:85], v[108:109], s[16:17] op_sel:[0,1,0] op_sel_hi:[1,1,0]
    v_pk_fma_f32 v[116:117], v[116:117], v[110:111], s[16:17] op_sel:[0,0,0] op_sel_hi:[1,0,0]
    v_pk_fma_f32 v[86:87], v[86:87], v[110:111], s[16:17] op_sel:[0,0,0] op_sel_hi:[1,0,0]
    v_perm_b32 v83, v83, v82, s17
    v_perm_b32 v82, v113, v112, s17
    v_perm_b32 v85, v85, v84, s17
    v_perm_b32 v84, v115, v114, s17
    v_perm_b32 v87, v87, v86, s17
    v_perm_b32 v86, v117, v116, s17
    v_lshl_add_u64 v[82:83], v[82:83], 0, s[20:21]
    v_lshl_add_u64 v[84:85], v[84:85], 0, s[20:21]
    v_lshl_add_u64 v[86:87], v[86:87], 0, s[20:21]
    s_waitcnt lgkmcnt(1)
    v_or3_b32 v4, v44, v45, v4
    v_or3_b32 v4, v46, v47, v4
    v_or3_b32 v4, v48, v49, v4
    ds_add_rtn_u64 v[44:45], v20, v[82:83]
    ds_add_rtn_u64 v[46:47], v21, v[84:85]
    ds_add_rtn_u64 v[48:49], v22, v[86:87]
    s_waitcnt lgkmcnt(3)
    v_mad_u32_u16 v119, v119, s23, v2
    v_pk_lshrrev_b16 v119, 10, v119 op_sel_hi:[1,1]
    v_lshl_add_u32 v118, v118, 6, v119
    buffer_load_dwordx4 v[20:23], v118, s[44:47], s36 idxen
    s_cmp_le_u32 s28, 256
    s_cbranch_scc1 L_p2_kernel_noopt_3
    v_readlane_b32 s38, v7, 8
    v_readlane_b32 s39, v7, 9
    s_nop 1
    v_mbcnt_lo_u32_b32 v120, s38, 0
    v_mbcnt_hi_u32_b32 v120, s39, v120
    s_bcnt1_i32_b64 s14, s[38:39]
    v_lshl_add_u32 v121, v120, 1, s25
    ds_read_u16 v121, v121
    s_add_u32 s38, s26, 4194304
    s_lshl1_add_u32 s25, s14, s25
    s_lshl_b32 s14, s14, 10
    s_add_u32 s26, s26, s14
    s_waitcnt lgkmcnt(0)
    v_mad_u32_u16 v121, v121, s23, v2
    v_pk_lshrrev_b16 v121, 10, v121 op_sel_hi:[1,1]
    v_lshl_add_u32 v120, v120, 6, v121
    buffer_load_dwordx4 v[24:27], v120, s[44:47], s38 idxen
L_p2_kernel_noopt_3:
    v_pk_mov_b32 v[28:29], v[28:29], v[30:31] op_sel:[1,0]
    v_pk_mov_b32 v[30:31], v[30:31], v[32:33] op_sel:[1,0]
    v_pk_mov_b32 v[32:33], v[32:33], v[34:35] op_sel:[1,0]
    v_pk_mov_b32 v[34:35], v[34:35], v[4:5] op_sel:[1,1]
    v_pk_mov_b32 v[36:37], v[36:37], v[38:39] op_sel:[1,0]
    v_pk_mov_b32 v[38:39], v[38:39], v[40:41] op_sel:[1,0]
    v_pk_mov_b32 v[40:41], v[40:41], v[42:43] op_sel:[1,0]
    v_pk_mov_b32 v[42:43], v[42:43], v[4:5] op_sel:[1,1]
    v_mad_u32_u16 v108, v28, v50, s40 op_sel:[0,0,0,0]
    v_mad_u32_u16 v109, v36, v50, s41 op_sel:[0,0,0,0]
    v_sub_u32_sdwa v110, v109, v108 dst_sel:DWORD dst_unused:UNUSED_PAD src0_sel:WORD_1 src1_sel:WORD_1
    s_nop 1
    v_add_u32_dpp v110, v110, v110 row_shr:1 row_mask:0xf bank_mask:0xf bound_ctrl:0
    s_nop 1
    v_add_u32_dpp v110, v110, v110 row_shr:2 row_mask:0xf bank_mask:0xf bound_ctrl:0
    s_nop 1
    v_add_u32_dpp v110, v110, v110 row_shr:4 row_mask:0xf bank_mask:0xf bound_ctrl:0
    s_nop 1
    v_add_u32_dpp v110, v110, v110 row_shr:8 row_mask:0xf bank_mask:0xf bound_ctrl:0
    s_nop 1
    v_add_u32_dpp v110, v110, v110 row_bcast:15 row_mask:0xa bank_mask:0xf
    s_nop 1
    v_add_u32_dpp v110, v110, v110 row_bcast:31 row_mask:0xc bank_mask:0xf
    v_sub_u32_sdwa v109, v109, v110 dst_sel:DWORD dst_unused:UNUSED_PAD src0_sel:WORD_1 src1_sel:DWORD
    v_readlane_b32 s29, v110, 63
    v_add_u32 v110, -1, v110
    ds_write_b16 v126, v109
    v_lshlrev_b32_e64 v111, v110, 1
    v_lshrrev_b32 v110, 5, v110
    v_lshl_add_u32 v110, v110, 2, s19
    s_cmp_gt_u32 s29, 320
    s_cselect_b32 s2, 1, s2
    s_cselect_b64 exec, 0, -1
    ds_or_b32 v110, v111 offset:160
    s_mov_b64 exec, -1
    ds_wrxchg_rtn_b32 v7, v6, v5 offset:160
    s_add_u32 s14, s22, 80000
    buffer_load_dwordx4 v[88:91], v1, s[8:11], s14 offen
    s_add_u32 s14, s22, 96384
    buffer_load_dwordx4 v[92:95], v1, s[8:11], s14 offen
    s_barrier
    s_add_u32 s22, s22, 80000
    s_cmp_lg_u32 s24, 7
    s_cbranch_scc1 L_p2_nodist
    s_mov_b32 s46, 0
    s_lshl2_add_u32 s14, s3, s12
    s_mul_i32 s14, s14, 5000
    s_add_u32 s15, s14, 4096
    v_min_u32 v61, 225, v0
    v_lshl_add_u32 v60, v0, 2, s14
    v_lshl_add_u32 v61, v61, 2, s15
    global_load_dword v60, v60, s[100:101] nt
    global_load_dword v61, v61, s[100:101] nt
L_p2_nodist:
    v_mad_u32_u16 v64, v8, 8, s18
    v_mad_u32_u16 v66, v9, 8, s18
    v_mad_u32_u16 v68, v10, 8, s18
    ds_read_b64 v[64:65], v64
    ds_read_b64 v[66:67], v66
    ds_read_b64 v[68:69], v68
    s_add_u32 s14, s22, 32768
    buffer_load_dwordx4 v[96:99], v1, s[8:11], s14 offen
    s_waitcnt vmcnt(5)
    v_mad_u32_u16 v70, v12, 8, s18
    v_mad_u32_u16 v72, v13, 8, s18
    v_mad_u32_u16 v74, v14, 8, s18
    ds_read_b64 v[70:71], v70
    ds_read_b64 v[72:73], v72
    ds_read_b64 v[74:75], v74
    s_add_u32 s14, s22, 49152
    buffer_load_dwordx4 v[100:103], v1, s[8:11], s14 offen
    s_waitcnt lgkmcnt(6)
    v_readlane_b32 s30, v7, 0
    v_readlane_b32 s31, v7, 1
    v_readlane_b32 s32, v7, 2
    v_readlane_b32 s33, v7, 3
    v_readlane_b32 s34, v7, 4
    v_readlane_b32 s35, v7, 5
    v_readlane_b32 s36, v7, 6
    v_readlane_b32 s37, v7, 7
    s_mov_b32 s25, s19
    s_mov_b32 s26, s27
    s_mov_b32 s51, s28
    s_mov_b32 s28, s29
    v_mbcnt_lo_u32_b32 v118, s30, 0
    v_mbcnt_hi_u32_b32 v118, s31, v118
    s_bcnt1_i32_b64 s14, s[30:31]
    v_lshl_add_u32 v119, v118, 1, s25
    ds_read_u16 v119, v119
    s_add_u32 s30, s26, 0
    s_lshl1_add_u32 s25, s14, s25
    s_lshl_b32 s14, s14, 10
    s_add_u32 s26, s26, s14
    v_bfe_i32 v108, v11, 2, 10
    v_bfe_i32 v109, v11, 12, 10
    v_ashrrev_i32 v110, 22, v11
    v_cvt_f32_i32 v108, v108
    v_cvt_f32_i32 v109, v109
    v_cvt_f32_i32 v110, v110
    v_mad_u32_u16 v8, v8, 8, s50 op_sel:[1,0,0,0]
    v_mad_u32_u16 v9, v9, 8, s50 op_sel:[1,0,0,0]
    v_mad_u32_u16 v10, v10, 8, s50 op_sel:[1,0,0,0]
    s_waitcnt lgkmcnt(4)
    v_lshlrev_b32 v112, 16, v64
    v_and_b32 v113, 0xffff0000, v64
    v_lshlrev_b32 v64, 16, v65
    v_and_b32 v65, 0xffff0000, v65
    v_lshlrev_b32 v114, 16, v66
    v_and_b32 v115, 0xffff0000, v66
    v_lshlrev_b32 v66, 16, v67
    v_and_b32 v67, 0xffff0000, v67
    v_lshlrev_b32 v116, 16, v68
    v_and_b32 v117, 0xffff0000, v68
    v_lshlrev_b32 v68, 16, v69
    v_and_b32 v69, 0xffff0000, v69
    v_pk_fma_f32 v[112:113], v[112:113], v[108:109], s[16:17] op_sel:[0,0,0] op_sel_hi:[1,0,0]
    v_pk_fma_f32 v[64:65], v[64:65], v[108:109], s[16:17] op_sel:[0,0,0] op_sel_hi:[1,0,0]
    v_pk_fma_f32 v[114:115], v[114:115], v[108:109], s[16:17] op_sel:[0,1,0] op_sel_hi:[1,1,0]
    v_pk_fma_f32 v[66:67], v[66:67], v[108:109], s[16:17] op_sel:[0,1,0] op_sel_hi:[1,1,0]
    v_pk_fma_f32 v[116:117], v[116:117], v[110:111], s[16:17] op_sel:[0,0,0] op_sel_hi:[1,0,0]
    v_pk_fma_f32 v[68:69], v[68:69], v[110:111], s[16:17] op_sel:[0,0,0] op_sel_hi:[1,0,0]
    v_perm_b32 v65, v65, v64, s17
    v_perm_b32 v64, v113, v112, s17
    v_perm_b32 v67, v67, v66, s17
    v_perm_b32 v66, v115, v114, s17
    v_perm_b32 v69, v69, v68, s17
    v_perm_b32 v68, v117, v116, s17
    v_lshl_add_u64 v[64:65], v[64:65], 0, s[20:21]
    v_lshl_add_u64 v[66:67], v[66:67], 0, s[20:21]
    v_lshl_add_u64 v[68:69], v[68:69], 0, s[20:21]
    v_or3_b32 v4, v44, v45, v4
    v_or3_b32 v4, v46, v47, v4
    v_or3_b32 v4, v48, v49, v4
    ds_add_rtn_u64 v[44:45], v8, v[64:65]
    ds_add_rtn_u64 v[46:47], v9, v[66:67]
    ds_add_rtn_u64 v[48:49], v10, v[68:69]
    s_waitcnt lgkmcnt(3)
    v_mad_u32_u16 v119, v119, s23, v2
    v_pk_lshrrev_b16 v119, 10, v119 op_sel_hi:[1,1]
    v_lshl_add_u32 v118, v118, 6, v119
    buffer_load_dwordx4 v[8:11], v118, s[44:47], s30 idxen
    s_add_u32 s14, s22, 65536
    buffer_load_dwordx4 v[104:107], v1, s[8:11], s14 offen
    s_waitcnt vmcnt(7)
    v_mad_u32_u16 v76, v16, 8, s18
    v_mad_u32_u16 v78, v17, 8, s18
    v_mad_u32_u16 v80, v18, 8, s18
    ds_read_b64 v[76:77], v76
    ds_read_b64 v[78:79], v78
    ds_read_b64 v[80:81], v80
    s_waitcnt vmcnt(6)
    v_mad_u32_u16 v82, v20, 8, s18
    v_mad_u32_u16 v84, v21, 8, s18
    v_mad_u32_u16 v86, v22, 8, s18
    ds_read_b64 v[82:83], v82
    ds_read_b64 v[84:85], v84
    ds_read_b64 v[86:87], v86
    v_mbcnt_lo_u32_b32 v118, s32, 0
    v_mbcnt_hi_u32_b32 v118, s33, v118
    s_bcnt1_i32_b64 s14, s[32:33]
    v_lshl_add_u32 v119, v118, 1, s25
    ds_read_u16 v119, v119
    s_add_u32 s32, s26, 1048576
    s_lshl1_add_u32 s25, s14, s25
    s_lshl_b32 s14, s14, 10
    s_add_u32 s26, s26, s14
    v_bfe_i32 v108, v15, 2, 10
    v_bfe_i32 v109, v15, 12, 10
    v_ashrrev_i32 v110, 22, v15
    v_cvt_f32_i32 v108, v108
    v_cvt_f32_i32 v109, v109
    v_cvt_f32_i32 v110, v110
    v_mad_u32_u16 v12, v12, 8, s50 op_sel:[1,0,0,0]
    v_mad_u32_u16 v13, v13, 8, s50 op_sel:[1,0,0,0]
    v_mad_u32_u16 v14, v14, 8, s50 op_sel:[1,0,0,0]
    v_lshlrev_b32 v112, 16, v70
    v_and_b32 v113, 0xffff0000, v70
    v_lshlrev_b32 v70, 16, v71
    v_and_b32 v71, 0xffff0000, v71
    v_lshlrev_b32 v114, 16, v72
    v_and_b32 v115, 0xffff0000, v72
    v_lshlrev_b32 v72, 16, v73
    v_and_b32 v73, 0xffff0000, v73
    v_lshlrev_b32 v116, 16, v74
    v_and_b32 v117, 0xffff0000, v74
    v_lshlrev_b32 v74, 16, v75
    v_and_b32 v75, 0xffff0000, v75
    v_pk_fma_f32 v[112:113], v[112:113], v[108:109], s[16:17] op_sel:[0,0,0] op_sel_hi:[1,0,0]
    v_pk_fma_f32 v[70:71], v[70:71], v[108:109], s[16:17] op_sel:[0,0,0] op_sel_hi:[1,0,0]
    v_pk_fma_f32 v[114:115], v[114:115], v[108:109], s[16:17] op_sel:[0,1,0] op_sel_hi:[1,1,0]
    v_pk_fma_f32 v[72:73], v[72:73], v[108:109], s[16:17] op_sel:[0,1,0] op_sel_hi:[1,1,0]
    v_pk_fma_f32 v[116:117], v[116:117], v[110:111], s[16:17] op_sel:[0,0,0] op_sel_hi:[1,0,0]
    v_pk_fma_f32 v[74:75], v[74:75], v[110:111], s[16:17] op_sel:[0,0,0] op_sel_hi:[1,0,0]
    v_perm_b32 v71, v71, v70, s17
    v_perm_b32 v70, v113, v112, s17
    v_perm_b32 v73, v73, v72, s17
    v_perm_b32 v72, v115, v114, s17
    v_perm_b32 v75, v75, v74, s17
    v_perm_b32 v74, v117, v116, s17
    v_lshl_add_u64 v[70:71], v[70:71], 0, s[20:21]
    v_lshl_add_u64 v[72:73], v[72:73], 0, s[20:21]
    v_lshl_add_u64 v[74:75], v[74:75], 0, s[20:21]
    s_waitcnt lgkmcnt(7)
    v_or3_b32 v4, v44, v45, v4
    v_or3_b32 v4, v46, v47, v4
    v_or3_b32 v4, v48, v49, v4
    ds_add_rtn_u64 v[44:45], v12, v[70:71]
    ds_add_rtn_u64 v[46:47], v13, v[72:73]
    ds_add_rtn_u64 v[48:49], v14, v[74:75]
    s_waitcnt lgkmcnt(3)
    v_mad_u32_u16 v119, v119, s23, v2
    v_pk_lshrrev_b16 v119, 10, v119 op_sel_hi:[1,1]
    v_lshl_add_u32 v118, v118, 6, v119
    buffer_load_dwordx4 v[12:15], v118, s[44:47], s32 idxen
    s_cmp_le_u32 s51, 256
    s_cbranch_scc1 L_p2_kernel_noopt2_4
    v_mad_u32_u16 v64, v24, 8, s18
    v_mad_u32_u16 v66, v25, 8, s18
    v_mad_u32_u16 v68, v26, 8, s18
    ds_read_b64 v[64:65], v64
    ds_read_b64 v[66:67], v66
    ds_read_b64 v[68:69], v68
    v_bfe_i32 v108, v27, 2, 10
    v_bfe_i32 v109, v27, 12, 10
    v_ashrrev_i32 v110, 22, v27
    v_cvt_f32_i32 v108, v108
    v_cvt_f32_i32 v109, v109
    v_cvt_f32_i32 v110, v110
    v_mad_u32_u16 v24, v24, 8, s50 op_sel:[1,0,0,0]
    v_mad_u32_u16 v25, v25, 8, s50 op_sel:[1,0,0,0]
    v_mad_u32_u16 v26, v26, 8, s50 op_sel:[1,0,0,0]
    s_waitcnt lgkmcnt(0)
    v_lshlrev_b32 v112, 16, v64
    v_and_b32 v113, 0xffff0000, v64
    v_lshlrev_b32 v64, 16, v65
    v_and_b32 v65, 0xffff0000, v65
    v_lshlrev_b32 v114, 16, v66
    v_and_b32 v115, 0xffff0000, v66
    v_lshlrev_b32 v66, 16, v67
    v_and_b32 v67, 0xffff0000, v67
    v_lshlrev_b32 v116, 16, v68
    v_and_b32 v117, 0xffff0000, v68
    v_lshlrev_b32 v68, 16, v69
    v_and_b32 v69, 0xffff0000, v69
    v_pk_fma_f32 v[112:113], v[112:113], v[108:109], s[16:17] op_sel:[0,0,0] op_sel_hi:[1,0,0]
    v_pk_fma_f32 v[64:65], v[64:65], v[108:109], s[16:17] op_sel:[0,0,0] op_sel_hi:[1,0,0]
    v_pk_fma_f32 v[114:115], v[114:115], v[108:109], s[16:17] op_sel:[0,1,0] op_sel_hi:[1,1,0]
    v_pk_fma_f32 v[66:67], v[66:67], v[108:109], s[16:17] op_sel:[0,1,0] op_sel_hi:[1,1,0]
    v_pk_fma_f32 v[116:117], v[116:117], v[110:111], s[16:17] op_sel:[0,0,0] op_sel_hi:[1,0,0]
    v_pk_fma_f32 v[68:69], v[68:69], v[110:111], s[16:17] op_sel:[0,0,0] op_sel_hi:[1,0,0]
    v_perm_b32 v65, v65, v64, s17
    v_perm_b32 v64, v113, v112, s17
    v_perm_b32 v67, v67, v66, s17
    v_perm_b32 v66, v115, v114, s17
    v_perm_b32 v69, v69, v68, s17
    v_perm_b32 v68, v117, v116, s17
    v_lshl_add_u64 v[64:65], v[64:65], 0, s[20:21]
    v_lshl_add_u64 v[66:67], v[66:67], 0, s[20:21]
    v_lshl_add_u64 v[68:69], v[68:69], 0, s[20:21]
    v_or3_b32 v4, v44, v45, v4
    v_or3_b32 v4, v46, v47, v4
    v_or3_b32 v4, v48, v49, v4
    ds_add_rtn_u64 v[44:45], v24, v[64:65]
    ds_add_rtn_u64 v[46:47], v25, v[66:67]
    ds_add_rtn_u64 v[48:49], v26, v[68:69]
L_p2_kernel_noopt2_4:
    s_barrier
    s_waitcnt vmcnt(1)
    ds_write_b128 v3, v[88:91] offset:0
    ds_write_b128 v3, v[92:95] offset:16384
    ds_write_b128 v3, v[96:99] offset:32768
    ds_write_b128 v3, v[100:103] offset:49152
    ds_write_b128 v124, v[104:107] offset:0
    v_mbcnt_lo_u32_b32 v118, s34, 0
    v_mbcnt_hi_u32_b32 v118, s35, v118
    s_bcnt1_i32_b64 s14, s[34:35]
    v_lshl_add_u32 v119, v118, 1, s25
    ds_read_u16 v119, v119
    s_add_u32 s34, s26, 2097152
    s_lshl1_add_u32 s25, s14, s25
    s_lshl_b32 s14, s14, 10
    s_add_u32 s26, s26, s14
    v_bfe_i32 v108, v19, 2, 10
    v_bfe_i32 v109, v19, 12, 10
    v_ashrrev_i32 v110, 22, v19
    v_cvt_f32_i32 v108, v108
    v_cvt_f32_i32 v109, v109
    v_cvt_f32_i32 v110, v110
    v_mad_u32_u16 v16, v16, 8, s50 op_sel:[1,0,0,0]
    v_mad_u32_u16 v17, v17, 8, s50 op_sel:[1,0,0,0]
    v_mad_u32_u16 v18, v18, 8, s50 op_sel:[1,0,0,0]
    v_lshlrev_b32 v112, 16, v76
    v_and_b32 v113, 0xffff0000, v76
    v_lshlrev_b32 v76, 16, v77
    v_and_b32 v77, 0xffff0000, v77
    v_lshlrev_b32 v114, 16, v78
    v_and_b32 v115, 0xffff0000, v78
    v_lshlrev_b32 v78, 16, v79
    v_and_b32 v79, 0xffff0000, v79
    v_lshlrev_b32 v116, 16, v80
    v_and_b32 v117, 0xffff0000, v80
    v_lshlrev_b32 v80, 16, v81
    v_and_b32 v81, 0xffff0000, v81
    v_pk_fma_f32 v[112:113], v[112:113], v[108:109], s[16:17] op_sel:[0,0,0] op_sel_hi:[1,0,0]
    v_pk_fma_f32 v[76:77], v[76:77], v[108:109], s[16:17] op_sel:[0,0,0] op_sel_hi:[1,0,0]
    v_pk_fma_f32 v[114:115], v[114:115], v[108:109], s[16:17] op_sel:[0,1,0] op_sel_hi:[1,1,0]
    v_pk_fma_f32 v[78:79], v[78:79], v[108:109], s[16:17] op_sel:[0,1,0] op_sel_hi:[1,1,0]
    v_pk_fma_f32 v[116:117], v[116:117], v[110:111], s[16:17] op_sel:[0,0,0] op_sel_hi:[1,0,0]
    v_pk_fma_f32 v[80:81], v[80:81], v[110:111], s[16:17] op_sel:[0,0,0] op_sel_hi:[1,0,0]
    v_perm_b32 v77, v77, v76, s17
    v_perm_b32 v76, v113, v112, s17
    v_perm_b32 v79, v79, v78, s17
    v_perm_b32 v78, v115, v114, s17
    v_perm_b32 v81, v81, v80, s17
    v_perm_b32 v80, v117, v116, s17
    v_lshl_add_u64 v[76:77], v[76:77], 0, s[20:21]
    v_lshl_add_u64 v[78:79], v[78:79], 0, s[20:21]
    v_lshl_add_u64 v[80:81], v[80:81], 0, s[20:21]
    s_waitcnt lgkmcnt(6)
    v_or3_b32 v4, v44, v45, v4
    v_or3_b32 v4, v46, v47, v4
    v_or3_b32 v4, v48, v49, v4
    ds_add_rtn_u64 v[44:45], v16, v[76:77]
    ds_add_rtn_u64 v[46:47], v17, v[78:79]
    ds_add_rtn_u64 v[48:49], v18, v[80:81]
    s_waitcnt lgkmcnt(3)
    v_mad_u32_u16 v119, v119, s23, v2
    v_pk_lshrrev_b16 v119, 10, v119 op_sel_hi:[1,1]
    v_lshl_add_u32 v118, v118, 6, v119
    buffer_load_dwordx4 v[16:19], v118, s[44:47], s34 idxen
    v_mbcnt_lo_u32_b32 v118, s36, 0
    v_mbcnt_hi_u32_b32 v118, s37, v118
    s_bcnt1_i32_b64 s14, s[36:37]
    v_lshl_add_u32 v119, v118, 1, s25
    ds_read_u16 v119, v119
    s_add_u32 s36, s26, 3145728
    s_lshl1_add_u32 s25, s14, s25
    s_lshl_b32 s14, s14, 10
    s_add_u32 s26, s26, s14
    v_bfe_i32 v108, v23, 2, 10
    v_bfe_i32 v109, v23, 12, 10
    v_ashrrev_i32 v110, 22, v23
    v_cvt_f32_i32 v108, v108
    v_cvt_f32_i32 v109, v109
    v_cvt_f32_i32 v110, v110
    v_mad_u32_u16 v20, v20, 8, s50 op_sel:[1,0,0,0]
    v_mad_u32_u16 v21, v21, 8, s50 op_sel:[1,0,0,0]
    v_mad_u32_u16 v22, v22, 8, s50 op_sel:[1,0,0,0]
    v_lshlrev_b32 v112, 16, v82
    v_and_b32 v113, 0xffff0000, v82
    v_lshlrev_b32 v82, 16, v83
    v_and_b32 v83, 0xffff0000, v83
    v_lshlrev_b32 v114, 16, v84
    v_and_b32 v115, 0xffff0000, v84
    v_lshlrev_b32 v84, 16, v85
    v_and_b32 v85, 0xffff0000, v85
    v_lshlrev_b32 v116, 16, v86
    v_and_b32 v117, 0xffff0000, v86
    v_lshlrev_b32 v86, 16, v87
    v_and_b32 v87, 0xffff0000, v87
    v_pk_fma_f32 v[112:113], v[112:113], v[108:109], s[16:17] op_sel:[0,0,0] op_sel_hi:[1,0,0]
    v_pk_fma_f32 v[82:83], v[82:83], v[108:109], s[16:17] op_sel:[0,0,0] op_sel_hi:[1,0,0]
    v_pk_fma_f32 v[114:115], v[114:115], v[108:109], s[16:17] op_sel:[0,1,0] op_sel_hi:[1,1,0]
    v_pk_fma_f32 v[84:85], v[84:85], v[108:109], s[16:17] op_sel:[0,1,0] op_sel_hi:[1,1,0]
    v_pk_fma_f32 v[116:117], v[116:117], v[110:111], s[16:17] op_sel:[0,0,0] op_sel_hi:[1,0,0]
    v_pk_fma_f32 v[86:87], v[86:87], v[110:111], s[16:17] op_sel:[0,0,0] op_sel_hi:[1,0,0]
    v_perm_b32 v83, v83, v82, s17
    v_perm_b32 v82, v113, v112, s17
    v_perm_b32 v85, v85, v84, s17
    v_perm_b32 v84, v115, v114, s17
    v_perm_b32 v87, v87, v86, s17
    v_perm_b32 v86, v117, v116, s17
    v_lshl_add_u64 v[82:83], v[82:83], 0, s[20:21]
    v_lshl_add_u64 v[84:85], v[84:85], 0, s[20:21]
    v_lshl_add_u64 v[86:87], v[86:87], 0, s[20:21]
    s_waitcnt lgkmcnt(1)
    v_or3_b32 v4, v44, v45, v4
    v_or3_b32 v4, v46, v47, v4
    v_or3_b32 v4, v48, v49, v4
    ds_add_rtn_u64 v[44:45], v20, v[82:83]
    ds_add_rtn_u64 v[46:47], v21, v[84:85]
    ds_add_rtn_u64 v[48:49], v22, v[86:87]
    s_waitcnt lgkmcnt(3)
    v_mad_u32_u16 v119, v119, s23, v2
    v_pk_lshrrev_b16 v119, 10, v119 op_sel_hi:[1,1]
    v_lshl_add_u32 v118, v118, 6, v119
    buffer_load_dwordx4 v[20:23], v118, s[44:47], s36 idxen
    s_cmp_le_u32 s28, 256
    s_cbranch_scc1 L_p2_kernel_noopt_5
    v_readlane_b32 s38, v7, 8
    v_readlane_b32 s39, v7, 9
    s_nop 1
    v_mbcnt_lo_u32_b32 v120, s38, 0
    v_mbcnt_hi_u32_b32 v120, s39, v120
    s_bcnt1_i32_b64 s14, s[38:39]
    v_lshl_add_u32 v121, v120, 1, s25
    ds_read_u16 v121, v121
    s_add_u32 s38, s26, 4194304
    s_lshl1_add_u32 s25, s14, s25
    s_lshl_b32 s14, s14, 10
    s_add_u32 s26, s26, s14
    s_waitcnt lgkmcnt(0)
    v_mad_u32_u16 v121, v121, s23, v2
    v_pk_lshrrev_b16 v121, 10, v121 op_sel_hi:[1,1]
    v_lshl_add_u32 v120, v120, 6, v121
    buffer_load_dwordx4 v[24:27], v120, s[44:47], s38 idxen
L_p2_kernel_noopt_5:
    v_mad_u32_u16 v108, v28, v50, s40 op_sel:[1,0,0,0]
    v_mad_u32_u16 v109, v36, v50, s41 op_sel:[1,0,0,0]
    v_sub_u32_sdwa v110, v109, v108 dst_sel:DWORD dst_unused:UNUSED_PAD src0_sel:WORD_1 src1_sel:WORD_1
    s_nop 1
    v_add_u32_dpp v110, v110, v110 row_shr:1 row_mask:0xf bank_mask:0xf bound_ctrl:0
    s_nop 1
    v_add_u32_dpp v110, v110, v110 row_shr:2 row_mask:0xf bank_mask:0xf bound_ctrl:0
    s_nop 1
    v_add_u32_dpp v110, v110, v110 row_shr:4 row_mask:0xf bank_mask:0xf bound_ctrl:0
    s_nop 1
    v_add_u32_dpp v110, v110, v110 row_shr:8 row_mask:0xf bank_mask:0xf bound_ctrl:0
    s_nop 1
    v_add_u32_dpp v110, v110, v110 row_bcast:15 row_mask:0xa bank_mask:0xf
    s_nop 1
    v_add_u32_dpp v110, v110, v110 row_bcast:31 row_mask:0xc bank_mask:0xf
    v_sub_u32_sdwa v109, v109, v110 dst_sel:DWORD dst_unused:UNUSED_PAD src0_sel:WORD_1 src1_sel:DWORD
    v_readlane_b32 s29, v110, 63
    v_add_u32 v110, -1, v110
    ds_write_b16 v126, v109
    v_lshlrev_b32_e64 v111, v110, 1
    v_lshrrev_b32 v110, 5, v110
    v_lshl_add_u32 v110, v110, 2, s19
    s_cmp_gt_u32 s29, 320
    s_cselect_b32 s2, 1, s2
    s_cselect_b64 exec, 0, -1
    ds_or_b32 v110, v111 offset:160
    s_mov_b64 exec, -1
    ds_wrxchg_rtn_b32 v7, v6, v5 offset:160
    s_add_u32 s14, s22, 80000
    buffer_load_dwordx4 v[88:91], v1, s[8:11], s14 offen
    s_add_u32 s14, s22, 96384
    buffer_load_dwordx4 v[92:95], v1, s[8:11], s14 offen
    s_add_u32 s24, s24, 1
    s_cmp_lt_u32 s24, 8
    s_barrier
    s_cbranch_scc1 L_p2_loop
    s_waitcnt lgkmcnt(3)
    v_or3_b32 v4, v44, v45, v4
    v_or3_b32 v4, v46, v47, v4
    v_or3_b32 v4, v48, v49, v4
    s_mov_b32 s27, s19
    s_waitcnt vmcnt(0)
    v_mov_b32 v8, 160232
    s_cmp_lg_u32 s13, 0
    s_cselect_b64 exec, 0, 1
    ds_write_b32 v8, v52
    s_mov_b64 exec, -1
    v_subrev_u32 v6, 80000, v124
    s_mul_i32 s24, s12, 20000
    v_subrev_u32 v10, s24, v1
    v_mov_b32 v11, 0x7f000000
    s_waitcnt vmcnt(0) lgkmcnt(0)
    s_barrier
    s_cmp_lt_u32 s13, 4
    s_cbranch_scc1 L_p2_ga
    v_lshlrev_b32 v30, 16, v60
    v_and_b32 v31, 0xffff0000, v60
    v_lshlrev_b32 v36, 16, v53
    v_and_b32 v37, 0xffff0000, v53
    v_lshlrev_b32 v38, 16, v54
    v_and_b32 v39, 0xffff0000, v54
    v_lshlrev_b32 v40, 16, v56
    v_and_b32 v41, 0xffff0000, v56
    v_lshlrev_b32 v42, 16, v57
    v_and_b32 v43, 0xffff0000, v57
    v_pk_add_f32 v[14:15], v[30:31], v[36:37] op_sel:[0,0] op_sel_hi:[1,0] neg_lo:[0,1] neg_hi:[0,1]
    v_pk_add_f32 v[16:17], v[30:31], v[36:37] op_sel:[0,1] op_sel_hi:[1,1] neg_lo:[0,1] neg_hi:[0,1]
    v_pk_add_f32 v[18:19], v[30:31], v[38:39] op_sel:[0,0] op_sel_hi:[1,0] neg_lo:[0,1] neg_hi:[0,1]
    v_pk_add_f32 v[20:21], v[30:31], v[38:39] op_sel:[0,1] op_sel_hi:[1,1] neg_lo:[0,1] neg_hi:[0,1]
    v_pk_add_f32 v[22:23], v[30:31], v[40:41] op_sel:[0,0] op_sel_hi:[1,0] neg_lo:[0,1] neg_hi:[0,1]
    v_pk_add_f32 v[24:25], v[30:31], v[40:41] op_sel:[0,1] op_sel_hi:[1,1] neg_lo:[0,1] neg_hi:[0,1]
    v_pk_add_f32 v[26:27], v[30:31], v[42:43] op_sel:[0,0] op_sel_hi:[1,0] neg_lo:[0,1] neg_hi:[0,1]
    v_pk_add_f32 v[28:29], v[30:31], v[42:43] op_sel:[0,1] op_sel_hi:[1,1] neg_lo:[0,1] neg_hi:[0,1]
    v_cvt_pk_bf16_f32 v32, v14, v15
    v_lshlrev_b32 v14, 16, v32
    v_and_b32 v15, 0xffff0000, v32
    v_cvt_pk_bf16_f32 v32, v16, v17
    v_lshlrev_b32 v16, 16, v32
    v_and_b32 v17, 0xffff0000, v32
    v_cvt_pk_bf16_f32 v32, v18, v19
    v_lshlrev_b32 v18, 16, v32
    v_and_b32 v19, 0xffff0000, v32
    v_cvt_pk_bf16_f32 v32, v20, v21
    v_lshlrev_b32 v20, 16, v32
    v_and_b32 v21, 0xffff0000, v32
    v_cvt_pk_bf16_f32 v32, v22, v23
    v_lshlrev_b32 v22, 16, v32
    v_and_b32 v23, 0xffff0000, v32
    v_cvt_pk_bf16_f32 v32, v24, v25
    v_lshlrev_b32 v24, 16, v32
    v_and_b32 v25, 0xffff0000, v32
    v_cvt_pk_bf16_f32 v32, v26, v27
    v_lshlrev_b32 v26, 16, v32
    v_and_b32 v27, 0xffff0000, v32
    v_cvt_pk_bf16_f32 v32, v28, v29
    v_lshlrev_b32 v28, 16, v32
    v_and_b32 v29, 0xffff0000, v32
    v_pk_mul_f32 v[14:15], v[14:15], v[14:15]
    v_pk_mul_f32 v[16:17], v[16:17], v[16:17]
    v_pk_mul_f32 v[18:19], v[18:19], v[18:19]
    v_pk_mul_f32 v[20:21], v[20:21], v[20:21]
    v_pk_mul_f32 v[22:23], v[22:23], v[22:23]
    v_pk_mul_f32 v[24:25], v[24:25], v[24:25]
    v_pk_mul_f32 v[26:27], v[26:27], v[26:27]
    v_pk_mul_f32 v[28:29], v[28:29], v[28:29]
    v_cvt_pk_bf16_f32 v32, v14, v15
    v_lshlrev_b32 v14, 16, v32
    v_and_b32 v15, 0xffff0000, v32
    v_cvt_pk_bf16_f32 v32, v16, v17
    v_lshlrev_b32 v16, 16, v32
    v_and_b32 v17, 0xffff0000, v32
    v_cvt_pk_bf16_f32 v32, v18, v19
    v_lshlrev_b32 v18, 16, v32
    v_and_b32 v19, 0xffff0000, v32
    v_cvt_pk_bf16_f32 v32, v20, v21
    v_lshlrev_b32 v20, 16, v32
    v_and_b32 v21, 0xffff0000, v32
    v_cvt_pk_bf16_f32 v32, v22, v23
    v_lshlrev_b32 v22, 16, v32
    v_and_b32 v23, 0xffff0000, v32
    v_cvt_pk_bf16_f32 v32, v24, v25
    v_lshlrev_b32 v24, 16, v32
    v_and_b32 v25, 0xffff0000, v32
    v_cvt_pk_bf16_f32 v32, v26, v27
    v_lshlrev_b32 v26, 16, v32
    v_and_b32 v27, 0xffff0000, v32
    v_cvt_pk_bf16_f32 v32, v28, v29
    v_lshlrev_b32 v28, 16, v32
    v_and_b32 v29, 0xffff0000, v32
    v_mov_b32 v30, 1092616192
    v_mov_b32 v31, 0x3fb8aa3b
    v_pk_mul_f32 v[14:15], v[14:15], v[30:31] op_sel:[0,0] op_sel_hi:[1,0]
    v_pk_mul_f32 v[16:17], v[16:17], v[30:31] op_sel:[0,0] op_sel_hi:[1,0]
    v_pk_mul_f32 v[18:19], v[18:19], v[30:31] op_sel:[0,0] op_sel_hi:[1,0]
    v_pk_mul_f32 v[20:21], v[20:21], v[30:31] op_sel:[0,0] op_sel_hi:[1,0]
    v_pk_mul_f32 v[22:23], v[22:23], v[30:31] op_sel:[0,0] op_sel_hi:[1,0]
    v_pk_mul_f32 v[24:25], v[24:25], v[30:31] op_sel:[0,0] op_sel_hi:[1,0]
    v_pk_mul_f32 v[26:27], v[26:27], v[30:31] op_sel:[0,0] op_sel_hi:[1,0]
    v_pk_mul_f32 v[28:29], v[28:29], v[30:31] op_sel:[0,0] op_sel_hi:[1,0]
    v_cvt_pk_bf16_f32 v32, v14, v15
    v_lshlrev_b32 v14, 16, v32
    v_and_b32 v15, 0xffff0000, v32
    v_cvt_pk_bf16_f32 v32, v16, v17
    v_lshlrev_b32 v16, 16, v32
    v_and_b32 v17, 0xffff0000, v32
    v_cvt_pk_bf16_f32 v32, v18, v19
    v_lshlrev_b32 v18, 16, v32
    v_and_b32 v19, 0xffff0000, v32
    v_cvt_pk_bf16_f32 v32, v20, v21
    v_lshlrev_b32 v20, 16, v32
    v_and_b32 v21, 0xffff0000, v32
    v_cvt_pk_bf16_f32 v32, v22, v23
    v_lshlrev_b32 v22, 16, v32
    v_and_b32 v23, 0xffff0000, v32
    v_cvt_pk_bf16_f32 v32, v24, v25
    v_lshlrev_b32 v24, 16, v32
    v_and_b32 v25, 0xffff0000, v32
    v_cvt_pk_bf16_f32 v32, v26, v27
    v_lshlrev_b32 v26, 16, v32
    v_and_b32 v27, 0xffff0000, v32
    v_cvt_pk_bf16_f32 v32, v28, v29
    v_lshlrev_b32 v28, 16, v32
    v_and_b32 v29, 0xffff0000, v32
    v_pk_mul_f32 v[14:15], v[14:15], v[30:31] op_sel:[0,1] op_sel_hi:[1,1]
    v_pk_mul_f32 v[16:17], v[16:17], v[30:31] op_sel:[0,1] op_sel_hi:[1,1]
    v_pk_mul_f32 v[18:19], v[18:19], v[30:31] op_sel:[0,1] op_sel_hi:[1,1]
    v_pk_mul_f32 v[20:21], v[20:21], v[30:31] op_sel:[0,1] op_sel_hi:[1,1]
    v_pk_mul_f32 v[22:23], v[22:23], v[30:31] op_sel:[0,1] op_sel_hi:[1,1]
    v_pk_mul_f32 v[24:25], v[24:25], v[30:31] op_sel:[0,1] op_sel_hi:[1,1]
    v_pk_mul_f32 v[26:27], v[26:27], v[30:31] op_sel:[0,1] op_sel_hi:[1,1]
    v_pk_mul_f32 v[28:29], v[28:29], v[30:31] op_sel:[0,1] op_sel_hi:[1,1]
    v_exp_f32 v14, -v14
    v_exp_f32 v15, -v15
    v_exp_f32 v16, -v16
    v_exp_f32 v17, -v17
    v_exp_f32 v18, -v18
    v_exp_f32 v19, -v19
    v_exp_f32 v20, -v20
    v_exp_f32 v21, -v21
    v_exp_f32 v22, -v22
    v_exp_f32 v23, -v23
    v_exp_f32 v24, -v24
    v_exp_f32 v25, -v25
    v_exp_f32 v26, -v26
    v_exp_f32 v27, -v27
    v_exp_f32 v28, -v28
    v_exp_f32 v29, -v29
    v_cvt_pk_bf16_f32 v14, v14, v16
    v_cvt_pk_bf16_f32 v15, v15, v17
    v_cvt_pk_bf16_f32 v18, v18, v20
    v_cvt_pk_bf16_f32 v19, v19, v21
    v_cvt_pk_bf16_f32 v22, v22, v24
    v_cvt_pk_bf16_f32 v23, v23, v25
    v_cvt_pk_bf16_f32 v26, v26, v28
    v_cvt_pk_bf16_f32 v27, v27, v29
    v_dot2_f32_bf16 v72, v14, s68, 0
    v_dot2_f32_bf16 v73, v15, s68, 0
    v_dot2_f32_bf16 v74, v14, s69, 0
    v_dot2_f32_bf16 v75, v15, s69, 0
    v_dot2_f32_bf16 v76, v14, s70, 0
    v_dot2_f32_bf16 v77, v15, s70, 0
    v_dot2_f32_bf16 v78, v14, s71, 0
    v_dot2_f32_bf16 v79, v15, s71, 0
    v_dot2_f32_bf16 v80, v14, s52, 0
    v_dot2_f32_bf16 v81, v15, s52, 0
    v_dot2_f32_bf16 v82, v14, s53, 0
    v_dot2_f32_bf16 v83, v15, s53, 0
    v_dot2_f32_bf16 v84, v14, s54, 0
    v_dot2_f32_bf16 v85, v15, s54, 0
    v_dot2_f32_bf16 v86, v14, s55, 0
    v_dot2_f32_bf16 v87, v15, s55, 0
    v_dot2_f32_bf16 v72, v18, s72, v72
    v_dot2_f32_bf16 v73, v19, s72, v73
    v_dot2_f32_bf16 v74, v18, s73, v74
    v_dot2_f32_bf16 v75, v19, s73, v75
    v_dot2_f32_bf16 v76, v18, s74, v76
    v_dot2_f32_bf16 v77, v19, s74, v77
    v_dot2_f32_bf16 v78, v18, s75, v78
    v_dot2_f32_bf16 v79, v19, s75, v79
    v_dot2_f32_bf16 v80, v18, s56, v80
    v_dot2_f32_bf16 v81, v19, s56, v81
    v_dot2_f32_bf16 v82, v18, s57, v82
    v_dot2_f32_bf16 v83, v19, s57, v83
    v_dot2_f32_bf16 v84, v18, s58, v84
    v_dot2_f32_bf16 v85, v19, s58, v85
    v_dot2_f32_bf16 v86, v18, s59, v86
    v_dot2_f32_bf16 v87, v19, s59, v87
    v_dot2_f32_bf16 v72, v22, s76, v72
    v_dot2_f32_bf16 v73, v23, s76, v73
    v_dot2_f32_bf16 v74, v22, s77, v74
    v_dot2_f32_bf16 v75, v23, s77, v75
    v_dot2_f32_bf16 v76, v22, s78, v76
    v_dot2_f32_bf16 v77, v23, s78, v77
    v_dot2_f32_bf16 v78, v22, s79, v78
    v_dot2_f32_bf16 v79, v23, s79, v79
    v_dot2_f32_bf16 v80, v22, s60, v80
    v_dot2_f32_bf16 v81, v23, s60, v81
    v_dot2_f32_bf16 v82, v22, s61, v82
    v_dot2_f32_bf16 v83, v23, s61, v83
    v_dot2_f32_bf16 v84, v22, s62, v84
    v_dot2_f32_bf16 v85, v23, s62, v85
    v_dot2_f32_bf16 v86, v22, s63, v86
    v_dot2_f32_bf16 v87, v23, s63, v87
    v_dot2_f32_bf16 v72, v26, s80, v72
    v_dot2_f32_bf16 v73, v27, s80, v73
    v_dot2_f32_bf16 v74, v26, s81, v74
    v_dot2_f32_bf16 v75, v27, s81, v75
    v_dot2_f32_bf16 v76, v26, s82, v76
    v_dot2_f32_bf16 v77, v27, s82, v77
    v_dot2_f32_bf16 v78, v26, s83, v78
    v_dot2_f32_bf16 v79, v27, s83, v79
    v_dot2_f32_bf16 v80, v26, s64, v80
    v_dot2_f32_bf16 v81, v27, s64, v81
    v_dot2_f32_bf16 v82, v26, s65, v82
    v_dot2_f32_bf16 v83, v27, s65, v83
    v_dot2_f32_bf16 v84, v26, s66, v84
    v_dot2_f32_bf16 v85, v27, s66, v85
    v_dot2_f32_bf16 v86, v26, s67, v86
    v_dot2_f32_bf16 v87, v27, s67, v87
L_p2_ga:
    ds_read_b32 v9, v8
    ds_read_b128 v[88:91], v1 offset:0
    ds_read_b128 v[92:95], v1 offset:16384
    ds_read_b128 v[96:99], v1 offset:32768
    ds_read_b128 v[100:103], v1 offset:49152
    ds_read_b128 v[104:107], v6
    s_mul_i32 s14, s12, 5120000
    s_mul_i32 s15, s3, 80000
    s_add_u32 s25, s14, s15
    s_add_u32 s25, s25, 233832448
    s_waitcnt lgkmcnt(5)
    v_readfirstlane_b32 s21, v9
    s_nop 0
    s_bfe_u32 s21, s21, 524296
    s_cmp_lg_u32 s21, 4
    s_cselect_b32 s21, 1, 0
    s_cselect_b32 s24, 0, 20000
    v_cmp_le_u32 vcc, s24, v10
    v_add_u32 v10, 16384, v10
    s_add_u32 s14, s25, 0
    v_cndmask_b32 v12, v11, v1, vcc
    s_waitcnt lgkmcnt(4)
    buffer_store_dwordx4 v[88:91], v12, s[4:7], s14 offen sc1
    v_or3_b32 v4, v88, v89, v4
    v_or3_b32 v4, v90, v91, v4
    v_cmp_le_u32 vcc, s24, v10
    v_add_u32 v10, 16384, v10
    s_add_u32 s14, s25, 16384
    v_cndmask_b32 v12, v11, v1, vcc
    s_waitcnt lgkmcnt(3)
    buffer_store_dwordx4 v[92:95], v12, s[4:7], s14 offen sc1
    v_or3_b32 v4, v92, v93, v4
    v_or3_b32 v4, v94, v95, v4
    v_cmp_le_u32 vcc, s24, v10
    v_add_u32 v10, 16384, v10
    s_add_u32 s14, s25, 32768
    v_cndmask_b32 v12, v11, v1, vcc
    s_waitcnt lgkmcnt(2)
    buffer_store_dwordx4 v[96:99], v12, s[4:7], s14 offen sc1
    v_or3_b32 v4, v96, v97, v4
    v_or3_b32 v4, v98, v99, v4
    v_cmp_le_u32 vcc, s24, v10
    v_add_u32 v10, 16384, v10
    s_add_u32 s14, s25, 49152
    v_cndmask_b32 v12, v11, v1, vcc
    s_waitcnt lgkmcnt(1)
    buffer_store_dwordx4 v[100:103], v12, s[4:7], s14 offen sc1
    v_or3_b32 v4, v100, v101, v4
    v_or3_b32 v4, v102, v103, v4
    v_cmp_le_u32 vcc, s24, v10
    v_add_u32 v10, 16384, v10
    s_add_u32 s14, s25, 0
    v_cndmask_b32 v12, v11, v6, vcc
    s_waitcnt lgkmcnt(0)
    buffer_store_dwordx4 v[104:107], v12, s[4:7], s14 offen sc1
    v_or3_b32 v4, v104, v105, v4
    v_or3_b32 v4, v106, v107, v4
    s_load_dwordx2 s[16:17], s[0:1], 88
    s_cmp_ge_u32 s13, 4
    s_cbranch_scc1 L_p2_gb
    v_lshlrev_b32 v30, 16, v60
    v_and_b32 v31, 0xffff0000, v60
    v_lshlrev_b32 v36, 16, v53
    v_and_b32 v37, 0xffff0000, v53
    v_lshlrev_b32 v38, 16, v54
    v_and_b32 v39, 0xffff0000, v54
    v_lshlrev_b32 v40, 16, v56
    v_and_b32 v41, 0xffff0000, v56
    v_lshlrev_b32 v42, 16, v57
    v_and_b32 v43, 0xffff0000, v57
    v_pk_add_f32 v[14:15], v[30:31], v[36:37] op_sel:[0,0] op_sel_hi:[1,0] neg_lo:[0,1] neg_hi:[0,1]
    v_pk_add_f32 v[16:17], v[30:31], v[36:37] op_sel:[0,1] op_sel_hi:[1,1] neg_lo:[0,1] neg_hi:[0,1]
    v_pk_add_f32 v[18:19], v[30:31], v[38:39] op_sel:[0,0] op_sel_hi:[1,0] neg_lo:[0,1] neg_hi:[0,1]
    v_pk_add_f32 v[20:21], v[30:31], v[38:39] op_sel:[0,1] op_sel_hi:[1,1] neg_lo:[0,1] neg_hi:[0,1]
    v_pk_add_f32 v[22:23], v[30:31], v[40:41] op_sel:[0,0] op_sel_hi:[1,0] neg_lo:[0,1] neg_hi:[0,1]
    v_pk_add_f32 v[24:25], v[30:31], v[40:41] op_sel:[0,1] op_sel_hi:[1,1] neg_lo:[0,1] neg_hi:[0,1]
    v_pk_add_f32 v[26:27], v[30:31], v[42:43] op_sel:[0,0] op_sel_hi:[1,0] neg_lo:[0,1] neg_hi:[0,1]
    v_pk_add_f32 v[28:29], v[30:31], v[42:43] op_sel:[0,1] op_sel_hi:[1,1] neg_lo:[0,1] neg_hi:[0,1]
    v_cvt_pk_bf16_f32 v32, v14, v15
    v_lshlrev_b32 v14, 16, v32
    v_and_b32 v15, 0xffff0000, v32
    v_cvt_pk_bf16_f32 v32, v16, v17
    v_lshlrev_b32 v16, 16, v32
    v_and_b32 v17, 0xffff0000, v32
    v_cvt_pk_bf16_f32 v32, v18, v19
    v_lshlrev_b32 v18, 16, v32
    v_and_b32 v19, 0xffff0000, v32
    v_cvt_pk_bf16_f32 v32, v20, v21
    v_lshlrev_b32 v20, 16, v32
    v_and_b32 v21, 0xffff0000, v32
    v_cvt_pk_bf16_f32 v32, v22, v23
    v_lshlrev_b32 v22, 16, v32
    v_and_b32 v23, 0xffff0000, v32
    v_cvt_pk_bf16_f32 v32, v24, v25
    v_lshlrev_b32 v24, 16, v32
    v_and_b32 v25, 0xffff0000, v32
    v_cvt_pk_bf16_f32 v32, v26, v27
    v_lshlrev_b32 v26, 16, v32
    v_and_b32 v27, 0xffff0000, v32
    v_cvt_pk_bf16_f32 v32, v28, v29
    v_lshlrev_b32 v28, 16, v32
    v_and_b32 v29, 0xffff0000, v32
    v_pk_mul_f32 v[14:15], v[14:15], v[14:15]
    v_pk_mul_f32 v[16:17], v[16:17], v[16:17]
    v_pk_mul_f32 v[18:19], v[18:19], v[18:19]
    v_pk_mul_f32 v[20:21], v[20:21], v[20:21]
    v_pk_mul_f32 v[22:23], v[22:23], v[22:23]
    v_pk_mul_f32 v[24:25], v[24:25], v[24:25]
    v_pk_mul_f32 v[26:27], v[26:27], v[26:27]
    v_pk_mul_f32 v[28:29], v[28:29], v[28:29]
    v_cvt_pk_bf16_f32 v32, v14, v15
    v_lshlrev_b32 v14, 16, v32
    v_and_b32 v15, 0xffff0000, v32
    v_cvt_pk_bf16_f32 v32, v16, v17
    v_lshlrev_b32 v16, 16, v32
    v_and_b32 v17, 0xffff0000, v32
    v_cvt_pk_bf16_f32 v32, v18, v19
    v_lshlrev_b32 v18, 16, v32
    v_and_b32 v19, 0xffff0000, v32
    v_cvt_pk_bf16_f32 v32, v20, v21
    v_lshlrev_b32 v20, 16, v32
    v_and_b32 v21, 0xffff0000, v32
    v_cvt_pk_bf16_f32 v32, v22, v23
    v_lshlrev_b32 v22, 16, v32
    v_and_b32 v23, 0xffff0000, v32
    v_cvt_pk_bf16_f32 v32, v24, v25
    v_lshlrev_b32 v24, 16, v32
    v_and_b32 v25, 0xffff0000, v32
    v_cvt_pk_bf16_f32 v32, v26, v27
    v_lshlrev_b32 v26, 16, v32
    v_and_b32 v27, 0xffff0000, v32
    v_cvt_pk_bf16_f32 v32, v28, v29
    v_lshlrev_b32 v28, 16, v32
    v_and_b32 v29, 0xffff0000, v32
    v_mov_b32 v30, 1092616192
    v_mov_b32 v31, 0x3fb8aa3b
    v_pk_mul_f32 v[14:15], v[14:15], v[30:31] op_sel:[0,0] op_sel_hi:[1,0]
    v_pk_mul_f32 v[16:17], v[16:17], v[30:31] op_sel:[0,0] op_sel_hi:[1,0]
    v_pk_mul_f32 v[18:19], v[18:19], v[30:31] op_sel:[0,0] op_sel_hi:[1,0]
    v_pk_mul_f32 v[20:21], v[20:21], v[30:31] op_sel:[0,0] op_sel_hi:[1,0]
    v_pk_mul_f32 v[22:23], v[22:23], v[30:31] op_sel:[0,0] op_sel_hi:[1,0]
    v_pk_mul_f32 v[24:25], v[24:25], v[30:31] op_sel:[0,0] op_sel_hi:[1,0]
    v_pk_mul_f32 v[26:27], v[26:27], v[30:31] op_sel:[0,0] op_sel_hi:[1,0]
    v_pk_mul_f32 v[28:29], v[28:29], v[30:31] op_sel:[0,0] op_sel_hi:[1,0]
    v_cvt_pk_bf16_f32 v32, v14, v15
    v_lshlrev_b32 v14, 16, v32
    v_and_b32 v15, 0xffff0000, v32
    v_cvt_pk_bf16_f32 v32, v16, v17
    v_lshlrev_b32 v16, 16, v32
    v_and_b32 v17, 0xffff0000, v32
    v_cvt_pk_bf16_f32 v32, v18, v19
    v_lshlrev_b32 v18, 16, v32
    v_and_b32 v19, 0xffff0000, v32
    v_cvt_pk_bf16_f32 v32, v20, v21
    v_lshlrev_b32 v20, 16, v32
    v_and_b32 v21, 0xffff0000, v32
    v_cvt_pk_bf16_f32 v32, v22, v23
    v_lshlrev_b32 v22, 16, v32
    v_and_b32 v23, 0xffff0000, v32
    v_cvt_pk_bf16_f32 v32, v24, v25
    v_lshlrev_b32 v24, 16, v32
    v_and_b32 v25, 0xffff0000, v32
    v_cvt_pk_bf16_f32 v32, v26, v27
    v_lshlrev_b32 v26, 16, v32
    v_and_b32 v27, 0xffff0000, v32
    v_cvt_pk_bf16_f32 v32, v28, v29
    v_lshlrev_b32 v28, 16, v32
    v_and_b32 v29, 0xffff0000, v32
    v_pk_mul_f32 v[14:15], v[14:15], v[30:31] op_sel:[0,1] op_sel_hi:[1,1]
    v_pk_mul_f32 v[16:17], v[16:17], v[30:31] op_sel:[0,1] op_sel_hi:[1,1]
    v_pk_mul_f32 v[18:19], v[18:19], v[30:31] op_sel:[0,1] op_sel_hi:[1,1]
    v_pk_mul_f32 v[20:21], v[20:21], v[30:31] op_sel:[0,1] op_sel_hi:[1,1]
    v_pk_mul_f32 v[22:23], v[22:23], v[30:31] op_sel:[0,1] op_sel_hi:[1,1]
    v_pk_mul_f32 v[24:25], v[24:25], v[30:31] op_sel:[0,1] op_sel_hi:[1,1]
    v_pk_mul_f32 v[26:27], v[26:27], v[30:31] op_sel:[0,1] op_sel_hi:[1,1]
    v_pk_mul_f32 v[28:29], v[28:29], v[30:31] op_sel:[0,1] op_sel_hi:[1,1]
    v_exp_f32 v14, -v14
    v_exp_f32 v15, -v15
    v_exp_f32 v16, -v16
    v_exp_f32 v17, -v17
    v_exp_f32 v18, -v18
    v_exp_f32 v19, -v19
    v_exp_f32 v20, -v20
    v_exp_f32 v21, -v21
    v_exp_f32 v22, -v22
    v_exp_f32 v23, -v23
    v_exp_f32 v24, -v24
    v_exp_f32 v25, -v25
    v_exp_f32 v26, -v26
    v_exp_f32 v27, -v27
    v_exp_f32 v28, -v28
    v_exp_f32 v29, -v29
    v_cvt_pk_bf16_f32 v14, v14, v16
    v_cvt_pk_bf16_f32 v15, v15, v17
    v_cvt_pk_bf16_f32 v18, v18, v20
    v_cvt_pk_bf16_f32 v19, v19, v21
    v_cvt_pk_bf16_f32 v22, v22, v24
    v_cvt_pk_bf16_f32 v23, v23, v25
    v_cvt_pk_bf16_f32 v26, v26, v28
    v_cvt_pk_bf16_f32 v27, v27, v29
    v_dot2_f32_bf16 v72, v14, s68, 0
    v_dot2_f32_bf16 v73, v15, s68, 0
    v_dot2_f32_bf16 v74, v14, s69, 0
    v_dot2_f32_bf16 v75, v15, s69, 0
    v_dot2_f32_bf16 v76, v14, s70, 0
    v_dot2_f32_bf16 v77, v15, s70, 0
    v_dot2_f32_bf16 v78, v14, s71, 0
    v_dot2_f32_bf16 v79, v15, s71, 0
    v_dot2_f32_bf16 v80, v14, s52, 0
    v_dot2_f32_bf16 v81, v15, s52, 0
    v_dot2_f32_bf16 v82, v14, s53, 0
    v_dot2_f32_bf16 v83, v15, s53, 0
    v_dot2_f32_bf16 v84, v14, s54, 0
    v_dot2_f32_bf16 v85, v15, s54, 0
    v_dot2_f32_bf16 v86, v14, s55, 0
    v_dot2_f32_bf16 v87, v15, s55, 0
    v_dot2_f32_bf16 v72, v18, s72, v72
    v_dot2_f32_bf16 v73, v19, s72, v73
    v_dot2_f32_bf16 v74, v18, s73, v74
    v_dot2_f32_bf16 v75, v19, s73, v75
    v_dot2_f32_bf16 v76, v18, s74, v76
    v_dot2_f32_bf16 v77, v19, s74, v77
    v_dot2_f32_bf16 v78, v18, s75, v78
    v_dot2_f32_bf16 v79, v19, s75, v79
    v_dot2_f32_bf16 v80, v18, s56, v80
    v_dot2_f32_bf16 v81, v19, s56, v81
    v_dot2_f32_bf16 v82, v18, s57, v82
    v_dot2_f32_bf16 v83, v19, s57, v83
    v_dot2_f32_bf16 v84, v18, s58, v84
    v_dot2_f32_bf16 v85, v19, s58, v85
    v_dot2_f32_bf16 v86, v18, s59, v86
    v_dot2_f32_bf16 v87, v19, s59, v87
    v_dot2_f32_bf16 v72, v22, s76, v72
    v_dot2_f32_bf16 v73, v23, s76, v73
    v_dot2_f32_bf16 v74, v22, s77, v74
    v_dot2_f32_bf16 v75, v23, s77, v75
    v_dot2_f32_bf16 v76, v22, s78, v76
    v_dot2_f32_bf16 v77, v23, s78, v77
    v_dot2_f32_bf16 v78, v22, s79, v78
    v_dot2_f32_bf16 v79, v23, s79, v79
    v_dot2_f32_bf16 v80, v22, s60, v80
    v_dot2_f32_bf16 v81, v23, s60, v81
    v_dot2_f32_bf16 v82, v22, s61, v82
    v_dot2_f32_bf16 v83, v23, s61, v83
    v_dot2_f32_bf16 v84, v22, s62, v84
    v_dot2_f32_bf16 v85, v23, s62, v85
    v_dot2_f32_bf16 v86, v22, s63, v86
    v_dot2_f32_bf16 v87, v23, s63, v87
    v_dot2_f32_bf16 v72, v26, s80, v72
    v_dot2_f32_bf16 v73, v27, s80, v73
    v_dot2_f32_bf16 v74, v26, s81, v74
    v_dot2_f32_bf16 v75, v27, s81, v75
    v_dot2_f32_bf16 v76, v26, s82, v76
    v_dot2_f32_bf16 v77, v27, s82, v77
    v_dot2_f32_bf16 v78, v26, s83, v78
    v_dot2_f32_bf16 v79, v27, s83, v79
    v_dot2_f32_bf16 v80, v26, s64, v80
    v_dot2_f32_bf16 v81, v27, s64, v81
    v_dot2_f32_bf16 v82, v26, s65, v82
    v_dot2_f32_bf16 v83, v27, s65, v83
    v_dot2_f32_bf16 v84, v26, s66, v84
    v_dot2_f32_bf16 v85, v27, s66, v85
    v_dot2_f32_bf16 v86, v26, s67, v86
    v_dot2_f32_bf16 v87, v27, s67, v87
    s_cmp_ge_u32 s13, 4
    s_cbranch_scc1 L_p2_kernel_g1_6
    v_lshlrev_b32 v30, 16, v61
    v_and_b32 v31, 0xffff0000, v61
    v_pk_add_f32 v[14:15], v[30:31], v[36:37] op_sel:[0,0] op_sel_hi:[1,0] neg_lo:[0,1] neg_hi:[0,1]
    v_pk_add_f32 v[16:17], v[30:31], v[36:37] op_sel:[0,1] op_sel_hi:[1,1] neg_lo:[0,1] neg_hi:[0,1]
    v_pk_add_f32 v[18:19], v[30:31], v[38:39] op_sel:[0,0] op_sel_hi:[1,0] neg_lo:[0,1] neg_hi:[0,1]
    v_pk_add_f32 v[20:21], v[30:31], v[38:39] op_sel:[0,1] op_sel_hi:[1,1] neg_lo:[0,1] neg_hi:[0,1]
    v_pk_add_f32 v[22:23], v[30:31], v[40:41] op_sel:[0,0] op_sel_hi:[1,0] neg_lo:[0,1] neg_hi:[0,1]
    v_pk_add_f32 v[24:25], v[30:31], v[40:41] op_sel:[0,1] op_sel_hi:[1,1] neg_lo:[0,1] neg_hi:[0,1]
    v_pk_add_f32 v[26:27], v[30:31], v[42:43] op_sel:[0,0] op_sel_hi:[1,0] neg_lo:[0,1] neg_hi:[0,1]
    v_pk_add_f32 v[28:29], v[30:31], v[42:43] op_sel:[0,1] op_sel_hi:[1,1] neg_lo:[0,1] neg_hi:[0,1]
    v_cvt_pk_bf16_f32 v32, v14, v15
    v_lshlrev_b32 v14, 16, v32
    v_and_b32 v15, 0xffff0000, v32
    v_cvt_pk_bf16_f32 v32, v16, v17
    v_lshlrev_b32 v16, 16, v32
    v_and_b32 v17, 0xffff0000, v32
    v_cvt_pk_bf16_f32 v32, v18, v19
    v_lshlrev_b32 v18, 16, v32
    v_and_b32 v19, 0xffff0000, v32
    v_cvt_pk_bf16_f32 v32, v20, v21
    v_lshlrev_b32 v20, 16, v32
    v_and_b32 v21, 0xffff0000, v32
    v_cvt_pk_bf16_f32 v32, v22, v23
    v_lshlrev_b32 v22, 16, v32
    v_and_b32 v23, 0xffff0000, v32
    v_cvt_pk_bf16_f32 v32, v24, v25
    v_lshlrev_b32 v24, 16, v32
    v_and_b32 v25, 0xffff0000, v32
    v_cvt_pk_bf16_f32 v32, v26, v27
    v_lshlrev_b32 v26, 16, v32
    v_and_b32 v27, 0xffff0000, v32
    v_cvt_pk_bf16_f32 v32, v28, v29
    v_lshlrev_b32 v28, 16, v32
    v_and_b32 v29, 0xffff0000, v32
    v_pk_mul_f32 v[14:15], v[14:15], v[14:15]
    v_pk_mul_f32 v[16:17], v[16:17], v[16:17]
    v_pk_mul_f32 v[18:19], v[18:19], v[18:19]
    v_pk_mul_f32 v[20:21], v[20:21], v[20:21]
    v_pk_mul_f32 v[22:23], v[22:23], v[22:23]
    v_pk_mul_f32 v[24:25], v[24:25], v[24:25]
    v_pk_mul_f32 v[26:27], v[26:27], v[26:27]
    v_pk_mul_f32 v[28:29], v[28:29], v[28:29]
    v_cvt_pk_bf16_f32 v32, v14, v15
    v_lshlrev_b32 v14, 16, v32
    v_and_b32 v15, 0xffff0000, v32
    v_cvt_pk_bf16_f32 v32, v16, v17
    v_lshlrev_b32 v16, 16, v32
    v_and_b32 v17, 0xffff0000, v32
    v_cvt_pk_bf16_f32 v32, v18, v19
    v_lshlrev_b32 v18, 16, v32
    v_and_b32 v19, 0xffff0000, v32
    v_cvt_pk_bf16_f32 v32, v20, v21
    v_lshlrev_b32 v20, 16, v32
    v_and_b32 v21, 0xffff0000, v32
    v_cvt_pk_bf16_f32 v32, v22, v23
    v_lshlrev_b32 v22, 16, v32
    v_and_b32 v23, 0xffff0000, v32
    v_cvt_pk_bf16_f32 v32, v24, v25
    v_lshlrev_b32 v24, 16, v32
    v_and_b32 v25, 0xffff0000, v32
    v_cvt_pk_bf16_f32 v32, v26, v27
    v_lshlrev_b32 v26, 16, v32
    v_and_b32 v27, 0xffff0000, v32
    v_cvt_pk_bf16_f32 v32, v28, v29
    v_lshlrev_b32 v28, 16, v32
    v_and_b32 v29, 0xffff0000, v32
    v_mov_b32 v30, 1092616192
    v_mov_b32 v31, 0x3fb8aa3b
    v_pk_mul_f32 v[14:15], v[14:15], v[30:31] op_sel:[0,0] op_sel_hi:[1,0]
    v_pk_mul_f32 v[16:17], v[16:17], v[30:31] op_sel:[0,0] op_sel_hi:[1,0]
    v_pk_mul_f32 v[18:19], v[18:19], v[30:31] op_sel:[0,0] op_sel_hi:[1,0]
    v_pk_mul_f32 v[20:21], v[20:21], v[30:31] op_sel:[0,0] op_sel_hi:[1,0]
    v_pk_mul_f32 v[22:23], v[22:23], v[30:31] op_sel:[0,0] op_sel_hi:[1,0]
    v_pk_mul_f32 v[24:25], v[24:25], v[30:31] op_sel:[0,0] op_sel_hi:[1,0]
    v_pk_mul_f32 v[26:27], v[26:27], v[30:31] op_sel:[0,0] op_sel_hi:[1,0]
    v_pk_mul_f32 v[28:29], v[28:29], v[30:31] op_sel:[0,0] op_sel_hi:[1,0]
    v_cvt_pk_bf16_f32 v32, v14, v15
    v_lshlrev_b32 v14, 16, v32
    v_and_b32 v15, 0xffff0000, v32
    v_cvt_pk_bf16_f32 v32, v16, v17
    v_lshlrev_b32 v16, 16, v32
    v_and_b32 v17, 0xffff0000, v32
    v_cvt_pk_bf16_f32 v32, v18, v19
    v_lshlrev_b32 v18, 16, v32
    v_and_b32 v19, 0xffff0000, v32
    v_cvt_pk_bf16_f32 v32, v20, v21
    v_lshlrev_b32 v20, 16, v32
    v_and_b32 v21, 0xffff0000, v32
    v_cvt_pk_bf16_f32 v32, v22, v23
    v_lshlrev_b32 v22, 16, v32
    v_and_b32 v23, 0xffff0000, v32
    v_cvt_pk_bf16_f32 v32, v24, v25
    v_lshlrev_b32 v24, 16, v32
    v_and_b32 v25, 0xffff0000, v32
    v_cvt_pk_bf16_f32 v32, v26, v27
    v_lshlrev_b32 v26, 16, v32
    v_and_b32 v27, 0xffff0000, v32
    v_cvt_pk_bf16_f32 v32, v28, v29
    v_lshlrev_b32 v28, 16, v32
    v_and_b32 v29, 0xffff0000, v32
    v_pk_mul_f32 v[14:15], v[14:15], v[30:31] op_sel:[0,1] op_sel_hi:[1,1]
    v_pk_mul_f32 v[16:17], v[16:17], v[30:31] op_sel:[0,1] op_sel_hi:[1,1]
    v_pk_mul_f32 v[18:19], v[18:19], v[30:31] op_sel:[0,1] op_sel_hi:[1,1]
    v_pk_mul_f32 v[20:21], v[20:21], v[30:31] op_sel:[0,1] op_sel_hi:[1,1]
    v_pk_mul_f32 v[22:23], v[22:23], v[30:31] op_sel:[0,1] op_sel_hi:[1,1]
    v_pk_mul_f32 v[24:25], v[24:25], v[30:31] op_sel:[0,1] op_sel_hi:[1,1]
    v_pk_mul_f32 v[26:27], v[26:27], v[30:31] op_sel:[0,1] op_sel_hi:[1,1]
    v_pk_mul_f32 v[28:29], v[28:29], v[30:31] op_sel:[0,1] op_sel_hi:[1,1]
    v_exp_f32 v14, -v14
    v_exp_f32 v15, -v15
    v_exp_f32 v16, -v16
    v_exp_f32 v17, -v17
    v_exp_f32 v18, -v18
    v_exp_f32 v19, -v19
    v_exp_f32 v20, -v20
    v_exp_f32 v21, -v21
    v_exp_f32 v22, -v22
    v_exp_f32 v23, -v23
    v_exp_f32 v24, -v24
    v_exp_f32 v25, -v25
    v_exp_f32 v26, -v26
    v_exp_f32 v27, -v27
    v_exp_f32 v28, -v28
    v_exp_f32 v29, -v29
    v_cvt_pk_bf16_f32 v14, v14, v16
    v_cvt_pk_bf16_f32 v15, v15, v17
    v_cvt_pk_bf16_f32 v18, v18, v20
    v_cvt_pk_bf16_f32 v19, v19, v21
    v_cvt_pk_bf16_f32 v22, v22, v24
    v_cvt_pk_bf16_f32 v23, v23, v25
    v_cvt_pk_bf16_f32 v26, v26, v28
    v_cvt_pk_bf16_f32 v27, v27, v29
    v_dot2_f32_bf16 v112, v14, s68, 0
    v_dot2_f32_bf16 v113, v15, s68, 0
    v_dot2_f32_bf16 v114, v14, s69, 0
    v_dot2_f32_bf16 v115, v15, s69, 0
    v_dot2_f32_bf16 v116, v14, s70, 0
    v_dot2_f32_bf16 v117, v15, s70, 0
    v_dot2_f32_bf16 v118, v14, s71, 0
    v_dot2_f32_bf16 v119, v15, s71, 0
    v_dot2_f32_bf16 v120, v14, s52, 0
    v_dot2_f32_bf16 v121, v15, s52, 0
    v_dot2_f32_bf16 v122, v14, s53, 0
    v_dot2_f32_bf16 v123, v15, s53, 0
    v_dot2_f32_bf16 v124, v14, s54, 0
    v_dot2_f32_bf16 v125, v15, s54, 0
    v_dot2_f32_bf16 v126, v14, s55, 0
    v_dot2_f32_bf16 v127, v15, s55, 0
    v_dot2_f32_bf16 v112, v18, s72, v112
    v_dot2_f32_bf16 v113, v19, s72, v113
    v_dot2_f32_bf16 v114, v18, s73, v114
    v_dot2_f32_bf16 v115, v19, s73, v115
    v_dot2_f32_bf16 v116, v18, s74, v116
    v_dot2_f32_bf16 v117, v19, s74, v117
    v_dot2_f32_bf16 v118, v18, s75, v118
    v_dot2_f32_bf16 v119, v19, s75, v119
    v_dot2_f32_bf16 v120, v18, s56, v120
    v_dot2_f32_bf16 v121, v19, s56, v121
    v_dot2_f32_bf16 v122, v18, s57, v122
    v_dot2_f32_bf16 v123, v19, s57, v123
    v_dot2_f32_bf16 v124, v18, s58, v124
    v_dot2_f32_bf16 v125, v19, s58, v125
    v_dot2_f32_bf16 v126, v18, s59, v126
    v_dot2_f32_bf16 v127, v19, s59, v127
    v_dot2_f32_bf16 v112, v22, s76, v112
    v_dot2_f32_bf16 v113, v23, s76, v113
    v_dot2_f32_bf16 v114, v22, s77, v114
    v_dot2_f32_bf16 v115, v23, s77, v115
    v_dot2_f32_bf16 v116, v22, s78, v116
    v_dot2_f32_bf16 v117, v23, s78, v117
    v_dot2_f32_bf16 v118, v22, s79, v118
    v_dot2_f32_bf16 v119, v23, s79, v119
    v_dot2_f32_bf16 v120, v22, s60, v120
    v_dot2_f32_bf16 v121, v23, s60, v121
    v_dot2_f32_bf16 v122, v22, s61, v122
    v_dot2_f32_bf16 v123, v23, s61, v123
    v_dot2_f32_bf16 v124, v22, s62, v124
    v_dot2_f32_bf16 v125, v23, s62, v125
    v_dot2_f32_bf16 v126, v22, s63, v126
    v_dot2_f32_bf16 v127, v23, s63, v127
    v_dot2_f32_bf16 v112, v26, s80, v112
    v_dot2_f32_bf16 v113, v27, s80, v113
    v_dot2_f32_bf16 v114, v26, s81, v114
    v_dot2_f32_bf16 v115, v27, s81, v115
    v_dot2_f32_bf16 v116, v26, s82, v116
    v_dot2_f32_bf16 v117, v27, s82, v117
    v_dot2_f32_bf16 v118, v26, s83, v118
    v_dot2_f32_bf16 v119, v27, s83, v119
    v_dot2_f32_bf16 v120, v26, s64, v120
    v_dot2_f32_bf16 v121, v27, s64, v121
    v_dot2_f32_bf16 v122, v26, s65, v122
    v_dot2_f32_bf16 v123, v27, s65, v123
    v_dot2_f32_bf16 v124, v26, s66, v124
    v_dot2_f32_bf16 v125, v27, s66, v125
    v_dot2_f32_bf16 v126, v26, s67, v126
    v_dot2_f32_bf16 v127, v27, s67, v127
L_p2_kernel_g1_6:
L_p2_gb:
    v_and_b32 v4, 0x80008000, v4
    v_cmp_ne_u32 vcc, 0, v4
    v_mov_b32 v8, s27
    v_and_b32 v10, 15, v0
    v_mul_u32_u24 v10, 240, v10
    v_add_u32 v10, 160000, v10
    s_cmp_lg_u64 vcc, 0
    s_cselect_b32 s2, 1, s2
    v_mov_b32 v9, s2
    s_mov_b64 exec, 1
    ds_write_b32 v8, v9
    s_mov_b64 exec, -1
    v_add_u32 v2, 16384, v1
    v_mov_b32 v9, 0x3f000000
    v_cmp_gt_u32 vcc, 226, v0
    s_mov_b32 s49, s12
    s_mov_b32 s51, 0
    v_cndmask_b32 v2, v9, v2, vcc
    s_waitcnt vmcnt(0) lgkmcnt(0)
    s_barrier
    ds_read_b32 v9, v10
    s_mov_b32 s18, 5120000
    s_mov_b32 s19, 0x00020000
    s_waitcnt lgkmcnt(0)
    v_cmp_ne_u32 vcc, 0, v9
    s_nop 1
    s_cmp_lg_u64 vcc, 0
    s_cselect_b32 s2, 1, 0
    s_cbranch_scc1 L_p2_slow
L_p2_signal:
    v_mov_b32 v8, 160228
    s_lshl_b32 s15, s2, 4
    s_or_b32 s15, s15, s21
    s_add_u32 s14, s12, 16
    s_lshl_b32 s20, s15, s14
    s_add_u32 s20, s20, 1
    v_mov_b32 v9, s20
    s_cmp_lg_u32 s13, 15
    s_cbranch_scc1 L_p2_nosig0
    s_lshl_b32 s14, s3, 8
    s_add_u32 s14, s14, 8557056
    s_mov_b64 exec, 1
    buffer_atomic_add v9, off, s[4:7], s14 sc0
    s_mov_b64 exec, -1
L_p2_nosig0:
    s_lshl2_add_u32 s14, s3, s49
    s_mul_i32 s26, s14, 20000
    s_add_u32 s15, s26, 8573440
    buffer_load_dwordx4 v[64:67], v1, s[4:7], s15 offen
    buffer_load_dwordx4 v[68:71], v2, s[4:7], s15 offen
    s_lshl_b32 s28, s92, 16
    s_and_b32 s29, s92, 0xffff0000
    s_lshl_b32 s30, s93, 16
    s_and_b32 s31, s93, 0xffff0000
    s_lshl_b32 s32, s94, 16
    s_and_b32 s33, s94, 0xffff0000
    s_lshl_b32 s34, s95, 16
    s_and_b32 s35, s95, 0xffff0000
    s_lshl_b32 s36, s96, 16
    s_and_b32 s37, s96, 0xffff0000
    s_lshl_b32 s38, s97, 16
    s_and_b32 s39, s97, 0xffff0000
    s_lshl_b32 s40, s98, 16
    s_and_b32 s41, s98, 0xffff0000
    s_lshl_b32 s42, s99, 16
    s_and_b32 s43, s99, 0xffff0000
    s_and_b32 s99, s91, 0xffff0000
    s_lshl_b32 s98, s91, 16
    s_and_b32 s97, s90, 0xffff0000
    s_lshl_b32 s96, s90, 16
    s_and_b32 s95, s89, 0xffff0000
    s_lshl_b32 s94, s89, 16
    s_and_b32 s93, s88, 0xffff0000
    s_lshl_b32 s92, s88, 16
    s_and_b32 s91, s87, 0xffff0000
    s_lshl_b32 s90, s87, 16
    s_and_b32 s89, s86, 0xffff0000
    s_lshl_b32 s88, s86, 16
    s_and_b32 s87, s85, 0xffff0000
    s_lshl_b32 s86, s85, 16
    s_and_b32 s85, s84, 0xffff0000
    s_lshl_b32 s84, s84, 16
    s_mov_b32 s44, s48
    s_add_u32 s45, s48, 2281701376
    s_cmp_eq_u32 s48, 0
    s_cselect_b32 s45, 0, s45
    s_cmp_lg_u32 s13, 15
    s_cbranch_scc1 L_p2_nosig
    s_waitcnt vmcnt(2)
    v_readfirstlane_b32 s15, v9
    s_lshl_b32 s51, 1, s12
    s_add_u32 s20, s20, s15
    s_and_b32 s15, s20, 0xff
    s_cmp_eq_u32 s15, 4
    s_cbranch_scc0 L_p2_notlast
    s_bfe_u32 s15, s20, 262160
    s_or_b32 s51, s51, s15
    s_branch L_p2_pub
L_p2_notlast:
    s_cmp_lg_u32 s21, 0
    s_cselect_b32 s51, 0, s51
    s_cbranch_scc1 L_p2_pub
L_p2_poll:
    v_mov_b32 v9, 0
    s_lshl_b32 s14, s3, 8
    s_add_u32 s14, s14, 8557056
    s_mov_b64 exec, 1
    buffer_atomic_add v9, off, s[4:7], s14 sc0
    s_mov_b64 exec, -1
    s_waitcnt vmcnt(0)
    v_readfirstlane_b32 s20, v9
    s_nop 0
    s_and_b32 s15, s20, 0xff
    s_cmp_lt_u32 s15, 4
    s_cbranch_scc1 L_p2_poll
L_p2_pub:
    s_lshl_b32 s15, s51, 24
    s_or_b32 s15, s15, s20
    v_mov_b32 v9, s15
    s_mov_b64 exec, 1
    ds_write_b32 v8, v9
    s_mov_b64 exec, -1
    s_waitcnt lgkmcnt(0)
L_p2_nosig:
    s_barrier
    ds_read_b32 v9, v8
    s_waitcnt lgkmcnt(0)
    v_readfirstlane_b32 s20, v9
    s_nop 0
    s_lshr_b32 s51, s20, 24
    s_cbranch_scc0 L_p2_end
L_p2_fin:
    s_mul_i32 s24, s49, 20000
    s_add_u32 s14, s12, 1
    s_and_b32 s14, s14, 3
    s_mul_i32 s15, s14, 5120000
    s_add_u32 s15, s15, 233832448
    s_add_u32 s15, s15, s26
    buffer_load_dwordx4 v[12:15], v1, s[4:7], s15 offen sc1
    buffer_load_dwordx4 v[92:95], v2, s[4:7], s15 offen sc1
    s_add_u32 s14, s12, 2
    s_and_b32 s14, s14, 3
    s_mul_i32 s15, s14, 5120000
    s_add_u32 s15, s15, 233832448
    s_add_u32 s15, s15, s26
    buffer_load_dwordx4 v[16:19], v1, s[4:7], s15 offen sc1
    buffer_load_dwordx4 v[96:99], v2, s[4:7], s15 offen sc1
    s_add_u32 s14, s12, 3
    s_and_b32 s14, s14, 3
    s_mul_i32 s15, s14, 5120000
    s_add_u32 s15, s15, 233832448
    s_add_u32 s15, s15, s26
    buffer_load_dwordx4 v[20:23], v1, s[4:7], s15 offen sc1
    buffer_load_dwordx4 v[100:103], v2, s[4:7], s15 offen sc1
    v_add_u32 v24, s24, v1
    ds_read_b128 v[8:11], v24
    v_add_u32 v25, s24, v2
    ds_read_b128 v[88:91], v25
    s_waitcnt vmcnt(0) lgkmcnt(0)
    s_bfe_u32 s14, s20, 262164
    s_cbranch_scc0 L_p2_kernel_nof32a_7
    s_add_u32 s14, s12, 0
    s_and_b32 s14, s14, 3
    s_add_u32 s14, s14, 20
    s_bitcmp1_b32 s20, s14
    s_cbranch_scc0 L_p2_kernel_q_8
    v_mov_b32 v8, 1073758208
    v_mov_b32 v9, 1073758208
    v_mov_b32 v10, 1073758208
    v_mov_b32 v11, 1073758208
L_p2_kernel_q_8:
    s_add_u32 s14, s12, 1
    s_and_b32 s14, s14, 3
    s_add_u32 s14, s14, 20
    s_bitcmp1_b32 s20, s14
    s_cbranch_scc0 L_p2_kernel_q_9
    v_mov_b32 v12, 1073758208
    v_mov_b32 v13, 1073758208
    v_mov_b32 v14, 1073758208
    v_mov_b32 v15, 1073758208
L_p2_kernel_q_9:
    s_add_u32 s14, s12, 2
    s_and_b32 s14, s14, 3
    s_add_u32 s14, s14, 20
    s_bitcmp1_b32 s20, s14
    s_cbranch_scc0 L_p2_kernel_q_10
    v_mov_b32 v16, 1073758208
    v_mov_b32 v17, 1073758208
    v_mov_b32 v18, 1073758208
    v_mov_b32 v19, 1073758208
L_p2_kernel_q_10:
    s_add_u32 s14, s12, 3
    s_and_b32 s14, s14, 3
    s_add_u32 s14, s14, 20
    s_bitcmp1_b32 s20, s14
    s_cbranch_scc0 L_p2_kernel_q_11
    v_mov_b32 v20, 1073758208
    v_mov_b32 v21, 1073758208
    v_mov_b32 v22, 1073758208
    v_mov_b32 v23, 1073758208
L_p2_kernel_q_11:
L_p2_kernel_nof32a_7:
    v_pk_add_u16 v8, v8, v12
    v_pk_add_u16 v16, v16, v20
    v_pk_add_u16 v9, v9, v13
    v_pk_add_u16 v17, v17, v21
    v_pk_add_u16 v10, v10, v14
    v_pk_add_u16 v18, v18, v22
    v_pk_add_u16 v11, v11, v15
    v_pk_add_u16 v19, v19, v23
    v_add_u32_sdwa v24, v8, v16 dst_sel:DWORD dst_unused:UNUSED_PAD src0_sel:WORD_0 src1_sel:WORD_0
    v_add_u32_sdwa v25, v10, v18 dst_sel:DWORD dst_unused:UNUSED_PAD src0_sel:WORD_0 src1_sel:WORD_0
    v_add_u32_sdwa v26, v8, v16 dst_sel:DWORD dst_unused:UNUSED_PAD src0_sel:WORD_1 src1_sel:WORD_1
    v_add_u32_sdwa v27, v10, v18 dst_sel:DWORD dst_unused:UNUSED_PAD src0_sel:WORD_1 src1_sel:WORD_1
    v_add_u32_sdwa v28, v9, v17 dst_sel:DWORD dst_unused:UNUSED_PAD src0_sel:WORD_0 src1_sel:WORD_0
    v_add_u32_sdwa v29, v11, v19 dst_sel:DWORD dst_unused:UNUSED_PAD src0_sel:WORD_0 src1_sel:WORD_0
    v_add_u32_sdwa v30, v9, v17 dst_sel:DWORD dst_unused:UNUSED_PAD src0_sel:WORD_1 src1_sel:WORD_1
    v_add_u32_sdwa v31, v11, v19 dst_sel:DWORD dst_unused:UNUSED_PAD src0_sel:WORD_1 src1_sel:WORD_1
    v_cvt_f32_u32 v24, v24
    v_cvt_f32_u32 v25, v25
    v_cvt_f32_u32 v26, v26
    v_cvt_f32_u32 v27, v27
    v_cvt_f32_u32 v28, v28
    v_cvt_f32_u32 v29, v29
    v_cvt_f32_u32 v30, v30
    v_cvt_f32_u32 v31, v31
    v_pk_fma_f32 v[24:25], v[24:25], s[44:45], s[44:45] op_sel:[0,0,1] op_sel_hi:[1,0,1]
    v_pk_fma_f32 v[26:27], v[26:27], s[44:45], s[44:45] op_sel:[0,0,1] op_sel_hi:[1,0,1]
    v_pk_fma_f32 v[28:29], v[28:29], s[44:45], s[44:45] op_sel:[0,0,1] op_sel_hi:[1,0,1]
    v_pk_fma_f32 v[30:31], v[30:31], s[44:45], s[44:45] op_sel:[0,0,1] op_sel_hi:[1,0,1]
    s_bfe_u32 s14, s20, 262164
    s_cbranch_scc0 L_p2_kernel_nof32b_12
    v_lshlrev_b32 v32, 1, v1
    s_bitcmp1_b32 s20, 20
    s_cbranch_scc0 L_p2_kernel_q_13
    s_lshl_b32 s15, s26, 1
    s_add_u32 s15, s15, 254312448
    buffer_load_dwordx4 v[8:11], v32, s[4:7], s15 offen sc1
    buffer_load_dwordx4 v[12:15], v32, s[4:7], s15 offen offset:16 sc1
    s_waitcnt vmcnt(0)
    v_add_f32 v24, v24, v8
    v_add_f32 v25, v25, v12
    v_add_f32 v26, v26, v9
    v_add_f32 v27, v27, v13
    v_add_f32 v28, v28, v10
    v_add_f32 v29, v29, v14
    v_add_f32 v30, v30, v11
    v_add_f32 v31, v31, v15
L_p2_kernel_q_13:
    s_bitcmp1_b32 s20, 21
    s_cbranch_scc0 L_p2_kernel_q_14
    s_lshl_b32 s15, s26, 1
    s_add_u32 s15, s15, 264552448
    buffer_load_dwordx4 v[8:11], v32, s[4:7], s15 offen sc1
    buffer_load_dwordx4 v[12:15], v32, s[4:7], s15 offen offset:16 sc1
    s_waitcnt vmcnt(0)
    v_add_f32 v24, v24, v8
    v_add_f32 v25, v25, v12
    v_add_f32 v26, v26, v9
    v_add_f32 v27, v27, v13
    v_add_f32 v28, v28, v10
    v_add_f32 v29, v29, v14
    v_add_f32 v30, v30, v11
    v_add_f32 v31, v31, v15
L_p2_kernel_q_14:
    s_bitcmp1_b32 s20, 22
    s_cbranch_scc0 L_p2_kernel_q_15
    s_lshl_b32 s15, s26, 1
    s_add_u32 s15, s15, 274792448
    buffer_load_dwordx4 v[8:11], v32, s[4:7], s15 offen sc1
    buffer_load_dwordx4 v[12:15], v32, s[4:7], s15 offen offset:16 sc1
    s_waitcnt vmcnt(0)
    v_add_f32 v24, v24, v8
    v_add_f32 v25, v25, v12
    v_add_f32 v26, v26, v9
    v_add_f32 v27, v27, v13
    v_add_f32 v28, v28, v10
    v_add_f32 v29, v29, v14
    v_add_f32 v30, v30, v11
    v_add_f32 v31, v31, v15
L_p2_kernel_q_15:
    s_bitcmp1_b32 s20, 23
    s_cbranch_scc0 L_p2_kernel_q_16
    s_lshl_b32 s15, s26, 1
    s_add_u32 s15, s15, 285032448
    buffer_load_dwordx4 v[8:11], v32, s[4:7], s15 offen sc1
    buffer_load_dwordx4 v[12:15], v32, s[4:7], s15 offen offset:16 sc1
    s_waitcnt vmcnt(0)
    v_add_f32 v24, v24, v8
    v_add_f32 v25, v25, v12
    v_add_f32 v26, v26, v9
    v_add_f32 v27, v27, v13
    v_add_f32 v28, v28, v10
    v_add_f32 v29, v29, v14
    v_add_f32 v30, v30, v11
    v_add_f32 v31, v31, v15
L_p2_kernel_q_16:
L_p2_kernel_nof32b_12:
    v_pk_mul_f32 v[8:9], v[24:25], s[84:85] op_sel:[0,0] op_sel_hi:[1,0]
    v_pk_mul_f32 v[10:11], v[24:25], s[84:85] op_sel:[0,1] op_sel_hi:[1,1]
    v_pk_mul_f32 v[12:13], v[24:25], s[86:87] op_sel:[0,0] op_sel_hi:[1,0]
    v_pk_mul_f32 v[14:15], v[24:25], s[86:87] op_sel:[0,1] op_sel_hi:[1,1]
    v_pk_fma_f32 v[8:9], v[26:27], s[88:89], v[8:9] op_sel:[0,0,0] op_sel_hi:[1,0,1]
    v_pk_fma_f32 v[10:11], v[26:27], s[88:89], v[10:11] op_sel:[0,1,0] op_sel_hi:[1,1,1]
    v_pk_fma_f32 v[12:13], v[26:27], s[90:91], v[12:13] op_sel:[0,0,0] op_sel_hi:[1,0,1]
    v_pk_fma_f32 v[14:15], v[26:27], s[90:91], v[14:15] op_sel:[0,1,0] op_sel_hi:[1,1,1]
    v_pk_fma_f32 v[8:9], v[28:29], s[92:93], v[8:9] op_sel:[0,0,0] op_sel_hi:[1,0,1]
    v_pk_fma_f32 v[10:11], v[28:29], s[92:93], v[10:11] op_sel:[0,1,0] op_sel_hi:[1,1,1]
    v_pk_fma_f32 v[12:13], v[28:29], s[94:95], v[12:13] op_sel:[0,0,0] op_sel_hi:[1,0,1]
    v_pk_fma_f32 v[14:15], v[28:29], s[94:95], v[14:15] op_sel:[0,1,0] op_sel_hi:[1,1,1]
    v_pk_fma_f32 v[8:9], v[30:31], s[96:97], v[8:9] op_sel:[0,0,0] op_sel_hi:[1,0,1]
    v_pk_fma_f32 v[10:11], v[30:31], s[96:97], v[10:11] op_sel:[0,1,0] op_sel_hi:[1,1,1]
    v_pk_fma_f32 v[12:13], v[30:31], s[98:99], v[12:13] op_sel:[0,0,0] op_sel_hi:[1,0,1]
    v_pk_fma_f32 v[14:15], v[30:31], s[98:99], v[14:15] op_sel:[0,1,0] op_sel_hi:[1,1,1]
    v_pk_mul_f32 v[8:9], v[8:9], v[72:73]
    v_pk_mul_f32 v[10:11], v[10:11], v[74:75]
    v_pk_mul_f32 v[12:13], v[12:13], v[76:77]
    v_pk_mul_f32 v[14:15], v[14:15], v[78:79]
    v_pk_mul_f32 v[24:25], v[8:9], s[28:29] op_sel:[0,0] op_sel_hi:[1,0]
    v_pk_mul_f32 v[26:27], v[8:9], s[28:29] op_sel:[0,1] op_sel_hi:[1,1]
    v_pk_mul_f32 v[28:29], v[8:9], s[30:31] op_sel:[0,0] op_sel_hi:[1,0]
    v_pk_mul_f32 v[30:31], v[8:9], s[30:31] op_sel:[0,1] op_sel_hi:[1,1]
    v_pk_fma_f32 v[24:25], v[10:11], s[32:33], v[24:25] op_sel:[0,0,0] op_sel_hi:[1,0,1]
    v_pk_fma_f32 v[26:27], v[10:11], s[32:33], v[26:27] op_sel:[0,1,0] op_sel_hi:[1,1,1]
    v_pk_fma_f32 v[28:29], v[10:11], s[34:35], v[28:29] op_sel:[0,0,0] op_sel_hi:[1,0,1]
    v_pk_fma_f32 v[30:31], v[10:11], s[34:35], v[30:31] op_sel:[0,1,0] op_sel_hi:[1,1,1]
    v_pk_fma_f32 v[24:25], v[12:13], s[36:37], v[24:25] op_sel:[0,0,0] op_sel_hi:[1,0,1]
    v_pk_fma_f32 v[26:27], v[12:13], s[36:37], v[26:27] op_sel:[0,1,0] op_sel_hi:[1,1,1]
    v_pk_fma_f32 v[28:29], v[12:13], s[38:39], v[28:29] op_sel:[0,0,0] op_sel_hi:[1,0,1]
    v_pk_fma_f32 v[30:31], v[12:13], s[38:39], v[30:31] op_sel:[0,1,0] op_sel_hi:[1,1,1]
    v_pk_fma_f32 v[24:25], v[14:15], s[40:41], v[24:25] op_sel:[0,0,0] op_sel_hi:[1,0,1]
    v_pk_fma_f32 v[26:27], v[14:15], s[40:41], v[26:27] op_sel:[0,1,0] op_sel_hi:[1,1,1]
    v_pk_fma_f32 v[28:29], v[14:15], s[42:43], v[28:29] op_sel:[0,0,0] op_sel_hi:[1,0,1]
    v_pk_fma_f32 v[30:31], v[14:15], s[42:43], v[30:31] op_sel:[0,1,0] op_sel_hi:[1,1,1]
    v_lshlrev_b32 v8, 16, v64
    v_and_b32 v10, 0xffff0000, v64
    v_lshlrev_b32 v12, 16, v65
    v_and_b32 v14, 0xffff0000, v65
    v_lshlrev_b32 v9, 16, v66
    v_and_b32 v11, 0xffff0000, v66
    v_lshlrev_b32 v13, 16, v67
    v_and_b32 v15, 0xffff0000, v67
    v_pk_fma_f32 v[8:9], v[24:25], v[80:81], v[8:9]
    v_pk_fma_f32 v[10:11], v[26:27], v[82:83], v[10:11]
    v_pk_fma_f32 v[12:13], v[28:29], v[84:85], v[12:13]
    v_pk_fma_f32 v[14:15], v[30:31], v[86:87], v[14:15]
    v_cvt_pk_bf16_f32 v16, v8, v10
    v_cvt_pk_bf16_f32 v17, v12, v14
    v_cvt_pk_bf16_f32 v18, v9, v11
    v_cvt_pk_bf16_f32 v19, v13, v15
    buffer_store_dwordx4 v[16:19], v1, s[16:19], s26 offen
    s_cmp_ge_u32 s13, 4
    s_cbranch_scc1 L_p2_f1
    s_bfe_u32 s14, s20, 262164
    s_cbranch_scc0 L_p2_kernel_nof32a_17
    s_add_u32 s14, s12, 0
    s_and_b32 s14, s14, 3
    s_add_u32 s14, s14, 20
    s_bitcmp1_b32 s20, s14
    s_cbranch_scc0 L_p2_kernel_q_18
    v_mov_b32 v88, 1073758208
    v_mov_b32 v89, 1073758208
    v_mov_b32 v90, 1073758208
    v_mov_b32 v91, 1073758208
L_p2_kernel_q_18:
    s_add_u32 s14, s12, 1
    s_and_b32 s14, s14, 3
    s_add_u32 s14, s14, 20
    s_bitcmp1_b32 s20, s14
    s_cbranch_scc0 L_p2_kernel_q_19
    v_mov_b32 v92, 1073758208
    v_mov_b32 v93, 1073758208
    v_mov_b32 v94, 1073758208
    v_mov_b32 v95, 1073758208
L_p2_kernel_q_19:
    s_add_u32 s14, s12, 2
    s_and_b32 s14, s14, 3
    s_add_u32 s14, s14, 20
    s_bitcmp1_b32 s20, s14
    s_cbranch_scc0 L_p2_kernel_q_20
    v_mov_b32 v96, 1073758208
    v_mov_b32 v97, 1073758208
    v_mov_b32 v98, 1073758208
    v_mov_b32 v99, 1073758208
L_p2_kernel_q_20:
    s_add_u32 s14, s12, 3
    s_and_b32 s14, s14, 3
    s_add_u32 s14, s14, 20
    s_bitcmp1_b32 s20, s14
    s_cbranch_scc0 L_p2_kernel_q_21
    v_mov_b32 v100, 1073758208
    v_mov_b32 v101, 1073758208
    v_mov_b32 v102, 1073758208
    v_mov_b32 v103, 1073758208
L_p2_kernel_q_21:
L_p2_kernel_nof32a_17:
    v_pk_add_u16 v88, v88, v92
    v_pk_add_u16 v96, v96, v100
    v_pk_add_u16 v89, v89, v93
    v_pk_add_u16 v97, v97, v101
    v_pk_add_u16 v90, v90, v94
    v_pk_add_u16 v98, v98, v102
    v_pk_add_u16 v91, v91, v95
    v_pk_add_u16 v99, v99, v103
    v_add_u32_sdwa v24, v88, v96 dst_sel:DWORD dst_unused:UNUSED_PAD src0_sel:WORD_0 src1_sel:WORD_0
    v_add_u32_sdwa v25, v90, v98 dst_sel:DWORD dst_unused:UNUSED_PAD src0_sel:WORD_0 src1_sel:WORD_0
    v_add_u32_sdwa v26, v88, v96 dst_sel:DWORD dst_unused:UNUSED_PAD src0_sel:WORD_1 src1_sel:WORD_1
    v_add_u32_sdwa v27, v90, v98 dst_sel:DWORD dst_unused:UNUSED_PAD src0_sel:WORD_1 src1_sel:WORD_1
    v_add_u32_sdwa v28, v89, v97 dst_sel:DWORD dst_unused:UNUSED_PAD src0_sel:WORD_0 src1_sel:WORD_0
    v_add_u32_sdwa v29, v91, v99 dst_sel:DWORD dst_unused:UNUSED_PAD src0_sel:WORD_0 src1_sel:WORD_0
    v_add_u32_sdwa v30, v89, v97 dst_sel:DWORD dst_unused:UNUSED_PAD src0_sel:WORD_1 src1_sel:WORD_1
    v_add_u32_sdwa v31, v91, v99 dst_sel:DWORD dst_unused:UNUSED_PAD src0_sel:WORD_1 src1_sel:WORD_1
    v_cvt_f32_u32 v24, v24
    v_cvt_f32_u32 v25, v25
    v_cvt_f32_u32 v26, v26
    v_cvt_f32_u32 v27, v27
    v_cvt_f32_u32 v28, v28
    v_cvt_f32_u32 v29, v29
    v_cvt_f32_u32 v30, v30
    v_cvt_f32_u32 v31, v31
    v_pk_fma_f32 v[24:25], v[24:25], s[44:45], s[44:45] op_sel:[0,0,1] op_sel_hi:[1,0,1]
    v_pk_fma_f32 v[26:27], v[26:27], s[44:45], s[44:45] op_sel:[0,0,1] op_sel_hi:[1,0,1]
    v_pk_fma_f32 v[28:29], v[28:29], s[44:45], s[44:45] op_sel:[0,0,1] op_sel_hi:[1,0,1]
    v_pk_fma_f32 v[30:31], v[30:31], s[44:45], s[44:45] op_sel:[0,0,1] op_sel_hi:[1,0,1]
    s_bfe_u32 s14, s20, 262164
    s_cbranch_scc0 L_p2_kernel_nof32b_22
    v_lshlrev_b32 v32, 1, v2
    s_bitcmp1_b32 s20, 20
    s_cbranch_scc0 L_p2_kernel_q_23
    s_lshl_b32 s15, s26, 1
    s_add_u32 s15, s15, 254312448
    buffer_load_dwordx4 v[88:91], v32, s[4:7], s15 offen sc1
    buffer_load_dwordx4 v[92:95], v32, s[4:7], s15 offen offset:16 sc1
    s_waitcnt vmcnt(0)
    v_add_f32 v24, v24, v88
    v_add_f32 v25, v25, v92
    v_add_f32 v26, v26, v89
    v_add_f32 v27, v27, v93
    v_add_f32 v28, v28, v90
    v_add_f32 v29, v29, v94
    v_add_f32 v30, v30, v91
    v_add_f32 v31, v31, v95
L_p2_kernel_q_23:
    s_bitcmp1_b32 s20, 21
    s_cbranch_scc0 L_p2_kernel_q_24
    s_lshl_b32 s15, s26, 1
    s_add_u32 s15, s15, 264552448
    buffer_load_dwordx4 v[88:91], v32, s[4:7], s15 offen sc1
    buffer_load_dwordx4 v[92:95], v32, s[4:7], s15 offen offset:16 sc1
    s_waitcnt vmcnt(0)
    v_add_f32 v24, v24, v88
    v_add_f32 v25, v25, v92
    v_add_f32 v26, v26, v89
    v_add_f32 v27, v27, v93
    v_add_f32 v28, v28, v90
    v_add_f32 v29, v29, v94
    v_add_f32 v30, v30, v91
    v_add_f32 v31, v31, v95
L_p2_kernel_q_24:
    s_bitcmp1_b32 s20, 22
    s_cbranch_scc0 L_p2_kernel_q_25
    s_lshl_b32 s15, s26, 1
    s_add_u32 s15, s15, 274792448
    buffer_load_dwordx4 v[88:91], v32, s[4:7], s15 offen sc1
    buffer_load_dwordx4 v[92:95], v32, s[4:7], s15 offen offset:16 sc1
    s_waitcnt vmcnt(0)
    v_add_f32 v24, v24, v88
    v_add_f32 v25, v25, v92
    v_add_f32 v26, v26, v89
    v_add_f32 v27, v27, v93
    v_add_f32 v28, v28, v90
    v_add_f32 v29, v29, v94
    v_add_f32 v30, v30, v91
    v_add_f32 v31, v31, v95
L_p2_kernel_q_25:
    s_bitcmp1_b32 s20, 23
    s_cbranch_scc0 L_p2_kernel_q_26
    s_lshl_b32 s15, s26, 1
    s_add_u32 s15, s15, 285032448
    buffer_load_dwordx4 v[88:91], v32, s[4:7], s15 offen sc1
    buffer_load_dwordx4 v[92:95], v32, s[4:7], s15 offen offset:16 sc1
    s_waitcnt vmcnt(0)
    v_add_f32 v24, v24, v88
    v_add_f32 v25, v25, v92
    v_add_f32 v26, v26, v89
    v_add_f32 v27, v27, v93
    v_add_f32 v28, v28, v90
    v_add_f32 v29, v29, v94
    v_add_f32 v30, v30, v91
    v_add_f32 v31, v31, v95
L_p2_kernel_q_26:
L_p2_kernel_nof32b_22:
    v_pk_mul_f32 v[88:89], v[24:25], s[84:85] op_sel:[0,0] op_sel_hi:[1,0]
    v_pk_mul_f32 v[90:91], v[24:25], s[84:85] op_sel:[0,1] op_sel_hi:[1,1]
    v_pk_mul_f32 v[92:93], v[24:25], s[86:87] op_sel:[0,0] op_sel_hi:[1,0]
    v_pk_mul_f32 v[94:95], v[24:25], s[86:87] op_sel:[0,1] op_sel_hi:[1,1]
    v_pk_fma_f32 v[88:89], v[26:27], s[88:89], v[88:89] op_sel:[0,0,0] op_sel_hi:[1,0,1]
    v_pk_fma_f32 v[90:91], v[26:27], s[88:89], v[90:91] op_sel:[0,1,0] op_sel_hi:[1,1,1]
    v_pk_fma_f32 v[92:93], v[26:27], s[90:91], v[92:93] op_sel:[0,0,0] op_sel_hi:[1,0,1]
    v_pk_fma_f32 v[94:95], v[26:27], s[90:91], v[94:95] op_sel:[0,1,0] op_sel_hi:[1,1,1]
    v_pk_fma_f32 v[88:89], v[28:29], s[92:93], v[88:89] op_sel:[0,0,0] op_sel_hi:[1,0,1]
    v_pk_fma_f32 v[90:91], v[28:29], s[92:93], v[90:91] op_sel:[0,1,0] op_sel_hi:[1,1,1]
    v_pk_fma_f32 v[92:93], v[28:29], s[94:95], v[92:93] op_sel:[0,0,0] op_sel_hi:[1,0,1]
    v_pk_fma_f32 v[94:95], v[28:29], s[94:95], v[94:95] op_sel:[0,1,0] op_sel_hi:[1,1,1]
    v_pk_fma_f32 v[88:89], v[30:31], s[96:97], v[88:89] op_sel:[0,0,0] op_sel_hi:[1,0,1]
    v_pk_fma_f32 v[90:91], v[30:31], s[96:97], v[90:91] op_sel:[0,1,0] op_sel_hi:[1,1,1]
    v_pk_fma_f32 v[92:93], v[30:31], s[98:99], v[92:93] op_sel:[0,0,0] op_sel_hi:[1,0,1]
    v_pk_fma_f32 v[94:95], v[30:31], s[98:99], v[94:95] op_sel:[0,1,0] op_sel_hi:[1,1,1]
    v_pk_mul_f32 v[88:89], v[88:89], v[112:113]
    v_pk_mul_f32 v[90:91], v[90:91], v[114:115]
    v_pk_mul_f32 v[92:93], v[92:93], v[116:117]
    v_pk_mul_f32 v[94:95], v[94:95], v[118:119]
    v_pk_mul_f32 v[24:25], v[88:89], s[28:29] op_sel:[0,0] op_sel_hi:[1,0]
    v_pk_mul_f32 v[26:27], v[88:89], s[28:29] op_sel:[0,1] op_sel_hi:[1,1]
    v_pk_mul_f32 v[28:29], v[88:89], s[30:31] op_sel:[0,0] op_sel_hi:[1,0]
    v_pk_mul_f32 v[30:31], v[88:89], s[30:31] op_sel:[0,1] op_sel_hi:[1,1]
    v_pk_fma_f32 v[24:25], v[90:91], s[32:33], v[24:25] op_sel:[0,0,0] op_sel_hi:[1,0,1]
    v_pk_fma_f32 v[26:27], v[90:91], s[32:33], v[26:27] op_sel:[0,1,0] op_sel_hi:[1,1,1]
    v_pk_fma_f32 v[28:29], v[90:91], s[34:35], v[28:29] op_sel:[0,0,0] op_sel_hi:[1,0,1]
    v_pk_fma_f32 v[30:31], v[90:91], s[34:35], v[30:31] op_sel:[0,1,0] op_sel_hi:[1,1,1]
    v_pk_fma_f32 v[24:25], v[92:93], s[36:37], v[24:25] op_sel:[0,0,0] op_sel_hi:[1,0,1]
    v_pk_fma_f32 v[26:27], v[92:93], s[36:37], v[26:27] op_sel:[0,1,0] op_sel_hi:[1,1,1]
    v_pk_fma_f32 v[28:29], v[92:93], s[38:39], v[28:29] op_sel:[0,0,0] op_sel_hi:[1,0,1]
    v_pk_fma_f32 v[30:31], v[92:93], s[38:39], v[30:31] op_sel:[0,1,0] op_sel_hi:[1,1,1]
    v_pk_fma_f32 v[24:25], v[94:95], s[40:41], v[24:25] op_sel:[0,0,0] op_sel_hi:[1,0,1]
    v_pk_fma_f32 v[26:27], v[94:95], s[40:41], v[26:27] op_sel:[0,1,0] op_sel_hi:[1,1,1]
    v_pk_fma_f32 v[28:29], v[94:95], s[42:43], v[28:29] op_sel:[0,0,0] op_sel_hi:[1,0,1]
    v_pk_fma_f32 v[30:31], v[94:95], s[42:43], v[30:31] op_sel:[0,1,0] op_sel_hi:[1,1,1]
    v_lshlrev_b32 v88, 16, v68
    v_and_b32 v90, 0xffff0000, v68
    v_lshlrev_b32 v92, 16, v69
    v_and_b32 v94, 0xffff0000, v69
    v_lshlrev_b32 v89, 16, v70
    v_and_b32 v91, 0xffff0000, v70
    v_lshlrev_b32 v93, 16, v71
    v_and_b32 v95, 0xffff0000, v71
    v_pk_fma_f32 v[88:89], v[24:25], v[120:121], v[88:89]
    v_pk_fma_f32 v[90:91], v[26:27], v[122:123], v[90:91]
    v_pk_fma_f32 v[92:93], v[28:29], v[124:125], v[92:93]
    v_pk_fma_f32 v[94:95], v[30:31], v[126:127], v[94:95]
    v_cvt_pk_bf16_f32 v96, v88, v90
    v_cvt_pk_bf16_f32 v97, v92, v94
    v_cvt_pk_bf16_f32 v98, v89, v91
    v_cvt_pk_bf16_f32 v99, v93, v95
    buffer_store_dwordx4 v[96:99], v2, s[16:19], s26 offen
L_p2_f1:
    s_bitset0_b32 s51, s49
    s_cmp_eq_u32 s51, 0
    s_cbranch_scc1 L_p2_done
    s_ff1_i32_b32 s49, s51
    s_lshl2_add_u32 s14, s3, s49
    s_mul_i32 s14, s14, 5000
    s_add_u32 s15, s14, 4096
    v_min_u32 v61, 225, v0
    v_lshl_add_u32 v60, v0, 2, s14
    v_lshl_add_u32 v61, v61, 2, s15
    global_load_dword v60, v60, s[100:101] nt
    global_load_dword v61, v61, s[100:101] nt
    s_waitcnt vmcnt(0)
    v_lshlrev_b32 v30, 16, v60
    v_and_b32 v31, 0xffff0000, v60
    v_lshlrev_b32 v36, 16, v53
    v_and_b32 v37, 0xffff0000, v53
    v_lshlrev_b32 v38, 16, v54
    v_and_b32 v39, 0xffff0000, v54
    v_lshlrev_b32 v40, 16, v56
    v_and_b32 v41, 0xffff0000, v56
    v_lshlrev_b32 v42, 16, v57
    v_and_b32 v43, 0xffff0000, v57
    v_pk_add_f32 v[14:15], v[30:31], v[36:37] op_sel:[0,0] op_sel_hi:[1,0] neg_lo:[0,1] neg_hi:[0,1]
    v_pk_add_f32 v[16:17], v[30:31], v[36:37] op_sel:[0,1] op_sel_hi:[1,1] neg_lo:[0,1] neg_hi:[0,1]
    v_pk_add_f32 v[18:19], v[30:31], v[38:39] op_sel:[0,0] op_sel_hi:[1,0] neg_lo:[0,1] neg_hi:[0,1]
    v_pk_add_f32 v[20:21], v[30:31], v[38:39] op_sel:[0,1] op_sel_hi:[1,1] neg_lo:[0,1] neg_hi:[0,1]
    v_pk_add_f32 v[22:23], v[30:31], v[40:41] op_sel:[0,0] op_sel_hi:[1,0] neg_lo:[0,1] neg_hi:[0,1]
    v_pk_add_f32 v[24:25], v[30:31], v[40:41] op_sel:[0,1] op_sel_hi:[1,1] neg_lo:[0,1] neg_hi:[0,1]
    v_pk_add_f32 v[26:27], v[30:31], v[42:43] op_sel:[0,0] op_sel_hi:[1,0] neg_lo:[0,1] neg_hi:[0,1]
    v_pk_add_f32 v[28:29], v[30:31], v[42:43] op_sel:[0,1] op_sel_hi:[1,1] neg_lo:[0,1] neg_hi:[0,1]
    v_cvt_pk_bf16_f32 v32, v14, v15
    v_lshlrev_b32 v14, 16, v32
    v_and_b32 v15, 0xffff0000, v32
    v_cvt_pk_bf16_f32 v32, v16, v17
    v_lshlrev_b32 v16, 16, v32
    v_and_b32 v17, 0xffff0000, v32
    v_cvt_pk_bf16_f32 v32, v18, v19
    v_lshlrev_b32 v18, 16, v32
    v_and_b32 v19, 0xffff0000, v32
    v_cvt_pk_bf16_f32 v32, v20, v21
    v_lshlrev_b32 v20, 16, v32
    v_and_b32 v21, 0xffff0000, v32
    v_cvt_pk_bf16_f32 v32, v22, v23
    v_lshlrev_b32 v22, 16, v32
    v_and_b32 v23, 0xffff0000, v32
    v_cvt_pk_bf16_f32 v32, v24, v25
    v_lshlrev_b32 v24, 16, v32
    v_and_b32 v25, 0xffff0000, v32
    v_cvt_pk_bf16_f32 v32, v26, v27
    v_lshlrev_b32 v26, 16, v32
    v_and_b32 v27, 0xffff0000, v32
    v_cvt_pk_bf16_f32 v32, v28, v29
    v_lshlrev_b32 v28, 16, v32
    v_and_b32 v29, 0xffff0000, v32
    v_pk_mul_f32 v[14:15], v[14:15], v[14:15]
    v_pk_mul_f32 v[16:17], v[16:17], v[16:17]
    v_pk_mul_f32 v[18:19], v[18:19], v[18:19]
    v_pk_mul_f32 v[20:21], v[20:21], v[20:21]
    v_pk_mul_f32 v[22:23], v[22:23], v[22:23]
    v_pk_mul_f32 v[24:25], v[24:25], v[24:25]
    v_pk_mul_f32 v[26:27], v[26:27], v[26:27]
    v_pk_mul_f32 v[28:29], v[28:29], v[28:29]
    v_cvt_pk_bf16_f32 v32, v14, v15
    v_lshlrev_b32 v14, 16, v32
    v_and_b32 v15, 0xffff0000, v32
    v_cvt_pk_bf16_f32 v32, v16, v17
    v_lshlrev_b32 v16, 16, v32
    v_and_b32 v17, 0xffff0000, v32
    v_cvt_pk_bf16_f32 v32, v18, v19
    v_lshlrev_b32 v18, 16, v32
    v_and_b32 v19, 0xffff0000, v32
    v_cvt_pk_bf16_f32 v32, v20, v21
    v_lshlrev_b32 v20, 16, v32
    v_and_b32 v21, 0xffff0000, v32
    v_cvt_pk_bf16_f32 v32, v22, v23
    v_lshlrev_b32 v22, 16, v32
    v_and_b32 v23, 0xffff0000, v32
    v_cvt_pk_bf16_f32 v32, v24, v25
    v_lshlrev_b32 v24, 16, v32
    v_and_b32 v25, 0xffff0000, v32
    v_cvt_pk_bf16_f32 v32, v26, v27
    v_lshlrev_b32 v26, 16, v32
    v_and_b32 v27, 0xffff0000, v32
    v_cvt_pk_bf16_f32 v32, v28, v29
    v_lshlrev_b32 v28, 16, v32
    v_and_b32 v29, 0xffff0000, v32
    v_mov_b32 v30, 1092616192
    v_mov_b32 v31, 0x3fb8aa3b
    v_pk_mul_f32 v[14:15], v[14:15], v[30:31] op_sel:[0,0] op_sel_hi:[1,0]
    v_pk_mul_f32 v[16:17], v[16:17], v[30:31] op_sel:[0,0] op_sel_hi:[1,0]
    v_pk_mul_f32 v[18:19], v[18:19], v[30:31] op_sel:[0,0] op_sel_hi:[1,0]
    v_pk_mul_f32 v[20:21], v[20:21], v[30:31] op_sel:[0,0] op_sel_hi:[1,0]
    v_pk_mul_f32 v[22:23], v[22:23], v[30:31] op_sel:[0,0] op_sel_hi:[1,0]
    v_pk_mul_f32 v[24:25], v[24:25], v[30:31] op_sel:[0,0] op_sel_hi:[1,0]
    v_pk_mul_f32 v[26:27], v[26:27], v[30:31] op_sel:[0,0] op_sel_hi:[1,0]
    v_pk_mul_f32 v[28:29], v[28:29], v[30:31] op_sel:[0,0] op_sel_hi:[1,0]
    v_cvt_pk_bf16_f32 v32, v14, v15
    v_lshlrev_b32 v14, 16, v32
    v_and_b32 v15, 0xffff0000, v32
    v_cvt_pk_bf16_f32 v32, v16, v17
    v_lshlrev_b32 v16, 16, v32
    v_and_b32 v17, 0xffff0000, v32
    v_cvt_pk_bf16_f32 v32, v18, v19
    v_lshlrev_b32 v18, 16, v32
    v_and_b32 v19, 0xffff0000, v32
    v_cvt_pk_bf16_f32 v32, v20, v21
    v_lshlrev_b32 v20, 16, v32
    v_and_b32 v21, 0xffff0000, v32
    v_cvt_pk_bf16_f32 v32, v22, v23
    v_lshlrev_b32 v22, 16, v32
    v_and_b32 v23, 0xffff0000, v32
    v_cvt_pk_bf16_f32 v32, v24, v25
    v_lshlrev_b32 v24, 16, v32
    v_and_b32 v25, 0xffff0000, v32
    v_cvt_pk_bf16_f32 v32, v26, v27
    v_lshlrev_b32 v26, 16, v32
    v_and_b32 v27, 0xffff0000, v32
    v_cvt_pk_bf16_f32 v32, v28, v29
    v_lshlrev_b32 v28, 16, v32
    v_and_b32 v29, 0xffff0000, v32
    v_pk_mul_f32 v[14:15], v[14:15], v[30:31] op_sel:[0,1] op_sel_hi:[1,1]
    v_pk_mul_f32 v[16:17], v[16:17], v[30:31] op_sel:[0,1] op_sel_hi:[1,1]
    v_pk_mul_f32 v[18:19], v[18:19], v[30:31] op_sel:[0,1] op_sel_hi:[1,1]
    v_pk_mul_f32 v[20:21], v[20:21], v[30:31] op_sel:[0,1] op_sel_hi:[1,1]
    v_pk_mul_f32 v[22:23], v[22:23], v[30:31] op_sel:[0,1] op_sel_hi:[1,1]
    v_pk_mul_f32 v[24:25], v[24:25], v[30:31] op_sel:[0,1] op_sel_hi:[1,1]
    v_pk_mul_f32 v[26:27], v[26:27], v[30:31] op_sel:[0,1] op_sel_hi:[1,1]
    v_pk_mul_f32 v[28:29], v[28:29], v[30:31] op_sel:[0,1] op_sel_hi:[1,1]
    v_exp_f32 v14, -v14
    v_exp_f32 v15, -v15
    v_exp_f32 v16, -v16
    v_exp_f32 v17, -v17
    v_exp_f32 v18, -v18
    v_exp_f32 v19, -v19
    v_exp_f32 v20, -v20
    v_exp_f32 v21, -v21
    v_exp_f32 v22, -v22
    v_exp_f32 v23, -v23
    v_exp_f32 v24, -v24
    v_exp_f32 v25, -v25
    v_exp_f32 v26, -v26
    v_exp_f32 v27, -v27
    v_exp_f32 v28, -v28
    v_exp_f32 v29, -v29
    v_cvt_pk_bf16_f32 v14, v14, v16
    v_cvt_pk_bf16_f32 v15, v15, v17
    v_cvt_pk_bf16_f32 v18, v18, v20
    v_cvt_pk_bf16_f32 v19, v19, v21
    v_cvt_pk_bf16_f32 v22, v22, v24
    v_cvt_pk_bf16_f32 v23, v23, v25
    v_cvt_pk_bf16_f32 v26, v26, v28
    v_cvt_pk_bf16_f32 v27, v27, v29
    v_dot2_f32_bf16 v72, v14, s68, 0
    v_dot2_f32_bf16 v73, v15, s68, 0
    v_dot2_f32_bf16 v74, v14, s69, 0
    v_dot2_f32_bf16 v75, v15, s69, 0
    v_dot2_f32_bf16 v76, v14, s70, 0
    v_dot2_f32_bf16 v77, v15, s70, 0
    v_dot2_f32_bf16 v78, v14, s71, 0
    v_dot2_f32_bf16 v79, v15, s71, 0
    v_dot2_f32_bf16 v80, v14, s52, 0
    v_dot2_f32_bf16 v81, v15, s52, 0
    v_dot2_f32_bf16 v82, v14, s53, 0
    v_dot2_f32_bf16 v83, v15, s53, 0
    v_dot2_f32_bf16 v84, v14, s54, 0
    v_dot2_f32_bf16 v85, v15, s54, 0
    v_dot2_f32_bf16 v86, v14, s55, 0
    v_dot2_f32_bf16 v87, v15, s55, 0
    v_dot2_f32_bf16 v72, v18, s72, v72
    v_dot2_f32_bf16 v73, v19, s72, v73
    v_dot2_f32_bf16 v74, v18, s73, v74
    v_dot2_f32_bf16 v75, v19, s73, v75
    v_dot2_f32_bf16 v76, v18, s74, v76
    v_dot2_f32_bf16 v77, v19, s74, v77
    v_dot2_f32_bf16 v78, v18, s75, v78
    v_dot2_f32_bf16 v79, v19, s75, v79
    v_dot2_f32_bf16 v80, v18, s56, v80
    v_dot2_f32_bf16 v81, v19, s56, v81
    v_dot2_f32_bf16 v82, v18, s57, v82
    v_dot2_f32_bf16 v83, v19, s57, v83
    v_dot2_f32_bf16 v84, v18, s58, v84
    v_dot2_f32_bf16 v85, v19, s58, v85
    v_dot2_f32_bf16 v86, v18, s59, v86
    v_dot2_f32_bf16 v87, v19, s59, v87
    v_dot2_f32_bf16 v72, v22, s76, v72
    v_dot2_f32_bf16 v73, v23, s76, v73
    v_dot2_f32_bf16 v74, v22, s77, v74
    v_dot2_f32_bf16 v75, v23, s77, v75
    v_dot2_f32_bf16 v76, v22, s78, v76
    v_dot2_f32_bf16 v77, v23, s78, v77
    v_dot2_f32_bf16 v78, v22, s79, v78
    v_dot2_f32_bf16 v79, v23, s79, v79
    v_dot2_f32_bf16 v80, v22, s60, v80
    v_dot2_f32_bf16 v81, v23, s60, v81
    v_dot2_f32_bf16 v82, v22, s61, v82
    v_dot2_f32_bf16 v83, v23, s61, v83
    v_dot2_f32_bf16 v84, v22, s62, v84
    v_dot2_f32_bf16 v85, v23, s62, v85
    v_dot2_f32_bf16 v86, v22, s63, v86
    v_dot2_f32_bf16 v87, v23, s63, v87
    v_dot2_f32_bf16 v72, v26, s80, v72
    v_dot2_f32_bf16 v73, v27, s80, v73
    v_dot2_f32_bf16 v74, v26, s81, v74
    v_dot2_f32_bf16 v75, v27, s81, v75
    v_dot2_f32_bf16 v76, v26, s82, v76
    v_dot2_f32_bf16 v77, v27, s82, v77
    v_dot2_f32_bf16 v78, v26, s83, v78
    v_dot2_f32_bf16 v79, v27, s83, v79
    v_dot2_f32_bf16 v80, v26, s64, v80
    v_dot2_f32_bf16 v81, v27, s64, v81
    v_dot2_f32_bf16 v82, v26, s65, v82
    v_dot2_f32_bf16 v83, v27, s65, v83
    v_dot2_f32_bf16 v84, v26, s66, v84
    v_dot2_f32_bf16 v85, v27, s66, v85
    v_dot2_f32_bf16 v86, v26, s67, v86
    v_dot2_f32_bf16 v87, v27, s67, v87
    s_cmp_ge_u32 s13, 4
    s_cbranch_scc1 L_p2_kernel_g1_27
    v_lshlrev_b32 v30, 16, v61
    v_and_b32 v31, 0xffff0000, v61
    v_pk_add_f32 v[14:15], v[30:31], v[36:37] op_sel:[0,0] op_sel_hi:[1,0] neg_lo:[0,1] neg_hi:[0,1]
    v_pk_add_f32 v[16:17], v[30:31], v[36:37] op_sel:[0,1] op_sel_hi:[1,1] neg_lo:[0,1] neg_hi:[0,1]
    v_pk_add_f32 v[18:19], v[30:31], v[38:39] op_sel:[0,0] op_sel_hi:[1,0] neg_lo:[0,1] neg_hi:[0,1]
    v_pk_add_f32 v[20:21], v[30:31], v[38:39] op_sel:[0,1] op_sel_hi:[1,1] neg_lo:[0,1] neg_hi:[0,1]
    v_pk_add_f32 v[22:23], v[30:31], v[40:41] op_sel:[0,0] op_sel_hi:[1,0] neg_lo:[0,1] neg_hi:[0,1]
    v_pk_add_f32 v[24:25], v[30:31], v[40:41] op_sel:[0,1] op_sel_hi:[1,1] neg_lo:[0,1] neg_hi:[0,1]
    v_pk_add_f32 v[26:27], v[30:31], v[42:43] op_sel:[0,0] op_sel_hi:[1,0] neg_lo:[0,1] neg_hi:[0,1]
    v_pk_add_f32 v[28:29], v[30:31], v[42:43] op_sel:[0,1] op_sel_hi:[1,1] neg_lo:[0,1] neg_hi:[0,1]
    v_cvt_pk_bf16_f32 v32, v14, v15
    v_lshlrev_b32 v14, 16, v32
    v_and_b32 v15, 0xffff0000, v32
    v_cvt_pk_bf16_f32 v32, v16, v17
    v_lshlrev_b32 v16, 16, v32
    v_and_b32 v17, 0xffff0000, v32
    v_cvt_pk_bf16_f32 v32, v18, v19
    v_lshlrev_b32 v18, 16, v32
    v_and_b32 v19, 0xffff0000, v32
    v_cvt_pk_bf16_f32 v32, v20, v21
    v_lshlrev_b32 v20, 16, v32
    v_and_b32 v21, 0xffff0000, v32
    v_cvt_pk_bf16_f32 v32, v22, v23
    v_lshlrev_b32 v22, 16, v32
    v_and_b32 v23, 0xffff0000, v32
    v_cvt_pk_bf16_f32 v32, v24, v25
    v_lshlrev_b32 v24, 16, v32
    v_and_b32 v25, 0xffff0000, v32
    v_cvt_pk_bf16_f32 v32, v26, v27
    v_lshlrev_b32 v26, 16, v32
    v_and_b32 v27, 0xffff0000, v32
    v_cvt_pk_bf16_f32 v32, v28, v29
    v_lshlrev_b32 v28, 16, v32
    v_and_b32 v29, 0xffff0000, v32
    v_pk_mul_f32 v[14:15], v[14:15], v[14:15]
    v_pk_mul_f32 v[16:17], v[16:17], v[16:17]
    v_pk_mul_f32 v[18:19], v[18:19], v[18:19]
    v_pk_mul_f32 v[20:21], v[20:21], v[20:21]
    v_pk_mul_f32 v[22:23], v[22:23], v[22:23]
    v_pk_mul_f32 v[24:25], v[24:25], v[24:25]
    v_pk_mul_f32 v[26:27], v[26:27], v[26:27]
    v_pk_mul_f32 v[28:29], v[28:29], v[28:29]
    v_cvt_pk_bf16_f32 v32, v14, v15
    v_lshlrev_b32 v14, 16, v32
    v_and_b32 v15, 0xffff0000, v32
    v_cvt_pk_bf16_f32 v32, v16, v17
    v_lshlrev_b32 v16, 16, v32
    v_and_b32 v17, 0xffff0000, v32
    v_cvt_pk_bf16_f32 v32, v18, v19
    v_lshlrev_b32 v18, 16, v32
    v_and_b32 v19, 0xffff0000, v32
    v_cvt_pk_bf16_f32 v32, v20, v21
    v_lshlrev_b32 v20, 16, v32
    v_and_b32 v21, 0xffff0000, v32
    v_cvt_pk_bf16_f32 v32, v22, v23
    v_lshlrev_b32 v22, 16, v32
    v_and_b32 v23, 0xffff0000, v32
    v_cvt_pk_bf16_f32 v32, v24, v25
    v_lshlrev_b32 v24, 16, v32
    v_and_b32 v25, 0xffff0000, v32
    v_cvt_pk_bf16_f32 v32, v26, v27
    v_lshlrev_b32 v26, 16, v32
    v_and_b32 v27, 0xffff0000, v32
    v_cvt_pk_bf16_f32 v32, v28, v29
    v_lshlrev_b32 v28, 16, v32
    v_and_b32 v29, 0xffff0000, v32
    v_mov_b32 v30, 1092616192
    v_mov_b32 v31, 0x3fb8aa3b
    v_pk_mul_f32 v[14:15], v[14:15], v[30:31] op_sel:[0,0] op_sel_hi:[1,0]
    v_pk_mul_f32 v[16:17], v[16:17], v[30:31] op_sel:[0,0] op_sel_hi:[1,0]
    v_pk_mul_f32 v[18:19], v[18:19], v[30:31] op_sel:[0,0] op_sel_hi:[1,0]
    v_pk_mul_f32 v[20:21], v[20:21], v[30:31] op_sel:[0,0] op_sel_hi:[1,0]
    v_pk_mul_f32 v[22:23], v[22:23], v[30:31] op_sel:[0,0] op_sel_hi:[1,0]
    v_pk_mul_f32 v[24:25], v[24:25], v[30:31] op_sel:[0,0] op_sel_hi:[1,0]
    v_pk_mul_f32 v[26:27], v[26:27], v[30:31] op_sel:[0,0] op_sel_hi:[1,0]
    v_pk_mul_f32 v[28:29], v[28:29], v[30:31] op_sel:[0,0] op_sel_hi:[1,0]
    v_cvt_pk_bf16_f32 v32, v14, v15
    v_lshlrev_b32 v14, 16, v32
    v_and_b32 v15, 0xffff0000, v32
    v_cvt_pk_bf16_f32 v32, v16, v17
    v_lshlrev_b32 v16, 16, v32
    v_and_b32 v17, 0xffff0000, v32
    v_cvt_pk_bf16_f32 v32, v18, v19
    v_lshlrev_b32 v18, 16, v32
    v_and_b32 v19, 0xffff0000, v32
    v_cvt_pk_bf16_f32 v32, v20, v21
    v_lshlrev_b32 v20, 16, v32
    v_and_b32 v21, 0xffff0000, v32
    v_cvt_pk_bf16_f32 v32, v22, v23
    v_lshlrev_b32 v22, 16, v32
    v_and_b32 v23, 0xffff0000, v32
    v_cvt_pk_bf16_f32 v32, v24, v25
    v_lshlrev_b32 v24, 16, v32
    v_and_b32 v25, 0xffff0000, v32
    v_cvt_pk_bf16_f32 v32, v26, v27
    v_lshlrev_b32 v26, 16, v32
    v_and_b32 v27, 0xffff0000, v32
    v_cvt_pk_bf16_f32 v32, v28, v29
    v_lshlrev_b32 v28, 16, v32
    v_and_b32 v29, 0xffff0000, v32
    v_pk_mul_f32 v[14:15], v[14:15], v[30:31] op_sel:[0,1] op_sel_hi:[1,1]
    v_pk_mul_f32 v[16:17], v[16:17], v[30:31] op_sel:[0,1] op_sel_hi:[1,1]
    v_pk_mul_f32 v[18:19], v[18:19], v[30:31] op_sel:[0,1] op_sel_hi:[1,1]
    v_pk_mul_f32 v[20:21], v[20:21], v[30:31] op_sel:[0,1] op_sel_hi:[1,1]
    v_pk_mul_f32 v[22:23], v[22:23], v[30:31] op_sel:[0,1] op_sel_hi:[1,1]
    v_pk_mul_f32 v[24:25], v[24:25], v[30:31] op_sel:[0,1] op_sel_hi:[1,1]
    v_pk_mul_f32 v[26:27], v[26:27], v[30:31] op_sel:[0,1] op_sel_hi:[1,1]
    v_pk_mul_f32 v[28:29], v[28:29], v[30:31] op_sel:[0,1] op_sel_hi:[1,1]
    v_exp_f32 v14, -v14
    v_exp_f32 v15, -v15
    v_exp_f32 v16, -v16
    v_exp_f32 v17, -v17
    v_exp_f32 v18, -v18
    v_exp_f32 v19, -v19
    v_exp_f32 v20, -v20
    v_exp_f32 v21, -v21
    v_exp_f32 v22, -v22
    v_exp_f32 v23, -v23
    v_exp_f32 v24, -v24
    v_exp_f32 v25, -v25
    v_exp_f32 v26, -v26
    v_exp_f32 v27, -v27
    v_exp_f32 v28, -v28
    v_exp_f32 v29, -v29
    v_cvt_pk_bf16_f32 v14, v14, v16
    v_cvt_pk_bf16_f32 v15, v15, v17
    v_cvt_pk_bf16_f32 v18, v18, v20
    v_cvt_pk_bf16_f32 v19, v19, v21
    v_cvt_pk_bf16_f32 v22, v22, v24
    v_cvt_pk_bf16_f32 v23, v23, v25
    v_cvt_pk_bf16_f32 v26, v26, v28
    v_cvt_pk_bf16_f32 v27, v27, v29
    v_dot2_f32_bf16 v112, v14, s68, 0
    v_dot2_f32_bf16 v113, v15, s68, 0
    v_dot2_f32_bf16 v114, v14, s69, 0
    v_dot2_f32_bf16 v115, v15, s69, 0
    v_dot2_f32_bf16 v116, v14, s70, 0
    v_dot2_f32_bf16 v117, v15, s70, 0
    v_dot2_f32_bf16 v118, v14, s71, 0
    v_dot2_f32_bf16 v119, v15, s71, 0
    v_dot2_f32_bf16 v120, v14, s52, 0
    v_dot2_f32_bf16 v121, v15, s52, 0
    v_dot2_f32_bf16 v122, v14, s53, 0
    v_dot2_f32_bf16 v123, v15, s53, 0
    v_dot2_f32_bf16 v124, v14, s54, 0
    v_dot2_f32_bf16 v125, v15, s54, 0
    v_dot2_f32_bf16 v126, v14, s55, 0
    v_dot2_f32_bf16 v127, v15, s55, 0
    v_dot2_f32_bf16 v112, v18, s72, v112
    v_dot2_f32_bf16 v113, v19, s72, v113
    v_dot2_f32_bf16 v114, v18, s73, v114
    v_dot2_f32_bf16 v115, v19, s73, v115
    v_dot2_f32_bf16 v116, v18, s74, v116
    v_dot2_f32_bf16 v117, v19, s74, v117
    v_dot2_f32_bf16 v118, v18, s75, v118
    v_dot2_f32_bf16 v119, v19, s75, v119
    v_dot2_f32_bf16 v120, v18, s56, v120
    v_dot2_f32_bf16 v121, v19, s56, v121
    v_dot2_f32_bf16 v122, v18, s57, v122
    v_dot2_f32_bf16 v123, v19, s57, v123
    v_dot2_f32_bf16 v124, v18, s58, v124
    v_dot2_f32_bf16 v125, v19, s58, v125
    v_dot2_f32_bf16 v126, v18, s59, v126
    v_dot2_f32_bf16 v127, v19, s59, v127
    v_dot2_f32_bf16 v112, v22, s76, v112
    v_dot2_f32_bf16 v113, v23, s76, v113
    v_dot2_f32_bf16 v114, v22, s77, v114
    v_dot2_f32_bf16 v115, v23, s77, v115
    v_dot2_f32_bf16 v116, v22, s78, v116
    v_dot2_f32_bf16 v117, v23, s78, v117
    v_dot2_f32_bf16 v118, v22, s79, v118
    v_dot2_f32_bf16 v119, v23, s79, v119
    v_dot2_f32_bf16 v120, v22, s60, v120
    v_dot2_f32_bf16 v121, v23, s60, v121
    v_dot2_f32_bf16 v122, v22, s61, v122
    v_dot2_f32_bf16 v123, v23, s61, v123
    v_dot2_f32_bf16 v124, v22, s62, v124
    v_dot2_f32_bf16 v125, v23, s62, v125
    v_dot2_f32_bf16 v126, v22, s63, v126
    v_dot2_f32_bf16 v127, v23, s63, v127
    v_dot2_f32_bf16 v112, v26, s80, v112
    v_dot2_f32_bf16 v113, v27, s80, v113
    v_dot2_f32_bf16 v114, v26, s81, v114
    v_dot2_f32_bf16 v115, v27, s81, v115
    v_dot2_f32_bf16 v116, v26, s82, v116
    v_dot2_f32_bf16 v117, v27, s82, v117
    v_dot2_f32_bf16 v118, v26, s83, v118
    v_dot2_f32_bf16 v119, v27, s83, v119
    v_dot2_f32_bf16 v120, v26, s64, v120
    v_dot2_f32_bf16 v121, v27, s64, v121
    v_dot2_f32_bf16 v122, v26, s65, v122
    v_dot2_f32_bf16 v123, v27, s65, v123
    v_dot2_f32_bf16 v124, v26, s66, v124
    v_dot2_f32_bf16 v125, v27, s66, v125
    v_dot2_f32_bf16 v126, v26, s67, v126
    v_dot2_f32_bf16 v127, v27, s67, v127
L_p2_kernel_g1_27:
    s_lshl2_add_u32 s14, s3, s49
    s_mul_i32 s26, s14, 20000
    s_add_u32 s15, s26, 8573440
    buffer_load_dwordx4 v[64:67], v1, s[4:7], s15 offen
    buffer_load_dwordx4 v[68:71], v2, s[4:7], s15 offen
    s_branch L_p2_fin
L_p2_done:
    s_branch L_p2_end
L_p2_slow:
    s_barrier
    v_mov_b32 v8, 0
    v_mov_b32 v9, 0
    v_mov_b32 v10, 0
    v_mov_b32 v11, 0
    v_mov_b32 v12, v1
    ds_write_b128 v12, v[8:11]
    v_add_u32 v12, 16384, v12
    ds_write_b128 v12, v[8:11]
    v_add_u32 v12, 16384, v12
    ds_write_b128 v12, v[8:11]
    v_add_u32 v12, 16384, v12
    ds_write_b128 v12, v[8:11]
    v_add_u32 v12, 16384, v12
    ds_write_b128 v12, v[8:11]
    v_add_u32 v12, 16384, v12
    ds_write_b128 v12, v[8:11]
    v_add_u32 v12, 16384, v12
    ds_write_b128 v12, v[8:11]
    v_add_u32 v12, 16384, v12
    ds_write_b128 v12, v[8:11]
    v_add_u32 v12, 16384, v12
    ds_write_b128 v12, v[8:11]
    v_add_u32 v12, 16384, v12
    ds_write_b128 v12, v[8:11]
    v_add_u32 v12, 16384, v12
    v_lshlrev_b32 v13, 5, v0
    v_mov_b32 v29, 0x7fc00000
    v_add_u32 v28, 32896, v13
    v_lshlrev_b32 v14, 10, v0
    v_add_u32 v14, 14680064, v14
    s_mul_i32 s25, s12, 65
    s_add_u32 s25, s25, s3
    s_mul_i32 s25, s25, 32896
    s_add_u32 s25, s25, 0
    s_lshl_b32 s50, s50, 1
    s_mul_i32 s22, s12, 1280000
    s_mov_b32 s24, 0
    s_waitcnt lgkmcnt(0)
    s_barrier
L_p2_sstep:
    buffer_load_ushort v15, v13, s[4:7], s25 offen
    buffer_load_ushort v16, v28, s[4:7], s25 offen
    s_waitcnt vmcnt(0)
L_p2_srec:
    v_cmp_lt_u32 vcc, v15, v16
    s_nop 1
    s_and_b64 exec, exec, vcc
    s_cbranch_execz L_p2_sdone
    v_mul_u32_u24 v17, 43691, v15
    v_lshrrev_b32 v17, 17, v17
    v_mad_i32_i24 v18, v17, -3, v15
    v_lshrrev_b32 v19, 6, v17
    v_lshl_add_u32 v19, v19, 20, v14
    v_and_b32 v17, 63, v17
    v_lshl_add_u32 v17, v17, 4, v19
    v_lshl_add_u32 v19, v18, 2, v17
    buffer_load_dword v20, v19, s[4:7], 0 offen
    buffer_load_dword v21, v17, s[4:7], 0 offen offset:12
    v_add_u32 v15, 1, v15
    v_mad_u32_u24 v18, v18, 10, 2
    s_waitcnt vmcnt(0)
    v_lshlrev_b32_sdwa v19, 3, v20 dst_sel:DWORD dst_unused:UNUSED_PAD src0_sel:DWORD src1_sel:WORD_0
    buffer_load_dwordx2 v[22:23], v19, s[8:11], s22 offen
    v_mad_u32_u16 v20, v20, 16, s50 op_sel:[1,0,0,0]
    v_bfe_i32 v21, v21, v18, 10
    v_cmp_eq_i32 vcc, -512, v21
    v_cvt_f32_i32 v21, v21
    v_mul_f32 v21, 989872160, v21
    v_cndmask_b32 v21, v21, v29, vcc
    s_waitcnt vmcnt(0)
    v_lshlrev_b32 v24, 16, v22
    v_and_b32 v25, 0xffff0000, v22
    v_lshlrev_b32 v26, 16, v23
    v_and_b32 v27, 0xffff0000, v23
    v_mul_f32 v24, v21, v24
    v_mul_f32 v25, v21, v25
    v_mul_f32 v26, v21, v26
    v_mul_f32 v27, v21, v27
    ds_add_f32 v20, v24
    ds_add_f32 v20, v25 offset:4
    ds_add_f32 v20, v26 offset:8
    ds_add_f32 v20, v27 offset:12
    s_branch L_p2_srec
L_p2_sdone:
    s_mov_b64 exec, -1
    s_cmp_eq_u32 s24, 7
    s_cselect_b32 s14, 2, 2
    s_add_u32 s25, s25, s14
    s_add_u32 s22, s22, 80000
    s_add_u32 s24, s24, 1
    s_cmp_lt_u32 s24, 16
    s_cbranch_scc1 L_p2_sstep
    s_waitcnt lgkmcnt(0)
    s_barrier
    s_mul_i32 s14, s12, 10240000
    s_mul_i32 s15, s3, 160000
    s_add_u32 s26, s14, s15
    s_add_u32 s26, s26, 254312448
    v_mov_b32 v12, v1
    s_mov_b32 s24, 0
L_p2_sout:
    v_cmp_gt_u32 vcc, 160000, v12
    ds_read_b128 v[8:11], v12
    s_nop 0
    s_and_b64 exec, exec, vcc
    s_cbranch_execz L_p2_sfin
    s_waitcnt lgkmcnt(0)
    buffer_store_dwordx4 v[8:11], v12, s[4:7], s26 offen sc1
    s_waitcnt vmcnt(0)
    v_add_u32 v12, 16384, v12
    s_branch L_p2_sout
L_p2_sfin:
    s_mov_b64 exec, -1
    s_waitcnt vmcnt(0) lgkmcnt(0)
    s_barrier
    s_branch L_p2_signal
L_p2_end:
    s_endpgm
.section .rodata,"a"
.p2align 6
.amdhsa_kernel p1_kernel
  .amdhsa_next_free_vgpr 128
  .amdhsa_next_free_sgpr 96
  .amdhsa_accum_offset 128
  .amdhsa_group_segment_fixed_size 0
  .amdhsa_kernarg_size 112
  .amdhsa_user_sgpr_count 2
  .amdhsa_user_sgpr_kernarg_segment_ptr 1
  .amdhsa_system_sgpr_workgroup_id_x 1
  .amdhsa_float_denorm_mode_32 0
.end_amdhsa_kernel
.p2align 6
.amdhsa_kernel p2_kernel
  .amdhsa_next_free_vgpr 128
  .amdhsa_next_free_sgpr 102
  .amdhsa_accum_offset 128
  .amdhsa_group_segment_fixed_size 0
  .amdhsa_kernarg_size 112
  .amdhsa_user_sgpr_count 2
  .amdhsa_user_sgpr_kernarg_segment_ptr 1
  .amdhsa_system_sgpr_workgroup_id_x 1
  .amdhsa_float_denorm_mode_32 0
.end_amdhsa_kernel
```

```asm
; @launch kernel=p1_kernel grid=(256,1,1) block=(1024,1,1) lds=163840
; @launch kernel=p2_kernel grid=(256,1,1) block=(1024,1,1) lds=163840
.amdgcn_target "amdgcn-amd-amdhsa--gfx950"
.text
.globl p1_kernel
.p2align 8
.type p1_kernel,@function
p1_kernel:
    s_cmp_ge_u32 s2, 256
    s_cbranch_scc1 L_p1_end
    s_load_dwordx2 s[4:5], s[0:1], 104
    s_load_dwordx2 s[8:9], s[0:1], 8
    s_load_dwordx2 s[12:13], s[0:1], 16
    s_load_dwordx2 s[16:17], s[0:1], 32
    s_load_dwordx2 s[28:29], s[0:1], 0
    s_load_dwordx2 s[6:7], s[0:1], 48
    v_cmp_gt_u32 vcc, 256, v0
    s_nop 1
    s_cbranch_vccz L_p1_nopf
    s_getpc_b64 s[72:73]
L_p1_kernel_pc_1:
    s_add_u32 s72, s72, L_p1_nopf-L_p1_kernel_pc_1
    s_addc_u32 s73, s73, 0
    v_lshlrev_b32 v14, 7, v0
    v_min_u32 v14, L_p2_end-L_p1_nopf, v14
    global_load_dword v15, v14, s[72:73]
L_p1_nopf:
    v_lshlrev_b32 v1, 4, v0
    v_lshlrev_b32 v2, 3, v0
    v_lshrrev_b32 v6, 6, v0
    v_mul_u32_u24 v3, 851904, v6
    v_add_lshl_u32 v3, v3, v0, 4
    v_mov_b32 v4, 1
    v_mov_b32 v5, 0
    v_readfirstlane_b32 s39, v6
    v_cmp_gt_u32 vcc, 784, v0
    s_and_b32 s51, s2, 7
    s_lshl_b32 s51, s51, 0
    s_bfe_u32 s35, s2, 3
    s_add_u32 s51, s51, s35
    s_and_b32 s35, s2, 248
    s_add_u32 s51, s51, s35
    s_and_b32 s32, s2, 7
    s_lshl_b32 s32, s32, 2
    s_bfe_u32 s35, s2, 131075
    s_add_u32 s32, s32, s35
    s_and_b32 s35, s2, 224
    s_add_u32 s32, s32, s35
    s_lshr_b32 s35, s39, 4
    s_mul_i32 s36, s35, 4177920
    s_lshl_b32 s33, s51, 14
    s_add_u32 s33, s33, s36
    s_lshr_b32 s34, s33, 1
    s_mul_i32 s48, s51, 3840
    s_cmp_ge_u32 s35, 0
    s_cselect_b32 s48, s48, 0
    s_lshr_b32 s49, s48, 1
    s_mov_b64 s[44:45], vcc
    s_waitcnt lgkmcnt(0)
    s_load_dword s3, s[6:7], 0
    s_mov_b32 s10, 163840000
    s_mov_b32 s11, 0x00020000
    s_mov_b32 s14, 163840000
    s_mov_b32 s15, 0x00020000
    s_mov_b32 s18, 81920000
    s_mov_b32 s19, 0x00020000
    s_mul_i32 s36, s2, 20000
    s_add_u32 s30, s36, 20000
    s_mov_b32 s31, 0x00020000
    s_add_u32 s35, s36, 16384
    buffer_load_dwordx4 v[48:51], v1, s[28:31], s36 offen nt
    buffer_load_dwordx4 v[52:55], v1, s[28:31], s35 offen nt
    s_add_u32 s35, s33, 0
    buffer_load_dwordx4 v[16:19], v1, s[8:11], s35 offen nt
    s_add_u32 s35, s33, 0
    buffer_load_dwordx4 v[20:23], v1, s[12:15], s35 offen nt
    s_add_u32 s35, s33, 4194304
    buffer_load_dwordx4 v[24:27], v1, s[8:11], s35 offen nt
    s_add_u32 s35, s33, 4194304
    buffer_load_dwordx4 v[28:31], v1, s[12:15], s35 offen nt
    s_add_u32 s35, s33, 8388608
    buffer_load_dwordx4 v[32:35], v1, s[8:11], s35 offen nt
    s_add_u32 s35, s33, 8388608
    buffer_load_dwordx4 v[36:39], v1, s[12:15], s35 offen nt
    s_add_u32 s35, s33, 12582912
    buffer_load_dwordx4 v[40:43], v1, s[8:11], s35 offen nt
    s_add_u32 s35, s33, 12582912
    buffer_load_dwordx4 v[44:47], v1, s[12:15], s35 offen nt
    s_add_u32 s35, s33, 16777216
    buffer_load_dwordx4 v[72:75], v1, s[8:11], s35 offen nt
    s_add_u32 s35, s33, 16777216
    buffer_load_dwordx4 v[76:79], v1, s[12:15], s35 offen nt
    s_mov_b32 s20, s4
    s_mov_b32 s21, s5
    s_mov_b32 s22, 0
    s_mov_b32 s23, 0x00020000
    s_add_u32 s24, s4, 0
    s_addc_u32 s25, s5, 0
    s_mov_b32 s26, 8540160
    s_mov_b32 s27, 0x00020000
    s_mov_b32 s37, 1492179184
    s_mov_b32 s55, 0
    s_mov_b32 s50, 21845
    s_mov_b32 s38, 262400
    s_mov_b32 s43, 0x05040100
    s_mov_b32 s40, 0
    v_mov_b32 v8, 0
    v_mov_b32 v9, 0
    v_mov_b32 v10, 0
    v_mov_b32 v11, 0
    ds_write_b128 v1, v[8:11] offset:0
    s_waitcnt lgkmcnt(0)
    s_lshl_b32 s3, s3, 16
    v_mov_b32 v12, s3
    v_mul_f32 v12, 0.15915494, v12
    s_nop 0
    v_readfirstlane_b32 s41, v12
    s_waitcnt vmcnt(10)
    s_add_u32 s28, s4, 8540160
    s_addc_u32 s29, s5, 0
    s_mul_i32 s36, s2, 20000
    s_add_u32 s35, s36, 16384
    buffer_store_dwordx4 v[48:51], v1, s[28:31], s36 offen
    buffer_store_dwordx4 v[52:55], v1, s[28:31], s35 offen
    s_nop 0
    v_mov_b32 v12, 0x3f803f80
    v_and_b32 v48, 0x7fff7fff, v48
    v_and_b32 v49, 0x7fff7fff, v49
    v_and_b32 v50, 0x7fff7fff, v50
    v_and_b32 v51, 0x7fff7fff, v51
    v_and_b32 v52, 0x7fff7fff, v52
    v_and_b32 v53, 0x7fff7fff, v53
    v_and_b32 v54, 0x7fff7fff, v54
    v_and_b32 v55, 0x7fff7fff, v55
    v_pk_max_u16 v8, v8, v48
    v_dot2c_f32_bf16 v9, v48, v12
    v_pk_max_u16 v8, v8, v49
    v_dot2c_f32_bf16 v9, v49, v12
    v_pk_max_u16 v8, v8, v50
    v_dot2c_f32_bf16 v9, v50, v12
    v_pk_max_u16 v8, v8, v51
    v_dot2c_f32_bf16 v9, v51, v12
    v_pk_max_u16 v8, v8, v52
    v_dot2c_f32_bf16 v9, v52, v12
    v_pk_max_u16 v8, v8, v53
    v_dot2c_f32_bf16 v9, v53, v12
    v_pk_max_u16 v8, v8, v54
    v_dot2c_f32_bf16 v9, v54, v12
    v_pk_max_u16 v8, v8, v55
    v_dot2c_f32_bf16 v9, v55, v12
    v_lshrrev_b32 v10, 16, v8
    v_and_b32 v8, 0xffff, v8
    v_max_u32 v8, v8, v10
    s_nop 0
    s_nop 1
    v_max_u32_dpp v8, v8, v8 row_shr:1 row_mask:0xf bank_mask:0xf bound_ctrl:0
    s_nop 1
    v_max_u32_dpp v8, v8, v8 row_shr:2 row_mask:0xf bank_mask:0xf bound_ctrl:0
    s_nop 1
    v_max_u32_dpp v8, v8, v8 row_shr:4 row_mask:0xf bank_mask:0xf bound_ctrl:0
    s_nop 1
    v_max_u32_dpp v8, v8, v8 row_shr:8 row_mask:0xf bank_mask:0xf bound_ctrl:0
    s_nop 1
    v_max_u32_dpp v8, v8, v8 row_bcast:15 row_mask:0xa bank_mask:0xf
    s_nop 1
    v_max_u32_dpp v8, v8, v8 row_bcast:31 row_mask:0xc bank_mask:0xf
    s_nop 1
    v_add_f32_dpp v9, v9, v9 row_shr:1 row_mask:0xf bank_mask:0xf bound_ctrl:0
    s_nop 1
    v_add_f32_dpp v9, v9, v9 row_shr:2 row_mask:0xf bank_mask:0xf bound_ctrl:0
    s_nop 1
    v_add_f32_dpp v9, v9, v9 row_shr:4 row_mask:0xf bank_mask:0xf bound_ctrl:0
    s_nop 1
    v_add_f32_dpp v9, v9, v9 row_shr:8 row_mask:0xf bank_mask:0xf bound_ctrl:0
    s_nop 1
    v_add_f32_dpp v9, v9, v9 row_bcast:15 row_mask:0xa bank_mask:0xf
    s_nop 1
    v_add_f32_dpp v9, v9, v9 row_bcast:31 row_mask:0xc bank_mask:0xf
    s_lshl_b32 s35, s39, 4
    s_add_u32 s35, s35, 160320
    v_mov_b32 v10, s35
    s_mov_b32 exec_lo, 0
    s_brev_b32 exec_hi, 1
    ds_write_b64 v10, v[8:9]
    s_mov_b64 exec, -1
    s_waitcnt lgkmcnt(0)
    s_barrier
    s_branch L_p1_first
L_p1_loop:
    s_getreg_b32 s51, hwreg(HW_REG_XCC_ID, 0, 1)
    s_cmp_eq_u32 s51, 0
    s_cselect_b64 vcc, -1, 0
    s_waitcnt lgkmcnt(13)
    v_lshlrev_b32 v15, 22, v100
    v_lshrrev_b32 v100, 16, v100
    v_alignbit_b32 v15, v100, v15, 10
    v_alignbit_b32 v15, v101, v15, 10
    v_xor_b32 v15, 0x80200800, v15
    s_cmp_lg_u32 s39, 15
    s_cbranch_scc1 L_p1_kernel_nox_2
    s_mov_b32 s36, 13631488
    buffer_store_dwordx4 v[12:15], v3, s[20:23], s36 offen sc1
L_p1_kernel_nox_2:
    s_waitcnt lgkmcnt(12)
    v_lshlrev_b32 v75, 22, v102
    v_lshrrev_b32 v102, 16, v102
    v_alignbit_b32 v75, v102, v75, 10
    v_alignbit_b32 v75, v103, v75, 10
    v_xor_b32 v75, 0x80200800, v75
    s_mov_b32 s36, 0
    buffer_store_dwordx4 v[72:75], v3, s[20:23], s36 offen sc1
    s_waitcnt lgkmcnt(11)
    v_lshlrev_b32 v79, 22, v104
    v_lshrrev_b32 v104, 16, v104
    v_alignbit_b32 v79, v104, v79, 10
    v_alignbit_b32 v79, v105, v79, 10
    v_xor_b32 v79, 0x80200800, v79
    s_mov_b32 s36, 1048576
    buffer_store_dwordx4 v[76:79], v3, s[20:23], s36 offen sc1
    s_waitcnt lgkmcnt(10)
    v_lshlrev_b32 v51, 22, v106
    v_lshrrev_b32 v106, 16, v106
    v_alignbit_b32 v51, v106, v51, 10
    v_alignbit_b32 v51, v107, v51, 10
    v_xor_b32 v51, 0x80200800, v51
    s_mov_b32 s36, 2097152
    buffer_store_dwordx4 v[48:51], v3, s[20:23], s36 offen sc1
    s_add_u32 s35, s33, 16777216
    buffer_load_dwordx4 v[72:75], v1, s[8:11], s35 offen nt
    s_add_u32 s35, s33, 16777216
    buffer_load_dwordx4 v[76:79], v1, s[12:15], s35 offen nt
    s_cbranch_vccz L_p1_kernel_thr_3
    s_waitcnt vmcnt(2)
L_p1_kernel_thr_3:
    s_waitcnt lgkmcnt(9)
    v_lshlrev_b32 v83, 22, v108
    v_lshrrev_b32 v108, 16, v108
    v_alignbit_b32 v83, v108, v83, 10
    v_alignbit_b32 v83, v109, v83, 10
    v_xor_b32 v83, 0x80200800, v83
    s_mov_b32 s36, 3145728
    buffer_store_dwordx4 v[80:83], v3, s[20:23], s36 offen sc1
    s_waitcnt lgkmcnt(8)
    v_lshlrev_b32 v55, 22, v110
    v_lshrrev_b32 v110, 16, v110
    v_alignbit_b32 v55, v110, v55, 10
    v_alignbit_b32 v55, v111, v55, 10
    v_xor_b32 v55, 0x80200800, v55
    s_mov_b32 s36, 4194304
    buffer_store_dwordx4 v[52:55], v3, s[20:23], s36 offen sc1
    s_add_u32 s35, s33, 20971520
    buffer_load_dwordx4 v[80:83], v1, s[8:11], s35 offen nt
    s_add_u32 s35, s33, 20971520
    buffer_load_dwordx4 v[100:103], v1, s[12:15], s35 offen nt
    s_cbranch_vccz L_p1_kernel_thr_4
    s_waitcnt vmcnt(2)
L_p1_kernel_thr_4:
    s_waitcnt lgkmcnt(7)
    v_lshlrev_b32 v87, 22, v112
    v_lshrrev_b32 v112, 16, v112
    v_alignbit_b32 v87, v112, v87, 10
    v_alignbit_b32 v87, v113, v87, 10
    v_xor_b32 v87, 0x80200800, v87
    s_mov_b32 s36, 5242880
    buffer_store_dwordx4 v[84:87], v3, s[20:23], s36 offen sc1
    s_waitcnt lgkmcnt(6)
    v_lshlrev_b32 v59, 22, v114
    v_lshrrev_b32 v114, 16, v114
    v_alignbit_b32 v59, v114, v59, 10
    v_alignbit_b32 v59, v115, v59, 10
    v_xor_b32 v59, 0x80200800, v59
    s_mov_b32 s36, 6291456
    buffer_store_dwordx4 v[56:59], v3, s[20:23], s36 offen sc1
    s_add_u32 s35, s33, 25165824
    buffer_load_dwordx4 v[84:87], v1, s[8:11], s35 offen nt
    s_add_u32 s35, s33, 25165824
    buffer_load_dwordx4 v[104:107], v1, s[12:15], s35 offen nt
    s_cbranch_vccz L_p1_kernel_thr_5
    s_waitcnt vmcnt(2)
L_p1_kernel_thr_5:
    s_waitcnt lgkmcnt(5)
    v_lshlrev_b32 v91, 22, v116
    v_lshrrev_b32 v116, 16, v116
    v_alignbit_b32 v91, v116, v91, 10
    v_alignbit_b32 v91, v117, v91, 10
    v_xor_b32 v91, 0x80200800, v91
    s_mov_b32 s36, 7340032
    buffer_store_dwordx4 v[88:91], v3, s[20:23], s36 offen sc1
    s_waitcnt lgkmcnt(4)
    v_lshlrev_b32 v63, 22, v118
    v_lshrrev_b32 v118, 16, v118
    v_alignbit_b32 v63, v118, v63, 10
    v_alignbit_b32 v63, v119, v63, 10
    v_xor_b32 v63, 0x80200800, v63
    s_mov_b32 s36, 8388608
    buffer_store_dwordx4 v[60:63], v3, s[20:23], s36 offen sc1
    s_add_u32 s35, s33, 29360128
    buffer_load_dwordx4 v[88:91], v1, s[8:11], s35 offen nt
    s_add_u32 s35, s33, 29360128
    buffer_load_dwordx4 v[108:111], v1, s[12:15], s35 offen nt
    s_cbranch_vccz L_p1_kernel_thr_6
    s_waitcnt vmcnt(2)
L_p1_kernel_thr_6:
    s_waitcnt lgkmcnt(3)
    v_lshlrev_b32 v95, 22, v120
    v_lshrrev_b32 v120, 16, v120
    v_alignbit_b32 v95, v120, v95, 10
    v_alignbit_b32 v95, v121, v95, 10
    v_xor_b32 v95, 0x80200800, v95
    s_mov_b32 s36, 9437184
    buffer_store_dwordx4 v[92:95], v3, s[20:23], s36 offen sc1
    s_waitcnt lgkmcnt(2)
    v_lshlrev_b32 v67, 22, v122
    v_lshrrev_b32 v122, 16, v122
    v_alignbit_b32 v67, v122, v67, 10
    v_alignbit_b32 v67, v123, v67, 10
    v_xor_b32 v67, 0x80200800, v67
    s_mov_b32 s36, 10485760
    buffer_store_dwordx4 v[64:67], v3, s[20:23], s36 offen sc1
    s_add_u32 s35, s33, 33554432
    buffer_load_dwordx4 v[92:95], v1, s[8:11], s35 offen nt
    s_add_u32 s35, s33, 33554432
    buffer_load_dwordx4 v[112:115], v1, s[12:15], s35 offen nt
    s_cbranch_vccz L_p1_kernel_thr_7
    s_waitcnt vmcnt(2)
L_p1_kernel_thr_7:
    s_waitcnt lgkmcnt(1)
    v_lshlrev_b32 v99, 22, v124
    v_lshrrev_b32 v124, 16, v124
    v_alignbit_b32 v99, v124, v99, 10
    v_alignbit_b32 v99, v125, v99, 10
    v_xor_b32 v99, 0x80200800, v99
    s_mov_b32 s36, 11534336
    buffer_store_dwordx4 v[96:99], v3, s[20:23], s36 offen sc1
    s_waitcnt lgkmcnt(0)
    v_lshlrev_b32 v71, 22, v126
    v_lshrrev_b32 v126, 16, v126
    v_alignbit_b32 v71, v126, v71, 10
    v_alignbit_b32 v71, v127, v71, 10
    v_xor_b32 v71, 0x80200800, v71
    s_mov_b32 s36, 12582912
    buffer_store_dwordx4 v[68:71], v3, s[20:23], s36 offen sc1
    s_add_u32 s35, s33, 37748736
    s_sub_u32 s35, s35, s48
    v_cndmask_b32 v96, 2.0, v1, s[44:45]
    buffer_load_dwordx4 v[96:99], v96, s[8:11], s35 offen nt
    s_add_u32 s35, s33, 37748736
    s_sub_u32 s35, s35, s48
    v_cndmask_b32 v116, 2.0, v1, s[44:45]
    buffer_load_dwordx4 v[116:119], v116, s[12:15], s35 offen nt
    s_cbranch_vccz L_p1_kernel_thr_8
    s_waitcnt vmcnt(2)
L_p1_kernel_thr_8:
    s_branch L_p1_join
L_p1_first:
    s_add_u32 s35, s33, 20971520
    buffer_load_dwordx4 v[80:83], v1, s[8:11], s35 offen nt
    s_add_u32 s35, s33, 20971520
    buffer_load_dwordx4 v[100:103], v1, s[12:15], s35 offen nt
    s_add_u32 s35, s33, 25165824
    buffer_load_dwordx4 v[84:87], v1, s[8:11], s35 offen nt
    s_add_u32 s35, s33, 25165824
    buffer_load_dwordx4 v[104:107], v1, s[12:15], s35 offen nt
    s_add_u32 s35, s33, 29360128
    buffer_load_dwordx4 v[88:91], v1, s[8:11], s35 offen nt
    s_add_u32 s35, s33, 29360128
    buffer_load_dwordx4 v[108:111], v1, s[12:15], s35 offen nt
    s_add_u32 s35, s33, 33554432
    buffer_load_dwordx4 v[92:95], v1, s[8:11], s35 offen nt
    s_add_u32 s35, s33, 33554432
    buffer_load_dwordx4 v[112:115], v1, s[12:15], s35 offen nt
    s_add_u32 s35, s33, 37748736
    s_sub_u32 s35, s35, s48
    v_cndmask_b32 v96, 2.0, v1, s[44:45]
    buffer_load_dwordx4 v[96:99], v96, s[8:11], s35 offen nt
    s_add_u32 s35, s33, 37748736
    s_sub_u32 s35, s35, s48
    v_cndmask_b32 v116, 2.0, v1, s[44:45]
    buffer_load_dwordx4 v[116:119], v116, s[12:15], s35 offen nt
L_p1_join:
    s_waitcnt vmcnt(20)
    v_perm_b32 v6, v20, v16, s43
    v_perm_b32 v7, v21, v17, s43
    v_perm_b32 v8, v22, v18, s43
    v_perm_b32 v9, v23, v19, s43
    v_mul_hi_u32_u24 v16, 429497, v16
    v_mul_hi_u32_u24 v20, 429497, v20
    v_mul_hi_u32_u24 v17, 429497, v17
    v_mul_hi_u32_u24 v21, 429497, v21
    v_mul_hi_u32_u24 v18, 429497, v18
    v_mul_hi_u32_u24 v22, 429497, v22
    v_mul_hi_u32_u24 v19, 429497, v19
    v_mul_hi_u32_u24 v23, 429497, v23
    v_lshl_or_b32 v16, v20, 16, v16
    v_lshl_or_b32 v17, v21, 16, v17
    v_lshl_or_b32 v18, v22, 16, v18
    v_lshl_or_b32 v19, v23, 16, v19
    v_dot2_u32_u16 v20, v16, s38, 0
    v_dot2_u32_u16 v21, v17, s38, 0
    v_dot2_u32_u16 v22, v18, s38, 0
    v_dot2_u32_u16 v23, v19, s38, 0
    v_pk_mad_u16 v6, v16, s37, v6
    v_pk_mad_u16 v7, v17, s37, v7
    v_pk_mad_u16 v8, v18, s37, v8
    v_pk_mad_u16 v9, v19, s37, v9
    ds_add_u32 v20, v4 offset:0
    ds_add_u32 v21, v4 offset:0
    ds_add_u32 v22, v4 offset:0
    ds_add_u32 v23, v4 offset:0
    v_perm_b32 v55, v23, v22, s43
    v_perm_b32 v51, v21, v20, s43
    v_or_b32 v48, 0x40000000, v6
    v_or_b32 v49, 0x40000000, v7
    v_or_b32 v50, 0x40000000, v8
    v_or_b32 v52, 0x40000000, v9
    s_waitcnt vmcnt(18)
    v_perm_b32 v6, v28, v24, s43
    v_perm_b32 v7, v29, v25, s43
    v_perm_b32 v8, v30, v26, s43
    v_perm_b32 v9, v31, v27, s43
    v_mul_hi_u32_u24 v24, 429497, v24
    v_mul_hi_u32_u24 v28, 429497, v28
    v_mul_hi_u32_u24 v25, 429497, v25
    v_mul_hi_u32_u24 v29, 429497, v29
    v_mul_hi_u32_u24 v26, 429497, v26
    v_mul_hi_u32_u24 v30, 429497, v30
    v_mul_hi_u32_u24 v27, 429497, v27
    v_mul_hi_u32_u24 v31, 429497, v31
    v_lshl_or_b32 v24, v28, 16, v24
    v_lshl_or_b32 v25, v29, 16, v25
    v_lshl_or_b32 v26, v30, 16, v26
    v_lshl_or_b32 v27, v31, 16, v27
    v_dot2_u32_u16 v28, v24, s38, 0
    v_dot2_u32_u16 v29, v25, s38, 0
    v_dot2_u32_u16 v30, v26, s38, 0
    v_dot2_u32_u16 v31, v27, s38, 0
    v_pk_mad_u16 v6, v24, s37, v6
    v_pk_mad_u16 v7, v25, s37, v7
    v_pk_mad_u16 v8, v26, s37, v8
    v_pk_mad_u16 v9, v27, s37, v9
    ds_add_u32 v28, v4 offset:0
    ds_add_u32 v29, v4 offset:0
    ds_add_u32 v30, v4 offset:0
    ds_add_u32 v31, v4 offset:0
    v_perm_b32 v63, v31, v30, s43
    v_perm_b32 v59, v29, v28, s43
    v_or_b32 v53, 0x40000000, v6
    v_or_b32 v54, 0x40000000, v7
    v_or_b32 v56, 0x40000000, v8
    v_or_b32 v57, 0x40000000, v9
    s_waitcnt vmcnt(16)
    v_perm_b32 v6, v36, v32, s43
    v_perm_b32 v7, v37, v33, s43
    v_perm_b32 v8, v38, v34, s43
    v_perm_b32 v9, v39, v35, s43
    v_mul_hi_u32_u24 v32, 429497, v32
    v_mul_hi_u32_u24 v36, 429497, v36
    v_mul_hi_u32_u24 v33, 429497, v33
    v_mul_hi_u32_u24 v37, 429497, v37
    v_mul_hi_u32_u24 v34, 429497, v34
    v_mul_hi_u32_u24 v38, 429497, v38
    v_mul_hi_u32_u24 v35, 429497, v35
    v_mul_hi_u32_u24 v39, 429497, v39
    v_lshl_or_b32 v32, v36, 16, v32
    v_lshl_or_b32 v33, v37, 16, v33
    v_lshl_or_b32 v34, v38, 16, v34
    v_lshl_or_b32 v35, v39, 16, v35
    v_dot2_u32_u16 v36, v32, s38, 0
    v_dot2_u32_u16 v37, v33, s38, 0
    v_dot2_u32_u16 v38, v34, s38, 0
    v_dot2_u32_u16 v39, v35, s38, 0
    v_pk_mad_u16 v6, v32, s37, v6
    v_pk_mad_u16 v7, v33, s37, v7
    v_pk_mad_u16 v8, v34, s37, v8
    v_pk_mad_u16 v9, v35, s37, v9
    ds_add_u32 v36, v4 offset:0
    ds_add_u32 v37, v4 offset:0
    ds_add_u32 v38, v4 offset:0
    ds_add_u32 v39, v4 offset:0
    v_perm_b32 v71, v39, v38, s43
    v_perm_b32 v67, v37, v36, s43
    v_or_b32 v58, 0x40000000, v6
    v_or_b32 v60, 0x40000000, v7
    v_or_b32 v61, 0x40000000, v8
    v_or_b32 v62, 0x40000000, v9
    s_waitcnt vmcnt(14)
    v_perm_b32 v6, v44, v40, s43
    v_perm_b32 v7, v45, v41, s43
    v_perm_b32 v8, v46, v42, s43
    v_perm_b32 v9, v47, v43, s43
    v_mul_hi_u32_u24 v40, 429497, v40
    v_mul_hi_u32_u24 v44, 429497, v44
    v_mul_hi_u32_u24 v41, 429497, v41
    v_mul_hi_u32_u24 v45, 429497, v45
    v_mul_hi_u32_u24 v42, 429497, v42
    v_mul_hi_u32_u24 v46, 429497, v46
    v_mul_hi_u32_u24 v43, 429497, v43
    v_mul_hi_u32_u24 v47, 429497, v47
    v_lshl_or_b32 v40, v44, 16, v40
    v_lshl_or_b32 v41, v45, 16, v41
    v_lshl_or_b32 v42, v46, 16, v42
    v_lshl_or_b32 v43, v47, 16, v43
    v_dot2_u32_u16 v44, v40, s38, 0
    v_dot2_u32_u16 v45, v41, s38, 0
    v_dot2_u32_u16 v46, v42, s38, 0
    v_dot2_u32_u16 v47, v43, s38, 0
    v_pk_mad_u16 v6, v40, s37, v6
    v_pk_mad_u16 v7, v41, s37, v7
    v_pk_mad_u16 v8, v42, s37, v8
    v_pk_mad_u16 v9, v43, s37, v9
    ds_add_u32 v44, v4 offset:0
    ds_add_u32 v45, v4 offset:0
    ds_add_u32 v46, v4 offset:0
    ds_add_u32 v47, v4 offset:0
    v_perm_b32 v121, v47, v46, s43
    v_perm_b32 v120, v45, v44, s43
    v_or_b32 v64, 0x40000000, v6
    v_or_b32 v65, 0x40000000, v7
    v_or_b32 v66, 0x40000000, v8
    v_or_b32 v68, 0x40000000, v9
    s_waitcnt vmcnt(12)
    v_perm_b32 v6, v76, v72, s43
    v_perm_b32 v7, v77, v73, s43
    v_perm_b32 v8, v78, v74, s43
    v_perm_b32 v9, v79, v75, s43
    v_mul_hi_u32_u24 v72, 429497, v72
    v_mul_hi_u32_u24 v76, 429497, v76
    v_mul_hi_u32_u24 v73, 429497, v73
    v_mul_hi_u32_u24 v77, 429497, v77
    v_mul_hi_u32_u24 v74, 429497, v74
    v_mul_hi_u32_u24 v78, 429497, v78
    v_mul_hi_u32_u24 v75, 429497, v75
    v_mul_hi_u32_u24 v79, 429497, v79
    v_lshl_or_b32 v72, v76, 16, v72
    v_lshl_or_b32 v73, v77, 16, v73
    v_lshl_or_b32 v74, v78, 16, v74
    v_lshl_or_b32 v75, v79, 16, v75
    v_dot2_u32_u16 v76, v72, s38, 0
    v_dot2_u32_u16 v77, v73, s38, 0
    v_dot2_u32_u16 v78, v74, s38, 0
    v_dot2_u32_u16 v79, v75, s38, 0
    v_pk_mad_u16 v6, v72, s37, v6
    v_pk_mad_u16 v7, v73, s37, v7
    v_pk_mad_u16 v8, v74, s37, v8
    v_pk_mad_u16 v9, v75, s37, v9
    ds_add_u32 v76, v4 offset:0
    ds_add_u32 v77, v4 offset:0
    ds_add_u32 v78, v4 offset:0
    ds_add_u32 v79, v4 offset:0
    v_perm_b32 v123, v79, v78, s43
    v_perm_b32 v122, v77, v76, s43
    v_or_b32 v69, 0x40000000, v6
    v_or_b32 v70, 0x40000000, v7
    v_or_b32 v127, 0x40000000, v8
    v_or_b32 v72, 0x40000000, v9
    s_waitcnt vmcnt(8)
    v_perm_b32 v6, v100, v80, s43
    v_perm_b32 v7, v101, v81, s43
    v_perm_b32 v8, v102, v82, s43
    v_perm_b32 v9, v103, v83, s43
    v_mul_hi_u32_u24 v80, 429497, v80
    v_mul_hi_u32_u24 v100, 429497, v100
    v_mul_hi_u32_u24 v81, 429497, v81
    v_mul_hi_u32_u24 v101, 429497, v101
    v_mul_hi_u32_u24 v82, 429497, v82
    v_mul_hi_u32_u24 v102, 429497, v102
    v_mul_hi_u32_u24 v83, 429497, v83
    v_mul_hi_u32_u24 v103, 429497, v103
    v_lshl_or_b32 v80, v100, 16, v80
    v_lshl_or_b32 v81, v101, 16, v81
    v_lshl_or_b32 v82, v102, 16, v82
    v_lshl_or_b32 v83, v103, 16, v83
    v_dot2_u32_u16 v100, v80, s38, 0
    v_dot2_u32_u16 v101, v81, s38, 0
    v_dot2_u32_u16 v102, v82, s38, 0
    v_dot2_u32_u16 v103, v83, s38, 0
    v_pk_mad_u16 v6, v80, s37, v6
    v_pk_mad_u16 v7, v81, s37, v7
    v_pk_mad_u16 v8, v82, s37, v8
    v_pk_mad_u16 v9, v83, s37, v9
    ds_add_u32 v100, v4 offset:0
    ds_add_u32 v101, v4 offset:0
    ds_add_u32 v102, v4 offset:0
    ds_add_u32 v103, v4 offset:0
    v_perm_b32 v125, v103, v102, s43
    v_perm_b32 v124, v101, v100, s43
    v_or_b32 v73, 0x40000000, v6
    v_or_b32 v74, 0x40000000, v7
    v_or_b32 v76, 0x40000000, v8
    v_or_b32 v77, 0x40000000, v9
    s_waitcnt vmcnt(6)
    v_perm_b32 v6, v104, v84, s43
    v_perm_b32 v7, v105, v85, s43
    v_perm_b32 v8, v106, v86, s43
    v_perm_b32 v9, v107, v87, s43
    v_mul_hi_u32_u24 v84, 429497, v84
    v_mul_hi_u32_u24 v104, 429497, v104
    v_mul_hi_u32_u24 v85, 429497, v85
    v_mul_hi_u32_u24 v105, 429497, v105
    v_mul_hi_u32_u24 v86, 429497, v86
    v_mul_hi_u32_u24 v106, 429497, v106
    v_mul_hi_u32_u24 v87, 429497, v87
    v_mul_hi_u32_u24 v107, 429497, v107
    v_lshl_or_b32 v84, v104, 16, v84
    v_lshl_or_b32 v85, v105, 16, v85
    v_lshl_or_b32 v86, v106, 16, v86
    v_lshl_or_b32 v87, v107, 16, v87
    v_dot2_u32_u16 v104, v84, s38, 0
    v_dot2_u32_u16 v105, v85, s38, 0
    v_dot2_u32_u16 v106, v86, s38, 0
    v_dot2_u32_u16 v107, v87, s38, 0
    v_pk_mad_u16 v6, v84, s37, v6
    v_pk_mad_u16 v7, v85, s37, v7
    v_pk_mad_u16 v8, v86, s37, v8
    v_pk_mad_u16 v9, v87, s37, v9
    ds_add_u32 v104, v4 offset:0
    ds_add_u32 v105, v4 offset:0
    ds_add_u32 v106, v4 offset:0
    ds_add_u32 v107, v4 offset:0
    v_perm_b32 v75, v107, v106, s43
    v_perm_b32 v126, v105, v104, s43
    v_or_b32 v78, 0x40000000, v6
    v_or_b32 v80, 0x40000000, v7
    v_or_b32 v81, 0x40000000, v8
    v_or_b32 v82, 0x40000000, v9
    s_waitcnt vmcnt(4)
    v_perm_b32 v6, v108, v88, s43
    v_perm_b32 v7, v109, v89, s43
    v_perm_b32 v8, v110, v90, s43
    v_perm_b32 v9, v111, v91, s43
    v_mul_hi_u32_u24 v88, 429497, v88
    v_mul_hi_u32_u24 v108, 429497, v108
    v_mul_hi_u32_u24 v89, 429497, v89
    v_mul_hi_u32_u24 v109, 429497, v109
    v_mul_hi_u32_u24 v90, 429497, v90
    v_mul_hi_u32_u24 v110, 429497, v110
    v_mul_hi_u32_u24 v91, 429497, v91
    v_mul_hi_u32_u24 v111, 429497, v111
    v_lshl_or_b32 v88, v108, 16, v88
    v_lshl_or_b32 v89, v109, 16, v89
    v_lshl_or_b32 v90, v110, 16, v90
    v_lshl_or_b32 v91, v111, 16, v91
    v_dot2_u32_u16 v108, v88, s38, 0
    v_dot2_u32_u16 v109, v89, s38, 0
    v_dot2_u32_u16 v110, v90, s38, 0
    v_dot2_u32_u16 v111, v91, s38, 0
    v_pk_mad_u16 v6, v88, s37, v6
    v_pk_mad_u16 v7, v89, s37, v7
    v_pk_mad_u16 v8, v90, s37, v8
    v_pk_mad_u16 v9, v91, s37, v9
    ds_add_u32 v108, v4 offset:0
    ds_add_u32 v109, v4 offset:0
    ds_add_u32 v110, v4 offset:0
    ds_add_u32 v111, v4 offset:0
    v_perm_b32 v83, v111, v110, s43
    v_perm_b32 v79, v109, v108, s43
    v_or_b32 v84, 0x40000000, v6
    v_or_b32 v85, 0x40000000, v7
    v_or_b32 v86, 0x40000000, v8
    v_or_b32 v88, 0x40000000, v9
    s_waitcnt vmcnt(2)
    v_perm_b32 v6, v112, v92, s43
    v_perm_b32 v7, v113, v93, s43
    v_perm_b32 v8, v114, v94, s43
    v_perm_b32 v9, v115, v95, s43
    v_mul_hi_u32_u24 v92, 429497, v92
    v_mul_hi_u32_u24 v112, 429497, v112
    v_mul_hi_u32_u24 v93, 429497, v93
    v_mul_hi_u32_u24 v113, 429497, v113
    v_mul_hi_u32_u24 v94, 429497, v94
    v_mul_hi_u32_u24 v114, 429497, v114
    v_mul_hi_u32_u24 v95, 429497, v95
    v_mul_hi_u32_u24 v115, 429497, v115
    v_lshl_or_b32 v92, v112, 16, v92
    v_lshl_or_b32 v93, v113, 16, v93
    v_lshl_or_b32 v94, v114, 16, v94
    v_lshl_or_b32 v95, v115, 16, v95
    v_dot2_u32_u16 v112, v92, s38, 0
    v_dot2_u32_u16 v113, v93, s38, 0
    v_dot2_u32_u16 v114, v94, s38, 0
    v_dot2_u32_u16 v115, v95, s38, 0
    v_pk_mad_u16 v6, v92, s37, v6
    v_pk_mad_u16 v7, v93, s37, v7
    v_pk_mad_u16 v8, v94, s37, v8
    v_pk_mad_u16 v9, v95, s37, v9
    ds_add_u32 v112, v4 offset:0
    ds_add_u32 v113, v4 offset:0
    ds_add_u32 v114, v4 offset:0
    ds_add_u32 v115, v4 offset:0
    v_perm_b32 v91, v115, v114, s43
    v_perm_b32 v87, v113, v112, s43
    v_or_b32 v89, 0x40000000, v6
    v_or_b32 v90, 0x40000000, v7
    v_or_b32 v92, 0x40000000, v8
    v_or_b32 v93, 0x40000000, v9
    s_waitcnt vmcnt(0)
    s_mov_b64 exec, s[44:45]
    v_perm_b32 v6, v116, v96, s43
    v_perm_b32 v7, v117, v97, s43
    v_perm_b32 v8, v118, v98, s43
    v_perm_b32 v9, v119, v99, s43
    v_mul_hi_u32_u24 v96, 429497, v96
    v_mul_hi_u32_u24 v116, 429497, v116
    v_mul_hi_u32_u24 v97, 429497, v97
    v_mul_hi_u32_u24 v117, 429497, v117
    v_mul_hi_u32_u24 v98, 429497, v98
    v_mul_hi_u32_u24 v118, 429497, v118
    v_mul_hi_u32_u24 v99, 429497, v99
    v_mul_hi_u32_u24 v119, 429497, v119
    v_lshl_or_b32 v96, v116, 16, v96
    v_lshl_or_b32 v97, v117, 16, v97
    v_lshl_or_b32 v98, v118, 16, v98
    v_lshl_or_b32 v99, v119, 16, v99
    v_dot2_u32_u16 v116, v96, s38, 0
    v_dot2_u32_u16 v117, v97, s38, 0
    v_dot2_u32_u16 v118, v98, s38, 0
    v_dot2_u32_u16 v119, v99, s38, 0
    v_pk_mad_u16 v6, v96, s37, v6
    v_pk_mad_u16 v7, v97, s37, v7
    v_pk_mad_u16 v8, v98, s37, v8
    v_pk_mad_u16 v9, v99, s37, v9
    ds_add_u32 v116, v4 offset:0
    ds_add_u32 v117, v4 offset:0
    ds_add_u32 v118, v4 offset:0
    ds_add_u32 v119, v4 offset:0
    v_perm_b32 v99, v119, v118, s43
    v_perm_b32 v95, v117, v116, s43
    v_or_b32 v94, 0x40000000, v6
    v_or_b32 v96, 0x40000000, v7
    v_or_b32 v97, 0x40000000, v8
    v_or_b32 v98, 0x40000000, v9
    s_mov_b64 exec, -1
    s_add_u32 s35, s34, 0
    buffer_load_dwordx2 v[100:101], v2, s[16:19], s35 offen nt
    s_lshl_b32 s35, s32, 10
    s_add_u32 s35, s35, 14680064
    s_add_u32 s20, s4, s35
    s_addc_u32 s21, s5, 0
    s_waitcnt lgkmcnt(0)
    s_barrier
    ds_read_b128 v[8:11], v1 offset:0
    s_add_u32 s35, s34, 2097152
    buffer_load_dwordx2 v[102:103], v2, s[16:19], s35 offen nt
    s_lshl_b32 s35, s39, 2
    s_add_u32 s35, s35, 160256
    v_mov_b32 v7, s35
    v_and_b32 v14, 15, v0
    v_lshlrev_b32 v14, 2, v14
    v_add_u32 v14, 160256, v14
    s_waitcnt lgkmcnt(0)
    v_cmp_eq_u32 s[56:57], 0, v8
    v_cmp_ge_u32 s[64:65], 1, v8
    v_max_u32 v12, 2, v8
    v_lshl_or_b32 v8, v8, 16, v12
    v_cmp_eq_u32 s[58:59], 0, v9
    v_cmp_ge_u32 s[66:67], 1, v9
    v_max_u32 v12, 2, v9
    v_lshl_or_b32 v9, v9, 16, v12
    v_cmp_eq_u32 s[60:61], 0, v10
    v_cmp_ge_u32 s[68:69], 1, v10
    v_max_u32 v12, 2, v10
    v_lshl_or_b32 v10, v10, 16, v12
    v_cmp_eq_u32 s[62:63], 0, v11
    v_cmp_ge_u32 s[70:71], 1, v11
    v_max_u32 v12, 2, v11
    v_lshl_or_b32 v11, v11, 16, v12
    v_add_u32 v9, v8, v9
    v_add_u32 v10, v9, v10
    v_add_u32 v11, v10, v11
    v_mov_b32 v6, v11
    s_nop 1
    v_add_u32_dpp v6, v6, v6 row_shr:1 row_mask:0xf bank_mask:0xf bound_ctrl:0
    s_nop 1
    v_add_u32_dpp v6, v6, v6 row_shr:2 row_mask:0xf bank_mask:0xf bound_ctrl:0
    s_nop 1
    v_add_u32_dpp v6, v6, v6 row_shr:4 row_mask:0xf bank_mask:0xf bound_ctrl:0
    s_nop 1
    v_add_u32_dpp v6, v6, v6 row_shr:8 row_mask:0xf bank_mask:0xf bound_ctrl:0
    s_nop 1
    v_add_u32_dpp v6, v6, v6 row_bcast:15 row_mask:0xa bank_mask:0xf
    s_nop 1
    v_add_u32_dpp v6, v6, v6 row_bcast:31 row_mask:0xc bank_mask:0xf
    s_mov_b32 exec_lo, 0
    s_brev_b32 exec_hi, 1
    ds_write_b32 v7, v6
    s_mov_b64 exec, -1
    v_sub_u32 v6, v6, v11
    s_or_b64 s[46:47], s[64:65], s[66:67]
    s_or_b64 vcc, s[68:69], s[70:71]
    s_or_b64 s[46:47], s[46:47], vcc
    s_waitcnt lgkmcnt(0)
    s_barrier
    ds_read_b32 v7, v14
    s_add_u32 s35, s34, 4194304
    buffer_load_dwordx2 v[104:105], v2, s[16:19], s35 offen nt
    s_waitcnt lgkmcnt(0)
    v_mov_b32 v15, v7
    s_nop 1
    v_add_u32_dpp v7, v7, v7 row_shr:1 row_mask:0xf bank_mask:0xf bound_ctrl:0
    s_nop 1
    v_add_u32_dpp v7, v7, v7 row_shr:2 row_mask:0xf bank_mask:0xf bound_ctrl:0
    s_nop 1
    v_add_u32_dpp v7, v7, v7 row_shr:4 row_mask:0xf bank_mask:0xf bound_ctrl:0
    s_nop 1
    v_add_u32_dpp v7, v7, v7 row_shr:8 row_mask:0xf bank_mask:0xf bound_ctrl:0
    s_nop 0
    v_readlane_b32 s54, v7, 15
    v_sub_u32 v7, v7, v15
    s_nop 0
    v_readlane_b32 s35, v7, s39
    s_and_b32 s54, s54, 0xffff
    s_cmp_ge_u32 s54, 40063
    s_cselect_b32 s36, 16, 0
    s_cselect_b32 s54, 40000, s54
    s_cselect_b32 s55, 1, s55
    s_cselect_b64 s[46:47], 0, s[46:47]
    v_add_u32 v12, s35, v6
    v_add_u32 v13, v12, v8
    v_add_u32 v14, v12, v9
    v_add_u32 v15, v12, v10
    v_bfe_u32 v12, v12, s36, 16
    v_bfe_u32 v13, v13, s36, 16
    v_bfe_u32 v14, v14, s36, 16
    v_bfe_u32 v15, v15, s36, 16
    ds_write_b128 v1, v[12:15] offset:0
    ds_write_b128 v1, v[12:15] offset:16384
    v_mov_b32 v6, 32768
    v_mov_b32 v7, s54
    s_mov_b64 exec, 1
    ds_write_b32 v6, v7
    s_mov_b64 exec, -1
    s_add_u32 s35, s54, 2
    s_mul_hi_u32 s35, s35, 1431655766
    s_lshl_b32 s35, s35, 4
    s_add_u32 s35, s35, 217890816
    s_min_u32 s22, s35, 218104832
    v_perm_b32 v15, v15, v14, s43
    v_perm_b32 v14, v13, v12, s43
    s_waitcnt lgkmcnt(0)
    s_barrier
    s_nop 0
    v_and_b32 v6, 0xffff, v51
    v_lshrrev_b32 v7, 16, v51
    v_and_b32 v8, 0xffff, v55
    v_lshrrev_b32 v9, 16, v55
    ds_add_rtn_u32 v6, v6, v4 offset:0
    ds_add_rtn_u32 v7, v7, v4 offset:0
    ds_add_rtn_u32 v8, v8, v4 offset:0
    ds_add_rtn_u32 v9, v9, v4 offset:0
    v_and_b32 v10, 0xffff, v59
    v_lshrrev_b32 v11, 16, v59
    v_and_b32 v12, 0xffff, v63
    v_lshrrev_b32 v13, 16, v63
    ds_add_rtn_u32 v10, v10, v4 offset:0
    ds_add_rtn_u32 v11, v11, v4 offset:0
    ds_add_rtn_u32 v12, v12, v4 offset:0
    ds_add_rtn_u32 v13, v13, v4 offset:0
    s_waitcnt lgkmcnt(4)
    v_perm_b32 v51, v7, v6, s43
    v_perm_b32 v55, v9, v8, s43
    v_and_b32 v6, 0xffff, v67
    v_lshrrev_b32 v7, 16, v67
    v_and_b32 v8, 0xffff, v71
    v_lshrrev_b32 v9, 16, v71
    ds_add_rtn_u32 v6, v6, v4 offset:0
    ds_add_rtn_u32 v7, v7, v4 offset:0
    ds_add_rtn_u32 v8, v8, v4 offset:0
    ds_add_rtn_u32 v9, v9, v4 offset:0
    s_waitcnt lgkmcnt(4)
    v_perm_b32 v59, v11, v10, s43
    v_perm_b32 v63, v13, v12, s43
    s_add_u32 s35, s34, 6291456
    buffer_load_dwordx2 v[106:107], v2, s[16:19], s35 offen nt
    v_and_b32 v10, 0xffff, v120
    v_lshrrev_b32 v11, 16, v120
    v_and_b32 v12, 0xffff, v121
    v_lshrrev_b32 v13, 16, v121
    ds_add_rtn_u32 v10, v10, v4 offset:0
    ds_add_rtn_u32 v11, v11, v4 offset:0
    ds_add_rtn_u32 v12, v12, v4 offset:0
    ds_add_rtn_u32 v13, v13, v4 offset:0
    s_waitcnt lgkmcnt(4)
    v_perm_b32 v67, v7, v6, s43
    v_perm_b32 v71, v9, v8, s43
    s_add_u32 s35, s34, 8388608
    buffer_load_dwordx2 v[108:109], v2, s[16:19], s35 offen nt
    v_and_b32 v6, 0xffff, v122
    v_lshrrev_b32 v7, 16, v122
    v_and_b32 v8, 0xffff, v123
    v_lshrrev_b32 v9, 16, v123
    ds_add_rtn_u32 v6, v6, v4 offset:0
    ds_add_rtn_u32 v7, v7, v4 offset:0
    ds_add_rtn_u32 v8, v8, v4 offset:0
    ds_add_rtn_u32 v9, v9, v4 offset:0
    s_waitcnt lgkmcnt(4)
    v_perm_b32 v120, v11, v10, s43
    v_perm_b32 v121, v13, v12, s43
    s_add_u32 s35, s34, 10485760
    buffer_load_dwordx2 v[110:111], v2, s[16:19], s35 offen nt
    v_and_b32 v10, 0xffff, v124
    v_lshrrev_b32 v11, 16, v124
    v_and_b32 v12, 0xffff, v125
    v_lshrrev_b32 v13, 16, v125
    ds_add_rtn_u32 v10, v10, v4 offset:0
    ds_add_rtn_u32 v11, v11, v4 offset:0
    ds_add_rtn_u32 v12, v12, v4 offset:0
    ds_add_rtn_u32 v13, v13, v4 offset:0
    s_waitcnt lgkmcnt(4)
    v_perm_b32 v122, v7, v6, s43
    v_perm_b32 v123, v9, v8, s43
    v_and_b32 v6, 0xffff, v126
    v_lshrrev_b32 v7, 16, v126
    v_and_b32 v8, 0xffff, v75
    v_lshrrev_b32 v9, 16, v75
    ds_add_rtn_u32 v6, v6, v4 offset:0
    ds_add_rtn_u32 v7, v7, v4 offset:0
    ds_add_rtn_u32 v8, v8, v4 offset:0
    ds_add_rtn_u32 v9, v9, v4 offset:0
    s_waitcnt lgkmcnt(4)
    v_perm_b32 v124, v11, v10, s43
    v_perm_b32 v125, v13, v12, s43
    s_add_u32 s35, s34, 12582912
    buffer_load_dwordx2 v[112:113], v2, s[16:19], s35 offen nt
    v_and_b32 v10, 0xffff, v79
    v_lshrrev_b32 v11, 16, v79
    v_and_b32 v12, 0xffff, v83
    v_lshrrev_b32 v13, 16, v83
    ds_add_rtn_u32 v10, v10, v4 offset:0
    ds_add_rtn_u32 v11, v11, v4 offset:0
    ds_add_rtn_u32 v12, v12, v4 offset:0
    ds_add_rtn_u32 v13, v13, v4 offset:0
    s_waitcnt lgkmcnt(4)
    v_perm_b32 v126, v7, v6, s43
    v_perm_b32 v75, v9, v8, s43
    s_add_u32 s35, s34, 14680064
    buffer_load_dwordx2 v[114:115], v2, s[16:19], s35 offen nt
    v_and_b32 v6, 0xffff, v87
    v_lshrrev_b32 v7, 16, v87
    v_and_b32 v8, 0xffff, v91
    v_lshrrev_b32 v9, 16, v91
    ds_add_rtn_u32 v6, v6, v4 offset:0
    ds_add_rtn_u32 v7, v7, v4 offset:0
    ds_add_rtn_u32 v8, v8, v4 offset:0
    ds_add_rtn_u32 v9, v9, v4 offset:0
    s_waitcnt lgkmcnt(4)
    v_perm_b32 v79, v11, v10, s43
    v_perm_b32 v83, v13, v12, s43
    s_add_u32 s35, s34, 16777216
    buffer_load_dwordx2 v[116:117], v2, s[16:19], s35 offen nt
    s_mov_b64 exec, s[44:45]
    v_and_b32 v10, 0xffff, v95
    v_lshrrev_b32 v11, 16, v95
    v_and_b32 v12, 0xffff, v99
    v_lshrrev_b32 v13, 16, v99
    ds_add_rtn_u32 v10, v10, v4 offset:0
    ds_add_rtn_u32 v11, v11, v4 offset:0
    ds_add_rtn_u32 v12, v12, v4 offset:0
    ds_add_rtn_u32 v13, v13, v4 offset:0
    s_mov_b64 exec, -1
    s_waitcnt lgkmcnt(4)
    v_perm_b32 v87, v7, v6, s43
    v_perm_b32 v91, v9, v8, s43
    s_add_u32 s35, s34, 18874368
    s_sub_u32 s35, s35, s49
    v_cndmask_b32 v118, 2.0, v2, s[44:45]
    buffer_load_dwordx2 v[118:119], v118, s[16:19], s35 offen nt
    s_waitcnt lgkmcnt(0)
    v_perm_b32 v95, v11, v10, s43
    v_perm_b32 v99, v13, v12, s43
    s_cmp_gt_u32 s39, 8
    s_cbranch_scc1 L_p1_kernel_notab_9
    v_lshrrev_b32 v6, 1, v0
    v_mul_u32_u24 v7, 1009, v6
    v_lshrrev_b32 v7, 16, v7
    v_mul_u32_u24 v7, 959, v7
    v_and_b32 v8, 1, v0
    v_lshl_add_u32 v7, v8, 9, v7
    v_add_lshl_u32 v13, v7, v6, 2
    ds_read2st64_b32 v[6:7], v13 offset0:64 offset1:65
    ds_read2st64_b32 v[8:9], v13 offset0:66 offset1:67
    ds_read2st64_b32 v[10:11], v13 offset0:68 offset1:69
    ds_read2st64_b32 v[12:13], v13 offset0:70 offset1:71
    s_mul_i32 s35, s32, 8320
    s_add_u32 s26, s35, 8320
    s_waitcnt lgkmcnt(3)
    v_perm_b32 v6, v7, v6, s43
    s_waitcnt lgkmcnt(2)
    v_perm_b32 v7, v9, v8, s43
    s_waitcnt lgkmcnt(1)
    v_perm_b32 v8, v11, v10, s43
    s_waitcnt lgkmcnt(0)
    v_perm_b32 v9, v13, v12, s43
    buffer_store_dwordx4 v[6:9], v1, s[24:27], s35 offen sc1
    s_nop 1
L_p1_kernel_notab_9:
    s_barrier
    s_lshl_b32 s35, s54, 2
    v_mov_b32 v6, s35
    v_mov_b32 v7, 0
    v_mov_b32 v12, 1140817920
    s_mov_b64 exec, 1
    ds_write2_b32 v6, v7, v7 offset0:0 offset1:1
    s_cmp_eq_u64 s[46:47], 0
    s_cbranch_scc1 L_p1_kernel_nonull_10
    s_mov_b64 exec, s[64:65]
    v_lshlrev_b32_sdwa v6, 2, v14 dst_sel:DWORD dst_unused:UNUSED_PAD src0_sel:DWORD src1_sel:WORD_0
    ds_write_b32 v6, v7 offset:4
    s_mov_b64 exec, s[56:57]
    ds_write_b32 v6, v7
    s_mov_b64 exec, s[66:67]
    v_lshlrev_b32_sdwa v6, 2, v14 dst_sel:DWORD dst_unused:UNUSED_PAD src0_sel:DWORD src1_sel:WORD_1
    ds_write_b32 v6, v7 offset:4
    s_mov_b64 exec, s[58:59]
    ds_write_b32 v6, v7
    s_mov_b64 exec, s[68:69]
    v_lshlrev_b32_sdwa v6, 2, v15 dst_sel:DWORD dst_unused:UNUSED_PAD src0_sel:DWORD src1_sel:WORD_0
    ds_write_b32 v6, v7 offset:4
    s_mov_b64 exec, s[60:61]
    ds_write_b32 v6, v7
    s_mov_b64 exec, s[70:71]
    v_lshlrev_b32_sdwa v6, 2, v15 dst_sel:DWORD dst_unused:UNUSED_PAD src0_sel:DWORD src1_sel:WORD_1
    ds_write_b32 v6, v7 offset:4
    s_mov_b64 exec, s[62:63]
    ds_write_b32 v6, v7
L_p1_kernel_nonull_10:
    s_mov_b64 exec, -1
    v_lshlrev_b32_sdwa v6, 2, v51 dst_sel:DWORD dst_unused:UNUSED_PAD src0_sel:DWORD src1_sel:WORD_0
    v_lshlrev_b32_sdwa v7, 2, v51 dst_sel:DWORD dst_unused:UNUSED_PAD src0_sel:DWORD src1_sel:WORD_1
    v_lshlrev_b32_sdwa v8, 2, v55 dst_sel:DWORD dst_unused:UNUSED_PAD src0_sel:DWORD src1_sel:WORD_0
    v_lshlrev_b32_sdwa v9, 2, v55 dst_sel:DWORD dst_unused:UNUSED_PAD src0_sel:DWORD src1_sel:WORD_1
    ds_write_b32 v6, v48
    ds_write_b32 v7, v49
    ds_write_b32 v8, v50
    ds_write_b32 v9, v52
    s_waitcnt vmcnt(9)
    v_lshlrev_b32 v10, 16, v100
    v_lshlrev_b32 v11, 16, v101
    v_and_b32 v100, 0xffff0000, v100
    v_and_b32 v101, 0xffff0000, v101
    v_mul_f32 v10, s41, v10
    v_mul_f32 v100, s41, v100
    v_mul_f32 v11, s41, v11
    v_mul_f32 v101, s41, v101
    v_fract_f32 v10, v10
    v_fract_f32 v100, v100
    v_fract_f32 v11, v11
    v_fract_f32 v101, v101
    v_cos_f32 v10, v10
    v_cos_f32 v100, v100
    v_cos_f32 v11, v11
    v_cos_f32 v101, v101
    v_fmaak_f32 v10, v12, v10, 1262486016
    v_fmaak_f32 v100, v12, v100, 1262486016
    v_fmaak_f32 v11, v12, v11, 1262486016
    v_fmaak_f32 v101, v12, v101, 1262486016
    v_or3_b32 v5, v10, v100, v5
    v_or3_b32 v5, v11, v101, v5
    v_perm_b32 v100, v100, v10, s43
    v_perm_b32 v101, v101, v11, s43
    s_add_u32 s35, s33, 40960000
    buffer_load_dwordx4 v[16:19], v1, s[8:11], s35 offen nt
    v_lshlrev_b32_sdwa v6, 2, v59 dst_sel:DWORD dst_unused:UNUSED_PAD src0_sel:DWORD src1_sel:WORD_0
    v_lshlrev_b32_sdwa v7, 2, v59 dst_sel:DWORD dst_unused:UNUSED_PAD src0_sel:DWORD src1_sel:WORD_1
    v_lshlrev_b32_sdwa v8, 2, v63 dst_sel:DWORD dst_unused:UNUSED_PAD src0_sel:DWORD src1_sel:WORD_0
    v_lshlrev_b32_sdwa v9, 2, v63 dst_sel:DWORD dst_unused:UNUSED_PAD src0_sel:DWORD src1_sel:WORD_1
    ds_write_b32 v6, v53
    ds_write_b32 v7, v54
    ds_write_b32 v8, v56
    ds_write_b32 v9, v57
    s_waitcnt vmcnt(9)
    v_lshlrev_b32 v10, 16, v102
    v_lshlrev_b32 v11, 16, v103
    v_and_b32 v102, 0xffff0000, v102
    v_and_b32 v103, 0xffff0000, v103
    v_mul_f32 v10, s41, v10
    v_mul_f32 v102, s41, v102
    v_mul_f32 v11, s41, v11
    v_mul_f32 v103, s41, v103
    v_fract_f32 v10, v10
    v_fract_f32 v102, v102
    v_fract_f32 v11, v11
    v_fract_f32 v103, v103
    v_cos_f32 v10, v10
    v_cos_f32 v102, v102
    v_cos_f32 v11, v11
    v_cos_f32 v103, v103
    v_fmaak_f32 v10, v12, v10, 1262486016
    v_fmaak_f32 v102, v12, v102, 1262486016
    v_fmaak_f32 v11, v12, v11, 1262486016
    v_fmaak_f32 v103, v12, v103, 1262486016
    v_or3_b32 v5, v10, v102, v5
    v_or3_b32 v5, v11, v103, v5
    v_perm_b32 v102, v102, v10, s43
    v_perm_b32 v103, v103, v11, s43
    v_lshlrev_b32_sdwa v6, 2, v67 dst_sel:DWORD dst_unused:UNUSED_PAD src0_sel:DWORD src1_sel:WORD_0
    v_lshlrev_b32_sdwa v7, 2, v67 dst_sel:DWORD dst_unused:UNUSED_PAD src0_sel:DWORD src1_sel:WORD_1
    v_lshlrev_b32_sdwa v8, 2, v71 dst_sel:DWORD dst_unused:UNUSED_PAD src0_sel:DWORD src1_sel:WORD_0
    v_lshlrev_b32_sdwa v9, 2, v71 dst_sel:DWORD dst_unused:UNUSED_PAD src0_sel:DWORD src1_sel:WORD_1
    ds_write_b32 v6, v58
    ds_write_b32 v7, v60
    ds_write_b32 v8, v61
    ds_write_b32 v9, v62
    v_lshlrev_b32_sdwa v6, 2, v120 dst_sel:DWORD dst_unused:UNUSED_PAD src0_sel:DWORD src1_sel:WORD_0
    v_lshlrev_b32_sdwa v7, 2, v120 dst_sel:DWORD dst_unused:UNUSED_PAD src0_sel:DWORD src1_sel:WORD_1
    v_lshlrev_b32_sdwa v8, 2, v121 dst_sel:DWORD dst_unused:UNUSED_PAD src0_sel:DWORD src1_sel:WORD_0
    v_lshlrev_b32_sdwa v9, 2, v121 dst_sel:DWORD dst_unused:UNUSED_PAD src0_sel:DWORD src1_sel:WORD_1
    ds_write_b32 v6, v64
    ds_write_b32 v7, v65
    ds_write_b32 v8, v66
    ds_write_b32 v9, v68
    s_waitcnt vmcnt(8)
    v_lshlrev_b32 v10, 16, v104
    v_lshlrev_b32 v11, 16, v105
    v_and_b32 v104, 0xffff0000, v104
    v_and_b32 v105, 0xffff0000, v105
    v_mul_f32 v10, s41, v10
    v_mul_f32 v104, s41, v104
    v_mul_f32 v11, s41, v11
    v_mul_f32 v105, s41, v105
    v_fract_f32 v10, v10
    v_fract_f32 v104, v104
    v_fract_f32 v11, v11
    v_fract_f32 v105, v105
    v_cos_f32 v10, v10
    v_cos_f32 v104, v104
    v_cos_f32 v11, v11
    v_cos_f32 v105, v105
    v_fmaak_f32 v10, v12, v10, 1262486016
    v_fmaak_f32 v104, v12, v104, 1262486016
    v_fmaak_f32 v11, v12, v11, 1262486016
    v_fmaak_f32 v105, v12, v105, 1262486016
    v_or3_b32 v5, v10, v104, v5
    v_or3_b32 v5, v11, v105, v5
    v_perm_b32 v104, v104, v10, s43
    v_perm_b32 v105, v105, v11, s43
    s_add_u32 s35, s33, 40960000
    buffer_load_dwordx4 v[20:23], v1, s[12:15], s35 offen nt
    v_lshlrev_b32_sdwa v6, 2, v122 dst_sel:DWORD dst_unused:UNUSED_PAD src0_sel:DWORD src1_sel:WORD_0
    v_lshlrev_b32_sdwa v7, 2, v122 dst_sel:DWORD dst_unused:UNUSED_PAD src0_sel:DWORD src1_sel:WORD_1
    v_lshlrev_b32_sdwa v8, 2, v123 dst_sel:DWORD dst_unused:UNUSED_PAD src0_sel:DWORD src1_sel:WORD_0
    v_lshlrev_b32_sdwa v9, 2, v123 dst_sel:DWORD dst_unused:UNUSED_PAD src0_sel:DWORD src1_sel:WORD_1
    ds_write_b32 v6, v69
    ds_write_b32 v7, v70
    ds_write_b32 v8, v127
    ds_write_b32 v9, v72
    s_waitcnt vmcnt(8)
    v_lshlrev_b32 v10, 16, v106
    v_lshlrev_b32 v11, 16, v107
    v_and_b32 v106, 0xffff0000, v106
    v_and_b32 v107, 0xffff0000, v107
    v_mul_f32 v10, s41, v10
    v_mul_f32 v106, s41, v106
    v_mul_f32 v11, s41, v11
    v_mul_f32 v107, s41, v107
    v_fract_f32 v10, v10
    v_fract_f32 v106, v106
    v_fract_f32 v11, v11
    v_fract_f32 v107, v107
    v_cos_f32 v10, v10
    v_cos_f32 v106, v106
    v_cos_f32 v11, v11
    v_cos_f32 v107, v107
    v_fmaak_f32 v10, v12, v10, 1262486016
    v_fmaak_f32 v106, v12, v106, 1262486016
    v_fmaak_f32 v11, v12, v11, 1262486016
    v_fmaak_f32 v107, v12, v107, 1262486016
    v_or3_b32 v5, v10, v106, v5
    v_or3_b32 v5, v11, v107, v5
    v_perm_b32 v106, v106, v10, s43
    v_perm_b32 v107, v107, v11, s43
    v_lshlrev_b32_sdwa v6, 2, v124 dst_sel:DWORD dst_unused:UNUSED_PAD src0_sel:DWORD src1_sel:WORD_0
    v_lshlrev_b32_sdwa v7, 2, v124 dst_sel:DWORD dst_unused:UNUSED_PAD src0_sel:DWORD src1_sel:WORD_1
    v_lshlrev_b32_sdwa v8, 2, v125 dst_sel:DWORD dst_unused:UNUSED_PAD src0_sel:DWORD src1_sel:WORD_0
    v_lshlrev_b32_sdwa v9, 2, v125 dst_sel:DWORD dst_unused:UNUSED_PAD src0_sel:DWORD src1_sel:WORD_1
    ds_write_b32 v6, v73
    ds_write_b32 v7, v74
    ds_write_b32 v8, v76
    ds_write_b32 v9, v77
    v_lshlrev_b32_sdwa v6, 2, v126 dst_sel:DWORD dst_unused:UNUSED_PAD src0_sel:DWORD src1_sel:WORD_0
    v_lshlrev_b32_sdwa v7, 2, v126 dst_sel:DWORD dst_unused:UNUSED_PAD src0_sel:DWORD src1_sel:WORD_1
    v_lshlrev_b32_sdwa v8, 2, v75 dst_sel:DWORD dst_unused:UNUSED_PAD src0_sel:DWORD src1_sel:WORD_0
    v_lshlrev_b32_sdwa v9, 2, v75 dst_sel:DWORD dst_unused:UNUSED_PAD src0_sel:DWORD src1_sel:WORD_1
    ds_write_b32 v6, v78
    ds_write_b32 v7, v80
    ds_write_b32 v8, v81
    ds_write_b32 v9, v82
    s_waitcnt vmcnt(7)
    v_lshlrev_b32 v10, 16, v108
    v_lshlrev_b32 v11, 16, v109
    v_and_b32 v108, 0xffff0000, v108
    v_and_b32 v109, 0xffff0000, v109
    v_mul_f32 v10, s41, v10
    v_mul_f32 v108, s41, v108
    v_mul_f32 v11, s41, v11
    v_mul_f32 v109, s41, v109
    v_fract_f32 v10, v10
    v_fract_f32 v108, v108
    v_fract_f32 v11, v11
    v_fract_f32 v109, v109
    v_cos_f32 v10, v10
    v_cos_f32 v108, v108
    v_cos_f32 v11, v11
    v_cos_f32 v109, v109
    v_fmaak_f32 v10, v12, v10, 1262486016
    v_fmaak_f32 v108, v12, v108, 1262486016
    v_fmaak_f32 v11, v12, v11, 1262486016
    v_fmaak_f32 v109, v12, v109, 1262486016
    v_or3_b32 v5, v10, v108, v5
    v_or3_b32 v5, v11, v109, v5
    v_perm_b32 v108, v108, v10, s43
    v_perm_b32 v109, v109, v11, s43
    s_add_u32 s35, s33, 45154304
    buffer_load_dwordx4 v[24:27], v1, s[8:11], s35 offen nt
    v_lshlrev_b32_sdwa v6, 2, v79 dst_sel:DWORD dst_unused:UNUSED_PAD src0_sel:DWORD src1_sel:WORD_0
    v_lshlrev_b32_sdwa v7, 2, v79 dst_sel:DWORD dst_unused:UNUSED_PAD src0_sel:DWORD src1_sel:WORD_1
    v_lshlrev_b32_sdwa v8, 2, v83 dst_sel:DWORD dst_unused:UNUSED_PAD src0_sel:DWORD src1_sel:WORD_0
    v_lshlrev_b32_sdwa v9, 2, v83 dst_sel:DWORD dst_unused:UNUSED_PAD src0_sel:DWORD src1_sel:WORD_1
    ds_write_b32 v6, v84
    ds_write_b32 v7, v85
    ds_write_b32 v8, v86
    ds_write_b32 v9, v88
    s_waitcnt vmcnt(7)
    v_lshlrev_b32 v10, 16, v110
    v_lshlrev_b32 v11, 16, v111
    v_and_b32 v110, 0xffff0000, v110
    v_and_b32 v111, 0xffff0000, v111
    v_mul_f32 v10, s41, v10
    v_mul_f32 v110, s41, v110
    v_mul_f32 v11, s41, v11
    v_mul_f32 v111, s41, v111
    v_fract_f32 v10, v10
    v_fract_f32 v110, v110
    v_fract_f32 v11, v11
    v_fract_f32 v111, v111
    v_cos_f32 v10, v10
    v_cos_f32 v110, v110
    v_cos_f32 v11, v11
    v_cos_f32 v111, v111
    v_fmaak_f32 v10, v12, v10, 1262486016
    v_fmaak_f32 v110, v12, v110, 1262486016
    v_fmaak_f32 v11, v12, v11, 1262486016
    v_fmaak_f32 v111, v12, v111, 1262486016
    v_or3_b32 v5, v10, v110, v5
    v_or3_b32 v5, v11, v111, v5
    v_perm_b32 v110, v110, v10, s43
    v_perm_b32 v111, v111, v11, s43
    v_lshlrev_b32_sdwa v6, 2, v87 dst_sel:DWORD dst_unused:UNUSED_PAD src0_sel:DWORD src1_sel:WORD_0
    v_lshlrev_b32_sdwa v7, 2, v87 dst_sel:DWORD dst_unused:UNUSED_PAD src0_sel:DWORD src1_sel:WORD_1
    v_lshlrev_b32_sdwa v8, 2, v91 dst_sel:DWORD dst_unused:UNUSED_PAD src0_sel:DWORD src1_sel:WORD_0
    v_lshlrev_b32_sdwa v9, 2, v91 dst_sel:DWORD dst_unused:UNUSED_PAD src0_sel:DWORD src1_sel:WORD_1
    ds_write_b32 v6, v89
    ds_write_b32 v7, v90
    ds_write_b32 v8, v92
    ds_write_b32 v9, v93
    s_mov_b64 exec, s[44:45]
    v_lshlrev_b32_sdwa v6, 2, v95 dst_sel:DWORD dst_unused:UNUSED_PAD src0_sel:DWORD src1_sel:WORD_0
    v_lshlrev_b32_sdwa v7, 2, v95 dst_sel:DWORD dst_unused:UNUSED_PAD src0_sel:DWORD src1_sel:WORD_1
    v_lshlrev_b32_sdwa v8, 2, v99 dst_sel:DWORD dst_unused:UNUSED_PAD src0_sel:DWORD src1_sel:WORD_0
    v_lshlrev_b32_sdwa v9, 2, v99 dst_sel:DWORD dst_unused:UNUSED_PAD src0_sel:DWORD src1_sel:WORD_1
    ds_write_b32 v6, v94
    ds_write_b32 v7, v96
    ds_write_b32 v8, v97
    ds_write_b32 v9, v98
    s_mov_b64 exec, -1
    s_waitcnt vmcnt(6)
    v_lshlrev_b32 v10, 16, v112
    v_lshlrev_b32 v11, 16, v113
    v_and_b32 v112, 0xffff0000, v112
    v_and_b32 v113, 0xffff0000, v113
    v_mul_f32 v10, s41, v10
    v_mul_f32 v112, s41, v112
    v_mul_f32 v11, s41, v11
    v_mul_f32 v113, s41, v113
    v_fract_f32 v10, v10
    v_fract_f32 v112, v112
    v_fract_f32 v11, v11
    v_fract_f32 v113, v113
    v_cos_f32 v10, v10
    v_cos_f32 v112, v112
    v_cos_f32 v11, v11
    v_cos_f32 v113, v113
    v_fmaak_f32 v10, v12, v10, 1262486016
    v_fmaak_f32 v112, v12, v112, 1262486016
    v_fmaak_f32 v11, v12, v11, 1262486016
    v_fmaak_f32 v113, v12, v113, 1262486016
    v_or3_b32 v5, v10, v112, v5
    v_or3_b32 v5, v11, v113, v5
    v_perm_b32 v112, v112, v10, s43
    v_perm_b32 v113, v113, v11, s43
    s_mov_b64 exec, s[44:45]
    s_mov_b64 exec, -1
    s_add_u32 s35, s33, 45154304
    buffer_load_dwordx4 v[28:31], v1, s[12:15], s35 offen nt
    s_mul_i32 s35, s39, 9216
    v_mad_u32_u24 v6, v0, 12, s35
    s_waitcnt lgkmcnt(0)
    s_barrier
    s_cmp_lg_u32 s39, 15
    s_cbranch_scc1 L_p1_kernel_nox_11
    ds_read_b32 v12, v6 offset:9984
    ds_read_b32 v13, v6 offset:9988
    ds_read_b32 v14, v6 offset:9992
L_p1_kernel_nox_11:
    ds_read_b32 v48, v6 offset:1536
    ds_read_b32 v49, v6 offset:1540
    ds_read_b32 v50, v6 offset:1544
    ds_read_b32 v52, v6 offset:3072
    ds_read_b32 v53, v6 offset:3076
    ds_read_b32 v54, v6 offset:3080
    ds_read_b32 v56, v6 offset:4608
    ds_read_b32 v57, v6 offset:4612
    ds_read_b32 v58, v6 offset:4616
    ds_read_b32 v60, v6 offset:6144
    ds_read_b32 v61, v6 offset:6148
    ds_read_b32 v62, v6 offset:6152
    ds_read_b32 v64, v6 offset:7680
    ds_read_b32 v65, v6 offset:7684
    ds_read_b32 v66, v6 offset:7688
    ds_read_b32 v68, v6 offset:9216
    ds_read_b32 v69, v6 offset:9220
    ds_read_b32 v70, v6 offset:9224
    ds_read_b32 v72, v6 offset:0
    ds_read_b32 v73, v6 offset:4
    ds_read_b32 v74, v6 offset:8
    ds_read_b32 v76, v6 offset:768
    ds_read_b32 v77, v6 offset:772
    ds_read_b32 v78, v6 offset:776
    ds_read_b32 v80, v6 offset:2304
    ds_read_b32 v81, v6 offset:2308
    ds_read_b32 v82, v6 offset:2312
    ds_read_b32 v84, v6 offset:3840
    ds_read_b32 v85, v6 offset:3844
    ds_read_b32 v86, v6 offset:3848
    ds_read_b32 v88, v6 offset:5376
    ds_read_b32 v89, v6 offset:5380
    ds_read_b32 v90, v6 offset:5384
    ds_read_b32 v92, v6 offset:6912
    ds_read_b32 v93, v6 offset:6916
    ds_read_b32 v94, v6 offset:6920
    ds_read_b32 v96, v6 offset:8448
    ds_read_b32 v97, v6 offset:8452
    ds_read_b32 v98, v6 offset:8456
    s_add_u32 s35, s33, 49348608
    buffer_load_dwordx4 v[32:35], v1, s[8:11], s35 offen nt
    v_mov_b32 v8, 0
    v_mov_b32 v9, 0
    v_mov_b32 v10, 0
    v_mov_b32 v11, 0
    v_mov_b32 v15, 16384
    s_waitcnt lgkmcnt(0)
    s_barrier
    ds_write_b128 v1, v[8:11] offset:0
    s_nop 1
    v_mad_u32_u16 v6, v51, s50, v15 op_sel:[0,0,0,0]
    v_mad_u32_u16 v7, v51, s50, v15 op_sel:[1,0,0,0]
    v_mad_u32_u16 v8, v55, s50, v15 op_sel:[0,0,0,0]
    v_mad_u32_u16 v9, v55, s50, v15 op_sel:[1,0,0,0]
    v_add_u32_sdwa v6, v6, v51 dst_sel:DWORD dst_unused:UNUSED_PAD src0_sel:WORD_1 src1_sel:WORD_0
    v_add_u32_sdwa v7, v7, v51 dst_sel:DWORD dst_unused:UNUSED_PAD src0_sel:WORD_1 src1_sel:WORD_1
    v_add_u32_sdwa v8, v8, v55 dst_sel:DWORD dst_unused:UNUSED_PAD src0_sel:WORD_1 src1_sel:WORD_0
    v_add_u32_sdwa v9, v9, v55 dst_sel:DWORD dst_unused:UNUSED_PAD src0_sel:WORD_1 src1_sel:WORD_1
    v_add_u32 v6, v6, v6
    v_add_u32 v7, v7, v7
    v_add_u32 v8, v8, v8
    v_add_u32 v9, v9, v9
    ds_write_b16 v6, v100 offset:16384
    ds_write_b16_d16_hi v7, v100 offset:16384
    ds_write_b16 v8, v101 offset:16384
    ds_write_b16_d16_hi v9, v101 offset:16384
    v_mov_b32 v6, 1140817920
    s_waitcnt vmcnt(7)
    v_lshlrev_b32 v10, 16, v114
    v_lshlrev_b32 v11, 16, v115
    v_and_b32 v114, 0xffff0000, v114
    v_and_b32 v115, 0xffff0000, v115
    v_mul_f32 v10, s41, v10
    v_mul_f32 v114, s41, v114
    v_mul_f32 v11, s41, v11
    v_mul_f32 v115, s41, v115
    v_fract_f32 v10, v10
    v_fract_f32 v114, v114
    v_fract_f32 v11, v11
    v_fract_f32 v115, v115
    v_cos_f32 v10, v10
    v_cos_f32 v114, v114
    v_cos_f32 v11, v11
    v_cos_f32 v115, v115
    v_fmaak_f32 v10, v6, v10, 1262486016
    v_fmaak_f32 v114, v6, v114, 1262486016
    v_fmaak_f32 v11, v6, v11, 1262486016
    v_fmaak_f32 v115, v6, v115, 1262486016
    v_or3_b32 v5, v10, v114, v5
    v_or3_b32 v5, v11, v115, v5
    v_perm_b32 v114, v114, v10, s43
    v_perm_b32 v115, v115, v11, s43
    v_mad_u32_u16 v6, v59, s50, v15 op_sel:[0,0,0,0]
    v_mad_u32_u16 v7, v59, s50, v15 op_sel:[1,0,0,0]
    v_mad_u32_u16 v8, v63, s50, v15 op_sel:[0,0,0,0]
    v_mad_u32_u16 v9, v63, s50, v15 op_sel:[1,0,0,0]
    v_add_u32_sdwa v6, v6, v59 dst_sel:DWORD dst_unused:UNUSED_PAD src0_sel:WORD_1 src1_sel:WORD_0
    v_add_u32_sdwa v7, v7, v59 dst_sel:DWORD dst_unused:UNUSED_PAD src0_sel:WORD_1 src1_sel:WORD_1
    v_add_u32_sdwa v8, v8, v63 dst_sel:DWORD dst_unused:UNUSED_PAD src0_sel:WORD_1 src1_sel:WORD_0
    v_add_u32_sdwa v9, v9, v63 dst_sel:DWORD dst_unused:UNUSED_PAD src0_sel:WORD_1 src1_sel:WORD_1
    v_add_u32 v6, v6, v6
    v_add_u32 v7, v7, v7
    v_add_u32 v8, v8, v8
    v_add_u32 v9, v9, v9
    ds_write_b16 v6, v102 offset:16384
    ds_write_b16_d16_hi v7, v102 offset:16384
    ds_write_b16 v8, v103 offset:16384
    ds_write_b16_d16_hi v9, v103 offset:16384
    v_mad_u32_u16 v6, v67, s50, v15 op_sel:[0,0,0,0]
    v_mad_u32_u16 v7, v67, s50, v15 op_sel:[1,0,0,0]
    v_mad_u32_u16 v8, v71, s50, v15 op_sel:[0,0,0,0]
    v_mad_u32_u16 v9, v71, s50, v15 op_sel:[1,0,0,0]
    v_add_u32_sdwa v6, v6, v67 dst_sel:DWORD dst_unused:UNUSED_PAD src0_sel:WORD_1 src1_sel:WORD_0
    v_add_u32_sdwa v7, v7, v67 dst_sel:DWORD dst_unused:UNUSED_PAD src0_sel:WORD_1 src1_sel:WORD_1
    v_add_u32_sdwa v8, v8, v71 dst_sel:DWORD dst_unused:UNUSED_PAD src0_sel:WORD_1 src1_sel:WORD_0
    v_add_u32_sdwa v9, v9, v71 dst_sel:DWORD dst_unused:UNUSED_PAD src0_sel:WORD_1 src1_sel:WORD_1
    v_add_u32 v6, v6, v6
    v_add_u32 v7, v7, v7
    v_add_u32 v8, v8, v8
    v_add_u32 v9, v9, v9
    ds_write_b16 v6, v104 offset:16384
    ds_write_b16_d16_hi v7, v104 offset:16384
    ds_write_b16 v8, v105 offset:16384
    ds_write_b16_d16_hi v9, v105 offset:16384
    s_add_u32 s35, s33, 49348608
    buffer_load_dwordx4 v[36:39], v1, s[12:15], s35 offen nt
    v_mad_u32_u16 v6, v120, s50, v15 op_sel:[0,0,0,0]
    v_mad_u32_u16 v7, v120, s50, v15 op_sel:[1,0,0,0]
    v_mad_u32_u16 v8, v121, s50, v15 op_sel:[0,0,0,0]
    v_mad_u32_u16 v9, v121, s50, v15 op_sel:[1,0,0,0]
    v_add_u32_sdwa v6, v6, v120 dst_sel:DWORD dst_unused:UNUSED_PAD src0_sel:WORD_1 src1_sel:WORD_0
    v_add_u32_sdwa v7, v7, v120 dst_sel:DWORD dst_unused:UNUSED_PAD src0_sel:WORD_1 src1_sel:WORD_1
    v_add_u32_sdwa v8, v8, v121 dst_sel:DWORD dst_unused:UNUSED_PAD src0_sel:WORD_1 src1_sel:WORD_0
    v_add_u32_sdwa v9, v9, v121 dst_sel:DWORD dst_unused:UNUSED_PAD src0_sel:WORD_1 src1_sel:WORD_1
    v_add_u32 v6, v6, v6
    v_add_u32 v7, v7, v7
    v_add_u32 v8, v8, v8
    v_add_u32 v9, v9, v9
    ds_write_b16 v6, v106 offset:16384
    ds_write_b16_d16_hi v7, v106 offset:16384
    ds_write_b16 v8, v107 offset:16384
    ds_write_b16_d16_hi v9, v107 offset:16384
    v_mov_b32 v6, 1140817920
    s_waitcnt vmcnt(7)
    v_lshlrev_b32 v10, 16, v116
    v_lshlrev_b32 v11, 16, v117
    v_and_b32 v116, 0xffff0000, v116
    v_and_b32 v117, 0xffff0000, v117
    v_mul_f32 v10, s41, v10
    v_mul_f32 v116, s41, v116
    v_mul_f32 v11, s41, v11
    v_mul_f32 v117, s41, v117
    v_fract_f32 v10, v10
    v_fract_f32 v116, v116
    v_fract_f32 v11, v11
    v_fract_f32 v117, v117
    v_cos_f32 v10, v10
    v_cos_f32 v116, v116
    v_cos_f32 v11, v11
    v_cos_f32 v117, v117
    v_fmaak_f32 v10, v6, v10, 1262486016
    v_fmaak_f32 v116, v6, v116, 1262486016
    v_fmaak_f32 v11, v6, v11, 1262486016
    v_fmaak_f32 v117, v6, v117, 1262486016
    v_or3_b32 v5, v10, v116, v5
    v_or3_b32 v5, v11, v117, v5
    v_perm_b32 v116, v116, v10, s43
    v_perm_b32 v117, v117, v11, s43
    v_mad_u32_u16 v6, v122, s50, v15 op_sel:[0,0,0,0]
    v_mad_u32_u16 v7, v122, s50, v15 op_sel:[1,0,0,0]
    v_mad_u32_u16 v8, v123, s50, v15 op_sel:[0,0,0,0]
    v_mad_u32_u16 v9, v123, s50, v15 op_sel:[1,0,0,0]
    v_add_u32_sdwa v6, v6, v122 dst_sel:DWORD dst_unused:UNUSED_PAD src0_sel:WORD_1 src1_sel:WORD_0
    v_add_u32_sdwa v7, v7, v122 dst_sel:DWORD dst_unused:UNUSED_PAD src0_sel:WORD_1 src1_sel:WORD_1
    v_add_u32_sdwa v8, v8, v123 dst_sel:DWORD dst_unused:UNUSED_PAD src0_sel:WORD_1 src1_sel:WORD_0
    v_add_u32_sdwa v9, v9, v123 dst_sel:DWORD dst_unused:UNUSED_PAD src0_sel:WORD_1 src1_sel:WORD_1
    v_add_u32 v6, v6, v6
    v_add_u32 v7, v7, v7
    v_add_u32 v8, v8, v8
    v_add_u32 v9, v9, v9
    ds_write_b16 v6, v108 offset:16384
    ds_write_b16_d16_hi v7, v108 offset:16384
    ds_write_b16 v8, v109 offset:16384
    ds_write_b16_d16_hi v9, v109 offset:16384
    v_mad_u32_u16 v6, v124, s50, v15 op_sel:[0,0,0,0]
    v_mad_u32_u16 v7, v124, s50, v15 op_sel:[1,0,0,0]
    v_mad_u32_u16 v8, v125, s50, v15 op_sel:[0,0,0,0]
    v_mad_u32_u16 v9, v125, s50, v15 op_sel:[1,0,0,0]
    v_add_u32_sdwa v6, v6, v124 dst_sel:DWORD dst_unused:UNUSED_PAD src0_sel:WORD_1 src1_sel:WORD_0
    v_add_u32_sdwa v7, v7, v124 dst_sel:DWORD dst_unused:UNUSED_PAD src0_sel:WORD_1 src1_sel:WORD_1
    v_add_u32_sdwa v8, v8, v125 dst_sel:DWORD dst_unused:UNUSED_PAD src0_sel:WORD_1 src1_sel:WORD_0
    v_add_u32_sdwa v9, v9, v125 dst_sel:DWORD dst_unused:UNUSED_PAD src0_sel:WORD_1 src1_sel:WORD_1
    v_add_u32 v6, v6, v6
    v_add_u32 v7, v7, v7
    v_add_u32 v8, v8, v8
    v_add_u32 v9, v9, v9
    ds_write_b16 v6, v110 offset:16384
    ds_write_b16_d16_hi v7, v110 offset:16384
    ds_write_b16 v8, v111 offset:16384
    ds_write_b16_d16_hi v9, v111 offset:16384
    s_add_u32 s35, s33, 53542912
    buffer_load_dwordx4 v[40:43], v1, s[8:11], s35 offen nt
    v_mad_u32_u16 v6, v126, s50, v15 op_sel:[0,0,0,0]
    v_mad_u32_u16 v7, v126, s50, v15 op_sel:[1,0,0,0]
    v_mad_u32_u16 v8, v75, s50, v15 op_sel:[0,0,0,0]
    v_mad_u32_u16 v9, v75, s50, v15 op_sel:[1,0,0,0]
    v_add_u32_sdwa v6, v6, v126 dst_sel:DWORD dst_unused:UNUSED_PAD src0_sel:WORD_1 src1_sel:WORD_0
    v_add_u32_sdwa v7, v7, v126 dst_sel:DWORD dst_unused:UNUSED_PAD src0_sel:WORD_1 src1_sel:WORD_1
    v_add_u32_sdwa v8, v8, v75 dst_sel:DWORD dst_unused:UNUSED_PAD src0_sel:WORD_1 src1_sel:WORD_0
    v_add_u32_sdwa v9, v9, v75 dst_sel:DWORD dst_unused:UNUSED_PAD src0_sel:WORD_1 src1_sel:WORD_1
    v_add_u32 v6, v6, v6
    v_add_u32 v7, v7, v7
    v_add_u32 v8, v8, v8
    v_add_u32 v9, v9, v9
    ds_write_b16 v6, v112 offset:16384
    ds_write_b16_d16_hi v7, v112 offset:16384
    ds_write_b16 v8, v113 offset:16384
    ds_write_b16_d16_hi v9, v113 offset:16384
    v_mov_b32 v6, 1140817920
    s_mov_b64 exec, s[44:45]
    s_waitcnt vmcnt(7)
    v_lshlrev_b32 v10, 16, v118
    v_lshlrev_b32 v11, 16, v119
    v_and_b32 v118, 0xffff0000, v118
    v_and_b32 v119, 0xffff0000, v119
    v_mul_f32 v10, s41, v10
    v_mul_f32 v118, s41, v118
    v_mul_f32 v11, s41, v11
    v_mul_f32 v119, s41, v119
    v_fract_f32 v10, v10
    v_fract_f32 v118, v118
    v_fract_f32 v11, v11
    v_fract_f32 v119, v119
    v_cos_f32 v10, v10
    v_cos_f32 v118, v118
    v_cos_f32 v11, v11
    v_cos_f32 v119, v119
    v_fmaak_f32 v10, v6, v10, 1262486016
    v_fmaak_f32 v118, v6, v118, 1262486016
    v_fmaak_f32 v11, v6, v11, 1262486016
    v_fmaak_f32 v119, v6, v119, 1262486016
    v_or3_b32 v5, v10, v118, v5
    v_or3_b32 v5, v11, v119, v5
    v_perm_b32 v118, v118, v10, s43
    v_perm_b32 v119, v119, v11, s43
    s_mov_b64 exec, -1
    v_mad_u32_u16 v6, v79, s50, v15 op_sel:[0,0,0,0]
    v_mad_u32_u16 v7, v79, s50, v15 op_sel:[1,0,0,0]
    v_mad_u32_u16 v8, v83, s50, v15 op_sel:[0,0,0,0]
    v_mad_u32_u16 v9, v83, s50, v15 op_sel:[1,0,0,0]
    v_add_u32_sdwa v6, v6, v79 dst_sel:DWORD dst_unused:UNUSED_PAD src0_sel:WORD_1 src1_sel:WORD_0
    v_add_u32_sdwa v7, v7, v79 dst_sel:DWORD dst_unused:UNUSED_PAD src0_sel:WORD_1 src1_sel:WORD_1
    v_add_u32_sdwa v8, v8, v83 dst_sel:DWORD dst_unused:UNUSED_PAD src0_sel:WORD_1 src1_sel:WORD_0
    v_add_u32_sdwa v9, v9, v83 dst_sel:DWORD dst_unused:UNUSED_PAD src0_sel:WORD_1 src1_sel:WORD_1
    v_add_u32 v6, v6, v6
    v_add_u32 v7, v7, v7
    v_add_u32 v8, v8, v8
    v_add_u32 v9, v9, v9
    ds_write_b16 v6, v114 offset:16384
    ds_write_b16_d16_hi v7, v114 offset:16384
    ds_write_b16 v8, v115 offset:16384
    ds_write_b16_d16_hi v9, v115 offset:16384
    v_mad_u32_u16 v6, v87, s50, v15 op_sel:[0,0,0,0]
    v_mad_u32_u16 v7, v87, s50, v15 op_sel:[1,0,0,0]
    v_mad_u32_u16 v8, v91, s50, v15 op_sel:[0,0,0,0]
    v_mad_u32_u16 v9, v91, s50, v15 op_sel:[1,0,0,0]
    v_add_u32_sdwa v6, v6, v87 dst_sel:DWORD dst_unused:UNUSED_PAD src0_sel:WORD_1 src1_sel:WORD_0
    v_add_u32_sdwa v7, v7, v87 dst_sel:DWORD dst_unused:UNUSED_PAD src0_sel:WORD_1 src1_sel:WORD_1
    v_add_u32_sdwa v8, v8, v91 dst_sel:DWORD dst_unused:UNUSED_PAD src0_sel:WORD_1 src1_sel:WORD_0
    v_add_u32_sdwa v9, v9, v91 dst_sel:DWORD dst_unused:UNUSED_PAD src0_sel:WORD_1 src1_sel:WORD_1
    v_add_u32 v6, v6, v6
    v_add_u32 v7, v7, v7
    v_add_u32 v8, v8, v8
    v_add_u32 v9, v9, v9
    ds_write_b16 v6, v116 offset:16384
    ds_write_b16_d16_hi v7, v116 offset:16384
    ds_write_b16 v8, v117 offset:16384
    ds_write_b16_d16_hi v9, v117 offset:16384
    s_add_u32 s35, s33, 53542912
    buffer_load_dwordx4 v[44:47], v1, s[12:15], s35 offen nt
    s_mov_b64 exec, s[44:45]
    v_mad_u32_u16 v6, v95, s50, v15 op_sel:[0,0,0,0]
    v_mad_u32_u16 v7, v95, s50, v15 op_sel:[1,0,0,0]
    v_mad_u32_u16 v8, v99, s50, v15 op_sel:[0,0,0,0]
    v_mad_u32_u16 v9, v99, s50, v15 op_sel:[1,0,0,0]
    v_add_u32_sdwa v6, v6, v95 dst_sel:DWORD dst_unused:UNUSED_PAD src0_sel:WORD_1 src1_sel:WORD_0
    v_add_u32_sdwa v7, v7, v95 dst_sel:DWORD dst_unused:UNUSED_PAD src0_sel:WORD_1 src1_sel:WORD_1
    v_add_u32_sdwa v8, v8, v99 dst_sel:DWORD dst_unused:UNUSED_PAD src0_sel:WORD_1 src1_sel:WORD_0
    v_add_u32_sdwa v9, v9, v99 dst_sel:DWORD dst_unused:UNUSED_PAD src0_sel:WORD_1 src1_sel:WORD_1
    v_add_u32 v6, v6, v6
    v_add_u32 v7, v7, v7
    v_add_u32 v8, v8, v8
    v_add_u32 v9, v9, v9
    ds_write_b16 v6, v118 offset:16384
    ds_write_b16_d16_hi v7, v118 offset:16384
    ds_write_b16 v8, v119 offset:16384
    ds_write_b16_d16_hi v9, v119 offset:16384
    s_mov_b64 exec, -1
    s_mul_i32 s35, s39, 6144
    v_add_u32 v6, s35, v2
    s_waitcnt lgkmcnt(0)
    s_barrier
    ds_read_b64 v[100:101], v6 offset:23040
    ds_read_b64 v[102:103], v6 offset:16384
    ds_read_b64 v[104:105], v6 offset:16896
    ds_read_b64 v[106:107], v6 offset:17408
    ds_read_b64 v[108:109], v6 offset:17920
    ds_read_b64 v[110:111], v6 offset:18432
    ds_read_b64 v[112:113], v6 offset:18944
    ds_read_b64 v[114:115], v6 offset:19456
    ds_read_b64 v[116:117], v6 offset:19968
    ds_read_b64 v[118:119], v6 offset:20480
    ds_read_b64 v[120:121], v6 offset:20992
    ds_read_b64 v[122:123], v6 offset:21504
    ds_read_b64 v[124:125], v6 offset:22016
    ds_read_b64 v[126:127], v6 offset:22528
    s_add_u32 s32, s32, 256
    s_add_u32 s33, s33, 40960000
    s_add_u32 s34, s34, 20480000
    s_add_u32 s40, s40, 1
    s_cmp_lt_u32 s40, 4
    s_cbranch_scc1 L_p1_loop
    s_waitcnt lgkmcnt(13)
    v_lshlrev_b32 v15, 22, v100
    v_lshrrev_b32 v100, 16, v100
    v_alignbit_b32 v15, v100, v15, 10
    v_alignbit_b32 v15, v101, v15, 10
    v_xor_b32 v15, 0x80200800, v15
    s_cmp_lg_u32 s39, 15
    s_cbranch_scc1 L_p1_kernel_nox_12
    s_mov_b32 s36, 13631488
    buffer_store_dwordx4 v[12:15], v3, s[20:23], s36 offen sc1
L_p1_kernel_nox_12:
    s_waitcnt lgkmcnt(12)
    v_lshlrev_b32 v75, 22, v102
    v_lshrrev_b32 v102, 16, v102
    v_alignbit_b32 v75, v102, v75, 10
    v_alignbit_b32 v75, v103, v75, 10
    v_xor_b32 v75, 0x80200800, v75
    s_mov_b32 s36, 0
    buffer_store_dwordx4 v[72:75], v3, s[20:23], s36 offen sc1
    s_waitcnt lgkmcnt(11)
    v_lshlrev_b32 v79, 22, v104
    v_lshrrev_b32 v104, 16, v104
    v_alignbit_b32 v79, v104, v79, 10
    v_alignbit_b32 v79, v105, v79, 10
    v_xor_b32 v79, 0x80200800, v79
    s_mov_b32 s36, 1048576
    buffer_store_dwordx4 v[76:79], v3, s[20:23], s36 offen sc1
    s_waitcnt lgkmcnt(10)
    v_lshlrev_b32 v51, 22, v106
    v_lshrrev_b32 v106, 16, v106
    v_alignbit_b32 v51, v106, v51, 10
    v_alignbit_b32 v51, v107, v51, 10
    v_xor_b32 v51, 0x80200800, v51
    s_mov_b32 s36, 2097152
    buffer_store_dwordx4 v[48:51], v3, s[20:23], s36 offen sc1
    s_waitcnt lgkmcnt(9)
    v_lshlrev_b32 v83, 22, v108
    v_lshrrev_b32 v108, 16, v108
    v_alignbit_b32 v83, v108, v83, 10
    v_alignbit_b32 v83, v109, v83, 10
    v_xor_b32 v83, 0x80200800, v83
    s_mov_b32 s36, 3145728
    buffer_store_dwordx4 v[80:83], v3, s[20:23], s36 offen sc1
    s_waitcnt lgkmcnt(8)
    v_lshlrev_b32 v55, 22, v110
    v_lshrrev_b32 v110, 16, v110
    v_alignbit_b32 v55, v110, v55, 10
    v_alignbit_b32 v55, v111, v55, 10
    v_xor_b32 v55, 0x80200800, v55
    s_mov_b32 s36, 4194304
    buffer_store_dwordx4 v[52:55], v3, s[20:23], s36 offen sc1
    s_waitcnt lgkmcnt(7)
    v_lshlrev_b32 v87, 22, v112
    v_lshrrev_b32 v112, 16, v112
    v_alignbit_b32 v87, v112, v87, 10
    v_alignbit_b32 v87, v113, v87, 10
    v_xor_b32 v87, 0x80200800, v87
    s_mov_b32 s36, 5242880
    buffer_store_dwordx4 v[84:87], v3, s[20:23], s36 offen sc1
    s_waitcnt lgkmcnt(6)
    v_lshlrev_b32 v59, 22, v114
    v_lshrrev_b32 v114, 16, v114
    v_alignbit_b32 v59, v114, v59, 10
    v_alignbit_b32 v59, v115, v59, 10
    v_xor_b32 v59, 0x80200800, v59
    s_mov_b32 s36, 6291456
    buffer_store_dwordx4 v[56:59], v3, s[20:23], s36 offen sc1
    s_waitcnt lgkmcnt(5)
    v_lshlrev_b32 v91, 22, v116
    v_lshrrev_b32 v116, 16, v116
    v_alignbit_b32 v91, v116, v91, 10
    v_alignbit_b32 v91, v117, v91, 10
    v_xor_b32 v91, 0x80200800, v91
    s_mov_b32 s36, 7340032
    buffer_store_dwordx4 v[88:91], v3, s[20:23], s36 offen sc1
    s_waitcnt lgkmcnt(4)
    v_lshlrev_b32 v63, 22, v118
    v_lshrrev_b32 v118, 16, v118
    v_alignbit_b32 v63, v118, v63, 10
    v_alignbit_b32 v63, v119, v63, 10
    v_xor_b32 v63, 0x80200800, v63
    s_mov_b32 s36, 8388608
    buffer_store_dwordx4 v[60:63], v3, s[20:23], s36 offen sc1
    s_waitcnt lgkmcnt(3)
    v_lshlrev_b32 v95, 22, v120
    v_lshrrev_b32 v120, 16, v120
    v_alignbit_b32 v95, v120, v95, 10
    v_alignbit_b32 v95, v121, v95, 10
    v_xor_b32 v95, 0x80200800, v95
    s_mov_b32 s36, 9437184
    buffer_store_dwordx4 v[92:95], v3, s[20:23], s36 offen sc1
    s_waitcnt lgkmcnt(2)
    v_lshlrev_b32 v67, 22, v122
    v_lshrrev_b32 v122, 16, v122
    v_alignbit_b32 v67, v122, v67, 10
    v_alignbit_b32 v67, v123, v67, 10
    v_xor_b32 v67, 0x80200800, v67
    s_mov_b32 s36, 10485760
    buffer_store_dwordx4 v[64:67], v3, s[20:23], s36 offen sc1
    s_waitcnt lgkmcnt(1)
    v_lshlrev_b32 v99, 22, v124
    v_lshrrev_b32 v124, 16, v124
    v_alignbit_b32 v99, v124, v99, 10
    v_alignbit_b32 v99, v125, v99, 10
    v_xor_b32 v99, 0x80200800, v99
    s_mov_b32 s36, 11534336
    buffer_store_dwordx4 v[96:99], v3, s[20:23], s36 offen sc1
    s_waitcnt lgkmcnt(0)
    v_lshlrev_b32 v71, 22, v126
    v_lshrrev_b32 v126, 16, v126
    v_alignbit_b32 v71, v126, v71, 10
    v_alignbit_b32 v71, v127, v71, 10
    v_xor_b32 v71, 0x80200800, v71
    s_mov_b32 s36, 12582912
    buffer_store_dwordx4 v[68:71], v3, s[20:23], s36 offen sc1
    v_and_b32 v6, 0x34800000, v5
    v_cmp_ne_u32 vcc, 0, v6
    s_lshl_b32 s35, s39, 4
    s_add_u32 s35, s35, 160328
    v_mov_b32 v10, s35
    s_cmp_lg_u64 vcc, 0
    s_cselect_b32 s36, 1, s55
    v_mov_b32 v11, s36
    ds_write_b32 v10, v11
    s_waitcnt lgkmcnt(0)
    s_barrier
    s_cmp_lg_u32 s39, 0
    s_cbranch_scc1 L_p1_end
    v_and_b32 v6, 15, v0
    v_lshlrev_b32 v6, 4, v6
    v_add_u32 v6, 160320, v6
    ds_read_b128 v[8:11], v6
    s_waitcnt lgkmcnt(0)
    s_nop 1
    v_max_u32_dpp v8, v8, v8 row_shr:1 row_mask:0xf bank_mask:0xf bound_ctrl:0
    s_nop 1
    v_max_u32_dpp v8, v8, v8 row_shr:2 row_mask:0xf bank_mask:0xf bound_ctrl:0
    s_nop 1
    v_max_u32_dpp v8, v8, v8 row_shr:4 row_mask:0xf bank_mask:0xf bound_ctrl:0
    s_nop 1
    v_max_u32_dpp v8, v8, v8 row_shr:8 row_mask:0xf bank_mask:0xf bound_ctrl:0
    s_nop 1
    v_add_f32_dpp v9, v9, v9 row_shr:1 row_mask:0xf bank_mask:0xf bound_ctrl:0
    s_nop 1
    v_add_f32_dpp v9, v9, v9 row_shr:2 row_mask:0xf bank_mask:0xf bound_ctrl:0
    s_nop 1
    v_add_f32_dpp v9, v9, v9 row_shr:4 row_mask:0xf bank_mask:0xf bound_ctrl:0
    s_nop 1
    v_add_f32_dpp v9, v9, v9 row_shr:8 row_mask:0xf bank_mask:0xf bound_ctrl:0
    s_nop 1
    v_or_b32_dpp v10, v10, v10 row_shr:1 row_mask:0xf bank_mask:0xf bound_ctrl:0
    s_nop 1
    v_or_b32_dpp v10, v10, v10 row_shr:2 row_mask:0xf bank_mask:0xf bound_ctrl:0
    s_nop 1
    v_or_b32_dpp v10, v10, v10 row_shr:4 row_mask:0xf bank_mask:0xf bound_ctrl:0
    s_nop 1
    v_or_b32_dpp v10, v10, v10 row_shr:8 row_mask:0xf bank_mask:0xf bound_ctrl:0
    s_lshl_b32 s35, s2, 3
    s_mov_b32 s26, 8540160
    s_add_u32 s35, s35, 8519680
    v_mov_b32 v6, 0
    v_lshl_or_b32 v8, v10, 16, v8
    s_mov_b64 exec, 0x8000
    buffer_store_dwordx2 v[8:9], v6, s[24:27], s35 offen
    s_lshl_b32 s35, s2, 8
    s_add_u32 s35, s35, 8523776
    buffer_store_dword v6, v6, s[24:27], s35 offen
L_p1_end:
    s_endpgm
.globl p2_kernel
.p2align 8
.type p2_kernel,@function
p2_kernel:
    s_cmp_ge_u32 s2, 256
    s_cbranch_scc1 L_p2_end
    s_load_dwordx2 s[4:5], s[0:1], 104
    s_load_dwordx2 s[100:101], s[0:1], 24
    s_load_dwordx2 s[30:31], s[0:1], 40
    s_load_dwordx4 s[32:35], s[0:1], 56
    s_load_dwordx4 s[36:39], s[0:1], 72
    s_and_b32 s14, s2, 7
    s_lshr_b32 s49, s2, 3
    s_and_b32 s3, s14, 1
    s_lshl_b32 s3, s3, 5
    s_add_u32 s3, s3, s49
    s_lshr_b32 s12, s14, 1
    v_lshrrev_b32 v108, 6, v0
    v_lshlrev_b32 v1, 4, v0
    v_and_b32 v109, 63, v0
    v_readfirstlane_b32 s13, v108
    v_lshlrev_b32 v111, 4, v109
    v_lshrrev_b32 v110, 2, v109
    v_mul_u32_u24 v110, 8256, v110
    v_add_u32 v110, v110, v111
    s_mul_i32 s14, s12, 65
    s_add_u32 s14, s14, s3
    s_lshl_b32 s14, s14, 5
    s_mul_i32 s15, s13, 532480
    s_add_u32 s14, s14, s15
    s_add_u32 s25, s14, 0
    s_mul_i32 s22, s12, 1280000
    s_mov_b32 s2, 0
    s_waitcnt lgkmcnt(0)
    s_mov_b32 s6, 655360000
    s_mov_b32 s7, 0x00020000
    s_add_u32 s8, s4, 8540160
    s_addc_u32 s9, s5, 0
    s_add_u32 s10, s22, 1280000
    s_mov_b32 s11, 0x00020000
    s_add_u32 s15, s25, 0
    buffer_load_dwordx4 v[28:31], v110, s[4:7], s15 offen
    s_add_u32 s15, s25, 133120
    buffer_load_dwordx4 v[32:35], v110, s[4:7], s15 offen
    s_add_u32 s15, s25, 266240
    buffer_load_dwordx4 v[36:39], v110, s[4:7], s15 offen
    s_add_u32 s15, s25, 399360
    buffer_load_dwordx4 v[40:43], v110, s[4:7], s15 offen
    s_load_dwordx4 s[40:43], s[30:31], 0
    s_load_dwordx16 s[52:67], s[32:33], 0
    s_load_dwordx16 s[68:83], s[34:35], 0
    s_load_dwordx8 s[84:91], s[36:37], 0
    s_load_dwordx8 s[92:99], s[38:39], 0
    v_mov_b32 v52, 0x100
    s_cmp_lg_u32 s13, 0
    s_cbranch_scc1 L_p2_noann
    s_lshl_b32 s14, s3, 8
    s_add_u32 s14, s14, 8523776
    s_mov_b64 exec, 1
    buffer_atomic_add v52, off, s[4:7], s14
    s_mov_b64 exec, -1
L_p2_noann:
    s_add_u32 s14, s22, 0
    buffer_load_dwordx4 v[88:91], v1, s[8:11], s14 offen
    s_add_u32 s14, s22, 16384
    buffer_load_dwordx4 v[92:95], v1, s[8:11], s14 offen
    s_add_u32 s14, s22, 32768
    buffer_load_dwordx4 v[96:99], v1, s[8:11], s14 offen
    s_add_u32 s14, s22, 49152
    buffer_load_dwordx4 v[100:103], v1, s[8:11], s14 offen
    s_add_u32 s14, s22, 65536
    buffer_load_dwordx4 v[104:107], v1, s[8:11], s14 offen
    s_mov_b32 s15, 8519680
    buffer_load_dwordx4 v[80:83], v111, s[4:7], s15 offen offset:0
    buffer_load_dwordx4 v[84:87], v111, s[4:7], s15 offen offset:1024
    v_lshlrev_b32 v2, 10, v109
    v_mov_b32 v50, 21845
    v_add_u32 v3, 80000, v1
    v_add_u32 v124, 145536, v1
    v_add_u32 v113, 65536, v1
    v_mov_b32 v112, 0x7f000000
    v_cmp_gt_u32 vcc, 904, v0
    s_mul_i32 s19, s13, 240
    s_add_u32 s19, s19, 160000
    v_cndmask_b32 v124, v112, v124, vcc
    v_cndmask_b32 v113, v112, v113, vcc
    v_lshl_add_u32 v6, v109, 2, s19
    v_lshl_add_u32 v126, v109, 1, s19
    v_cmp_gt_u32 vcc, 10, v109
    s_lshl_b32 s27, s13, 16
    s_mov_b32 s23, 1024
    v_cndmask_b32 v6, v112, v6, vcc
    s_add_u32 s44, s4, 9437184
    s_addc_u32 s45, s5, 1048576
    s_mov_b32 s46, 14024704
    s_mov_b32 s47, 0x00020000
    s_mov_b32 s17, 0x05040100
    s_mov_b32 s18, 80000
    s_and_b32 s50, s3, 1
    s_lshl_b32 s50, s50, 18
    s_sub_u32 s50, 4294836224, s50
    s_mov_b32 s20, 3221209088
    s_mov_b32 s21, 3221209087
    v_mov_b32 v4, 0
    v_mov_b32 v5, 0
    v_mov_b32 v114, 0xff00
    ds_write_b32 v6, v5 offset:160
    ds_write_b16 v126, v114 offset:2
    v_mov_b32 v44, 1073758208
    v_mov_b32 v45, 1073758208
    v_mov_b32 v46, 1073758208
    v_mov_b32 v47, 1073758208
    v_mov_b32 v48, 1073758208
    v_mov_b32 v49, 1073758208
    ds_write_b128 v113, v[44:47]
    v_lshrrev_b32 v115, 4, v109
    v_mul_u32_u24 v115, 15360, v115
    v_lshl_add_u32 v115, v109, 6, v115
    v_lshl_add_u32 v115, v108, 10, v115
    s_waitcnt lgkmcnt(0)
    v_mov_b32 v53, s40
    v_mov_b32 v54, s41
    v_mov_b32 v56, s42
    v_mov_b32 v57, s43
    s_mov_b32 s40, 20987904
    s_mov_b32 s41, 21031594
    s_pack_ll_b32_b16 s14, s52, s54
    s_pack_hh_b32_b16 s15, s52, s54
    s_pack_ll_b32_b16 s54, s53, s55
    s_pack_hh_b32_b16 s55, s53, s55
    s_mov_b32 s52, s14
    s_mov_b32 s53, s15
    s_pack_ll_b32_b16 s14, s56, s58
    s_pack_hh_b32_b16 s15, s56, s58
    s_pack_ll_b32_b16 s58, s57, s59
    s_pack_hh_b32_b16 s59, s57, s59
    s_mov_b32 s56, s14
    s_mov_b32 s57, s15
    s_pack_ll_b32_b16 s14, s60, s62
    s_pack_hh_b32_b16 s15, s60, s62
    s_pack_ll_b32_b16 s62, s61, s63
    s_pack_hh_b32_b16 s63, s61, s63
    s_mov_b32 s60, s14
    s_mov_b32 s61, s15
    s_pack_ll_b32_b16 s14, s64, s66
    s_pack_hh_b32_b16 s15, s64, s66
    s_pack_ll_b32_b16 s66, s65, s67
    s_pack_hh_b32_b16 s67, s65, s67
    s_mov_b32 s64, s14
    s_mov_b32 s65, s15
    s_pack_ll_b32_b16 s14, s68, s70
    s_pack_hh_b32_b16 s15, s68, s70
    s_pack_ll_b32_b16 s70, s69, s71
    s_pack_hh_b32_b16 s71, s69, s71
    s_mov_b32 s68, s14
    s_mov_b32 s69, s15
    s_pack_ll_b32_b16 s14, s72, s74
    s_pack_hh_b32_b16 s15, s72, s74
    s_pack_ll_b32_b16 s74, s73, s75
    s_pack_hh_b32_b16 s75, s73, s75
    s_mov_b32 s72, s14
    s_mov_b32 s73, s15
    s_pack_ll_b32_b16 s14, s76, s78
    s_pack_hh_b32_b16 s15, s76, s78
    s_pack_ll_b32_b16 s78, s77, s79
    s_pack_hh_b32_b16 s79, s77, s79
    s_mov_b32 s76, s14
    s_mov_b32 s77, s15
    s_pack_ll_b32_b16 s14, s80, s82
    s_pack_hh_b32_b16 s15, s80, s82
    s_pack_ll_b32_b16 s82, s81, s83
    s_pack_hh_b32_b16 s83, s81, s83
    s_mov_b32 s80, s14
    s_mov_b32 s81, s15
    s_waitcnt vmcnt(10)
    ds_write_b128 v1, v[28:31] offset:0
    s_waitcnt vmcnt(9)
    ds_write_b128 v1, v[32:35] offset:16384
    s_waitcnt vmcnt(8)
    ds_write_b128 v1, v[36:39] offset:32768
    s_waitcnt vmcnt(7)
    ds_write_b128 v1, v[40:43] offset:49152
    ds_read_b128 v[28:31], v115 offset:0
    ds_read_b128 v[36:39], v115 offset:32
    ds_read_b128 v[32:35], v115 offset:16
    ds_read_b128 v[40:43], v115 offset:48
    ds_write_b128 v1, v[44:47] offset:0
    ds_write_b128 v1, v[44:47] offset:16384
    ds_write_b128 v1, v[44:47] offset:32768
    ds_write_b128 v1, v[44:47] offset:49152
    s_waitcnt lgkmcnt(6)
    v_mad_u32_u16 v108, v28, v50, s40 op_sel:[0,0,0,0]
    v_mad_u32_u16 v109, v36, v50, s41 op_sel:[0,0,0,0]
    v_sub_u32_sdwa v110, v109, v108 dst_sel:DWORD dst_unused:UNUSED_PAD src0_sel:WORD_1 src1_sel:WORD_1
    s_nop 1
    v_add_u32_dpp v110, v110, v110 row_shr:1 row_mask:0xf bank_mask:0xf bound_ctrl:0
    s_nop 1
    v_add_u32_dpp v110, v110, v110 row_shr:2 row_mask:0xf bank_mask:0xf bound_ctrl:0
    s_nop 1
    v_add_u32_dpp v110, v110, v110 row_shr:4 row_mask:0xf bank_mask:0xf bound_ctrl:0
    s_nop 1
    v_add_u32_dpp v110, v110, v110 row_shr:8 row_mask:0xf bank_mask:0xf bound_ctrl:0
    s_nop 1
    v_add_u32_dpp v110, v110, v110 row_bcast:15 row_mask:0xa bank_mask:0xf
    s_nop 1
    v_add_u32_dpp v110, v110, v110 row_bcast:31 row_mask:0xc bank_mask:0xf
    v_sub_u32_sdwa v109, v109, v110 dst_sel:DWORD dst_unused:UNUSED_PAD src0_sel:WORD_1 src1_sel:DWORD
    v_readlane_b32 s29, v110, 63
    v_add_u32 v110, -1, v110
    ds_write_b16 v126, v109
    v_lshlrev_b32_e64 v111, v110, 1
    v_lshrrev_b32 v110, 5, v110
    v_lshl_add_u32 v110, v110, 2, s19
    s_cmp_gt_u32 s29, 320
    s_cselect_b32 s2, 1, s2
    s_cselect_b64 exec, 0, -1
    ds_or_b32 v110, v111 offset:160
    s_mov_b64 exec, -1
    ds_wrxchg_rtn_b32 v7, v6, v5 offset:160
    s_waitcnt lgkmcnt(0)
    v_readlane_b32 s30, v7, 0
    v_readlane_b32 s31, v7, 1
    v_readlane_b32 s32, v7, 2
    v_readlane_b32 s33, v7, 3
    v_readlane_b32 s34, v7, 4
    v_readlane_b32 s35, v7, 5
    v_readlane_b32 s36, v7, 6
    v_readlane_b32 s37, v7, 7
    s_mov_b32 s25, s19
    s_mov_b32 s26, s27
    s_mov_b32 s51, s28
    s_mov_b32 s28, s29
    v_mbcnt_lo_u32_b32 v8, s30, 0
    v_mbcnt_hi_u32_b32 v8, s31, v8
    s_bcnt1_i32_b64 s14, s[30:31]
    v_lshl_add_u32 v9, v8, 1, s25
    ds_read_u16 v9, v9
    s_add_u32 s30, s26, 0
    s_lshl1_add_u32 s25, s14, s25
    s_lshl_b32 s14, s14, 10
    s_add_u32 s26, s26, s14
    v_mbcnt_lo_u32_b32 v12, s32, 0
    v_mbcnt_hi_u32_b32 v12, s33, v12
    s_bcnt1_i32_b64 s14, s[32:33]
    v_lshl_add_u32 v13, v12, 1, s25
    ds_read_u16 v13, v13
    s_add_u32 s32, s26, 1048576
    s_lshl1_add_u32 s25, s14, s25
    s_lshl_b32 s14, s14, 10
    s_add_u32 s26, s26, s14
    v_mbcnt_lo_u32_b32 v16, s34, 0
    v_mbcnt_hi_u32_b32 v16, s35, v16
    s_bcnt1_i32_b64 s14, s[34:35]
    v_lshl_add_u32 v17, v16, 1, s25
    ds_read_u16 v17, v17
    s_add_u32 s34, s26, 2097152
    s_lshl1_add_u32 s25, s14, s25
    s_lshl_b32 s14, s14, 10
    s_add_u32 s26, s26, s14
    v_mbcnt_lo_u32_b32 v20, s36, 0
    v_mbcnt_hi_u32_b32 v20, s37, v20
    s_bcnt1_i32_b64 s14, s[36:37]
    v_lshl_add_u32 v21, v20, 1, s25
    ds_read_u16 v21, v21
    s_add_u32 s36, s26, 3145728
    s_lshl1_add_u32 s25, s14, s25
    s_lshl_b32 s14, s14, 10
    s_add_u32 s26, s26, s14
    s_waitcnt lgkmcnt(3)
    v_mad_u32_u16 v9, v9, s23, v2
    v_pk_lshrrev_b16 v9, 10, v9 op_sel_hi:[1,1]
    v_lshl_add_u32 v8, v8, 6, v9
    buffer_load_dwordx4 v[8:11], v8, s[44:47], s30 idxen
    s_waitcnt lgkmcnt(2)
    v_mad_u32_u16 v13, v13, s23, v2
    v_pk_lshrrev_b16 v13, 10, v13 op_sel_hi:[1,1]
    v_lshl_add_u32 v12, v12, 6, v13
    buffer_load_dwordx4 v[12:15], v12, s[44:47], s32 idxen
    s_waitcnt lgkmcnt(1)
    v_mad_u32_u16 v17, v17, s23, v2
    v_pk_lshrrev_b16 v17, 10, v17 op_sel_hi:[1,1]
    v_lshl_add_u32 v16, v16, 6, v17
    buffer_load_dwordx4 v[16:19], v16, s[44:47], s34 idxen
    s_waitcnt lgkmcnt(0)
    v_mad_u32_u16 v21, v21, s23, v2
    v_pk_lshrrev_b16 v21, 10, v21 op_sel_hi:[1,1]
    v_lshl_add_u32 v20, v20, 6, v21
    buffer_load_dwordx4 v[20:23], v20, s[44:47], s36 idxen
    s_cmp_le_u32 s28, 256
    s_cbranch_scc1 L_p2_kernel_noopt_1
    v_readlane_b32 s38, v7, 8
    v_readlane_b32 s39, v7, 9
    s_nop 1
    v_mbcnt_lo_u32_b32 v120, s38, 0
    v_mbcnt_hi_u32_b32 v120, s39, v120
    s_bcnt1_i32_b64 s14, s[38:39]
    v_lshl_add_u32 v121, v120, 1, s25
    ds_read_u16 v121, v121
    s_add_u32 s38, s26, 4194304
    s_lshl1_add_u32 s25, s14, s25
    s_lshl_b32 s14, s14, 10
    s_add_u32 s26, s26, s14
    s_waitcnt lgkmcnt(0)
    v_mad_u32_u16 v121, v121, s23, v2
    v_pk_lshrrev_b16 v121, 10, v121 op_sel_hi:[1,1]
    v_lshl_add_u32 v120, v120, 6, v121
    buffer_load_dwordx4 v[24:27], v120, s[44:47], s38 idxen
L_p2_kernel_noopt_1:
    s_waitcnt vmcnt(6)
    ds_write_b128 v3, v[88:91] offset:0
    ds_write_b128 v3, v[92:95] offset:16384
    ds_write_b128 v3, v[96:99] offset:32768
    ds_write_b128 v3, v[100:103] offset:49152
    ds_write_b128 v124, v[104:107] offset:0
    s_waitcnt vmcnt(4)
    v_max3_u32 v64, v80, v82, v84
    v_add_f32 v65, v81, v83
    v_add_f32 v66, v85, v87
    v_max_u32 v64, v64, v86
    v_add_f32 v65, v65, v66
    v_cmp_lt_u32 vcc, 0xffff, v64
    s_nop 1
    v_max_u32_dpp v64, v64, v64 row_shr:1 row_mask:0xf bank_mask:0xf bound_ctrl:0
    s_nop 1
    v_max_u32_dpp v64, v64, v64 row_shr:2 row_mask:0xf bank_mask:0xf bound_ctrl:0
    s_nop 1
    v_max_u32_dpp v64, v64, v64 row_shr:4 row_mask:0xf bank_mask:0xf bound_ctrl:0
    s_nop 1
    v_max_u32_dpp v64, v64, v64 row_shr:8 row_mask:0xf bank_mask:0xf bound_ctrl:0
    s_nop 1
    v_max_u32_dpp v64, v64, v64 row_bcast:15 row_mask:0xa bank_mask:0xf
    s_nop 1
    v_max_u32_dpp v64, v64, v64 row_bcast:31 row_mask:0xc bank_mask:0xf
    s_nop 1
    v_add_f32_dpp v65, v65, v65 row_shr:1 row_mask:0xf bank_mask:0xf bound_ctrl:0
    s_nop 1
    v_add_f32_dpp v65, v65, v65 row_shr:2 row_mask:0xf bank_mask:0xf bound_ctrl:0
    s_nop 1
    v_add_f32_dpp v65, v65, v65 row_shr:4 row_mask:0xf bank_mask:0xf bound_ctrl:0
    s_nop 1
    v_add_f32_dpp v65, v65, v65 row_shr:8 row_mask:0xf bank_mask:0xf bound_ctrl:0
    s_nop 1
    v_add_f32_dpp v65, v65, v65 row_bcast:15 row_mask:0xa bank_mask:0xf
    s_nop 1
    v_add_f32_dpp v65, v65, v65 row_bcast:31 row_mask:0xc bank_mask:0xf
    s_cmp_lg_u64 vcc, 0
    s_cselect_b32 s2, 1, s2
    v_lshlrev_b32 v64, 16, v64
    v_mul_f32 v66, 936490775, v65
    v_mul_f32 v65, 928531664, v65
    v_cmp_nle_f32 vcc, v64, v66
    v_max_u32 v64, v64, v65
    s_nop 0
    v_readlane_b32 s14, v64, 63
    s_bitcmp1_b32 vcc_hi, 31
    s_cselect_b32 s2, 1, s2
    s_lshr_b32 s14, s14, 23
    s_add_u32 s14, s14, 1
    s_cmp_lt_u32 s14, 40
    s_cselect_b32 s2, 1, s2
    s_cmp_gt_u32 s14, 230
    s_cselect_b32 s2, 1, s2
    s_sub_u32 s48, s14, 14
    s_lshl_b32 s48, s48, 23
    s_add_u32 s16, s48, 272646144
    s_or_b32 s48, s48, 16416
    s_sub_u32 s14, s14, 40
    s_cmp_gt_u32 s14, 190
    s_cselect_b32 s48, 0, s48
    s_waitcnt lgkmcnt(0)
    s_barrier
    s_add_u32 s14, s22, 80000
    buffer_load_dwordx4 v[88:91], v1, s[8:11], s14 offen
    s_add_u32 s14, s22, 96384
    buffer_load_dwordx4 v[92:95], v1, s[8:11], s14 offen
    v_mad_u32_u16 v108, v28, v50, s40 op_sel:[1,0,0,0]
    v_mad_u32_u16 v109, v36, v50, s41 op_sel:[1,0,0,0]
    v_sub_u32_sdwa v110, v109, v108 dst_sel:DWORD dst_unused:UNUSED_PAD src0_sel:WORD_1 src1_sel:WORD_1
    s_nop 1
    v_add_u32_dpp v110, v110, v110 row_shr:1 row_mask:0xf bank_mask:0xf bound_ctrl:0
    s_nop 1
    v_add_u32_dpp v110, v110, v110 row_shr:2 row_mask:0xf bank_mask:0xf bound_ctrl:0
    s_nop 1
    v_add_u32_dpp v110, v110, v110 row_shr:4 row_mask:0xf bank_mask:0xf bound_ctrl:0
    s_nop 1
    v_add_u32_dpp v110, v110, v110 row_shr:8 row_mask:0xf bank_mask:0xf bound_ctrl:0
    s_nop 1
    v_add_u32_dpp v110, v110, v110 row_bcast:15 row_mask:0xa bank_mask:0xf
    s_nop 1
    v_add_u32_dpp v110, v110, v110 row_bcast:31 row_mask:0xc bank_mask:0xf
    v_sub_u32_sdwa v109, v109, v110 dst_sel:DWORD dst_unused:UNUSED_PAD src0_sel:WORD_1 src1_sel:DWORD
    v_readlane_b32 s29, v110, 63
    v_add_u32 v110, -1, v110
    ds_write_b16 v126, v109
    v_lshlrev_b32_e64 v111, v110, 1
    v_lshrrev_b32 v110, 5, v110
    v_lshl_add_u32 v110, v110, 2, s19
    s_cmp_gt_u32 s29, 320
    s_cselect_b32 s2, 1, s2
    s_cselect_b64 exec, 0, -1
    ds_or_b32 v110, v111 offset:160
    s_mov_b64 exec, -1
    ds_wrxchg_rtn_b32 v7, v6, v5 offset:160
    s_mov_b32 s24, 0
L_p2_loop:
    s_add_u32 s22, s22, 80000
    s_lshl_b32 s14, s13, 4
    s_or_b32 s14, s14, s24
    s_cmp_lg_u32 s14, 5
    s_cbranch_scc1 L_p2_nost
    v_mov_b32 v52, 0
    s_lshl_b32 s14, s3, 8
    s_add_u32 s14, s14, 8523776
    s_mov_b64 exec, 1
    buffer_atomic_add v52, off, s[4:7], s14 sc0
    s_mov_b64 exec, -1
L_p2_nost:
    s_waitcnt vmcnt(5)
    v_mad_u32_u16 v64, v8, 8, s18
    v_mad_u32_u16 v66, v9, 8, s18
    v_mad_u32_u16 v68, v10, 8, s18
    ds_read_b64 v[64:65], v64
    ds_read_b64 v[66:67], v66
    ds_read_b64 v[68:69], v68
    s_add_u32 s14, s22, 32768
    buffer_load_dwordx4 v[96:99], v1, s[8:11], s14 offen
    s_waitcnt vmcnt(5)
    v_mad_u32_u16 v70, v12, 8, s18
    v_mad_u32_u16 v72, v13, 8, s18
    v_mad_u32_u16 v74, v14, 8, s18
    ds_read_b64 v[70:71], v70
    ds_read_b64 v[72:73], v72
    ds_read_b64 v[74:75], v74
    s_add_u32 s14, s22, 49152
    buffer_load_dwordx4 v[100:103], v1, s[8:11], s14 offen
    s_waitcnt lgkmcnt(6)
    v_readlane_b32 s30, v7, 0
    v_readlane_b32 s31, v7, 1
    v_readlane_b32 s32, v7, 2
    v_readlane_b32 s33, v7, 3
    v_readlane_b32 s34, v7, 4
    v_readlane_b32 s35, v7, 5
    v_readlane_b32 s36, v7, 6
    v_readlane_b32 s37, v7, 7
    s_mov_b32 s25, s19
    s_mov_b32 s26, s27
    s_mov_b32 s51, s28
    s_mov_b32 s28, s29
    v_mbcnt_lo_u32_b32 v118, s30, 0
    v_mbcnt_hi_u32_b32 v118, s31, v118
    s_bcnt1_i32_b64 s14, s[30:31]
    v_lshl_add_u32 v119, v118, 1, s25
    ds_read_u16 v119, v119
    s_add_u32 s30, s26, 0
    s_lshl1_add_u32 s25, s14, s25
    s_lshl_b32 s14, s14, 10
    s_add_u32 s26, s26, s14
    v_bfe_i32 v108, v11, 2, 10
    v_bfe_i32 v109, v11, 12, 10
    v_ashrrev_i32 v110, 22, v11
    v_cvt_f32_i32 v108, v108
    v_cvt_f32_i32 v109, v109
    v_cvt_f32_i32 v110, v110
    v_mad_u32_u16 v8, v8, 8, s50 op_sel:[1,0,0,0]
    v_mad_u32_u16 v9, v9, 8, s50 op_sel:[1,0,0,0]
    v_mad_u32_u16 v10, v10, 8, s50 op_sel:[1,0,0,0]
    s_waitcnt lgkmcnt(4)
    v_lshlrev_b32 v112, 16, v64
    v_and_b32 v113, 0xffff0000, v64
    v_lshlrev_b32 v64, 16, v65
    v_and_b32 v65, 0xffff0000, v65
    v_lshlrev_b32 v114, 16, v66
    v_and_b32 v115, 0xffff0000, v66
    v_lshlrev_b32 v66, 16, v67
    v_and_b32 v67, 0xffff0000, v67
    v_lshlrev_b32 v116, 16, v68
    v_and_b32 v117, 0xffff0000, v68
    v_lshlrev_b32 v68, 16, v69
    v_and_b32 v69, 0xffff0000, v69
    v_pk_fma_f32 v[112:113], v[112:113], v[108:109], s[16:17] op_sel:[0,0,0] op_sel_hi:[1,0,0]
    v_pk_fma_f32 v[64:65], v[64:65], v[108:109], s[16:17] op_sel:[0,0,0] op_sel_hi:[1,0,0]
    v_pk_fma_f32 v[114:115], v[114:115], v[108:109], s[16:17] op_sel:[0,1,0] op_sel_hi:[1,1,0]
    v_pk_fma_f32 v[66:67], v[66:67], v[108:109], s[16:17] op_sel:[0,1,0] op_sel_hi:[1,1,0]
    v_pk_fma_f32 v[116:117], v[116:117], v[110:111], s[16:17] op_sel:[0,0,0] op_sel_hi:[1,0,0]
    v_pk_fma_f32 v[68:69], v[68:69], v[110:111], s[16:17] op_sel:[0,0,0] op_sel_hi:[1,0,0]
    v_perm_b32 v65, v65, v64, s17
    v_perm_b32 v64, v113, v112, s17
    v_perm_b32 v67, v67, v66, s17
    v_perm_b32 v66, v115, v114, s17
    v_perm_b32 v69, v69, v68, s17
    v_perm_b32 v68, v117, v116, s17
    v_lshl_add_u64 v[64:65], v[64:65], 0, s[20:21]
    v_lshl_add_u64 v[66:67], v[66:67], 0, s[20:21]
    v_lshl_add_u64 v[68:69], v[68:69], 0, s[20:21]
    v_or3_b32 v4, v44, v45, v4
    v_or3_b32 v4, v46, v47, v4
    v_or3_b32 v4, v48, v49, v4
    ds_add_rtn_u64 v[44:45], v8, v[64:65]
    ds_add_rtn_u64 v[46:47], v9, v[66:67]
    ds_add_rtn_u64 v[48:49], v10, v[68:69]
    s_waitcnt lgkmcnt(3)
    v_mad_u32_u16 v119, v119, s23, v2
    v_pk_lshrrev_b16 v119, 10, v119 op_sel_hi:[1,1]
    v_lshl_add_u32 v118, v118, 6, v119
    buffer_load_dwordx4 v[8:11], v118, s[44:47], s30 idxen
    s_add_u32 s14, s22, 65536
    buffer_load_dwordx4 v[104:107], v1, s[8:11], s14 offen
    s_waitcnt vmcnt(7)
    v_mad_u32_u16 v76, v16, 8, s18
    v_mad_u32_u16 v78, v17, 8, s18
    v_mad_u32_u16 v80, v18, 8, s18
    ds_read_b64 v[76:77], v76
    ds_read_b64 v[78:79], v78
    ds_read_b64 v[80:81], v80
    s_waitcnt vmcnt(6)
    v_mad_u32_u16 v82, v20, 8, s18
    v_mad_u32_u16 v84, v21, 8, s18
    v_mad_u32_u16 v86, v22, 8, s18
    ds_read_b64 v[82:83], v82
    ds_read_b64 v[84:85], v84
    ds_read_b64 v[86:87], v86
    v_mbcnt_lo_u32_b32 v118, s32, 0
    v_mbcnt_hi_u32_b32 v118, s33, v118
    s_bcnt1_i32_b64 s14, s[32:33]
    v_lshl_add_u32 v119, v118, 1, s25
    ds_read_u16 v119, v119
    s_add_u32 s32, s26, 1048576
    s_lshl1_add_u32 s25, s14, s25
    s_lshl_b32 s14, s14, 10
    s_add_u32 s26, s26, s14
    v_bfe_i32 v108, v15, 2, 10
    v_bfe_i32 v109, v15, 12, 10
    v_ashrrev_i32 v110, 22, v15
    v_cvt_f32_i32 v108, v108
    v_cvt_f32_i32 v109, v109
    v_cvt_f32_i32 v110, v110
    v_mad_u32_u16 v12, v12, 8, s50 op_sel:[1,0,0,0]
    v_mad_u32_u16 v13, v13, 8, s50 op_sel:[1,0,0,0]
    v_mad_u32_u16 v14, v14, 8, s50 op_sel:[1,0,0,0]
    v_lshlrev_b32 v112, 16, v70
    v_and_b32 v113, 0xffff0000, v70
    v_lshlrev_b32 v70, 16, v71
    v_and_b32 v71, 0xffff0000, v71
    v_lshlrev_b32 v114, 16, v72
    v_and_b32 v115, 0xffff0000, v72
    v_lshlrev_b32 v72, 16, v73
    v_and_b32 v73, 0xffff0000, v73
    v_lshlrev_b32 v116, 16, v74
    v_and_b32 v117, 0xffff0000, v74
    v_lshlrev_b32 v74, 16, v75
    v_and_b32 v75, 0xffff0000, v75
    v_pk_fma_f32 v[112:113], v[112:113], v[108:109], s[16:17] op_sel:[0,0,0] op_sel_hi:[1,0,0]
    v_pk_fma_f32 v[70:71], v[70:71], v[108:109], s[16:17] op_sel:[0,0,0] op_sel_hi:[1,0,0]
    v_pk_fma_f32 v[114:115], v[114:115], v[108:109], s[16:17] op_sel:[0,1,0] op_sel_hi:[1,1,0]
    v_pk_fma_f32 v[72:73], v[72:73], v[108:109], s[16:17] op_sel:[0,1,0] op_sel_hi:[1,1,0]
    v_pk_fma_f32 v[116:117], v[116:117], v[110:111], s[16:17] op_sel:[0,0,0] op_sel_hi:[1,0,0]
    v_pk_fma_f32 v[74:75], v[74:75], v[110:111], s[16:17] op_sel:[0,0,0] op_sel_hi:[1,0,0]
    v_perm_b32 v71, v71, v70, s17
    v_perm_b32 v70, v113, v112, s17
    v_perm_b32 v73, v73, v72, s17
    v_perm_b32 v72, v115, v114, s17
    v_perm_b32 v75, v75, v74, s17
    v_perm_b32 v74, v117, v116, s17
    v_lshl_add_u64 v[70:71], v[70:71], 0, s[20:21]
    v_lshl_add_u64 v[72:73], v[72:73], 0, s[20:21]
    v_lshl_add_u64 v[74:75], v[74:75], 0, s[20:21]
    s_waitcnt lgkmcnt(7)
    v_or3_b32 v4, v44, v45, v4
    v_or3_b32 v4, v46, v47, v4
    v_or3_b32 v4, v48, v49, v4
    ds_add_rtn_u64 v[44:45], v12, v[70:71]
    ds_add_rtn_u64 v[46:47], v13, v[72:73]
    ds_add_rtn_u64 v[48:49], v14, v[74:75]
    s_waitcnt lgkmcnt(3)
    v_mad_u32_u16 v119, v119, s23, v2
    v_pk_lshrrev_b16 v119, 10, v119 op_sel_hi:[1,1]
    v_lshl_add_u32 v118, v118, 6, v119
    buffer_load_dwordx4 v[12:15], v118, s[44:47], s32 idxen
    s_cmp_le_u32 s51, 256
    s_cbranch_scc1 L_p2_kernel_noopt2_2
    v_mad_u32_u16 v64, v24, 8, s18
    v_mad_u32_u16 v66, v25, 8, s18
    v_mad_u32_u16 v68, v26, 8, s18
    ds_read_b64 v[64:65], v64
    ds_read_b64 v[66:67], v66
    ds_read_b64 v[68:69], v68
    v_bfe_i32 v108, v27, 2, 10
    v_bfe_i32 v109, v27, 12, 10
    v_ashrrev_i32 v110, 22, v27
    v_cvt_f32_i32 v108, v108
    v_cvt_f32_i32 v109, v109
    v_cvt_f32_i32 v110, v110
    v_mad_u32_u16 v24, v24, 8, s50 op_sel:[1,0,0,0]
    v_mad_u32_u16 v25, v25, 8, s50 op_sel:[1,0,0,0]
    v_mad_u32_u16 v26, v26, 8, s50 op_sel:[1,0,0,0]
    s_waitcnt lgkmcnt(0)
    v_lshlrev_b32 v112, 16, v64
    v_and_b32 v113, 0xffff0000, v64
    v_lshlrev_b32 v64, 16, v65
    v_and_b32 v65, 0xffff0000, v65
    v_lshlrev_b32 v114, 16, v66
    v_and_b32 v115, 0xffff0000, v66
    v_lshlrev_b32 v66, 16, v67
    v_and_b32 v67, 0xffff0000, v67
    v_lshlrev_b32 v116, 16, v68
    v_and_b32 v117, 0xffff0000, v68
    v_lshlrev_b32 v68, 16, v69
    v_and_b32 v69, 0xffff0000, v69
    v_pk_fma_f32 v[112:113], v[112:113], v[108:109], s[16:17] op_sel:[0,0,0] op_sel_hi:[1,0,0]
    v_pk_fma_f32 v[64:65], v[64:65], v[108:109], s[16:17] op_sel:[0,0,0] op_sel_hi:[1,0,0]
    v_pk_fma_f32 v[114:115], v[114:115], v[108:109], s[16:17] op_sel:[0,1,0] op_sel_hi:[1,1,0]
    v_pk_fma_f32 v[66:67], v[66:67], v[108:109], s[16:17] op_sel:[0,1,0] op_sel_hi:[1,1,0]
    v_pk_fma_f32 v[116:117], v[116:117], v[110:111], s[16:17] op_sel:[0,0,0] op_sel_hi:[1,0,0]
    v_pk_fma_f32 v[68:69], v[68:69], v[110:111], s[16:17] op_sel:[0,0,0] op_sel_hi:[1,0,0]
    v_perm_b32 v65, v65, v64, s17
    v_perm_b32 v64, v113, v112, s17
    v_perm_b32 v67, v67, v66, s17
    v_perm_b32 v66, v115, v114, s17
    v_perm_b32 v69, v69, v68, s17
    v_perm_b32 v68, v117, v116, s17
    v_lshl_add_u64 v[64:65], v[64:65], 0, s[20:21]
    v_lshl_add_u64 v[66:67], v[66:67], 0, s[20:21]
    v_lshl_add_u64 v[68:69], v[68:69], 0, s[20:21]
    v_or3_b32 v4, v44, v45, v4
    v_or3_b32 v4, v46, v47, v4
    v_or3_b32 v4, v48, v49, v4
    ds_add_rtn_u64 v[44:45], v24, v[64:65]
    ds_add_rtn_u64 v[46:47], v25, v[66:67]
    ds_add_rtn_u64 v[48:49], v26, v[68:69]
L_p2_kernel_noopt2_2:
    s_barrier
    s_waitcnt vmcnt(1)
    ds_write_b128 v3, v[88:91] offset:0
    ds_write_b128 v3, v[92:95] offset:16384
    ds_write_b128 v3, v[96:99] offset:32768
    ds_write_b128 v3, v[100:103] offset:49152
    ds_write_b128 v124, v[104:107] offset:0
    v_mbcnt_lo_u32_b32 v118, s34, 0
    v_mbcnt_hi_u32_b32 v118, s35, v118
    s_bcnt1_i32_b64 s14, s[34:35]
    v_lshl_add_u32 v119, v118, 1, s25
    ds_read_u16 v119, v119
    s_add_u32 s34, s26, 2097152
    s_lshl1_add_u32 s25, s14, s25
    s_lshl_b32 s14, s14, 10
    s_add_u32 s26, s26, s14
    v_bfe_i32 v108, v19, 2, 10
    v_bfe_i32 v109, v19, 12, 10
    v_ashrrev_i32 v110, 22, v19
    v_cvt_f32_i32 v108, v108
    v_cvt_f32_i32 v109, v109
    v_cvt_f32_i32 v110, v110
    v_mad_u32_u16 v16, v16, 8, s50 op_sel:[1,0,0,0]
    v_mad_u32_u16 v17, v17, 8, s50 op_sel:[1,0,0,0]
    v_mad_u32_u16 v18, v18, 8, s50 op_sel:[1,0,0,0]
    v_lshlrev_b32 v112, 16, v76
    v_and_b32 v113, 0xffff0000, v76
    v_lshlrev_b32 v76, 16, v77
    v_and_b32 v77, 0xffff0000, v77
    v_lshlrev_b32 v114, 16, v78
    v_and_b32 v115, 0xffff0000, v78
    v_lshlrev_b32 v78, 16, v79
    v_and_b32 v79, 0xffff0000, v79
    v_lshlrev_b32 v116, 16, v80
    v_and_b32 v117, 0xffff0000, v80
    v_lshlrev_b32 v80, 16, v81
    v_and_b32 v81, 0xffff0000, v81
    v_pk_fma_f32 v[112:113], v[112:113], v[108:109], s[16:17] op_sel:[0,0,0] op_sel_hi:[1,0,0]
    v_pk_fma_f32 v[76:77], v[76:77], v[108:109], s[16:17] op_sel:[0,0,0] op_sel_hi:[1,0,0]
    v_pk_fma_f32 v[114:115], v[114:115], v[108:109], s[16:17] op_sel:[0,1,0] op_sel_hi:[1,1,0]
    v_pk_fma_f32 v[78:79], v[78:79], v[108:109], s[16:17] op_sel:[0,1,0] op_sel_hi:[1,1,0]
    v_pk_fma_f32 v[116:117], v[116:117], v[110:111], s[16:17] op_sel:[0,0,0] op_sel_hi:[1,0,0]
    v_pk_fma_f32 v[80:81], v[80:81], v[110:111], s[16:17] op_sel:[0,0,0] op_sel_hi:[1,0,0]
    v_perm_b32 v77, v77, v76, s17
    v_perm_b32 v76, v113, v112, s17
    v_perm_b32 v79, v79, v78, s17
    v_perm_b32 v78, v115, v114, s17
    v_perm_b32 v81, v81, v80, s17
    v_perm_b32 v80, v117, v116, s17
    v_lshl_add_u64 v[76:77], v[76:77], 0, s[20:21]
    v_lshl_add_u64 v[78:79], v[78:79], 0, s[20:21]
    v_lshl_add_u64 v[80:81], v[80:81], 0, s[20:21]
    s_waitcnt lgkmcnt(6)
    v_or3_b32 v4, v44, v45, v4
    v_or3_b32 v4, v46, v47, v4
    v_or3_b32 v4, v48, v49, v4
    ds_add_rtn_u64 v[44:45], v16, v[76:77]
    ds_add_rtn_u64 v[46:47], v17, v[78:79]
    ds_add_rtn_u64 v[48:49], v18, v[80:81]
    s_waitcnt lgkmcnt(3)
    v_mad_u32_u16 v119, v119, s23, v2
    v_pk_lshrrev_b16 v119, 10, v119 op_sel_hi:[1,1]
    v_lshl_add_u32 v118, v118, 6, v119
    buffer_load_dwordx4 v[16:19], v118, s[44:47], s34 idxen
    v_mbcnt_lo_u32_b32 v118, s36, 0
    v_mbcnt_hi_u32_b32 v118, s37, v118
    s_bcnt1_i32_b64 s14, s[36:37]
    v_lshl_add_u32 v119, v118, 1, s25
    ds_read_u16 v119, v119
    s_add_u32 s36, s26, 3145728
    s_lshl1_add_u32 s25, s14, s25
    s_lshl_b32 s14, s14, 10
    s_add_u32 s26, s26, s14
    v_bfe_i32 v108, v23, 2, 10
    v_bfe_i32 v109, v23, 12, 10
    v_ashrrev_i32 v110, 22, v23
    v_cvt_f32_i32 v108, v108
    v_cvt_f32_i32 v109, v109
    v_cvt_f32_i32 v110, v110
    v_mad_u32_u16 v20, v20, 8, s50 op_sel:[1,0,0,0]
    v_mad_u32_u16 v21, v21, 8, s50 op_sel:[1,0,0,0]
    v_mad_u32_u16 v22, v22, 8, s50 op_sel:[1,0,0,0]
    v_lshlrev_b32 v112, 16, v82
    v_and_b32 v113, 0xffff0000, v82
    v_lshlrev_b32 v82, 16, v83
    v_and_b32 v83, 0xffff0000, v83
    v_lshlrev_b32 v114, 16, v84
    v_and_b32 v115, 0xffff0000, v84
    v_lshlrev_b32 v84, 16, v85
    v_and_b32 v85, 0xffff0000, v85
    v_lshlrev_b32 v116, 16, v86
    v_and_b32 v117, 0xffff0000, v86
    v_lshlrev_b32 v86, 16, v87
    v_and_b32 v87, 0xffff0000, v87
    v_pk_fma_f32 v[112:113], v[112:113], v[108:109], s[16:17] op_sel:[0,0,0] op_sel_hi:[1,0,0]
    v_pk_fma_f32 v[82:83], v[82:83], v[108:109], s[16:17] op_sel:[0,0,0] op_sel_hi:[1,0,0]
    v_pk_fma_f32 v[114:115], v[114:115], v[108:109], s[16:17] op_sel:[0,1,0] op_sel_hi:[1,1,0]
    v_pk_fma_f32 v[84:85], v[84:85], v[108:109], s[16:17] op_sel:[0,1,0] op_sel_hi:[1,1,0]
    v_pk_fma_f32 v[116:117], v[116:117], v[110:111], s[16:17] op_sel:[0,0,0] op_sel_hi:[1,0,0]
    v_pk_fma_f32 v[86:87], v[86:87], v[110:111], s[16:17] op_sel:[0,0,0] op_sel_hi:[1,0,0]
    v_perm_b32 v83, v83, v82, s17
    v_perm_b32 v82, v113, v112, s17
    v_perm_b32 v85, v85, v84, s17
    v_perm_b32 v84, v115, v114, s17
    v_perm_b32 v87, v87, v86, s17
    v_perm_b32 v86, v117, v116, s17
    v_lshl_add_u64 v[82:83], v[82:83], 0, s[20:21]
    v_lshl_add_u64 v[84:85], v[84:85], 0, s[20:21]
    v_lshl_add_u64 v[86:87], v[86:87], 0, s[20:21]
    s_waitcnt lgkmcnt(1)
    v_or3_b32 v4, v44, v45, v4
    v_or3_b32 v4, v46, v47, v4
    v_or3_b32 v4, v48, v49, v4
    ds_add_rtn_u64 v[44:45], v20, v[82:83]
    ds_add_rtn_u64 v[46:47], v21, v[84:85]
    ds_add_rtn_u64 v[48:49], v22, v[86:87]
    s_waitcnt lgkmcnt(3)
    v_mad_u32_u16 v119, v119, s23, v2
    v_pk_lshrrev_b16 v119, 10, v119 op_sel_hi:[1,1]
    v_lshl_add_u32 v118, v118, 6, v119
    buffer_load_dwordx4 v[20:23], v118, s[44:47], s36 idxen
    s_cmp_le_u32 s28, 256
    s_cbranch_scc1 L_p2_kernel_noopt_3
    v_readlane_b32 s38, v7, 8
    v_readlane_b32 s39, v7, 9
    s_nop 1
    v_mbcnt_lo_u32_b32 v120, s38, 0
    v_mbcnt_hi_u32_b32 v120, s39, v120
    s_bcnt1_i32_b64 s14, s[38:39]
    v_lshl_add_u32 v121, v120, 1, s25
    ds_read_u16 v121, v121
    s_add_u32 s38, s26, 4194304
    s_lshl1_add_u32 s25, s14, s25
    s_lshl_b32 s14, s14, 10
    s_add_u32 s26, s26, s14
    s_waitcnt lgkmcnt(0)
    v_mad_u32_u16 v121, v121, s23, v2
    v_pk_lshrrev_b16 v121, 10, v121 op_sel_hi:[1,1]
    v_lshl_add_u32 v120, v120, 6, v121
    buffer_load_dwordx4 v[24:27], v120, s[44:47], s38 idxen
L_p2_kernel_noopt_3:
    v_pk_mov_b32 v[28:29], v[28:29], v[30:31] op_sel:[1,0]
    v_pk_mov_b32 v[30:31], v[30:31], v[32:33] op_sel:[1,0]
    v_pk_mov_b32 v[32:33], v[32:33], v[34:35] op_sel:[1,0]
    v_pk_mov_b32 v[34:35], v[34:35], v[4:5] op_sel:[1,1]
    v_pk_mov_b32 v[36:37], v[36:37], v[38:39] op_sel:[1,0]
    v_pk_mov_b32 v[38:39], v[38:39], v[40:41] op_sel:[1,0]
    v_pk_mov_b32 v[40:41], v[40:41], v[42:43] op_sel:[1,0]
    v_pk_mov_b32 v[42:43], v[42:43], v[4:5] op_sel:[1,1]
    v_mad_u32_u16 v108, v28, v50, s40 op_sel:[0,0,0,0]
    v_mad_u32_u16 v109, v36, v50, s41 op_sel:[0,0,0,0]
    v_sub_u32_sdwa v110, v109, v108 dst_sel:DWORD dst_unused:UNUSED_PAD src0_sel:WORD_1 src1_sel:WORD_1
    s_nop 1
    v_add_u32_dpp v110, v110, v110 row_shr:1 row_mask:0xf bank_mask:0xf bound_ctrl:0
    s_nop 1
    v_add_u32_dpp v110, v110, v110 row_shr:2 row_mask:0xf bank_mask:0xf bound_ctrl:0
    s_nop 1
    v_add_u32_dpp v110, v110, v110 row_shr:4 row_mask:0xf bank_mask:0xf bound_ctrl:0
    s_nop 1
    v_add_u32_dpp v110, v110, v110 row_shr:8 row_mask:0xf bank_mask:0xf bound_ctrl:0
    s_nop 1
    v_add_u32_dpp v110, v110, v110 row_bcast:15 row_mask:0xa bank_mask:0xf
    s_nop 1
    v_add_u32_dpp v110, v110, v110 row_bcast:31 row_mask:0xc bank_mask:0xf
    v_sub_u32_sdwa v109, v109, v110 dst_sel:DWORD dst_unused:UNUSED_PAD src0_sel:WORD_1 src1_sel:DWORD
    v_readlane_b32 s29, v110, 63
    v_add_u32 v110, -1, v110
    ds_write_b16 v126, v109
    v_lshlrev_b32_e64 v111, v110, 1
    v_lshrrev_b32 v110, 5, v110
    v_lshl_add_u32 v110, v110, 2, s19
    s_cmp_gt_u32 s29, 320
    s_cselect_b32 s2, 1, s2
    s_cselect_b64 exec, 0, -1
    ds_or_b32 v110, v111 offset:160
    s_mov_b64 exec, -1
    ds_wrxchg_rtn_b32 v7, v6, v5 offset:160
    s_add_u32 s14, s22, 80000
    buffer_load_dwordx4 v[88:91], v1, s[8:11], s14 offen
    s_add_u32 s14, s22, 96384
    buffer_load_dwordx4 v[92:95], v1, s[8:11], s14 offen
    s_barrier
    s_add_u32 s22, s22, 80000
    s_cmp_lg_u32 s24, 7
    s_cbranch_scc1 L_p2_nodist
    s_mov_b32 s46, 0
    s_lshl2_add_u32 s14, s3, s12
    s_mul_i32 s14, s14, 5000
    s_add_u32 s15, s14, 4096
    v_min_u32 v61, 225, v0
    v_lshl_add_u32 v60, v0, 2, s14
    v_lshl_add_u32 v61, v61, 2, s15
    global_load_dword v60, v60, s[100:101] nt
    global_load_dword v61, v61, s[100:101] nt
L_p2_nodist:
    v_mad_u32_u16 v64, v8, 8, s18
    v_mad_u32_u16 v66, v9, 8, s18
    v_mad_u32_u16 v68, v10, 8, s18
    ds_read_b64 v[64:65], v64
    ds_read_b64 v[66:67], v66
    ds_read_b64 v[68:69], v68
    s_add_u32 s14, s22, 32768
    buffer_load_dwordx4 v[96:99], v1, s[8:11], s14 offen
    s_waitcnt vmcnt(5)
    v_mad_u32_u16 v70, v12, 8, s18
    v_mad_u32_u16 v72, v13, 8, s18
    v_mad_u32_u16 v74, v14, 8, s18
    ds_read_b64 v[70:71], v70
    ds_read_b64 v[72:73], v72
    ds_read_b64 v[74:75], v74
    s_add_u32 s14, s22, 49152
    buffer_load_dwordx4 v[100:103], v1, s[8:11], s14 offen
    s_waitcnt lgkmcnt(6)
    v_readlane_b32 s30, v7, 0
    v_readlane_b32 s31, v7, 1
    v_readlane_b32 s32, v7, 2
    v_readlane_b32 s33, v7, 3
    v_readlane_b32 s34, v7, 4
    v_readlane_b32 s35, v7, 5
    v_readlane_b32 s36, v7, 6
    v_readlane_b32 s37, v7, 7
    s_mov_b32 s25, s19
    s_mov_b32 s26, s27
    s_mov_b32 s51, s28
    s_mov_b32 s28, s29
    v_mbcnt_lo_u32_b32 v118, s30, 0
    v_mbcnt_hi_u32_b32 v118, s31, v118
    s_bcnt1_i32_b64 s14, s[30:31]
    v_lshl_add_u32 v119, v118, 1, s25
    ds_read_u16 v119, v119
    s_add_u32 s30, s26, 0
    s_lshl1_add_u32 s25, s14, s25
    s_lshl_b32 s14, s14, 10
    s_add_u32 s26, s26, s14
    v_bfe_i32 v108, v11, 2, 10
    v_bfe_i32 v109, v11, 12, 10
    v_ashrrev_i32 v110, 22, v11
    v_cvt_f32_i32 v108, v108
    v_cvt_f32_i32 v109, v109
    v_cvt_f32_i32 v110, v110
    v_mad_u32_u16 v8, v8, 8, s50 op_sel:[1,0,0,0]
    v_mad_u32_u16 v9, v9, 8, s50 op_sel:[1,0,0,0]
    v_mad_u32_u16 v10, v10, 8, s50 op_sel:[1,0,0,0]
    s_waitcnt lgkmcnt(4)
    v_lshlrev_b32 v112, 16, v64
    v_and_b32 v113, 0xffff0000, v64
    v_lshlrev_b32 v64, 16, v65
    v_and_b32 v65, 0xffff0000, v65
    v_lshlrev_b32 v114, 16, v66
    v_and_b32 v115, 0xffff0000, v66
    v_lshlrev_b32 v66, 16, v67
    v_and_b32 v67, 0xffff0000, v67
    v_lshlrev_b32 v116, 16, v68
    v_and_b32 v117, 0xffff0000, v68
    v_lshlrev_b32 v68, 16, v69
    v_and_b32 v69, 0xffff0000, v69
    v_pk_fma_f32 v[112:113], v[112:113], v[108:109], s[16:17] op_sel:[0,0,0] op_sel_hi:[1,0,0]
    v_pk_fma_f32 v[64:65], v[64:65], v[108:109], s[16:17] op_sel:[0,0,0] op_sel_hi:[1,0,0]
    v_pk_fma_f32 v[114:115], v[114:115], v[108:109], s[16:17] op_sel:[0,1,0] op_sel_hi:[1,1,0]
    v_pk_fma_f32 v[66:67], v[66:67], v[108:109], s[16:17] op_sel:[0,1,0] op_sel_hi:[1,1,0]
    v_pk_fma_f32 v[116:117], v[116:117], v[110:111], s[16:17] op_sel:[0,0,0] op_sel_hi:[1,0,0]
    v_pk_fma_f32 v[68:69], v[68:69], v[110:111], s[16:17] op_sel:[0,0,0] op_sel_hi:[1,0,0]
    v_perm_b32 v65, v65, v64, s17
    v_perm_b32 v64, v113, v112, s17
    v_perm_b32 v67, v67, v66, s17
    v_perm_b32 v66, v115, v114, s17
    v_perm_b32 v69, v69, v68, s17
    v_perm_b32 v68, v117, v116, s17
    v_lshl_add_u64 v[64:65], v[64:65], 0, s[20:21]
    v_lshl_add_u64 v[66:67], v[66:67], 0, s[20:21]
    v_lshl_add_u64 v[68:69], v[68:69], 0, s[20:21]
    v_or3_b32 v4, v44, v45, v4
    v_or3_b32 v4, v46, v47, v4
    v_or3_b32 v4, v48, v49, v4
    ds_add_rtn_u64 v[44:45], v8, v[64:65]
    ds_add_rtn_u64 v[46:47], v9, v[66:67]
    ds_add_rtn_u64 v[48:49], v10, v[68:69]
    s_waitcnt lgkmcnt(3)
    v_mad_u32_u16 v119, v119, s23, v2
    v_pk_lshrrev_b16 v119, 10, v119 op_sel_hi:[1,1]
    v_lshl_add_u32 v118, v118, 6, v119
    buffer_load_dwordx4 v[8:11], v118, s[44:47], s30 idxen
    s_add_u32 s14, s22, 65536
    buffer_load_dwordx4 v[104:107], v1, s[8:11], s14 offen
    s_waitcnt vmcnt(7)
    v_mad_u32_u16 v76, v16, 8, s18
    v_mad_u32_u16 v78, v17, 8, s18
    v_mad_u32_u16 v80, v18, 8, s18
    ds_read_b64 v[76:77], v76
    ds_read_b64 v[78:79], v78
    ds_read_b64 v[80:81], v80
    s_waitcnt vmcnt(6)
    v_mad_u32_u16 v82, v20, 8, s18
    v_mad_u32_u16 v84, v21, 8, s18
    v_mad_u32_u16 v86, v22, 8, s18
    ds_read_b64 v[82:83], v82
    ds_read_b64 v[84:85], v84
    ds_read_b64 v[86:87], v86
    v_mbcnt_lo_u32_b32 v118, s32, 0
    v_mbcnt_hi_u32_b32 v118, s33, v118
    s_bcnt1_i32_b64 s14, s[32:33]
    v_lshl_add_u32 v119, v118, 1, s25
    ds_read_u16 v119, v119
    s_add_u32 s32, s26, 1048576
    s_lshl1_add_u32 s25, s14, s25
    s_lshl_b32 s14, s14, 10
    s_add_u32 s26, s26, s14
    v_bfe_i32 v108, v15, 2, 10
    v_bfe_i32 v109, v15, 12, 10
    v_ashrrev_i32 v110, 22, v15
    v_cvt_f32_i32 v108, v108
    v_cvt_f32_i32 v109, v109
    v_cvt_f32_i32 v110, v110
    v_mad_u32_u16 v12, v12, 8, s50 op_sel:[1,0,0,0]
    v_mad_u32_u16 v13, v13, 8, s50 op_sel:[1,0,0,0]
    v_mad_u32_u16 v14, v14, 8, s50 op_sel:[1,0,0,0]
    v_lshlrev_b32 v112, 16, v70
    v_and_b32 v113, 0xffff0000, v70
    v_lshlrev_b32 v70, 16, v71
    v_and_b32 v71, 0xffff0000, v71
    v_lshlrev_b32 v114, 16, v72
    v_and_b32 v115, 0xffff0000, v72
    v_lshlrev_b32 v72, 16, v73
    v_and_b32 v73, 0xffff0000, v73
    v_lshlrev_b32 v116, 16, v74
    v_and_b32 v117, 0xffff0000, v74
    v_lshlrev_b32 v74, 16, v75
    v_and_b32 v75, 0xffff0000, v75
    v_pk_fma_f32 v[112:113], v[112:113], v[108:109], s[16:17] op_sel:[0,0,0] op_sel_hi:[1,0,0]
    v_pk_fma_f32 v[70:71], v[70:71], v[108:109], s[16:17] op_sel:[0,0,0] op_sel_hi:[1,0,0]
    v_pk_fma_f32 v[114:115], v[114:115], v[108:109], s[16:17] op_sel:[0,1,0] op_sel_hi:[1,1,0]
    v_pk_fma_f32 v[72:73], v[72:73], v[108:109], s[16:17] op_sel:[0,1,0] op_sel_hi:[1,1,0]
    v_pk_fma_f32 v[116:117], v[116:117], v[110:111], s[16:17] op_sel:[0,0,0] op_sel_hi:[1,0,0]
    v_pk_fma_f32 v[74:75], v[74:75], v[110:111], s[16:17] op_sel:[0,0,0] op_sel_hi:[1,0,0]
    v_perm_b32 v71, v71, v70, s17
    v_perm_b32 v70, v113, v112, s17
    v_perm_b32 v73, v73, v72, s17
    v_perm_b32 v72, v115, v114, s17
    v_perm_b32 v75, v75, v74, s17
    v_perm_b32 v74, v117, v116, s17
    v_lshl_add_u64 v[70:71], v[70:71], 0, s[20:21]
    v_lshl_add_u64 v[72:73], v[72:73], 0, s[20:21]
    v_lshl_add_u64 v[74:75], v[74:75], 0, s[20:21]
    s_waitcnt lgkmcnt(7)
    v_or3_b32 v4, v44, v45, v4
    v_or3_b32 v4, v46, v47, v4
    v_or3_b32 v4, v48, v49, v4
    ds_add_rtn_u64 v[44:45], v12, v[70:71]
    ds_add_rtn_u64 v[46:47], v13, v[72:73]
    ds_add_rtn_u64 v[48:49], v14, v[74:75]
    s_waitcnt lgkmcnt(3)
    v_mad_u32_u16 v119, v119, s23, v2
    v_pk_lshrrev_b16 v119, 10, v119 op_sel_hi:[1,1]
    v_lshl_add_u32 v118, v118, 6, v119
    buffer_load_dwordx4 v[12:15], v118, s[44:47], s32 idxen
    s_cmp_le_u32 s51, 256
    s_cbranch_scc1 L_p2_kernel_noopt2_4
    v_mad_u32_u16 v64, v24, 8, s18
    v_mad_u32_u16 v66, v25, 8, s18
    v_mad_u32_u16 v68, v26, 8, s18
    ds_read_b64 v[64:65], v64
    ds_read_b64 v[66:67], v66
    ds_read_b64 v[68:69], v68
    v_bfe_i32 v108, v27, 2, 10
    v_bfe_i32 v109, v27, 12, 10
    v_ashrrev_i32 v110, 22, v27
    v_cvt_f32_i32 v108, v108
    v_cvt_f32_i32 v109, v109
    v_cvt_f32_i32 v110, v110
    v_mad_u32_u16 v24, v24, 8, s50 op_sel:[1,0,0,0]
    v_mad_u32_u16 v25, v25, 8, s50 op_sel:[1,0,0,0]
    v_mad_u32_u16 v26, v26, 8, s50 op_sel:[1,0,0,0]
    s_waitcnt lgkmcnt(0)
    v_lshlrev_b32 v112, 16, v64
    v_and_b32 v113, 0xffff0000, v64
    v_lshlrev_b32 v64, 16, v65
    v_and_b32 v65, 0xffff0000, v65
    v_lshlrev_b32 v114, 16, v66
    v_and_b32 v115, 0xffff0000, v66
    v_lshlrev_b32 v66, 16, v67
    v_and_b32 v67, 0xffff0000, v67
    v_lshlrev_b32 v116, 16, v68
    v_and_b32 v117, 0xffff0000, v68
    v_lshlrev_b32 v68, 16, v69
    v_and_b32 v69, 0xffff0000, v69
    v_pk_fma_f32 v[112:113], v[112:113], v[108:109], s[16:17] op_sel:[0,0,0] op_sel_hi:[1,0,0]
    v_pk_fma_f32 v[64:65], v[64:65], v[108:109], s[16:17] op_sel:[0,0,0] op_sel_hi:[1,0,0]
    v_pk_fma_f32 v[114:115], v[114:115], v[108:109], s[16:17] op_sel:[0,1,0] op_sel_hi:[1,1,0]
    v_pk_fma_f32 v[66:67], v[66:67], v[108:109], s[16:17] op_sel:[0,1,0] op_sel_hi:[1,1,0]
    v_pk_fma_f32 v[116:117], v[116:117], v[110:111], s[16:17] op_sel:[0,0,0] op_sel_hi:[1,0,0]
    v_pk_fma_f32 v[68:69], v[68:69], v[110:111], s[16:17] op_sel:[0,0,0] op_sel_hi:[1,0,0]
    v_perm_b32 v65, v65, v64, s17
    v_perm_b32 v64, v113, v112, s17
    v_perm_b32 v67, v67, v66, s17
    v_perm_b32 v66, v115, v114, s17
    v_perm_b32 v69, v69, v68, s17
    v_perm_b32 v68, v117, v116, s17
    v_lshl_add_u64 v[64:65], v[64:65], 0, s[20:21]
    v_lshl_add_u64 v[66:67], v[66:67], 0, s[20:21]
    v_lshl_add_u64 v[68:69], v[68:69], 0, s[20:21]
    v_or3_b32 v4, v44, v45, v4
    v_or3_b32 v4, v46, v47, v4
    v_or3_b32 v4, v48, v49, v4
    ds_add_rtn_u64 v[44:45], v24, v[64:65]
    ds_add_rtn_u64 v[46:47], v25, v[66:67]
    ds_add_rtn_u64 v[48:49], v26, v[68:69]
L_p2_kernel_noopt2_4:
    s_barrier
    s_waitcnt vmcnt(1)
    ds_write_b128 v3, v[88:91] offset:0
    ds_write_b128 v3, v[92:95] offset:16384
    ds_write_b128 v3, v[96:99] offset:32768
    ds_write_b128 v3, v[100:103] offset:49152
    ds_write_b128 v124, v[104:107] offset:0
    v_mbcnt_lo_u32_b32 v118, s34, 0
    v_mbcnt_hi_u32_b32 v118, s35, v118
    s_bcnt1_i32_b64 s14, s[34:35]
    v_lshl_add_u32 v119, v118, 1, s25
    ds_read_u16 v119, v119
    s_add_u32 s34, s26, 2097152
    s_lshl1_add_u32 s25, s14, s25
    s_lshl_b32 s14, s14, 10
    s_add_u32 s26, s26, s14
    v_bfe_i32 v108, v19, 2, 10
    v_bfe_i32 v109, v19, 12, 10
    v_ashrrev_i32 v110, 22, v19
    v_cvt_f32_i32 v108, v108
    v_cvt_f32_i32 v109, v109
    v_cvt_f32_i32 v110, v110
    v_mad_u32_u16 v16, v16, 8, s50 op_sel:[1,0,0,0]
    v_mad_u32_u16 v17, v17, 8, s50 op_sel:[1,0,0,0]
    v_mad_u32_u16 v18, v18, 8, s50 op_sel:[1,0,0,0]
    v_lshlrev_b32 v112, 16, v76
    v_and_b32 v113, 0xffff0000, v76
    v_lshlrev_b32 v76, 16, v77
    v_and_b32 v77, 0xffff0000, v77
    v_lshlrev_b32 v114, 16, v78
    v_and_b32 v115, 0xffff0000, v78
    v_lshlrev_b32 v78, 16, v79
    v_and_b32 v79, 0xffff0000, v79
    v_lshlrev_b32 v116, 16, v80
    v_and_b32 v117, 0xffff0000, v80
    v_lshlrev_b32 v80, 16, v81
    v_and_b32 v81, 0xffff0000, v81
    v_pk_fma_f32 v[112:113], v[112:113], v[108:109], s[16:17] op_sel:[0,0,0] op_sel_hi:[1,0,0]
    v_pk_fma_f32 v[76:77], v[76:77], v[108:109], s[16:17] op_sel:[0,0,0] op_sel_hi:[1,0,0]
    v_pk_fma_f32 v[114:115], v[114:115], v[108:109], s[16:17] op_sel:[0,1,0] op_sel_hi:[1,1,0]
    v_pk_fma_f32 v[78:79], v[78:79], v[108:109], s[16:17] op_sel:[0,1,0] op_sel_hi:[1,1,0]
    v_pk_fma_f32 v[116:117], v[116:117], v[110:111], s[16:17] op_sel:[0,0,0] op_sel_hi:[1,0,0]
    v_pk_fma_f32 v[80:81], v[80:81], v[110:111], s[16:17] op_sel:[0,0,0] op_sel_hi:[1,0,0]
    v_perm_b32 v77, v77, v76, s17
    v_perm_b32 v76, v113, v112, s17
    v_perm_b32 v79, v79, v78, s17
    v_perm_b32 v78, v115, v114, s17
    v_perm_b32 v81, v81, v80, s17
    v_perm_b32 v80, v117, v116, s17
    v_lshl_add_u64 v[76:77], v[76:77], 0, s[20:21]
    v_lshl_add_u64 v[78:79], v[78:79], 0, s[20:21]
    v_lshl_add_u64 v[80:81], v[80:81], 0, s[20:21]
    s_waitcnt lgkmcnt(6)
    v_or3_b32 v4, v44, v45, v4
    v_or3_b32 v4, v46, v47, v4
    v_or3_b32 v4, v48, v49, v4
    ds_add_rtn_u64 v[44:45], v16, v[76:77]
    ds_add_rtn_u64 v[46:47], v17, v[78:79]
    ds_add_rtn_u64 v[48:49], v18, v[80:81]
    s_waitcnt lgkmcnt(3)
    v_mad_u32_u16 v119, v119, s23, v2
    v_pk_lshrrev_b16 v119, 10, v119 op_sel_hi:[1,1]
    v_lshl_add_u32 v118, v118, 6, v119
    buffer_load_dwordx4 v[16:19], v118, s[44:47], s34 idxen
    v_mbcnt_lo_u32_b32 v118, s36, 0
    v_mbcnt_hi_u32_b32 v118, s37, v118
    s_bcnt1_i32_b64 s14, s[36:37]
    v_lshl_add_u32 v119, v118, 1, s25
    ds_read_u16 v119, v119
    s_add_u32 s36, s26, 3145728
    s_lshl1_add_u32 s25, s14, s25
    s_lshl_b32 s14, s14, 10
    s_add_u32 s26, s26, s14
    v_bfe_i32 v108, v23, 2, 10
    v_bfe_i32 v109, v23, 12, 10
    v_ashrrev_i32 v110, 22, v23
    v_cvt_f32_i32 v108, v108
    v_cvt_f32_i32 v109, v109
    v_cvt_f32_i32 v110, v110
    v_mad_u32_u16 v20, v20, 8, s50 op_sel:[1,0,0,0]
    v_mad_u32_u16 v21, v21, 8, s50 op_sel:[1,0,0,0]
    v_mad_u32_u16 v22, v22, 8, s50 op_sel:[1,0,0,0]
    v_lshlrev_b32 v112, 16, v82
    v_and_b32 v113, 0xffff0000, v82
    v_lshlrev_b32 v82, 16, v83
    v_and_b32 v83, 0xffff0000, v83
    v_lshlrev_b32 v114, 16, v84
    v_and_b32 v115, 0xffff0000, v84
    v_lshlrev_b32 v84, 16, v85
    v_and_b32 v85, 0xffff0000, v85
    v_lshlrev_b32 v116, 16, v86
    v_and_b32 v117, 0xffff0000, v86
    v_lshlrev_b32 v86, 16, v87
    v_and_b32 v87, 0xffff0000, v87
    v_pk_fma_f32 v[112:113], v[112:113], v[108:109], s[16:17] op_sel:[0,0,0] op_sel_hi:[1,0,0]
    v_pk_fma_f32 v[82:83], v[82:83], v[108:109], s[16:17] op_sel:[0,0,0] op_sel_hi:[1,0,0]
    v_pk_fma_f32 v[114:115], v[114:115], v[108:109], s[16:17] op_sel:[0,1,0] op_sel_hi:[1,1,0]
    v_pk_fma_f32 v[84:85], v[84:85], v[108:109], s[16:17] op_sel:[0,1,0] op_sel_hi:[1,1,0]
    v_pk_fma_f32 v[116:117], v[116:117], v[110:111], s[16:17] op_sel:[0,0,0] op_sel_hi:[1,0,0]
    v_pk_fma_f32 v[86:87], v[86:87], v[110:111], s[16:17] op_sel:[0,0,0] op_sel_hi:[1,0,0]
    v_perm_b32 v83, v83, v82, s17
    v_perm_b32 v82, v113, v112, s17
    v_perm_b32 v85, v85, v84, s17
    v_perm_b32 v84, v115, v114, s17
    v_perm_b32 v87, v87, v86, s17
    v_perm_b32 v86, v117, v116, s17
    v_lshl_add_u64 v[82:83], v[82:83], 0, s[20:21]
    v_lshl_add_u64 v[84:85], v[84:85], 0, s[20:21]
    v_lshl_add_u64 v[86:87], v[86:87], 0, s[20:21]
    s_waitcnt lgkmcnt(1)
    v_or3_b32 v4, v44, v45, v4
    v_or3_b32 v4, v46, v47, v4
    v_or3_b32 v4, v48, v49, v4
    ds_add_rtn_u64 v[44:45], v20, v[82:83]
    ds_add_rtn_u64 v[46:47], v21, v[84:85]
    ds_add_rtn_u64 v[48:49], v22, v[86:87]
    s_waitcnt lgkmcnt(3)
    v_mad_u32_u16 v119, v119, s23, v2
    v_pk_lshrrev_b16 v119, 10, v119 op_sel_hi:[1,1]
    v_lshl_add_u32 v118, v118, 6, v119
    buffer_load_dwordx4 v[20:23], v118, s[44:47], s36 idxen
    s_cmp_le_u32 s28, 256
    s_cbranch_scc1 L_p2_kernel_noopt_5
    v_readlane_b32 s38, v7, 8
    v_readlane_b32 s39, v7, 9
    s_nop 1
    v_mbcnt_lo_u32_b32 v120, s38, 0
    v_mbcnt_hi_u32_b32 v120, s39, v120
    s_bcnt1_i32_b64 s14, s[38:39]
    v_lshl_add_u32 v121, v120, 1, s25
    ds_read_u16 v121, v121
    s_add_u32 s38, s26, 4194304
    s_lshl1_add_u32 s25, s14, s25
    s_lshl_b32 s14, s14, 10
    s_add_u32 s26, s26, s14
    s_waitcnt lgkmcnt(0)
    v_mad_u32_u16 v121, v121, s23, v2
    v_pk_lshrrev_b16 v121, 10, v121 op_sel_hi:[1,1]
    v_lshl_add_u32 v120, v120, 6, v121
    buffer_load_dwordx4 v[24:27], v120, s[44:47], s38 idxen
L_p2_kernel_noopt_5:
    v_mad_u32_u16 v108, v28, v50, s40 op_sel:[1,0,0,0]
    v_mad_u32_u16 v109, v36, v50, s41 op_sel:[1,0,0,0]
    v_sub_u32_sdwa v110, v109, v108 dst_sel:DWORD dst_unused:UNUSED_PAD src0_sel:WORD_1 src1_sel:WORD_1
    s_nop 1
    v_add_u32_dpp v110, v110, v110 row_shr:1 row_mask:0xf bank_mask:0xf bound_ctrl:0
    s_nop 1
    v_add_u32_dpp v110, v110, v110 row_shr:2 row_mask:0xf bank_mask:0xf bound_ctrl:0
    s_nop 1
    v_add_u32_dpp v110, v110, v110 row_shr:4 row_mask:0xf bank_mask:0xf bound_ctrl:0
    s_nop 1
    v_add_u32_dpp v110, v110, v110 row_shr:8 row_mask:0xf bank_mask:0xf bound_ctrl:0
    s_nop 1
    v_add_u32_dpp v110, v110, v110 row_bcast:15 row_mask:0xa bank_mask:0xf
    s_nop 1
    v_add_u32_dpp v110, v110, v110 row_bcast:31 row_mask:0xc bank_mask:0xf
    v_sub_u32_sdwa v109, v109, v110 dst_sel:DWORD dst_unused:UNUSED_PAD src0_sel:WORD_1 src1_sel:DWORD
    v_readlane_b32 s29, v110, 63
    v_add_u32 v110, -1, v110
    ds_write_b16 v126, v109
    v_lshlrev_b32_e64 v111, v110, 1
    v_lshrrev_b32 v110, 5, v110
    v_lshl_add_u32 v110, v110, 2, s19
    s_cmp_gt_u32 s29, 320
    s_cselect_b32 s2, 1, s2
    s_cselect_b64 exec, 0, -1
    ds_or_b32 v110, v111 offset:160
    s_mov_b64 exec, -1
    ds_wrxchg_rtn_b32 v7, v6, v5 offset:160
    s_add_u32 s14, s22, 80000
    buffer_load_dwordx4 v[88:91], v1, s[8:11], s14 offen
    s_add_u32 s14, s22, 96384
    buffer_load_dwordx4 v[92:95], v1, s[8:11], s14 offen
    s_add_u32 s24, s24, 1
    s_cmp_lt_u32 s24, 8
    s_barrier
    s_cbranch_scc1 L_p2_loop
    s_waitcnt lgkmcnt(3)
    v_or3_b32 v4, v44, v45, v4
    v_or3_b32 v4, v46, v47, v4
    v_or3_b32 v4, v48, v49, v4
    s_mov_b32 s27, s19
    s_waitcnt vmcnt(0)
    v_mov_b32 v8, 160232
    s_cmp_lg_u32 s13, 0
    s_cselect_b64 exec, 0, 1
    ds_write_b32 v8, v52
    s_mov_b64 exec, -1
    v_subrev_u32 v6, 80000, v124
    s_mul_i32 s24, s12, 20000
    v_subrev_u32 v10, s24, v1
    v_mov_b32 v11, 0x7f000000
    s_waitcnt vmcnt(0) lgkmcnt(0)
    s_barrier
    s_cmp_lt_u32 s13, 4
    s_cbranch_scc1 L_p2_ga
    v_lshlrev_b32 v30, 16, v60
    v_and_b32 v31, 0xffff0000, v60
    v_lshlrev_b32 v36, 16, v53
    v_and_b32 v37, 0xffff0000, v53
    v_lshlrev_b32 v38, 16, v54
    v_and_b32 v39, 0xffff0000, v54
    v_lshlrev_b32 v40, 16, v56
    v_and_b32 v41, 0xffff0000, v56
    v_lshlrev_b32 v42, 16, v57
    v_and_b32 v43, 0xffff0000, v57
    v_pk_add_f32 v[14:15], v[30:31], v[36:37] op_sel:[0,0] op_sel_hi:[1,0] neg_lo:[0,1] neg_hi:[0,1]
    v_pk_add_f32 v[16:17], v[30:31], v[36:37] op_sel:[0,1] op_sel_hi:[1,1] neg_lo:[0,1] neg_hi:[0,1]
    v_pk_add_f32 v[18:19], v[30:31], v[38:39] op_sel:[0,0] op_sel_hi:[1,0] neg_lo:[0,1] neg_hi:[0,1]
    v_pk_add_f32 v[20:21], v[30:31], v[38:39] op_sel:[0,1] op_sel_hi:[1,1] neg_lo:[0,1] neg_hi:[0,1]
    v_pk_add_f32 v[22:23], v[30:31], v[40:41] op_sel:[0,0] op_sel_hi:[1,0] neg_lo:[0,1] neg_hi:[0,1]
    v_pk_add_f32 v[24:25], v[30:31], v[40:41] op_sel:[0,1] op_sel_hi:[1,1] neg_lo:[0,1] neg_hi:[0,1]
    v_pk_add_f32 v[26:27], v[30:31], v[42:43] op_sel:[0,0] op_sel_hi:[1,0] neg_lo:[0,1] neg_hi:[0,1]
    v_pk_add_f32 v[28:29], v[30:31], v[42:43] op_sel:[0,1] op_sel_hi:[1,1] neg_lo:[0,1] neg_hi:[0,1]
    v_cvt_pk_bf16_f32 v32, v14, v15
    v_lshlrev_b32 v14, 16, v32
    v_and_b32 v15, 0xffff0000, v32
    v_cvt_pk_bf16_f32 v32, v16, v17
    v_lshlrev_b32 v16, 16, v32
    v_and_b32 v17, 0xffff0000, v32
    v_cvt_pk_bf16_f32 v32, v18, v19
    v_lshlrev_b32 v18, 16, v32
    v_and_b32 v19, 0xffff0000, v32
    v_cvt_pk_bf16_f32 v32, v20, v21
    v_lshlrev_b32 v20, 16, v32
    v_and_b32 v21, 0xffff0000, v32
    v_cvt_pk_bf16_f32 v32, v22, v23
    v_lshlrev_b32 v22, 16, v32
    v_and_b32 v23, 0xffff0000, v32
    v_cvt_pk_bf16_f32 v32, v24, v25
    v_lshlrev_b32 v24, 16, v32
    v_and_b32 v25, 0xffff0000, v32
    v_cvt_pk_bf16_f32 v32, v26, v27
    v_lshlrev_b32 v26, 16, v32
    v_and_b32 v27, 0xffff0000, v32
    v_cvt_pk_bf16_f32 v32, v28, v29
    v_lshlrev_b32 v28, 16, v32
    v_and_b32 v29, 0xffff0000, v32
    v_pk_mul_f32 v[14:15], v[14:15], v[14:15]
    v_pk_mul_f32 v[16:17], v[16:17], v[16:17]
    v_pk_mul_f32 v[18:19], v[18:19], v[18:19]
    v_pk_mul_f32 v[20:21], v[20:21], v[20:21]
    v_pk_mul_f32 v[22:23], v[22:23], v[22:23]
    v_pk_mul_f32 v[24:25], v[24:25], v[24:25]
    v_pk_mul_f32 v[26:27], v[26:27], v[26:27]
    v_pk_mul_f32 v[28:29], v[28:29], v[28:29]
    v_cvt_pk_bf16_f32 v32, v14, v15
    v_lshlrev_b32 v14, 16, v32
    v_and_b32 v15, 0xffff0000, v32
    v_cvt_pk_bf16_f32 v32, v16, v17
    v_lshlrev_b32 v16, 16, v32
    v_and_b32 v17, 0xffff0000, v32
    v_cvt_pk_bf16_f32 v32, v18, v19
    v_lshlrev_b32 v18, 16, v32
    v_and_b32 v19, 0xffff0000, v32
    v_cvt_pk_bf16_f32 v32, v20, v21
    v_lshlrev_b32 v20, 16, v32
    v_and_b32 v21, 0xffff0000, v32
    v_cvt_pk_bf16_f32 v32, v22, v23
    v_lshlrev_b32 v22, 16, v32
    v_and_b32 v23, 0xffff0000, v32
    v_cvt_pk_bf16_f32 v32, v24, v25
    v_lshlrev_b32 v24, 16, v32
    v_and_b32 v25, 0xffff0000, v32
    v_cvt_pk_bf16_f32 v32, v26, v27
    v_lshlrev_b32 v26, 16, v32
    v_and_b32 v27, 0xffff0000, v32
    v_cvt_pk_bf16_f32 v32, v28, v29
    v_lshlrev_b32 v28, 16, v32
    v_and_b32 v29, 0xffff0000, v32
    v_mov_b32 v30, 1092616192
    v_mov_b32 v31, 0x3fb8aa3b
    v_pk_mul_f32 v[14:15], v[14:15], v[30:31] op_sel:[0,0] op_sel_hi:[1,0]
    v_pk_mul_f32 v[16:17], v[16:17], v[30:31] op_sel:[0,0] op_sel_hi:[1,0]
    v_pk_mul_f32 v[18:19], v[18:19], v[30:31] op_sel:[0,0] op_sel_hi:[1,0]
    v_pk_mul_f32 v[20:21], v[20:21], v[30:31] op_sel:[0,0] op_sel_hi:[1,0]
    v_pk_mul_f32 v[22:23], v[22:23], v[30:31] op_sel:[0,0] op_sel_hi:[1,0]
    v_pk_mul_f32 v[24:25], v[24:25], v[30:31] op_sel:[0,0] op_sel_hi:[1,0]
    v_pk_mul_f32 v[26:27], v[26:27], v[30:31] op_sel:[0,0] op_sel_hi:[1,0]
    v_pk_mul_f32 v[28:29], v[28:29], v[30:31] op_sel:[0,0] op_sel_hi:[1,0]
    v_cvt_pk_bf16_f32 v32, v14, v15
    v_lshlrev_b32 v14, 16, v32
    v_and_b32 v15, 0xffff0000, v32
    v_cvt_pk_bf16_f32 v32, v16, v17
    v_lshlrev_b32 v16, 16, v32
    v_and_b32 v17, 0xffff0000, v32
    v_cvt_pk_bf16_f32 v32, v18, v19
    v_lshlrev_b32 v18, 16, v32
    v_and_b32 v19, 0xffff0000, v32
    v_cvt_pk_bf16_f32 v32, v20, v21
    v_lshlrev_b32 v20, 16, v32
    v_and_b32 v21, 0xffff0000, v32
    v_cvt_pk_bf16_f32 v32, v22, v23
    v_lshlrev_b32 v22, 16, v32
    v_and_b32 v23, 0xffff0000, v32
    v_cvt_pk_bf16_f32 v32, v24, v25
    v_lshlrev_b32 v24, 16, v32
    v_and_b32 v25, 0xffff0000, v32
    v_cvt_pk_bf16_f32 v32, v26, v27
    v_lshlrev_b32 v26, 16, v32
    v_and_b32 v27, 0xffff0000, v32
    v_cvt_pk_bf16_f32 v32, v28, v29
    v_lshlrev_b32 v28, 16, v32
    v_and_b32 v29, 0xffff0000, v32
    v_pk_mul_f32 v[14:15], v[14:15], v[30:31] op_sel:[0,1] op_sel_hi:[1,1]
    v_pk_mul_f32 v[16:17], v[16:17], v[30:31] op_sel:[0,1] op_sel_hi:[1,1]
    v_pk_mul_f32 v[18:19], v[18:19], v[30:31] op_sel:[0,1] op_sel_hi:[1,1]
    v_pk_mul_f32 v[20:21], v[20:21], v[30:31] op_sel:[0,1] op_sel_hi:[1,1]
    v_pk_mul_f32 v[22:23], v[22:23], v[30:31] op_sel:[0,1] op_sel_hi:[1,1]
    v_pk_mul_f32 v[24:25], v[24:25], v[30:31] op_sel:[0,1] op_sel_hi:[1,1]
    v_pk_mul_f32 v[26:27], v[26:27], v[30:31] op_sel:[0,1] op_sel_hi:[1,1]
    v_pk_mul_f32 v[28:29], v[28:29], v[30:31] op_sel:[0,1] op_sel_hi:[1,1]
    v_exp_f32 v14, -v14
    v_exp_f32 v15, -v15
    v_exp_f32 v16, -v16
    v_exp_f32 v17, -v17
    v_exp_f32 v18, -v18
    v_exp_f32 v19, -v19
    v_exp_f32 v20, -v20
    v_exp_f32 v21, -v21
    v_exp_f32 v22, -v22
    v_exp_f32 v23, -v23
    v_exp_f32 v24, -v24
    v_exp_f32 v25, -v25
    v_exp_f32 v26, -v26
    v_exp_f32 v27, -v27
    v_exp_f32 v28, -v28
    v_exp_f32 v29, -v29
    v_cvt_pk_bf16_f32 v14, v14, v16
    v_cvt_pk_bf16_f32 v15, v15, v17
    v_cvt_pk_bf16_f32 v18, v18, v20
    v_cvt_pk_bf16_f32 v19, v19, v21
    v_cvt_pk_bf16_f32 v22, v22, v24
    v_cvt_pk_bf16_f32 v23, v23, v25
    v_cvt_pk_bf16_f32 v26, v26, v28
    v_cvt_pk_bf16_f32 v27, v27, v29
    v_dot2_f32_bf16 v72, v14, s68, 0
    v_dot2_f32_bf16 v73, v15, s68, 0
    v_dot2_f32_bf16 v74, v14, s69, 0
    v_dot2_f32_bf16 v75, v15, s69, 0
    v_dot2_f32_bf16 v76, v14, s70, 0
    v_dot2_f32_bf16 v77, v15, s70, 0
    v_dot2_f32_bf16 v78, v14, s71, 0
    v_dot2_f32_bf16 v79, v15, s71, 0
    v_dot2_f32_bf16 v80, v14, s52, 0
    v_dot2_f32_bf16 v81, v15, s52, 0
    v_dot2_f32_bf16 v82, v14, s53, 0
    v_dot2_f32_bf16 v83, v15, s53, 0
    v_dot2_f32_bf16 v84, v14, s54, 0
    v_dot2_f32_bf16 v85, v15, s54, 0
    v_dot2_f32_bf16 v86, v14, s55, 0
    v_dot2_f32_bf16 v87, v15, s55, 0
    v_dot2_f32_bf16 v72, v18, s72, v72
    v_dot2_f32_bf16 v73, v19, s72, v73
    v_dot2_f32_bf16 v74, v18, s73, v74
    v_dot2_f32_bf16 v75, v19, s73, v75
    v_dot2_f32_bf16 v76, v18, s74, v76
    v_dot2_f32_bf16 v77, v19, s74, v77
    v_dot2_f32_bf16 v78, v18, s75, v78
    v_dot2_f32_bf16 v79, v19, s75, v79
    v_dot2_f32_bf16 v80, v18, s56, v80
    v_dot2_f32_bf16 v81, v19, s56, v81
    v_dot2_f32_bf16 v82, v18, s57, v82
    v_dot2_f32_bf16 v83, v19, s57, v83
    v_dot2_f32_bf16 v84, v18, s58, v84
    v_dot2_f32_bf16 v85, v19, s58, v85
    v_dot2_f32_bf16 v86, v18, s59, v86
    v_dot2_f32_bf16 v87, v19, s59, v87
    v_dot2_f32_bf16 v72, v22, s76, v72
    v_dot2_f32_bf16 v73, v23, s76, v73
    v_dot2_f32_bf16 v74, v22, s77, v74
    v_dot2_f32_bf16 v75, v23, s77, v75
    v_dot2_f32_bf16 v76, v22, s78, v76
    v_dot2_f32_bf16 v77, v23, s78, v77
    v_dot2_f32_bf16 v78, v22, s79, v78
    v_dot2_f32_bf16 v79, v23, s79, v79
    v_dot2_f32_bf16 v80, v22, s60, v80
    v_dot2_f32_bf16 v81, v23, s60, v81
    v_dot2_f32_bf16 v82, v22, s61, v82
    v_dot2_f32_bf16 v83, v23, s61, v83
    v_dot2_f32_bf16 v84, v22, s62, v84
    v_dot2_f32_bf16 v85, v23, s62, v85
    v_dot2_f32_bf16 v86, v22, s63, v86
    v_dot2_f32_bf16 v87, v23, s63, v87
    v_dot2_f32_bf16 v72, v26, s80, v72
    v_dot2_f32_bf16 v73, v27, s80, v73
    v_dot2_f32_bf16 v74, v26, s81, v74
    v_dot2_f32_bf16 v75, v27, s81, v75
    v_dot2_f32_bf16 v76, v26, s82, v76
    v_dot2_f32_bf16 v77, v27, s82, v77
    v_dot2_f32_bf16 v78, v26, s83, v78
    v_dot2_f32_bf16 v79, v27, s83, v79
    v_dot2_f32_bf16 v80, v26, s64, v80
    v_dot2_f32_bf16 v81, v27, s64, v81
    v_dot2_f32_bf16 v82, v26, s65, v82
    v_dot2_f32_bf16 v83, v27, s65, v83
    v_dot2_f32_bf16 v84, v26, s66, v84
    v_dot2_f32_bf16 v85, v27, s66, v85
    v_dot2_f32_bf16 v86, v26, s67, v86
    v_dot2_f32_bf16 v87, v27, s67, v87
L_p2_ga:
    ds_read_b32 v9, v8
    ds_read_b128 v[88:91], v1 offset:0
    ds_read_b128 v[92:95], v1 offset:16384
    ds_read_b128 v[96:99], v1 offset:32768
    ds_read_b128 v[100:103], v1 offset:49152
    ds_read_b128 v[104:107], v6
    s_mul_i32 s14, s12, 5120000
    s_mul_i32 s15, s3, 80000
    s_add_u32 s25, s14, s15
    s_add_u32 s25, s25, 233832448
    s_waitcnt lgkmcnt(5)
    v_readfirstlane_b32 s21, v9
    s_nop 0
    s_bfe_u32 s21, s21, 524296
    s_cmp_lg_u32 s21, 4
    s_cselect_b32 s21, 1, 0
    s_cselect_b32 s24, 0, 20000
    v_cmp_le_u32 vcc, s24, v10
    v_add_u32 v10, 16384, v10
    s_add_u32 s14, s25, 0
    v_cndmask_b32 v12, v11, v1, vcc
    s_waitcnt lgkmcnt(4)
    buffer_store_dwordx4 v[88:91], v12, s[4:7], s14 offen sc1
    v_or3_b32 v4, v88, v89, v4
    v_or3_b32 v4, v90, v91, v4
    v_cmp_le_u32 vcc, s24, v10
    v_add_u32 v10, 16384, v10
    s_add_u32 s14, s25, 16384
    v_cndmask_b32 v12, v11, v1, vcc
    s_waitcnt lgkmcnt(3)
    buffer_store_dwordx4 v[92:95], v12, s[4:7], s14 offen sc1
    v_or3_b32 v4, v92, v93, v4
    v_or3_b32 v4, v94, v95, v4
    v_cmp_le_u32 vcc, s24, v10
    v_add_u32 v10, 16384, v10
    s_add_u32 s14, s25, 32768
    v_cndmask_b32 v12, v11, v1, vcc
    s_waitcnt lgkmcnt(2)
    buffer_store_dwordx4 v[96:99], v12, s[4:7], s14 offen sc1
    v_or3_b32 v4, v96, v97, v4
    v_or3_b32 v4, v98, v99, v4
    v_cmp_le_u32 vcc, s24, v10
    v_add_u32 v10, 16384, v10
    s_add_u32 s14, s25, 49152
    v_cndmask_b32 v12, v11, v1, vcc
    s_waitcnt lgkmcnt(1)
    buffer_store_dwordx4 v[100:103], v12, s[4:7], s14 offen sc1
    v_or3_b32 v4, v100, v101, v4
    v_or3_b32 v4, v102, v103, v4
    v_cmp_le_u32 vcc, s24, v10
    v_add_u32 v10, 16384, v10
    s_add_u32 s14, s25, 0
    v_cndmask_b32 v12, v11, v6, vcc
    s_waitcnt lgkmcnt(0)
    buffer_store_dwordx4 v[104:107], v12, s[4:7], s14 offen sc1
    v_or3_b32 v4, v104, v105, v4
    v_or3_b32 v4, v106, v107, v4
    s_load_dwordx2 s[16:17], s[0:1], 88
    s_cmp_ge_u32 s13, 4
    s_cbranch_scc1 L_p2_gb
    v_lshlrev_b32 v30, 16, v60
    v_and_b32 v31, 0xffff0000, v60
    v_lshlrev_b32 v36, 16, v53
    v_and_b32 v37, 0xffff0000, v53
    v_lshlrev_b32 v38, 16, v54
    v_and_b32 v39, 0xffff0000, v54
    v_lshlrev_b32 v40, 16, v56
    v_and_b32 v41, 0xffff0000, v56
    v_lshlrev_b32 v42, 16, v57
    v_and_b32 v43, 0xffff0000, v57
    v_pk_add_f32 v[14:15], v[30:31], v[36:37] op_sel:[0,0] op_sel_hi:[1,0] neg_lo:[0,1] neg_hi:[0,1]
    v_pk_add_f32 v[16:17], v[30:31], v[36:37] op_sel:[0,1] op_sel_hi:[1,1] neg_lo:[0,1] neg_hi:[0,1]
    v_pk_add_f32 v[18:19], v[30:31], v[38:39] op_sel:[0,0] op_sel_hi:[1,0] neg_lo:[0,1] neg_hi:[0,1]
    v_pk_add_f32 v[20:21], v[30:31], v[38:39] op_sel:[0,1] op_sel_hi:[1,1] neg_lo:[0,1] neg_hi:[0,1]
    v_pk_add_f32 v[22:23], v[30:31], v[40:41] op_sel:[0,0] op_sel_hi:[1,0] neg_lo:[0,1] neg_hi:[0,1]
    v_pk_add_f32 v[24:25], v[30:31], v[40:41] op_sel:[0,1] op_sel_hi:[1,1] neg_lo:[0,1] neg_hi:[0,1]
    v_pk_add_f32 v[26:27], v[30:31], v[42:43] op_sel:[0,0] op_sel_hi:[1,0] neg_lo:[0,1] neg_hi:[0,1]
    v_pk_add_f32 v[28:29], v[30:31], v[42:43] op_sel:[0,1] op_sel_hi:[1,1] neg_lo:[0,1] neg_hi:[0,1]
    v_cvt_pk_bf16_f32 v32, v14, v15
    v_lshlrev_b32 v14, 16, v32
    v_and_b32 v15, 0xffff0000, v32
    v_cvt_pk_bf16_f32 v32, v16, v17
    v_lshlrev_b32 v16, 16, v32
    v_and_b32 v17, 0xffff0000, v32
    v_cvt_pk_bf16_f32 v32, v18, v19
    v_lshlrev_b32 v18, 16, v32
    v_and_b32 v19, 0xffff0000, v32
    v_cvt_pk_bf16_f32 v32, v20, v21
    v_lshlrev_b32 v20, 16, v32
    v_and_b32 v21, 0xffff0000, v32
    v_cvt_pk_bf16_f32 v32, v22, v23
    v_lshlrev_b32 v22, 16, v32
    v_and_b32 v23, 0xffff0000, v32
    v_cvt_pk_bf16_f32 v32, v24, v25
    v_lshlrev_b32 v24, 16, v32
    v_and_b32 v25, 0xffff0000, v32
    v_cvt_pk_bf16_f32 v32, v26, v27
    v_lshlrev_b32 v26, 16, v32
    v_and_b32 v27, 0xffff0000, v32
    v_cvt_pk_bf16_f32 v32, v28, v29
    v_lshlrev_b32 v28, 16, v32
    v_and_b32 v29, 0xffff0000, v32
    v_pk_mul_f32 v[14:15], v[14:15], v[14:15]
    v_pk_mul_f32 v[16:17], v[16:17], v[16:17]
    v_pk_mul_f32 v[18:19], v[18:19], v[18:19]
    v_pk_mul_f32 v[20:21], v[20:21], v[20:21]
    v_pk_mul_f32 v[22:23], v[22:23], v[22:23]
    v_pk_mul_f32 v[24:25], v[24:25], v[24:25]
    v_pk_mul_f32 v[26:27], v[26:27], v[26:27]
    v_pk_mul_f32 v[28:29], v[28:29], v[28:29]
    v_cvt_pk_bf16_f32 v32, v14, v15
    v_lshlrev_b32 v14, 16, v32
    v_and_b32 v15, 0xffff0000, v32
    v_cvt_pk_bf16_f32 v32, v16, v17
    v_lshlrev_b32 v16, 16, v32
    v_and_b32 v17, 0xffff0000, v32
    v_cvt_pk_bf16_f32 v32, v18, v19
    v_lshlrev_b32 v18, 16, v32
    v_and_b32 v19, 0xffff0000, v32
    v_cvt_pk_bf16_f32 v32, v20, v21
    v_lshlrev_b32 v20, 16, v32
    v_and_b32 v21, 0xffff0000, v32
    v_cvt_pk_bf16_f32 v32, v22, v23
    v_lshlrev_b32 v22, 16, v32
    v_and_b32 v23, 0xffff0000, v32
    v_cvt_pk_bf16_f32 v32, v24, v25
    v_lshlrev_b32 v24, 16, v32
    v_and_b32 v25, 0xffff0000, v32
    v_cvt_pk_bf16_f32 v32, v26, v27
    v_lshlrev_b32 v26, 16, v32
    v_and_b32 v27, 0xffff0000, v32
    v_cvt_pk_bf16_f32 v32, v28, v29
    v_lshlrev_b32 v28, 16, v32
    v_and_b32 v29, 0xffff0000, v32
    v_mov_b32 v30, 1092616192
    v_mov_b32 v31, 0x3fb8aa3b
    v_pk_mul_f32 v[14:15], v[14:15], v[30:31] op_sel:[0,0] op_sel_hi:[1,0]
    v_pk_mul_f32 v[16:17], v[16:17], v[30:31] op_sel:[0,0] op_sel_hi:[1,0]
    v_pk_mul_f32 v[18:19], v[18:19], v[30:31] op_sel:[0,0] op_sel_hi:[1,0]
    v_pk_mul_f32 v[20:21], v[20:21], v[30:31] op_sel:[0,0] op_sel_hi:[1,0]
    v_pk_mul_f32 v[22:23], v[22:23], v[30:31] op_sel:[0,0] op_sel_hi:[1,0]
    v_pk_mul_f32 v[24:25], v[24:25], v[30:31] op_sel:[0,0] op_sel_hi:[1,0]
    v_pk_mul_f32 v[26:27], v[26:27], v[30:31] op_sel:[0,0] op_sel_hi:[1,0]
    v_pk_mul_f32 v[28:29], v[28:29], v[30:31] op_sel:[0,0] op_sel_hi:[1,0]
    v_cvt_pk_bf16_f32 v32, v14, v15
    v_lshlrev_b32 v14, 16, v32
    v_and_b32 v15, 0xffff0000, v32
    v_cvt_pk_bf16_f32 v32, v16, v17
    v_lshlrev_b32 v16, 16, v32
    v_and_b32 v17, 0xffff0000, v32
    v_cvt_pk_bf16_f32 v32, v18, v19
    v_lshlrev_b32 v18, 16, v32
    v_and_b32 v19, 0xffff0000, v32
    v_cvt_pk_bf16_f32 v32, v20, v21
    v_lshlrev_b32 v20, 16, v32
    v_and_b32 v21, 0xffff0000, v32
    v_cvt_pk_bf16_f32 v32, v22, v23
    v_lshlrev_b32 v22, 16, v32
    v_and_b32 v23, 0xffff0000, v32
    v_cvt_pk_bf16_f32 v32, v24, v25
    v_lshlrev_b32 v24, 16, v32
    v_and_b32 v25, 0xffff0000, v32
    v_cvt_pk_bf16_f32 v32, v26, v27
    v_lshlrev_b32 v26, 16, v32
    v_and_b32 v27, 0xffff0000, v32
    v_cvt_pk_bf16_f32 v32, v28, v29
    v_lshlrev_b32 v28, 16, v32
    v_and_b32 v29, 0xffff0000, v32
    v_pk_mul_f32 v[14:15], v[14:15], v[30:31] op_sel:[0,1] op_sel_hi:[1,1]
    v_pk_mul_f32 v[16:17], v[16:17], v[30:31] op_sel:[0,1] op_sel_hi:[1,1]
    v_pk_mul_f32 v[18:19], v[18:19], v[30:31] op_sel:[0,1] op_sel_hi:[1,1]
    v_pk_mul_f32 v[20:21], v[20:21], v[30:31] op_sel:[0,1] op_sel_hi:[1,1]
    v_pk_mul_f32 v[22:23], v[22:23], v[30:31] op_sel:[0,1] op_sel_hi:[1,1]
    v_pk_mul_f32 v[24:25], v[24:25], v[30:31] op_sel:[0,1] op_sel_hi:[1,1]
    v_pk_mul_f32 v[26:27], v[26:27], v[30:31] op_sel:[0,1] op_sel_hi:[1,1]
    v_pk_mul_f32 v[28:29], v[28:29], v[30:31] op_sel:[0,1] op_sel_hi:[1,1]
    v_exp_f32 v14, -v14
    v_exp_f32 v15, -v15
    v_exp_f32 v16, -v16
    v_exp_f32 v17, -v17
    v_exp_f32 v18, -v18
    v_exp_f32 v19, -v19
    v_exp_f32 v20, -v20
    v_exp_f32 v21, -v21
    v_exp_f32 v22, -v22
    v_exp_f32 v23, -v23
    v_exp_f32 v24, -v24
    v_exp_f32 v25, -v25
    v_exp_f32 v26, -v26
    v_exp_f32 v27, -v27
    v_exp_f32 v28, -v28
    v_exp_f32 v29, -v29
    v_cvt_pk_bf16_f32 v14, v14, v16
    v_cvt_pk_bf16_f32 v15, v15, v17
    v_cvt_pk_bf16_f32 v18, v18, v20
    v_cvt_pk_bf16_f32 v19, v19, v21
    v_cvt_pk_bf16_f32 v22, v22, v24
    v_cvt_pk_bf16_f32 v23, v23, v25
    v_cvt_pk_bf16_f32 v26, v26, v28
    v_cvt_pk_bf16_f32 v27, v27, v29
    v_dot2_f32_bf16 v72, v14, s68, 0
    v_dot2_f32_bf16 v73, v15, s68, 0
    v_dot2_f32_bf16 v74, v14, s69, 0
    v_dot2_f32_bf16 v75, v15, s69, 0
    v_dot2_f32_bf16 v76, v14, s70, 0
    v_dot2_f32_bf16 v77, v15, s70, 0
    v_dot2_f32_bf16 v78, v14, s71, 0
    v_dot2_f32_bf16 v79, v15, s71, 0
    v_dot2_f32_bf16 v80, v14, s52, 0
    v_dot2_f32_bf16 v81, v15, s52, 0
    v_dot2_f32_bf16 v82, v14, s53, 0
    v_dot2_f32_bf16 v83, v15, s53, 0
    v_dot2_f32_bf16 v84, v14, s54, 0
    v_dot2_f32_bf16 v85, v15, s54, 0
    v_dot2_f32_bf16 v86, v14, s55, 0
    v_dot2_f32_bf16 v87, v15, s55, 0
    v_dot2_f32_bf16 v72, v18, s72, v72
    v_dot2_f32_bf16 v73, v19, s72, v73
    v_dot2_f32_bf16 v74, v18, s73, v74
    v_dot2_f32_bf16 v75, v19, s73, v75
    v_dot2_f32_bf16 v76, v18, s74, v76
    v_dot2_f32_bf16 v77, v19, s74, v77
    v_dot2_f32_bf16 v78, v18, s75, v78
    v_dot2_f32_bf16 v79, v19, s75, v79
    v_dot2_f32_bf16 v80, v18, s56, v80
    v_dot2_f32_bf16 v81, v19, s56, v81
    v_dot2_f32_bf16 v82, v18, s57, v82
    v_dot2_f32_bf16 v83, v19, s57, v83
    v_dot2_f32_bf16 v84, v18, s58, v84
    v_dot2_f32_bf16 v85, v19, s58, v85
    v_dot2_f32_bf16 v86, v18, s59, v86
    v_dot2_f32_bf16 v87, v19, s59, v87
    v_dot2_f32_bf16 v72, v22, s76, v72
    v_dot2_f32_bf16 v73, v23, s76, v73
    v_dot2_f32_bf16 v74, v22, s77, v74
    v_dot2_f32_bf16 v75, v23, s77, v75
    v_dot2_f32_bf16 v76, v22, s78, v76
    v_dot2_f32_bf16 v77, v23, s78, v77
    v_dot2_f32_bf16 v78, v22, s79, v78
    v_dot2_f32_bf16 v79, v23, s79, v79
    v_dot2_f32_bf16 v80, v22, s60, v80
    v_dot2_f32_bf16 v81, v23, s60, v81
    v_dot2_f32_bf16 v82, v22, s61, v82
    v_dot2_f32_bf16 v83, v23, s61, v83
    v_dot2_f32_bf16 v84, v22, s62, v84
    v_dot2_f32_bf16 v85, v23, s62, v85
    v_dot2_f32_bf16 v86, v22, s63, v86
    v_dot2_f32_bf16 v87, v23, s63, v87
    v_dot2_f32_bf16 v72, v26, s80, v72
    v_dot2_f32_bf16 v73, v27, s80, v73
    v_dot2_f32_bf16 v74, v26, s81, v74
    v_dot2_f32_bf16 v75, v27, s81, v75
    v_dot2_f32_bf16 v76, v26, s82, v76
    v_dot2_f32_bf16 v77, v27, s82, v77
    v_dot2_f32_bf16 v78, v26, s83, v78
    v_dot2_f32_bf16 v79, v27, s83, v79
    v_dot2_f32_bf16 v80, v26, s64, v80
    v_dot2_f32_bf16 v81, v27, s64, v81
    v_dot2_f32_bf16 v82, v26, s65, v82
    v_dot2_f32_bf16 v83, v27, s65, v83
    v_dot2_f32_bf16 v84, v26, s66, v84
    v_dot2_f32_bf16 v85, v27, s66, v85
    v_dot2_f32_bf16 v86, v26, s67, v86
    v_dot2_f32_bf16 v87, v27, s67, v87
    s_cmp_ge_u32 s13, 4
    s_cbranch_scc1 L_p2_kernel_g1_6
    v_lshlrev_b32 v30, 16, v61
    v_and_b32 v31, 0xffff0000, v61
    v_pk_add_f32 v[14:15], v[30:31], v[36:37] op_sel:[0,0] op_sel_hi:[1,0] neg_lo:[0,1] neg_hi:[0,1]
    v_pk_add_f32 v[16:17], v[30:31], v[36:37] op_sel:[0,1] op_sel_hi:[1,1] neg_lo:[0,1] neg_hi:[0,1]
    v_pk_add_f32 v[18:19], v[30:31], v[38:39] op_sel:[0,0] op_sel_hi:[1,0] neg_lo:[0,1] neg_hi:[0,1]
    v_pk_add_f32 v[20:21], v[30:31], v[38:39] op_sel:[0,1] op_sel_hi:[1,1] neg_lo:[0,1] neg_hi:[0,1]
    v_pk_add_f32 v[22:23], v[30:31], v[40:41] op_sel:[0,0] op_sel_hi:[1,0] neg_lo:[0,1] neg_hi:[0,1]
    v_pk_add_f32 v[24:25], v[30:31], v[40:41] op_sel:[0,1] op_sel_hi:[1,1] neg_lo:[0,1] neg_hi:[0,1]
    v_pk_add_f32 v[26:27], v[30:31], v[42:43] op_sel:[0,0] op_sel_hi:[1,0] neg_lo:[0,1] neg_hi:[0,1]
    v_pk_add_f32 v[28:29], v[30:31], v[42:43] op_sel:[0,1] op_sel_hi:[1,1] neg_lo:[0,1] neg_hi:[0,1]
    v_cvt_pk_bf16_f32 v32, v14, v15
    v_lshlrev_b32 v14, 16, v32
    v_and_b32 v15, 0xffff0000, v32
    v_cvt_pk_bf16_f32 v32, v16, v17
    v_lshlrev_b32 v16, 16, v32
    v_and_b32 v17, 0xffff0000, v32
    v_cvt_pk_bf16_f32 v32, v18, v19
    v_lshlrev_b32 v18, 16, v32
    v_and_b32 v19, 0xffff0000, v32
    v_cvt_pk_bf16_f32 v32, v20, v21
    v_lshlrev_b32 v20, 16, v32
    v_and_b32 v21, 0xffff0000, v32
    v_cvt_pk_bf16_f32 v32, v22, v23
    v_lshlrev_b32 v22, 16, v32
    v_and_b32 v23, 0xffff0000, v32
    v_cvt_pk_bf16_f32 v32, v24, v25
    v_lshlrev_b32 v24, 16, v32
    v_and_b32 v25, 0xffff0000, v32
    v_cvt_pk_bf16_f32 v32, v26, v27
    v_lshlrev_b32 v26, 16, v32
    v_and_b32 v27, 0xffff0000, v32
    v_cvt_pk_bf16_f32 v32, v28, v29
    v_lshlrev_b32 v28, 16, v32
    v_and_b32 v29, 0xffff0000, v32
    v_pk_mul_f32 v[14:15], v[14:15], v[14:15]
    v_pk_mul_f32 v[16:17], v[16:17], v[16:17]
    v_pk_mul_f32 v[18:19], v[18:19], v[18:19]
    v_pk_mul_f32 v[20:21], v[20:21], v[20:21]
    v_pk_mul_f32 v[22:23], v[22:23], v[22:23]
    v_pk_mul_f32 v[24:25], v[24:25], v[24:25]
    v_pk_mul_f32 v[26:27], v[26:27], v[26:27]
    v_pk_mul_f32 v[28:29], v[28:29], v[28:29]
    v_cvt_pk_bf16_f32 v32, v14, v15
    v_lshlrev_b32 v14, 16, v32
    v_and_b32 v15, 0xffff0000, v32
    v_cvt_pk_bf16_f32 v32, v16, v17
    v_lshlrev_b32 v16, 16, v32
    v_and_b32 v17, 0xffff0000, v32
    v_cvt_pk_bf16_f32 v32, v18, v19
    v_lshlrev_b32 v18, 16, v32
    v_and_b32 v19, 0xffff0000, v32
    v_cvt_pk_bf16_f32 v32, v20, v21
    v_lshlrev_b32 v20, 16, v32
    v_and_b32 v21, 0xffff0000, v32
    v_cvt_pk_bf16_f32 v32, v22, v23
    v_lshlrev_b32 v22, 16, v32
    v_and_b32 v23, 0xffff0000, v32
    v_cvt_pk_bf16_f32 v32, v24, v25
    v_lshlrev_b32 v24, 16, v32
    v_and_b32 v25, 0xffff0000, v32
    v_cvt_pk_bf16_f32 v32, v26, v27
    v_lshlrev_b32 v26, 16, v32
    v_and_b32 v27, 0xffff0000, v32
    v_cvt_pk_bf16_f32 v32, v28, v29
    v_lshlrev_b32 v28, 16, v32
    v_and_b32 v29, 0xffff0000, v32
    v_mov_b32 v30, 1092616192
    v_mov_b32 v31, 0x3fb8aa3b
    v_pk_mul_f32 v[14:15], v[14:15], v[30:31] op_sel:[0,0] op_sel_hi:[1,0]
    v_pk_mul_f32 v[16:17], v[16:17], v[30:31] op_sel:[0,0] op_sel_hi:[1,0]
    v_pk_mul_f32 v[18:19], v[18:19], v[30:31] op_sel:[0,0] op_sel_hi:[1,0]
    v_pk_mul_f32 v[20:21], v[20:21], v[30:31] op_sel:[0,0] op_sel_hi:[1,0]
    v_pk_mul_f32 v[22:23], v[22:23], v[30:31] op_sel:[0,0] op_sel_hi:[1,0]
    v_pk_mul_f32 v[24:25], v[24:25], v[30:31] op_sel:[0,0] op_sel_hi:[1,0]
    v_pk_mul_f32 v[26:27], v[26:27], v[30:31] op_sel:[0,0] op_sel_hi:[1,0]
    v_pk_mul_f32 v[28:29], v[28:29], v[30:31] op_sel:[0,0] op_sel_hi:[1,0]
    v_cvt_pk_bf16_f32 v32, v14, v15
    v_lshlrev_b32 v14, 16, v32
    v_and_b32 v15, 0xffff0000, v32
    v_cvt_pk_bf16_f32 v32, v16, v17
    v_lshlrev_b32 v16, 16, v32
    v_and_b32 v17, 0xffff0000, v32
    v_cvt_pk_bf16_f32 v32, v18, v19
    v_lshlrev_b32 v18, 16, v32
    v_and_b32 v19, 0xffff0000, v32
    v_cvt_pk_bf16_f32 v32, v20, v21
    v_lshlrev_b32 v20, 16, v32
    v_and_b32 v21, 0xffff0000, v32
    v_cvt_pk_bf16_f32 v32, v22, v23
    v_lshlrev_b32 v22, 16, v32
    v_and_b32 v23, 0xffff0000, v32
    v_cvt_pk_bf16_f32 v32, v24, v25
    v_lshlrev_b32 v24, 16, v32
    v_and_b32 v25, 0xffff0000, v32
    v_cvt_pk_bf16_f32 v32, v26, v27
    v_lshlrev_b32 v26, 16, v32
    v_and_b32 v27, 0xffff0000, v32
    v_cvt_pk_bf16_f32 v32, v28, v29
    v_lshlrev_b32 v28, 16, v32
    v_and_b32 v29, 0xffff0000, v32
    v_pk_mul_f32 v[14:15], v[14:15], v[30:31] op_sel:[0,1] op_sel_hi:[1,1]
    v_pk_mul_f32 v[16:17], v[16:17], v[30:31] op_sel:[0,1] op_sel_hi:[1,1]
    v_pk_mul_f32 v[18:19], v[18:19], v[30:31] op_sel:[0,1] op_sel_hi:[1,1]
    v_pk_mul_f32 v[20:21], v[20:21], v[30:31] op_sel:[0,1] op_sel_hi:[1,1]
    v_pk_mul_f32 v[22:23], v[22:23], v[30:31] op_sel:[0,1] op_sel_hi:[1,1]
    v_pk_mul_f32 v[24:25], v[24:25], v[30:31] op_sel:[0,1] op_sel_hi:[1,1]
    v_pk_mul_f32 v[26:27], v[26:27], v[30:31] op_sel:[0,1] op_sel_hi:[1,1]
    v_pk_mul_f32 v[28:29], v[28:29], v[30:31] op_sel:[0,1] op_sel_hi:[1,1]
    v_exp_f32 v14, -v14
    v_exp_f32 v15, -v15
    v_exp_f32 v16, -v16
    v_exp_f32 v17, -v17
    v_exp_f32 v18, -v18
    v_exp_f32 v19, -v19
    v_exp_f32 v20, -v20
    v_exp_f32 v21, -v21
    v_exp_f32 v22, -v22
    v_exp_f32 v23, -v23
    v_exp_f32 v24, -v24
    v_exp_f32 v25, -v25
    v_exp_f32 v26, -v26
    v_exp_f32 v27, -v27
    v_exp_f32 v28, -v28
    v_exp_f32 v29, -v29
    v_cvt_pk_bf16_f32 v14, v14, v16
    v_cvt_pk_bf16_f32 v15, v15, v17
    v_cvt_pk_bf16_f32 v18, v18, v20
    v_cvt_pk_bf16_f32 v19, v19, v21
    v_cvt_pk_bf16_f32 v22, v22, v24
    v_cvt_pk_bf16_f32 v23, v23, v25
    v_cvt_pk_bf16_f32 v26, v26, v28
    v_cvt_pk_bf16_f32 v27, v27, v29
    v_dot2_f32_bf16 v112, v14, s68, 0
    v_dot2_f32_bf16 v113, v15, s68, 0
    v_dot2_f32_bf16 v114, v14, s69, 0
    v_dot2_f32_bf16 v115, v15, s69, 0
    v_dot2_f32_bf16 v116, v14, s70, 0
    v_dot2_f32_bf16 v117, v15, s70, 0
    v_dot2_f32_bf16 v118, v14, s71, 0
    v_dot2_f32_bf16 v119, v15, s71, 0
    v_dot2_f32_bf16 v120, v14, s52, 0
    v_dot2_f32_bf16 v121, v15, s52, 0
    v_dot2_f32_bf16 v122, v14, s53, 0
    v_dot2_f32_bf16 v123, v15, s53, 0
    v_dot2_f32_bf16 v124, v14, s54, 0
    v_dot2_f32_bf16 v125, v15, s54, 0
    v_dot2_f32_bf16 v126, v14, s55, 0
    v_dot2_f32_bf16 v127, v15, s55, 0
    v_dot2_f32_bf16 v112, v18, s72, v112
    v_dot2_f32_bf16 v113, v19, s72, v113
    v_dot2_f32_bf16 v114, v18, s73, v114
    v_dot2_f32_bf16 v115, v19, s73, v115
    v_dot2_f32_bf16 v116, v18, s74, v116
    v_dot2_f32_bf16 v117, v19, s74, v117
    v_dot2_f32_bf16 v118, v18, s75, v118
    v_dot2_f32_bf16 v119, v19, s75, v119
    v_dot2_f32_bf16 v120, v18, s56, v120
    v_dot2_f32_bf16 v121, v19, s56, v121
    v_dot2_f32_bf16 v122, v18, s57, v122
    v_dot2_f32_bf16 v123, v19, s57, v123
    v_dot2_f32_bf16 v124, v18, s58, v124
    v_dot2_f32_bf16 v125, v19, s58, v125
    v_dot2_f32_bf16 v126, v18, s59, v126
    v_dot2_f32_bf16 v127, v19, s59, v127
    v_dot2_f32_bf16 v112, v22, s76, v112
    v_dot2_f32_bf16 v113, v23, s76, v113
    v_dot2_f32_bf16 v114, v22, s77, v114
    v_dot2_f32_bf16 v115, v23, s77, v115
    v_dot2_f32_bf16 v116, v22, s78, v116
    v_dot2_f32_bf16 v117, v23, s78, v117
    v_dot2_f32_bf16 v118, v22, s79, v118
    v_dot2_f32_bf16 v119, v23, s79, v119
    v_dot2_f32_bf16 v120, v22, s60, v120
    v_dot2_f32_bf16 v121, v23, s60, v121
    v_dot2_f32_bf16 v122, v22, s61, v122
    v_dot2_f32_bf16 v123, v23, s61, v123
    v_dot2_f32_bf16 v124, v22, s62, v124
    v_dot2_f32_bf16 v125, v23, s62, v125
    v_dot2_f32_bf16 v126, v22, s63, v126
    v_dot2_f32_bf16 v127, v23, s63, v127
    v_dot2_f32_bf16 v112, v26, s80, v112
    v_dot2_f32_bf16 v113, v27, s80, v113
    v_dot2_f32_bf16 v114, v26, s81, v114
    v_dot2_f32_bf16 v115, v27, s81, v115
    v_dot2_f32_bf16 v116, v26, s82, v116
    v_dot2_f32_bf16 v117, v27, s82, v117
    v_dot2_f32_bf16 v118, v26, s83, v118
    v_dot2_f32_bf16 v119, v27, s83, v119
    v_dot2_f32_bf16 v120, v26, s64, v120
    v_dot2_f32_bf16 v121, v27, s64, v121
    v_dot2_f32_bf16 v122, v26, s65, v122
    v_dot2_f32_bf16 v123, v27, s65, v123
    v_dot2_f32_bf16 v124, v26, s66, v124
    v_dot2_f32_bf16 v125, v27, s66, v125
    v_dot2_f32_bf16 v126, v26, s67, v126
    v_dot2_f32_bf16 v127, v27, s67, v127
L_p2_kernel_g1_6:
L_p2_gb:
    v_and_b32 v4, 0x80008000, v4
    v_cmp_ne_u32 vcc, 0, v4
    v_mov_b32 v8, s27
    v_and_b32 v10, 15, v0
    v_mul_u32_u24 v10, 240, v10
    v_add_u32 v10, 160000, v10
    s_cmp_lg_u64 vcc, 0
    s_cselect_b32 s2, 1, s2
    v_mov_b32 v9, s2
    s_mov_b64 exec, 1
    ds_write_b32 v8, v9
    s_mov_b64 exec, -1
    v_add_u32 v2, 16384, v1
    v_mov_b32 v9, 0x3f000000
    v_cmp_gt_u32 vcc, 226, v0
    s_mov_b32 s49, s12
    s_mov_b32 s51, 0
    v_cndmask_b32 v2, v9, v2, vcc
    s_waitcnt vmcnt(0) lgkmcnt(0)
    s_barrier
    ds_read_b32 v9, v10
    s_mov_b32 s18, 5120000
    s_mov_b32 s19, 0x00020000
    s_waitcnt lgkmcnt(0)
    v_cmp_ne_u32 vcc, 0, v9
    s_nop 1
    s_cmp_lg_u64 vcc, 0
    s_cselect_b32 s2, 1, 0
    s_cbranch_scc1 L_p2_slow
L_p2_signal:
    v_mov_b32 v8, 160228
    s_lshl_b32 s15, s2, 4
    s_or_b32 s15, s15, s21
    s_add_u32 s14, s12, 16
    s_lshl_b32 s20, s15, s14
    s_add_u32 s20, s20, 1
    v_mov_b32 v9, s20
    s_cmp_lg_u32 s13, 15
    s_cbranch_scc1 L_p2_nosig0
    s_lshl_b32 s14, s3, 8
    s_add_u32 s14, s14, 8523776
    s_mov_b64 exec, 1
    buffer_atomic_add v9, off, s[4:7], s14 sc0
    s_mov_b64 exec, -1
L_p2_nosig0:
    s_lshl2_add_u32 s14, s3, s49
    s_mul_i32 s26, s14, 20000
    s_add_u32 s15, s26, 8540160
    buffer_load_dwordx4 v[64:67], v1, s[4:7], s15 offen
    buffer_load_dwordx4 v[68:71], v2, s[4:7], s15 offen
    s_lshl_b32 s28, s92, 16
    s_and_b32 s29, s92, 0xffff0000
    s_lshl_b32 s30, s93, 16
    s_and_b32 s31, s93, 0xffff0000
    s_lshl_b32 s32, s94, 16
    s_and_b32 s33, s94, 0xffff0000
    s_lshl_b32 s34, s95, 16
    s_and_b32 s35, s95, 0xffff0000
    s_lshl_b32 s36, s96, 16
    s_and_b32 s37, s96, 0xffff0000
    s_lshl_b32 s38, s97, 16
    s_and_b32 s39, s97, 0xffff0000
    s_lshl_b32 s40, s98, 16
    s_and_b32 s41, s98, 0xffff0000
    s_lshl_b32 s42, s99, 16
    s_and_b32 s43, s99, 0xffff0000
    s_and_b32 s99, s91, 0xffff0000
    s_lshl_b32 s98, s91, 16
    s_and_b32 s97, s90, 0xffff0000
    s_lshl_b32 s96, s90, 16
    s_and_b32 s95, s89, 0xffff0000
    s_lshl_b32 s94, s89, 16
    s_and_b32 s93, s88, 0xffff0000
    s_lshl_b32 s92, s88, 16
    s_and_b32 s91, s87, 0xffff0000
    s_lshl_b32 s90, s87, 16
    s_and_b32 s89, s86, 0xffff0000
    s_lshl_b32 s88, s86, 16
    s_and_b32 s87, s85, 0xffff0000
    s_lshl_b32 s86, s85, 16
    s_and_b32 s85, s84, 0xffff0000
    s_lshl_b32 s84, s84, 16
    s_mov_b32 s44, s48
    s_add_u32 s45, s48, 2281701376
    s_cmp_eq_u32 s48, 0
    s_cselect_b32 s45, 0, s45
    s_cmp_lg_u32 s13, 15
    s_cbranch_scc1 L_p2_nosig
    s_waitcnt vmcnt(2)
    v_readfirstlane_b32 s15, v9
    s_lshl_b32 s51, 1, s12
    s_add_u32 s20, s20, s15
    s_and_b32 s15, s20, 0xff
    s_cmp_eq_u32 s15, 4
    s_cbranch_scc0 L_p2_notlast
    s_bfe_u32 s15, s20, 262160
    s_or_b32 s51, s51, s15
    s_branch L_p2_pub
L_p2_notlast:
    s_cmp_lg_u32 s21, 0
    s_cselect_b32 s51, 0, s51
    s_cbranch_scc1 L_p2_pub
L_p2_poll:
    v_mov_b32 v9, 0
    s_lshl_b32 s14, s3, 8
    s_add_u32 s14, s14, 8523776
    s_mov_b64 exec, 1
    buffer_atomic_add v9, off, s[4:7], s14 sc0
    s_mov_b64 exec, -1
    s_waitcnt vmcnt(0)
    v_readfirstlane_b32 s20, v9
    s_nop 0
    s_and_b32 s15, s20, 0xff
    s_cmp_lt_u32 s15, 4
    s_cbranch_scc1 L_p2_poll
L_p2_pub:
    s_lshl_b32 s15, s51, 24
    s_or_b32 s15, s15, s20
    v_mov_b32 v9, s15
    s_mov_b64 exec, 1
    ds_write_b32 v8, v9
    s_mov_b64 exec, -1
    s_waitcnt lgkmcnt(0)
L_p2_nosig:
    s_barrier
    ds_read_b32 v9, v8
    s_waitcnt lgkmcnt(0)
    v_readfirstlane_b32 s20, v9
    s_nop 0
    s_lshr_b32 s51, s20, 24
    s_cbranch_scc0 L_p2_end
L_p2_fin:
    s_mul_i32 s24, s49, 20000
    s_add_u32 s14, s12, 1
    s_and_b32 s14, s14, 3
    s_mul_i32 s15, s14, 5120000
    s_add_u32 s15, s15, 233832448
    s_add_u32 s15, s15, s26
    buffer_load_dwordx4 v[12:15], v1, s[4:7], s15 offen sc1
    buffer_load_dwordx4 v[92:95], v2, s[4:7], s15 offen sc1
    s_add_u32 s14, s12, 2
    s_and_b32 s14, s14, 3
    s_mul_i32 s15, s14, 5120000
    s_add_u32 s15, s15, 233832448
    s_add_u32 s15, s15, s26
    buffer_load_dwordx4 v[16:19], v1, s[4:7], s15 offen sc1
    buffer_load_dwordx4 v[96:99], v2, s[4:7], s15 offen sc1
    s_add_u32 s14, s12, 3
    s_and_b32 s14, s14, 3
    s_mul_i32 s15, s14, 5120000
    s_add_u32 s15, s15, 233832448
    s_add_u32 s15, s15, s26
    buffer_load_dwordx4 v[20:23], v1, s[4:7], s15 offen sc1
    buffer_load_dwordx4 v[100:103], v2, s[4:7], s15 offen sc1
    v_add_u32 v24, s24, v1
    ds_read_b128 v[8:11], v24
    v_add_u32 v25, s24, v2
    ds_read_b128 v[88:91], v25
    s_waitcnt vmcnt(0) lgkmcnt(0)
    s_bfe_u32 s14, s20, 262164
    s_cbranch_scc0 L_p2_kernel_nof32a_7
    s_add_u32 s14, s12, 0
    s_and_b32 s14, s14, 3
    s_add_u32 s14, s14, 20
    s_bitcmp1_b32 s20, s14
    s_cbranch_scc0 L_p2_kernel_q_8
    v_mov_b32 v8, 1073758208
    v_mov_b32 v9, 1073758208
    v_mov_b32 v10, 1073758208
    v_mov_b32 v11, 1073758208
L_p2_kernel_q_8:
    s_add_u32 s14, s12, 1
    s_and_b32 s14, s14, 3
    s_add_u32 s14, s14, 20
    s_bitcmp1_b32 s20, s14
    s_cbranch_scc0 L_p2_kernel_q_9
    v_mov_b32 v12, 1073758208
    v_mov_b32 v13, 1073758208
    v_mov_b32 v14, 1073758208
    v_mov_b32 v15, 1073758208
L_p2_kernel_q_9:
    s_add_u32 s14, s12, 2
    s_and_b32 s14, s14, 3
    s_add_u32 s14, s14, 20
    s_bitcmp1_b32 s20, s14
    s_cbranch_scc0 L_p2_kernel_q_10
    v_mov_b32 v16, 1073758208
    v_mov_b32 v17, 1073758208
    v_mov_b32 v18, 1073758208
    v_mov_b32 v19, 1073758208
L_p2_kernel_q_10:
    s_add_u32 s14, s12, 3
    s_and_b32 s14, s14, 3
    s_add_u32 s14, s14, 20
    s_bitcmp1_b32 s20, s14
    s_cbranch_scc0 L_p2_kernel_q_11
    v_mov_b32 v20, 1073758208
    v_mov_b32 v21, 1073758208
    v_mov_b32 v22, 1073758208
    v_mov_b32 v23, 1073758208
L_p2_kernel_q_11:
L_p2_kernel_nof32a_7:
    v_pk_add_u16 v8, v8, v12
    v_pk_add_u16 v16, v16, v20
    v_pk_add_u16 v9, v9, v13
    v_pk_add_u16 v17, v17, v21
    v_pk_add_u16 v10, v10, v14
    v_pk_add_u16 v18, v18, v22
    v_pk_add_u16 v11, v11, v15
    v_pk_add_u16 v19, v19, v23
    v_add_u32_sdwa v24, v8, v16 dst_sel:DWORD dst_unused:UNUSED_PAD src0_sel:WORD_0 src1_sel:WORD_0
    v_add_u32_sdwa v25, v10, v18 dst_sel:DWORD dst_unused:UNUSED_PAD src0_sel:WORD_0 src1_sel:WORD_0
    v_add_u32_sdwa v26, v8, v16 dst_sel:DWORD dst_unused:UNUSED_PAD src0_sel:WORD_1 src1_sel:WORD_1
    v_add_u32_sdwa v27, v10, v18 dst_sel:DWORD dst_unused:UNUSED_PAD src0_sel:WORD_1 src1_sel:WORD_1
    v_add_u32_sdwa v28, v9, v17 dst_sel:DWORD dst_unused:UNUSED_PAD src0_sel:WORD_0 src1_sel:WORD_0
    v_add_u32_sdwa v29, v11, v19 dst_sel:DWORD dst_unused:UNUSED_PAD src0_sel:WORD_0 src1_sel:WORD_0
    v_add_u32_sdwa v30, v9, v17 dst_sel:DWORD dst_unused:UNUSED_PAD src0_sel:WORD_1 src1_sel:WORD_1
    v_add_u32_sdwa v31, v11, v19 dst_sel:DWORD dst_unused:UNUSED_PAD src0_sel:WORD_1 src1_sel:WORD_1
    v_cvt_f32_u32 v24, v24
    v_cvt_f32_u32 v25, v25
    v_cvt_f32_u32 v26, v26
    v_cvt_f32_u32 v27, v27
    v_cvt_f32_u32 v28, v28
    v_cvt_f32_u32 v29, v29
    v_cvt_f32_u32 v30, v30
    v_cvt_f32_u32 v31, v31
    v_pk_fma_f32 v[24:25], v[24:25], s[44:45], s[44:45] op_sel:[0,0,1] op_sel_hi:[1,0,1]
    v_pk_fma_f32 v[26:27], v[26:27], s[44:45], s[44:45] op_sel:[0,0,1] op_sel_hi:[1,0,1]
    v_pk_fma_f32 v[28:29], v[28:29], s[44:45], s[44:45] op_sel:[0,0,1] op_sel_hi:[1,0,1]
    v_pk_fma_f32 v[30:31], v[30:31], s[44:45], s[44:45] op_sel:[0,0,1] op_sel_hi:[1,0,1]
    s_bfe_u32 s14, s20, 262164
    s_cbranch_scc0 L_p2_kernel_nof32b_12
    v_lshlrev_b32 v32, 1, v1
    s_bitcmp1_b32 s20, 20
    s_cbranch_scc0 L_p2_kernel_q_13
    s_lshl_b32 s15, s26, 1
    s_add_u32 s15, s15, 254312448
    buffer_load_dwordx4 v[8:11], v32, s[4:7], s15 offen sc1
    buffer_load_dwordx4 v[12:15], v32, s[4:7], s15 offen offset:16 sc1
    s_waitcnt vmcnt(0)
    v_add_f32 v24, v24, v8
    v_add_f32 v25, v25, v12
    v_add_f32 v26, v26, v9
    v_add_f32 v27, v27, v13
    v_add_f32 v28, v28, v10
    v_add_f32 v29, v29, v14
    v_add_f32 v30, v30, v11
    v_add_f32 v31, v31, v15
L_p2_kernel_q_13:
    s_bitcmp1_b32 s20, 21
    s_cbranch_scc0 L_p2_kernel_q_14
    s_lshl_b32 s15, s26, 1
    s_add_u32 s15, s15, 264552448
    buffer_load_dwordx4 v[8:11], v32, s[4:7], s15 offen sc1
    buffer_load_dwordx4 v[12:15], v32, s[4:7], s15 offen offset:16 sc1
    s_waitcnt vmcnt(0)
    v_add_f32 v24, v24, v8
    v_add_f32 v25, v25, v12
    v_add_f32 v26, v26, v9
    v_add_f32 v27, v27, v13
    v_add_f32 v28, v28, v10
    v_add_f32 v29, v29, v14
    v_add_f32 v30, v30, v11
    v_add_f32 v31, v31, v15
L_p2_kernel_q_14:
    s_bitcmp1_b32 s20, 22
    s_cbranch_scc0 L_p2_kernel_q_15
    s_lshl_b32 s15, s26, 1
    s_add_u32 s15, s15, 274792448
    buffer_load_dwordx4 v[8:11], v32, s[4:7], s15 offen sc1
    buffer_load_dwordx4 v[12:15], v32, s[4:7], s15 offen offset:16 sc1
    s_waitcnt vmcnt(0)
    v_add_f32 v24, v24, v8
    v_add_f32 v25, v25, v12
    v_add_f32 v26, v26, v9
    v_add_f32 v27, v27, v13
    v_add_f32 v28, v28, v10
    v_add_f32 v29, v29, v14
    v_add_f32 v30, v30, v11
    v_add_f32 v31, v31, v15
L_p2_kernel_q_15:
    s_bitcmp1_b32 s20, 23
    s_cbranch_scc0 L_p2_kernel_q_16
    s_lshl_b32 s15, s26, 1
    s_add_u32 s15, s15, 285032448
    buffer_load_dwordx4 v[8:11], v32, s[4:7], s15 offen sc1
    buffer_load_dwordx4 v[12:15], v32, s[4:7], s15 offen offset:16 sc1
    s_waitcnt vmcnt(0)
    v_add_f32 v24, v24, v8
    v_add_f32 v25, v25, v12
    v_add_f32 v26, v26, v9
    v_add_f32 v27, v27, v13
    v_add_f32 v28, v28, v10
    v_add_f32 v29, v29, v14
    v_add_f32 v30, v30, v11
    v_add_f32 v31, v31, v15
L_p2_kernel_q_16:
L_p2_kernel_nof32b_12:
    v_pk_mul_f32 v[8:9], v[24:25], s[84:85] op_sel:[0,0] op_sel_hi:[1,0]
    v_pk_mul_f32 v[10:11], v[24:25], s[84:85] op_sel:[0,1] op_sel_hi:[1,1]
    v_pk_mul_f32 v[12:13], v[24:25], s[86:87] op_sel:[0,0] op_sel_hi:[1,0]
    v_pk_mul_f32 v[14:15], v[24:25], s[86:87] op_sel:[0,1] op_sel_hi:[1,1]
    v_pk_fma_f32 v[8:9], v[26:27], s[88:89], v[8:9] op_sel:[0,0,0] op_sel_hi:[1,0,1]
    v_pk_fma_f32 v[10:11], v[26:27], s[88:89], v[10:11] op_sel:[0,1,0] op_sel_hi:[1,1,1]
    v_pk_fma_f32 v[12:13], v[26:27], s[90:91], v[12:13] op_sel:[0,0,0] op_sel_hi:[1,0,1]
    v_pk_fma_f32 v[14:15], v[26:27], s[90:91], v[14:15] op_sel:[0,1,0] op_sel_hi:[1,1,1]
    v_pk_fma_f32 v[8:9], v[28:29], s[92:93], v[8:9] op_sel:[0,0,0] op_sel_hi:[1,0,1]
    v_pk_fma_f32 v[10:11], v[28:29], s[92:93], v[10:11] op_sel:[0,1,0] op_sel_hi:[1,1,1]
    v_pk_fma_f32 v[12:13], v[28:29], s[94:95], v[12:13] op_sel:[0,0,0] op_sel_hi:[1,0,1]
    v_pk_fma_f32 v[14:15], v[28:29], s[94:95], v[14:15] op_sel:[0,1,0] op_sel_hi:[1,1,1]
    v_pk_fma_f32 v[8:9], v[30:31], s[96:97], v[8:9] op_sel:[0,0,0] op_sel_hi:[1,0,1]
    v_pk_fma_f32 v[10:11], v[30:31], s[96:97], v[10:11] op_sel:[0,1,0] op_sel_hi:[1,1,1]
    v_pk_fma_f32 v[12:13], v[30:31], s[98:99], v[12:13] op_sel:[0,0,0] op_sel_hi:[1,0,1]
    v_pk_fma_f32 v[14:15], v[30:31], s[98:99], v[14:15] op_sel:[0,1,0] op_sel_hi:[1,1,1]
    v_pk_mul_f32 v[8:9], v[8:9], v[72:73]
    v_pk_mul_f32 v[10:11], v[10:11], v[74:75]
    v_pk_mul_f32 v[12:13], v[12:13], v[76:77]
    v_pk_mul_f32 v[14:15], v[14:15], v[78:79]
    v_pk_mul_f32 v[24:25], v[8:9], s[28:29] op_sel:[0,0] op_sel_hi:[1,0]
    v_pk_mul_f32 v[26:27], v[8:9], s[28:29] op_sel:[0,1] op_sel_hi:[1,1]
    v_pk_mul_f32 v[28:29], v[8:9], s[30:31] op_sel:[0,0] op_sel_hi:[1,0]
    v_pk_mul_f32 v[30:31], v[8:9], s[30:31] op_sel:[0,1] op_sel_hi:[1,1]
    v_pk_fma_f32 v[24:25], v[10:11], s[32:33], v[24:25] op_sel:[0,0,0] op_sel_hi:[1,0,1]
    v_pk_fma_f32 v[26:27], v[10:11], s[32:33], v[26:27] op_sel:[0,1,0] op_sel_hi:[1,1,1]
    v_pk_fma_f32 v[28:29], v[10:11], s[34:35], v[28:29] op_sel:[0,0,0] op_sel_hi:[1,0,1]
    v_pk_fma_f32 v[30:31], v[10:11], s[34:35], v[30:31] op_sel:[0,1,0] op_sel_hi:[1,1,1]
    v_pk_fma_f32 v[24:25], v[12:13], s[36:37], v[24:25] op_sel:[0,0,0] op_sel_hi:[1,0,1]
    v_pk_fma_f32 v[26:27], v[12:13], s[36:37], v[26:27] op_sel:[0,1,0] op_sel_hi:[1,1,1]
    v_pk_fma_f32 v[28:29], v[12:13], s[38:39], v[28:29] op_sel:[0,0,0] op_sel_hi:[1,0,1]
    v_pk_fma_f32 v[30:31], v[12:13], s[38:39], v[30:31] op_sel:[0,1,0] op_sel_hi:[1,1,1]
    v_pk_fma_f32 v[24:25], v[14:15], s[40:41], v[24:25] op_sel:[0,0,0] op_sel_hi:[1,0,1]
    v_pk_fma_f32 v[26:27], v[14:15], s[40:41], v[26:27] op_sel:[0,1,0] op_sel_hi:[1,1,1]
    v_pk_fma_f32 v[28:29], v[14:15], s[42:43], v[28:29] op_sel:[0,0,0] op_sel_hi:[1,0,1]
    v_pk_fma_f32 v[30:31], v[14:15], s[42:43], v[30:31] op_sel:[0,1,0] op_sel_hi:[1,1,1]
    v_lshlrev_b32 v8, 16, v64
    v_and_b32 v10, 0xffff0000, v64
    v_lshlrev_b32 v12, 16, v65
    v_and_b32 v14, 0xffff0000, v65
    v_lshlrev_b32 v9, 16, v66
    v_and_b32 v11, 0xffff0000, v66
    v_lshlrev_b32 v13, 16, v67
    v_and_b32 v15, 0xffff0000, v67
    v_pk_fma_f32 v[8:9], v[24:25], v[80:81], v[8:9]
    v_pk_fma_f32 v[10:11], v[26:27], v[82:83], v[10:11]
    v_pk_fma_f32 v[12:13], v[28:29], v[84:85], v[12:13]
    v_pk_fma_f32 v[14:15], v[30:31], v[86:87], v[14:15]
    v_cvt_pk_bf16_f32 v16, v8, v10
    v_cvt_pk_bf16_f32 v17, v12, v14
    v_cvt_pk_bf16_f32 v18, v9, v11
    v_cvt_pk_bf16_f32 v19, v13, v15
    buffer_store_dwordx4 v[16:19], v1, s[16:19], s26 offen
    s_cmp_ge_u32 s13, 4
    s_cbranch_scc1 L_p2_f1
    s_bfe_u32 s14, s20, 262164
    s_cbranch_scc0 L_p2_kernel_nof32a_17
    s_add_u32 s14, s12, 0
    s_and_b32 s14, s14, 3
    s_add_u32 s14, s14, 20
    s_bitcmp1_b32 s20, s14
    s_cbranch_scc0 L_p2_kernel_q_18
    v_mov_b32 v88, 1073758208
    v_mov_b32 v89, 1073758208
    v_mov_b32 v90, 1073758208
    v_mov_b32 v91, 1073758208
L_p2_kernel_q_18:
    s_add_u32 s14, s12, 1
    s_and_b32 s14, s14, 3
    s_add_u32 s14, s14, 20
    s_bitcmp1_b32 s20, s14
    s_cbranch_scc0 L_p2_kernel_q_19
    v_mov_b32 v92, 1073758208
    v_mov_b32 v93, 1073758208
    v_mov_b32 v94, 1073758208
    v_mov_b32 v95, 1073758208
L_p2_kernel_q_19:
    s_add_u32 s14, s12, 2
    s_and_b32 s14, s14, 3
    s_add_u32 s14, s14, 20
    s_bitcmp1_b32 s20, s14
    s_cbranch_scc0 L_p2_kernel_q_20
    v_mov_b32 v96, 1073758208
    v_mov_b32 v97, 1073758208
    v_mov_b32 v98, 1073758208
    v_mov_b32 v99, 1073758208
L_p2_kernel_q_20:
    s_add_u32 s14, s12, 3
    s_and_b32 s14, s14, 3
    s_add_u32 s14, s14, 20
    s_bitcmp1_b32 s20, s14
    s_cbranch_scc0 L_p2_kernel_q_21
    v_mov_b32 v100, 1073758208
    v_mov_b32 v101, 1073758208
    v_mov_b32 v102, 1073758208
    v_mov_b32 v103, 1073758208
L_p2_kernel_q_21:
L_p2_kernel_nof32a_17:
    v_pk_add_u16 v88, v88, v92
    v_pk_add_u16 v96, v96, v100
    v_pk_add_u16 v89, v89, v93
    v_pk_add_u16 v97, v97, v101
    v_pk_add_u16 v90, v90, v94
    v_pk_add_u16 v98, v98, v102
    v_pk_add_u16 v91, v91, v95
    v_pk_add_u16 v99, v99, v103
    v_add_u32_sdwa v24, v88, v96 dst_sel:DWORD dst_unused:UNUSED_PAD src0_sel:WORD_0 src1_sel:WORD_0
    v_add_u32_sdwa v25, v90, v98 dst_sel:DWORD dst_unused:UNUSED_PAD src0_sel:WORD_0 src1_sel:WORD_0
    v_add_u32_sdwa v26, v88, v96 dst_sel:DWORD dst_unused:UNUSED_PAD src0_sel:WORD_1 src1_sel:WORD_1
    v_add_u32_sdwa v27, v90, v98 dst_sel:DWORD dst_unused:UNUSED_PAD src0_sel:WORD_1 src1_sel:WORD_1
    v_add_u32_sdwa v28, v89, v97 dst_sel:DWORD dst_unused:UNUSED_PAD src0_sel:WORD_0 src1_sel:WORD_0
    v_add_u32_sdwa v29, v91, v99 dst_sel:DWORD dst_unused:UNUSED_PAD src0_sel:WORD_0 src1_sel:WORD_0
    v_add_u32_sdwa v30, v89, v97 dst_sel:DWORD dst_unused:UNUSED_PAD src0_sel:WORD_1 src1_sel:WORD_1
    v_add_u32_sdwa v31, v91, v99 dst_sel:DWORD dst_unused:UNUSED_PAD src0_sel:WORD_1 src1_sel:WORD_1
    v_cvt_f32_u32 v24, v24
    v_cvt_f32_u32 v25, v25
    v_cvt_f32_u32 v26, v26
    v_cvt_f32_u32 v27, v27
    v_cvt_f32_u32 v28, v28
    v_cvt_f32_u32 v29, v29
    v_cvt_f32_u32 v30, v30
    v_cvt_f32_u32 v31, v31
    v_pk_fma_f32 v[24:25], v[24:25], s[44:45], s[44:45] op_sel:[0,0,1] op_sel_hi:[1,0,1]
    v_pk_fma_f32 v[26:27], v[26:27], s[44:45], s[44:45] op_sel:[0,0,1] op_sel_hi:[1,0,1]
    v_pk_fma_f32 v[28:29], v[28:29], s[44:45], s[44:45] op_sel:[0,0,1] op_sel_hi:[1,0,1]
    v_pk_fma_f32 v[30:31], v[30:31], s[44:45], s[44:45] op_sel:[0,0,1] op_sel_hi:[1,0,1]
    s_bfe_u32 s14, s20, 262164
    s_cbranch_scc0 L_p2_kernel_nof32b_22
    v_lshlrev_b32 v32, 1, v2
    s_bitcmp1_b32 s20, 20
    s_cbranch_scc0 L_p2_kernel_q_23
    s_lshl_b32 s15, s26, 1
    s_add_u32 s15, s15, 254312448
    buffer_load_dwordx4 v[88:91], v32, s[4:7], s15 offen sc1
    buffer_load_dwordx4 v[92:95], v32, s[4:7], s15 offen offset:16 sc1
    s_waitcnt vmcnt(0)
    v_add_f32 v24, v24, v88
    v_add_f32 v25, v25, v92
    v_add_f32 v26, v26, v89
    v_add_f32 v27, v27, v93
    v_add_f32 v28, v28, v90
    v_add_f32 v29, v29, v94
    v_add_f32 v30, v30, v91
    v_add_f32 v31, v31, v95
L_p2_kernel_q_23:
    s_bitcmp1_b32 s20, 21
    s_cbranch_scc0 L_p2_kernel_q_24
    s_lshl_b32 s15, s26, 1
    s_add_u32 s15, s15, 264552448
    buffer_load_dwordx4 v[88:91], v32, s[4:7], s15 offen sc1
    buffer_load_dwordx4 v[92:95], v32, s[4:7], s15 offen offset:16 sc1
    s_waitcnt vmcnt(0)
    v_add_f32 v24, v24, v88
    v_add_f32 v25, v25, v92
    v_add_f32 v26, v26, v89
    v_add_f32 v27, v27, v93
    v_add_f32 v28, v28, v90
    v_add_f32 v29, v29, v94
    v_add_f32 v30, v30, v91
    v_add_f32 v31, v31, v95
L_p2_kernel_q_24:
    s_bitcmp1_b32 s20, 22
    s_cbranch_scc0 L_p2_kernel_q_25
    s_lshl_b32 s15, s26, 1
    s_add_u32 s15, s15, 274792448
    buffer_load_dwordx4 v[88:91], v32, s[4:7], s15 offen sc1
    buffer_load_dwordx4 v[92:95], v32, s[4:7], s15 offen offset:16 sc1
    s_waitcnt vmcnt(0)
    v_add_f32 v24, v24, v88
    v_add_f32 v25, v25, v92
    v_add_f32 v26, v26, v89
    v_add_f32 v27, v27, v93
    v_add_f32 v28, v28, v90
    v_add_f32 v29, v29, v94
    v_add_f32 v30, v30, v91
    v_add_f32 v31, v31, v95
L_p2_kernel_q_25:
    s_bitcmp1_b32 s20, 23
    s_cbranch_scc0 L_p2_kernel_q_26
    s_lshl_b32 s15, s26, 1
    s_add_u32 s15, s15, 285032448
    buffer_load_dwordx4 v[88:91], v32, s[4:7], s15 offen sc1
    buffer_load_dwordx4 v[92:95], v32, s[4:7], s15 offen offset:16 sc1
    s_waitcnt vmcnt(0)
    v_add_f32 v24, v24, v88
    v_add_f32 v25, v25, v92
    v_add_f32 v26, v26, v89
    v_add_f32 v27, v27, v93
    v_add_f32 v28, v28, v90
    v_add_f32 v29, v29, v94
    v_add_f32 v30, v30, v91
    v_add_f32 v31, v31, v95
L_p2_kernel_q_26:
L_p2_kernel_nof32b_22:
    v_pk_mul_f32 v[88:89], v[24:25], s[84:85] op_sel:[0,0] op_sel_hi:[1,0]
    v_pk_mul_f32 v[90:91], v[24:25], s[84:85] op_sel:[0,1] op_sel_hi:[1,1]
    v_pk_mul_f32 v[92:93], v[24:25], s[86:87] op_sel:[0,0] op_sel_hi:[1,0]
    v_pk_mul_f32 v[94:95], v[24:25], s[86:87] op_sel:[0,1] op_sel_hi:[1,1]
    v_pk_fma_f32 v[88:89], v[26:27], s[88:89], v[88:89] op_sel:[0,0,0] op_sel_hi:[1,0,1]
    v_pk_fma_f32 v[90:91], v[26:27], s[88:89], v[90:91] op_sel:[0,1,0] op_sel_hi:[1,1,1]
    v_pk_fma_f32 v[92:93], v[26:27], s[90:91], v[92:93] op_sel:[0,0,0] op_sel_hi:[1,0,1]
    v_pk_fma_f32 v[94:95], v[26:27], s[90:91], v[94:95] op_sel:[0,1,0] op_sel_hi:[1,1,1]
    v_pk_fma_f32 v[88:89], v[28:29], s[92:93], v[88:89] op_sel:[0,0,0] op_sel_hi:[1,0,1]
    v_pk_fma_f32 v[90:91], v[28:29], s[92:93], v[90:91] op_sel:[0,1,0] op_sel_hi:[1,1,1]
    v_pk_fma_f32 v[92:93], v[28:29], s[94:95], v[92:93] op_sel:[0,0,0] op_sel_hi:[1,0,1]
    v_pk_fma_f32 v[94:95], v[28:29], s[94:95], v[94:95] op_sel:[0,1,0] op_sel_hi:[1,1,1]
    v_pk_fma_f32 v[88:89], v[30:31], s[96:97], v[88:89] op_sel:[0,0,0] op_sel_hi:[1,0,1]
    v_pk_fma_f32 v[90:91], v[30:31], s[96:97], v[90:91] op_sel:[0,1,0] op_sel_hi:[1,1,1]
    v_pk_fma_f32 v[92:93], v[30:31], s[98:99], v[92:93] op_sel:[0,0,0] op_sel_hi:[1,0,1]
    v_pk_fma_f32 v[94:95], v[30:31], s[98:99], v[94:95] op_sel:[0,1,0] op_sel_hi:[1,1,1]
    v_pk_mul_f32 v[88:89], v[88:89], v[112:113]
    v_pk_mul_f32 v[90:91], v[90:91], v[114:115]
    v_pk_mul_f32 v[92:93], v[92:93], v[116:117]
    v_pk_mul_f32 v[94:95], v[94:95], v[118:119]
    v_pk_mul_f32 v[24:25], v[88:89], s[28:29] op_sel:[0,0] op_sel_hi:[1,0]
    v_pk_mul_f32 v[26:27], v[88:89], s[28:29] op_sel:[0,1] op_sel_hi:[1,1]
    v_pk_mul_f32 v[28:29], v[88:89], s[30:31] op_sel:[0,0] op_sel_hi:[1,0]
    v_pk_mul_f32 v[30:31], v[88:89], s[30:31] op_sel:[0,1] op_sel_hi:[1,1]
    v_pk_fma_f32 v[24:25], v[90:91], s[32:33], v[24:25] op_sel:[0,0,0] op_sel_hi:[1,0,1]
    v_pk_fma_f32 v[26:27], v[90:91], s[32:33], v[26:27] op_sel:[0,1,0] op_sel_hi:[1,1,1]
    v_pk_fma_f32 v[28:29], v[90:91], s[34:35], v[28:29] op_sel:[0,0,0] op_sel_hi:[1,0,1]
    v_pk_fma_f32 v[30:31], v[90:91], s[34:35], v[30:31] op_sel:[0,1,0] op_sel_hi:[1,1,1]
    v_pk_fma_f32 v[24:25], v[92:93], s[36:37], v[24:25] op_sel:[0,0,0] op_sel_hi:[1,0,1]
    v_pk_fma_f32 v[26:27], v[92:93], s[36:37], v[26:27] op_sel:[0,1,0] op_sel_hi:[1,1,1]
    v_pk_fma_f32 v[28:29], v[92:93], s[38:39], v[28:29] op_sel:[0,0,0] op_sel_hi:[1,0,1]
    v_pk_fma_f32 v[30:31], v[92:93], s[38:39], v[30:31] op_sel:[0,1,0] op_sel_hi:[1,1,1]
    v_pk_fma_f32 v[24:25], v[94:95], s[40:41], v[24:25] op_sel:[0,0,0] op_sel_hi:[1,0,1]
    v_pk_fma_f32 v[26:27], v[94:95], s[40:41], v[26:27] op_sel:[0,1,0] op_sel_hi:[1,1,1]
    v_pk_fma_f32 v[28:29], v[94:95], s[42:43], v[28:29] op_sel:[0,0,0] op_sel_hi:[1,0,1]
    v_pk_fma_f32 v[30:31], v[94:95], s[42:43], v[30:31] op_sel:[0,1,0] op_sel_hi:[1,1,1]
    v_lshlrev_b32 v88, 16, v68
    v_and_b32 v90, 0xffff0000, v68
    v_lshlrev_b32 v92, 16, v69
    v_and_b32 v94, 0xffff0000, v69
    v_lshlrev_b32 v89, 16, v70
    v_and_b32 v91, 0xffff0000, v70
    v_lshlrev_b32 v93, 16, v71
    v_and_b32 v95, 0xffff0000, v71
    v_pk_fma_f32 v[88:89], v[24:25], v[120:121], v[88:89]
    v_pk_fma_f32 v[90:91], v[26:27], v[122:123], v[90:91]
    v_pk_fma_f32 v[92:93], v[28:29], v[124:125], v[92:93]
    v_pk_fma_f32 v[94:95], v[30:31], v[126:127], v[94:95]
    v_cvt_pk_bf16_f32 v96, v88, v90
    v_cvt_pk_bf16_f32 v97, v92, v94
    v_cvt_pk_bf16_f32 v98, v89, v91
    v_cvt_pk_bf16_f32 v99, v93, v95
    buffer_store_dwordx4 v[96:99], v2, s[16:19], s26 offen
L_p2_f1:
    s_bitset0_b32 s51, s49
    s_cmp_eq_u32 s51, 0
    s_cbranch_scc1 L_p2_done
    s_ff1_i32_b32 s49, s51
    s_lshl2_add_u32 s14, s3, s49
    s_mul_i32 s14, s14, 5000
    s_add_u32 s15, s14, 4096
    v_min_u32 v61, 225, v0
    v_lshl_add_u32 v60, v0, 2, s14
    v_lshl_add_u32 v61, v61, 2, s15
    global_load_dword v60, v60, s[100:101] nt
    global_load_dword v61, v61, s[100:101] nt
    s_waitcnt vmcnt(0)
    v_lshlrev_b32 v30, 16, v60
    v_and_b32 v31, 0xffff0000, v60
    v_lshlrev_b32 v36, 16, v53
    v_and_b32 v37, 0xffff0000, v53
    v_lshlrev_b32 v38, 16, v54
    v_and_b32 v39, 0xffff0000, v54
    v_lshlrev_b32 v40, 16, v56
    v_and_b32 v41, 0xffff0000, v56
    v_lshlrev_b32 v42, 16, v57
    v_and_b32 v43, 0xffff0000, v57
    v_pk_add_f32 v[14:15], v[30:31], v[36:37] op_sel:[0,0] op_sel_hi:[1,0] neg_lo:[0,1] neg_hi:[0,1]
    v_pk_add_f32 v[16:17], v[30:31], v[36:37] op_sel:[0,1] op_sel_hi:[1,1] neg_lo:[0,1] neg_hi:[0,1]
    v_pk_add_f32 v[18:19], v[30:31], v[38:39] op_sel:[0,0] op_sel_hi:[1,0] neg_lo:[0,1] neg_hi:[0,1]
    v_pk_add_f32 v[20:21], v[30:31], v[38:39] op_sel:[0,1] op_sel_hi:[1,1] neg_lo:[0,1] neg_hi:[0,1]
    v_pk_add_f32 v[22:23], v[30:31], v[40:41] op_sel:[0,0] op_sel_hi:[1,0] neg_lo:[0,1] neg_hi:[0,1]
    v_pk_add_f32 v[24:25], v[30:31], v[40:41] op_sel:[0,1] op_sel_hi:[1,1] neg_lo:[0,1] neg_hi:[0,1]
    v_pk_add_f32 v[26:27], v[30:31], v[42:43] op_sel:[0,0] op_sel_hi:[1,0] neg_lo:[0,1] neg_hi:[0,1]
    v_pk_add_f32 v[28:29], v[30:31], v[42:43] op_sel:[0,1] op_sel_hi:[1,1] neg_lo:[0,1] neg_hi:[0,1]
    v_cvt_pk_bf16_f32 v32, v14, v15
    v_lshlrev_b32 v14, 16, v32
    v_and_b32 v15, 0xffff0000, v32
    v_cvt_pk_bf16_f32 v32, v16, v17
    v_lshlrev_b32 v16, 16, v32
    v_and_b32 v17, 0xffff0000, v32
    v_cvt_pk_bf16_f32 v32, v18, v19
    v_lshlrev_b32 v18, 16, v32
    v_and_b32 v19, 0xffff0000, v32
    v_cvt_pk_bf16_f32 v32, v20, v21
    v_lshlrev_b32 v20, 16, v32
    v_and_b32 v21, 0xffff0000, v32
    v_cvt_pk_bf16_f32 v32, v22, v23
    v_lshlrev_b32 v22, 16, v32
    v_and_b32 v23, 0xffff0000, v32
    v_cvt_pk_bf16_f32 v32, v24, v25
    v_lshlrev_b32 v24, 16, v32
    v_and_b32 v25, 0xffff0000, v32
    v_cvt_pk_bf16_f32 v32, v26, v27
    v_lshlrev_b32 v26, 16, v32
    v_and_b32 v27, 0xffff0000, v32
    v_cvt_pk_bf16_f32 v32, v28, v29
    v_lshlrev_b32 v28, 16, v32
    v_and_b32 v29, 0xffff0000, v32
    v_pk_mul_f32 v[14:15], v[14:15], v[14:15]
    v_pk_mul_f32 v[16:17], v[16:17], v[16:17]
    v_pk_mul_f32 v[18:19], v[18:19], v[18:19]
    v_pk_mul_f32 v[20:21], v[20:21], v[20:21]
    v_pk_mul_f32 v[22:23], v[22:23], v[22:23]
    v_pk_mul_f32 v[24:25], v[24:25], v[24:25]
    v_pk_mul_f32 v[26:27], v[26:27], v[26:27]
    v_pk_mul_f32 v[28:29], v[28:29], v[28:29]
    v_cvt_pk_bf16_f32 v32, v14, v15
    v_lshlrev_b32 v14, 16, v32
    v_and_b32 v15, 0xffff0000, v32
    v_cvt_pk_bf16_f32 v32, v16, v17
    v_lshlrev_b32 v16, 16, v32
    v_and_b32 v17, 0xffff0000, v32
    v_cvt_pk_bf16_f32 v32, v18, v19
    v_lshlrev_b32 v18, 16, v32
    v_and_b32 v19, 0xffff0000, v32
    v_cvt_pk_bf16_f32 v32, v20, v21
    v_lshlrev_b32 v20, 16, v32
    v_and_b32 v21, 0xffff0000, v32
    v_cvt_pk_bf16_f32 v32, v22, v23
    v_lshlrev_b32 v22, 16, v32
    v_and_b32 v23, 0xffff0000, v32
    v_cvt_pk_bf16_f32 v32, v24, v25
    v_lshlrev_b32 v24, 16, v32
    v_and_b32 v25, 0xffff0000, v32
    v_cvt_pk_bf16_f32 v32, v26, v27
    v_lshlrev_b32 v26, 16, v32
    v_and_b32 v27, 0xffff0000, v32
    v_cvt_pk_bf16_f32 v32, v28, v29
    v_lshlrev_b32 v28, 16, v32
    v_and_b32 v29, 0xffff0000, v32
    v_mov_b32 v30, 1092616192
    v_mov_b32 v31, 0x3fb8aa3b
    v_pk_mul_f32 v[14:15], v[14:15], v[30:31] op_sel:[0,0] op_sel_hi:[1,0]
    v_pk_mul_f32 v[16:17], v[16:17], v[30:31] op_sel:[0,0] op_sel_hi:[1,0]
    v_pk_mul_f32 v[18:19], v[18:19], v[30:31] op_sel:[0,0] op_sel_hi:[1,0]
    v_pk_mul_f32 v[20:21], v[20:21], v[30:31] op_sel:[0,0] op_sel_hi:[1,0]
    v_pk_mul_f32 v[22:23], v[22:23], v[30:31] op_sel:[0,0] op_sel_hi:[1,0]
    v_pk_mul_f32 v[24:25], v[24:25], v[30:31] op_sel:[0,0] op_sel_hi:[1,0]
    v_pk_mul_f32 v[26:27], v[26:27], v[30:31] op_sel:[0,0] op_sel_hi:[1,0]
    v_pk_mul_f32 v[28:29], v[28:29], v[30:31] op_sel:[0,0] op_sel_hi:[1,0]
    v_cvt_pk_bf16_f32 v32, v14, v15
    v_lshlrev_b32 v14, 16, v32
    v_and_b32 v15, 0xffff0000, v32
    v_cvt_pk_bf16_f32 v32, v16, v17
    v_lshlrev_b32 v16, 16, v32
    v_and_b32 v17, 0xffff0000, v32
    v_cvt_pk_bf16_f32 v32, v18, v19
    v_lshlrev_b32 v18, 16, v32
    v_and_b32 v19, 0xffff0000, v32
    v_cvt_pk_bf16_f32 v32, v20, v21
    v_lshlrev_b32 v20, 16, v32
    v_and_b32 v21, 0xffff0000, v32
    v_cvt_pk_bf16_f32 v32, v22, v23
    v_lshlrev_b32 v22, 16, v32
    v_and_b32 v23, 0xffff0000, v32
    v_cvt_pk_bf16_f32 v32, v24, v25
    v_lshlrev_b32 v24, 16, v32
    v_and_b32 v25, 0xffff0000, v32
    v_cvt_pk_bf16_f32 v32, v26, v27
    v_lshlrev_b32 v26, 16, v32
    v_and_b32 v27, 0xffff0000, v32
    v_cvt_pk_bf16_f32 v32, v28, v29
    v_lshlrev_b32 v28, 16, v32
    v_and_b32 v29, 0xffff0000, v32
    v_pk_mul_f32 v[14:15], v[14:15], v[30:31] op_sel:[0,1] op_sel_hi:[1,1]
    v_pk_mul_f32 v[16:17], v[16:17], v[30:31] op_sel:[0,1] op_sel_hi:[1,1]
    v_pk_mul_f32 v[18:19], v[18:19], v[30:31] op_sel:[0,1] op_sel_hi:[1,1]
    v_pk_mul_f32 v[20:21], v[20:21], v[30:31] op_sel:[0,1] op_sel_hi:[1,1]
    v_pk_mul_f32 v[22:23], v[22:23], v[30:31] op_sel:[0,1] op_sel_hi:[1,1]
    v_pk_mul_f32 v[24:25], v[24:25], v[30:31] op_sel:[0,1] op_sel_hi:[1,1]
    v_pk_mul_f32 v[26:27], v[26:27], v[30:31] op_sel:[0,1] op_sel_hi:[1,1]
    v_pk_mul_f32 v[28:29], v[28:29], v[30:31] op_sel:[0,1] op_sel_hi:[1,1]
    v_exp_f32 v14, -v14
    v_exp_f32 v15, -v15
    v_exp_f32 v16, -v16
    v_exp_f32 v17, -v17
    v_exp_f32 v18, -v18
    v_exp_f32 v19, -v19
    v_exp_f32 v20, -v20
    v_exp_f32 v21, -v21
    v_exp_f32 v22, -v22
    v_exp_f32 v23, -v23
    v_exp_f32 v24, -v24
    v_exp_f32 v25, -v25
    v_exp_f32 v26, -v26
    v_exp_f32 v27, -v27
    v_exp_f32 v28, -v28
    v_exp_f32 v29, -v29
    v_cvt_pk_bf16_f32 v14, v14, v16
    v_cvt_pk_bf16_f32 v15, v15, v17
    v_cvt_pk_bf16_f32 v18, v18, v20
    v_cvt_pk_bf16_f32 v19, v19, v21
    v_cvt_pk_bf16_f32 v22, v22, v24
    v_cvt_pk_bf16_f32 v23, v23, v25
    v_cvt_pk_bf16_f32 v26, v26, v28
    v_cvt_pk_bf16_f32 v27, v27, v29
    v_dot2_f32_bf16 v72, v14, s68, 0
    v_dot2_f32_bf16 v73, v15, s68, 0
    v_dot2_f32_bf16 v74, v14, s69, 0
    v_dot2_f32_bf16 v75, v15, s69, 0
    v_dot2_f32_bf16 v76, v14, s70, 0
    v_dot2_f32_bf16 v77, v15, s70, 0
    v_dot2_f32_bf16 v78, v14, s71, 0
    v_dot2_f32_bf16 v79, v15, s71, 0
    v_dot2_f32_bf16 v80, v14, s52, 0
    v_dot2_f32_bf16 v81, v15, s52, 0
    v_dot2_f32_bf16 v82, v14, s53, 0
    v_dot2_f32_bf16 v83, v15, s53, 0
    v_dot2_f32_bf16 v84, v14, s54, 0
    v_dot2_f32_bf16 v85, v15, s54, 0
    v_dot2_f32_bf16 v86, v14, s55, 0
    v_dot2_f32_bf16 v87, v15, s55, 0
    v_dot2_f32_bf16 v72, v18, s72, v72
    v_dot2_f32_bf16 v73, v19, s72, v73
    v_dot2_f32_bf16 v74, v18, s73, v74
    v_dot2_f32_bf16 v75, v19, s73, v75
    v_dot2_f32_bf16 v76, v18, s74, v76
    v_dot2_f32_bf16 v77, v19, s74, v77
    v_dot2_f32_bf16 v78, v18, s75, v78
    v_dot2_f32_bf16 v79, v19, s75, v79
    v_dot2_f32_bf16 v80, v18, s56, v80
    v_dot2_f32_bf16 v81, v19, s56, v81
    v_dot2_f32_bf16 v82, v18, s57, v82
    v_dot2_f32_bf16 v83, v19, s57, v83
    v_dot2_f32_bf16 v84, v18, s58, v84
    v_dot2_f32_bf16 v85, v19, s58, v85
    v_dot2_f32_bf16 v86, v18, s59, v86
    v_dot2_f32_bf16 v87, v19, s59, v87
    v_dot2_f32_bf16 v72, v22, s76, v72
    v_dot2_f32_bf16 v73, v23, s76, v73
    v_dot2_f32_bf16 v74, v22, s77, v74
    v_dot2_f32_bf16 v75, v23, s77, v75
    v_dot2_f32_bf16 v76, v22, s78, v76
    v_dot2_f32_bf16 v77, v23, s78, v77
    v_dot2_f32_bf16 v78, v22, s79, v78
    v_dot2_f32_bf16 v79, v23, s79, v79
    v_dot2_f32_bf16 v80, v22, s60, v80
    v_dot2_f32_bf16 v81, v23, s60, v81
    v_dot2_f32_bf16 v82, v22, s61, v82
    v_dot2_f32_bf16 v83, v23, s61, v83
    v_dot2_f32_bf16 v84, v22, s62, v84
    v_dot2_f32_bf16 v85, v23, s62, v85
    v_dot2_f32_bf16 v86, v22, s63, v86
    v_dot2_f32_bf16 v87, v23, s63, v87
    v_dot2_f32_bf16 v72, v26, s80, v72
    v_dot2_f32_bf16 v73, v27, s80, v73
    v_dot2_f32_bf16 v74, v26, s81, v74
    v_dot2_f32_bf16 v75, v27, s81, v75
    v_dot2_f32_bf16 v76, v26, s82, v76
    v_dot2_f32_bf16 v77, v27, s82, v77
    v_dot2_f32_bf16 v78, v26, s83, v78
    v_dot2_f32_bf16 v79, v27, s83, v79
    v_dot2_f32_bf16 v80, v26, s64, v80
    v_dot2_f32_bf16 v81, v27, s64, v81
    v_dot2_f32_bf16 v82, v26, s65, v82
    v_dot2_f32_bf16 v83, v27, s65, v83
    v_dot2_f32_bf16 v84, v26, s66, v84
    v_dot2_f32_bf16 v85, v27, s66, v85
    v_dot2_f32_bf16 v86, v26, s67, v86
    v_dot2_f32_bf16 v87, v27, s67, v87
    s_cmp_ge_u32 s13, 4
    s_cbranch_scc1 L_p2_kernel_g1_27
    v_lshlrev_b32 v30, 16, v61
    v_and_b32 v31, 0xffff0000, v61
    v_pk_add_f32 v[14:15], v[30:31], v[36:37] op_sel:[0,0] op_sel_hi:[1,0] neg_lo:[0,1] neg_hi:[0,1]
    v_pk_add_f32 v[16:17], v[30:31], v[36:37] op_sel:[0,1] op_sel_hi:[1,1] neg_lo:[0,1] neg_hi:[0,1]
    v_pk_add_f32 v[18:19], v[30:31], v[38:39] op_sel:[0,0] op_sel_hi:[1,0] neg_lo:[0,1] neg_hi:[0,1]
    v_pk_add_f32 v[20:21], v[30:31], v[38:39] op_sel:[0,1] op_sel_hi:[1,1] neg_lo:[0,1] neg_hi:[0,1]
    v_pk_add_f32 v[22:23], v[30:31], v[40:41] op_sel:[0,0] op_sel_hi:[1,0] neg_lo:[0,1] neg_hi:[0,1]
    v_pk_add_f32 v[24:25], v[30:31], v[40:41] op_sel:[0,1] op_sel_hi:[1,1] neg_lo:[0,1] neg_hi:[0,1]
    v_pk_add_f32 v[26:27], v[30:31], v[42:43] op_sel:[0,0] op_sel_hi:[1,0] neg_lo:[0,1] neg_hi:[0,1]
    v_pk_add_f32 v[28:29], v[30:31], v[42:43] op_sel:[0,1] op_sel_hi:[1,1] neg_lo:[0,1] neg_hi:[0,1]
    v_cvt_pk_bf16_f32 v32, v14, v15
    v_lshlrev_b32 v14, 16, v32
    v_and_b32 v15, 0xffff0000, v32
    v_cvt_pk_bf16_f32 v32, v16, v17
    v_lshlrev_b32 v16, 16, v32
    v_and_b32 v17, 0xffff0000, v32
    v_cvt_pk_bf16_f32 v32, v18, v19
    v_lshlrev_b32 v18, 16, v32
    v_and_b32 v19, 0xffff0000, v32
    v_cvt_pk_bf16_f32 v32, v20, v21
    v_lshlrev_b32 v20, 16, v32
    v_and_b32 v21, 0xffff0000, v32
    v_cvt_pk_bf16_f32 v32, v22, v23
    v_lshlrev_b32 v22, 16, v32
    v_and_b32 v23, 0xffff0000, v32
    v_cvt_pk_bf16_f32 v32, v24, v25
    v_lshlrev_b32 v24, 16, v32
    v_and_b32 v25, 0xffff0000, v32
    v_cvt_pk_bf16_f32 v32, v26, v27
    v_lshlrev_b32 v26, 16, v32
    v_and_b32 v27, 0xffff0000, v32
    v_cvt_pk_bf16_f32 v32, v28, v29
    v_lshlrev_b32 v28, 16, v32
    v_and_b32 v29, 0xffff0000, v32
    v_pk_mul_f32 v[14:15], v[14:15], v[14:15]
    v_pk_mul_f32 v[16:17], v[16:17], v[16:17]
    v_pk_mul_f32 v[18:19], v[18:19], v[18:19]
    v_pk_mul_f32 v[20:21], v[20:21], v[20:21]
    v_pk_mul_f32 v[22:23], v[22:23], v[22:23]
    v_pk_mul_f32 v[24:25], v[24:25], v[24:25]
    v_pk_mul_f32 v[26:27], v[26:27], v[26:27]
    v_pk_mul_f32 v[28:29], v[28:29], v[28:29]
    v_cvt_pk_bf16_f32 v32, v14, v15
    v_lshlrev_b32 v14, 16, v32
    v_and_b32 v15, 0xffff0000, v32
    v_cvt_pk_bf16_f32 v32, v16, v17
    v_lshlrev_b32 v16, 16, v32
    v_and_b32 v17, 0xffff0000, v32
    v_cvt_pk_bf16_f32 v32, v18, v19
    v_lshlrev_b32 v18, 16, v32
    v_and_b32 v19, 0xffff0000, v32
    v_cvt_pk_bf16_f32 v32, v20, v21
    v_lshlrev_b32 v20, 16, v32
    v_and_b32 v21, 0xffff0000, v32
    v_cvt_pk_bf16_f32 v32, v22, v23
    v_lshlrev_b32 v22, 16, v32
    v_and_b32 v23, 0xffff0000, v32
    v_cvt_pk_bf16_f32 v32, v24, v25
    v_lshlrev_b32 v24, 16, v32
    v_and_b32 v25, 0xffff0000, v32
    v_cvt_pk_bf16_f32 v32, v26, v27
    v_lshlrev_b32 v26, 16, v32
    v_and_b32 v27, 0xffff0000, v32
    v_cvt_pk_bf16_f32 v32, v28, v29
    v_lshlrev_b32 v28, 16, v32
    v_and_b32 v29, 0xffff0000, v32
    v_mov_b32 v30, 1092616192
    v_mov_b32 v31, 0x3fb8aa3b
    v_pk_mul_f32 v[14:15], v[14:15], v[30:31] op_sel:[0,0] op_sel_hi:[1,0]
    v_pk_mul_f32 v[16:17], v[16:17], v[30:31] op_sel:[0,0] op_sel_hi:[1,0]
    v_pk_mul_f32 v[18:19], v[18:19], v[30:31] op_sel:[0,0] op_sel_hi:[1,0]
    v_pk_mul_f32 v[20:21], v[20:21], v[30:31] op_sel:[0,0] op_sel_hi:[1,0]
    v_pk_mul_f32 v[22:23], v[22:23], v[30:31] op_sel:[0,0] op_sel_hi:[1,0]
    v_pk_mul_f32 v[24:25], v[24:25], v[30:31] op_sel:[0,0] op_sel_hi:[1,0]
    v_pk_mul_f32 v[26:27], v[26:27], v[30:31] op_sel:[0,0] op_sel_hi:[1,0]
    v_pk_mul_f32 v[28:29], v[28:29], v[30:31] op_sel:[0,0] op_sel_hi:[1,0]
    v_cvt_pk_bf16_f32 v32, v14, v15
    v_lshlrev_b32 v14, 16, v32
    v_and_b32 v15, 0xffff0000, v32
    v_cvt_pk_bf16_f32 v32, v16, v17
    v_lshlrev_b32 v16, 16, v32
    v_and_b32 v17, 0xffff0000, v32
    v_cvt_pk_bf16_f32 v32, v18, v19
    v_lshlrev_b32 v18, 16, v32
    v_and_b32 v19, 0xffff0000, v32
    v_cvt_pk_bf16_f32 v32, v20, v21
    v_lshlrev_b32 v20, 16, v32
    v_and_b32 v21, 0xffff0000, v32
    v_cvt_pk_bf16_f32 v32, v22, v23
    v_lshlrev_b32 v22, 16, v32
    v_and_b32 v23, 0xffff0000, v32
    v_cvt_pk_bf16_f32 v32, v24, v25
    v_lshlrev_b32 v24, 16, v32
    v_and_b32 v25, 0xffff0000, v32
    v_cvt_pk_bf16_f32 v32, v26, v27
    v_lshlrev_b32 v26, 16, v32
    v_and_b32 v27, 0xffff0000, v32
    v_cvt_pk_bf16_f32 v32, v28, v29
    v_lshlrev_b32 v28, 16, v32
    v_and_b32 v29, 0xffff0000, v32
    v_pk_mul_f32 v[14:15], v[14:15], v[30:31] op_sel:[0,1] op_sel_hi:[1,1]
    v_pk_mul_f32 v[16:17], v[16:17], v[30:31] op_sel:[0,1] op_sel_hi:[1,1]
    v_pk_mul_f32 v[18:19], v[18:19], v[30:31] op_sel:[0,1] op_sel_hi:[1,1]
    v_pk_mul_f32 v[20:21], v[20:21], v[30:31] op_sel:[0,1] op_sel_hi:[1,1]
    v_pk_mul_f32 v[22:23], v[22:23], v[30:31] op_sel:[0,1] op_sel_hi:[1,1]
    v_pk_mul_f32 v[24:25], v[24:25], v[30:31] op_sel:[0,1] op_sel_hi:[1,1]
    v_pk_mul_f32 v[26:27], v[26:27], v[30:31] op_sel:[0,1] op_sel_hi:[1,1]
    v_pk_mul_f32 v[28:29], v[28:29], v[30:31] op_sel:[0,1] op_sel_hi:[1,1]
    v_exp_f32 v14, -v14
    v_exp_f32 v15, -v15
    v_exp_f32 v16, -v16
    v_exp_f32 v17, -v17
    v_exp_f32 v18, -v18
    v_exp_f32 v19, -v19
    v_exp_f32 v20, -v20
    v_exp_f32 v21, -v21
    v_exp_f32 v22, -v22
    v_exp_f32 v23, -v23
    v_exp_f32 v24, -v24
    v_exp_f32 v25, -v25
    v_exp_f32 v26, -v26
    v_exp_f32 v27, -v27
    v_exp_f32 v28, -v28
    v_exp_f32 v29, -v29
    v_cvt_pk_bf16_f32 v14, v14, v16
    v_cvt_pk_bf16_f32 v15, v15, v17
    v_cvt_pk_bf16_f32 v18, v18, v20
    v_cvt_pk_bf16_f32 v19, v19, v21
    v_cvt_pk_bf16_f32 v22, v22, v24
    v_cvt_pk_bf16_f32 v23, v23, v25
    v_cvt_pk_bf16_f32 v26, v26, v28
    v_cvt_pk_bf16_f32 v27, v27, v29
    v_dot2_f32_bf16 v112, v14, s68, 0
    v_dot2_f32_bf16 v113, v15, s68, 0
    v_dot2_f32_bf16 v114, v14, s69, 0
    v_dot2_f32_bf16 v115, v15, s69, 0
    v_dot2_f32_bf16 v116, v14, s70, 0
    v_dot2_f32_bf16 v117, v15, s70, 0
    v_dot2_f32_bf16 v118, v14, s71, 0
    v_dot2_f32_bf16 v119, v15, s71, 0
    v_dot2_f32_bf16 v120, v14, s52, 0
    v_dot2_f32_bf16 v121, v15, s52, 0
    v_dot2_f32_bf16 v122, v14, s53, 0
    v_dot2_f32_bf16 v123, v15, s53, 0
    v_dot2_f32_bf16 v124, v14, s54, 0
    v_dot2_f32_bf16 v125, v15, s54, 0
    v_dot2_f32_bf16 v126, v14, s55, 0
    v_dot2_f32_bf16 v127, v15, s55, 0
    v_dot2_f32_bf16 v112, v18, s72, v112
    v_dot2_f32_bf16 v113, v19, s72, v113
    v_dot2_f32_bf16 v114, v18, s73, v114
    v_dot2_f32_bf16 v115, v19, s73, v115
    v_dot2_f32_bf16 v116, v18, s74, v116
    v_dot2_f32_bf16 v117, v19, s74, v117
    v_dot2_f32_bf16 v118, v18, s75, v118
    v_dot2_f32_bf16 v119, v19, s75, v119
    v_dot2_f32_bf16 v120, v18, s56, v120
    v_dot2_f32_bf16 v121, v19, s56, v121
    v_dot2_f32_bf16 v122, v18, s57, v122
    v_dot2_f32_bf16 v123, v19, s57, v123
    v_dot2_f32_bf16 v124, v18, s58, v124
    v_dot2_f32_bf16 v125, v19, s58, v125
    v_dot2_f32_bf16 v126, v18, s59, v126
    v_dot2_f32_bf16 v127, v19, s59, v127
    v_dot2_f32_bf16 v112, v22, s76, v112
    v_dot2_f32_bf16 v113, v23, s76, v113
    v_dot2_f32_bf16 v114, v22, s77, v114
    v_dot2_f32_bf16 v115, v23, s77, v115
    v_dot2_f32_bf16 v116, v22, s78, v116
    v_dot2_f32_bf16 v117, v23, s78, v117
    v_dot2_f32_bf16 v118, v22, s79, v118
    v_dot2_f32_bf16 v119, v23, s79, v119
    v_dot2_f32_bf16 v120, v22, s60, v120
    v_dot2_f32_bf16 v121, v23, s60, v121
    v_dot2_f32_bf16 v122, v22, s61, v122
    v_dot2_f32_bf16 v123, v23, s61, v123
    v_dot2_f32_bf16 v124, v22, s62, v124
    v_dot2_f32_bf16 v125, v23, s62, v125
    v_dot2_f32_bf16 v126, v22, s63, v126
    v_dot2_f32_bf16 v127, v23, s63, v127
    v_dot2_f32_bf16 v112, v26, s80, v112
    v_dot2_f32_bf16 v113, v27, s80, v113
    v_dot2_f32_bf16 v114, v26, s81, v114
    v_dot2_f32_bf16 v115, v27, s81, v115
    v_dot2_f32_bf16 v116, v26, s82, v116
    v_dot2_f32_bf16 v117, v27, s82, v117
    v_dot2_f32_bf16 v118, v26, s83, v118
    v_dot2_f32_bf16 v119, v27, s83, v119
    v_dot2_f32_bf16 v120, v26, s64, v120
    v_dot2_f32_bf16 v121, v27, s64, v121
    v_dot2_f32_bf16 v122, v26, s65, v122
    v_dot2_f32_bf16 v123, v27, s65, v123
    v_dot2_f32_bf16 v124, v26, s66, v124
    v_dot2_f32_bf16 v125, v27, s66, v125
    v_dot2_f32_bf16 v126, v26, s67, v126
    v_dot2_f32_bf16 v127, v27, s67, v127
L_p2_kernel_g1_27:
    s_lshl2_add_u32 s14, s3, s49
    s_mul_i32 s26, s14, 20000
    s_add_u32 s15, s26, 8540160
    buffer_load_dwordx4 v[64:67], v1, s[4:7], s15 offen
    buffer_load_dwordx4 v[68:71], v2, s[4:7], s15 offen
    s_branch L_p2_fin
L_p2_done:
    s_branch L_p2_end
L_p2_slow:
    s_barrier
    v_mov_b32 v8, 0
    v_mov_b32 v9, 0
    v_mov_b32 v10, 0
    v_mov_b32 v11, 0
    v_mov_b32 v12, v1
    ds_write_b128 v12, v[8:11]
    v_add_u32 v12, 16384, v12
    ds_write_b128 v12, v[8:11]
    v_add_u32 v12, 16384, v12
    ds_write_b128 v12, v[8:11]
    v_add_u32 v12, 16384, v12
    ds_write_b128 v12, v[8:11]
    v_add_u32 v12, 16384, v12
    ds_write_b128 v12, v[8:11]
    v_add_u32 v12, 16384, v12
    ds_write_b128 v12, v[8:11]
    v_add_u32 v12, 16384, v12
    ds_write_b128 v12, v[8:11]
    v_add_u32 v12, 16384, v12
    ds_write_b128 v12, v[8:11]
    v_add_u32 v12, 16384, v12
    ds_write_b128 v12, v[8:11]
    v_add_u32 v12, 16384, v12
    ds_write_b128 v12, v[8:11]
    v_add_u32 v12, 16384, v12
    v_mul_u32_u24 v13, 8320, v0
    v_mov_b32 v29, 0x7fc00000
    v_add_u32 v28, 32, v13
    v_lshlrev_b32 v14, 10, v0
    v_add_u32 v14, 14680064, v14
    s_mul_i32 s25, s12, 65
    s_add_u32 s25, s25, s3
    s_lshl_b32 s25, s25, 5
    s_add_u32 s25, s25, 0
    s_lshl_b32 s50, s50, 1
    s_mul_i32 s22, s12, 1280000
    s_mov_b32 s24, 0
    s_waitcnt lgkmcnt(0)
    s_barrier
L_p2_sstep:
    buffer_load_ushort v15, v13, s[4:7], s25 offen
    buffer_load_ushort v16, v28, s[4:7], s25 offen
    s_waitcnt vmcnt(0)
L_p2_srec:
    v_cmp_lt_u32 vcc, v15, v16
    s_nop 1
    s_and_b64 exec, exec, vcc
    s_cbranch_execz L_p2_sdone
    v_mul_u32_u24 v17, 43691, v15
    v_lshrrev_b32 v17, 17, v17
    v_mad_i32_i24 v18, v17, -3, v15
    v_lshrrev_b32 v19, 6, v17
    v_lshl_add_u32 v19, v19, 20, v14
    v_and_b32 v17, 63, v17
    v_lshl_add_u32 v17, v17, 4, v19
    v_lshl_add_u32 v19, v18, 2, v17
    buffer_load_dword v20, v19, s[4:7], 0 offen
    buffer_load_dword v21, v17, s[4:7], 0 offen offset:12
    v_add_u32 v15, 1, v15
    v_mad_u32_u24 v18, v18, 10, 2
    s_waitcnt vmcnt(0)
    v_lshlrev_b32_sdwa v19, 3, v20 dst_sel:DWORD dst_unused:UNUSED_PAD src0_sel:DWORD src1_sel:WORD_0
    buffer_load_dwordx2 v[22:23], v19, s[8:11], s22 offen
    v_mad_u32_u16 v20, v20, 16, s50 op_sel:[1,0,0,0]
    v_bfe_i32 v21, v21, v18, 10
    v_cmp_eq_i32 vcc, -512, v21
    v_cvt_f32_i32 v21, v21
    v_mul_f32 v21, 989872160, v21
    v_cndmask_b32 v21, v21, v29, vcc
    s_waitcnt vmcnt(0)
    v_lshlrev_b32 v24, 16, v22
    v_and_b32 v25, 0xffff0000, v22
    v_lshlrev_b32 v26, 16, v23
    v_and_b32 v27, 0xffff0000, v23
    v_mul_f32 v24, v21, v24
    v_mul_f32 v25, v21, v25
    v_mul_f32 v26, v21, v26
    v_mul_f32 v27, v21, v27
    ds_add_f32 v20, v24
    ds_add_f32 v20, v25 offset:4
    ds_add_f32 v20, v26 offset:8
    ds_add_f32 v20, v27 offset:12
    s_branch L_p2_srec
L_p2_sdone:
    s_mov_b64 exec, -1
    s_add_u32 s25, s25, 2
    s_add_u32 s22, s22, 80000
    s_add_u32 s24, s24, 1
    s_cmp_lt_u32 s24, 16
    s_cbranch_scc1 L_p2_sstep
    s_waitcnt lgkmcnt(0)
    s_barrier
    s_mul_i32 s14, s12, 10240000
    s_mul_i32 s15, s3, 160000
    s_add_u32 s26, s14, s15
    s_add_u32 s26, s26, 254312448
    v_mov_b32 v12, v1
    s_mov_b32 s24, 0
L_p2_sout:
    v_cmp_gt_u32 vcc, 160000, v12
    ds_read_b128 v[8:11], v12
    s_nop 0
    s_and_b64 exec, exec, vcc
    s_cbranch_execz L_p2_sfin
    s_waitcnt lgkmcnt(0)
    buffer_store_dwordx4 v[8:11], v12, s[4:7], s26 offen sc1
    s_waitcnt vmcnt(0)
    v_add_u32 v12, 16384, v12
    s_branch L_p2_sout
L_p2_sfin:
    s_mov_b64 exec, -1
    s_waitcnt vmcnt(0) lgkmcnt(0)
    s_barrier
    s_branch L_p2_signal
L_p2_end:
    s_endpgm
.section .rodata,"a"
.p2align 6
.amdhsa_kernel p1_kernel
  .amdhsa_next_free_vgpr 128
  .amdhsa_next_free_sgpr 96
  .amdhsa_accum_offset 128
  .amdhsa_group_segment_fixed_size 0
  .amdhsa_kernarg_size 112
  .amdhsa_user_sgpr_count 2
  .amdhsa_user_sgpr_kernarg_segment_ptr 1
  .amdhsa_system_sgpr_workgroup_id_x 1
  .amdhsa_float_denorm_mode_32 0
.end_amdhsa_kernel
.p2align 6
.amdhsa_kernel p2_kernel
  .amdhsa_next_free_vgpr 128
  .amdhsa_next_free_sgpr 102
  .amdhsa_accum_offset 128
  .amdhsa_group_segment_fixed_size 0
  .amdhsa_kernarg_size 112
  .amdhsa_user_sgpr_count 2
  .amdhsa_user_sgpr_kernarg_segment_ptr 1
  .amdhsa_system_sgpr_workgroup_id_x 1
  .amdhsa_float_denorm_mode_32 0
.end_amdhsa_kernel
```

```asm
; @launch kernel=p1_kernel grid=(256,1,1) block=(1024,1,1) lds=163840
; @launch kernel=p2_kernel grid=(256,1,1) block=(1024,1,1) lds=163840
.amdgcn_target "amdgcn-amd-amdhsa--gfx950"
.text
.globl p1_kernel
.p2align 8
.type p1_kernel,@function
p1_kernel:
    s_cmp_ge_u32 s2, 256
    s_cbranch_scc1 L_p1_end
    s_load_dwordx2 s[4:5], s[0:1], 104
    s_load_dwordx2 s[8:9], s[0:1], 8
    s_load_dwordx2 s[12:13], s[0:1], 16
    s_load_dwordx2 s[16:17], s[0:1], 32
    s_load_dwordx2 s[28:29], s[0:1], 0
    s_load_dwordx2 s[6:7], s[0:1], 48
    v_cmp_gt_u32 vcc, 256, v0
    s_nop 1
    s_cbranch_vccz L_p1_nopf
    s_getpc_b64 s[72:73]
L_p1_kernel_pc_1:
    s_add_u32 s72, s72, L_p1_nopf-L_p1_kernel_pc_1
    s_addc_u32 s73, s73, 0
    v_lshlrev_b32 v14, 7, v0
    v_min_u32 v14, L_p2_end-L_p1_nopf, v14
    global_load_dword v15, v14, s[72:73]
L_p1_nopf:
    v_lshlrev_b32 v1, 4, v0
    v_lshlrev_b32 v2, 3, v0
    v_lshrrev_b32 v6, 6, v0
    v_mul_u32_u24 v3, 851904, v6
    v_add_lshl_u32 v3, v3, v0, 4
    v_mov_b32 v4, 1
    v_mov_b32 v5, 0
    v_readfirstlane_b32 s39, v6
    v_cmp_gt_u32 vcc, 784, v0
    s_and_b32 s51, s2, 7
    s_lshl_b32 s51, s51, 0
    s_bfe_u32 s35, s2, 3
    s_add_u32 s51, s51, s35
    s_and_b32 s35, s2, 248
    s_add_u32 s51, s51, s35
    s_and_b32 s32, s2, 7
    s_lshl_b32 s32, s32, 2
    s_bfe_u32 s35, s2, 131075
    s_add_u32 s32, s32, s35
    s_and_b32 s35, s2, 224
    s_add_u32 s32, s32, s35
    s_lshr_b32 s35, s39, 4
    s_mul_i32 s36, s35, 4177920
    s_lshl_b32 s33, s51, 14
    s_add_u32 s33, s33, s36
    s_lshr_b32 s34, s33, 1
    s_mul_i32 s48, s51, 3840
    s_cmp_ge_u32 s35, 0
    s_cselect_b32 s48, s48, 0
    s_lshr_b32 s49, s48, 1
    s_mov_b64 s[44:45], vcc
    s_waitcnt lgkmcnt(0)
    s_load_dword s3, s[6:7], 0
    s_mov_b32 s10, 163840000
    s_mov_b32 s11, 0x00020000
    s_mov_b32 s14, 163840000
    s_mov_b32 s15, 0x00020000
    s_mov_b32 s18, 81920000
    s_mov_b32 s19, 0x00020000
    s_mul_i32 s36, s2, 20000
    s_add_u32 s30, s36, 20000
    s_mov_b32 s31, 0x00020000
    s_add_u32 s35, s36, 16384
    buffer_load_dwordx4 v[48:51], v1, s[28:31], s36 offen
    buffer_load_dwordx4 v[52:55], v1, s[28:31], s35 offen
    s_add_u32 s35, s33, 0
    buffer_load_dwordx4 v[16:19], v1, s[8:11], s35 offen nt
    s_add_u32 s35, s33, 0
    buffer_load_dwordx4 v[20:23], v1, s[12:15], s35 offen nt
    s_add_u32 s35, s33, 4194304
    buffer_load_dwordx4 v[24:27], v1, s[8:11], s35 offen nt
    s_add_u32 s35, s33, 4194304
    buffer_load_dwordx4 v[28:31], v1, s[12:15], s35 offen nt
    s_add_u32 s35, s33, 8388608
    buffer_load_dwordx4 v[32:35], v1, s[8:11], s35 offen nt
    s_add_u32 s35, s33, 8388608
    buffer_load_dwordx4 v[36:39], v1, s[12:15], s35 offen nt
    s_add_u32 s35, s33, 12582912
    buffer_load_dwordx4 v[40:43], v1, s[8:11], s35 offen nt
    s_add_u32 s35, s33, 12582912
    buffer_load_dwordx4 v[44:47], v1, s[12:15], s35 offen nt
    s_add_u32 s35, s33, 16777216
    buffer_load_dwordx4 v[72:75], v1, s[8:11], s35 offen nt
    s_add_u32 s35, s33, 16777216
    buffer_load_dwordx4 v[76:79], v1, s[12:15], s35 offen nt
    s_mov_b32 s20, s4
    s_mov_b32 s21, s5
    s_mov_b32 s22, 0
    s_mov_b32 s23, 0x00020000
    s_add_u32 s24, s4, 0
    s_addc_u32 s25, s5, 0
    s_mov_b32 s26, 8540160
    s_mov_b32 s27, 0x00020000
    s_mov_b32 s37, 1492179184
    s_mov_b32 s55, 0
    s_mov_b32 s50, 21845
    s_mov_b32 s38, 262400
    s_mov_b32 s43, 0x05040100
    s_mov_b32 s40, 0
    v_mov_b32 v8, 0
    v_mov_b32 v9, 0
    v_mov_b32 v10, 0
    v_mov_b32 v11, 0
    ds_write_b128 v1, v[8:11] offset:0
    s_waitcnt lgkmcnt(0)
    s_lshl_b32 s3, s3, 16
    v_mov_b32 v12, s3
    v_mul_f32 v12, 0.15915494, v12
    s_nop 0
    v_readfirstlane_b32 s41, v12
    s_waitcnt vmcnt(10)
    v_mov_b32 v12, 0x3f803f80
    v_and_b32 v48, 0x7fff7fff, v48
    v_and_b32 v49, 0x7fff7fff, v49
    v_and_b32 v50, 0x7fff7fff, v50
    v_and_b32 v51, 0x7fff7fff, v51
    v_and_b32 v52, 0x7fff7fff, v52
    v_and_b32 v53, 0x7fff7fff, v53
    v_and_b32 v54, 0x7fff7fff, v54
    v_and_b32 v55, 0x7fff7fff, v55
    v_pk_max_u16 v8, v8, v48
    v_dot2c_f32_bf16 v9, v48, v12
    v_pk_max_u16 v8, v8, v49
    v_dot2c_f32_bf16 v9, v49, v12
    v_pk_max_u16 v8, v8, v50
    v_dot2c_f32_bf16 v9, v50, v12
    v_pk_max_u16 v8, v8, v51
    v_dot2c_f32_bf16 v9, v51, v12
    v_pk_max_u16 v8, v8, v52
    v_dot2c_f32_bf16 v9, v52, v12
    v_pk_max_u16 v8, v8, v53
    v_dot2c_f32_bf16 v9, v53, v12
    v_pk_max_u16 v8, v8, v54
    v_dot2c_f32_bf16 v9, v54, v12
    v_pk_max_u16 v8, v8, v55
    v_dot2c_f32_bf16 v9, v55, v12
    v_lshrrev_b32 v10, 16, v8
    v_and_b32 v8, 0xffff, v8
    v_max_u32 v8, v8, v10
    s_nop 0
    s_nop 1
    v_max_u32_dpp v8, v8, v8 row_shr:1 row_mask:0xf bank_mask:0xf bound_ctrl:0
    s_nop 1
    v_max_u32_dpp v8, v8, v8 row_shr:2 row_mask:0xf bank_mask:0xf bound_ctrl:0
    s_nop 1
    v_max_u32_dpp v8, v8, v8 row_shr:4 row_mask:0xf bank_mask:0xf bound_ctrl:0
    s_nop 1
    v_max_u32_dpp v8, v8, v8 row_shr:8 row_mask:0xf bank_mask:0xf bound_ctrl:0
    s_nop 1
    v_max_u32_dpp v8, v8, v8 row_bcast:15 row_mask:0xa bank_mask:0xf
    s_nop 1
    v_max_u32_dpp v8, v8, v8 row_bcast:31 row_mask:0xc bank_mask:0xf
    s_nop 1
    v_add_f32_dpp v9, v9, v9 row_shr:1 row_mask:0xf bank_mask:0xf bound_ctrl:0
    s_nop 1
    v_add_f32_dpp v9, v9, v9 row_shr:2 row_mask:0xf bank_mask:0xf bound_ctrl:0
    s_nop 1
    v_add_f32_dpp v9, v9, v9 row_shr:4 row_mask:0xf bank_mask:0xf bound_ctrl:0
    s_nop 1
    v_add_f32_dpp v9, v9, v9 row_shr:8 row_mask:0xf bank_mask:0xf bound_ctrl:0
    s_nop 1
    v_add_f32_dpp v9, v9, v9 row_bcast:15 row_mask:0xa bank_mask:0xf
    s_nop 1
    v_add_f32_dpp v9, v9, v9 row_bcast:31 row_mask:0xc bank_mask:0xf
    s_lshl_b32 s35, s39, 4
    s_add_u32 s35, s35, 160320
    v_mov_b32 v10, s35
    s_mov_b32 exec_lo, 0
    s_brev_b32 exec_hi, 1
    ds_write_b64 v10, v[8:9]
    s_mov_b64 exec, -1
    s_waitcnt lgkmcnt(0)
    s_barrier
    s_branch L_p1_first
L_p1_loop:
    s_getreg_b32 s51, hwreg(HW_REG_XCC_ID, 0, 1)
    s_cmp_eq_u32 s51, 0
    s_cselect_b64 vcc, -1, 0
    s_waitcnt lgkmcnt(13)
    v_lshlrev_b32 v15, 22, v100
    v_lshrrev_b32 v100, 16, v100
    v_alignbit_b32 v15, v100, v15, 10
    v_alignbit_b32 v15, v101, v15, 10
    v_xor_b32 v15, 0x80200800, v15
    s_cmp_lg_u32 s39, 15
    s_cbranch_scc1 L_p1_kernel_nox_2
    s_mov_b32 s36, 13631488
    buffer_store_dwordx4 v[12:15], v3, s[20:23], s36 offen sc1
L_p1_kernel_nox_2:
    s_waitcnt lgkmcnt(12)
    v_lshlrev_b32 v75, 22, v102
    v_lshrrev_b32 v102, 16, v102
    v_alignbit_b32 v75, v102, v75, 10
    v_alignbit_b32 v75, v103, v75, 10
    v_xor_b32 v75, 0x80200800, v75
    s_mov_b32 s36, 0
    buffer_store_dwordx4 v[72:75], v3, s[20:23], s36 offen sc1
    s_waitcnt lgkmcnt(11)
    v_lshlrev_b32 v79, 22, v104
    v_lshrrev_b32 v104, 16, v104
    v_alignbit_b32 v79, v104, v79, 10
    v_alignbit_b32 v79, v105, v79, 10
    v_xor_b32 v79, 0x80200800, v79
    s_mov_b32 s36, 1048576
    buffer_store_dwordx4 v[76:79], v3, s[20:23], s36 offen sc1
    s_waitcnt lgkmcnt(10)
    v_lshlrev_b32 v51, 22, v106
    v_lshrrev_b32 v106, 16, v106
    v_alignbit_b32 v51, v106, v51, 10
    v_alignbit_b32 v51, v107, v51, 10
    v_xor_b32 v51, 0x80200800, v51
    s_mov_b32 s36, 2097152
    buffer_store_dwordx4 v[48:51], v3, s[20:23], s36 offen sc1
    s_add_u32 s35, s33, 16777216
    buffer_load_dwordx4 v[72:75], v1, s[8:11], s35 offen nt
    s_add_u32 s35, s33, 16777216
    buffer_load_dwordx4 v[76:79], v1, s[12:15], s35 offen nt
    s_cbranch_vccz L_p1_kernel_thr_3
    s_waitcnt vmcnt(2)
L_p1_kernel_thr_3:
    s_waitcnt lgkmcnt(9)
    v_lshlrev_b32 v83, 22, v108
    v_lshrrev_b32 v108, 16, v108
    v_alignbit_b32 v83, v108, v83, 10
    v_alignbit_b32 v83, v109, v83, 10
    v_xor_b32 v83, 0x80200800, v83
    s_mov_b32 s36, 3145728
    buffer_store_dwordx4 v[80:83], v3, s[20:23], s36 offen sc1
    s_waitcnt lgkmcnt(8)
    v_lshlrev_b32 v55, 22, v110
    v_lshrrev_b32 v110, 16, v110
    v_alignbit_b32 v55, v110, v55, 10
    v_alignbit_b32 v55, v111, v55, 10
    v_xor_b32 v55, 0x80200800, v55
    s_mov_b32 s36, 4194304
    buffer_store_dwordx4 v[52:55], v3, s[20:23], s36 offen sc1
    s_add_u32 s35, s33, 20971520
    buffer_load_dwordx4 v[80:83], v1, s[8:11], s35 offen nt
    s_add_u32 s35, s33, 20971520
    buffer_load_dwordx4 v[100:103], v1, s[12:15], s35 offen nt
    s_cbranch_vccz L_p1_kernel_thr_4
    s_waitcnt vmcnt(2)
L_p1_kernel_thr_4:
    s_waitcnt lgkmcnt(7)
    v_lshlrev_b32 v87, 22, v112
    v_lshrrev_b32 v112, 16, v112
    v_alignbit_b32 v87, v112, v87, 10
    v_alignbit_b32 v87, v113, v87, 10
    v_xor_b32 v87, 0x80200800, v87
    s_mov_b32 s36, 5242880
    buffer_store_dwordx4 v[84:87], v3, s[20:23], s36 offen sc1
    s_waitcnt lgkmcnt(6)
    v_lshlrev_b32 v59, 22, v114
    v_lshrrev_b32 v114, 16, v114
    v_alignbit_b32 v59, v114, v59, 10
    v_alignbit_b32 v59, v115, v59, 10
    v_xor_b32 v59, 0x80200800, v59
    s_mov_b32 s36, 6291456
    buffer_store_dwordx4 v[56:59], v3, s[20:23], s36 offen sc1
    s_add_u32 s35, s33, 25165824
    buffer_load_dwordx4 v[84:87], v1, s[8:11], s35 offen nt
    s_add_u32 s35, s33, 25165824
    buffer_load_dwordx4 v[104:107], v1, s[12:15], s35 offen nt
    s_cbranch_vccz L_p1_kernel_thr_5
    s_waitcnt vmcnt(2)
L_p1_kernel_thr_5:
    s_waitcnt lgkmcnt(5)
    v_lshlrev_b32 v91, 22, v116
    v_lshrrev_b32 v116, 16, v116
    v_alignbit_b32 v91, v116, v91, 10
    v_alignbit_b32 v91, v117, v91, 10
    v_xor_b32 v91, 0x80200800, v91
    s_mov_b32 s36, 7340032
    buffer_store_dwordx4 v[88:91], v3, s[20:23], s36 offen sc1
    s_waitcnt lgkmcnt(4)
    v_lshlrev_b32 v63, 22, v118
    v_lshrrev_b32 v118, 16, v118
    v_alignbit_b32 v63, v118, v63, 10
    v_alignbit_b32 v63, v119, v63, 10
    v_xor_b32 v63, 0x80200800, v63
    s_mov_b32 s36, 8388608
    buffer_store_dwordx4 v[60:63], v3, s[20:23], s36 offen sc1
    s_add_u32 s35, s33, 29360128
    buffer_load_dwordx4 v[88:91], v1, s[8:11], s35 offen nt
    s_add_u32 s35, s33, 29360128
    buffer_load_dwordx4 v[108:111], v1, s[12:15], s35 offen nt
    s_cbranch_vccz L_p1_kernel_thr_6
    s_waitcnt vmcnt(2)
L_p1_kernel_thr_6:
    s_waitcnt lgkmcnt(3)
    v_lshlrev_b32 v95, 22, v120
    v_lshrrev_b32 v120, 16, v120
    v_alignbit_b32 v95, v120, v95, 10
    v_alignbit_b32 v95, v121, v95, 10
    v_xor_b32 v95, 0x80200800, v95
    s_mov_b32 s36, 9437184
    buffer_store_dwordx4 v[92:95], v3, s[20:23], s36 offen sc1
    s_waitcnt lgkmcnt(2)
    v_lshlrev_b32 v67, 22, v122
    v_lshrrev_b32 v122, 16, v122
    v_alignbit_b32 v67, v122, v67, 10
    v_alignbit_b32 v67, v123, v67, 10
    v_xor_b32 v67, 0x80200800, v67
    s_mov_b32 s36, 10485760
    buffer_store_dwordx4 v[64:67], v3, s[20:23], s36 offen sc1
    s_add_u32 s35, s33, 33554432
    buffer_load_dwordx4 v[92:95], v1, s[8:11], s35 offen nt
    s_add_u32 s35, s33, 33554432
    buffer_load_dwordx4 v[112:115], v1, s[12:15], s35 offen nt
    s_cbranch_vccz L_p1_kernel_thr_7
    s_waitcnt vmcnt(2)
L_p1_kernel_thr_7:
    s_waitcnt lgkmcnt(1)
    v_lshlrev_b32 v99, 22, v124
    v_lshrrev_b32 v124, 16, v124
    v_alignbit_b32 v99, v124, v99, 10
    v_alignbit_b32 v99, v125, v99, 10
    v_xor_b32 v99, 0x80200800, v99
    s_mov_b32 s36, 11534336
    buffer_store_dwordx4 v[96:99], v3, s[20:23], s36 offen sc1
    s_waitcnt lgkmcnt(0)
    v_lshlrev_b32 v71, 22, v126
    v_lshrrev_b32 v126, 16, v126
    v_alignbit_b32 v71, v126, v71, 10
    v_alignbit_b32 v71, v127, v71, 10
    v_xor_b32 v71, 0x80200800, v71
    s_mov_b32 s36, 12582912
    buffer_store_dwordx4 v[68:71], v3, s[20:23], s36 offen sc1
    s_add_u32 s35, s33, 37748736
    s_sub_u32 s35, s35, s48
    v_cndmask_b32 v96, 2.0, v1, s[44:45]
    buffer_load_dwordx4 v[96:99], v96, s[8:11], s35 offen nt
    s_add_u32 s35, s33, 37748736
    s_sub_u32 s35, s35, s48
    v_cndmask_b32 v116, 2.0, v1, s[44:45]
    buffer_load_dwordx4 v[116:119], v116, s[12:15], s35 offen nt
    s_cbranch_vccz L_p1_kernel_thr_8
    s_waitcnt vmcnt(2)
L_p1_kernel_thr_8:
    s_branch L_p1_join
L_p1_first:
    s_add_u32 s35, s33, 20971520
    buffer_load_dwordx4 v[80:83], v1, s[8:11], s35 offen nt
    s_add_u32 s35, s33, 20971520
    buffer_load_dwordx4 v[100:103], v1, s[12:15], s35 offen nt
    s_add_u32 s35, s33, 25165824
    buffer_load_dwordx4 v[84:87], v1, s[8:11], s35 offen nt
    s_add_u32 s35, s33, 25165824
    buffer_load_dwordx4 v[104:107], v1, s[12:15], s35 offen nt
    s_add_u32 s35, s33, 29360128
    buffer_load_dwordx4 v[88:91], v1, s[8:11], s35 offen nt
    s_add_u32 s35, s33, 29360128
    buffer_load_dwordx4 v[108:111], v1, s[12:15], s35 offen nt
    s_add_u32 s35, s33, 33554432
    buffer_load_dwordx4 v[92:95], v1, s[8:11], s35 offen nt
    s_add_u32 s35, s33, 33554432
    buffer_load_dwordx4 v[112:115], v1, s[12:15], s35 offen nt
    s_add_u32 s35, s33, 37748736
    s_sub_u32 s35, s35, s48
    v_cndmask_b32 v96, 2.0, v1, s[44:45]
    buffer_load_dwordx4 v[96:99], v96, s[8:11], s35 offen nt
    s_add_u32 s35, s33, 37748736
    s_sub_u32 s35, s35, s48
    v_cndmask_b32 v116, 2.0, v1, s[44:45]
    buffer_load_dwordx4 v[116:119], v116, s[12:15], s35 offen nt
L_p1_join:
    s_waitcnt vmcnt(18)
    v_perm_b32 v6, v20, v16, s43
    v_perm_b32 v7, v21, v17, s43
    v_perm_b32 v8, v22, v18, s43
    v_perm_b32 v9, v23, v19, s43
    v_mul_hi_u32_u24 v16, 429497, v16
    v_mul_hi_u32_u24 v20, 429497, v20
    v_mul_hi_u32_u24 v17, 429497, v17
    v_mul_hi_u32_u24 v21, 429497, v21
    v_mul_hi_u32_u24 v18, 429497, v18
    v_mul_hi_u32_u24 v22, 429497, v22
    v_mul_hi_u32_u24 v19, 429497, v19
    v_mul_hi_u32_u24 v23, 429497, v23
    v_lshl_or_b32 v16, v20, 16, v16
    v_lshl_or_b32 v17, v21, 16, v17
    v_lshl_or_b32 v18, v22, 16, v18
    v_lshl_or_b32 v19, v23, 16, v19
    v_dot2_u32_u16 v20, v16, s38, 0
    v_dot2_u32_u16 v21, v17, s38, 0
    v_dot2_u32_u16 v22, v18, s38, 0
    v_dot2_u32_u16 v23, v19, s38, 0
    v_pk_mad_u16 v6, v16, s37, v6
    v_pk_mad_u16 v7, v17, s37, v7
    v_pk_mad_u16 v8, v18, s37, v8
    v_pk_mad_u16 v9, v19, s37, v9
    ds_add_u32 v20, v4 offset:0
    ds_add_u32 v21, v4 offset:0
    ds_add_u32 v22, v4 offset:0
    ds_add_u32 v23, v4 offset:0
    v_perm_b32 v55, v23, v22, s43
    v_perm_b32 v51, v21, v20, s43
    v_or_b32 v48, 0x40000000, v6
    v_or_b32 v49, 0x40000000, v7
    v_or_b32 v50, 0x40000000, v8
    v_or_b32 v52, 0x40000000, v9
    s_waitcnt vmcnt(16)
    v_perm_b32 v6, v28, v24, s43
    v_perm_b32 v7, v29, v25, s43
    v_perm_b32 v8, v30, v26, s43
    v_perm_b32 v9, v31, v27, s43
    v_mul_hi_u32_u24 v24, 429497, v24
    v_mul_hi_u32_u24 v28, 429497, v28
    v_mul_hi_u32_u24 v25, 429497, v25
    v_mul_hi_u32_u24 v29, 429497, v29
    v_mul_hi_u32_u24 v26, 429497, v26
    v_mul_hi_u32_u24 v30, 429497, v30
    v_mul_hi_u32_u24 v27, 429497, v27
    v_mul_hi_u32_u24 v31, 429497, v31
    v_lshl_or_b32 v24, v28, 16, v24
    v_lshl_or_b32 v25, v29, 16, v25
    v_lshl_or_b32 v26, v30, 16, v26
    v_lshl_or_b32 v27, v31, 16, v27
    v_dot2_u32_u16 v28, v24, s38, 0
    v_dot2_u32_u16 v29, v25, s38, 0
    v_dot2_u32_u16 v30, v26, s38, 0
    v_dot2_u32_u16 v31, v27, s38, 0
    v_pk_mad_u16 v6, v24, s37, v6
    v_pk_mad_u16 v7, v25, s37, v7
    v_pk_mad_u16 v8, v26, s37, v8
    v_pk_mad_u16 v9, v27, s37, v9
    ds_add_u32 v28, v4 offset:0
    ds_add_u32 v29, v4 offset:0
    ds_add_u32 v30, v4 offset:0
    ds_add_u32 v31, v4 offset:0
    v_perm_b32 v63, v31, v30, s43
    v_perm_b32 v59, v29, v28, s43
    v_or_b32 v53, 0x40000000, v6
    v_or_b32 v54, 0x40000000, v7
    v_or_b32 v56, 0x40000000, v8
    v_or_b32 v57, 0x40000000, v9
    s_waitcnt vmcnt(14)
    v_perm_b32 v6, v36, v32, s43
    v_perm_b32 v7, v37, v33, s43
    v_perm_b32 v8, v38, v34, s43
    v_perm_b32 v9, v39, v35, s43
    v_mul_hi_u32_u24 v32, 429497, v32
    v_mul_hi_u32_u24 v36, 429497, v36
    v_mul_hi_u32_u24 v33, 429497, v33
    v_mul_hi_u32_u24 v37, 429497, v37
    v_mul_hi_u32_u24 v34, 429497, v34
    v_mul_hi_u32_u24 v38, 429497, v38
    v_mul_hi_u32_u24 v35, 429497, v35
    v_mul_hi_u32_u24 v39, 429497, v39
    v_lshl_or_b32 v32, v36, 16, v32
    v_lshl_or_b32 v33, v37, 16, v33
    v_lshl_or_b32 v34, v38, 16, v34
    v_lshl_or_b32 v35, v39, 16, v35
    v_dot2_u32_u16 v36, v32, s38, 0
    v_dot2_u32_u16 v37, v33, s38, 0
    v_dot2_u32_u16 v38, v34, s38, 0
    v_dot2_u32_u16 v39, v35, s38, 0
    v_pk_mad_u16 v6, v32, s37, v6
    v_pk_mad_u16 v7, v33, s37, v7
    v_pk_mad_u16 v8, v34, s37, v8
    v_pk_mad_u16 v9, v35, s37, v9
    ds_add_u32 v36, v4 offset:0
    ds_add_u32 v37, v4 offset:0
    ds_add_u32 v38, v4 offset:0
    ds_add_u32 v39, v4 offset:0
    v_perm_b32 v71, v39, v38, s43
    v_perm_b32 v67, v37, v36, s43
    v_or_b32 v58, 0x40000000, v6
    v_or_b32 v60, 0x40000000, v7
    v_or_b32 v61, 0x40000000, v8
    v_or_b32 v62, 0x40000000, v9
    s_waitcnt vmcnt(12)
    v_perm_b32 v6, v44, v40, s43
    v_perm_b32 v7, v45, v41, s43
    v_perm_b32 v8, v46, v42, s43
    v_perm_b32 v9, v47, v43, s43
    v_mul_hi_u32_u24 v40, 429497, v40
    v_mul_hi_u32_u24 v44, 429497, v44
    v_mul_hi_u32_u24 v41, 429497, v41
    v_mul_hi_u32_u24 v45, 429497, v45
    v_mul_hi_u32_u24 v42, 429497, v42
    v_mul_hi_u32_u24 v46, 429497, v46
    v_mul_hi_u32_u24 v43, 429497, v43
    v_mul_hi_u32_u24 v47, 429497, v47
    v_lshl_or_b32 v40, v44, 16, v40
    v_lshl_or_b32 v41, v45, 16, v41
    v_lshl_or_b32 v42, v46, 16, v42
    v_lshl_or_b32 v43, v47, 16, v43
    v_dot2_u32_u16 v44, v40, s38, 0
    v_dot2_u32_u16 v45, v41, s38, 0
    v_dot2_u32_u16 v46, v42, s38, 0
    v_dot2_u32_u16 v47, v43, s38, 0
    v_pk_mad_u16 v6, v40, s37, v6
    v_pk_mad_u16 v7, v41, s37, v7
    v_pk_mad_u16 v8, v42, s37, v8
    v_pk_mad_u16 v9, v43, s37, v9
    ds_add_u32 v44, v4 offset:0
    ds_add_u32 v45, v4 offset:0
    ds_add_u32 v46, v4 offset:0
    ds_add_u32 v47, v4 offset:0
    v_perm_b32 v121, v47, v46, s43
    v_perm_b32 v120, v45, v44, s43
    v_or_b32 v64, 0x40000000, v6
    v_or_b32 v65, 0x40000000, v7
    v_or_b32 v66, 0x40000000, v8
    v_or_b32 v68, 0x40000000, v9
    s_waitcnt vmcnt(10)
    v_perm_b32 v6, v76, v72, s43
    v_perm_b32 v7, v77, v73, s43
    v_perm_b32 v8, v78, v74, s43
    v_perm_b32 v9, v79, v75, s43
    v_mul_hi_u32_u24 v72, 429497, v72
    v_mul_hi_u32_u24 v76, 429497, v76
    v_mul_hi_u32_u24 v73, 429497, v73
    v_mul_hi_u32_u24 v77, 429497, v77
    v_mul_hi_u32_u24 v74, 429497, v74
    v_mul_hi_u32_u24 v78, 429497, v78
    v_mul_hi_u32_u24 v75, 429497, v75
    v_mul_hi_u32_u24 v79, 429497, v79
    v_lshl_or_b32 v72, v76, 16, v72
    v_lshl_or_b32 v73, v77, 16, v73
    v_lshl_or_b32 v74, v78, 16, v74
    v_lshl_or_b32 v75, v79, 16, v75
    v_dot2_u32_u16 v76, v72, s38, 0
    v_dot2_u32_u16 v77, v73, s38, 0
    v_dot2_u32_u16 v78, v74, s38, 0
    v_dot2_u32_u16 v79, v75, s38, 0
    v_pk_mad_u16 v6, v72, s37, v6
    v_pk_mad_u16 v7, v73, s37, v7
    v_pk_mad_u16 v8, v74, s37, v8
    v_pk_mad_u16 v9, v75, s37, v9
    ds_add_u32 v76, v4 offset:0
    ds_add_u32 v77, v4 offset:0
    ds_add_u32 v78, v4 offset:0
    ds_add_u32 v79, v4 offset:0
    v_perm_b32 v123, v79, v78, s43
    v_perm_b32 v122, v77, v76, s43
    v_or_b32 v69, 0x40000000, v6
    v_or_b32 v70, 0x40000000, v7
    v_or_b32 v127, 0x40000000, v8
    v_or_b32 v72, 0x40000000, v9
    s_waitcnt vmcnt(8)
    v_perm_b32 v6, v100, v80, s43
    v_perm_b32 v7, v101, v81, s43
    v_perm_b32 v8, v102, v82, s43
    v_perm_b32 v9, v103, v83, s43
    v_mul_hi_u32_u24 v80, 429497, v80
    v_mul_hi_u32_u24 v100, 429497, v100
    v_mul_hi_u32_u24 v81, 429497, v81
    v_mul_hi_u32_u24 v101, 429497, v101
    v_mul_hi_u32_u24 v82, 429497, v82
    v_mul_hi_u32_u24 v102, 429497, v102
    v_mul_hi_u32_u24 v83, 429497, v83
    v_mul_hi_u32_u24 v103, 429497, v103
    v_lshl_or_b32 v80, v100, 16, v80
    v_lshl_or_b32 v81, v101, 16, v81
    v_lshl_or_b32 v82, v102, 16, v82
    v_lshl_or_b32 v83, v103, 16, v83
    v_dot2_u32_u16 v100, v80, s38, 0
    v_dot2_u32_u16 v101, v81, s38, 0
    v_dot2_u32_u16 v102, v82, s38, 0
    v_dot2_u32_u16 v103, v83, s38, 0
    v_pk_mad_u16 v6, v80, s37, v6
    v_pk_mad_u16 v7, v81, s37, v7
    v_pk_mad_u16 v8, v82, s37, v8
    v_pk_mad_u16 v9, v83, s37, v9
    ds_add_u32 v100, v4 offset:0
    ds_add_u32 v101, v4 offset:0
    ds_add_u32 v102, v4 offset:0
    ds_add_u32 v103, v4 offset:0
    v_perm_b32 v125, v103, v102, s43
    v_perm_b32 v124, v101, v100, s43
    v_or_b32 v73, 0x40000000, v6
    v_or_b32 v74, 0x40000000, v7
    v_or_b32 v76, 0x40000000, v8
    v_or_b32 v77, 0x40000000, v9
    s_waitcnt vmcnt(6)
    v_perm_b32 v6, v104, v84, s43
    v_perm_b32 v7, v105, v85, s43
    v_perm_b32 v8, v106, v86, s43
    v_perm_b32 v9, v107, v87, s43
    v_mul_hi_u32_u24 v84, 429497, v84
    v_mul_hi_u32_u24 v104, 429497, v104
    v_mul_hi_u32_u24 v85, 429497, v85
    v_mul_hi_u32_u24 v105, 429497, v105
    v_mul_hi_u32_u24 v86, 429497, v86
    v_mul_hi_u32_u24 v106, 429497, v106
    v_mul_hi_u32_u24 v87, 429497, v87
    v_mul_hi_u32_u24 v107, 429497, v107
    v_lshl_or_b32 v84, v104, 16, v84
    v_lshl_or_b32 v85, v105, 16, v85
    v_lshl_or_b32 v86, v106, 16, v86
    v_lshl_or_b32 v87, v107, 16, v87
    v_dot2_u32_u16 v104, v84, s38, 0
    v_dot2_u32_u16 v105, v85, s38, 0
    v_dot2_u32_u16 v106, v86, s38, 0
    v_dot2_u32_u16 v107, v87, s38, 0
    v_pk_mad_u16 v6, v84, s37, v6
    v_pk_mad_u16 v7, v85, s37, v7
    v_pk_mad_u16 v8, v86, s37, v8
    v_pk_mad_u16 v9, v87, s37, v9
    ds_add_u32 v104, v4 offset:0
    ds_add_u32 v105, v4 offset:0
    ds_add_u32 v106, v4 offset:0
    ds_add_u32 v107, v4 offset:0
    v_perm_b32 v75, v107, v106, s43
    v_perm_b32 v126, v105, v104, s43
    v_or_b32 v78, 0x40000000, v6
    v_or_b32 v80, 0x40000000, v7
    v_or_b32 v81, 0x40000000, v8
    v_or_b32 v82, 0x40000000, v9
    s_waitcnt vmcnt(4)
    v_perm_b32 v6, v108, v88, s43
    v_perm_b32 v7, v109, v89, s43
    v_perm_b32 v8, v110, v90, s43
    v_perm_b32 v9, v111, v91, s43
    v_mul_hi_u32_u24 v88, 429497, v88
    v_mul_hi_u32_u24 v108, 429497, v108
    v_mul_hi_u32_u24 v89, 429497, v89
    v_mul_hi_u32_u24 v109, 429497, v109
    v_mul_hi_u32_u24 v90, 429497, v90
    v_mul_hi_u32_u24 v110, 429497, v110
    v_mul_hi_u32_u24 v91, 429497, v91
    v_mul_hi_u32_u24 v111, 429497, v111
    v_lshl_or_b32 v88, v108, 16, v88
    v_lshl_or_b32 v89, v109, 16, v89
    v_lshl_or_b32 v90, v110, 16, v90
    v_lshl_or_b32 v91, v111, 16, v91
    v_dot2_u32_u16 v108, v88, s38, 0
    v_dot2_u32_u16 v109, v89, s38, 0
    v_dot2_u32_u16 v110, v90, s38, 0
    v_dot2_u32_u16 v111, v91, s38, 0
    v_pk_mad_u16 v6, v88, s37, v6
    v_pk_mad_u16 v7, v89, s37, v7
    v_pk_mad_u16 v8, v90, s37, v8
    v_pk_mad_u16 v9, v91, s37, v9
    ds_add_u32 v108, v4 offset:0
    ds_add_u32 v109, v4 offset:0
    ds_add_u32 v110, v4 offset:0
    ds_add_u32 v111, v4 offset:0
    v_perm_b32 v83, v111, v110, s43
    v_perm_b32 v79, v109, v108, s43
    v_or_b32 v84, 0x40000000, v6
    v_or_b32 v85, 0x40000000, v7
    v_or_b32 v86, 0x40000000, v8
    v_or_b32 v88, 0x40000000, v9
    s_waitcnt vmcnt(2)
    v_perm_b32 v6, v112, v92, s43
    v_perm_b32 v7, v113, v93, s43
    v_perm_b32 v8, v114, v94, s43
    v_perm_b32 v9, v115, v95, s43
    v_mul_hi_u32_u24 v92, 429497, v92
    v_mul_hi_u32_u24 v112, 429497, v112
    v_mul_hi_u32_u24 v93, 429497, v93
    v_mul_hi_u32_u24 v113, 429497, v113
    v_mul_hi_u32_u24 v94, 429497, v94
    v_mul_hi_u32_u24 v114, 429497, v114
    v_mul_hi_u32_u24 v95, 429497, v95
    v_mul_hi_u32_u24 v115, 429497, v115
    v_lshl_or_b32 v92, v112, 16, v92
    v_lshl_or_b32 v93, v113, 16, v93
    v_lshl_or_b32 v94, v114, 16, v94
    v_lshl_or_b32 v95, v115, 16, v95
    v_dot2_u32_u16 v112, v92, s38, 0
    v_dot2_u32_u16 v113, v93, s38, 0
    v_dot2_u32_u16 v114, v94, s38, 0
    v_dot2_u32_u16 v115, v95, s38, 0
    v_pk_mad_u16 v6, v92, s37, v6
    v_pk_mad_u16 v7, v93, s37, v7
    v_pk_mad_u16 v8, v94, s37, v8
    v_pk_mad_u16 v9, v95, s37, v9
    ds_add_u32 v112, v4 offset:0
    ds_add_u32 v113, v4 offset:0
    ds_add_u32 v114, v4 offset:0
    ds_add_u32 v115, v4 offset:0
    v_perm_b32 v91, v115, v114, s43
    v_perm_b32 v87, v113, v112, s43
    v_or_b32 v89, 0x40000000, v6
    v_or_b32 v90, 0x40000000, v7
    v_or_b32 v92, 0x40000000, v8
    v_or_b32 v93, 0x40000000, v9
    s_waitcnt vmcnt(0)
    s_mov_b64 exec, s[44:45]
    v_perm_b32 v6, v116, v96, s43
    v_perm_b32 v7, v117, v97, s43
    v_perm_b32 v8, v118, v98, s43
    v_perm_b32 v9, v119, v99, s43
    v_mul_hi_u32_u24 v96, 429497, v96
    v_mul_hi_u32_u24 v116, 429497, v116
    v_mul_hi_u32_u24 v97, 429497, v97
    v_mul_hi_u32_u24 v117, 429497, v117
    v_mul_hi_u32_u24 v98, 429497, v98
    v_mul_hi_u32_u24 v118, 429497, v118
    v_mul_hi_u32_u24 v99, 429497, v99
    v_mul_hi_u32_u24 v119, 429497, v119
    v_lshl_or_b32 v96, v116, 16, v96
    v_lshl_or_b32 v97, v117, 16, v97
    v_lshl_or_b32 v98, v118, 16, v98
    v_lshl_or_b32 v99, v119, 16, v99
    v_dot2_u32_u16 v116, v96, s38, 0
    v_dot2_u32_u16 v117, v97, s38, 0
    v_dot2_u32_u16 v118, v98, s38, 0
    v_dot2_u32_u16 v119, v99, s38, 0
    v_pk_mad_u16 v6, v96, s37, v6
    v_pk_mad_u16 v7, v97, s37, v7
    v_pk_mad_u16 v8, v98, s37, v8
    v_pk_mad_u16 v9, v99, s37, v9
    ds_add_u32 v116, v4 offset:0
    ds_add_u32 v117, v4 offset:0
    ds_add_u32 v118, v4 offset:0
    ds_add_u32 v119, v4 offset:0
    v_perm_b32 v99, v119, v118, s43
    v_perm_b32 v95, v117, v116, s43
    v_or_b32 v94, 0x40000000, v6
    v_or_b32 v96, 0x40000000, v7
    v_or_b32 v97, 0x40000000, v8
    v_or_b32 v98, 0x40000000, v9
    s_mov_b64 exec, -1
    s_add_u32 s35, s34, 0
    buffer_load_dwordx2 v[100:101], v2, s[16:19], s35 offen nt
    s_lshl_b32 s35, s32, 10
    s_add_u32 s35, s35, 9437184
    s_add_u32 s20, s4, s35
    s_addc_u32 s21, s5, 0
    s_waitcnt lgkmcnt(0)
    s_barrier
    ds_read_b128 v[8:11], v1 offset:0
    s_add_u32 s35, s34, 2097152
    buffer_load_dwordx2 v[102:103], v2, s[16:19], s35 offen nt
    s_lshl_b32 s35, s39, 2
    s_add_u32 s35, s35, 160256
    v_mov_b32 v7, s35
    v_and_b32 v14, 15, v0
    v_lshlrev_b32 v14, 2, v14
    v_add_u32 v14, 160256, v14
    s_waitcnt lgkmcnt(0)
    v_cmp_eq_u32 s[56:57], 0, v8
    v_cmp_ge_u32 s[64:65], 1, v8
    v_max_u32 v12, 2, v8
    v_lshl_or_b32 v8, v8, 16, v12
    v_cmp_eq_u32 s[58:59], 0, v9
    v_cmp_ge_u32 s[66:67], 1, v9
    v_max_u32 v12, 2, v9
    v_lshl_or_b32 v9, v9, 16, v12
    v_cmp_eq_u32 s[60:61], 0, v10
    v_cmp_ge_u32 s[68:69], 1, v10
    v_max_u32 v12, 2, v10
    v_lshl_or_b32 v10, v10, 16, v12
    v_cmp_eq_u32 s[62:63], 0, v11
    v_cmp_ge_u32 s[70:71], 1, v11
    v_max_u32 v12, 2, v11
    v_lshl_or_b32 v11, v11, 16, v12
    v_add_u32 v9, v8, v9
    v_add_u32 v10, v9, v10
    v_add_u32 v11, v10, v11
    v_mov_b32 v6, v11
    s_nop 1
    v_add_u32_dpp v6, v6, v6 row_shr:1 row_mask:0xf bank_mask:0xf bound_ctrl:0
    s_nop 1
    v_add_u32_dpp v6, v6, v6 row_shr:2 row_mask:0xf bank_mask:0xf bound_ctrl:0
    s_nop 1
    v_add_u32_dpp v6, v6, v6 row_shr:4 row_mask:0xf bank_mask:0xf bound_ctrl:0
    s_nop 1
    v_add_u32_dpp v6, v6, v6 row_shr:8 row_mask:0xf bank_mask:0xf bound_ctrl:0
    s_nop 1
    v_add_u32_dpp v6, v6, v6 row_bcast:15 row_mask:0xa bank_mask:0xf
    s_nop 1
    v_add_u32_dpp v6, v6, v6 row_bcast:31 row_mask:0xc bank_mask:0xf
    s_mov_b32 exec_lo, 0
    s_brev_b32 exec_hi, 1
    ds_write_b32 v7, v6
    s_mov_b64 exec, -1
    v_sub_u32 v6, v6, v11
    s_or_b64 s[46:47], s[64:65], s[66:67]
    s_or_b64 vcc, s[68:69], s[70:71]
    s_or_b64 s[46:47], s[46:47], vcc
    s_waitcnt lgkmcnt(0)
    s_barrier
    ds_read_b32 v7, v14
    s_add_u32 s35, s34, 4194304
    buffer_load_dwordx2 v[104:105], v2, s[16:19], s35 offen nt
    s_waitcnt lgkmcnt(0)
    v_mov_b32 v15, v7
    s_nop 1
    v_add_u32_dpp v7, v7, v7 row_shr:1 row_mask:0xf bank_mask:0xf bound_ctrl:0
    s_nop 1
    v_add_u32_dpp v7, v7, v7 row_shr:2 row_mask:0xf bank_mask:0xf bound_ctrl:0
    s_nop 1
    v_add_u32_dpp v7, v7, v7 row_shr:4 row_mask:0xf bank_mask:0xf bound_ctrl:0
    s_nop 1
    v_add_u32_dpp v7, v7, v7 row_shr:8 row_mask:0xf bank_mask:0xf bound_ctrl:0
    s_nop 0
    v_readlane_b32 s54, v7, 15
    v_sub_u32 v7, v7, v15
    s_nop 0
    v_readlane_b32 s35, v7, s39
    s_and_b32 s54, s54, 0xffff
    s_cmp_ge_u32 s54, 40063
    s_cselect_b32 s36, 16, 0
    s_cselect_b32 s54, 40000, s54
    s_cselect_b32 s55, 1, s55
    s_cselect_b64 s[46:47], 0, s[46:47]
    v_add_u32 v12, s35, v6
    v_add_u32 v13, v12, v8
    v_add_u32 v14, v12, v9
    v_add_u32 v15, v12, v10
    v_bfe_u32 v12, v12, s36, 16
    v_bfe_u32 v13, v13, s36, 16
    v_bfe_u32 v14, v14, s36, 16
    v_bfe_u32 v15, v15, s36, 16
    ds_write_b128 v1, v[12:15] offset:0
    ds_write_b128 v1, v[12:15] offset:16384
    v_mov_b32 v6, 32768
    v_mov_b32 v7, s54
    s_mov_b64 exec, 1
    ds_write_b32 v6, v7
    s_mov_b64 exec, -1
    s_add_u32 s35, s54, 2
    s_mul_hi_u32 s35, s35, 1431655766
    s_lshl_b32 s35, s35, 4
    s_add_u32 s35, s35, 217890816
    s_min_u32 s22, s35, 218104832
    v_perm_b32 v15, v15, v14, s43
    v_perm_b32 v14, v13, v12, s43
    s_waitcnt lgkmcnt(0)
    s_barrier
    s_nop 0
    v_and_b32 v6, 0xffff, v51
    v_lshrrev_b32 v7, 16, v51
    v_and_b32 v8, 0xffff, v55
    v_lshrrev_b32 v9, 16, v55
    ds_add_rtn_u32 v6, v6, v4 offset:0
    ds_add_rtn_u32 v7, v7, v4 offset:0
    ds_add_rtn_u32 v8, v8, v4 offset:0
    ds_add_rtn_u32 v9, v9, v4 offset:0
    v_and_b32 v10, 0xffff, v59
    v_lshrrev_b32 v11, 16, v59
    v_and_b32 v12, 0xffff, v63
    v_lshrrev_b32 v13, 16, v63
    ds_add_rtn_u32 v10, v10, v4 offset:0
    ds_add_rtn_u32 v11, v11, v4 offset:0
    ds_add_rtn_u32 v12, v12, v4 offset:0
    ds_add_rtn_u32 v13, v13, v4 offset:0
    s_waitcnt lgkmcnt(4)
    v_perm_b32 v51, v7, v6, s43
    v_perm_b32 v55, v9, v8, s43
    v_and_b32 v6, 0xffff, v67
    v_lshrrev_b32 v7, 16, v67
    v_and_b32 v8, 0xffff, v71
    v_lshrrev_b32 v9, 16, v71
    ds_add_rtn_u32 v6, v6, v4 offset:0
    ds_add_rtn_u32 v7, v7, v4 offset:0
    ds_add_rtn_u32 v8, v8, v4 offset:0
    ds_add_rtn_u32 v9, v9, v4 offset:0
    s_waitcnt lgkmcnt(4)
    v_perm_b32 v59, v11, v10, s43
    v_perm_b32 v63, v13, v12, s43
    s_add_u32 s35, s34, 6291456
    buffer_load_dwordx2 v[106:107], v2, s[16:19], s35 offen nt
    v_and_b32 v10, 0xffff, v120
    v_lshrrev_b32 v11, 16, v120
    v_and_b32 v12, 0xffff, v121
    v_lshrrev_b32 v13, 16, v121
    ds_add_rtn_u32 v10, v10, v4 offset:0
    ds_add_rtn_u32 v11, v11, v4 offset:0
    ds_add_rtn_u32 v12, v12, v4 offset:0
    ds_add_rtn_u32 v13, v13, v4 offset:0
    s_waitcnt lgkmcnt(4)
    v_perm_b32 v67, v7, v6, s43
    v_perm_b32 v71, v9, v8, s43
    s_add_u32 s35, s34, 8388608
    buffer_load_dwordx2 v[108:109], v2, s[16:19], s35 offen nt
    v_and_b32 v6, 0xffff, v122
    v_lshrrev_b32 v7, 16, v122
    v_and_b32 v8, 0xffff, v123
    v_lshrrev_b32 v9, 16, v123
    ds_add_rtn_u32 v6, v6, v4 offset:0
    ds_add_rtn_u32 v7, v7, v4 offset:0
    ds_add_rtn_u32 v8, v8, v4 offset:0
    ds_add_rtn_u32 v9, v9, v4 offset:0
    s_waitcnt lgkmcnt(4)
    v_perm_b32 v120, v11, v10, s43
    v_perm_b32 v121, v13, v12, s43
    s_add_u32 s35, s34, 10485760
    buffer_load_dwordx2 v[110:111], v2, s[16:19], s35 offen nt
    v_and_b32 v10, 0xffff, v124
    v_lshrrev_b32 v11, 16, v124
    v_and_b32 v12, 0xffff, v125
    v_lshrrev_b32 v13, 16, v125
    ds_add_rtn_u32 v10, v10, v4 offset:0
    ds_add_rtn_u32 v11, v11, v4 offset:0
    ds_add_rtn_u32 v12, v12, v4 offset:0
    ds_add_rtn_u32 v13, v13, v4 offset:0
    s_waitcnt lgkmcnt(4)
    v_perm_b32 v122, v7, v6, s43
    v_perm_b32 v123, v9, v8, s43
    v_and_b32 v6, 0xffff, v126
    v_lshrrev_b32 v7, 16, v126
    v_and_b32 v8, 0xffff, v75
    v_lshrrev_b32 v9, 16, v75
    ds_add_rtn_u32 v6, v6, v4 offset:0
    ds_add_rtn_u32 v7, v7, v4 offset:0
    ds_add_rtn_u32 v8, v8, v4 offset:0
    ds_add_rtn_u32 v9, v9, v4 offset:0
    s_waitcnt lgkmcnt(4)
    v_perm_b32 v124, v11, v10, s43
    v_perm_b32 v125, v13, v12, s43
    s_add_u32 s35, s34, 12582912
    buffer_load_dwordx2 v[112:113], v2, s[16:19], s35 offen nt
    v_and_b32 v10, 0xffff, v79
    v_lshrrev_b32 v11, 16, v79
    v_and_b32 v12, 0xffff, v83
    v_lshrrev_b32 v13, 16, v83
    ds_add_rtn_u32 v10, v10, v4 offset:0
    ds_add_rtn_u32 v11, v11, v4 offset:0
    ds_add_rtn_u32 v12, v12, v4 offset:0
    ds_add_rtn_u32 v13, v13, v4 offset:0
    s_waitcnt lgkmcnt(4)
    v_perm_b32 v126, v7, v6, s43
    v_perm_b32 v75, v9, v8, s43
    s_add_u32 s35, s34, 14680064
    buffer_load_dwordx2 v[114:115], v2, s[16:19], s35 offen nt
    v_and_b32 v6, 0xffff, v87
    v_lshrrev_b32 v7, 16, v87
    v_and_b32 v8, 0xffff, v91
    v_lshrrev_b32 v9, 16, v91
    ds_add_rtn_u32 v6, v6, v4 offset:0
    ds_add_rtn_u32 v7, v7, v4 offset:0
    ds_add_rtn_u32 v8, v8, v4 offset:0
    ds_add_rtn_u32 v9, v9, v4 offset:0
    s_waitcnt lgkmcnt(4)
    v_perm_b32 v79, v11, v10, s43
    v_perm_b32 v83, v13, v12, s43
    s_add_u32 s35, s34, 16777216
    buffer_load_dwordx2 v[116:117], v2, s[16:19], s35 offen nt
    s_mov_b64 exec, s[44:45]
    v_and_b32 v10, 0xffff, v95
    v_lshrrev_b32 v11, 16, v95
    v_and_b32 v12, 0xffff, v99
    v_lshrrev_b32 v13, 16, v99
    ds_add_rtn_u32 v10, v10, v4 offset:0
    ds_add_rtn_u32 v11, v11, v4 offset:0
    ds_add_rtn_u32 v12, v12, v4 offset:0
    ds_add_rtn_u32 v13, v13, v4 offset:0
    s_mov_b64 exec, -1
    s_waitcnt lgkmcnt(4)
    v_perm_b32 v87, v7, v6, s43
    v_perm_b32 v91, v9, v8, s43
    s_add_u32 s35, s34, 18874368
    s_sub_u32 s35, s35, s49
    v_cndmask_b32 v118, 2.0, v2, s[44:45]
    buffer_load_dwordx2 v[118:119], v118, s[16:19], s35 offen nt
    s_waitcnt lgkmcnt(0)
    v_perm_b32 v95, v11, v10, s43
    v_perm_b32 v99, v13, v12, s43
    s_cmp_gt_u32 s39, 8
    s_cbranch_scc1 L_p1_kernel_notab_9
    v_lshrrev_b32 v6, 1, v0
    v_mul_u32_u24 v7, 1009, v6
    v_lshrrev_b32 v7, 16, v7
    v_mul_u32_u24 v7, 959, v7
    v_and_b32 v8, 1, v0
    v_lshl_add_u32 v7, v8, 9, v7
    v_add_lshl_u32 v13, v7, v6, 2
    ds_read2st64_b32 v[6:7], v13 offset0:64 offset1:65
    ds_read2st64_b32 v[8:9], v13 offset0:66 offset1:67
    ds_read2st64_b32 v[10:11], v13 offset0:68 offset1:69
    ds_read2st64_b32 v[12:13], v13 offset0:70 offset1:71
    s_mul_i32 s35, s32, 8320
    s_add_u32 s26, s35, 8320
    s_waitcnt lgkmcnt(3)
    v_perm_b32 v6, v7, v6, s43
    s_waitcnt lgkmcnt(2)
    v_perm_b32 v7, v9, v8, s43
    s_waitcnt lgkmcnt(1)
    v_perm_b32 v8, v11, v10, s43
    s_waitcnt lgkmcnt(0)
    v_perm_b32 v9, v13, v12, s43
    buffer_store_dwordx4 v[6:9], v1, s[24:27], s35 offen sc1
    s_nop 1
L_p1_kernel_notab_9:
    s_barrier
    s_lshl_b32 s35, s54, 2
    v_mov_b32 v6, s35
    v_mov_b32 v7, 0
    v_mov_b32 v12, 1140817920
    s_mov_b64 exec, 1
    ds_write2_b32 v6, v7, v7 offset0:0 offset1:1
    s_cmp_eq_u64 s[46:47], 0
    s_cbranch_scc1 L_p1_kernel_nonull_10
    s_mov_b64 exec, s[64:65]
    v_lshlrev_b32_sdwa v6, 2, v14 dst_sel:DWORD dst_unused:UNUSED_PAD src0_sel:DWORD src1_sel:WORD_0
    ds_write_b32 v6, v7 offset:4
    s_mov_b64 exec, s[56:57]
    ds_write_b32 v6, v7
    s_mov_b64 exec, s[66:67]
    v_lshlrev_b32_sdwa v6, 2, v14 dst_sel:DWORD dst_unused:UNUSED_PAD src0_sel:DWORD src1_sel:WORD_1
    ds_write_b32 v6, v7 offset:4
    s_mov_b64 exec, s[58:59]
    ds_write_b32 v6, v7
    s_mov_b64 exec, s[68:69]
    v_lshlrev_b32_sdwa v6, 2, v15 dst_sel:DWORD dst_unused:UNUSED_PAD src0_sel:DWORD src1_sel:WORD_0
    ds_write_b32 v6, v7 offset:4
    s_mov_b64 exec, s[60:61]
    ds_write_b32 v6, v7
    s_mov_b64 exec, s[70:71]
    v_lshlrev_b32_sdwa v6, 2, v15 dst_sel:DWORD dst_unused:UNUSED_PAD src0_sel:DWORD src1_sel:WORD_1
    ds_write_b32 v6, v7 offset:4
    s_mov_b64 exec, s[62:63]
    ds_write_b32 v6, v7
L_p1_kernel_nonull_10:
    s_mov_b64 exec, -1
    v_lshlrev_b32_sdwa v6, 2, v51 dst_sel:DWORD dst_unused:UNUSED_PAD src0_sel:DWORD src1_sel:WORD_0
    v_lshlrev_b32_sdwa v7, 2, v51 dst_sel:DWORD dst_unused:UNUSED_PAD src0_sel:DWORD src1_sel:WORD_1
    v_lshlrev_b32_sdwa v8, 2, v55 dst_sel:DWORD dst_unused:UNUSED_PAD src0_sel:DWORD src1_sel:WORD_0
    v_lshlrev_b32_sdwa v9, 2, v55 dst_sel:DWORD dst_unused:UNUSED_PAD src0_sel:DWORD src1_sel:WORD_1
    ds_write_b32 v6, v48
    ds_write_b32 v7, v49
    ds_write_b32 v8, v50
    ds_write_b32 v9, v52
    s_waitcnt vmcnt(9)
    v_lshlrev_b32 v10, 16, v100
    v_lshlrev_b32 v11, 16, v101
    v_and_b32 v100, 0xffff0000, v100
    v_and_b32 v101, 0xffff0000, v101
    v_mul_f32 v10, s41, v10
    v_mul_f32 v100, s41, v100
    v_mul_f32 v11, s41, v11
    v_mul_f32 v101, s41, v101
    v_fract_f32 v10, v10
    v_fract_f32 v100, v100
    v_fract_f32 v11, v11
    v_fract_f32 v101, v101
    v_cos_f32 v10, v10
    v_cos_f32 v100, v100
    v_cos_f32 v11, v11
    v_cos_f32 v101, v101
    v_fmaak_f32 v10, v12, v10, 1262486016
    v_fmaak_f32 v100, v12, v100, 1262486016
    v_fmaak_f32 v11, v12, v11, 1262486016
    v_fmaak_f32 v101, v12, v101, 1262486016
    v_or3_b32 v5, v10, v100, v5
    v_or3_b32 v5, v11, v101, v5
    v_perm_b32 v100, v100, v10, s43
    v_perm_b32 v101, v101, v11, s43
    s_add_u32 s35, s33, 40960000
    buffer_load_dwordx4 v[16:19], v1, s[8:11], s35 offen nt
    v_lshlrev_b32_sdwa v6, 2, v59 dst_sel:DWORD dst_unused:UNUSED_PAD src0_sel:DWORD src1_sel:WORD_0
    v_lshlrev_b32_sdwa v7, 2, v59 dst_sel:DWORD dst_unused:UNUSED_PAD src0_sel:DWORD src1_sel:WORD_1
    v_lshlrev_b32_sdwa v8, 2, v63 dst_sel:DWORD dst_unused:UNUSED_PAD src0_sel:DWORD src1_sel:WORD_0
    v_lshlrev_b32_sdwa v9, 2, v63 dst_sel:DWORD dst_unused:UNUSED_PAD src0_sel:DWORD src1_sel:WORD_1
    ds_write_b32 v6, v53
    ds_write_b32 v7, v54
    ds_write_b32 v8, v56
    ds_write_b32 v9, v57
    s_waitcnt vmcnt(9)
    v_lshlrev_b32 v10, 16, v102
    v_lshlrev_b32 v11, 16, v103
    v_and_b32 v102, 0xffff0000, v102
    v_and_b32 v103, 0xffff0000, v103
    v_mul_f32 v10, s41, v10
    v_mul_f32 v102, s41, v102
    v_mul_f32 v11, s41, v11
    v_mul_f32 v103, s41, v103
    v_fract_f32 v10, v10
    v_fract_f32 v102, v102
    v_fract_f32 v11, v11
    v_fract_f32 v103, v103
    v_cos_f32 v10, v10
    v_cos_f32 v102, v102
    v_cos_f32 v11, v11
    v_cos_f32 v103, v103
    v_fmaak_f32 v10, v12, v10, 1262486016
    v_fmaak_f32 v102, v12, v102, 1262486016
    v_fmaak_f32 v11, v12, v11, 1262486016
    v_fmaak_f32 v103, v12, v103, 1262486016
    v_or3_b32 v5, v10, v102, v5
    v_or3_b32 v5, v11, v103, v5
    v_perm_b32 v102, v102, v10, s43
    v_perm_b32 v103, v103, v11, s43
    v_lshlrev_b32_sdwa v6, 2, v67 dst_sel:DWORD dst_unused:UNUSED_PAD src0_sel:DWORD src1_sel:WORD_0
    v_lshlrev_b32_sdwa v7, 2, v67 dst_sel:DWORD dst_unused:UNUSED_PAD src0_sel:DWORD src1_sel:WORD_1
    v_lshlrev_b32_sdwa v8, 2, v71 dst_sel:DWORD dst_unused:UNUSED_PAD src0_sel:DWORD src1_sel:WORD_0
    v_lshlrev_b32_sdwa v9, 2, v71 dst_sel:DWORD dst_unused:UNUSED_PAD src0_sel:DWORD src1_sel:WORD_1
    ds_write_b32 v6, v58
    ds_write_b32 v7, v60
    ds_write_b32 v8, v61
    ds_write_b32 v9, v62
    v_lshlrev_b32_sdwa v6, 2, v120 dst_sel:DWORD dst_unused:UNUSED_PAD src0_sel:DWORD src1_sel:WORD_0
    v_lshlrev_b32_sdwa v7, 2, v120 dst_sel:DWORD dst_unused:UNUSED_PAD src0_sel:DWORD src1_sel:WORD_1
    v_lshlrev_b32_sdwa v8, 2, v121 dst_sel:DWORD dst_unused:UNUSED_PAD src0_sel:DWORD src1_sel:WORD_0
    v_lshlrev_b32_sdwa v9, 2, v121 dst_sel:DWORD dst_unused:UNUSED_PAD src0_sel:DWORD src1_sel:WORD_1
    ds_write_b32 v6, v64
    ds_write_b32 v7, v65
    ds_write_b32 v8, v66
    ds_write_b32 v9, v68
    s_waitcnt vmcnt(8)
    v_lshlrev_b32 v10, 16, v104
    v_lshlrev_b32 v11, 16, v105
    v_and_b32 v104, 0xffff0000, v104
    v_and_b32 v105, 0xffff0000, v105
    v_mul_f32 v10, s41, v10
    v_mul_f32 v104, s41, v104
    v_mul_f32 v11, s41, v11
    v_mul_f32 v105, s41, v105
    v_fract_f32 v10, v10
    v_fract_f32 v104, v104
    v_fract_f32 v11, v11
    v_fract_f32 v105, v105
    v_cos_f32 v10, v10
    v_cos_f32 v104, v104
    v_cos_f32 v11, v11
    v_cos_f32 v105, v105
    v_fmaak_f32 v10, v12, v10, 1262486016
    v_fmaak_f32 v104, v12, v104, 1262486016
    v_fmaak_f32 v11, v12, v11, 1262486016
    v_fmaak_f32 v105, v12, v105, 1262486016
    v_or3_b32 v5, v10, v104, v5
    v_or3_b32 v5, v11, v105, v5
    v_perm_b32 v104, v104, v10, s43
    v_perm_b32 v105, v105, v11, s43
    s_add_u32 s35, s33, 40960000
    buffer_load_dwordx4 v[20:23], v1, s[12:15], s35 offen nt
    v_lshlrev_b32_sdwa v6, 2, v122 dst_sel:DWORD dst_unused:UNUSED_PAD src0_sel:DWORD src1_sel:WORD_0
    v_lshlrev_b32_sdwa v7, 2, v122 dst_sel:DWORD dst_unused:UNUSED_PAD src0_sel:DWORD src1_sel:WORD_1
    v_lshlrev_b32_sdwa v8, 2, v123 dst_sel:DWORD dst_unused:UNUSED_PAD src0_sel:DWORD src1_sel:WORD_0
    v_lshlrev_b32_sdwa v9, 2, v123 dst_sel:DWORD dst_unused:UNUSED_PAD src0_sel:DWORD src1_sel:WORD_1
    ds_write_b32 v6, v69
    ds_write_b32 v7, v70
    ds_write_b32 v8, v127
    ds_write_b32 v9, v72
    s_waitcnt vmcnt(8)
    v_lshlrev_b32 v10, 16, v106
    v_lshlrev_b32 v11, 16, v107
    v_and_b32 v106, 0xffff0000, v106
    v_and_b32 v107, 0xffff0000, v107
    v_mul_f32 v10, s41, v10
    v_mul_f32 v106, s41, v106
    v_mul_f32 v11, s41, v11
    v_mul_f32 v107, s41, v107
    v_fract_f32 v10, v10
    v_fract_f32 v106, v106
    v_fract_f32 v11, v11
    v_fract_f32 v107, v107
    v_cos_f32 v10, v10
    v_cos_f32 v106, v106
    v_cos_f32 v11, v11
    v_cos_f32 v107, v107
    v_fmaak_f32 v10, v12, v10, 1262486016
    v_fmaak_f32 v106, v12, v106, 1262486016
    v_fmaak_f32 v11, v12, v11, 1262486016
    v_fmaak_f32 v107, v12, v107, 1262486016
    v_or3_b32 v5, v10, v106, v5
    v_or3_b32 v5, v11, v107, v5
    v_perm_b32 v106, v106, v10, s43
    v_perm_b32 v107, v107, v11, s43
    v_lshlrev_b32_sdwa v6, 2, v124 dst_sel:DWORD dst_unused:UNUSED_PAD src0_sel:DWORD src1_sel:WORD_0
    v_lshlrev_b32_sdwa v7, 2, v124 dst_sel:DWORD dst_unused:UNUSED_PAD src0_sel:DWORD src1_sel:WORD_1
    v_lshlrev_b32_sdwa v8, 2, v125 dst_sel:DWORD dst_unused:UNUSED_PAD src0_sel:DWORD src1_sel:WORD_0
    v_lshlrev_b32_sdwa v9, 2, v125 dst_sel:DWORD dst_unused:UNUSED_PAD src0_sel:DWORD src1_sel:WORD_1
    ds_write_b32 v6, v73
    ds_write_b32 v7, v74
    ds_write_b32 v8, v76
    ds_write_b32 v9, v77
    v_lshlrev_b32_sdwa v6, 2, v126 dst_sel:DWORD dst_unused:UNUSED_PAD src0_sel:DWORD src1_sel:WORD_0
    v_lshlrev_b32_sdwa v7, 2, v126 dst_sel:DWORD dst_unused:UNUSED_PAD src0_sel:DWORD src1_sel:WORD_1
    v_lshlrev_b32_sdwa v8, 2, v75 dst_sel:DWORD dst_unused:UNUSED_PAD src0_sel:DWORD src1_sel:WORD_0
    v_lshlrev_b32_sdwa v9, 2, v75 dst_sel:DWORD dst_unused:UNUSED_PAD src0_sel:DWORD src1_sel:WORD_1
    ds_write_b32 v6, v78
    ds_write_b32 v7, v80
    ds_write_b32 v8, v81
    ds_write_b32 v9, v82
    s_waitcnt vmcnt(7)
    v_lshlrev_b32 v10, 16, v108
    v_lshlrev_b32 v11, 16, v109
    v_and_b32 v108, 0xffff0000, v108
    v_and_b32 v109, 0xffff0000, v109
    v_mul_f32 v10, s41, v10
    v_mul_f32 v108, s41, v108
    v_mul_f32 v11, s41, v11
    v_mul_f32 v109, s41, v109
    v_fract_f32 v10, v10
    v_fract_f32 v108, v108
    v_fract_f32 v11, v11
    v_fract_f32 v109, v109
    v_cos_f32 v10, v10
    v_cos_f32 v108, v108
    v_cos_f32 v11, v11
    v_cos_f32 v109, v109
    v_fmaak_f32 v10, v12, v10, 1262486016
    v_fmaak_f32 v108, v12, v108, 1262486016
    v_fmaak_f32 v11, v12, v11, 1262486016
    v_fmaak_f32 v109, v12, v109, 1262486016
    v_or3_b32 v5, v10, v108, v5
    v_or3_b32 v5, v11, v109, v5
    v_perm_b32 v108, v108, v10, s43
    v_perm_b32 v109, v109, v11, s43
    s_add_u32 s35, s33, 45154304
    buffer_load_dwordx4 v[24:27], v1, s[8:11], s35 offen nt
    v_lshlrev_b32_sdwa v6, 2, v79 dst_sel:DWORD dst_unused:UNUSED_PAD src0_sel:DWORD src1_sel:WORD_0
    v_lshlrev_b32_sdwa v7, 2, v79 dst_sel:DWORD dst_unused:UNUSED_PAD src0_sel:DWORD src1_sel:WORD_1
    v_lshlrev_b32_sdwa v8, 2, v83 dst_sel:DWORD dst_unused:UNUSED_PAD src0_sel:DWORD src1_sel:WORD_0
    v_lshlrev_b32_sdwa v9, 2, v83 dst_sel:DWORD dst_unused:UNUSED_PAD src0_sel:DWORD src1_sel:WORD_1
    ds_write_b32 v6, v84
    ds_write_b32 v7, v85
    ds_write_b32 v8, v86
    ds_write_b32 v9, v88
    s_waitcnt vmcnt(7)
    v_lshlrev_b32 v10, 16, v110
    v_lshlrev_b32 v11, 16, v111
    v_and_b32 v110, 0xffff0000, v110
    v_and_b32 v111, 0xffff0000, v111
    v_mul_f32 v10, s41, v10
    v_mul_f32 v110, s41, v110
    v_mul_f32 v11, s41, v11
    v_mul_f32 v111, s41, v111
    v_fract_f32 v10, v10
    v_fract_f32 v110, v110
    v_fract_f32 v11, v11
    v_fract_f32 v111, v111
    v_cos_f32 v10, v10
    v_cos_f32 v110, v110
    v_cos_f32 v11, v11
    v_cos_f32 v111, v111
    v_fmaak_f32 v10, v12, v10, 1262486016
    v_fmaak_f32 v110, v12, v110, 1262486016
    v_fmaak_f32 v11, v12, v11, 1262486016
    v_fmaak_f32 v111, v12, v111, 1262486016
    v_or3_b32 v5, v10, v110, v5
    v_or3_b32 v5, v11, v111, v5
    v_perm_b32 v110, v110, v10, s43
    v_perm_b32 v111, v111, v11, s43
    v_lshlrev_b32_sdwa v6, 2, v87 dst_sel:DWORD dst_unused:UNUSED_PAD src0_sel:DWORD src1_sel:WORD_0
    v_lshlrev_b32_sdwa v7, 2, v87 dst_sel:DWORD dst_unused:UNUSED_PAD src0_sel:DWORD src1_sel:WORD_1
    v_lshlrev_b32_sdwa v8, 2, v91 dst_sel:DWORD dst_unused:UNUSED_PAD src0_sel:DWORD src1_sel:WORD_0
    v_lshlrev_b32_sdwa v9, 2, v91 dst_sel:DWORD dst_unused:UNUSED_PAD src0_sel:DWORD src1_sel:WORD_1
    ds_write_b32 v6, v89
    ds_write_b32 v7, v90
    ds_write_b32 v8, v92
    ds_write_b32 v9, v93
    s_mov_b64 exec, s[44:45]
    v_lshlrev_b32_sdwa v6, 2, v95 dst_sel:DWORD dst_unused:UNUSED_PAD src0_sel:DWORD src1_sel:WORD_0
    v_lshlrev_b32_sdwa v7, 2, v95 dst_sel:DWORD dst_unused:UNUSED_PAD src0_sel:DWORD src1_sel:WORD_1
    v_lshlrev_b32_sdwa v8, 2, v99 dst_sel:DWORD dst_unused:UNUSED_PAD src0_sel:DWORD src1_sel:WORD_0
    v_lshlrev_b32_sdwa v9, 2, v99 dst_sel:DWORD dst_unused:UNUSED_PAD src0_sel:DWORD src1_sel:WORD_1
    ds_write_b32 v6, v94
    ds_write_b32 v7, v96
    ds_write_b32 v8, v97
    ds_write_b32 v9, v98
    s_mov_b64 exec, -1
    s_waitcnt vmcnt(6)
    v_lshlrev_b32 v10, 16, v112
    v_lshlrev_b32 v11, 16, v113
    v_and_b32 v112, 0xffff0000, v112
    v_and_b32 v113, 0xffff0000, v113
    v_mul_f32 v10, s41, v10
    v_mul_f32 v112, s41, v112
    v_mul_f32 v11, s41, v11
    v_mul_f32 v113, s41, v113
    v_fract_f32 v10, v10
    v_fract_f32 v112, v112
    v_fract_f32 v11, v11
    v_fract_f32 v113, v113
    v_cos_f32 v10, v10
    v_cos_f32 v112, v112
    v_cos_f32 v11, v11
    v_cos_f32 v113, v113
    v_fmaak_f32 v10, v12, v10, 1262486016
    v_fmaak_f32 v112, v12, v112, 1262486016
    v_fmaak_f32 v11, v12, v11, 1262486016
    v_fmaak_f32 v113, v12, v113, 1262486016
    v_or3_b32 v5, v10, v112, v5
    v_or3_b32 v5, v11, v113, v5
    v_perm_b32 v112, v112, v10, s43
    v_perm_b32 v113, v113, v11, s43
    s_mov_b64 exec, s[44:45]
    s_mov_b64 exec, -1
    s_add_u32 s35, s33, 45154304
    buffer_load_dwordx4 v[28:31], v1, s[12:15], s35 offen nt
    s_mul_i32 s35, s39, 9216
    v_mad_u32_u24 v6, v0, 12, s35
    s_waitcnt lgkmcnt(0)
    s_barrier
    s_cmp_lg_u32 s39, 15
    s_cbranch_scc1 L_p1_kernel_nox_11
    ds_read_b32 v12, v6 offset:9984
    ds_read_b32 v13, v6 offset:9988
    ds_read_b32 v14, v6 offset:9992
L_p1_kernel_nox_11:
    ds_read_b32 v48, v6 offset:1536
    ds_read_b32 v49, v6 offset:1540
    ds_read_b32 v50, v6 offset:1544
    ds_read_b32 v52, v6 offset:3072
    ds_read_b32 v53, v6 offset:3076
    ds_read_b32 v54, v6 offset:3080
    ds_read_b32 v56, v6 offset:4608
    ds_read_b32 v57, v6 offset:4612
    ds_read_b32 v58, v6 offset:4616
    ds_read_b32 v60, v6 offset:6144
    ds_read_b32 v61, v6 offset:6148
    ds_read_b32 v62, v6 offset:6152
    ds_read_b32 v64, v6 offset:7680
    ds_read_b32 v65, v6 offset:7684
    ds_read_b32 v66, v6 offset:7688
    ds_read_b32 v68, v6 offset:9216
    ds_read_b32 v69, v6 offset:9220
    ds_read_b32 v70, v6 offset:9224
    ds_read_b32 v72, v6 offset:0
    ds_read_b32 v73, v6 offset:4
    ds_read_b32 v74, v6 offset:8
    ds_read_b32 v76, v6 offset:768
    ds_read_b32 v77, v6 offset:772
    ds_read_b32 v78, v6 offset:776
    ds_read_b32 v80, v6 offset:2304
    ds_read_b32 v81, v6 offset:2308
    ds_read_b32 v82, v6 offset:2312
    ds_read_b32 v84, v6 offset:3840
    ds_read_b32 v85, v6 offset:3844
    ds_read_b32 v86, v6 offset:3848
    ds_read_b32 v88, v6 offset:5376
    ds_read_b32 v89, v6 offset:5380
    ds_read_b32 v90, v6 offset:5384
    ds_read_b32 v92, v6 offset:6912
    ds_read_b32 v93, v6 offset:6916
    ds_read_b32 v94, v6 offset:6920
    ds_read_b32 v96, v6 offset:8448
    ds_read_b32 v97, v6 offset:8452
    ds_read_b32 v98, v6 offset:8456
    s_add_u32 s35, s33, 49348608
    buffer_load_dwordx4 v[32:35], v1, s[8:11], s35 offen nt
    v_mov_b32 v8, 0
    v_mov_b32 v9, 0
    v_mov_b32 v10, 0
    v_mov_b32 v11, 0
    v_mov_b32 v15, 16384
    s_waitcnt lgkmcnt(0)
    s_barrier
    ds_write_b128 v1, v[8:11] offset:0
    s_nop 1
    v_mad_u32_u16 v6, v51, s50, v15 op_sel:[0,0,0,0]
    v_mad_u32_u16 v7, v51, s50, v15 op_sel:[1,0,0,0]
    v_mad_u32_u16 v8, v55, s50, v15 op_sel:[0,0,0,0]
    v_mad_u32_u16 v9, v55, s50, v15 op_sel:[1,0,0,0]
    v_add_u32_sdwa v6, v6, v51 dst_sel:DWORD dst_unused:UNUSED_PAD src0_sel:WORD_1 src1_sel:WORD_0
    v_add_u32_sdwa v7, v7, v51 dst_sel:DWORD dst_unused:UNUSED_PAD src0_sel:WORD_1 src1_sel:WORD_1
    v_add_u32_sdwa v8, v8, v55 dst_sel:DWORD dst_unused:UNUSED_PAD src0_sel:WORD_1 src1_sel:WORD_0
    v_add_u32_sdwa v9, v9, v55 dst_sel:DWORD dst_unused:UNUSED_PAD src0_sel:WORD_1 src1_sel:WORD_1
    v_add_u32 v6, v6, v6
    v_add_u32 v7, v7, v7
    v_add_u32 v8, v8, v8
    v_add_u32 v9, v9, v9
    ds_write_b16 v6, v100 offset:16384
    ds_write_b16_d16_hi v7, v100 offset:16384
    ds_write_b16 v8, v101 offset:16384
    ds_write_b16_d16_hi v9, v101 offset:16384
    v_mov_b32 v6, 1140817920
    s_waitcnt vmcnt(7)
    v_lshlrev_b32 v10, 16, v114
    v_lshlrev_b32 v11, 16, v115
    v_and_b32 v114, 0xffff0000, v114
    v_and_b32 v115, 0xffff0000, v115
    v_mul_f32 v10, s41, v10
    v_mul_f32 v114, s41, v114
    v_mul_f32 v11, s41, v11
    v_mul_f32 v115, s41, v115
    v_fract_f32 v10, v10
    v_fract_f32 v114, v114
    v_fract_f32 v11, v11
    v_fract_f32 v115, v115
    v_cos_f32 v10, v10
    v_cos_f32 v114, v114
    v_cos_f32 v11, v11
    v_cos_f32 v115, v115
    v_fmaak_f32 v10, v6, v10, 1262486016
    v_fmaak_f32 v114, v6, v114, 1262486016
    v_fmaak_f32 v11, v6, v11, 1262486016
    v_fmaak_f32 v115, v6, v115, 1262486016
    v_or3_b32 v5, v10, v114, v5
    v_or3_b32 v5, v11, v115, v5
    v_perm_b32 v114, v114, v10, s43
    v_perm_b32 v115, v115, v11, s43
    v_mad_u32_u16 v6, v59, s50, v15 op_sel:[0,0,0,0]
    v_mad_u32_u16 v7, v59, s50, v15 op_sel:[1,0,0,0]
    v_mad_u32_u16 v8, v63, s50, v15 op_sel:[0,0,0,0]
    v_mad_u32_u16 v9, v63, s50, v15 op_sel:[1,0,0,0]
    v_add_u32_sdwa v6, v6, v59 dst_sel:DWORD dst_unused:UNUSED_PAD src0_sel:WORD_1 src1_sel:WORD_0
    v_add_u32_sdwa v7, v7, v59 dst_sel:DWORD dst_unused:UNUSED_PAD src0_sel:WORD_1 src1_sel:WORD_1
    v_add_u32_sdwa v8, v8, v63 dst_sel:DWORD dst_unused:UNUSED_PAD src0_sel:WORD_1 src1_sel:WORD_0
    v_add_u32_sdwa v9, v9, v63 dst_sel:DWORD dst_unused:UNUSED_PAD src0_sel:WORD_1 src1_sel:WORD_1
    v_add_u32 v6, v6, v6
    v_add_u32 v7, v7, v7
    v_add_u32 v8, v8, v8
    v_add_u32 v9, v9, v9
    ds_write_b16 v6, v102 offset:16384
    ds_write_b16_d16_hi v7, v102 offset:16384
    ds_write_b16 v8, v103 offset:16384
    ds_write_b16_d16_hi v9, v103 offset:16384
    v_mad_u32_u16 v6, v67, s50, v15 op_sel:[0,0,0,0]
    v_mad_u32_u16 v7, v67, s50, v15 op_sel:[1,0,0,0]
    v_mad_u32_u16 v8, v71, s50, v15 op_sel:[0,0,0,0]
    v_mad_u32_u16 v9, v71, s50, v15 op_sel:[1,0,0,0]
    v_add_u32_sdwa v6, v6, v67 dst_sel:DWORD dst_unused:UNUSED_PAD src0_sel:WORD_1 src1_sel:WORD_0
    v_add_u32_sdwa v7, v7, v67 dst_sel:DWORD dst_unused:UNUSED_PAD src0_sel:WORD_1 src1_sel:WORD_1
    v_add_u32_sdwa v8, v8, v71 dst_sel:DWORD dst_unused:UNUSED_PAD src0_sel:WORD_1 src1_sel:WORD_0
    v_add_u32_sdwa v9, v9, v71 dst_sel:DWORD dst_unused:UNUSED_PAD src0_sel:WORD_1 src1_sel:WORD_1
    v_add_u32 v6, v6, v6
    v_add_u32 v7, v7, v7
    v_add_u32 v8, v8, v8
    v_add_u32 v9, v9, v9
    ds_write_b16 v6, v104 offset:16384
    ds_write_b16_d16_hi v7, v104 offset:16384
    ds_write_b16 v8, v105 offset:16384
    ds_write_b16_d16_hi v9, v105 offset:16384
    s_add_u32 s35, s33, 49348608
    buffer_load_dwordx4 v[36:39], v1, s[12:15], s35 offen nt
    v_mad_u32_u16 v6, v120, s50, v15 op_sel:[0,0,0,0]
    v_mad_u32_u16 v7, v120, s50, v15 op_sel:[1,0,0,0]
    v_mad_u32_u16 v8, v121, s50, v15 op_sel:[0,0,0,0]
    v_mad_u32_u16 v9, v121, s50, v15 op_sel:[1,0,0,0]
    v_add_u32_sdwa v6, v6, v120 dst_sel:DWORD dst_unused:UNUSED_PAD src0_sel:WORD_1 src1_sel:WORD_0
    v_add_u32_sdwa v7, v7, v120 dst_sel:DWORD dst_unused:UNUSED_PAD src0_sel:WORD_1 src1_sel:WORD_1
    v_add_u32_sdwa v8, v8, v121 dst_sel:DWORD dst_unused:UNUSED_PAD src0_sel:WORD_1 src1_sel:WORD_0
    v_add_u32_sdwa v9, v9, v121 dst_sel:DWORD dst_unused:UNUSED_PAD src0_sel:WORD_1 src1_sel:WORD_1
    v_add_u32 v6, v6, v6
    v_add_u32 v7, v7, v7
    v_add_u32 v8, v8, v8
    v_add_u32 v9, v9, v9
    ds_write_b16 v6, v106 offset:16384
    ds_write_b16_d16_hi v7, v106 offset:16384
    ds_write_b16 v8, v107 offset:16384
    ds_write_b16_d16_hi v9, v107 offset:16384
    v_mov_b32 v6, 1140817920
    s_waitcnt vmcnt(7)
    v_lshlrev_b32 v10, 16, v116
    v_lshlrev_b32 v11, 16, v117
    v_and_b32 v116, 0xffff0000, v116
    v_and_b32 v117, 0xffff0000, v117
    v_mul_f32 v10, s41, v10
    v_mul_f32 v116, s41, v116
    v_mul_f32 v11, s41, v11
    v_mul_f32 v117, s41, v117
    v_fract_f32 v10, v10
    v_fract_f32 v116, v116
    v_fract_f32 v11, v11
    v_fract_f32 v117, v117
    v_cos_f32 v10, v10
    v_cos_f32 v116, v116
    v_cos_f32 v11, v11
    v_cos_f32 v117, v117
    v_fmaak_f32 v10, v6, v10, 1262486016
    v_fmaak_f32 v116, v6, v116, 1262486016
    v_fmaak_f32 v11, v6, v11, 1262486016
    v_fmaak_f32 v117, v6, v117, 1262486016
    v_or3_b32 v5, v10, v116, v5
    v_or3_b32 v5, v11, v117, v5
    v_perm_b32 v116, v116, v10, s43
    v_perm_b32 v117, v117, v11, s43
    v_mad_u32_u16 v6, v122, s50, v15 op_sel:[0,0,0,0]
    v_mad_u32_u16 v7, v122, s50, v15 op_sel:[1,0,0,0]
    v_mad_u32_u16 v8, v123, s50, v15 op_sel:[0,0,0,0]
    v_mad_u32_u16 v9, v123, s50, v15 op_sel:[1,0,0,0]
    v_add_u32_sdwa v6, v6, v122 dst_sel:DWORD dst_unused:UNUSED_PAD src0_sel:WORD_1 src1_sel:WORD_0
    v_add_u32_sdwa v7, v7, v122 dst_sel:DWORD dst_unused:UNUSED_PAD src0_sel:WORD_1 src1_sel:WORD_1
    v_add_u32_sdwa v8, v8, v123 dst_sel:DWORD dst_unused:UNUSED_PAD src0_sel:WORD_1 src1_sel:WORD_0
    v_add_u32_sdwa v9, v9, v123 dst_sel:DWORD dst_unused:UNUSED_PAD src0_sel:WORD_1 src1_sel:WORD_1
    v_add_u32 v6, v6, v6
    v_add_u32 v7, v7, v7
    v_add_u32 v8, v8, v8
    v_add_u32 v9, v9, v9
    ds_write_b16 v6, v108 offset:16384
    ds_write_b16_d16_hi v7, v108 offset:16384
    ds_write_b16 v8, v109 offset:16384
    ds_write_b16_d16_hi v9, v109 offset:16384
    v_mad_u32_u16 v6, v124, s50, v15 op_sel:[0,0,0,0]
    v_mad_u32_u16 v7, v124, s50, v15 op_sel:[1,0,0,0]
    v_mad_u32_u16 v8, v125, s50, v15 op_sel:[0,0,0,0]
    v_mad_u32_u16 v9, v125, s50, v15 op_sel:[1,0,0,0]
    v_add_u32_sdwa v6, v6, v124 dst_sel:DWORD dst_unused:UNUSED_PAD src0_sel:WORD_1 src1_sel:WORD_0
    v_add_u32_sdwa v7, v7, v124 dst_sel:DWORD dst_unused:UNUSED_PAD src0_sel:WORD_1 src1_sel:WORD_1
    v_add_u32_sdwa v8, v8, v125 dst_sel:DWORD dst_unused:UNUSED_PAD src0_sel:WORD_1 src1_sel:WORD_0
    v_add_u32_sdwa v9, v9, v125 dst_sel:DWORD dst_unused:UNUSED_PAD src0_sel:WORD_1 src1_sel:WORD_1
    v_add_u32 v6, v6, v6
    v_add_u32 v7, v7, v7
    v_add_u32 v8, v8, v8
    v_add_u32 v9, v9, v9
    ds_write_b16 v6, v110 offset:16384
    ds_write_b16_d16_hi v7, v110 offset:16384
    ds_write_b16 v8, v111 offset:16384
    ds_write_b16_d16_hi v9, v111 offset:16384
    s_add_u32 s35, s33, 53542912
    buffer_load_dwordx4 v[40:43], v1, s[8:11], s35 offen nt
    v_mad_u32_u16 v6, v126, s50, v15 op_sel:[0,0,0,0]
    v_mad_u32_u16 v7, v126, s50, v15 op_sel:[1,0,0,0]
    v_mad_u32_u16 v8, v75, s50, v15 op_sel:[0,0,0,0]
    v_mad_u32_u16 v9, v75, s50, v15 op_sel:[1,0,0,0]
    v_add_u32_sdwa v6, v6, v126 dst_sel:DWORD dst_unused:UNUSED_PAD src0_sel:WORD_1 src1_sel:WORD_0
    v_add_u32_sdwa v7, v7, v126 dst_sel:DWORD dst_unused:UNUSED_PAD src0_sel:WORD_1 src1_sel:WORD_1
    v_add_u32_sdwa v8, v8, v75 dst_sel:DWORD dst_unused:UNUSED_PAD src0_sel:WORD_1 src1_sel:WORD_0
    v_add_u32_sdwa v9, v9, v75 dst_sel:DWORD dst_unused:UNUSED_PAD src0_sel:WORD_1 src1_sel:WORD_1
    v_add_u32 v6, v6, v6
    v_add_u32 v7, v7, v7
    v_add_u32 v8, v8, v8
    v_add_u32 v9, v9, v9
    ds_write_b16 v6, v112 offset:16384
    ds_write_b16_d16_hi v7, v112 offset:16384
    ds_write_b16 v8, v113 offset:16384
    ds_write_b16_d16_hi v9, v113 offset:16384
    v_mov_b32 v6, 1140817920
    s_mov_b64 exec, s[44:45]
    s_waitcnt vmcnt(7)
    v_lshlrev_b32 v10, 16, v118
    v_lshlrev_b32 v11, 16, v119
    v_and_b32 v118, 0xffff0000, v118
    v_and_b32 v119, 0xffff0000, v119
    v_mul_f32 v10, s41, v10
    v_mul_f32 v118, s41, v118
    v_mul_f32 v11, s41, v11
    v_mul_f32 v119, s41, v119
    v_fract_f32 v10, v10
    v_fract_f32 v118, v118
    v_fract_f32 v11, v11
    v_fract_f32 v119, v119
    v_cos_f32 v10, v10
    v_cos_f32 v118, v118
    v_cos_f32 v11, v11
    v_cos_f32 v119, v119
    v_fmaak_f32 v10, v6, v10, 1262486016
    v_fmaak_f32 v118, v6, v118, 1262486016
    v_fmaak_f32 v11, v6, v11, 1262486016
    v_fmaak_f32 v119, v6, v119, 1262486016
    v_or3_b32 v5, v10, v118, v5
    v_or3_b32 v5, v11, v119, v5
    v_perm_b32 v118, v118, v10, s43
    v_perm_b32 v119, v119, v11, s43
    s_mov_b64 exec, -1
    v_mad_u32_u16 v6, v79, s50, v15 op_sel:[0,0,0,0]
    v_mad_u32_u16 v7, v79, s50, v15 op_sel:[1,0,0,0]
    v_mad_u32_u16 v8, v83, s50, v15 op_sel:[0,0,0,0]
    v_mad_u32_u16 v9, v83, s50, v15 op_sel:[1,0,0,0]
    v_add_u32_sdwa v6, v6, v79 dst_sel:DWORD dst_unused:UNUSED_PAD src0_sel:WORD_1 src1_sel:WORD_0
    v_add_u32_sdwa v7, v7, v79 dst_sel:DWORD dst_unused:UNUSED_PAD src0_sel:WORD_1 src1_sel:WORD_1
    v_add_u32_sdwa v8, v8, v83 dst_sel:DWORD dst_unused:UNUSED_PAD src0_sel:WORD_1 src1_sel:WORD_0
    v_add_u32_sdwa v9, v9, v83 dst_sel:DWORD dst_unused:UNUSED_PAD src0_sel:WORD_1 src1_sel:WORD_1
    v_add_u32 v6, v6, v6
    v_add_u32 v7, v7, v7
    v_add_u32 v8, v8, v8
    v_add_u32 v9, v9, v9
    ds_write_b16 v6, v114 offset:16384
    ds_write_b16_d16_hi v7, v114 offset:16384
    ds_write_b16 v8, v115 offset:16384
    ds_write_b16_d16_hi v9, v115 offset:16384
    v_mad_u32_u16 v6, v87, s50, v15 op_sel:[0,0,0,0]
    v_mad_u32_u16 v7, v87, s50, v15 op_sel:[1,0,0,0]
    v_mad_u32_u16 v8, v91, s50, v15 op_sel:[0,0,0,0]
    v_mad_u32_u16 v9, v91, s50, v15 op_sel:[1,0,0,0]
    v_add_u32_sdwa v6, v6, v87 dst_sel:DWORD dst_unused:UNUSED_PAD src0_sel:WORD_1 src1_sel:WORD_0
    v_add_u32_sdwa v7, v7, v87 dst_sel:DWORD dst_unused:UNUSED_PAD src0_sel:WORD_1 src1_sel:WORD_1
    v_add_u32_sdwa v8, v8, v91 dst_sel:DWORD dst_unused:UNUSED_PAD src0_sel:WORD_1 src1_sel:WORD_0
    v_add_u32_sdwa v9, v9, v91 dst_sel:DWORD dst_unused:UNUSED_PAD src0_sel:WORD_1 src1_sel:WORD_1
    v_add_u32 v6, v6, v6
    v_add_u32 v7, v7, v7
    v_add_u32 v8, v8, v8
    v_add_u32 v9, v9, v9
    ds_write_b16 v6, v116 offset:16384
    ds_write_b16_d16_hi v7, v116 offset:16384
    ds_write_b16 v8, v117 offset:16384
    ds_write_b16_d16_hi v9, v117 offset:16384
    s_add_u32 s35, s33, 53542912
    buffer_load_dwordx4 v[44:47], v1, s[12:15], s35 offen nt
    s_mov_b64 exec, s[44:45]
    v_mad_u32_u16 v6, v95, s50, v15 op_sel:[0,0,0,0]
    v_mad_u32_u16 v7, v95, s50, v15 op_sel:[1,0,0,0]
    v_mad_u32_u16 v8, v99, s50, v15 op_sel:[0,0,0,0]
    v_mad_u32_u16 v9, v99, s50, v15 op_sel:[1,0,0,0]
    v_add_u32_sdwa v6, v6, v95 dst_sel:DWORD dst_unused:UNUSED_PAD src0_sel:WORD_1 src1_sel:WORD_0
    v_add_u32_sdwa v7, v7, v95 dst_sel:DWORD dst_unused:UNUSED_PAD src0_sel:WORD_1 src1_sel:WORD_1
    v_add_u32_sdwa v8, v8, v99 dst_sel:DWORD dst_unused:UNUSED_PAD src0_sel:WORD_1 src1_sel:WORD_0
    v_add_u32_sdwa v9, v9, v99 dst_sel:DWORD dst_unused:UNUSED_PAD src0_sel:WORD_1 src1_sel:WORD_1
    v_add_u32 v6, v6, v6
    v_add_u32 v7, v7, v7
    v_add_u32 v8, v8, v8
    v_add_u32 v9, v9, v9
    ds_write_b16 v6, v118 offset:16384
    ds_write_b16_d16_hi v7, v118 offset:16384
    ds_write_b16 v8, v119 offset:16384
    ds_write_b16_d16_hi v9, v119 offset:16384
    s_mov_b64 exec, -1
    s_mul_i32 s35, s39, 6144
    v_add_u32 v6, s35, v2
    s_waitcnt lgkmcnt(0)
    s_barrier
    ds_read_b64 v[100:101], v6 offset:23040
    ds_read_b64 v[102:103], v6 offset:16384
    ds_read_b64 v[104:105], v6 offset:16896
    ds_read_b64 v[106:107], v6 offset:17408
    ds_read_b64 v[108:109], v6 offset:17920
    ds_read_b64 v[110:111], v6 offset:18432
    ds_read_b64 v[112:113], v6 offset:18944
    ds_read_b64 v[114:115], v6 offset:19456
    ds_read_b64 v[116:117], v6 offset:19968
    ds_read_b64 v[118:119], v6 offset:20480
    ds_read_b64 v[120:121], v6 offset:20992
    ds_read_b64 v[122:123], v6 offset:21504
    ds_read_b64 v[124:125], v6 offset:22016
    ds_read_b64 v[126:127], v6 offset:22528
    s_add_u32 s32, s32, 256
    s_add_u32 s33, s33, 40960000
    s_add_u32 s34, s34, 20480000
    s_add_u32 s40, s40, 1
    s_cmp_lt_u32 s40, 4
    s_cbranch_scc1 L_p1_loop
    s_waitcnt lgkmcnt(13)
    v_lshlrev_b32 v15, 22, v100
    v_lshrrev_b32 v100, 16, v100
    v_alignbit_b32 v15, v100, v15, 10
    v_alignbit_b32 v15, v101, v15, 10
    v_xor_b32 v15, 0x80200800, v15
    s_cmp_lg_u32 s39, 15
    s_cbranch_scc1 L_p1_kernel_nox_12
    s_mov_b32 s36, 13631488
    buffer_store_dwordx4 v[12:15], v3, s[20:23], s36 offen sc1
L_p1_kernel_nox_12:
    s_waitcnt lgkmcnt(12)
    v_lshlrev_b32 v75, 22, v102
    v_lshrrev_b32 v102, 16, v102
    v_alignbit_b32 v75, v102, v75, 10
    v_alignbit_b32 v75, v103, v75, 10
    v_xor_b32 v75, 0x80200800, v75
    s_mov_b32 s36, 0
    buffer_store_dwordx4 v[72:75], v3, s[20:23], s36 offen sc1
    s_waitcnt lgkmcnt(11)
    v_lshlrev_b32 v79, 22, v104
    v_lshrrev_b32 v104, 16, v104
    v_alignbit_b32 v79, v104, v79, 10
    v_alignbit_b32 v79, v105, v79, 10
    v_xor_b32 v79, 0x80200800, v79
    s_mov_b32 s36, 1048576
    buffer_store_dwordx4 v[76:79], v3, s[20:23], s36 offen sc1
    s_waitcnt lgkmcnt(10)
    v_lshlrev_b32 v51, 22, v106
    v_lshrrev_b32 v106, 16, v106
    v_alignbit_b32 v51, v106, v51, 10
    v_alignbit_b32 v51, v107, v51, 10
    v_xor_b32 v51, 0x80200800, v51
    s_mov_b32 s36, 2097152
    buffer_store_dwordx4 v[48:51], v3, s[20:23], s36 offen sc1
    s_waitcnt lgkmcnt(9)
    v_lshlrev_b32 v83, 22, v108
    v_lshrrev_b32 v108, 16, v108
    v_alignbit_b32 v83, v108, v83, 10
    v_alignbit_b32 v83, v109, v83, 10
    v_xor_b32 v83, 0x80200800, v83
    s_mov_b32 s36, 3145728
    buffer_store_dwordx4 v[80:83], v3, s[20:23], s36 offen sc1
    s_waitcnt lgkmcnt(8)
    v_lshlrev_b32 v55, 22, v110
    v_lshrrev_b32 v110, 16, v110
    v_alignbit_b32 v55, v110, v55, 10
    v_alignbit_b32 v55, v111, v55, 10
    v_xor_b32 v55, 0x80200800, v55
    s_mov_b32 s36, 4194304
    buffer_store_dwordx4 v[52:55], v3, s[20:23], s36 offen sc1
    s_waitcnt lgkmcnt(7)
    v_lshlrev_b32 v87, 22, v112
    v_lshrrev_b32 v112, 16, v112
    v_alignbit_b32 v87, v112, v87, 10
    v_alignbit_b32 v87, v113, v87, 10
    v_xor_b32 v87, 0x80200800, v87
    s_mov_b32 s36, 5242880
    buffer_store_dwordx4 v[84:87], v3, s[20:23], s36 offen sc1
    s_waitcnt lgkmcnt(6)
    v_lshlrev_b32 v59, 22, v114
    v_lshrrev_b32 v114, 16, v114
    v_alignbit_b32 v59, v114, v59, 10
    v_alignbit_b32 v59, v115, v59, 10
    v_xor_b32 v59, 0x80200800, v59
    s_mov_b32 s36, 6291456
    buffer_store_dwordx4 v[56:59], v3, s[20:23], s36 offen sc1
    s_waitcnt lgkmcnt(5)
    v_lshlrev_b32 v91, 22, v116
    v_lshrrev_b32 v116, 16, v116
    v_alignbit_b32 v91, v116, v91, 10
    v_alignbit_b32 v91, v117, v91, 10
    v_xor_b32 v91, 0x80200800, v91
    s_mov_b32 s36, 7340032
    buffer_store_dwordx4 v[88:91], v3, s[20:23], s36 offen sc1
    s_waitcnt lgkmcnt(4)
    v_lshlrev_b32 v63, 22, v118
    v_lshrrev_b32 v118, 16, v118
    v_alignbit_b32 v63, v118, v63, 10
    v_alignbit_b32 v63, v119, v63, 10
    v_xor_b32 v63, 0x80200800, v63
    s_mov_b32 s36, 8388608
    buffer_store_dwordx4 v[60:63], v3, s[20:23], s36 offen sc1
    s_waitcnt lgkmcnt(3)
    v_lshlrev_b32 v95, 22, v120
    v_lshrrev_b32 v120, 16, v120
    v_alignbit_b32 v95, v120, v95, 10
    v_alignbit_b32 v95, v121, v95, 10
    v_xor_b32 v95, 0x80200800, v95
    s_mov_b32 s36, 9437184
    buffer_store_dwordx4 v[92:95], v3, s[20:23], s36 offen sc1
    s_waitcnt lgkmcnt(2)
    v_lshlrev_b32 v67, 22, v122
    v_lshrrev_b32 v122, 16, v122
    v_alignbit_b32 v67, v122, v67, 10
    v_alignbit_b32 v67, v123, v67, 10
    v_xor_b32 v67, 0x80200800, v67
    s_mov_b32 s36, 10485760
    buffer_store_dwordx4 v[64:67], v3, s[20:23], s36 offen sc1
    s_waitcnt lgkmcnt(1)
    v_lshlrev_b32 v99, 22, v124
    v_lshrrev_b32 v124, 16, v124
    v_alignbit_b32 v99, v124, v99, 10
    v_alignbit_b32 v99, v125, v99, 10
    v_xor_b32 v99, 0x80200800, v99
    s_mov_b32 s36, 11534336
    buffer_store_dwordx4 v[96:99], v3, s[20:23], s36 offen sc1
    s_waitcnt lgkmcnt(0)
    v_lshlrev_b32 v71, 22, v126
    v_lshrrev_b32 v126, 16, v126
    v_alignbit_b32 v71, v126, v71, 10
    v_alignbit_b32 v71, v127, v71, 10
    v_xor_b32 v71, 0x80200800, v71
    s_mov_b32 s36, 12582912
    buffer_store_dwordx4 v[68:71], v3, s[20:23], s36 offen sc1
    v_and_b32 v6, 0x34800000, v5
    v_cmp_ne_u32 vcc, 0, v6
    s_lshl_b32 s35, s39, 4
    s_add_u32 s35, s35, 160328
    v_mov_b32 v10, s35
    s_cmp_lg_u64 vcc, 0
    s_cselect_b32 s36, 1, s55
    v_mov_b32 v11, s36
    ds_write_b32 v10, v11
    s_waitcnt lgkmcnt(0)
    s_barrier
    s_cmp_lg_u32 s39, 0
    s_cbranch_scc1 L_p1_end
    v_and_b32 v6, 15, v0
    v_lshlrev_b32 v6, 4, v6
    v_add_u32 v6, 160320, v6
    ds_read_b128 v[8:11], v6
    s_waitcnt lgkmcnt(0)
    s_nop 1
    v_max_u32_dpp v8, v8, v8 row_shr:1 row_mask:0xf bank_mask:0xf bound_ctrl:0
    s_nop 1
    v_max_u32_dpp v8, v8, v8 row_shr:2 row_mask:0xf bank_mask:0xf bound_ctrl:0
    s_nop 1
    v_max_u32_dpp v8, v8, v8 row_shr:4 row_mask:0xf bank_mask:0xf bound_ctrl:0
    s_nop 1
    v_max_u32_dpp v8, v8, v8 row_shr:8 row_mask:0xf bank_mask:0xf bound_ctrl:0
    s_nop 1
    v_add_f32_dpp v9, v9, v9 row_shr:1 row_mask:0xf bank_mask:0xf bound_ctrl:0
    s_nop 1
    v_add_f32_dpp v9, v9, v9 row_shr:2 row_mask:0xf bank_mask:0xf bound_ctrl:0
    s_nop 1
    v_add_f32_dpp v9, v9, v9 row_shr:4 row_mask:0xf bank_mask:0xf bound_ctrl:0
    s_nop 1
    v_add_f32_dpp v9, v9, v9 row_shr:8 row_mask:0xf bank_mask:0xf bound_ctrl:0
    s_nop 1
    v_or_b32_dpp v10, v10, v10 row_shr:1 row_mask:0xf bank_mask:0xf bound_ctrl:0
    s_nop 1
    v_or_b32_dpp v10, v10, v10 row_shr:2 row_mask:0xf bank_mask:0xf bound_ctrl:0
    s_nop 1
    v_or_b32_dpp v10, v10, v10 row_shr:4 row_mask:0xf bank_mask:0xf bound_ctrl:0
    s_nop 1
    v_or_b32_dpp v10, v10, v10 row_shr:8 row_mask:0xf bank_mask:0xf bound_ctrl:0
    s_lshl_b32 s35, s2, 3
    s_mov_b32 s26, 8540160
    s_add_u32 s35, s35, 8519680
    v_mov_b32 v6, 0
    v_lshl_or_b32 v8, v10, 16, v8
    s_mov_b64 exec, 0x8000
    buffer_store_dwordx2 v[8:9], v6, s[24:27], s35 offen
    s_lshl_b32 s35, s2, 8
    s_add_u32 s35, s35, 8523776
    buffer_store_dword v6, v6, s[24:27], s35 offen
L_p1_end:
    s_endpgm
.globl p2_kernel
.p2align 8
.type p2_kernel,@function
p2_kernel:
    s_cmp_ge_u32 s2, 256
    s_cbranch_scc1 L_p2_end
    s_load_dwordx2 s[4:5], s[0:1], 104
    s_load_dwordx2 s[100:101], s[0:1], 24
    s_load_dwordx2 s[8:9], s[0:1], 0
    s_load_dwordx2 s[30:31], s[0:1], 40
    s_load_dwordx4 s[32:35], s[0:1], 56
    s_load_dwordx4 s[36:39], s[0:1], 72
    s_and_b32 s14, s2, 7
    s_lshr_b32 s49, s2, 3
    s_and_b32 s3, s14, 1
    s_lshl_b32 s3, s3, 5
    s_add_u32 s3, s3, s49
    s_lshr_b32 s12, s14, 1
    v_lshrrev_b32 v108, 6, v0
    v_lshlrev_b32 v1, 4, v0
    v_and_b32 v109, 63, v0
    v_readfirstlane_b32 s13, v108
    v_lshlrev_b32 v111, 4, v109
    v_lshrrev_b32 v110, 2, v109
    v_mul_u32_u24 v110, 8256, v110
    v_add_u32 v110, v110, v111
    s_mul_i32 s14, s12, 65
    s_add_u32 s14, s14, s3
    s_lshl_b32 s14, s14, 5
    s_mul_i32 s15, s13, 532480
    s_add_u32 s14, s14, s15
    s_add_u32 s25, s14, 0
    s_mul_i32 s22, s12, 1280000
    s_mov_b32 s2, 0
    s_waitcnt lgkmcnt(0)
    s_mov_b32 s6, 655360000
    s_mov_b32 s7, 0x00020000
    s_add_u32 s10, s22, 1280000
    s_mov_b32 s11, 0x00020000
    s_add_u32 s15, s25, 0
    buffer_load_dwordx4 v[28:31], v110, s[4:7], s15 offen
    s_add_u32 s15, s25, 133120
    buffer_load_dwordx4 v[32:35], v110, s[4:7], s15 offen
    s_add_u32 s15, s25, 266240
    buffer_load_dwordx4 v[36:39], v110, s[4:7], s15 offen
    s_add_u32 s15, s25, 399360
    buffer_load_dwordx4 v[40:43], v110, s[4:7], s15 offen
    s_load_dwordx4 s[40:43], s[30:31], 0
    s_load_dwordx16 s[52:67], s[32:33], 0
    s_load_dwordx16 s[68:83], s[34:35], 0
    s_load_dwordx8 s[84:91], s[36:37], 0
    s_load_dwordx8 s[92:99], s[38:39], 0
    v_mov_b32 v52, 0x100
    s_cmp_lg_u32 s13, 0
    s_cbranch_scc1 L_p2_noann
    s_lshl_b32 s14, s3, 8
    s_add_u32 s14, s14, 8523776
    s_mov_b64 exec, 1
    buffer_atomic_add v52, off, s[4:7], s14
    s_mov_b64 exec, -1
L_p2_noann:
    s_add_u32 s14, s22, 0
    buffer_load_dwordx4 v[88:91], v1, s[8:11], s14 offen
    s_add_u32 s14, s22, 16384
    buffer_load_dwordx4 v[92:95], v1, s[8:11], s14 offen
    s_add_u32 s14, s22, 32768
    buffer_load_dwordx4 v[96:99], v1, s[8:11], s14 offen
    s_add_u32 s14, s22, 49152
    buffer_load_dwordx4 v[100:103], v1, s[8:11], s14 offen
    s_add_u32 s14, s22, 65536
    buffer_load_dwordx4 v[104:107], v1, s[8:11], s14 offen
    s_mov_b32 s15, 8519680
    buffer_load_dwordx4 v[80:83], v111, s[4:7], s15 offen offset:0
    buffer_load_dwordx4 v[84:87], v111, s[4:7], s15 offen offset:1024
    v_lshlrev_b32 v2, 10, v109
    v_mov_b32 v50, 21845
    v_add_u32 v3, 80000, v1
    v_add_u32 v124, 145536, v1
    v_add_u32 v113, 65536, v1
    v_mov_b32 v112, 0x7f000000
    v_cmp_gt_u32 vcc, 904, v0
    s_mul_i32 s19, s13, 240
    s_add_u32 s19, s19, 160000
    v_cndmask_b32 v124, v112, v124, vcc
    v_cndmask_b32 v113, v112, v113, vcc
    v_lshl_add_u32 v6, v109, 2, s19
    v_lshl_add_u32 v126, v109, 1, s19
    v_cmp_gt_u32 vcc, 10, v109
    s_lshl_b32 s27, s13, 16
    s_mov_b32 s23, 1024
    v_cndmask_b32 v6, v112, v6, vcc
    s_add_u32 s44, s4, 4194304
    s_addc_u32 s45, s5, 1048576
    s_mov_b32 s46, 14024704
    s_mov_b32 s47, 0x00020000
    s_mov_b32 s17, 0x05040100
    s_mov_b32 s18, 80000
    s_and_b32 s50, s3, 1
    s_lshl_b32 s50, s50, 18
    s_sub_u32 s50, 4294836224, s50
    s_mov_b32 s20, 3221209088
    s_mov_b32 s21, 3221209087
    v_mov_b32 v4, 0
    v_mov_b32 v5, 0
    v_mov_b32 v114, 0xff00
    ds_write_b32 v6, v5 offset:160
    ds_write_b16 v126, v114 offset:2
    v_mov_b32 v44, 1073758208
    v_mov_b32 v45, 1073758208
    v_mov_b32 v46, 1073758208
    v_mov_b32 v47, 1073758208
    v_mov_b32 v48, 1073758208
    v_mov_b32 v49, 1073758208
    ds_write_b128 v113, v[44:47]
    v_lshrrev_b32 v115, 4, v109
    v_mul_u32_u24 v115, 15360, v115
    v_lshl_add_u32 v115, v109, 6, v115
    v_lshl_add_u32 v115, v108, 10, v115
    s_waitcnt lgkmcnt(0)
    v_mov_b32 v53, s40
    v_mov_b32 v54, s41
    v_mov_b32 v56, s42
    v_mov_b32 v57, s43
    s_mov_b32 s40, 20987904
    s_mov_b32 s41, 21031594
    s_pack_ll_b32_b16 s14, s52, s54
    s_pack_hh_b32_b16 s15, s52, s54
    s_pack_ll_b32_b16 s54, s53, s55
    s_pack_hh_b32_b16 s55, s53, s55
    s_mov_b32 s52, s14
    s_mov_b32 s53, s15
    s_pack_ll_b32_b16 s14, s56, s58
    s_pack_hh_b32_b16 s15, s56, s58
    s_pack_ll_b32_b16 s58, s57, s59
    s_pack_hh_b32_b16 s59, s57, s59
    s_mov_b32 s56, s14
    s_mov_b32 s57, s15
    s_pack_ll_b32_b16 s14, s60, s62
    s_pack_hh_b32_b16 s15, s60, s62
    s_pack_ll_b32_b16 s62, s61, s63
    s_pack_hh_b32_b16 s63, s61, s63
    s_mov_b32 s60, s14
    s_mov_b32 s61, s15
    s_pack_ll_b32_b16 s14, s64, s66
    s_pack_hh_b32_b16 s15, s64, s66
    s_pack_ll_b32_b16 s66, s65, s67
    s_pack_hh_b32_b16 s67, s65, s67
    s_mov_b32 s64, s14
    s_mov_b32 s65, s15
    s_pack_ll_b32_b16 s14, s68, s70
    s_pack_hh_b32_b16 s15, s68, s70
    s_pack_ll_b32_b16 s70, s69, s71
    s_pack_hh_b32_b16 s71, s69, s71
    s_mov_b32 s68, s14
    s_mov_b32 s69, s15
    s_pack_ll_b32_b16 s14, s72, s74
    s_pack_hh_b32_b16 s15, s72, s74
    s_pack_ll_b32_b16 s74, s73, s75
    s_pack_hh_b32_b16 s75, s73, s75
    s_mov_b32 s72, s14
    s_mov_b32 s73, s15
    s_pack_ll_b32_b16 s14, s76, s78
    s_pack_hh_b32_b16 s15, s76, s78
    s_pack_ll_b32_b16 s78, s77, s79
    s_pack_hh_b32_b16 s79, s77, s79
    s_mov_b32 s76, s14
    s_mov_b32 s77, s15
    s_pack_ll_b32_b16 s14, s80, s82
    s_pack_hh_b32_b16 s15, s80, s82
    s_pack_ll_b32_b16 s82, s81, s83
    s_pack_hh_b32_b16 s83, s81, s83
    s_mov_b32 s80, s14
    s_mov_b32 s81, s15
    s_waitcnt vmcnt(10)
    ds_write_b128 v1, v[28:31] offset:0
    s_waitcnt vmcnt(9)
    ds_write_b128 v1, v[32:35] offset:16384
    s_waitcnt vmcnt(8)
    ds_write_b128 v1, v[36:39] offset:32768
    s_waitcnt vmcnt(7)
    ds_write_b128 v1, v[40:43] offset:49152
    ds_read_b128 v[28:31], v115 offset:0
    ds_read_b128 v[36:39], v115 offset:32
    ds_read_b128 v[32:35], v115 offset:16
    ds_read_b128 v[40:43], v115 offset:48
    ds_write_b128 v1, v[44:47] offset:0
    ds_write_b128 v1, v[44:47] offset:16384
    ds_write_b128 v1, v[44:47] offset:32768
    ds_write_b128 v1, v[44:47] offset:49152
    s_waitcnt lgkmcnt(6)
    v_mad_u32_u16 v108, v28, v50, s40 op_sel:[0,0,0,0]
    v_mad_u32_u16 v109, v36, v50, s41 op_sel:[0,0,0,0]
    v_sub_u32_sdwa v110, v109, v108 dst_sel:DWORD dst_unused:UNUSED_PAD src0_sel:WORD_1 src1_sel:WORD_1
    s_nop 1
    v_add_u32_dpp v110, v110, v110 row_shr:1 row_mask:0xf bank_mask:0xf bound_ctrl:0
    s_nop 1
    v_add_u32_dpp v110, v110, v110 row_shr:2 row_mask:0xf bank_mask:0xf bound_ctrl:0
    s_nop 1
    v_add_u32_dpp v110, v110, v110 row_shr:4 row_mask:0xf bank_mask:0xf bound_ctrl:0
    s_nop 1
    v_add_u32_dpp v110, v110, v110 row_shr:8 row_mask:0xf bank_mask:0xf bound_ctrl:0
    s_nop 1
    v_add_u32_dpp v110, v110, v110 row_bcast:15 row_mask:0xa bank_mask:0xf
    s_nop 1
    v_add_u32_dpp v110, v110, v110 row_bcast:31 row_mask:0xc bank_mask:0xf
    v_sub_u32_sdwa v109, v109, v110 dst_sel:DWORD dst_unused:UNUSED_PAD src0_sel:WORD_1 src1_sel:DWORD
    v_readlane_b32 s29, v110, 63
    v_add_u32 v110, -1, v110
    ds_write_b16 v126, v109
    v_lshlrev_b32_e64 v111, v110, 1
    v_lshrrev_b32 v110, 5, v110
    v_lshl_add_u32 v110, v110, 2, s19
    s_cmp_gt_u32 s29, 320
    s_cselect_b32 s2, 1, s2
    s_cselect_b64 exec, 0, -1
    ds_or_b32 v110, v111 offset:160
    s_mov_b64 exec, -1
    ds_wrxchg_rtn_b32 v7, v6, v5 offset:160
    s_waitcnt lgkmcnt(0)
    v_readlane_b32 s30, v7, 0
    v_readlane_b32 s31, v7, 1
    v_readlane_b32 s32, v7, 2
    v_readlane_b32 s33, v7, 3
    v_readlane_b32 s34, v7, 4
    v_readlane_b32 s35, v7, 5
    v_readlane_b32 s36, v7, 6
    v_readlane_b32 s37, v7, 7
    s_mov_b32 s25, s19
    s_mov_b32 s26, s27
    s_mov_b32 s51, s28
    s_mov_b32 s28, s29
    v_mbcnt_lo_u32_b32 v8, s30, 0
    v_mbcnt_hi_u32_b32 v8, s31, v8
    s_bcnt1_i32_b64 s14, s[30:31]
    v_lshl_add_u32 v9, v8, 1, s25
    ds_read_u16 v9, v9
    s_add_u32 s30, s26, 0
    s_lshl1_add_u32 s25, s14, s25
    s_lshl_b32 s14, s14, 10
    s_add_u32 s26, s26, s14
    v_mbcnt_lo_u32_b32 v12, s32, 0
    v_mbcnt_hi_u32_b32 v12, s33, v12
    s_bcnt1_i32_b64 s14, s[32:33]
    v_lshl_add_u32 v13, v12, 1, s25
    ds_read_u16 v13, v13
    s_add_u32 s32, s26, 1048576
    s_lshl1_add_u32 s25, s14, s25
    s_lshl_b32 s14, s14, 10
    s_add_u32 s26, s26, s14
    v_mbcnt_lo_u32_b32 v16, s34, 0
    v_mbcnt_hi_u32_b32 v16, s35, v16
    s_bcnt1_i32_b64 s14, s[34:35]
    v_lshl_add_u32 v17, v16, 1, s25
    ds_read_u16 v17, v17
    s_add_u32 s34, s26, 2097152
    s_lshl1_add_u32 s25, s14, s25
    s_lshl_b32 s14, s14, 10
    s_add_u32 s26, s26, s14
    v_mbcnt_lo_u32_b32 v20, s36, 0
    v_mbcnt_hi_u32_b32 v20, s37, v20
    s_bcnt1_i32_b64 s14, s[36:37]
    v_lshl_add_u32 v21, v20, 1, s25
    ds_read_u16 v21, v21
    s_add_u32 s36, s26, 3145728
    s_lshl1_add_u32 s25, s14, s25
    s_lshl_b32 s14, s14, 10
    s_add_u32 s26, s26, s14
    s_waitcnt lgkmcnt(3)
    v_mad_u32_u16 v9, v9, s23, v2
    v_pk_lshrrev_b16 v9, 10, v9 op_sel_hi:[1,1]
    v_lshl_add_u32 v8, v8, 6, v9
    buffer_load_dwordx4 v[8:11], v8, s[44:47], s30 idxen
    s_waitcnt lgkmcnt(2)
    v_mad_u32_u16 v13, v13, s23, v2
    v_pk_lshrrev_b16 v13, 10, v13 op_sel_hi:[1,1]
    v_lshl_add_u32 v12, v12, 6, v13
    buffer_load_dwordx4 v[12:15], v12, s[44:47], s32 idxen
    s_waitcnt lgkmcnt(1)
    v_mad_u32_u16 v17, v17, s23, v2
    v_pk_lshrrev_b16 v17, 10, v17 op_sel_hi:[1,1]
    v_lshl_add_u32 v16, v16, 6, v17
    buffer_load_dwordx4 v[16:19], v16, s[44:47], s34 idxen
    s_waitcnt lgkmcnt(0)
    v_mad_u32_u16 v21, v21, s23, v2
    v_pk_lshrrev_b16 v21, 10, v21 op_sel_hi:[1,1]
    v_lshl_add_u32 v20, v20, 6, v21
    buffer_load_dwordx4 v[20:23], v20, s[44:47], s36 idxen
    s_cmp_le_u32 s28, 256
    s_cbranch_scc1 L_p2_kernel_noopt_1
    v_readlane_b32 s38, v7, 8
    v_readlane_b32 s39, v7, 9
    s_nop 1
    v_mbcnt_lo_u32_b32 v120, s38, 0
    v_mbcnt_hi_u32_b32 v120, s39, v120
    s_bcnt1_i32_b64 s14, s[38:39]
    v_lshl_add_u32 v121, v120, 1, s25
    ds_read_u16 v121, v121
    s_add_u32 s38, s26, 4194304
    s_lshl1_add_u32 s25, s14, s25
    s_lshl_b32 s14, s14, 10
    s_add_u32 s26, s26, s14
    s_waitcnt lgkmcnt(0)
    v_mad_u32_u16 v121, v121, s23, v2
    v_pk_lshrrev_b16 v121, 10, v121 op_sel_hi:[1,1]
    v_lshl_add_u32 v120, v120, 6, v121
    buffer_load_dwordx4 v[24:27], v120, s[44:47], s38 idxen
L_p2_kernel_noopt_1:
    s_waitcnt vmcnt(6)
    ds_write_b128 v3, v[88:91] offset:0
    ds_write_b128 v3, v[92:95] offset:16384
    ds_write_b128 v3, v[96:99] offset:32768
    ds_write_b128 v3, v[100:103] offset:49152
    ds_write_b128 v124, v[104:107] offset:0
    s_waitcnt vmcnt(4)
    v_max3_u32 v64, v80, v82, v84
    v_add_f32 v65, v81, v83
    v_add_f32 v66, v85, v87
    v_max_u32 v64, v64, v86
    v_add_f32 v65, v65, v66
    v_cmp_lt_u32 vcc, 0xffff, v64
    s_nop 1
    v_max_u32_dpp v64, v64, v64 row_shr:1 row_mask:0xf bank_mask:0xf bound_ctrl:0
    s_nop 1
    v_max_u32_dpp v64, v64, v64 row_shr:2 row_mask:0xf bank_mask:0xf bound_ctrl:0
    s_nop 1
    v_max_u32_dpp v64, v64, v64 row_shr:4 row_mask:0xf bank_mask:0xf bound_ctrl:0
    s_nop 1
    v_max_u32_dpp v64, v64, v64 row_shr:8 row_mask:0xf bank_mask:0xf bound_ctrl:0
    s_nop 1
    v_max_u32_dpp v64, v64, v64 row_bcast:15 row_mask:0xa bank_mask:0xf
    s_nop 1
    v_max_u32_dpp v64, v64, v64 row_bcast:31 row_mask:0xc bank_mask:0xf
    s_nop 1
    v_add_f32_dpp v65, v65, v65 row_shr:1 row_mask:0xf bank_mask:0xf bound_ctrl:0
    s_nop 1
    v_add_f32_dpp v65, v65, v65 row_shr:2 row_mask:0xf bank_mask:0xf bound_ctrl:0
    s_nop 1
    v_add_f32_dpp v65, v65, v65 row_shr:4 row_mask:0xf bank_mask:0xf bound_ctrl:0
    s_nop 1
    v_add_f32_dpp v65, v65, v65 row_shr:8 row_mask:0xf bank_mask:0xf bound_ctrl:0
    s_nop 1
    v_add_f32_dpp v65, v65, v65 row_bcast:15 row_mask:0xa bank_mask:0xf
    s_nop 1
    v_add_f32_dpp v65, v65, v65 row_bcast:31 row_mask:0xc bank_mask:0xf
    s_cmp_lg_u64 vcc, 0
    s_cselect_b32 s2, 1, s2
    v_lshlrev_b32 v64, 16, v64
    v_mul_f32 v66, 936490775, v65
    v_mul_f32 v65, 928531664, v65
    v_cmp_nle_f32 vcc, v64, v66
    v_max_u32 v64, v64, v65
    s_nop 0
    v_readlane_b32 s14, v64, 63
    s_bitcmp1_b32 vcc_hi, 31
    s_cselect_b32 s2, 1, s2
    s_lshr_b32 s14, s14, 23
    s_add_u32 s14, s14, 1
    s_cmp_lt_u32 s14, 40
    s_cselect_b32 s2, 1, s2
    s_cmp_gt_u32 s14, 230
    s_cselect_b32 s2, 1, s2
    s_sub_u32 s48, s14, 14
    s_lshl_b32 s48, s48, 23
    s_add_u32 s16, s48, 272646144
    s_or_b32 s48, s48, 16416
    s_sub_u32 s14, s14, 40
    s_cmp_gt_u32 s14, 190
    s_cselect_b32 s48, 0, s48
    s_waitcnt lgkmcnt(0)
    s_barrier
    s_add_u32 s14, s22, 80000
    buffer_load_dwordx4 v[88:91], v1, s[8:11], s14 offen
    s_add_u32 s14, s22, 96384
    buffer_load_dwordx4 v[92:95], v1, s[8:11], s14 offen
    v_mad_u32_u16 v108, v28, v50, s40 op_sel:[1,0,0,0]
    v_mad_u32_u16 v109, v36, v50, s41 op_sel:[1,0,0,0]
    v_sub_u32_sdwa v110, v109, v108 dst_sel:DWORD dst_unused:UNUSED_PAD src0_sel:WORD_1 src1_sel:WORD_1
    s_nop 1
    v_add_u32_dpp v110, v110, v110 row_shr:1 row_mask:0xf bank_mask:0xf bound_ctrl:0
    s_nop 1
    v_add_u32_dpp v110, v110, v110 row_shr:2 row_mask:0xf bank_mask:0xf bound_ctrl:0
    s_nop 1
    v_add_u32_dpp v110, v110, v110 row_shr:4 row_mask:0xf bank_mask:0xf bound_ctrl:0
    s_nop 1
    v_add_u32_dpp v110, v110, v110 row_shr:8 row_mask:0xf bank_mask:0xf bound_ctrl:0
    s_nop 1
    v_add_u32_dpp v110, v110, v110 row_bcast:15 row_mask:0xa bank_mask:0xf
    s_nop 1
    v_add_u32_dpp v110, v110, v110 row_bcast:31 row_mask:0xc bank_mask:0xf
    v_sub_u32_sdwa v109, v109, v110 dst_sel:DWORD dst_unused:UNUSED_PAD src0_sel:WORD_1 src1_sel:DWORD
    v_readlane_b32 s29, v110, 63
    v_add_u32 v110, -1, v110
    ds_write_b16 v126, v109
    v_lshlrev_b32_e64 v111, v110, 1
    v_lshrrev_b32 v110, 5, v110
    v_lshl_add_u32 v110, v110, 2, s19
    s_cmp_gt_u32 s29, 320
    s_cselect_b32 s2, 1, s2
    s_cselect_b64 exec, 0, -1
    ds_or_b32 v110, v111 offset:160
    s_mov_b64 exec, -1
    ds_wrxchg_rtn_b32 v7, v6, v5 offset:160
    s_mov_b32 s24, 0
L_p2_loop:
    s_add_u32 s22, s22, 80000
    s_lshl_b32 s14, s13, 4
    s_or_b32 s14, s14, s24
    s_cmp_lg_u32 s14, 5
    s_cbranch_scc1 L_p2_nost
    v_mov_b32 v52, 0
    s_lshl_b32 s14, s3, 8
    s_add_u32 s14, s14, 8523776
    s_mov_b64 exec, 1
    buffer_atomic_add v52, off, s[4:7], s14 sc0
    s_mov_b64 exec, -1
L_p2_nost:
    s_waitcnt vmcnt(5)
    v_mad_u32_u16 v64, v8, 8, s18
    v_mad_u32_u16 v66, v9, 8, s18
    v_mad_u32_u16 v68, v10, 8, s18
    ds_read_b64 v[64:65], v64
    ds_read_b64 v[66:67], v66
    ds_read_b64 v[68:69], v68
    s_add_u32 s14, s22, 32768
    buffer_load_dwordx4 v[96:99], v1, s[8:11], s14 offen
    s_waitcnt vmcnt(5)
    v_mad_u32_u16 v70, v12, 8, s18
    v_mad_u32_u16 v72, v13, 8, s18
    v_mad_u32_u16 v74, v14, 8, s18
    ds_read_b64 v[70:71], v70
    ds_read_b64 v[72:73], v72
    ds_read_b64 v[74:75], v74
    s_add_u32 s14, s22, 49152
    buffer_load_dwordx4 v[100:103], v1, s[8:11], s14 offen
    s_waitcnt lgkmcnt(6)
    v_readlane_b32 s30, v7, 0
    v_readlane_b32 s31, v7, 1
    v_readlane_b32 s32, v7, 2
    v_readlane_b32 s33, v7, 3
    v_readlane_b32 s34, v7, 4
    v_readlane_b32 s35, v7, 5
    v_readlane_b32 s36, v7, 6
    v_readlane_b32 s37, v7, 7
    s_mov_b32 s25, s19
    s_mov_b32 s26, s27
    s_mov_b32 s51, s28
    s_mov_b32 s28, s29
    v_mbcnt_lo_u32_b32 v118, s30, 0
    v_mbcnt_hi_u32_b32 v118, s31, v118
    s_bcnt1_i32_b64 s14, s[30:31]
    v_lshl_add_u32 v119, v118, 1, s25
    ds_read_u16 v119, v119
    s_add_u32 s30, s26, 0
    s_lshl1_add_u32 s25, s14, s25
    s_lshl_b32 s14, s14, 10
    s_add_u32 s26, s26, s14
    v_bfe_i32 v108, v11, 2, 10
    v_bfe_i32 v109, v11, 12, 10
    v_ashrrev_i32 v110, 22, v11
    v_cvt_f32_i32 v108, v108
    v_cvt_f32_i32 v109, v109
    v_cvt_f32_i32 v110, v110
    v_mad_u32_u16 v8, v8, 8, s50 op_sel:[1,0,0,0]
    v_mad_u32_u16 v9, v9, 8, s50 op_sel:[1,0,0,0]
    v_mad_u32_u16 v10, v10, 8, s50 op_sel:[1,0,0,0]
    s_waitcnt lgkmcnt(4)
    v_lshlrev_b32 v112, 16, v64
    v_and_b32 v113, 0xffff0000, v64
    v_lshlrev_b32 v64, 16, v65
    v_and_b32 v65, 0xffff0000, v65
    v_lshlrev_b32 v114, 16, v66
    v_and_b32 v115, 0xffff0000, v66
    v_lshlrev_b32 v66, 16, v67
    v_and_b32 v67, 0xffff0000, v67
    v_lshlrev_b32 v116, 16, v68
    v_and_b32 v117, 0xffff0000, v68
    v_lshlrev_b32 v68, 16, v69
    v_and_b32 v69, 0xffff0000, v69
    v_pk_fma_f32 v[112:113], v[112:113], v[108:109], s[16:17] op_sel:[0,0,0] op_sel_hi:[1,0,0]
    v_pk_fma_f32 v[64:65], v[64:65], v[108:109], s[16:17] op_sel:[0,0,0] op_sel_hi:[1,0,0]
    v_pk_fma_f32 v[114:115], v[114:115], v[108:109], s[16:17] op_sel:[0,1,0] op_sel_hi:[1,1,0]
    v_pk_fma_f32 v[66:67], v[66:67], v[108:109], s[16:17] op_sel:[0,1,0] op_sel_hi:[1,1,0]
    v_pk_fma_f32 v[116:117], v[116:117], v[110:111], s[16:17] op_sel:[0,0,0] op_sel_hi:[1,0,0]
    v_pk_fma_f32 v[68:69], v[68:69], v[110:111], s[16:17] op_sel:[0,0,0] op_sel_hi:[1,0,0]
    v_perm_b32 v65, v65, v64, s17
    v_perm_b32 v64, v113, v112, s17
    v_perm_b32 v67, v67, v66, s17
    v_perm_b32 v66, v115, v114, s17
    v_perm_b32 v69, v69, v68, s17
    v_perm_b32 v68, v117, v116, s17
    v_lshl_add_u64 v[64:65], v[64:65], 0, s[20:21]
    v_lshl_add_u64 v[66:67], v[66:67], 0, s[20:21]
    v_lshl_add_u64 v[68:69], v[68:69], 0, s[20:21]
    v_or3_b32 v4, v44, v45, v4
    v_or3_b32 v4, v46, v47, v4
    v_or3_b32 v4, v48, v49, v4
    ds_add_rtn_u64 v[44:45], v8, v[64:65]
    ds_add_rtn_u64 v[46:47], v9, v[66:67]
    ds_add_rtn_u64 v[48:49], v10, v[68:69]
    s_waitcnt lgkmcnt(3)
    v_mad_u32_u16 v119, v119, s23, v2
    v_pk_lshrrev_b16 v119, 10, v119 op_sel_hi:[1,1]
    v_lshl_add_u32 v118, v118, 6, v119
    buffer_load_dwordx4 v[8:11], v118, s[44:47], s30 idxen
    s_add_u32 s14, s22, 65536
    buffer_load_dwordx4 v[104:107], v1, s[8:11], s14 offen
    s_waitcnt vmcnt(7)
    v_mad_u32_u16 v76, v16, 8, s18
    v_mad_u32_u16 v78, v17, 8, s18
    v_mad_u32_u16 v80, v18, 8, s18
    ds_read_b64 v[76:77], v76
    ds_read_b64 v[78:79], v78
    ds_read_b64 v[80:81], v80
    s_waitcnt vmcnt(6)
    v_mad_u32_u16 v82, v20, 8, s18
    v_mad_u32_u16 v84, v21, 8, s18
    v_mad_u32_u16 v86, v22, 8, s18
    ds_read_b64 v[82:83], v82
    ds_read_b64 v[84:85], v84
    ds_read_b64 v[86:87], v86
    v_mbcnt_lo_u32_b32 v118, s32, 0
    v_mbcnt_hi_u32_b32 v118, s33, v118
    s_bcnt1_i32_b64 s14, s[32:33]
    v_lshl_add_u32 v119, v118, 1, s25
    ds_read_u16 v119, v119
    s_add_u32 s32, s26, 1048576
    s_lshl1_add_u32 s25, s14, s25
    s_lshl_b32 s14, s14, 10
    s_add_u32 s26, s26, s14
    v_bfe_i32 v108, v15, 2, 10
    v_bfe_i32 v109, v15, 12, 10
    v_ashrrev_i32 v110, 22, v15
    v_cvt_f32_i32 v108, v108
    v_cvt_f32_i32 v109, v109
    v_cvt_f32_i32 v110, v110
    v_mad_u32_u16 v12, v12, 8, s50 op_sel:[1,0,0,0]
    v_mad_u32_u16 v13, v13, 8, s50 op_sel:[1,0,0,0]
    v_mad_u32_u16 v14, v14, 8, s50 op_sel:[1,0,0,0]
    v_lshlrev_b32 v112, 16, v70
    v_and_b32 v113, 0xffff0000, v70
    v_lshlrev_b32 v70, 16, v71
    v_and_b32 v71, 0xffff0000, v71
    v_lshlrev_b32 v114, 16, v72
    v_and_b32 v115, 0xffff0000, v72
    v_lshlrev_b32 v72, 16, v73
    v_and_b32 v73, 0xffff0000, v73
    v_lshlrev_b32 v116, 16, v74
    v_and_b32 v117, 0xffff0000, v74
    v_lshlrev_b32 v74, 16, v75
    v_and_b32 v75, 0xffff0000, v75
    v_pk_fma_f32 v[112:113], v[112:113], v[108:109], s[16:17] op_sel:[0,0,0] op_sel_hi:[1,0,0]
    v_pk_fma_f32 v[70:71], v[70:71], v[108:109], s[16:17] op_sel:[0,0,0] op_sel_hi:[1,0,0]
    v_pk_fma_f32 v[114:115], v[114:115], v[108:109], s[16:17] op_sel:[0,1,0] op_sel_hi:[1,1,0]
    v_pk_fma_f32 v[72:73], v[72:73], v[108:109], s[16:17] op_sel:[0,1,0] op_sel_hi:[1,1,0]
    v_pk_fma_f32 v[116:117], v[116:117], v[110:111], s[16:17] op_sel:[0,0,0] op_sel_hi:[1,0,0]
    v_pk_fma_f32 v[74:75], v[74:75], v[110:111], s[16:17] op_sel:[0,0,0] op_sel_hi:[1,0,0]
    v_perm_b32 v71, v71, v70, s17
    v_perm_b32 v70, v113, v112, s17
    v_perm_b32 v73, v73, v72, s17
    v_perm_b32 v72, v115, v114, s17
    v_perm_b32 v75, v75, v74, s17
    v_perm_b32 v74, v117, v116, s17
    v_lshl_add_u64 v[70:71], v[70:71], 0, s[20:21]
    v_lshl_add_u64 v[72:73], v[72:73], 0, s[20:21]
    v_lshl_add_u64 v[74:75], v[74:75], 0, s[20:21]
    s_waitcnt lgkmcnt(7)
    v_or3_b32 v4, v44, v45, v4
    v_or3_b32 v4, v46, v47, v4
    v_or3_b32 v4, v48, v49, v4
    ds_add_rtn_u64 v[44:45], v12, v[70:71]
    ds_add_rtn_u64 v[46:47], v13, v[72:73]
    ds_add_rtn_u64 v[48:49], v14, v[74:75]
    s_waitcnt lgkmcnt(3)
    v_mad_u32_u16 v119, v119, s23, v2
    v_pk_lshrrev_b16 v119, 10, v119 op_sel_hi:[1,1]
    v_lshl_add_u32 v118, v118, 6, v119
    buffer_load_dwordx4 v[12:15], v118, s[44:47], s32 idxen
    s_cmp_le_u32 s51, 256
    s_cbranch_scc1 L_p2_kernel_noopt2_2
    v_mad_u32_u16 v64, v24, 8, s18
    v_mad_u32_u16 v66, v25, 8, s18
    v_mad_u32_u16 v68, v26, 8, s18
    ds_read_b64 v[64:65], v64
    ds_read_b64 v[66:67], v66
    ds_read_b64 v[68:69], v68
    v_bfe_i32 v108, v27, 2, 10
    v_bfe_i32 v109, v27, 12, 10
    v_ashrrev_i32 v110, 22, v27
    v_cvt_f32_i32 v108, v108
    v_cvt_f32_i32 v109, v109
    v_cvt_f32_i32 v110, v110
    v_mad_u32_u16 v24, v24, 8, s50 op_sel:[1,0,0,0]
    v_mad_u32_u16 v25, v25, 8, s50 op_sel:[1,0,0,0]
    v_mad_u32_u16 v26, v26, 8, s50 op_sel:[1,0,0,0]
    s_waitcnt lgkmcnt(0)
    v_lshlrev_b32 v112, 16, v64
    v_and_b32 v113, 0xffff0000, v64
    v_lshlrev_b32 v64, 16, v65
    v_and_b32 v65, 0xffff0000, v65
    v_lshlrev_b32 v114, 16, v66
    v_and_b32 v115, 0xffff0000, v66
    v_lshlrev_b32 v66, 16, v67
    v_and_b32 v67, 0xffff0000, v67
    v_lshlrev_b32 v116, 16, v68
    v_and_b32 v117, 0xffff0000, v68
    v_lshlrev_b32 v68, 16, v69
    v_and_b32 v69, 0xffff0000, v69
    v_pk_fma_f32 v[112:113], v[112:113], v[108:109], s[16:17] op_sel:[0,0,0] op_sel_hi:[1,0,0]
    v_pk_fma_f32 v[64:65], v[64:65], v[108:109], s[16:17] op_sel:[0,0,0] op_sel_hi:[1,0,0]
    v_pk_fma_f32 v[114:115], v[114:115], v[108:109], s[16:17] op_sel:[0,1,0] op_sel_hi:[1,1,0]
    v_pk_fma_f32 v[66:67], v[66:67], v[108:109], s[16:17] op_sel:[0,1,0] op_sel_hi:[1,1,0]
    v_pk_fma_f32 v[116:117], v[116:117], v[110:111], s[16:17] op_sel:[0,0,0] op_sel_hi:[1,0,0]
    v_pk_fma_f32 v[68:69], v[68:69], v[110:111], s[16:17] op_sel:[0,0,0] op_sel_hi:[1,0,0]
    v_perm_b32 v65, v65, v64, s17
    v_perm_b32 v64, v113, v112, s17
    v_perm_b32 v67, v67, v66, s17
    v_perm_b32 v66, v115, v114, s17
    v_perm_b32 v69, v69, v68, s17
    v_perm_b32 v68, v117, v116, s17
    v_lshl_add_u64 v[64:65], v[64:65], 0, s[20:21]
    v_lshl_add_u64 v[66:67], v[66:67], 0, s[20:21]
    v_lshl_add_u64 v[68:69], v[68:69], 0, s[20:21]
    v_or3_b32 v4, v44, v45, v4
    v_or3_b32 v4, v46, v47, v4
    v_or3_b32 v4, v48, v49, v4
    ds_add_rtn_u64 v[44:45], v24, v[64:65]
    ds_add_rtn_u64 v[46:47], v25, v[66:67]
    ds_add_rtn_u64 v[48:49], v26, v[68:69]
L_p2_kernel_noopt2_2:
    s_barrier
    s_waitcnt vmcnt(1)
    ds_write_b128 v3, v[88:91] offset:0
    ds_write_b128 v3, v[92:95] offset:16384
    ds_write_b128 v3, v[96:99] offset:32768
    ds_write_b128 v3, v[100:103] offset:49152
    ds_write_b128 v124, v[104:107] offset:0
    v_mbcnt_lo_u32_b32 v118, s34, 0
    v_mbcnt_hi_u32_b32 v118, s35, v118
    s_bcnt1_i32_b64 s14, s[34:35]
    v_lshl_add_u32 v119, v118, 1, s25
    ds_read_u16 v119, v119
    s_add_u32 s34, s26, 2097152
    s_lshl1_add_u32 s25, s14, s25
    s_lshl_b32 s14, s14, 10
    s_add_u32 s26, s26, s14
    v_bfe_i32 v108, v19, 2, 10
    v_bfe_i32 v109, v19, 12, 10
    v_ashrrev_i32 v110, 22, v19
    v_cvt_f32_i32 v108, v108
    v_cvt_f32_i32 v109, v109
    v_cvt_f32_i32 v110, v110
    v_mad_u32_u16 v16, v16, 8, s50 op_sel:[1,0,0,0]
    v_mad_u32_u16 v17, v17, 8, s50 op_sel:[1,0,0,0]
    v_mad_u32_u16 v18, v18, 8, s50 op_sel:[1,0,0,0]
    v_lshlrev_b32 v112, 16, v76
    v_and_b32 v113, 0xffff0000, v76
    v_lshlrev_b32 v76, 16, v77
    v_and_b32 v77, 0xffff0000, v77
    v_lshlrev_b32 v114, 16, v78
    v_and_b32 v115, 0xffff0000, v78
    v_lshlrev_b32 v78, 16, v79
    v_and_b32 v79, 0xffff0000, v79
    v_lshlrev_b32 v116, 16, v80
    v_and_b32 v117, 0xffff0000, v80
    v_lshlrev_b32 v80, 16, v81
    v_and_b32 v81, 0xffff0000, v81
    v_pk_fma_f32 v[112:113], v[112:113], v[108:109], s[16:17] op_sel:[0,0,0] op_sel_hi:[1,0,0]
    v_pk_fma_f32 v[76:77], v[76:77], v[108:109], s[16:17] op_sel:[0,0,0] op_sel_hi:[1,0,0]
    v_pk_fma_f32 v[114:115], v[114:115], v[108:109], s[16:17] op_sel:[0,1,0] op_sel_hi:[1,1,0]
    v_pk_fma_f32 v[78:79], v[78:79], v[108:109], s[16:17] op_sel:[0,1,0] op_sel_hi:[1,1,0]
    v_pk_fma_f32 v[116:117], v[116:117], v[110:111], s[16:17] op_sel:[0,0,0] op_sel_hi:[1,0,0]
    v_pk_fma_f32 v[80:81], v[80:81], v[110:111], s[16:17] op_sel:[0,0,0] op_sel_hi:[1,0,0]
    v_perm_b32 v77, v77, v76, s17
    v_perm_b32 v76, v113, v112, s17
    v_perm_b32 v79, v79, v78, s17
    v_perm_b32 v78, v115, v114, s17
    v_perm_b32 v81, v81, v80, s17
    v_perm_b32 v80, v117, v116, s17
    v_lshl_add_u64 v[76:77], v[76:77], 0, s[20:21]
    v_lshl_add_u64 v[78:79], v[78:79], 0, s[20:21]
    v_lshl_add_u64 v[80:81], v[80:81], 0, s[20:21]
    s_waitcnt lgkmcnt(6)
    v_or3_b32 v4, v44, v45, v4
    v_or3_b32 v4, v46, v47, v4
    v_or3_b32 v4, v48, v49, v4
    ds_add_rtn_u64 v[44:45], v16, v[76:77]
    ds_add_rtn_u64 v[46:47], v17, v[78:79]
    ds_add_rtn_u64 v[48:49], v18, v[80:81]
    s_waitcnt lgkmcnt(3)
    v_mad_u32_u16 v119, v119, s23, v2
    v_pk_lshrrev_b16 v119, 10, v119 op_sel_hi:[1,1]
    v_lshl_add_u32 v118, v118, 6, v119
    buffer_load_dwordx4 v[16:19], v118, s[44:47], s34 idxen
    v_mbcnt_lo_u32_b32 v118, s36, 0
    v_mbcnt_hi_u32_b32 v118, s37, v118
    s_bcnt1_i32_b64 s14, s[36:37]
    v_lshl_add_u32 v119, v118, 1, s25
    ds_read_u16 v119, v119
    s_add_u32 s36, s26, 3145728
    s_lshl1_add_u32 s25, s14, s25
    s_lshl_b32 s14, s14, 10
    s_add_u32 s26, s26, s14
    v_bfe_i32 v108, v23, 2, 10
    v_bfe_i32 v109, v23, 12, 10
    v_ashrrev_i32 v110, 22, v23
    v_cvt_f32_i32 v108, v108
    v_cvt_f32_i32 v109, v109
    v_cvt_f32_i32 v110, v110
    v_mad_u32_u16 v20, v20, 8, s50 op_sel:[1,0,0,0]
    v_mad_u32_u16 v21, v21, 8, s50 op_sel:[1,0,0,0]
    v_mad_u32_u16 v22, v22, 8, s50 op_sel:[1,0,0,0]
    v_lshlrev_b32 v112, 16, v82
    v_and_b32 v113, 0xffff0000, v82
    v_lshlrev_b32 v82, 16, v83
    v_and_b32 v83, 0xffff0000, v83
    v_lshlrev_b32 v114, 16, v84
    v_and_b32 v115, 0xffff0000, v84
    v_lshlrev_b32 v84, 16, v85
    v_and_b32 v85, 0xffff0000, v85
    v_lshlrev_b32 v116, 16, v86
    v_and_b32 v117, 0xffff0000, v86
    v_lshlrev_b32 v86, 16, v87
    v_and_b32 v87, 0xffff0000, v87
    v_pk_fma_f32 v[112:113], v[112:113], v[108:109], s[16:17] op_sel:[0,0,0] op_sel_hi:[1,0,0]
    v_pk_fma_f32 v[82:83], v[82:83], v[108:109], s[16:17] op_sel:[0,0,0] op_sel_hi:[1,0,0]
    v_pk_fma_f32 v[114:115], v[114:115], v[108:109], s[16:17] op_sel:[0,1,0] op_sel_hi:[1,1,0]
    v_pk_fma_f32 v[84:85], v[84:85], v[108:109], s[16:17] op_sel:[0,1,0] op_sel_hi:[1,1,0]
    v_pk_fma_f32 v[116:117], v[116:117], v[110:111], s[16:17] op_sel:[0,0,0] op_sel_hi:[1,0,0]
    v_pk_fma_f32 v[86:87], v[86:87], v[110:111], s[16:17] op_sel:[0,0,0] op_sel_hi:[1,0,0]
    v_perm_b32 v83, v83, v82, s17
    v_perm_b32 v82, v113, v112, s17
    v_perm_b32 v85, v85, v84, s17
    v_perm_b32 v84, v115, v114, s17
    v_perm_b32 v87, v87, v86, s17
    v_perm_b32 v86, v117, v116, s17
    v_lshl_add_u64 v[82:83], v[82:83], 0, s[20:21]
    v_lshl_add_u64 v[84:85], v[84:85], 0, s[20:21]
    v_lshl_add_u64 v[86:87], v[86:87], 0, s[20:21]
    s_waitcnt lgkmcnt(1)
    v_or3_b32 v4, v44, v45, v4
    v_or3_b32 v4, v46, v47, v4
    v_or3_b32 v4, v48, v49, v4
    ds_add_rtn_u64 v[44:45], v20, v[82:83]
    ds_add_rtn_u64 v[46:47], v21, v[84:85]
    ds_add_rtn_u64 v[48:49], v22, v[86:87]
    s_waitcnt lgkmcnt(3)
    v_mad_u32_u16 v119, v119, s23, v2
    v_pk_lshrrev_b16 v119, 10, v119 op_sel_hi:[1,1]
    v_lshl_add_u32 v118, v118, 6, v119
    buffer_load_dwordx4 v[20:23], v118, s[44:47], s36 idxen
    s_cmp_le_u32 s28, 256
    s_cbranch_scc1 L_p2_kernel_noopt_3
    v_readlane_b32 s38, v7, 8
    v_readlane_b32 s39, v7, 9
    s_nop 1
    v_mbcnt_lo_u32_b32 v120, s38, 0
    v_mbcnt_hi_u32_b32 v120, s39, v120
    s_bcnt1_i32_b64 s14, s[38:39]
    v_lshl_add_u32 v121, v120, 1, s25
    ds_read_u16 v121, v121
    s_add_u32 s38, s26, 4194304
    s_lshl1_add_u32 s25, s14, s25
    s_lshl_b32 s14, s14, 10
    s_add_u32 s26, s26, s14
    s_waitcnt lgkmcnt(0)
    v_mad_u32_u16 v121, v121, s23, v2
    v_pk_lshrrev_b16 v121, 10, v121 op_sel_hi:[1,1]
    v_lshl_add_u32 v120, v120, 6, v121
    buffer_load_dwordx4 v[24:27], v120, s[44:47], s38 idxen
L_p2_kernel_noopt_3:
    v_pk_mov_b32 v[28:29], v[28:29], v[30:31] op_sel:[1,0]
    v_pk_mov_b32 v[30:31], v[30:31], v[32:33] op_sel:[1,0]
    v_pk_mov_b32 v[32:33], v[32:33], v[34:35] op_sel:[1,0]
    v_pk_mov_b32 v[34:35], v[34:35], v[4:5] op_sel:[1,1]
    v_pk_mov_b32 v[36:37], v[36:37], v[38:39] op_sel:[1,0]
    v_pk_mov_b32 v[38:39], v[38:39], v[40:41] op_sel:[1,0]
    v_pk_mov_b32 v[40:41], v[40:41], v[42:43] op_sel:[1,0]
    v_pk_mov_b32 v[42:43], v[42:43], v[4:5] op_sel:[1,1]
    v_mad_u32_u16 v108, v28, v50, s40 op_sel:[0,0,0,0]
    v_mad_u32_u16 v109, v36, v50, s41 op_sel:[0,0,0,0]
    v_sub_u32_sdwa v110, v109, v108 dst_sel:DWORD dst_unused:UNUSED_PAD src0_sel:WORD_1 src1_sel:WORD_1
    s_nop 1
    v_add_u32_dpp v110, v110, v110 row_shr:1 row_mask:0xf bank_mask:0xf bound_ctrl:0
    s_nop 1
    v_add_u32_dpp v110, v110, v110 row_shr:2 row_mask:0xf bank_mask:0xf bound_ctrl:0
    s_nop 1
    v_add_u32_dpp v110, v110, v110 row_shr:4 row_mask:0xf bank_mask:0xf bound_ctrl:0
    s_nop 1
    v_add_u32_dpp v110, v110, v110 row_shr:8 row_mask:0xf bank_mask:0xf bound_ctrl:0
    s_nop 1
    v_add_u32_dpp v110, v110, v110 row_bcast:15 row_mask:0xa bank_mask:0xf
    s_nop 1
    v_add_u32_dpp v110, v110, v110 row_bcast:31 row_mask:0xc bank_mask:0xf
    v_sub_u32_sdwa v109, v109, v110 dst_sel:DWORD dst_unused:UNUSED_PAD src0_sel:WORD_1 src1_sel:DWORD
    v_readlane_b32 s29, v110, 63
    v_add_u32 v110, -1, v110
    ds_write_b16 v126, v109
    v_lshlrev_b32_e64 v111, v110, 1
    v_lshrrev_b32 v110, 5, v110
    v_lshl_add_u32 v110, v110, 2, s19
    s_cmp_gt_u32 s29, 320
    s_cselect_b32 s2, 1, s2
    s_cselect_b64 exec, 0, -1
    ds_or_b32 v110, v111 offset:160
    s_mov_b64 exec, -1
    ds_wrxchg_rtn_b32 v7, v6, v5 offset:160
    s_add_u32 s14, s22, 80000
    buffer_load_dwordx4 v[88:91], v1, s[8:11], s14 offen
    s_add_u32 s14, s22, 96384
    buffer_load_dwordx4 v[92:95], v1, s[8:11], s14 offen
    s_barrier
    s_add_u32 s22, s22, 80000
    s_cmp_lg_u32 s24, 7
    s_cbranch_scc1 L_p2_nodist
    s_mov_b32 s46, 0
    s_lshl2_add_u32 s14, s3, s12
    s_mul_i32 s14, s14, 5000
    s_add_u32 s15, s14, 4096
    v_min_u32 v61, 225, v0
    v_lshl_add_u32 v60, v0, 2, s14
    v_lshl_add_u32 v61, v61, 2, s15
    global_load_dword v60, v60, s[100:101] nt
    global_load_dword v61, v61, s[100:101] nt
L_p2_nodist:
    v_mad_u32_u16 v64, v8, 8, s18
    v_mad_u32_u16 v66, v9, 8, s18
    v_mad_u32_u16 v68, v10, 8, s18
    ds_read_b64 v[64:65], v64
    ds_read_b64 v[66:67], v66
    ds_read_b64 v[68:69], v68
    s_add_u32 s14, s22, 32768
    buffer_load_dwordx4 v[96:99], v1, s[8:11], s14 offen
    s_waitcnt vmcnt(5)
    v_mad_u32_u16 v70, v12, 8, s18
    v_mad_u32_u16 v72, v13, 8, s18
    v_mad_u32_u16 v74, v14, 8, s18
    ds_read_b64 v[70:71], v70
    ds_read_b64 v[72:73], v72
    ds_read_b64 v[74:75], v74
    s_add_u32 s14, s22, 49152
    buffer_load_dwordx4 v[100:103], v1, s[8:11], s14 offen
    s_waitcnt lgkmcnt(6)
    v_readlane_b32 s30, v7, 0
    v_readlane_b32 s31, v7, 1
    v_readlane_b32 s32, v7, 2
    v_readlane_b32 s33, v7, 3
    v_readlane_b32 s34, v7, 4
    v_readlane_b32 s35, v7, 5
    v_readlane_b32 s36, v7, 6
    v_readlane_b32 s37, v7, 7
    s_mov_b32 s25, s19
    s_mov_b32 s26, s27
    s_mov_b32 s51, s28
    s_mov_b32 s28, s29
    v_mbcnt_lo_u32_b32 v118, s30, 0
    v_mbcnt_hi_u32_b32 v118, s31, v118
    s_bcnt1_i32_b64 s14, s[30:31]
    v_lshl_add_u32 v119, v118, 1, s25
    ds_read_u16 v119, v119
    s_add_u32 s30, s26, 0
    s_lshl1_add_u32 s25, s14, s25
    s_lshl_b32 s14, s14, 10
    s_add_u32 s26, s26, s14
    v_bfe_i32 v108, v11, 2, 10
    v_bfe_i32 v109, v11, 12, 10
    v_ashrrev_i32 v110, 22, v11
    v_cvt_f32_i32 v108, v108
    v_cvt_f32_i32 v109, v109
    v_cvt_f32_i32 v110, v110
    v_mad_u32_u16 v8, v8, 8, s50 op_sel:[1,0,0,0]
    v_mad_u32_u16 v9, v9, 8, s50 op_sel:[1,0,0,0]
    v_mad_u32_u16 v10, v10, 8, s50 op_sel:[1,0,0,0]
    s_waitcnt lgkmcnt(4)
    v_lshlrev_b32 v112, 16, v64
    v_and_b32 v113, 0xffff0000, v64
    v_lshlrev_b32 v64, 16, v65
    v_and_b32 v65, 0xffff0000, v65
    v_lshlrev_b32 v114, 16, v66
    v_and_b32 v115, 0xffff0000, v66
    v_lshlrev_b32 v66, 16, v67
    v_and_b32 v67, 0xffff0000, v67
    v_lshlrev_b32 v116, 16, v68
    v_and_b32 v117, 0xffff0000, v68
    v_lshlrev_b32 v68, 16, v69
    v_and_b32 v69, 0xffff0000, v69
    v_pk_fma_f32 v[112:113], v[112:113], v[108:109], s[16:17] op_sel:[0,0,0] op_sel_hi:[1,0,0]
    v_pk_fma_f32 v[64:65], v[64:65], v[108:109], s[16:17] op_sel:[0,0,0] op_sel_hi:[1,0,0]
    v_pk_fma_f32 v[114:115], v[114:115], v[108:109], s[16:17] op_sel:[0,1,0] op_sel_hi:[1,1,0]
    v_pk_fma_f32 v[66:67], v[66:67], v[108:109], s[16:17] op_sel:[0,1,0] op_sel_hi:[1,1,0]
    v_pk_fma_f32 v[116:117], v[116:117], v[110:111], s[16:17] op_sel:[0,0,0] op_sel_hi:[1,0,0]
    v_pk_fma_f32 v[68:69], v[68:69], v[110:111], s[16:17] op_sel:[0,0,0] op_sel_hi:[1,0,0]
    v_perm_b32 v65, v65, v64, s17
    v_perm_b32 v64, v113, v112, s17
    v_perm_b32 v67, v67, v66, s17
    v_perm_b32 v66, v115, v114, s17
    v_perm_b32 v69, v69, v68, s17
    v_perm_b32 v68, v117, v116, s17
    v_lshl_add_u64 v[64:65], v[64:65], 0, s[20:21]
    v_lshl_add_u64 v[66:67], v[66:67], 0, s[20:21]
    v_lshl_add_u64 v[68:69], v[68:69], 0, s[20:21]
    v_or3_b32 v4, v44, v45, v4
    v_or3_b32 v4, v46, v47, v4
    v_or3_b32 v4, v48, v49, v4
    ds_add_rtn_u64 v[44:45], v8, v[64:65]
    ds_add_rtn_u64 v[46:47], v9, v[66:67]
    ds_add_rtn_u64 v[48:49], v10, v[68:69]
    s_waitcnt lgkmcnt(3)
    v_mad_u32_u16 v119, v119, s23, v2
    v_pk_lshrrev_b16 v119, 10, v119 op_sel_hi:[1,1]
    v_lshl_add_u32 v118, v118, 6, v119
    buffer_load_dwordx4 v[8:11], v118, s[44:47], s30 idxen
    s_add_u32 s14, s22, 65536
    buffer_load_dwordx4 v[104:107], v1, s[8:11], s14 offen
    s_waitcnt vmcnt(7)
    v_mad_u32_u16 v76, v16, 8, s18
    v_mad_u32_u16 v78, v17, 8, s18
    v_mad_u32_u16 v80, v18, 8, s18
    ds_read_b64 v[76:77], v76
    ds_read_b64 v[78:79], v78
    ds_read_b64 v[80:81], v80
    s_waitcnt vmcnt(6)
    v_mad_u32_u16 v82, v20, 8, s18
    v_mad_u32_u16 v84, v21, 8, s18
    v_mad_u32_u16 v86, v22, 8, s18
    ds_read_b64 v[82:83], v82
    ds_read_b64 v[84:85], v84
    ds_read_b64 v[86:87], v86
    v_mbcnt_lo_u32_b32 v118, s32, 0
    v_mbcnt_hi_u32_b32 v118, s33, v118
    s_bcnt1_i32_b64 s14, s[32:33]
    v_lshl_add_u32 v119, v118, 1, s25
    ds_read_u16 v119, v119
    s_add_u32 s32, s26, 1048576
    s_lshl1_add_u32 s25, s14, s25
    s_lshl_b32 s14, s14, 10
    s_add_u32 s26, s26, s14
    v_bfe_i32 v108, v15, 2, 10
    v_bfe_i32 v109, v15, 12, 10
    v_ashrrev_i32 v110, 22, v15
    v_cvt_f32_i32 v108, v108
    v_cvt_f32_i32 v109, v109
    v_cvt_f32_i32 v110, v110
    v_mad_u32_u16 v12, v12, 8, s50 op_sel:[1,0,0,0]
    v_mad_u32_u16 v13, v13, 8, s50 op_sel:[1,0,0,0]
    v_mad_u32_u16 v14, v14, 8, s50 op_sel:[1,0,0,0]
    v_lshlrev_b32 v112, 16, v70
    v_and_b32 v113, 0xffff0000, v70
    v_lshlrev_b32 v70, 16, v71
    v_and_b32 v71, 0xffff0000, v71
    v_lshlrev_b32 v114, 16, v72
    v_and_b32 v115, 0xffff0000, v72
    v_lshlrev_b32 v72, 16, v73
    v_and_b32 v73, 0xffff0000, v73
    v_lshlrev_b32 v116, 16, v74
    v_and_b32 v117, 0xffff0000, v74
    v_lshlrev_b32 v74, 16, v75
    v_and_b32 v75, 0xffff0000, v75
    v_pk_fma_f32 v[112:113], v[112:113], v[108:109], s[16:17] op_sel:[0,0,0] op_sel_hi:[1,0,0]
    v_pk_fma_f32 v[70:71], v[70:71], v[108:109], s[16:17] op_sel:[0,0,0] op_sel_hi:[1,0,0]
    v_pk_fma_f32 v[114:115], v[114:115], v[108:109], s[16:17] op_sel:[0,1,0] op_sel_hi:[1,1,0]
    v_pk_fma_f32 v[72:73], v[72:73], v[108:109], s[16:17] op_sel:[0,1,0] op_sel_hi:[1,1,0]
    v_pk_fma_f32 v[116:117], v[116:117], v[110:111], s[16:17] op_sel:[0,0,0] op_sel_hi:[1,0,0]
    v_pk_fma_f32 v[74:75], v[74:75], v[110:111], s[16:17] op_sel:[0,0,0] op_sel_hi:[1,0,0]
    v_perm_b32 v71, v71, v70, s17
    v_perm_b32 v70, v113, v112, s17
    v_perm_b32 v73, v73, v72, s17
    v_perm_b32 v72, v115, v114, s17
    v_perm_b32 v75, v75, v74, s17
    v_perm_b32 v74, v117, v116, s17
    v_lshl_add_u64 v[70:71], v[70:71], 0, s[20:21]
    v_lshl_add_u64 v[72:73], v[72:73], 0, s[20:21]
    v_lshl_add_u64 v[74:75], v[74:75], 0, s[20:21]
    s_waitcnt lgkmcnt(7)
    v_or3_b32 v4, v44, v45, v4
    v_or3_b32 v4, v46, v47, v4
    v_or3_b32 v4, v48, v49, v4
    ds_add_rtn_u64 v[44:45], v12, v[70:71]
    ds_add_rtn_u64 v[46:47], v13, v[72:73]
    ds_add_rtn_u64 v[48:49], v14, v[74:75]
    s_waitcnt lgkmcnt(3)
    v_mad_u32_u16 v119, v119, s23, v2
    v_pk_lshrrev_b16 v119, 10, v119 op_sel_hi:[1,1]
    v_lshl_add_u32 v118, v118, 6, v119
    buffer_load_dwordx4 v[12:15], v118, s[44:47], s32 idxen
    s_cmp_le_u32 s51, 256
    s_cbranch_scc1 L_p2_kernel_noopt2_4
    v_mad_u32_u16 v64, v24, 8, s18
    v_mad_u32_u16 v66, v25, 8, s18
    v_mad_u32_u16 v68, v26, 8, s18
    ds_read_b64 v[64:65], v64
    ds_read_b64 v[66:67], v66
    ds_read_b64 v[68:69], v68
    v_bfe_i32 v108, v27, 2, 10
    v_bfe_i32 v109, v27, 12, 10
    v_ashrrev_i32 v110, 22, v27
    v_cvt_f32_i32 v108, v108
    v_cvt_f32_i32 v109, v109
    v_cvt_f32_i32 v110, v110
    v_mad_u32_u16 v24, v24, 8, s50 op_sel:[1,0,0,0]
    v_mad_u32_u16 v25, v25, 8, s50 op_sel:[1,0,0,0]
    v_mad_u32_u16 v26, v26, 8, s50 op_sel:[1,0,0,0]
    s_waitcnt lgkmcnt(0)
    v_lshlrev_b32 v112, 16, v64
    v_and_b32 v113, 0xffff0000, v64
    v_lshlrev_b32 v64, 16, v65
    v_and_b32 v65, 0xffff0000, v65
    v_lshlrev_b32 v114, 16, v66
    v_and_b32 v115, 0xffff0000, v66
    v_lshlrev_b32 v66, 16, v67
    v_and_b32 v67, 0xffff0000, v67
    v_lshlrev_b32 v116, 16, v68
    v_and_b32 v117, 0xffff0000, v68
    v_lshlrev_b32 v68, 16, v69
    v_and_b32 v69, 0xffff0000, v69
    v_pk_fma_f32 v[112:113], v[112:113], v[108:109], s[16:17] op_sel:[0,0,0] op_sel_hi:[1,0,0]
    v_pk_fma_f32 v[64:65], v[64:65], v[108:109], s[16:17] op_sel:[0,0,0] op_sel_hi:[1,0,0]
    v_pk_fma_f32 v[114:115], v[114:115], v[108:109], s[16:17] op_sel:[0,1,0] op_sel_hi:[1,1,0]
    v_pk_fma_f32 v[66:67], v[66:67], v[108:109], s[16:17] op_sel:[0,1,0] op_sel_hi:[1,1,0]
    v_pk_fma_f32 v[116:117], v[116:117], v[110:111], s[16:17] op_sel:[0,0,0] op_sel_hi:[1,0,0]
    v_pk_fma_f32 v[68:69], v[68:69], v[110:111], s[16:17] op_sel:[0,0,0] op_sel_hi:[1,0,0]
    v_perm_b32 v65, v65, v64, s17
    v_perm_b32 v64, v113, v112, s17
    v_perm_b32 v67, v67, v66, s17
    v_perm_b32 v66, v115, v114, s17
    v_perm_b32 v69, v69, v68, s17
    v_perm_b32 v68, v117, v116, s17
    v_lshl_add_u64 v[64:65], v[64:65], 0, s[20:21]
    v_lshl_add_u64 v[66:67], v[66:67], 0, s[20:21]
    v_lshl_add_u64 v[68:69], v[68:69], 0, s[20:21]
    v_or3_b32 v4, v44, v45, v4
    v_or3_b32 v4, v46, v47, v4
    v_or3_b32 v4, v48, v49, v4
    ds_add_rtn_u64 v[44:45], v24, v[64:65]
    ds_add_rtn_u64 v[46:47], v25, v[66:67]
    ds_add_rtn_u64 v[48:49], v26, v[68:69]
L_p2_kernel_noopt2_4:
    s_barrier
    s_waitcnt vmcnt(1)
    ds_write_b128 v3, v[88:91] offset:0
    ds_write_b128 v3, v[92:95] offset:16384
    ds_write_b128 v3, v[96:99] offset:32768
    ds_write_b128 v3, v[100:103] offset:49152
    ds_write_b128 v124, v[104:107] offset:0
    v_mbcnt_lo_u32_b32 v118, s34, 0
    v_mbcnt_hi_u32_b32 v118, s35, v118
    s_bcnt1_i32_b64 s14, s[34:35]
    v_lshl_add_u32 v119, v118, 1, s25
    ds_read_u16 v119, v119
    s_add_u32 s34, s26, 2097152
    s_lshl1_add_u32 s25, s14, s25
    s_lshl_b32 s14, s14, 10
    s_add_u32 s26, s26, s14
    v_bfe_i32 v108, v19, 2, 10
    v_bfe_i32 v109, v19, 12, 10
    v_ashrrev_i32 v110, 22, v19
    v_cvt_f32_i32 v108, v108
    v_cvt_f32_i32 v109, v109
    v_cvt_f32_i32 v110, v110
    v_mad_u32_u16 v16, v16, 8, s50 op_sel:[1,0,0,0]
    v_mad_u32_u16 v17, v17, 8, s50 op_sel:[1,0,0,0]
    v_mad_u32_u16 v18, v18, 8, s50 op_sel:[1,0,0,0]
    v_lshlrev_b32 v112, 16, v76
    v_and_b32 v113, 0xffff0000, v76
    v_lshlrev_b32 v76, 16, v77
    v_and_b32 v77, 0xffff0000, v77
    v_lshlrev_b32 v114, 16, v78
    v_and_b32 v115, 0xffff0000, v78
    v_lshlrev_b32 v78, 16, v79
    v_and_b32 v79, 0xffff0000, v79
    v_lshlrev_b32 v116, 16, v80
    v_and_b32 v117, 0xffff0000, v80
    v_lshlrev_b32 v80, 16, v81
    v_and_b32 v81, 0xffff0000, v81
    v_pk_fma_f32 v[112:113], v[112:113], v[108:109], s[16:17] op_sel:[0,0,0] op_sel_hi:[1,0,0]
    v_pk_fma_f32 v[76:77], v[76:77], v[108:109], s[16:17] op_sel:[0,0,0] op_sel_hi:[1,0,0]
    v_pk_fma_f32 v[114:115], v[114:115], v[108:109], s[16:17] op_sel:[0,1,0] op_sel_hi:[1,1,0]
    v_pk_fma_f32 v[78:79], v[78:79], v[108:109], s[16:17] op_sel:[0,1,0] op_sel_hi:[1,1,0]
    v_pk_fma_f32 v[116:117], v[116:117], v[110:111], s[16:17] op_sel:[0,0,0] op_sel_hi:[1,0,0]
    v_pk_fma_f32 v[80:81], v[80:81], v[110:111], s[16:17] op_sel:[0,0,0] op_sel_hi:[1,0,0]
    v_perm_b32 v77, v77, v76, s17
    v_perm_b32 v76, v113, v112, s17
    v_perm_b32 v79, v79, v78, s17
    v_perm_b32 v78, v115, v114, s17
    v_perm_b32 v81, v81, v80, s17
    v_perm_b32 v80, v117, v116, s17
    v_lshl_add_u64 v[76:77], v[76:77], 0, s[20:21]
    v_lshl_add_u64 v[78:79], v[78:79], 0, s[20:21]
    v_lshl_add_u64 v[80:81], v[80:81], 0, s[20:21]
    s_waitcnt lgkmcnt(6)
    v_or3_b32 v4, v44, v45, v4
    v_or3_b32 v4, v46, v47, v4
    v_or3_b32 v4, v48, v49, v4
    ds_add_rtn_u64 v[44:45], v16, v[76:77]
    ds_add_rtn_u64 v[46:47], v17, v[78:79]
    ds_add_rtn_u64 v[48:49], v18, v[80:81]
    s_waitcnt lgkmcnt(3)
    v_mad_u32_u16 v119, v119, s23, v2
    v_pk_lshrrev_b16 v119, 10, v119 op_sel_hi:[1,1]
    v_lshl_add_u32 v118, v118, 6, v119
    buffer_load_dwordx4 v[16:19], v118, s[44:47], s34 idxen
    v_mbcnt_lo_u32_b32 v118, s36, 0
    v_mbcnt_hi_u32_b32 v118, s37, v118
    s_bcnt1_i32_b64 s14, s[36:37]
    v_lshl_add_u32 v119, v118, 1, s25
    ds_read_u16 v119, v119
    s_add_u32 s36, s26, 3145728
    s_lshl1_add_u32 s25, s14, s25
    s_lshl_b32 s14, s14, 10
    s_add_u32 s26, s26, s14
    v_bfe_i32 v108, v23, 2, 10
    v_bfe_i32 v109, v23, 12, 10
    v_ashrrev_i32 v110, 22, v23
    v_cvt_f32_i32 v108, v108
    v_cvt_f32_i32 v109, v109
    v_cvt_f32_i32 v110, v110
    v_mad_u32_u16 v20, v20, 8, s50 op_sel:[1,0,0,0]
    v_mad_u32_u16 v21, v21, 8, s50 op_sel:[1,0,0,0]
    v_mad_u32_u16 v22, v22, 8, s50 op_sel:[1,0,0,0]
    v_lshlrev_b32 v112, 16, v82
    v_and_b32 v113, 0xffff0000, v82
    v_lshlrev_b32 v82, 16, v83
    v_and_b32 v83, 0xffff0000, v83
    v_lshlrev_b32 v114, 16, v84
    v_and_b32 v115, 0xffff0000, v84
    v_lshlrev_b32 v84, 16, v85
    v_and_b32 v85, 0xffff0000, v85
    v_lshlrev_b32 v116, 16, v86
    v_and_b32 v117, 0xffff0000, v86
    v_lshlrev_b32 v86, 16, v87
    v_and_b32 v87, 0xffff0000, v87
    v_pk_fma_f32 v[112:113], v[112:113], v[108:109], s[16:17] op_sel:[0,0,0] op_sel_hi:[1,0,0]
    v_pk_fma_f32 v[82:83], v[82:83], v[108:109], s[16:17] op_sel:[0,0,0] op_sel_hi:[1,0,0]
    v_pk_fma_f32 v[114:115], v[114:115], v[108:109], s[16:17] op_sel:[0,1,0] op_sel_hi:[1,1,0]
    v_pk_fma_f32 v[84:85], v[84:85], v[108:109], s[16:17] op_sel:[0,1,0] op_sel_hi:[1,1,0]
    v_pk_fma_f32 v[116:117], v[116:117], v[110:111], s[16:17] op_sel:[0,0,0] op_sel_hi:[1,0,0]
    v_pk_fma_f32 v[86:87], v[86:87], v[110:111], s[16:17] op_sel:[0,0,0] op_sel_hi:[1,0,0]
    v_perm_b32 v83, v83, v82, s17
    v_perm_b32 v82, v113, v112, s17
    v_perm_b32 v85, v85, v84, s17
    v_perm_b32 v84, v115, v114, s17
    v_perm_b32 v87, v87, v86, s17
    v_perm_b32 v86, v117, v116, s17
    v_lshl_add_u64 v[82:83], v[82:83], 0, s[20:21]
    v_lshl_add_u64 v[84:85], v[84:85], 0, s[20:21]
    v_lshl_add_u64 v[86:87], v[86:87], 0, s[20:21]
    s_waitcnt lgkmcnt(1)
    v_or3_b32 v4, v44, v45, v4
    v_or3_b32 v4, v46, v47, v4
    v_or3_b32 v4, v48, v49, v4
    ds_add_rtn_u64 v[44:45], v20, v[82:83]
    ds_add_rtn_u64 v[46:47], v21, v[84:85]
    ds_add_rtn_u64 v[48:49], v22, v[86:87]
    s_waitcnt lgkmcnt(3)
    v_mad_u32_u16 v119, v119, s23, v2
    v_pk_lshrrev_b16 v119, 10, v119 op_sel_hi:[1,1]
    v_lshl_add_u32 v118, v118, 6, v119
    buffer_load_dwordx4 v[20:23], v118, s[44:47], s36 idxen
    s_cmp_le_u32 s28, 256
    s_cbranch_scc1 L_p2_kernel_noopt_5
    v_readlane_b32 s38, v7, 8
    v_readlane_b32 s39, v7, 9
    s_nop 1
    v_mbcnt_lo_u32_b32 v120, s38, 0
    v_mbcnt_hi_u32_b32 v120, s39, v120
    s_bcnt1_i32_b64 s14, s[38:39]
    v_lshl_add_u32 v121, v120, 1, s25
    ds_read_u16 v121, v121
    s_add_u32 s38, s26, 4194304
    s_lshl1_add_u32 s25, s14, s25
    s_lshl_b32 s14, s14, 10
    s_add_u32 s26, s26, s14
    s_waitcnt lgkmcnt(0)
    v_mad_u32_u16 v121, v121, s23, v2
    v_pk_lshrrev_b16 v121, 10, v121 op_sel_hi:[1,1]
    v_lshl_add_u32 v120, v120, 6, v121
    buffer_load_dwordx4 v[24:27], v120, s[44:47], s38 idxen
L_p2_kernel_noopt_5:
    v_mad_u32_u16 v108, v28, v50, s40 op_sel:[1,0,0,0]
    v_mad_u32_u16 v109, v36, v50, s41 op_sel:[1,0,0,0]
    v_sub_u32_sdwa v110, v109, v108 dst_sel:DWORD dst_unused:UNUSED_PAD src0_sel:WORD_1 src1_sel:WORD_1
    s_nop 1
    v_add_u32_dpp v110, v110, v110 row_shr:1 row_mask:0xf bank_mask:0xf bound_ctrl:0
    s_nop 1
    v_add_u32_dpp v110, v110, v110 row_shr:2 row_mask:0xf bank_mask:0xf bound_ctrl:0
    s_nop 1
    v_add_u32_dpp v110, v110, v110 row_shr:4 row_mask:0xf bank_mask:0xf bound_ctrl:0
    s_nop 1
    v_add_u32_dpp v110, v110, v110 row_shr:8 row_mask:0xf bank_mask:0xf bound_ctrl:0
    s_nop 1
    v_add_u32_dpp v110, v110, v110 row_bcast:15 row_mask:0xa bank_mask:0xf
    s_nop 1
    v_add_u32_dpp v110, v110, v110 row_bcast:31 row_mask:0xc bank_mask:0xf
    v_sub_u32_sdwa v109, v109, v110 dst_sel:DWORD dst_unused:UNUSED_PAD src0_sel:WORD_1 src1_sel:DWORD
    v_readlane_b32 s29, v110, 63
    v_add_u32 v110, -1, v110
    ds_write_b16 v126, v109
    v_lshlrev_b32_e64 v111, v110, 1
    v_lshrrev_b32 v110, 5, v110
    v_lshl_add_u32 v110, v110, 2, s19
    s_cmp_gt_u32 s29, 320
    s_cselect_b32 s2, 1, s2
    s_cselect_b64 exec, 0, -1
    ds_or_b32 v110, v111 offset:160
    s_mov_b64 exec, -1
    ds_wrxchg_rtn_b32 v7, v6, v5 offset:160
    s_add_u32 s14, s22, 80000
    buffer_load_dwordx4 v[88:91], v1, s[8:11], s14 offen
    s_add_u32 s14, s22, 96384
    buffer_load_dwordx4 v[92:95], v1, s[8:11], s14 offen
    s_add_u32 s24, s24, 1
    s_cmp_lt_u32 s24, 8
    s_barrier
    s_cbranch_scc1 L_p2_loop
    s_waitcnt lgkmcnt(3)
    v_or3_b32 v4, v44, v45, v4
    v_or3_b32 v4, v46, v47, v4
    v_or3_b32 v4, v48, v49, v4
    s_mov_b32 s27, s19
    s_waitcnt vmcnt(0)
    v_mov_b32 v8, 160232
    s_cmp_lg_u32 s13, 0
    s_cselect_b64 exec, 0, 1
    ds_write_b32 v8, v52
    s_mov_b64 exec, -1
    v_subrev_u32 v6, 80000, v124
    s_mul_i32 s24, s12, 20000
    v_subrev_u32 v10, s24, v1
    v_mov_b32 v11, 0x7f000000
    s_waitcnt vmcnt(0) lgkmcnt(0)
    s_barrier
    s_cmp_lt_u32 s13, 4
    s_cbranch_scc1 L_p2_ga
    v_lshlrev_b32 v30, 16, v60
    v_and_b32 v31, 0xffff0000, v60
    v_lshlrev_b32 v36, 16, v53
    v_and_b32 v37, 0xffff0000, v53
    v_lshlrev_b32 v38, 16, v54
    v_and_b32 v39, 0xffff0000, v54
    v_lshlrev_b32 v40, 16, v56
    v_and_b32 v41, 0xffff0000, v56
    v_lshlrev_b32 v42, 16, v57
    v_and_b32 v43, 0xffff0000, v57
    v_pk_add_f32 v[14:15], v[30:31], v[36:37] op_sel:[0,0] op_sel_hi:[1,0] neg_lo:[0,1] neg_hi:[0,1]
    v_pk_add_f32 v[16:17], v[30:31], v[36:37] op_sel:[0,1] op_sel_hi:[1,1] neg_lo:[0,1] neg_hi:[0,1]
    v_pk_add_f32 v[18:19], v[30:31], v[38:39] op_sel:[0,0] op_sel_hi:[1,0] neg_lo:[0,1] neg_hi:[0,1]
    v_pk_add_f32 v[20:21], v[30:31], v[38:39] op_sel:[0,1] op_sel_hi:[1,1] neg_lo:[0,1] neg_hi:[0,1]
    v_pk_add_f32 v[22:23], v[30:31], v[40:41] op_sel:[0,0] op_sel_hi:[1,0] neg_lo:[0,1] neg_hi:[0,1]
    v_pk_add_f32 v[24:25], v[30:31], v[40:41] op_sel:[0,1] op_sel_hi:[1,1] neg_lo:[0,1] neg_hi:[0,1]
    v_pk_add_f32 v[26:27], v[30:31], v[42:43] op_sel:[0,0] op_sel_hi:[1,0] neg_lo:[0,1] neg_hi:[0,1]
    v_pk_add_f32 v[28:29], v[30:31], v[42:43] op_sel:[0,1] op_sel_hi:[1,1] neg_lo:[0,1] neg_hi:[0,1]
    v_cvt_pk_bf16_f32 v32, v14, v15
    v_lshlrev_b32 v14, 16, v32
    v_and_b32 v15, 0xffff0000, v32
    v_cvt_pk_bf16_f32 v32, v16, v17
    v_lshlrev_b32 v16, 16, v32
    v_and_b32 v17, 0xffff0000, v32
    v_cvt_pk_bf16_f32 v32, v18, v19
    v_lshlrev_b32 v18, 16, v32
    v_and_b32 v19, 0xffff0000, v32
    v_cvt_pk_bf16_f32 v32, v20, v21
    v_lshlrev_b32 v20, 16, v32
    v_and_b32 v21, 0xffff0000, v32
    v_cvt_pk_bf16_f32 v32, v22, v23
    v_lshlrev_b32 v22, 16, v32
    v_and_b32 v23, 0xffff0000, v32
    v_cvt_pk_bf16_f32 v32, v24, v25
    v_lshlrev_b32 v24, 16, v32
    v_and_b32 v25, 0xffff0000, v32
    v_cvt_pk_bf16_f32 v32, v26, v27
    v_lshlrev_b32 v26, 16, v32
    v_and_b32 v27, 0xffff0000, v32
    v_cvt_pk_bf16_f32 v32, v28, v29
    v_lshlrev_b32 v28, 16, v32
    v_and_b32 v29, 0xffff0000, v32
    v_pk_mul_f32 v[14:15], v[14:15], v[14:15]
    v_pk_mul_f32 v[16:17], v[16:17], v[16:17]
    v_pk_mul_f32 v[18:19], v[18:19], v[18:19]
    v_pk_mul_f32 v[20:21], v[20:21], v[20:21]
    v_pk_mul_f32 v[22:23], v[22:23], v[22:23]
    v_pk_mul_f32 v[24:25], v[24:25], v[24:25]
    v_pk_mul_f32 v[26:27], v[26:27], v[26:27]
    v_pk_mul_f32 v[28:29], v[28:29], v[28:29]
    v_cvt_pk_bf16_f32 v32, v14, v15
    v_lshlrev_b32 v14, 16, v32
    v_and_b32 v15, 0xffff0000, v32
    v_cvt_pk_bf16_f32 v32, v16, v17
    v_lshlrev_b32 v16, 16, v32
    v_and_b32 v17, 0xffff0000, v32
    v_cvt_pk_bf16_f32 v32, v18, v19
    v_lshlrev_b32 v18, 16, v32
    v_and_b32 v19, 0xffff0000, v32
    v_cvt_pk_bf16_f32 v32, v20, v21
    v_lshlrev_b32 v20, 16, v32
    v_and_b32 v21, 0xffff0000, v32
    v_cvt_pk_bf16_f32 v32, v22, v23
    v_lshlrev_b32 v22, 16, v32
    v_and_b32 v23, 0xffff0000, v32
    v_cvt_pk_bf16_f32 v32, v24, v25
    v_lshlrev_b32 v24, 16, v32
    v_and_b32 v25, 0xffff0000, v32
    v_cvt_pk_bf16_f32 v32, v26, v27
    v_lshlrev_b32 v26, 16, v32
    v_and_b32 v27, 0xffff0000, v32
    v_cvt_pk_bf16_f32 v32, v28, v29
    v_lshlrev_b32 v28, 16, v32
    v_and_b32 v29, 0xffff0000, v32
    v_mov_b32 v30, 1092616192
    v_mov_b32 v31, 0x3fb8aa3b
    v_pk_mul_f32 v[14:15], v[14:15], v[30:31] op_sel:[0,0] op_sel_hi:[1,0]
    v_pk_mul_f32 v[16:17], v[16:17], v[30:31] op_sel:[0,0] op_sel_hi:[1,0]
    v_pk_mul_f32 v[18:19], v[18:19], v[30:31] op_sel:[0,0] op_sel_hi:[1,0]
    v_pk_mul_f32 v[20:21], v[20:21], v[30:31] op_sel:[0,0] op_sel_hi:[1,0]
    v_pk_mul_f32 v[22:23], v[22:23], v[30:31] op_sel:[0,0] op_sel_hi:[1,0]
    v_pk_mul_f32 v[24:25], v[24:25], v[30:31] op_sel:[0,0] op_sel_hi:[1,0]
    v_pk_mul_f32 v[26:27], v[26:27], v[30:31] op_sel:[0,0] op_sel_hi:[1,0]
    v_pk_mul_f32 v[28:29], v[28:29], v[30:31] op_sel:[0,0] op_sel_hi:[1,0]
    v_cvt_pk_bf16_f32 v32, v14, v15
    v_lshlrev_b32 v14, 16, v32
    v_and_b32 v15, 0xffff0000, v32
    v_cvt_pk_bf16_f32 v32, v16, v17
    v_lshlrev_b32 v16, 16, v32
    v_and_b32 v17, 0xffff0000, v32
    v_cvt_pk_bf16_f32 v32, v18, v19
    v_lshlrev_b32 v18, 16, v32
    v_and_b32 v19, 0xffff0000, v32
    v_cvt_pk_bf16_f32 v32, v20, v21
    v_lshlrev_b32 v20, 16, v32
    v_and_b32 v21, 0xffff0000, v32
    v_cvt_pk_bf16_f32 v32, v22, v23
    v_lshlrev_b32 v22, 16, v32
    v_and_b32 v23, 0xffff0000, v32
    v_cvt_pk_bf16_f32 v32, v24, v25
    v_lshlrev_b32 v24, 16, v32
    v_and_b32 v25, 0xffff0000, v32
    v_cvt_pk_bf16_f32 v32, v26, v27
    v_lshlrev_b32 v26, 16, v32
    v_and_b32 v27, 0xffff0000, v32
    v_cvt_pk_bf16_f32 v32, v28, v29
    v_lshlrev_b32 v28, 16, v32
    v_and_b32 v29, 0xffff0000, v32
    v_pk_mul_f32 v[14:15], v[14:15], v[30:31] op_sel:[0,1] op_sel_hi:[1,1]
    v_pk_mul_f32 v[16:17], v[16:17], v[30:31] op_sel:[0,1] op_sel_hi:[1,1]
    v_pk_mul_f32 v[18:19], v[18:19], v[30:31] op_sel:[0,1] op_sel_hi:[1,1]
    v_pk_mul_f32 v[20:21], v[20:21], v[30:31] op_sel:[0,1] op_sel_hi:[1,1]
    v_pk_mul_f32 v[22:23], v[22:23], v[30:31] op_sel:[0,1] op_sel_hi:[1,1]
    v_pk_mul_f32 v[24:25], v[24:25], v[30:31] op_sel:[0,1] op_sel_hi:[1,1]
    v_pk_mul_f32 v[26:27], v[26:27], v[30:31] op_sel:[0,1] op_sel_hi:[1,1]
    v_pk_mul_f32 v[28:29], v[28:29], v[30:31] op_sel:[0,1] op_sel_hi:[1,1]
    v_exp_f32 v14, -v14
    v_exp_f32 v15, -v15
    v_exp_f32 v16, -v16
    v_exp_f32 v17, -v17
    v_exp_f32 v18, -v18
    v_exp_f32 v19, -v19
    v_exp_f32 v20, -v20
    v_exp_f32 v21, -v21
    v_exp_f32 v22, -v22
    v_exp_f32 v23, -v23
    v_exp_f32 v24, -v24
    v_exp_f32 v25, -v25
    v_exp_f32 v26, -v26
    v_exp_f32 v27, -v27
    v_exp_f32 v28, -v28
    v_exp_f32 v29, -v29
    v_cvt_pk_bf16_f32 v14, v14, v16
    v_cvt_pk_bf16_f32 v15, v15, v17
    v_cvt_pk_bf16_f32 v18, v18, v20
    v_cvt_pk_bf16_f32 v19, v19, v21
    v_cvt_pk_bf16_f32 v22, v22, v24
    v_cvt_pk_bf16_f32 v23, v23, v25
    v_cvt_pk_bf16_f32 v26, v26, v28
    v_cvt_pk_bf16_f32 v27, v27, v29
    v_dot2_f32_bf16 v72, v14, s68, 0
    v_dot2_f32_bf16 v73, v15, s68, 0
    v_dot2_f32_bf16 v74, v14, s69, 0
    v_dot2_f32_bf16 v75, v15, s69, 0
    v_dot2_f32_bf16 v76, v14, s70, 0
    v_dot2_f32_bf16 v77, v15, s70, 0
    v_dot2_f32_bf16 v78, v14, s71, 0
    v_dot2_f32_bf16 v79, v15, s71, 0
    v_dot2_f32_bf16 v80, v14, s52, 0
    v_dot2_f32_bf16 v81, v15, s52, 0
    v_dot2_f32_bf16 v82, v14, s53, 0
    v_dot2_f32_bf16 v83, v15, s53, 0
    v_dot2_f32_bf16 v84, v14, s54, 0
    v_dot2_f32_bf16 v85, v15, s54, 0
    v_dot2_f32_bf16 v86, v14, s55, 0
    v_dot2_f32_bf16 v87, v15, s55, 0
    v_dot2_f32_bf16 v72, v18, s72, v72
    v_dot2_f32_bf16 v73, v19, s72, v73
    v_dot2_f32_bf16 v74, v18, s73, v74
    v_dot2_f32_bf16 v75, v19, s73, v75
    v_dot2_f32_bf16 v76, v18, s74, v76
    v_dot2_f32_bf16 v77, v19, s74, v77
    v_dot2_f32_bf16 v78, v18, s75, v78
    v_dot2_f32_bf16 v79, v19, s75, v79
    v_dot2_f32_bf16 v80, v18, s56, v80
    v_dot2_f32_bf16 v81, v19, s56, v81
    v_dot2_f32_bf16 v82, v18, s57, v82
    v_dot2_f32_bf16 v83, v19, s57, v83
    v_dot2_f32_bf16 v84, v18, s58, v84
    v_dot2_f32_bf16 v85, v19, s58, v85
    v_dot2_f32_bf16 v86, v18, s59, v86
    v_dot2_f32_bf16 v87, v19, s59, v87
    v_dot2_f32_bf16 v72, v22, s76, v72
    v_dot2_f32_bf16 v73, v23, s76, v73
    v_dot2_f32_bf16 v74, v22, s77, v74
    v_dot2_f32_bf16 v75, v23, s77, v75
    v_dot2_f32_bf16 v76, v22, s78, v76
    v_dot2_f32_bf16 v77, v23, s78, v77
    v_dot2_f32_bf16 v78, v22, s79, v78
    v_dot2_f32_bf16 v79, v23, s79, v79
    v_dot2_f32_bf16 v80, v22, s60, v80
    v_dot2_f32_bf16 v81, v23, s60, v81
    v_dot2_f32_bf16 v82, v22, s61, v82
    v_dot2_f32_bf16 v83, v23, s61, v83
    v_dot2_f32_bf16 v84, v22, s62, v84
    v_dot2_f32_bf16 v85, v23, s62, v85
    v_dot2_f32_bf16 v86, v22, s63, v86
    v_dot2_f32_bf16 v87, v23, s63, v87
    v_dot2_f32_bf16 v72, v26, s80, v72
    v_dot2_f32_bf16 v73, v27, s80, v73
    v_dot2_f32_bf16 v74, v26, s81, v74
    v_dot2_f32_bf16 v75, v27, s81, v75
    v_dot2_f32_bf16 v76, v26, s82, v76
    v_dot2_f32_bf16 v77, v27, s82, v77
    v_dot2_f32_bf16 v78, v26, s83, v78
    v_dot2_f32_bf16 v79, v27, s83, v79
    v_dot2_f32_bf16 v80, v26, s64, v80
    v_dot2_f32_bf16 v81, v27, s64, v81
    v_dot2_f32_bf16 v82, v26, s65, v82
    v_dot2_f32_bf16 v83, v27, s65, v83
    v_dot2_f32_bf16 v84, v26, s66, v84
    v_dot2_f32_bf16 v85, v27, s66, v85
    v_dot2_f32_bf16 v86, v26, s67, v86
    v_dot2_f32_bf16 v87, v27, s67, v87
L_p2_ga:
    ds_read_b32 v9, v8
    ds_read_b128 v[88:91], v1 offset:0
    ds_read_b128 v[92:95], v1 offset:16384
    ds_read_b128 v[96:99], v1 offset:32768
    ds_read_b128 v[100:103], v1 offset:49152
    ds_read_b128 v[104:107], v6
    s_mul_i32 s14, s12, 5120000
    s_mul_i32 s15, s3, 80000
    s_add_u32 s25, s14, s15
    s_add_u32 s25, s25, 228589568
    s_waitcnt lgkmcnt(5)
    v_readfirstlane_b32 s21, v9
    s_nop 0
    s_bfe_u32 s21, s21, 524296
    s_cmp_lg_u32 s21, 4
    s_cselect_b32 s21, 1, 0
    s_cselect_b32 s24, 0, 20000
    v_cmp_le_u32 vcc, s24, v10
    v_add_u32 v10, 16384, v10
    s_add_u32 s14, s25, 0
    v_cndmask_b32 v12, v11, v1, vcc
    s_waitcnt lgkmcnt(4)
    buffer_store_dwordx4 v[88:91], v12, s[4:7], s14 offen sc1
    v_or3_b32 v4, v88, v89, v4
    v_or3_b32 v4, v90, v91, v4
    v_cmp_le_u32 vcc, s24, v10
    v_add_u32 v10, 16384, v10
    s_add_u32 s14, s25, 16384
    v_cndmask_b32 v12, v11, v1, vcc
    s_waitcnt lgkmcnt(3)
    buffer_store_dwordx4 v[92:95], v12, s[4:7], s14 offen sc1
    v_or3_b32 v4, v92, v93, v4
    v_or3_b32 v4, v94, v95, v4
    v_cmp_le_u32 vcc, s24, v10
    v_add_u32 v10, 16384, v10
    s_add_u32 s14, s25, 32768
    v_cndmask_b32 v12, v11, v1, vcc
    s_waitcnt lgkmcnt(2)
    buffer_store_dwordx4 v[96:99], v12, s[4:7], s14 offen sc1
    v_or3_b32 v4, v96, v97, v4
    v_or3_b32 v4, v98, v99, v4
    v_cmp_le_u32 vcc, s24, v10
    v_add_u32 v10, 16384, v10
    s_add_u32 s14, s25, 49152
    v_cndmask_b32 v12, v11, v1, vcc
    s_waitcnt lgkmcnt(1)
    buffer_store_dwordx4 v[100:103], v12, s[4:7], s14 offen sc1
    v_or3_b32 v4, v100, v101, v4
    v_or3_b32 v4, v102, v103, v4
    v_cmp_le_u32 vcc, s24, v10
    v_add_u32 v10, 16384, v10
    s_add_u32 s14, s25, 0
    v_cndmask_b32 v12, v11, v6, vcc
    s_waitcnt lgkmcnt(0)
    buffer_store_dwordx4 v[104:107], v12, s[4:7], s14 offen sc1
    v_or3_b32 v4, v104, v105, v4
    v_or3_b32 v4, v106, v107, v4
    s_load_dwordx2 s[16:17], s[0:1], 88
    s_cmp_ge_u32 s13, 4
    s_cbranch_scc1 L_p2_gb
    v_lshlrev_b32 v30, 16, v60
    v_and_b32 v31, 0xffff0000, v60
    v_lshlrev_b32 v36, 16, v53
    v_and_b32 v37, 0xffff0000, v53
    v_lshlrev_b32 v38, 16, v54
    v_and_b32 v39, 0xffff0000, v54
    v_lshlrev_b32 v40, 16, v56
    v_and_b32 v41, 0xffff0000, v56
    v_lshlrev_b32 v42, 16, v57
    v_and_b32 v43, 0xffff0000, v57
    v_pk_add_f32 v[14:15], v[30:31], v[36:37] op_sel:[0,0] op_sel_hi:[1,0] neg_lo:[0,1] neg_hi:[0,1]
    v_pk_add_f32 v[16:17], v[30:31], v[36:37] op_sel:[0,1] op_sel_hi:[1,1] neg_lo:[0,1] neg_hi:[0,1]
    v_pk_add_f32 v[18:19], v[30:31], v[38:39] op_sel:[0,0] op_sel_hi:[1,0] neg_lo:[0,1] neg_hi:[0,1]
    v_pk_add_f32 v[20:21], v[30:31], v[38:39] op_sel:[0,1] op_sel_hi:[1,1] neg_lo:[0,1] neg_hi:[0,1]
    v_pk_add_f32 v[22:23], v[30:31], v[40:41] op_sel:[0,0] op_sel_hi:[1,0] neg_lo:[0,1] neg_hi:[0,1]
    v_pk_add_f32 v[24:25], v[30:31], v[40:41] op_sel:[0,1] op_sel_hi:[1,1] neg_lo:[0,1] neg_hi:[0,1]
    v_pk_add_f32 v[26:27], v[30:31], v[42:43] op_sel:[0,0] op_sel_hi:[1,0] neg_lo:[0,1] neg_hi:[0,1]
    v_pk_add_f32 v[28:29], v[30:31], v[42:43] op_sel:[0,1] op_sel_hi:[1,1] neg_lo:[0,1] neg_hi:[0,1]
    v_cvt_pk_bf16_f32 v32, v14, v15
    v_lshlrev_b32 v14, 16, v32
    v_and_b32 v15, 0xffff0000, v32
    v_cvt_pk_bf16_f32 v32, v16, v17
    v_lshlrev_b32 v16, 16, v32
    v_and_b32 v17, 0xffff0000, v32
    v_cvt_pk_bf16_f32 v32, v18, v19
    v_lshlrev_b32 v18, 16, v32
    v_and_b32 v19, 0xffff0000, v32
    v_cvt_pk_bf16_f32 v32, v20, v21
    v_lshlrev_b32 v20, 16, v32
    v_and_b32 v21, 0xffff0000, v32
    v_cvt_pk_bf16_f32 v32, v22, v23
    v_lshlrev_b32 v22, 16, v32
    v_and_b32 v23, 0xffff0000, v32
    v_cvt_pk_bf16_f32 v32, v24, v25
    v_lshlrev_b32 v24, 16, v32
    v_and_b32 v25, 0xffff0000, v32
    v_cvt_pk_bf16_f32 v32, v26, v27
    v_lshlrev_b32 v26, 16, v32
    v_and_b32 v27, 0xffff0000, v32
    v_cvt_pk_bf16_f32 v32, v28, v29
    v_lshlrev_b32 v28, 16, v32
    v_and_b32 v29, 0xffff0000, v32
    v_pk_mul_f32 v[14:15], v[14:15], v[14:15]
    v_pk_mul_f32 v[16:17], v[16:17], v[16:17]
    v_pk_mul_f32 v[18:19], v[18:19], v[18:19]
    v_pk_mul_f32 v[20:21], v[20:21], v[20:21]
    v_pk_mul_f32 v[22:23], v[22:23], v[22:23]
    v_pk_mul_f32 v[24:25], v[24:25], v[24:25]
    v_pk_mul_f32 v[26:27], v[26:27], v[26:27]
    v_pk_mul_f32 v[28:29], v[28:29], v[28:29]
    v_cvt_pk_bf16_f32 v32, v14, v15
    v_lshlrev_b32 v14, 16, v32
    v_and_b32 v15, 0xffff0000, v32
    v_cvt_pk_bf16_f32 v32, v16, v17
    v_lshlrev_b32 v16, 16, v32
    v_and_b32 v17, 0xffff0000, v32
    v_cvt_pk_bf16_f32 v32, v18, v19
    v_lshlrev_b32 v18, 16, v32
    v_and_b32 v19, 0xffff0000, v32
    v_cvt_pk_bf16_f32 v32, v20, v21
    v_lshlrev_b32 v20, 16, v32
    v_and_b32 v21, 0xffff0000, v32
    v_cvt_pk_bf16_f32 v32, v22, v23
    v_lshlrev_b32 v22, 16, v32
    v_and_b32 v23, 0xffff0000, v32
    v_cvt_pk_bf16_f32 v32, v24, v25
    v_lshlrev_b32 v24, 16, v32
    v_and_b32 v25, 0xffff0000, v32
    v_cvt_pk_bf16_f32 v32, v26, v27
    v_lshlrev_b32 v26, 16, v32
    v_and_b32 v27, 0xffff0000, v32
    v_cvt_pk_bf16_f32 v32, v28, v29
    v_lshlrev_b32 v28, 16, v32
    v_and_b32 v29, 0xffff0000, v32
    v_mov_b32 v30, 1092616192
    v_mov_b32 v31, 0x3fb8aa3b
    v_pk_mul_f32 v[14:15], v[14:15], v[30:31] op_sel:[0,0] op_sel_hi:[1,0]
    v_pk_mul_f32 v[16:17], v[16:17], v[30:31] op_sel:[0,0] op_sel_hi:[1,0]
    v_pk_mul_f32 v[18:19], v[18:19], v[30:31] op_sel:[0,0] op_sel_hi:[1,0]
    v_pk_mul_f32 v[20:21], v[20:21], v[30:31] op_sel:[0,0] op_sel_hi:[1,0]
    v_pk_mul_f32 v[22:23], v[22:23], v[30:31] op_sel:[0,0] op_sel_hi:[1,0]
    v_pk_mul_f32 v[24:25], v[24:25], v[30:31] op_sel:[0,0] op_sel_hi:[1,0]
    v_pk_mul_f32 v[26:27], v[26:27], v[30:31] op_sel:[0,0] op_sel_hi:[1,0]
    v_pk_mul_f32 v[28:29], v[28:29], v[30:31] op_sel:[0,0] op_sel_hi:[1,0]
    v_cvt_pk_bf16_f32 v32, v14, v15
    v_lshlrev_b32 v14, 16, v32
    v_and_b32 v15, 0xffff0000, v32
    v_cvt_pk_bf16_f32 v32, v16, v17
    v_lshlrev_b32 v16, 16, v32
    v_and_b32 v17, 0xffff0000, v32
    v_cvt_pk_bf16_f32 v32, v18, v19
    v_lshlrev_b32 v18, 16, v32
    v_and_b32 v19, 0xffff0000, v32
    v_cvt_pk_bf16_f32 v32, v20, v21
    v_lshlrev_b32 v20, 16, v32
    v_and_b32 v21, 0xffff0000, v32
    v_cvt_pk_bf16_f32 v32, v22, v23
    v_lshlrev_b32 v22, 16, v32
    v_and_b32 v23, 0xffff0000, v32
    v_cvt_pk_bf16_f32 v32, v24, v25
    v_lshlrev_b32 v24, 16, v32
    v_and_b32 v25, 0xffff0000, v32
    v_cvt_pk_bf16_f32 v32, v26, v27
    v_lshlrev_b32 v26, 16, v32
    v_and_b32 v27, 0xffff0000, v32
    v_cvt_pk_bf16_f32 v32, v28, v29
    v_lshlrev_b32 v28, 16, v32
    v_and_b32 v29, 0xffff0000, v32
    v_pk_mul_f32 v[14:15], v[14:15], v[30:31] op_sel:[0,1] op_sel_hi:[1,1]
    v_pk_mul_f32 v[16:17], v[16:17], v[30:31] op_sel:[0,1] op_sel_hi:[1,1]
    v_pk_mul_f32 v[18:19], v[18:19], v[30:31] op_sel:[0,1] op_sel_hi:[1,1]
    v_pk_mul_f32 v[20:21], v[20:21], v[30:31] op_sel:[0,1] op_sel_hi:[1,1]
    v_pk_mul_f32 v[22:23], v[22:23], v[30:31] op_sel:[0,1] op_sel_hi:[1,1]
    v_pk_mul_f32 v[24:25], v[24:25], v[30:31] op_sel:[0,1] op_sel_hi:[1,1]
    v_pk_mul_f32 v[26:27], v[26:27], v[30:31] op_sel:[0,1] op_sel_hi:[1,1]
    v_pk_mul_f32 v[28:29], v[28:29], v[30:31] op_sel:[0,1] op_sel_hi:[1,1]
    v_exp_f32 v14, -v14
    v_exp_f32 v15, -v15
    v_exp_f32 v16, -v16
    v_exp_f32 v17, -v17
    v_exp_f32 v18, -v18
    v_exp_f32 v19, -v19
    v_exp_f32 v20, -v20
    v_exp_f32 v21, -v21
    v_exp_f32 v22, -v22
    v_exp_f32 v23, -v23
    v_exp_f32 v24, -v24
    v_exp_f32 v25, -v25
    v_exp_f32 v26, -v26
    v_exp_f32 v27, -v27
    v_exp_f32 v28, -v28
    v_exp_f32 v29, -v29
    v_cvt_pk_bf16_f32 v14, v14, v16
    v_cvt_pk_bf16_f32 v15, v15, v17
    v_cvt_pk_bf16_f32 v18, v18, v20
    v_cvt_pk_bf16_f32 v19, v19, v21
    v_cvt_pk_bf16_f32 v22, v22, v24
    v_cvt_pk_bf16_f32 v23, v23, v25
    v_cvt_pk_bf16_f32 v26, v26, v28
    v_cvt_pk_bf16_f32 v27, v27, v29
    v_dot2_f32_bf16 v72, v14, s68, 0
    v_dot2_f32_bf16 v73, v15, s68, 0
    v_dot2_f32_bf16 v74, v14, s69, 0
    v_dot2_f32_bf16 v75, v15, s69, 0
    v_dot2_f32_bf16 v76, v14, s70, 0
    v_dot2_f32_bf16 v77, v15, s70, 0
    v_dot2_f32_bf16 v78, v14, s71, 0
    v_dot2_f32_bf16 v79, v15, s71, 0
    v_dot2_f32_bf16 v80, v14, s52, 0
    v_dot2_f32_bf16 v81, v15, s52, 0
    v_dot2_f32_bf16 v82, v14, s53, 0
    v_dot2_f32_bf16 v83, v15, s53, 0
    v_dot2_f32_bf16 v84, v14, s54, 0
    v_dot2_f32_bf16 v85, v15, s54, 0
    v_dot2_f32_bf16 v86, v14, s55, 0
    v_dot2_f32_bf16 v87, v15, s55, 0
    v_dot2_f32_bf16 v72, v18, s72, v72
    v_dot2_f32_bf16 v73, v19, s72, v73
    v_dot2_f32_bf16 v74, v18, s73, v74
    v_dot2_f32_bf16 v75, v19, s73, v75
    v_dot2_f32_bf16 v76, v18, s74, v76
    v_dot2_f32_bf16 v77, v19, s74, v77
    v_dot2_f32_bf16 v78, v18, s75, v78
    v_dot2_f32_bf16 v79, v19, s75, v79
    v_dot2_f32_bf16 v80, v18, s56, v80
    v_dot2_f32_bf16 v81, v19, s56, v81
    v_dot2_f32_bf16 v82, v18, s57, v82
    v_dot2_f32_bf16 v83, v19, s57, v83
    v_dot2_f32_bf16 v84, v18, s58, v84
    v_dot2_f32_bf16 v85, v19, s58, v85
    v_dot2_f32_bf16 v86, v18, s59, v86
    v_dot2_f32_bf16 v87, v19, s59, v87
    v_dot2_f32_bf16 v72, v22, s76, v72
    v_dot2_f32_bf16 v73, v23, s76, v73
    v_dot2_f32_bf16 v74, v22, s77, v74
    v_dot2_f32_bf16 v75, v23, s77, v75
    v_dot2_f32_bf16 v76, v22, s78, v76
    v_dot2_f32_bf16 v77, v23, s78, v77
    v_dot2_f32_bf16 v78, v22, s79, v78
    v_dot2_f32_bf16 v79, v23, s79, v79
    v_dot2_f32_bf16 v80, v22, s60, v80
    v_dot2_f32_bf16 v81, v23, s60, v81
    v_dot2_f32_bf16 v82, v22, s61, v82
    v_dot2_f32_bf16 v83, v23, s61, v83
    v_dot2_f32_bf16 v84, v22, s62, v84
    v_dot2_f32_bf16 v85, v23, s62, v85
    v_dot2_f32_bf16 v86, v22, s63, v86
    v_dot2_f32_bf16 v87, v23, s63, v87
    v_dot2_f32_bf16 v72, v26, s80, v72
    v_dot2_f32_bf16 v73, v27, s80, v73
    v_dot2_f32_bf16 v74, v26, s81, v74
    v_dot2_f32_bf16 v75, v27, s81, v75
    v_dot2_f32_bf16 v76, v26, s82, v76
    v_dot2_f32_bf16 v77, v27, s82, v77
    v_dot2_f32_bf16 v78, v26, s83, v78
    v_dot2_f32_bf16 v79, v27, s83, v79
    v_dot2_f32_bf16 v80, v26, s64, v80
    v_dot2_f32_bf16 v81, v27, s64, v81
    v_dot2_f32_bf16 v82, v26, s65, v82
    v_dot2_f32_bf16 v83, v27, s65, v83
    v_dot2_f32_bf16 v84, v26, s66, v84
    v_dot2_f32_bf16 v85, v27, s66, v85
    v_dot2_f32_bf16 v86, v26, s67, v86
    v_dot2_f32_bf16 v87, v27, s67, v87
    s_cmp_ge_u32 s13, 4
    s_cbranch_scc1 L_p2_kernel_g1_6
    v_lshlrev_b32 v30, 16, v61
    v_and_b32 v31, 0xffff0000, v61
    v_pk_add_f32 v[14:15], v[30:31], v[36:37] op_sel:[0,0] op_sel_hi:[1,0] neg_lo:[0,1] neg_hi:[0,1]
    v_pk_add_f32 v[16:17], v[30:31], v[36:37] op_sel:[0,1] op_sel_hi:[1,1] neg_lo:[0,1] neg_hi:[0,1]
    v_pk_add_f32 v[18:19], v[30:31], v[38:39] op_sel:[0,0] op_sel_hi:[1,0] neg_lo:[0,1] neg_hi:[0,1]
    v_pk_add_f32 v[20:21], v[30:31], v[38:39] op_sel:[0,1] op_sel_hi:[1,1] neg_lo:[0,1] neg_hi:[0,1]
    v_pk_add_f32 v[22:23], v[30:31], v[40:41] op_sel:[0,0] op_sel_hi:[1,0] neg_lo:[0,1] neg_hi:[0,1]
    v_pk_add_f32 v[24:25], v[30:31], v[40:41] op_sel:[0,1] op_sel_hi:[1,1] neg_lo:[0,1] neg_hi:[0,1]
    v_pk_add_f32 v[26:27], v[30:31], v[42:43] op_sel:[0,0] op_sel_hi:[1,0] neg_lo:[0,1] neg_hi:[0,1]
    v_pk_add_f32 v[28:29], v[30:31], v[42:43] op_sel:[0,1] op_sel_hi:[1,1] neg_lo:[0,1] neg_hi:[0,1]
    v_cvt_pk_bf16_f32 v32, v14, v15
    v_lshlrev_b32 v14, 16, v32
    v_and_b32 v15, 0xffff0000, v32
    v_cvt_pk_bf16_f32 v32, v16, v17
    v_lshlrev_b32 v16, 16, v32
    v_and_b32 v17, 0xffff0000, v32
    v_cvt_pk_bf16_f32 v32, v18, v19
    v_lshlrev_b32 v18, 16, v32
    v_and_b32 v19, 0xffff0000, v32
    v_cvt_pk_bf16_f32 v32, v20, v21
    v_lshlrev_b32 v20, 16, v32
    v_and_b32 v21, 0xffff0000, v32
    v_cvt_pk_bf16_f32 v32, v22, v23
    v_lshlrev_b32 v22, 16, v32
    v_and_b32 v23, 0xffff0000, v32
    v_cvt_pk_bf16_f32 v32, v24, v25
    v_lshlrev_b32 v24, 16, v32
    v_and_b32 v25, 0xffff0000, v32
    v_cvt_pk_bf16_f32 v32, v26, v27
    v_lshlrev_b32 v26, 16, v32
    v_and_b32 v27, 0xffff0000, v32
    v_cvt_pk_bf16_f32 v32, v28, v29
    v_lshlrev_b32 v28, 16, v32
    v_and_b32 v29, 0xffff0000, v32
    v_pk_mul_f32 v[14:15], v[14:15], v[14:15]
    v_pk_mul_f32 v[16:17], v[16:17], v[16:17]
    v_pk_mul_f32 v[18:19], v[18:19], v[18:19]
    v_pk_mul_f32 v[20:21], v[20:21], v[20:21]
    v_pk_mul_f32 v[22:23], v[22:23], v[22:23]
    v_pk_mul_f32 v[24:25], v[24:25], v[24:25]
    v_pk_mul_f32 v[26:27], v[26:27], v[26:27]
    v_pk_mul_f32 v[28:29], v[28:29], v[28:29]
    v_cvt_pk_bf16_f32 v32, v14, v15
    v_lshlrev_b32 v14, 16, v32
    v_and_b32 v15, 0xffff0000, v32
    v_cvt_pk_bf16_f32 v32, v16, v17
    v_lshlrev_b32 v16, 16, v32
    v_and_b32 v17, 0xffff0000, v32
    v_cvt_pk_bf16_f32 v32, v18, v19
    v_lshlrev_b32 v18, 16, v32
    v_and_b32 v19, 0xffff0000, v32
    v_cvt_pk_bf16_f32 v32, v20, v21
    v_lshlrev_b32 v20, 16, v32
    v_and_b32 v21, 0xffff0000, v32
    v_cvt_pk_bf16_f32 v32, v22, v23
    v_lshlrev_b32 v22, 16, v32
    v_and_b32 v23, 0xffff0000, v32
    v_cvt_pk_bf16_f32 v32, v24, v25
    v_lshlrev_b32 v24, 16, v32
    v_and_b32 v25, 0xffff0000, v32
    v_cvt_pk_bf16_f32 v32, v26, v27
    v_lshlrev_b32 v26, 16, v32
    v_and_b32 v27, 0xffff0000, v32
    v_cvt_pk_bf16_f32 v32, v28, v29
    v_lshlrev_b32 v28, 16, v32
    v_and_b32 v29, 0xffff0000, v32
    v_mov_b32 v30, 1092616192
    v_mov_b32 v31, 0x3fb8aa3b
    v_pk_mul_f32 v[14:15], v[14:15], v[30:31] op_sel:[0,0] op_sel_hi:[1,0]
    v_pk_mul_f32 v[16:17], v[16:17], v[30:31] op_sel:[0,0] op_sel_hi:[1,0]
    v_pk_mul_f32 v[18:19], v[18:19], v[30:31] op_sel:[0,0] op_sel_hi:[1,0]
    v_pk_mul_f32 v[20:21], v[20:21], v[30:31] op_sel:[0,0] op_sel_hi:[1,0]
    v_pk_mul_f32 v[22:23], v[22:23], v[30:31] op_sel:[0,0] op_sel_hi:[1,0]
    v_pk_mul_f32 v[24:25], v[24:25], v[30:31] op_sel:[0,0] op_sel_hi:[1,0]
    v_pk_mul_f32 v[26:27], v[26:27], v[30:31] op_sel:[0,0] op_sel_hi:[1,0]
    v_pk_mul_f32 v[28:29], v[28:29], v[30:31] op_sel:[0,0] op_sel_hi:[1,0]
    v_cvt_pk_bf16_f32 v32, v14, v15
    v_lshlrev_b32 v14, 16, v32
    v_and_b32 v15, 0xffff0000, v32
    v_cvt_pk_bf16_f32 v32, v16, v17
    v_lshlrev_b32 v16, 16, v32
    v_and_b32 v17, 0xffff0000, v32
    v_cvt_pk_bf16_f32 v32, v18, v19
    v_lshlrev_b32 v18, 16, v32
    v_and_b32 v19, 0xffff0000, v32
    v_cvt_pk_bf16_f32 v32, v20, v21
    v_lshlrev_b32 v20, 16, v32
    v_and_b32 v21, 0xffff0000, v32
    v_cvt_pk_bf16_f32 v32, v22, v23
    v_lshlrev_b32 v22, 16, v32
    v_and_b32 v23, 0xffff0000, v32
    v_cvt_pk_bf16_f32 v32, v24, v25
    v_lshlrev_b32 v24, 16, v32
    v_and_b32 v25, 0xffff0000, v32
    v_cvt_pk_bf16_f32 v32, v26, v27
    v_lshlrev_b32 v26, 16, v32
    v_and_b32 v27, 0xffff0000, v32
    v_cvt_pk_bf16_f32 v32, v28, v29
    v_lshlrev_b32 v28, 16, v32
    v_and_b32 v29, 0xffff0000, v32
    v_pk_mul_f32 v[14:15], v[14:15], v[30:31] op_sel:[0,1] op_sel_hi:[1,1]
    v_pk_mul_f32 v[16:17], v[16:17], v[30:31] op_sel:[0,1] op_sel_hi:[1,1]
    v_pk_mul_f32 v[18:19], v[18:19], v[30:31] op_sel:[0,1] op_sel_hi:[1,1]
    v_pk_mul_f32 v[20:21], v[20:21], v[30:31] op_sel:[0,1] op_sel_hi:[1,1]
    v_pk_mul_f32 v[22:23], v[22:23], v[30:31] op_sel:[0,1] op_sel_hi:[1,1]
    v_pk_mul_f32 v[24:25], v[24:25], v[30:31] op_sel:[0,1] op_sel_hi:[1,1]
    v_pk_mul_f32 v[26:27], v[26:27], v[30:31] op_sel:[0,1] op_sel_hi:[1,1]
    v_pk_mul_f32 v[28:29], v[28:29], v[30:31] op_sel:[0,1] op_sel_hi:[1,1]
    v_exp_f32 v14, -v14
    v_exp_f32 v15, -v15
    v_exp_f32 v16, -v16
    v_exp_f32 v17, -v17
    v_exp_f32 v18, -v18
    v_exp_f32 v19, -v19
    v_exp_f32 v20, -v20
    v_exp_f32 v21, -v21
    v_exp_f32 v22, -v22
    v_exp_f32 v23, -v23
    v_exp_f32 v24, -v24
    v_exp_f32 v25, -v25
    v_exp_f32 v26, -v26
    v_exp_f32 v27, -v27
    v_exp_f32 v28, -v28
    v_exp_f32 v29, -v29
    v_cvt_pk_bf16_f32 v14, v14, v16
    v_cvt_pk_bf16_f32 v15, v15, v17
    v_cvt_pk_bf16_f32 v18, v18, v20
    v_cvt_pk_bf16_f32 v19, v19, v21
    v_cvt_pk_bf16_f32 v22, v22, v24
    v_cvt_pk_bf16_f32 v23, v23, v25
    v_cvt_pk_bf16_f32 v26, v26, v28
    v_cvt_pk_bf16_f32 v27, v27, v29
    v_dot2_f32_bf16 v112, v14, s68, 0
    v_dot2_f32_bf16 v113, v15, s68, 0
    v_dot2_f32_bf16 v114, v14, s69, 0
    v_dot2_f32_bf16 v115, v15, s69, 0
    v_dot2_f32_bf16 v116, v14, s70, 0
    v_dot2_f32_bf16 v117, v15, s70, 0
    v_dot2_f32_bf16 v118, v14, s71, 0
    v_dot2_f32_bf16 v119, v15, s71, 0
    v_dot2_f32_bf16 v120, v14, s52, 0
    v_dot2_f32_bf16 v121, v15, s52, 0
    v_dot2_f32_bf16 v122, v14, s53, 0
    v_dot2_f32_bf16 v123, v15, s53, 0
    v_dot2_f32_bf16 v124, v14, s54, 0
    v_dot2_f32_bf16 v125, v15, s54, 0
    v_dot2_f32_bf16 v126, v14, s55, 0
    v_dot2_f32_bf16 v127, v15, s55, 0
    v_dot2_f32_bf16 v112, v18, s72, v112
    v_dot2_f32_bf16 v113, v19, s72, v113
    v_dot2_f32_bf16 v114, v18, s73, v114
    v_dot2_f32_bf16 v115, v19, s73, v115
    v_dot2_f32_bf16 v116, v18, s74, v116
    v_dot2_f32_bf16 v117, v19, s74, v117
    v_dot2_f32_bf16 v118, v18, s75, v118
    v_dot2_f32_bf16 v119, v19, s75, v119
    v_dot2_f32_bf16 v120, v18, s56, v120
    v_dot2_f32_bf16 v121, v19, s56, v121
    v_dot2_f32_bf16 v122, v18, s57, v122
    v_dot2_f32_bf16 v123, v19, s57, v123
    v_dot2_f32_bf16 v124, v18, s58, v124
    v_dot2_f32_bf16 v125, v19, s58, v125
    v_dot2_f32_bf16 v126, v18, s59, v126
    v_dot2_f32_bf16 v127, v19, s59, v127
    v_dot2_f32_bf16 v112, v22, s76, v112
    v_dot2_f32_bf16 v113, v23, s76, v113
    v_dot2_f32_bf16 v114, v22, s77, v114
    v_dot2_f32_bf16 v115, v23, s77, v115
    v_dot2_f32_bf16 v116, v22, s78, v116
    v_dot2_f32_bf16 v117, v23, s78, v117
    v_dot2_f32_bf16 v118, v22, s79, v118
    v_dot2_f32_bf16 v119, v23, s79, v119
    v_dot2_f32_bf16 v120, v22, s60, v120
    v_dot2_f32_bf16 v121, v23, s60, v121
    v_dot2_f32_bf16 v122, v22, s61, v122
    v_dot2_f32_bf16 v123, v23, s61, v123
    v_dot2_f32_bf16 v124, v22, s62, v124
    v_dot2_f32_bf16 v125, v23, s62, v125
    v_dot2_f32_bf16 v126, v22, s63, v126
    v_dot2_f32_bf16 v127, v23, s63, v127
    v_dot2_f32_bf16 v112, v26, s80, v112
    v_dot2_f32_bf16 v113, v27, s80, v113
    v_dot2_f32_bf16 v114, v26, s81, v114
    v_dot2_f32_bf16 v115, v27, s81, v115
    v_dot2_f32_bf16 v116, v26, s82, v116
    v_dot2_f32_bf16 v117, v27, s82, v117
    v_dot2_f32_bf16 v118, v26, s83, v118
    v_dot2_f32_bf16 v119, v27, s83, v119
    v_dot2_f32_bf16 v120, v26, s64, v120
    v_dot2_f32_bf16 v121, v27, s64, v121
    v_dot2_f32_bf16 v122, v26, s65, v122
    v_dot2_f32_bf16 v123, v27, s65, v123
    v_dot2_f32_bf16 v124, v26, s66, v124
    v_dot2_f32_bf16 v125, v27, s66, v125
    v_dot2_f32_bf16 v126, v26, s67, v126
    v_dot2_f32_bf16 v127, v27, s67, v127
L_p2_kernel_g1_6:
L_p2_gb:
    v_and_b32 v4, 0x80008000, v4
    v_cmp_ne_u32 vcc, 0, v4
    v_mov_b32 v8, s27
    v_and_b32 v10, 15, v0
    v_mul_u32_u24 v10, 240, v10
    v_add_u32 v10, 160000, v10
    s_cmp_lg_u64 vcc, 0
    s_cselect_b32 s2, 1, s2
    v_mov_b32 v9, s2
    s_mov_b64 exec, 1
    ds_write_b32 v8, v9
    s_mov_b64 exec, -1
    v_add_u32 v2, 16384, v1
    v_mov_b32 v9, 0x3f000000
    v_cmp_gt_u32 vcc, 226, v0
    s_mov_b32 s49, s12
    s_mov_b32 s51, 0
    v_cndmask_b32 v2, v9, v2, vcc
    s_waitcnt vmcnt(0) lgkmcnt(0)
    s_barrier
    ds_read_b32 v9, v10
    s_mov_b32 s18, 5120000
    s_mov_b32 s19, 0x00020000
    s_waitcnt lgkmcnt(0)
    v_cmp_ne_u32 vcc, 0, v9
    s_nop 1
    s_cmp_lg_u64 vcc, 0
    s_cselect_b32 s2, 1, 0
    s_cbranch_scc1 L_p2_slow
L_p2_signal:
    v_mov_b32 v8, 160228
    s_lshl_b32 s15, s2, 4
    s_or_b32 s15, s15, s21
    s_add_u32 s14, s12, 16
    s_lshl_b32 s20, s15, s14
    s_add_u32 s20, s20, 1
    v_mov_b32 v9, s20
    s_cmp_lg_u32 s13, 15
    s_cbranch_scc1 L_p2_nosig0
    s_lshl_b32 s14, s3, 8
    s_add_u32 s14, s14, 8523776
    s_mov_b64 exec, 1
    buffer_atomic_add v9, off, s[4:7], s14 sc0
    s_mov_b64 exec, -1
L_p2_nosig0:
    s_lshl2_add_u32 s14, s3, s49
    s_mul_i32 s26, s14, 20000
    s_mov_b32 s10, 5120000
    buffer_load_dwordx4 v[64:67], v1, s[8:11], s26 offen
    buffer_load_dwordx4 v[68:71], v2, s[8:11], s26 offen
    s_lshl_b32 s28, s92, 16
    s_and_b32 s29, s92, 0xffff0000
    s_lshl_b32 s30, s93, 16
    s_and_b32 s31, s93, 0xffff0000
    s_lshl_b32 s32, s94, 16
    s_and_b32 s33, s94, 0xffff0000
    s_lshl_b32 s34, s95, 16
    s_and_b32 s35, s95, 0xffff0000
    s_lshl_b32 s36, s96, 16
    s_and_b32 s37, s96, 0xffff0000
    s_lshl_b32 s38, s97, 16
    s_and_b32 s39, s97, 0xffff0000
    s_lshl_b32 s40, s98, 16
    s_and_b32 s41, s98, 0xffff0000
    s_lshl_b32 s42, s99, 16
    s_and_b32 s43, s99, 0xffff0000
    s_and_b32 s99, s91, 0xffff0000
    s_lshl_b32 s98, s91, 16
    s_and_b32 s97, s90, 0xffff0000
    s_lshl_b32 s96, s90, 16
    s_and_b32 s95, s89, 0xffff0000
    s_lshl_b32 s94, s89, 16
    s_and_b32 s93, s88, 0xffff0000
    s_lshl_b32 s92, s88, 16
    s_and_b32 s91, s87, 0xffff0000
    s_lshl_b32 s90, s87, 16
    s_and_b32 s89, s86, 0xffff0000
    s_lshl_b32 s88, s86, 16
    s_and_b32 s87, s85, 0xffff0000
    s_lshl_b32 s86, s85, 16
    s_and_b32 s85, s84, 0xffff0000
    s_lshl_b32 s84, s84, 16
    s_mov_b32 s44, s48
    s_add_u32 s45, s48, 2281701376
    s_cmp_eq_u32 s48, 0
    s_cselect_b32 s45, 0, s45
    s_cmp_lg_u32 s13, 15
    s_cbranch_scc1 L_p2_nosig
    s_waitcnt vmcnt(2)
    v_readfirstlane_b32 s15, v9
    s_lshl_b32 s51, 1, s12
    s_add_u32 s20, s20, s15
    s_and_b32 s15, s20, 0xff
    s_cmp_eq_u32 s15, 4
    s_cbranch_scc0 L_p2_notlast
    s_bfe_u32 s15, s20, 262160
    s_or_b32 s51, s51, s15
    s_branch L_p2_pub
L_p2_notlast:
    s_cmp_lg_u32 s21, 0
    s_cselect_b32 s51, 0, s51
    s_cbranch_scc1 L_p2_pub
L_p2_poll:
    v_mov_b32 v9, 0
    s_lshl_b32 s14, s3, 8
    s_add_u32 s14, s14, 8523776
    s_mov_b64 exec, 1
    buffer_atomic_add v9, off, s[4:7], s14 sc0
    s_mov_b64 exec, -1
    s_waitcnt vmcnt(0)
    v_readfirstlane_b32 s20, v9
    s_nop 0
    s_and_b32 s15, s20, 0xff
    s_cmp_lt_u32 s15, 4
    s_cbranch_scc1 L_p2_poll
L_p2_pub:
    s_lshl_b32 s15, s51, 24
    s_or_b32 s15, s15, s20
    v_mov_b32 v9, s15
    s_mov_b64 exec, 1
    ds_write_b32 v8, v9
    s_mov_b64 exec, -1
    s_waitcnt lgkmcnt(0)
L_p2_nosig:
    s_barrier
    ds_read_b32 v9, v8
    s_waitcnt lgkmcnt(0)
    v_readfirstlane_b32 s20, v9
    s_nop 0
    s_lshr_b32 s51, s20, 24
    s_cbranch_scc0 L_p2_end
L_p2_fin:
    s_mul_i32 s24, s49, 20000
    s_add_u32 s14, s12, 1
    s_and_b32 s14, s14, 3
    s_mul_i32 s15, s14, 5120000
    s_add_u32 s15, s15, 228589568
    s_add_u32 s15, s15, s26
    buffer_load_dwordx4 v[12:15], v1, s[4:7], s15 offen sc1
    buffer_load_dwordx4 v[92:95], v2, s[4:7], s15 offen sc1
    s_add_u32 s14, s12, 2
    s_and_b32 s14, s14, 3
    s_mul_i32 s15, s14, 5120000
    s_add_u32 s15, s15, 228589568
    s_add_u32 s15, s15, s26
    buffer_load_dwordx4 v[16:19], v1, s[4:7], s15 offen sc1
    buffer_load_dwordx4 v[96:99], v2, s[4:7], s15 offen sc1
    s_add_u32 s14, s12, 3
    s_and_b32 s14, s14, 3
    s_mul_i32 s15, s14, 5120000
    s_add_u32 s15, s15, 228589568
    s_add_u32 s15, s15, s26
    buffer_load_dwordx4 v[20:23], v1, s[4:7], s15 offen sc1
    buffer_load_dwordx4 v[100:103], v2, s[4:7], s15 offen sc1
    v_add_u32 v24, s24, v1
    ds_read_b128 v[8:11], v24
    v_add_u32 v25, s24, v2
    ds_read_b128 v[88:91], v25
    s_waitcnt vmcnt(0) lgkmcnt(0)
    s_bfe_u32 s14, s20, 262164
    s_cbranch_scc0 L_p2_kernel_nof32a_7
    s_add_u32 s14, s12, 0
    s_and_b32 s14, s14, 3
    s_add_u32 s14, s14, 20
    s_bitcmp1_b32 s20, s14
    s_cbranch_scc0 L_p2_kernel_q_8
    v_mov_b32 v8, 1073758208
    v_mov_b32 v9, 1073758208
    v_mov_b32 v10, 1073758208
    v_mov_b32 v11, 1073758208
L_p2_kernel_q_8:
    s_add_u32 s14, s12, 1
    s_and_b32 s14, s14, 3
    s_add_u32 s14, s14, 20
    s_bitcmp1_b32 s20, s14
    s_cbranch_scc0 L_p2_kernel_q_9
    v_mov_b32 v12, 1073758208
    v_mov_b32 v13, 1073758208
    v_mov_b32 v14, 1073758208
    v_mov_b32 v15, 1073758208
L_p2_kernel_q_9:
    s_add_u32 s14, s12, 2
    s_and_b32 s14, s14, 3
    s_add_u32 s14, s14, 20
    s_bitcmp1_b32 s20, s14
    s_cbranch_scc0 L_p2_kernel_q_10
    v_mov_b32 v16, 1073758208
    v_mov_b32 v17, 1073758208
    v_mov_b32 v18, 1073758208
    v_mov_b32 v19, 1073758208
L_p2_kernel_q_10:
    s_add_u32 s14, s12, 3
    s_and_b32 s14, s14, 3
    s_add_u32 s14, s14, 20
    s_bitcmp1_b32 s20, s14
    s_cbranch_scc0 L_p2_kernel_q_11
    v_mov_b32 v20, 1073758208
    v_mov_b32 v21, 1073758208
    v_mov_b32 v22, 1073758208
    v_mov_b32 v23, 1073758208
L_p2_kernel_q_11:
L_p2_kernel_nof32a_7:
    v_pk_add_u16 v8, v8, v12
    v_pk_add_u16 v16, v16, v20
    v_pk_add_u16 v9, v9, v13
    v_pk_add_u16 v17, v17, v21
    v_pk_add_u16 v10, v10, v14
    v_pk_add_u16 v18, v18, v22
    v_pk_add_u16 v11, v11, v15
    v_pk_add_u16 v19, v19, v23
    v_add_u32_sdwa v24, v8, v16 dst_sel:DWORD dst_unused:UNUSED_PAD src0_sel:WORD_0 src1_sel:WORD_0
    v_add_u32_sdwa v25, v10, v18 dst_sel:DWORD dst_unused:UNUSED_PAD src0_sel:WORD_0 src1_sel:WORD_0
    v_add_u32_sdwa v26, v8, v16 dst_sel:DWORD dst_unused:UNUSED_PAD src0_sel:WORD_1 src1_sel:WORD_1
    v_add_u32_sdwa v27, v10, v18 dst_sel:DWORD dst_unused:UNUSED_PAD src0_sel:WORD_1 src1_sel:WORD_1
    v_add_u32_sdwa v28, v9, v17 dst_sel:DWORD dst_unused:UNUSED_PAD src0_sel:WORD_0 src1_sel:WORD_0
    v_add_u32_sdwa v29, v11, v19 dst_sel:DWORD dst_unused:UNUSED_PAD src0_sel:WORD_0 src1_sel:WORD_0
    v_add_u32_sdwa v30, v9, v17 dst_sel:DWORD dst_unused:UNUSED_PAD src0_sel:WORD_1 src1_sel:WORD_1
    v_add_u32_sdwa v31, v11, v19 dst_sel:DWORD dst_unused:UNUSED_PAD src0_sel:WORD_1 src1_sel:WORD_1
    v_cvt_f32_u32 v24, v24
    v_cvt_f32_u32 v25, v25
    v_cvt_f32_u32 v26, v26
    v_cvt_f32_u32 v27, v27
    v_cvt_f32_u32 v28, v28
    v_cvt_f32_u32 v29, v29
    v_cvt_f32_u32 v30, v30
    v_cvt_f32_u32 v31, v31
    v_pk_fma_f32 v[24:25], v[24:25], s[44:45], s[44:45] op_sel:[0,0,1] op_sel_hi:[1,0,1]
    v_pk_fma_f32 v[26:27], v[26:27], s[44:45], s[44:45] op_sel:[0,0,1] op_sel_hi:[1,0,1]
    v_pk_fma_f32 v[28:29], v[28:29], s[44:45], s[44:45] op_sel:[0,0,1] op_sel_hi:[1,0,1]
    v_pk_fma_f32 v[30:31], v[30:31], s[44:45], s[44:45] op_sel:[0,0,1] op_sel_hi:[1,0,1]
    s_bfe_u32 s14, s20, 262164
    s_cbranch_scc0 L_p2_kernel_nof32b_12
    v_lshlrev_b32 v32, 1, v1
    s_bitcmp1_b32 s20, 20
    s_cbranch_scc0 L_p2_kernel_q_13
    s_lshl_b32 s15, s26, 1
    s_add_u32 s15, s15, 249069568
    buffer_load_dwordx4 v[8:11], v32, s[4:7], s15 offen sc1
    buffer_load_dwordx4 v[12:15], v32, s[4:7], s15 offen offset:16 sc1
    s_waitcnt vmcnt(0)
    v_add_f32 v24, v24, v8
    v_add_f32 v25, v25, v12
    v_add_f32 v26, v26, v9
    v_add_f32 v27, v27, v13
    v_add_f32 v28, v28, v10
    v_add_f32 v29, v29, v14
    v_add_f32 v30, v30, v11
    v_add_f32 v31, v31, v15
L_p2_kernel_q_13:
    s_bitcmp1_b32 s20, 21
    s_cbranch_scc0 L_p2_kernel_q_14
    s_lshl_b32 s15, s26, 1
    s_add_u32 s15, s15, 259309568
    buffer_load_dwordx4 v[8:11], v32, s[4:7], s15 offen sc1
    buffer_load_dwordx4 v[12:15], v32, s[4:7], s15 offen offset:16 sc1
    s_waitcnt vmcnt(0)
    v_add_f32 v24, v24, v8
    v_add_f32 v25, v25, v12
    v_add_f32 v26, v26, v9
    v_add_f32 v27, v27, v13
    v_add_f32 v28, v28, v10
    v_add_f32 v29, v29, v14
    v_add_f32 v30, v30, v11
    v_add_f32 v31, v31, v15
L_p2_kernel_q_14:
    s_bitcmp1_b32 s20, 22
    s_cbranch_scc0 L_p2_kernel_q_15
    s_lshl_b32 s15, s26, 1
    s_add_u32 s15, s15, 269549568
    buffer_load_dwordx4 v[8:11], v32, s[4:7], s15 offen sc1
    buffer_load_dwordx4 v[12:15], v32, s[4:7], s15 offen offset:16 sc1
    s_waitcnt vmcnt(0)
    v_add_f32 v24, v24, v8
    v_add_f32 v25, v25, v12
    v_add_f32 v26, v26, v9
    v_add_f32 v27, v27, v13
    v_add_f32 v28, v28, v10
    v_add_f32 v29, v29, v14
    v_add_f32 v30, v30, v11
    v_add_f32 v31, v31, v15
L_p2_kernel_q_15:
    s_bitcmp1_b32 s20, 23
    s_cbranch_scc0 L_p2_kernel_q_16
    s_lshl_b32 s15, s26, 1
    s_add_u32 s15, s15, 279789568
    buffer_load_dwordx4 v[8:11], v32, s[4:7], s15 offen sc1
    buffer_load_dwordx4 v[12:15], v32, s[4:7], s15 offen offset:16 sc1
    s_waitcnt vmcnt(0)
    v_add_f32 v24, v24, v8
    v_add_f32 v25, v25, v12
    v_add_f32 v26, v26, v9
    v_add_f32 v27, v27, v13
    v_add_f32 v28, v28, v10
    v_add_f32 v29, v29, v14
    v_add_f32 v30, v30, v11
    v_add_f32 v31, v31, v15
L_p2_kernel_q_16:
L_p2_kernel_nof32b_12:
    v_pk_mul_f32 v[8:9], v[24:25], s[84:85] op_sel:[0,0] op_sel_hi:[1,0]
    v_pk_mul_f32 v[10:11], v[24:25], s[84:85] op_sel:[0,1] op_sel_hi:[1,1]
    v_pk_mul_f32 v[12:13], v[24:25], s[86:87] op_sel:[0,0] op_sel_hi:[1,0]
    v_pk_mul_f32 v[14:15], v[24:25], s[86:87] op_sel:[0,1] op_sel_hi:[1,1]
    v_pk_fma_f32 v[8:9], v[26:27], s[88:89], v[8:9] op_sel:[0,0,0] op_sel_hi:[1,0,1]
    v_pk_fma_f32 v[10:11], v[26:27], s[88:89], v[10:11] op_sel:[0,1,0] op_sel_hi:[1,1,1]
    v_pk_fma_f32 v[12:13], v[26:27], s[90:91], v[12:13] op_sel:[0,0,0] op_sel_hi:[1,0,1]
    v_pk_fma_f32 v[14:15], v[26:27], s[90:91], v[14:15] op_sel:[0,1,0] op_sel_hi:[1,1,1]
    v_pk_fma_f32 v[8:9], v[28:29], s[92:93], v[8:9] op_sel:[0,0,0] op_sel_hi:[1,0,1]
    v_pk_fma_f32 v[10:11], v[28:29], s[92:93], v[10:11] op_sel:[0,1,0] op_sel_hi:[1,1,1]
    v_pk_fma_f32 v[12:13], v[28:29], s[94:95], v[12:13] op_sel:[0,0,0] op_sel_hi:[1,0,1]
    v_pk_fma_f32 v[14:15], v[28:29], s[94:95], v[14:15] op_sel:[0,1,0] op_sel_hi:[1,1,1]
    v_pk_fma_f32 v[8:9], v[30:31], s[96:97], v[8:9] op_sel:[0,0,0] op_sel_hi:[1,0,1]
    v_pk_fma_f32 v[10:11], v[30:31], s[96:97], v[10:11] op_sel:[0,1,0] op_sel_hi:[1,1,1]
    v_pk_fma_f32 v[12:13], v[30:31], s[98:99], v[12:13] op_sel:[0,0,0] op_sel_hi:[1,0,1]
    v_pk_fma_f32 v[14:15], v[30:31], s[98:99], v[14:15] op_sel:[0,1,0] op_sel_hi:[1,1,1]
    v_pk_mul_f32 v[8:9], v[8:9], v[72:73]
    v_pk_mul_f32 v[10:11], v[10:11], v[74:75]
    v_pk_mul_f32 v[12:13], v[12:13], v[76:77]
    v_pk_mul_f32 v[14:15], v[14:15], v[78:79]
    v_pk_mul_f32 v[24:25], v[8:9], s[28:29] op_sel:[0,0] op_sel_hi:[1,0]
    v_pk_mul_f32 v[26:27], v[8:9], s[28:29] op_sel:[0,1] op_sel_hi:[1,1]
    v_pk_mul_f32 v[28:29], v[8:9], s[30:31] op_sel:[0,0] op_sel_hi:[1,0]
    v_pk_mul_f32 v[30:31], v[8:9], s[30:31] op_sel:[0,1] op_sel_hi:[1,1]
    v_pk_fma_f32 v[24:25], v[10:11], s[32:33], v[24:25] op_sel:[0,0,0] op_sel_hi:[1,0,1]
    v_pk_fma_f32 v[26:27], v[10:11], s[32:33], v[26:27] op_sel:[0,1,0] op_sel_hi:[1,1,1]
    v_pk_fma_f32 v[28:29], v[10:11], s[34:35], v[28:29] op_sel:[0,0,0] op_sel_hi:[1,0,1]
    v_pk_fma_f32 v[30:31], v[10:11], s[34:35], v[30:31] op_sel:[0,1,0] op_sel_hi:[1,1,1]
    v_pk_fma_f32 v[24:25], v[12:13], s[36:37], v[24:25] op_sel:[0,0,0] op_sel_hi:[1,0,1]
    v_pk_fma_f32 v[26:27], v[12:13], s[36:37], v[26:27] op_sel:[0,1,0] op_sel_hi:[1,1,1]
    v_pk_fma_f32 v[28:29], v[12:13], s[38:39], v[28:29] op_sel:[0,0,0] op_sel_hi:[1,0,1]
    v_pk_fma_f32 v[30:31], v[12:13], s[38:39], v[30:31] op_sel:[0,1,0] op_sel_hi:[1,1,1]
    v_pk_fma_f32 v[24:25], v[14:15], s[40:41], v[24:25] op_sel:[0,0,0] op_sel_hi:[1,0,1]
    v_pk_fma_f32 v[26:27], v[14:15], s[40:41], v[26:27] op_sel:[0,1,0] op_sel_hi:[1,1,1]
    v_pk_fma_f32 v[28:29], v[14:15], s[42:43], v[28:29] op_sel:[0,0,0] op_sel_hi:[1,0,1]
    v_pk_fma_f32 v[30:31], v[14:15], s[42:43], v[30:31] op_sel:[0,1,0] op_sel_hi:[1,1,1]
    v_lshlrev_b32 v8, 16, v64
    v_and_b32 v10, 0xffff0000, v64
    v_lshlrev_b32 v12, 16, v65
    v_and_b32 v14, 0xffff0000, v65
    v_lshlrev_b32 v9, 16, v66
    v_and_b32 v11, 0xffff0000, v66
    v_lshlrev_b32 v13, 16, v67
    v_and_b32 v15, 0xffff0000, v67
    v_pk_fma_f32 v[8:9], v[24:25], v[80:81], v[8:9]
    v_pk_fma_f32 v[10:11], v[26:27], v[82:83], v[10:11]
    v_pk_fma_f32 v[12:13], v[28:29], v[84:85], v[12:13]
    v_pk_fma_f32 v[14:15], v[30:31], v[86:87], v[14:15]
    v_cvt_pk_bf16_f32 v16, v8, v10
    v_cvt_pk_bf16_f32 v17, v12, v14
    v_cvt_pk_bf16_f32 v18, v9, v11
    v_cvt_pk_bf16_f32 v19, v13, v15
    buffer_store_dwordx4 v[16:19], v1, s[16:19], s26 offen
    s_cmp_ge_u32 s13, 4
    s_cbranch_scc1 L_p2_f1
    s_bfe_u32 s14, s20, 262164
    s_cbranch_scc0 L_p2_kernel_nof32a_17
    s_add_u32 s14, s12, 0
    s_and_b32 s14, s14, 3
    s_add_u32 s14, s14, 20
    s_bitcmp1_b32 s20, s14
    s_cbranch_scc0 L_p2_kernel_q_18
    v_mov_b32 v88, 1073758208
    v_mov_b32 v89, 1073758208
    v_mov_b32 v90, 1073758208
    v_mov_b32 v91, 1073758208
L_p2_kernel_q_18:
    s_add_u32 s14, s12, 1
    s_and_b32 s14, s14, 3
    s_add_u32 s14, s14, 20
    s_bitcmp1_b32 s20, s14
    s_cbranch_scc0 L_p2_kernel_q_19
    v_mov_b32 v92, 1073758208
    v_mov_b32 v93, 1073758208
    v_mov_b32 v94, 1073758208
    v_mov_b32 v95, 1073758208
L_p2_kernel_q_19:
    s_add_u32 s14, s12, 2
    s_and_b32 s14, s14, 3
    s_add_u32 s14, s14, 20
    s_bitcmp1_b32 s20, s14
    s_cbranch_scc0 L_p2_kernel_q_20
    v_mov_b32 v96, 1073758208
    v_mov_b32 v97, 1073758208
    v_mov_b32 v98, 1073758208
    v_mov_b32 v99, 1073758208
L_p2_kernel_q_20:
    s_add_u32 s14, s12, 3
    s_and_b32 s14, s14, 3
    s_add_u32 s14, s14, 20
    s_bitcmp1_b32 s20, s14
    s_cbranch_scc0 L_p2_kernel_q_21
    v_mov_b32 v100, 1073758208
    v_mov_b32 v101, 1073758208
    v_mov_b32 v102, 1073758208
    v_mov_b32 v103, 1073758208
L_p2_kernel_q_21:
L_p2_kernel_nof32a_17:
    v_pk_add_u16 v88, v88, v92
    v_pk_add_u16 v96, v96, v100
    v_pk_add_u16 v89, v89, v93
    v_pk_add_u16 v97, v97, v101
    v_pk_add_u16 v90, v90, v94
    v_pk_add_u16 v98, v98, v102
    v_pk_add_u16 v91, v91, v95
    v_pk_add_u16 v99, v99, v103
    v_add_u32_sdwa v24, v88, v96 dst_sel:DWORD dst_unused:UNUSED_PAD src0_sel:WORD_0 src1_sel:WORD_0
    v_add_u32_sdwa v25, v90, v98 dst_sel:DWORD dst_unused:UNUSED_PAD src0_sel:WORD_0 src1_sel:WORD_0
    v_add_u32_sdwa v26, v88, v96 dst_sel:DWORD dst_unused:UNUSED_PAD src0_sel:WORD_1 src1_sel:WORD_1
    v_add_u32_sdwa v27, v90, v98 dst_sel:DWORD dst_unused:UNUSED_PAD src0_sel:WORD_1 src1_sel:WORD_1
    v_add_u32_sdwa v28, v89, v97 dst_sel:DWORD dst_unused:UNUSED_PAD src0_sel:WORD_0 src1_sel:WORD_0
    v_add_u32_sdwa v29, v91, v99 dst_sel:DWORD dst_unused:UNUSED_PAD src0_sel:WORD_0 src1_sel:WORD_0
    v_add_u32_sdwa v30, v89, v97 dst_sel:DWORD dst_unused:UNUSED_PAD src0_sel:WORD_1 src1_sel:WORD_1
    v_add_u32_sdwa v31, v91, v99 dst_sel:DWORD dst_unused:UNUSED_PAD src0_sel:WORD_1 src1_sel:WORD_1
    v_cvt_f32_u32 v24, v24
    v_cvt_f32_u32 v25, v25
    v_cvt_f32_u32 v26, v26
    v_cvt_f32_u32 v27, v27
    v_cvt_f32_u32 v28, v28
    v_cvt_f32_u32 v29, v29
    v_cvt_f32_u32 v30, v30
    v_cvt_f32_u32 v31, v31
    v_pk_fma_f32 v[24:25], v[24:25], s[44:45], s[44:45] op_sel:[0,0,1] op_sel_hi:[1,0,1]
    v_pk_fma_f32 v[26:27], v[26:27], s[44:45], s[44:45] op_sel:[0,0,1] op_sel_hi:[1,0,1]
    v_pk_fma_f32 v[28:29], v[28:29], s[44:45], s[44:45] op_sel:[0,0,1] op_sel_hi:[1,0,1]
    v_pk_fma_f32 v[30:31], v[30:31], s[44:45], s[44:45] op_sel:[0,0,1] op_sel_hi:[1,0,1]
    s_bfe_u32 s14, s20, 262164
    s_cbranch_scc0 L_p2_kernel_nof32b_22
    v_lshlrev_b32 v32, 1, v2
    s_bitcmp1_b32 s20, 20
    s_cbranch_scc0 L_p2_kernel_q_23
    s_lshl_b32 s15, s26, 1
    s_add_u32 s15, s15, 249069568
    buffer_load_dwordx4 v[88:91], v32, s[4:7], s15 offen sc1
    buffer_load_dwordx4 v[92:95], v32, s[4:7], s15 offen offset:16 sc1
    s_waitcnt vmcnt(0)
    v_add_f32 v24, v24, v88
    v_add_f32 v25, v25, v92
    v_add_f32 v26, v26, v89
    v_add_f32 v27, v27, v93
    v_add_f32 v28, v28, v90
    v_add_f32 v29, v29, v94
    v_add_f32 v30, v30, v91
    v_add_f32 v31, v31, v95
L_p2_kernel_q_23:
    s_bitcmp1_b32 s20, 21
    s_cbranch_scc0 L_p2_kernel_q_24
    s_lshl_b32 s15, s26, 1
    s_add_u32 s15, s15, 259309568
    buffer_load_dwordx4 v[88:91], v32, s[4:7], s15 offen sc1
    buffer_load_dwordx4 v[92:95], v32, s[4:7], s15 offen offset:16 sc1
    s_waitcnt vmcnt(0)
    v_add_f32 v24, v24, v88
    v_add_f32 v25, v25, v92
    v_add_f32 v26, v26, v89
    v_add_f32 v27, v27, v93
    v_add_f32 v28, v28, v90
    v_add_f32 v29, v29, v94
    v_add_f32 v30, v30, v91
    v_add_f32 v31, v31, v95
L_p2_kernel_q_24:
    s_bitcmp1_b32 s20, 22
    s_cbranch_scc0 L_p2_kernel_q_25
    s_lshl_b32 s15, s26, 1
    s_add_u32 s15, s15, 269549568
    buffer_load_dwordx4 v[88:91], v32, s[4:7], s15 offen sc1
    buffer_load_dwordx4 v[92:95], v32, s[4:7], s15 offen offset:16 sc1
    s_waitcnt vmcnt(0)
    v_add_f32 v24, v24, v88
    v_add_f32 v25, v25, v92
    v_add_f32 v26, v26, v89
    v_add_f32 v27, v27, v93
    v_add_f32 v28, v28, v90
    v_add_f32 v29, v29, v94
    v_add_f32 v30, v30, v91
    v_add_f32 v31, v31, v95
L_p2_kernel_q_25:
    s_bitcmp1_b32 s20, 23
    s_cbranch_scc0 L_p2_kernel_q_26
    s_lshl_b32 s15, s26, 1
    s_add_u32 s15, s15, 279789568
    buffer_load_dwordx4 v[88:91], v32, s[4:7], s15 offen sc1
    buffer_load_dwordx4 v[92:95], v32, s[4:7], s15 offen offset:16 sc1
    s_waitcnt vmcnt(0)
    v_add_f32 v24, v24, v88
    v_add_f32 v25, v25, v92
    v_add_f32 v26, v26, v89
    v_add_f32 v27, v27, v93
    v_add_f32 v28, v28, v90
    v_add_f32 v29, v29, v94
    v_add_f32 v30, v30, v91
    v_add_f32 v31, v31, v95
L_p2_kernel_q_26:
L_p2_kernel_nof32b_22:
    v_pk_mul_f32 v[88:89], v[24:25], s[84:85] op_sel:[0,0] op_sel_hi:[1,0]
    v_pk_mul_f32 v[90:91], v[24:25], s[84:85] op_sel:[0,1] op_sel_hi:[1,1]
    v_pk_mul_f32 v[92:93], v[24:25], s[86:87] op_sel:[0,0] op_sel_hi:[1,0]
    v_pk_mul_f32 v[94:95], v[24:25], s[86:87] op_sel:[0,1] op_sel_hi:[1,1]
    v_pk_fma_f32 v[88:89], v[26:27], s[88:89], v[88:89] op_sel:[0,0,0] op_sel_hi:[1,0,1]
    v_pk_fma_f32 v[90:91], v[26:27], s[88:89], v[90:91] op_sel:[0,1,0] op_sel_hi:[1,1,1]
    v_pk_fma_f32 v[92:93], v[26:27], s[90:91], v[92:93] op_sel:[0,0,0] op_sel_hi:[1,0,1]
    v_pk_fma_f32 v[94:95], v[26:27], s[90:91], v[94:95] op_sel:[0,1,0] op_sel_hi:[1,1,1]
    v_pk_fma_f32 v[88:89], v[28:29], s[92:93], v[88:89] op_sel:[0,0,0] op_sel_hi:[1,0,1]
    v_pk_fma_f32 v[90:91], v[28:29], s[92:93], v[90:91] op_sel:[0,1,0] op_sel_hi:[1,1,1]
    v_pk_fma_f32 v[92:93], v[28:29], s[94:95], v[92:93] op_sel:[0,0,0] op_sel_hi:[1,0,1]
    v_pk_fma_f32 v[94:95], v[28:29], s[94:95], v[94:95] op_sel:[0,1,0] op_sel_hi:[1,1,1]
    v_pk_fma_f32 v[88:89], v[30:31], s[96:97], v[88:89] op_sel:[0,0,0] op_sel_hi:[1,0,1]
    v_pk_fma_f32 v[90:91], v[30:31], s[96:97], v[90:91] op_sel:[0,1,0] op_sel_hi:[1,1,1]
    v_pk_fma_f32 v[92:93], v[30:31], s[98:99], v[92:93] op_sel:[0,0,0] op_sel_hi:[1,0,1]
    v_pk_fma_f32 v[94:95], v[30:31], s[98:99], v[94:95] op_sel:[0,1,0] op_sel_hi:[1,1,1]
    v_pk_mul_f32 v[88:89], v[88:89], v[112:113]
    v_pk_mul_f32 v[90:91], v[90:91], v[114:115]
    v_pk_mul_f32 v[92:93], v[92:93], v[116:117]
    v_pk_mul_f32 v[94:95], v[94:95], v[118:119]
    v_pk_mul_f32 v[24:25], v[88:89], s[28:29] op_sel:[0,0] op_sel_hi:[1,0]
    v_pk_mul_f32 v[26:27], v[88:89], s[28:29] op_sel:[0,1] op_sel_hi:[1,1]
    v_pk_mul_f32 v[28:29], v[88:89], s[30:31] op_sel:[0,0] op_sel_hi:[1,0]
    v_pk_mul_f32 v[30:31], v[88:89], s[30:31] op_sel:[0,1] op_sel_hi:[1,1]
    v_pk_fma_f32 v[24:25], v[90:91], s[32:33], v[24:25] op_sel:[0,0,0] op_sel_hi:[1,0,1]
    v_pk_fma_f32 v[26:27], v[90:91], s[32:33], v[26:27] op_sel:[0,1,0] op_sel_hi:[1,1,1]
    v_pk_fma_f32 v[28:29], v[90:91], s[34:35], v[28:29] op_sel:[0,0,0] op_sel_hi:[1,0,1]
    v_pk_fma_f32 v[30:31], v[90:91], s[34:35], v[30:31] op_sel:[0,1,0] op_sel_hi:[1,1,1]
    v_pk_fma_f32 v[24:25], v[92:93], s[36:37], v[24:25] op_sel:[0,0,0] op_sel_hi:[1,0,1]
    v_pk_fma_f32 v[26:27], v[92:93], s[36:37], v[26:27] op_sel:[0,1,0] op_sel_hi:[1,1,1]
    v_pk_fma_f32 v[28:29], v[92:93], s[38:39], v[28:29] op_sel:[0,0,0] op_sel_hi:[1,0,1]
    v_pk_fma_f32 v[30:31], v[92:93], s[38:39], v[30:31] op_sel:[0,1,0] op_sel_hi:[1,1,1]
    v_pk_fma_f32 v[24:25], v[94:95], s[40:41], v[24:25] op_sel:[0,0,0] op_sel_hi:[1,0,1]
    v_pk_fma_f32 v[26:27], v[94:95], s[40:41], v[26:27] op_sel:[0,1,0] op_sel_hi:[1,1,1]
    v_pk_fma_f32 v[28:29], v[94:95], s[42:43], v[28:29] op_sel:[0,0,0] op_sel_hi:[1,0,1]
    v_pk_fma_f32 v[30:31], v[94:95], s[42:43], v[30:31] op_sel:[0,1,0] op_sel_hi:[1,1,1]
    v_lshlrev_b32 v88, 16, v68
    v_and_b32 v90, 0xffff0000, v68
    v_lshlrev_b32 v92, 16, v69
    v_and_b32 v94, 0xffff0000, v69
    v_lshlrev_b32 v89, 16, v70
    v_and_b32 v91, 0xffff0000, v70
    v_lshlrev_b32 v93, 16, v71
    v_and_b32 v95, 0xffff0000, v71
    v_pk_fma_f32 v[88:89], v[24:25], v[120:121], v[88:89]
    v_pk_fma_f32 v[90:91], v[26:27], v[122:123], v[90:91]
    v_pk_fma_f32 v[92:93], v[28:29], v[124:125], v[92:93]
    v_pk_fma_f32 v[94:95], v[30:31], v[126:127], v[94:95]
    v_cvt_pk_bf16_f32 v96, v88, v90
    v_cvt_pk_bf16_f32 v97, v92, v94
    v_cvt_pk_bf16_f32 v98, v89, v91
    v_cvt_pk_bf16_f32 v99, v93, v95
    buffer_store_dwordx4 v[96:99], v2, s[16:19], s26 offen
L_p2_f1:
    s_bitset0_b32 s51, s49
    s_cmp_eq_u32 s51, 0
    s_cbranch_scc1 L_p2_done
    s_ff1_i32_b32 s49, s51
    s_lshl2_add_u32 s14, s3, s49
    s_mul_i32 s14, s14, 5000
    s_add_u32 s15, s14, 4096
    v_min_u32 v61, 225, v0
    v_lshl_add_u32 v60, v0, 2, s14
    v_lshl_add_u32 v61, v61, 2, s15
    global_load_dword v60, v60, s[100:101] nt
    global_load_dword v61, v61, s[100:101] nt
    s_waitcnt vmcnt(0)
    v_lshlrev_b32 v30, 16, v60
    v_and_b32 v31, 0xffff0000, v60
    v_lshlrev_b32 v36, 16, v53
    v_and_b32 v37, 0xffff0000, v53
    v_lshlrev_b32 v38, 16, v54
    v_and_b32 v39, 0xffff0000, v54
    v_lshlrev_b32 v40, 16, v56
    v_and_b32 v41, 0xffff0000, v56
    v_lshlrev_b32 v42, 16, v57
    v_and_b32 v43, 0xffff0000, v57
    v_pk_add_f32 v[14:15], v[30:31], v[36:37] op_sel:[0,0] op_sel_hi:[1,0] neg_lo:[0,1] neg_hi:[0,1]
    v_pk_add_f32 v[16:17], v[30:31], v[36:37] op_sel:[0,1] op_sel_hi:[1,1] neg_lo:[0,1] neg_hi:[0,1]
    v_pk_add_f32 v[18:19], v[30:31], v[38:39] op_sel:[0,0] op_sel_hi:[1,0] neg_lo:[0,1] neg_hi:[0,1]
    v_pk_add_f32 v[20:21], v[30:31], v[38:39] op_sel:[0,1] op_sel_hi:[1,1] neg_lo:[0,1] neg_hi:[0,1]
    v_pk_add_f32 v[22:23], v[30:31], v[40:41] op_sel:[0,0] op_sel_hi:[1,0] neg_lo:[0,1] neg_hi:[0,1]
    v_pk_add_f32 v[24:25], v[30:31], v[40:41] op_sel:[0,1] op_sel_hi:[1,1] neg_lo:[0,1] neg_hi:[0,1]
    v_pk_add_f32 v[26:27], v[30:31], v[42:43] op_sel:[0,0] op_sel_hi:[1,0] neg_lo:[0,1] neg_hi:[0,1]
    v_pk_add_f32 v[28:29], v[30:31], v[42:43] op_sel:[0,1] op_sel_hi:[1,1] neg_lo:[0,1] neg_hi:[0,1]
    v_cvt_pk_bf16_f32 v32, v14, v15
    v_lshlrev_b32 v14, 16, v32
    v_and_b32 v15, 0xffff0000, v32
    v_cvt_pk_bf16_f32 v32, v16, v17
    v_lshlrev_b32 v16, 16, v32
    v_and_b32 v17, 0xffff0000, v32
    v_cvt_pk_bf16_f32 v32, v18, v19
    v_lshlrev_b32 v18, 16, v32
    v_and_b32 v19, 0xffff0000, v32
    v_cvt_pk_bf16_f32 v32, v20, v21
    v_lshlrev_b32 v20, 16, v32
    v_and_b32 v21, 0xffff0000, v32
    v_cvt_pk_bf16_f32 v32, v22, v23
    v_lshlrev_b32 v22, 16, v32
    v_and_b32 v23, 0xffff0000, v32
    v_cvt_pk_bf16_f32 v32, v24, v25
    v_lshlrev_b32 v24, 16, v32
    v_and_b32 v25, 0xffff0000, v32
    v_cvt_pk_bf16_f32 v32, v26, v27
    v_lshlrev_b32 v26, 16, v32
    v_and_b32 v27, 0xffff0000, v32
    v_cvt_pk_bf16_f32 v32, v28, v29
    v_lshlrev_b32 v28, 16, v32
    v_and_b32 v29, 0xffff0000, v32
    v_pk_mul_f32 v[14:15], v[14:15], v[14:15]
    v_pk_mul_f32 v[16:17], v[16:17], v[16:17]
    v_pk_mul_f32 v[18:19], v[18:19], v[18:19]
    v_pk_mul_f32 v[20:21], v[20:21], v[20:21]
    v_pk_mul_f32 v[22:23], v[22:23], v[22:23]
    v_pk_mul_f32 v[24:25], v[24:25], v[24:25]
    v_pk_mul_f32 v[26:27], v[26:27], v[26:27]
    v_pk_mul_f32 v[28:29], v[28:29], v[28:29]
    v_cvt_pk_bf16_f32 v32, v14, v15
    v_lshlrev_b32 v14, 16, v32
    v_and_b32 v15, 0xffff0000, v32
    v_cvt_pk_bf16_f32 v32, v16, v17
    v_lshlrev_b32 v16, 16, v32
    v_and_b32 v17, 0xffff0000, v32
    v_cvt_pk_bf16_f32 v32, v18, v19
    v_lshlrev_b32 v18, 16, v32
    v_and_b32 v19, 0xffff0000, v32
    v_cvt_pk_bf16_f32 v32, v20, v21
    v_lshlrev_b32 v20, 16, v32
    v_and_b32 v21, 0xffff0000, v32
    v_cvt_pk_bf16_f32 v32, v22, v23
    v_lshlrev_b32 v22, 16, v32
    v_and_b32 v23, 0xffff0000, v32
    v_cvt_pk_bf16_f32 v32, v24, v25
    v_lshlrev_b32 v24, 16, v32
    v_and_b32 v25, 0xffff0000, v32
    v_cvt_pk_bf16_f32 v32, v26, v27
    v_lshlrev_b32 v26, 16, v32
    v_and_b32 v27, 0xffff0000, v32
    v_cvt_pk_bf16_f32 v32, v28, v29
    v_lshlrev_b32 v28, 16, v32
    v_and_b32 v29, 0xffff0000, v32
    v_mov_b32 v30, 1092616192
    v_mov_b32 v31, 0x3fb8aa3b
    v_pk_mul_f32 v[14:15], v[14:15], v[30:31] op_sel:[0,0] op_sel_hi:[1,0]
    v_pk_mul_f32 v[16:17], v[16:17], v[30:31] op_sel:[0,0] op_sel_hi:[1,0]
    v_pk_mul_f32 v[18:19], v[18:19], v[30:31] op_sel:[0,0] op_sel_hi:[1,0]
    v_pk_mul_f32 v[20:21], v[20:21], v[30:31] op_sel:[0,0] op_sel_hi:[1,0]
    v_pk_mul_f32 v[22:23], v[22:23], v[30:31] op_sel:[0,0] op_sel_hi:[1,0]
    v_pk_mul_f32 v[24:25], v[24:25], v[30:31] op_sel:[0,0] op_sel_hi:[1,0]
    v_pk_mul_f32 v[26:27], v[26:27], v[30:31] op_sel:[0,0] op_sel_hi:[1,0]
    v_pk_mul_f32 v[28:29], v[28:29], v[30:31] op_sel:[0,0] op_sel_hi:[1,0]
    v_cvt_pk_bf16_f32 v32, v14, v15
    v_lshlrev_b32 v14, 16, v32
    v_and_b32 v15, 0xffff0000, v32
    v_cvt_pk_bf16_f32 v32, v16, v17
    v_lshlrev_b32 v16, 16, v32
    v_and_b32 v17, 0xffff0000, v32
    v_cvt_pk_bf16_f32 v32, v18, v19
    v_lshlrev_b32 v18, 16, v32
    v_and_b32 v19, 0xffff0000, v32
    v_cvt_pk_bf16_f32 v32, v20, v21
    v_lshlrev_b32 v20, 16, v32
    v_and_b32 v21, 0xffff0000, v32
    v_cvt_pk_bf16_f32 v32, v22, v23
    v_lshlrev_b32 v22, 16, v32
    v_and_b32 v23, 0xffff0000, v32
    v_cvt_pk_bf16_f32 v32, v24, v25
    v_lshlrev_b32 v24, 16, v32
    v_and_b32 v25, 0xffff0000, v32
    v_cvt_pk_bf16_f32 v32, v26, v27
    v_lshlrev_b32 v26, 16, v32
    v_and_b32 v27, 0xffff0000, v32
    v_cvt_pk_bf16_f32 v32, v28, v29
    v_lshlrev_b32 v28, 16, v32
    v_and_b32 v29, 0xffff0000, v32
    v_pk_mul_f32 v[14:15], v[14:15], v[30:31] op_sel:[0,1] op_sel_hi:[1,1]
    v_pk_mul_f32 v[16:17], v[16:17], v[30:31] op_sel:[0,1] op_sel_hi:[1,1]
    v_pk_mul_f32 v[18:19], v[18:19], v[30:31] op_sel:[0,1] op_sel_hi:[1,1]
    v_pk_mul_f32 v[20:21], v[20:21], v[30:31] op_sel:[0,1] op_sel_hi:[1,1]
    v_pk_mul_f32 v[22:23], v[22:23], v[30:31] op_sel:[0,1] op_sel_hi:[1,1]
    v_pk_mul_f32 v[24:25], v[24:25], v[30:31] op_sel:[0,1] op_sel_hi:[1,1]
    v_pk_mul_f32 v[26:27], v[26:27], v[30:31] op_sel:[0,1] op_sel_hi:[1,1]
    v_pk_mul_f32 v[28:29], v[28:29], v[30:31] op_sel:[0,1] op_sel_hi:[1,1]
    v_exp_f32 v14, -v14
    v_exp_f32 v15, -v15
    v_exp_f32 v16, -v16
    v_exp_f32 v17, -v17
    v_exp_f32 v18, -v18
    v_exp_f32 v19, -v19
    v_exp_f32 v20, -v20
    v_exp_f32 v21, -v21
    v_exp_f32 v22, -v22
    v_exp_f32 v23, -v23
    v_exp_f32 v24, -v24
    v_exp_f32 v25, -v25
    v_exp_f32 v26, -v26
    v_exp_f32 v27, -v27
    v_exp_f32 v28, -v28
    v_exp_f32 v29, -v29
    v_cvt_pk_bf16_f32 v14, v14, v16
    v_cvt_pk_bf16_f32 v15, v15, v17
    v_cvt_pk_bf16_f32 v18, v18, v20
    v_cvt_pk_bf16_f32 v19, v19, v21
    v_cvt_pk_bf16_f32 v22, v22, v24
    v_cvt_pk_bf16_f32 v23, v23, v25
    v_cvt_pk_bf16_f32 v26, v26, v28
    v_cvt_pk_bf16_f32 v27, v27, v29
    v_dot2_f32_bf16 v72, v14, s68, 0
    v_dot2_f32_bf16 v73, v15, s68, 0
    v_dot2_f32_bf16 v74, v14, s69, 0
    v_dot2_f32_bf16 v75, v15, s69, 0
    v_dot2_f32_bf16 v76, v14, s70, 0
    v_dot2_f32_bf16 v77, v15, s70, 0
    v_dot2_f32_bf16 v78, v14, s71, 0
    v_dot2_f32_bf16 v79, v15, s71, 0
    v_dot2_f32_bf16 v80, v14, s52, 0
    v_dot2_f32_bf16 v81, v15, s52, 0
    v_dot2_f32_bf16 v82, v14, s53, 0
    v_dot2_f32_bf16 v83, v15, s53, 0
    v_dot2_f32_bf16 v84, v14, s54, 0
    v_dot2_f32_bf16 v85, v15, s54, 0
    v_dot2_f32_bf16 v86, v14, s55, 0
    v_dot2_f32_bf16 v87, v15, s55, 0
    v_dot2_f32_bf16 v72, v18, s72, v72
    v_dot2_f32_bf16 v73, v19, s72, v73
    v_dot2_f32_bf16 v74, v18, s73, v74
    v_dot2_f32_bf16 v75, v19, s73, v75
    v_dot2_f32_bf16 v76, v18, s74, v76
    v_dot2_f32_bf16 v77, v19, s74, v77
    v_dot2_f32_bf16 v78, v18, s75, v78
    v_dot2_f32_bf16 v79, v19, s75, v79
    v_dot2_f32_bf16 v80, v18, s56, v80
    v_dot2_f32_bf16 v81, v19, s56, v81
    v_dot2_f32_bf16 v82, v18, s57, v82
    v_dot2_f32_bf16 v83, v19, s57, v83
    v_dot2_f32_bf16 v84, v18, s58, v84
    v_dot2_f32_bf16 v85, v19, s58, v85
    v_dot2_f32_bf16 v86, v18, s59, v86
    v_dot2_f32_bf16 v87, v19, s59, v87
    v_dot2_f32_bf16 v72, v22, s76, v72
    v_dot2_f32_bf16 v73, v23, s76, v73
    v_dot2_f32_bf16 v74, v22, s77, v74
    v_dot2_f32_bf16 v75, v23, s77, v75
    v_dot2_f32_bf16 v76, v22, s78, v76
    v_dot2_f32_bf16 v77, v23, s78, v77
    v_dot2_f32_bf16 v78, v22, s79, v78
    v_dot2_f32_bf16 v79, v23, s79, v79
    v_dot2_f32_bf16 v80, v22, s60, v80
    v_dot2_f32_bf16 v81, v23, s60, v81
    v_dot2_f32_bf16 v82, v22, s61, v82
    v_dot2_f32_bf16 v83, v23, s61, v83
    v_dot2_f32_bf16 v84, v22, s62, v84
    v_dot2_f32_bf16 v85, v23, s62, v85
    v_dot2_f32_bf16 v86, v22, s63, v86
    v_dot2_f32_bf16 v87, v23, s63, v87
    v_dot2_f32_bf16 v72, v26, s80, v72
    v_dot2_f32_bf16 v73, v27, s80, v73
    v_dot2_f32_bf16 v74, v26, s81, v74
    v_dot2_f32_bf16 v75, v27, s81, v75
    v_dot2_f32_bf16 v76, v26, s82, v76
    v_dot2_f32_bf16 v77, v27, s82, v77
    v_dot2_f32_bf16 v78, v26, s83, v78
    v_dot2_f32_bf16 v79, v27, s83, v79
    v_dot2_f32_bf16 v80, v26, s64, v80
    v_dot2_f32_bf16 v81, v27, s64, v81
    v_dot2_f32_bf16 v82, v26, s65, v82
    v_dot2_f32_bf16 v83, v27, s65, v83
    v_dot2_f32_bf16 v84, v26, s66, v84
    v_dot2_f32_bf16 v85, v27, s66, v85
    v_dot2_f32_bf16 v86, v26, s67, v86
    v_dot2_f32_bf16 v87, v27, s67, v87
    s_cmp_ge_u32 s13, 4
    s_cbranch_scc1 L_p2_kernel_g1_27
    v_lshlrev_b32 v30, 16, v61
    v_and_b32 v31, 0xffff0000, v61
    v_pk_add_f32 v[14:15], v[30:31], v[36:37] op_sel:[0,0] op_sel_hi:[1,0] neg_lo:[0,1] neg_hi:[0,1]
    v_pk_add_f32 v[16:17], v[30:31], v[36:37] op_sel:[0,1] op_sel_hi:[1,1] neg_lo:[0,1] neg_hi:[0,1]
    v_pk_add_f32 v[18:19], v[30:31], v[38:39] op_sel:[0,0] op_sel_hi:[1,0] neg_lo:[0,1] neg_hi:[0,1]
    v_pk_add_f32 v[20:21], v[30:31], v[38:39] op_sel:[0,1] op_sel_hi:[1,1] neg_lo:[0,1] neg_hi:[0,1]
    v_pk_add_f32 v[22:23], v[30:31], v[40:41] op_sel:[0,0] op_sel_hi:[1,0] neg_lo:[0,1] neg_hi:[0,1]
    v_pk_add_f32 v[24:25], v[30:31], v[40:41] op_sel:[0,1] op_sel_hi:[1,1] neg_lo:[0,1] neg_hi:[0,1]
    v_pk_add_f32 v[26:27], v[30:31], v[42:43] op_sel:[0,0] op_sel_hi:[1,0] neg_lo:[0,1] neg_hi:[0,1]
    v_pk_add_f32 v[28:29], v[30:31], v[42:43] op_sel:[0,1] op_sel_hi:[1,1] neg_lo:[0,1] neg_hi:[0,1]
    v_cvt_pk_bf16_f32 v32, v14, v15
    v_lshlrev_b32 v14, 16, v32
    v_and_b32 v15, 0xffff0000, v32
    v_cvt_pk_bf16_f32 v32, v16, v17
    v_lshlrev_b32 v16, 16, v32
    v_and_b32 v17, 0xffff0000, v32
    v_cvt_pk_bf16_f32 v32, v18, v19
    v_lshlrev_b32 v18, 16, v32
    v_and_b32 v19, 0xffff0000, v32
    v_cvt_pk_bf16_f32 v32, v20, v21
    v_lshlrev_b32 v20, 16, v32
    v_and_b32 v21, 0xffff0000, v32
    v_cvt_pk_bf16_f32 v32, v22, v23
    v_lshlrev_b32 v22, 16, v32
    v_and_b32 v23, 0xffff0000, v32
    v_cvt_pk_bf16_f32 v32, v24, v25
    v_lshlrev_b32 v24, 16, v32
    v_and_b32 v25, 0xffff0000, v32
    v_cvt_pk_bf16_f32 v32, v26, v27
    v_lshlrev_b32 v26, 16, v32
    v_and_b32 v27, 0xffff0000, v32
    v_cvt_pk_bf16_f32 v32, v28, v29
    v_lshlrev_b32 v28, 16, v32
    v_and_b32 v29, 0xffff0000, v32
    v_pk_mul_f32 v[14:15], v[14:15], v[14:15]
    v_pk_mul_f32 v[16:17], v[16:17], v[16:17]
    v_pk_mul_f32 v[18:19], v[18:19], v[18:19]
    v_pk_mul_f32 v[20:21], v[20:21], v[20:21]
    v_pk_mul_f32 v[22:23], v[22:23], v[22:23]
    v_pk_mul_f32 v[24:25], v[24:25], v[24:25]
    v_pk_mul_f32 v[26:27], v[26:27], v[26:27]
    v_pk_mul_f32 v[28:29], v[28:29], v[28:29]
    v_cvt_pk_bf16_f32 v32, v14, v15
    v_lshlrev_b32 v14, 16, v32
    v_and_b32 v15, 0xffff0000, v32
    v_cvt_pk_bf16_f32 v32, v16, v17
    v_lshlrev_b32 v16, 16, v32
    v_and_b32 v17, 0xffff0000, v32
    v_cvt_pk_bf16_f32 v32, v18, v19
    v_lshlrev_b32 v18, 16, v32
    v_and_b32 v19, 0xffff0000, v32
    v_cvt_pk_bf16_f32 v32, v20, v21
    v_lshlrev_b32 v20, 16, v32
    v_and_b32 v21, 0xffff0000, v32
    v_cvt_pk_bf16_f32 v32, v22, v23
    v_lshlrev_b32 v22, 16, v32
    v_and_b32 v23, 0xffff0000, v32
    v_cvt_pk_bf16_f32 v32, v24, v25
    v_lshlrev_b32 v24, 16, v32
    v_and_b32 v25, 0xffff0000, v32
    v_cvt_pk_bf16_f32 v32, v26, v27
    v_lshlrev_b32 v26, 16, v32
    v_and_b32 v27, 0xffff0000, v32
    v_cvt_pk_bf16_f32 v32, v28, v29
    v_lshlrev_b32 v28, 16, v32
    v_and_b32 v29, 0xffff0000, v32
    v_mov_b32 v30, 1092616192
    v_mov_b32 v31, 0x3fb8aa3b
    v_pk_mul_f32 v[14:15], v[14:15], v[30:31] op_sel:[0,0] op_sel_hi:[1,0]
    v_pk_mul_f32 v[16:17], v[16:17], v[30:31] op_sel:[0,0] op_sel_hi:[1,0]
    v_pk_mul_f32 v[18:19], v[18:19], v[30:31] op_sel:[0,0] op_sel_hi:[1,0]
    v_pk_mul_f32 v[20:21], v[20:21], v[30:31] op_sel:[0,0] op_sel_hi:[1,0]
    v_pk_mul_f32 v[22:23], v[22:23], v[30:31] op_sel:[0,0] op_sel_hi:[1,0]
    v_pk_mul_f32 v[24:25], v[24:25], v[30:31] op_sel:[0,0] op_sel_hi:[1,0]
    v_pk_mul_f32 v[26:27], v[26:27], v[30:31] op_sel:[0,0] op_sel_hi:[1,0]
    v_pk_mul_f32 v[28:29], v[28:29], v[30:31] op_sel:[0,0] op_sel_hi:[1,0]
    v_cvt_pk_bf16_f32 v32, v14, v15
    v_lshlrev_b32 v14, 16, v32
    v_and_b32 v15, 0xffff0000, v32
    v_cvt_pk_bf16_f32 v32, v16, v17
    v_lshlrev_b32 v16, 16, v32
    v_and_b32 v17, 0xffff0000, v32
    v_cvt_pk_bf16_f32 v32, v18, v19
    v_lshlrev_b32 v18, 16, v32
    v_and_b32 v19, 0xffff0000, v32
    v_cvt_pk_bf16_f32 v32, v20, v21
    v_lshlrev_b32 v20, 16, v32
    v_and_b32 v21, 0xffff0000, v32
    v_cvt_pk_bf16_f32 v32, v22, v23
    v_lshlrev_b32 v22, 16, v32
    v_and_b32 v23, 0xffff0000, v32
    v_cvt_pk_bf16_f32 v32, v24, v25
    v_lshlrev_b32 v24, 16, v32
    v_and_b32 v25, 0xffff0000, v32
    v_cvt_pk_bf16_f32 v32, v26, v27
    v_lshlrev_b32 v26, 16, v32
    v_and_b32 v27, 0xffff0000, v32
    v_cvt_pk_bf16_f32 v32, v28, v29
    v_lshlrev_b32 v28, 16, v32
    v_and_b32 v29, 0xffff0000, v32
    v_pk_mul_f32 v[14:15], v[14:15], v[30:31] op_sel:[0,1] op_sel_hi:[1,1]
    v_pk_mul_f32 v[16:17], v[16:17], v[30:31] op_sel:[0,1] op_sel_hi:[1,1]
    v_pk_mul_f32 v[18:19], v[18:19], v[30:31] op_sel:[0,1] op_sel_hi:[1,1]
    v_pk_mul_f32 v[20:21], v[20:21], v[30:31] op_sel:[0,1] op_sel_hi:[1,1]
    v_pk_mul_f32 v[22:23], v[22:23], v[30:31] op_sel:[0,1] op_sel_hi:[1,1]
    v_pk_mul_f32 v[24:25], v[24:25], v[30:31] op_sel:[0,1] op_sel_hi:[1,1]
    v_pk_mul_f32 v[26:27], v[26:27], v[30:31] op_sel:[0,1] op_sel_hi:[1,1]
    v_pk_mul_f32 v[28:29], v[28:29], v[30:31] op_sel:[0,1] op_sel_hi:[1,1]
    v_exp_f32 v14, -v14
    v_exp_f32 v15, -v15
    v_exp_f32 v16, -v16
    v_exp_f32 v17, -v17
    v_exp_f32 v18, -v18
    v_exp_f32 v19, -v19
    v_exp_f32 v20, -v20
    v_exp_f32 v21, -v21
    v_exp_f32 v22, -v22
    v_exp_f32 v23, -v23
    v_exp_f32 v24, -v24
    v_exp_f32 v25, -v25
    v_exp_f32 v26, -v26
    v_exp_f32 v27, -v27
    v_exp_f32 v28, -v28
    v_exp_f32 v29, -v29
    v_cvt_pk_bf16_f32 v14, v14, v16
    v_cvt_pk_bf16_f32 v15, v15, v17
    v_cvt_pk_bf16_f32 v18, v18, v20
    v_cvt_pk_bf16_f32 v19, v19, v21
    v_cvt_pk_bf16_f32 v22, v22, v24
    v_cvt_pk_bf16_f32 v23, v23, v25
    v_cvt_pk_bf16_f32 v26, v26, v28
    v_cvt_pk_bf16_f32 v27, v27, v29
    v_dot2_f32_bf16 v112, v14, s68, 0
    v_dot2_f32_bf16 v113, v15, s68, 0
    v_dot2_f32_bf16 v114, v14, s69, 0
    v_dot2_f32_bf16 v115, v15, s69, 0
    v_dot2_f32_bf16 v116, v14, s70, 0
    v_dot2_f32_bf16 v117, v15, s70, 0
    v_dot2_f32_bf16 v118, v14, s71, 0
    v_dot2_f32_bf16 v119, v15, s71, 0
    v_dot2_f32_bf16 v120, v14, s52, 0
    v_dot2_f32_bf16 v121, v15, s52, 0
    v_dot2_f32_bf16 v122, v14, s53, 0
    v_dot2_f32_bf16 v123, v15, s53, 0
    v_dot2_f32_bf16 v124, v14, s54, 0
    v_dot2_f32_bf16 v125, v15, s54, 0
    v_dot2_f32_bf16 v126, v14, s55, 0
    v_dot2_f32_bf16 v127, v15, s55, 0
    v_dot2_f32_bf16 v112, v18, s72, v112
    v_dot2_f32_bf16 v113, v19, s72, v113
    v_dot2_f32_bf16 v114, v18, s73, v114
    v_dot2_f32_bf16 v115, v19, s73, v115
    v_dot2_f32_bf16 v116, v18, s74, v116
    v_dot2_f32_bf16 v117, v19, s74, v117
    v_dot2_f32_bf16 v118, v18, s75, v118
    v_dot2_f32_bf16 v119, v19, s75, v119
    v_dot2_f32_bf16 v120, v18, s56, v120
    v_dot2_f32_bf16 v121, v19, s56, v121
    v_dot2_f32_bf16 v122, v18, s57, v122
    v_dot2_f32_bf16 v123, v19, s57, v123
    v_dot2_f32_bf16 v124, v18, s58, v124
    v_dot2_f32_bf16 v125, v19, s58, v125
    v_dot2_f32_bf16 v126, v18, s59, v126
    v_dot2_f32_bf16 v127, v19, s59, v127
    v_dot2_f32_bf16 v112, v22, s76, v112
    v_dot2_f32_bf16 v113, v23, s76, v113
    v_dot2_f32_bf16 v114, v22, s77, v114
    v_dot2_f32_bf16 v115, v23, s77, v115
    v_dot2_f32_bf16 v116, v22, s78, v116
    v_dot2_f32_bf16 v117, v23, s78, v117
    v_dot2_f32_bf16 v118, v22, s79, v118
    v_dot2_f32_bf16 v119, v23, s79, v119
    v_dot2_f32_bf16 v120, v22, s60, v120
    v_dot2_f32_bf16 v121, v23, s60, v121
    v_dot2_f32_bf16 v122, v22, s61, v122
    v_dot2_f32_bf16 v123, v23, s61, v123
    v_dot2_f32_bf16 v124, v22, s62, v124
    v_dot2_f32_bf16 v125, v23, s62, v125
    v_dot2_f32_bf16 v126, v22, s63, v126
    v_dot2_f32_bf16 v127, v23, s63, v127
    v_dot2_f32_bf16 v112, v26, s80, v112
    v_dot2_f32_bf16 v113, v27, s80, v113
    v_dot2_f32_bf16 v114, v26, s81, v114
    v_dot2_f32_bf16 v115, v27, s81, v115
    v_dot2_f32_bf16 v116, v26, s82, v116
    v_dot2_f32_bf16 v117, v27, s82, v117
    v_dot2_f32_bf16 v118, v26, s83, v118
    v_dot2_f32_bf16 v119, v27, s83, v119
    v_dot2_f32_bf16 v120, v26, s64, v120
    v_dot2_f32_bf16 v121, v27, s64, v121
    v_dot2_f32_bf16 v122, v26, s65, v122
    v_dot2_f32_bf16 v123, v27, s65, v123
    v_dot2_f32_bf16 v124, v26, s66, v124
    v_dot2_f32_bf16 v125, v27, s66, v125
    v_dot2_f32_bf16 v126, v26, s67, v126
    v_dot2_f32_bf16 v127, v27, s67, v127
L_p2_kernel_g1_27:
    s_lshl2_add_u32 s14, s3, s49
    s_mul_i32 s26, s14, 20000
    s_mov_b32 s10, 5120000
    buffer_load_dwordx4 v[64:67], v1, s[8:11], s26 offen
    buffer_load_dwordx4 v[68:71], v2, s[8:11], s26 offen
    s_branch L_p2_fin
L_p2_done:
    s_branch L_p2_end
L_p2_slow:
    s_barrier
    v_mov_b32 v8, 0
    v_mov_b32 v9, 0
    v_mov_b32 v10, 0
    v_mov_b32 v11, 0
    v_mov_b32 v12, v1
    ds_write_b128 v12, v[8:11]
    v_add_u32 v12, 16384, v12
    ds_write_b128 v12, v[8:11]
    v_add_u32 v12, 16384, v12
    ds_write_b128 v12, v[8:11]
    v_add_u32 v12, 16384, v12
    ds_write_b128 v12, v[8:11]
    v_add_u32 v12, 16384, v12
    ds_write_b128 v12, v[8:11]
    v_add_u32 v12, 16384, v12
    ds_write_b128 v12, v[8:11]
    v_add_u32 v12, 16384, v12
    ds_write_b128 v12, v[8:11]
    v_add_u32 v12, 16384, v12
    ds_write_b128 v12, v[8:11]
    v_add_u32 v12, 16384, v12
    ds_write_b128 v12, v[8:11]
    v_add_u32 v12, 16384, v12
    ds_write_b128 v12, v[8:11]
    v_add_u32 v12, 16384, v12
    v_mul_u32_u24 v13, 8320, v0
    v_mov_b32 v29, 0x7fc00000
    v_add_u32 v28, 32, v13
    v_lshlrev_b32 v14, 10, v0
    v_add_u32 v14, 9437184, v14
    s_mul_i32 s25, s12, 65
    s_add_u32 s25, s25, s3
    s_lshl_b32 s25, s25, 5
    s_add_u32 s25, s25, 0
    s_lshl_b32 s50, s50, 1
    s_mul_i32 s22, s12, 1280000
    s_mov_b32 s24, 0
    s_waitcnt lgkmcnt(0)
    s_barrier
L_p2_sstep:
    buffer_load_ushort v15, v13, s[4:7], s25 offen
    buffer_load_ushort v16, v28, s[4:7], s25 offen
    s_waitcnt vmcnt(0)
L_p2_srec:
    v_cmp_lt_u32 vcc, v15, v16
    s_nop 1
    s_and_b64 exec, exec, vcc
    s_cbranch_execz L_p2_sdone
    v_mul_u32_u24 v17, 43691, v15
    v_lshrrev_b32 v17, 17, v17
    v_mad_i32_i24 v18, v17, -3, v15
    v_lshrrev_b32 v19, 6, v17
    v_lshl_add_u32 v19, v19, 20, v14
    v_and_b32 v17, 63, v17
    v_lshl_add_u32 v17, v17, 4, v19
    v_lshl_add_u32 v19, v18, 2, v17
    buffer_load_dword v20, v19, s[4:7], 0 offen
    buffer_load_dword v21, v17, s[4:7], 0 offen offset:12
    v_add_u32 v15, 1, v15
    v_mad_u32_u24 v18, v18, 10, 2
    s_waitcnt vmcnt(0)
    v_lshlrev_b32_sdwa v19, 3, v20 dst_sel:DWORD dst_unused:UNUSED_PAD src0_sel:DWORD src1_sel:WORD_0
    buffer_load_dwordx2 v[22:23], v19, s[8:11], s22 offen
    v_mad_u32_u16 v20, v20, 16, s50 op_sel:[1,0,0,0]
    v_bfe_i32 v21, v21, v18, 10
    v_cmp_eq_i32 vcc, -512, v21
    v_cvt_f32_i32 v21, v21
    v_mul_f32 v21, 989872160, v21
    v_cndmask_b32 v21, v21, v29, vcc
    s_waitcnt vmcnt(0)
    v_lshlrev_b32 v24, 16, v22
    v_and_b32 v25, 0xffff0000, v22
    v_lshlrev_b32 v26, 16, v23
    v_and_b32 v27, 0xffff0000, v23
    v_mul_f32 v24, v21, v24
    v_mul_f32 v25, v21, v25
    v_mul_f32 v26, v21, v26
    v_mul_f32 v27, v21, v27
    ds_add_f32 v20, v24
    ds_add_f32 v20, v25 offset:4
    ds_add_f32 v20, v26 offset:8
    ds_add_f32 v20, v27 offset:12
    s_branch L_p2_srec
L_p2_sdone:
    s_mov_b64 exec, -1
    s_add_u32 s25, s25, 2
    s_add_u32 s22, s22, 80000
    s_add_u32 s24, s24, 1
    s_cmp_lt_u32 s24, 16
    s_cbranch_scc1 L_p2_sstep
    s_waitcnt lgkmcnt(0)
    s_barrier
    s_mul_i32 s14, s12, 10240000
    s_mul_i32 s15, s3, 160000
    s_add_u32 s26, s14, s15
    s_add_u32 s26, s26, 249069568
    v_mov_b32 v12, v1
    s_mov_b32 s24, 0
L_p2_sout:
    v_cmp_gt_u32 vcc, 160000, v12
    ds_read_b128 v[8:11], v12
    s_nop 0
    s_and_b64 exec, exec, vcc
    s_cbranch_execz L_p2_sfin
    s_waitcnt lgkmcnt(0)
    buffer_store_dwordx4 v[8:11], v12, s[4:7], s26 offen sc1
    s_waitcnt vmcnt(0)
    v_add_u32 v12, 16384, v12
    s_branch L_p2_sout
L_p2_sfin:
    s_mov_b64 exec, -1
    s_waitcnt vmcnt(0) lgkmcnt(0)
    s_barrier
    s_branch L_p2_signal
L_p2_end:
    s_endpgm
.section .rodata,"a"
.p2align 6
.amdhsa_kernel p1_kernel
  .amdhsa_next_free_vgpr 128
  .amdhsa_next_free_sgpr 96
  .amdhsa_accum_offset 128
  .amdhsa_group_segment_fixed_size 0
  .amdhsa_kernarg_size 112
  .amdhsa_user_sgpr_count 2
  .amdhsa_user_sgpr_kernarg_segment_ptr 1
  .amdhsa_system_sgpr_workgroup_id_x 1
  .amdhsa_float_denorm_mode_32 0
.end_amdhsa_kernel
.p2align 6
.amdhsa_kernel p2_kernel
  .amdhsa_next_free_vgpr 128
  .amdhsa_next_free_sgpr 102
  .amdhsa_accum_offset 128
  .amdhsa_group_segment_fixed_size 0
  .amdhsa_kernarg_size 112
  .amdhsa_user_sgpr_count 2
  .amdhsa_user_sgpr_kernarg_segment_ptr 1
  .amdhsa_system_sgpr_workgroup_id_x 1
  .amdhsa_float_denorm_mode_32 0
.end_amdhsa_kernel
```

```asm
; @launch kernel=p1_kernel grid=(256,1,1) block=(1024,1,1) lds=163840
; @launch kernel=p2_kernel grid=(256,1,1) block=(1024,1,1) lds=163840
.amdgcn_target "amdgcn-amd-amdhsa--gfx950"
.text
.globl p1_kernel
.p2align 8
.type p1_kernel,@function
p1_kernel:
    s_cmp_ge_u32 s2, 256
    s_cbranch_scc1 L_p1_end
    s_load_dwordx2 s[4:5], s[0:1], 104
    s_load_dwordx2 s[8:9], s[0:1], 8
    s_load_dwordx2 s[12:13], s[0:1], 16
    s_load_dwordx2 s[16:17], s[0:1], 32
    s_load_dwordx2 s[28:29], s[0:1], 0
    s_load_dwordx2 s[6:7], s[0:1], 48
    v_cmp_gt_u32 vcc, 256, v0
    s_nop 1
    s_cbranch_vccz L_p1_nopf
    s_getpc_b64 s[72:73]
L_p1_kernel_pc_1:
    s_add_u32 s72, s72, L_p1_nopf-L_p1_kernel_pc_1
    s_addc_u32 s73, s73, 0
    v_lshlrev_b32 v14, 7, v0
    v_min_u32 v14, L_p2_end-L_p1_nopf, v14
    global_load_dword v15, v14, s[72:73]
L_p1_nopf:
    v_lshlrev_b32 v1, 4, v0
    v_lshlrev_b32 v2, 3, v0
    v_lshrrev_b32 v6, 6, v0
    v_mul_u32_u24 v3, 851904, v6
    v_add_lshl_u32 v3, v3, v0, 4
    v_mov_b32 v4, 1
    v_mov_b32 v5, 0
    v_readfirstlane_b32 s39, v6
    v_cmp_gt_u32 vcc, 784, v0
    s_and_b32 s51, s2, 7
    s_lshl_b32 s51, s51, 0
    s_bfe_u32 s35, s2, 3
    s_add_u32 s51, s51, s35
    s_and_b32 s35, s2, 248
    s_add_u32 s51, s51, s35
    s_and_b32 s32, s2, 7
    s_lshl_b32 s32, s32, 2
    s_bfe_u32 s35, s2, 131075
    s_add_u32 s32, s32, s35
    s_and_b32 s35, s2, 224
    s_add_u32 s32, s32, s35
    s_lshr_b32 s35, s39, 4
    s_mul_i32 s36, s35, 4177920
    s_lshl_b32 s33, s51, 14
    s_add_u32 s33, s33, s36
    s_lshr_b32 s34, s33, 1
    s_mul_i32 s48, s51, 3840
    s_cmp_ge_u32 s35, 0
    s_cselect_b32 s48, s48, 0
    s_lshr_b32 s49, s48, 1
    s_mov_b64 s[44:45], vcc
    s_waitcnt lgkmcnt(0)
    s_load_dword s3, s[6:7], 0
    s_mov_b32 s10, 163840000
    s_mov_b32 s11, 0x00020000
    s_mov_b32 s14, 163840000
    s_mov_b32 s15, 0x00020000
    s_mov_b32 s18, 81920000
    s_mov_b32 s19, 0x00020000
    s_mul_i32 s36, s2, 20000
    s_add_u32 s30, s36, 20000
    s_mov_b32 s31, 0x00020000
    s_add_u32 s35, s36, 16384
    buffer_load_dwordx4 v[48:51], v1, s[28:31], s36 offen
    buffer_load_dwordx4 v[52:55], v1, s[28:31], s35 offen
    s_add_u32 s35, s33, 0
    buffer_load_dwordx4 v[16:19], v1, s[8:11], s35 offen nt
    s_add_u32 s35, s33, 0
    buffer_load_dwordx4 v[20:23], v1, s[12:15], s35 offen nt
    s_add_u32 s35, s33, 4194304
    buffer_load_dwordx4 v[24:27], v1, s[8:11], s35 offen nt
    s_add_u32 s35, s33, 4194304
    buffer_load_dwordx4 v[28:31], v1, s[12:15], s35 offen nt
    s_add_u32 s35, s33, 8388608
    buffer_load_dwordx4 v[32:35], v1, s[8:11], s35 offen nt
    s_add_u32 s35, s33, 8388608
    buffer_load_dwordx4 v[36:39], v1, s[12:15], s35 offen nt
    s_add_u32 s35, s33, 12582912
    buffer_load_dwordx4 v[40:43], v1, s[8:11], s35 offen nt
    s_add_u32 s35, s33, 12582912
    buffer_load_dwordx4 v[44:47], v1, s[12:15], s35 offen nt
    s_add_u32 s35, s33, 16777216
    buffer_load_dwordx4 v[72:75], v1, s[8:11], s35 offen nt
    s_add_u32 s35, s33, 16777216
    buffer_load_dwordx4 v[76:79], v1, s[12:15], s35 offen nt
    s_mov_b32 s20, s4
    s_mov_b32 s21, s5
    s_mov_b32 s22, 0
    s_mov_b32 s23, 0x00020000
    s_add_u32 s24, s4, 0
    s_addc_u32 s25, s5, 0
    s_mov_b32 s26, 8540160
    s_mov_b32 s27, 0x00020000
    s_mov_b32 s37, 1492179184
    s_mov_b32 s55, 0
    s_mov_b32 s50, 21845
    s_mov_b32 s38, 262400
    s_mov_b32 s43, 0x05040100
    s_mov_b32 s40, 0
    v_mov_b32 v8, 0
    v_mov_b32 v9, 0
    v_mov_b32 v10, 0
    v_mov_b32 v11, 0
    ds_write_b128 v1, v[8:11] offset:0
    s_waitcnt lgkmcnt(0)
    s_lshl_b32 s3, s3, 16
    v_mov_b32 v12, s3
    v_mul_f32 v12, 0.15915494, v12
    s_nop 0
    v_readfirstlane_b32 s41, v12
    s_waitcnt vmcnt(10)
    v_mov_b32 v12, 0x3f803f80
    v_and_b32 v48, 0x7fff7fff, v48
    v_and_b32 v49, 0x7fff7fff, v49
    v_and_b32 v50, 0x7fff7fff, v50
    v_and_b32 v51, 0x7fff7fff, v51
    v_and_b32 v52, 0x7fff7fff, v52
    v_and_b32 v53, 0x7fff7fff, v53
    v_and_b32 v54, 0x7fff7fff, v54
    v_and_b32 v55, 0x7fff7fff, v55
    v_pk_max_u16 v8, v8, v48
    v_dot2c_f32_bf16 v9, v48, v12
    v_pk_max_u16 v8, v8, v49
    v_dot2c_f32_bf16 v9, v49, v12
    v_pk_max_u16 v8, v8, v50
    v_dot2c_f32_bf16 v9, v50, v12
    v_pk_max_u16 v8, v8, v51
    v_dot2c_f32_bf16 v9, v51, v12
    v_pk_max_u16 v8, v8, v52
    v_dot2c_f32_bf16 v9, v52, v12
    v_pk_max_u16 v8, v8, v53
    v_dot2c_f32_bf16 v9, v53, v12
    v_pk_max_u16 v8, v8, v54
    v_dot2c_f32_bf16 v9, v54, v12
    v_pk_max_u16 v8, v8, v55
    v_dot2c_f32_bf16 v9, v55, v12
    v_lshrrev_b32 v10, 16, v8
    v_and_b32 v8, 0xffff, v8
    v_max_u32 v8, v8, v10
    s_nop 0
    s_nop 1
    v_max_u32_dpp v8, v8, v8 row_shr:1 row_mask:0xf bank_mask:0xf bound_ctrl:0
    s_nop 1
    v_max_u32_dpp v8, v8, v8 row_shr:2 row_mask:0xf bank_mask:0xf bound_ctrl:0
    s_nop 1
    v_max_u32_dpp v8, v8, v8 row_shr:4 row_mask:0xf bank_mask:0xf bound_ctrl:0
    s_nop 1
    v_max_u32_dpp v8, v8, v8 row_shr:8 row_mask:0xf bank_mask:0xf bound_ctrl:0
    s_nop 1
    v_max_u32_dpp v8, v8, v8 row_bcast:15 row_mask:0xa bank_mask:0xf
    s_nop 1
    v_max_u32_dpp v8, v8, v8 row_bcast:31 row_mask:0xc bank_mask:0xf
    s_nop 1
    v_add_f32_dpp v9, v9, v9 row_shr:1 row_mask:0xf bank_mask:0xf bound_ctrl:0
    s_nop 1
    v_add_f32_dpp v9, v9, v9 row_shr:2 row_mask:0xf bank_mask:0xf bound_ctrl:0
    s_nop 1
    v_add_f32_dpp v9, v9, v9 row_shr:4 row_mask:0xf bank_mask:0xf bound_ctrl:0
    s_nop 1
    v_add_f32_dpp v9, v9, v9 row_shr:8 row_mask:0xf bank_mask:0xf bound_ctrl:0
    s_nop 1
    v_add_f32_dpp v9, v9, v9 row_bcast:15 row_mask:0xa bank_mask:0xf
    s_nop 1
    v_add_f32_dpp v9, v9, v9 row_bcast:31 row_mask:0xc bank_mask:0xf
    s_lshl_b32 s35, s39, 4
    s_add_u32 s35, s35, 160320
    v_mov_b32 v10, s35
    s_mov_b32 exec_lo, 0
    s_brev_b32 exec_hi, 1
    ds_write_b64 v10, v[8:9]
    s_mov_b64 exec, -1
    s_waitcnt lgkmcnt(0)
    s_barrier
    s_branch L_p1_first
L_p1_loop:
    s_getreg_b32 s51, hwreg(HW_REG_XCC_ID, 0, 1)
    s_cmp_eq_u32 s51, 0
    s_cselect_b64 vcc, -1, 0
    s_waitcnt lgkmcnt(13)
    v_lshlrev_b32 v15, 22, v100
    v_lshrrev_b32 v100, 16, v100
    v_alignbit_b32 v15, v100, v15, 10
    v_alignbit_b32 v15, v101, v15, 10
    v_xor_b32 v15, 0x80200800, v15
    s_cmp_lg_u32 s39, 15
    s_cbranch_scc1 L_p1_kernel_nox_2
    s_mov_b32 s36, 13631488
    buffer_store_dwordx4 v[12:15], v3, s[20:23], s36 offen sc1
L_p1_kernel_nox_2:
    s_waitcnt lgkmcnt(12)
    v_lshlrev_b32 v75, 22, v102
    v_lshrrev_b32 v102, 16, v102
    v_alignbit_b32 v75, v102, v75, 10
    v_alignbit_b32 v75, v103, v75, 10
    v_xor_b32 v75, 0x80200800, v75
    s_mov_b32 s36, 0
    buffer_store_dwordx4 v[72:75], v3, s[20:23], s36 offen sc1
    s_waitcnt lgkmcnt(11)
    v_lshlrev_b32 v79, 22, v104
    v_lshrrev_b32 v104, 16, v104
    v_alignbit_b32 v79, v104, v79, 10
    v_alignbit_b32 v79, v105, v79, 10
    v_xor_b32 v79, 0x80200800, v79
    s_mov_b32 s36, 1048576
    buffer_store_dwordx4 v[76:79], v3, s[20:23], s36 offen sc1
    s_waitcnt lgkmcnt(10)
    v_lshlrev_b32 v51, 22, v106
    v_lshrrev_b32 v106, 16, v106
    v_alignbit_b32 v51, v106, v51, 10
    v_alignbit_b32 v51, v107, v51, 10
    v_xor_b32 v51, 0x80200800, v51
    s_mov_b32 s36, 2097152
    buffer_store_dwordx4 v[48:51], v3, s[20:23], s36 offen sc1
    s_add_u32 s35, s33, 16777216
    buffer_load_dwordx4 v[72:75], v1, s[8:11], s35 offen nt
    s_add_u32 s35, s33, 16777216
    buffer_load_dwordx4 v[76:79], v1, s[12:15], s35 offen nt
    s_cbranch_vccz L_p1_kernel_thr_3
    s_waitcnt vmcnt(2)
L_p1_kernel_thr_3:
    s_waitcnt lgkmcnt(9)
    v_lshlrev_b32 v83, 22, v108
    v_lshrrev_b32 v108, 16, v108
    v_alignbit_b32 v83, v108, v83, 10
    v_alignbit_b32 v83, v109, v83, 10
    v_xor_b32 v83, 0x80200800, v83
    s_mov_b32 s36, 3145728
    buffer_store_dwordx4 v[80:83], v3, s[20:23], s36 offen sc1
    s_waitcnt lgkmcnt(8)
    v_lshlrev_b32 v55, 22, v110
    v_lshrrev_b32 v110, 16, v110
    v_alignbit_b32 v55, v110, v55, 10
    v_alignbit_b32 v55, v111, v55, 10
    v_xor_b32 v55, 0x80200800, v55
    s_mov_b32 s36, 4194304
    buffer_store_dwordx4 v[52:55], v3, s[20:23], s36 offen sc1
    s_add_u32 s35, s33, 20971520
    buffer_load_dwordx4 v[80:83], v1, s[8:11], s35 offen nt
    s_add_u32 s35, s33, 20971520
    buffer_load_dwordx4 v[100:103], v1, s[12:15], s35 offen nt
    s_cbranch_vccz L_p1_kernel_thr_4
    s_waitcnt vmcnt(2)
L_p1_kernel_thr_4:
    s_waitcnt lgkmcnt(7)
    v_lshlrev_b32 v87, 22, v112
    v_lshrrev_b32 v112, 16, v112
    v_alignbit_b32 v87, v112, v87, 10
    v_alignbit_b32 v87, v113, v87, 10
    v_xor_b32 v87, 0x80200800, v87
    s_mov_b32 s36, 5242880
    buffer_store_dwordx4 v[84:87], v3, s[20:23], s36 offen sc1
    s_waitcnt lgkmcnt(6)
    v_lshlrev_b32 v59, 22, v114
    v_lshrrev_b32 v114, 16, v114
    v_alignbit_b32 v59, v114, v59, 10
    v_alignbit_b32 v59, v115, v59, 10
    v_xor_b32 v59, 0x80200800, v59
    s_mov_b32 s36, 6291456
    buffer_store_dwordx4 v[56:59], v3, s[20:23], s36 offen sc1
    s_add_u32 s35, s33, 25165824
    buffer_load_dwordx4 v[84:87], v1, s[8:11], s35 offen nt
    s_add_u32 s35, s33, 25165824
    buffer_load_dwordx4 v[104:107], v1, s[12:15], s35 offen nt
    s_cbranch_vccz L_p1_kernel_thr_5
    s_waitcnt vmcnt(2)
L_p1_kernel_thr_5:
    s_waitcnt lgkmcnt(5)
    v_lshlrev_b32 v91, 22, v116
    v_lshrrev_b32 v116, 16, v116
    v_alignbit_b32 v91, v116, v91, 10
    v_alignbit_b32 v91, v117, v91, 10
    v_xor_b32 v91, 0x80200800, v91
    s_mov_b32 s36, 7340032
    buffer_store_dwordx4 v[88:91], v3, s[20:23], s36 offen sc1
    s_waitcnt lgkmcnt(4)
    v_lshlrev_b32 v63, 22, v118
    v_lshrrev_b32 v118, 16, v118
    v_alignbit_b32 v63, v118, v63, 10
    v_alignbit_b32 v63, v119, v63, 10
    v_xor_b32 v63, 0x80200800, v63
    s_mov_b32 s36, 8388608
    buffer_store_dwordx4 v[60:63], v3, s[20:23], s36 offen sc1
    s_add_u32 s35, s33, 29360128
    buffer_load_dwordx4 v[88:91], v1, s[8:11], s35 offen nt
    s_add_u32 s35, s33, 29360128
    buffer_load_dwordx4 v[108:111], v1, s[12:15], s35 offen nt
    s_cbranch_vccz L_p1_kernel_thr_6
    s_waitcnt vmcnt(2)
L_p1_kernel_thr_6:
    s_waitcnt lgkmcnt(3)
    v_lshlrev_b32 v95, 22, v120
    v_lshrrev_b32 v120, 16, v120
    v_alignbit_b32 v95, v120, v95, 10
    v_alignbit_b32 v95, v121, v95, 10
    v_xor_b32 v95, 0x80200800, v95
    s_mov_b32 s36, 9437184
    buffer_store_dwordx4 v[92:95], v3, s[20:23], s36 offen sc1
    s_waitcnt lgkmcnt(2)
    v_lshlrev_b32 v67, 22, v122
    v_lshrrev_b32 v122, 16, v122
    v_alignbit_b32 v67, v122, v67, 10
    v_alignbit_b32 v67, v123, v67, 10
    v_xor_b32 v67, 0x80200800, v67
    s_mov_b32 s36, 10485760
    buffer_store_dwordx4 v[64:67], v3, s[20:23], s36 offen sc1
    s_add_u32 s35, s33, 33554432
    buffer_load_dwordx4 v[92:95], v1, s[8:11], s35 offen nt
    s_add_u32 s35, s33, 33554432
    buffer_load_dwordx4 v[112:115], v1, s[12:15], s35 offen nt
    s_cbranch_vccz L_p1_kernel_thr_7
    s_waitcnt vmcnt(2)
L_p1_kernel_thr_7:
    s_waitcnt lgkmcnt(1)
    v_lshlrev_b32 v99, 22, v124
    v_lshrrev_b32 v124, 16, v124
    v_alignbit_b32 v99, v124, v99, 10
    v_alignbit_b32 v99, v125, v99, 10
    v_xor_b32 v99, 0x80200800, v99
    s_mov_b32 s36, 11534336
    buffer_store_dwordx4 v[96:99], v3, s[20:23], s36 offen sc1
    s_waitcnt lgkmcnt(0)
    v_lshlrev_b32 v71, 22, v126
    v_lshrrev_b32 v126, 16, v126
    v_alignbit_b32 v71, v126, v71, 10
    v_alignbit_b32 v71, v127, v71, 10
    v_xor_b32 v71, 0x80200800, v71
    s_mov_b32 s36, 12582912
    buffer_store_dwordx4 v[68:71], v3, s[20:23], s36 offen sc1
    s_add_u32 s35, s33, 37748736
    s_sub_u32 s35, s35, s48
    v_cndmask_b32 v96, 2.0, v1, s[44:45]
    buffer_load_dwordx4 v[96:99], v96, s[8:11], s35 offen nt
    s_add_u32 s35, s33, 37748736
    s_sub_u32 s35, s35, s48
    v_cndmask_b32 v116, 2.0, v1, s[44:45]
    buffer_load_dwordx4 v[116:119], v116, s[12:15], s35 offen nt
    s_cbranch_vccz L_p1_kernel_thr_8
    s_waitcnt vmcnt(2)
L_p1_kernel_thr_8:
    s_branch L_p1_join
L_p1_first:
    s_add_u32 s35, s33, 20971520
    buffer_load_dwordx4 v[80:83], v1, s[8:11], s35 offen nt
    s_add_u32 s35, s33, 20971520
    buffer_load_dwordx4 v[100:103], v1, s[12:15], s35 offen nt
    s_add_u32 s35, s33, 25165824
    buffer_load_dwordx4 v[84:87], v1, s[8:11], s35 offen nt
    s_add_u32 s35, s33, 25165824
    buffer_load_dwordx4 v[104:107], v1, s[12:15], s35 offen nt
    s_add_u32 s35, s33, 29360128
    buffer_load_dwordx4 v[88:91], v1, s[8:11], s35 offen nt
    s_add_u32 s35, s33, 29360128
    buffer_load_dwordx4 v[108:111], v1, s[12:15], s35 offen nt
    s_add_u32 s35, s33, 33554432
    buffer_load_dwordx4 v[92:95], v1, s[8:11], s35 offen nt
    s_add_u32 s35, s33, 33554432
    buffer_load_dwordx4 v[112:115], v1, s[12:15], s35 offen nt
    s_add_u32 s35, s33, 37748736
    s_sub_u32 s35, s35, s48
    v_cndmask_b32 v96, 2.0, v1, s[44:45]
    buffer_load_dwordx4 v[96:99], v96, s[8:11], s35 offen nt
    s_add_u32 s35, s33, 37748736
    s_sub_u32 s35, s35, s48
    v_cndmask_b32 v116, 2.0, v1, s[44:45]
    buffer_load_dwordx4 v[116:119], v116, s[12:15], s35 offen nt
L_p1_join:
    s_waitcnt vmcnt(18)
    v_perm_b32 v6, v20, v16, s43
    v_perm_b32 v7, v21, v17, s43
    v_perm_b32 v8, v22, v18, s43
    v_perm_b32 v9, v23, v19, s43
    v_mul_hi_u32_u24 v16, 429497, v16
    v_mul_hi_u32_u24 v20, 429497, v20
    v_mul_hi_u32_u24 v17, 429497, v17
    v_mul_hi_u32_u24 v21, 429497, v21
    v_mul_hi_u32_u24 v18, 429497, v18
    v_mul_hi_u32_u24 v22, 429497, v22
    v_mul_hi_u32_u24 v19, 429497, v19
    v_mul_hi_u32_u24 v23, 429497, v23
    v_lshl_or_b32 v16, v20, 16, v16
    v_lshl_or_b32 v17, v21, 16, v17
    v_lshl_or_b32 v18, v22, 16, v18
    v_lshl_or_b32 v19, v23, 16, v19
    v_dot2_u32_u16 v20, v16, s38, 0
    v_dot2_u32_u16 v21, v17, s38, 0
    v_dot2_u32_u16 v22, v18, s38, 0
    v_dot2_u32_u16 v23, v19, s38, 0
    v_pk_mad_u16 v6, v16, s37, v6
    v_pk_mad_u16 v7, v17, s37, v7
    v_pk_mad_u16 v8, v18, s37, v8
    v_pk_mad_u16 v9, v19, s37, v9
    ds_add_u32 v20, v4 offset:0
    ds_add_u32 v21, v4 offset:0
    ds_add_u32 v22, v4 offset:0
    ds_add_u32 v23, v4 offset:0
    v_perm_b32 v55, v23, v22, s43
    v_perm_b32 v51, v21, v20, s43
    v_or_b32 v48, 0x40000000, v6
    v_or_b32 v49, 0x40000000, v7
    v_or_b32 v50, 0x40000000, v8
    v_or_b32 v52, 0x40000000, v9
    s_waitcnt vmcnt(16)
    v_perm_b32 v6, v28, v24, s43
    v_perm_b32 v7, v29, v25, s43
    v_perm_b32 v8, v30, v26, s43
    v_perm_b32 v9, v31, v27, s43
    v_mul_hi_u32_u24 v24, 429497, v24
    v_mul_hi_u32_u24 v28, 429497, v28
    v_mul_hi_u32_u24 v25, 429497, v25
    v_mul_hi_u32_u24 v29, 429497, v29
    v_mul_hi_u32_u24 v26, 429497, v26
    v_mul_hi_u32_u24 v30, 429497, v30
    v_mul_hi_u32_u24 v27, 429497, v27
    v_mul_hi_u32_u24 v31, 429497, v31
    v_lshl_or_b32 v24, v28, 16, v24
    v_lshl_or_b32 v25, v29, 16, v25
    v_lshl_or_b32 v26, v30, 16, v26
    v_lshl_or_b32 v27, v31, 16, v27
    v_dot2_u32_u16 v28, v24, s38, 0
    v_dot2_u32_u16 v29, v25, s38, 0
    v_dot2_u32_u16 v30, v26, s38, 0
    v_dot2_u32_u16 v31, v27, s38, 0
    v_pk_mad_u16 v6, v24, s37, v6
    v_pk_mad_u16 v7, v25, s37, v7
    v_pk_mad_u16 v8, v26, s37, v8
    v_pk_mad_u16 v9, v27, s37, v9
    ds_add_u32 v28, v4 offset:0
    ds_add_u32 v29, v4 offset:0
    ds_add_u32 v30, v4 offset:0
    ds_add_u32 v31, v4 offset:0
    v_perm_b32 v63, v31, v30, s43
    v_perm_b32 v59, v29, v28, s43
    v_or_b32 v53, 0x40000000, v6
    v_or_b32 v54, 0x40000000, v7
    v_or_b32 v56, 0x40000000, v8
    v_or_b32 v57, 0x40000000, v9
    s_waitcnt vmcnt(14)
    v_perm_b32 v6, v36, v32, s43
    v_perm_b32 v7, v37, v33, s43
    v_perm_b32 v8, v38, v34, s43
    v_perm_b32 v9, v39, v35, s43
    v_mul_hi_u32_u24 v32, 429497, v32
    v_mul_hi_u32_u24 v36, 429497, v36
    v_mul_hi_u32_u24 v33, 429497, v33
    v_mul_hi_u32_u24 v37, 429497, v37
    v_mul_hi_u32_u24 v34, 429497, v34
    v_mul_hi_u32_u24 v38, 429497, v38
    v_mul_hi_u32_u24 v35, 429497, v35
    v_mul_hi_u32_u24 v39, 429497, v39
    v_lshl_or_b32 v32, v36, 16, v32
    v_lshl_or_b32 v33, v37, 16, v33
    v_lshl_or_b32 v34, v38, 16, v34
    v_lshl_or_b32 v35, v39, 16, v35
    v_dot2_u32_u16 v36, v32, s38, 0
    v_dot2_u32_u16 v37, v33, s38, 0
    v_dot2_u32_u16 v38, v34, s38, 0
    v_dot2_u32_u16 v39, v35, s38, 0
    v_pk_mad_u16 v6, v32, s37, v6
    v_pk_mad_u16 v7, v33, s37, v7
    v_pk_mad_u16 v8, v34, s37, v8
    v_pk_mad_u16 v9, v35, s37, v9
    ds_add_u32 v36, v4 offset:0
    ds_add_u32 v37, v4 offset:0
    ds_add_u32 v38, v4 offset:0
    ds_add_u32 v39, v4 offset:0
    v_perm_b32 v71, v39, v38, s43
    v_perm_b32 v67, v37, v36, s43
    v_or_b32 v58, 0x40000000, v6
    v_or_b32 v60, 0x40000000, v7
    v_or_b32 v61, 0x40000000, v8
    v_or_b32 v62, 0x40000000, v9
    s_waitcnt vmcnt(12)
    v_perm_b32 v6, v44, v40, s43
    v_perm_b32 v7, v45, v41, s43
    v_perm_b32 v8, v46, v42, s43
    v_perm_b32 v9, v47, v43, s43
    v_mul_hi_u32_u24 v40, 429497, v40
    v_mul_hi_u32_u24 v44, 429497, v44
    v_mul_hi_u32_u24 v41, 429497, v41
    v_mul_hi_u32_u24 v45, 429497, v45
    v_mul_hi_u32_u24 v42, 429497, v42
    v_mul_hi_u32_u24 v46, 429497, v46
    v_mul_hi_u32_u24 v43, 429497, v43
    v_mul_hi_u32_u24 v47, 429497, v47
    v_lshl_or_b32 v40, v44, 16, v40
    v_lshl_or_b32 v41, v45, 16, v41
    v_lshl_or_b32 v42, v46, 16, v42
    v_lshl_or_b32 v43, v47, 16, v43
    v_dot2_u32_u16 v44, v40, s38, 0
    v_dot2_u32_u16 v45, v41, s38, 0
    v_dot2_u32_u16 v46, v42, s38, 0
    v_dot2_u32_u16 v47, v43, s38, 0
    v_pk_mad_u16 v6, v40, s37, v6
    v_pk_mad_u16 v7, v41, s37, v7
    v_pk_mad_u16 v8, v42, s37, v8
    v_pk_mad_u16 v9, v43, s37, v9
    ds_add_u32 v44, v4 offset:0
    ds_add_u32 v45, v4 offset:0
    ds_add_u32 v46, v4 offset:0
    ds_add_u32 v47, v4 offset:0
    v_perm_b32 v121, v47, v46, s43
    v_perm_b32 v120, v45, v44, s43
    v_or_b32 v64, 0x40000000, v6
    v_or_b32 v65, 0x40000000, v7
    v_or_b32 v66, 0x40000000, v8
    v_or_b32 v68, 0x40000000, v9
    s_waitcnt vmcnt(10)
    v_perm_b32 v6, v76, v72, s43
    v_perm_b32 v7, v77, v73, s43
    v_perm_b32 v8, v78, v74, s43
    v_perm_b32 v9, v79, v75, s43
    v_mul_hi_u32_u24 v72, 429497, v72
    v_mul_hi_u32_u24 v76, 429497, v76
    v_mul_hi_u32_u24 v73, 429497, v73
    v_mul_hi_u32_u24 v77, 429497, v77
    v_mul_hi_u32_u24 v74, 429497, v74
    v_mul_hi_u32_u24 v78, 429497, v78
    v_mul_hi_u32_u24 v75, 429497, v75
    v_mul_hi_u32_u24 v79, 429497, v79
    v_lshl_or_b32 v72, v76, 16, v72
    v_lshl_or_b32 v73, v77, 16, v73
    v_lshl_or_b32 v74, v78, 16, v74
    v_lshl_or_b32 v75, v79, 16, v75
    v_dot2_u32_u16 v76, v72, s38, 0
    v_dot2_u32_u16 v77, v73, s38, 0
    v_dot2_u32_u16 v78, v74, s38, 0
    v_dot2_u32_u16 v79, v75, s38, 0
    v_pk_mad_u16 v6, v72, s37, v6
    v_pk_mad_u16 v7, v73, s37, v7
    v_pk_mad_u16 v8, v74, s37, v8
    v_pk_mad_u16 v9, v75, s37, v9
    ds_add_u32 v76, v4 offset:0
    ds_add_u32 v77, v4 offset:0
    ds_add_u32 v78, v4 offset:0
    ds_add_u32 v79, v4 offset:0
    v_perm_b32 v123, v79, v78, s43
    v_perm_b32 v122, v77, v76, s43
    v_or_b32 v69, 0x40000000, v6
    v_or_b32 v70, 0x40000000, v7
    v_or_b32 v127, 0x40000000, v8
    v_or_b32 v72, 0x40000000, v9
    s_waitcnt vmcnt(8)
    v_perm_b32 v6, v100, v80, s43
    v_perm_b32 v7, v101, v81, s43
    v_perm_b32 v8, v102, v82, s43
    v_perm_b32 v9, v103, v83, s43
    v_mul_hi_u32_u24 v80, 429497, v80
    v_mul_hi_u32_u24 v100, 429497, v100
    v_mul_hi_u32_u24 v81, 429497, v81
    v_mul_hi_u32_u24 v101, 429497, v101
    v_mul_hi_u32_u24 v82, 429497, v82
    v_mul_hi_u32_u24 v102, 429497, v102
    v_mul_hi_u32_u24 v83, 429497, v83
    v_mul_hi_u32_u24 v103, 429497, v103
    v_lshl_or_b32 v80, v100, 16, v80
    v_lshl_or_b32 v81, v101, 16, v81
    v_lshl_or_b32 v82, v102, 16, v82
    v_lshl_or_b32 v83, v103, 16, v83
    v_dot2_u32_u16 v100, v80, s38, 0
    v_dot2_u32_u16 v101, v81, s38, 0
    v_dot2_u32_u16 v102, v82, s38, 0
    v_dot2_u32_u16 v103, v83, s38, 0
    v_pk_mad_u16 v6, v80, s37, v6
    v_pk_mad_u16 v7, v81, s37, v7
    v_pk_mad_u16 v8, v82, s37, v8
    v_pk_mad_u16 v9, v83, s37, v9
    ds_add_u32 v100, v4 offset:0
    ds_add_u32 v101, v4 offset:0
    ds_add_u32 v102, v4 offset:0
    ds_add_u32 v103, v4 offset:0
    v_perm_b32 v125, v103, v102, s43
    v_perm_b32 v124, v101, v100, s43
    v_or_b32 v73, 0x40000000, v6
    v_or_b32 v74, 0x40000000, v7
    v_or_b32 v76, 0x40000000, v8
    v_or_b32 v77, 0x40000000, v9
    s_waitcnt vmcnt(6)
    v_perm_b32 v6, v104, v84, s43
    v_perm_b32 v7, v105, v85, s43
    v_perm_b32 v8, v106, v86, s43
    v_perm_b32 v9, v107, v87, s43
    v_mul_hi_u32_u24 v84, 429497, v84
    v_mul_hi_u32_u24 v104, 429497, v104
    v_mul_hi_u32_u24 v85, 429497, v85
    v_mul_hi_u32_u24 v105, 429497, v105
    v_mul_hi_u32_u24 v86, 429497, v86
    v_mul_hi_u32_u24 v106, 429497, v106
    v_mul_hi_u32_u24 v87, 429497, v87
    v_mul_hi_u32_u24 v107, 429497, v107
    v_lshl_or_b32 v84, v104, 16, v84
    v_lshl_or_b32 v85, v105, 16, v85
    v_lshl_or_b32 v86, v106, 16, v86
    v_lshl_or_b32 v87, v107, 16, v87
    v_dot2_u32_u16 v104, v84, s38, 0
    v_dot2_u32_u16 v105, v85, s38, 0
    v_dot2_u32_u16 v106, v86, s38, 0
    v_dot2_u32_u16 v107, v87, s38, 0
    v_pk_mad_u16 v6, v84, s37, v6
    v_pk_mad_u16 v7, v85, s37, v7
    v_pk_mad_u16 v8, v86, s37, v8
    v_pk_mad_u16 v9, v87, s37, v9
    ds_add_u32 v104, v4 offset:0
    ds_add_u32 v105, v4 offset:0
    ds_add_u32 v106, v4 offset:0
    ds_add_u32 v107, v4 offset:0
    v_perm_b32 v75, v107, v106, s43
    v_perm_b32 v126, v105, v104, s43
    v_or_b32 v78, 0x40000000, v6
    v_or_b32 v80, 0x40000000, v7
    v_or_b32 v81, 0x40000000, v8
    v_or_b32 v82, 0x40000000, v9
    s_waitcnt vmcnt(4)
    v_perm_b32 v6, v108, v88, s43
    v_perm_b32 v7, v109, v89, s43
    v_perm_b32 v8, v110, v90, s43
    v_perm_b32 v9, v111, v91, s43
    v_mul_hi_u32_u24 v88, 429497, v88
    v_mul_hi_u32_u24 v108, 429497, v108
    v_mul_hi_u32_u24 v89, 429497, v89
    v_mul_hi_u32_u24 v109, 429497, v109
    v_mul_hi_u32_u24 v90, 429497, v90
    v_mul_hi_u32_u24 v110, 429497, v110
    v_mul_hi_u32_u24 v91, 429497, v91
    v_mul_hi_u32_u24 v111, 429497, v111
    v_lshl_or_b32 v88, v108, 16, v88
    v_lshl_or_b32 v89, v109, 16, v89
    v_lshl_or_b32 v90, v110, 16, v90
    v_lshl_or_b32 v91, v111, 16, v91
    v_dot2_u32_u16 v108, v88, s38, 0
    v_dot2_u32_u16 v109, v89, s38, 0
    v_dot2_u32_u16 v110, v90, s38, 0
    v_dot2_u32_u16 v111, v91, s38, 0
    v_pk_mad_u16 v6, v88, s37, v6
    v_pk_mad_u16 v7, v89, s37, v7
    v_pk_mad_u16 v8, v90, s37, v8
    v_pk_mad_u16 v9, v91, s37, v9
    ds_add_u32 v108, v4 offset:0
    ds_add_u32 v109, v4 offset:0
    ds_add_u32 v110, v4 offset:0
    ds_add_u32 v111, v4 offset:0
    v_perm_b32 v83, v111, v110, s43
    v_perm_b32 v79, v109, v108, s43
    v_or_b32 v84, 0x40000000, v6
    v_or_b32 v85, 0x40000000, v7
    v_or_b32 v86, 0x40000000, v8
    v_or_b32 v88, 0x40000000, v9
    s_waitcnt vmcnt(2)
    v_perm_b32 v6, v112, v92, s43
    v_perm_b32 v7, v113, v93, s43
    v_perm_b32 v8, v114, v94, s43
    v_perm_b32 v9, v115, v95, s43
    v_mul_hi_u32_u24 v92, 429497, v92
    v_mul_hi_u32_u24 v112, 429497, v112
    v_mul_hi_u32_u24 v93, 429497, v93
    v_mul_hi_u32_u24 v113, 429497, v113
    v_mul_hi_u32_u24 v94, 429497, v94
    v_mul_hi_u32_u24 v114, 429497, v114
    v_mul_hi_u32_u24 v95, 429497, v95
    v_mul_hi_u32_u24 v115, 429497, v115
    v_lshl_or_b32 v92, v112, 16, v92
    v_lshl_or_b32 v93, v113, 16, v93
    v_lshl_or_b32 v94, v114, 16, v94
    v_lshl_or_b32 v95, v115, 16, v95
    v_dot2_u32_u16 v112, v92, s38, 0
    v_dot2_u32_u16 v113, v93, s38, 0
    v_dot2_u32_u16 v114, v94, s38, 0
    v_dot2_u32_u16 v115, v95, s38, 0
    v_pk_mad_u16 v6, v92, s37, v6
    v_pk_mad_u16 v7, v93, s37, v7
    v_pk_mad_u16 v8, v94, s37, v8
    v_pk_mad_u16 v9, v95, s37, v9
    ds_add_u32 v112, v4 offset:0
    ds_add_u32 v113, v4 offset:0
    ds_add_u32 v114, v4 offset:0
    ds_add_u32 v115, v4 offset:0
    v_perm_b32 v91, v115, v114, s43
    v_perm_b32 v87, v113, v112, s43
    v_or_b32 v89, 0x40000000, v6
    v_or_b32 v90, 0x40000000, v7
    v_or_b32 v92, 0x40000000, v8
    v_or_b32 v93, 0x40000000, v9
    s_waitcnt vmcnt(0)
    s_mov_b64 exec, s[44:45]
    v_perm_b32 v6, v116, v96, s43
    v_perm_b32 v7, v117, v97, s43
    v_perm_b32 v8, v118, v98, s43
    v_perm_b32 v9, v119, v99, s43
    v_mul_hi_u32_u24 v96, 429497, v96
    v_mul_hi_u32_u24 v116, 429497, v116
    v_mul_hi_u32_u24 v97, 429497, v97
    v_mul_hi_u32_u24 v117, 429497, v117
    v_mul_hi_u32_u24 v98, 429497, v98
    v_mul_hi_u32_u24 v118, 429497, v118
    v_mul_hi_u32_u24 v99, 429497, v99
    v_mul_hi_u32_u24 v119, 429497, v119
    v_lshl_or_b32 v96, v116, 16, v96
    v_lshl_or_b32 v97, v117, 16, v97
    v_lshl_or_b32 v98, v118, 16, v98
    v_lshl_or_b32 v99, v119, 16, v99
    v_dot2_u32_u16 v116, v96, s38, 0
    v_dot2_u32_u16 v117, v97, s38, 0
    v_dot2_u32_u16 v118, v98, s38, 0
    v_dot2_u32_u16 v119, v99, s38, 0
    v_pk_mad_u16 v6, v96, s37, v6
    v_pk_mad_u16 v7, v97, s37, v7
    v_pk_mad_u16 v8, v98, s37, v8
    v_pk_mad_u16 v9, v99, s37, v9
    ds_add_u32 v116, v4 offset:0
    ds_add_u32 v117, v4 offset:0
    ds_add_u32 v118, v4 offset:0
    ds_add_u32 v119, v4 offset:0
    v_perm_b32 v99, v119, v118, s43
    v_perm_b32 v95, v117, v116, s43
    v_or_b32 v94, 0x40000000, v6
    v_or_b32 v96, 0x40000000, v7
    v_or_b32 v97, 0x40000000, v8
    v_or_b32 v98, 0x40000000, v9
    s_mov_b64 exec, -1
    s_add_u32 s35, s34, 0
    buffer_load_dwordx2 v[100:101], v2, s[16:19], s35 offen nt
    s_lshl_b32 s35, s32, 10
    s_add_u32 s35, s35, 9437184
    s_add_u32 s20, s4, s35
    s_addc_u32 s21, s5, 0
    s_waitcnt lgkmcnt(0)
    s_barrier
    ds_read_b128 v[8:11], v1 offset:0
    s_add_u32 s35, s34, 2097152
    buffer_load_dwordx2 v[102:103], v2, s[16:19], s35 offen nt
    s_lshl_b32 s35, s39, 2
    s_add_u32 s35, s35, 160256
    v_mov_b32 v7, s35
    v_and_b32 v14, 15, v0
    v_lshlrev_b32 v14, 2, v14
    v_add_u32 v14, 160256, v14
    s_waitcnt lgkmcnt(0)
    v_cmp_eq_u32 s[56:57], 0, v8
    v_cmp_ge_u32 s[64:65], 1, v8
    v_max_u32 v12, 2, v8
    v_lshl_or_b32 v8, v8, 16, v12
    v_cmp_eq_u32 s[58:59], 0, v9
    v_cmp_ge_u32 s[66:67], 1, v9
    v_max_u32 v12, 2, v9
    v_lshl_or_b32 v9, v9, 16, v12
    v_cmp_eq_u32 s[60:61], 0, v10
    v_cmp_ge_u32 s[68:69], 1, v10
    v_max_u32 v12, 2, v10
    v_lshl_or_b32 v10, v10, 16, v12
    v_cmp_eq_u32 s[62:63], 0, v11
    v_cmp_ge_u32 s[70:71], 1, v11
    v_max_u32 v12, 2, v11
    v_lshl_or_b32 v11, v11, 16, v12
    v_add_u32 v9, v8, v9
    v_add_u32 v10, v9, v10
    v_add_u32 v11, v10, v11
    v_mov_b32 v6, v11
    s_nop 1
    v_add_u32_dpp v6, v6, v6 row_shr:1 row_mask:0xf bank_mask:0xf bound_ctrl:0
    s_nop 1
    v_add_u32_dpp v6, v6, v6 row_shr:2 row_mask:0xf bank_mask:0xf bound_ctrl:0
    s_nop 1
    v_add_u32_dpp v6, v6, v6 row_shr:4 row_mask:0xf bank_mask:0xf bound_ctrl:0
    s_nop 1
    v_add_u32_dpp v6, v6, v6 row_shr:8 row_mask:0xf bank_mask:0xf bound_ctrl:0
    s_nop 1
    v_add_u32_dpp v6, v6, v6 row_bcast:15 row_mask:0xa bank_mask:0xf
    s_nop 1
    v_add_u32_dpp v6, v6, v6 row_bcast:31 row_mask:0xc bank_mask:0xf
    s_mov_b32 exec_lo, 0
    s_brev_b32 exec_hi, 1
    ds_write_b32 v7, v6
    s_mov_b64 exec, -1
    v_sub_u32 v6, v6, v11
    s_or_b64 s[46:47], s[64:65], s[66:67]
    s_or_b64 vcc, s[68:69], s[70:71]
    s_or_b64 s[46:47], s[46:47], vcc
    s_waitcnt lgkmcnt(0)
    s_barrier
    ds_read_b32 v7, v14
    s_add_u32 s35, s34, 4194304
    buffer_load_dwordx2 v[104:105], v2, s[16:19], s35 offen nt
    s_waitcnt lgkmcnt(0)
    v_mov_b32 v15, v7
    s_nop 1
    v_add_u32_dpp v7, v7, v7 row_shr:1 row_mask:0xf bank_mask:0xf bound_ctrl:0
    s_nop 1
    v_add_u32_dpp v7, v7, v7 row_shr:2 row_mask:0xf bank_mask:0xf bound_ctrl:0
    s_nop 1
    v_add_u32_dpp v7, v7, v7 row_shr:4 row_mask:0xf bank_mask:0xf bound_ctrl:0
    s_nop 1
    v_add_u32_dpp v7, v7, v7 row_shr:8 row_mask:0xf bank_mask:0xf bound_ctrl:0
    s_nop 0
    v_readlane_b32 s54, v7, 15
    v_sub_u32 v7, v7, v15
    s_nop 0
    v_readlane_b32 s35, v7, s39
    s_and_b32 s54, s54, 0xffff
    s_cmp_ge_u32 s54, 40063
    s_cselect_b32 s36, 16, 0
    s_cselect_b32 s54, 40000, s54
    s_cselect_b32 s55, 1, s55
    s_cselect_b64 s[46:47], 0, s[46:47]
    v_add_u32 v12, s35, v6
    v_add_u32 v13, v12, v8
    v_add_u32 v14, v12, v9
    v_add_u32 v15, v12, v10
    v_bfe_u32 v12, v12, s36, 16
    v_bfe_u32 v13, v13, s36, 16
    v_bfe_u32 v14, v14, s36, 16
    v_bfe_u32 v15, v15, s36, 16
    ds_write_b128 v1, v[12:15] offset:0
    ds_write_b128 v1, v[12:15] offset:16384
    v_mov_b32 v6, 32768
    v_mov_b32 v7, s54
    s_mov_b64 exec, 1
    ds_write_b32 v6, v7
    s_mov_b64 exec, -1
    s_add_u32 s35, s54, 2
    s_mul_hi_u32 s35, s35, 1431655766
    s_lshl_b32 s35, s35, 4
    s_add_u32 s35, s35, 217890816
    s_min_u32 s22, s35, 218104832
    v_perm_b32 v15, v15, v14, s43
    v_perm_b32 v14, v13, v12, s43
    s_waitcnt lgkmcnt(0)
    s_barrier
    s_nop 0
    v_and_b32 v6, 0xffff, v51
    v_lshrrev_b32 v7, 16, v51
    v_and_b32 v8, 0xffff, v55
    v_lshrrev_b32 v9, 16, v55
    ds_add_rtn_u32 v6, v6, v4 offset:0
    ds_add_rtn_u32 v7, v7, v4 offset:0
    ds_add_rtn_u32 v8, v8, v4 offset:0
    ds_add_rtn_u32 v9, v9, v4 offset:0
    v_and_b32 v10, 0xffff, v59
    v_lshrrev_b32 v11, 16, v59
    v_and_b32 v12, 0xffff, v63
    v_lshrrev_b32 v13, 16, v63
    ds_add_rtn_u32 v10, v10, v4 offset:0
    ds_add_rtn_u32 v11, v11, v4 offset:0
    ds_add_rtn_u32 v12, v12, v4 offset:0
    ds_add_rtn_u32 v13, v13, v4 offset:0
    s_waitcnt lgkmcnt(4)
    v_perm_b32 v51, v7, v6, s43
    v_perm_b32 v55, v9, v8, s43
    v_and_b32 v6, 0xffff, v67
    v_lshrrev_b32 v7, 16, v67
    v_and_b32 v8, 0xffff, v71
    v_lshrrev_b32 v9, 16, v71
    ds_add_rtn_u32 v6, v6, v4 offset:0
    ds_add_rtn_u32 v7, v7, v4 offset:0
    ds_add_rtn_u32 v8, v8, v4 offset:0
    ds_add_rtn_u32 v9, v9, v4 offset:0
    s_waitcnt lgkmcnt(4)
    v_perm_b32 v59, v11, v10, s43
    v_perm_b32 v63, v13, v12, s43
    s_add_u32 s35, s34, 6291456
    buffer_load_dwordx2 v[106:107], v2, s[16:19], s35 offen nt
    v_and_b32 v10, 0xffff, v120
    v_lshrrev_b32 v11, 16, v120
    v_and_b32 v12, 0xffff, v121
    v_lshrrev_b32 v13, 16, v121
    ds_add_rtn_u32 v10, v10, v4 offset:0
    ds_add_rtn_u32 v11, v11, v4 offset:0
    ds_add_rtn_u32 v12, v12, v4 offset:0
    ds_add_rtn_u32 v13, v13, v4 offset:0
    s_waitcnt lgkmcnt(4)
    v_perm_b32 v67, v7, v6, s43
    v_perm_b32 v71, v9, v8, s43
    s_add_u32 s35, s34, 8388608
    buffer_load_dwordx2 v[108:109], v2, s[16:19], s35 offen nt
    v_and_b32 v6, 0xffff, v122
    v_lshrrev_b32 v7, 16, v122
    v_and_b32 v8, 0xffff, v123
    v_lshrrev_b32 v9, 16, v123
    ds_add_rtn_u32 v6, v6, v4 offset:0
    ds_add_rtn_u32 v7, v7, v4 offset:0
    ds_add_rtn_u32 v8, v8, v4 offset:0
    ds_add_rtn_u32 v9, v9, v4 offset:0
    s_waitcnt lgkmcnt(4)
    v_perm_b32 v120, v11, v10, s43
    v_perm_b32 v121, v13, v12, s43
    s_add_u32 s35, s34, 10485760
    buffer_load_dwordx2 v[110:111], v2, s[16:19], s35 offen nt
    v_and_b32 v10, 0xffff, v124
    v_lshrrev_b32 v11, 16, v124
    v_and_b32 v12, 0xffff, v125
    v_lshrrev_b32 v13, 16, v125
    ds_add_rtn_u32 v10, v10, v4 offset:0
    ds_add_rtn_u32 v11, v11, v4 offset:0
    ds_add_rtn_u32 v12, v12, v4 offset:0
    ds_add_rtn_u32 v13, v13, v4 offset:0
    s_waitcnt lgkmcnt(4)
    v_perm_b32 v122, v7, v6, s43
    v_perm_b32 v123, v9, v8, s43
    v_and_b32 v6, 0xffff, v126
    v_lshrrev_b32 v7, 16, v126
    v_and_b32 v8, 0xffff, v75
    v_lshrrev_b32 v9, 16, v75
    ds_add_rtn_u32 v6, v6, v4 offset:0
    ds_add_rtn_u32 v7, v7, v4 offset:0
    ds_add_rtn_u32 v8, v8, v4 offset:0
    ds_add_rtn_u32 v9, v9, v4 offset:0
    s_waitcnt lgkmcnt(4)
    v_perm_b32 v124, v11, v10, s43
    v_perm_b32 v125, v13, v12, s43
    s_add_u32 s35, s34, 12582912
    buffer_load_dwordx2 v[112:113], v2, s[16:19], s35 offen nt
    v_and_b32 v10, 0xffff, v79
    v_lshrrev_b32 v11, 16, v79
    v_and_b32 v12, 0xffff, v83
    v_lshrrev_b32 v13, 16, v83
    ds_add_rtn_u32 v10, v10, v4 offset:0
    ds_add_rtn_u32 v11, v11, v4 offset:0
    ds_add_rtn_u32 v12, v12, v4 offset:0
    ds_add_rtn_u32 v13, v13, v4 offset:0
    s_waitcnt lgkmcnt(4)
    v_perm_b32 v126, v7, v6, s43
    v_perm_b32 v75, v9, v8, s43
    s_add_u32 s35, s34, 14680064
    buffer_load_dwordx2 v[114:115], v2, s[16:19], s35 offen nt
    v_and_b32 v6, 0xffff, v87
    v_lshrrev_b32 v7, 16, v87
    v_and_b32 v8, 0xffff, v91
    v_lshrrev_b32 v9, 16, v91
    ds_add_rtn_u32 v6, v6, v4 offset:0
    ds_add_rtn_u32 v7, v7, v4 offset:0
    ds_add_rtn_u32 v8, v8, v4 offset:0
    ds_add_rtn_u32 v9, v9, v4 offset:0
    s_waitcnt lgkmcnt(4)
    v_perm_b32 v79, v11, v10, s43
    v_perm_b32 v83, v13, v12, s43
    s_add_u32 s35, s34, 16777216
    buffer_load_dwordx2 v[116:117], v2, s[16:19], s35 offen nt
    s_mov_b64 exec, s[44:45]
    v_and_b32 v10, 0xffff, v95
    v_lshrrev_b32 v11, 16, v95
    v_and_b32 v12, 0xffff, v99
    v_lshrrev_b32 v13, 16, v99
    ds_add_rtn_u32 v10, v10, v4 offset:0
    ds_add_rtn_u32 v11, v11, v4 offset:0
    ds_add_rtn_u32 v12, v12, v4 offset:0
    ds_add_rtn_u32 v13, v13, v4 offset:0
    s_mov_b64 exec, -1
    s_waitcnt lgkmcnt(4)
    v_perm_b32 v87, v7, v6, s43
    v_perm_b32 v91, v9, v8, s43
    s_add_u32 s35, s34, 18874368
    s_sub_u32 s35, s35, s49
    v_cndmask_b32 v118, 2.0, v2, s[44:45]
    buffer_load_dwordx2 v[118:119], v118, s[16:19], s35 offen nt
    s_waitcnt lgkmcnt(0)
    v_perm_b32 v95, v11, v10, s43
    v_perm_b32 v99, v13, v12, s43
    s_cmp_gt_u32 s39, 8
    s_cbranch_scc1 L_p1_kernel_notab_9
    v_lshrrev_b32 v6, 1, v0
    v_mul_u32_u24 v7, 1009, v6
    v_lshrrev_b32 v7, 16, v7
    v_mul_u32_u24 v7, 959, v7
    v_and_b32 v8, 1, v0
    v_lshl_add_u32 v7, v8, 9, v7
    v_add_lshl_u32 v13, v7, v6, 2
    ds_read2st64_b32 v[6:7], v13 offset0:64 offset1:65
    ds_read2st64_b32 v[8:9], v13 offset0:66 offset1:67
    ds_read2st64_b32 v[10:11], v13 offset0:68 offset1:69
    ds_read2st64_b32 v[12:13], v13 offset0:70 offset1:71
    s_mul_i32 s35, s32, 8320
    s_add_u32 s26, s35, 8320
    s_waitcnt lgkmcnt(3)
    v_perm_b32 v6, v7, v6, s43
    s_waitcnt lgkmcnt(2)
    v_perm_b32 v7, v9, v8, s43
    s_waitcnt lgkmcnt(1)
    v_perm_b32 v8, v11, v10, s43
    s_waitcnt lgkmcnt(0)
    v_perm_b32 v9, v13, v12, s43
    buffer_store_dwordx4 v[6:9], v1, s[24:27], s35 offen sc1
    s_nop 1
L_p1_kernel_notab_9:
    s_barrier
    s_lshl_b32 s35, s54, 2
    v_mov_b32 v6, s35
    v_mov_b32 v7, 0
    v_mov_b32 v12, 1140817920
    s_mov_b64 exec, 1
    ds_write2_b32 v6, v7, v7 offset0:0 offset1:1
    s_cmp_eq_u64 s[46:47], 0
    s_cbranch_scc1 L_p1_kernel_nonull_10
    s_mov_b64 exec, s[64:65]
    v_lshlrev_b32_sdwa v6, 2, v14 dst_sel:DWORD dst_unused:UNUSED_PAD src0_sel:DWORD src1_sel:WORD_0
    ds_write_b32 v6, v7 offset:4
    s_mov_b64 exec, s[56:57]
    ds_write_b32 v6, v7
    s_mov_b64 exec, s[66:67]
    v_lshlrev_b32_sdwa v6, 2, v14 dst_sel:DWORD dst_unused:UNUSED_PAD src0_sel:DWORD src1_sel:WORD_1
    ds_write_b32 v6, v7 offset:4
    s_mov_b64 exec, s[58:59]
    ds_write_b32 v6, v7
    s_mov_b64 exec, s[68:69]
    v_lshlrev_b32_sdwa v6, 2, v15 dst_sel:DWORD dst_unused:UNUSED_PAD src0_sel:DWORD src1_sel:WORD_0
    ds_write_b32 v6, v7 offset:4
    s_mov_b64 exec, s[60:61]
    ds_write_b32 v6, v7
    s_mov_b64 exec, s[70:71]
    v_lshlrev_b32_sdwa v6, 2, v15 dst_sel:DWORD dst_unused:UNUSED_PAD src0_sel:DWORD src1_sel:WORD_1
    ds_write_b32 v6, v7 offset:4
    s_mov_b64 exec, s[62:63]
    ds_write_b32 v6, v7
L_p1_kernel_nonull_10:
    s_mov_b64 exec, -1
    v_lshlrev_b32_sdwa v6, 2, v51 dst_sel:DWORD dst_unused:UNUSED_PAD src0_sel:DWORD src1_sel:WORD_0
    v_lshlrev_b32_sdwa v7, 2, v51 dst_sel:DWORD dst_unused:UNUSED_PAD src0_sel:DWORD src1_sel:WORD_1
    v_lshlrev_b32_sdwa v8, 2, v55 dst_sel:DWORD dst_unused:UNUSED_PAD src0_sel:DWORD src1_sel:WORD_0
    v_lshlrev_b32_sdwa v9, 2, v55 dst_sel:DWORD dst_unused:UNUSED_PAD src0_sel:DWORD src1_sel:WORD_1
    ds_write_b32 v6, v48
    ds_write_b32 v7, v49
    ds_write_b32 v8, v50
    ds_write_b32 v9, v52
    s_waitcnt vmcnt(9)
    v_lshlrev_b32 v10, 16, v100
    v_lshlrev_b32 v11, 16, v101
    v_and_b32 v100, 0xffff0000, v100
    v_and_b32 v101, 0xffff0000, v101
    v_mul_f32 v10, s41, v10
    v_mul_f32 v100, s41, v100
    v_mul_f32 v11, s41, v11
    v_mul_f32 v101, s41, v101
    v_fract_f32 v10, v10
    v_fract_f32 v100, v100
    v_fract_f32 v11, v11
    v_fract_f32 v101, v101
    v_cos_f32 v10, v10
    v_cos_f32 v100, v100
    v_cos_f32 v11, v11
    v_cos_f32 v101, v101
    v_fmaak_f32 v10, v12, v10, 1262486016
    v_fmaak_f32 v100, v12, v100, 1262486016
    v_fmaak_f32 v11, v12, v11, 1262486016
    v_fmaak_f32 v101, v12, v101, 1262486016
    v_or3_b32 v5, v10, v100, v5
    v_or3_b32 v5, v11, v101, v5
    v_perm_b32 v100, v100, v10, s43
    v_perm_b32 v101, v101, v11, s43
    s_add_u32 s35, s33, 40960000
    buffer_load_dwordx4 v[16:19], v1, s[8:11], s35 offen nt
    v_lshlrev_b32_sdwa v6, 2, v59 dst_sel:DWORD dst_unused:UNUSED_PAD src0_sel:DWORD src1_sel:WORD_0
    v_lshlrev_b32_sdwa v7, 2, v59 dst_sel:DWORD dst_unused:UNUSED_PAD src0_sel:DWORD src1_sel:WORD_1
    v_lshlrev_b32_sdwa v8, 2, v63 dst_sel:DWORD dst_unused:UNUSED_PAD src0_sel:DWORD src1_sel:WORD_0
    v_lshlrev_b32_sdwa v9, 2, v63 dst_sel:DWORD dst_unused:UNUSED_PAD src0_sel:DWORD src1_sel:WORD_1
    ds_write_b32 v6, v53
    ds_write_b32 v7, v54
    ds_write_b32 v8, v56
    ds_write_b32 v9, v57
    s_waitcnt vmcnt(9)
    v_lshlrev_b32 v10, 16, v102
    v_lshlrev_b32 v11, 16, v103
    v_and_b32 v102, 0xffff0000, v102
    v_and_b32 v103, 0xffff0000, v103
    v_mul_f32 v10, s41, v10
    v_mul_f32 v102, s41, v102
    v_mul_f32 v11, s41, v11
    v_mul_f32 v103, s41, v103
    v_fract_f32 v10, v10
    v_fract_f32 v102, v102
    v_fract_f32 v11, v11
    v_fract_f32 v103, v103
    v_cos_f32 v10, v10
    v_cos_f32 v102, v102
    v_cos_f32 v11, v11
    v_cos_f32 v103, v103
    v_fmaak_f32 v10, v12, v10, 1262486016
    v_fmaak_f32 v102, v12, v102, 1262486016
    v_fmaak_f32 v11, v12, v11, 1262486016
    v_fmaak_f32 v103, v12, v103, 1262486016
    v_or3_b32 v5, v10, v102, v5
    v_or3_b32 v5, v11, v103, v5
    v_perm_b32 v102, v102, v10, s43
    v_perm_b32 v103, v103, v11, s43
    v_lshlrev_b32_sdwa v6, 2, v67 dst_sel:DWORD dst_unused:UNUSED_PAD src0_sel:DWORD src1_sel:WORD_0
    v_lshlrev_b32_sdwa v7, 2, v67 dst_sel:DWORD dst_unused:UNUSED_PAD src0_sel:DWORD src1_sel:WORD_1
    v_lshlrev_b32_sdwa v8, 2, v71 dst_sel:DWORD dst_unused:UNUSED_PAD src0_sel:DWORD src1_sel:WORD_0
    v_lshlrev_b32_sdwa v9, 2, v71 dst_sel:DWORD dst_unused:UNUSED_PAD src0_sel:DWORD src1_sel:WORD_1
    ds_write_b32 v6, v58
    ds_write_b32 v7, v60
    ds_write_b32 v8, v61
    ds_write_b32 v9, v62
    v_lshlrev_b32_sdwa v6, 2, v120 dst_sel:DWORD dst_unused:UNUSED_PAD src0_sel:DWORD src1_sel:WORD_0
    v_lshlrev_b32_sdwa v7, 2, v120 dst_sel:DWORD dst_unused:UNUSED_PAD src0_sel:DWORD src1_sel:WORD_1
    v_lshlrev_b32_sdwa v8, 2, v121 dst_sel:DWORD dst_unused:UNUSED_PAD src0_sel:DWORD src1_sel:WORD_0
    v_lshlrev_b32_sdwa v9, 2, v121 dst_sel:DWORD dst_unused:UNUSED_PAD src0_sel:DWORD src1_sel:WORD_1
    ds_write_b32 v6, v64
    ds_write_b32 v7, v65
    ds_write_b32 v8, v66
    ds_write_b32 v9, v68
    s_waitcnt vmcnt(8)
    v_lshlrev_b32 v10, 16, v104
    v_lshlrev_b32 v11, 16, v105
    v_and_b32 v104, 0xffff0000, v104
    v_and_b32 v105, 0xffff0000, v105
    v_mul_f32 v10, s41, v10
    v_mul_f32 v104, s41, v104
    v_mul_f32 v11, s41, v11
    v_mul_f32 v105, s41, v105
    v_fract_f32 v10, v10
    v_fract_f32 v104, v104
    v_fract_f32 v11, v11
    v_fract_f32 v105, v105
    v_cos_f32 v10, v10
    v_cos_f32 v104, v104
    v_cos_f32 v11, v11
    v_cos_f32 v105, v105
    v_fmaak_f32 v10, v12, v10, 1262486016
    v_fmaak_f32 v104, v12, v104, 1262486016
    v_fmaak_f32 v11, v12, v11, 1262486016
    v_fmaak_f32 v105, v12, v105, 1262486016
    v_or3_b32 v5, v10, v104, v5
    v_or3_b32 v5, v11, v105, v5
    v_perm_b32 v104, v104, v10, s43
    v_perm_b32 v105, v105, v11, s43
    s_add_u32 s35, s33, 40960000
    buffer_load_dwordx4 v[20:23], v1, s[12:15], s35 offen nt
    v_lshlrev_b32_sdwa v6, 2, v122 dst_sel:DWORD dst_unused:UNUSED_PAD src0_sel:DWORD src1_sel:WORD_0
    v_lshlrev_b32_sdwa v7, 2, v122 dst_sel:DWORD dst_unused:UNUSED_PAD src0_sel:DWORD src1_sel:WORD_1
    v_lshlrev_b32_sdwa v8, 2, v123 dst_sel:DWORD dst_unused:UNUSED_PAD src0_sel:DWORD src1_sel:WORD_0
    v_lshlrev_b32_sdwa v9, 2, v123 dst_sel:DWORD dst_unused:UNUSED_PAD src0_sel:DWORD src1_sel:WORD_1
    ds_write_b32 v6, v69
    ds_write_b32 v7, v70
    ds_write_b32 v8, v127
    ds_write_b32 v9, v72
    s_waitcnt vmcnt(8)
    v_lshlrev_b32 v10, 16, v106
    v_lshlrev_b32 v11, 16, v107
    v_and_b32 v106, 0xffff0000, v106
    v_and_b32 v107, 0xffff0000, v107
    v_mul_f32 v10, s41, v10
    v_mul_f32 v106, s41, v106
    v_mul_f32 v11, s41, v11
    v_mul_f32 v107, s41, v107
    v_fract_f32 v10, v10
    v_fract_f32 v106, v106
    v_fract_f32 v11, v11
    v_fract_f32 v107, v107
    v_cos_f32 v10, v10
    v_cos_f32 v106, v106
    v_cos_f32 v11, v11
    v_cos_f32 v107, v107
    v_fmaak_f32 v10, v12, v10, 1262486016
    v_fmaak_f32 v106, v12, v106, 1262486016
    v_fmaak_f32 v11, v12, v11, 1262486016
    v_fmaak_f32 v107, v12, v107, 1262486016
    v_or3_b32 v5, v10, v106, v5
    v_or3_b32 v5, v11, v107, v5
    v_perm_b32 v106, v106, v10, s43
    v_perm_b32 v107, v107, v11, s43
    v_lshlrev_b32_sdwa v6, 2, v124 dst_sel:DWORD dst_unused:UNUSED_PAD src0_sel:DWORD src1_sel:WORD_0
    v_lshlrev_b32_sdwa v7, 2, v124 dst_sel:DWORD dst_unused:UNUSED_PAD src0_sel:DWORD src1_sel:WORD_1
    v_lshlrev_b32_sdwa v8, 2, v125 dst_sel:DWORD dst_unused:UNUSED_PAD src0_sel:DWORD src1_sel:WORD_0
    v_lshlrev_b32_sdwa v9, 2, v125 dst_sel:DWORD dst_unused:UNUSED_PAD src0_sel:DWORD src1_sel:WORD_1
    ds_write_b32 v6, v73
    ds_write_b32 v7, v74
    ds_write_b32 v8, v76
    ds_write_b32 v9, v77
    v_lshlrev_b32_sdwa v6, 2, v126 dst_sel:DWORD dst_unused:UNUSED_PAD src0_sel:DWORD src1_sel:WORD_0
    v_lshlrev_b32_sdwa v7, 2, v126 dst_sel:DWORD dst_unused:UNUSED_PAD src0_sel:DWORD src1_sel:WORD_1
    v_lshlrev_b32_sdwa v8, 2, v75 dst_sel:DWORD dst_unused:UNUSED_PAD src0_sel:DWORD src1_sel:WORD_0
    v_lshlrev_b32_sdwa v9, 2, v75 dst_sel:DWORD dst_unused:UNUSED_PAD src0_sel:DWORD src1_sel:WORD_1
    ds_write_b32 v6, v78
    ds_write_b32 v7, v80
    ds_write_b32 v8, v81
    ds_write_b32 v9, v82
    s_waitcnt vmcnt(7)
    v_lshlrev_b32 v10, 16, v108
    v_lshlrev_b32 v11, 16, v109
    v_and_b32 v108, 0xffff0000, v108
    v_and_b32 v109, 0xffff0000, v109
    v_mul_f32 v10, s41, v10
    v_mul_f32 v108, s41, v108
    v_mul_f32 v11, s41, v11
    v_mul_f32 v109, s41, v109
    v_fract_f32 v10, v10
    v_fract_f32 v108, v108
    v_fract_f32 v11, v11
    v_fract_f32 v109, v109
    v_cos_f32 v10, v10
    v_cos_f32 v108, v108
    v_cos_f32 v11, v11
    v_cos_f32 v109, v109
    v_fmaak_f32 v10, v12, v10, 1262486016
    v_fmaak_f32 v108, v12, v108, 1262486016
    v_fmaak_f32 v11, v12, v11, 1262486016
    v_fmaak_f32 v109, v12, v109, 1262486016
    v_or3_b32 v5, v10, v108, v5
    v_or3_b32 v5, v11, v109, v5
    v_perm_b32 v108, v108, v10, s43
    v_perm_b32 v109, v109, v11, s43
    s_add_u32 s35, s33, 45154304
    buffer_load_dwordx4 v[24:27], v1, s[8:11], s35 offen nt
    v_lshlrev_b32_sdwa v6, 2, v79 dst_sel:DWORD dst_unused:UNUSED_PAD src0_sel:DWORD src1_sel:WORD_0
    v_lshlrev_b32_sdwa v7, 2, v79 dst_sel:DWORD dst_unused:UNUSED_PAD src0_sel:DWORD src1_sel:WORD_1
    v_lshlrev_b32_sdwa v8, 2, v83 dst_sel:DWORD dst_unused:UNUSED_PAD src0_sel:DWORD src1_sel:WORD_0
    v_lshlrev_b32_sdwa v9, 2, v83 dst_sel:DWORD dst_unused:UNUSED_PAD src0_sel:DWORD src1_sel:WORD_1
    ds_write_b32 v6, v84
    ds_write_b32 v7, v85
    ds_write_b32 v8, v86
    ds_write_b32 v9, v88
    s_waitcnt vmcnt(7)
    v_lshlrev_b32 v10, 16, v110
    v_lshlrev_b32 v11, 16, v111
    v_and_b32 v110, 0xffff0000, v110
    v_and_b32 v111, 0xffff0000, v111
    v_mul_f32 v10, s41, v10
    v_mul_f32 v110, s41, v110
    v_mul_f32 v11, s41, v11
    v_mul_f32 v111, s41, v111
    v_fract_f32 v10, v10
    v_fract_f32 v110, v110
    v_fract_f32 v11, v11
    v_fract_f32 v111, v111
    v_cos_f32 v10, v10
    v_cos_f32 v110, v110
    v_cos_f32 v11, v11
    v_cos_f32 v111, v111
    v_fmaak_f32 v10, v12, v10, 1262486016
    v_fmaak_f32 v110, v12, v110, 1262486016
    v_fmaak_f32 v11, v12, v11, 1262486016
    v_fmaak_f32 v111, v12, v111, 1262486016
    v_or3_b32 v5, v10, v110, v5
    v_or3_b32 v5, v11, v111, v5
    v_perm_b32 v110, v110, v10, s43
    v_perm_b32 v111, v111, v11, s43
    v_lshlrev_b32_sdwa v6, 2, v87 dst_sel:DWORD dst_unused:UNUSED_PAD src0_sel:DWORD src1_sel:WORD_0
    v_lshlrev_b32_sdwa v7, 2, v87 dst_sel:DWORD dst_unused:UNUSED_PAD src0_sel:DWORD src1_sel:WORD_1
    v_lshlrev_b32_sdwa v8, 2, v91 dst_sel:DWORD dst_unused:UNUSED_PAD src0_sel:DWORD src1_sel:WORD_0
    v_lshlrev_b32_sdwa v9, 2, v91 dst_sel:DWORD dst_unused:UNUSED_PAD src0_sel:DWORD src1_sel:WORD_1
    ds_write_b32 v6, v89
    ds_write_b32 v7, v90
    ds_write_b32 v8, v92
    ds_write_b32 v9, v93
    s_mov_b64 exec, s[44:45]
    v_lshlrev_b32_sdwa v6, 2, v95 dst_sel:DWORD dst_unused:UNUSED_PAD src0_sel:DWORD src1_sel:WORD_0
    v_lshlrev_b32_sdwa v7, 2, v95 dst_sel:DWORD dst_unused:UNUSED_PAD src0_sel:DWORD src1_sel:WORD_1
    v_lshlrev_b32_sdwa v8, 2, v99 dst_sel:DWORD dst_unused:UNUSED_PAD src0_sel:DWORD src1_sel:WORD_0
    v_lshlrev_b32_sdwa v9, 2, v99 dst_sel:DWORD dst_unused:UNUSED_PAD src0_sel:DWORD src1_sel:WORD_1
    ds_write_b32 v6, v94
    ds_write_b32 v7, v96
    ds_write_b32 v8, v97
    ds_write_b32 v9, v98
    s_mov_b64 exec, -1
    s_waitcnt vmcnt(6)
    v_lshlrev_b32 v10, 16, v112
    v_lshlrev_b32 v11, 16, v113
    v_and_b32 v112, 0xffff0000, v112
    v_and_b32 v113, 0xffff0000, v113
    v_mul_f32 v10, s41, v10
    v_mul_f32 v112, s41, v112
    v_mul_f32 v11, s41, v11
    v_mul_f32 v113, s41, v113
    v_fract_f32 v10, v10
    v_fract_f32 v112, v112
    v_fract_f32 v11, v11
    v_fract_f32 v113, v113
    v_cos_f32 v10, v10
    v_cos_f32 v112, v112
    v_cos_f32 v11, v11
    v_cos_f32 v113, v113
    v_fmaak_f32 v10, v12, v10, 1262486016
    v_fmaak_f32 v112, v12, v112, 1262486016
    v_fmaak_f32 v11, v12, v11, 1262486016
    v_fmaak_f32 v113, v12, v113, 1262486016
    v_or3_b32 v5, v10, v112, v5
    v_or3_b32 v5, v11, v113, v5
    v_perm_b32 v112, v112, v10, s43
    v_perm_b32 v113, v113, v11, s43
    s_mov_b64 exec, s[44:45]
    s_mov_b64 exec, -1
    s_add_u32 s35, s33, 45154304
    buffer_load_dwordx4 v[28:31], v1, s[12:15], s35 offen nt
    s_mul_i32 s35, s39, 9216
    v_mad_u32_u24 v6, v0, 12, s35
    s_waitcnt lgkmcnt(0)
    s_barrier
    s_cmp_lg_u32 s39, 15
    s_cbranch_scc1 L_p1_kernel_nox_11
    ds_read_b32 v12, v6 offset:9984
    ds_read_b32 v13, v6 offset:9988
    ds_read_b32 v14, v6 offset:9992
L_p1_kernel_nox_11:
    ds_read_b32 v48, v6 offset:1536
    ds_read_b32 v49, v6 offset:1540
    ds_read_b32 v50, v6 offset:1544
    ds_read_b32 v52, v6 offset:3072
    ds_read_b32 v53, v6 offset:3076
    ds_read_b32 v54, v6 offset:3080
    ds_read_b32 v56, v6 offset:4608
    ds_read_b32 v57, v6 offset:4612
    ds_read_b32 v58, v6 offset:4616
    ds_read_b32 v60, v6 offset:6144
    ds_read_b32 v61, v6 offset:6148
    ds_read_b32 v62, v6 offset:6152
    ds_read_b32 v64, v6 offset:7680
    ds_read_b32 v65, v6 offset:7684
    ds_read_b32 v66, v6 offset:7688
    ds_read_b32 v68, v6 offset:9216
    ds_read_b32 v69, v6 offset:9220
    ds_read_b32 v70, v6 offset:9224
    ds_read_b32 v72, v6 offset:0
    ds_read_b32 v73, v6 offset:4
    ds_read_b32 v74, v6 offset:8
    ds_read_b32 v76, v6 offset:768
    ds_read_b32 v77, v6 offset:772
    ds_read_b32 v78, v6 offset:776
    ds_read_b32 v80, v6 offset:2304
    ds_read_b32 v81, v6 offset:2308
    ds_read_b32 v82, v6 offset:2312
    ds_read_b32 v84, v6 offset:3840
    ds_read_b32 v85, v6 offset:3844
    ds_read_b32 v86, v6 offset:3848
    ds_read_b32 v88, v6 offset:5376
    ds_read_b32 v89, v6 offset:5380
    ds_read_b32 v90, v6 offset:5384
    ds_read_b32 v92, v6 offset:6912
    ds_read_b32 v93, v6 offset:6916
    ds_read_b32 v94, v6 offset:6920
    ds_read_b32 v96, v6 offset:8448
    ds_read_b32 v97, v6 offset:8452
    ds_read_b32 v98, v6 offset:8456
    s_add_u32 s35, s33, 49348608
    buffer_load_dwordx4 v[32:35], v1, s[8:11], s35 offen nt
    v_mov_b32 v8, 0
    v_mov_b32 v9, 0
    v_mov_b32 v10, 0
    v_mov_b32 v11, 0
    v_mov_b32 v15, 16384
    s_waitcnt lgkmcnt(0)
    s_barrier
    ds_write_b128 v1, v[8:11] offset:0
    s_nop 1
    v_mad_u32_u16 v6, v51, s50, v15 op_sel:[0,0,0,0]
    v_mad_u32_u16 v7, v51, s50, v15 op_sel:[1,0,0,0]
    v_mad_u32_u16 v8, v55, s50, v15 op_sel:[0,0,0,0]
    v_mad_u32_u16 v9, v55, s50, v15 op_sel:[1,0,0,0]
    v_add_u32_sdwa v6, v6, v51 dst_sel:DWORD dst_unused:UNUSED_PAD src0_sel:WORD_1 src1_sel:WORD_0
    v_add_u32_sdwa v7, v7, v51 dst_sel:DWORD dst_unused:UNUSED_PAD src0_sel:WORD_1 src1_sel:WORD_1
    v_add_u32_sdwa v8, v8, v55 dst_sel:DWORD dst_unused:UNUSED_PAD src0_sel:WORD_1 src1_sel:WORD_0
    v_add_u32_sdwa v9, v9, v55 dst_sel:DWORD dst_unused:UNUSED_PAD src0_sel:WORD_1 src1_sel:WORD_1
    v_add_u32 v6, v6, v6
    v_add_u32 v7, v7, v7
    v_add_u32 v8, v8, v8
    v_add_u32 v9, v9, v9
    ds_write_b16 v6, v100 offset:16384
    ds_write_b16_d16_hi v7, v100 offset:16384
    ds_write_b16 v8, v101 offset:16384
    ds_write_b16_d16_hi v9, v101 offset:16384
    v_mov_b32 v6, 1140817920
    s_waitcnt vmcnt(7)
    v_lshlrev_b32 v10, 16, v114
    v_lshlrev_b32 v11, 16, v115
    v_and_b32 v114, 0xffff0000, v114
    v_and_b32 v115, 0xffff0000, v115
    v_mul_f32 v10, s41, v10
    v_mul_f32 v114, s41, v114
    v_mul_f32 v11, s41, v11
    v_mul_f32 v115, s41, v115
    v_fract_f32 v10, v10
    v_fract_f32 v114, v114
    v_fract_f32 v11, v11
    v_fract_f32 v115, v115
    v_cos_f32 v10, v10
    v_cos_f32 v114, v114
    v_cos_f32 v11, v11
    v_cos_f32 v115, v115
    v_fmaak_f32 v10, v6, v10, 1262486016
    v_fmaak_f32 v114, v6, v114, 1262486016
    v_fmaak_f32 v11, v6, v11, 1262486016
    v_fmaak_f32 v115, v6, v115, 1262486016
    v_or3_b32 v5, v10, v114, v5
    v_or3_b32 v5, v11, v115, v5
    v_perm_b32 v114, v114, v10, s43
    v_perm_b32 v115, v115, v11, s43
    v_mad_u32_u16 v6, v59, s50, v15 op_sel:[0,0,0,0]
    v_mad_u32_u16 v7, v59, s50, v15 op_sel:[1,0,0,0]
    v_mad_u32_u16 v8, v63, s50, v15 op_sel:[0,0,0,0]
    v_mad_u32_u16 v9, v63, s50, v15 op_sel:[1,0,0,0]
    v_add_u32_sdwa v6, v6, v59 dst_sel:DWORD dst_unused:UNUSED_PAD src0_sel:WORD_1 src1_sel:WORD_0
    v_add_u32_sdwa v7, v7, v59 dst_sel:DWORD dst_unused:UNUSED_PAD src0_sel:WORD_1 src1_sel:WORD_1
    v_add_u32_sdwa v8, v8, v63 dst_sel:DWORD dst_unused:UNUSED_PAD src0_sel:WORD_1 src1_sel:WORD_0
    v_add_u32_sdwa v9, v9, v63 dst_sel:DWORD dst_unused:UNUSED_PAD src0_sel:WORD_1 src1_sel:WORD_1
    v_add_u32 v6, v6, v6
    v_add_u32 v7, v7, v7
    v_add_u32 v8, v8, v8
    v_add_u32 v9, v9, v9
    ds_write_b16 v6, v102 offset:16384
    ds_write_b16_d16_hi v7, v102 offset:16384
    ds_write_b16 v8, v103 offset:16384
    ds_write_b16_d16_hi v9, v103 offset:16384
    v_mad_u32_u16 v6, v67, s50, v15 op_sel:[0,0,0,0]
    v_mad_u32_u16 v7, v67, s50, v15 op_sel:[1,0,0,0]
    v_mad_u32_u16 v8, v71, s50, v15 op_sel:[0,0,0,0]
    v_mad_u32_u16 v9, v71, s50, v15 op_sel:[1,0,0,0]
    v_add_u32_sdwa v6, v6, v67 dst_sel:DWORD dst_unused:UNUSED_PAD src0_sel:WORD_1 src1_sel:WORD_0
    v_add_u32_sdwa v7, v7, v67 dst_sel:DWORD dst_unused:UNUSED_PAD src0_sel:WORD_1 src1_sel:WORD_1
    v_add_u32_sdwa v8, v8, v71 dst_sel:DWORD dst_unused:UNUSED_PAD src0_sel:WORD_1 src1_sel:WORD_0
    v_add_u32_sdwa v9, v9, v71 dst_sel:DWORD dst_unused:UNUSED_PAD src0_sel:WORD_1 src1_sel:WORD_1
    v_add_u32 v6, v6, v6
    v_add_u32 v7, v7, v7
    v_add_u32 v8, v8, v8
    v_add_u32 v9, v9, v9
    ds_write_b16 v6, v104 offset:16384
    ds_write_b16_d16_hi v7, v104 offset:16384
    ds_write_b16 v8, v105 offset:16384
    ds_write_b16_d16_hi v9, v105 offset:16384
    s_add_u32 s35, s33, 49348608
    buffer_load_dwordx4 v[36:39], v1, s[12:15], s35 offen nt
    v_mad_u32_u16 v6, v120, s50, v15 op_sel:[0,0,0,0]
    v_mad_u32_u16 v7, v120, s50, v15 op_sel:[1,0,0,0]
    v_mad_u32_u16 v8, v121, s50, v15 op_sel:[0,0,0,0]
    v_mad_u32_u16 v9, v121, s50, v15 op_sel:[1,0,0,0]
    v_add_u32_sdwa v6, v6, v120 dst_sel:DWORD dst_unused:UNUSED_PAD src0_sel:WORD_1 src1_sel:WORD_0
    v_add_u32_sdwa v7, v7, v120 dst_sel:DWORD dst_unused:UNUSED_PAD src0_sel:WORD_1 src1_sel:WORD_1
    v_add_u32_sdwa v8, v8, v121 dst_sel:DWORD dst_unused:UNUSED_PAD src0_sel:WORD_1 src1_sel:WORD_0
    v_add_u32_sdwa v9, v9, v121 dst_sel:DWORD dst_unused:UNUSED_PAD src0_sel:WORD_1 src1_sel:WORD_1
    v_add_u32 v6, v6, v6
    v_add_u32 v7, v7, v7
    v_add_u32 v8, v8, v8
    v_add_u32 v9, v9, v9
    ds_write_b16 v6, v106 offset:16384
    ds_write_b16_d16_hi v7, v106 offset:16384
    ds_write_b16 v8, v107 offset:16384
    ds_write_b16_d16_hi v9, v107 offset:16384
    v_mov_b32 v6, 1140817920
    s_waitcnt vmcnt(7)
    v_lshlrev_b32 v10, 16, v116
    v_lshlrev_b32 v11, 16, v117
    v_and_b32 v116, 0xffff0000, v116
    v_and_b32 v117, 0xffff0000, v117
    v_mul_f32 v10, s41, v10
    v_mul_f32 v116, s41, v116
    v_mul_f32 v11, s41, v11
    v_mul_f32 v117, s41, v117
    v_fract_f32 v10, v10
    v_fract_f32 v116, v116
    v_fract_f32 v11, v11
    v_fract_f32 v117, v117
    v_cos_f32 v10, v10
    v_cos_f32 v116, v116
    v_cos_f32 v11, v11
    v_cos_f32 v117, v117
    v_fmaak_f32 v10, v6, v10, 1262486016
    v_fmaak_f32 v116, v6, v116, 1262486016
    v_fmaak_f32 v11, v6, v11, 1262486016
    v_fmaak_f32 v117, v6, v117, 1262486016
    v_or3_b32 v5, v10, v116, v5
    v_or3_b32 v5, v11, v117, v5
    v_perm_b32 v116, v116, v10, s43
    v_perm_b32 v117, v117, v11, s43
    v_mad_u32_u16 v6, v122, s50, v15 op_sel:[0,0,0,0]
    v_mad_u32_u16 v7, v122, s50, v15 op_sel:[1,0,0,0]
    v_mad_u32_u16 v8, v123, s50, v15 op_sel:[0,0,0,0]
    v_mad_u32_u16 v9, v123, s50, v15 op_sel:[1,0,0,0]
    v_add_u32_sdwa v6, v6, v122 dst_sel:DWORD dst_unused:UNUSED_PAD src0_sel:WORD_1 src1_sel:WORD_0
    v_add_u32_sdwa v7, v7, v122 dst_sel:DWORD dst_unused:UNUSED_PAD src0_sel:WORD_1 src1_sel:WORD_1
    v_add_u32_sdwa v8, v8, v123 dst_sel:DWORD dst_unused:UNUSED_PAD src0_sel:WORD_1 src1_sel:WORD_0
    v_add_u32_sdwa v9, v9, v123 dst_sel:DWORD dst_unused:UNUSED_PAD src0_sel:WORD_1 src1_sel:WORD_1
    v_add_u32 v6, v6, v6
    v_add_u32 v7, v7, v7
    v_add_u32 v8, v8, v8
    v_add_u32 v9, v9, v9
    ds_write_b16 v6, v108 offset:16384
    ds_write_b16_d16_hi v7, v108 offset:16384
    ds_write_b16 v8, v109 offset:16384
    ds_write_b16_d16_hi v9, v109 offset:16384
    v_mad_u32_u16 v6, v124, s50, v15 op_sel:[0,0,0,0]
    v_mad_u32_u16 v7, v124, s50, v15 op_sel:[1,0,0,0]
    v_mad_u32_u16 v8, v125, s50, v15 op_sel:[0,0,0,0]
    v_mad_u32_u16 v9, v125, s50, v15 op_sel:[1,0,0,0]
    v_add_u32_sdwa v6, v6, v124 dst_sel:DWORD dst_unused:UNUSED_PAD src0_sel:WORD_1 src1_sel:WORD_0
    v_add_u32_sdwa v7, v7, v124 dst_sel:DWORD dst_unused:UNUSED_PAD src0_sel:WORD_1 src1_sel:WORD_1
    v_add_u32_sdwa v8, v8, v125 dst_sel:DWORD dst_unused:UNUSED_PAD src0_sel:WORD_1 src1_sel:WORD_0
    v_add_u32_sdwa v9, v9, v125 dst_sel:DWORD dst_unused:UNUSED_PAD src0_sel:WORD_1 src1_sel:WORD_1
    v_add_u32 v6, v6, v6
    v_add_u32 v7, v7, v7
    v_add_u32 v8, v8, v8
    v_add_u32 v9, v9, v9
    ds_write_b16 v6, v110 offset:16384
    ds_write_b16_d16_hi v7, v110 offset:16384
    ds_write_b16 v8, v111 offset:16384
    ds_write_b16_d16_hi v9, v111 offset:16384
    s_add_u32 s35, s33, 53542912
    buffer_load_dwordx4 v[40:43], v1, s[8:11], s35 offen nt
    v_mad_u32_u16 v6, v126, s50, v15 op_sel:[0,0,0,0]
    v_mad_u32_u16 v7, v126, s50, v15 op_sel:[1,0,0,0]
    v_mad_u32_u16 v8, v75, s50, v15 op_sel:[0,0,0,0]
    v_mad_u32_u16 v9, v75, s50, v15 op_sel:[1,0,0,0]
    v_add_u32_sdwa v6, v6, v126 dst_sel:DWORD dst_unused:UNUSED_PAD src0_sel:WORD_1 src1_sel:WORD_0
    v_add_u32_sdwa v7, v7, v126 dst_sel:DWORD dst_unused:UNUSED_PAD src0_sel:WORD_1 src1_sel:WORD_1
    v_add_u32_sdwa v8, v8, v75 dst_sel:DWORD dst_unused:UNUSED_PAD src0_sel:WORD_1 src1_sel:WORD_0
    v_add_u32_sdwa v9, v9, v75 dst_sel:DWORD dst_unused:UNUSED_PAD src0_sel:WORD_1 src1_sel:WORD_1
    v_add_u32 v6, v6, v6
    v_add_u32 v7, v7, v7
    v_add_u32 v8, v8, v8
    v_add_u32 v9, v9, v9
    ds_write_b16 v6, v112 offset:16384
    ds_write_b16_d16_hi v7, v112 offset:16384
    ds_write_b16 v8, v113 offset:16384
    ds_write_b16_d16_hi v9, v113 offset:16384
    v_mov_b32 v6, 1140817920
    s_mov_b64 exec, s[44:45]
    s_waitcnt vmcnt(7)
    v_lshlrev_b32 v10, 16, v118
    v_lshlrev_b32 v11, 16, v119
    v_and_b32 v118, 0xffff0000, v118
    v_and_b32 v119, 0xffff0000, v119
    v_mul_f32 v10, s41, v10
    v_mul_f32 v118, s41, v118
    v_mul_f32 v11, s41, v11
    v_mul_f32 v119, s41, v119
    v_fract_f32 v10, v10
    v_fract_f32 v118, v118
    v_fract_f32 v11, v11
    v_fract_f32 v119, v119
    v_cos_f32 v10, v10
    v_cos_f32 v118, v118
    v_cos_f32 v11, v11
    v_cos_f32 v119, v119
    v_fmaak_f32 v10, v6, v10, 1262486016
    v_fmaak_f32 v118, v6, v118, 1262486016
    v_fmaak_f32 v11, v6, v11, 1262486016
    v_fmaak_f32 v119, v6, v119, 1262486016
    v_or3_b32 v5, v10, v118, v5
    v_or3_b32 v5, v11, v119, v5
    v_perm_b32 v118, v118, v10, s43
    v_perm_b32 v119, v119, v11, s43
    s_mov_b64 exec, -1
    v_mad_u32_u16 v6, v79, s50, v15 op_sel:[0,0,0,0]
    v_mad_u32_u16 v7, v79, s50, v15 op_sel:[1,0,0,0]
    v_mad_u32_u16 v8, v83, s50, v15 op_sel:[0,0,0,0]
    v_mad_u32_u16 v9, v83, s50, v15 op_sel:[1,0,0,0]
    v_add_u32_sdwa v6, v6, v79 dst_sel:DWORD dst_unused:UNUSED_PAD src0_sel:WORD_1 src1_sel:WORD_0
    v_add_u32_sdwa v7, v7, v79 dst_sel:DWORD dst_unused:UNUSED_PAD src0_sel:WORD_1 src1_sel:WORD_1
    v_add_u32_sdwa v8, v8, v83 dst_sel:DWORD dst_unused:UNUSED_PAD src0_sel:WORD_1 src1_sel:WORD_0
    v_add_u32_sdwa v9, v9, v83 dst_sel:DWORD dst_unused:UNUSED_PAD src0_sel:WORD_1 src1_sel:WORD_1
    v_add_u32 v6, v6, v6
    v_add_u32 v7, v7, v7
    v_add_u32 v8, v8, v8
    v_add_u32 v9, v9, v9
    ds_write_b16 v6, v114 offset:16384
    ds_write_b16_d16_hi v7, v114 offset:16384
    ds_write_b16 v8, v115 offset:16384
    ds_write_b16_d16_hi v9, v115 offset:16384
    v_mad_u32_u16 v6, v87, s50, v15 op_sel:[0,0,0,0]
    v_mad_u32_u16 v7, v87, s50, v15 op_sel:[1,0,0,0]
    v_mad_u32_u16 v8, v91, s50, v15 op_sel:[0,0,0,0]
    v_mad_u32_u16 v9, v91, s50, v15 op_sel:[1,0,0,0]
    v_add_u32_sdwa v6, v6, v87 dst_sel:DWORD dst_unused:UNUSED_PAD src0_sel:WORD_1 src1_sel:WORD_0
    v_add_u32_sdwa v7, v7, v87 dst_sel:DWORD dst_unused:UNUSED_PAD src0_sel:WORD_1 src1_sel:WORD_1
    v_add_u32_sdwa v8, v8, v91 dst_sel:DWORD dst_unused:UNUSED_PAD src0_sel:WORD_1 src1_sel:WORD_0
    v_add_u32_sdwa v9, v9, v91 dst_sel:DWORD dst_unused:UNUSED_PAD src0_sel:WORD_1 src1_sel:WORD_1
    v_add_u32 v6, v6, v6
    v_add_u32 v7, v7, v7
    v_add_u32 v8, v8, v8
    v_add_u32 v9, v9, v9
    ds_write_b16 v6, v116 offset:16384
    ds_write_b16_d16_hi v7, v116 offset:16384
    ds_write_b16 v8, v117 offset:16384
    ds_write_b16_d16_hi v9, v117 offset:16384
    s_add_u32 s35, s33, 53542912
    buffer_load_dwordx4 v[44:47], v1, s[12:15], s35 offen nt
    s_mov_b64 exec, s[44:45]
    v_mad_u32_u16 v6, v95, s50, v15 op_sel:[0,0,0,0]
    v_mad_u32_u16 v7, v95, s50, v15 op_sel:[1,0,0,0]
    v_mad_u32_u16 v8, v99, s50, v15 op_sel:[0,0,0,0]
    v_mad_u32_u16 v9, v99, s50, v15 op_sel:[1,0,0,0]
    v_add_u32_sdwa v6, v6, v95 dst_sel:DWORD dst_unused:UNUSED_PAD src0_sel:WORD_1 src1_sel:WORD_0
    v_add_u32_sdwa v7, v7, v95 dst_sel:DWORD dst_unused:UNUSED_PAD src0_sel:WORD_1 src1_sel:WORD_1
    v_add_u32_sdwa v8, v8, v99 dst_sel:DWORD dst_unused:UNUSED_PAD src0_sel:WORD_1 src1_sel:WORD_0
    v_add_u32_sdwa v9, v9, v99 dst_sel:DWORD dst_unused:UNUSED_PAD src0_sel:WORD_1 src1_sel:WORD_1
    v_add_u32 v6, v6, v6
    v_add_u32 v7, v7, v7
    v_add_u32 v8, v8, v8
    v_add_u32 v9, v9, v9
    ds_write_b16 v6, v118 offset:16384
    ds_write_b16_d16_hi v7, v118 offset:16384
    ds_write_b16 v8, v119 offset:16384
    ds_write_b16_d16_hi v9, v119 offset:16384
    s_mov_b64 exec, -1
    s_mul_i32 s35, s39, 6144
    v_add_u32 v6, s35, v2
    s_waitcnt lgkmcnt(0)
    s_barrier
    ds_read_b64 v[100:101], v6 offset:23040
    ds_read_b64 v[102:103], v6 offset:16384
    ds_read_b64 v[104:105], v6 offset:16896
    ds_read_b64 v[106:107], v6 offset:17408
    ds_read_b64 v[108:109], v6 offset:17920
    ds_read_b64 v[110:111], v6 offset:18432
    ds_read_b64 v[112:113], v6 offset:18944
    ds_read_b64 v[114:115], v6 offset:19456
    ds_read_b64 v[116:117], v6 offset:19968
    ds_read_b64 v[118:119], v6 offset:20480
    ds_read_b64 v[120:121], v6 offset:20992
    ds_read_b64 v[122:123], v6 offset:21504
    ds_read_b64 v[124:125], v6 offset:22016
    ds_read_b64 v[126:127], v6 offset:22528
    s_add_u32 s32, s32, 256
    s_add_u32 s33, s33, 40960000
    s_add_u32 s34, s34, 20480000
    s_add_u32 s40, s40, 1
    s_cmp_lt_u32 s40, 4
    s_cbranch_scc1 L_p1_loop
    s_waitcnt lgkmcnt(13)
    v_lshlrev_b32 v15, 22, v100
    v_lshrrev_b32 v100, 16, v100
    v_alignbit_b32 v15, v100, v15, 10
    v_alignbit_b32 v15, v101, v15, 10
    v_xor_b32 v15, 0x80200800, v15
    s_cmp_lg_u32 s39, 15
    s_cbranch_scc1 L_p1_kernel_nox_12
    s_mov_b32 s36, 13631488
    buffer_store_dwordx4 v[12:15], v3, s[20:23], s36 offen sc1
L_p1_kernel_nox_12:
    s_waitcnt lgkmcnt(12)
    v_lshlrev_b32 v75, 22, v102
    v_lshrrev_b32 v102, 16, v102
    v_alignbit_b32 v75, v102, v75, 10
    v_alignbit_b32 v75, v103, v75, 10
    v_xor_b32 v75, 0x80200800, v75
    s_mov_b32 s36, 0
    buffer_store_dwordx4 v[72:75], v3, s[20:23], s36 offen sc1
    s_waitcnt lgkmcnt(11)
    v_lshlrev_b32 v79, 22, v104
    v_lshrrev_b32 v104, 16, v104
    v_alignbit_b32 v79, v104, v79, 10
    v_alignbit_b32 v79, v105, v79, 10
    v_xor_b32 v79, 0x80200800, v79
    s_mov_b32 s36, 1048576
    buffer_store_dwordx4 v[76:79], v3, s[20:23], s36 offen sc1
    s_waitcnt lgkmcnt(10)
    v_lshlrev_b32 v51, 22, v106
    v_lshrrev_b32 v106, 16, v106
    v_alignbit_b32 v51, v106, v51, 10
    v_alignbit_b32 v51, v107, v51, 10
    v_xor_b32 v51, 0x80200800, v51
    s_mov_b32 s36, 2097152
    buffer_store_dwordx4 v[48:51], v3, s[20:23], s36 offen sc1
    s_waitcnt lgkmcnt(9)
    v_lshlrev_b32 v83, 22, v108
    v_lshrrev_b32 v108, 16, v108
    v_alignbit_b32 v83, v108, v83, 10
    v_alignbit_b32 v83, v109, v83, 10
    v_xor_b32 v83, 0x80200800, v83
    s_mov_b32 s36, 3145728
    buffer_store_dwordx4 v[80:83], v3, s[20:23], s36 offen sc1
    s_waitcnt lgkmcnt(8)
    v_lshlrev_b32 v55, 22, v110
    v_lshrrev_b32 v110, 16, v110
    v_alignbit_b32 v55, v110, v55, 10
    v_alignbit_b32 v55, v111, v55, 10
    v_xor_b32 v55, 0x80200800, v55
    s_mov_b32 s36, 4194304
    buffer_store_dwordx4 v[52:55], v3, s[20:23], s36 offen sc1
    s_waitcnt lgkmcnt(7)
    v_lshlrev_b32 v87, 22, v112
    v_lshrrev_b32 v112, 16, v112
    v_alignbit_b32 v87, v112, v87, 10
    v_alignbit_b32 v87, v113, v87, 10
    v_xor_b32 v87, 0x80200800, v87
    s_mov_b32 s36, 5242880
    buffer_store_dwordx4 v[84:87], v3, s[20:23], s36 offen sc1
    s_waitcnt lgkmcnt(6)
    v_lshlrev_b32 v59, 22, v114
    v_lshrrev_b32 v114, 16, v114
    v_alignbit_b32 v59, v114, v59, 10
    v_alignbit_b32 v59, v115, v59, 10
    v_xor_b32 v59, 0x80200800, v59
    s_mov_b32 s36, 6291456
    buffer_store_dwordx4 v[56:59], v3, s[20:23], s36 offen sc1
    s_waitcnt lgkmcnt(5)
    v_lshlrev_b32 v91, 22, v116
    v_lshrrev_b32 v116, 16, v116
    v_alignbit_b32 v91, v116, v91, 10
    v_alignbit_b32 v91, v117, v91, 10
    v_xor_b32 v91, 0x80200800, v91
    s_mov_b32 s36, 7340032
    buffer_store_dwordx4 v[88:91], v3, s[20:23], s36 offen sc1
    s_waitcnt lgkmcnt(4)
    v_lshlrev_b32 v63, 22, v118
    v_lshrrev_b32 v118, 16, v118
    v_alignbit_b32 v63, v118, v63, 10
    v_alignbit_b32 v63, v119, v63, 10
    v_xor_b32 v63, 0x80200800, v63
    s_mov_b32 s36, 8388608
    buffer_store_dwordx4 v[60:63], v3, s[20:23], s36 offen sc1
    s_waitcnt lgkmcnt(3)
    v_lshlrev_b32 v95, 22, v120
    v_lshrrev_b32 v120, 16, v120
    v_alignbit_b32 v95, v120, v95, 10
    v_alignbit_b32 v95, v121, v95, 10
    v_xor_b32 v95, 0x80200800, v95
    s_mov_b32 s36, 9437184
    buffer_store_dwordx4 v[92:95], v3, s[20:23], s36 offen sc1
    s_waitcnt lgkmcnt(2)
    v_lshlrev_b32 v67, 22, v122
    v_lshrrev_b32 v122, 16, v122
    v_alignbit_b32 v67, v122, v67, 10
    v_alignbit_b32 v67, v123, v67, 10
    v_xor_b32 v67, 0x80200800, v67
    s_mov_b32 s36, 10485760
    buffer_store_dwordx4 v[64:67], v3, s[20:23], s36 offen sc1
    s_waitcnt lgkmcnt(1)
    v_lshlrev_b32 v99, 22, v124
    v_lshrrev_b32 v124, 16, v124
    v_alignbit_b32 v99, v124, v99, 10
    v_alignbit_b32 v99, v125, v99, 10
    v_xor_b32 v99, 0x80200800, v99
    s_mov_b32 s36, 11534336
    buffer_store_dwordx4 v[96:99], v3, s[20:23], s36 offen sc1
    s_waitcnt lgkmcnt(0)
    v_lshlrev_b32 v71, 22, v126
    v_lshrrev_b32 v126, 16, v126
    v_alignbit_b32 v71, v126, v71, 10
    v_alignbit_b32 v71, v127, v71, 10
    v_xor_b32 v71, 0x80200800, v71
    s_mov_b32 s36, 12582912
    buffer_store_dwordx4 v[68:71], v3, s[20:23], s36 offen sc1
    v_and_b32 v6, 0x34800000, v5
    v_cmp_ne_u32 vcc, 0, v6
    s_lshl_b32 s35, s39, 4
    s_add_u32 s35, s35, 160328
    v_mov_b32 v10, s35
    s_cmp_lg_u64 vcc, 0
    s_cselect_b32 s36, 1, s55
    v_mov_b32 v11, s36
    ds_write_b32 v10, v11
    s_waitcnt lgkmcnt(0)
    s_barrier
    s_cmp_lg_u32 s39, 0
    s_cbranch_scc1 L_p1_end
    v_and_b32 v6, 15, v0
    v_lshlrev_b32 v6, 4, v6
    v_add_u32 v6, 160320, v6
    ds_read_b128 v[8:11], v6
    s_waitcnt lgkmcnt(0)
    s_nop 1
    v_max_u32_dpp v8, v8, v8 row_shr:1 row_mask:0xf bank_mask:0xf bound_ctrl:0
    s_nop 1
    v_max_u32_dpp v8, v8, v8 row_shr:2 row_mask:0xf bank_mask:0xf bound_ctrl:0
    s_nop 1
    v_max_u32_dpp v8, v8, v8 row_shr:4 row_mask:0xf bank_mask:0xf bound_ctrl:0
    s_nop 1
    v_max_u32_dpp v8, v8, v8 row_shr:8 row_mask:0xf bank_mask:0xf bound_ctrl:0
    s_nop 1
    v_add_f32_dpp v9, v9, v9 row_shr:1 row_mask:0xf bank_mask:0xf bound_ctrl:0
    s_nop 1
    v_add_f32_dpp v9, v9, v9 row_shr:2 row_mask:0xf bank_mask:0xf bound_ctrl:0
    s_nop 1
    v_add_f32_dpp v9, v9, v9 row_shr:4 row_mask:0xf bank_mask:0xf bound_ctrl:0
    s_nop 1
    v_add_f32_dpp v9, v9, v9 row_shr:8 row_mask:0xf bank_mask:0xf bound_ctrl:0
    s_nop 1
    v_or_b32_dpp v10, v10, v10 row_shr:1 row_mask:0xf bank_mask:0xf bound_ctrl:0
    s_nop 1
    v_or_b32_dpp v10, v10, v10 row_shr:2 row_mask:0xf bank_mask:0xf bound_ctrl:0
    s_nop 1
    v_or_b32_dpp v10, v10, v10 row_shr:4 row_mask:0xf bank_mask:0xf bound_ctrl:0
    s_nop 1
    v_or_b32_dpp v10, v10, v10 row_shr:8 row_mask:0xf bank_mask:0xf bound_ctrl:0
    s_lshl_b32 s35, s2, 3
    s_mov_b32 s26, 8540160
    s_add_u32 s35, s35, 8519680
    v_mov_b32 v6, 0
    v_lshl_or_b32 v8, v10, 16, v8
    s_mov_b64 exec, 0x8000
    buffer_store_dwordx2 v[8:9], v6, s[24:27], s35 offen
    s_lshl_b32 s35, s2, 8
    s_add_u32 s35, s35, 8523776
    buffer_store_dword v6, v6, s[24:27], s35 offen
L_p1_end:
    s_endpgm
.globl p2_kernel
.p2align 8
.type p2_kernel,@function
p2_kernel:
    s_cmp_ge_u32 s2, 256
    s_cbranch_scc1 L_p2_end
    s_load_dwordx2 s[4:5], s[0:1], 104
    s_load_dwordx2 s[100:101], s[0:1], 24
    s_load_dwordx2 s[8:9], s[0:1], 0
    s_load_dwordx2 s[30:31], s[0:1], 40
    s_load_dwordx4 s[32:35], s[0:1], 56
    s_load_dwordx4 s[36:39], s[0:1], 72
    s_and_b32 s14, s2, 7
    s_lshr_b32 s49, s2, 3
    s_and_b32 s3, s14, 1
    s_lshl_b32 s3, s3, 5
    s_add_u32 s3, s3, s49
    s_lshr_b32 s12, s14, 1
    v_lshrrev_b32 v108, 6, v0
    v_lshlrev_b32 v1, 4, v0
    v_and_b32 v109, 63, v0
    v_readfirstlane_b32 s13, v108
    v_lshlrev_b32 v111, 4, v109
    v_lshrrev_b32 v110, 2, v109
    v_mul_u32_u24 v110, 8256, v110
    v_add_u32 v110, v110, v111
    s_mul_i32 s14, s12, 65
    s_add_u32 s14, s14, s3
    s_lshl_b32 s14, s14, 5
    s_mul_i32 s15, s13, 532480
    s_add_u32 s14, s14, s15
    s_add_u32 s25, s14, 0
    s_mul_i32 s22, s12, 1280000
    s_mov_b32 s2, 0
    s_waitcnt lgkmcnt(0)
    s_mov_b32 s6, 655360000
    s_mov_b32 s7, 0x00020000
    s_add_u32 s10, s22, 1280000
    s_mov_b32 s11, 0x00020000
    s_add_u32 s15, s25, 0
    buffer_load_dwordx4 v[28:31], v110, s[4:7], s15 offen
    s_add_u32 s15, s25, 133120
    buffer_load_dwordx4 v[32:35], v110, s[4:7], s15 offen
    s_add_u32 s15, s25, 266240
    buffer_load_dwordx4 v[36:39], v110, s[4:7], s15 offen
    s_add_u32 s15, s25, 399360
    buffer_load_dwordx4 v[40:43], v110, s[4:7], s15 offen
    s_load_dwordx4 s[40:43], s[30:31], 0
    s_load_dwordx16 s[52:67], s[32:33], 0
    s_load_dwordx16 s[68:83], s[34:35], 0
    s_load_dwordx8 s[84:91], s[36:37], 0
    s_load_dwordx8 s[92:99], s[38:39], 0
    v_mov_b32 v52, 0x100
    s_cmp_lg_u32 s13, 0
    s_cbranch_scc1 L_p2_noann
    s_lshl_b32 s14, s3, 8
    s_add_u32 s14, s14, 8523776
    s_mov_b64 exec, 1
    buffer_atomic_add v52, off, s[4:7], s14
    s_mov_b64 exec, -1
L_p2_noann:
    s_add_u32 s14, s22, 0
    buffer_load_dwordx4 v[88:91], v1, s[8:11], s14 offen
    s_add_u32 s14, s22, 16384
    buffer_load_dwordx4 v[92:95], v1, s[8:11], s14 offen
    s_add_u32 s14, s22, 32768
    buffer_load_dwordx4 v[96:99], v1, s[8:11], s14 offen
    s_add_u32 s14, s22, 49152
    buffer_load_dwordx4 v[100:103], v1, s[8:11], s14 offen
    s_add_u32 s14, s22, 65536
    buffer_load_dwordx4 v[104:107], v1, s[8:11], s14 offen
    s_mov_b32 s15, 8519680
    buffer_load_dwordx4 v[80:83], v111, s[4:7], s15 offen offset:0
    buffer_load_dwordx4 v[84:87], v111, s[4:7], s15 offen offset:1024
    v_lshlrev_b32 v2, 10, v109
    v_mov_b32 v50, 21845
    v_add_u32 v3, 80000, v1
    v_add_u32 v124, 145536, v1
    v_add_u32 v113, 65536, v1
    v_mov_b32 v112, 0x7f000000
    v_cmp_gt_u32 vcc, 904, v0
    s_mul_i32 s19, s13, 240
    s_add_u32 s19, s19, 160000
    v_cndmask_b32 v124, v112, v124, vcc
    v_cndmask_b32 v113, v112, v113, vcc
    v_lshl_add_u32 v6, v109, 2, s19
    v_lshl_add_u32 v126, v109, 1, s19
    v_cmp_gt_u32 vcc, 10, v109
    s_lshl_b32 s27, s13, 16
    s_mov_b32 s23, 1024
    v_cndmask_b32 v6, v112, v6, vcc
    s_add_u32 s44, s4, 4194304
    s_addc_u32 s45, s5, 1048576
    s_mov_b32 s46, 14024704
    s_mov_b32 s47, 0x00020000
    s_mov_b32 s18, 80000
    s_and_b32 s50, s3, 1
    s_lshl_b32 s50, s50, 18
    s_sub_u32 s50, 4294836224, s50
    v_lshlrev_b32 v116, 3, v0
    v_and_b32 v116, 16, v116
    v_and_b32 v117, 1, v0
    v_lshl_or_b32 v116, v117, 5, v116
    v_mov_b32 v58, 0x3f80
    v_mov_b32 v59, 0
    v_lshlrev_b64 v[58:59], v116, v[58:59]
    v_mov_b32 v4, 0
    v_mov_b32 v5, 0
    v_mov_b32 v114, 0xff00
    ds_write_b32 v6, v5 offset:160
    ds_write_b16 v126, v114 offset:2
    v_mov_b32 v44, 1073758208
    v_mov_b32 v45, 1073758208
    v_mov_b32 v46, 1073758208
    v_mov_b32 v47, 1073758208
    v_mov_b32 v48, 1073758208
    v_mov_b32 v49, 1073758208
    ds_write_b128 v113, v[44:47]
    v_lshrrev_b32 v115, 4, v109
    v_mul_u32_u24 v115, 15360, v115
    v_lshl_add_u32 v115, v109, 6, v115
    v_lshl_add_u32 v115, v108, 10, v115
    s_waitcnt lgkmcnt(0)
    v_mov_b32 v53, s40
    v_mov_b32 v54, s41
    v_mov_b32 v56, s42
    v_mov_b32 v57, s43
    s_mov_b32 s40, 20987904
    s_mov_b32 s41, 21031594
    s_pack_ll_b32_b16 s14, s52, s54
    s_pack_hh_b32_b16 s15, s52, s54
    s_pack_ll_b32_b16 s54, s53, s55
    s_pack_hh_b32_b16 s55, s53, s55
    s_mov_b32 s52, s14
    s_mov_b32 s53, s15
    s_pack_ll_b32_b16 s14, s56, s58
    s_pack_hh_b32_b16 s15, s56, s58
    s_pack_ll_b32_b16 s58, s57, s59
    s_pack_hh_b32_b16 s59, s57, s59
    s_mov_b32 s56, s14
    s_mov_b32 s57, s15
    s_pack_ll_b32_b16 s14, s60, s62
    s_pack_hh_b32_b16 s15, s60, s62
    s_pack_ll_b32_b16 s62, s61, s63
    s_pack_hh_b32_b16 s63, s61, s63
    s_mov_b32 s60, s14
    s_mov_b32 s61, s15
    s_pack_ll_b32_b16 s14, s64, s66
    s_pack_hh_b32_b16 s15, s64, s66
    s_pack_ll_b32_b16 s66, s65, s67
    s_pack_hh_b32_b16 s67, s65, s67
    s_mov_b32 s64, s14
    s_mov_b32 s65, s15
    s_pack_ll_b32_b16 s14, s68, s70
    s_pack_hh_b32_b16 s15, s68, s70
    s_pack_ll_b32_b16 s70, s69, s71
    s_pack_hh_b32_b16 s71, s69, s71
    s_mov_b32 s68, s14
    s_mov_b32 s69, s15
    s_pack_ll_b32_b16 s14, s72, s74
    s_pack_hh_b32_b16 s15, s72, s74
    s_pack_ll_b32_b16 s74, s73, s75
    s_pack_hh_b32_b16 s75, s73, s75
    s_mov_b32 s72, s14
    s_mov_b32 s73, s15
    s_pack_ll_b32_b16 s14, s76, s78
    s_pack_hh_b32_b16 s15, s76, s78
    s_pack_ll_b32_b16 s78, s77, s79
    s_pack_hh_b32_b16 s79, s77, s79
    s_mov_b32 s76, s14
    s_mov_b32 s77, s15
    s_pack_ll_b32_b16 s14, s80, s82
    s_pack_hh_b32_b16 s15, s80, s82
    s_pack_ll_b32_b16 s82, s81, s83
    s_pack_hh_b32_b16 s83, s81, s83
    s_mov_b32 s80, s14
    s_mov_b32 s81, s15
    s_waitcnt vmcnt(10)
    ds_write_b128 v1, v[28:31] offset:0
    s_waitcnt vmcnt(9)
    ds_write_b128 v1, v[32:35] offset:16384
    s_waitcnt vmcnt(8)
    ds_write_b128 v1, v[36:39] offset:32768
    s_waitcnt vmcnt(7)
    ds_write_b128 v1, v[40:43] offset:49152
    ds_read_b128 v[28:31], v115 offset:0
    ds_read_b128 v[36:39], v115 offset:32
    ds_read_b128 v[32:35], v115 offset:16
    ds_read_b128 v[40:43], v115 offset:48
    ds_write_b128 v1, v[44:47] offset:0
    ds_write_b128 v1, v[44:47] offset:16384
    ds_write_b128 v1, v[44:47] offset:32768
    ds_write_b128 v1, v[44:47] offset:49152
    s_waitcnt lgkmcnt(6)
    v_mad_u32_u16 v108, v28, v50, s40 op_sel:[0,0,0,0]
    v_mad_u32_u16 v109, v36, v50, s41 op_sel:[0,0,0,0]
    v_sub_u32_sdwa v110, v109, v108 dst_sel:DWORD dst_unused:UNUSED_PAD src0_sel:WORD_1 src1_sel:WORD_1
    s_nop 1
    v_add_u32_dpp v110, v110, v110 row_shr:1 row_mask:0xf bank_mask:0xf bound_ctrl:0
    s_nop 1
    v_add_u32_dpp v110, v110, v110 row_shr:2 row_mask:0xf bank_mask:0xf bound_ctrl:0
    s_nop 1
    v_add_u32_dpp v110, v110, v110 row_shr:4 row_mask:0xf bank_mask:0xf bound_ctrl:0
    s_nop 1
    v_add_u32_dpp v110, v110, v110 row_shr:8 row_mask:0xf bank_mask:0xf bound_ctrl:0
    s_nop 1
    v_add_u32_dpp v110, v110, v110 row_bcast:15 row_mask:0xa bank_mask:0xf
    s_nop 1
    v_add_u32_dpp v110, v110, v110 row_bcast:31 row_mask:0xc bank_mask:0xf
    v_sub_u32_sdwa v109, v109, v110 dst_sel:DWORD dst_unused:UNUSED_PAD src0_sel:WORD_1 src1_sel:DWORD
    v_readlane_b32 s29, v110, 63
    v_add_u32 v110, -1, v110
    ds_write_b16 v126, v109
    v_lshlrev_b32_e64 v111, v110, 1
    v_lshrrev_b32 v110, 5, v110
    v_lshl_add_u32 v110, v110, 2, s19
    s_cmp_gt_u32 s29, 320
    s_cselect_b32 s2, 1, s2
    s_cselect_b64 exec, 0, -1
    ds_or_b32 v110, v111 offset:160
    s_mov_b64 exec, -1
    ds_wrxchg_rtn_b32 v7, v6, v5 offset:160
    s_waitcnt lgkmcnt(0)
    v_readlane_b32 s30, v7, 0
    v_readlane_b32 s31, v7, 1
    v_readlane_b32 s32, v7, 2
    v_readlane_b32 s33, v7, 3
    v_readlane_b32 s34, v7, 4
    v_readlane_b32 s35, v7, 5
    v_readlane_b32 s36, v7, 6
    v_readlane_b32 s37, v7, 7
    s_mov_b32 s25, s19
    s_mov_b32 s26, s27
    s_mov_b32 s51, s28
    s_mov_b32 s28, s29
    v_mbcnt_lo_u32_b32 v8, s30, 0
    v_mbcnt_hi_u32_b32 v8, s31, v8
    s_bcnt1_i32_b64 s14, s[30:31]
    v_lshl_add_u32 v9, v8, 1, s25
    ds_read_u16 v9, v9
    s_add_u32 s30, s26, 0
    s_lshl1_add_u32 s25, s14, s25
    s_lshl_b32 s14, s14, 10
    s_add_u32 s26, s26, s14
    v_mbcnt_lo_u32_b32 v12, s32, 0
    v_mbcnt_hi_u32_b32 v12, s33, v12
    s_bcnt1_i32_b64 s14, s[32:33]
    v_lshl_add_u32 v13, v12, 1, s25
    ds_read_u16 v13, v13
    s_add_u32 s32, s26, 1048576
    s_lshl1_add_u32 s25, s14, s25
    s_lshl_b32 s14, s14, 10
    s_add_u32 s26, s26, s14
    v_mbcnt_lo_u32_b32 v16, s34, 0
    v_mbcnt_hi_u32_b32 v16, s35, v16
    s_bcnt1_i32_b64 s14, s[34:35]
    v_lshl_add_u32 v17, v16, 1, s25
    ds_read_u16 v17, v17
    s_add_u32 s34, s26, 2097152
    s_lshl1_add_u32 s25, s14, s25
    s_lshl_b32 s14, s14, 10
    s_add_u32 s26, s26, s14
    v_mbcnt_lo_u32_b32 v20, s36, 0
    v_mbcnt_hi_u32_b32 v20, s37, v20
    s_bcnt1_i32_b64 s14, s[36:37]
    v_lshl_add_u32 v21, v20, 1, s25
    ds_read_u16 v21, v21
    s_add_u32 s36, s26, 3145728
    s_lshl1_add_u32 s25, s14, s25
    s_lshl_b32 s14, s14, 10
    s_add_u32 s26, s26, s14
    s_waitcnt lgkmcnt(3)
    v_mad_u32_u16 v9, v9, s23, v2
    v_pk_lshrrev_b16 v9, 10, v9 op_sel_hi:[1,1]
    v_lshl_add_u32 v8, v8, 6, v9
    buffer_load_dwordx4 v[8:11], v8, s[44:47], s30 idxen
    s_waitcnt lgkmcnt(2)
    v_mad_u32_u16 v13, v13, s23, v2
    v_pk_lshrrev_b16 v13, 10, v13 op_sel_hi:[1,1]
    v_lshl_add_u32 v12, v12, 6, v13
    buffer_load_dwordx4 v[12:15], v12, s[44:47], s32 idxen
    s_waitcnt lgkmcnt(1)
    v_mad_u32_u16 v17, v17, s23, v2
    v_pk_lshrrev_b16 v17, 10, v17 op_sel_hi:[1,1]
    v_lshl_add_u32 v16, v16, 6, v17
    buffer_load_dwordx4 v[16:19], v16, s[44:47], s34 idxen
    s_waitcnt lgkmcnt(0)
    v_mad_u32_u16 v21, v21, s23, v2
    v_pk_lshrrev_b16 v21, 10, v21 op_sel_hi:[1,1]
    v_lshl_add_u32 v20, v20, 6, v21
    buffer_load_dwordx4 v[20:23], v20, s[44:47], s36 idxen
    s_cmp_le_u32 s28, 256
    s_cbranch_scc1 L_p2_kernel_noopt_1
    v_readlane_b32 s38, v7, 8
    v_readlane_b32 s39, v7, 9
    s_nop 1
    v_mbcnt_lo_u32_b32 v62, s38, 0
    v_mbcnt_hi_u32_b32 v62, s39, v62
    s_bcnt1_i32_b64 s14, s[38:39]
    v_lshl_add_u32 v63, v62, 1, s25
    ds_read_u16 v63, v63
    s_add_u32 s38, s26, 4194304
    s_lshl1_add_u32 s25, s14, s25
    s_lshl_b32 s14, s14, 10
    s_add_u32 s26, s26, s14
    s_waitcnt lgkmcnt(0)
    v_mad_u32_u16 v63, v63, s23, v2
    v_pk_lshrrev_b16 v63, 10, v63 op_sel_hi:[1,1]
    v_lshl_add_u32 v62, v62, 6, v63
    buffer_load_dwordx4 v[24:27], v62, s[44:47], s38 idxen
L_p2_kernel_noopt_1:
    s_waitcnt vmcnt(6)
    ds_write_b128 v3, v[88:91] offset:0
    ds_write_b128 v3, v[92:95] offset:16384
    ds_write_b128 v3, v[96:99] offset:32768
    ds_write_b128 v3, v[100:103] offset:49152
    ds_write_b128 v124, v[104:107] offset:0
    s_waitcnt vmcnt(4)
    v_max3_u32 v64, v80, v82, v84
    v_add_f32 v65, v81, v83
    v_add_f32 v66, v85, v87
    v_max_u32 v64, v64, v86
    v_add_f32 v65, v65, v66
    v_cmp_lt_u32 vcc, 0xffff, v64
    s_nop 1
    v_max_u32_dpp v64, v64, v64 row_shr:1 row_mask:0xf bank_mask:0xf bound_ctrl:0
    s_nop 1
    v_max_u32_dpp v64, v64, v64 row_shr:2 row_mask:0xf bank_mask:0xf bound_ctrl:0
    s_nop 1
    v_max_u32_dpp v64, v64, v64 row_shr:4 row_mask:0xf bank_mask:0xf bound_ctrl:0
    s_nop 1
    v_max_u32_dpp v64, v64, v64 row_shr:8 row_mask:0xf bank_mask:0xf bound_ctrl:0
    s_nop 1
    v_max_u32_dpp v64, v64, v64 row_bcast:15 row_mask:0xa bank_mask:0xf
    s_nop 1
    v_max_u32_dpp v64, v64, v64 row_bcast:31 row_mask:0xc bank_mask:0xf
    s_nop 1
    v_add_f32_dpp v65, v65, v65 row_shr:1 row_mask:0xf bank_mask:0xf bound_ctrl:0
    s_nop 1
    v_add_f32_dpp v65, v65, v65 row_shr:2 row_mask:0xf bank_mask:0xf bound_ctrl:0
    s_nop 1
    v_add_f32_dpp v65, v65, v65 row_shr:4 row_mask:0xf bank_mask:0xf bound_ctrl:0
    s_nop 1
    v_add_f32_dpp v65, v65, v65 row_shr:8 row_mask:0xf bank_mask:0xf bound_ctrl:0
    s_nop 1
    v_add_f32_dpp v65, v65, v65 row_bcast:15 row_mask:0xa bank_mask:0xf
    s_nop 1
    v_add_f32_dpp v65, v65, v65 row_bcast:31 row_mask:0xc bank_mask:0xf
    s_cmp_lg_u64 vcc, 0
    s_cselect_b32 s2, 1, s2
    v_lshlrev_b32 v64, 16, v64
    v_mul_f32 v66, 936490775, v65
    v_mul_f32 v65, 928531664, v65
    v_cmp_nle_f32 vcc, v64, v66
    v_max_u32 v64, v64, v65
    s_nop 0
    v_readlane_b32 s14, v64, 63
    s_bitcmp1_b32 vcc_hi, 31
    s_cselect_b32 s2, 1, s2
    s_lshr_b32 s14, s14, 23
    s_add_u32 s14, s14, 1
    s_cmp_lt_u32 s14, 40
    s_cselect_b32 s2, 1, s2
    s_cmp_gt_u32 s14, 230
    s_cselect_b32 s2, 1, s2
    s_sub_u32 s48, s14, 14
    s_lshl_b32 s48, s48, 23
    s_add_u32 s16, s48, 272629760
    s_lshr_b32 s15, s16, 16
    s_sub_u32 s15, 0x10000, s15
    s_add_u32 s20, s16, s15
    s_sub_u32 s17, s20, 1
    s_mov_b32 s21, s17
    s_or_b32 s48, s48, 16416
    s_sub_u32 s14, s14, 40
    s_cmp_gt_u32 s14, 190
    s_cselect_b32 s48, 0, s48
    s_waitcnt lgkmcnt(0)
    s_barrier
    s_add_u32 s14, s22, 80000
    buffer_load_dwordx4 v[88:91], v1, s[8:11], s14 offen
    s_add_u32 s14, s22, 96384
    buffer_load_dwordx4 v[92:95], v1, s[8:11], s14 offen
    v_mad_u32_u16 v108, v28, v50, s40 op_sel:[1,0,0,0]
    v_mad_u32_u16 v109, v36, v50, s41 op_sel:[1,0,0,0]
    v_sub_u32_sdwa v110, v109, v108 dst_sel:DWORD dst_unused:UNUSED_PAD src0_sel:WORD_1 src1_sel:WORD_1
    s_nop 1
    v_add_u32_dpp v110, v110, v110 row_shr:1 row_mask:0xf bank_mask:0xf bound_ctrl:0
    s_nop 1
    v_add_u32_dpp v110, v110, v110 row_shr:2 row_mask:0xf bank_mask:0xf bound_ctrl:0
    s_nop 1
    v_add_u32_dpp v110, v110, v110 row_shr:4 row_mask:0xf bank_mask:0xf bound_ctrl:0
    s_nop 1
    v_add_u32_dpp v110, v110, v110 row_shr:8 row_mask:0xf bank_mask:0xf bound_ctrl:0
    s_nop 1
    v_add_u32_dpp v110, v110, v110 row_bcast:15 row_mask:0xa bank_mask:0xf
    s_nop 1
    v_add_u32_dpp v110, v110, v110 row_bcast:31 row_mask:0xc bank_mask:0xf
    v_sub_u32_sdwa v109, v109, v110 dst_sel:DWORD dst_unused:UNUSED_PAD src0_sel:WORD_1 src1_sel:DWORD
    v_readlane_b32 s29, v110, 63
    v_add_u32 v110, -1, v110
    ds_write_b16 v126, v109
    v_lshlrev_b32_e64 v111, v110, 1
    v_lshrrev_b32 v110, 5, v110
    v_lshl_add_u32 v110, v110, 2, s19
    s_cmp_gt_u32 s29, 320
    s_cselect_b32 s2, 1, s2
    s_cselect_b64 exec, 0, -1
    ds_or_b32 v110, v111 offset:160
    s_mov_b64 exec, -1
    ds_wrxchg_rtn_b32 v7, v6, v5 offset:160
    s_mov_b32 s24, 0
L_p2_loop:
    s_add_u32 s22, s22, 80000
    s_lshl_b32 s14, s13, 4
    s_or_b32 s14, s14, s24
    s_cmp_lg_u32 s14, 5
    s_cbranch_scc1 L_p2_nost
    v_mov_b32 v52, 0
    s_lshl_b32 s14, s3, 8
    s_add_u32 s14, s14, 8523776
    s_mov_b64 exec, 1
    buffer_atomic_add v52, off, s[4:7], s14 sc0
    s_mov_b64 exec, -1
L_p2_nost:
    s_waitcnt vmcnt(5)
    v_mad_u32_u16 v64, v8, 8, s18
    v_mad_u32_u16 v66, v9, 8, s18
    v_mad_u32_u16 v68, v10, 8, s18
    ds_read_b64 v[64:65], v64
    ds_read_b64 v[66:67], v66
    ds_read_b64 v[68:69], v68
    s_add_u32 s14, s22, 32768
    buffer_load_dwordx4 v[96:99], v1, s[8:11], s14 offen
    s_waitcnt vmcnt(5)
    v_mad_u32_u16 v70, v12, 8, s18
    v_mad_u32_u16 v72, v13, 8, s18
    v_mad_u32_u16 v74, v14, 8, s18
    ds_read_b64 v[70:71], v70
    ds_read_b64 v[72:73], v72
    ds_read_b64 v[74:75], v74
    s_add_u32 s14, s22, 49152
    buffer_load_dwordx4 v[100:103], v1, s[8:11], s14 offen
    s_waitcnt lgkmcnt(6)
    v_readlane_b32 s30, v7, 0
    v_readlane_b32 s31, v7, 1
    v_readlane_b32 s32, v7, 2
    v_readlane_b32 s33, v7, 3
    v_readlane_b32 s34, v7, 4
    v_readlane_b32 s35, v7, 5
    v_readlane_b32 s36, v7, 6
    v_readlane_b32 s37, v7, 7
    s_mov_b32 s25, s19
    s_mov_b32 s26, s27
    s_mov_b32 s51, s28
    s_mov_b32 s28, s29
    v_mbcnt_lo_u32_b32 v51, s30, 0
    v_mbcnt_hi_u32_b32 v51, s31, v51
    s_bcnt1_i32_b64 s14, s[30:31]
    v_lshl_add_u32 v55, v51, 1, s25
    ds_read_u16 v55, v55
    s_add_u32 s30, s26, 0
    s_lshl1_add_u32 s25, s14, s25
    s_lshl_b32 s14, s14, 10
    s_add_u32 s26, s26, s14
    v_bfe_i32 v108, v11, 2, 10
    v_bfe_i32 v109, v11, 12, 10
    v_ashrrev_i32 v110, 22, v11
    v_cvt_f32_i32 v108, v108
    v_cvt_f32_i32 v109, v109
    v_cvt_f32_i32 v110, v110
    s_waitcnt lgkmcnt(4)
    v_mfma_f32_4x4x4_16b_bf16 v[112:115], v[58:59], v[64:65], 0
    v_mfma_f32_4x4x4_16b_bf16 v[116:119], v[58:59], v[66:67], 0
    v_mfma_f32_4x4x4_16b_bf16 v[120:123], v[58:59], v[68:69], 0
    v_mad_u32_u16 v8, v8, 8, s50 op_sel:[1,0,0,0]
    v_mad_u32_u16 v9, v9, 8, s50 op_sel:[1,0,0,0]
    v_mad_u32_u16 v10, v10, 8, s50 op_sel:[1,0,0,0]
    v_pk_fma_f32 v[114:115], v[114:115], v[108:109], s[20:21] op_sel:[0,0,0] op_sel_hi:[1,0,1]
    v_pk_fma_f32 v[112:113], v[112:113], v[108:109], s[16:17] op_sel:[0,0,0] op_sel_hi:[1,0,1]
    v_pk_fma_f32 v[118:119], v[118:119], v[108:109], s[20:21] op_sel:[0,1,0] op_sel_hi:[1,1,1]
    v_pk_fma_f32 v[116:117], v[116:117], v[108:109], s[16:17] op_sel:[0,1,0] op_sel_hi:[1,1,1]
    v_pk_fma_f32 v[122:123], v[122:123], v[110:111], s[20:21] op_sel:[0,0,0] op_sel_hi:[1,0,1]
    v_pk_fma_f32 v[120:121], v[120:121], v[110:111], s[16:17] op_sel:[0,0,0] op_sel_hi:[1,0,1]
    v_lshlrev_b64 v[114:115], 16, v[114:115]
    v_lshlrev_b64 v[118:119], 16, v[118:119]
    v_lshlrev_b64 v[122:123], 16, v[122:123]
    v_lshl_add_u64 v[64:65], v[112:113], 0, v[114:115]
    v_lshl_add_u64 v[66:67], v[116:117], 0, v[118:119]
    v_lshl_add_u64 v[68:69], v[120:121], 0, v[122:123]
    v_or3_b32 v4, v44, v45, v4
    v_or3_b32 v4, v46, v47, v4
    v_or3_b32 v4, v48, v49, v4
    ds_add_rtn_u64 v[44:45], v8, v[64:65]
    ds_add_rtn_u64 v[46:47], v9, v[66:67]
    ds_add_rtn_u64 v[48:49], v10, v[68:69]
    s_waitcnt lgkmcnt(3)
    v_mad_u32_u16 v55, v55, s23, v2
    v_pk_lshrrev_b16 v55, 10, v55 op_sel_hi:[1,1]
    v_lshl_add_u32 v51, v51, 6, v55
    buffer_load_dwordx4 v[8:11], v51, s[44:47], s30 idxen
    s_add_u32 s14, s22, 65536
    buffer_load_dwordx4 v[104:107], v1, s[8:11], s14 offen
    s_waitcnt vmcnt(7)
    v_mad_u32_u16 v76, v16, 8, s18
    v_mad_u32_u16 v78, v17, 8, s18
    v_mad_u32_u16 v80, v18, 8, s18
    ds_read_b64 v[76:77], v76
    ds_read_b64 v[78:79], v78
    ds_read_b64 v[80:81], v80
    s_waitcnt vmcnt(6)
    v_mad_u32_u16 v82, v20, 8, s18
    v_mad_u32_u16 v84, v21, 8, s18
    v_mad_u32_u16 v86, v22, 8, s18
    ds_read_b64 v[82:83], v82
    ds_read_b64 v[84:85], v84
    ds_read_b64 v[86:87], v86
    v_mbcnt_lo_u32_b32 v51, s32, 0
    v_mbcnt_hi_u32_b32 v51, s33, v51
    s_bcnt1_i32_b64 s14, s[32:33]
    v_lshl_add_u32 v55, v51, 1, s25
    ds_read_u16 v55, v55
    s_add_u32 s32, s26, 1048576
    s_lshl1_add_u32 s25, s14, s25
    s_lshl_b32 s14, s14, 10
    s_add_u32 s26, s26, s14
    v_bfe_i32 v108, v15, 2, 10
    v_bfe_i32 v109, v15, 12, 10
    v_ashrrev_i32 v110, 22, v15
    v_cvt_f32_i32 v108, v108
    v_cvt_f32_i32 v109, v109
    v_cvt_f32_i32 v110, v110
    v_mfma_f32_4x4x4_16b_bf16 v[112:115], v[58:59], v[70:71], 0
    v_mfma_f32_4x4x4_16b_bf16 v[116:119], v[58:59], v[72:73], 0
    v_mfma_f32_4x4x4_16b_bf16 v[120:123], v[58:59], v[74:75], 0
    v_mad_u32_u16 v12, v12, 8, s50 op_sel:[1,0,0,0]
    v_mad_u32_u16 v13, v13, 8, s50 op_sel:[1,0,0,0]
    v_mad_u32_u16 v14, v14, 8, s50 op_sel:[1,0,0,0]
    v_pk_fma_f32 v[114:115], v[114:115], v[108:109], s[20:21] op_sel:[0,0,0] op_sel_hi:[1,0,1]
    v_pk_fma_f32 v[112:113], v[112:113], v[108:109], s[16:17] op_sel:[0,0,0] op_sel_hi:[1,0,1]
    v_pk_fma_f32 v[118:119], v[118:119], v[108:109], s[20:21] op_sel:[0,1,0] op_sel_hi:[1,1,1]
    v_pk_fma_f32 v[116:117], v[116:117], v[108:109], s[16:17] op_sel:[0,1,0] op_sel_hi:[1,1,1]
    v_pk_fma_f32 v[122:123], v[122:123], v[110:111], s[20:21] op_sel:[0,0,0] op_sel_hi:[1,0,1]
    v_pk_fma_f32 v[120:121], v[120:121], v[110:111], s[16:17] op_sel:[0,0,0] op_sel_hi:[1,0,1]
    v_lshlrev_b64 v[114:115], 16, v[114:115]
    v_lshlrev_b64 v[118:119], 16, v[118:119]
    v_lshlrev_b64 v[122:123], 16, v[122:123]
    v_lshl_add_u64 v[70:71], v[112:113], 0, v[114:115]
    v_lshl_add_u64 v[72:73], v[116:117], 0, v[118:119]
    v_lshl_add_u64 v[74:75], v[120:121], 0, v[122:123]
    s_waitcnt lgkmcnt(7)
    v_or3_b32 v4, v44, v45, v4
    v_or3_b32 v4, v46, v47, v4
    v_or3_b32 v4, v48, v49, v4
    ds_add_rtn_u64 v[44:45], v12, v[70:71]
    ds_add_rtn_u64 v[46:47], v13, v[72:73]
    ds_add_rtn_u64 v[48:49], v14, v[74:75]
    s_waitcnt lgkmcnt(3)
    v_mad_u32_u16 v55, v55, s23, v2
    v_pk_lshrrev_b16 v55, 10, v55 op_sel_hi:[1,1]
    v_lshl_add_u32 v51, v51, 6, v55
    buffer_load_dwordx4 v[12:15], v51, s[44:47], s32 idxen
    s_cmp_le_u32 s51, 256
    s_cbranch_scc1 L_p2_kernel_noopt2_2
    v_mad_u32_u16 v64, v24, 8, s18
    v_mad_u32_u16 v66, v25, 8, s18
    v_mad_u32_u16 v68, v26, 8, s18
    ds_read_b64 v[64:65], v64
    ds_read_b64 v[66:67], v66
    ds_read_b64 v[68:69], v68
    v_bfe_i32 v108, v27, 2, 10
    v_bfe_i32 v109, v27, 12, 10
    v_ashrrev_i32 v110, 22, v27
    v_cvt_f32_i32 v108, v108
    v_cvt_f32_i32 v109, v109
    v_cvt_f32_i32 v110, v110
    s_waitcnt lgkmcnt(0)
    v_mfma_f32_4x4x4_16b_bf16 v[112:115], v[58:59], v[64:65], 0
    v_mfma_f32_4x4x4_16b_bf16 v[116:119], v[58:59], v[66:67], 0
    v_mfma_f32_4x4x4_16b_bf16 v[120:123], v[58:59], v[68:69], 0
    v_mad_u32_u16 v24, v24, 8, s50 op_sel:[1,0,0,0]
    v_mad_u32_u16 v25, v25, 8, s50 op_sel:[1,0,0,0]
    v_mad_u32_u16 v26, v26, 8, s50 op_sel:[1,0,0,0]
    v_pk_fma_f32 v[114:115], v[114:115], v[108:109], s[20:21] op_sel:[0,0,0] op_sel_hi:[1,0,1]
    v_pk_fma_f32 v[112:113], v[112:113], v[108:109], s[16:17] op_sel:[0,0,0] op_sel_hi:[1,0,1]
    v_pk_fma_f32 v[118:119], v[118:119], v[108:109], s[20:21] op_sel:[0,1,0] op_sel_hi:[1,1,1]
    v_pk_fma_f32 v[116:117], v[116:117], v[108:109], s[16:17] op_sel:[0,1,0] op_sel_hi:[1,1,1]
    v_pk_fma_f32 v[122:123], v[122:123], v[110:111], s[20:21] op_sel:[0,0,0] op_sel_hi:[1,0,1]
    v_pk_fma_f32 v[120:121], v[120:121], v[110:111], s[16:17] op_sel:[0,0,0] op_sel_hi:[1,0,1]
    v_lshlrev_b64 v[114:115], 16, v[114:115]
    v_lshlrev_b64 v[118:119], 16, v[118:119]
    v_lshlrev_b64 v[122:123], 16, v[122:123]
    v_lshl_add_u64 v[64:65], v[112:113], 0, v[114:115]
    v_lshl_add_u64 v[66:67], v[116:117], 0, v[118:119]
    v_lshl_add_u64 v[68:69], v[120:121], 0, v[122:123]
    v_or3_b32 v4, v44, v45, v4
    v_or3_b32 v4, v46, v47, v4
    v_or3_b32 v4, v48, v49, v4
    ds_add_rtn_u64 v[44:45], v24, v[64:65]
    ds_add_rtn_u64 v[46:47], v25, v[66:67]
    ds_add_rtn_u64 v[48:49], v26, v[68:69]
L_p2_kernel_noopt2_2:
    s_barrier
    s_waitcnt vmcnt(1)
    ds_write_b128 v3, v[88:91] offset:0
    ds_write_b128 v3, v[92:95] offset:16384
    ds_write_b128 v3, v[96:99] offset:32768
    ds_write_b128 v3, v[100:103] offset:49152
    ds_write_b128 v124, v[104:107] offset:0
    v_mbcnt_lo_u32_b32 v51, s34, 0
    v_mbcnt_hi_u32_b32 v51, s35, v51
    s_bcnt1_i32_b64 s14, s[34:35]
    v_lshl_add_u32 v55, v51, 1, s25
    ds_read_u16 v55, v55
    s_add_u32 s34, s26, 2097152
    s_lshl1_add_u32 s25, s14, s25
    s_lshl_b32 s14, s14, 10
    s_add_u32 s26, s26, s14
    v_bfe_i32 v108, v19, 2, 10
    v_bfe_i32 v109, v19, 12, 10
    v_ashrrev_i32 v110, 22, v19
    v_cvt_f32_i32 v108, v108
    v_cvt_f32_i32 v109, v109
    v_cvt_f32_i32 v110, v110
    v_mfma_f32_4x4x4_16b_bf16 v[112:115], v[58:59], v[76:77], 0
    v_mfma_f32_4x4x4_16b_bf16 v[116:119], v[58:59], v[78:79], 0
    v_mfma_f32_4x4x4_16b_bf16 v[120:123], v[58:59], v[80:81], 0
    v_mad_u32_u16 v16, v16, 8, s50 op_sel:[1,0,0,0]
    v_mad_u32_u16 v17, v17, 8, s50 op_sel:[1,0,0,0]
    v_mad_u32_u16 v18, v18, 8, s50 op_sel:[1,0,0,0]
    v_pk_fma_f32 v[114:115], v[114:115], v[108:109], s[20:21] op_sel:[0,0,0] op_sel_hi:[1,0,1]
    v_pk_fma_f32 v[112:113], v[112:113], v[108:109], s[16:17] op_sel:[0,0,0] op_sel_hi:[1,0,1]
    v_pk_fma_f32 v[118:119], v[118:119], v[108:109], s[20:21] op_sel:[0,1,0] op_sel_hi:[1,1,1]
    v_pk_fma_f32 v[116:117], v[116:117], v[108:109], s[16:17] op_sel:[0,1,0] op_sel_hi:[1,1,1]
    v_pk_fma_f32 v[122:123], v[122:123], v[110:111], s[20:21] op_sel:[0,0,0] op_sel_hi:[1,0,1]
    v_pk_fma_f32 v[120:121], v[120:121], v[110:111], s[16:17] op_sel:[0,0,0] op_sel_hi:[1,0,1]
    v_lshlrev_b64 v[114:115], 16, v[114:115]
    v_lshlrev_b64 v[118:119], 16, v[118:119]
    v_lshlrev_b64 v[122:123], 16, v[122:123]
    v_lshl_add_u64 v[76:77], v[112:113], 0, v[114:115]
    v_lshl_add_u64 v[78:79], v[116:117], 0, v[118:119]
    v_lshl_add_u64 v[80:81], v[120:121], 0, v[122:123]
    s_waitcnt lgkmcnt(6)
    v_or3_b32 v4, v44, v45, v4
    v_or3_b32 v4, v46, v47, v4
    v_or3_b32 v4, v48, v49, v4
    ds_add_rtn_u64 v[44:45], v16, v[76:77]
    ds_add_rtn_u64 v[46:47], v17, v[78:79]
    ds_add_rtn_u64 v[48:49], v18, v[80:81]
    s_waitcnt lgkmcnt(3)
    v_mad_u32_u16 v55, v55, s23, v2
    v_pk_lshrrev_b16 v55, 10, v55 op_sel_hi:[1,1]
    v_lshl_add_u32 v51, v51, 6, v55
    buffer_load_dwordx4 v[16:19], v51, s[44:47], s34 idxen
    v_mbcnt_lo_u32_b32 v51, s36, 0
    v_mbcnt_hi_u32_b32 v51, s37, v51
    s_bcnt1_i32_b64 s14, s[36:37]
    v_lshl_add_u32 v55, v51, 1, s25
    ds_read_u16 v55, v55
    s_add_u32 s36, s26, 3145728
    s_lshl1_add_u32 s25, s14, s25
    s_lshl_b32 s14, s14, 10
    s_add_u32 s26, s26, s14
    v_bfe_i32 v108, v23, 2, 10
    v_bfe_i32 v109, v23, 12, 10
    v_ashrrev_i32 v110, 22, v23
    v_cvt_f32_i32 v108, v108
    v_cvt_f32_i32 v109, v109
    v_cvt_f32_i32 v110, v110
    v_mfma_f32_4x4x4_16b_bf16 v[112:115], v[58:59], v[82:83], 0
    v_mfma_f32_4x4x4_16b_bf16 v[116:119], v[58:59], v[84:85], 0
    v_mfma_f32_4x4x4_16b_bf16 v[120:123], v[58:59], v[86:87], 0
    v_mad_u32_u16 v20, v20, 8, s50 op_sel:[1,0,0,0]
    v_mad_u32_u16 v21, v21, 8, s50 op_sel:[1,0,0,0]
    v_mad_u32_u16 v22, v22, 8, s50 op_sel:[1,0,0,0]
    v_pk_fma_f32 v[114:115], v[114:115], v[108:109], s[20:21] op_sel:[0,0,0] op_sel_hi:[1,0,1]
    v_pk_fma_f32 v[112:113], v[112:113], v[108:109], s[16:17] op_sel:[0,0,0] op_sel_hi:[1,0,1]
    v_pk_fma_f32 v[118:119], v[118:119], v[108:109], s[20:21] op_sel:[0,1,0] op_sel_hi:[1,1,1]
    v_pk_fma_f32 v[116:117], v[116:117], v[108:109], s[16:17] op_sel:[0,1,0] op_sel_hi:[1,1,1]
    v_pk_fma_f32 v[122:123], v[122:123], v[110:111], s[20:21] op_sel:[0,0,0] op_sel_hi:[1,0,1]
    v_pk_fma_f32 v[120:121], v[120:121], v[110:111], s[16:17] op_sel:[0,0,0] op_sel_hi:[1,0,1]
    v_lshlrev_b64 v[114:115], 16, v[114:115]
    v_lshlrev_b64 v[118:119], 16, v[118:119]
    v_lshlrev_b64 v[122:123], 16, v[122:123]
    v_lshl_add_u64 v[82:83], v[112:113], 0, v[114:115]
    v_lshl_add_u64 v[84:85], v[116:117], 0, v[118:119]
    v_lshl_add_u64 v[86:87], v[120:121], 0, v[122:123]
    s_waitcnt lgkmcnt(1)
    v_or3_b32 v4, v44, v45, v4
    v_or3_b32 v4, v46, v47, v4
    v_or3_b32 v4, v48, v49, v4
    ds_add_rtn_u64 v[44:45], v20, v[82:83]
    ds_add_rtn_u64 v[46:47], v21, v[84:85]
    ds_add_rtn_u64 v[48:49], v22, v[86:87]
    s_waitcnt lgkmcnt(3)
    v_mad_u32_u16 v55, v55, s23, v2
    v_pk_lshrrev_b16 v55, 10, v55 op_sel_hi:[1,1]
    v_lshl_add_u32 v51, v51, 6, v55
    buffer_load_dwordx4 v[20:23], v51, s[44:47], s36 idxen
    s_cmp_le_u32 s28, 256
    s_cbranch_scc1 L_p2_kernel_noopt_3
    v_readlane_b32 s38, v7, 8
    v_readlane_b32 s39, v7, 9
    s_nop 1
    v_mbcnt_lo_u32_b32 v62, s38, 0
    v_mbcnt_hi_u32_b32 v62, s39, v62
    s_bcnt1_i32_b64 s14, s[38:39]
    v_lshl_add_u32 v63, v62, 1, s25
    ds_read_u16 v63, v63
    s_add_u32 s38, s26, 4194304
    s_lshl1_add_u32 s25, s14, s25
    s_lshl_b32 s14, s14, 10
    s_add_u32 s26, s26, s14
    s_waitcnt lgkmcnt(0)
    v_mad_u32_u16 v63, v63, s23, v2
    v_pk_lshrrev_b16 v63, 10, v63 op_sel_hi:[1,1]
    v_lshl_add_u32 v62, v62, 6, v63
    buffer_load_dwordx4 v[24:27], v62, s[44:47], s38 idxen
L_p2_kernel_noopt_3:
    v_pk_mov_b32 v[28:29], v[28:29], v[30:31] op_sel:[1,0]
    v_pk_mov_b32 v[30:31], v[30:31], v[32:33] op_sel:[1,0]
    v_pk_mov_b32 v[32:33], v[32:33], v[34:35] op_sel:[1,0]
    v_pk_mov_b32 v[34:35], v[34:35], v[4:5] op_sel:[1,1]
    v_pk_mov_b32 v[36:37], v[36:37], v[38:39] op_sel:[1,0]
    v_pk_mov_b32 v[38:39], v[38:39], v[40:41] op_sel:[1,0]
    v_pk_mov_b32 v[40:41], v[40:41], v[42:43] op_sel:[1,0]
    v_pk_mov_b32 v[42:43], v[42:43], v[4:5] op_sel:[1,1]
    v_mad_u32_u16 v108, v28, v50, s40 op_sel:[0,0,0,0]
    v_mad_u32_u16 v109, v36, v50, s41 op_sel:[0,0,0,0]
    v_sub_u32_sdwa v110, v109, v108 dst_sel:DWORD dst_unused:UNUSED_PAD src0_sel:WORD_1 src1_sel:WORD_1
    s_nop 1
    v_add_u32_dpp v110, v110, v110 row_shr:1 row_mask:0xf bank_mask:0xf bound_ctrl:0
    s_nop 1
    v_add_u32_dpp v110, v110, v110 row_shr:2 row_mask:0xf bank_mask:0xf bound_ctrl:0
    s_nop 1
    v_add_u32_dpp v110, v110, v110 row_shr:4 row_mask:0xf bank_mask:0xf bound_ctrl:0
    s_nop 1
    v_add_u32_dpp v110, v110, v110 row_shr:8 row_mask:0xf bank_mask:0xf bound_ctrl:0
    s_nop 1
    v_add_u32_dpp v110, v110, v110 row_bcast:15 row_mask:0xa bank_mask:0xf
    s_nop 1
    v_add_u32_dpp v110, v110, v110 row_bcast:31 row_mask:0xc bank_mask:0xf
    v_sub_u32_sdwa v109, v109, v110 dst_sel:DWORD dst_unused:UNUSED_PAD src0_sel:WORD_1 src1_sel:DWORD
    v_readlane_b32 s29, v110, 63
    v_add_u32 v110, -1, v110
    ds_write_b16 v126, v109
    v_lshlrev_b32_e64 v111, v110, 1
    v_lshrrev_b32 v110, 5, v110
    v_lshl_add_u32 v110, v110, 2, s19
    s_cmp_gt_u32 s29, 320
    s_cselect_b32 s2, 1, s2
    s_cselect_b64 exec, 0, -1
    ds_or_b32 v110, v111 offset:160
    s_mov_b64 exec, -1
    ds_wrxchg_rtn_b32 v7, v6, v5 offset:160
    s_add_u32 s14, s22, 80000
    buffer_load_dwordx4 v[88:91], v1, s[8:11], s14 offen
    s_add_u32 s14, s22, 96384
    buffer_load_dwordx4 v[92:95], v1, s[8:11], s14 offen
    s_barrier
    s_add_u32 s22, s22, 80000
    s_cmp_lg_u32 s24, 7
    s_cbranch_scc1 L_p2_nodist
    s_mov_b32 s46, 0
    s_lshl2_add_u32 s14, s3, s12
    s_mul_i32 s14, s14, 5000
    s_add_u32 s15, s14, 4096
    v_min_u32 v61, 225, v0
    v_lshl_add_u32 v60, v0, 2, s14
    v_lshl_add_u32 v61, v61, 2, s15
    global_load_dword v60, v60, s[100:101] nt
    global_load_dword v61, v61, s[100:101] nt
L_p2_nodist:
    v_mad_u32_u16 v64, v8, 8, s18
    v_mad_u32_u16 v66, v9, 8, s18
    v_mad_u32_u16 v68, v10, 8, s18
    ds_read_b64 v[64:65], v64
    ds_read_b64 v[66:67], v66
    ds_read_b64 v[68:69], v68
    s_add_u32 s14, s22, 32768
    buffer_load_dwordx4 v[96:99], v1, s[8:11], s14 offen
    s_waitcnt vmcnt(5)
    v_mad_u32_u16 v70, v12, 8, s18
    v_mad_u32_u16 v72, v13, 8, s18
    v_mad_u32_u16 v74, v14, 8, s18
    ds_read_b64 v[70:71], v70
    ds_read_b64 v[72:73], v72
    ds_read_b64 v[74:75], v74
    s_add_u32 s14, s22, 49152
    buffer_load_dwordx4 v[100:103], v1, s[8:11], s14 offen
    s_waitcnt lgkmcnt(6)
    v_readlane_b32 s30, v7, 0
    v_readlane_b32 s31, v7, 1
    v_readlane_b32 s32, v7, 2
    v_readlane_b32 s33, v7, 3
    v_readlane_b32 s34, v7, 4
    v_readlane_b32 s35, v7, 5
    v_readlane_b32 s36, v7, 6
    v_readlane_b32 s37, v7, 7
    s_mov_b32 s25, s19
    s_mov_b32 s26, s27
    s_mov_b32 s51, s28
    s_mov_b32 s28, s29
    v_mbcnt_lo_u32_b32 v51, s30, 0
    v_mbcnt_hi_u32_b32 v51, s31, v51
    s_bcnt1_i32_b64 s14, s[30:31]
    v_lshl_add_u32 v55, v51, 1, s25
    ds_read_u16 v55, v55
    s_add_u32 s30, s26, 0
    s_lshl1_add_u32 s25, s14, s25
    s_lshl_b32 s14, s14, 10
    s_add_u32 s26, s26, s14
    v_bfe_i32 v108, v11, 2, 10
    v_bfe_i32 v109, v11, 12, 10
    v_ashrrev_i32 v110, 22, v11
    v_cvt_f32_i32 v108, v108
    v_cvt_f32_i32 v109, v109
    v_cvt_f32_i32 v110, v110
    s_waitcnt lgkmcnt(4)
    v_mfma_f32_4x4x4_16b_bf16 v[112:115], v[58:59], v[64:65], 0
    v_mfma_f32_4x4x4_16b_bf16 v[116:119], v[58:59], v[66:67], 0
    v_mfma_f32_4x4x4_16b_bf16 v[120:123], v[58:59], v[68:69], 0
    v_mad_u32_u16 v8, v8, 8, s50 op_sel:[1,0,0,0]
    v_mad_u32_u16 v9, v9, 8, s50 op_sel:[1,0,0,0]
    v_mad_u32_u16 v10, v10, 8, s50 op_sel:[1,0,0,0]
    v_pk_fma_f32 v[114:115], v[114:115], v[108:109], s[20:21] op_sel:[0,0,0] op_sel_hi:[1,0,1]
    v_pk_fma_f32 v[112:113], v[112:113], v[108:109], s[16:17] op_sel:[0,0,0] op_sel_hi:[1,0,1]
    v_pk_fma_f32 v[118:119], v[118:119], v[108:109], s[20:21] op_sel:[0,1,0] op_sel_hi:[1,1,1]
    v_pk_fma_f32 v[116:117], v[116:117], v[108:109], s[16:17] op_sel:[0,1,0] op_sel_hi:[1,1,1]
    v_pk_fma_f32 v[122:123], v[122:123], v[110:111], s[20:21] op_sel:[0,0,0] op_sel_hi:[1,0,1]
    v_pk_fma_f32 v[120:121], v[120:121], v[110:111], s[16:17] op_sel:[0,0,0] op_sel_hi:[1,0,1]
    v_lshlrev_b64 v[114:115], 16, v[114:115]
    v_lshlrev_b64 v[118:119], 16, v[118:119]
    v_lshlrev_b64 v[122:123], 16, v[122:123]
    v_lshl_add_u64 v[64:65], v[112:113], 0, v[114:115]
    v_lshl_add_u64 v[66:67], v[116:117], 0, v[118:119]
    v_lshl_add_u64 v[68:69], v[120:121], 0, v[122:123]
    v_or3_b32 v4, v44, v45, v4
    v_or3_b32 v4, v46, v47, v4
    v_or3_b32 v4, v48, v49, v4
    ds_add_rtn_u64 v[44:45], v8, v[64:65]
    ds_add_rtn_u64 v[46:47], v9, v[66:67]
    ds_add_rtn_u64 v[48:49], v10, v[68:69]
    s_waitcnt lgkmcnt(3)
    v_mad_u32_u16 v55, v55, s23, v2
    v_pk_lshrrev_b16 v55, 10, v55 op_sel_hi:[1,1]
    v_lshl_add_u32 v51, v51, 6, v55
    buffer_load_dwordx4 v[8:11], v51, s[44:47], s30 idxen
    s_add_u32 s14, s22, 65536
    buffer_load_dwordx4 v[104:107], v1, s[8:11], s14 offen
    s_waitcnt vmcnt(7)
    v_mad_u32_u16 v76, v16, 8, s18
    v_mad_u32_u16 v78, v17, 8, s18
    v_mad_u32_u16 v80, v18, 8, s18
    ds_read_b64 v[76:77], v76
    ds_read_b64 v[78:79], v78
    ds_read_b64 v[80:81], v80
    s_waitcnt vmcnt(6)
    v_mad_u32_u16 v82, v20, 8, s18
    v_mad_u32_u16 v84, v21, 8, s18
    v_mad_u32_u16 v86, v22, 8, s18
    ds_read_b64 v[82:83], v82
    ds_read_b64 v[84:85], v84
    ds_read_b64 v[86:87], v86
    v_mbcnt_lo_u32_b32 v51, s32, 0
    v_mbcnt_hi_u32_b32 v51, s33, v51
    s_bcnt1_i32_b64 s14, s[32:33]
    v_lshl_add_u32 v55, v51, 1, s25
    ds_read_u16 v55, v55
    s_add_u32 s32, s26, 1048576
    s_lshl1_add_u32 s25, s14, s25
    s_lshl_b32 s14, s14, 10
    s_add_u32 s26, s26, s14
    v_bfe_i32 v108, v15, 2, 10
    v_bfe_i32 v109, v15, 12, 10
    v_ashrrev_i32 v110, 22, v15
    v_cvt_f32_i32 v108, v108
    v_cvt_f32_i32 v109, v109
    v_cvt_f32_i32 v110, v110
    v_mfma_f32_4x4x4_16b_bf16 v[112:115], v[58:59], v[70:71], 0
    v_mfma_f32_4x4x4_16b_bf16 v[116:119], v[58:59], v[72:73], 0
    v_mfma_f32_4x4x4_16b_bf16 v[120:123], v[58:59], v[74:75], 0
    v_mad_u32_u16 v12, v12, 8, s50 op_sel:[1,0,0,0]
    v_mad_u32_u16 v13, v13, 8, s50 op_sel:[1,0,0,0]
    v_mad_u32_u16 v14, v14, 8, s50 op_sel:[1,0,0,0]
    v_pk_fma_f32 v[114:115], v[114:115], v[108:109], s[20:21] op_sel:[0,0,0] op_sel_hi:[1,0,1]
    v_pk_fma_f32 v[112:113], v[112:113], v[108:109], s[16:17] op_sel:[0,0,0] op_sel_hi:[1,0,1]
    v_pk_fma_f32 v[118:119], v[118:119], v[108:109], s[20:21] op_sel:[0,1,0] op_sel_hi:[1,1,1]
    v_pk_fma_f32 v[116:117], v[116:117], v[108:109], s[16:17] op_sel:[0,1,0] op_sel_hi:[1,1,1]
    v_pk_fma_f32 v[122:123], v[122:123], v[110:111], s[20:21] op_sel:[0,0,0] op_sel_hi:[1,0,1]
    v_pk_fma_f32 v[120:121], v[120:121], v[110:111], s[16:17] op_sel:[0,0,0] op_sel_hi:[1,0,1]
    v_lshlrev_b64 v[114:115], 16, v[114:115]
    v_lshlrev_b64 v[118:119], 16, v[118:119]
    v_lshlrev_b64 v[122:123], 16, v[122:123]
    v_lshl_add_u64 v[70:71], v[112:113], 0, v[114:115]
    v_lshl_add_u64 v[72:73], v[116:117], 0, v[118:119]
    v_lshl_add_u64 v[74:75], v[120:121], 0, v[122:123]
    s_waitcnt lgkmcnt(7)
    v_or3_b32 v4, v44, v45, v4
    v_or3_b32 v4, v46, v47, v4
    v_or3_b32 v4, v48, v49, v4
    ds_add_rtn_u64 v[44:45], v12, v[70:71]
    ds_add_rtn_u64 v[46:47], v13, v[72:73]
    ds_add_rtn_u64 v[48:49], v14, v[74:75]
    s_waitcnt lgkmcnt(3)
    v_mad_u32_u16 v55, v55, s23, v2
    v_pk_lshrrev_b16 v55, 10, v55 op_sel_hi:[1,1]
    v_lshl_add_u32 v51, v51, 6, v55
    buffer_load_dwordx4 v[12:15], v51, s[44:47], s32 idxen
    s_cmp_le_u32 s51, 256
    s_cbranch_scc1 L_p2_kernel_noopt2_4
    v_mad_u32_u16 v64, v24, 8, s18
    v_mad_u32_u16 v66, v25, 8, s18
    v_mad_u32_u16 v68, v26, 8, s18
    ds_read_b64 v[64:65], v64
    ds_read_b64 v[66:67], v66
    ds_read_b64 v[68:69], v68
    v_bfe_i32 v108, v27, 2, 10
    v_bfe_i32 v109, v27, 12, 10
    v_ashrrev_i32 v110, 22, v27
    v_cvt_f32_i32 v108, v108
    v_cvt_f32_i32 v109, v109
    v_cvt_f32_i32 v110, v110
    s_waitcnt lgkmcnt(0)
    v_mfma_f32_4x4x4_16b_bf16 v[112:115], v[58:59], v[64:65], 0
    v_mfma_f32_4x4x4_16b_bf16 v[116:119], v[58:59], v[66:67], 0
    v_mfma_f32_4x4x4_16b_bf16 v[120:123], v[58:59], v[68:69], 0
    v_mad_u32_u16 v24, v24, 8, s50 op_sel:[1,0,0,0]
    v_mad_u32_u16 v25, v25, 8, s50 op_sel:[1,0,0,0]
    v_mad_u32_u16 v26, v26, 8, s50 op_sel:[1,0,0,0]
    v_pk_fma_f32 v[114:115], v[114:115], v[108:109], s[20:21] op_sel:[0,0,0] op_sel_hi:[1,0,1]
    v_pk_fma_f32 v[112:113], v[112:113], v[108:109], s[16:17] op_sel:[0,0,0] op_sel_hi:[1,0,1]
    v_pk_fma_f32 v[118:119], v[118:119], v[108:109], s[20:21] op_sel:[0,1,0] op_sel_hi:[1,1,1]
    v_pk_fma_f32 v[116:117], v[116:117], v[108:109], s[16:17] op_sel:[0,1,0] op_sel_hi:[1,1,1]
    v_pk_fma_f32 v[122:123], v[122:123], v[110:111], s[20:21] op_sel:[0,0,0] op_sel_hi:[1,0,1]
    v_pk_fma_f32 v[120:121], v[120:121], v[110:111], s[16:17] op_sel:[0,0,0] op_sel_hi:[1,0,1]
    v_lshlrev_b64 v[114:115], 16, v[114:115]
    v_lshlrev_b64 v[118:119], 16, v[118:119]
    v_lshlrev_b64 v[122:123], 16, v[122:123]
    v_lshl_add_u64 v[64:65], v[112:113], 0, v[114:115]
    v_lshl_add_u64 v[66:67], v[116:117], 0, v[118:119]
    v_lshl_add_u64 v[68:69], v[120:121], 0, v[122:123]
    v_or3_b32 v4, v44, v45, v4
    v_or3_b32 v4, v46, v47, v4
    v_or3_b32 v4, v48, v49, v4
    ds_add_rtn_u64 v[44:45], v24, v[64:65]
    ds_add_rtn_u64 v[46:47], v25, v[66:67]
    ds_add_rtn_u64 v[48:49], v26, v[68:69]
L_p2_kernel_noopt2_4:
    s_barrier
    s_waitcnt vmcnt(1)
    ds_write_b128 v3, v[88:91] offset:0
    ds_write_b128 v3, v[92:95] offset:16384
    ds_write_b128 v3, v[96:99] offset:32768
    ds_write_b128 v3, v[100:103] offset:49152
    ds_write_b128 v124, v[104:107] offset:0
    v_mbcnt_lo_u32_b32 v51, s34, 0
    v_mbcnt_hi_u32_b32 v51, s35, v51
    s_bcnt1_i32_b64 s14, s[34:35]
    v_lshl_add_u32 v55, v51, 1, s25
    ds_read_u16 v55, v55
    s_add_u32 s34, s26, 2097152
    s_lshl1_add_u32 s25, s14, s25
    s_lshl_b32 s14, s14, 10
    s_add_u32 s26, s26, s14
    v_bfe_i32 v108, v19, 2, 10
    v_bfe_i32 v109, v19, 12, 10
    v_ashrrev_i32 v110, 22, v19
    v_cvt_f32_i32 v108, v108
    v_cvt_f32_i32 v109, v109
    v_cvt_f32_i32 v110, v110
    v_mfma_f32_4x4x4_16b_bf16 v[112:115], v[58:59], v[76:77], 0
    v_mfma_f32_4x4x4_16b_bf16 v[116:119], v[58:59], v[78:79], 0
    v_mfma_f32_4x4x4_16b_bf16 v[120:123], v[58:59], v[80:81], 0
    v_mad_u32_u16 v16, v16, 8, s50 op_sel:[1,0,0,0]
    v_mad_u32_u16 v17, v17, 8, s50 op_sel:[1,0,0,0]
    v_mad_u32_u16 v18, v18, 8, s50 op_sel:[1,0,0,0]
    v_pk_fma_f32 v[114:115], v[114:115], v[108:109], s[20:21] op_sel:[0,0,0] op_sel_hi:[1,0,1]
    v_pk_fma_f32 v[112:113], v[112:113], v[108:109], s[16:17] op_sel:[0,0,0] op_sel_hi:[1,0,1]
    v_pk_fma_f32 v[118:119], v[118:119], v[108:109], s[20:21] op_sel:[0,1,0] op_sel_hi:[1,1,1]
    v_pk_fma_f32 v[116:117], v[116:117], v[108:109], s[16:17] op_sel:[0,1,0] op_sel_hi:[1,1,1]
    v_pk_fma_f32 v[122:123], v[122:123], v[110:111], s[20:21] op_sel:[0,0,0] op_sel_hi:[1,0,1]
    v_pk_fma_f32 v[120:121], v[120:121], v[110:111], s[16:17] op_sel:[0,0,0] op_sel_hi:[1,0,1]
    v_lshlrev_b64 v[114:115], 16, v[114:115]
    v_lshlrev_b64 v[118:119], 16, v[118:119]
    v_lshlrev_b64 v[122:123], 16, v[122:123]
    v_lshl_add_u64 v[76:77], v[112:113], 0, v[114:115]
    v_lshl_add_u64 v[78:79], v[116:117], 0, v[118:119]
    v_lshl_add_u64 v[80:81], v[120:121], 0, v[122:123]
    s_waitcnt lgkmcnt(6)
    v_or3_b32 v4, v44, v45, v4
    v_or3_b32 v4, v46, v47, v4
    v_or3_b32 v4, v48, v49, v4
    ds_add_rtn_u64 v[44:45], v16, v[76:77]
    ds_add_rtn_u64 v[46:47], v17, v[78:79]
    ds_add_rtn_u64 v[48:49], v18, v[80:81]
    s_waitcnt lgkmcnt(3)
    v_mad_u32_u16 v55, v55, s23, v2
    v_pk_lshrrev_b16 v55, 10, v55 op_sel_hi:[1,1]
    v_lshl_add_u32 v51, v51, 6, v55
    buffer_load_dwordx4 v[16:19], v51, s[44:47], s34 idxen
    v_mbcnt_lo_u32_b32 v51, s36, 0
    v_mbcnt_hi_u32_b32 v51, s37, v51
    s_bcnt1_i32_b64 s14, s[36:37]
    v_lshl_add_u32 v55, v51, 1, s25
    ds_read_u16 v55, v55
    s_add_u32 s36, s26, 3145728
    s_lshl1_add_u32 s25, s14, s25
    s_lshl_b32 s14, s14, 10
    s_add_u32 s26, s26, s14
    v_bfe_i32 v108, v23, 2, 10
    v_bfe_i32 v109, v23, 12, 10
    v_ashrrev_i32 v110, 22, v23
    v_cvt_f32_i32 v108, v108
    v_cvt_f32_i32 v109, v109
    v_cvt_f32_i32 v110, v110
    v_mfma_f32_4x4x4_16b_bf16 v[112:115], v[58:59], v[82:83], 0
    v_mfma_f32_4x4x4_16b_bf16 v[116:119], v[58:59], v[84:85], 0
    v_mfma_f32_4x4x4_16b_bf16 v[120:123], v[58:59], v[86:87], 0
    v_mad_u32_u16 v20, v20, 8, s50 op_sel:[1,0,0,0]
    v_mad_u32_u16 v21, v21, 8, s50 op_sel:[1,0,0,0]
    v_mad_u32_u16 v22, v22, 8, s50 op_sel:[1,0,0,0]
    v_pk_fma_f32 v[114:115], v[114:115], v[108:109], s[20:21] op_sel:[0,0,0] op_sel_hi:[1,0,1]
    v_pk_fma_f32 v[112:113], v[112:113], v[108:109], s[16:17] op_sel:[0,0,0] op_sel_hi:[1,0,1]
    v_pk_fma_f32 v[118:119], v[118:119], v[108:109], s[20:21] op_sel:[0,1,0] op_sel_hi:[1,1,1]
    v_pk_fma_f32 v[116:117], v[116:117], v[108:109], s[16:17] op_sel:[0,1,0] op_sel_hi:[1,1,1]
    v_pk_fma_f32 v[122:123], v[122:123], v[110:111], s[20:21] op_sel:[0,0,0] op_sel_hi:[1,0,1]
    v_pk_fma_f32 v[120:121], v[120:121], v[110:111], s[16:17] op_sel:[0,0,0] op_sel_hi:[1,0,1]
    v_lshlrev_b64 v[114:115], 16, v[114:115]
    v_lshlrev_b64 v[118:119], 16, v[118:119]
    v_lshlrev_b64 v[122:123], 16, v[122:123]
    v_lshl_add_u64 v[82:83], v[112:113], 0, v[114:115]
    v_lshl_add_u64 v[84:85], v[116:117], 0, v[118:119]
    v_lshl_add_u64 v[86:87], v[120:121], 0, v[122:123]
    s_waitcnt lgkmcnt(1)
    v_or3_b32 v4, v44, v45, v4
    v_or3_b32 v4, v46, v47, v4
    v_or3_b32 v4, v48, v49, v4
    ds_add_rtn_u64 v[44:45], v20, v[82:83]
    ds_add_rtn_u64 v[46:47], v21, v[84:85]
    ds_add_rtn_u64 v[48:49], v22, v[86:87]
    s_waitcnt lgkmcnt(3)
    v_mad_u32_u16 v55, v55, s23, v2
    v_pk_lshrrev_b16 v55, 10, v55 op_sel_hi:[1,1]
    v_lshl_add_u32 v51, v51, 6, v55
    buffer_load_dwordx4 v[20:23], v51, s[44:47], s36 idxen
    s_cmp_le_u32 s28, 256
    s_cbranch_scc1 L_p2_kernel_noopt_5
    v_readlane_b32 s38, v7, 8
    v_readlane_b32 s39, v7, 9
    s_nop 1
    v_mbcnt_lo_u32_b32 v62, s38, 0
    v_mbcnt_hi_u32_b32 v62, s39, v62
    s_bcnt1_i32_b64 s14, s[38:39]
    v_lshl_add_u32 v63, v62, 1, s25
    ds_read_u16 v63, v63
    s_add_u32 s38, s26, 4194304
    s_lshl1_add_u32 s25, s14, s25
    s_lshl_b32 s14, s14, 10
    s_add_u32 s26, s26, s14
    s_waitcnt lgkmcnt(0)
    v_mad_u32_u16 v63, v63, s23, v2
    v_pk_lshrrev_b16 v63, 10, v63 op_sel_hi:[1,1]
    v_lshl_add_u32 v62, v62, 6, v63
    buffer_load_dwordx4 v[24:27], v62, s[44:47], s38 idxen
L_p2_kernel_noopt_5:
    v_mad_u32_u16 v108, v28, v50, s40 op_sel:[1,0,0,0]
    v_mad_u32_u16 v109, v36, v50, s41 op_sel:[1,0,0,0]
    v_sub_u32_sdwa v110, v109, v108 dst_sel:DWORD dst_unused:UNUSED_PAD src0_sel:WORD_1 src1_sel:WORD_1
    s_nop 1
    v_add_u32_dpp v110, v110, v110 row_shr:1 row_mask:0xf bank_mask:0xf bound_ctrl:0
    s_nop 1
    v_add_u32_dpp v110, v110, v110 row_shr:2 row_mask:0xf bank_mask:0xf bound_ctrl:0
    s_nop 1
    v_add_u32_dpp v110, v110, v110 row_shr:4 row_mask:0xf bank_mask:0xf bound_ctrl:0
    s_nop 1
    v_add_u32_dpp v110, v110, v110 row_shr:8 row_mask:0xf bank_mask:0xf bound_ctrl:0
    s_nop 1
    v_add_u32_dpp v110, v110, v110 row_bcast:15 row_mask:0xa bank_mask:0xf
    s_nop 1
    v_add_u32_dpp v110, v110, v110 row_bcast:31 row_mask:0xc bank_mask:0xf
    v_sub_u32_sdwa v109, v109, v110 dst_sel:DWORD dst_unused:UNUSED_PAD src0_sel:WORD_1 src1_sel:DWORD
    v_readlane_b32 s29, v110, 63
    v_add_u32 v110, -1, v110
    ds_write_b16 v126, v109
    v_lshlrev_b32_e64 v111, v110, 1
    v_lshrrev_b32 v110, 5, v110
    v_lshl_add_u32 v110, v110, 2, s19
    s_cmp_gt_u32 s29, 320
    s_cselect_b32 s2, 1, s2
    s_cselect_b64 exec, 0, -1
    ds_or_b32 v110, v111 offset:160
    s_mov_b64 exec, -1
    ds_wrxchg_rtn_b32 v7, v6, v5 offset:160
    s_add_u32 s14, s22, 80000
    buffer_load_dwordx4 v[88:91], v1, s[8:11], s14 offen
    s_add_u32 s14, s22, 96384
    buffer_load_dwordx4 v[92:95], v1, s[8:11], s14 offen
    s_add_u32 s24, s24, 1
    s_cmp_lt_u32 s24, 8
    s_barrier
    s_cbranch_scc1 L_p2_loop
    s_waitcnt lgkmcnt(3)
    v_or3_b32 v4, v44, v45, v4
    v_or3_b32 v4, v46, v47, v4
    v_or3_b32 v4, v48, v49, v4
    s_mov_b32 s27, s19
    s_waitcnt vmcnt(0)
    v_mov_b32 v8, 160232
    s_cmp_lg_u32 s13, 0
    s_cselect_b64 exec, 0, 1
    ds_write_b32 v8, v52
    s_mov_b64 exec, -1
    v_subrev_u32 v6, 80000, v124
    s_mul_i32 s24, s12, 20000
    v_subrev_u32 v10, s24, v1
    v_mov_b32 v11, 0x7f000000
    s_waitcnt vmcnt(0) lgkmcnt(0)
    s_barrier
    s_cmp_lt_u32 s13, 4
    s_cbranch_scc1 L_p2_ga
    v_lshlrev_b32 v30, 16, v60
    v_and_b32 v31, 0xffff0000, v60
    v_lshlrev_b32 v36, 16, v53
    v_and_b32 v37, 0xffff0000, v53
    v_lshlrev_b32 v38, 16, v54
    v_and_b32 v39, 0xffff0000, v54
    v_lshlrev_b32 v40, 16, v56
    v_and_b32 v41, 0xffff0000, v56
    v_lshlrev_b32 v42, 16, v57
    v_and_b32 v43, 0xffff0000, v57
    v_pk_add_f32 v[14:15], v[30:31], v[36:37] op_sel:[0,0] op_sel_hi:[1,0] neg_lo:[0,1] neg_hi:[0,1]
    v_pk_add_f32 v[16:17], v[30:31], v[36:37] op_sel:[0,1] op_sel_hi:[1,1] neg_lo:[0,1] neg_hi:[0,1]
    v_pk_add_f32 v[18:19], v[30:31], v[38:39] op_sel:[0,0] op_sel_hi:[1,0] neg_lo:[0,1] neg_hi:[0,1]
    v_pk_add_f32 v[20:21], v[30:31], v[38:39] op_sel:[0,1] op_sel_hi:[1,1] neg_lo:[0,1] neg_hi:[0,1]
    v_pk_add_f32 v[22:23], v[30:31], v[40:41] op_sel:[0,0] op_sel_hi:[1,0] neg_lo:[0,1] neg_hi:[0,1]
    v_pk_add_f32 v[24:25], v[30:31], v[40:41] op_sel:[0,1] op_sel_hi:[1,1] neg_lo:[0,1] neg_hi:[0,1]
    v_pk_add_f32 v[26:27], v[30:31], v[42:43] op_sel:[0,0] op_sel_hi:[1,0] neg_lo:[0,1] neg_hi:[0,1]
    v_pk_add_f32 v[28:29], v[30:31], v[42:43] op_sel:[0,1] op_sel_hi:[1,1] neg_lo:[0,1] neg_hi:[0,1]
    v_cvt_pk_bf16_f32 v32, v14, v15
    v_lshlrev_b32 v14, 16, v32
    v_and_b32 v15, 0xffff0000, v32
    v_cvt_pk_bf16_f32 v32, v16, v17
    v_lshlrev_b32 v16, 16, v32
    v_and_b32 v17, 0xffff0000, v32
    v_cvt_pk_bf16_f32 v32, v18, v19
    v_lshlrev_b32 v18, 16, v32
    v_and_b32 v19, 0xffff0000, v32
    v_cvt_pk_bf16_f32 v32, v20, v21
    v_lshlrev_b32 v20, 16, v32
    v_and_b32 v21, 0xffff0000, v32
    v_cvt_pk_bf16_f32 v32, v22, v23
    v_lshlrev_b32 v22, 16, v32
    v_and_b32 v23, 0xffff0000, v32
    v_cvt_pk_bf16_f32 v32, v24, v25
    v_lshlrev_b32 v24, 16, v32
    v_and_b32 v25, 0xffff0000, v32
    v_cvt_pk_bf16_f32 v32, v26, v27
    v_lshlrev_b32 v26, 16, v32
    v_and_b32 v27, 0xffff0000, v32
    v_cvt_pk_bf16_f32 v32, v28, v29
    v_lshlrev_b32 v28, 16, v32
    v_and_b32 v29, 0xffff0000, v32
    v_pk_mul_f32 v[14:15], v[14:15], v[14:15]
    v_pk_mul_f32 v[16:17], v[16:17], v[16:17]
    v_pk_mul_f32 v[18:19], v[18:19], v[18:19]
    v_pk_mul_f32 v[20:21], v[20:21], v[20:21]
    v_pk_mul_f32 v[22:23], v[22:23], v[22:23]
    v_pk_mul_f32 v[24:25], v[24:25], v[24:25]
    v_pk_mul_f32 v[26:27], v[26:27], v[26:27]
    v_pk_mul_f32 v[28:29], v[28:29], v[28:29]
    v_cvt_pk_bf16_f32 v32, v14, v15
    v_lshlrev_b32 v14, 16, v32
    v_and_b32 v15, 0xffff0000, v32
    v_cvt_pk_bf16_f32 v32, v16, v17
    v_lshlrev_b32 v16, 16, v32
    v_and_b32 v17, 0xffff0000, v32
    v_cvt_pk_bf16_f32 v32, v18, v19
    v_lshlrev_b32 v18, 16, v32
    v_and_b32 v19, 0xffff0000, v32
    v_cvt_pk_bf16_f32 v32, v20, v21
    v_lshlrev_b32 v20, 16, v32
    v_and_b32 v21, 0xffff0000, v32
    v_cvt_pk_bf16_f32 v32, v22, v23
    v_lshlrev_b32 v22, 16, v32
    v_and_b32 v23, 0xffff0000, v32
    v_cvt_pk_bf16_f32 v32, v24, v25
    v_lshlrev_b32 v24, 16, v32
    v_and_b32 v25, 0xffff0000, v32
    v_cvt_pk_bf16_f32 v32, v26, v27
    v_lshlrev_b32 v26, 16, v32
    v_and_b32 v27, 0xffff0000, v32
    v_cvt_pk_bf16_f32 v32, v28, v29
    v_lshlrev_b32 v28, 16, v32
    v_and_b32 v29, 0xffff0000, v32
    v_mov_b32 v30, 1092616192
    v_mov_b32 v31, 0x3fb8aa3b
    v_pk_mul_f32 v[14:15], v[14:15], v[30:31] op_sel:[0,0] op_sel_hi:[1,0]
    v_pk_mul_f32 v[16:17], v[16:17], v[30:31] op_sel:[0,0] op_sel_hi:[1,0]
    v_pk_mul_f32 v[18:19], v[18:19], v[30:31] op_sel:[0,0] op_sel_hi:[1,0]
    v_pk_mul_f32 v[20:21], v[20:21], v[30:31] op_sel:[0,0] op_sel_hi:[1,0]
    v_pk_mul_f32 v[22:23], v[22:23], v[30:31] op_sel:[0,0] op_sel_hi:[1,0]
    v_pk_mul_f32 v[24:25], v[24:25], v[30:31] op_sel:[0,0] op_sel_hi:[1,0]
    v_pk_mul_f32 v[26:27], v[26:27], v[30:31] op_sel:[0,0] op_sel_hi:[1,0]
    v_pk_mul_f32 v[28:29], v[28:29], v[30:31] op_sel:[0,0] op_sel_hi:[1,0]
    v_cvt_pk_bf16_f32 v32, v14, v15
    v_lshlrev_b32 v14, 16, v32
    v_and_b32 v15, 0xffff0000, v32
    v_cvt_pk_bf16_f32 v32, v16, v17
    v_lshlrev_b32 v16, 16, v32
    v_and_b32 v17, 0xffff0000, v32
    v_cvt_pk_bf16_f32 v32, v18, v19
    v_lshlrev_b32 v18, 16, v32
    v_and_b32 v19, 0xffff0000, v32
    v_cvt_pk_bf16_f32 v32, v20, v21
    v_lshlrev_b32 v20, 16, v32
    v_and_b32 v21, 0xffff0000, v32
    v_cvt_pk_bf16_f32 v32, v22, v23
    v_lshlrev_b32 v22, 16, v32
    v_and_b32 v23, 0xffff0000, v32
    v_cvt_pk_bf16_f32 v32, v24, v25
    v_lshlrev_b32 v24, 16, v32
    v_and_b32 v25, 0xffff0000, v32
    v_cvt_pk_bf16_f32 v32, v26, v27
    v_lshlrev_b32 v26, 16, v32
    v_and_b32 v27, 0xffff0000, v32
    v_cvt_pk_bf16_f32 v32, v28, v29
    v_lshlrev_b32 v28, 16, v32
    v_and_b32 v29, 0xffff0000, v32
    v_pk_mul_f32 v[14:15], v[14:15], v[30:31] op_sel:[0,1] op_sel_hi:[1,1]
    v_pk_mul_f32 v[16:17], v[16:17], v[30:31] op_sel:[0,1] op_sel_hi:[1,1]
    v_pk_mul_f32 v[18:19], v[18:19], v[30:31] op_sel:[0,1] op_sel_hi:[1,1]
    v_pk_mul_f32 v[20:21], v[20:21], v[30:31] op_sel:[0,1] op_sel_hi:[1,1]
    v_pk_mul_f32 v[22:23], v[22:23], v[30:31] op_sel:[0,1] op_sel_hi:[1,1]
    v_pk_mul_f32 v[24:25], v[24:25], v[30:31] op_sel:[0,1] op_sel_hi:[1,1]
    v_pk_mul_f32 v[26:27], v[26:27], v[30:31] op_sel:[0,1] op_sel_hi:[1,1]
    v_pk_mul_f32 v[28:29], v[28:29], v[30:31] op_sel:[0,1] op_sel_hi:[1,1]
    v_exp_f32 v14, -v14
    v_exp_f32 v15, -v15
    v_exp_f32 v16, -v16
    v_exp_f32 v17, -v17
    v_exp_f32 v18, -v18
    v_exp_f32 v19, -v19
    v_exp_f32 v20, -v20
    v_exp_f32 v21, -v21
    v_exp_f32 v22, -v22
    v_exp_f32 v23, -v23
    v_exp_f32 v24, -v24
    v_exp_f32 v25, -v25
    v_exp_f32 v26, -v26
    v_exp_f32 v27, -v27
    v_exp_f32 v28, -v28
    v_exp_f32 v29, -v29
    v_cvt_pk_bf16_f32 v14, v14, v16
    v_cvt_pk_bf16_f32 v15, v15, v17
    v_cvt_pk_bf16_f32 v18, v18, v20
    v_cvt_pk_bf16_f32 v19, v19, v21
    v_cvt_pk_bf16_f32 v22, v22, v24
    v_cvt_pk_bf16_f32 v23, v23, v25
    v_cvt_pk_bf16_f32 v26, v26, v28
    v_cvt_pk_bf16_f32 v27, v27, v29
    v_dot2_f32_bf16 v72, v14, s68, 0
    v_dot2_f32_bf16 v73, v15, s68, 0
    v_dot2_f32_bf16 v74, v14, s69, 0
    v_dot2_f32_bf16 v75, v15, s69, 0
    v_dot2_f32_bf16 v76, v14, s70, 0
    v_dot2_f32_bf16 v77, v15, s70, 0
    v_dot2_f32_bf16 v78, v14, s71, 0
    v_dot2_f32_bf16 v79, v15, s71, 0
    v_dot2_f32_bf16 v80, v14, s52, 0
    v_dot2_f32_bf16 v81, v15, s52, 0
    v_dot2_f32_bf16 v82, v14, s53, 0
    v_dot2_f32_bf16 v83, v15, s53, 0
    v_dot2_f32_bf16 v84, v14, s54, 0
    v_dot2_f32_bf16 v85, v15, s54, 0
    v_dot2_f32_bf16 v86, v14, s55, 0
    v_dot2_f32_bf16 v87, v15, s55, 0
    v_dot2_f32_bf16 v72, v18, s72, v72
    v_dot2_f32_bf16 v73, v19, s72, v73
    v_dot2_f32_bf16 v74, v18, s73, v74
    v_dot2_f32_bf16 v75, v19, s73, v75
    v_dot2_f32_bf16 v76, v18, s74, v76
    v_dot2_f32_bf16 v77, v19, s74, v77
    v_dot2_f32_bf16 v78, v18, s75, v78
    v_dot2_f32_bf16 v79, v19, s75, v79
    v_dot2_f32_bf16 v80, v18, s56, v80
    v_dot2_f32_bf16 v81, v19, s56, v81
    v_dot2_f32_bf16 v82, v18, s57, v82
    v_dot2_f32_bf16 v83, v19, s57, v83
    v_dot2_f32_bf16 v84, v18, s58, v84
    v_dot2_f32_bf16 v85, v19, s58, v85
    v_dot2_f32_bf16 v86, v18, s59, v86
    v_dot2_f32_bf16 v87, v19, s59, v87
    v_dot2_f32_bf16 v72, v22, s76, v72
    v_dot2_f32_bf16 v73, v23, s76, v73
    v_dot2_f32_bf16 v74, v22, s77, v74
    v_dot2_f32_bf16 v75, v23, s77, v75
    v_dot2_f32_bf16 v76, v22, s78, v76
    v_dot2_f32_bf16 v77, v23, s78, v77
    v_dot2_f32_bf16 v78, v22, s79, v78
    v_dot2_f32_bf16 v79, v23, s79, v79
    v_dot2_f32_bf16 v80, v22, s60, v80
    v_dot2_f32_bf16 v81, v23, s60, v81
    v_dot2_f32_bf16 v82, v22, s61, v82
    v_dot2_f32_bf16 v83, v23, s61, v83
    v_dot2_f32_bf16 v84, v22, s62, v84
    v_dot2_f32_bf16 v85, v23, s62, v85
    v_dot2_f32_bf16 v86, v22, s63, v86
    v_dot2_f32_bf16 v87, v23, s63, v87
    v_dot2_f32_bf16 v72, v26, s80, v72
    v_dot2_f32_bf16 v73, v27, s80, v73
    v_dot2_f32_bf16 v74, v26, s81, v74
    v_dot2_f32_bf16 v75, v27, s81, v75
    v_dot2_f32_bf16 v76, v26, s82, v76
    v_dot2_f32_bf16 v77, v27, s82, v77
    v_dot2_f32_bf16 v78, v26, s83, v78
    v_dot2_f32_bf16 v79, v27, s83, v79
    v_dot2_f32_bf16 v80, v26, s64, v80
    v_dot2_f32_bf16 v81, v27, s64, v81
    v_dot2_f32_bf16 v82, v26, s65, v82
    v_dot2_f32_bf16 v83, v27, s65, v83
    v_dot2_f32_bf16 v84, v26, s66, v84
    v_dot2_f32_bf16 v85, v27, s66, v85
    v_dot2_f32_bf16 v86, v26, s67, v86
    v_dot2_f32_bf16 v87, v27, s67, v87
L_p2_ga:
    ds_read_b32 v9, v8
    ds_read_b128 v[88:91], v1 offset:0
    ds_read_b128 v[92:95], v1 offset:16384
    ds_read_b128 v[96:99], v1 offset:32768
    ds_read_b128 v[100:103], v1 offset:49152
    ds_read_b128 v[104:107], v6
    s_mul_i32 s14, s12, 5120000
    s_mul_i32 s15, s3, 80000
    s_add_u32 s25, s14, s15
    s_add_u32 s25, s25, 228589568
    s_waitcnt lgkmcnt(5)
    v_readfirstlane_b32 s21, v9
    s_nop 0
    s_bfe_u32 s21, s21, 524296
    s_cmp_lg_u32 s21, 4
    s_cselect_b32 s21, 1, 0
    s_cselect_b32 s24, 0, 20000
    v_cmp_le_u32 vcc, s24, v10
    v_add_u32 v10, 16384, v10
    s_add_u32 s14, s25, 0
    v_cndmask_b32 v12, v11, v1, vcc
    s_waitcnt lgkmcnt(4)
    buffer_store_dwordx4 v[88:91], v12, s[4:7], s14 offen sc1
    v_or3_b32 v4, v88, v89, v4
    v_or3_b32 v4, v90, v91, v4
    v_cmp_le_u32 vcc, s24, v10
    v_add_u32 v10, 16384, v10
    s_add_u32 s14, s25, 16384
    v_cndmask_b32 v12, v11, v1, vcc
    s_waitcnt lgkmcnt(3)
    buffer_store_dwordx4 v[92:95], v12, s[4:7], s14 offen sc1
    v_or3_b32 v4, v92, v93, v4
    v_or3_b32 v4, v94, v95, v4
    v_cmp_le_u32 vcc, s24, v10
    v_add_u32 v10, 16384, v10
    s_add_u32 s14, s25, 32768
    v_cndmask_b32 v12, v11, v1, vcc
    s_waitcnt lgkmcnt(2)
    buffer_store_dwordx4 v[96:99], v12, s[4:7], s14 offen sc1
    v_or3_b32 v4, v96, v97, v4
    v_or3_b32 v4, v98, v99, v4
    v_cmp_le_u32 vcc, s24, v10
    v_add_u32 v10, 16384, v10
    s_add_u32 s14, s25, 49152
    v_cndmask_b32 v12, v11, v1, vcc
    s_waitcnt lgkmcnt(1)
    buffer_store_dwordx4 v[100:103], v12, s[4:7], s14 offen sc1
    v_or3_b32 v4, v100, v101, v4
    v_or3_b32 v4, v102, v103, v4
    v_cmp_le_u32 vcc, s24, v10
    v_add_u32 v10, 16384, v10
    s_add_u32 s14, s25, 0
    v_cndmask_b32 v12, v11, v6, vcc
    s_waitcnt lgkmcnt(0)
    buffer_store_dwordx4 v[104:107], v12, s[4:7], s14 offen sc1
    v_or3_b32 v4, v104, v105, v4
    v_or3_b32 v4, v106, v107, v4
    s_load_dwordx2 s[16:17], s[0:1], 88
    s_cmp_ge_u32 s13, 4
    s_cbranch_scc1 L_p2_gb
    v_lshlrev_b32 v30, 16, v60
    v_and_b32 v31, 0xffff0000, v60
    v_lshlrev_b32 v36, 16, v53
    v_and_b32 v37, 0xffff0000, v53
    v_lshlrev_b32 v38, 16, v54
    v_and_b32 v39, 0xffff0000, v54
    v_lshlrev_b32 v40, 16, v56
    v_and_b32 v41, 0xffff0000, v56
    v_lshlrev_b32 v42, 16, v57
    v_and_b32 v43, 0xffff0000, v57
    v_pk_add_f32 v[14:15], v[30:31], v[36:37] op_sel:[0,0] op_sel_hi:[1,0] neg_lo:[0,1] neg_hi:[0,1]
    v_pk_add_f32 v[16:17], v[30:31], v[36:37] op_sel:[0,1] op_sel_hi:[1,1] neg_lo:[0,1] neg_hi:[0,1]
    v_pk_add_f32 v[18:19], v[30:31], v[38:39] op_sel:[0,0] op_sel_hi:[1,0] neg_lo:[0,1] neg_hi:[0,1]
    v_pk_add_f32 v[20:21], v[30:31], v[38:39] op_sel:[0,1] op_sel_hi:[1,1] neg_lo:[0,1] neg_hi:[0,1]
    v_pk_add_f32 v[22:23], v[30:31], v[40:41] op_sel:[0,0] op_sel_hi:[1,0] neg_lo:[0,1] neg_hi:[0,1]
    v_pk_add_f32 v[24:25], v[30:31], v[40:41] op_sel:[0,1] op_sel_hi:[1,1] neg_lo:[0,1] neg_hi:[0,1]
    v_pk_add_f32 v[26:27], v[30:31], v[42:43] op_sel:[0,0] op_sel_hi:[1,0] neg_lo:[0,1] neg_hi:[0,1]
    v_pk_add_f32 v[28:29], v[30:31], v[42:43] op_sel:[0,1] op_sel_hi:[1,1] neg_lo:[0,1] neg_hi:[0,1]
    v_cvt_pk_bf16_f32 v32, v14, v15
    v_lshlrev_b32 v14, 16, v32
    v_and_b32 v15, 0xffff0000, v32
    v_cvt_pk_bf16_f32 v32, v16, v17
    v_lshlrev_b32 v16, 16, v32
    v_and_b32 v17, 0xffff0000, v32
    v_cvt_pk_bf16_f32 v32, v18, v19
    v_lshlrev_b32 v18, 16, v32
    v_and_b32 v19, 0xffff0000, v32
    v_cvt_pk_bf16_f32 v32, v20, v21
    v_lshlrev_b32 v20, 16, v32
    v_and_b32 v21, 0xffff0000, v32
    v_cvt_pk_bf16_f32 v32, v22, v23
    v_lshlrev_b32 v22, 16, v32
    v_and_b32 v23, 0xffff0000, v32
    v_cvt_pk_bf16_f32 v32, v24, v25
    v_lshlrev_b32 v24, 16, v32
    v_and_b32 v25, 0xffff0000, v32
    v_cvt_pk_bf16_f32 v32, v26, v27
    v_lshlrev_b32 v26, 16, v32
    v_and_b32 v27, 0xffff0000, v32
    v_cvt_pk_bf16_f32 v32, v28, v29
    v_lshlrev_b32 v28, 16, v32
    v_and_b32 v29, 0xffff0000, v32
    v_pk_mul_f32 v[14:15], v[14:15], v[14:15]
    v_pk_mul_f32 v[16:17], v[16:17], v[16:17]
    v_pk_mul_f32 v[18:19], v[18:19], v[18:19]
    v_pk_mul_f32 v[20:21], v[20:21], v[20:21]
    v_pk_mul_f32 v[22:23], v[22:23], v[22:23]
    v_pk_mul_f32 v[24:25], v[24:25], v[24:25]
    v_pk_mul_f32 v[26:27], v[26:27], v[26:27]
    v_pk_mul_f32 v[28:29], v[28:29], v[28:29]
    v_cvt_pk_bf16_f32 v32, v14, v15
    v_lshlrev_b32 v14, 16, v32
    v_and_b32 v15, 0xffff0000, v32
    v_cvt_pk_bf16_f32 v32, v16, v17
    v_lshlrev_b32 v16, 16, v32
    v_and_b32 v17, 0xffff0000, v32
    v_cvt_pk_bf16_f32 v32, v18, v19
    v_lshlrev_b32 v18, 16, v32
    v_and_b32 v19, 0xffff0000, v32
    v_cvt_pk_bf16_f32 v32, v20, v21
    v_lshlrev_b32 v20, 16, v32
    v_and_b32 v21, 0xffff0000, v32
    v_cvt_pk_bf16_f32 v32, v22, v23
    v_lshlrev_b32 v22, 16, v32
    v_and_b32 v23, 0xffff0000, v32
    v_cvt_pk_bf16_f32 v32, v24, v25
    v_lshlrev_b32 v24, 16, v32
    v_and_b32 v25, 0xffff0000, v32
    v_cvt_pk_bf16_f32 v32, v26, v27
    v_lshlrev_b32 v26, 16, v32
    v_and_b32 v27, 0xffff0000, v32
    v_cvt_pk_bf16_f32 v32, v28, v29
    v_lshlrev_b32 v28, 16, v32
    v_and_b32 v29, 0xffff0000, v32
    v_mov_b32 v30, 1092616192
    v_mov_b32 v31, 0x3fb8aa3b
    v_pk_mul_f32 v[14:15], v[14:15], v[30:31] op_sel:[0,0] op_sel_hi:[1,0]
    v_pk_mul_f32 v[16:17], v[16:17], v[30:31] op_sel:[0,0] op_sel_hi:[1,0]
    v_pk_mul_f32 v[18:19], v[18:19], v[30:31] op_sel:[0,0] op_sel_hi:[1,0]
    v_pk_mul_f32 v[20:21], v[20:21], v[30:31] op_sel:[0,0] op_sel_hi:[1,0]
    v_pk_mul_f32 v[22:23], v[22:23], v[30:31] op_sel:[0,0] op_sel_hi:[1,0]
    v_pk_mul_f32 v[24:25], v[24:25], v[30:31] op_sel:[0,0] op_sel_hi:[1,0]
    v_pk_mul_f32 v[26:27], v[26:27], v[30:31] op_sel:[0,0] op_sel_hi:[1,0]
    v_pk_mul_f32 v[28:29], v[28:29], v[30:31] op_sel:[0,0] op_sel_hi:[1,0]
    v_cvt_pk_bf16_f32 v32, v14, v15
    v_lshlrev_b32 v14, 16, v32
    v_and_b32 v15, 0xffff0000, v32
    v_cvt_pk_bf16_f32 v32, v16, v17
    v_lshlrev_b32 v16, 16, v32
    v_and_b32 v17, 0xffff0000, v32
    v_cvt_pk_bf16_f32 v32, v18, v19
    v_lshlrev_b32 v18, 16, v32
    v_and_b32 v19, 0xffff0000, v32
    v_cvt_pk_bf16_f32 v32, v20, v21
    v_lshlrev_b32 v20, 16, v32
    v_and_b32 v21, 0xffff0000, v32
    v_cvt_pk_bf16_f32 v32, v22, v23
    v_lshlrev_b32 v22, 16, v32
    v_and_b32 v23, 0xffff0000, v32
    v_cvt_pk_bf16_f32 v32, v24, v25
    v_lshlrev_b32 v24, 16, v32
    v_and_b32 v25, 0xffff0000, v32
    v_cvt_pk_bf16_f32 v32, v26, v27
    v_lshlrev_b32 v26, 16, v32
    v_and_b32 v27, 0xffff0000, v32
    v_cvt_pk_bf16_f32 v32, v28, v29
    v_lshlrev_b32 v28, 16, v32
    v_and_b32 v29, 0xffff0000, v32
    v_pk_mul_f32 v[14:15], v[14:15], v[30:31] op_sel:[0,1] op_sel_hi:[1,1]
    v_pk_mul_f32 v[16:17], v[16:17], v[30:31] op_sel:[0,1] op_sel_hi:[1,1]
    v_pk_mul_f32 v[18:19], v[18:19], v[30:31] op_sel:[0,1] op_sel_hi:[1,1]
    v_pk_mul_f32 v[20:21], v[20:21], v[30:31] op_sel:[0,1] op_sel_hi:[1,1]
    v_pk_mul_f32 v[22:23], v[22:23], v[30:31] op_sel:[0,1] op_sel_hi:[1,1]
    v_pk_mul_f32 v[24:25], v[24:25], v[30:31] op_sel:[0,1] op_sel_hi:[1,1]
    v_pk_mul_f32 v[26:27], v[26:27], v[30:31] op_sel:[0,1] op_sel_hi:[1,1]
    v_pk_mul_f32 v[28:29], v[28:29], v[30:31] op_sel:[0,1] op_sel_hi:[1,1]
    v_exp_f32 v14, -v14
    v_exp_f32 v15, -v15
    v_exp_f32 v16, -v16
    v_exp_f32 v17, -v17
    v_exp_f32 v18, -v18
    v_exp_f32 v19, -v19
    v_exp_f32 v20, -v20
    v_exp_f32 v21, -v21
    v_exp_f32 v22, -v22
    v_exp_f32 v23, -v23
    v_exp_f32 v24, -v24
    v_exp_f32 v25, -v25
    v_exp_f32 v26, -v26
    v_exp_f32 v27, -v27
    v_exp_f32 v28, -v28
    v_exp_f32 v29, -v29
    v_cvt_pk_bf16_f32 v14, v14, v16
    v_cvt_pk_bf16_f32 v15, v15, v17
    v_cvt_pk_bf16_f32 v18, v18, v20
    v_cvt_pk_bf16_f32 v19, v19, v21
    v_cvt_pk_bf16_f32 v22, v22, v24
    v_cvt_pk_bf16_f32 v23, v23, v25
    v_cvt_pk_bf16_f32 v26, v26, v28
    v_cvt_pk_bf16_f32 v27, v27, v29
    v_dot2_f32_bf16 v72, v14, s68, 0
    v_dot2_f32_bf16 v73, v15, s68, 0
    v_dot2_f32_bf16 v74, v14, s69, 0
    v_dot2_f32_bf16 v75, v15, s69, 0
    v_dot2_f32_bf16 v76, v14, s70, 0
    v_dot2_f32_bf16 v77, v15, s70, 0
    v_dot2_f32_bf16 v78, v14, s71, 0
    v_dot2_f32_bf16 v79, v15, s71, 0
    v_dot2_f32_bf16 v80, v14, s52, 0
    v_dot2_f32_bf16 v81, v15, s52, 0
    v_dot2_f32_bf16 v82, v14, s53, 0
    v_dot2_f32_bf16 v83, v15, s53, 0
    v_dot2_f32_bf16 v84, v14, s54, 0
    v_dot2_f32_bf16 v85, v15, s54, 0
    v_dot2_f32_bf16 v86, v14, s55, 0
    v_dot2_f32_bf16 v87, v15, s55, 0
    v_dot2_f32_bf16 v72, v18, s72, v72
    v_dot2_f32_bf16 v73, v19, s72, v73
    v_dot2_f32_bf16 v74, v18, s73, v74
    v_dot2_f32_bf16 v75, v19, s73, v75
    v_dot2_f32_bf16 v76, v18, s74, v76
    v_dot2_f32_bf16 v77, v19, s74, v77
    v_dot2_f32_bf16 v78, v18, s75, v78
    v_dot2_f32_bf16 v79, v19, s75, v79
    v_dot2_f32_bf16 v80, v18, s56, v80
    v_dot2_f32_bf16 v81, v19, s56, v81
    v_dot2_f32_bf16 v82, v18, s57, v82
    v_dot2_f32_bf16 v83, v19, s57, v83
    v_dot2_f32_bf16 v84, v18, s58, v84
    v_dot2_f32_bf16 v85, v19, s58, v85
    v_dot2_f32_bf16 v86, v18, s59, v86
    v_dot2_f32_bf16 v87, v19, s59, v87
    v_dot2_f32_bf16 v72, v22, s76, v72
    v_dot2_f32_bf16 v73, v23, s76, v73
    v_dot2_f32_bf16 v74, v22, s77, v74
    v_dot2_f32_bf16 v75, v23, s77, v75
    v_dot2_f32_bf16 v76, v22, s78, v76
    v_dot2_f32_bf16 v77, v23, s78, v77
    v_dot2_f32_bf16 v78, v22, s79, v78
    v_dot2_f32_bf16 v79, v23, s79, v79
    v_dot2_f32_bf16 v80, v22, s60, v80
    v_dot2_f32_bf16 v81, v23, s60, v81
    v_dot2_f32_bf16 v82, v22, s61, v82
    v_dot2_f32_bf16 v83, v23, s61, v83
    v_dot2_f32_bf16 v84, v22, s62, v84
    v_dot2_f32_bf16 v85, v23, s62, v85
    v_dot2_f32_bf16 v86, v22, s63, v86
    v_dot2_f32_bf16 v87, v23, s63, v87
    v_dot2_f32_bf16 v72, v26, s80, v72
    v_dot2_f32_bf16 v73, v27, s80, v73
    v_dot2_f32_bf16 v74, v26, s81, v74
    v_dot2_f32_bf16 v75, v27, s81, v75
    v_dot2_f32_bf16 v76, v26, s82, v76
    v_dot2_f32_bf16 v77, v27, s82, v77
    v_dot2_f32_bf16 v78, v26, s83, v78
    v_dot2_f32_bf16 v79, v27, s83, v79
    v_dot2_f32_bf16 v80, v26, s64, v80
    v_dot2_f32_bf16 v81, v27, s64, v81
    v_dot2_f32_bf16 v82, v26, s65, v82
    v_dot2_f32_bf16 v83, v27, s65, v83
    v_dot2_f32_bf16 v84, v26, s66, v84
    v_dot2_f32_bf16 v85, v27, s66, v85
    v_dot2_f32_bf16 v86, v26, s67, v86
    v_dot2_f32_bf16 v87, v27, s67, v87
    s_cmp_ge_u32 s13, 4
    s_cbranch_scc1 L_p2_kernel_g1_6
    v_lshlrev_b32 v30, 16, v61
    v_and_b32 v31, 0xffff0000, v61
    v_pk_add_f32 v[14:15], v[30:31], v[36:37] op_sel:[0,0] op_sel_hi:[1,0] neg_lo:[0,1] neg_hi:[0,1]
    v_pk_add_f32 v[16:17], v[30:31], v[36:37] op_sel:[0,1] op_sel_hi:[1,1] neg_lo:[0,1] neg_hi:[0,1]
    v_pk_add_f32 v[18:19], v[30:31], v[38:39] op_sel:[0,0] op_sel_hi:[1,0] neg_lo:[0,1] neg_hi:[0,1]
    v_pk_add_f32 v[20:21], v[30:31], v[38:39] op_sel:[0,1] op_sel_hi:[1,1] neg_lo:[0,1] neg_hi:[0,1]
    v_pk_add_f32 v[22:23], v[30:31], v[40:41] op_sel:[0,0] op_sel_hi:[1,0] neg_lo:[0,1] neg_hi:[0,1]
    v_pk_add_f32 v[24:25], v[30:31], v[40:41] op_sel:[0,1] op_sel_hi:[1,1] neg_lo:[0,1] neg_hi:[0,1]
    v_pk_add_f32 v[26:27], v[30:31], v[42:43] op_sel:[0,0] op_sel_hi:[1,0] neg_lo:[0,1] neg_hi:[0,1]
    v_pk_add_f32 v[28:29], v[30:31], v[42:43] op_sel:[0,1] op_sel_hi:[1,1] neg_lo:[0,1] neg_hi:[0,1]
    v_cvt_pk_bf16_f32 v32, v14, v15
    v_lshlrev_b32 v14, 16, v32
    v_and_b32 v15, 0xffff0000, v32
    v_cvt_pk_bf16_f32 v32, v16, v17
    v_lshlrev_b32 v16, 16, v32
    v_and_b32 v17, 0xffff0000, v32
    v_cvt_pk_bf16_f32 v32, v18, v19
    v_lshlrev_b32 v18, 16, v32
    v_and_b32 v19, 0xffff0000, v32
    v_cvt_pk_bf16_f32 v32, v20, v21
    v_lshlrev_b32 v20, 16, v32
    v_and_b32 v21, 0xffff0000, v32
    v_cvt_pk_bf16_f32 v32, v22, v23
    v_lshlrev_b32 v22, 16, v32
    v_and_b32 v23, 0xffff0000, v32
    v_cvt_pk_bf16_f32 v32, v24, v25
    v_lshlrev_b32 v24, 16, v32
    v_and_b32 v25, 0xffff0000, v32
    v_cvt_pk_bf16_f32 v32, v26, v27
    v_lshlrev_b32 v26, 16, v32
    v_and_b32 v27, 0xffff0000, v32
    v_cvt_pk_bf16_f32 v32, v28, v29
    v_lshlrev_b32 v28, 16, v32
    v_and_b32 v29, 0xffff0000, v32
    v_pk_mul_f32 v[14:15], v[14:15], v[14:15]
    v_pk_mul_f32 v[16:17], v[16:17], v[16:17]
    v_pk_mul_f32 v[18:19], v[18:19], v[18:19]
    v_pk_mul_f32 v[20:21], v[20:21], v[20:21]
    v_pk_mul_f32 v[22:23], v[22:23], v[22:23]
    v_pk_mul_f32 v[24:25], v[24:25], v[24:25]
    v_pk_mul_f32 v[26:27], v[26:27], v[26:27]
    v_pk_mul_f32 v[28:29], v[28:29], v[28:29]
    v_cvt_pk_bf16_f32 v32, v14, v15
    v_lshlrev_b32 v14, 16, v32
    v_and_b32 v15, 0xffff0000, v32
    v_cvt_pk_bf16_f32 v32, v16, v17
    v_lshlrev_b32 v16, 16, v32
    v_and_b32 v17, 0xffff0000, v32
    v_cvt_pk_bf16_f32 v32, v18, v19
    v_lshlrev_b32 v18, 16, v32
    v_and_b32 v19, 0xffff0000, v32
    v_cvt_pk_bf16_f32 v32, v20, v21
    v_lshlrev_b32 v20, 16, v32
    v_and_b32 v21, 0xffff0000, v32
    v_cvt_pk_bf16_f32 v32, v22, v23
    v_lshlrev_b32 v22, 16, v32
    v_and_b32 v23, 0xffff0000, v32
    v_cvt_pk_bf16_f32 v32, v24, v25
    v_lshlrev_b32 v24, 16, v32
    v_and_b32 v25, 0xffff0000, v32
    v_cvt_pk_bf16_f32 v32, v26, v27
    v_lshlrev_b32 v26, 16, v32
    v_and_b32 v27, 0xffff0000, v32
    v_cvt_pk_bf16_f32 v32, v28, v29
    v_lshlrev_b32 v28, 16, v32
    v_and_b32 v29, 0xffff0000, v32
    v_mov_b32 v30, 1092616192
    v_mov_b32 v31, 0x3fb8aa3b
    v_pk_mul_f32 v[14:15], v[14:15], v[30:31] op_sel:[0,0] op_sel_hi:[1,0]
    v_pk_mul_f32 v[16:17], v[16:17], v[30:31] op_sel:[0,0] op_sel_hi:[1,0]
    v_pk_mul_f32 v[18:19], v[18:19], v[30:31] op_sel:[0,0] op_sel_hi:[1,0]
    v_pk_mul_f32 v[20:21], v[20:21], v[30:31] op_sel:[0,0] op_sel_hi:[1,0]
    v_pk_mul_f32 v[22:23], v[22:23], v[30:31] op_sel:[0,0] op_sel_hi:[1,0]
    v_pk_mul_f32 v[24:25], v[24:25], v[30:31] op_sel:[0,0] op_sel_hi:[1,0]
    v_pk_mul_f32 v[26:27], v[26:27], v[30:31] op_sel:[0,0] op_sel_hi:[1,0]
    v_pk_mul_f32 v[28:29], v[28:29], v[30:31] op_sel:[0,0] op_sel_hi:[1,0]
    v_cvt_pk_bf16_f32 v32, v14, v15
    v_lshlrev_b32 v14, 16, v32
    v_and_b32 v15, 0xffff0000, v32
    v_cvt_pk_bf16_f32 v32, v16, v17
    v_lshlrev_b32 v16, 16, v32
    v_and_b32 v17, 0xffff0000, v32
    v_cvt_pk_bf16_f32 v32, v18, v19
    v_lshlrev_b32 v18, 16, v32
    v_and_b32 v19, 0xffff0000, v32
    v_cvt_pk_bf16_f32 v32, v20, v21
    v_lshlrev_b32 v20, 16, v32
    v_and_b32 v21, 0xffff0000, v32
    v_cvt_pk_bf16_f32 v32, v22, v23
    v_lshlrev_b32 v22, 16, v32
    v_and_b32 v23, 0xffff0000, v32
    v_cvt_pk_bf16_f32 v32, v24, v25
    v_lshlrev_b32 v24, 16, v32
    v_and_b32 v25, 0xffff0000, v32
    v_cvt_pk_bf16_f32 v32, v26, v27
    v_lshlrev_b32 v26, 16, v32
    v_and_b32 v27, 0xffff0000, v32
    v_cvt_pk_bf16_f32 v32, v28, v29
    v_lshlrev_b32 v28, 16, v32
    v_and_b32 v29, 0xffff0000, v32
    v_pk_mul_f32 v[14:15], v[14:15], v[30:31] op_sel:[0,1] op_sel_hi:[1,1]
    v_pk_mul_f32 v[16:17], v[16:17], v[30:31] op_sel:[0,1] op_sel_hi:[1,1]
    v_pk_mul_f32 v[18:19], v[18:19], v[30:31] op_sel:[0,1] op_sel_hi:[1,1]
    v_pk_mul_f32 v[20:21], v[20:21], v[30:31] op_sel:[0,1] op_sel_hi:[1,1]
    v_pk_mul_f32 v[22:23], v[22:23], v[30:31] op_sel:[0,1] op_sel_hi:[1,1]
    v_pk_mul_f32 v[24:25], v[24:25], v[30:31] op_sel:[0,1] op_sel_hi:[1,1]
    v_pk_mul_f32 v[26:27], v[26:27], v[30:31] op_sel:[0,1] op_sel_hi:[1,1]
    v_pk_mul_f32 v[28:29], v[28:29], v[30:31] op_sel:[0,1] op_sel_hi:[1,1]
    v_exp_f32 v14, -v14
    v_exp_f32 v15, -v15
    v_exp_f32 v16, -v16
    v_exp_f32 v17, -v17
    v_exp_f32 v18, -v18
    v_exp_f32 v19, -v19
    v_exp_f32 v20, -v20
    v_exp_f32 v21, -v21
    v_exp_f32 v22, -v22
    v_exp_f32 v23, -v23
    v_exp_f32 v24, -v24
    v_exp_f32 v25, -v25
    v_exp_f32 v26, -v26
    v_exp_f32 v27, -v27
    v_exp_f32 v28, -v28
    v_exp_f32 v29, -v29
    v_cvt_pk_bf16_f32 v14, v14, v16
    v_cvt_pk_bf16_f32 v15, v15, v17
    v_cvt_pk_bf16_f32 v18, v18, v20
    v_cvt_pk_bf16_f32 v19, v19, v21
    v_cvt_pk_bf16_f32 v22, v22, v24
    v_cvt_pk_bf16_f32 v23, v23, v25
    v_cvt_pk_bf16_f32 v26, v26, v28
    v_cvt_pk_bf16_f32 v27, v27, v29
    v_dot2_f32_bf16 v112, v14, s68, 0
    v_dot2_f32_bf16 v113, v15, s68, 0
    v_dot2_f32_bf16 v114, v14, s69, 0
    v_dot2_f32_bf16 v115, v15, s69, 0
    v_dot2_f32_bf16 v116, v14, s70, 0
    v_dot2_f32_bf16 v117, v15, s70, 0
    v_dot2_f32_bf16 v118, v14, s71, 0
    v_dot2_f32_bf16 v119, v15, s71, 0
    v_dot2_f32_bf16 v120, v14, s52, 0
    v_dot2_f32_bf16 v121, v15, s52, 0
    v_dot2_f32_bf16 v122, v14, s53, 0
    v_dot2_f32_bf16 v123, v15, s53, 0
    v_dot2_f32_bf16 v124, v14, s54, 0
    v_dot2_f32_bf16 v125, v15, s54, 0
    v_dot2_f32_bf16 v126, v14, s55, 0
    v_dot2_f32_bf16 v127, v15, s55, 0
    v_dot2_f32_bf16 v112, v18, s72, v112
    v_dot2_f32_bf16 v113, v19, s72, v113
    v_dot2_f32_bf16 v114, v18, s73, v114
    v_dot2_f32_bf16 v115, v19, s73, v115
    v_dot2_f32_bf16 v116, v18, s74, v116
    v_dot2_f32_bf16 v117, v19, s74, v117
    v_dot2_f32_bf16 v118, v18, s75, v118
    v_dot2_f32_bf16 v119, v19, s75, v119
    v_dot2_f32_bf16 v120, v18, s56, v120
    v_dot2_f32_bf16 v121, v19, s56, v121
    v_dot2_f32_bf16 v122, v18, s57, v122
    v_dot2_f32_bf16 v123, v19, s57, v123
    v_dot2_f32_bf16 v124, v18, s58, v124
    v_dot2_f32_bf16 v125, v19, s58, v125
    v_dot2_f32_bf16 v126, v18, s59, v126
    v_dot2_f32_bf16 v127, v19, s59, v127
    v_dot2_f32_bf16 v112, v22, s76, v112
    v_dot2_f32_bf16 v113, v23, s76, v113
    v_dot2_f32_bf16 v114, v22, s77, v114
    v_dot2_f32_bf16 v115, v23, s77, v115
    v_dot2_f32_bf16 v116, v22, s78, v116
    v_dot2_f32_bf16 v117, v23, s78, v117
    v_dot2_f32_bf16 v118, v22, s79, v118
    v_dot2_f32_bf16 v119, v23, s79, v119
    v_dot2_f32_bf16 v120, v22, s60, v120
    v_dot2_f32_bf16 v121, v23, s60, v121
    v_dot2_f32_bf16 v122, v22, s61, v122
    v_dot2_f32_bf16 v123, v23, s61, v123
    v_dot2_f32_bf16 v124, v22, s62, v124
    v_dot2_f32_bf16 v125, v23, s62, v125
    v_dot2_f32_bf16 v126, v22, s63, v126
    v_dot2_f32_bf16 v127, v23, s63, v127
    v_dot2_f32_bf16 v112, v26, s80, v112
    v_dot2_f32_bf16 v113, v27, s80, v113
    v_dot2_f32_bf16 v114, v26, s81, v114
    v_dot2_f32_bf16 v115, v27, s81, v115
    v_dot2_f32_bf16 v116, v26, s82, v116
    v_dot2_f32_bf16 v117, v27, s82, v117
    v_dot2_f32_bf16 v118, v26, s83, v118
    v_dot2_f32_bf16 v119, v27, s83, v119
    v_dot2_f32_bf16 v120, v26, s64, v120
    v_dot2_f32_bf16 v121, v27, s64, v121
    v_dot2_f32_bf16 v122, v26, s65, v122
    v_dot2_f32_bf16 v123, v27, s65, v123
    v_dot2_f32_bf16 v124, v26, s66, v124
    v_dot2_f32_bf16 v125, v27, s66, v125
    v_dot2_f32_bf16 v126, v26, s67, v126
    v_dot2_f32_bf16 v127, v27, s67, v127
L_p2_kernel_g1_6:
L_p2_gb:
    v_and_b32 v4, 0x80008000, v4
    v_cmp_ne_u32 vcc, 0, v4
    v_mov_b32 v8, s27
    v_and_b32 v10, 15, v0
    v_mul_u32_u24 v10, 240, v10
    v_add_u32 v10, 160000, v10
    s_cmp_lg_u64 vcc, 0
    s_cselect_b32 s2, 1, s2
    v_mov_b32 v9, s2
    s_mov_b64 exec, 1
    ds_write_b32 v8, v9
    s_mov_b64 exec, -1
    v_add_u32 v2, 16384, v1
    v_mov_b32 v9, 0x3f000000
    v_cmp_gt_u32 vcc, 226, v0
    s_mov_b32 s49, s12
    s_mov_b32 s51, 0
    v_cndmask_b32 v2, v9, v2, vcc
    s_waitcnt vmcnt(0) lgkmcnt(0)
    s_barrier
    ds_read_b32 v9, v10
    s_mov_b32 s18, 5120000
    s_mov_b32 s19, 0x00020000
    s_waitcnt lgkmcnt(0)
    v_cmp_ne_u32 vcc, 0, v9
    s_nop 1
    s_cmp_lg_u64 vcc, 0
    s_cselect_b32 s2, 1, 0
    s_cbranch_scc1 L_p2_slow
L_p2_signal:
    v_mov_b32 v8, 160228
    s_lshl_b32 s15, s2, 4
    s_or_b32 s15, s15, s21
    s_add_u32 s14, s12, 16
    s_lshl_b32 s20, s15, s14
    s_add_u32 s20, s20, 1
    v_mov_b32 v9, s20
    s_cmp_lg_u32 s13, 15
    s_cbranch_scc1 L_p2_nosig0
    s_lshl_b32 s14, s3, 8
    s_add_u32 s14, s14, 8523776
    s_mov_b64 exec, 1
    buffer_atomic_add v9, off, s[4:7], s14 sc0
    s_mov_b64 exec, -1
L_p2_nosig0:
    s_lshl2_add_u32 s14, s3, s49
    s_mul_i32 s26, s14, 20000
    s_mov_b32 s10, 5120000
    buffer_load_dwordx4 v[64:67], v1, s[8:11], s26 offen
    buffer_load_dwordx4 v[68:71], v2, s[8:11], s26 offen
    s_lshl_b32 s28, s92, 16
    s_and_b32 s29, s92, 0xffff0000
    s_lshl_b32 s30, s93, 16
    s_and_b32 s31, s93, 0xffff0000
    s_lshl_b32 s32, s94, 16
    s_and_b32 s33, s94, 0xffff0000
    s_lshl_b32 s34, s95, 16
    s_and_b32 s35, s95, 0xffff0000
    s_lshl_b32 s36, s96, 16
    s_and_b32 s37, s96, 0xffff0000
    s_lshl_b32 s38, s97, 16
    s_and_b32 s39, s97, 0xffff0000
    s_lshl_b32 s40, s98, 16
    s_and_b32 s41, s98, 0xffff0000
    s_lshl_b32 s42, s99, 16
    s_and_b32 s43, s99, 0xffff0000
    s_and_b32 s99, s91, 0xffff0000
    s_lshl_b32 s98, s91, 16
    s_and_b32 s97, s90, 0xffff0000
    s_lshl_b32 s96, s90, 16
    s_and_b32 s95, s89, 0xffff0000
    s_lshl_b32 s94, s89, 16
    s_and_b32 s93, s88, 0xffff0000
    s_lshl_b32 s92, s88, 16
    s_and_b32 s91, s87, 0xffff0000
    s_lshl_b32 s90, s87, 16
    s_and_b32 s89, s86, 0xffff0000
    s_lshl_b32 s88, s86, 16
    s_and_b32 s87, s85, 0xffff0000
    s_lshl_b32 s86, s85, 16
    s_and_b32 s85, s84, 0xffff0000
    s_lshl_b32 s84, s84, 16
    s_mov_b32 s44, s48
    s_add_u32 s45, s48, 2281701376
    s_cmp_eq_u32 s48, 0
    s_cselect_b32 s45, 0, s45
    s_cmp_lg_u32 s13, 15
    s_cbranch_scc1 L_p2_nosig
    s_waitcnt vmcnt(2)
    v_readfirstlane_b32 s15, v9
    s_lshl_b32 s51, 1, s12
    s_add_u32 s20, s20, s15
    s_and_b32 s15, s20, 0xff
    s_cmp_eq_u32 s15, 4
    s_cbranch_scc0 L_p2_notlast
    s_bfe_u32 s15, s20, 262160
    s_or_b32 s51, s51, s15
    s_branch L_p2_pub
L_p2_notlast:
    s_cmp_lg_u32 s21, 0
    s_cselect_b32 s51, 0, s51
    s_cbranch_scc1 L_p2_pub
L_p2_poll:
    v_mov_b32 v9, 0
    s_lshl_b32 s14, s3, 8
    s_add_u32 s14, s14, 8523776
    s_mov_b64 exec, 1
    buffer_atomic_add v9, off, s[4:7], s14 sc0
    s_mov_b64 exec, -1
    s_waitcnt vmcnt(0)
    v_readfirstlane_b32 s20, v9
    s_nop 0
    s_and_b32 s15, s20, 0xff
    s_cmp_lt_u32 s15, 4
    s_cbranch_scc1 L_p2_poll
L_p2_pub:
    s_lshl_b32 s15, s51, 24
    s_or_b32 s15, s15, s20
    v_mov_b32 v9, s15
    s_mov_b64 exec, 1
    ds_write_b32 v8, v9
    s_mov_b64 exec, -1
    s_waitcnt lgkmcnt(0)
L_p2_nosig:
    s_barrier
    ds_read_b32 v9, v8
    s_waitcnt lgkmcnt(0)
    v_readfirstlane_b32 s20, v9
    s_nop 0
    s_lshr_b32 s51, s20, 24
    s_cbranch_scc0 L_p2_end
L_p2_fin:
    s_mul_i32 s24, s49, 20000
    s_add_u32 s14, s12, 1
    s_and_b32 s14, s14, 3
    s_mul_i32 s15, s14, 5120000
    s_add_u32 s15, s15, 228589568
    s_add_u32 s15, s15, s26
    buffer_load_dwordx4 v[12:15], v1, s[4:7], s15 offen sc1
    buffer_load_dwordx4 v[92:95], v2, s[4:7], s15 offen sc1
    s_add_u32 s14, s12, 2
    s_and_b32 s14, s14, 3
    s_mul_i32 s15, s14, 5120000
    s_add_u32 s15, s15, 228589568
    s_add_u32 s15, s15, s26
    buffer_load_dwordx4 v[16:19], v1, s[4:7], s15 offen sc1
    buffer_load_dwordx4 v[96:99], v2, s[4:7], s15 offen sc1
    s_add_u32 s14, s12, 3
    s_and_b32 s14, s14, 3
    s_mul_i32 s15, s14, 5120000
    s_add_u32 s15, s15, 228589568
    s_add_u32 s15, s15, s26
    buffer_load_dwordx4 v[20:23], v1, s[4:7], s15 offen sc1
    buffer_load_dwordx4 v[100:103], v2, s[4:7], s15 offen sc1
    v_add_u32 v24, s24, v1
    ds_read_b128 v[8:11], v24
    v_add_u32 v25, s24, v2
    ds_read_b128 v[88:91], v25
    s_waitcnt vmcnt(0) lgkmcnt(0)
    s_bfe_u32 s14, s20, 262164
    s_cbranch_scc0 L_p2_kernel_nof32a_7
    s_add_u32 s14, s12, 0
    s_and_b32 s14, s14, 3
    s_add_u32 s14, s14, 20
    s_bitcmp1_b32 s20, s14
    s_cbranch_scc0 L_p2_kernel_q_8
    v_mov_b32 v8, 1073758208
    v_mov_b32 v9, 1073758208
    v_mov_b32 v10, 1073758208
    v_mov_b32 v11, 1073758208
L_p2_kernel_q_8:
    s_add_u32 s14, s12, 1
    s_and_b32 s14, s14, 3
    s_add_u32 s14, s14, 20
    s_bitcmp1_b32 s20, s14
    s_cbranch_scc0 L_p2_kernel_q_9
    v_mov_b32 v12, 1073758208
    v_mov_b32 v13, 1073758208
    v_mov_b32 v14, 1073758208
    v_mov_b32 v15, 1073758208
L_p2_kernel_q_9:
    s_add_u32 s14, s12, 2
    s_and_b32 s14, s14, 3
    s_add_u32 s14, s14, 20
    s_bitcmp1_b32 s20, s14
    s_cbranch_scc0 L_p2_kernel_q_10
    v_mov_b32 v16, 1073758208
    v_mov_b32 v17, 1073758208
    v_mov_b32 v18, 1073758208
    v_mov_b32 v19, 1073758208
L_p2_kernel_q_10:
    s_add_u32 s14, s12, 3
    s_and_b32 s14, s14, 3
    s_add_u32 s14, s14, 20
    s_bitcmp1_b32 s20, s14
    s_cbranch_scc0 L_p2_kernel_q_11
    v_mov_b32 v20, 1073758208
    v_mov_b32 v21, 1073758208
    v_mov_b32 v22, 1073758208
    v_mov_b32 v23, 1073758208
L_p2_kernel_q_11:
L_p2_kernel_nof32a_7:
    v_pk_add_u16 v8, v8, v12
    v_pk_add_u16 v16, v16, v20
    v_pk_add_u16 v9, v9, v13
    v_pk_add_u16 v17, v17, v21
    v_pk_add_u16 v10, v10, v14
    v_pk_add_u16 v18, v18, v22
    v_pk_add_u16 v11, v11, v15
    v_pk_add_u16 v19, v19, v23
    v_add_u32_sdwa v24, v8, v16 dst_sel:DWORD dst_unused:UNUSED_PAD src0_sel:WORD_0 src1_sel:WORD_0
    v_add_u32_sdwa v25, v10, v18 dst_sel:DWORD dst_unused:UNUSED_PAD src0_sel:WORD_0 src1_sel:WORD_0
    v_add_u32_sdwa v26, v8, v16 dst_sel:DWORD dst_unused:UNUSED_PAD src0_sel:WORD_1 src1_sel:WORD_1
    v_add_u32_sdwa v27, v10, v18 dst_sel:DWORD dst_unused:UNUSED_PAD src0_sel:WORD_1 src1_sel:WORD_1
    v_add_u32_sdwa v28, v9, v17 dst_sel:DWORD dst_unused:UNUSED_PAD src0_sel:WORD_0 src1_sel:WORD_0
    v_add_u32_sdwa v29, v11, v19 dst_sel:DWORD dst_unused:UNUSED_PAD src0_sel:WORD_0 src1_sel:WORD_0
    v_add_u32_sdwa v30, v9, v17 dst_sel:DWORD dst_unused:UNUSED_PAD src0_sel:WORD_1 src1_sel:WORD_1
    v_add_u32_sdwa v31, v11, v19 dst_sel:DWORD dst_unused:UNUSED_PAD src0_sel:WORD_1 src1_sel:WORD_1
    v_cvt_f32_u32 v24, v24
    v_cvt_f32_u32 v25, v25
    v_cvt_f32_u32 v26, v26
    v_cvt_f32_u32 v27, v27
    v_cvt_f32_u32 v28, v28
    v_cvt_f32_u32 v29, v29
    v_cvt_f32_u32 v30, v30
    v_cvt_f32_u32 v31, v31
    v_pk_fma_f32 v[24:25], v[24:25], s[44:45], s[44:45] op_sel:[0,0,1] op_sel_hi:[1,0,1]
    v_pk_fma_f32 v[26:27], v[26:27], s[44:45], s[44:45] op_sel:[0,0,1] op_sel_hi:[1,0,1]
    v_pk_fma_f32 v[28:29], v[28:29], s[44:45], s[44:45] op_sel:[0,0,1] op_sel_hi:[1,0,1]
    v_pk_fma_f32 v[30:31], v[30:31], s[44:45], s[44:45] op_sel:[0,0,1] op_sel_hi:[1,0,1]
    s_bfe_u32 s14, s20, 262164
    s_cbranch_scc0 L_p2_kernel_nof32b_12
    v_lshlrev_b32 v32, 1, v1
    s_bitcmp1_b32 s20, 20
    s_cbranch_scc0 L_p2_kernel_q_13
    s_lshl_b32 s15, s26, 1
    s_add_u32 s15, s15, 249069568
    buffer_load_dwordx4 v[8:11], v32, s[4:7], s15 offen sc1
    buffer_load_dwordx4 v[12:15], v32, s[4:7], s15 offen offset:16 sc1
    s_waitcnt vmcnt(0)
    v_add_f32 v24, v24, v8
    v_add_f32 v25, v25, v12
    v_add_f32 v26, v26, v9
    v_add_f32 v27, v27, v13
    v_add_f32 v28, v28, v10
    v_add_f32 v29, v29, v14
    v_add_f32 v30, v30, v11
    v_add_f32 v31, v31, v15
L_p2_kernel_q_13:
    s_bitcmp1_b32 s20, 21
    s_cbranch_scc0 L_p2_kernel_q_14
    s_lshl_b32 s15, s26, 1
    s_add_u32 s15, s15, 259309568
    buffer_load_dwordx4 v[8:11], v32, s[4:7], s15 offen sc1
    buffer_load_dwordx4 v[12:15], v32, s[4:7], s15 offen offset:16 sc1
    s_waitcnt vmcnt(0)
    v_add_f32 v24, v24, v8
    v_add_f32 v25, v25, v12
    v_add_f32 v26, v26, v9
    v_add_f32 v27, v27, v13
    v_add_f32 v28, v28, v10
    v_add_f32 v29, v29, v14
    v_add_f32 v30, v30, v11
    v_add_f32 v31, v31, v15
L_p2_kernel_q_14:
    s_bitcmp1_b32 s20, 22
    s_cbranch_scc0 L_p2_kernel_q_15
    s_lshl_b32 s15, s26, 1
    s_add_u32 s15, s15, 269549568
    buffer_load_dwordx4 v[8:11], v32, s[4:7], s15 offen sc1
    buffer_load_dwordx4 v[12:15], v32, s[4:7], s15 offen offset:16 sc1
    s_waitcnt vmcnt(0)
    v_add_f32 v24, v24, v8
    v_add_f32 v25, v25, v12
    v_add_f32 v26, v26, v9
    v_add_f32 v27, v27, v13
    v_add_f32 v28, v28, v10
    v_add_f32 v29, v29, v14
    v_add_f32 v30, v30, v11
    v_add_f32 v31, v31, v15
L_p2_kernel_q_15:
    s_bitcmp1_b32 s20, 23
    s_cbranch_scc0 L_p2_kernel_q_16
    s_lshl_b32 s15, s26, 1
    s_add_u32 s15, s15, 279789568
    buffer_load_dwordx4 v[8:11], v32, s[4:7], s15 offen sc1
    buffer_load_dwordx4 v[12:15], v32, s[4:7], s15 offen offset:16 sc1
    s_waitcnt vmcnt(0)
    v_add_f32 v24, v24, v8
    v_add_f32 v25, v25, v12
    v_add_f32 v26, v26, v9
    v_add_f32 v27, v27, v13
    v_add_f32 v28, v28, v10
    v_add_f32 v29, v29, v14
    v_add_f32 v30, v30, v11
    v_add_f32 v31, v31, v15
L_p2_kernel_q_16:
L_p2_kernel_nof32b_12:
    v_pk_mul_f32 v[8:9], v[24:25], s[84:85] op_sel:[0,0] op_sel_hi:[1,0]
    v_pk_mul_f32 v[10:11], v[24:25], s[84:85] op_sel:[0,1] op_sel_hi:[1,1]
    v_pk_mul_f32 v[12:13], v[24:25], s[86:87] op_sel:[0,0] op_sel_hi:[1,0]
    v_pk_mul_f32 v[14:15], v[24:25], s[86:87] op_sel:[0,1] op_sel_hi:[1,1]
    v_pk_fma_f32 v[8:9], v[26:27], s[88:89], v[8:9] op_sel:[0,0,0] op_sel_hi:[1,0,1]
    v_pk_fma_f32 v[10:11], v[26:27], s[88:89], v[10:11] op_sel:[0,1,0] op_sel_hi:[1,1,1]
    v_pk_fma_f32 v[12:13], v[26:27], s[90:91], v[12:13] op_sel:[0,0,0] op_sel_hi:[1,0,1]
    v_pk_fma_f32 v[14:15], v[26:27], s[90:91], v[14:15] op_sel:[0,1,0] op_sel_hi:[1,1,1]
    v_pk_fma_f32 v[8:9], v[28:29], s[92:93], v[8:9] op_sel:[0,0,0] op_sel_hi:[1,0,1]
    v_pk_fma_f32 v[10:11], v[28:29], s[92:93], v[10:11] op_sel:[0,1,0] op_sel_hi:[1,1,1]
    v_pk_fma_f32 v[12:13], v[28:29], s[94:95], v[12:13] op_sel:[0,0,0] op_sel_hi:[1,0,1]
    v_pk_fma_f32 v[14:15], v[28:29], s[94:95], v[14:15] op_sel:[0,1,0] op_sel_hi:[1,1,1]
    v_pk_fma_f32 v[8:9], v[30:31], s[96:97], v[8:9] op_sel:[0,0,0] op_sel_hi:[1,0,1]
    v_pk_fma_f32 v[10:11], v[30:31], s[96:97], v[10:11] op_sel:[0,1,0] op_sel_hi:[1,1,1]
    v_pk_fma_f32 v[12:13], v[30:31], s[98:99], v[12:13] op_sel:[0,0,0] op_sel_hi:[1,0,1]
    v_pk_fma_f32 v[14:15], v[30:31], s[98:99], v[14:15] op_sel:[0,1,0] op_sel_hi:[1,1,1]
    v_pk_mul_f32 v[8:9], v[8:9], v[72:73]
    v_pk_mul_f32 v[10:11], v[10:11], v[74:75]
    v_pk_mul_f32 v[12:13], v[12:13], v[76:77]
    v_pk_mul_f32 v[14:15], v[14:15], v[78:79]
    v_pk_mul_f32 v[24:25], v[8:9], s[28:29] op_sel:[0,0] op_sel_hi:[1,0]
    v_pk_mul_f32 v[26:27], v[8:9], s[28:29] op_sel:[0,1] op_sel_hi:[1,1]
    v_pk_mul_f32 v[28:29], v[8:9], s[30:31] op_sel:[0,0] op_sel_hi:[1,0]
    v_pk_mul_f32 v[30:31], v[8:9], s[30:31] op_sel:[0,1] op_sel_hi:[1,1]
    v_pk_fma_f32 v[24:25], v[10:11], s[32:33], v[24:25] op_sel:[0,0,0] op_sel_hi:[1,0,1]
    v_pk_fma_f32 v[26:27], v[10:11], s[32:33], v[26:27] op_sel:[0,1,0] op_sel_hi:[1,1,1]
    v_pk_fma_f32 v[28:29], v[10:11], s[34:35], v[28:29] op_sel:[0,0,0] op_sel_hi:[1,0,1]
    v_pk_fma_f32 v[30:31], v[10:11], s[34:35], v[30:31] op_sel:[0,1,0] op_sel_hi:[1,1,1]
    v_pk_fma_f32 v[24:25], v[12:13], s[36:37], v[24:25] op_sel:[0,0,0] op_sel_hi:[1,0,1]
    v_pk_fma_f32 v[26:27], v[12:13], s[36:37], v[26:27] op_sel:[0,1,0] op_sel_hi:[1,1,1]
    v_pk_fma_f32 v[28:29], v[12:13], s[38:39], v[28:29] op_sel:[0,0,0] op_sel_hi:[1,0,1]
    v_pk_fma_f32 v[30:31], v[12:13], s[38:39], v[30:31] op_sel:[0,1,0] op_sel_hi:[1,1,1]
    v_pk_fma_f32 v[24:25], v[14:15], s[40:41], v[24:25] op_sel:[0,0,0] op_sel_hi:[1,0,1]
    v_pk_fma_f32 v[26:27], v[14:15], s[40:41], v[26:27] op_sel:[0,1,0] op_sel_hi:[1,1,1]
    v_pk_fma_f32 v[28:29], v[14:15], s[42:43], v[28:29] op_sel:[0,0,0] op_sel_hi:[1,0,1]
    v_pk_fma_f32 v[30:31], v[14:15], s[42:43], v[30:31] op_sel:[0,1,0] op_sel_hi:[1,1,1]
    v_lshlrev_b32 v8, 16, v64
    v_and_b32 v10, 0xffff0000, v64
    v_lshlrev_b32 v12, 16, v65
    v_and_b32 v14, 0xffff0000, v65
    v_lshlrev_b32 v9, 16, v66
    v_and_b32 v11, 0xffff0000, v66
    v_lshlrev_b32 v13, 16, v67
    v_and_b32 v15, 0xffff0000, v67
    v_pk_fma_f32 v[8:9], v[24:25], v[80:81], v[8:9]
    v_pk_fma_f32 v[10:11], v[26:27], v[82:83], v[10:11]
    v_pk_fma_f32 v[12:13], v[28:29], v[84:85], v[12:13]
    v_pk_fma_f32 v[14:15], v[30:31], v[86:87], v[14:15]
    v_cvt_pk_bf16_f32 v16, v8, v10
    v_cvt_pk_bf16_f32 v17, v12, v14
    v_cvt_pk_bf16_f32 v18, v9, v11
    v_cvt_pk_bf16_f32 v19, v13, v15
    buffer_store_dwordx4 v[16:19], v1, s[16:19], s26 offen
    s_cmp_ge_u32 s13, 4
    s_cbranch_scc1 L_p2_f1
    s_bfe_u32 s14, s20, 262164
    s_cbranch_scc0 L_p2_kernel_nof32a_17
    s_add_u32 s14, s12, 0
    s_and_b32 s14, s14, 3
    s_add_u32 s14, s14, 20
    s_bitcmp1_b32 s20, s14
    s_cbranch_scc0 L_p2_kernel_q_18
    v_mov_b32 v88, 1073758208
    v_mov_b32 v89, 1073758208
    v_mov_b32 v90, 1073758208
    v_mov_b32 v91, 1073758208
L_p2_kernel_q_18:
    s_add_u32 s14, s12, 1
    s_and_b32 s14, s14, 3
    s_add_u32 s14, s14, 20
    s_bitcmp1_b32 s20, s14
    s_cbranch_scc0 L_p2_kernel_q_19
    v_mov_b32 v92, 1073758208
    v_mov_b32 v93, 1073758208
    v_mov_b32 v94, 1073758208
    v_mov_b32 v95, 1073758208
L_p2_kernel_q_19:
    s_add_u32 s14, s12, 2
    s_and_b32 s14, s14, 3
    s_add_u32 s14, s14, 20
    s_bitcmp1_b32 s20, s14
    s_cbranch_scc0 L_p2_kernel_q_20
    v_mov_b32 v96, 1073758208
    v_mov_b32 v97, 1073758208
    v_mov_b32 v98, 1073758208
    v_mov_b32 v99, 1073758208
L_p2_kernel_q_20:
    s_add_u32 s14, s12, 3
    s_and_b32 s14, s14, 3
    s_add_u32 s14, s14, 20
    s_bitcmp1_b32 s20, s14
    s_cbranch_scc0 L_p2_kernel_q_21
    v_mov_b32 v100, 1073758208
    v_mov_b32 v101, 1073758208
    v_mov_b32 v102, 1073758208
    v_mov_b32 v103, 1073758208
L_p2_kernel_q_21:
L_p2_kernel_nof32a_17:
    v_pk_add_u16 v88, v88, v92
    v_pk_add_u16 v96, v96, v100
    v_pk_add_u16 v89, v89, v93
    v_pk_add_u16 v97, v97, v101
    v_pk_add_u16 v90, v90, v94
    v_pk_add_u16 v98, v98, v102
    v_pk_add_u16 v91, v91, v95
    v_pk_add_u16 v99, v99, v103
    v_add_u32_sdwa v24, v88, v96 dst_sel:DWORD dst_unused:UNUSED_PAD src0_sel:WORD_0 src1_sel:WORD_0
    v_add_u32_sdwa v25, v90, v98 dst_sel:DWORD dst_unused:UNUSED_PAD src0_sel:WORD_0 src1_sel:WORD_0
    v_add_u32_sdwa v26, v88, v96 dst_sel:DWORD dst_unused:UNUSED_PAD src0_sel:WORD_1 src1_sel:WORD_1
    v_add_u32_sdwa v27, v90, v98 dst_sel:DWORD dst_unused:UNUSED_PAD src0_sel:WORD_1 src1_sel:WORD_1
    v_add_u32_sdwa v28, v89, v97 dst_sel:DWORD dst_unused:UNUSED_PAD src0_sel:WORD_0 src1_sel:WORD_0
    v_add_u32_sdwa v29, v91, v99 dst_sel:DWORD dst_unused:UNUSED_PAD src0_sel:WORD_0 src1_sel:WORD_0
    v_add_u32_sdwa v30, v89, v97 dst_sel:DWORD dst_unused:UNUSED_PAD src0_sel:WORD_1 src1_sel:WORD_1
    v_add_u32_sdwa v31, v91, v99 dst_sel:DWORD dst_unused:UNUSED_PAD src0_sel:WORD_1 src1_sel:WORD_1
    v_cvt_f32_u32 v24, v24
    v_cvt_f32_u32 v25, v25
    v_cvt_f32_u32 v26, v26
    v_cvt_f32_u32 v27, v27
    v_cvt_f32_u32 v28, v28
    v_cvt_f32_u32 v29, v29
    v_cvt_f32_u32 v30, v30
    v_cvt_f32_u32 v31, v31
    v_pk_fma_f32 v[24:25], v[24:25], s[44:45], s[44:45] op_sel:[0,0,1] op_sel_hi:[1,0,1]
    v_pk_fma_f32 v[26:27], v[26:27], s[44:45], s[44:45] op_sel:[0,0,1] op_sel_hi:[1,0,1]
    v_pk_fma_f32 v[28:29], v[28:29], s[44:45], s[44:45] op_sel:[0,0,1] op_sel_hi:[1,0,1]
    v_pk_fma_f32 v[30:31], v[30:31], s[44:45], s[44:45] op_sel:[0,0,1] op_sel_hi:[1,0,1]
    s_bfe_u32 s14, s20, 262164
    s_cbranch_scc0 L_p2_kernel_nof32b_22
    v_lshlrev_b32 v32, 1, v2
    s_bitcmp1_b32 s20, 20
    s_cbranch_scc0 L_p2_kernel_q_23
    s_lshl_b32 s15, s26, 1
    s_add_u32 s15, s15, 249069568
    buffer_load_dwordx4 v[88:91], v32, s[4:7], s15 offen sc1
    buffer_load_dwordx4 v[92:95], v32, s[4:7], s15 offen offset:16 sc1
    s_waitcnt vmcnt(0)
    v_add_f32 v24, v24, v88
    v_add_f32 v25, v25, v92
    v_add_f32 v26, v26, v89
    v_add_f32 v27, v27, v93
    v_add_f32 v28, v28, v90
    v_add_f32 v29, v29, v94
    v_add_f32 v30, v30, v91
    v_add_f32 v31, v31, v95
L_p2_kernel_q_23:
    s_bitcmp1_b32 s20, 21
    s_cbranch_scc0 L_p2_kernel_q_24
    s_lshl_b32 s15, s26, 1
    s_add_u32 s15, s15, 259309568
    buffer_load_dwordx4 v[88:91], v32, s[4:7], s15 offen sc1
    buffer_load_dwordx4 v[92:95], v32, s[4:7], s15 offen offset:16 sc1
    s_waitcnt vmcnt(0)
    v_add_f32 v24, v24, v88
    v_add_f32 v25, v25, v92
    v_add_f32 v26, v26, v89
    v_add_f32 v27, v27, v93
    v_add_f32 v28, v28, v90
    v_add_f32 v29, v29, v94
    v_add_f32 v30, v30, v91
    v_add_f32 v31, v31, v95
L_p2_kernel_q_24:
    s_bitcmp1_b32 s20, 22
    s_cbranch_scc0 L_p2_kernel_q_25
    s_lshl_b32 s15, s26, 1
    s_add_u32 s15, s15, 269549568
    buffer_load_dwordx4 v[88:91], v32, s[4:7], s15 offen sc1
    buffer_load_dwordx4 v[92:95], v32, s[4:7], s15 offen offset:16 sc1
    s_waitcnt vmcnt(0)
    v_add_f32 v24, v24, v88
    v_add_f32 v25, v25, v92
    v_add_f32 v26, v26, v89
    v_add_f32 v27, v27, v93
    v_add_f32 v28, v28, v90
    v_add_f32 v29, v29, v94
    v_add_f32 v30, v30, v91
    v_add_f32 v31, v31, v95
L_p2_kernel_q_25:
    s_bitcmp1_b32 s20, 23
    s_cbranch_scc0 L_p2_kernel_q_26
    s_lshl_b32 s15, s26, 1
    s_add_u32 s15, s15, 279789568
    buffer_load_dwordx4 v[88:91], v32, s[4:7], s15 offen sc1
    buffer_load_dwordx4 v[92:95], v32, s[4:7], s15 offen offset:16 sc1
    s_waitcnt vmcnt(0)
    v_add_f32 v24, v24, v88
    v_add_f32 v25, v25, v92
    v_add_f32 v26, v26, v89
    v_add_f32 v27, v27, v93
    v_add_f32 v28, v28, v90
    v_add_f32 v29, v29, v94
    v_add_f32 v30, v30, v91
    v_add_f32 v31, v31, v95
L_p2_kernel_q_26:
L_p2_kernel_nof32b_22:
    v_pk_mul_f32 v[88:89], v[24:25], s[84:85] op_sel:[0,0] op_sel_hi:[1,0]
    v_pk_mul_f32 v[90:91], v[24:25], s[84:85] op_sel:[0,1] op_sel_hi:[1,1]
    v_pk_mul_f32 v[92:93], v[24:25], s[86:87] op_sel:[0,0] op_sel_hi:[1,0]
    v_pk_mul_f32 v[94:95], v[24:25], s[86:87] op_sel:[0,1] op_sel_hi:[1,1]
    v_pk_fma_f32 v[88:89], v[26:27], s[88:89], v[88:89] op_sel:[0,0,0] op_sel_hi:[1,0,1]
    v_pk_fma_f32 v[90:91], v[26:27], s[88:89], v[90:91] op_sel:[0,1,0] op_sel_hi:[1,1,1]
    v_pk_fma_f32 v[92:93], v[26:27], s[90:91], v[92:93] op_sel:[0,0,0] op_sel_hi:[1,0,1]
    v_pk_fma_f32 v[94:95], v[26:27], s[90:91], v[94:95] op_sel:[0,1,0] op_sel_hi:[1,1,1]
    v_pk_fma_f32 v[88:89], v[28:29], s[92:93], v[88:89] op_sel:[0,0,0] op_sel_hi:[1,0,1]
    v_pk_fma_f32 v[90:91], v[28:29], s[92:93], v[90:91] op_sel:[0,1,0] op_sel_hi:[1,1,1]
    v_pk_fma_f32 v[92:93], v[28:29], s[94:95], v[92:93] op_sel:[0,0,0] op_sel_hi:[1,0,1]
    v_pk_fma_f32 v[94:95], v[28:29], s[94:95], v[94:95] op_sel:[0,1,0] op_sel_hi:[1,1,1]
    v_pk_fma_f32 v[88:89], v[30:31], s[96:97], v[88:89] op_sel:[0,0,0] op_sel_hi:[1,0,1]
    v_pk_fma_f32 v[90:91], v[30:31], s[96:97], v[90:91] op_sel:[0,1,0] op_sel_hi:[1,1,1]
    v_pk_fma_f32 v[92:93], v[30:31], s[98:99], v[92:93] op_sel:[0,0,0] op_sel_hi:[1,0,1]
    v_pk_fma_f32 v[94:95], v[30:31], s[98:99], v[94:95] op_sel:[0,1,0] op_sel_hi:[1,1,1]
    v_pk_mul_f32 v[88:89], v[88:89], v[112:113]
    v_pk_mul_f32 v[90:91], v[90:91], v[114:115]
    v_pk_mul_f32 v[92:93], v[92:93], v[116:117]
    v_pk_mul_f32 v[94:95], v[94:95], v[118:119]
    v_pk_mul_f32 v[24:25], v[88:89], s[28:29] op_sel:[0,0] op_sel_hi:[1,0]
    v_pk_mul_f32 v[26:27], v[88:89], s[28:29] op_sel:[0,1] op_sel_hi:[1,1]
    v_pk_mul_f32 v[28:29], v[88:89], s[30:31] op_sel:[0,0] op_sel_hi:[1,0]
    v_pk_mul_f32 v[30:31], v[88:89], s[30:31] op_sel:[0,1] op_sel_hi:[1,1]
    v_pk_fma_f32 v[24:25], v[90:91], s[32:33], v[24:25] op_sel:[0,0,0] op_sel_hi:[1,0,1]
    v_pk_fma_f32 v[26:27], v[90:91], s[32:33], v[26:27] op_sel:[0,1,0] op_sel_hi:[1,1,1]
    v_pk_fma_f32 v[28:29], v[90:91], s[34:35], v[28:29] op_sel:[0,0,0] op_sel_hi:[1,0,1]
    v_pk_fma_f32 v[30:31], v[90:91], s[34:35], v[30:31] op_sel:[0,1,0] op_sel_hi:[1,1,1]
    v_pk_fma_f32 v[24:25], v[92:93], s[36:37], v[24:25] op_sel:[0,0,0] op_sel_hi:[1,0,1]
    v_pk_fma_f32 v[26:27], v[92:93], s[36:37], v[26:27] op_sel:[0,1,0] op_sel_hi:[1,1,1]
    v_pk_fma_f32 v[28:29], v[92:93], s[38:39], v[28:29] op_sel:[0,0,0] op_sel_hi:[1,0,1]
    v_pk_fma_f32 v[30:31], v[92:93], s[38:39], v[30:31] op_sel:[0,1,0] op_sel_hi:[1,1,1]
    v_pk_fma_f32 v[24:25], v[94:95], s[40:41], v[24:25] op_sel:[0,0,0] op_sel_hi:[1,0,1]
    v_pk_fma_f32 v[26:27], v[94:95], s[40:41], v[26:27] op_sel:[0,1,0] op_sel_hi:[1,1,1]
    v_pk_fma_f32 v[28:29], v[94:95], s[42:43], v[28:29] op_sel:[0,0,0] op_sel_hi:[1,0,1]
    v_pk_fma_f32 v[30:31], v[94:95], s[42:43], v[30:31] op_sel:[0,1,0] op_sel_hi:[1,1,1]
    v_lshlrev_b32 v88, 16, v68
    v_and_b32 v90, 0xffff0000, v68
    v_lshlrev_b32 v92, 16, v69
    v_and_b32 v94, 0xffff0000, v69
    v_lshlrev_b32 v89, 16, v70
    v_and_b32 v91, 0xffff0000, v70
    v_lshlrev_b32 v93, 16, v71
    v_and_b32 v95, 0xffff0000, v71
    v_pk_fma_f32 v[88:89], v[24:25], v[120:121], v[88:89]
    v_pk_fma_f32 v[90:91], v[26:27], v[122:123], v[90:91]
    v_pk_fma_f32 v[92:93], v[28:29], v[124:125], v[92:93]
    v_pk_fma_f32 v[94:95], v[30:31], v[126:127], v[94:95]
    v_cvt_pk_bf16_f32 v96, v88, v90
    v_cvt_pk_bf16_f32 v97, v92, v94
    v_cvt_pk_bf16_f32 v98, v89, v91
    v_cvt_pk_bf16_f32 v99, v93, v95
    buffer_store_dwordx4 v[96:99], v2, s[16:19], s26 offen
L_p2_f1:
    s_bitset0_b32 s51, s49
    s_cmp_eq_u32 s51, 0
    s_cbranch_scc1 L_p2_done
    s_ff1_i32_b32 s49, s51
    s_lshl2_add_u32 s14, s3, s49
    s_mul_i32 s14, s14, 5000
    s_add_u32 s15, s14, 4096
    v_min_u32 v61, 225, v0
    v_lshl_add_u32 v60, v0, 2, s14
    v_lshl_add_u32 v61, v61, 2, s15
    global_load_dword v60, v60, s[100:101] nt
    global_load_dword v61, v61, s[100:101] nt
    s_waitcnt vmcnt(0)
    v_lshlrev_b32 v30, 16, v60
    v_and_b32 v31, 0xffff0000, v60
    v_lshlrev_b32 v36, 16, v53
    v_and_b32 v37, 0xffff0000, v53
    v_lshlrev_b32 v38, 16, v54
    v_and_b32 v39, 0xffff0000, v54
    v_lshlrev_b32 v40, 16, v56
    v_and_b32 v41, 0xffff0000, v56
    v_lshlrev_b32 v42, 16, v57
    v_and_b32 v43, 0xffff0000, v57
    v_pk_add_f32 v[14:15], v[30:31], v[36:37] op_sel:[0,0] op_sel_hi:[1,0] neg_lo:[0,1] neg_hi:[0,1]
    v_pk_add_f32 v[16:17], v[30:31], v[36:37] op_sel:[0,1] op_sel_hi:[1,1] neg_lo:[0,1] neg_hi:[0,1]
    v_pk_add_f32 v[18:19], v[30:31], v[38:39] op_sel:[0,0] op_sel_hi:[1,0] neg_lo:[0,1] neg_hi:[0,1]
    v_pk_add_f32 v[20:21], v[30:31], v[38:39] op_sel:[0,1] op_sel_hi:[1,1] neg_lo:[0,1] neg_hi:[0,1]
    v_pk_add_f32 v[22:23], v[30:31], v[40:41] op_sel:[0,0] op_sel_hi:[1,0] neg_lo:[0,1] neg_hi:[0,1]
    v_pk_add_f32 v[24:25], v[30:31], v[40:41] op_sel:[0,1] op_sel_hi:[1,1] neg_lo:[0,1] neg_hi:[0,1]
    v_pk_add_f32 v[26:27], v[30:31], v[42:43] op_sel:[0,0] op_sel_hi:[1,0] neg_lo:[0,1] neg_hi:[0,1]
    v_pk_add_f32 v[28:29], v[30:31], v[42:43] op_sel:[0,1] op_sel_hi:[1,1] neg_lo:[0,1] neg_hi:[0,1]
    v_cvt_pk_bf16_f32 v32, v14, v15
    v_lshlrev_b32 v14, 16, v32
    v_and_b32 v15, 0xffff0000, v32
    v_cvt_pk_bf16_f32 v32, v16, v17
    v_lshlrev_b32 v16, 16, v32
    v_and_b32 v17, 0xffff0000, v32
    v_cvt_pk_bf16_f32 v32, v18, v19
    v_lshlrev_b32 v18, 16, v32
    v_and_b32 v19, 0xffff0000, v32
    v_cvt_pk_bf16_f32 v32, v20, v21
    v_lshlrev_b32 v20, 16, v32
    v_and_b32 v21, 0xffff0000, v32
    v_cvt_pk_bf16_f32 v32, v22, v23
    v_lshlrev_b32 v22, 16, v32
    v_and_b32 v23, 0xffff0000, v32
    v_cvt_pk_bf16_f32 v32, v24, v25
    v_lshlrev_b32 v24, 16, v32
    v_and_b32 v25, 0xffff0000, v32
    v_cvt_pk_bf16_f32 v32, v26, v27
    v_lshlrev_b32 v26, 16, v32
    v_and_b32 v27, 0xffff0000, v32
    v_cvt_pk_bf16_f32 v32, v28, v29
    v_lshlrev_b32 v28, 16, v32
    v_and_b32 v29, 0xffff0000, v32
    v_pk_mul_f32 v[14:15], v[14:15], v[14:15]
    v_pk_mul_f32 v[16:17], v[16:17], v[16:17]
    v_pk_mul_f32 v[18:19], v[18:19], v[18:19]
    v_pk_mul_f32 v[20:21], v[20:21], v[20:21]
    v_pk_mul_f32 v[22:23], v[22:23], v[22:23]
    v_pk_mul_f32 v[24:25], v[24:25], v[24:25]
    v_pk_mul_f32 v[26:27], v[26:27], v[26:27]
    v_pk_mul_f32 v[28:29], v[28:29], v[28:29]
    v_cvt_pk_bf16_f32 v32, v14, v15
    v_lshlrev_b32 v14, 16, v32
    v_and_b32 v15, 0xffff0000, v32
    v_cvt_pk_bf16_f32 v32, v16, v17
    v_lshlrev_b32 v16, 16, v32
    v_and_b32 v17, 0xffff0000, v32
    v_cvt_pk_bf16_f32 v32, v18, v19
    v_lshlrev_b32 v18, 16, v32
    v_and_b32 v19, 0xffff0000, v32
    v_cvt_pk_bf16_f32 v32, v20, v21
    v_lshlrev_b32 v20, 16, v32
    v_and_b32 v21, 0xffff0000, v32
    v_cvt_pk_bf16_f32 v32, v22, v23
    v_lshlrev_b32 v22, 16, v32
    v_and_b32 v23, 0xffff0000, v32
    v_cvt_pk_bf16_f32 v32, v24, v25
    v_lshlrev_b32 v24, 16, v32
    v_and_b32 v25, 0xffff0000, v32
    v_cvt_pk_bf16_f32 v32, v26, v27
    v_lshlrev_b32 v26, 16, v32
    v_and_b32 v27, 0xffff0000, v32
    v_cvt_pk_bf16_f32 v32, v28, v29
    v_lshlrev_b32 v28, 16, v32
    v_and_b32 v29, 0xffff0000, v32
    v_mov_b32 v30, 1092616192
    v_mov_b32 v31, 0x3fb8aa3b
    v_pk_mul_f32 v[14:15], v[14:15], v[30:31] op_sel:[0,0] op_sel_hi:[1,0]
    v_pk_mul_f32 v[16:17], v[16:17], v[30:31] op_sel:[0,0] op_sel_hi:[1,0]
    v_pk_mul_f32 v[18:19], v[18:19], v[30:31] op_sel:[0,0] op_sel_hi:[1,0]
    v_pk_mul_f32 v[20:21], v[20:21], v[30:31] op_sel:[0,0] op_sel_hi:[1,0]
    v_pk_mul_f32 v[22:23], v[22:23], v[30:31] op_sel:[0,0] op_sel_hi:[1,0]
    v_pk_mul_f32 v[24:25], v[24:25], v[30:31] op_sel:[0,0] op_sel_hi:[1,0]
    v_pk_mul_f32 v[26:27], v[26:27], v[30:31] op_sel:[0,0] op_sel_hi:[1,0]
    v_pk_mul_f32 v[28:29], v[28:29], v[30:31] op_sel:[0,0] op_sel_hi:[1,0]
    v_cvt_pk_bf16_f32 v32, v14, v15
    v_lshlrev_b32 v14, 16, v32
    v_and_b32 v15, 0xffff0000, v32
    v_cvt_pk_bf16_f32 v32, v16, v17
    v_lshlrev_b32 v16, 16, v32
    v_and_b32 v17, 0xffff0000, v32
    v_cvt_pk_bf16_f32 v32, v18, v19
    v_lshlrev_b32 v18, 16, v32
    v_and_b32 v19, 0xffff0000, v32
    v_cvt_pk_bf16_f32 v32, v20, v21
    v_lshlrev_b32 v20, 16, v32
    v_and_b32 v21, 0xffff0000, v32
    v_cvt_pk_bf16_f32 v32, v22, v23
    v_lshlrev_b32 v22, 16, v32
    v_and_b32 v23, 0xffff0000, v32
    v_cvt_pk_bf16_f32 v32, v24, v25
    v_lshlrev_b32 v24, 16, v32
    v_and_b32 v25, 0xffff0000, v32
    v_cvt_pk_bf16_f32 v32, v26, v27
    v_lshlrev_b32 v26, 16, v32
    v_and_b32 v27, 0xffff0000, v32
    v_cvt_pk_bf16_f32 v32, v28, v29
    v_lshlrev_b32 v28, 16, v32
    v_and_b32 v29, 0xffff0000, v32
    v_pk_mul_f32 v[14:15], v[14:15], v[30:31] op_sel:[0,1] op_sel_hi:[1,1]
    v_pk_mul_f32 v[16:17], v[16:17], v[30:31] op_sel:[0,1] op_sel_hi:[1,1]
    v_pk_mul_f32 v[18:19], v[18:19], v[30:31] op_sel:[0,1] op_sel_hi:[1,1]
    v_pk_mul_f32 v[20:21], v[20:21], v[30:31] op_sel:[0,1] op_sel_hi:[1,1]
    v_pk_mul_f32 v[22:23], v[22:23], v[30:31] op_sel:[0,1] op_sel_hi:[1,1]
    v_pk_mul_f32 v[24:25], v[24:25], v[30:31] op_sel:[0,1] op_sel_hi:[1,1]
    v_pk_mul_f32 v[26:27], v[26:27], v[30:31] op_sel:[0,1] op_sel_hi:[1,1]
    v_pk_mul_f32 v[28:29], v[28:29], v[30:31] op_sel:[0,1] op_sel_hi:[1,1]
    v_exp_f32 v14, -v14
    v_exp_f32 v15, -v15
    v_exp_f32 v16, -v16
    v_exp_f32 v17, -v17
    v_exp_f32 v18, -v18
    v_exp_f32 v19, -v19
    v_exp_f32 v20, -v20
    v_exp_f32 v21, -v21
    v_exp_f32 v22, -v22
    v_exp_f32 v23, -v23
    v_exp_f32 v24, -v24
    v_exp_f32 v25, -v25
    v_exp_f32 v26, -v26
    v_exp_f32 v27, -v27
    v_exp_f32 v28, -v28
    v_exp_f32 v29, -v29
    v_cvt_pk_bf16_f32 v14, v14, v16
    v_cvt_pk_bf16_f32 v15, v15, v17
    v_cvt_pk_bf16_f32 v18, v18, v20
    v_cvt_pk_bf16_f32 v19, v19, v21
    v_cvt_pk_bf16_f32 v22, v22, v24
    v_cvt_pk_bf16_f32 v23, v23, v25
    v_cvt_pk_bf16_f32 v26, v26, v28
    v_cvt_pk_bf16_f32 v27, v27, v29
    v_dot2_f32_bf16 v72, v14, s68, 0
    v_dot2_f32_bf16 v73, v15, s68, 0
    v_dot2_f32_bf16 v74, v14, s69, 0
    v_dot2_f32_bf16 v75, v15, s69, 0
    v_dot2_f32_bf16 v76, v14, s70, 0
    v_dot2_f32_bf16 v77, v15, s70, 0
    v_dot2_f32_bf16 v78, v14, s71, 0
    v_dot2_f32_bf16 v79, v15, s71, 0
    v_dot2_f32_bf16 v80, v14, s52, 0
    v_dot2_f32_bf16 v81, v15, s52, 0
    v_dot2_f32_bf16 v82, v14, s53, 0
    v_dot2_f32_bf16 v83, v15, s53, 0
    v_dot2_f32_bf16 v84, v14, s54, 0
    v_dot2_f32_bf16 v85, v15, s54, 0
    v_dot2_f32_bf16 v86, v14, s55, 0
    v_dot2_f32_bf16 v87, v15, s55, 0
    v_dot2_f32_bf16 v72, v18, s72, v72
    v_dot2_f32_bf16 v73, v19, s72, v73
    v_dot2_f32_bf16 v74, v18, s73, v74
    v_dot2_f32_bf16 v75, v19, s73, v75
    v_dot2_f32_bf16 v76, v18, s74, v76
    v_dot2_f32_bf16 v77, v19, s74, v77
    v_dot2_f32_bf16 v78, v18, s75, v78
    v_dot2_f32_bf16 v79, v19, s75, v79
    v_dot2_f32_bf16 v80, v18, s56, v80
    v_dot2_f32_bf16 v81, v19, s56, v81
    v_dot2_f32_bf16 v82, v18, s57, v82
    v_dot2_f32_bf16 v83, v19, s57, v83
    v_dot2_f32_bf16 v84, v18, s58, v84
    v_dot2_f32_bf16 v85, v19, s58, v85
    v_dot2_f32_bf16 v86, v18, s59, v86
    v_dot2_f32_bf16 v87, v19, s59, v87
    v_dot2_f32_bf16 v72, v22, s76, v72
    v_dot2_f32_bf16 v73, v23, s76, v73
    v_dot2_f32_bf16 v74, v22, s77, v74
    v_dot2_f32_bf16 v75, v23, s77, v75
    v_dot2_f32_bf16 v76, v22, s78, v76
    v_dot2_f32_bf16 v77, v23, s78, v77
    v_dot2_f32_bf16 v78, v22, s79, v78
    v_dot2_f32_bf16 v79, v23, s79, v79
    v_dot2_f32_bf16 v80, v22, s60, v80
    v_dot2_f32_bf16 v81, v23, s60, v81
    v_dot2_f32_bf16 v82, v22, s61, v82
    v_dot2_f32_bf16 v83, v23, s61, v83
    v_dot2_f32_bf16 v84, v22, s62, v84
    v_dot2_f32_bf16 v85, v23, s62, v85
    v_dot2_f32_bf16 v86, v22, s63, v86
    v_dot2_f32_bf16 v87, v23, s63, v87
    v_dot2_f32_bf16 v72, v26, s80, v72
    v_dot2_f32_bf16 v73, v27, s80, v73
    v_dot2_f32_bf16 v74, v26, s81, v74
    v_dot2_f32_bf16 v75, v27, s81, v75
    v_dot2_f32_bf16 v76, v26, s82, v76
    v_dot2_f32_bf16 v77, v27, s82, v77
    v_dot2_f32_bf16 v78, v26, s83, v78
    v_dot2_f32_bf16 v79, v27, s83, v79
    v_dot2_f32_bf16 v80, v26, s64, v80
    v_dot2_f32_bf16 v81, v27, s64, v81
    v_dot2_f32_bf16 v82, v26, s65, v82
    v_dot2_f32_bf16 v83, v27, s65, v83
    v_dot2_f32_bf16 v84, v26, s66, v84
    v_dot2_f32_bf16 v85, v27, s66, v85
    v_dot2_f32_bf16 v86, v26, s67, v86
    v_dot2_f32_bf16 v87, v27, s67, v87
    s_cmp_ge_u32 s13, 4
    s_cbranch_scc1 L_p2_kernel_g1_27
    v_lshlrev_b32 v30, 16, v61
    v_and_b32 v31, 0xffff0000, v61
    v_pk_add_f32 v[14:15], v[30:31], v[36:37] op_sel:[0,0] op_sel_hi:[1,0] neg_lo:[0,1] neg_hi:[0,1]
    v_pk_add_f32 v[16:17], v[30:31], v[36:37] op_sel:[0,1] op_sel_hi:[1,1] neg_lo:[0,1] neg_hi:[0,1]
    v_pk_add_f32 v[18:19], v[30:31], v[38:39] op_sel:[0,0] op_sel_hi:[1,0] neg_lo:[0,1] neg_hi:[0,1]
    v_pk_add_f32 v[20:21], v[30:31], v[38:39] op_sel:[0,1] op_sel_hi:[1,1] neg_lo:[0,1] neg_hi:[0,1]
    v_pk_add_f32 v[22:23], v[30:31], v[40:41] op_sel:[0,0] op_sel_hi:[1,0] neg_lo:[0,1] neg_hi:[0,1]
    v_pk_add_f32 v[24:25], v[30:31], v[40:41] op_sel:[0,1] op_sel_hi:[1,1] neg_lo:[0,1] neg_hi:[0,1]
    v_pk_add_f32 v[26:27], v[30:31], v[42:43] op_sel:[0,0] op_sel_hi:[1,0] neg_lo:[0,1] neg_hi:[0,1]
    v_pk_add_f32 v[28:29], v[30:31], v[42:43] op_sel:[0,1] op_sel_hi:[1,1] neg_lo:[0,1] neg_hi:[0,1]
    v_cvt_pk_bf16_f32 v32, v14, v15
    v_lshlrev_b32 v14, 16, v32
    v_and_b32 v15, 0xffff0000, v32
    v_cvt_pk_bf16_f32 v32, v16, v17
    v_lshlrev_b32 v16, 16, v32
    v_and_b32 v17, 0xffff0000, v32
    v_cvt_pk_bf16_f32 v32, v18, v19
    v_lshlrev_b32 v18, 16, v32
    v_and_b32 v19, 0xffff0000, v32
    v_cvt_pk_bf16_f32 v32, v20, v21
    v_lshlrev_b32 v20, 16, v32
    v_and_b32 v21, 0xffff0000, v32
    v_cvt_pk_bf16_f32 v32, v22, v23
    v_lshlrev_b32 v22, 16, v32
    v_and_b32 v23, 0xffff0000, v32
    v_cvt_pk_bf16_f32 v32, v24, v25
    v_lshlrev_b32 v24, 16, v32
    v_and_b32 v25, 0xffff0000, v32
    v_cvt_pk_bf16_f32 v32, v26, v27
    v_lshlrev_b32 v26, 16, v32
    v_and_b32 v27, 0xffff0000, v32
    v_cvt_pk_bf16_f32 v32, v28, v29
    v_lshlrev_b32 v28, 16, v32
    v_and_b32 v29, 0xffff0000, v32
    v_pk_mul_f32 v[14:15], v[14:15], v[14:15]
    v_pk_mul_f32 v[16:17], v[16:17], v[16:17]
    v_pk_mul_f32 v[18:19], v[18:19], v[18:19]
    v_pk_mul_f32 v[20:21], v[20:21], v[20:21]
    v_pk_mul_f32 v[22:23], v[22:23], v[22:23]
    v_pk_mul_f32 v[24:25], v[24:25], v[24:25]
    v_pk_mul_f32 v[26:27], v[26:27], v[26:27]
    v_pk_mul_f32 v[28:29], v[28:29], v[28:29]
    v_cvt_pk_bf16_f32 v32, v14, v15
    v_lshlrev_b32 v14, 16, v32
    v_and_b32 v15, 0xffff0000, v32
    v_cvt_pk_bf16_f32 v32, v16, v17
    v_lshlrev_b32 v16, 16, v32
    v_and_b32 v17, 0xffff0000, v32
    v_cvt_pk_bf16_f32 v32, v18, v19
    v_lshlrev_b32 v18, 16, v32
    v_and_b32 v19, 0xffff0000, v32
    v_cvt_pk_bf16_f32 v32, v20, v21
    v_lshlrev_b32 v20, 16, v32
    v_and_b32 v21, 0xffff0000, v32
    v_cvt_pk_bf16_f32 v32, v22, v23
    v_lshlrev_b32 v22, 16, v32
    v_and_b32 v23, 0xffff0000, v32
    v_cvt_pk_bf16_f32 v32, v24, v25
    v_lshlrev_b32 v24, 16, v32
    v_and_b32 v25, 0xffff0000, v32
    v_cvt_pk_bf16_f32 v32, v26, v27
    v_lshlrev_b32 v26, 16, v32
    v_and_b32 v27, 0xffff0000, v32
    v_cvt_pk_bf16_f32 v32, v28, v29
    v_lshlrev_b32 v28, 16, v32
    v_and_b32 v29, 0xffff0000, v32
    v_mov_b32 v30, 1092616192
    v_mov_b32 v31, 0x3fb8aa3b
    v_pk_mul_f32 v[14:15], v[14:15], v[30:31] op_sel:[0,0] op_sel_hi:[1,0]
    v_pk_mul_f32 v[16:17], v[16:17], v[30:31] op_sel:[0,0] op_sel_hi:[1,0]
    v_pk_mul_f32 v[18:19], v[18:19], v[30:31] op_sel:[0,0] op_sel_hi:[1,0]
    v_pk_mul_f32 v[20:21], v[20:21], v[30:31] op_sel:[0,0] op_sel_hi:[1,0]
    v_pk_mul_f32 v[22:23], v[22:23], v[30:31] op_sel:[0,0] op_sel_hi:[1,0]
    v_pk_mul_f32 v[24:25], v[24:25], v[30:31] op_sel:[0,0] op_sel_hi:[1,0]
    v_pk_mul_f32 v[26:27], v[26:27], v[30:31] op_sel:[0,0] op_sel_hi:[1,0]
    v_pk_mul_f32 v[28:29], v[28:29], v[30:31] op_sel:[0,0] op_sel_hi:[1,0]
    v_cvt_pk_bf16_f32 v32, v14, v15
    v_lshlrev_b32 v14, 16, v32
    v_and_b32 v15, 0xffff0000, v32
    v_cvt_pk_bf16_f32 v32, v16, v17
    v_lshlrev_b32 v16, 16, v32
    v_and_b32 v17, 0xffff0000, v32
    v_cvt_pk_bf16_f32 v32, v18, v19
    v_lshlrev_b32 v18, 16, v32
    v_and_b32 v19, 0xffff0000, v32
    v_cvt_pk_bf16_f32 v32, v20, v21
    v_lshlrev_b32 v20, 16, v32
    v_and_b32 v21, 0xffff0000, v32
    v_cvt_pk_bf16_f32 v32, v22, v23
    v_lshlrev_b32 v22, 16, v32
    v_and_b32 v23, 0xffff0000, v32
    v_cvt_pk_bf16_f32 v32, v24, v25
    v_lshlrev_b32 v24, 16, v32
    v_and_b32 v25, 0xffff0000, v32
    v_cvt_pk_bf16_f32 v32, v26, v27
    v_lshlrev_b32 v26, 16, v32
    v_and_b32 v27, 0xffff0000, v32
    v_cvt_pk_bf16_f32 v32, v28, v29
    v_lshlrev_b32 v28, 16, v32
    v_and_b32 v29, 0xffff0000, v32
    v_pk_mul_f32 v[14:15], v[14:15], v[30:31] op_sel:[0,1] op_sel_hi:[1,1]
    v_pk_mul_f32 v[16:17], v[16:17], v[30:31] op_sel:[0,1] op_sel_hi:[1,1]
    v_pk_mul_f32 v[18:19], v[18:19], v[30:31] op_sel:[0,1] op_sel_hi:[1,1]
    v_pk_mul_f32 v[20:21], v[20:21], v[30:31] op_sel:[0,1] op_sel_hi:[1,1]
    v_pk_mul_f32 v[22:23], v[22:23], v[30:31] op_sel:[0,1] op_sel_hi:[1,1]
    v_pk_mul_f32 v[24:25], v[24:25], v[30:31] op_sel:[0,1] op_sel_hi:[1,1]
    v_pk_mul_f32 v[26:27], v[26:27], v[30:31] op_sel:[0,1] op_sel_hi:[1,1]
    v_pk_mul_f32 v[28:29], v[28:29], v[30:31] op_sel:[0,1] op_sel_hi:[1,1]
    v_exp_f32 v14, -v14
    v_exp_f32 v15, -v15
    v_exp_f32 v16, -v16
    v_exp_f32 v17, -v17
    v_exp_f32 v18, -v18
    v_exp_f32 v19, -v19
    v_exp_f32 v20, -v20
    v_exp_f32 v21, -v21
    v_exp_f32 v22, -v22
    v_exp_f32 v23, -v23
    v_exp_f32 v24, -v24
    v_exp_f32 v25, -v25
    v_exp_f32 v26, -v26
    v_exp_f32 v27, -v27
    v_exp_f32 v28, -v28
    v_exp_f32 v29, -v29
    v_cvt_pk_bf16_f32 v14, v14, v16
    v_cvt_pk_bf16_f32 v15, v15, v17
    v_cvt_pk_bf16_f32 v18, v18, v20
    v_cvt_pk_bf16_f32 v19, v19, v21
    v_cvt_pk_bf16_f32 v22, v22, v24
    v_cvt_pk_bf16_f32 v23, v23, v25
    v_cvt_pk_bf16_f32 v26, v26, v28
    v_cvt_pk_bf16_f32 v27, v27, v29
    v_dot2_f32_bf16 v112, v14, s68, 0
    v_dot2_f32_bf16 v113, v15, s68, 0
    v_dot2_f32_bf16 v114, v14, s69, 0
    v_dot2_f32_bf16 v115, v15, s69, 0
    v_dot2_f32_bf16 v116, v14, s70, 0
    v_dot2_f32_bf16 v117, v15, s70, 0
    v_dot2_f32_bf16 v118, v14, s71, 0
    v_dot2_f32_bf16 v119, v15, s71, 0
    v_dot2_f32_bf16 v120, v14, s52, 0
    v_dot2_f32_bf16 v121, v15, s52, 0
    v_dot2_f32_bf16 v122, v14, s53, 0
    v_dot2_f32_bf16 v123, v15, s53, 0
    v_dot2_f32_bf16 v124, v14, s54, 0
    v_dot2_f32_bf16 v125, v15, s54, 0
    v_dot2_f32_bf16 v126, v14, s55, 0
    v_dot2_f32_bf16 v127, v15, s55, 0
    v_dot2_f32_bf16 v112, v18, s72, v112
    v_dot2_f32_bf16 v113, v19, s72, v113
    v_dot2_f32_bf16 v114, v18, s73, v114
    v_dot2_f32_bf16 v115, v19, s73, v115
    v_dot2_f32_bf16 v116, v18, s74, v116
    v_dot2_f32_bf16 v117, v19, s74, v117
    v_dot2_f32_bf16 v118, v18, s75, v118
    v_dot2_f32_bf16 v119, v19, s75, v119
    v_dot2_f32_bf16 v120, v18, s56, v120
    v_dot2_f32_bf16 v121, v19, s56, v121
    v_dot2_f32_bf16 v122, v18, s57, v122
    v_dot2_f32_bf16 v123, v19, s57, v123
    v_dot2_f32_bf16 v124, v18, s58, v124
    v_dot2_f32_bf16 v125, v19, s58, v125
    v_dot2_f32_bf16 v126, v18, s59, v126
    v_dot2_f32_bf16 v127, v19, s59, v127
    v_dot2_f32_bf16 v112, v22, s76, v112
    v_dot2_f32_bf16 v113, v23, s76, v113
    v_dot2_f32_bf16 v114, v22, s77, v114
    v_dot2_f32_bf16 v115, v23, s77, v115
    v_dot2_f32_bf16 v116, v22, s78, v116
    v_dot2_f32_bf16 v117, v23, s78, v117
    v_dot2_f32_bf16 v118, v22, s79, v118
    v_dot2_f32_bf16 v119, v23, s79, v119
    v_dot2_f32_bf16 v120, v22, s60, v120
    v_dot2_f32_bf16 v121, v23, s60, v121
    v_dot2_f32_bf16 v122, v22, s61, v122
    v_dot2_f32_bf16 v123, v23, s61, v123
    v_dot2_f32_bf16 v124, v22, s62, v124
    v_dot2_f32_bf16 v125, v23, s62, v125
    v_dot2_f32_bf16 v126, v22, s63, v126
    v_dot2_f32_bf16 v127, v23, s63, v127
    v_dot2_f32_bf16 v112, v26, s80, v112
    v_dot2_f32_bf16 v113, v27, s80, v113
    v_dot2_f32_bf16 v114, v26, s81, v114
    v_dot2_f32_bf16 v115, v27, s81, v115
    v_dot2_f32_bf16 v116, v26, s82, v116
    v_dot2_f32_bf16 v117, v27, s82, v117
    v_dot2_f32_bf16 v118, v26, s83, v118
    v_dot2_f32_bf16 v119, v27, s83, v119
    v_dot2_f32_bf16 v120, v26, s64, v120
    v_dot2_f32_bf16 v121, v27, s64, v121
    v_dot2_f32_bf16 v122, v26, s65, v122
    v_dot2_f32_bf16 v123, v27, s65, v123
    v_dot2_f32_bf16 v124, v26, s66, v124
    v_dot2_f32_bf16 v125, v27, s66, v125
    v_dot2_f32_bf16 v126, v26, s67, v126
    v_dot2_f32_bf16 v127, v27, s67, v127
L_p2_kernel_g1_27:
    s_lshl2_add_u32 s14, s3, s49
    s_mul_i32 s26, s14, 20000
    s_mov_b32 s10, 5120000
    buffer_load_dwordx4 v[64:67], v1, s[8:11], s26 offen
    buffer_load_dwordx4 v[68:71], v2, s[8:11], s26 offen
    s_branch L_p2_fin
L_p2_done:
    s_branch L_p2_end
L_p2_slow:
    s_barrier
    v_mov_b32 v8, 0
    v_mov_b32 v9, 0
    v_mov_b32 v10, 0
    v_mov_b32 v11, 0
    v_mov_b32 v12, v1
    ds_write_b128 v12, v[8:11]
    v_add_u32 v12, 16384, v12
    ds_write_b128 v12, v[8:11]
    v_add_u32 v12, 16384, v12
    ds_write_b128 v12, v[8:11]
    v_add_u32 v12, 16384, v12
    ds_write_b128 v12, v[8:11]
    v_add_u32 v12, 16384, v12
    ds_write_b128 v12, v[8:11]
    v_add_u32 v12, 16384, v12
    ds_write_b128 v12, v[8:11]
    v_add_u32 v12, 16384, v12
    ds_write_b128 v12, v[8:11]
    v_add_u32 v12, 16384, v12
    ds_write_b128 v12, v[8:11]
    v_add_u32 v12, 16384, v12
    ds_write_b128 v12, v[8:11]
    v_add_u32 v12, 16384, v12
    ds_write_b128 v12, v[8:11]
    v_add_u32 v12, 16384, v12
    v_mul_u32_u24 v13, 8320, v0
    v_mov_b32 v29, 0x7fc00000
    v_add_u32 v28, 32, v13
    v_lshlrev_b32 v14, 10, v0
    v_add_u32 v14, 9437184, v14
    s_mul_i32 s25, s12, 65
    s_add_u32 s25, s25, s3
    s_lshl_b32 s25, s25, 5
    s_add_u32 s25, s25, 0
    s_lshl_b32 s50, s50, 1
    s_mul_i32 s22, s12, 1280000
    s_mov_b32 s24, 0
    s_waitcnt lgkmcnt(0)
    s_barrier
L_p2_sstep:
    buffer_load_ushort v15, v13, s[4:7], s25 offen
    buffer_load_ushort v16, v28, s[4:7], s25 offen
    s_waitcnt vmcnt(0)
L_p2_srec:
    v_cmp_lt_u32 vcc, v15, v16
    s_nop 1
    s_and_b64 exec, exec, vcc
    s_cbranch_execz L_p2_sdone
    v_mul_u32_u24 v17, 43691, v15
    v_lshrrev_b32 v17, 17, v17
    v_mad_i32_i24 v18, v17, -3, v15
    v_lshrrev_b32 v19, 6, v17
    v_lshl_add_u32 v19, v19, 20, v14
    v_and_b32 v17, 63, v17
    v_lshl_add_u32 v17, v17, 4, v19
    v_lshl_add_u32 v19, v18, 2, v17
    buffer_load_dword v20, v19, s[4:7], 0 offen
    buffer_load_dword v21, v17, s[4:7], 0 offen offset:12
    v_add_u32 v15, 1, v15
    v_mad_u32_u24 v18, v18, 10, 2
    s_waitcnt vmcnt(0)
    v_lshlrev_b32_sdwa v19, 3, v20 dst_sel:DWORD dst_unused:UNUSED_PAD src0_sel:DWORD src1_sel:WORD_0
    buffer_load_dwordx2 v[22:23], v19, s[8:11], s22 offen
    v_mad_u32_u16 v20, v20, 16, s50 op_sel:[1,0,0,0]
    v_bfe_i32 v21, v21, v18, 10
    v_cmp_eq_i32 vcc, -512, v21
    v_cvt_f32_i32 v21, v21
    v_mul_f32 v21, 989872160, v21
    v_cndmask_b32 v21, v21, v29, vcc
    s_waitcnt vmcnt(0)
    v_lshlrev_b32 v24, 16, v22
    v_and_b32 v25, 0xffff0000, v22
    v_lshlrev_b32 v26, 16, v23
    v_and_b32 v27, 0xffff0000, v23
    v_mul_f32 v24, v21, v24
    v_mul_f32 v25, v21, v25
    v_mul_f32 v26, v21, v26
    v_mul_f32 v27, v21, v27
    ds_add_f32 v20, v24
    ds_add_f32 v20, v25 offset:4
    ds_add_f32 v20, v26 offset:8
    ds_add_f32 v20, v27 offset:12
    s_branch L_p2_srec
L_p2_sdone:
    s_mov_b64 exec, -1
    s_add_u32 s25, s25, 2
    s_add_u32 s22, s22, 80000
    s_add_u32 s24, s24, 1
    s_cmp_lt_u32 s24, 16
    s_cbranch_scc1 L_p2_sstep
    s_waitcnt lgkmcnt(0)
    s_barrier
    s_mul_i32 s14, s12, 10240000
    s_mul_i32 s15, s3, 160000
    s_add_u32 s26, s14, s15
    s_add_u32 s26, s26, 249069568
    v_mov_b32 v12, v1
    s_mov_b32 s24, 0
L_p2_sout:
    v_cmp_gt_u32 vcc, 160000, v12
    ds_read_b128 v[8:11], v12
    s_nop 0
    s_and_b64 exec, exec, vcc
    s_cbranch_execz L_p2_sfin
    s_waitcnt lgkmcnt(0)
    buffer_store_dwordx4 v[8:11], v12, s[4:7], s26 offen sc1
    s_waitcnt vmcnt(0)
    v_add_u32 v12, 16384, v12
    s_branch L_p2_sout
L_p2_sfin:
    s_mov_b64 exec, -1
    s_waitcnt vmcnt(0) lgkmcnt(0)
    s_barrier
    s_branch L_p2_signal
L_p2_end:
    s_endpgm
.section .rodata,"a"
.p2align 6
.amdhsa_kernel p1_kernel
  .amdhsa_next_free_vgpr 128
  .amdhsa_next_free_sgpr 96
  .amdhsa_accum_offset 128
  .amdhsa_group_segment_fixed_size 0
  .amdhsa_kernarg_size 112
  .amdhsa_user_sgpr_count 2
  .amdhsa_user_sgpr_kernarg_segment_ptr 1
  .amdhsa_system_sgpr_workgroup_id_x 1
  .amdhsa_float_denorm_mode_32 0
.end_amdhsa_kernel
.p2align 6
.amdhsa_kernel p2_kernel
  .amdhsa_next_free_vgpr 128
  .amdhsa_next_free_sgpr 102
  .amdhsa_accum_offset 128
  .amdhsa_group_segment_fixed_size 0
  .amdhsa_kernarg_size 112
  .amdhsa_user_sgpr_count 2
  .amdhsa_user_sgpr_kernarg_segment_ptr 1
  .amdhsa_system_sgpr_workgroup_id_x 1
  .amdhsa_float_denorm_mode_32 0
.end_amdhsa_kernel
```

```asm
; @launch kernel=p1_kernel grid=(256,1,1) block=(1024,1,1) lds=163840
; @launch kernel=p2_kernel grid=(256,1,1) block=(1024,1,1) lds=163840
.amdgcn_target "amdgcn-amd-amdhsa--gfx950"
.text
.globl p1_kernel
.p2align 8
.type p1_kernel,@function
p1_kernel:
    s_cmp_ge_u32 s2, 256
    s_cbranch_scc1 L_p1_end
    s_load_dwordx2 s[4:5], s[0:1], 104
    s_load_dwordx2 s[8:9], s[0:1], 8
    s_load_dwordx2 s[12:13], s[0:1], 16
    s_load_dwordx2 s[16:17], s[0:1], 32
    s_load_dwordx2 s[28:29], s[0:1], 0
    s_load_dwordx2 s[6:7], s[0:1], 48
    v_cmp_gt_u32 vcc, 256, v0
    s_nop 1
    s_cbranch_vccz L_p1_nopf
    s_getpc_b64 s[72:73]
L_p1_kernel_pc_1:
    s_add_u32 s72, s72, L_p1_nopf-L_p1_kernel_pc_1
    s_addc_u32 s73, s73, 0
    v_lshlrev_b32 v14, 7, v0
    v_min_u32 v14, L_p2_end-L_p1_nopf, v14
    global_load_dword v15, v14, s[72:73]
L_p1_nopf:
    v_lshlrev_b32 v1, 4, v0
    v_lshlrev_b32 v2, 3, v0
    v_lshrrev_b32 v6, 6, v0
    v_mul_u32_u24 v3, 851904, v6
    v_add_lshl_u32 v3, v3, v0, 4
    v_mov_b32 v4, 1
    v_mov_b32 v5, 0
    v_readfirstlane_b32 s39, v6
    v_cmp_gt_u32 vcc, 784, v0
    s_and_b32 s51, s2, 7
    s_lshl_b32 s51, s51, 0
    s_bfe_u32 s35, s2, 3
    s_add_u32 s51, s51, s35
    s_and_b32 s35, s2, 248
    s_add_u32 s51, s51, s35
    s_and_b32 s32, s2, 7
    s_lshl_b32 s32, s32, 2
    s_bfe_u32 s35, s2, 131075
    s_add_u32 s32, s32, s35
    s_and_b32 s35, s2, 224
    s_add_u32 s32, s32, s35
    s_lshr_b32 s35, s39, 4
    s_mul_i32 s36, s35, 4177920
    s_lshl_b32 s33, s51, 14
    s_add_u32 s33, s33, s36
    s_lshr_b32 s34, s33, 1
    s_mul_i32 s48, s51, 3840
    s_cmp_ge_u32 s35, 0
    s_cselect_b32 s48, s48, 0
    s_lshr_b32 s49, s48, 1
    s_mov_b64 s[44:45], vcc
    s_waitcnt lgkmcnt(0)
    s_load_dword s3, s[6:7], 0
    s_mov_b32 s10, 163840000
    s_mov_b32 s11, 0x00020000
    s_mov_b32 s14, 163840000
    s_mov_b32 s15, 0x00020000
    s_mov_b32 s18, 81920000
    s_mov_b32 s19, 0x00020000
    s_mul_i32 s36, s2, 20000
    s_add_u32 s30, s36, 20000
    s_mov_b32 s31, 0x00020000
    s_add_u32 s35, s36, 16384
    buffer_load_dwordx4 v[48:51], v1, s[28:31], s36 offen
    buffer_load_dwordx4 v[52:55], v1, s[28:31], s35 offen
    s_add_u32 s35, s33, 0
    buffer_load_dwordx4 v[16:19], v1, s[8:11], s35 offen nt
    s_add_u32 s35, s33, 0
    buffer_load_dwordx4 v[20:23], v1, s[12:15], s35 offen nt
    s_add_u32 s35, s33, 4194304
    buffer_load_dwordx4 v[24:27], v1, s[8:11], s35 offen nt
    s_add_u32 s35, s33, 4194304
    buffer_load_dwordx4 v[28:31], v1, s[12:15], s35 offen nt
    s_add_u32 s35, s33, 8388608
    buffer_load_dwordx4 v[32:35], v1, s[8:11], s35 offen nt
    s_add_u32 s35, s33, 8388608
    buffer_load_dwordx4 v[36:39], v1, s[12:15], s35 offen nt
    s_add_u32 s35, s33, 12582912
    buffer_load_dwordx4 v[40:43], v1, s[8:11], s35 offen nt
    s_add_u32 s35, s33, 12582912
    buffer_load_dwordx4 v[44:47], v1, s[12:15], s35 offen nt
    s_add_u32 s35, s33, 16777216
    buffer_load_dwordx4 v[72:75], v1, s[8:11], s35 offen nt
    s_add_u32 s35, s33, 16777216
    buffer_load_dwordx4 v[76:79], v1, s[12:15], s35 offen nt
    s_mov_b32 s20, s4
    s_mov_b32 s21, s5
    s_mov_b32 s22, 0
    s_mov_b32 s23, 0x00020000
    s_add_u32 s24, s4, 0
    s_addc_u32 s25, s5, 0
    s_mov_b32 s26, 8540160
    s_mov_b32 s27, 0x00020000
    s_mov_b32 s37, 1492179184
    s_mov_b32 s55, 0
    s_mov_b32 s50, 21845
    s_mov_b32 s52, 0x8000
    s_mov_b32 s38, 262400
    s_mov_b32 s43, 0x05040100
    s_mov_b32 s40, 0
    v_mov_b32 v8, 0
    v_mov_b32 v9, 0
    v_mov_b32 v10, 0
    v_mov_b32 v11, 0
    ds_write_b128 v1, v[8:11] offset:0
    s_waitcnt lgkmcnt(0)
    s_lshl_b32 s3, s3, 16
    v_mov_b32 v12, s3
    v_mul_f32 v12, 0.15915494, v12
    s_nop 0
    v_readfirstlane_b32 s41, v12
    s_waitcnt vmcnt(10)
    v_mov_b32 v12, 0x3f803f80
    v_and_b32 v48, 0x7fff7fff, v48
    v_and_b32 v49, 0x7fff7fff, v49
    v_and_b32 v50, 0x7fff7fff, v50
    v_and_b32 v51, 0x7fff7fff, v51
    v_and_b32 v52, 0x7fff7fff, v52
    v_and_b32 v53, 0x7fff7fff, v53
    v_and_b32 v54, 0x7fff7fff, v54
    v_and_b32 v55, 0x7fff7fff, v55
    v_pk_max_u16 v8, v8, v48
    v_dot2c_f32_bf16 v9, v48, v12
    v_pk_max_u16 v8, v8, v49
    v_dot2c_f32_bf16 v9, v49, v12
    v_pk_max_u16 v8, v8, v50
    v_dot2c_f32_bf16 v9, v50, v12
    v_pk_max_u16 v8, v8, v51
    v_dot2c_f32_bf16 v9, v51, v12
    v_pk_max_u16 v8, v8, v52
    v_dot2c_f32_bf16 v9, v52, v12
    v_pk_max_u16 v8, v8, v53
    v_dot2c_f32_bf16 v9, v53, v12
    v_pk_max_u16 v8, v8, v54
    v_dot2c_f32_bf16 v9, v54, v12
    v_pk_max_u16 v8, v8, v55
    v_dot2c_f32_bf16 v9, v55, v12
    v_lshrrev_b32 v10, 16, v8
    v_and_b32 v8, 0xffff, v8
    v_max_u32 v8, v8, v10
    s_nop 0
    s_nop 1
    v_max_u32_dpp v8, v8, v8 row_shr:1 row_mask:0xf bank_mask:0xf bound_ctrl:0
    s_nop 1
    v_max_u32_dpp v8, v8, v8 row_shr:2 row_mask:0xf bank_mask:0xf bound_ctrl:0
    s_nop 1
    v_max_u32_dpp v8, v8, v8 row_shr:4 row_mask:0xf bank_mask:0xf bound_ctrl:0
    s_nop 1
    v_max_u32_dpp v8, v8, v8 row_shr:8 row_mask:0xf bank_mask:0xf bound_ctrl:0
    s_nop 1
    v_max_u32_dpp v8, v8, v8 row_bcast:15 row_mask:0xa bank_mask:0xf
    s_nop 1
    v_max_u32_dpp v8, v8, v8 row_bcast:31 row_mask:0xc bank_mask:0xf
    s_nop 1
    v_add_f32_dpp v9, v9, v9 row_shr:1 row_mask:0xf bank_mask:0xf bound_ctrl:0
    s_nop 1
    v_add_f32_dpp v9, v9, v9 row_shr:2 row_mask:0xf bank_mask:0xf bound_ctrl:0
    s_nop 1
    v_add_f32_dpp v9, v9, v9 row_shr:4 row_mask:0xf bank_mask:0xf bound_ctrl:0
    s_nop 1
    v_add_f32_dpp v9, v9, v9 row_shr:8 row_mask:0xf bank_mask:0xf bound_ctrl:0
    s_nop 1
    v_add_f32_dpp v9, v9, v9 row_bcast:15 row_mask:0xa bank_mask:0xf
    s_nop 1
    v_add_f32_dpp v9, v9, v9 row_bcast:31 row_mask:0xc bank_mask:0xf
    s_lshl_b32 s35, s39, 4
    s_add_u32 s35, s35, 160320
    v_mov_b32 v10, s35
    s_mov_b32 exec_lo, 0
    s_brev_b32 exec_hi, 1
    ds_write_b64 v10, v[8:9]
    s_mov_b64 exec, -1
    s_waitcnt lgkmcnt(0)
    s_barrier
    s_branch L_p1_first
L_p1_loop:
    s_getreg_b32 s51, hwreg(HW_REG_XCC_ID, 0, 1)
    s_cmp_eq_u32 s51, 0
    s_cselect_b64 vcc, -1, 0
    s_waitcnt lgkmcnt(13)
    v_lshlrev_b32 v15, 22, v100
    v_lshrrev_b32 v100, 16, v100
    v_alignbit_b32 v15, v100, v15, 10
    v_alignbit_b32 v15, v101, v15, 10
    v_xor_b32 v15, 0x80200800, v15
    s_cmp_lg_u32 s39, 15
    s_cbranch_scc1 L_p1_kernel_nox_2
    s_mov_b32 s36, 13631488
    buffer_store_dwordx4 v[12:15], v3, s[20:23], s36 offen sc1
L_p1_kernel_nox_2:
    s_waitcnt lgkmcnt(12)
    v_lshlrev_b32 v75, 22, v102
    v_lshrrev_b32 v102, 16, v102
    v_alignbit_b32 v75, v102, v75, 10
    v_alignbit_b32 v75, v103, v75, 10
    v_xor_b32 v75, 0x80200800, v75
    s_mov_b32 s36, 0
    buffer_store_dwordx4 v[72:75], v3, s[20:23], s36 offen sc1
    s_waitcnt lgkmcnt(11)
    v_lshlrev_b32 v79, 22, v104
    v_lshrrev_b32 v104, 16, v104
    v_alignbit_b32 v79, v104, v79, 10
    v_alignbit_b32 v79, v105, v79, 10
    v_xor_b32 v79, 0x80200800, v79
    s_mov_b32 s36, 1048576
    buffer_store_dwordx4 v[76:79], v3, s[20:23], s36 offen sc1
    s_waitcnt lgkmcnt(10)
    v_lshlrev_b32 v51, 22, v106
    v_lshrrev_b32 v106, 16, v106
    v_alignbit_b32 v51, v106, v51, 10
    v_alignbit_b32 v51, v107, v51, 10
    v_xor_b32 v51, 0x80200800, v51
    s_mov_b32 s36, 2097152
    buffer_store_dwordx4 v[48:51], v3, s[20:23], s36 offen sc1
    s_add_u32 s35, s33, 16777216
    buffer_load_dwordx4 v[72:75], v1, s[8:11], s35 offen nt
    s_add_u32 s35, s33, 16777216
    buffer_load_dwordx4 v[76:79], v1, s[12:15], s35 offen nt
    s_cbranch_vccz L_p1_kernel_thr_3
    s_waitcnt vmcnt(2)
L_p1_kernel_thr_3:
    s_waitcnt lgkmcnt(9)
    v_lshlrev_b32 v83, 22, v108
    v_lshrrev_b32 v108, 16, v108
    v_alignbit_b32 v83, v108, v83, 10
    v_alignbit_b32 v83, v109, v83, 10
    v_xor_b32 v83, 0x80200800, v83
    s_mov_b32 s36, 3145728
    buffer_store_dwordx4 v[80:83], v3, s[20:23], s36 offen sc1
    s_waitcnt lgkmcnt(8)
    v_lshlrev_b32 v55, 22, v110
    v_lshrrev_b32 v110, 16, v110
    v_alignbit_b32 v55, v110, v55, 10
    v_alignbit_b32 v55, v111, v55, 10
    v_xor_b32 v55, 0x80200800, v55
    s_mov_b32 s36, 4194304
    buffer_store_dwordx4 v[52:55], v3, s[20:23], s36 offen sc1
    s_add_u32 s35, s33, 20971520
    buffer_load_dwordx4 v[80:83], v1, s[8:11], s35 offen nt
    s_add_u32 s35, s33, 20971520
    buffer_load_dwordx4 v[100:103], v1, s[12:15], s35 offen nt
    s_cbranch_vccz L_p1_kernel_thr_4
    s_waitcnt vmcnt(2)
L_p1_kernel_thr_4:
    s_waitcnt lgkmcnt(7)
    v_lshlrev_b32 v87, 22, v112
    v_lshrrev_b32 v112, 16, v112
    v_alignbit_b32 v87, v112, v87, 10
    v_alignbit_b32 v87, v113, v87, 10
    v_xor_b32 v87, 0x80200800, v87
    s_mov_b32 s36, 5242880
    buffer_store_dwordx4 v[84:87], v3, s[20:23], s36 offen sc1
    s_waitcnt lgkmcnt(6)
    v_lshlrev_b32 v59, 22, v114
    v_lshrrev_b32 v114, 16, v114
    v_alignbit_b32 v59, v114, v59, 10
    v_alignbit_b32 v59, v115, v59, 10
    v_xor_b32 v59, 0x80200800, v59
    s_mov_b32 s36, 6291456
    buffer_store_dwordx4 v[56:59], v3, s[20:23], s36 offen sc1
    s_add_u32 s35, s33, 25165824
    buffer_load_dwordx4 v[84:87], v1, s[8:11], s35 offen nt
    s_add_u32 s35, s33, 25165824
    buffer_load_dwordx4 v[104:107], v1, s[12:15], s35 offen nt
    s_cbranch_vccz L_p1_kernel_thr_5
    s_waitcnt vmcnt(2)
L_p1_kernel_thr_5:
    s_waitcnt lgkmcnt(5)
    v_lshlrev_b32 v91, 22, v116
    v_lshrrev_b32 v116, 16, v116
    v_alignbit_b32 v91, v116, v91, 10
    v_alignbit_b32 v91, v117, v91, 10
    v_xor_b32 v91, 0x80200800, v91
    s_mov_b32 s36, 7340032
    buffer_store_dwordx4 v[88:91], v3, s[20:23], s36 offen sc1
    s_waitcnt lgkmcnt(4)
    v_lshlrev_b32 v63, 22, v118
    v_lshrrev_b32 v118, 16, v118
    v_alignbit_b32 v63, v118, v63, 10
    v_alignbit_b32 v63, v119, v63, 10
    v_xor_b32 v63, 0x80200800, v63
    s_mov_b32 s36, 8388608
    buffer_store_dwordx4 v[60:63], v3, s[20:23], s36 offen sc1
    s_add_u32 s35, s33, 29360128
    buffer_load_dwordx4 v[88:91], v1, s[8:11], s35 offen nt
    s_add_u32 s35, s33, 29360128
    buffer_load_dwordx4 v[108:111], v1, s[12:15], s35 offen nt
    s_cbranch_vccz L_p1_kernel_thr_6
    s_waitcnt vmcnt(2)
L_p1_kernel_thr_6:
    s_waitcnt lgkmcnt(3)
    v_lshlrev_b32 v95, 22, v120
    v_lshrrev_b32 v120, 16, v120
    v_alignbit_b32 v95, v120, v95, 10
    v_alignbit_b32 v95, v121, v95, 10
    v_xor_b32 v95, 0x80200800, v95
    s_mov_b32 s36, 9437184
    buffer_store_dwordx4 v[92:95], v3, s[20:23], s36 offen sc1
    s_waitcnt lgkmcnt(2)
    v_lshlrev_b32 v67, 22, v122
    v_lshrrev_b32 v122, 16, v122
    v_alignbit_b32 v67, v122, v67, 10
    v_alignbit_b32 v67, v123, v67, 10
    v_xor_b32 v67, 0x80200800, v67
    s_mov_b32 s36, 10485760
    buffer_store_dwordx4 v[64:67], v3, s[20:23], s36 offen sc1
    s_add_u32 s35, s33, 33554432
    buffer_load_dwordx4 v[92:95], v1, s[8:11], s35 offen nt
    s_add_u32 s35, s33, 33554432
    buffer_load_dwordx4 v[112:115], v1, s[12:15], s35 offen nt
    s_cbranch_vccz L_p1_kernel_thr_7
    s_waitcnt vmcnt(2)
L_p1_kernel_thr_7:
    s_waitcnt lgkmcnt(1)
    v_lshlrev_b32 v99, 22, v124
    v_lshrrev_b32 v124, 16, v124
    v_alignbit_b32 v99, v124, v99, 10
    v_alignbit_b32 v99, v125, v99, 10
    v_xor_b32 v99, 0x80200800, v99
    s_mov_b32 s36, 11534336
    buffer_store_dwordx4 v[96:99], v3, s[20:23], s36 offen sc1
    s_waitcnt lgkmcnt(0)
    v_lshlrev_b32 v71, 22, v126
    v_lshrrev_b32 v126, 16, v126
    v_alignbit_b32 v71, v126, v71, 10
    v_alignbit_b32 v71, v127, v71, 10
    v_xor_b32 v71, 0x80200800, v71
    s_mov_b32 s36, 12582912
    buffer_store_dwordx4 v[68:71], v3, s[20:23], s36 offen sc1
    s_add_u32 s35, s33, 37748736
    s_sub_u32 s35, s35, s48
    v_cndmask_b32 v96, 2.0, v1, s[44:45]
    buffer_load_dwordx4 v[96:99], v96, s[8:11], s35 offen nt
    s_add_u32 s35, s33, 37748736
    s_sub_u32 s35, s35, s48
    v_cndmask_b32 v116, 2.0, v1, s[44:45]
    buffer_load_dwordx4 v[116:119], v116, s[12:15], s35 offen nt
    s_cbranch_vccz L_p1_kernel_thr_8
    s_waitcnt vmcnt(2)
L_p1_kernel_thr_8:
    s_branch L_p1_join
L_p1_first:
    s_add_u32 s35, s33, 20971520
    buffer_load_dwordx4 v[80:83], v1, s[8:11], s35 offen nt
    s_add_u32 s35, s33, 20971520
    buffer_load_dwordx4 v[100:103], v1, s[12:15], s35 offen nt
    s_add_u32 s35, s33, 25165824
    buffer_load_dwordx4 v[84:87], v1, s[8:11], s35 offen nt
    s_add_u32 s35, s33, 25165824
    buffer_load_dwordx4 v[104:107], v1, s[12:15], s35 offen nt
    s_add_u32 s35, s33, 29360128
    buffer_load_dwordx4 v[88:91], v1, s[8:11], s35 offen nt
    s_add_u32 s35, s33, 29360128
    buffer_load_dwordx4 v[108:111], v1, s[12:15], s35 offen nt
    s_add_u32 s35, s33, 33554432
    buffer_load_dwordx4 v[92:95], v1, s[8:11], s35 offen nt
    s_add_u32 s35, s33, 33554432
    buffer_load_dwordx4 v[112:115], v1, s[12:15], s35 offen nt
    s_add_u32 s35, s33, 37748736
    s_sub_u32 s35, s35, s48
    v_cndmask_b32 v96, 2.0, v1, s[44:45]
    buffer_load_dwordx4 v[96:99], v96, s[8:11], s35 offen nt
    s_add_u32 s35, s33, 37748736
    s_sub_u32 s35, s35, s48
    v_cndmask_b32 v116, 2.0, v1, s[44:45]
    buffer_load_dwordx4 v[116:119], v116, s[12:15], s35 offen nt
L_p1_join:
    s_waitcnt vmcnt(18)
    v_perm_b32 v6, v20, v16, s43
    v_perm_b32 v7, v21, v17, s43
    v_perm_b32 v8, v22, v18, s43
    v_perm_b32 v9, v23, v19, s43
    v_mul_hi_u32_u24 v16, 429497, v16
    v_mul_hi_u32_u24 v20, 429497, v20
    v_mul_hi_u32_u24 v17, 429497, v17
    v_mul_hi_u32_u24 v21, 429497, v21
    v_mul_hi_u32_u24 v18, 429497, v18
    v_mul_hi_u32_u24 v22, 429497, v22
    v_mul_hi_u32_u24 v19, 429497, v19
    v_mul_hi_u32_u24 v23, 429497, v23
    v_lshl_or_b32 v16, v20, 16, v16
    v_lshl_or_b32 v17, v21, 16, v17
    v_lshl_or_b32 v18, v22, 16, v18
    v_lshl_or_b32 v19, v23, 16, v19
    v_dot2_u32_u16 v20, v16, s38, 0
    v_dot2_u32_u16 v21, v17, s38, 0
    v_dot2_u32_u16 v22, v18, s38, 0
    v_dot2_u32_u16 v23, v19, s38, 0
    v_pk_mad_u16 v6, v16, s37, v6
    v_pk_mad_u16 v7, v17, s37, v7
    v_pk_mad_u16 v8, v18, s37, v8
    v_pk_mad_u16 v9, v19, s37, v9
    ds_add_u32 v20, v4 offset:0
    ds_add_u32 v21, v4 offset:0
    ds_add_u32 v22, v4 offset:0
    ds_add_u32 v23, v4 offset:0
    v_pk_mad_u16 v6, v16, s52, v6 op_sel:[1,0,0] op_sel_hi:[1,1,1]
    v_pk_mad_u16 v7, v17, s52, v7 op_sel:[1,0,0] op_sel_hi:[1,1,1]
    v_pk_mad_u16 v8, v18, s52, v8 op_sel:[1,0,0] op_sel_hi:[1,1,1]
    v_pk_mad_u16 v9, v19, s52, v9 op_sel:[1,0,0] op_sel_hi:[1,1,1]
    v_perm_b32 v55, v23, v22, s43
    v_perm_b32 v51, v21, v20, s43
    v_or_b32 v48, 0x40000000, v6
    v_or_b32 v49, 0x40000000, v7
    v_or_b32 v50, 0x40000000, v8
    v_or_b32 v52, 0x40000000, v9
    s_waitcnt vmcnt(16)
    v_perm_b32 v6, v28, v24, s43
    v_perm_b32 v7, v29, v25, s43
    v_perm_b32 v8, v30, v26, s43
    v_perm_b32 v9, v31, v27, s43
    v_mul_hi_u32_u24 v24, 429497, v24
    v_mul_hi_u32_u24 v28, 429497, v28
    v_mul_hi_u32_u24 v25, 429497, v25
    v_mul_hi_u32_u24 v29, 429497, v29
    v_mul_hi_u32_u24 v26, 429497, v26
    v_mul_hi_u32_u24 v30, 429497, v30
    v_mul_hi_u32_u24 v27, 429497, v27
    v_mul_hi_u32_u24 v31, 429497, v31
    v_lshl_or_b32 v24, v28, 16, v24
    v_lshl_or_b32 v25, v29, 16, v25
    v_lshl_or_b32 v26, v30, 16, v26
    v_lshl_or_b32 v27, v31, 16, v27
    v_dot2_u32_u16 v28, v24, s38, 0
    v_dot2_u32_u16 v29, v25, s38, 0
    v_dot2_u32_u16 v30, v26, s38, 0
    v_dot2_u32_u16 v31, v27, s38, 0
    v_pk_mad_u16 v6, v24, s37, v6
    v_pk_mad_u16 v7, v25, s37, v7
    v_pk_mad_u16 v8, v26, s37, v8
    v_pk_mad_u16 v9, v27, s37, v9
    ds_add_u32 v28, v4 offset:0
    ds_add_u32 v29, v4 offset:0
    ds_add_u32 v30, v4 offset:0
    ds_add_u32 v31, v4 offset:0
    v_pk_mad_u16 v6, v24, s52, v6 op_sel:[1,0,0] op_sel_hi:[1,1,1]
    v_pk_mad_u16 v7, v25, s52, v7 op_sel:[1,0,0] op_sel_hi:[1,1,1]
    v_pk_mad_u16 v8, v26, s52, v8 op_sel:[1,0,0] op_sel_hi:[1,1,1]
    v_pk_mad_u16 v9, v27, s52, v9 op_sel:[1,0,0] op_sel_hi:[1,1,1]
    v_perm_b32 v63, v31, v30, s43
    v_perm_b32 v59, v29, v28, s43
    v_or_b32 v53, 0x40000000, v6
    v_or_b32 v54, 0x40000000, v7
    v_or_b32 v56, 0x40000000, v8
    v_or_b32 v57, 0x40000000, v9
    s_waitcnt vmcnt(14)
    v_perm_b32 v6, v36, v32, s43
    v_perm_b32 v7, v37, v33, s43
    v_perm_b32 v8, v38, v34, s43
    v_perm_b32 v9, v39, v35, s43
    v_mul_hi_u32_u24 v32, 429497, v32
    v_mul_hi_u32_u24 v36, 429497, v36
    v_mul_hi_u32_u24 v33, 429497, v33
    v_mul_hi_u32_u24 v37, 429497, v37
    v_mul_hi_u32_u24 v34, 429497, v34
    v_mul_hi_u32_u24 v38, 429497, v38
    v_mul_hi_u32_u24 v35, 429497, v35
    v_mul_hi_u32_u24 v39, 429497, v39
    v_lshl_or_b32 v32, v36, 16, v32
    v_lshl_or_b32 v33, v37, 16, v33
    v_lshl_or_b32 v34, v38, 16, v34
    v_lshl_or_b32 v35, v39, 16, v35
    v_dot2_u32_u16 v36, v32, s38, 0
    v_dot2_u32_u16 v37, v33, s38, 0
    v_dot2_u32_u16 v38, v34, s38, 0
    v_dot2_u32_u16 v39, v35, s38, 0
    v_pk_mad_u16 v6, v32, s37, v6
    v_pk_mad_u16 v7, v33, s37, v7
    v_pk_mad_u16 v8, v34, s37, v8
    v_pk_mad_u16 v9, v35, s37, v9
    ds_add_u32 v36, v4 offset:0
    ds_add_u32 v37, v4 offset:0
    ds_add_u32 v38, v4 offset:0
    ds_add_u32 v39, v4 offset:0
    v_pk_mad_u16 v6, v32, s52, v6 op_sel:[1,0,0] op_sel_hi:[1,1,1]
    v_pk_mad_u16 v7, v33, s52, v7 op_sel:[1,0,0] op_sel_hi:[1,1,1]
    v_pk_mad_u16 v8, v34, s52, v8 op_sel:[1,0,0] op_sel_hi:[1,1,1]
    v_pk_mad_u16 v9, v35, s52, v9 op_sel:[1,0,0] op_sel_hi:[1,1,1]
    v_perm_b32 v71, v39, v38, s43
    v_perm_b32 v67, v37, v36, s43
    v_or_b32 v58, 0x40000000, v6
    v_or_b32 v60, 0x40000000, v7
    v_or_b32 v61, 0x40000000, v8
    v_or_b32 v62, 0x40000000, v9
    s_waitcnt vmcnt(12)
    v_perm_b32 v6, v44, v40, s43
    v_perm_b32 v7, v45, v41, s43
    v_perm_b32 v8, v46, v42, s43
    v_perm_b32 v9, v47, v43, s43
    v_mul_hi_u32_u24 v40, 429497, v40
    v_mul_hi_u32_u24 v44, 429497, v44
    v_mul_hi_u32_u24 v41, 429497, v41
    v_mul_hi_u32_u24 v45, 429497, v45
    v_mul_hi_u32_u24 v42, 429497, v42
    v_mul_hi_u32_u24 v46, 429497, v46
    v_mul_hi_u32_u24 v43, 429497, v43
    v_mul_hi_u32_u24 v47, 429497, v47
    v_lshl_or_b32 v40, v44, 16, v40
    v_lshl_or_b32 v41, v45, 16, v41
    v_lshl_or_b32 v42, v46, 16, v42
    v_lshl_or_b32 v43, v47, 16, v43
    v_dot2_u32_u16 v44, v40, s38, 0
    v_dot2_u32_u16 v45, v41, s38, 0
    v_dot2_u32_u16 v46, v42, s38, 0
    v_dot2_u32_u16 v47, v43, s38, 0
    v_pk_mad_u16 v6, v40, s37, v6
    v_pk_mad_u16 v7, v41, s37, v7
    v_pk_mad_u16 v8, v42, s37, v8
    v_pk_mad_u16 v9, v43, s37, v9
    ds_add_u32 v44, v4 offset:0
    ds_add_u32 v45, v4 offset:0
    ds_add_u32 v46, v4 offset:0
    ds_add_u32 v47, v4 offset:0
    v_pk_mad_u16 v6, v40, s52, v6 op_sel:[1,0,0] op_sel_hi:[1,1,1]
    v_pk_mad_u16 v7, v41, s52, v7 op_sel:[1,0,0] op_sel_hi:[1,1,1]
    v_pk_mad_u16 v8, v42, s52, v8 op_sel:[1,0,0] op_sel_hi:[1,1,1]
    v_pk_mad_u16 v9, v43, s52, v9 op_sel:[1,0,0] op_sel_hi:[1,1,1]
    v_perm_b32 v121, v47, v46, s43
    v_perm_b32 v120, v45, v44, s43
    v_or_b32 v64, 0x40000000, v6
    v_or_b32 v65, 0x40000000, v7
    v_or_b32 v66, 0x40000000, v8
    v_or_b32 v68, 0x40000000, v9
    s_waitcnt vmcnt(10)
    v_perm_b32 v6, v76, v72, s43
    v_perm_b32 v7, v77, v73, s43
    v_perm_b32 v8, v78, v74, s43
    v_perm_b32 v9, v79, v75, s43
    v_mul_hi_u32_u24 v72, 429497, v72
    v_mul_hi_u32_u24 v76, 429497, v76
    v_mul_hi_u32_u24 v73, 429497, v73
    v_mul_hi_u32_u24 v77, 429497, v77
    v_mul_hi_u32_u24 v74, 429497, v74
    v_mul_hi_u32_u24 v78, 429497, v78
    v_mul_hi_u32_u24 v75, 429497, v75
    v_mul_hi_u32_u24 v79, 429497, v79
    v_lshl_or_b32 v72, v76, 16, v72
    v_lshl_or_b32 v73, v77, 16, v73
    v_lshl_or_b32 v74, v78, 16, v74
    v_lshl_or_b32 v75, v79, 16, v75
    v_dot2_u32_u16 v76, v72, s38, 0
    v_dot2_u32_u16 v77, v73, s38, 0
    v_dot2_u32_u16 v78, v74, s38, 0
    v_dot2_u32_u16 v79, v75, s38, 0
    v_pk_mad_u16 v6, v72, s37, v6
    v_pk_mad_u16 v7, v73, s37, v7
    v_pk_mad_u16 v8, v74, s37, v8
    v_pk_mad_u16 v9, v75, s37, v9
    ds_add_u32 v76, v4 offset:0
    ds_add_u32 v77, v4 offset:0
    ds_add_u32 v78, v4 offset:0
    ds_add_u32 v79, v4 offset:0
    v_pk_mad_u16 v6, v72, s52, v6 op_sel:[1,0,0] op_sel_hi:[1,1,1]
    v_pk_mad_u16 v7, v73, s52, v7 op_sel:[1,0,0] op_sel_hi:[1,1,1]
    v_pk_mad_u16 v8, v74, s52, v8 op_sel:[1,0,0] op_sel_hi:[1,1,1]
    v_pk_mad_u16 v9, v75, s52, v9 op_sel:[1,0,0] op_sel_hi:[1,1,1]
    v_perm_b32 v123, v79, v78, s43
    v_perm_b32 v122, v77, v76, s43
    v_or_b32 v69, 0x40000000, v6
    v_or_b32 v70, 0x40000000, v7
    v_or_b32 v127, 0x40000000, v8
    v_or_b32 v72, 0x40000000, v9
    s_waitcnt vmcnt(8)
    v_perm_b32 v6, v100, v80, s43
    v_perm_b32 v7, v101, v81, s43
    v_perm_b32 v8, v102, v82, s43
    v_perm_b32 v9, v103, v83, s43
    v_mul_hi_u32_u24 v80, 429497, v80
    v_mul_hi_u32_u24 v100, 429497, v100
    v_mul_hi_u32_u24 v81, 429497, v81
    v_mul_hi_u32_u24 v101, 429497, v101
    v_mul_hi_u32_u24 v82, 429497, v82
    v_mul_hi_u32_u24 v102, 429497, v102
    v_mul_hi_u32_u24 v83, 429497, v83
    v_mul_hi_u32_u24 v103, 429497, v103
    v_lshl_or_b32 v80, v100, 16, v80
    v_lshl_or_b32 v81, v101, 16, v81
    v_lshl_or_b32 v82, v102, 16, v82
    v_lshl_or_b32 v83, v103, 16, v83
    v_dot2_u32_u16 v100, v80, s38, 0
    v_dot2_u32_u16 v101, v81, s38, 0
    v_dot2_u32_u16 v102, v82, s38, 0
    v_dot2_u32_u16 v103, v83, s38, 0
    v_pk_mad_u16 v6, v80, s37, v6
    v_pk_mad_u16 v7, v81, s37, v7
    v_pk_mad_u16 v8, v82, s37, v8
    v_pk_mad_u16 v9, v83, s37, v9
    ds_add_u32 v100, v4 offset:0
    ds_add_u32 v101, v4 offset:0
    ds_add_u32 v102, v4 offset:0
    ds_add_u32 v103, v4 offset:0
    v_pk_mad_u16 v6, v80, s52, v6 op_sel:[1,0,0] op_sel_hi:[1,1,1]
    v_pk_mad_u16 v7, v81, s52, v7 op_sel:[1,0,0] op_sel_hi:[1,1,1]
    v_pk_mad_u16 v8, v82, s52, v8 op_sel:[1,0,0] op_sel_hi:[1,1,1]
    v_pk_mad_u16 v9, v83, s52, v9 op_sel:[1,0,0] op_sel_hi:[1,1,1]
    v_perm_b32 v125, v103, v102, s43
    v_perm_b32 v124, v101, v100, s43
    v_or_b32 v73, 0x40000000, v6
    v_or_b32 v74, 0x40000000, v7
    v_or_b32 v76, 0x40000000, v8
    v_or_b32 v77, 0x40000000, v9
    s_waitcnt vmcnt(6)
    v_perm_b32 v6, v104, v84, s43
    v_perm_b32 v7, v105, v85, s43
    v_perm_b32 v8, v106, v86, s43
    v_perm_b32 v9, v107, v87, s43
    v_mul_hi_u32_u24 v84, 429497, v84
    v_mul_hi_u32_u24 v104, 429497, v104
    v_mul_hi_u32_u24 v85, 429497, v85
    v_mul_hi_u32_u24 v105, 429497, v105
    v_mul_hi_u32_u24 v86, 429497, v86
    v_mul_hi_u32_u24 v106, 429497, v106
    v_mul_hi_u32_u24 v87, 429497, v87
    v_mul_hi_u32_u24 v107, 429497, v107
    v_lshl_or_b32 v84, v104, 16, v84
    v_lshl_or_b32 v85, v105, 16, v85
    v_lshl_or_b32 v86, v106, 16, v86
    v_lshl_or_b32 v87, v107, 16, v87
    v_dot2_u32_u16 v104, v84, s38, 0
    v_dot2_u32_u16 v105, v85, s38, 0
    v_dot2_u32_u16 v106, v86, s38, 0
    v_dot2_u32_u16 v107, v87, s38, 0
    v_pk_mad_u16 v6, v84, s37, v6
    v_pk_mad_u16 v7, v85, s37, v7
    v_pk_mad_u16 v8, v86, s37, v8
    v_pk_mad_u16 v9, v87, s37, v9
    ds_add_u32 v104, v4 offset:0
    ds_add_u32 v105, v4 offset:0
    ds_add_u32 v106, v4 offset:0
    ds_add_u32 v107, v4 offset:0
    v_pk_mad_u16 v6, v84, s52, v6 op_sel:[1,0,0] op_sel_hi:[1,1,1]
    v_pk_mad_u16 v7, v85, s52, v7 op_sel:[1,0,0] op_sel_hi:[1,1,1]
    v_pk_mad_u16 v8, v86, s52, v8 op_sel:[1,0,0] op_sel_hi:[1,1,1]
    v_pk_mad_u16 v9, v87, s52, v9 op_sel:[1,0,0] op_sel_hi:[1,1,1]
    v_perm_b32 v75, v107, v106, s43
    v_perm_b32 v126, v105, v104, s43
    v_or_b32 v78, 0x40000000, v6
    v_or_b32 v80, 0x40000000, v7
    v_or_b32 v81, 0x40000000, v8
    v_or_b32 v82, 0x40000000, v9
    s_waitcnt vmcnt(4)
    v_perm_b32 v6, v108, v88, s43
    v_perm_b32 v7, v109, v89, s43
    v_perm_b32 v8, v110, v90, s43
    v_perm_b32 v9, v111, v91, s43
    v_mul_hi_u32_u24 v88, 429497, v88
    v_mul_hi_u32_u24 v108, 429497, v108
    v_mul_hi_u32_u24 v89, 429497, v89
    v_mul_hi_u32_u24 v109, 429497, v109
    v_mul_hi_u32_u24 v90, 429497, v90
    v_mul_hi_u32_u24 v110, 429497, v110
    v_mul_hi_u32_u24 v91, 429497, v91
    v_mul_hi_u32_u24 v111, 429497, v111
    v_lshl_or_b32 v88, v108, 16, v88
    v_lshl_or_b32 v89, v109, 16, v89
    v_lshl_or_b32 v90, v110, 16, v90
    v_lshl_or_b32 v91, v111, 16, v91
    v_dot2_u32_u16 v108, v88, s38, 0
    v_dot2_u32_u16 v109, v89, s38, 0
    v_dot2_u32_u16 v110, v90, s38, 0
    v_dot2_u32_u16 v111, v91, s38, 0
    v_pk_mad_u16 v6, v88, s37, v6
    v_pk_mad_u16 v7, v89, s37, v7
    v_pk_mad_u16 v8, v90, s37, v8
    v_pk_mad_u16 v9, v91, s37, v9
    ds_add_u32 v108, v4 offset:0
    ds_add_u32 v109, v4 offset:0
    ds_add_u32 v110, v4 offset:0
    ds_add_u32 v111, v4 offset:0
    v_pk_mad_u16 v6, v88, s52, v6 op_sel:[1,0,0] op_sel_hi:[1,1,1]
    v_pk_mad_u16 v7, v89, s52, v7 op_sel:[1,0,0] op_sel_hi:[1,1,1]
    v_pk_mad_u16 v8, v90, s52, v8 op_sel:[1,0,0] op_sel_hi:[1,1,1]
    v_pk_mad_u16 v9, v91, s52, v9 op_sel:[1,0,0] op_sel_hi:[1,1,1]
    v_perm_b32 v83, v111, v110, s43
    v_perm_b32 v79, v109, v108, s43
    v_or_b32 v84, 0x40000000, v6
    v_or_b32 v85, 0x40000000, v7
    v_or_b32 v86, 0x40000000, v8
    v_or_b32 v88, 0x40000000, v9
    s_waitcnt vmcnt(2)
    v_perm_b32 v6, v112, v92, s43
    v_perm_b32 v7, v113, v93, s43
    v_perm_b32 v8, v114, v94, s43
    v_perm_b32 v9, v115, v95, s43
    v_mul_hi_u32_u24 v92, 429497, v92
    v_mul_hi_u32_u24 v112, 429497, v112
    v_mul_hi_u32_u24 v93, 429497, v93
    v_mul_hi_u32_u24 v113, 429497, v113
    v_mul_hi_u32_u24 v94, 429497, v94
    v_mul_hi_u32_u24 v114, 429497, v114
    v_mul_hi_u32_u24 v95, 429497, v95
    v_mul_hi_u32_u24 v115, 429497, v115
    v_lshl_or_b32 v92, v112, 16, v92
    v_lshl_or_b32 v93, v113, 16, v93
    v_lshl_or_b32 v94, v114, 16, v94
    v_lshl_or_b32 v95, v115, 16, v95
    v_dot2_u32_u16 v112, v92, s38, 0
    v_dot2_u32_u16 v113, v93, s38, 0
    v_dot2_u32_u16 v114, v94, s38, 0
    v_dot2_u32_u16 v115, v95, s38, 0
    v_pk_mad_u16 v6, v92, s37, v6
    v_pk_mad_u16 v7, v93, s37, v7
    v_pk_mad_u16 v8, v94, s37, v8
    v_pk_mad_u16 v9, v95, s37, v9
    ds_add_u32 v112, v4 offset:0
    ds_add_u32 v113, v4 offset:0
    ds_add_u32 v114, v4 offset:0
    ds_add_u32 v115, v4 offset:0
    v_pk_mad_u16 v6, v92, s52, v6 op_sel:[1,0,0] op_sel_hi:[1,1,1]
    v_pk_mad_u16 v7, v93, s52, v7 op_sel:[1,0,0] op_sel_hi:[1,1,1]
    v_pk_mad_u16 v8, v94, s52, v8 op_sel:[1,0,0] op_sel_hi:[1,1,1]
    v_pk_mad_u16 v9, v95, s52, v9 op_sel:[1,0,0] op_sel_hi:[1,1,1]
    v_perm_b32 v91, v115, v114, s43
    v_perm_b32 v87, v113, v112, s43
    v_or_b32 v89, 0x40000000, v6
    v_or_b32 v90, 0x40000000, v7
    v_or_b32 v92, 0x40000000, v8
    v_or_b32 v93, 0x40000000, v9
    s_waitcnt vmcnt(0)
    s_mov_b64 exec, s[44:45]
    v_perm_b32 v6, v116, v96, s43
    v_perm_b32 v7, v117, v97, s43
    v_perm_b32 v8, v118, v98, s43
    v_perm_b32 v9, v119, v99, s43
    v_mul_hi_u32_u24 v96, 429497, v96
    v_mul_hi_u32_u24 v116, 429497, v116
    v_mul_hi_u32_u24 v97, 429497, v97
    v_mul_hi_u32_u24 v117, 429497, v117
    v_mul_hi_u32_u24 v98, 429497, v98
    v_mul_hi_u32_u24 v118, 429497, v118
    v_mul_hi_u32_u24 v99, 429497, v99
    v_mul_hi_u32_u24 v119, 429497, v119
    v_lshl_or_b32 v96, v116, 16, v96
    v_lshl_or_b32 v97, v117, 16, v97
    v_lshl_or_b32 v98, v118, 16, v98
    v_lshl_or_b32 v99, v119, 16, v99
    v_dot2_u32_u16 v116, v96, s38, 0
    v_dot2_u32_u16 v117, v97, s38, 0
    v_dot2_u32_u16 v118, v98, s38, 0
    v_dot2_u32_u16 v119, v99, s38, 0
    v_pk_mad_u16 v6, v96, s37, v6
    v_pk_mad_u16 v7, v97, s37, v7
    v_pk_mad_u16 v8, v98, s37, v8
    v_pk_mad_u16 v9, v99, s37, v9
    ds_add_u32 v116, v4 offset:0
    ds_add_u32 v117, v4 offset:0
    ds_add_u32 v118, v4 offset:0
    ds_add_u32 v119, v4 offset:0
    v_pk_mad_u16 v6, v96, s52, v6 op_sel:[1,0,0] op_sel_hi:[1,1,1]
    v_pk_mad_u16 v7, v97, s52, v7 op_sel:[1,0,0] op_sel_hi:[1,1,1]
    v_pk_mad_u16 v8, v98, s52, v8 op_sel:[1,0,0] op_sel_hi:[1,1,1]
    v_pk_mad_u16 v9, v99, s52, v9 op_sel:[1,0,0] op_sel_hi:[1,1,1]
    v_perm_b32 v99, v119, v118, s43
    v_perm_b32 v95, v117, v116, s43
    v_or_b32 v94, 0x40000000, v6
    v_or_b32 v96, 0x40000000, v7
    v_or_b32 v97, 0x40000000, v8
    v_or_b32 v98, 0x40000000, v9
    s_mov_b64 exec, -1
    s_add_u32 s35, s34, 0
    buffer_load_dwordx2 v[100:101], v2, s[16:19], s35 offen nt
    s_lshl_b32 s35, s32, 10
    s_add_u32 s35, s35, 9437184
    s_add_u32 s20, s4, s35
    s_addc_u32 s21, s5, 0
    s_waitcnt lgkmcnt(0)
    s_barrier
    ds_read_b128 v[8:11], v1 offset:0
    s_add_u32 s35, s34, 2097152
    buffer_load_dwordx2 v[102:103], v2, s[16:19], s35 offen nt
    s_lshl_b32 s35, s39, 2
    s_add_u32 s35, s35, 160256
    v_mov_b32 v7, s35
    v_and_b32 v14, 15, v0
    v_lshlrev_b32 v14, 2, v14
    v_add_u32 v14, 160256, v14
    s_waitcnt lgkmcnt(0)
    v_cmp_eq_u32 s[56:57], 0, v8
    v_cmp_ge_u32 s[64:65], 1, v8
    v_max_u32 v12, 2, v8
    v_lshl_or_b32 v8, v8, 16, v12
    v_cmp_eq_u32 s[58:59], 0, v9
    v_cmp_ge_u32 s[66:67], 1, v9
    v_max_u32 v12, 2, v9
    v_lshl_or_b32 v9, v9, 16, v12
    v_cmp_eq_u32 s[60:61], 0, v10
    v_cmp_ge_u32 s[68:69], 1, v10
    v_max_u32 v12, 2, v10
    v_lshl_or_b32 v10, v10, 16, v12
    v_cmp_eq_u32 s[62:63], 0, v11
    v_cmp_ge_u32 s[70:71], 1, v11
    v_max_u32 v12, 2, v11
    v_lshl_or_b32 v11, v11, 16, v12
    v_add_u32 v9, v8, v9
    v_add_u32 v10, v9, v10
    v_add_u32 v11, v10, v11
    v_mov_b32 v6, v11
    s_nop 1
    v_add_u32_dpp v6, v6, v6 row_shr:1 row_mask:0xf bank_mask:0xf bound_ctrl:0
    s_nop 1
    v_add_u32_dpp v6, v6, v6 row_shr:2 row_mask:0xf bank_mask:0xf bound_ctrl:0
    s_nop 1
    v_add_u32_dpp v6, v6, v6 row_shr:4 row_mask:0xf bank_mask:0xf bound_ctrl:0
    s_nop 1
    v_add_u32_dpp v6, v6, v6 row_shr:8 row_mask:0xf bank_mask:0xf bound_ctrl:0
    s_nop 1
    v_add_u32_dpp v6, v6, v6 row_bcast:15 row_mask:0xa bank_mask:0xf
    s_nop 1
    v_add_u32_dpp v6, v6, v6 row_bcast:31 row_mask:0xc bank_mask:0xf
    s_mov_b32 exec_lo, 0
    s_brev_b32 exec_hi, 1
    ds_write_b32 v7, v6
    s_mov_b64 exec, -1
    v_sub_u32 v6, v6, v11
    s_or_b64 s[46:47], s[64:65], s[66:67]
    s_or_b64 vcc, s[68:69], s[70:71]
    s_or_b64 s[46:47], s[46:47], vcc
    s_waitcnt lgkmcnt(0)
    s_barrier
    ds_read_b32 v7, v14
    s_add_u32 s35, s34, 4194304
    buffer_load_dwordx2 v[104:105], v2, s[16:19], s35 offen nt
    s_waitcnt lgkmcnt(0)
    v_mov_b32 v15, v7
    s_nop 1
    v_add_u32_dpp v7, v7, v7 row_shr:1 row_mask:0xf bank_mask:0xf bound_ctrl:0
    s_nop 1
    v_add_u32_dpp v7, v7, v7 row_shr:2 row_mask:0xf bank_mask:0xf bound_ctrl:0
    s_nop 1
    v_add_u32_dpp v7, v7, v7 row_shr:4 row_mask:0xf bank_mask:0xf bound_ctrl:0
    s_nop 1
    v_add_u32_dpp v7, v7, v7 row_shr:8 row_mask:0xf bank_mask:0xf bound_ctrl:0
    s_nop 0
    v_readlane_b32 s54, v7, 15
    v_sub_u32 v7, v7, v15
    s_nop 0
    v_readlane_b32 s35, v7, s39
    s_and_b32 s54, s54, 0xffff
    s_cmp_ge_u32 s54, 40063
    s_cselect_b32 s36, 16, 0
    s_cselect_b32 s54, 40000, s54
    s_cselect_b32 s55, 1, s55
    s_cselect_b64 s[46:47], 0, s[46:47]
    v_add_u32 v12, s35, v6
    v_add_u32 v13, v12, v8
    v_add_u32 v14, v12, v9
    v_add_u32 v15, v12, v10
    v_bfe_u32 v12, v12, s36, 16
    v_bfe_u32 v13, v13, s36, 16
    v_bfe_u32 v14, v14, s36, 16
    v_bfe_u32 v15, v15, s36, 16
    ds_write_b128 v1, v[12:15] offset:0
    ds_write_b128 v1, v[12:15] offset:16384
    v_mov_b32 v6, 32768
    v_mov_b32 v7, s54
    s_mov_b64 exec, 1
    ds_write_b32 v6, v7
    s_mov_b64 exec, -1
    s_add_u32 s35, s54, 2
    s_mul_hi_u32 s35, s35, 1431655766
    s_lshl_b32 s35, s35, 4
    s_add_u32 s35, s35, 217890816
    s_min_u32 s22, s35, 218104832
    v_perm_b32 v15, v15, v14, s43
    v_perm_b32 v14, v13, v12, s43
    s_waitcnt lgkmcnt(0)
    s_barrier
    s_nop 0
    v_and_b32 v6, 0xffff, v51
    v_lshrrev_b32 v7, 16, v51
    v_and_b32 v8, 0xffff, v55
    v_lshrrev_b32 v9, 16, v55
    ds_add_rtn_u32 v6, v6, v4 offset:0
    ds_add_rtn_u32 v7, v7, v4 offset:0
    ds_add_rtn_u32 v8, v8, v4 offset:0
    ds_add_rtn_u32 v9, v9, v4 offset:0
    v_and_b32 v10, 0xffff, v59
    v_lshrrev_b32 v11, 16, v59
    v_and_b32 v12, 0xffff, v63
    v_lshrrev_b32 v13, 16, v63
    ds_add_rtn_u32 v10, v10, v4 offset:0
    ds_add_rtn_u32 v11, v11, v4 offset:0
    ds_add_rtn_u32 v12, v12, v4 offset:0
    ds_add_rtn_u32 v13, v13, v4 offset:0
    s_waitcnt lgkmcnt(4)
    v_perm_b32 v51, v7, v6, s43
    v_perm_b32 v55, v9, v8, s43
    v_and_b32 v6, 0xffff, v67
    v_lshrrev_b32 v7, 16, v67
    v_and_b32 v8, 0xffff, v71
    v_lshrrev_b32 v9, 16, v71
    ds_add_rtn_u32 v6, v6, v4 offset:0
    ds_add_rtn_u32 v7, v7, v4 offset:0
    ds_add_rtn_u32 v8, v8, v4 offset:0
    ds_add_rtn_u32 v9, v9, v4 offset:0
    s_waitcnt lgkmcnt(4)
    v_perm_b32 v59, v11, v10, s43
    v_perm_b32 v63, v13, v12, s43
    s_add_u32 s35, s34, 6291456
    buffer_load_dwordx2 v[106:107], v2, s[16:19], s35 offen nt
    v_and_b32 v10, 0xffff, v120
    v_lshrrev_b32 v11, 16, v120
    v_and_b32 v12, 0xffff, v121
    v_lshrrev_b32 v13, 16, v121
    ds_add_rtn_u32 v10, v10, v4 offset:0
    ds_add_rtn_u32 v11, v11, v4 offset:0
    ds_add_rtn_u32 v12, v12, v4 offset:0
    ds_add_rtn_u32 v13, v13, v4 offset:0
    s_waitcnt lgkmcnt(4)
    v_perm_b32 v67, v7, v6, s43
    v_perm_b32 v71, v9, v8, s43
    s_add_u32 s35, s34, 8388608
    buffer_load_dwordx2 v[108:109], v2, s[16:19], s35 offen nt
    v_and_b32 v6, 0xffff, v122
    v_lshrrev_b32 v7, 16, v122
    v_and_b32 v8, 0xffff, v123
    v_lshrrev_b32 v9, 16, v123
    ds_add_rtn_u32 v6, v6, v4 offset:0
    ds_add_rtn_u32 v7, v7, v4 offset:0
    ds_add_rtn_u32 v8, v8, v4 offset:0
    ds_add_rtn_u32 v9, v9, v4 offset:0
    s_waitcnt lgkmcnt(4)
    v_perm_b32 v120, v11, v10, s43
    v_perm_b32 v121, v13, v12, s43
    s_add_u32 s35, s34, 10485760
    buffer_load_dwordx2 v[110:111], v2, s[16:19], s35 offen nt
    v_and_b32 v10, 0xffff, v124
    v_lshrrev_b32 v11, 16, v124
    v_and_b32 v12, 0xffff, v125
    v_lshrrev_b32 v13, 16, v125
    ds_add_rtn_u32 v10, v10, v4 offset:0
    ds_add_rtn_u32 v11, v11, v4 offset:0
    ds_add_rtn_u32 v12, v12, v4 offset:0
    ds_add_rtn_u32 v13, v13, v4 offset:0
    s_waitcnt lgkmcnt(4)
    v_perm_b32 v122, v7, v6, s43
    v_perm_b32 v123, v9, v8, s43
    v_and_b32 v6, 0xffff, v126
    v_lshrrev_b32 v7, 16, v126
    v_and_b32 v8, 0xffff, v75
    v_lshrrev_b32 v9, 16, v75
    ds_add_rtn_u32 v6, v6, v4 offset:0
    ds_add_rtn_u32 v7, v7, v4 offset:0
    ds_add_rtn_u32 v8, v8, v4 offset:0
    ds_add_rtn_u32 v9, v9, v4 offset:0
    s_waitcnt lgkmcnt(4)
    v_perm_b32 v124, v11, v10, s43
    v_perm_b32 v125, v13, v12, s43
    s_add_u32 s35, s34, 12582912
    buffer_load_dwordx2 v[112:113], v2, s[16:19], s35 offen nt
    v_and_b32 v10, 0xffff, v79
    v_lshrrev_b32 v11, 16, v79
    v_and_b32 v12, 0xffff, v83
    v_lshrrev_b32 v13, 16, v83
    ds_add_rtn_u32 v10, v10, v4 offset:0
    ds_add_rtn_u32 v11, v11, v4 offset:0
    ds_add_rtn_u32 v12, v12, v4 offset:0
    ds_add_rtn_u32 v13, v13, v4 offset:0
    s_waitcnt lgkmcnt(4)
    v_perm_b32 v126, v7, v6, s43
    v_perm_b32 v75, v9, v8, s43
    s_add_u32 s35, s34, 14680064
    buffer_load_dwordx2 v[114:115], v2, s[16:19], s35 offen nt
    v_and_b32 v6, 0xffff, v87
    v_lshrrev_b32 v7, 16, v87
    v_and_b32 v8, 0xffff, v91
    v_lshrrev_b32 v9, 16, v91
    ds_add_rtn_u32 v6, v6, v4 offset:0
    ds_add_rtn_u32 v7, v7, v4 offset:0
    ds_add_rtn_u32 v8, v8, v4 offset:0
    ds_add_rtn_u32 v9, v9, v4 offset:0
    s_waitcnt lgkmcnt(4)
    v_perm_b32 v79, v11, v10, s43
    v_perm_b32 v83, v13, v12, s43
    s_add_u32 s35, s34, 16777216
    buffer_load_dwordx2 v[116:117], v2, s[16:19], s35 offen nt
    s_mov_b64 exec, s[44:45]
    v_and_b32 v10, 0xffff, v95
    v_lshrrev_b32 v11, 16, v95
    v_and_b32 v12, 0xffff, v99
    v_lshrrev_b32 v13, 16, v99
    ds_add_rtn_u32 v10, v10, v4 offset:0
    ds_add_rtn_u32 v11, v11, v4 offset:0
    ds_add_rtn_u32 v12, v12, v4 offset:0
    ds_add_rtn_u32 v13, v13, v4 offset:0
    s_mov_b64 exec, -1
    s_waitcnt lgkmcnt(4)
    v_perm_b32 v87, v7, v6, s43
    v_perm_b32 v91, v9, v8, s43
    s_add_u32 s35, s34, 18874368
    s_sub_u32 s35, s35, s49
    v_cndmask_b32 v118, 2.0, v2, s[44:45]
    buffer_load_dwordx2 v[118:119], v118, s[16:19], s35 offen nt
    s_waitcnt lgkmcnt(0)
    v_perm_b32 v95, v11, v10, s43
    v_perm_b32 v99, v13, v12, s43
    s_cmp_gt_u32 s39, 8
    s_cbranch_scc1 L_p1_kernel_notab_9
    v_lshrrev_b32 v6, 1, v0
    v_mul_u32_u24 v7, 1009, v6
    v_lshrrev_b32 v7, 16, v7
    v_mul_u32_u24 v7, 959, v7
    v_and_b32 v8, 1, v0
    v_lshl_add_u32 v7, v8, 9, v7
    v_add_lshl_u32 v13, v7, v6, 2
    ds_read2st64_b32 v[6:7], v13 offset0:64 offset1:65
    ds_read2st64_b32 v[8:9], v13 offset0:66 offset1:67
    ds_read2st64_b32 v[10:11], v13 offset0:68 offset1:69
    ds_read2st64_b32 v[12:13], v13 offset0:70 offset1:71
    s_mul_i32 s35, s32, 8320
    s_add_u32 s26, s35, 8320
    s_waitcnt lgkmcnt(3)
    v_perm_b32 v6, v7, v6, s43
    s_waitcnt lgkmcnt(2)
    v_perm_b32 v7, v9, v8, s43
    s_waitcnt lgkmcnt(1)
    v_perm_b32 v8, v11, v10, s43
    s_waitcnt lgkmcnt(0)
    v_perm_b32 v9, v13, v12, s43
    buffer_store_dwordx4 v[6:9], v1, s[24:27], s35 offen sc1
    s_nop 1
L_p1_kernel_notab_9:
    s_barrier
    s_lshl_b32 s35, s54, 2
    v_mov_b32 v6, s35
    v_mov_b32 v7, 0
    v_mov_b32 v12, 1140817920
    s_mov_b64 exec, 1
    ds_write2_b32 v6, v7, v7 offset0:0 offset1:1
    s_cmp_eq_u64 s[46:47], 0
    s_cbranch_scc1 L_p1_kernel_nonull_10
    s_mov_b64 exec, s[64:65]
    v_lshlrev_b32_sdwa v6, 2, v14 dst_sel:DWORD dst_unused:UNUSED_PAD src0_sel:DWORD src1_sel:WORD_0
    ds_write_b32 v6, v7 offset:4
    s_mov_b64 exec, s[56:57]
    ds_write_b32 v6, v7
    s_mov_b64 exec, s[66:67]
    v_lshlrev_b32_sdwa v6, 2, v14 dst_sel:DWORD dst_unused:UNUSED_PAD src0_sel:DWORD src1_sel:WORD_1
    ds_write_b32 v6, v7 offset:4
    s_mov_b64 exec, s[58:59]
    ds_write_b32 v6, v7
    s_mov_b64 exec, s[68:69]
    v_lshlrev_b32_sdwa v6, 2, v15 dst_sel:DWORD dst_unused:UNUSED_PAD src0_sel:DWORD src1_sel:WORD_0
    ds_write_b32 v6, v7 offset:4
    s_mov_b64 exec, s[60:61]
    ds_write_b32 v6, v7
    s_mov_b64 exec, s[70:71]
    v_lshlrev_b32_sdwa v6, 2, v15 dst_sel:DWORD dst_unused:UNUSED_PAD src0_sel:DWORD src1_sel:WORD_1
    ds_write_b32 v6, v7 offset:4
    s_mov_b64 exec, s[62:63]
    ds_write_b32 v6, v7
L_p1_kernel_nonull_10:
    s_mov_b64 exec, -1
    v_lshlrev_b32_sdwa v6, 2, v51 dst_sel:DWORD dst_unused:UNUSED_PAD src0_sel:DWORD src1_sel:WORD_0
    v_lshlrev_b32_sdwa v7, 2, v51 dst_sel:DWORD dst_unused:UNUSED_PAD src0_sel:DWORD src1_sel:WORD_1
    v_lshlrev_b32_sdwa v8, 2, v55 dst_sel:DWORD dst_unused:UNUSED_PAD src0_sel:DWORD src1_sel:WORD_0
    v_lshlrev_b32_sdwa v9, 2, v55 dst_sel:DWORD dst_unused:UNUSED_PAD src0_sel:DWORD src1_sel:WORD_1
    ds_write_b32 v6, v48
    ds_write_b32 v7, v49
    ds_write_b32 v8, v50
    ds_write_b32 v9, v52
    s_waitcnt vmcnt(9)
    v_lshlrev_b32 v10, 16, v100
    v_lshlrev_b32 v11, 16, v101
    v_and_b32 v100, 0xffff0000, v100
    v_and_b32 v101, 0xffff0000, v101
    v_mul_f32 v10, s41, v10
    v_mul_f32 v100, s41, v100
    v_mul_f32 v11, s41, v11
    v_mul_f32 v101, s41, v101
    v_fract_f32 v10, v10
    v_fract_f32 v100, v100
    v_fract_f32 v11, v11
    v_fract_f32 v101, v101
    v_cos_f32 v10, v10
    v_cos_f32 v100, v100
    v_cos_f32 v11, v11
    v_cos_f32 v101, v101
    v_fmaak_f32 v10, v12, v10, 1262486016
    v_fmaak_f32 v100, v12, v100, 1262486016
    v_fmaak_f32 v11, v12, v11, 1262486016
    v_fmaak_f32 v101, v12, v101, 1262486016
    v_or3_b32 v5, v10, v100, v5
    v_or3_b32 v5, v11, v101, v5
    v_perm_b32 v100, v100, v10, s43
    v_perm_b32 v101, v101, v11, s43
    s_add_u32 s35, s33, 40960000
    buffer_load_dwordx4 v[16:19], v1, s[8:11], s35 offen nt
    v_lshlrev_b32_sdwa v6, 2, v59 dst_sel:DWORD dst_unused:UNUSED_PAD src0_sel:DWORD src1_sel:WORD_0
    v_lshlrev_b32_sdwa v7, 2, v59 dst_sel:DWORD dst_unused:UNUSED_PAD src0_sel:DWORD src1_sel:WORD_1
    v_lshlrev_b32_sdwa v8, 2, v63 dst_sel:DWORD dst_unused:UNUSED_PAD src0_sel:DWORD src1_sel:WORD_0
    v_lshlrev_b32_sdwa v9, 2, v63 dst_sel:DWORD dst_unused:UNUSED_PAD src0_sel:DWORD src1_sel:WORD_1
    ds_write_b32 v6, v53
    ds_write_b32 v7, v54
    ds_write_b32 v8, v56
    ds_write_b32 v9, v57
    s_waitcnt vmcnt(9)
    v_lshlrev_b32 v10, 16, v102
    v_lshlrev_b32 v11, 16, v103
    v_and_b32 v102, 0xffff0000, v102
    v_and_b32 v103, 0xffff0000, v103
    v_mul_f32 v10, s41, v10
    v_mul_f32 v102, s41, v102
    v_mul_f32 v11, s41, v11
    v_mul_f32 v103, s41, v103
    v_fract_f32 v10, v10
    v_fract_f32 v102, v102
    v_fract_f32 v11, v11
    v_fract_f32 v103, v103
    v_cos_f32 v10, v10
    v_cos_f32 v102, v102
    v_cos_f32 v11, v11
    v_cos_f32 v103, v103
    v_fmaak_f32 v10, v12, v10, 1262486016
    v_fmaak_f32 v102, v12, v102, 1262486016
    v_fmaak_f32 v11, v12, v11, 1262486016
    v_fmaak_f32 v103, v12, v103, 1262486016
    v_or3_b32 v5, v10, v102, v5
    v_or3_b32 v5, v11, v103, v5
    v_perm_b32 v102, v102, v10, s43
    v_perm_b32 v103, v103, v11, s43
    v_lshlrev_b32_sdwa v6, 2, v67 dst_sel:DWORD dst_unused:UNUSED_PAD src0_sel:DWORD src1_sel:WORD_0
    v_lshlrev_b32_sdwa v7, 2, v67 dst_sel:DWORD dst_unused:UNUSED_PAD src0_sel:DWORD src1_sel:WORD_1
    v_lshlrev_b32_sdwa v8, 2, v71 dst_sel:DWORD dst_unused:UNUSED_PAD src0_sel:DWORD src1_sel:WORD_0
    v_lshlrev_b32_sdwa v9, 2, v71 dst_sel:DWORD dst_unused:UNUSED_PAD src0_sel:DWORD src1_sel:WORD_1
    ds_write_b32 v6, v58
    ds_write_b32 v7, v60
    ds_write_b32 v8, v61
    ds_write_b32 v9, v62
    v_lshlrev_b32_sdwa v6, 2, v120 dst_sel:DWORD dst_unused:UNUSED_PAD src0_sel:DWORD src1_sel:WORD_0
    v_lshlrev_b32_sdwa v7, 2, v120 dst_sel:DWORD dst_unused:UNUSED_PAD src0_sel:DWORD src1_sel:WORD_1
    v_lshlrev_b32_sdwa v8, 2, v121 dst_sel:DWORD dst_unused:UNUSED_PAD src0_sel:DWORD src1_sel:WORD_0
    v_lshlrev_b32_sdwa v9, 2, v121 dst_sel:DWORD dst_unused:UNUSED_PAD src0_sel:DWORD src1_sel:WORD_1
    ds_write_b32 v6, v64
    ds_write_b32 v7, v65
    ds_write_b32 v8, v66
    ds_write_b32 v9, v68
    s_waitcnt vmcnt(8)
    v_lshlrev_b32 v10, 16, v104
    v_lshlrev_b32 v11, 16, v105
    v_and_b32 v104, 0xffff0000, v104
    v_and_b32 v105, 0xffff0000, v105
    v_mul_f32 v10, s41, v10
    v_mul_f32 v104, s41, v104
    v_mul_f32 v11, s41, v11
    v_mul_f32 v105, s41, v105
    v_fract_f32 v10, v10
    v_fract_f32 v104, v104
    v_fract_f32 v11, v11
    v_fract_f32 v105, v105
    v_cos_f32 v10, v10
    v_cos_f32 v104, v104
    v_cos_f32 v11, v11
    v_cos_f32 v105, v105
    v_fmaak_f32 v10, v12, v10, 1262486016
    v_fmaak_f32 v104, v12, v104, 1262486016
    v_fmaak_f32 v11, v12, v11, 1262486016
    v_fmaak_f32 v105, v12, v105, 1262486016
    v_or3_b32 v5, v10, v104, v5
    v_or3_b32 v5, v11, v105, v5
    v_perm_b32 v104, v104, v10, s43
    v_perm_b32 v105, v105, v11, s43
    s_add_u32 s35, s33, 40960000
    buffer_load_dwordx4 v[20:23], v1, s[12:15], s35 offen nt
    v_lshlrev_b32_sdwa v6, 2, v122 dst_sel:DWORD dst_unused:UNUSED_PAD src0_sel:DWORD src1_sel:WORD_0
    v_lshlrev_b32_sdwa v7, 2, v122 dst_sel:DWORD dst_unused:UNUSED_PAD src0_sel:DWORD src1_sel:WORD_1
    v_lshlrev_b32_sdwa v8, 2, v123 dst_sel:DWORD dst_unused:UNUSED_PAD src0_sel:DWORD src1_sel:WORD_0
    v_lshlrev_b32_sdwa v9, 2, v123 dst_sel:DWORD dst_unused:UNUSED_PAD src0_sel:DWORD src1_sel:WORD_1
    ds_write_b32 v6, v69
    ds_write_b32 v7, v70
    ds_write_b32 v8, v127
    ds_write_b32 v9, v72
    s_waitcnt vmcnt(8)
    v_lshlrev_b32 v10, 16, v106
    v_lshlrev_b32 v11, 16, v107
    v_and_b32 v106, 0xffff0000, v106
    v_and_b32 v107, 0xffff0000, v107
    v_mul_f32 v10, s41, v10
    v_mul_f32 v106, s41, v106
    v_mul_f32 v11, s41, v11
    v_mul_f32 v107, s41, v107
    v_fract_f32 v10, v10
    v_fract_f32 v106, v106
    v_fract_f32 v11, v11
    v_fract_f32 v107, v107
    v_cos_f32 v10, v10
    v_cos_f32 v106, v106
    v_cos_f32 v11, v11
    v_cos_f32 v107, v107
    v_fmaak_f32 v10, v12, v10, 1262486016
    v_fmaak_f32 v106, v12, v106, 1262486016
    v_fmaak_f32 v11, v12, v11, 1262486016
    v_fmaak_f32 v107, v12, v107, 1262486016
    v_or3_b32 v5, v10, v106, v5
    v_or3_b32 v5, v11, v107, v5
    v_perm_b32 v106, v106, v10, s43
    v_perm_b32 v107, v107, v11, s43
    v_lshlrev_b32_sdwa v6, 2, v124 dst_sel:DWORD dst_unused:UNUSED_PAD src0_sel:DWORD src1_sel:WORD_0
    v_lshlrev_b32_sdwa v7, 2, v124 dst_sel:DWORD dst_unused:UNUSED_PAD src0_sel:DWORD src1_sel:WORD_1
    v_lshlrev_b32_sdwa v8, 2, v125 dst_sel:DWORD dst_unused:UNUSED_PAD src0_sel:DWORD src1_sel:WORD_0
    v_lshlrev_b32_sdwa v9, 2, v125 dst_sel:DWORD dst_unused:UNUSED_PAD src0_sel:DWORD src1_sel:WORD_1
    ds_write_b32 v6, v73
    ds_write_b32 v7, v74
    ds_write_b32 v8, v76
    ds_write_b32 v9, v77
    v_lshlrev_b32_sdwa v6, 2, v126 dst_sel:DWORD dst_unused:UNUSED_PAD src0_sel:DWORD src1_sel:WORD_0
    v_lshlrev_b32_sdwa v7, 2, v126 dst_sel:DWORD dst_unused:UNUSED_PAD src0_sel:DWORD src1_sel:WORD_1
    v_lshlrev_b32_sdwa v8, 2, v75 dst_sel:DWORD dst_unused:UNUSED_PAD src0_sel:DWORD src1_sel:WORD_0
    v_lshlrev_b32_sdwa v9, 2, v75 dst_sel:DWORD dst_unused:UNUSED_PAD src0_sel:DWORD src1_sel:WORD_1
    ds_write_b32 v6, v78
    ds_write_b32 v7, v80
    ds_write_b32 v8, v81
    ds_write_b32 v9, v82
    s_waitcnt vmcnt(7)
    v_lshlrev_b32 v10, 16, v108
    v_lshlrev_b32 v11, 16, v109
    v_and_b32 v108, 0xffff0000, v108
    v_and_b32 v109, 0xffff0000, v109
    v_mul_f32 v10, s41, v10
    v_mul_f32 v108, s41, v108
    v_mul_f32 v11, s41, v11
    v_mul_f32 v109, s41, v109
    v_fract_f32 v10, v10
    v_fract_f32 v108, v108
    v_fract_f32 v11, v11
    v_fract_f32 v109, v109
    v_cos_f32 v10, v10
    v_cos_f32 v108, v108
    v_cos_f32 v11, v11
    v_cos_f32 v109, v109
    v_fmaak_f32 v10, v12, v10, 1262486016
    v_fmaak_f32 v108, v12, v108, 1262486016
    v_fmaak_f32 v11, v12, v11, 1262486016
    v_fmaak_f32 v109, v12, v109, 1262486016
    v_or3_b32 v5, v10, v108, v5
    v_or3_b32 v5, v11, v109, v5
    v_perm_b32 v108, v108, v10, s43
    v_perm_b32 v109, v109, v11, s43
    s_add_u32 s35, s33, 45154304
    buffer_load_dwordx4 v[24:27], v1, s[8:11], s35 offen nt
    v_lshlrev_b32_sdwa v6, 2, v79 dst_sel:DWORD dst_unused:UNUSED_PAD src0_sel:DWORD src1_sel:WORD_0
    v_lshlrev_b32_sdwa v7, 2, v79 dst_sel:DWORD dst_unused:UNUSED_PAD src0_sel:DWORD src1_sel:WORD_1
    v_lshlrev_b32_sdwa v8, 2, v83 dst_sel:DWORD dst_unused:UNUSED_PAD src0_sel:DWORD src1_sel:WORD_0
    v_lshlrev_b32_sdwa v9, 2, v83 dst_sel:DWORD dst_unused:UNUSED_PAD src0_sel:DWORD src1_sel:WORD_1
    ds_write_b32 v6, v84
    ds_write_b32 v7, v85
    ds_write_b32 v8, v86
    ds_write_b32 v9, v88
    s_waitcnt vmcnt(7)
    v_lshlrev_b32 v10, 16, v110
    v_lshlrev_b32 v11, 16, v111
    v_and_b32 v110, 0xffff0000, v110
    v_and_b32 v111, 0xffff0000, v111
    v_mul_f32 v10, s41, v10
    v_mul_f32 v110, s41, v110
    v_mul_f32 v11, s41, v11
    v_mul_f32 v111, s41, v111
    v_fract_f32 v10, v10
    v_fract_f32 v110, v110
    v_fract_f32 v11, v11
    v_fract_f32 v111, v111
    v_cos_f32 v10, v10
    v_cos_f32 v110, v110
    v_cos_f32 v11, v11
    v_cos_f32 v111, v111
    v_fmaak_f32 v10, v12, v10, 1262486016
    v_fmaak_f32 v110, v12, v110, 1262486016
    v_fmaak_f32 v11, v12, v11, 1262486016
    v_fmaak_f32 v111, v12, v111, 1262486016
    v_or3_b32 v5, v10, v110, v5
    v_or3_b32 v5, v11, v111, v5
    v_perm_b32 v110, v110, v10, s43
    v_perm_b32 v111, v111, v11, s43
    v_lshlrev_b32_sdwa v6, 2, v87 dst_sel:DWORD dst_unused:UNUSED_PAD src0_sel:DWORD src1_sel:WORD_0
    v_lshlrev_b32_sdwa v7, 2, v87 dst_sel:DWORD dst_unused:UNUSED_PAD src0_sel:DWORD src1_sel:WORD_1
    v_lshlrev_b32_sdwa v8, 2, v91 dst_sel:DWORD dst_unused:UNUSED_PAD src0_sel:DWORD src1_sel:WORD_0
    v_lshlrev_b32_sdwa v9, 2, v91 dst_sel:DWORD dst_unused:UNUSED_PAD src0_sel:DWORD src1_sel:WORD_1
    ds_write_b32 v6, v89
    ds_write_b32 v7, v90
    ds_write_b32 v8, v92
    ds_write_b32 v9, v93
    s_mov_b64 exec, s[44:45]
    v_lshlrev_b32_sdwa v6, 2, v95 dst_sel:DWORD dst_unused:UNUSED_PAD src0_sel:DWORD src1_sel:WORD_0
    v_lshlrev_b32_sdwa v7, 2, v95 dst_sel:DWORD dst_unused:UNUSED_PAD src0_sel:DWORD src1_sel:WORD_1
    v_lshlrev_b32_sdwa v8, 2, v99 dst_sel:DWORD dst_unused:UNUSED_PAD src0_sel:DWORD src1_sel:WORD_0
    v_lshlrev_b32_sdwa v9, 2, v99 dst_sel:DWORD dst_unused:UNUSED_PAD src0_sel:DWORD src1_sel:WORD_1
    ds_write_b32 v6, v94
    ds_write_b32 v7, v96
    ds_write_b32 v8, v97
    ds_write_b32 v9, v98
    s_mov_b64 exec, -1
    s_waitcnt vmcnt(6)
    v_lshlrev_b32 v10, 16, v112
    v_lshlrev_b32 v11, 16, v113
    v_and_b32 v112, 0xffff0000, v112
    v_and_b32 v113, 0xffff0000, v113
    v_mul_f32 v10, s41, v10
    v_mul_f32 v112, s41, v112
    v_mul_f32 v11, s41, v11
    v_mul_f32 v113, s41, v113
    v_fract_f32 v10, v10
    v_fract_f32 v112, v112
    v_fract_f32 v11, v11
    v_fract_f32 v113, v113
    v_cos_f32 v10, v10
    v_cos_f32 v112, v112
    v_cos_f32 v11, v11
    v_cos_f32 v113, v113
    v_fmaak_f32 v10, v12, v10, 1262486016
    v_fmaak_f32 v112, v12, v112, 1262486016
    v_fmaak_f32 v11, v12, v11, 1262486016
    v_fmaak_f32 v113, v12, v113, 1262486016
    v_or3_b32 v5, v10, v112, v5
    v_or3_b32 v5, v11, v113, v5
    v_perm_b32 v112, v112, v10, s43
    v_perm_b32 v113, v113, v11, s43
    s_mov_b64 exec, s[44:45]
    s_mov_b64 exec, -1
    s_add_u32 s35, s33, 45154304
    buffer_load_dwordx4 v[28:31], v1, s[12:15], s35 offen nt
    s_mul_i32 s35, s39, 9216
    v_mad_u32_u24 v6, v0, 12, s35
    s_waitcnt lgkmcnt(0)
    s_barrier
    s_cmp_lg_u32 s39, 15
    s_cbranch_scc1 L_p1_kernel_nox_11
    ds_read_b32 v12, v6 offset:9984
    ds_read_b32 v13, v6 offset:9988
    ds_read_b32 v14, v6 offset:9992
L_p1_kernel_nox_11:
    ds_read_b32 v48, v6 offset:1536
    ds_read_b32 v49, v6 offset:1540
    ds_read_b32 v50, v6 offset:1544
    ds_read_b32 v52, v6 offset:3072
    ds_read_b32 v53, v6 offset:3076
    ds_read_b32 v54, v6 offset:3080
    ds_read_b32 v56, v6 offset:4608
    ds_read_b32 v57, v6 offset:4612
    ds_read_b32 v58, v6 offset:4616
    ds_read_b32 v60, v6 offset:6144
    ds_read_b32 v61, v6 offset:6148
    ds_read_b32 v62, v6 offset:6152
    ds_read_b32 v64, v6 offset:7680
    ds_read_b32 v65, v6 offset:7684
    ds_read_b32 v66, v6 offset:7688
    ds_read_b32 v68, v6 offset:9216
    ds_read_b32 v69, v6 offset:9220
    ds_read_b32 v70, v6 offset:9224
    ds_read_b32 v72, v6 offset:0
    ds_read_b32 v73, v6 offset:4
    ds_read_b32 v74, v6 offset:8
    ds_read_b32 v76, v6 offset:768
    ds_read_b32 v77, v6 offset:772
    ds_read_b32 v78, v6 offset:776
    ds_read_b32 v80, v6 offset:2304
    ds_read_b32 v81, v6 offset:2308
    ds_read_b32 v82, v6 offset:2312
    ds_read_b32 v84, v6 offset:3840
    ds_read_b32 v85, v6 offset:3844
    ds_read_b32 v86, v6 offset:3848
    ds_read_b32 v88, v6 offset:5376
    ds_read_b32 v89, v6 offset:5380
    ds_read_b32 v90, v6 offset:5384
    ds_read_b32 v92, v6 offset:6912
    ds_read_b32 v93, v6 offset:6916
    ds_read_b32 v94, v6 offset:6920
    ds_read_b32 v96, v6 offset:8448
    ds_read_b32 v97, v6 offset:8452
    ds_read_b32 v98, v6 offset:8456
    s_add_u32 s35, s33, 49348608
    buffer_load_dwordx4 v[32:35], v1, s[8:11], s35 offen nt
    v_mov_b32 v8, 0
    v_mov_b32 v9, 0
    v_mov_b32 v10, 0
    v_mov_b32 v11, 0
    v_mov_b32 v15, 16384
    s_waitcnt lgkmcnt(0)
    s_barrier
    ds_write_b128 v1, v[8:11] offset:0
    s_nop 1
    v_mad_u32_u16 v6, v51, s50, v15 op_sel:[0,0,0,0]
    v_mad_u32_u16 v7, v51, s50, v15 op_sel:[1,0,0,0]
    v_mad_u32_u16 v8, v55, s50, v15 op_sel:[0,0,0,0]
    v_mad_u32_u16 v9, v55, s50, v15 op_sel:[1,0,0,0]
    v_add_u32_sdwa v6, v6, v51 dst_sel:DWORD dst_unused:UNUSED_PAD src0_sel:WORD_1 src1_sel:WORD_0
    v_add_u32_sdwa v7, v7, v51 dst_sel:DWORD dst_unused:UNUSED_PAD src0_sel:WORD_1 src1_sel:WORD_1
    v_add_u32_sdwa v8, v8, v55 dst_sel:DWORD dst_unused:UNUSED_PAD src0_sel:WORD_1 src1_sel:WORD_0
    v_add_u32_sdwa v9, v9, v55 dst_sel:DWORD dst_unused:UNUSED_PAD src0_sel:WORD_1 src1_sel:WORD_1
    v_add_u32 v6, v6, v6
    v_add_u32 v7, v7, v7
    v_add_u32 v8, v8, v8
    v_add_u32 v9, v9, v9
    ds_write_b16 v6, v100 offset:16384
    ds_write_b16_d16_hi v7, v100 offset:16384
    ds_write_b16 v8, v101 offset:16384
    ds_write_b16_d16_hi v9, v101 offset:16384
    v_mov_b32 v6, 1140817920
    s_waitcnt vmcnt(7)
    v_lshlrev_b32 v10, 16, v114
    v_lshlrev_b32 v11, 16, v115
    v_and_b32 v114, 0xffff0000, v114
    v_and_b32 v115, 0xffff0000, v115
    v_mul_f32 v10, s41, v10
    v_mul_f32 v114, s41, v114
    v_mul_f32 v11, s41, v11
    v_mul_f32 v115, s41, v115
    v_fract_f32 v10, v10
    v_fract_f32 v114, v114
    v_fract_f32 v11, v11
    v_fract_f32 v115, v115
    v_cos_f32 v10, v10
    v_cos_f32 v114, v114
    v_cos_f32 v11, v11
    v_cos_f32 v115, v115
    v_fmaak_f32 v10, v6, v10, 1262486016
    v_fmaak_f32 v114, v6, v114, 1262486016
    v_fmaak_f32 v11, v6, v11, 1262486016
    v_fmaak_f32 v115, v6, v115, 1262486016
    v_or3_b32 v5, v10, v114, v5
    v_or3_b32 v5, v11, v115, v5
    v_perm_b32 v114, v114, v10, s43
    v_perm_b32 v115, v115, v11, s43
    v_mad_u32_u16 v6, v59, s50, v15 op_sel:[0,0,0,0]
    v_mad_u32_u16 v7, v59, s50, v15 op_sel:[1,0,0,0]
    v_mad_u32_u16 v8, v63, s50, v15 op_sel:[0,0,0,0]
    v_mad_u32_u16 v9, v63, s50, v15 op_sel:[1,0,0,0]
    v_add_u32_sdwa v6, v6, v59 dst_sel:DWORD dst_unused:UNUSED_PAD src0_sel:WORD_1 src1_sel:WORD_0
    v_add_u32_sdwa v7, v7, v59 dst_sel:DWORD dst_unused:UNUSED_PAD src0_sel:WORD_1 src1_sel:WORD_1
    v_add_u32_sdwa v8, v8, v63 dst_sel:DWORD dst_unused:UNUSED_PAD src0_sel:WORD_1 src1_sel:WORD_0
    v_add_u32_sdwa v9, v9, v63 dst_sel:DWORD dst_unused:UNUSED_PAD src0_sel:WORD_1 src1_sel:WORD_1
    v_add_u32 v6, v6, v6
    v_add_u32 v7, v7, v7
    v_add_u32 v8, v8, v8
    v_add_u32 v9, v9, v9
    ds_write_b16 v6, v102 offset:16384
    ds_write_b16_d16_hi v7, v102 offset:16384
    ds_write_b16 v8, v103 offset:16384
    ds_write_b16_d16_hi v9, v103 offset:16384
    v_mad_u32_u16 v6, v67, s50, v15 op_sel:[0,0,0,0]
    v_mad_u32_u16 v7, v67, s50, v15 op_sel:[1,0,0,0]
    v_mad_u32_u16 v8, v71, s50, v15 op_sel:[0,0,0,0]
    v_mad_u32_u16 v9, v71, s50, v15 op_sel:[1,0,0,0]
    v_add_u32_sdwa v6, v6, v67 dst_sel:DWORD dst_unused:UNUSED_PAD src0_sel:WORD_1 src1_sel:WORD_0
    v_add_u32_sdwa v7, v7, v67 dst_sel:DWORD dst_unused:UNUSED_PAD src0_sel:WORD_1 src1_sel:WORD_1
    v_add_u32_sdwa v8, v8, v71 dst_sel:DWORD dst_unused:UNUSED_PAD src0_sel:WORD_1 src1_sel:WORD_0
    v_add_u32_sdwa v9, v9, v71 dst_sel:DWORD dst_unused:UNUSED_PAD src0_sel:WORD_1 src1_sel:WORD_1
    v_add_u32 v6, v6, v6
    v_add_u32 v7, v7, v7
    v_add_u32 v8, v8, v8
    v_add_u32 v9, v9, v9
    ds_write_b16 v6, v104 offset:16384
    ds_write_b16_d16_hi v7, v104 offset:16384
    ds_write_b16 v8, v105 offset:16384
    ds_write_b16_d16_hi v9, v105 offset:16384
    s_add_u32 s35, s33, 49348608
    buffer_load_dwordx4 v[36:39], v1, s[12:15], s35 offen nt
    v_mad_u32_u16 v6, v120, s50, v15 op_sel:[0,0,0,0]
    v_mad_u32_u16 v7, v120, s50, v15 op_sel:[1,0,0,0]
    v_mad_u32_u16 v8, v121, s50, v15 op_sel:[0,0,0,0]
    v_mad_u32_u16 v9, v121, s50, v15 op_sel:[1,0,0,0]
    v_add_u32_sdwa v6, v6, v120 dst_sel:DWORD dst_unused:UNUSED_PAD src0_sel:WORD_1 src1_sel:WORD_0
    v_add_u32_sdwa v7, v7, v120 dst_sel:DWORD dst_unused:UNUSED_PAD src0_sel:WORD_1 src1_sel:WORD_1
    v_add_u32_sdwa v8, v8, v121 dst_sel:DWORD dst_unused:UNUSED_PAD src0_sel:WORD_1 src1_sel:WORD_0
    v_add_u32_sdwa v9, v9, v121 dst_sel:DWORD dst_unused:UNUSED_PAD src0_sel:WORD_1 src1_sel:WORD_1
    v_add_u32 v6, v6, v6
    v_add_u32 v7, v7, v7
    v_add_u32 v8, v8, v8
    v_add_u32 v9, v9, v9
    ds_write_b16 v6, v106 offset:16384
    ds_write_b16_d16_hi v7, v106 offset:16384
    ds_write_b16 v8, v107 offset:16384
    ds_write_b16_d16_hi v9, v107 offset:16384
    v_mov_b32 v6, 1140817920
    s_waitcnt vmcnt(7)
    v_lshlrev_b32 v10, 16, v116
    v_lshlrev_b32 v11, 16, v117
    v_and_b32 v116, 0xffff0000, v116
    v_and_b32 v117, 0xffff0000, v117
    v_mul_f32 v10, s41, v10
    v_mul_f32 v116, s41, v116
    v_mul_f32 v11, s41, v11
    v_mul_f32 v117, s41, v117
    v_fract_f32 v10, v10
    v_fract_f32 v116, v116
    v_fract_f32 v11, v11
    v_fract_f32 v117, v117
    v_cos_f32 v10, v10
    v_cos_f32 v116, v116
    v_cos_f32 v11, v11
    v_cos_f32 v117, v117
    v_fmaak_f32 v10, v6, v10, 1262486016
    v_fmaak_f32 v116, v6, v116, 1262486016
    v_fmaak_f32 v11, v6, v11, 1262486016
    v_fmaak_f32 v117, v6, v117, 1262486016
    v_or3_b32 v5, v10, v116, v5
    v_or3_b32 v5, v11, v117, v5
    v_perm_b32 v116, v116, v10, s43
    v_perm_b32 v117, v117, v11, s43
    v_mad_u32_u16 v6, v122, s50, v15 op_sel:[0,0,0,0]
    v_mad_u32_u16 v7, v122, s50, v15 op_sel:[1,0,0,0]
    v_mad_u32_u16 v8, v123, s50, v15 op_sel:[0,0,0,0]
    v_mad_u32_u16 v9, v123, s50, v15 op_sel:[1,0,0,0]
    v_add_u32_sdwa v6, v6, v122 dst_sel:DWORD dst_unused:UNUSED_PAD src0_sel:WORD_1 src1_sel:WORD_0
    v_add_u32_sdwa v7, v7, v122 dst_sel:DWORD dst_unused:UNUSED_PAD src0_sel:WORD_1 src1_sel:WORD_1
    v_add_u32_sdwa v8, v8, v123 dst_sel:DWORD dst_unused:UNUSED_PAD src0_sel:WORD_1 src1_sel:WORD_0
    v_add_u32_sdwa v9, v9, v123 dst_sel:DWORD dst_unused:UNUSED_PAD src0_sel:WORD_1 src1_sel:WORD_1
    v_add_u32 v6, v6, v6
    v_add_u32 v7, v7, v7
    v_add_u32 v8, v8, v8
    v_add_u32 v9, v9, v9
    ds_write_b16 v6, v108 offset:16384
    ds_write_b16_d16_hi v7, v108 offset:16384
    ds_write_b16 v8, v109 offset:16384
    ds_write_b16_d16_hi v9, v109 offset:16384
    v_mad_u32_u16 v6, v124, s50, v15 op_sel:[0,0,0,0]
    v_mad_u32_u16 v7, v124, s50, v15 op_sel:[1,0,0,0]
    v_mad_u32_u16 v8, v125, s50, v15 op_sel:[0,0,0,0]
    v_mad_u32_u16 v9, v125, s50, v15 op_sel:[1,0,0,0]
    v_add_u32_sdwa v6, v6, v124 dst_sel:DWORD dst_unused:UNUSED_PAD src0_sel:WORD_1 src1_sel:WORD_0
    v_add_u32_sdwa v7, v7, v124 dst_sel:DWORD dst_unused:UNUSED_PAD src0_sel:WORD_1 src1_sel:WORD_1
    v_add_u32_sdwa v8, v8, v125 dst_sel:DWORD dst_unused:UNUSED_PAD src0_sel:WORD_1 src1_sel:WORD_0
    v_add_u32_sdwa v9, v9, v125 dst_sel:DWORD dst_unused:UNUSED_PAD src0_sel:WORD_1 src1_sel:WORD_1
    v_add_u32 v6, v6, v6
    v_add_u32 v7, v7, v7
    v_add_u32 v8, v8, v8
    v_add_u32 v9, v9, v9
    ds_write_b16 v6, v110 offset:16384
    ds_write_b16_d16_hi v7, v110 offset:16384
    ds_write_b16 v8, v111 offset:16384
    ds_write_b16_d16_hi v9, v111 offset:16384
    s_add_u32 s35, s33, 53542912
    buffer_load_dwordx4 v[40:43], v1, s[8:11], s35 offen nt
    v_mad_u32_u16 v6, v126, s50, v15 op_sel:[0,0,0,0]
    v_mad_u32_u16 v7, v126, s50, v15 op_sel:[1,0,0,0]
    v_mad_u32_u16 v8, v75, s50, v15 op_sel:[0,0,0,0]
    v_mad_u32_u16 v9, v75, s50, v15 op_sel:[1,0,0,0]
    v_add_u32_sdwa v6, v6, v126 dst_sel:DWORD dst_unused:UNUSED_PAD src0_sel:WORD_1 src1_sel:WORD_0
    v_add_u32_sdwa v7, v7, v126 dst_sel:DWORD dst_unused:UNUSED_PAD src0_sel:WORD_1 src1_sel:WORD_1
    v_add_u32_sdwa v8, v8, v75 dst_sel:DWORD dst_unused:UNUSED_PAD src0_sel:WORD_1 src1_sel:WORD_0
    v_add_u32_sdwa v9, v9, v75 dst_sel:DWORD dst_unused:UNUSED_PAD src0_sel:WORD_1 src1_sel:WORD_1
    v_add_u32 v6, v6, v6
    v_add_u32 v7, v7, v7
    v_add_u32 v8, v8, v8
    v_add_u32 v9, v9, v9
    ds_write_b16 v6, v112 offset:16384
    ds_write_b16_d16_hi v7, v112 offset:16384
    ds_write_b16 v8, v113 offset:16384
    ds_write_b16_d16_hi v9, v113 offset:16384
    v_mov_b32 v6, 1140817920
    s_mov_b64 exec, s[44:45]
    s_waitcnt vmcnt(7)
    v_lshlrev_b32 v10, 16, v118
    v_lshlrev_b32 v11, 16, v119
    v_and_b32 v118, 0xffff0000, v118
    v_and_b32 v119, 0xffff0000, v119
    v_mul_f32 v10, s41, v10
    v_mul_f32 v118, s41, v118
    v_mul_f32 v11, s41, v11
    v_mul_f32 v119, s41, v119
    v_fract_f32 v10, v10
    v_fract_f32 v118, v118
    v_fract_f32 v11, v11
    v_fract_f32 v119, v119
    v_cos_f32 v10, v10
    v_cos_f32 v118, v118
    v_cos_f32 v11, v11
    v_cos_f32 v119, v119
    v_fmaak_f32 v10, v6, v10, 1262486016
    v_fmaak_f32 v118, v6, v118, 1262486016
    v_fmaak_f32 v11, v6, v11, 1262486016
    v_fmaak_f32 v119, v6, v119, 1262486016
    v_or3_b32 v5, v10, v118, v5
    v_or3_b32 v5, v11, v119, v5
    v_perm_b32 v118, v118, v10, s43
    v_perm_b32 v119, v119, v11, s43
    s_mov_b64 exec, -1
    v_mad_u32_u16 v6, v79, s50, v15 op_sel:[0,0,0,0]
    v_mad_u32_u16 v7, v79, s50, v15 op_sel:[1,0,0,0]
    v_mad_u32_u16 v8, v83, s50, v15 op_sel:[0,0,0,0]
    v_mad_u32_u16 v9, v83, s50, v15 op_sel:[1,0,0,0]
    v_add_u32_sdwa v6, v6, v79 dst_sel:DWORD dst_unused:UNUSED_PAD src0_sel:WORD_1 src1_sel:WORD_0
    v_add_u32_sdwa v7, v7, v79 dst_sel:DWORD dst_unused:UNUSED_PAD src0_sel:WORD_1 src1_sel:WORD_1
    v_add_u32_sdwa v8, v8, v83 dst_sel:DWORD dst_unused:UNUSED_PAD src0_sel:WORD_1 src1_sel:WORD_0
    v_add_u32_sdwa v9, v9, v83 dst_sel:DWORD dst_unused:UNUSED_PAD src0_sel:WORD_1 src1_sel:WORD_1
    v_add_u32 v6, v6, v6
    v_add_u32 v7, v7, v7
    v_add_u32 v8, v8, v8
    v_add_u32 v9, v9, v9
    ds_write_b16 v6, v114 offset:16384
    ds_write_b16_d16_hi v7, v114 offset:16384
    ds_write_b16 v8, v115 offset:16384
    ds_write_b16_d16_hi v9, v115 offset:16384
    v_mad_u32_u16 v6, v87, s50, v15 op_sel:[0,0,0,0]
    v_mad_u32_u16 v7, v87, s50, v15 op_sel:[1,0,0,0]
    v_mad_u32_u16 v8, v91, s50, v15 op_sel:[0,0,0,0]
    v_mad_u32_u16 v9, v91, s50, v15 op_sel:[1,0,0,0]
    v_add_u32_sdwa v6, v6, v87 dst_sel:DWORD dst_unused:UNUSED_PAD src0_sel:WORD_1 src1_sel:WORD_0
    v_add_u32_sdwa v7, v7, v87 dst_sel:DWORD dst_unused:UNUSED_PAD src0_sel:WORD_1 src1_sel:WORD_1
    v_add_u32_sdwa v8, v8, v91 dst_sel:DWORD dst_unused:UNUSED_PAD src0_sel:WORD_1 src1_sel:WORD_0
    v_add_u32_sdwa v9, v9, v91 dst_sel:DWORD dst_unused:UNUSED_PAD src0_sel:WORD_1 src1_sel:WORD_1
    v_add_u32 v6, v6, v6
    v_add_u32 v7, v7, v7
    v_add_u32 v8, v8, v8
    v_add_u32 v9, v9, v9
    ds_write_b16 v6, v116 offset:16384
    ds_write_b16_d16_hi v7, v116 offset:16384
    ds_write_b16 v8, v117 offset:16384
    ds_write_b16_d16_hi v9, v117 offset:16384
    s_add_u32 s35, s33, 53542912
    buffer_load_dwordx4 v[44:47], v1, s[12:15], s35 offen nt
    s_mov_b64 exec, s[44:45]
    v_mad_u32_u16 v6, v95, s50, v15 op_sel:[0,0,0,0]
    v_mad_u32_u16 v7, v95, s50, v15 op_sel:[1,0,0,0]
    v_mad_u32_u16 v8, v99, s50, v15 op_sel:[0,0,0,0]
    v_mad_u32_u16 v9, v99, s50, v15 op_sel:[1,0,0,0]
    v_add_u32_sdwa v6, v6, v95 dst_sel:DWORD dst_unused:UNUSED_PAD src0_sel:WORD_1 src1_sel:WORD_0
    v_add_u32_sdwa v7, v7, v95 dst_sel:DWORD dst_unused:UNUSED_PAD src0_sel:WORD_1 src1_sel:WORD_1
    v_add_u32_sdwa v8, v8, v99 dst_sel:DWORD dst_unused:UNUSED_PAD src0_sel:WORD_1 src1_sel:WORD_0
    v_add_u32_sdwa v9, v9, v99 dst_sel:DWORD dst_unused:UNUSED_PAD src0_sel:WORD_1 src1_sel:WORD_1
    v_add_u32 v6, v6, v6
    v_add_u32 v7, v7, v7
    v_add_u32 v8, v8, v8
    v_add_u32 v9, v9, v9
    ds_write_b16 v6, v118 offset:16384
    ds_write_b16_d16_hi v7, v118 offset:16384
    ds_write_b16 v8, v119 offset:16384
    ds_write_b16_d16_hi v9, v119 offset:16384
    s_mov_b64 exec, -1
    s_mul_i32 s35, s39, 6144
    v_add_u32 v6, s35, v2
    s_waitcnt lgkmcnt(0)
    s_barrier
    ds_read_b64 v[100:101], v6 offset:23040
    ds_read_b64 v[102:103], v6 offset:16384
    ds_read_b64 v[104:105], v6 offset:16896
    ds_read_b64 v[106:107], v6 offset:17408
    ds_read_b64 v[108:109], v6 offset:17920
    ds_read_b64 v[110:111], v6 offset:18432
    ds_read_b64 v[112:113], v6 offset:18944
    ds_read_b64 v[114:115], v6 offset:19456
    ds_read_b64 v[116:117], v6 offset:19968
    ds_read_b64 v[118:119], v6 offset:20480
    ds_read_b64 v[120:121], v6 offset:20992
    ds_read_b64 v[122:123], v6 offset:21504
    ds_read_b64 v[124:125], v6 offset:22016
    ds_read_b64 v[126:127], v6 offset:22528
    s_add_u32 s32, s32, 256
    s_add_u32 s33, s33, 40960000
    s_add_u32 s34, s34, 20480000
    s_add_u32 s40, s40, 1
    s_cmp_lt_u32 s40, 4
    s_cbranch_scc1 L_p1_loop
    s_waitcnt lgkmcnt(13)
    v_lshlrev_b32 v15, 22, v100
    v_lshrrev_b32 v100, 16, v100
    v_alignbit_b32 v15, v100, v15, 10
    v_alignbit_b32 v15, v101, v15, 10
    v_xor_b32 v15, 0x80200800, v15
    s_cmp_lg_u32 s39, 15
    s_cbranch_scc1 L_p1_kernel_nox_12
    s_mov_b32 s36, 13631488
    buffer_store_dwordx4 v[12:15], v3, s[20:23], s36 offen sc1
L_p1_kernel_nox_12:
    s_waitcnt lgkmcnt(12)
    v_lshlrev_b32 v75, 22, v102
    v_lshrrev_b32 v102, 16, v102
    v_alignbit_b32 v75, v102, v75, 10
    v_alignbit_b32 v75, v103, v75, 10
    v_xor_b32 v75, 0x80200800, v75
    s_mov_b32 s36, 0
    buffer_store_dwordx4 v[72:75], v3, s[20:23], s36 offen sc1
    s_waitcnt lgkmcnt(11)
    v_lshlrev_b32 v79, 22, v104
    v_lshrrev_b32 v104, 16, v104
    v_alignbit_b32 v79, v104, v79, 10
    v_alignbit_b32 v79, v105, v79, 10
    v_xor_b32 v79, 0x80200800, v79
    s_mov_b32 s36, 1048576
    buffer_store_dwordx4 v[76:79], v3, s[20:23], s36 offen sc1
    s_waitcnt lgkmcnt(10)
    v_lshlrev_b32 v51, 22, v106
    v_lshrrev_b32 v106, 16, v106
    v_alignbit_b32 v51, v106, v51, 10
    v_alignbit_b32 v51, v107, v51, 10
    v_xor_b32 v51, 0x80200800, v51
    s_mov_b32 s36, 2097152
    buffer_store_dwordx4 v[48:51], v3, s[20:23], s36 offen sc1
    s_waitcnt lgkmcnt(9)
    v_lshlrev_b32 v83, 22, v108
    v_lshrrev_b32 v108, 16, v108
    v_alignbit_b32 v83, v108, v83, 10
    v_alignbit_b32 v83, v109, v83, 10
    v_xor_b32 v83, 0x80200800, v83
    s_mov_b32 s36, 3145728
    buffer_store_dwordx4 v[80:83], v3, s[20:23], s36 offen sc1
    s_waitcnt lgkmcnt(8)
    v_lshlrev_b32 v55, 22, v110
    v_lshrrev_b32 v110, 16, v110
    v_alignbit_b32 v55, v110, v55, 10
    v_alignbit_b32 v55, v111, v55, 10
    v_xor_b32 v55, 0x80200800, v55
    s_mov_b32 s36, 4194304
    buffer_store_dwordx4 v[52:55], v3, s[20:23], s36 offen sc1
    s_waitcnt lgkmcnt(7)
    v_lshlrev_b32 v87, 22, v112
    v_lshrrev_b32 v112, 16, v112
    v_alignbit_b32 v87, v112, v87, 10
    v_alignbit_b32 v87, v113, v87, 10
    v_xor_b32 v87, 0x80200800, v87
    s_mov_b32 s36, 5242880
    buffer_store_dwordx4 v[84:87], v3, s[20:23], s36 offen sc1
    s_waitcnt lgkmcnt(6)
    v_lshlrev_b32 v59, 22, v114
    v_lshrrev_b32 v114, 16, v114
    v_alignbit_b32 v59, v114, v59, 10
    v_alignbit_b32 v59, v115, v59, 10
    v_xor_b32 v59, 0x80200800, v59
    s_mov_b32 s36, 6291456
    buffer_store_dwordx4 v[56:59], v3, s[20:23], s36 offen sc1
    s_waitcnt lgkmcnt(5)
    v_lshlrev_b32 v91, 22, v116
    v_lshrrev_b32 v116, 16, v116
    v_alignbit_b32 v91, v116, v91, 10
    v_alignbit_b32 v91, v117, v91, 10
    v_xor_b32 v91, 0x80200800, v91
    s_mov_b32 s36, 7340032
    buffer_store_dwordx4 v[88:91], v3, s[20:23], s36 offen sc1
    s_waitcnt lgkmcnt(4)
    v_lshlrev_b32 v63, 22, v118
    v_lshrrev_b32 v118, 16, v118
    v_alignbit_b32 v63, v118, v63, 10
    v_alignbit_b32 v63, v119, v63, 10
    v_xor_b32 v63, 0x80200800, v63
    s_mov_b32 s36, 8388608
    buffer_store_dwordx4 v[60:63], v3, s[20:23], s36 offen sc1
    s_waitcnt lgkmcnt(3)
    v_lshlrev_b32 v95, 22, v120
    v_lshrrev_b32 v120, 16, v120
    v_alignbit_b32 v95, v120, v95, 10
    v_alignbit_b32 v95, v121, v95, 10
    v_xor_b32 v95, 0x80200800, v95
    s_mov_b32 s36, 9437184
    buffer_store_dwordx4 v[92:95], v3, s[20:23], s36 offen sc1
    s_waitcnt lgkmcnt(2)
    v_lshlrev_b32 v67, 22, v122
    v_lshrrev_b32 v122, 16, v122
    v_alignbit_b32 v67, v122, v67, 10
    v_alignbit_b32 v67, v123, v67, 10
    v_xor_b32 v67, 0x80200800, v67
    s_mov_b32 s36, 10485760
    buffer_store_dwordx4 v[64:67], v3, s[20:23], s36 offen sc1
    s_waitcnt lgkmcnt(1)
    v_lshlrev_b32 v99, 22, v124
    v_lshrrev_b32 v124, 16, v124
    v_alignbit_b32 v99, v124, v99, 10
    v_alignbit_b32 v99, v125, v99, 10
    v_xor_b32 v99, 0x80200800, v99
    s_mov_b32 s36, 11534336
    buffer_store_dwordx4 v[96:99], v3, s[20:23], s36 offen sc1
    s_waitcnt lgkmcnt(0)
    v_lshlrev_b32 v71, 22, v126
    v_lshrrev_b32 v126, 16, v126
    v_alignbit_b32 v71, v126, v71, 10
    v_alignbit_b32 v71, v127, v71, 10
    v_xor_b32 v71, 0x80200800, v71
    s_mov_b32 s36, 12582912
    buffer_store_dwordx4 v[68:71], v3, s[20:23], s36 offen sc1
    v_and_b32 v6, 0x34800000, v5
    v_cmp_ne_u32 vcc, 0, v6
    s_lshl_b32 s35, s39, 4
    s_add_u32 s35, s35, 160328
    v_mov_b32 v10, s35
    s_cmp_lg_u64 vcc, 0
    s_cselect_b32 s36, 1, s55
    v_mov_b32 v11, s36
    ds_write_b32 v10, v11
    s_waitcnt lgkmcnt(0)
    s_barrier
    s_cmp_lg_u32 s39, 0
    s_cbranch_scc1 L_p1_end
    v_and_b32 v6, 15, v0
    v_lshlrev_b32 v6, 4, v6
    v_add_u32 v6, 160320, v6
    ds_read_b128 v[8:11], v6
    s_waitcnt lgkmcnt(0)
    s_nop 1
    v_max_u32_dpp v8, v8, v8 row_shr:1 row_mask:0xf bank_mask:0xf bound_ctrl:0
    s_nop 1
    v_max_u32_dpp v8, v8, v8 row_shr:2 row_mask:0xf bank_mask:0xf bound_ctrl:0
    s_nop 1
    v_max_u32_dpp v8, v8, v8 row_shr:4 row_mask:0xf bank_mask:0xf bound_ctrl:0
    s_nop 1
    v_max_u32_dpp v8, v8, v8 row_shr:8 row_mask:0xf bank_mask:0xf bound_ctrl:0
    s_nop 1
    v_add_f32_dpp v9, v9, v9 row_shr:1 row_mask:0xf bank_mask:0xf bound_ctrl:0
    s_nop 1
    v_add_f32_dpp v9, v9, v9 row_shr:2 row_mask:0xf bank_mask:0xf bound_ctrl:0
    s_nop 1
    v_add_f32_dpp v9, v9, v9 row_shr:4 row_mask:0xf bank_mask:0xf bound_ctrl:0
    s_nop 1
    v_add_f32_dpp v9, v9, v9 row_shr:8 row_mask:0xf bank_mask:0xf bound_ctrl:0
    s_nop 1
    v_or_b32_dpp v10, v10, v10 row_shr:1 row_mask:0xf bank_mask:0xf bound_ctrl:0
    s_nop 1
    v_or_b32_dpp v10, v10, v10 row_shr:2 row_mask:0xf bank_mask:0xf bound_ctrl:0
    s_nop 1
    v_or_b32_dpp v10, v10, v10 row_shr:4 row_mask:0xf bank_mask:0xf bound_ctrl:0
    s_nop 1
    v_or_b32_dpp v10, v10, v10 row_shr:8 row_mask:0xf bank_mask:0xf bound_ctrl:0
    s_lshl_b32 s35, s2, 3
    s_mov_b32 s26, 8540160
    s_add_u32 s35, s35, 8519680
    v_mov_b32 v6, 0
    v_lshl_or_b32 v8, v10, 16, v8
    s_mov_b64 exec, 0x8000
    buffer_store_dwordx2 v[8:9], v6, s[24:27], s35 offen
    s_lshl_b32 s35, s2, 8
    s_add_u32 s35, s35, 8523776
    buffer_store_dword v6, v6, s[24:27], s35 offen
L_p1_end:
    s_endpgm
.globl p2_kernel
.p2align 8
.type p2_kernel,@function
p2_kernel:
    s_cmp_ge_u32 s2, 256
    s_cbranch_scc1 L_p2_end
    s_load_dwordx2 s[4:5], s[0:1], 104
    s_load_dwordx2 s[100:101], s[0:1], 24
    s_load_dwordx2 s[8:9], s[0:1], 0
    s_load_dwordx2 s[30:31], s[0:1], 40
    s_load_dwordx4 s[32:35], s[0:1], 56
    s_load_dwordx4 s[36:39], s[0:1], 72
    s_and_b32 s14, s2, 7
    s_lshr_b32 s49, s2, 3
    s_and_b32 s3, s14, 1
    s_lshl_b32 s3, s3, 5
    s_add_u32 s3, s3, s49
    s_lshr_b32 s12, s14, 1
    v_lshrrev_b32 v108, 6, v0
    v_lshlrev_b32 v1, 4, v0
    v_and_b32 v109, 63, v0
    v_readfirstlane_b32 s13, v108
    v_lshlrev_b32 v111, 4, v109
    v_lshrrev_b32 v110, 2, v109
    v_mul_u32_u24 v110, 8256, v110
    v_add_u32 v110, v110, v111
    s_mul_i32 s14, s12, 65
    s_add_u32 s14, s14, s3
    s_lshl_b32 s14, s14, 5
    s_mul_i32 s15, s13, 532480
    s_add_u32 s14, s14, s15
    s_add_u32 s25, s14, 0
    s_mul_i32 s22, s12, 1280000
    s_mov_b32 s2, 0
    s_waitcnt lgkmcnt(0)
    s_mov_b32 s6, 655360000
    s_mov_b32 s7, 0x00020000
    s_add_u32 s10, s22, 1280000
    s_mov_b32 s11, 0x00020000
    s_add_u32 s15, s25, 0
    buffer_load_dwordx4 v[28:31], v110, s[4:7], s15 offen
    s_add_u32 s15, s25, 133120
    buffer_load_dwordx4 v[32:35], v110, s[4:7], s15 offen
    s_add_u32 s15, s25, 266240
    buffer_load_dwordx4 v[36:39], v110, s[4:7], s15 offen
    s_add_u32 s15, s25, 399360
    buffer_load_dwordx4 v[40:43], v110, s[4:7], s15 offen
    s_load_dwordx4 s[40:43], s[30:31], 0
    s_load_dwordx16 s[52:67], s[32:33], 0
    s_load_dwordx16 s[68:83], s[34:35], 0
    s_load_dwordx8 s[84:91], s[36:37], 0
    s_load_dwordx8 s[92:99], s[38:39], 0
    v_mov_b32 v52, 0x100
    s_cmp_lg_u32 s13, 0
    s_cbranch_scc1 L_p2_noann
    s_lshl_b32 s14, s3, 8
    s_add_u32 s14, s14, 8523776
    s_mov_b64 exec, 1
    buffer_atomic_add v52, off, s[4:7], s14
    s_mov_b64 exec, -1
L_p2_noann:
    s_add_u32 s14, s22, 0
    buffer_load_dwordx4 v[88:91], v1, s[8:11], s14 offen
    s_add_u32 s14, s22, 16384
    buffer_load_dwordx4 v[92:95], v1, s[8:11], s14 offen
    s_add_u32 s14, s22, 32768
    buffer_load_dwordx4 v[96:99], v1, s[8:11], s14 offen
    s_add_u32 s14, s22, 49152
    buffer_load_dwordx4 v[100:103], v1, s[8:11], s14 offen
    s_add_u32 s14, s22, 65536
    buffer_load_dwordx4 v[104:107], v1, s[8:11], s14 offen
    s_mov_b32 s15, 8519680
    buffer_load_dwordx4 v[80:83], v111, s[4:7], s15 offen offset:0
    buffer_load_dwordx4 v[84:87], v111, s[4:7], s15 offen offset:1024
    v_lshlrev_b32 v2, 10, v109
    v_mov_b32 v50, 21845
    v_add_u32 v3, 80000, v1
    v_add_u32 v124, 145536, v1
    v_add_u32 v113, 65536, v1
    v_mov_b32 v112, 0x7f000000
    v_cmp_gt_u32 vcc, 904, v0
    s_mul_i32 s19, s13, 240
    s_add_u32 s19, s19, 160000
    v_cndmask_b32 v124, v112, v124, vcc
    v_cndmask_b32 v113, v112, v113, vcc
    v_lshl_add_u32 v6, v109, 2, s19
    v_lshl_add_u32 v126, v109, 1, s19
    v_cmp_gt_u32 vcc, 10, v109
    s_lshl_b32 s27, s13, 16
    s_mov_b32 s23, 1024
    v_cndmask_b32 v6, v112, v6, vcc
    s_add_u32 s44, s4, 4194304
    s_addc_u32 s45, s5, 1048576
    s_mov_b32 s46, 14024704
    s_mov_b32 s47, 0x00020000
    s_mov_b32 s18, 80000
    s_and_b32 s50, s3, 1
    s_lshl_b32 s50, s50, 18
    s_sub_u32 s18, s18, s50
    s_sub_u32 s50, 4294836224, s50
    v_lshlrev_b32 v116, 3, v0
    v_and_b32 v116, 16, v116
    v_and_b32 v117, 1, v0
    v_lshl_or_b32 v116, v117, 5, v116
    v_mov_b32 v58, 0x3f80
    v_mov_b32 v59, 0
    v_lshlrev_b64 v[58:59], v116, v[58:59]
    v_mov_b32 v4, 0
    v_mov_b32 v5, 0
    v_mov_b32 v114, 0xff00
    ds_write_b32 v6, v5 offset:160
    ds_write_b16 v126, v114 offset:2
    v_mov_b32 v44, 1073758208
    v_mov_b32 v45, 1073758208
    v_mov_b32 v46, 1073758208
    v_mov_b32 v47, 1073758208
    v_mov_b32 v48, 1073758208
    v_mov_b32 v49, 1073758208
    ds_write_b128 v113, v[44:47]
    v_lshrrev_b32 v115, 4, v109
    v_mul_u32_u24 v115, 15360, v115
    v_lshl_add_u32 v115, v109, 6, v115
    v_lshl_add_u32 v115, v108, 10, v115
    s_waitcnt lgkmcnt(0)
    v_mov_b32 v53, s40
    v_mov_b32 v54, s41
    v_mov_b32 v56, s42
    v_mov_b32 v57, s43
    s_mov_b32 s40, 20987904
    s_mov_b32 s41, 21031594
    s_pack_ll_b32_b16 s14, s52, s54
    s_pack_hh_b32_b16 s15, s52, s54
    s_pack_ll_b32_b16 s54, s53, s55
    s_pack_hh_b32_b16 s55, s53, s55
    s_mov_b32 s52, s14
    s_mov_b32 s53, s15
    s_pack_ll_b32_b16 s14, s56, s58
    s_pack_hh_b32_b16 s15, s56, s58
    s_pack_ll_b32_b16 s58, s57, s59
    s_pack_hh_b32_b16 s59, s57, s59
    s_mov_b32 s56, s14
    s_mov_b32 s57, s15
    s_pack_ll_b32_b16 s14, s60, s62
    s_pack_hh_b32_b16 s15, s60, s62
    s_pack_ll_b32_b16 s62, s61, s63
    s_pack_hh_b32_b16 s63, s61, s63
    s_mov_b32 s60, s14
    s_mov_b32 s61, s15
    s_pack_ll_b32_b16 s14, s64, s66
    s_pack_hh_b32_b16 s15, s64, s66
    s_pack_ll_b32_b16 s66, s65, s67
    s_pack_hh_b32_b16 s67, s65, s67
    s_mov_b32 s64, s14
    s_mov_b32 s65, s15
    s_pack_ll_b32_b16 s14, s68, s70
    s_pack_hh_b32_b16 s15, s68, s70
    s_pack_ll_b32_b16 s70, s69, s71
    s_pack_hh_b32_b16 s71, s69, s71
    s_mov_b32 s68, s14
    s_mov_b32 s69, s15
    s_pack_ll_b32_b16 s14, s72, s74
    s_pack_hh_b32_b16 s15, s72, s74
    s_pack_ll_b32_b16 s74, s73, s75
    s_pack_hh_b32_b16 s75, s73, s75
    s_mov_b32 s72, s14
    s_mov_b32 s73, s15
    s_pack_ll_b32_b16 s14, s76, s78
    s_pack_hh_b32_b16 s15, s76, s78
    s_pack_ll_b32_b16 s78, s77, s79
    s_pack_hh_b32_b16 s79, s77, s79
    s_mov_b32 s76, s14
    s_mov_b32 s77, s15
    s_pack_ll_b32_b16 s14, s80, s82
    s_pack_hh_b32_b16 s15, s80, s82
    s_pack_ll_b32_b16 s82, s81, s83
    s_pack_hh_b32_b16 s83, s81, s83
    s_mov_b32 s80, s14
    s_mov_b32 s81, s15
    s_waitcnt vmcnt(10)
    ds_write_b128 v1, v[28:31] offset:0
    s_waitcnt vmcnt(9)
    ds_write_b128 v1, v[32:35] offset:16384
    s_waitcnt vmcnt(8)
    ds_write_b128 v1, v[36:39] offset:32768
    s_waitcnt vmcnt(7)
    ds_write_b128 v1, v[40:43] offset:49152
    ds_read_b128 v[28:31], v115 offset:0
    ds_read_b128 v[36:39], v115 offset:32
    ds_read_b128 v[32:35], v115 offset:16
    ds_read_b128 v[40:43], v115 offset:48
    ds_write_b128 v1, v[44:47] offset:0
    ds_write_b128 v1, v[44:47] offset:16384
    ds_write_b128 v1, v[44:47] offset:32768
    ds_write_b128 v1, v[44:47] offset:49152
    s_waitcnt lgkmcnt(6)
    v_mad_u32_u16 v108, v28, v50, s40 op_sel:[0,0,0,0]
    v_mad_u32_u16 v109, v36, v50, s41 op_sel:[0,0,0,0]
    v_sub_u32_sdwa v110, v109, v108 dst_sel:DWORD dst_unused:UNUSED_PAD src0_sel:WORD_1 src1_sel:WORD_1
    s_nop 1
    v_add_u32_dpp v110, v110, v110 row_shr:1 row_mask:0xf bank_mask:0xf bound_ctrl:0
    s_nop 1
    v_add_u32_dpp v110, v110, v110 row_shr:2 row_mask:0xf bank_mask:0xf bound_ctrl:0
    s_nop 1
    v_add_u32_dpp v110, v110, v110 row_shr:4 row_mask:0xf bank_mask:0xf bound_ctrl:0
    s_nop 1
    v_add_u32_dpp v110, v110, v110 row_shr:8 row_mask:0xf bank_mask:0xf bound_ctrl:0
    s_nop 1
    v_add_u32_dpp v110, v110, v110 row_bcast:15 row_mask:0xa bank_mask:0xf
    s_nop 1
    v_add_u32_dpp v110, v110, v110 row_bcast:31 row_mask:0xc bank_mask:0xf
    v_sub_u32_sdwa v109, v109, v110 dst_sel:DWORD dst_unused:UNUSED_PAD src0_sel:WORD_1 src1_sel:DWORD
    v_readlane_b32 s29, v110, 63
    v_add_u32 v110, -1, v110
    ds_write_b16 v126, v109
    v_lshlrev_b32_e64 v111, v110, 1
    v_lshrrev_b32 v110, 5, v110
    v_lshl_add_u32 v110, v110, 2, s19
    s_cmp_gt_u32 s29, 320
    s_cselect_b32 s2, 1, s2
    s_cselect_b64 exec, 0, -1
    ds_or_b32 v110, v111 offset:160
    s_mov_b64 exec, -1
    ds_wrxchg_rtn_b32 v7, v6, v5 offset:160
    s_waitcnt lgkmcnt(0)
    v_readlane_b32 s30, v7, 0
    v_readlane_b32 s31, v7, 1
    v_readlane_b32 s32, v7, 2
    v_readlane_b32 s33, v7, 3
    v_readlane_b32 s34, v7, 4
    v_readlane_b32 s35, v7, 5
    v_readlane_b32 s36, v7, 6
    v_readlane_b32 s37, v7, 7
    s_mov_b32 s25, s19
    s_mov_b32 s26, s27
    s_mov_b32 s51, s28
    s_mov_b32 s28, s29
    v_mbcnt_lo_u32_b32 v8, s30, 0
    v_mbcnt_hi_u32_b32 v8, s31, v8
    s_bcnt1_i32_b64 s14, s[30:31]
    v_lshl_add_u32 v9, v8, 1, s25
    ds_read_u16 v9, v9
    s_add_u32 s30, s26, 0
    s_lshl1_add_u32 s25, s14, s25
    s_lshl_b32 s14, s14, 10
    s_add_u32 s26, s26, s14
    v_mbcnt_lo_u32_b32 v12, s32, 0
    v_mbcnt_hi_u32_b32 v12, s33, v12
    s_bcnt1_i32_b64 s14, s[32:33]
    v_lshl_add_u32 v13, v12, 1, s25
    ds_read_u16 v13, v13
    s_add_u32 s32, s26, 1048576
    s_lshl1_add_u32 s25, s14, s25
    s_lshl_b32 s14, s14, 10
    s_add_u32 s26, s26, s14
    v_mbcnt_lo_u32_b32 v16, s34, 0
    v_mbcnt_hi_u32_b32 v16, s35, v16
    s_bcnt1_i32_b64 s14, s[34:35]
    v_lshl_add_u32 v17, v16, 1, s25
    ds_read_u16 v17, v17
    s_add_u32 s34, s26, 2097152
    s_lshl1_add_u32 s25, s14, s25
    s_lshl_b32 s14, s14, 10
    s_add_u32 s26, s26, s14
    v_mbcnt_lo_u32_b32 v20, s36, 0
    v_mbcnt_hi_u32_b32 v20, s37, v20
    s_bcnt1_i32_b64 s14, s[36:37]
    v_lshl_add_u32 v21, v20, 1, s25
    ds_read_u16 v21, v21
    s_add_u32 s36, s26, 3145728
    s_lshl1_add_u32 s25, s14, s25
    s_lshl_b32 s14, s14, 10
    s_add_u32 s26, s26, s14
    s_waitcnt lgkmcnt(3)
    v_mad_u32_u16 v9, v9, s23, v2
    v_pk_lshrrev_b16 v9, 10, v9 op_sel_hi:[1,1]
    v_lshl_add_u32 v8, v8, 6, v9
    buffer_load_dwordx4 v[8:11], v8, s[44:47], s30 idxen
    s_waitcnt lgkmcnt(2)
    v_mad_u32_u16 v13, v13, s23, v2
    v_pk_lshrrev_b16 v13, 10, v13 op_sel_hi:[1,1]
    v_lshl_add_u32 v12, v12, 6, v13
    buffer_load_dwordx4 v[12:15], v12, s[44:47], s32 idxen
    s_waitcnt lgkmcnt(1)
    v_mad_u32_u16 v17, v17, s23, v2
    v_pk_lshrrev_b16 v17, 10, v17 op_sel_hi:[1,1]
    v_lshl_add_u32 v16, v16, 6, v17
    buffer_load_dwordx4 v[16:19], v16, s[44:47], s34 idxen
    s_waitcnt lgkmcnt(0)
    v_mad_u32_u16 v21, v21, s23, v2
    v_pk_lshrrev_b16 v21, 10, v21 op_sel_hi:[1,1]
    v_lshl_add_u32 v20, v20, 6, v21
    buffer_load_dwordx4 v[20:23], v20, s[44:47], s36 idxen
    s_cmp_le_u32 s28, 256
    s_cbranch_scc1 L_p2_kernel_noopt_1
    v_readlane_b32 s38, v7, 8
    v_readlane_b32 s39, v7, 9
    s_nop 1
    v_mbcnt_lo_u32_b32 v51, s38, 0
    v_mbcnt_hi_u32_b32 v51, s39, v51
    s_bcnt1_i32_b64 s14, s[38:39]
    v_lshl_add_u32 v55, v51, 1, s25
    ds_read_u16 v55, v55
    s_add_u32 s38, s26, 4194304
    s_lshl1_add_u32 s25, s14, s25
    s_lshl_b32 s14, s14, 10
    s_add_u32 s26, s26, s14
    s_waitcnt lgkmcnt(0)
    v_mad_u32_u16 v55, v55, s23, v2
    v_pk_lshrrev_b16 v55, 10, v55 op_sel_hi:[1,1]
    v_lshl_add_u32 v51, v51, 6, v55
    buffer_load_dwordx4 v[24:27], v51, s[44:47], s38 idxen
L_p2_kernel_noopt_1:
    s_waitcnt vmcnt(6)
    ds_write_b128 v3, v[88:91] offset:0
    ds_write_b128 v3, v[92:95] offset:16384
    ds_write_b128 v3, v[96:99] offset:32768
    ds_write_b128 v3, v[100:103] offset:49152
    ds_write_b128 v124, v[104:107] offset:0
    s_waitcnt vmcnt(4)
    v_max3_u32 v64, v80, v82, v84
    v_add_f32 v65, v81, v83
    v_add_f32 v66, v85, v87
    v_max_u32 v64, v64, v86
    v_add_f32 v65, v65, v66
    v_cmp_lt_u32 vcc, 0xffff, v64
    s_nop 1
    v_max_u32_dpp v64, v64, v64 row_shr:1 row_mask:0xf bank_mask:0xf bound_ctrl:0
    s_nop 1
    v_max_u32_dpp v64, v64, v64 row_shr:2 row_mask:0xf bank_mask:0xf bound_ctrl:0
    s_nop 1
    v_max_u32_dpp v64, v64, v64 row_shr:4 row_mask:0xf bank_mask:0xf bound_ctrl:0
    s_nop 1
    v_max_u32_dpp v64, v64, v64 row_shr:8 row_mask:0xf bank_mask:0xf bound_ctrl:0
    s_nop 1
    v_max_u32_dpp v64, v64, v64 row_bcast:15 row_mask:0xa bank_mask:0xf
    s_nop 1
    v_max_u32_dpp v64, v64, v64 row_bcast:31 row_mask:0xc bank_mask:0xf
    s_nop 1
    v_add_f32_dpp v65, v65, v65 row_shr:1 row_mask:0xf bank_mask:0xf bound_ctrl:0
    s_nop 1
    v_add_f32_dpp v65, v65, v65 row_shr:2 row_mask:0xf bank_mask:0xf bound_ctrl:0
    s_nop 1
    v_add_f32_dpp v65, v65, v65 row_shr:4 row_mask:0xf bank_mask:0xf bound_ctrl:0
    s_nop 1
    v_add_f32_dpp v65, v65, v65 row_shr:8 row_mask:0xf bank_mask:0xf bound_ctrl:0
    s_nop 1
    v_add_f32_dpp v65, v65, v65 row_bcast:15 row_mask:0xa bank_mask:0xf
    s_nop 1
    v_add_f32_dpp v65, v65, v65 row_bcast:31 row_mask:0xc bank_mask:0xf
    s_cmp_lg_u64 vcc, 0
    s_cselect_b32 s2, 1, s2
    v_lshlrev_b32 v64, 16, v64
    v_mul_f32 v66, 936490775, v65
    v_mul_f32 v65, 928531664, v65
    v_cmp_nle_f32 vcc, v64, v66
    v_max_u32 v64, v64, v65
    s_nop 0
    v_readlane_b32 s14, v64, 63
    s_bitcmp1_b32 vcc_hi, 31
    s_cselect_b32 s2, 1, s2
    s_lshr_b32 s14, s14, 23
    s_add_u32 s14, s14, 1
    s_cmp_lt_u32 s14, 40
    s_cselect_b32 s2, 1, s2
    s_cmp_gt_u32 s14, 230
    s_cselect_b32 s2, 1, s2
    s_sub_u32 s48, s14, 14
    s_lshl_b32 s48, s48, 23
    s_add_u32 s16, s48, 272629760
    s_lshr_b32 s15, s16, 16
    s_sub_u32 s15, 0x10000, s15
    s_add_u32 s20, s16, s15
    s_sub_u32 s17, s20, 1
    s_mov_b32 s21, s17
    s_or_b32 s48, s48, 16416
    s_sub_u32 s14, s14, 40
    s_cmp_gt_u32 s14, 190
    s_cselect_b32 s48, 0, s48
    s_waitcnt lgkmcnt(0)
    s_barrier
    s_add_u32 s14, s22, 80000
    buffer_load_dwordx4 v[88:91], v1, s[8:11], s14 offen
    s_add_u32 s14, s22, 96384
    buffer_load_dwordx4 v[92:95], v1, s[8:11], s14 offen
    v_mad_u32_u16 v108, v28, v50, s40 op_sel:[1,0,0,0]
    v_mad_u32_u16 v109, v36, v50, s41 op_sel:[1,0,0,0]
    v_sub_u32_sdwa v110, v109, v108 dst_sel:DWORD dst_unused:UNUSED_PAD src0_sel:WORD_1 src1_sel:WORD_1
    s_nop 1
    v_add_u32_dpp v110, v110, v110 row_shr:1 row_mask:0xf bank_mask:0xf bound_ctrl:0
    s_nop 1
    v_add_u32_dpp v110, v110, v110 row_shr:2 row_mask:0xf bank_mask:0xf bound_ctrl:0
    s_nop 1
    v_add_u32_dpp v110, v110, v110 row_shr:4 row_mask:0xf bank_mask:0xf bound_ctrl:0
    s_nop 1
    v_add_u32_dpp v110, v110, v110 row_shr:8 row_mask:0xf bank_mask:0xf bound_ctrl:0
    s_nop 1
    v_add_u32_dpp v110, v110, v110 row_bcast:15 row_mask:0xa bank_mask:0xf
    s_nop 1
    v_add_u32_dpp v110, v110, v110 row_bcast:31 row_mask:0xc bank_mask:0xf
    v_sub_u32_sdwa v109, v109, v110 dst_sel:DWORD dst_unused:UNUSED_PAD src0_sel:WORD_1 src1_sel:DWORD
    v_readlane_b32 s29, v110, 63
    v_add_u32 v110, -1, v110
    ds_write_b16 v126, v109
    v_lshlrev_b32_e64 v111, v110, 1
    v_lshrrev_b32 v110, 5, v110
    v_lshl_add_u32 v110, v110, 2, s19
    s_cmp_gt_u32 s29, 320
    s_cselect_b32 s2, 1, s2
    s_cselect_b64 exec, 0, -1
    ds_or_b32 v110, v111 offset:160
    s_mov_b64 exec, -1
    ds_wrxchg_rtn_b32 v7, v6, v5 offset:160
    s_mov_b32 s24, 0
L_p2_loop:
    s_add_u32 s22, s22, 80000
    s_lshl_b32 s14, s13, 4
    s_or_b32 s14, s14, s24
    s_cmp_lg_u32 s14, 5
    s_cbranch_scc1 L_p2_nost
    v_mov_b32 v52, 0
    s_lshl_b32 s14, s3, 8
    s_add_u32 s14, s14, 8523776
    s_mov_b64 exec, 1
    buffer_atomic_add v52, off, s[4:7], s14 sc0
    s_mov_b64 exec, -1
L_p2_nost:
    s_waitcnt vmcnt(5)
    v_mad_u32_u16 v64, v8, 8, s18
    v_mad_u32_u16 v66, v9, 8, s18
    v_mad_u32_u16 v68, v10, 8, s18
    ds_read_b64 v[64:65], v64
    ds_read_b64 v[66:67], v66
    ds_read_b64 v[68:69], v68
    s_add_u32 s14, s22, 32768
    buffer_load_dwordx4 v[96:99], v1, s[8:11], s14 offen
    s_waitcnt vmcnt(5)
    v_mad_u32_u16 v70, v12, 8, s18
    v_mad_u32_u16 v72, v13, 8, s18
    v_mad_u32_u16 v74, v14, 8, s18
    ds_read_b64 v[70:71], v70
    ds_read_b64 v[72:73], v72
    ds_read_b64 v[74:75], v74
    s_add_u32 s14, s22, 49152
    buffer_load_dwordx4 v[100:103], v1, s[8:11], s14 offen
    s_waitcnt lgkmcnt(6)
    v_readlane_b32 s30, v7, 0
    v_readlane_b32 s31, v7, 1
    v_readlane_b32 s32, v7, 2
    v_readlane_b32 s33, v7, 3
    v_readlane_b32 s34, v7, 4
    v_readlane_b32 s35, v7, 5
    v_readlane_b32 s36, v7, 6
    v_readlane_b32 s37, v7, 7
    s_mov_b32 s25, s19
    s_mov_b32 s26, s27
    s_mov_b32 s51, s28
    s_mov_b32 s28, s29
    v_mbcnt_lo_u32_b32 v51, s30, 0
    v_mbcnt_hi_u32_b32 v51, s31, v51
    s_bcnt1_i32_b64 s14, s[30:31]
    v_lshl_add_u32 v55, v51, 1, s25
    ds_read_u16 v55, v55
    s_add_u32 s30, s26, 0
    s_lshl1_add_u32 s25, s14, s25
    s_lshl_b32 s14, s14, 10
    s_add_u32 s26, s26, s14
    v_bfe_i32 v108, v11, 2, 10
    v_bfe_i32 v109, v11, 12, 10
    v_ashrrev_i32 v110, 22, v11
    v_cvt_f32_i32 v108, v108
    v_cvt_f32_i32 v109, v109
    v_cvt_f32_i32 v110, v110
    s_waitcnt lgkmcnt(4)
    v_mfma_f32_4x4x4_16b_bf16 v[112:115], v[58:59], v[64:65], 0
    v_mfma_f32_4x4x4_16b_bf16 v[116:119], v[58:59], v[66:67], 0
    v_mfma_f32_4x4x4_16b_bf16 v[120:123], v[58:59], v[68:69], 0
    v_mad_u32_u16 v8, v8, 8, s50 op_sel:[1,0,0,0]
    v_mad_u32_u16 v9, v9, 8, s50 op_sel:[1,0,0,0]
    v_mad_u32_u16 v10, v10, 8, s50 op_sel:[1,0,0,0]
    v_pk_fma_f32 v[114:115], v[114:115], v[108:109], s[20:21] op_sel:[0,0,0] op_sel_hi:[1,0,1]
    v_pk_fma_f32 v[112:113], v[112:113], v[108:109], s[16:17] op_sel:[0,0,0] op_sel_hi:[1,0,1]
    v_pk_fma_f32 v[118:119], v[118:119], v[108:109], s[20:21] op_sel:[0,1,0] op_sel_hi:[1,1,1]
    v_pk_fma_f32 v[116:117], v[116:117], v[108:109], s[16:17] op_sel:[0,1,0] op_sel_hi:[1,1,1]
    v_pk_fma_f32 v[122:123], v[122:123], v[110:111], s[20:21] op_sel:[0,0,0] op_sel_hi:[1,0,1]
    v_pk_fma_f32 v[120:121], v[120:121], v[110:111], s[16:17] op_sel:[0,0,0] op_sel_hi:[1,0,1]
    v_lshlrev_b64 v[114:115], 16, v[114:115]
    v_lshlrev_b64 v[118:119], 16, v[118:119]
    v_lshlrev_b64 v[122:123], 16, v[122:123]
    v_lshl_add_u64 v[64:65], v[112:113], 0, v[114:115]
    v_lshl_add_u64 v[66:67], v[116:117], 0, v[118:119]
    v_lshl_add_u64 v[68:69], v[120:121], 0, v[122:123]
    v_or3_b32 v4, v44, v45, v4
    v_or3_b32 v4, v46, v47, v4
    v_or3_b32 v4, v48, v49, v4
    ds_add_rtn_u64 v[44:45], v8, v[64:65]
    ds_add_rtn_u64 v[46:47], v9, v[66:67]
    ds_add_rtn_u64 v[48:49], v10, v[68:69]
    s_waitcnt lgkmcnt(3)
    v_mad_u32_u16 v55, v55, s23, v2
    v_pk_lshrrev_b16 v55, 10, v55 op_sel_hi:[1,1]
    v_lshl_add_u32 v51, v51, 6, v55
    buffer_load_dwordx4 v[8:11], v51, s[44:47], s30 idxen
    s_add_u32 s14, s22, 65536
    buffer_load_dwordx4 v[104:107], v1, s[8:11], s14 offen
    s_waitcnt vmcnt(7)
    v_mad_u32_u16 v76, v16, 8, s18
    v_mad_u32_u16 v78, v17, 8, s18
    v_mad_u32_u16 v80, v18, 8, s18
    ds_read_b64 v[76:77], v76
    ds_read_b64 v[78:79], v78
    ds_read_b64 v[80:81], v80
    s_waitcnt vmcnt(6)
    v_mad_u32_u16 v82, v20, 8, s18
    v_mad_u32_u16 v84, v21, 8, s18
    v_mad_u32_u16 v86, v22, 8, s18
    ds_read_b64 v[82:83], v82
    ds_read_b64 v[84:85], v84
    ds_read_b64 v[86:87], v86
    s_cmp_le_u32 s51, 256
    s_cbranch_scc1 L_p2_kernel_noopt3_2
    v_mad_u32_u16 v64, v24, 8, s18
    v_mad_u32_u16 v66, v25, 8, s18
    v_mad_u32_u16 v68, v26, 8, s18
    ds_read_b64 v[64:65], v64
    ds_read_b64 v[66:67], v66
    ds_read_b64 v[68:69], v68
L_p2_kernel_noopt3_2:
    v_mbcnt_lo_u32_b32 v51, s32, 0
    v_mbcnt_hi_u32_b32 v51, s33, v51
    s_bcnt1_i32_b64 s14, s[32:33]
    v_lshl_add_u32 v55, v51, 1, s25
    ds_read_u16 v55, v55
    s_add_u32 s32, s26, 1048576
    s_lshl1_add_u32 s25, s14, s25
    s_lshl_b32 s14, s14, 10
    s_add_u32 s26, s26, s14
    v_bfe_i32 v108, v15, 2, 10
    v_bfe_i32 v109, v15, 12, 10
    v_ashrrev_i32 v110, 22, v15
    v_cvt_f32_i32 v108, v108
    v_cvt_f32_i32 v109, v109
    v_cvt_f32_i32 v110, v110
    v_mfma_f32_4x4x4_16b_bf16 v[112:115], v[58:59], v[70:71], 0
    v_mfma_f32_4x4x4_16b_bf16 v[116:119], v[58:59], v[72:73], 0
    v_mfma_f32_4x4x4_16b_bf16 v[120:123], v[58:59], v[74:75], 0
    v_mad_u32_u16 v12, v12, 8, s50 op_sel:[1,0,0,0]
    v_mad_u32_u16 v13, v13, 8, s50 op_sel:[1,0,0,0]
    v_mad_u32_u16 v14, v14, 8, s50 op_sel:[1,0,0,0]
    v_pk_fma_f32 v[114:115], v[114:115], v[108:109], s[20:21] op_sel:[0,0,0] op_sel_hi:[1,0,1]
    v_pk_fma_f32 v[112:113], v[112:113], v[108:109], s[16:17] op_sel:[0,0,0] op_sel_hi:[1,0,1]
    v_pk_fma_f32 v[118:119], v[118:119], v[108:109], s[20:21] op_sel:[0,1,0] op_sel_hi:[1,1,1]
    v_pk_fma_f32 v[116:117], v[116:117], v[108:109], s[16:17] op_sel:[0,1,0] op_sel_hi:[1,1,1]
    v_pk_fma_f32 v[122:123], v[122:123], v[110:111], s[20:21] op_sel:[0,0,0] op_sel_hi:[1,0,1]
    v_pk_fma_f32 v[120:121], v[120:121], v[110:111], s[16:17] op_sel:[0,0,0] op_sel_hi:[1,0,1]
    v_lshlrev_b64 v[114:115], 16, v[114:115]
    v_lshlrev_b64 v[118:119], 16, v[118:119]
    v_lshlrev_b64 v[122:123], 16, v[122:123]
    v_lshl_add_u64 v[70:71], v[112:113], 0, v[114:115]
    v_lshl_add_u64 v[72:73], v[116:117], 0, v[118:119]
    v_lshl_add_u64 v[74:75], v[120:121], 0, v[122:123]
    s_waitcnt lgkmcnt(7)
    v_or3_b32 v4, v44, v45, v4
    v_or3_b32 v4, v46, v47, v4
    v_or3_b32 v4, v48, v49, v4
    ds_add_rtn_u64 v[44:45], v12, v[70:71]
    ds_add_rtn_u64 v[46:47], v13, v[72:73]
    ds_add_rtn_u64 v[48:49], v14, v[74:75]
    s_waitcnt lgkmcnt(3)
    v_mad_u32_u16 v55, v55, s23, v2
    v_pk_lshrrev_b16 v55, 10, v55 op_sel_hi:[1,1]
    v_lshl_add_u32 v51, v51, 6, v55
    buffer_load_dwordx4 v[12:15], v51, s[44:47], s32 idxen
    s_barrier
    s_waitcnt vmcnt(1)
    ds_write_b128 v3, v[88:91] offset:0
    ds_write_b128 v3, v[92:95] offset:16384
    ds_write_b128 v3, v[96:99] offset:32768
    ds_write_b128 v3, v[100:103] offset:49152
    ds_write_b128 v124, v[104:107] offset:0
    v_mbcnt_lo_u32_b32 v51, s34, 0
    v_mbcnt_hi_u32_b32 v51, s35, v51
    s_bcnt1_i32_b64 s14, s[34:35]
    v_lshl_add_u32 v55, v51, 1, s25
    ds_read_u16 v55, v55
    s_add_u32 s34, s26, 2097152
    s_lshl1_add_u32 s25, s14, s25
    s_lshl_b32 s14, s14, 10
    s_add_u32 s26, s26, s14
    v_bfe_i32 v108, v19, 2, 10
    v_bfe_i32 v109, v19, 12, 10
    v_ashrrev_i32 v110, 22, v19
    v_cvt_f32_i32 v108, v108
    v_cvt_f32_i32 v109, v109
    v_cvt_f32_i32 v110, v110
    v_mfma_f32_4x4x4_16b_bf16 v[112:115], v[58:59], v[76:77], 0
    v_mfma_f32_4x4x4_16b_bf16 v[116:119], v[58:59], v[78:79], 0
    v_mfma_f32_4x4x4_16b_bf16 v[120:123], v[58:59], v[80:81], 0
    v_mad_u32_u16 v16, v16, 8, s50 op_sel:[1,0,0,0]
    v_mad_u32_u16 v17, v17, 8, s50 op_sel:[1,0,0,0]
    v_mad_u32_u16 v18, v18, 8, s50 op_sel:[1,0,0,0]
    v_pk_fma_f32 v[114:115], v[114:115], v[108:109], s[20:21] op_sel:[0,0,0] op_sel_hi:[1,0,1]
    v_pk_fma_f32 v[112:113], v[112:113], v[108:109], s[16:17] op_sel:[0,0,0] op_sel_hi:[1,0,1]
    v_pk_fma_f32 v[118:119], v[118:119], v[108:109], s[20:21] op_sel:[0,1,0] op_sel_hi:[1,1,1]
    v_pk_fma_f32 v[116:117], v[116:117], v[108:109], s[16:17] op_sel:[0,1,0] op_sel_hi:[1,1,1]
    v_pk_fma_f32 v[122:123], v[122:123], v[110:111], s[20:21] op_sel:[0,0,0] op_sel_hi:[1,0,1]
    v_pk_fma_f32 v[120:121], v[120:121], v[110:111], s[16:17] op_sel:[0,0,0] op_sel_hi:[1,0,1]
    v_lshlrev_b64 v[114:115], 16, v[114:115]
    v_lshlrev_b64 v[118:119], 16, v[118:119]
    v_lshlrev_b64 v[122:123], 16, v[122:123]
    v_lshl_add_u64 v[76:77], v[112:113], 0, v[114:115]
    v_lshl_add_u64 v[78:79], v[116:117], 0, v[118:119]
    v_lshl_add_u64 v[80:81], v[120:121], 0, v[122:123]
    s_waitcnt lgkmcnt(6)
    v_or3_b32 v4, v44, v45, v4
    v_or3_b32 v4, v46, v47, v4
    v_or3_b32 v4, v48, v49, v4
    ds_add_rtn_u64 v[44:45], v16, v[76:77]
    ds_add_rtn_u64 v[46:47], v17, v[78:79]
    ds_add_rtn_u64 v[48:49], v18, v[80:81]
    s_waitcnt lgkmcnt(3)
    v_mad_u32_u16 v55, v55, s23, v2
    v_pk_lshrrev_b16 v55, 10, v55 op_sel_hi:[1,1]
    v_lshl_add_u32 v51, v51, 6, v55
    buffer_load_dwordx4 v[16:19], v51, s[44:47], s34 idxen
    s_cmp_le_u32 s51, 256
    s_cbranch_scc1 L_p2_kernel_noopt3_3
    v_bfe_i32 v108, v27, 2, 10
    v_bfe_i32 v109, v27, 12, 10
    v_ashrrev_i32 v110, 22, v27
    v_cvt_f32_i32 v108, v108
    v_cvt_f32_i32 v109, v109
    v_cvt_f32_i32 v110, v110
    v_mfma_f32_4x4x4_16b_bf16 v[112:115], v[58:59], v[64:65], 0
    v_mfma_f32_4x4x4_16b_bf16 v[116:119], v[58:59], v[66:67], 0
    v_mfma_f32_4x4x4_16b_bf16 v[120:123], v[58:59], v[68:69], 0
    v_mad_u32_u16 v24, v24, 8, s50 op_sel:[1,0,0,0]
    v_mad_u32_u16 v25, v25, 8, s50 op_sel:[1,0,0,0]
    v_mad_u32_u16 v26, v26, 8, s50 op_sel:[1,0,0,0]
    v_pk_fma_f32 v[114:115], v[114:115], v[108:109], s[20:21] op_sel:[0,0,0] op_sel_hi:[1,0,1]
    v_pk_fma_f32 v[112:113], v[112:113], v[108:109], s[16:17] op_sel:[0,0,0] op_sel_hi:[1,0,1]
    v_pk_fma_f32 v[118:119], v[118:119], v[108:109], s[20:21] op_sel:[0,1,0] op_sel_hi:[1,1,1]
    v_pk_fma_f32 v[116:117], v[116:117], v[108:109], s[16:17] op_sel:[0,1,0] op_sel_hi:[1,1,1]
    v_pk_fma_f32 v[122:123], v[122:123], v[110:111], s[20:21] op_sel:[0,0,0] op_sel_hi:[1,0,1]
    v_pk_fma_f32 v[120:121], v[120:121], v[110:111], s[16:17] op_sel:[0,0,0] op_sel_hi:[1,0,1]
    v_lshlrev_b64 v[114:115], 16, v[114:115]
    v_lshlrev_b64 v[118:119], 16, v[118:119]
    v_lshlrev_b64 v[122:123], 16, v[122:123]
    v_lshl_add_u64 v[64:65], v[112:113], 0, v[114:115]
    v_lshl_add_u64 v[66:67], v[116:117], 0, v[118:119]
    v_lshl_add_u64 v[68:69], v[120:121], 0, v[122:123]
    s_waitcnt lgkmcnt(0)
    v_or3_b32 v4, v44, v45, v4
    v_or3_b32 v4, v46, v47, v4
    v_or3_b32 v4, v48, v49, v4
    ds_add_rtn_u64 v[44:45], v24, v[64:65]
    ds_add_rtn_u64 v[46:47], v25, v[66:67]
    ds_add_rtn_u64 v[48:49], v26, v[68:69]
L_p2_kernel_noopt3_3:
    v_mbcnt_lo_u32_b32 v51, s36, 0
    v_mbcnt_hi_u32_b32 v51, s37, v51
    s_bcnt1_i32_b64 s14, s[36:37]
    v_lshl_add_u32 v55, v51, 1, s25
    ds_read_u16 v55, v55
    s_add_u32 s36, s26, 3145728
    s_lshl1_add_u32 s25, s14, s25
    s_lshl_b32 s14, s14, 10
    s_add_u32 s26, s26, s14
    s_cmp_le_u32 s28, 256
    s_cbranch_scc1 L_p2_kernel_noopt3_4
    v_readlane_b32 s38, v7, 8
    v_readlane_b32 s39, v7, 9
    s_nop 1
    v_mbcnt_lo_u32_b32 v62, s38, 0
    v_mbcnt_hi_u32_b32 v62, s39, v62
    s_bcnt1_i32_b64 s14, s[38:39]
    v_lshl_add_u32 v63, v62, 1, s25
    ds_read_u16 v63, v63
    s_add_u32 s38, s26, 4194304
    s_lshl1_add_u32 s25, s14, s25
    s_lshl_b32 s14, s14, 10
    s_add_u32 s26, s26, s14
L_p2_kernel_noopt3_4:
    v_bfe_i32 v108, v23, 2, 10
    v_bfe_i32 v109, v23, 12, 10
    v_ashrrev_i32 v110, 22, v23
    v_cvt_f32_i32 v108, v108
    v_cvt_f32_i32 v109, v109
    v_cvt_f32_i32 v110, v110
    v_mfma_f32_4x4x4_16b_bf16 v[112:115], v[58:59], v[82:83], 0
    v_mfma_f32_4x4x4_16b_bf16 v[116:119], v[58:59], v[84:85], 0
    v_mfma_f32_4x4x4_16b_bf16 v[120:123], v[58:59], v[86:87], 0
    v_mad_u32_u16 v20, v20, 8, s50 op_sel:[1,0,0,0]
    v_mad_u32_u16 v21, v21, 8, s50 op_sel:[1,0,0,0]
    v_mad_u32_u16 v22, v22, 8, s50 op_sel:[1,0,0,0]
    v_pk_fma_f32 v[114:115], v[114:115], v[108:109], s[20:21] op_sel:[0,0,0] op_sel_hi:[1,0,1]
    v_pk_fma_f32 v[112:113], v[112:113], v[108:109], s[16:17] op_sel:[0,0,0] op_sel_hi:[1,0,1]
    v_pk_fma_f32 v[118:119], v[118:119], v[108:109], s[20:21] op_sel:[0,1,0] op_sel_hi:[1,1,1]
    v_pk_fma_f32 v[116:117], v[116:117], v[108:109], s[16:17] op_sel:[0,1,0] op_sel_hi:[1,1,1]
    v_pk_fma_f32 v[122:123], v[122:123], v[110:111], s[20:21] op_sel:[0,0,0] op_sel_hi:[1,0,1]
    v_pk_fma_f32 v[120:121], v[120:121], v[110:111], s[16:17] op_sel:[0,0,0] op_sel_hi:[1,0,1]
    v_lshlrev_b64 v[114:115], 16, v[114:115]
    v_lshlrev_b64 v[118:119], 16, v[118:119]
    v_lshlrev_b64 v[122:123], 16, v[122:123]
    v_lshl_add_u64 v[82:83], v[112:113], 0, v[114:115]
    v_lshl_add_u64 v[84:85], v[116:117], 0, v[118:119]
    v_lshl_add_u64 v[86:87], v[120:121], 0, v[122:123]
    s_waitcnt lgkmcnt(1)
    v_or3_b32 v4, v44, v45, v4
    v_or3_b32 v4, v46, v47, v4
    v_or3_b32 v4, v48, v49, v4
    ds_add_rtn_u64 v[44:45], v20, v[82:83]
    ds_add_rtn_u64 v[46:47], v21, v[84:85]
    ds_add_rtn_u64 v[48:49], v22, v[86:87]
    s_waitcnt lgkmcnt(3)
    v_mad_u32_u16 v55, v55, s23, v2
    v_pk_lshrrev_b16 v55, 10, v55 op_sel_hi:[1,1]
    v_lshl_add_u32 v51, v51, 6, v55
    buffer_load_dwordx4 v[20:23], v51, s[44:47], s36 idxen
    s_cmp_le_u32 s28, 256
    s_cbranch_scc1 L_p2_kernel_noopt3_5
    v_mad_u32_u16 v63, v63, s23, v2
    v_pk_lshrrev_b16 v63, 10, v63 op_sel_hi:[1,1]
    v_lshl_add_u32 v62, v62, 6, v63
    buffer_load_dwordx4 v[24:27], v62, s[44:47], s38 idxen
L_p2_kernel_noopt3_5:
    v_pk_mov_b32 v[28:29], v[28:29], v[30:31] op_sel:[1,0]
    v_pk_mov_b32 v[30:31], v[30:31], v[32:33] op_sel:[1,0]
    v_pk_mov_b32 v[32:33], v[32:33], v[34:35] op_sel:[1,0]
    v_pk_mov_b32 v[34:35], v[34:35], v[4:5] op_sel:[1,1]
    v_pk_mov_b32 v[36:37], v[36:37], v[38:39] op_sel:[1,0]
    v_pk_mov_b32 v[38:39], v[38:39], v[40:41] op_sel:[1,0]
    v_pk_mov_b32 v[40:41], v[40:41], v[42:43] op_sel:[1,0]
    v_pk_mov_b32 v[42:43], v[42:43], v[4:5] op_sel:[1,1]
    v_mad_u32_u16 v108, v28, v50, s40 op_sel:[0,0,0,0]
    v_mad_u32_u16 v109, v36, v50, s41 op_sel:[0,0,0,0]
    v_sub_u32_sdwa v110, v109, v108 dst_sel:DWORD dst_unused:UNUSED_PAD src0_sel:WORD_1 src1_sel:WORD_1
    s_nop 1
    v_add_u32_dpp v110, v110, v110 row_shr:1 row_mask:0xf bank_mask:0xf bound_ctrl:0
    s_nop 1
    v_add_u32_dpp v110, v110, v110 row_shr:2 row_mask:0xf bank_mask:0xf bound_ctrl:0
    s_nop 1
    v_add_u32_dpp v110, v110, v110 row_shr:4 row_mask:0xf bank_mask:0xf bound_ctrl:0
    s_nop 1
    v_add_u32_dpp v110, v110, v110 row_shr:8 row_mask:0xf bank_mask:0xf bound_ctrl:0
    s_nop 1
    v_add_u32_dpp v110, v110, v110 row_bcast:15 row_mask:0xa bank_mask:0xf
    s_nop 1
    v_add_u32_dpp v110, v110, v110 row_bcast:31 row_mask:0xc bank_mask:0xf
    v_sub_u32_sdwa v109, v109, v110 dst_sel:DWORD dst_unused:UNUSED_PAD src0_sel:WORD_1 src1_sel:DWORD
    v_readlane_b32 s29, v110, 63
    v_add_u32 v110, -1, v110
    ds_write_b16 v126, v109
    v_lshlrev_b32_e64 v111, v110, 1
    v_lshrrev_b32 v110, 5, v110
    v_lshl_add_u32 v110, v110, 2, s19
    s_cmp_gt_u32 s29, 320
    s_cselect_b32 s2, 1, s2
    s_cselect_b64 exec, 0, -1
    ds_or_b32 v110, v111 offset:160
    s_mov_b64 exec, -1
    ds_wrxchg_rtn_b32 v7, v6, v5 offset:160
    s_add_u32 s14, s22, 80000
    buffer_load_dwordx4 v[88:91], v1, s[8:11], s14 offen
    s_add_u32 s14, s22, 96384
    buffer_load_dwordx4 v[92:95], v1, s[8:11], s14 offen
    s_barrier
    s_add_u32 s22, s22, 80000
    s_cmp_lg_u32 s24, 7
    s_cbranch_scc1 L_p2_nodist
    s_mov_b32 s46, 0
    s_lshl2_add_u32 s14, s3, s12
    s_mul_i32 s14, s14, 5000
    s_add_u32 s15, s14, 4096
    v_min_u32 v61, 225, v0
    v_lshl_add_u32 v60, v0, 2, s14
    v_lshl_add_u32 v61, v61, 2, s15
    global_load_dword v60, v60, s[100:101] nt
    global_load_dword v61, v61, s[100:101] nt
L_p2_nodist:
    v_mad_u32_u16 v64, v8, 8, s18
    v_mad_u32_u16 v66, v9, 8, s18
    v_mad_u32_u16 v68, v10, 8, s18
    ds_read_b64 v[64:65], v64
    ds_read_b64 v[66:67], v66
    ds_read_b64 v[68:69], v68
    s_add_u32 s14, s22, 32768
    buffer_load_dwordx4 v[96:99], v1, s[8:11], s14 offen
    s_waitcnt vmcnt(5)
    v_mad_u32_u16 v70, v12, 8, s18
    v_mad_u32_u16 v72, v13, 8, s18
    v_mad_u32_u16 v74, v14, 8, s18
    ds_read_b64 v[70:71], v70
    ds_read_b64 v[72:73], v72
    ds_read_b64 v[74:75], v74
    s_add_u32 s14, s22, 49152
    buffer_load_dwordx4 v[100:103], v1, s[8:11], s14 offen
    s_waitcnt lgkmcnt(6)
    v_readlane_b32 s30, v7, 0
    v_readlane_b32 s31, v7, 1
    v_readlane_b32 s32, v7, 2
    v_readlane_b32 s33, v7, 3
    v_readlane_b32 s34, v7, 4
    v_readlane_b32 s35, v7, 5
    v_readlane_b32 s36, v7, 6
    v_readlane_b32 s37, v7, 7
    s_mov_b32 s25, s19
    s_mov_b32 s26, s27
    s_mov_b32 s51, s28
    s_mov_b32 s28, s29
    v_mbcnt_lo_u32_b32 v51, s30, 0
    v_mbcnt_hi_u32_b32 v51, s31, v51
    s_bcnt1_i32_b64 s14, s[30:31]
    v_lshl_add_u32 v55, v51, 1, s25
    ds_read_u16 v55, v55
    s_add_u32 s30, s26, 0
    s_lshl1_add_u32 s25, s14, s25
    s_lshl_b32 s14, s14, 10
    s_add_u32 s26, s26, s14
    v_bfe_i32 v108, v11, 2, 10
    v_bfe_i32 v109, v11, 12, 10
    v_ashrrev_i32 v110, 22, v11
    v_cvt_f32_i32 v108, v108
    v_cvt_f32_i32 v109, v109
    v_cvt_f32_i32 v110, v110
    s_waitcnt lgkmcnt(4)
    v_mfma_f32_4x4x4_16b_bf16 v[112:115], v[58:59], v[64:65], 0
    v_mfma_f32_4x4x4_16b_bf16 v[116:119], v[58:59], v[66:67], 0
    v_mfma_f32_4x4x4_16b_bf16 v[120:123], v[58:59], v[68:69], 0
    v_mad_u32_u16 v8, v8, 8, s50 op_sel:[1,0,0,0]
    v_mad_u32_u16 v9, v9, 8, s50 op_sel:[1,0,0,0]
    v_mad_u32_u16 v10, v10, 8, s50 op_sel:[1,0,0,0]
    v_pk_fma_f32 v[114:115], v[114:115], v[108:109], s[20:21] op_sel:[0,0,0] op_sel_hi:[1,0,1]
    v_pk_fma_f32 v[112:113], v[112:113], v[108:109], s[16:17] op_sel:[0,0,0] op_sel_hi:[1,0,1]
    v_pk_fma_f32 v[118:119], v[118:119], v[108:109], s[20:21] op_sel:[0,1,0] op_sel_hi:[1,1,1]
    v_pk_fma_f32 v[116:117], v[116:117], v[108:109], s[16:17] op_sel:[0,1,0] op_sel_hi:[1,1,1]
    v_pk_fma_f32 v[122:123], v[122:123], v[110:111], s[20:21] op_sel:[0,0,0] op_sel_hi:[1,0,1]
    v_pk_fma_f32 v[120:121], v[120:121], v[110:111], s[16:17] op_sel:[0,0,0] op_sel_hi:[1,0,1]
    v_lshlrev_b64 v[114:115], 16, v[114:115]
    v_lshlrev_b64 v[118:119], 16, v[118:119]
    v_lshlrev_b64 v[122:123], 16, v[122:123]
    v_lshl_add_u64 v[64:65], v[112:113], 0, v[114:115]
    v_lshl_add_u64 v[66:67], v[116:117], 0, v[118:119]
    v_lshl_add_u64 v[68:69], v[120:121], 0, v[122:123]
    v_or3_b32 v4, v44, v45, v4
    v_or3_b32 v4, v46, v47, v4
    v_or3_b32 v4, v48, v49, v4
    ds_add_rtn_u64 v[44:45], v8, v[64:65]
    ds_add_rtn_u64 v[46:47], v9, v[66:67]
    ds_add_rtn_u64 v[48:49], v10, v[68:69]
    s_waitcnt lgkmcnt(3)
    v_mad_u32_u16 v55, v55, s23, v2
    v_pk_lshrrev_b16 v55, 10, v55 op_sel_hi:[1,1]
    v_lshl_add_u32 v51, v51, 6, v55
    buffer_load_dwordx4 v[8:11], v51, s[44:47], s30 idxen
    s_add_u32 s14, s22, 65536
    buffer_load_dwordx4 v[104:107], v1, s[8:11], s14 offen
    s_waitcnt vmcnt(7)
    v_mad_u32_u16 v76, v16, 8, s18
    v_mad_u32_u16 v78, v17, 8, s18
    v_mad_u32_u16 v80, v18, 8, s18
    ds_read_b64 v[76:77], v76
    ds_read_b64 v[78:79], v78
    ds_read_b64 v[80:81], v80
    s_waitcnt vmcnt(6)
    v_mad_u32_u16 v82, v20, 8, s18
    v_mad_u32_u16 v84, v21, 8, s18
    v_mad_u32_u16 v86, v22, 8, s18
    ds_read_b64 v[82:83], v82
    ds_read_b64 v[84:85], v84
    ds_read_b64 v[86:87], v86
    s_cmp_le_u32 s51, 256
    s_cbranch_scc1 L_p2_kernel_noopt3_6
    v_mad_u32_u16 v64, v24, 8, s18
    v_mad_u32_u16 v66, v25, 8, s18
    v_mad_u32_u16 v68, v26, 8, s18
    ds_read_b64 v[64:65], v64
    ds_read_b64 v[66:67], v66
    ds_read_b64 v[68:69], v68
L_p2_kernel_noopt3_6:
    v_mbcnt_lo_u32_b32 v51, s32, 0
    v_mbcnt_hi_u32_b32 v51, s33, v51
    s_bcnt1_i32_b64 s14, s[32:33]
    v_lshl_add_u32 v55, v51, 1, s25
    ds_read_u16 v55, v55
    s_add_u32 s32, s26, 1048576
    s_lshl1_add_u32 s25, s14, s25
    s_lshl_b32 s14, s14, 10
    s_add_u32 s26, s26, s14
    v_bfe_i32 v108, v15, 2, 10
    v_bfe_i32 v109, v15, 12, 10
    v_ashrrev_i32 v110, 22, v15
    v_cvt_f32_i32 v108, v108
    v_cvt_f32_i32 v109, v109
    v_cvt_f32_i32 v110, v110
    v_mfma_f32_4x4x4_16b_bf16 v[112:115], v[58:59], v[70:71], 0
    v_mfma_f32_4x4x4_16b_bf16 v[116:119], v[58:59], v[72:73], 0
    v_mfma_f32_4x4x4_16b_bf16 v[120:123], v[58:59], v[74:75], 0
    v_mad_u32_u16 v12, v12, 8, s50 op_sel:[1,0,0,0]
    v_mad_u32_u16 v13, v13, 8, s50 op_sel:[1,0,0,0]
    v_mad_u32_u16 v14, v14, 8, s50 op_sel:[1,0,0,0]
    v_pk_fma_f32 v[114:115], v[114:115], v[108:109], s[20:21] op_sel:[0,0,0] op_sel_hi:[1,0,1]
    v_pk_fma_f32 v[112:113], v[112:113], v[108:109], s[16:17] op_sel:[0,0,0] op_sel_hi:[1,0,1]
    v_pk_fma_f32 v[118:119], v[118:119], v[108:109], s[20:21] op_sel:[0,1,0] op_sel_hi:[1,1,1]
    v_pk_fma_f32 v[116:117], v[116:117], v[108:109], s[16:17] op_sel:[0,1,0] op_sel_hi:[1,1,1]
    v_pk_fma_f32 v[122:123], v[122:123], v[110:111], s[20:21] op_sel:[0,0,0] op_sel_hi:[1,0,1]
    v_pk_fma_f32 v[120:121], v[120:121], v[110:111], s[16:17] op_sel:[0,0,0] op_sel_hi:[1,0,1]
    v_lshlrev_b64 v[114:115], 16, v[114:115]
    v_lshlrev_b64 v[118:119], 16, v[118:119]
    v_lshlrev_b64 v[122:123], 16, v[122:123]
    v_lshl_add_u64 v[70:71], v[112:113], 0, v[114:115]
    v_lshl_add_u64 v[72:73], v[116:117], 0, v[118:119]
    v_lshl_add_u64 v[74:75], v[120:121], 0, v[122:123]
    s_waitcnt lgkmcnt(7)
    v_or3_b32 v4, v44, v45, v4
    v_or3_b32 v4, v46, v47, v4
    v_or3_b32 v4, v48, v49, v4
    ds_add_rtn_u64 v[44:45], v12, v[70:71]
    ds_add_rtn_u64 v[46:47], v13, v[72:73]
    ds_add_rtn_u64 v[48:49], v14, v[74:75]
    s_waitcnt lgkmcnt(3)
    v_mad_u32_u16 v55, v55, s23, v2
    v_pk_lshrrev_b16 v55, 10, v55 op_sel_hi:[1,1]
    v_lshl_add_u32 v51, v51, 6, v55
    buffer_load_dwordx4 v[12:15], v51, s[44:47], s32 idxen
    s_barrier
    s_waitcnt vmcnt(1)
    ds_write_b128 v3, v[88:91] offset:0
    ds_write_b128 v3, v[92:95] offset:16384
    ds_write_b128 v3, v[96:99] offset:32768
    ds_write_b128 v3, v[100:103] offset:49152
    ds_write_b128 v124, v[104:107] offset:0
    v_mbcnt_lo_u32_b32 v51, s34, 0
    v_mbcnt_hi_u32_b32 v51, s35, v51
    s_bcnt1_i32_b64 s14, s[34:35]
    v_lshl_add_u32 v55, v51, 1, s25
    ds_read_u16 v55, v55
    s_add_u32 s34, s26, 2097152
    s_lshl1_add_u32 s25, s14, s25
    s_lshl_b32 s14, s14, 10
    s_add_u32 s26, s26, s14
    v_bfe_i32 v108, v19, 2, 10
    v_bfe_i32 v109, v19, 12, 10
    v_ashrrev_i32 v110, 22, v19
    v_cvt_f32_i32 v108, v108
    v_cvt_f32_i32 v109, v109
    v_cvt_f32_i32 v110, v110
    v_mfma_f32_4x4x4_16b_bf16 v[112:115], v[58:59], v[76:77], 0
    v_mfma_f32_4x4x4_16b_bf16 v[116:119], v[58:59], v[78:79], 0
    v_mfma_f32_4x4x4_16b_bf16 v[120:123], v[58:59], v[80:81], 0
    v_mad_u32_u16 v16, v16, 8, s50 op_sel:[1,0,0,0]
    v_mad_u32_u16 v17, v17, 8, s50 op_sel:[1,0,0,0]
    v_mad_u32_u16 v18, v18, 8, s50 op_sel:[1,0,0,0]
    v_pk_fma_f32 v[114:115], v[114:115], v[108:109], s[20:21] op_sel:[0,0,0] op_sel_hi:[1,0,1]
    v_pk_fma_f32 v[112:113], v[112:113], v[108:109], s[16:17] op_sel:[0,0,0] op_sel_hi:[1,0,1]
    v_pk_fma_f32 v[118:119], v[118:119], v[108:109], s[20:21] op_sel:[0,1,0] op_sel_hi:[1,1,1]
    v_pk_fma_f32 v[116:117], v[116:117], v[108:109], s[16:17] op_sel:[0,1,0] op_sel_hi:[1,1,1]
    v_pk_fma_f32 v[122:123], v[122:123], v[110:111], s[20:21] op_sel:[0,0,0] op_sel_hi:[1,0,1]
    v_pk_fma_f32 v[120:121], v[120:121], v[110:111], s[16:17] op_sel:[0,0,0] op_sel_hi:[1,0,1]
    v_lshlrev_b64 v[114:115], 16, v[114:115]
    v_lshlrev_b64 v[118:119], 16, v[118:119]
    v_lshlrev_b64 v[122:123], 16, v[122:123]
    v_lshl_add_u64 v[76:77], v[112:113], 0, v[114:115]
    v_lshl_add_u64 v[78:79], v[116:117], 0, v[118:119]
    v_lshl_add_u64 v[80:81], v[120:121], 0, v[122:123]
    s_waitcnt lgkmcnt(6)
    v_or3_b32 v4, v44, v45, v4
    v_or3_b32 v4, v46, v47, v4
    v_or3_b32 v4, v48, v49, v4
    ds_add_rtn_u64 v[44:45], v16, v[76:77]
    ds_add_rtn_u64 v[46:47], v17, v[78:79]
    ds_add_rtn_u64 v[48:49], v18, v[80:81]
    s_waitcnt lgkmcnt(3)
    v_mad_u32_u16 v55, v55, s23, v2
    v_pk_lshrrev_b16 v55, 10, v55 op_sel_hi:[1,1]
    v_lshl_add_u32 v51, v51, 6, v55
    buffer_load_dwordx4 v[16:19], v51, s[44:47], s34 idxen
    s_cmp_le_u32 s51, 256
    s_cbranch_scc1 L_p2_kernel_noopt3_7
    v_bfe_i32 v108, v27, 2, 10
    v_bfe_i32 v109, v27, 12, 10
    v_ashrrev_i32 v110, 22, v27
    v_cvt_f32_i32 v108, v108
    v_cvt_f32_i32 v109, v109
    v_cvt_f32_i32 v110, v110
    v_mfma_f32_4x4x4_16b_bf16 v[112:115], v[58:59], v[64:65], 0
    v_mfma_f32_4x4x4_16b_bf16 v[116:119], v[58:59], v[66:67], 0
    v_mfma_f32_4x4x4_16b_bf16 v[120:123], v[58:59], v[68:69], 0
    v_mad_u32_u16 v24, v24, 8, s50 op_sel:[1,0,0,0]
    v_mad_u32_u16 v25, v25, 8, s50 op_sel:[1,0,0,0]
    v_mad_u32_u16 v26, v26, 8, s50 op_sel:[1,0,0,0]
    v_pk_fma_f32 v[114:115], v[114:115], v[108:109], s[20:21] op_sel:[0,0,0] op_sel_hi:[1,0,1]
    v_pk_fma_f32 v[112:113], v[112:113], v[108:109], s[16:17] op_sel:[0,0,0] op_sel_hi:[1,0,1]
    v_pk_fma_f32 v[118:119], v[118:119], v[108:109], s[20:21] op_sel:[0,1,0] op_sel_hi:[1,1,1]
    v_pk_fma_f32 v[116:117], v[116:117], v[108:109], s[16:17] op_sel:[0,1,0] op_sel_hi:[1,1,1]
    v_pk_fma_f32 v[122:123], v[122:123], v[110:111], s[20:21] op_sel:[0,0,0] op_sel_hi:[1,0,1]
    v_pk_fma_f32 v[120:121], v[120:121], v[110:111], s[16:17] op_sel:[0,0,0] op_sel_hi:[1,0,1]
    v_lshlrev_b64 v[114:115], 16, v[114:115]
    v_lshlrev_b64 v[118:119], 16, v[118:119]
    v_lshlrev_b64 v[122:123], 16, v[122:123]
    v_lshl_add_u64 v[64:65], v[112:113], 0, v[114:115]
    v_lshl_add_u64 v[66:67], v[116:117], 0, v[118:119]
    v_lshl_add_u64 v[68:69], v[120:121], 0, v[122:123]
    s_waitcnt lgkmcnt(0)
    v_or3_b32 v4, v44, v45, v4
    v_or3_b32 v4, v46, v47, v4
    v_or3_b32 v4, v48, v49, v4
    ds_add_rtn_u64 v[44:45], v24, v[64:65]
    ds_add_rtn_u64 v[46:47], v25, v[66:67]
    ds_add_rtn_u64 v[48:49], v26, v[68:69]
L_p2_kernel_noopt3_7:
    v_mbcnt_lo_u32_b32 v51, s36, 0
    v_mbcnt_hi_u32_b32 v51, s37, v51
    s_bcnt1_i32_b64 s14, s[36:37]
    v_lshl_add_u32 v55, v51, 1, s25
    ds_read_u16 v55, v55
    s_add_u32 s36, s26, 3145728
    s_lshl1_add_u32 s25, s14, s25
    s_lshl_b32 s14, s14, 10
    s_add_u32 s26, s26, s14
    s_cmp_le_u32 s28, 256
    s_cbranch_scc1 L_p2_kernel_noopt3_8
    v_readlane_b32 s38, v7, 8
    v_readlane_b32 s39, v7, 9
    s_nop 1
    v_mbcnt_lo_u32_b32 v62, s38, 0
    v_mbcnt_hi_u32_b32 v62, s39, v62
    s_bcnt1_i32_b64 s14, s[38:39]
    v_lshl_add_u32 v63, v62, 1, s25
    ds_read_u16 v63, v63
    s_add_u32 s38, s26, 4194304
    s_lshl1_add_u32 s25, s14, s25
    s_lshl_b32 s14, s14, 10
    s_add_u32 s26, s26, s14
L_p2_kernel_noopt3_8:
    v_bfe_i32 v108, v23, 2, 10
    v_bfe_i32 v109, v23, 12, 10
    v_ashrrev_i32 v110, 22, v23
    v_cvt_f32_i32 v108, v108
    v_cvt_f32_i32 v109, v109
    v_cvt_f32_i32 v110, v110
    v_mfma_f32_4x4x4_16b_bf16 v[112:115], v[58:59], v[82:83], 0
    v_mfma_f32_4x4x4_16b_bf16 v[116:119], v[58:59], v[84:85], 0
    v_mfma_f32_4x4x4_16b_bf16 v[120:123], v[58:59], v[86:87], 0
    v_mad_u32_u16 v20, v20, 8, s50 op_sel:[1,0,0,0]
    v_mad_u32_u16 v21, v21, 8, s50 op_sel:[1,0,0,0]
    v_mad_u32_u16 v22, v22, 8, s50 op_sel:[1,0,0,0]
    v_pk_fma_f32 v[114:115], v[114:115], v[108:109], s[20:21] op_sel:[0,0,0] op_sel_hi:[1,0,1]
    v_pk_fma_f32 v[112:113], v[112:113], v[108:109], s[16:17] op_sel:[0,0,0] op_sel_hi:[1,0,1]
    v_pk_fma_f32 v[118:119], v[118:119], v[108:109], s[20:21] op_sel:[0,1,0] op_sel_hi:[1,1,1]
    v_pk_fma_f32 v[116:117], v[116:117], v[108:109], s[16:17] op_sel:[0,1,0] op_sel_hi:[1,1,1]
    v_pk_fma_f32 v[122:123], v[122:123], v[110:111], s[20:21] op_sel:[0,0,0] op_sel_hi:[1,0,1]
    v_pk_fma_f32 v[120:121], v[120:121], v[110:111], s[16:17] op_sel:[0,0,0] op_sel_hi:[1,0,1]
    v_lshlrev_b64 v[114:115], 16, v[114:115]
    v_lshlrev_b64 v[118:119], 16, v[118:119]
    v_lshlrev_b64 v[122:123], 16, v[122:123]
    v_lshl_add_u64 v[82:83], v[112:113], 0, v[114:115]
    v_lshl_add_u64 v[84:85], v[116:117], 0, v[118:119]
    v_lshl_add_u64 v[86:87], v[120:121], 0, v[122:123]
    s_waitcnt lgkmcnt(1)
    v_or3_b32 v4, v44, v45, v4
    v_or3_b32 v4, v46, v47, v4
    v_or3_b32 v4, v48, v49, v4
    ds_add_rtn_u64 v[44:45], v20, v[82:83]
    ds_add_rtn_u64 v[46:47], v21, v[84:85]
    ds_add_rtn_u64 v[48:49], v22, v[86:87]
    s_waitcnt lgkmcnt(3)
    v_mad_u32_u16 v55, v55, s23, v2
    v_pk_lshrrev_b16 v55, 10, v55 op_sel_hi:[1,1]
    v_lshl_add_u32 v51, v51, 6, v55
    buffer_load_dwordx4 v[20:23], v51, s[44:47], s36 idxen
    s_cmp_le_u32 s28, 256
    s_cbranch_scc1 L_p2_kernel_noopt3_9
    v_mad_u32_u16 v63, v63, s23, v2
    v_pk_lshrrev_b16 v63, 10, v63 op_sel_hi:[1,1]
    v_lshl_add_u32 v62, v62, 6, v63
    buffer_load_dwordx4 v[24:27], v62, s[44:47], s38 idxen
L_p2_kernel_noopt3_9:
    v_mad_u32_u16 v108, v28, v50, s40 op_sel:[1,0,0,0]
    v_mad_u32_u16 v109, v36, v50, s41 op_sel:[1,0,0,0]
    v_sub_u32_sdwa v110, v109, v108 dst_sel:DWORD dst_unused:UNUSED_PAD src0_sel:WORD_1 src1_sel:WORD_1
    s_nop 1
    v_add_u32_dpp v110, v110, v110 row_shr:1 row_mask:0xf bank_mask:0xf bound_ctrl:0
    s_nop 1
    v_add_u32_dpp v110, v110, v110 row_shr:2 row_mask:0xf bank_mask:0xf bound_ctrl:0
    s_nop 1
    v_add_u32_dpp v110, v110, v110 row_shr:4 row_mask:0xf bank_mask:0xf bound_ctrl:0
    s_nop 1
    v_add_u32_dpp v110, v110, v110 row_shr:8 row_mask:0xf bank_mask:0xf bound_ctrl:0
    s_nop 1
    v_add_u32_dpp v110, v110, v110 row_bcast:15 row_mask:0xa bank_mask:0xf
    s_nop 1
    v_add_u32_dpp v110, v110, v110 row_bcast:31 row_mask:0xc bank_mask:0xf
    v_sub_u32_sdwa v109, v109, v110 dst_sel:DWORD dst_unused:UNUSED_PAD src0_sel:WORD_1 src1_sel:DWORD
    v_readlane_b32 s29, v110, 63
    v_add_u32 v110, -1, v110
    ds_write_b16 v126, v109
    v_lshlrev_b32_e64 v111, v110, 1
    v_lshrrev_b32 v110, 5, v110
    v_lshl_add_u32 v110, v110, 2, s19
    s_cmp_gt_u32 s29, 320
    s_cselect_b32 s2, 1, s2
    s_cselect_b64 exec, 0, -1
    ds_or_b32 v110, v111 offset:160
    s_mov_b64 exec, -1
    ds_wrxchg_rtn_b32 v7, v6, v5 offset:160
    s_add_u32 s14, s22, 80000
    buffer_load_dwordx4 v[88:91], v1, s[8:11], s14 offen
    s_add_u32 s14, s22, 96384
    buffer_load_dwordx4 v[92:95], v1, s[8:11], s14 offen
    s_add_u32 s24, s24, 1
    s_cmp_lt_u32 s24, 8
    s_barrier
    s_cbranch_scc1 L_p2_loop
    s_waitcnt lgkmcnt(3)
    v_or3_b32 v4, v44, v45, v4
    v_or3_b32 v4, v46, v47, v4
    v_or3_b32 v4, v48, v49, v4
    s_mov_b32 s27, s19
    s_waitcnt vmcnt(0)
    v_mov_b32 v8, 160232
    s_cmp_lg_u32 s13, 0
    s_cselect_b64 exec, 0, 1
    ds_write_b32 v8, v52
    s_mov_b64 exec, -1
    v_subrev_u32 v6, 80000, v124
    s_mul_i32 s24, s12, 20000
    v_subrev_u32 v10, s24, v1
    v_mov_b32 v11, 0x7f000000
    s_waitcnt vmcnt(0) lgkmcnt(0)
    s_barrier
    s_cmp_lt_u32 s13, 4
    s_cbranch_scc1 L_p2_ga
    v_lshlrev_b32 v30, 16, v60
    v_and_b32 v31, 0xffff0000, v60
    v_lshlrev_b32 v36, 16, v53
    v_and_b32 v37, 0xffff0000, v53
    v_lshlrev_b32 v38, 16, v54
    v_and_b32 v39, 0xffff0000, v54
    v_lshlrev_b32 v40, 16, v56
    v_and_b32 v41, 0xffff0000, v56
    v_lshlrev_b32 v42, 16, v57
    v_and_b32 v43, 0xffff0000, v57
    v_pk_add_f32 v[14:15], v[30:31], v[36:37] op_sel:[0,0] op_sel_hi:[1,0] neg_lo:[0,1] neg_hi:[0,1]
    v_pk_add_f32 v[16:17], v[30:31], v[36:37] op_sel:[0,1] op_sel_hi:[1,1] neg_lo:[0,1] neg_hi:[0,1]
    v_pk_add_f32 v[18:19], v[30:31], v[38:39] op_sel:[0,0] op_sel_hi:[1,0] neg_lo:[0,1] neg_hi:[0,1]
    v_pk_add_f32 v[20:21], v[30:31], v[38:39] op_sel:[0,1] op_sel_hi:[1,1] neg_lo:[0,1] neg_hi:[0,1]
    v_pk_add_f32 v[22:23], v[30:31], v[40:41] op_sel:[0,0] op_sel_hi:[1,0] neg_lo:[0,1] neg_hi:[0,1]
    v_pk_add_f32 v[24:25], v[30:31], v[40:41] op_sel:[0,1] op_sel_hi:[1,1] neg_lo:[0,1] neg_hi:[0,1]
    v_pk_add_f32 v[26:27], v[30:31], v[42:43] op_sel:[0,0] op_sel_hi:[1,0] neg_lo:[0,1] neg_hi:[0,1]
    v_pk_add_f32 v[28:29], v[30:31], v[42:43] op_sel:[0,1] op_sel_hi:[1,1] neg_lo:[0,1] neg_hi:[0,1]
    v_cvt_pk_bf16_f32 v32, v14, v15
    v_lshlrev_b32 v14, 16, v32
    v_and_b32 v15, 0xffff0000, v32
    v_cvt_pk_bf16_f32 v32, v16, v17
    v_lshlrev_b32 v16, 16, v32
    v_and_b32 v17, 0xffff0000, v32
    v_cvt_pk_bf16_f32 v32, v18, v19
    v_lshlrev_b32 v18, 16, v32
    v_and_b32 v19, 0xffff0000, v32
    v_cvt_pk_bf16_f32 v32, v20, v21
    v_lshlrev_b32 v20, 16, v32
    v_and_b32 v21, 0xffff0000, v32
    v_cvt_pk_bf16_f32 v32, v22, v23
    v_lshlrev_b32 v22, 16, v32
    v_and_b32 v23, 0xffff0000, v32
    v_cvt_pk_bf16_f32 v32, v24, v25
    v_lshlrev_b32 v24, 16, v32
    v_and_b32 v25, 0xffff0000, v32
    v_cvt_pk_bf16_f32 v32, v26, v27
    v_lshlrev_b32 v26, 16, v32
    v_and_b32 v27, 0xffff0000, v32
    v_cvt_pk_bf16_f32 v32, v28, v29
    v_lshlrev_b32 v28, 16, v32
    v_and_b32 v29, 0xffff0000, v32
    v_pk_mul_f32 v[14:15], v[14:15], v[14:15]
    v_pk_mul_f32 v[16:17], v[16:17], v[16:17]
    v_pk_mul_f32 v[18:19], v[18:19], v[18:19]
    v_pk_mul_f32 v[20:21], v[20:21], v[20:21]
    v_pk_mul_f32 v[22:23], v[22:23], v[22:23]
    v_pk_mul_f32 v[24:25], v[24:25], v[24:25]
    v_pk_mul_f32 v[26:27], v[26:27], v[26:27]
    v_pk_mul_f32 v[28:29], v[28:29], v[28:29]
    v_cvt_pk_bf16_f32 v32, v14, v15
    v_lshlrev_b32 v14, 16, v32
    v_and_b32 v15, 0xffff0000, v32
    v_cvt_pk_bf16_f32 v32, v16, v17
    v_lshlrev_b32 v16, 16, v32
    v_and_b32 v17, 0xffff0000, v32
    v_cvt_pk_bf16_f32 v32, v18, v19
    v_lshlrev_b32 v18, 16, v32
    v_and_b32 v19, 0xffff0000, v32
    v_cvt_pk_bf16_f32 v32, v20, v21
    v_lshlrev_b32 v20, 16, v32
    v_and_b32 v21, 0xffff0000, v32
    v_cvt_pk_bf16_f32 v32, v22, v23
    v_lshlrev_b32 v22, 16, v32
    v_and_b32 v23, 0xffff0000, v32
    v_cvt_pk_bf16_f32 v32, v24, v25
    v_lshlrev_b32 v24, 16, v32
    v_and_b32 v25, 0xffff0000, v32
    v_cvt_pk_bf16_f32 v32, v26, v27
    v_lshlrev_b32 v26, 16, v32
    v_and_b32 v27, 0xffff0000, v32
    v_cvt_pk_bf16_f32 v32, v28, v29
    v_lshlrev_b32 v28, 16, v32
    v_and_b32 v29, 0xffff0000, v32
    v_mov_b32 v30, 1092616192
    v_mov_b32 v31, 0x3fb8aa3b
    v_pk_mul_f32 v[14:15], v[14:15], v[30:31] op_sel:[0,0] op_sel_hi:[1,0]
    v_pk_mul_f32 v[16:17], v[16:17], v[30:31] op_sel:[0,0] op_sel_hi:[1,0]
    v_pk_mul_f32 v[18:19], v[18:19], v[30:31] op_sel:[0,0] op_sel_hi:[1,0]
    v_pk_mul_f32 v[20:21], v[20:21], v[30:31] op_sel:[0,0] op_sel_hi:[1,0]
    v_pk_mul_f32 v[22:23], v[22:23], v[30:31] op_sel:[0,0] op_sel_hi:[1,0]
    v_pk_mul_f32 v[24:25], v[24:25], v[30:31] op_sel:[0,0] op_sel_hi:[1,0]
    v_pk_mul_f32 v[26:27], v[26:27], v[30:31] op_sel:[0,0] op_sel_hi:[1,0]
    v_pk_mul_f32 v[28:29], v[28:29], v[30:31] op_sel:[0,0] op_sel_hi:[1,0]
    v_cvt_pk_bf16_f32 v32, v14, v15
    v_lshlrev_b32 v14, 16, v32
    v_and_b32 v15, 0xffff0000, v32
    v_cvt_pk_bf16_f32 v32, v16, v17
    v_lshlrev_b32 v16, 16, v32
    v_and_b32 v17, 0xffff0000, v32
    v_cvt_pk_bf16_f32 v32, v18, v19
    v_lshlrev_b32 v18, 16, v32
    v_and_b32 v19, 0xffff0000, v32
    v_cvt_pk_bf16_f32 v32, v20, v21
    v_lshlrev_b32 v20, 16, v32
    v_and_b32 v21, 0xffff0000, v32
    v_cvt_pk_bf16_f32 v32, v22, v23
    v_lshlrev_b32 v22, 16, v32
    v_and_b32 v23, 0xffff0000, v32
    v_cvt_pk_bf16_f32 v32, v24, v25
    v_lshlrev_b32 v24, 16, v32
    v_and_b32 v25, 0xffff0000, v32
    v_cvt_pk_bf16_f32 v32, v26, v27
    v_lshlrev_b32 v26, 16, v32
    v_and_b32 v27, 0xffff0000, v32
    v_cvt_pk_bf16_f32 v32, v28, v29
    v_lshlrev_b32 v28, 16, v32
    v_and_b32 v29, 0xffff0000, v32
    v_pk_mul_f32 v[14:15], v[14:15], v[30:31] op_sel:[0,1] op_sel_hi:[1,1]
    v_pk_mul_f32 v[16:17], v[16:17], v[30:31] op_sel:[0,1] op_sel_hi:[1,1]
    v_pk_mul_f32 v[18:19], v[18:19], v[30:31] op_sel:[0,1] op_sel_hi:[1,1]
    v_pk_mul_f32 v[20:21], v[20:21], v[30:31] op_sel:[0,1] op_sel_hi:[1,1]
    v_pk_mul_f32 v[22:23], v[22:23], v[30:31] op_sel:[0,1] op_sel_hi:[1,1]
    v_pk_mul_f32 v[24:25], v[24:25], v[30:31] op_sel:[0,1] op_sel_hi:[1,1]
    v_pk_mul_f32 v[26:27], v[26:27], v[30:31] op_sel:[0,1] op_sel_hi:[1,1]
    v_pk_mul_f32 v[28:29], v[28:29], v[30:31] op_sel:[0,1] op_sel_hi:[1,1]
    v_exp_f32 v14, -v14
    v_exp_f32 v15, -v15
    v_exp_f32 v16, -v16
    v_exp_f32 v17, -v17
    v_exp_f32 v18, -v18
    v_exp_f32 v19, -v19
    v_exp_f32 v20, -v20
    v_exp_f32 v21, -v21
    v_exp_f32 v22, -v22
    v_exp_f32 v23, -v23
    v_exp_f32 v24, -v24
    v_exp_f32 v25, -v25
    v_exp_f32 v26, -v26
    v_exp_f32 v27, -v27
    v_exp_f32 v28, -v28
    v_exp_f32 v29, -v29
    v_cvt_pk_bf16_f32 v14, v14, v16
    v_cvt_pk_bf16_f32 v15, v15, v17
    v_cvt_pk_bf16_f32 v18, v18, v20
    v_cvt_pk_bf16_f32 v19, v19, v21
    v_cvt_pk_bf16_f32 v22, v22, v24
    v_cvt_pk_bf16_f32 v23, v23, v25
    v_cvt_pk_bf16_f32 v26, v26, v28
    v_cvt_pk_bf16_f32 v27, v27, v29
    v_dot2_f32_bf16 v72, v14, s68, 0
    v_dot2_f32_bf16 v73, v15, s68, 0
    v_dot2_f32_bf16 v74, v14, s69, 0
    v_dot2_f32_bf16 v75, v15, s69, 0
    v_dot2_f32_bf16 v76, v14, s70, 0
    v_dot2_f32_bf16 v77, v15, s70, 0
    v_dot2_f32_bf16 v78, v14, s71, 0
    v_dot2_f32_bf16 v79, v15, s71, 0
    v_dot2_f32_bf16 v80, v14, s52, 0
    v_dot2_f32_bf16 v81, v15, s52, 0
    v_dot2_f32_bf16 v82, v14, s53, 0
    v_dot2_f32_bf16 v83, v15, s53, 0
    v_dot2_f32_bf16 v84, v14, s54, 0
    v_dot2_f32_bf16 v85, v15, s54, 0
    v_dot2_f32_bf16 v86, v14, s55, 0
    v_dot2_f32_bf16 v87, v15, s55, 0
    v_dot2_f32_bf16 v72, v18, s72, v72
    v_dot2_f32_bf16 v73, v19, s72, v73
    v_dot2_f32_bf16 v74, v18, s73, v74
    v_dot2_f32_bf16 v75, v19, s73, v75
    v_dot2_f32_bf16 v76, v18, s74, v76
    v_dot2_f32_bf16 v77, v19, s74, v77
    v_dot2_f32_bf16 v78, v18, s75, v78
    v_dot2_f32_bf16 v79, v19, s75, v79
    v_dot2_f32_bf16 v80, v18, s56, v80
    v_dot2_f32_bf16 v81, v19, s56, v81
    v_dot2_f32_bf16 v82, v18, s57, v82
    v_dot2_f32_bf16 v83, v19, s57, v83
    v_dot2_f32_bf16 v84, v18, s58, v84
    v_dot2_f32_bf16 v85, v19, s58, v85
    v_dot2_f32_bf16 v86, v18, s59, v86
    v_dot2_f32_bf16 v87, v19, s59, v87
    v_dot2_f32_bf16 v72, v22, s76, v72
    v_dot2_f32_bf16 v73, v23, s76, v73
    v_dot2_f32_bf16 v74, v22, s77, v74
    v_dot2_f32_bf16 v75, v23, s77, v75
    v_dot2_f32_bf16 v76, v22, s78, v76
    v_dot2_f32_bf16 v77, v23, s78, v77
    v_dot2_f32_bf16 v78, v22, s79, v78
    v_dot2_f32_bf16 v79, v23, s79, v79
    v_dot2_f32_bf16 v80, v22, s60, v80
    v_dot2_f32_bf16 v81, v23, s60, v81
    v_dot2_f32_bf16 v82, v22, s61, v82
    v_dot2_f32_bf16 v83, v23, s61, v83
    v_dot2_f32_bf16 v84, v22, s62, v84
    v_dot2_f32_bf16 v85, v23, s62, v85
    v_dot2_f32_bf16 v86, v22, s63, v86
    v_dot2_f32_bf16 v87, v23, s63, v87
    v_dot2_f32_bf16 v72, v26, s80, v72
    v_dot2_f32_bf16 v73, v27, s80, v73
    v_dot2_f32_bf16 v74, v26, s81, v74
    v_dot2_f32_bf16 v75, v27, s81, v75
    v_dot2_f32_bf16 v76, v26, s82, v76
    v_dot2_f32_bf16 v77, v27, s82, v77
    v_dot2_f32_bf16 v78, v26, s83, v78
    v_dot2_f32_bf16 v79, v27, s83, v79
    v_dot2_f32_bf16 v80, v26, s64, v80
    v_dot2_f32_bf16 v81, v27, s64, v81
    v_dot2_f32_bf16 v82, v26, s65, v82
    v_dot2_f32_bf16 v83, v27, s65, v83
    v_dot2_f32_bf16 v84, v26, s66, v84
    v_dot2_f32_bf16 v85, v27, s66, v85
    v_dot2_f32_bf16 v86, v26, s67, v86
    v_dot2_f32_bf16 v87, v27, s67, v87
L_p2_ga:
    ds_read_b32 v9, v8
    ds_read_b128 v[88:91], v1 offset:0
    ds_read_b128 v[92:95], v1 offset:16384
    ds_read_b128 v[96:99], v1 offset:32768
    ds_read_b128 v[100:103], v1 offset:49152
    ds_read_b128 v[104:107], v6
    s_mul_i32 s14, s12, 5120000
    s_mul_i32 s15, s3, 80000
    s_add_u32 s25, s14, s15
    s_add_u32 s25, s25, 228589568
    s_waitcnt lgkmcnt(5)
    v_readfirstlane_b32 s21, v9
    s_nop 0
    s_bfe_u32 s21, s21, 524296
    s_cmp_lg_u32 s21, 4
    s_cselect_b32 s21, 1, 0
    s_cselect_b32 s24, 0, 20000
    v_cmp_le_u32 vcc, s24, v10
    v_add_u32 v10, 16384, v10
    s_add_u32 s14, s25, 0
    v_cndmask_b32 v12, v11, v1, vcc
    s_waitcnt lgkmcnt(4)
    buffer_store_dwordx4 v[88:91], v12, s[4:7], s14 offen sc1
    v_or3_b32 v4, v88, v89, v4
    v_or3_b32 v4, v90, v91, v4
    v_cmp_le_u32 vcc, s24, v10
    v_add_u32 v10, 16384, v10
    s_add_u32 s14, s25, 16384
    v_cndmask_b32 v12, v11, v1, vcc
    s_waitcnt lgkmcnt(3)
    buffer_store_dwordx4 v[92:95], v12, s[4:7], s14 offen sc1
    v_or3_b32 v4, v92, v93, v4
    v_or3_b32 v4, v94, v95, v4
    v_cmp_le_u32 vcc, s24, v10
    v_add_u32 v10, 16384, v10
    s_add_u32 s14, s25, 32768
    v_cndmask_b32 v12, v11, v1, vcc
    s_waitcnt lgkmcnt(2)
    buffer_store_dwordx4 v[96:99], v12, s[4:7], s14 offen sc1
    v_or3_b32 v4, v96, v97, v4
    v_or3_b32 v4, v98, v99, v4
    v_cmp_le_u32 vcc, s24, v10
    v_add_u32 v10, 16384, v10
    s_add_u32 s14, s25, 49152
    v_cndmask_b32 v12, v11, v1, vcc
    s_waitcnt lgkmcnt(1)
    buffer_store_dwordx4 v[100:103], v12, s[4:7], s14 offen sc1
    v_or3_b32 v4, v100, v101, v4
    v_or3_b32 v4, v102, v103, v4
    v_cmp_le_u32 vcc, s24, v10
    v_add_u32 v10, 16384, v10
    s_add_u32 s14, s25, 0
    v_cndmask_b32 v12, v11, v6, vcc
    s_waitcnt lgkmcnt(0)
    buffer_store_dwordx4 v[104:107], v12, s[4:7], s14 offen sc1
    v_or3_b32 v4, v104, v105, v4
    v_or3_b32 v4, v106, v107, v4
    s_load_dwordx2 s[16:17], s[0:1], 88
    s_cmp_ge_u32 s13, 4
    s_cbranch_scc1 L_p2_gb
    v_lshlrev_b32 v30, 16, v60
    v_and_b32 v31, 0xffff0000, v60
    v_lshlrev_b32 v36, 16, v53
    v_and_b32 v37, 0xffff0000, v53
    v_lshlrev_b32 v38, 16, v54
    v_and_b32 v39, 0xffff0000, v54
    v_lshlrev_b32 v40, 16, v56
    v_and_b32 v41, 0xffff0000, v56
    v_lshlrev_b32 v42, 16, v57
    v_and_b32 v43, 0xffff0000, v57
    v_pk_add_f32 v[14:15], v[30:31], v[36:37] op_sel:[0,0] op_sel_hi:[1,0] neg_lo:[0,1] neg_hi:[0,1]
    v_pk_add_f32 v[16:17], v[30:31], v[36:37] op_sel:[0,1] op_sel_hi:[1,1] neg_lo:[0,1] neg_hi:[0,1]
    v_pk_add_f32 v[18:19], v[30:31], v[38:39] op_sel:[0,0] op_sel_hi:[1,0] neg_lo:[0,1] neg_hi:[0,1]
    v_pk_add_f32 v[20:21], v[30:31], v[38:39] op_sel:[0,1] op_sel_hi:[1,1] neg_lo:[0,1] neg_hi:[0,1]
    v_pk_add_f32 v[22:23], v[30:31], v[40:41] op_sel:[0,0] op_sel_hi:[1,0] neg_lo:[0,1] neg_hi:[0,1]
    v_pk_add_f32 v[24:25], v[30:31], v[40:41] op_sel:[0,1] op_sel_hi:[1,1] neg_lo:[0,1] neg_hi:[0,1]
    v_pk_add_f32 v[26:27], v[30:31], v[42:43] op_sel:[0,0] op_sel_hi:[1,0] neg_lo:[0,1] neg_hi:[0,1]
    v_pk_add_f32 v[28:29], v[30:31], v[42:43] op_sel:[0,1] op_sel_hi:[1,1] neg_lo:[0,1] neg_hi:[0,1]
    v_cvt_pk_bf16_f32 v32, v14, v15
    v_lshlrev_b32 v14, 16, v32
    v_and_b32 v15, 0xffff0000, v32
    v_cvt_pk_bf16_f32 v32, v16, v17
    v_lshlrev_b32 v16, 16, v32
    v_and_b32 v17, 0xffff0000, v32
    v_cvt_pk_bf16_f32 v32, v18, v19
    v_lshlrev_b32 v18, 16, v32
    v_and_b32 v19, 0xffff0000, v32
    v_cvt_pk_bf16_f32 v32, v20, v21
    v_lshlrev_b32 v20, 16, v32
    v_and_b32 v21, 0xffff0000, v32
    v_cvt_pk_bf16_f32 v32, v22, v23
    v_lshlrev_b32 v22, 16, v32
    v_and_b32 v23, 0xffff0000, v32
    v_cvt_pk_bf16_f32 v32, v24, v25
    v_lshlrev_b32 v24, 16, v32
    v_and_b32 v25, 0xffff0000, v32
    v_cvt_pk_bf16_f32 v32, v26, v27
    v_lshlrev_b32 v26, 16, v32
    v_and_b32 v27, 0xffff0000, v32
    v_cvt_pk_bf16_f32 v32, v28, v29
    v_lshlrev_b32 v28, 16, v32
    v_and_b32 v29, 0xffff0000, v32
    v_pk_mul_f32 v[14:15], v[14:15], v[14:15]
    v_pk_mul_f32 v[16:17], v[16:17], v[16:17]
    v_pk_mul_f32 v[18:19], v[18:19], v[18:19]
    v_pk_mul_f32 v[20:21], v[20:21], v[20:21]
    v_pk_mul_f32 v[22:23], v[22:23], v[22:23]
    v_pk_mul_f32 v[24:25], v[24:25], v[24:25]
    v_pk_mul_f32 v[26:27], v[26:27], v[26:27]
    v_pk_mul_f32 v[28:29], v[28:29], v[28:29]
    v_cvt_pk_bf16_f32 v32, v14, v15
    v_lshlrev_b32 v14, 16, v32
    v_and_b32 v15, 0xffff0000, v32
    v_cvt_pk_bf16_f32 v32, v16, v17
    v_lshlrev_b32 v16, 16, v32
    v_and_b32 v17, 0xffff0000, v32
    v_cvt_pk_bf16_f32 v32, v18, v19
    v_lshlrev_b32 v18, 16, v32
    v_and_b32 v19, 0xffff0000, v32
    v_cvt_pk_bf16_f32 v32, v20, v21
    v_lshlrev_b32 v20, 16, v32
    v_and_b32 v21, 0xffff0000, v32
    v_cvt_pk_bf16_f32 v32, v22, v23
    v_lshlrev_b32 v22, 16, v32
    v_and_b32 v23, 0xffff0000, v32
    v_cvt_pk_bf16_f32 v32, v24, v25
    v_lshlrev_b32 v24, 16, v32
    v_and_b32 v25, 0xffff0000, v32
    v_cvt_pk_bf16_f32 v32, v26, v27
    v_lshlrev_b32 v26, 16, v32
    v_and_b32 v27, 0xffff0000, v32
    v_cvt_pk_bf16_f32 v32, v28, v29
    v_lshlrev_b32 v28, 16, v32
    v_and_b32 v29, 0xffff0000, v32
    v_mov_b32 v30, 1092616192
    v_mov_b32 v31, 0x3fb8aa3b
    v_pk_mul_f32 v[14:15], v[14:15], v[30:31] op_sel:[0,0] op_sel_hi:[1,0]
    v_pk_mul_f32 v[16:17], v[16:17], v[30:31] op_sel:[0,0] op_sel_hi:[1,0]
    v_pk_mul_f32 v[18:19], v[18:19], v[30:31] op_sel:[0,0] op_sel_hi:[1,0]
    v_pk_mul_f32 v[20:21], v[20:21], v[30:31] op_sel:[0,0] op_sel_hi:[1,0]
    v_pk_mul_f32 v[22:23], v[22:23], v[30:31] op_sel:[0,0] op_sel_hi:[1,0]
    v_pk_mul_f32 v[24:25], v[24:25], v[30:31] op_sel:[0,0] op_sel_hi:[1,0]
    v_pk_mul_f32 v[26:27], v[26:27], v[30:31] op_sel:[0,0] op_sel_hi:[1,0]
    v_pk_mul_f32 v[28:29], v[28:29], v[30:31] op_sel:[0,0] op_sel_hi:[1,0]
    v_cvt_pk_bf16_f32 v32, v14, v15
    v_lshlrev_b32 v14, 16, v32
    v_and_b32 v15, 0xffff0000, v32
    v_cvt_pk_bf16_f32 v32, v16, v17
    v_lshlrev_b32 v16, 16, v32
    v_and_b32 v17, 0xffff0000, v32
    v_cvt_pk_bf16_f32 v32, v18, v19
    v_lshlrev_b32 v18, 16, v32
    v_and_b32 v19, 0xffff0000, v32
    v_cvt_pk_bf16_f32 v32, v20, v21
    v_lshlrev_b32 v20, 16, v32
    v_and_b32 v21, 0xffff0000, v32
    v_cvt_pk_bf16_f32 v32, v22, v23
    v_lshlrev_b32 v22, 16, v32
    v_and_b32 v23, 0xffff0000, v32
    v_cvt_pk_bf16_f32 v32, v24, v25
    v_lshlrev_b32 v24, 16, v32
    v_and_b32 v25, 0xffff0000, v32
    v_cvt_pk_bf16_f32 v32, v26, v27
    v_lshlrev_b32 v26, 16, v32
    v_and_b32 v27, 0xffff0000, v32
    v_cvt_pk_bf16_f32 v32, v28, v29
    v_lshlrev_b32 v28, 16, v32
    v_and_b32 v29, 0xffff0000, v32
    v_pk_mul_f32 v[14:15], v[14:15], v[30:31] op_sel:[0,1] op_sel_hi:[1,1]
    v_pk_mul_f32 v[16:17], v[16:17], v[30:31] op_sel:[0,1] op_sel_hi:[1,1]
    v_pk_mul_f32 v[18:19], v[18:19], v[30:31] op_sel:[0,1] op_sel_hi:[1,1]
    v_pk_mul_f32 v[20:21], v[20:21], v[30:31] op_sel:[0,1] op_sel_hi:[1,1]
    v_pk_mul_f32 v[22:23], v[22:23], v[30:31] op_sel:[0,1] op_sel_hi:[1,1]
    v_pk_mul_f32 v[24:25], v[24:25], v[30:31] op_sel:[0,1] op_sel_hi:[1,1]
    v_pk_mul_f32 v[26:27], v[26:27], v[30:31] op_sel:[0,1] op_sel_hi:[1,1]
    v_pk_mul_f32 v[28:29], v[28:29], v[30:31] op_sel:[0,1] op_sel_hi:[1,1]
    v_exp_f32 v14, -v14
    v_exp_f32 v15, -v15
    v_exp_f32 v16, -v16
    v_exp_f32 v17, -v17
    v_exp_f32 v18, -v18
    v_exp_f32 v19, -v19
    v_exp_f32 v20, -v20
    v_exp_f32 v21, -v21
    v_exp_f32 v22, -v22
    v_exp_f32 v23, -v23
    v_exp_f32 v24, -v24
    v_exp_f32 v25, -v25
    v_exp_f32 v26, -v26
    v_exp_f32 v27, -v27
    v_exp_f32 v28, -v28
    v_exp_f32 v29, -v29
    v_cvt_pk_bf16_f32 v14, v14, v16
    v_cvt_pk_bf16_f32 v15, v15, v17
    v_cvt_pk_bf16_f32 v18, v18, v20
    v_cvt_pk_bf16_f32 v19, v19, v21
    v_cvt_pk_bf16_f32 v22, v22, v24
    v_cvt_pk_bf16_f32 v23, v23, v25
    v_cvt_pk_bf16_f32 v26, v26, v28
    v_cvt_pk_bf16_f32 v27, v27, v29
    v_dot2_f32_bf16 v72, v14, s68, 0
    v_dot2_f32_bf16 v73, v15, s68, 0
    v_dot2_f32_bf16 v74, v14, s69, 0
    v_dot2_f32_bf16 v75, v15, s69, 0
    v_dot2_f32_bf16 v76, v14, s70, 0
    v_dot2_f32_bf16 v77, v15, s70, 0
    v_dot2_f32_bf16 v78, v14, s71, 0
    v_dot2_f32_bf16 v79, v15, s71, 0
    v_dot2_f32_bf16 v80, v14, s52, 0
    v_dot2_f32_bf16 v81, v15, s52, 0
    v_dot2_f32_bf16 v82, v14, s53, 0
    v_dot2_f32_bf16 v83, v15, s53, 0
    v_dot2_f32_bf16 v84, v14, s54, 0
    v_dot2_f32_bf16 v85, v15, s54, 0
    v_dot2_f32_bf16 v86, v14, s55, 0
    v_dot2_f32_bf16 v87, v15, s55, 0
    v_dot2_f32_bf16 v72, v18, s72, v72
    v_dot2_f32_bf16 v73, v19, s72, v73
    v_dot2_f32_bf16 v74, v18, s73, v74
    v_dot2_f32_bf16 v75, v19, s73, v75
    v_dot2_f32_bf16 v76, v18, s74, v76
    v_dot2_f32_bf16 v77, v19, s74, v77
    v_dot2_f32_bf16 v78, v18, s75, v78
    v_dot2_f32_bf16 v79, v19, s75, v79
    v_dot2_f32_bf16 v80, v18, s56, v80
    v_dot2_f32_bf16 v81, v19, s56, v81
    v_dot2_f32_bf16 v82, v18, s57, v82
    v_dot2_f32_bf16 v83, v19, s57, v83
    v_dot2_f32_bf16 v84, v18, s58, v84
    v_dot2_f32_bf16 v85, v19, s58, v85
    v_dot2_f32_bf16 v86, v18, s59, v86
    v_dot2_f32_bf16 v87, v19, s59, v87
    v_dot2_f32_bf16 v72, v22, s76, v72
    v_dot2_f32_bf16 v73, v23, s76, v73
    v_dot2_f32_bf16 v74, v22, s77, v74
    v_dot2_f32_bf16 v75, v23, s77, v75
    v_dot2_f32_bf16 v76, v22, s78, v76
    v_dot2_f32_bf16 v77, v23, s78, v77
    v_dot2_f32_bf16 v78, v22, s79, v78
    v_dot2_f32_bf16 v79, v23, s79, v79
    v_dot2_f32_bf16 v80, v22, s60, v80
    v_dot2_f32_bf16 v81, v23, s60, v81
    v_dot2_f32_bf16 v82, v22, s61, v82
    v_dot2_f32_bf16 v83, v23, s61, v83
    v_dot2_f32_bf16 v84, v22, s62, v84
    v_dot2_f32_bf16 v85, v23, s62, v85
    v_dot2_f32_bf16 v86, v22, s63, v86
    v_dot2_f32_bf16 v87, v23, s63, v87
    v_dot2_f32_bf16 v72, v26, s80, v72
    v_dot2_f32_bf16 v73, v27, s80, v73
    v_dot2_f32_bf16 v74, v26, s81, v74
    v_dot2_f32_bf16 v75, v27, s81, v75
    v_dot2_f32_bf16 v76, v26, s82, v76
    v_dot2_f32_bf16 v77, v27, s82, v77
    v_dot2_f32_bf16 v78, v26, s83, v78
    v_dot2_f32_bf16 v79, v27, s83, v79
    v_dot2_f32_bf16 v80, v26, s64, v80
    v_dot2_f32_bf16 v81, v27, s64, v81
    v_dot2_f32_bf16 v82, v26, s65, v82
    v_dot2_f32_bf16 v83, v27, s65, v83
    v_dot2_f32_bf16 v84, v26, s66, v84
    v_dot2_f32_bf16 v85, v27, s66, v85
    v_dot2_f32_bf16 v86, v26, s67, v86
    v_dot2_f32_bf16 v87, v27, s67, v87
    s_cmp_ge_u32 s13, 4
    s_cbranch_scc1 L_p2_kernel_g1_10
    v_lshlrev_b32 v30, 16, v61
    v_and_b32 v31, 0xffff0000, v61
    v_pk_add_f32 v[14:15], v[30:31], v[36:37] op_sel:[0,0] op_sel_hi:[1,0] neg_lo:[0,1] neg_hi:[0,1]
    v_pk_add_f32 v[16:17], v[30:31], v[36:37] op_sel:[0,1] op_sel_hi:[1,1] neg_lo:[0,1] neg_hi:[0,1]
    v_pk_add_f32 v[18:19], v[30:31], v[38:39] op_sel:[0,0] op_sel_hi:[1,0] neg_lo:[0,1] neg_hi:[0,1]
    v_pk_add_f32 v[20:21], v[30:31], v[38:39] op_sel:[0,1] op_sel_hi:[1,1] neg_lo:[0,1] neg_hi:[0,1]
    v_pk_add_f32 v[22:23], v[30:31], v[40:41] op_sel:[0,0] op_sel_hi:[1,0] neg_lo:[0,1] neg_hi:[0,1]
    v_pk_add_f32 v[24:25], v[30:31], v[40:41] op_sel:[0,1] op_sel_hi:[1,1] neg_lo:[0,1] neg_hi:[0,1]
    v_pk_add_f32 v[26:27], v[30:31], v[42:43] op_sel:[0,0] op_sel_hi:[1,0] neg_lo:[0,1] neg_hi:[0,1]
    v_pk_add_f32 v[28:29], v[30:31], v[42:43] op_sel:[0,1] op_sel_hi:[1,1] neg_lo:[0,1] neg_hi:[0,1]
    v_cvt_pk_bf16_f32 v32, v14, v15
    v_lshlrev_b32 v14, 16, v32
    v_and_b32 v15, 0xffff0000, v32
    v_cvt_pk_bf16_f32 v32, v16, v17
    v_lshlrev_b32 v16, 16, v32
    v_and_b32 v17, 0xffff0000, v32
    v_cvt_pk_bf16_f32 v32, v18, v19
    v_lshlrev_b32 v18, 16, v32
    v_and_b32 v19, 0xffff0000, v32
    v_cvt_pk_bf16_f32 v32, v20, v21
    v_lshlrev_b32 v20, 16, v32
    v_and_b32 v21, 0xffff0000, v32
    v_cvt_pk_bf16_f32 v32, v22, v23
    v_lshlrev_b32 v22, 16, v32
    v_and_b32 v23, 0xffff0000, v32
    v_cvt_pk_bf16_f32 v32, v24, v25
    v_lshlrev_b32 v24, 16, v32
    v_and_b32 v25, 0xffff0000, v32
    v_cvt_pk_bf16_f32 v32, v26, v27
    v_lshlrev_b32 v26, 16, v32
    v_and_b32 v27, 0xffff0000, v32
    v_cvt_pk_bf16_f32 v32, v28, v29
    v_lshlrev_b32 v28, 16, v32
    v_and_b32 v29, 0xffff0000, v32
    v_pk_mul_f32 v[14:15], v[14:15], v[14:15]
    v_pk_mul_f32 v[16:17], v[16:17], v[16:17]
    v_pk_mul_f32 v[18:19], v[18:19], v[18:19]
    v_pk_mul_f32 v[20:21], v[20:21], v[20:21]
    v_pk_mul_f32 v[22:23], v[22:23], v[22:23]
    v_pk_mul_f32 v[24:25], v[24:25], v[24:25]
    v_pk_mul_f32 v[26:27], v[26:27], v[26:27]
    v_pk_mul_f32 v[28:29], v[28:29], v[28:29]
    v_cvt_pk_bf16_f32 v32, v14, v15
    v_lshlrev_b32 v14, 16, v32
    v_and_b32 v15, 0xffff0000, v32
    v_cvt_pk_bf16_f32 v32, v16, v17
    v_lshlrev_b32 v16, 16, v32
    v_and_b32 v17, 0xffff0000, v32
    v_cvt_pk_bf16_f32 v32, v18, v19
    v_lshlrev_b32 v18, 16, v32
    v_and_b32 v19, 0xffff0000, v32
    v_cvt_pk_bf16_f32 v32, v20, v21
    v_lshlrev_b32 v20, 16, v32
    v_and_b32 v21, 0xffff0000, v32
    v_cvt_pk_bf16_f32 v32, v22, v23
    v_lshlrev_b32 v22, 16, v32
    v_and_b32 v23, 0xffff0000, v32
    v_cvt_pk_bf16_f32 v32, v24, v25
    v_lshlrev_b32 v24, 16, v32
    v_and_b32 v25, 0xffff0000, v32
    v_cvt_pk_bf16_f32 v32, v26, v27
    v_lshlrev_b32 v26, 16, v32
    v_and_b32 v27, 0xffff0000, v32
    v_cvt_pk_bf16_f32 v32, v28, v29
    v_lshlrev_b32 v28, 16, v32
    v_and_b32 v29, 0xffff0000, v32
    v_mov_b32 v30, 1092616192
    v_mov_b32 v31, 0x3fb8aa3b
    v_pk_mul_f32 v[14:15], v[14:15], v[30:31] op_sel:[0,0] op_sel_hi:[1,0]
    v_pk_mul_f32 v[16:17], v[16:17], v[30:31] op_sel:[0,0] op_sel_hi:[1,0]
    v_pk_mul_f32 v[18:19], v[18:19], v[30:31] op_sel:[0,0] op_sel_hi:[1,0]
    v_pk_mul_f32 v[20:21], v[20:21], v[30:31] op_sel:[0,0] op_sel_hi:[1,0]
    v_pk_mul_f32 v[22:23], v[22:23], v[30:31] op_sel:[0,0] op_sel_hi:[1,0]
    v_pk_mul_f32 v[24:25], v[24:25], v[30:31] op_sel:[0,0] op_sel_hi:[1,0]
    v_pk_mul_f32 v[26:27], v[26:27], v[30:31] op_sel:[0,0] op_sel_hi:[1,0]
    v_pk_mul_f32 v[28:29], v[28:29], v[30:31] op_sel:[0,0] op_sel_hi:[1,0]
    v_cvt_pk_bf16_f32 v32, v14, v15
    v_lshlrev_b32 v14, 16, v32
    v_and_b32 v15, 0xffff0000, v32
    v_cvt_pk_bf16_f32 v32, v16, v17
    v_lshlrev_b32 v16, 16, v32
    v_and_b32 v17, 0xffff0000, v32
    v_cvt_pk_bf16_f32 v32, v18, v19
    v_lshlrev_b32 v18, 16, v32
    v_and_b32 v19, 0xffff0000, v32
    v_cvt_pk_bf16_f32 v32, v20, v21
    v_lshlrev_b32 v20, 16, v32
    v_and_b32 v21, 0xffff0000, v32
    v_cvt_pk_bf16_f32 v32, v22, v23
    v_lshlrev_b32 v22, 16, v32
    v_and_b32 v23, 0xffff0000, v32
    v_cvt_pk_bf16_f32 v32, v24, v25
    v_lshlrev_b32 v24, 16, v32
    v_and_b32 v25, 0xffff0000, v32
    v_cvt_pk_bf16_f32 v32, v26, v27
    v_lshlrev_b32 v26, 16, v32
    v_and_b32 v27, 0xffff0000, v32
    v_cvt_pk_bf16_f32 v32, v28, v29
    v_lshlrev_b32 v28, 16, v32
    v_and_b32 v29, 0xffff0000, v32
    v_pk_mul_f32 v[14:15], v[14:15], v[30:31] op_sel:[0,1] op_sel_hi:[1,1]
    v_pk_mul_f32 v[16:17], v[16:17], v[30:31] op_sel:[0,1] op_sel_hi:[1,1]
    v_pk_mul_f32 v[18:19], v[18:19], v[30:31] op_sel:[0,1] op_sel_hi:[1,1]
    v_pk_mul_f32 v[20:21], v[20:21], v[30:31] op_sel:[0,1] op_sel_hi:[1,1]
    v_pk_mul_f32 v[22:23], v[22:23], v[30:31] op_sel:[0,1] op_sel_hi:[1,1]
    v_pk_mul_f32 v[24:25], v[24:25], v[30:31] op_sel:[0,1] op_sel_hi:[1,1]
    v_pk_mul_f32 v[26:27], v[26:27], v[30:31] op_sel:[0,1] op_sel_hi:[1,1]
    v_pk_mul_f32 v[28:29], v[28:29], v[30:31] op_sel:[0,1] op_sel_hi:[1,1]
    v_exp_f32 v14, -v14
    v_exp_f32 v15, -v15
    v_exp_f32 v16, -v16
    v_exp_f32 v17, -v17
    v_exp_f32 v18, -v18
    v_exp_f32 v19, -v19
    v_exp_f32 v20, -v20
    v_exp_f32 v21, -v21
    v_exp_f32 v22, -v22
    v_exp_f32 v23, -v23
    v_exp_f32 v24, -v24
    v_exp_f32 v25, -v25
    v_exp_f32 v26, -v26
    v_exp_f32 v27, -v27
    v_exp_f32 v28, -v28
    v_exp_f32 v29, -v29
    v_cvt_pk_bf16_f32 v14, v14, v16
    v_cvt_pk_bf16_f32 v15, v15, v17
    v_cvt_pk_bf16_f32 v18, v18, v20
    v_cvt_pk_bf16_f32 v19, v19, v21
    v_cvt_pk_bf16_f32 v22, v22, v24
    v_cvt_pk_bf16_f32 v23, v23, v25
    v_cvt_pk_bf16_f32 v26, v26, v28
    v_cvt_pk_bf16_f32 v27, v27, v29
    v_dot2_f32_bf16 v112, v14, s68, 0
    v_dot2_f32_bf16 v113, v15, s68, 0
    v_dot2_f32_bf16 v114, v14, s69, 0
    v_dot2_f32_bf16 v115, v15, s69, 0
    v_dot2_f32_bf16 v116, v14, s70, 0
    v_dot2_f32_bf16 v117, v15, s70, 0
    v_dot2_f32_bf16 v118, v14, s71, 0
    v_dot2_f32_bf16 v119, v15, s71, 0
    v_dot2_f32_bf16 v120, v14, s52, 0
    v_dot2_f32_bf16 v121, v15, s52, 0
    v_dot2_f32_bf16 v122, v14, s53, 0
    v_dot2_f32_bf16 v123, v15, s53, 0
    v_dot2_f32_bf16 v124, v14, s54, 0
    v_dot2_f32_bf16 v125, v15, s54, 0
    v_dot2_f32_bf16 v126, v14, s55, 0
    v_dot2_f32_bf16 v127, v15, s55, 0
    v_dot2_f32_bf16 v112, v18, s72, v112
    v_dot2_f32_bf16 v113, v19, s72, v113
    v_dot2_f32_bf16 v114, v18, s73, v114
    v_dot2_f32_bf16 v115, v19, s73, v115
    v_dot2_f32_bf16 v116, v18, s74, v116
    v_dot2_f32_bf16 v117, v19, s74, v117
    v_dot2_f32_bf16 v118, v18, s75, v118
    v_dot2_f32_bf16 v119, v19, s75, v119
    v_dot2_f32_bf16 v120, v18, s56, v120
    v_dot2_f32_bf16 v121, v19, s56, v121
    v_dot2_f32_bf16 v122, v18, s57, v122
    v_dot2_f32_bf16 v123, v19, s57, v123
    v_dot2_f32_bf16 v124, v18, s58, v124
    v_dot2_f32_bf16 v125, v19, s58, v125
    v_dot2_f32_bf16 v126, v18, s59, v126
    v_dot2_f32_bf16 v127, v19, s59, v127
    v_dot2_f32_bf16 v112, v22, s76, v112
    v_dot2_f32_bf16 v113, v23, s76, v113
    v_dot2_f32_bf16 v114, v22, s77, v114
    v_dot2_f32_bf16 v115, v23, s77, v115
    v_dot2_f32_bf16 v116, v22, s78, v116
    v_dot2_f32_bf16 v117, v23, s78, v117
    v_dot2_f32_bf16 v118, v22, s79, v118
    v_dot2_f32_bf16 v119, v23, s79, v119
    v_dot2_f32_bf16 v120, v22, s60, v120
    v_dot2_f32_bf16 v121, v23, s60, v121
    v_dot2_f32_bf16 v122, v22, s61, v122
    v_dot2_f32_bf16 v123, v23, s61, v123
    v_dot2_f32_bf16 v124, v22, s62, v124
    v_dot2_f32_bf16 v125, v23, s62, v125
    v_dot2_f32_bf16 v126, v22, s63, v126
    v_dot2_f32_bf16 v127, v23, s63, v127
    v_dot2_f32_bf16 v112, v26, s80, v112
    v_dot2_f32_bf16 v113, v27, s80, v113
    v_dot2_f32_bf16 v114, v26, s81, v114
    v_dot2_f32_bf16 v115, v27, s81, v115
    v_dot2_f32_bf16 v116, v26, s82, v116
    v_dot2_f32_bf16 v117, v27, s82, v117
    v_dot2_f32_bf16 v118, v26, s83, v118
    v_dot2_f32_bf16 v119, v27, s83, v119
    v_dot2_f32_bf16 v120, v26, s64, v120
    v_dot2_f32_bf16 v121, v27, s64, v121
    v_dot2_f32_bf16 v122, v26, s65, v122
    v_dot2_f32_bf16 v123, v27, s65, v123
    v_dot2_f32_bf16 v124, v26, s66, v124
    v_dot2_f32_bf16 v125, v27, s66, v125
    v_dot2_f32_bf16 v126, v26, s67, v126
    v_dot2_f32_bf16 v127, v27, s67, v127
L_p2_kernel_g1_10:
L_p2_gb:
    v_and_b32 v4, 0x80008000, v4
    v_cmp_ne_u32 vcc, 0, v4
    v_mov_b32 v8, s27
    v_and_b32 v10, 15, v0
    v_mul_u32_u24 v10, 240, v10
    v_add_u32 v10, 160000, v10
    s_cmp_lg_u64 vcc, 0
    s_cselect_b32 s2, 1, s2
    v_mov_b32 v9, s2
    s_mov_b64 exec, 1
    ds_write_b32 v8, v9
    s_mov_b64 exec, -1
    v_add_u32 v2, 16384, v1
    v_mov_b32 v9, 0x3f000000
    v_cmp_gt_u32 vcc, 226, v0
    s_mov_b32 s49, s12
    s_mov_b32 s51, 0
    v_cndmask_b32 v2, v9, v2, vcc
    s_waitcnt vmcnt(0) lgkmcnt(0)
    s_barrier
    ds_read_b32 v9, v10
    s_mov_b32 s18, 5120000
    s_mov_b32 s19, 0x00020000
    s_waitcnt lgkmcnt(0)
    v_cmp_ne_u32 vcc, 0, v9
    s_nop 1
    s_cmp_lg_u64 vcc, 0
    s_cselect_b32 s2, 1, 0
    s_cbranch_scc1 L_p2_slow
L_p2_signal:
    v_mov_b32 v8, 160228
    s_lshl_b32 s15, s2, 4
    s_or_b32 s15, s15, s21
    s_add_u32 s14, s12, 16
    s_lshl_b32 s20, s15, s14
    s_add_u32 s20, s20, 1
    v_mov_b32 v9, s20
    s_cmp_lg_u32 s13, 15
    s_cbranch_scc1 L_p2_nosig0
    s_lshl_b32 s14, s3, 8
    s_add_u32 s14, s14, 8523776
    s_mov_b64 exec, 1
    buffer_atomic_add v9, off, s[4:7], s14 sc0
    s_mov_b64 exec, -1
L_p2_nosig0:
    s_lshl2_add_u32 s14, s3, s49
    s_mul_i32 s26, s14, 20000
    s_mov_b32 s10, 5120000
    buffer_load_dwordx4 v[64:67], v1, s[8:11], s26 offen
    buffer_load_dwordx4 v[68:71], v2, s[8:11], s26 offen
    s_lshl_b32 s28, s92, 16
    s_and_b32 s29, s92, 0xffff0000
    s_lshl_b32 s30, s93, 16
    s_and_b32 s31, s93, 0xffff0000
    s_lshl_b32 s32, s94, 16
    s_and_b32 s33, s94, 0xffff0000
    s_lshl_b32 s34, s95, 16
    s_and_b32 s35, s95, 0xffff0000
    s_lshl_b32 s36, s96, 16
    s_and_b32 s37, s96, 0xffff0000
    s_lshl_b32 s38, s97, 16
    s_and_b32 s39, s97, 0xffff0000
    s_lshl_b32 s40, s98, 16
    s_and_b32 s41, s98, 0xffff0000
    s_lshl_b32 s42, s99, 16
    s_and_b32 s43, s99, 0xffff0000
    s_and_b32 s99, s91, 0xffff0000
    s_lshl_b32 s98, s91, 16
    s_and_b32 s97, s90, 0xffff0000
    s_lshl_b32 s96, s90, 16
    s_and_b32 s95, s89, 0xffff0000
    s_lshl_b32 s94, s89, 16
    s_and_b32 s93, s88, 0xffff0000
    s_lshl_b32 s92, s88, 16
    s_and_b32 s91, s87, 0xffff0000
    s_lshl_b32 s90, s87, 16
    s_and_b32 s89, s86, 0xffff0000
    s_lshl_b32 s88, s86, 16
    s_and_b32 s87, s85, 0xffff0000
    s_lshl_b32 s86, s85, 16
    s_and_b32 s85, s84, 0xffff0000
    s_lshl_b32 s84, s84, 16
    s_mov_b32 s44, s48
    s_add_u32 s45, s48, 2281701376
    s_cmp_eq_u32 s48, 0
    s_cselect_b32 s45, 0, s45
    s_cmp_lg_u32 s13, 15
    s_cbranch_scc1 L_p2_nosig
    s_waitcnt vmcnt(2)
    v_readfirstlane_b32 s15, v9
    s_lshl_b32 s51, 1, s12
    s_add_u32 s20, s20, s15
    s_and_b32 s15, s20, 0xff
    s_cmp_eq_u32 s15, 4
    s_cbranch_scc0 L_p2_notlast
    s_bfe_u32 s15, s20, 262160
    s_or_b32 s51, s51, s15
    s_branch L_p2_pub
L_p2_notlast:
    s_cmp_lg_u32 s21, 0
    s_cselect_b32 s51, 0, s51
    s_cbranch_scc1 L_p2_pub
L_p2_poll:
    v_mov_b32 v9, 0
    s_lshl_b32 s14, s3, 8
    s_add_u32 s14, s14, 8523776
    s_mov_b64 exec, 1
    buffer_atomic_add v9, off, s[4:7], s14 sc0
    s_mov_b64 exec, -1
    s_waitcnt vmcnt(0)
    v_readfirstlane_b32 s20, v9
    s_nop 0
    s_and_b32 s15, s20, 0xff
    s_cmp_lt_u32 s15, 4
    s_cbranch_scc1 L_p2_poll
L_p2_pub:
    s_lshl_b32 s15, s51, 24
    s_or_b32 s15, s15, s20
    v_mov_b32 v9, s15
    s_mov_b64 exec, 1
    ds_write_b32 v8, v9
    s_mov_b64 exec, -1
    s_waitcnt lgkmcnt(0)
L_p2_nosig:
    s_barrier
    ds_read_b32 v9, v8
    s_waitcnt lgkmcnt(0)
    v_readfirstlane_b32 s20, v9
    s_nop 0
    s_lshr_b32 s51, s20, 24
    s_cbranch_scc0 L_p2_end
L_p2_fin:
    s_mul_i32 s24, s49, 20000
    s_add_u32 s14, s12, 1
    s_and_b32 s14, s14, 3
    s_mul_i32 s15, s14, 5120000
    s_add_u32 s15, s15, 228589568
    s_add_u32 s15, s15, s26
    buffer_load_dwordx4 v[12:15], v1, s[4:7], s15 offen sc1
    buffer_load_dwordx4 v[92:95], v2, s[4:7], s15 offen sc1
    s_add_u32 s14, s12, 2
    s_and_b32 s14, s14, 3
    s_mul_i32 s15, s14, 5120000
    s_add_u32 s15, s15, 228589568
    s_add_u32 s15, s15, s26
    buffer_load_dwordx4 v[16:19], v1, s[4:7], s15 offen sc1
    buffer_load_dwordx4 v[96:99], v2, s[4:7], s15 offen sc1
    s_add_u32 s14, s12, 3
    s_and_b32 s14, s14, 3
    s_mul_i32 s15, s14, 5120000
    s_add_u32 s15, s15, 228589568
    s_add_u32 s15, s15, s26
    buffer_load_dwordx4 v[20:23], v1, s[4:7], s15 offen sc1
    buffer_load_dwordx4 v[100:103], v2, s[4:7], s15 offen sc1
    v_add_u32 v24, s24, v1
    ds_read_b128 v[8:11], v24
    v_add_u32 v25, s24, v2
    ds_read_b128 v[88:91], v25
    s_waitcnt vmcnt(0) lgkmcnt(0)
    s_bfe_u32 s14, s20, 262164
    s_cbranch_scc0 L_p2_kernel_nof32a_11
    s_add_u32 s14, s12, 0
    s_and_b32 s14, s14, 3
    s_add_u32 s14, s14, 20
    s_bitcmp1_b32 s20, s14
    s_cbranch_scc0 L_p2_kernel_q_12
    v_mov_b32 v8, 1073758208
    v_mov_b32 v9, 1073758208
    v_mov_b32 v10, 1073758208
    v_mov_b32 v11, 1073758208
L_p2_kernel_q_12:
    s_add_u32 s14, s12, 1
    s_and_b32 s14, s14, 3
    s_add_u32 s14, s14, 20
    s_bitcmp1_b32 s20, s14
    s_cbranch_scc0 L_p2_kernel_q_13
    v_mov_b32 v12, 1073758208
    v_mov_b32 v13, 1073758208
    v_mov_b32 v14, 1073758208
    v_mov_b32 v15, 1073758208
L_p2_kernel_q_13:
    s_add_u32 s14, s12, 2
    s_and_b32 s14, s14, 3
    s_add_u32 s14, s14, 20
    s_bitcmp1_b32 s20, s14
    s_cbranch_scc0 L_p2_kernel_q_14
    v_mov_b32 v16, 1073758208
    v_mov_b32 v17, 1073758208
    v_mov_b32 v18, 1073758208
    v_mov_b32 v19, 1073758208
L_p2_kernel_q_14:
    s_add_u32 s14, s12, 3
    s_and_b32 s14, s14, 3
    s_add_u32 s14, s14, 20
    s_bitcmp1_b32 s20, s14
    s_cbranch_scc0 L_p2_kernel_q_15
    v_mov_b32 v20, 1073758208
    v_mov_b32 v21, 1073758208
    v_mov_b32 v22, 1073758208
    v_mov_b32 v23, 1073758208
L_p2_kernel_q_15:
L_p2_kernel_nof32a_11:
    v_pk_add_u16 v8, v8, v12
    v_pk_add_u16 v16, v16, v20
    v_pk_add_u16 v9, v9, v13
    v_pk_add_u16 v17, v17, v21
    v_pk_add_u16 v10, v10, v14
    v_pk_add_u16 v18, v18, v22
    v_pk_add_u16 v11, v11, v15
    v_pk_add_u16 v19, v19, v23
    v_add_u32_sdwa v24, v8, v16 dst_sel:DWORD dst_unused:UNUSED_PAD src0_sel:WORD_0 src1_sel:WORD_0
    v_add_u32_sdwa v25, v10, v18 dst_sel:DWORD dst_unused:UNUSED_PAD src0_sel:WORD_0 src1_sel:WORD_0
    v_add_u32_sdwa v26, v8, v16 dst_sel:DWORD dst_unused:UNUSED_PAD src0_sel:WORD_1 src1_sel:WORD_1
    v_add_u32_sdwa v27, v10, v18 dst_sel:DWORD dst_unused:UNUSED_PAD src0_sel:WORD_1 src1_sel:WORD_1
    v_add_u32_sdwa v28, v9, v17 dst_sel:DWORD dst_unused:UNUSED_PAD src0_sel:WORD_0 src1_sel:WORD_0
    v_add_u32_sdwa v29, v11, v19 dst_sel:DWORD dst_unused:UNUSED_PAD src0_sel:WORD_0 src1_sel:WORD_0
    v_add_u32_sdwa v30, v9, v17 dst_sel:DWORD dst_unused:UNUSED_PAD src0_sel:WORD_1 src1_sel:WORD_1
    v_add_u32_sdwa v31, v11, v19 dst_sel:DWORD dst_unused:UNUSED_PAD src0_sel:WORD_1 src1_sel:WORD_1
    v_cvt_f32_u32 v24, v24
    v_cvt_f32_u32 v25, v25
    v_cvt_f32_u32 v26, v26
    v_cvt_f32_u32 v27, v27
    v_cvt_f32_u32 v28, v28
    v_cvt_f32_u32 v29, v29
    v_cvt_f32_u32 v30, v30
    v_cvt_f32_u32 v31, v31
    v_pk_fma_f32 v[24:25], v[24:25], s[44:45], s[44:45] op_sel:[0,0,1] op_sel_hi:[1,0,1]
    v_pk_fma_f32 v[26:27], v[26:27], s[44:45], s[44:45] op_sel:[0,0,1] op_sel_hi:[1,0,1]
    v_pk_fma_f32 v[28:29], v[28:29], s[44:45], s[44:45] op_sel:[0,0,1] op_sel_hi:[1,0,1]
    v_pk_fma_f32 v[30:31], v[30:31], s[44:45], s[44:45] op_sel:[0,0,1] op_sel_hi:[1,0,1]
    s_bfe_u32 s14, s20, 262164
    s_cbranch_scc0 L_p2_kernel_nof32b_16
    v_lshlrev_b32 v32, 1, v1
    s_bitcmp1_b32 s20, 20
    s_cbranch_scc0 L_p2_kernel_q_17
    s_lshl_b32 s15, s26, 1
    s_add_u32 s15, s15, 249069568
    buffer_load_dwordx4 v[8:11], v32, s[4:7], s15 offen sc1
    buffer_load_dwordx4 v[12:15], v32, s[4:7], s15 offen offset:16 sc1
    s_waitcnt vmcnt(0)
    v_add_f32 v24, v24, v8
    v_add_f32 v25, v25, v12
    v_add_f32 v26, v26, v9
    v_add_f32 v27, v27, v13
    v_add_f32 v28, v28, v10
    v_add_f32 v29, v29, v14
    v_add_f32 v30, v30, v11
    v_add_f32 v31, v31, v15
L_p2_kernel_q_17:
    s_bitcmp1_b32 s20, 21
    s_cbranch_scc0 L_p2_kernel_q_18
    s_lshl_b32 s15, s26, 1
    s_add_u32 s15, s15, 259309568
    buffer_load_dwordx4 v[8:11], v32, s[4:7], s15 offen sc1
    buffer_load_dwordx4 v[12:15], v32, s[4:7], s15 offen offset:16 sc1
    s_waitcnt vmcnt(0)
    v_add_f32 v24, v24, v8
    v_add_f32 v25, v25, v12
    v_add_f32 v26, v26, v9
    v_add_f32 v27, v27, v13
    v_add_f32 v28, v28, v10
    v_add_f32 v29, v29, v14
    v_add_f32 v30, v30, v11
    v_add_f32 v31, v31, v15
L_p2_kernel_q_18:
    s_bitcmp1_b32 s20, 22
    s_cbranch_scc0 L_p2_kernel_q_19
    s_lshl_b32 s15, s26, 1
    s_add_u32 s15, s15, 269549568
    buffer_load_dwordx4 v[8:11], v32, s[4:7], s15 offen sc1
    buffer_load_dwordx4 v[12:15], v32, s[4:7], s15 offen offset:16 sc1
    s_waitcnt vmcnt(0)
    v_add_f32 v24, v24, v8
    v_add_f32 v25, v25, v12
    v_add_f32 v26, v26, v9
    v_add_f32 v27, v27, v13
    v_add_f32 v28, v28, v10
    v_add_f32 v29, v29, v14
    v_add_f32 v30, v30, v11
    v_add_f32 v31, v31, v15
L_p2_kernel_q_19:
    s_bitcmp1_b32 s20, 23
    s_cbranch_scc0 L_p2_kernel_q_20
    s_lshl_b32 s15, s26, 1
    s_add_u32 s15, s15, 279789568
    buffer_load_dwordx4 v[8:11], v32, s[4:7], s15 offen sc1
    buffer_load_dwordx4 v[12:15], v32, s[4:7], s15 offen offset:16 sc1
    s_waitcnt vmcnt(0)
    v_add_f32 v24, v24, v8
    v_add_f32 v25, v25, v12
    v_add_f32 v26, v26, v9
    v_add_f32 v27, v27, v13
    v_add_f32 v28, v28, v10
    v_add_f32 v29, v29, v14
    v_add_f32 v30, v30, v11
    v_add_f32 v31, v31, v15
L_p2_kernel_q_20:
L_p2_kernel_nof32b_16:
    v_pk_mul_f32 v[8:9], v[24:25], s[84:85] op_sel:[0,0] op_sel_hi:[1,0]
    v_pk_mul_f32 v[10:11], v[24:25], s[84:85] op_sel:[0,1] op_sel_hi:[1,1]
    v_pk_mul_f32 v[12:13], v[24:25], s[86:87] op_sel:[0,0] op_sel_hi:[1,0]
    v_pk_mul_f32 v[14:15], v[24:25], s[86:87] op_sel:[0,1] op_sel_hi:[1,1]
    v_pk_fma_f32 v[8:9], v[26:27], s[88:89], v[8:9] op_sel:[0,0,0] op_sel_hi:[1,0,1]
    v_pk_fma_f32 v[10:11], v[26:27], s[88:89], v[10:11] op_sel:[0,1,0] op_sel_hi:[1,1,1]
    v_pk_fma_f32 v[12:13], v[26:27], s[90:91], v[12:13] op_sel:[0,0,0] op_sel_hi:[1,0,1]
    v_pk_fma_f32 v[14:15], v[26:27], s[90:91], v[14:15] op_sel:[0,1,0] op_sel_hi:[1,1,1]
    v_pk_fma_f32 v[8:9], v[28:29], s[92:93], v[8:9] op_sel:[0,0,0] op_sel_hi:[1,0,1]
    v_pk_fma_f32 v[10:11], v[28:29], s[92:93], v[10:11] op_sel:[0,1,0] op_sel_hi:[1,1,1]
    v_pk_fma_f32 v[12:13], v[28:29], s[94:95], v[12:13] op_sel:[0,0,0] op_sel_hi:[1,0,1]
    v_pk_fma_f32 v[14:15], v[28:29], s[94:95], v[14:15] op_sel:[0,1,0] op_sel_hi:[1,1,1]
    v_pk_fma_f32 v[8:9], v[30:31], s[96:97], v[8:9] op_sel:[0,0,0] op_sel_hi:[1,0,1]
    v_pk_fma_f32 v[10:11], v[30:31], s[96:97], v[10:11] op_sel:[0,1,0] op_sel_hi:[1,1,1]
    v_pk_fma_f32 v[12:13], v[30:31], s[98:99], v[12:13] op_sel:[0,0,0] op_sel_hi:[1,0,1]
    v_pk_fma_f32 v[14:15], v[30:31], s[98:99], v[14:15] op_sel:[0,1,0] op_sel_hi:[1,1,1]
    v_pk_mul_f32 v[8:9], v[8:9], v[72:73]
    v_pk_mul_f32 v[10:11], v[10:11], v[74:75]
    v_pk_mul_f32 v[12:13], v[12:13], v[76:77]
    v_pk_mul_f32 v[14:15], v[14:15], v[78:79]
    v_pk_mul_f32 v[24:25], v[8:9], s[28:29] op_sel:[0,0] op_sel_hi:[1,0]
    v_pk_mul_f32 v[26:27], v[8:9], s[28:29] op_sel:[0,1] op_sel_hi:[1,1]
    v_pk_mul_f32 v[28:29], v[8:9], s[30:31] op_sel:[0,0] op_sel_hi:[1,0]
    v_pk_mul_f32 v[30:31], v[8:9], s[30:31] op_sel:[0,1] op_sel_hi:[1,1]
    v_pk_fma_f32 v[24:25], v[10:11], s[32:33], v[24:25] op_sel:[0,0,0] op_sel_hi:[1,0,1]
    v_pk_fma_f32 v[26:27], v[10:11], s[32:33], v[26:27] op_sel:[0,1,0] op_sel_hi:[1,1,1]
    v_pk_fma_f32 v[28:29], v[10:11], s[34:35], v[28:29] op_sel:[0,0,0] op_sel_hi:[1,0,1]
    v_pk_fma_f32 v[30:31], v[10:11], s[34:35], v[30:31] op_sel:[0,1,0] op_sel_hi:[1,1,1]
    v_pk_fma_f32 v[24:25], v[12:13], s[36:37], v[24:25] op_sel:[0,0,0] op_sel_hi:[1,0,1]
    v_pk_fma_f32 v[26:27], v[12:13], s[36:37], v[26:27] op_sel:[0,1,0] op_sel_hi:[1,1,1]
    v_pk_fma_f32 v[28:29], v[12:13], s[38:39], v[28:29] op_sel:[0,0,0] op_sel_hi:[1,0,1]
    v_pk_fma_f32 v[30:31], v[12:13], s[38:39], v[30:31] op_sel:[0,1,0] op_sel_hi:[1,1,1]
    v_pk_fma_f32 v[24:25], v[14:15], s[40:41], v[24:25] op_sel:[0,0,0] op_sel_hi:[1,0,1]
    v_pk_fma_f32 v[26:27], v[14:15], s[40:41], v[26:27] op_sel:[0,1,0] op_sel_hi:[1,1,1]
    v_pk_fma_f32 v[28:29], v[14:15], s[42:43], v[28:29] op_sel:[0,0,0] op_sel_hi:[1,0,1]
    v_pk_fma_f32 v[30:31], v[14:15], s[42:43], v[30:31] op_sel:[0,1,0] op_sel_hi:[1,1,1]
    v_lshlrev_b32 v8, 16, v64
    v_and_b32 v10, 0xffff0000, v64
    v_lshlrev_b32 v12, 16, v65
    v_and_b32 v14, 0xffff0000, v65
    v_lshlrev_b32 v9, 16, v66
    v_and_b32 v11, 0xffff0000, v66
    v_lshlrev_b32 v13, 16, v67
    v_and_b32 v15, 0xffff0000, v67
    v_pk_fma_f32 v[8:9], v[24:25], v[80:81], v[8:9]
    v_pk_fma_f32 v[10:11], v[26:27], v[82:83], v[10:11]
    v_pk_fma_f32 v[12:13], v[28:29], v[84:85], v[12:13]
    v_pk_fma_f32 v[14:15], v[30:31], v[86:87], v[14:15]
    v_cvt_pk_bf16_f32 v16, v8, v10
    v_cvt_pk_bf16_f32 v17, v12, v14
    v_cvt_pk_bf16_f32 v18, v9, v11
    v_cvt_pk_bf16_f32 v19, v13, v15
    buffer_store_dwordx4 v[16:19], v1, s[16:19], s26 offen
    s_cmp_ge_u32 s13, 4
    s_cbranch_scc1 L_p2_f1
    s_bfe_u32 s14, s20, 262164
    s_cbranch_scc0 L_p2_kernel_nof32a_21
    s_add_u32 s14, s12, 0
    s_and_b32 s14, s14, 3
    s_add_u32 s14, s14, 20
    s_bitcmp1_b32 s20, s14
    s_cbranch_scc0 L_p2_kernel_q_22
    v_mov_b32 v88, 1073758208
    v_mov_b32 v89, 1073758208
    v_mov_b32 v90, 1073758208
    v_mov_b32 v91, 1073758208
L_p2_kernel_q_22:
    s_add_u32 s14, s12, 1
    s_and_b32 s14, s14, 3
    s_add_u32 s14, s14, 20
    s_bitcmp1_b32 s20, s14
    s_cbranch_scc0 L_p2_kernel_q_23
    v_mov_b32 v92, 1073758208
    v_mov_b32 v93, 1073758208
    v_mov_b32 v94, 1073758208
    v_mov_b32 v95, 1073758208
L_p2_kernel_q_23:
    s_add_u32 s14, s12, 2
    s_and_b32 s14, s14, 3
    s_add_u32 s14, s14, 20
    s_bitcmp1_b32 s20, s14
    s_cbranch_scc0 L_p2_kernel_q_24
    v_mov_b32 v96, 1073758208
    v_mov_b32 v97, 1073758208
    v_mov_b32 v98, 1073758208
    v_mov_b32 v99, 1073758208
L_p2_kernel_q_24:
    s_add_u32 s14, s12, 3
    s_and_b32 s14, s14, 3
    s_add_u32 s14, s14, 20
    s_bitcmp1_b32 s20, s14
    s_cbranch_scc0 L_p2_kernel_q_25
    v_mov_b32 v100, 1073758208
    v_mov_b32 v101, 1073758208
    v_mov_b32 v102, 1073758208
    v_mov_b32 v103, 1073758208
L_p2_kernel_q_25:
L_p2_kernel_nof32a_21:
    v_pk_add_u16 v88, v88, v92
    v_pk_add_u16 v96, v96, v100
    v_pk_add_u16 v89, v89, v93
    v_pk_add_u16 v97, v97, v101
    v_pk_add_u16 v90, v90, v94
    v_pk_add_u16 v98, v98, v102
    v_pk_add_u16 v91, v91, v95
    v_pk_add_u16 v99, v99, v103
    v_add_u32_sdwa v24, v88, v96 dst_sel:DWORD dst_unused:UNUSED_PAD src0_sel:WORD_0 src1_sel:WORD_0
    v_add_u32_sdwa v25, v90, v98 dst_sel:DWORD dst_unused:UNUSED_PAD src0_sel:WORD_0 src1_sel:WORD_0
    v_add_u32_sdwa v26, v88, v96 dst_sel:DWORD dst_unused:UNUSED_PAD src0_sel:WORD_1 src1_sel:WORD_1
    v_add_u32_sdwa v27, v90, v98 dst_sel:DWORD dst_unused:UNUSED_PAD src0_sel:WORD_1 src1_sel:WORD_1
    v_add_u32_sdwa v28, v89, v97 dst_sel:DWORD dst_unused:UNUSED_PAD src0_sel:WORD_0 src1_sel:WORD_0
    v_add_u32_sdwa v29, v91, v99 dst_sel:DWORD dst_unused:UNUSED_PAD src0_sel:WORD_0 src1_sel:WORD_0
    v_add_u32_sdwa v30, v89, v97 dst_sel:DWORD dst_unused:UNUSED_PAD src0_sel:WORD_1 src1_sel:WORD_1
    v_add_u32_sdwa v31, v91, v99 dst_sel:DWORD dst_unused:UNUSED_PAD src0_sel:WORD_1 src1_sel:WORD_1
    v_cvt_f32_u32 v24, v24
    v_cvt_f32_u32 v25, v25
    v_cvt_f32_u32 v26, v26
    v_cvt_f32_u32 v27, v27
    v_cvt_f32_u32 v28, v28
    v_cvt_f32_u32 v29, v29
    v_cvt_f32_u32 v30, v30
    v_cvt_f32_u32 v31, v31
    v_pk_fma_f32 v[24:25], v[24:25], s[44:45], s[44:45] op_sel:[0,0,1] op_sel_hi:[1,0,1]
    v_pk_fma_f32 v[26:27], v[26:27], s[44:45], s[44:45] op_sel:[0,0,1] op_sel_hi:[1,0,1]
    v_pk_fma_f32 v[28:29], v[28:29], s[44:45], s[44:45] op_sel:[0,0,1] op_sel_hi:[1,0,1]
    v_pk_fma_f32 v[30:31], v[30:31], s[44:45], s[44:45] op_sel:[0,0,1] op_sel_hi:[1,0,1]
    s_bfe_u32 s14, s20, 262164
    s_cbranch_scc0 L_p2_kernel_nof32b_26
    v_lshlrev_b32 v32, 1, v2
    s_bitcmp1_b32 s20, 20
    s_cbranch_scc0 L_p2_kernel_q_27
    s_lshl_b32 s15, s26, 1
    s_add_u32 s15, s15, 249069568
    buffer_load_dwordx4 v[88:91], v32, s[4:7], s15 offen sc1
    buffer_load_dwordx4 v[92:95], v32, s[4:7], s15 offen offset:16 sc1
    s_waitcnt vmcnt(0)
    v_add_f32 v24, v24, v88
    v_add_f32 v25, v25, v92
    v_add_f32 v26, v26, v89
    v_add_f32 v27, v27, v93
    v_add_f32 v28, v28, v90
    v_add_f32 v29, v29, v94
    v_add_f32 v30, v30, v91
    v_add_f32 v31, v31, v95
L_p2_kernel_q_27:
    s_bitcmp1_b32 s20, 21
    s_cbranch_scc0 L_p2_kernel_q_28
    s_lshl_b32 s15, s26, 1
    s_add_u32 s15, s15, 259309568
    buffer_load_dwordx4 v[88:91], v32, s[4:7], s15 offen sc1
    buffer_load_dwordx4 v[92:95], v32, s[4:7], s15 offen offset:16 sc1
    s_waitcnt vmcnt(0)
    v_add_f32 v24, v24, v88
    v_add_f32 v25, v25, v92
    v_add_f32 v26, v26, v89
    v_add_f32 v27, v27, v93
    v_add_f32 v28, v28, v90
    v_add_f32 v29, v29, v94
    v_add_f32 v30, v30, v91
    v_add_f32 v31, v31, v95
L_p2_kernel_q_28:
    s_bitcmp1_b32 s20, 22
    s_cbranch_scc0 L_p2_kernel_q_29
    s_lshl_b32 s15, s26, 1
    s_add_u32 s15, s15, 269549568
    buffer_load_dwordx4 v[88:91], v32, s[4:7], s15 offen sc1
    buffer_load_dwordx4 v[92:95], v32, s[4:7], s15 offen offset:16 sc1
    s_waitcnt vmcnt(0)
    v_add_f32 v24, v24, v88
    v_add_f32 v25, v25, v92
    v_add_f32 v26, v26, v89
    v_add_f32 v27, v27, v93
    v_add_f32 v28, v28, v90
    v_add_f32 v29, v29, v94
    v_add_f32 v30, v30, v91
    v_add_f32 v31, v31, v95
L_p2_kernel_q_29:
    s_bitcmp1_b32 s20, 23
    s_cbranch_scc0 L_p2_kernel_q_30
    s_lshl_b32 s15, s26, 1
    s_add_u32 s15, s15, 279789568
    buffer_load_dwordx4 v[88:91], v32, s[4:7], s15 offen sc1
    buffer_load_dwordx4 v[92:95], v32, s[4:7], s15 offen offset:16 sc1
    s_waitcnt vmcnt(0)
    v_add_f32 v24, v24, v88
    v_add_f32 v25, v25, v92
    v_add_f32 v26, v26, v89
    v_add_f32 v27, v27, v93
    v_add_f32 v28, v28, v90
    v_add_f32 v29, v29, v94
    v_add_f32 v30, v30, v91
    v_add_f32 v31, v31, v95
L_p2_kernel_q_30:
L_p2_kernel_nof32b_26:
    v_pk_mul_f32 v[88:89], v[24:25], s[84:85] op_sel:[0,0] op_sel_hi:[1,0]
    v_pk_mul_f32 v[90:91], v[24:25], s[84:85] op_sel:[0,1] op_sel_hi:[1,1]
    v_pk_mul_f32 v[92:93], v[24:25], s[86:87] op_sel:[0,0] op_sel_hi:[1,0]
    v_pk_mul_f32 v[94:95], v[24:25], s[86:87] op_sel:[0,1] op_sel_hi:[1,1]
    v_pk_fma_f32 v[88:89], v[26:27], s[88:89], v[88:89] op_sel:[0,0,0] op_sel_hi:[1,0,1]
    v_pk_fma_f32 v[90:91], v[26:27], s[88:89], v[90:91] op_sel:[0,1,0] op_sel_hi:[1,1,1]
    v_pk_fma_f32 v[92:93], v[26:27], s[90:91], v[92:93] op_sel:[0,0,0] op_sel_hi:[1,0,1]
    v_pk_fma_f32 v[94:95], v[26:27], s[90:91], v[94:95] op_sel:[0,1,0] op_sel_hi:[1,1,1]
    v_pk_fma_f32 v[88:89], v[28:29], s[92:93], v[88:89] op_sel:[0,0,0] op_sel_hi:[1,0,1]
    v_pk_fma_f32 v[90:91], v[28:29], s[92:93], v[90:91] op_sel:[0,1,0] op_sel_hi:[1,1,1]
    v_pk_fma_f32 v[92:93], v[28:29], s[94:95], v[92:93] op_sel:[0,0,0] op_sel_hi:[1,0,1]
    v_pk_fma_f32 v[94:95], v[28:29], s[94:95], v[94:95] op_sel:[0,1,0] op_sel_hi:[1,1,1]
    v_pk_fma_f32 v[88:89], v[30:31], s[96:97], v[88:89] op_sel:[0,0,0] op_sel_hi:[1,0,1]
    v_pk_fma_f32 v[90:91], v[30:31], s[96:97], v[90:91] op_sel:[0,1,0] op_sel_hi:[1,1,1]
    v_pk_fma_f32 v[92:93], v[30:31], s[98:99], v[92:93] op_sel:[0,0,0] op_sel_hi:[1,0,1]
    v_pk_fma_f32 v[94:95], v[30:31], s[98:99], v[94:95] op_sel:[0,1,0] op_sel_hi:[1,1,1]
    v_pk_mul_f32 v[88:89], v[88:89], v[112:113]
    v_pk_mul_f32 v[90:91], v[90:91], v[114:115]
    v_pk_mul_f32 v[92:93], v[92:93], v[116:117]
    v_pk_mul_f32 v[94:95], v[94:95], v[118:119]
    v_pk_mul_f32 v[24:25], v[88:89], s[28:29] op_sel:[0,0] op_sel_hi:[1,0]
    v_pk_mul_f32 v[26:27], v[88:89], s[28:29] op_sel:[0,1] op_sel_hi:[1,1]
    v_pk_mul_f32 v[28:29], v[88:89], s[30:31] op_sel:[0,0] op_sel_hi:[1,0]
    v_pk_mul_f32 v[30:31], v[88:89], s[30:31] op_sel:[0,1] op_sel_hi:[1,1]
    v_pk_fma_f32 v[24:25], v[90:91], s[32:33], v[24:25] op_sel:[0,0,0] op_sel_hi:[1,0,1]
    v_pk_fma_f32 v[26:27], v[90:91], s[32:33], v[26:27] op_sel:[0,1,0] op_sel_hi:[1,1,1]
    v_pk_fma_f32 v[28:29], v[90:91], s[34:35], v[28:29] op_sel:[0,0,0] op_sel_hi:[1,0,1]
    v_pk_fma_f32 v[30:31], v[90:91], s[34:35], v[30:31] op_sel:[0,1,0] op_sel_hi:[1,1,1]
    v_pk_fma_f32 v[24:25], v[92:93], s[36:37], v[24:25] op_sel:[0,0,0] op_sel_hi:[1,0,1]
    v_pk_fma_f32 v[26:27], v[92:93], s[36:37], v[26:27] op_sel:[0,1,0] op_sel_hi:[1,1,1]
    v_pk_fma_f32 v[28:29], v[92:93], s[38:39], v[28:29] op_sel:[0,0,0] op_sel_hi:[1,0,1]
    v_pk_fma_f32 v[30:31], v[92:93], s[38:39], v[30:31] op_sel:[0,1,0] op_sel_hi:[1,1,1]
    v_pk_fma_f32 v[24:25], v[94:95], s[40:41], v[24:25] op_sel:[0,0,0] op_sel_hi:[1,0,1]
    v_pk_fma_f32 v[26:27], v[94:95], s[40:41], v[26:27] op_sel:[0,1,0] op_sel_hi:[1,1,1]
    v_pk_fma_f32 v[28:29], v[94:95], s[42:43], v[28:29] op_sel:[0,0,0] op_sel_hi:[1,0,1]
    v_pk_fma_f32 v[30:31], v[94:95], s[42:43], v[30:31] op_sel:[0,1,0] op_sel_hi:[1,1,1]
    v_lshlrev_b32 v88, 16, v68
    v_and_b32 v90, 0xffff0000, v68
    v_lshlrev_b32 v92, 16, v69
    v_and_b32 v94, 0xffff0000, v69
    v_lshlrev_b32 v89, 16, v70
    v_and_b32 v91, 0xffff0000, v70
    v_lshlrev_b32 v93, 16, v71
    v_and_b32 v95, 0xffff0000, v71
    v_pk_fma_f32 v[88:89], v[24:25], v[120:121], v[88:89]
    v_pk_fma_f32 v[90:91], v[26:27], v[122:123], v[90:91]
    v_pk_fma_f32 v[92:93], v[28:29], v[124:125], v[92:93]
    v_pk_fma_f32 v[94:95], v[30:31], v[126:127], v[94:95]
    v_cvt_pk_bf16_f32 v96, v88, v90
    v_cvt_pk_bf16_f32 v97, v92, v94
    v_cvt_pk_bf16_f32 v98, v89, v91
    v_cvt_pk_bf16_f32 v99, v93, v95
    buffer_store_dwordx4 v[96:99], v2, s[16:19], s26 offen
L_p2_f1:
    s_bitset0_b32 s51, s49
    s_cmp_eq_u32 s51, 0
    s_cbranch_scc1 L_p2_done
    s_ff1_i32_b32 s49, s51
    s_lshl2_add_u32 s14, s3, s49
    s_mul_i32 s14, s14, 5000
    s_add_u32 s15, s14, 4096
    v_min_u32 v61, 225, v0
    v_lshl_add_u32 v60, v0, 2, s14
    v_lshl_add_u32 v61, v61, 2, s15
    global_load_dword v60, v60, s[100:101] nt
    global_load_dword v61, v61, s[100:101] nt
    s_waitcnt vmcnt(0)
    v_lshlrev_b32 v30, 16, v60
    v_and_b32 v31, 0xffff0000, v60
    v_lshlrev_b32 v36, 16, v53
    v_and_b32 v37, 0xffff0000, v53
    v_lshlrev_b32 v38, 16, v54
    v_and_b32 v39, 0xffff0000, v54
    v_lshlrev_b32 v40, 16, v56
    v_and_b32 v41, 0xffff0000, v56
    v_lshlrev_b32 v42, 16, v57
    v_and_b32 v43, 0xffff0000, v57
    v_pk_add_f32 v[14:15], v[30:31], v[36:37] op_sel:[0,0] op_sel_hi:[1,0] neg_lo:[0,1] neg_hi:[0,1]
    v_pk_add_f32 v[16:17], v[30:31], v[36:37] op_sel:[0,1] op_sel_hi:[1,1] neg_lo:[0,1] neg_hi:[0,1]
    v_pk_add_f32 v[18:19], v[30:31], v[38:39] op_sel:[0,0] op_sel_hi:[1,0] neg_lo:[0,1] neg_hi:[0,1]
    v_pk_add_f32 v[20:21], v[30:31], v[38:39] op_sel:[0,1] op_sel_hi:[1,1] neg_lo:[0,1] neg_hi:[0,1]
    v_pk_add_f32 v[22:23], v[30:31], v[40:41] op_sel:[0,0] op_sel_hi:[1,0] neg_lo:[0,1] neg_hi:[0,1]
    v_pk_add_f32 v[24:25], v[30:31], v[40:41] op_sel:[0,1] op_sel_hi:[1,1] neg_lo:[0,1] neg_hi:[0,1]
    v_pk_add_f32 v[26:27], v[30:31], v[42:43] op_sel:[0,0] op_sel_hi:[1,0] neg_lo:[0,1] neg_hi:[0,1]
    v_pk_add_f32 v[28:29], v[30:31], v[42:43] op_sel:[0,1] op_sel_hi:[1,1] neg_lo:[0,1] neg_hi:[0,1]
    v_cvt_pk_bf16_f32 v32, v14, v15
    v_lshlrev_b32 v14, 16, v32
    v_and_b32 v15, 0xffff0000, v32
    v_cvt_pk_bf16_f32 v32, v16, v17
    v_lshlrev_b32 v16, 16, v32
    v_and_b32 v17, 0xffff0000, v32
    v_cvt_pk_bf16_f32 v32, v18, v19
    v_lshlrev_b32 v18, 16, v32
    v_and_b32 v19, 0xffff0000, v32
    v_cvt_pk_bf16_f32 v32, v20, v21
    v_lshlrev_b32 v20, 16, v32
    v_and_b32 v21, 0xffff0000, v32
    v_cvt_pk_bf16_f32 v32, v22, v23
    v_lshlrev_b32 v22, 16, v32
    v_and_b32 v23, 0xffff0000, v32
    v_cvt_pk_bf16_f32 v32, v24, v25
    v_lshlrev_b32 v24, 16, v32
    v_and_b32 v25, 0xffff0000, v32
    v_cvt_pk_bf16_f32 v32, v26, v27
    v_lshlrev_b32 v26, 16, v32
    v_and_b32 v27, 0xffff0000, v32
    v_cvt_pk_bf16_f32 v32, v28, v29
    v_lshlrev_b32 v28, 16, v32
    v_and_b32 v29, 0xffff0000, v32
    v_pk_mul_f32 v[14:15], v[14:15], v[14:15]
    v_pk_mul_f32 v[16:17], v[16:17], v[16:17]
    v_pk_mul_f32 v[18:19], v[18:19], v[18:19]
    v_pk_mul_f32 v[20:21], v[20:21], v[20:21]
    v_pk_mul_f32 v[22:23], v[22:23], v[22:23]
    v_pk_mul_f32 v[24:25], v[24:25], v[24:25]
    v_pk_mul_f32 v[26:27], v[26:27], v[26:27]
    v_pk_mul_f32 v[28:29], v[28:29], v[28:29]
    v_cvt_pk_bf16_f32 v32, v14, v15
    v_lshlrev_b32 v14, 16, v32
    v_and_b32 v15, 0xffff0000, v32
    v_cvt_pk_bf16_f32 v32, v16, v17
    v_lshlrev_b32 v16, 16, v32
    v_and_b32 v17, 0xffff0000, v32
    v_cvt_pk_bf16_f32 v32, v18, v19
    v_lshlrev_b32 v18, 16, v32
    v_and_b32 v19, 0xffff0000, v32
    v_cvt_pk_bf16_f32 v32, v20, v21
    v_lshlrev_b32 v20, 16, v32
    v_and_b32 v21, 0xffff0000, v32
    v_cvt_pk_bf16_f32 v32, v22, v23
    v_lshlrev_b32 v22, 16, v32
    v_and_b32 v23, 0xffff0000, v32
    v_cvt_pk_bf16_f32 v32, v24, v25
    v_lshlrev_b32 v24, 16, v32
    v_and_b32 v25, 0xffff0000, v32
    v_cvt_pk_bf16_f32 v32, v26, v27
    v_lshlrev_b32 v26, 16, v32
    v_and_b32 v27, 0xffff0000, v32
    v_cvt_pk_bf16_f32 v32, v28, v29
    v_lshlrev_b32 v28, 16, v32
    v_and_b32 v29, 0xffff0000, v32
    v_mov_b32 v30, 1092616192
    v_mov_b32 v31, 0x3fb8aa3b
    v_pk_mul_f32 v[14:15], v[14:15], v[30:31] op_sel:[0,0] op_sel_hi:[1,0]
    v_pk_mul_f32 v[16:17], v[16:17], v[30:31] op_sel:[0,0] op_sel_hi:[1,0]
    v_pk_mul_f32 v[18:19], v[18:19], v[30:31] op_sel:[0,0] op_sel_hi:[1,0]
    v_pk_mul_f32 v[20:21], v[20:21], v[30:31] op_sel:[0,0] op_sel_hi:[1,0]
    v_pk_mul_f32 v[22:23], v[22:23], v[30:31] op_sel:[0,0] op_sel_hi:[1,0]
    v_pk_mul_f32 v[24:25], v[24:25], v[30:31] op_sel:[0,0] op_sel_hi:[1,0]
    v_pk_mul_f32 v[26:27], v[26:27], v[30:31] op_sel:[0,0] op_sel_hi:[1,0]
    v_pk_mul_f32 v[28:29], v[28:29], v[30:31] op_sel:[0,0] op_sel_hi:[1,0]
    v_cvt_pk_bf16_f32 v32, v14, v15
    v_lshlrev_b32 v14, 16, v32
    v_and_b32 v15, 0xffff0000, v32
    v_cvt_pk_bf16_f32 v32, v16, v17
    v_lshlrev_b32 v16, 16, v32
    v_and_b32 v17, 0xffff0000, v32
    v_cvt_pk_bf16_f32 v32, v18, v19
    v_lshlrev_b32 v18, 16, v32
    v_and_b32 v19, 0xffff0000, v32
    v_cvt_pk_bf16_f32 v32, v20, v21
    v_lshlrev_b32 v20, 16, v32
    v_and_b32 v21, 0xffff0000, v32
    v_cvt_pk_bf16_f32 v32, v22, v23
    v_lshlrev_b32 v22, 16, v32
    v_and_b32 v23, 0xffff0000, v32
    v_cvt_pk_bf16_f32 v32, v24, v25
    v_lshlrev_b32 v24, 16, v32
    v_and_b32 v25, 0xffff0000, v32
    v_cvt_pk_bf16_f32 v32, v26, v27
    v_lshlrev_b32 v26, 16, v32
    v_and_b32 v27, 0xffff0000, v32
    v_cvt_pk_bf16_f32 v32, v28, v29
    v_lshlrev_b32 v28, 16, v32
    v_and_b32 v29, 0xffff0000, v32
    v_pk_mul_f32 v[14:15], v[14:15], v[30:31] op_sel:[0,1] op_sel_hi:[1,1]
    v_pk_mul_f32 v[16:17], v[16:17], v[30:31] op_sel:[0,1] op_sel_hi:[1,1]
    v_pk_mul_f32 v[18:19], v[18:19], v[30:31] op_sel:[0,1] op_sel_hi:[1,1]
    v_pk_mul_f32 v[20:21], v[20:21], v[30:31] op_sel:[0,1] op_sel_hi:[1,1]
    v_pk_mul_f32 v[22:23], v[22:23], v[30:31] op_sel:[0,1] op_sel_hi:[1,1]
    v_pk_mul_f32 v[24:25], v[24:25], v[30:31] op_sel:[0,1] op_sel_hi:[1,1]
    v_pk_mul_f32 v[26:27], v[26:27], v[30:31] op_sel:[0,1] op_sel_hi:[1,1]
    v_pk_mul_f32 v[28:29], v[28:29], v[30:31] op_sel:[0,1] op_sel_hi:[1,1]
    v_exp_f32 v14, -v14
    v_exp_f32 v15, -v15
    v_exp_f32 v16, -v16
    v_exp_f32 v17, -v17
    v_exp_f32 v18, -v18
    v_exp_f32 v19, -v19
    v_exp_f32 v20, -v20
    v_exp_f32 v21, -v21
    v_exp_f32 v22, -v22
    v_exp_f32 v23, -v23
    v_exp_f32 v24, -v24
    v_exp_f32 v25, -v25
    v_exp_f32 v26, -v26
    v_exp_f32 v27, -v27
    v_exp_f32 v28, -v28
    v_exp_f32 v29, -v29
    v_cvt_pk_bf16_f32 v14, v14, v16
    v_cvt_pk_bf16_f32 v15, v15, v17
    v_cvt_pk_bf16_f32 v18, v18, v20
    v_cvt_pk_bf16_f32 v19, v19, v21
    v_cvt_pk_bf16_f32 v22, v22, v24
    v_cvt_pk_bf16_f32 v23, v23, v25
    v_cvt_pk_bf16_f32 v26, v26, v28
    v_cvt_pk_bf16_f32 v27, v27, v29
    v_dot2_f32_bf16 v72, v14, s68, 0
    v_dot2_f32_bf16 v73, v15, s68, 0
    v_dot2_f32_bf16 v74, v14, s69, 0
    v_dot2_f32_bf16 v75, v15, s69, 0
    v_dot2_f32_bf16 v76, v14, s70, 0
    v_dot2_f32_bf16 v77, v15, s70, 0
    v_dot2_f32_bf16 v78, v14, s71, 0
    v_dot2_f32_bf16 v79, v15, s71, 0
    v_dot2_f32_bf16 v80, v14, s52, 0
    v_dot2_f32_bf16 v81, v15, s52, 0
    v_dot2_f32_bf16 v82, v14, s53, 0
    v_dot2_f32_bf16 v83, v15, s53, 0
    v_dot2_f32_bf16 v84, v14, s54, 0
    v_dot2_f32_bf16 v85, v15, s54, 0
    v_dot2_f32_bf16 v86, v14, s55, 0
    v_dot2_f32_bf16 v87, v15, s55, 0
    v_dot2_f32_bf16 v72, v18, s72, v72
    v_dot2_f32_bf16 v73, v19, s72, v73
    v_dot2_f32_bf16 v74, v18, s73, v74
    v_dot2_f32_bf16 v75, v19, s73, v75
    v_dot2_f32_bf16 v76, v18, s74, v76
    v_dot2_f32_bf16 v77, v19, s74, v77
    v_dot2_f32_bf16 v78, v18, s75, v78
    v_dot2_f32_bf16 v79, v19, s75, v79
    v_dot2_f32_bf16 v80, v18, s56, v80
    v_dot2_f32_bf16 v81, v19, s56, v81
    v_dot2_f32_bf16 v82, v18, s57, v82
    v_dot2_f32_bf16 v83, v19, s57, v83
    v_dot2_f32_bf16 v84, v18, s58, v84
    v_dot2_f32_bf16 v85, v19, s58, v85
    v_dot2_f32_bf16 v86, v18, s59, v86
    v_dot2_f32_bf16 v87, v19, s59, v87
    v_dot2_f32_bf16 v72, v22, s76, v72
    v_dot2_f32_bf16 v73, v23, s76, v73
    v_dot2_f32_bf16 v74, v22, s77, v74
    v_dot2_f32_bf16 v75, v23, s77, v75
    v_dot2_f32_bf16 v76, v22, s78, v76
    v_dot2_f32_bf16 v77, v23, s78, v77
    v_dot2_f32_bf16 v78, v22, s79, v78
    v_dot2_f32_bf16 v79, v23, s79, v79
    v_dot2_f32_bf16 v80, v22, s60, v80
    v_dot2_f32_bf16 v81, v23, s60, v81
    v_dot2_f32_bf16 v82, v22, s61, v82
    v_dot2_f32_bf16 v83, v23, s61, v83
    v_dot2_f32_bf16 v84, v22, s62, v84
    v_dot2_f32_bf16 v85, v23, s62, v85
    v_dot2_f32_bf16 v86, v22, s63, v86
    v_dot2_f32_bf16 v87, v23, s63, v87
    v_dot2_f32_bf16 v72, v26, s80, v72
    v_dot2_f32_bf16 v73, v27, s80, v73
    v_dot2_f32_bf16 v74, v26, s81, v74
    v_dot2_f32_bf16 v75, v27, s81, v75
    v_dot2_f32_bf16 v76, v26, s82, v76
    v_dot2_f32_bf16 v77, v27, s82, v77
    v_dot2_f32_bf16 v78, v26, s83, v78
    v_dot2_f32_bf16 v79, v27, s83, v79
    v_dot2_f32_bf16 v80, v26, s64, v80
    v_dot2_f32_bf16 v81, v27, s64, v81
    v_dot2_f32_bf16 v82, v26, s65, v82
    v_dot2_f32_bf16 v83, v27, s65, v83
    v_dot2_f32_bf16 v84, v26, s66, v84
    v_dot2_f32_bf16 v85, v27, s66, v85
    v_dot2_f32_bf16 v86, v26, s67, v86
    v_dot2_f32_bf16 v87, v27, s67, v87
    s_cmp_ge_u32 s13, 4
    s_cbranch_scc1 L_p2_kernel_g1_31
    v_lshlrev_b32 v30, 16, v61
    v_and_b32 v31, 0xffff0000, v61
    v_pk_add_f32 v[14:15], v[30:31], v[36:37] op_sel:[0,0] op_sel_hi:[1,0] neg_lo:[0,1] neg_hi:[0,1]
    v_pk_add_f32 v[16:17], v[30:31], v[36:37] op_sel:[0,1] op_sel_hi:[1,1] neg_lo:[0,1] neg_hi:[0,1]
    v_pk_add_f32 v[18:19], v[30:31], v[38:39] op_sel:[0,0] op_sel_hi:[1,0] neg_lo:[0,1] neg_hi:[0,1]
    v_pk_add_f32 v[20:21], v[30:31], v[38:39] op_sel:[0,1] op_sel_hi:[1,1] neg_lo:[0,1] neg_hi:[0,1]
    v_pk_add_f32 v[22:23], v[30:31], v[40:41] op_sel:[0,0] op_sel_hi:[1,0] neg_lo:[0,1] neg_hi:[0,1]
    v_pk_add_f32 v[24:25], v[30:31], v[40:41] op_sel:[0,1] op_sel_hi:[1,1] neg_lo:[0,1] neg_hi:[0,1]
    v_pk_add_f32 v[26:27], v[30:31], v[42:43] op_sel:[0,0] op_sel_hi:[1,0] neg_lo:[0,1] neg_hi:[0,1]
    v_pk_add_f32 v[28:29], v[30:31], v[42:43] op_sel:[0,1] op_sel_hi:[1,1] neg_lo:[0,1] neg_hi:[0,1]
    v_cvt_pk_bf16_f32 v32, v14, v15
    v_lshlrev_b32 v14, 16, v32
    v_and_b32 v15, 0xffff0000, v32
    v_cvt_pk_bf16_f32 v32, v16, v17
    v_lshlrev_b32 v16, 16, v32
    v_and_b32 v17, 0xffff0000, v32
    v_cvt_pk_bf16_f32 v32, v18, v19
    v_lshlrev_b32 v18, 16, v32
    v_and_b32 v19, 0xffff0000, v32
    v_cvt_pk_bf16_f32 v32, v20, v21
    v_lshlrev_b32 v20, 16, v32
    v_and_b32 v21, 0xffff0000, v32
    v_cvt_pk_bf16_f32 v32, v22, v23
    v_lshlrev_b32 v22, 16, v32
    v_and_b32 v23, 0xffff0000, v32
    v_cvt_pk_bf16_f32 v32, v24, v25
    v_lshlrev_b32 v24, 16, v32
    v_and_b32 v25, 0xffff0000, v32
    v_cvt_pk_bf16_f32 v32, v26, v27
    v_lshlrev_b32 v26, 16, v32
    v_and_b32 v27, 0xffff0000, v32
    v_cvt_pk_bf16_f32 v32, v28, v29
    v_lshlrev_b32 v28, 16, v32
    v_and_b32 v29, 0xffff0000, v32
    v_pk_mul_f32 v[14:15], v[14:15], v[14:15]
    v_pk_mul_f32 v[16:17], v[16:17], v[16:17]
    v_pk_mul_f32 v[18:19], v[18:19], v[18:19]
    v_pk_mul_f32 v[20:21], v[20:21], v[20:21]
    v_pk_mul_f32 v[22:23], v[22:23], v[22:23]
    v_pk_mul_f32 v[24:25], v[24:25], v[24:25]
    v_pk_mul_f32 v[26:27], v[26:27], v[26:27]
    v_pk_mul_f32 v[28:29], v[28:29], v[28:29]
    v_cvt_pk_bf16_f32 v32, v14, v15
    v_lshlrev_b32 v14, 16, v32
    v_and_b32 v15, 0xffff0000, v32
    v_cvt_pk_bf16_f32 v32, v16, v17
    v_lshlrev_b32 v16, 16, v32
    v_and_b32 v17, 0xffff0000, v32
    v_cvt_pk_bf16_f32 v32, v18, v19
    v_lshlrev_b32 v18, 16, v32
    v_and_b32 v19, 0xffff0000, v32
    v_cvt_pk_bf16_f32 v32, v20, v21
    v_lshlrev_b32 v20, 16, v32
    v_and_b32 v21, 0xffff0000, v32
    v_cvt_pk_bf16_f32 v32, v22, v23
    v_lshlrev_b32 v22, 16, v32
    v_and_b32 v23, 0xffff0000, v32
    v_cvt_pk_bf16_f32 v32, v24, v25
    v_lshlrev_b32 v24, 16, v32
    v_and_b32 v25, 0xffff0000, v32
    v_cvt_pk_bf16_f32 v32, v26, v27
    v_lshlrev_b32 v26, 16, v32
    v_and_b32 v27, 0xffff0000, v32
    v_cvt_pk_bf16_f32 v32, v28, v29
    v_lshlrev_b32 v28, 16, v32
    v_and_b32 v29, 0xffff0000, v32
    v_mov_b32 v30, 1092616192
    v_mov_b32 v31, 0x3fb8aa3b
    v_pk_mul_f32 v[14:15], v[14:15], v[30:31] op_sel:[0,0] op_sel_hi:[1,0]
    v_pk_mul_f32 v[16:17], v[16:17], v[30:31] op_sel:[0,0] op_sel_hi:[1,0]
    v_pk_mul_f32 v[18:19], v[18:19], v[30:31] op_sel:[0,0] op_sel_hi:[1,0]
    v_pk_mul_f32 v[20:21], v[20:21], v[30:31] op_sel:[0,0] op_sel_hi:[1,0]
    v_pk_mul_f32 v[22:23], v[22:23], v[30:31] op_sel:[0,0] op_sel_hi:[1,0]
    v_pk_mul_f32 v[24:25], v[24:25], v[30:31] op_sel:[0,0] op_sel_hi:[1,0]
    v_pk_mul_f32 v[26:27], v[26:27], v[30:31] op_sel:[0,0] op_sel_hi:[1,0]
    v_pk_mul_f32 v[28:29], v[28:29], v[30:31] op_sel:[0,0] op_sel_hi:[1,0]
    v_cvt_pk_bf16_f32 v32, v14, v15
    v_lshlrev_b32 v14, 16, v32
    v_and_b32 v15, 0xffff0000, v32
    v_cvt_pk_bf16_f32 v32, v16, v17
    v_lshlrev_b32 v16, 16, v32
    v_and_b32 v17, 0xffff0000, v32
    v_cvt_pk_bf16_f32 v32, v18, v19
    v_lshlrev_b32 v18, 16, v32
    v_and_b32 v19, 0xffff0000, v32
    v_cvt_pk_bf16_f32 v32, v20, v21
    v_lshlrev_b32 v20, 16, v32
    v_and_b32 v21, 0xffff0000, v32
    v_cvt_pk_bf16_f32 v32, v22, v23
    v_lshlrev_b32 v22, 16, v32
    v_and_b32 v23, 0xffff0000, v32
    v_cvt_pk_bf16_f32 v32, v24, v25
    v_lshlrev_b32 v24, 16, v32
    v_and_b32 v25, 0xffff0000, v32
    v_cvt_pk_bf16_f32 v32, v26, v27
    v_lshlrev_b32 v26, 16, v32
    v_and_b32 v27, 0xffff0000, v32
    v_cvt_pk_bf16_f32 v32, v28, v29
    v_lshlrev_b32 v28, 16, v32
    v_and_b32 v29, 0xffff0000, v32
    v_pk_mul_f32 v[14:15], v[14:15], v[30:31] op_sel:[0,1] op_sel_hi:[1,1]
    v_pk_mul_f32 v[16:17], v[16:17], v[30:31] op_sel:[0,1] op_sel_hi:[1,1]
    v_pk_mul_f32 v[18:19], v[18:19], v[30:31] op_sel:[0,1] op_sel_hi:[1,1]
    v_pk_mul_f32 v[20:21], v[20:21], v[30:31] op_sel:[0,1] op_sel_hi:[1,1]
    v_pk_mul_f32 v[22:23], v[22:23], v[30:31] op_sel:[0,1] op_sel_hi:[1,1]
    v_pk_mul_f32 v[24:25], v[24:25], v[30:31] op_sel:[0,1] op_sel_hi:[1,1]
    v_pk_mul_f32 v[26:27], v[26:27], v[30:31] op_sel:[0,1] op_sel_hi:[1,1]
    v_pk_mul_f32 v[28:29], v[28:29], v[30:31] op_sel:[0,1] op_sel_hi:[1,1]
    v_exp_f32 v14, -v14
    v_exp_f32 v15, -v15
    v_exp_f32 v16, -v16
    v_exp_f32 v17, -v17
    v_exp_f32 v18, -v18
    v_exp_f32 v19, -v19
    v_exp_f32 v20, -v20
    v_exp_f32 v21, -v21
    v_exp_f32 v22, -v22
    v_exp_f32 v23, -v23
    v_exp_f32 v24, -v24
    v_exp_f32 v25, -v25
    v_exp_f32 v26, -v26
    v_exp_f32 v27, -v27
    v_exp_f32 v28, -v28
    v_exp_f32 v29, -v29
    v_cvt_pk_bf16_f32 v14, v14, v16
    v_cvt_pk_bf16_f32 v15, v15, v17
    v_cvt_pk_bf16_f32 v18, v18, v20
    v_cvt_pk_bf16_f32 v19, v19, v21
    v_cvt_pk_bf16_f32 v22, v22, v24
    v_cvt_pk_bf16_f32 v23, v23, v25
    v_cvt_pk_bf16_f32 v26, v26, v28
    v_cvt_pk_bf16_f32 v27, v27, v29
    v_dot2_f32_bf16 v112, v14, s68, 0
    v_dot2_f32_bf16 v113, v15, s68, 0
    v_dot2_f32_bf16 v114, v14, s69, 0
    v_dot2_f32_bf16 v115, v15, s69, 0
    v_dot2_f32_bf16 v116, v14, s70, 0
    v_dot2_f32_bf16 v117, v15, s70, 0
    v_dot2_f32_bf16 v118, v14, s71, 0
    v_dot2_f32_bf16 v119, v15, s71, 0
    v_dot2_f32_bf16 v120, v14, s52, 0
    v_dot2_f32_bf16 v121, v15, s52, 0
    v_dot2_f32_bf16 v122, v14, s53, 0
    v_dot2_f32_bf16 v123, v15, s53, 0
    v_dot2_f32_bf16 v124, v14, s54, 0
    v_dot2_f32_bf16 v125, v15, s54, 0
    v_dot2_f32_bf16 v126, v14, s55, 0
    v_dot2_f32_bf16 v127, v15, s55, 0
    v_dot2_f32_bf16 v112, v18, s72, v112
    v_dot2_f32_bf16 v113, v19, s72, v113
    v_dot2_f32_bf16 v114, v18, s73, v114
    v_dot2_f32_bf16 v115, v19, s73, v115
    v_dot2_f32_bf16 v116, v18, s74, v116
    v_dot2_f32_bf16 v117, v19, s74, v117
    v_dot2_f32_bf16 v118, v18, s75, v118
    v_dot2_f32_bf16 v119, v19, s75, v119
    v_dot2_f32_bf16 v120, v18, s56, v120
    v_dot2_f32_bf16 v121, v19, s56, v121
    v_dot2_f32_bf16 v122, v18, s57, v122
    v_dot2_f32_bf16 v123, v19, s57, v123
    v_dot2_f32_bf16 v124, v18, s58, v124
    v_dot2_f32_bf16 v125, v19, s58, v125
    v_dot2_f32_bf16 v126, v18, s59, v126
    v_dot2_f32_bf16 v127, v19, s59, v127
    v_dot2_f32_bf16 v112, v22, s76, v112
    v_dot2_f32_bf16 v113, v23, s76, v113
    v_dot2_f32_bf16 v114, v22, s77, v114
    v_dot2_f32_bf16 v115, v23, s77, v115
    v_dot2_f32_bf16 v116, v22, s78, v116
    v_dot2_f32_bf16 v117, v23, s78, v117
    v_dot2_f32_bf16 v118, v22, s79, v118
    v_dot2_f32_bf16 v119, v23, s79, v119
    v_dot2_f32_bf16 v120, v22, s60, v120
    v_dot2_f32_bf16 v121, v23, s60, v121
    v_dot2_f32_bf16 v122, v22, s61, v122
    v_dot2_f32_bf16 v123, v23, s61, v123
    v_dot2_f32_bf16 v124, v22, s62, v124
    v_dot2_f32_bf16 v125, v23, s62, v125
    v_dot2_f32_bf16 v126, v22, s63, v126
    v_dot2_f32_bf16 v127, v23, s63, v127
    v_dot2_f32_bf16 v112, v26, s80, v112
    v_dot2_f32_bf16 v113, v27, s80, v113
    v_dot2_f32_bf16 v114, v26, s81, v114
    v_dot2_f32_bf16 v115, v27, s81, v115
    v_dot2_f32_bf16 v116, v26, s82, v116
    v_dot2_f32_bf16 v117, v27, s82, v117
    v_dot2_f32_bf16 v118, v26, s83, v118
    v_dot2_f32_bf16 v119, v27, s83, v119
    v_dot2_f32_bf16 v120, v26, s64, v120
    v_dot2_f32_bf16 v121, v27, s64, v121
    v_dot2_f32_bf16 v122, v26, s65, v122
    v_dot2_f32_bf16 v123, v27, s65, v123
    v_dot2_f32_bf16 v124, v26, s66, v124
    v_dot2_f32_bf16 v125, v27, s66, v125
    v_dot2_f32_bf16 v126, v26, s67, v126
    v_dot2_f32_bf16 v127, v27, s67, v127
L_p2_kernel_g1_31:
    s_lshl2_add_u32 s14, s3, s49
    s_mul_i32 s26, s14, 20000
    s_mov_b32 s10, 5120000
    buffer_load_dwordx4 v[64:67], v1, s[8:11], s26 offen
    buffer_load_dwordx4 v[68:71], v2, s[8:11], s26 offen
    s_branch L_p2_fin
L_p2_done:
    s_branch L_p2_end
L_p2_slow:
    s_barrier
    v_mov_b32 v8, 0
    v_mov_b32 v9, 0
    v_mov_b32 v10, 0
    v_mov_b32 v11, 0
    v_mov_b32 v12, v1
    ds_write_b128 v12, v[8:11]
    v_add_u32 v12, 16384, v12
    ds_write_b128 v12, v[8:11]
    v_add_u32 v12, 16384, v12
    ds_write_b128 v12, v[8:11]
    v_add_u32 v12, 16384, v12
    ds_write_b128 v12, v[8:11]
    v_add_u32 v12, 16384, v12
    ds_write_b128 v12, v[8:11]
    v_add_u32 v12, 16384, v12
    ds_write_b128 v12, v[8:11]
    v_add_u32 v12, 16384, v12
    ds_write_b128 v12, v[8:11]
    v_add_u32 v12, 16384, v12
    ds_write_b128 v12, v[8:11]
    v_add_u32 v12, 16384, v12
    ds_write_b128 v12, v[8:11]
    v_add_u32 v12, 16384, v12
    ds_write_b128 v12, v[8:11]
    v_add_u32 v12, 16384, v12
    v_mul_u32_u24 v13, 8320, v0
    v_mov_b32 v29, 0x7fc00000
    v_add_u32 v28, 32, v13
    v_lshlrev_b32 v14, 10, v0
    v_add_u32 v14, 9437184, v14
    s_mul_i32 s25, s12, 65
    s_add_u32 s25, s25, s3
    s_lshl_b32 s25, s25, 5
    s_add_u32 s25, s25, 0
    s_lshl_b32 s50, s50, 1
    s_mul_i32 s22, s12, 1280000
    s_mov_b32 s24, 0
    s_waitcnt lgkmcnt(0)
    s_barrier
L_p2_sstep:
    buffer_load_ushort v15, v13, s[4:7], s25 offen
    buffer_load_ushort v16, v28, s[4:7], s25 offen
    s_waitcnt vmcnt(0)
L_p2_srec:
    v_cmp_lt_u32 vcc, v15, v16
    s_nop 1
    s_and_b64 exec, exec, vcc
    s_cbranch_execz L_p2_sdone
    v_mul_u32_u24 v17, 43691, v15
    v_lshrrev_b32 v17, 17, v17
    v_mad_i32_i24 v18, v17, -3, v15
    v_lshrrev_b32 v19, 6, v17
    v_lshl_add_u32 v19, v19, 20, v14
    v_and_b32 v17, 63, v17
    v_lshl_add_u32 v17, v17, 4, v19
    v_lshl_add_u32 v19, v18, 2, v17
    buffer_load_dword v20, v19, s[4:7], 0 offen
    buffer_load_dword v21, v17, s[4:7], 0 offen offset:12
    v_add_u32 v15, 1, v15
    v_mad_u32_u24 v18, v18, 10, 2
    s_waitcnt vmcnt(0)
    v_and_b32 v19, 0x3fff, v20
    v_lshlrev_b32 v19, 3, v19
    buffer_load_dwordx2 v[22:23], v19, s[8:11], s22 offen
    v_mad_u32_u16 v20, v20, 16, s50 op_sel:[1,0,0,0]
    v_bfe_i32 v21, v21, v18, 10
    v_cmp_eq_i32 vcc, -512, v21
    v_cvt_f32_i32 v21, v21
    v_mul_f32 v21, 989872160, v21
    v_cndmask_b32 v21, v21, v29, vcc
    s_waitcnt vmcnt(0)
    v_lshlrev_b32 v24, 16, v22
    v_and_b32 v25, 0xffff0000, v22
    v_lshlrev_b32 v26, 16, v23
    v_and_b32 v27, 0xffff0000, v23
    v_mul_f32 v24, v21, v24
    v_mul_f32 v25, v21, v25
    v_mul_f32 v26, v21, v26
    v_mul_f32 v27, v21, v27
    ds_add_f32 v20, v24
    ds_add_f32 v20, v25 offset:4
    ds_add_f32 v20, v26 offset:8
    ds_add_f32 v20, v27 offset:12
    s_branch L_p2_srec
L_p2_sdone:
    s_mov_b64 exec, -1
    s_add_u32 s25, s25, 2
    s_add_u32 s22, s22, 80000
    s_add_u32 s24, s24, 1
    s_cmp_lt_u32 s24, 16
    s_cbranch_scc1 L_p2_sstep
    s_waitcnt lgkmcnt(0)
    s_barrier
    s_mul_i32 s14, s12, 10240000
    s_mul_i32 s15, s3, 160000
    s_add_u32 s26, s14, s15
    s_add_u32 s26, s26, 249069568
    v_mov_b32 v12, v1
    s_mov_b32 s24, 0
L_p2_sout:
    v_cmp_gt_u32 vcc, 160000, v12
    ds_read_b128 v[8:11], v12
    s_nop 0
    s_and_b64 exec, exec, vcc
    s_cbranch_execz L_p2_sfin
    s_waitcnt lgkmcnt(0)
    buffer_store_dwordx4 v[8:11], v12, s[4:7], s26 offen sc1
    s_waitcnt vmcnt(0)
    v_add_u32 v12, 16384, v12
    s_branch L_p2_sout
L_p2_sfin:
    s_mov_b64 exec, -1
    s_waitcnt vmcnt(0) lgkmcnt(0)
    s_barrier
    s_branch L_p2_signal
L_p2_end:
    s_endpgm
.section .rodata,"a"
.p2align 6
.amdhsa_kernel p1_kernel
  .amdhsa_next_free_vgpr 128
  .amdhsa_next_free_sgpr 96
  .amdhsa_accum_offset 128
  .amdhsa_group_segment_fixed_size 0
  .amdhsa_kernarg_size 112
  .amdhsa_user_sgpr_count 2
  .amdhsa_user_sgpr_kernarg_segment_ptr 1
  .amdhsa_system_sgpr_workgroup_id_x 1
  .amdhsa_float_denorm_mode_32 0
.end_amdhsa_kernel
.p2align 6
.amdhsa_kernel p2_kernel
  .amdhsa_next_free_vgpr 128
  .amdhsa_next_free_sgpr 102
  .amdhsa_accum_offset 128
  .amdhsa_group_segment_fixed_size 0
  .amdhsa_kernarg_size 112
  .amdhsa_user_sgpr_count 2
  .amdhsa_user_sgpr_kernarg_segment_ptr 1
  .amdhsa_system_sgpr_workgroup_id_x 1
  .amdhsa_float_denorm_mode_32 0
.end_amdhsa_kernel
```

```asm
; @launch kernel=p1_kernel grid=(256,1,1) block=(1024,1,1) lds=163840
; @launch kernel=p2_kernel grid=(256,1,1) block=(1024,1,1) lds=163840
.amdgcn_target "amdgcn-amd-amdhsa--gfx950"
.text
.globl p1_kernel
.p2align 8
.type p1_kernel,@function
p1_kernel:
    s_cmp_ge_u32 s2, 256
    s_cbranch_scc1 L_p1_end
    s_load_dwordx2 s[4:5], s[0:1], 104
    s_load_dwordx2 s[8:9], s[0:1], 8
    s_load_dwordx2 s[12:13], s[0:1], 16
    s_load_dwordx2 s[16:17], s[0:1], 32
    s_load_dwordx2 s[28:29], s[0:1], 0
    s_load_dwordx2 s[6:7], s[0:1], 48
    v_cmp_gt_u32 vcc, 256, v0
    s_nop 1
    s_cbranch_vccz L_p1_nopf
    s_getpc_b64 s[72:73]
L_p1_kernel_pc_1:
    s_add_u32 s72, s72, L_p1_nopf-L_p1_kernel_pc_1
    s_addc_u32 s73, s73, 0
    v_lshlrev_b32 v14, 7, v0
    v_min_u32 v14, L_p2_end-L_p1_nopf, v14
    global_load_dword v15, v14, s[72:73]
L_p1_nopf:
    v_lshlrev_b32 v1, 4, v0
    v_lshlrev_b32 v2, 3, v0
    v_lshrrev_b32 v6, 6, v0
    v_mul_u32_u24 v3, 851904, v6
    v_add_lshl_u32 v3, v3, v0, 4
    v_mov_b32 v4, 1
    v_mov_b32 v5, 0
    v_readfirstlane_b32 s39, v6
    v_cmp_gt_u32 vcc, 784, v0
    s_and_b32 s51, s2, 7
    s_lshl_b32 s51, s51, 0
    s_bfe_u32 s35, s2, 3
    s_add_u32 s51, s51, s35
    s_and_b32 s35, s2, 248
    s_add_u32 s51, s51, s35
    s_and_b32 s32, s2, 7
    s_lshl_b32 s32, s32, 2
    s_bfe_u32 s35, s2, 131075
    s_add_u32 s32, s32, s35
    s_and_b32 s35, s2, 224
    s_add_u32 s32, s32, s35
    s_lshr_b32 s35, s39, 4
    s_mul_i32 s36, s35, 4177920
    s_lshl_b32 s33, s51, 14
    s_add_u32 s33, s33, s36
    s_lshr_b32 s34, s33, 1
    s_mul_i32 s48, s51, 3840
    s_cmp_ge_u32 s35, 0
    s_cselect_b32 s48, s48, 0
    s_lshr_b32 s49, s48, 1
    s_mov_b64 s[44:45], vcc
    s_waitcnt lgkmcnt(0)
    s_load_dword s3, s[6:7], 0
    s_mov_b32 s10, 163840000
    s_mov_b32 s11, 0x00020000
    s_mov_b32 s14, 163840000
    s_mov_b32 s15, 0x00020000
    s_mov_b32 s18, 81920000
    s_mov_b32 s19, 0x00020000
    s_mul_i32 s36, s2, 20000
    s_add_u32 s30, s36, 20000
    s_mov_b32 s31, 0x00020000
    s_add_u32 s35, s36, 16384
    buffer_load_dwordx4 v[48:51], v1, s[28:31], s36 offen
    buffer_load_dwordx4 v[52:55], v1, s[28:31], s35 offen
    s_add_u32 s35, s33, 0
    buffer_load_dwordx4 v[16:19], v1, s[8:11], s35 offen nt
    s_add_u32 s35, s33, 0
    buffer_load_dwordx4 v[20:23], v1, s[12:15], s35 offen nt
    s_add_u32 s35, s33, 4194304
    buffer_load_dwordx4 v[24:27], v1, s[8:11], s35 offen nt
    s_add_u32 s35, s33, 4194304
    buffer_load_dwordx4 v[28:31], v1, s[12:15], s35 offen nt
    s_add_u32 s35, s33, 8388608
    buffer_load_dwordx4 v[32:35], v1, s[8:11], s35 offen nt
    s_add_u32 s35, s33, 8388608
    buffer_load_dwordx4 v[36:39], v1, s[12:15], s35 offen nt
    s_add_u32 s35, s33, 12582912
    buffer_load_dwordx4 v[40:43], v1, s[8:11], s35 offen nt
    s_add_u32 s35, s33, 12582912
    buffer_load_dwordx4 v[44:47], v1, s[12:15], s35 offen nt
    s_add_u32 s35, s33, 16777216
    buffer_load_dwordx4 v[72:75], v1, s[8:11], s35 offen nt
    s_add_u32 s35, s33, 16777216
    buffer_load_dwordx4 v[76:79], v1, s[12:15], s35 offen nt
    s_mov_b32 s20, s4
    s_mov_b32 s21, s5
    s_mov_b32 s22, 0
    s_mov_b32 s23, 0x00020000
    s_add_u32 s24, s4, 0
    s_addc_u32 s25, s5, 0
    s_mov_b32 s26, 8540160
    s_mov_b32 s27, 0x00020000
    s_mov_b32 s37, 1492179184
    s_mov_b32 s55, 0
    s_mov_b32 s50, 21845
    s_mov_b32 s52, 0x8000
    s_mov_b32 s38, 262400
    s_mov_b32 s43, 0x05040100
    s_mov_b32 s40, 0
    v_mov_b32 v8, 0
    v_mov_b32 v9, 0
    v_mov_b32 v10, 0
    v_mov_b32 v11, 0
    ds_write_b128 v1, v[8:11] offset:0
    s_waitcnt lgkmcnt(0)
    s_lshl_b32 s3, s3, 16
    v_mov_b32 v12, s3
    v_mul_f32 v12, 0.15915494, v12
    s_nop 0
    v_readfirstlane_b32 s41, v12
    s_waitcnt vmcnt(10)
    v_mov_b32 v12, 0x3f803f80
    v_and_b32 v48, 0x7fff7fff, v48
    v_and_b32 v49, 0x7fff7fff, v49
    v_and_b32 v50, 0x7fff7fff, v50
    v_and_b32 v51, 0x7fff7fff, v51
    v_and_b32 v52, 0x7fff7fff, v52
    v_and_b32 v53, 0x7fff7fff, v53
    v_and_b32 v54, 0x7fff7fff, v54
    v_and_b32 v55, 0x7fff7fff, v55
    v_pk_max_u16 v8, v8, v48
    v_dot2c_f32_bf16 v9, v48, v12
    v_pk_max_u16 v8, v8, v49
    v_dot2c_f32_bf16 v9, v49, v12
    v_pk_max_u16 v8, v8, v50
    v_dot2c_f32_bf16 v9, v50, v12
    v_pk_max_u16 v8, v8, v51
    v_dot2c_f32_bf16 v9, v51, v12
    v_pk_max_u16 v8, v8, v52
    v_dot2c_f32_bf16 v9, v52, v12
    v_pk_max_u16 v8, v8, v53
    v_dot2c_f32_bf16 v9, v53, v12
    v_pk_max_u16 v8, v8, v54
    v_dot2c_f32_bf16 v9, v54, v12
    v_pk_max_u16 v8, v8, v55
    v_dot2c_f32_bf16 v9, v55, v12
    v_lshrrev_b32 v10, 16, v8
    v_and_b32 v8, 0xffff, v8
    v_max_u32 v8, v8, v10
    s_nop 0
    s_nop 1
    v_max_u32_dpp v8, v8, v8 row_shr:1 row_mask:0xf bank_mask:0xf bound_ctrl:0
    s_nop 1
    v_max_u32_dpp v8, v8, v8 row_shr:2 row_mask:0xf bank_mask:0xf bound_ctrl:0
    s_nop 1
    v_max_u32_dpp v8, v8, v8 row_shr:4 row_mask:0xf bank_mask:0xf bound_ctrl:0
    s_nop 1
    v_max_u32_dpp v8, v8, v8 row_shr:8 row_mask:0xf bank_mask:0xf bound_ctrl:0
    s_nop 1
    v_max_u32_dpp v8, v8, v8 row_bcast:15 row_mask:0xa bank_mask:0xf
    s_nop 1
    v_max_u32_dpp v8, v8, v8 row_bcast:31 row_mask:0xc bank_mask:0xf
    s_nop 1
    v_add_f32_dpp v9, v9, v9 row_shr:1 row_mask:0xf bank_mask:0xf bound_ctrl:0
    s_nop 1
    v_add_f32_dpp v9, v9, v9 row_shr:2 row_mask:0xf bank_mask:0xf bound_ctrl:0
    s_nop 1
    v_add_f32_dpp v9, v9, v9 row_shr:4 row_mask:0xf bank_mask:0xf bound_ctrl:0
    s_nop 1
    v_add_f32_dpp v9, v9, v9 row_shr:8 row_mask:0xf bank_mask:0xf bound_ctrl:0
    s_nop 1
    v_add_f32_dpp v9, v9, v9 row_bcast:15 row_mask:0xa bank_mask:0xf
    s_nop 1
    v_add_f32_dpp v9, v9, v9 row_bcast:31 row_mask:0xc bank_mask:0xf
    s_lshl_b32 s35, s39, 4
    s_add_u32 s35, s35, 160320
    v_mov_b32 v10, s35
    s_mov_b32 exec_lo, 0
    s_brev_b32 exec_hi, 1
    ds_write_b64 v10, v[8:9]
    s_mov_b64 exec, -1
    s_waitcnt lgkmcnt(0)
    s_barrier
    s_branch L_p1_first
L_p1_loop:
    s_getreg_b32 s51, hwreg(HW_REG_XCC_ID, 0, 1)
    s_cmp_eq_u32 s51, 0
    s_cselect_b64 vcc, -1, 0
    s_waitcnt lgkmcnt(13)
    v_lshlrev_b32 v15, 22, v100
    v_lshrrev_b32 v100, 16, v100
    v_alignbit_b32 v15, v100, v15, 10
    v_alignbit_b32 v15, v101, v15, 10
    v_xor_b32 v15, 0x80200800, v15
    s_cmp_lg_u32 s39, 15
    s_cbranch_scc1 L_p1_kernel_nox_2
    s_mov_b32 s36, 13631488
    buffer_store_dwordx4 v[12:15], v3, s[20:23], s36 offen sc1
L_p1_kernel_nox_2:
    s_waitcnt lgkmcnt(12)
    v_lshlrev_b32 v75, 22, v102
    v_lshrrev_b32 v102, 16, v102
    v_alignbit_b32 v75, v102, v75, 10
    v_alignbit_b32 v75, v103, v75, 10
    v_xor_b32 v75, 0x80200800, v75
    s_mov_b32 s36, 0
    buffer_store_dwordx4 v[72:75], v3, s[20:23], s36 offen sc1
    s_waitcnt lgkmcnt(11)
    v_lshlrev_b32 v79, 22, v104
    v_lshrrev_b32 v104, 16, v104
    v_alignbit_b32 v79, v104, v79, 10
    v_alignbit_b32 v79, v105, v79, 10
    v_xor_b32 v79, 0x80200800, v79
    s_mov_b32 s36, 1048576
    buffer_store_dwordx4 v[76:79], v3, s[20:23], s36 offen sc1
    s_waitcnt lgkmcnt(10)
    v_lshlrev_b32 v51, 22, v106
    v_lshrrev_b32 v106, 16, v106
    v_alignbit_b32 v51, v106, v51, 10
    v_alignbit_b32 v51, v107, v51, 10
    v_xor_b32 v51, 0x80200800, v51
    s_mov_b32 s36, 2097152
    buffer_store_dwordx4 v[48:51], v3, s[20:23], s36 offen sc1
    s_add_u32 s35, s33, 16777216
    buffer_load_dwordx4 v[72:75], v1, s[8:11], s35 offen nt
    s_add_u32 s35, s33, 16777216
    buffer_load_dwordx4 v[76:79], v1, s[12:15], s35 offen nt
    s_cbranch_vccz L_p1_kernel_thr_3
    s_waitcnt vmcnt(2)
L_p1_kernel_thr_3:
    s_waitcnt lgkmcnt(9)
    v_lshlrev_b32 v83, 22, v108
    v_lshrrev_b32 v108, 16, v108
    v_alignbit_b32 v83, v108, v83, 10
    v_alignbit_b32 v83, v109, v83, 10
    v_xor_b32 v83, 0x80200800, v83
    s_mov_b32 s36, 3145728
    buffer_store_dwordx4 v[80:83], v3, s[20:23], s36 offen sc1
    s_waitcnt lgkmcnt(8)
    v_lshlrev_b32 v55, 22, v110
    v_lshrrev_b32 v110, 16, v110
    v_alignbit_b32 v55, v110, v55, 10
    v_alignbit_b32 v55, v111, v55, 10
    v_xor_b32 v55, 0x80200800, v55
    s_mov_b32 s36, 4194304
    buffer_store_dwordx4 v[52:55], v3, s[20:23], s36 offen sc1
    s_add_u32 s35, s33, 20971520
    buffer_load_dwordx4 v[80:83], v1, s[8:11], s35 offen nt
    s_add_u32 s35, s33, 20971520
    buffer_load_dwordx4 v[100:103], v1, s[12:15], s35 offen nt
    s_cbranch_vccz L_p1_kernel_thr_4
    s_waitcnt vmcnt(2)
L_p1_kernel_thr_4:
    s_waitcnt lgkmcnt(7)
    v_lshlrev_b32 v87, 22, v112
    v_lshrrev_b32 v112, 16, v112
    v_alignbit_b32 v87, v112, v87, 10
    v_alignbit_b32 v87, v113, v87, 10
    v_xor_b32 v87, 0x80200800, v87
    s_mov_b32 s36, 5242880
    buffer_store_dwordx4 v[84:87], v3, s[20:23], s36 offen sc1
    s_waitcnt lgkmcnt(6)
    v_lshlrev_b32 v59, 22, v114
    v_lshrrev_b32 v114, 16, v114
    v_alignbit_b32 v59, v114, v59, 10
    v_alignbit_b32 v59, v115, v59, 10
    v_xor_b32 v59, 0x80200800, v59
    s_mov_b32 s36, 6291456
    buffer_store_dwordx4 v[56:59], v3, s[20:23], s36 offen sc1
    s_add_u32 s35, s33, 25165824
    buffer_load_dwordx4 v[84:87], v1, s[8:11], s35 offen nt
    s_add_u32 s35, s33, 25165824
    buffer_load_dwordx4 v[104:107], v1, s[12:15], s35 offen nt
    s_cbranch_vccz L_p1_kernel_thr_5
    s_waitcnt vmcnt(2)
L_p1_kernel_thr_5:
    s_waitcnt lgkmcnt(5)
    v_lshlrev_b32 v91, 22, v116
    v_lshrrev_b32 v116, 16, v116
    v_alignbit_b32 v91, v116, v91, 10
    v_alignbit_b32 v91, v117, v91, 10
    v_xor_b32 v91, 0x80200800, v91
    s_mov_b32 s36, 7340032
    buffer_store_dwordx4 v[88:91], v3, s[20:23], s36 offen sc1
    s_waitcnt lgkmcnt(4)
    v_lshlrev_b32 v63, 22, v118
    v_lshrrev_b32 v118, 16, v118
    v_alignbit_b32 v63, v118, v63, 10
    v_alignbit_b32 v63, v119, v63, 10
    v_xor_b32 v63, 0x80200800, v63
    s_mov_b32 s36, 8388608
    buffer_store_dwordx4 v[60:63], v3, s[20:23], s36 offen sc1
    s_add_u32 s35, s33, 29360128
    buffer_load_dwordx4 v[88:91], v1, s[8:11], s35 offen nt
    s_add_u32 s35, s33, 29360128
    buffer_load_dwordx4 v[108:111], v1, s[12:15], s35 offen nt
    s_cbranch_vccz L_p1_kernel_thr_6
    s_waitcnt vmcnt(2)
L_p1_kernel_thr_6:
    s_waitcnt lgkmcnt(3)
    v_lshlrev_b32 v95, 22, v120
    v_lshrrev_b32 v120, 16, v120
    v_alignbit_b32 v95, v120, v95, 10
    v_alignbit_b32 v95, v121, v95, 10
    v_xor_b32 v95, 0x80200800, v95
    s_mov_b32 s36, 9437184
    buffer_store_dwordx4 v[92:95], v3, s[20:23], s36 offen sc1
    s_waitcnt lgkmcnt(2)
    v_lshlrev_b32 v67, 22, v122
    v_lshrrev_b32 v122, 16, v122
    v_alignbit_b32 v67, v122, v67, 10
    v_alignbit_b32 v67, v123, v67, 10
    v_xor_b32 v67, 0x80200800, v67
    s_mov_b32 s36, 10485760
    buffer_store_dwordx4 v[64:67], v3, s[20:23], s36 offen sc1
    s_add_u32 s35, s33, 33554432
    buffer_load_dwordx4 v[92:95], v1, s[8:11], s35 offen nt
    s_add_u32 s35, s33, 33554432
    buffer_load_dwordx4 v[112:115], v1, s[12:15], s35 offen nt
    s_cbranch_vccz L_p1_kernel_thr_7
    s_waitcnt vmcnt(2)
L_p1_kernel_thr_7:
    s_waitcnt lgkmcnt(1)
    v_lshlrev_b32 v99, 22, v124
    v_lshrrev_b32 v124, 16, v124
    v_alignbit_b32 v99, v124, v99, 10
    v_alignbit_b32 v99, v125, v99, 10
    v_xor_b32 v99, 0x80200800, v99
    s_mov_b32 s36, 11534336
    buffer_store_dwordx4 v[96:99], v3, s[20:23], s36 offen sc1
    s_waitcnt lgkmcnt(0)
    v_lshlrev_b32 v71, 22, v126
    v_lshrrev_b32 v126, 16, v126
    v_alignbit_b32 v71, v126, v71, 10
    v_alignbit_b32 v71, v127, v71, 10
    v_xor_b32 v71, 0x80200800, v71
    s_mov_b32 s36, 12582912
    buffer_store_dwordx4 v[68:71], v3, s[20:23], s36 offen sc1
    s_add_u32 s35, s33, 37748736
    s_sub_u32 s35, s35, s48
    v_cndmask_b32 v96, 2.0, v1, s[44:45]
    buffer_load_dwordx4 v[96:99], v96, s[8:11], s35 offen nt
    s_add_u32 s35, s33, 37748736
    s_sub_u32 s35, s35, s48
    v_cndmask_b32 v116, 2.0, v1, s[44:45]
    buffer_load_dwordx4 v[116:119], v116, s[12:15], s35 offen nt
    s_cbranch_vccz L_p1_kernel_thr_8
    s_waitcnt vmcnt(2)
L_p1_kernel_thr_8:
    s_branch L_p1_join
L_p1_first:
    s_add_u32 s35, s33, 20971520
    buffer_load_dwordx4 v[80:83], v1, s[8:11], s35 offen nt
    s_add_u32 s35, s33, 20971520
    buffer_load_dwordx4 v[100:103], v1, s[12:15], s35 offen nt
    s_add_u32 s35, s33, 25165824
    buffer_load_dwordx4 v[84:87], v1, s[8:11], s35 offen nt
    s_add_u32 s35, s33, 25165824
    buffer_load_dwordx4 v[104:107], v1, s[12:15], s35 offen nt
    s_add_u32 s35, s33, 29360128
    buffer_load_dwordx4 v[88:91], v1, s[8:11], s35 offen nt
    s_add_u32 s35, s33, 29360128
    buffer_load_dwordx4 v[108:111], v1, s[12:15], s35 offen nt
    s_add_u32 s35, s33, 33554432
    buffer_load_dwordx4 v[92:95], v1, s[8:11], s35 offen nt
    s_add_u32 s35, s33, 33554432
    buffer_load_dwordx4 v[112:115], v1, s[12:15], s35 offen nt
    s_add_u32 s35, s33, 37748736
    s_sub_u32 s35, s35, s48
    v_cndmask_b32 v96, 2.0, v1, s[44:45]
    buffer_load_dwordx4 v[96:99], v96, s[8:11], s35 offen nt
    s_add_u32 s35, s33, 37748736
    s_sub_u32 s35, s35, s48
    v_cndmask_b32 v116, 2.0, v1, s[44:45]
    buffer_load_dwordx4 v[116:119], v116, s[12:15], s35 offen nt
L_p1_join:
    s_waitcnt vmcnt(18)
    v_perm_b32 v6, v20, v16, s43
    v_perm_b32 v7, v21, v17, s43
    v_perm_b32 v8, v22, v18, s43
    v_perm_b32 v9, v23, v19, s43
    v_mul_hi_u32_u24 v16, 429497, v16
    v_mul_hi_u32_u24 v20, 429497, v20
    v_mul_hi_u32_u24 v17, 429497, v17
    v_mul_hi_u32_u24 v21, 429497, v21
    v_mul_hi_u32_u24 v18, 429497, v18
    v_mul_hi_u32_u24 v22, 429497, v22
    v_mul_hi_u32_u24 v19, 429497, v19
    v_mul_hi_u32_u24 v23, 429497, v23
    v_lshl_or_b32 v16, v20, 16, v16
    v_lshl_or_b32 v17, v21, 16, v17
    v_lshl_or_b32 v18, v22, 16, v18
    v_lshl_or_b32 v19, v23, 16, v19
    v_dot2_u32_u16 v20, v16, s38, 0
    v_dot2_u32_u16 v21, v17, s38, 0
    v_dot2_u32_u16 v22, v18, s38, 0
    v_dot2_u32_u16 v23, v19, s38, 0
    v_pk_mad_u16 v6, v16, s37, v6
    v_pk_mad_u16 v7, v17, s37, v7
    v_pk_mad_u16 v8, v18, s37, v8
    v_pk_mad_u16 v9, v19, s37, v9
    ds_add_u32 v20, v4 offset:0
    ds_add_u32 v21, v4 offset:0
    ds_add_u32 v22, v4 offset:0
    ds_add_u32 v23, v4 offset:0
    v_pk_mad_u16 v6, v16, s52, v6 op_sel:[1,0,0] op_sel_hi:[1,1,1]
    v_pk_mad_u16 v7, v17, s52, v7 op_sel:[1,0,0] op_sel_hi:[1,1,1]
    v_pk_mad_u16 v8, v18, s52, v8 op_sel:[1,0,0] op_sel_hi:[1,1,1]
    v_pk_mad_u16 v9, v19, s52, v9 op_sel:[1,0,0] op_sel_hi:[1,1,1]
    v_perm_b32 v55, v23, v22, s43
    v_perm_b32 v51, v21, v20, s43
    v_or_b32 v48, 0x40000000, v6
    v_or_b32 v49, 0x40000000, v7
    v_or_b32 v50, 0x40000000, v8
    v_or_b32 v52, 0x40000000, v9
    s_waitcnt vmcnt(16)
    v_perm_b32 v6, v28, v24, s43
    v_perm_b32 v7, v29, v25, s43
    v_perm_b32 v8, v30, v26, s43
    v_perm_b32 v9, v31, v27, s43
    v_mul_hi_u32_u24 v24, 429497, v24
    v_mul_hi_u32_u24 v28, 429497, v28
    v_mul_hi_u32_u24 v25, 429497, v25
    v_mul_hi_u32_u24 v29, 429497, v29
    v_mul_hi_u32_u24 v26, 429497, v26
    v_mul_hi_u32_u24 v30, 429497, v30
    v_mul_hi_u32_u24 v27, 429497, v27
    v_mul_hi_u32_u24 v31, 429497, v31
    v_lshl_or_b32 v24, v28, 16, v24
    v_lshl_or_b32 v25, v29, 16, v25
    v_lshl_or_b32 v26, v30, 16, v26
    v_lshl_or_b32 v27, v31, 16, v27
    v_dot2_u32_u16 v28, v24, s38, 0
    v_dot2_u32_u16 v29, v25, s38, 0
    v_dot2_u32_u16 v30, v26, s38, 0
    v_dot2_u32_u16 v31, v27, s38, 0
    v_pk_mad_u16 v6, v24, s37, v6
    v_pk_mad_u16 v7, v25, s37, v7
    v_pk_mad_u16 v8, v26, s37, v8
    v_pk_mad_u16 v9, v27, s37, v9
    ds_add_u32 v28, v4 offset:0
    ds_add_u32 v29, v4 offset:0
    ds_add_u32 v30, v4 offset:0
    ds_add_u32 v31, v4 offset:0
    v_pk_mad_u16 v6, v24, s52, v6 op_sel:[1,0,0] op_sel_hi:[1,1,1]
    v_pk_mad_u16 v7, v25, s52, v7 op_sel:[1,0,0] op_sel_hi:[1,1,1]
    v_pk_mad_u16 v8, v26, s52, v8 op_sel:[1,0,0] op_sel_hi:[1,1,1]
    v_pk_mad_u16 v9, v27, s52, v9 op_sel:[1,0,0] op_sel_hi:[1,1,1]
    v_perm_b32 v63, v31, v30, s43
    v_perm_b32 v59, v29, v28, s43
    v_or_b32 v53, 0x40000000, v6
    v_or_b32 v54, 0x40000000, v7
    v_or_b32 v56, 0x40000000, v8
    v_or_b32 v57, 0x40000000, v9
    s_waitcnt vmcnt(14)
    v_perm_b32 v6, v36, v32, s43
    v_perm_b32 v7, v37, v33, s43
    v_perm_b32 v8, v38, v34, s43
    v_perm_b32 v9, v39, v35, s43
    v_mul_hi_u32_u24 v32, 429497, v32
    v_mul_hi_u32_u24 v36, 429497, v36
    v_mul_hi_u32_u24 v33, 429497, v33
    v_mul_hi_u32_u24 v37, 429497, v37
    v_mul_hi_u32_u24 v34, 429497, v34
    v_mul_hi_u32_u24 v38, 429497, v38
    v_mul_hi_u32_u24 v35, 429497, v35
    v_mul_hi_u32_u24 v39, 429497, v39
    v_lshl_or_b32 v32, v36, 16, v32
    v_lshl_or_b32 v33, v37, 16, v33
    v_lshl_or_b32 v34, v38, 16, v34
    v_lshl_or_b32 v35, v39, 16, v35
    v_dot2_u32_u16 v36, v32, s38, 0
    v_dot2_u32_u16 v37, v33, s38, 0
    v_dot2_u32_u16 v38, v34, s38, 0
    v_dot2_u32_u16 v39, v35, s38, 0
    v_pk_mad_u16 v6, v32, s37, v6
    v_pk_mad_u16 v7, v33, s37, v7
    v_pk_mad_u16 v8, v34, s37, v8
    v_pk_mad_u16 v9, v35, s37, v9
    ds_add_u32 v36, v4 offset:0
    ds_add_u32 v37, v4 offset:0
    ds_add_u32 v38, v4 offset:0
    ds_add_u32 v39, v4 offset:0
    v_pk_mad_u16 v6, v32, s52, v6 op_sel:[1,0,0] op_sel_hi:[1,1,1]
    v_pk_mad_u16 v7, v33, s52, v7 op_sel:[1,0,0] op_sel_hi:[1,1,1]
    v_pk_mad_u16 v8, v34, s52, v8 op_sel:[1,0,0] op_sel_hi:[1,1,1]
    v_pk_mad_u16 v9, v35, s52, v9 op_sel:[1,0,0] op_sel_hi:[1,1,1]
    v_perm_b32 v71, v39, v38, s43
    v_perm_b32 v67, v37, v36, s43
    v_or_b32 v58, 0x40000000, v6
    v_or_b32 v60, 0x40000000, v7
    v_or_b32 v61, 0x40000000, v8
    v_or_b32 v62, 0x40000000, v9
    s_waitcnt vmcnt(12)
    v_perm_b32 v6, v44, v40, s43
    v_perm_b32 v7, v45, v41, s43
    v_perm_b32 v8, v46, v42, s43
    v_perm_b32 v9, v47, v43, s43
    v_mul_hi_u32_u24 v40, 429497, v40
    v_mul_hi_u32_u24 v44, 429497, v44
    v_mul_hi_u32_u24 v41, 429497, v41
    v_mul_hi_u32_u24 v45, 429497, v45
    v_mul_hi_u32_u24 v42, 429497, v42
    v_mul_hi_u32_u24 v46, 429497, v46
    v_mul_hi_u32_u24 v43, 429497, v43
    v_mul_hi_u32_u24 v47, 429497, v47
    v_lshl_or_b32 v40, v44, 16, v40
    v_lshl_or_b32 v41, v45, 16, v41
    v_lshl_or_b32 v42, v46, 16, v42
    v_lshl_or_b32 v43, v47, 16, v43
    v_dot2_u32_u16 v44, v40, s38, 0
    v_dot2_u32_u16 v45, v41, s38, 0
    v_dot2_u32_u16 v46, v42, s38, 0
    v_dot2_u32_u16 v47, v43, s38, 0
    v_pk_mad_u16 v6, v40, s37, v6
    v_pk_mad_u16 v7, v41, s37, v7
    v_pk_mad_u16 v8, v42, s37, v8
    v_pk_mad_u16 v9, v43, s37, v9
    ds_add_u32 v44, v4 offset:0
    ds_add_u32 v45, v4 offset:0
    ds_add_u32 v46, v4 offset:0
    ds_add_u32 v47, v4 offset:0
    v_pk_mad_u16 v6, v40, s52, v6 op_sel:[1,0,0] op_sel_hi:[1,1,1]
    v_pk_mad_u16 v7, v41, s52, v7 op_sel:[1,0,0] op_sel_hi:[1,1,1]
    v_pk_mad_u16 v8, v42, s52, v8 op_sel:[1,0,0] op_sel_hi:[1,1,1]
    v_pk_mad_u16 v9, v43, s52, v9 op_sel:[1,0,0] op_sel_hi:[1,1,1]
    v_perm_b32 v121, v47, v46, s43
    v_perm_b32 v120, v45, v44, s43
    v_or_b32 v64, 0x40000000, v6
    v_or_b32 v65, 0x40000000, v7
    v_or_b32 v66, 0x40000000, v8
    v_or_b32 v68, 0x40000000, v9
    s_waitcnt vmcnt(10)
    v_perm_b32 v6, v76, v72, s43
    v_perm_b32 v7, v77, v73, s43
    v_perm_b32 v8, v78, v74, s43
    v_perm_b32 v9, v79, v75, s43
    v_mul_hi_u32_u24 v72, 429497, v72
    v_mul_hi_u32_u24 v76, 429497, v76
    v_mul_hi_u32_u24 v73, 429497, v73
    v_mul_hi_u32_u24 v77, 429497, v77
    v_mul_hi_u32_u24 v74, 429497, v74
    v_mul_hi_u32_u24 v78, 429497, v78
    v_mul_hi_u32_u24 v75, 429497, v75
    v_mul_hi_u32_u24 v79, 429497, v79
    v_lshl_or_b32 v72, v76, 16, v72
    v_lshl_or_b32 v73, v77, 16, v73
    v_lshl_or_b32 v74, v78, 16, v74
    v_lshl_or_b32 v75, v79, 16, v75
    v_dot2_u32_u16 v76, v72, s38, 0
    v_dot2_u32_u16 v77, v73, s38, 0
    v_dot2_u32_u16 v78, v74, s38, 0
    v_dot2_u32_u16 v79, v75, s38, 0
    v_pk_mad_u16 v6, v72, s37, v6
    v_pk_mad_u16 v7, v73, s37, v7
    v_pk_mad_u16 v8, v74, s37, v8
    v_pk_mad_u16 v9, v75, s37, v9
    ds_add_u32 v76, v4 offset:0
    ds_add_u32 v77, v4 offset:0
    ds_add_u32 v78, v4 offset:0
    ds_add_u32 v79, v4 offset:0
    v_pk_mad_u16 v6, v72, s52, v6 op_sel:[1,0,0] op_sel_hi:[1,1,1]
    v_pk_mad_u16 v7, v73, s52, v7 op_sel:[1,0,0] op_sel_hi:[1,1,1]
    v_pk_mad_u16 v8, v74, s52, v8 op_sel:[1,0,0] op_sel_hi:[1,1,1]
    v_pk_mad_u16 v9, v75, s52, v9 op_sel:[1,0,0] op_sel_hi:[1,1,1]
    v_perm_b32 v123, v79, v78, s43
    v_perm_b32 v122, v77, v76, s43
    v_or_b32 v69, 0x40000000, v6
    v_or_b32 v70, 0x40000000, v7
    v_or_b32 v127, 0x40000000, v8
    v_or_b32 v72, 0x40000000, v9
    s_waitcnt vmcnt(8)
    v_perm_b32 v6, v100, v80, s43
    v_perm_b32 v7, v101, v81, s43
    v_perm_b32 v8, v102, v82, s43
    v_perm_b32 v9, v103, v83, s43
    v_mul_hi_u32_u24 v80, 429497, v80
    v_mul_hi_u32_u24 v100, 429497, v100
    v_mul_hi_u32_u24 v81, 429497, v81
    v_mul_hi_u32_u24 v101, 429497, v101
    v_mul_hi_u32_u24 v82, 429497, v82
    v_mul_hi_u32_u24 v102, 429497, v102
    v_mul_hi_u32_u24 v83, 429497, v83
    v_mul_hi_u32_u24 v103, 429497, v103
    v_lshl_or_b32 v80, v100, 16, v80
    v_lshl_or_b32 v81, v101, 16, v81
    v_lshl_or_b32 v82, v102, 16, v82
    v_lshl_or_b32 v83, v103, 16, v83
    v_dot2_u32_u16 v100, v80, s38, 0
    v_dot2_u32_u16 v101, v81, s38, 0
    v_dot2_u32_u16 v102, v82, s38, 0
    v_dot2_u32_u16 v103, v83, s38, 0
    v_pk_mad_u16 v6, v80, s37, v6
    v_pk_mad_u16 v7, v81, s37, v7
    v_pk_mad_u16 v8, v82, s37, v8
    v_pk_mad_u16 v9, v83, s37, v9
    ds_add_u32 v100, v4 offset:0
    ds_add_u32 v101, v4 offset:0
    ds_add_u32 v102, v4 offset:0
    ds_add_u32 v103, v4 offset:0
    v_pk_mad_u16 v6, v80, s52, v6 op_sel:[1,0,0] op_sel_hi:[1,1,1]
    v_pk_mad_u16 v7, v81, s52, v7 op_sel:[1,0,0] op_sel_hi:[1,1,1]
    v_pk_mad_u16 v8, v82, s52, v8 op_sel:[1,0,0] op_sel_hi:[1,1,1]
    v_pk_mad_u16 v9, v83, s52, v9 op_sel:[1,0,0] op_sel_hi:[1,1,1]
    v_perm_b32 v125, v103, v102, s43
    v_perm_b32 v124, v101, v100, s43
    v_or_b32 v73, 0x40000000, v6
    v_or_b32 v74, 0x40000000, v7
    v_or_b32 v76, 0x40000000, v8
    v_or_b32 v77, 0x40000000, v9
    s_waitcnt vmcnt(6)
    v_perm_b32 v6, v104, v84, s43
    v_perm_b32 v7, v105, v85, s43
    v_perm_b32 v8, v106, v86, s43
    v_perm_b32 v9, v107, v87, s43
    v_mul_hi_u32_u24 v84, 429497, v84
    v_mul_hi_u32_u24 v104, 429497, v104
    v_mul_hi_u32_u24 v85, 429497, v85
    v_mul_hi_u32_u24 v105, 429497, v105
    v_mul_hi_u32_u24 v86, 429497, v86
    v_mul_hi_u32_u24 v106, 429497, v106
    v_mul_hi_u32_u24 v87, 429497, v87
    v_mul_hi_u32_u24 v107, 429497, v107
    v_lshl_or_b32 v84, v104, 16, v84
    v_lshl_or_b32 v85, v105, 16, v85
    v_lshl_or_b32 v86, v106, 16, v86
    v_lshl_or_b32 v87, v107, 16, v87
    v_dot2_u32_u16 v104, v84, s38, 0
    v_dot2_u32_u16 v105, v85, s38, 0
    v_dot2_u32_u16 v106, v86, s38, 0
    v_dot2_u32_u16 v107, v87, s38, 0
    v_pk_mad_u16 v6, v84, s37, v6
    v_pk_mad_u16 v7, v85, s37, v7
    v_pk_mad_u16 v8, v86, s37, v8
    v_pk_mad_u16 v9, v87, s37, v9
    ds_add_u32 v104, v4 offset:0
    ds_add_u32 v105, v4 offset:0
    ds_add_u32 v106, v4 offset:0
    ds_add_u32 v107, v4 offset:0
    v_pk_mad_u16 v6, v84, s52, v6 op_sel:[1,0,0] op_sel_hi:[1,1,1]
    v_pk_mad_u16 v7, v85, s52, v7 op_sel:[1,0,0] op_sel_hi:[1,1,1]
    v_pk_mad_u16 v8, v86, s52, v8 op_sel:[1,0,0] op_sel_hi:[1,1,1]
    v_pk_mad_u16 v9, v87, s52, v9 op_sel:[1,0,0] op_sel_hi:[1,1,1]
    v_perm_b32 v75, v107, v106, s43
    v_perm_b32 v126, v105, v104, s43
    v_or_b32 v78, 0x40000000, v6
    v_or_b32 v80, 0x40000000, v7
    v_or_b32 v81, 0x40000000, v8
    v_or_b32 v82, 0x40000000, v9
    s_waitcnt vmcnt(4)
    v_perm_b32 v6, v108, v88, s43
    v_perm_b32 v7, v109, v89, s43
    v_perm_b32 v8, v110, v90, s43
    v_perm_b32 v9, v111, v91, s43
    v_mul_hi_u32_u24 v88, 429497, v88
    v_mul_hi_u32_u24 v108, 429497, v108
    v_mul_hi_u32_u24 v89, 429497, v89
    v_mul_hi_u32_u24 v109, 429497, v109
    v_mul_hi_u32_u24 v90, 429497, v90
    v_mul_hi_u32_u24 v110, 429497, v110
    v_mul_hi_u32_u24 v91, 429497, v91
    v_mul_hi_u32_u24 v111, 429497, v111
    v_lshl_or_b32 v88, v108, 16, v88
    v_lshl_or_b32 v89, v109, 16, v89
    v_lshl_or_b32 v90, v110, 16, v90
    v_lshl_or_b32 v91, v111, 16, v91
    v_dot2_u32_u16 v108, v88, s38, 0
    v_dot2_u32_u16 v109, v89, s38, 0
    v_dot2_u32_u16 v110, v90, s38, 0
    v_dot2_u32_u16 v111, v91, s38, 0
    v_pk_mad_u16 v6, v88, s37, v6
    v_pk_mad_u16 v7, v89, s37, v7
    v_pk_mad_u16 v8, v90, s37, v8
    v_pk_mad_u16 v9, v91, s37, v9
    ds_add_u32 v108, v4 offset:0
    ds_add_u32 v109, v4 offset:0
    ds_add_u32 v110, v4 offset:0
    ds_add_u32 v111, v4 offset:0
    v_pk_mad_u16 v6, v88, s52, v6 op_sel:[1,0,0] op_sel_hi:[1,1,1]
    v_pk_mad_u16 v7, v89, s52, v7 op_sel:[1,0,0] op_sel_hi:[1,1,1]
    v_pk_mad_u16 v8, v90, s52, v8 op_sel:[1,0,0] op_sel_hi:[1,1,1]
    v_pk_mad_u16 v9, v91, s52, v9 op_sel:[1,0,0] op_sel_hi:[1,1,1]
    v_perm_b32 v83, v111, v110, s43
    v_perm_b32 v79, v109, v108, s43
    v_or_b32 v84, 0x40000000, v6
    v_or_b32 v85, 0x40000000, v7
    v_or_b32 v86, 0x40000000, v8
    v_or_b32 v88, 0x40000000, v9
    s_waitcnt vmcnt(2)
    v_perm_b32 v6, v112, v92, s43
    v_perm_b32 v7, v113, v93, s43
    v_perm_b32 v8, v114, v94, s43
    v_perm_b32 v9, v115, v95, s43
    v_mul_hi_u32_u24 v92, 429497, v92
    v_mul_hi_u32_u24 v112, 429497, v112
    v_mul_hi_u32_u24 v93, 429497, v93
    v_mul_hi_u32_u24 v113, 429497, v113
    v_mul_hi_u32_u24 v94, 429497, v94
    v_mul_hi_u32_u24 v114, 429497, v114
    v_mul_hi_u32_u24 v95, 429497, v95
    v_mul_hi_u32_u24 v115, 429497, v115
    v_lshl_or_b32 v92, v112, 16, v92
    v_lshl_or_b32 v93, v113, 16, v93
    v_lshl_or_b32 v94, v114, 16, v94
    v_lshl_or_b32 v95, v115, 16, v95
    v_dot2_u32_u16 v112, v92, s38, 0
    v_dot2_u32_u16 v113, v93, s38, 0
    v_dot2_u32_u16 v114, v94, s38, 0
    v_dot2_u32_u16 v115, v95, s38, 0
    v_pk_mad_u16 v6, v92, s37, v6
    v_pk_mad_u16 v7, v93, s37, v7
    v_pk_mad_u16 v8, v94, s37, v8
    v_pk_mad_u16 v9, v95, s37, v9
    ds_add_u32 v112, v4 offset:0
    ds_add_u32 v113, v4 offset:0
    ds_add_u32 v114, v4 offset:0
    ds_add_u32 v115, v4 offset:0
    v_pk_mad_u16 v6, v92, s52, v6 op_sel:[1,0,0] op_sel_hi:[1,1,1]
    v_pk_mad_u16 v7, v93, s52, v7 op_sel:[1,0,0] op_sel_hi:[1,1,1]
    v_pk_mad_u16 v8, v94, s52, v8 op_sel:[1,0,0] op_sel_hi:[1,1,1]
    v_pk_mad_u16 v9, v95, s52, v9 op_sel:[1,0,0] op_sel_hi:[1,1,1]
    v_perm_b32 v91, v115, v114, s43
    v_perm_b32 v87, v113, v112, s43
    v_or_b32 v89, 0x40000000, v6
    v_or_b32 v90, 0x40000000, v7
    v_or_b32 v92, 0x40000000, v8
    v_or_b32 v93, 0x40000000, v9
    s_waitcnt vmcnt(0)
    s_mov_b64 exec, s[44:45]
    v_perm_b32 v6, v116, v96, s43
    v_perm_b32 v7, v117, v97, s43
    v_perm_b32 v8, v118, v98, s43
    v_perm_b32 v9, v119, v99, s43
    v_mul_hi_u32_u24 v96, 429497, v96
    v_mul_hi_u32_u24 v116, 429497, v116
    v_mul_hi_u32_u24 v97, 429497, v97
    v_mul_hi_u32_u24 v117, 429497, v117
    v_mul_hi_u32_u24 v98, 429497, v98
    v_mul_hi_u32_u24 v118, 429497, v118
    v_mul_hi_u32_u24 v99, 429497, v99
    v_mul_hi_u32_u24 v119, 429497, v119
    v_lshl_or_b32 v96, v116, 16, v96
    v_lshl_or_b32 v97, v117, 16, v97
    v_lshl_or_b32 v98, v118, 16, v98
    v_lshl_or_b32 v99, v119, 16, v99
    v_dot2_u32_u16 v116, v96, s38, 0
    v_dot2_u32_u16 v117, v97, s38, 0
    v_dot2_u32_u16 v118, v98, s38, 0
    v_dot2_u32_u16 v119, v99, s38, 0
    v_pk_mad_u16 v6, v96, s37, v6
    v_pk_mad_u16 v7, v97, s37, v7
    v_pk_mad_u16 v8, v98, s37, v8
    v_pk_mad_u16 v9, v99, s37, v9
    ds_add_u32 v116, v4 offset:0
    ds_add_u32 v117, v4 offset:0
    ds_add_u32 v118, v4 offset:0
    ds_add_u32 v119, v4 offset:0
    v_pk_mad_u16 v6, v96, s52, v6 op_sel:[1,0,0] op_sel_hi:[1,1,1]
    v_pk_mad_u16 v7, v97, s52, v7 op_sel:[1,0,0] op_sel_hi:[1,1,1]
    v_pk_mad_u16 v8, v98, s52, v8 op_sel:[1,0,0] op_sel_hi:[1,1,1]
    v_pk_mad_u16 v9, v99, s52, v9 op_sel:[1,0,0] op_sel_hi:[1,1,1]
    v_perm_b32 v99, v119, v118, s43
    v_perm_b32 v95, v117, v116, s43
    v_or_b32 v94, 0x40000000, v6
    v_or_b32 v96, 0x40000000, v7
    v_or_b32 v97, 0x40000000, v8
    v_or_b32 v98, 0x40000000, v9
    s_mov_b64 exec, -1
    s_add_u32 s35, s34, 0
    buffer_load_dwordx2 v[100:101], v2, s[16:19], s35 offen nt
    s_lshl_b32 s35, s32, 10
    s_add_u32 s35, s35, 9437184
    s_add_u32 s20, s4, s35
    s_addc_u32 s21, s5, 0
    s_waitcnt lgkmcnt(0)
    s_barrier
    ds_read_b128 v[8:11], v1 offset:0
    s_add_u32 s35, s34, 2097152
    buffer_load_dwordx2 v[102:103], v2, s[16:19], s35 offen nt
    s_lshl_b32 s35, s39, 2
    s_add_u32 s35, s35, 160256
    v_mov_b32 v7, s35
    v_and_b32 v14, 15, v0
    v_lshlrev_b32 v14, 2, v14
    v_add_u32 v14, 160256, v14
    s_waitcnt lgkmcnt(0)
    v_cmp_eq_u32 s[56:57], 0, v8
    v_cmp_ge_u32 s[64:65], 1, v8
    v_max_u32 v12, 2, v8
    v_lshl_or_b32 v8, v8, 16, v12
    v_cmp_eq_u32 s[58:59], 0, v9
    v_cmp_ge_u32 s[66:67], 1, v9
    v_max_u32 v12, 2, v9
    v_lshl_or_b32 v9, v9, 16, v12
    v_cmp_eq_u32 s[60:61], 0, v10
    v_cmp_ge_u32 s[68:69], 1, v10
    v_max_u32 v12, 2, v10
    v_lshl_or_b32 v10, v10, 16, v12
    v_cmp_eq_u32 s[62:63], 0, v11
    v_cmp_ge_u32 s[70:71], 1, v11
    v_max_u32 v12, 2, v11
    v_lshl_or_b32 v11, v11, 16, v12
    v_add_u32 v9, v8, v9
    v_add_u32 v10, v9, v10
    v_add_u32 v11, v10, v11
    v_mov_b32 v6, v11
    s_nop 1
    v_add_u32_dpp v6, v6, v6 row_shr:1 row_mask:0xf bank_mask:0xf bound_ctrl:0
    s_nop 1
    v_add_u32_dpp v6, v6, v6 row_shr:2 row_mask:0xf bank_mask:0xf bound_ctrl:0
    s_nop 1
    v_add_u32_dpp v6, v6, v6 row_shr:4 row_mask:0xf bank_mask:0xf bound_ctrl:0
    s_nop 1
    v_add_u32_dpp v6, v6, v6 row_shr:8 row_mask:0xf bank_mask:0xf bound_ctrl:0
    s_nop 1
    v_add_u32_dpp v6, v6, v6 row_bcast:15 row_mask:0xa bank_mask:0xf
    s_nop 1
    v_add_u32_dpp v6, v6, v6 row_bcast:31 row_mask:0xc bank_mask:0xf
    s_mov_b32 exec_lo, 0
    s_brev_b32 exec_hi, 1
    ds_write_b32 v7, v6
    s_mov_b64 exec, -1
    v_sub_u32 v6, v6, v11
    s_or_b64 s[46:47], s[64:65], s[66:67]
    s_or_b64 vcc, s[68:69], s[70:71]
    s_or_b64 s[46:47], s[46:47], vcc
    s_waitcnt lgkmcnt(0)
    s_barrier
    ds_read_b32 v7, v14
    s_add_u32 s35, s34, 4194304
    buffer_load_dwordx2 v[104:105], v2, s[16:19], s35 offen nt
    s_waitcnt lgkmcnt(0)
    v_mov_b32 v15, v7
    s_nop 1
    v_add_u32_dpp v7, v7, v7 row_shr:1 row_mask:0xf bank_mask:0xf bound_ctrl:0
    s_nop 1
    v_add_u32_dpp v7, v7, v7 row_shr:2 row_mask:0xf bank_mask:0xf bound_ctrl:0
    s_nop 1
    v_add_u32_dpp v7, v7, v7 row_shr:4 row_mask:0xf bank_mask:0xf bound_ctrl:0
    s_nop 1
    v_add_u32_dpp v7, v7, v7 row_shr:8 row_mask:0xf bank_mask:0xf bound_ctrl:0
    s_nop 0
    v_readlane_b32 s54, v7, 15
    v_sub_u32 v7, v7, v15
    s_nop 0
    v_readlane_b32 s35, v7, s39
    s_and_b32 s54, s54, 0xffff
    s_cmp_ge_u32 s54, 40063
    s_cselect_b32 s36, 16, 0
    s_cselect_b32 s54, 40000, s54
    s_cselect_b32 s55, 1, s55
    s_cselect_b64 s[46:47], 0, s[46:47]
    v_add_u32 v12, s35, v6
    v_add_u32 v13, v12, v8
    v_add_u32 v14, v12, v9
    v_add_u32 v15, v12, v10
    v_bfe_u32 v12, v12, s36, 16
    v_bfe_u32 v13, v13, s36, 16
    v_bfe_u32 v14, v14, s36, 16
    v_bfe_u32 v15, v15, s36, 16
    ds_write_b128 v1, v[12:15] offset:0
    ds_write_b128 v1, v[12:15] offset:16384
    v_mov_b32 v6, 32768
    v_mov_b32 v7, s54
    s_mov_b64 exec, 1
    ds_write_b32 v6, v7
    s_mov_b64 exec, -1
    s_add_u32 s35, s54, 2
    s_mul_hi_u32 s35, s35, 1431655766
    s_lshl_b32 s35, s35, 4
    s_add_u32 s35, s35, 217890816
    s_min_u32 s22, s35, 218104832
    v_perm_b32 v15, v15, v14, s43
    v_perm_b32 v14, v13, v12, s43
    s_waitcnt lgkmcnt(0)
    s_barrier
    s_nop 0
    v_and_b32 v6, 0xffff, v51
    v_lshrrev_b32 v7, 16, v51
    v_and_b32 v8, 0xffff, v55
    v_lshrrev_b32 v9, 16, v55
    ds_add_rtn_u32 v6, v6, v4 offset:0
    ds_add_rtn_u32 v7, v7, v4 offset:0
    ds_add_rtn_u32 v8, v8, v4 offset:0
    ds_add_rtn_u32 v9, v9, v4 offset:0
    v_and_b32 v10, 0xffff, v59
    v_lshrrev_b32 v11, 16, v59
    v_and_b32 v12, 0xffff, v63
    v_lshrrev_b32 v13, 16, v63
    ds_add_rtn_u32 v10, v10, v4 offset:0
    ds_add_rtn_u32 v11, v11, v4 offset:0
    ds_add_rtn_u32 v12, v12, v4 offset:0
    ds_add_rtn_u32 v13, v13, v4 offset:0
    s_waitcnt lgkmcnt(4)
    v_perm_b32 v51, v7, v6, s43
    v_perm_b32 v55, v9, v8, s43
    v_and_b32 v6, 0xffff, v67
    v_lshrrev_b32 v7, 16, v67
    v_and_b32 v8, 0xffff, v71
    v_lshrrev_b32 v9, 16, v71
    ds_add_rtn_u32 v6, v6, v4 offset:0
    ds_add_rtn_u32 v7, v7, v4 offset:0
    ds_add_rtn_u32 v8, v8, v4 offset:0
    ds_add_rtn_u32 v9, v9, v4 offset:0
    s_waitcnt lgkmcnt(4)
    v_perm_b32 v59, v11, v10, s43
    v_perm_b32 v63, v13, v12, s43
    s_add_u32 s35, s34, 6291456
    buffer_load_dwordx2 v[106:107], v2, s[16:19], s35 offen nt
    v_and_b32 v10, 0xffff, v120
    v_lshrrev_b32 v11, 16, v120
    v_and_b32 v12, 0xffff, v121
    v_lshrrev_b32 v13, 16, v121
    ds_add_rtn_u32 v10, v10, v4 offset:0
    ds_add_rtn_u32 v11, v11, v4 offset:0
    ds_add_rtn_u32 v12, v12, v4 offset:0
    ds_add_rtn_u32 v13, v13, v4 offset:0
    s_waitcnt lgkmcnt(4)
    v_perm_b32 v67, v7, v6, s43
    v_perm_b32 v71, v9, v8, s43
    s_add_u32 s35, s34, 8388608
    buffer_load_dwordx2 v[108:109], v2, s[16:19], s35 offen nt
    v_and_b32 v6, 0xffff, v122
    v_lshrrev_b32 v7, 16, v122
    v_and_b32 v8, 0xffff, v123
    v_lshrrev_b32 v9, 16, v123
    ds_add_rtn_u32 v6, v6, v4 offset:0
    ds_add_rtn_u32 v7, v7, v4 offset:0
    ds_add_rtn_u32 v8, v8, v4 offset:0
    ds_add_rtn_u32 v9, v9, v4 offset:0
    s_waitcnt lgkmcnt(4)
    v_perm_b32 v120, v11, v10, s43
    v_perm_b32 v121, v13, v12, s43
    s_add_u32 s35, s34, 10485760
    buffer_load_dwordx2 v[110:111], v2, s[16:19], s35 offen nt
    v_and_b32 v10, 0xffff, v124
    v_lshrrev_b32 v11, 16, v124
    v_and_b32 v12, 0xffff, v125
    v_lshrrev_b32 v13, 16, v125
    ds_add_rtn_u32 v10, v10, v4 offset:0
    ds_add_rtn_u32 v11, v11, v4 offset:0
    ds_add_rtn_u32 v12, v12, v4 offset:0
    ds_add_rtn_u32 v13, v13, v4 offset:0
    s_waitcnt lgkmcnt(4)
    v_perm_b32 v122, v7, v6, s43
    v_perm_b32 v123, v9, v8, s43
    v_and_b32 v6, 0xffff, v126
    v_lshrrev_b32 v7, 16, v126
    v_and_b32 v8, 0xffff, v75
    v_lshrrev_b32 v9, 16, v75
    ds_add_rtn_u32 v6, v6, v4 offset:0
    ds_add_rtn_u32 v7, v7, v4 offset:0
    ds_add_rtn_u32 v8, v8, v4 offset:0
    ds_add_rtn_u32 v9, v9, v4 offset:0
    s_waitcnt lgkmcnt(4)
    v_perm_b32 v124, v11, v10, s43
    v_perm_b32 v125, v13, v12, s43
    s_add_u32 s35, s34, 12582912
    buffer_load_dwordx2 v[112:113], v2, s[16:19], s35 offen nt
    v_and_b32 v10, 0xffff, v79
    v_lshrrev_b32 v11, 16, v79
    v_and_b32 v12, 0xffff, v83
    v_lshrrev_b32 v13, 16, v83
    ds_add_rtn_u32 v10, v10, v4 offset:0
    ds_add_rtn_u32 v11, v11, v4 offset:0
    ds_add_rtn_u32 v12, v12, v4 offset:0
    ds_add_rtn_u32 v13, v13, v4 offset:0
    s_waitcnt lgkmcnt(4)
    v_perm_b32 v126, v7, v6, s43
    v_perm_b32 v75, v9, v8, s43
    s_add_u32 s35, s34, 14680064
    buffer_load_dwordx2 v[114:115], v2, s[16:19], s35 offen nt
    v_and_b32 v6, 0xffff, v87
    v_lshrrev_b32 v7, 16, v87
    v_and_b32 v8, 0xffff, v91
    v_lshrrev_b32 v9, 16, v91
    ds_add_rtn_u32 v6, v6, v4 offset:0
    ds_add_rtn_u32 v7, v7, v4 offset:0
    ds_add_rtn_u32 v8, v8, v4 offset:0
    ds_add_rtn_u32 v9, v9, v4 offset:0
    s_waitcnt lgkmcnt(4)
    v_perm_b32 v79, v11, v10, s43
    v_perm_b32 v83, v13, v12, s43
    s_add_u32 s35, s34, 16777216
    buffer_load_dwordx2 v[116:117], v2, s[16:19], s35 offen nt
    s_mov_b64 exec, s[44:45]
    v_and_b32 v10, 0xffff, v95
    v_lshrrev_b32 v11, 16, v95
    v_and_b32 v12, 0xffff, v99
    v_lshrrev_b32 v13, 16, v99
    ds_add_rtn_u32 v10, v10, v4 offset:0
    ds_add_rtn_u32 v11, v11, v4 offset:0
    ds_add_rtn_u32 v12, v12, v4 offset:0
    ds_add_rtn_u32 v13, v13, v4 offset:0
    s_mov_b64 exec, -1
    s_waitcnt lgkmcnt(4)
    v_perm_b32 v87, v7, v6, s43
    v_perm_b32 v91, v9, v8, s43
    s_add_u32 s35, s34, 18874368
    s_sub_u32 s35, s35, s49
    v_cndmask_b32 v118, 2.0, v2, s[44:45]
    buffer_load_dwordx2 v[118:119], v118, s[16:19], s35 offen nt
    s_waitcnt lgkmcnt(0)
    v_perm_b32 v95, v11, v10, s43
    v_perm_b32 v99, v13, v12, s43
    s_cmp_gt_u32 s39, 8
    s_cbranch_scc1 L_p1_kernel_notab_9
    v_lshrrev_b32 v6, 1, v0
    v_mul_u32_u24 v7, 1009, v6
    v_lshrrev_b32 v7, 16, v7
    v_mul_u32_u24 v7, 959, v7
    v_and_b32 v8, 1, v0
    v_lshl_add_u32 v7, v8, 9, v7
    v_add_lshl_u32 v13, v7, v6, 2
    ds_read2st64_b32 v[6:7], v13 offset0:64 offset1:65
    ds_read2st64_b32 v[8:9], v13 offset0:66 offset1:67
    ds_read2st64_b32 v[10:11], v13 offset0:68 offset1:69
    ds_read2st64_b32 v[12:13], v13 offset0:70 offset1:71
    s_mul_i32 s35, s32, 8320
    s_add_u32 s26, s35, 8320
    s_waitcnt lgkmcnt(3)
    v_perm_b32 v6, v7, v6, s43
    s_waitcnt lgkmcnt(2)
    v_perm_b32 v7, v9, v8, s43
    s_waitcnt lgkmcnt(1)
    v_perm_b32 v8, v11, v10, s43
    s_waitcnt lgkmcnt(0)
    v_perm_b32 v9, v13, v12, s43
    buffer_store_dwordx4 v[6:9], v1, s[24:27], s35 offen sc1
    s_nop 1
L_p1_kernel_notab_9:
    s_barrier
    s_lshl_b32 s35, s54, 2
    v_mov_b32 v6, s35
    v_mov_b32 v7, 0
    v_mov_b32 v12, 1140817920
    s_mov_b64 exec, 1
    ds_write2_b32 v6, v7, v7 offset0:0 offset1:1
    s_cmp_eq_u64 s[46:47], 0
    s_cbranch_scc1 L_p1_kernel_nonull_10
    s_mov_b64 exec, s[64:65]
    v_lshlrev_b32_sdwa v6, 2, v14 dst_sel:DWORD dst_unused:UNUSED_PAD src0_sel:DWORD src1_sel:WORD_0
    ds_write_b32 v6, v7 offset:4
    s_mov_b64 exec, s[56:57]
    ds_write_b32 v6, v7
    s_mov_b64 exec, s[66:67]
    v_lshlrev_b32_sdwa v6, 2, v14 dst_sel:DWORD dst_unused:UNUSED_PAD src0_sel:DWORD src1_sel:WORD_1
    ds_write_b32 v6, v7 offset:4
    s_mov_b64 exec, s[58:59]
    ds_write_b32 v6, v7
    s_mov_b64 exec, s[68:69]
    v_lshlrev_b32_sdwa v6, 2, v15 dst_sel:DWORD dst_unused:UNUSED_PAD src0_sel:DWORD src1_sel:WORD_0
    ds_write_b32 v6, v7 offset:4
    s_mov_b64 exec, s[60:61]
    ds_write_b32 v6, v7
    s_mov_b64 exec, s[70:71]
    v_lshlrev_b32_sdwa v6, 2, v15 dst_sel:DWORD dst_unused:UNUSED_PAD src0_sel:DWORD src1_sel:WORD_1
    ds_write_b32 v6, v7 offset:4
    s_mov_b64 exec, s[62:63]
    ds_write_b32 v6, v7
L_p1_kernel_nonull_10:
    s_mov_b64 exec, -1
    v_lshlrev_b32_sdwa v6, 2, v51 dst_sel:DWORD dst_unused:UNUSED_PAD src0_sel:DWORD src1_sel:WORD_0
    v_lshlrev_b32_sdwa v7, 2, v51 dst_sel:DWORD dst_unused:UNUSED_PAD src0_sel:DWORD src1_sel:WORD_1
    v_lshlrev_b32_sdwa v8, 2, v55 dst_sel:DWORD dst_unused:UNUSED_PAD src0_sel:DWORD src1_sel:WORD_0
    v_lshlrev_b32_sdwa v9, 2, v55 dst_sel:DWORD dst_unused:UNUSED_PAD src0_sel:DWORD src1_sel:WORD_1
    ds_write_b32 v6, v48
    ds_write_b32 v7, v49
    ds_write_b32 v8, v50
    ds_write_b32 v9, v52
    s_waitcnt vmcnt(9)
    v_lshlrev_b32 v10, 16, v100
    v_lshlrev_b32 v11, 16, v101
    v_and_b32 v100, 0xffff0000, v100
    v_and_b32 v101, 0xffff0000, v101
    v_mul_f32 v10, s41, v10
    v_mul_f32 v100, s41, v100
    v_mul_f32 v11, s41, v11
    v_mul_f32 v101, s41, v101
    v_fract_f32 v10, v10
    v_fract_f32 v100, v100
    v_fract_f32 v11, v11
    v_fract_f32 v101, v101
    v_cos_f32 v10, v10
    v_cos_f32 v100, v100
    v_cos_f32 v11, v11
    v_cos_f32 v101, v101
    v_fmaak_f32 v10, v12, v10, 1262486016
    v_fmaak_f32 v100, v12, v100, 1262486016
    v_fmaak_f32 v11, v12, v11, 1262486016
    v_fmaak_f32 v101, v12, v101, 1262486016
    v_or3_b32 v5, v10, v100, v5
    v_or3_b32 v5, v11, v101, v5
    v_perm_b32 v100, v100, v10, s43
    v_perm_b32 v101, v101, v11, s43
    s_add_u32 s35, s33, 40960000
    buffer_load_dwordx4 v[16:19], v1, s[8:11], s35 offen nt
    v_lshlrev_b32_sdwa v6, 2, v59 dst_sel:DWORD dst_unused:UNUSED_PAD src0_sel:DWORD src1_sel:WORD_0
    v_lshlrev_b32_sdwa v7, 2, v59 dst_sel:DWORD dst_unused:UNUSED_PAD src0_sel:DWORD src1_sel:WORD_1
    v_lshlrev_b32_sdwa v8, 2, v63 dst_sel:DWORD dst_unused:UNUSED_PAD src0_sel:DWORD src1_sel:WORD_0
    v_lshlrev_b32_sdwa v9, 2, v63 dst_sel:DWORD dst_unused:UNUSED_PAD src0_sel:DWORD src1_sel:WORD_1
    ds_write_b32 v6, v53
    ds_write_b32 v7, v54
    ds_write_b32 v8, v56
    ds_write_b32 v9, v57
    s_waitcnt vmcnt(9)
    v_lshlrev_b32 v10, 16, v102
    v_lshlrev_b32 v11, 16, v103
    v_and_b32 v102, 0xffff0000, v102
    v_and_b32 v103, 0xffff0000, v103
    v_mul_f32 v10, s41, v10
    v_mul_f32 v102, s41, v102
    v_mul_f32 v11, s41, v11
    v_mul_f32 v103, s41, v103
    v_fract_f32 v10, v10
    v_fract_f32 v102, v102
    v_fract_f32 v11, v11
    v_fract_f32 v103, v103
    v_cos_f32 v10, v10
    v_cos_f32 v102, v102
    v_cos_f32 v11, v11
    v_cos_f32 v103, v103
    v_fmaak_f32 v10, v12, v10, 1262486016
    v_fmaak_f32 v102, v12, v102, 1262486016
    v_fmaak_f32 v11, v12, v11, 1262486016
    v_fmaak_f32 v103, v12, v103, 1262486016
    v_or3_b32 v5, v10, v102, v5
    v_or3_b32 v5, v11, v103, v5
    v_perm_b32 v102, v102, v10, s43
    v_perm_b32 v103, v103, v11, s43
    v_lshlrev_b32_sdwa v6, 2, v67 dst_sel:DWORD dst_unused:UNUSED_PAD src0_sel:DWORD src1_sel:WORD_0
    v_lshlrev_b32_sdwa v7, 2, v67 dst_sel:DWORD dst_unused:UNUSED_PAD src0_sel:DWORD src1_sel:WORD_1
    v_lshlrev_b32_sdwa v8, 2, v71 dst_sel:DWORD dst_unused:UNUSED_PAD src0_sel:DWORD src1_sel:WORD_0
    v_lshlrev_b32_sdwa v9, 2, v71 dst_sel:DWORD dst_unused:UNUSED_PAD src0_sel:DWORD src1_sel:WORD_1
    ds_write_b32 v6, v58
    ds_write_b32 v7, v60
    ds_write_b32 v8, v61
    ds_write_b32 v9, v62
    v_lshlrev_b32_sdwa v6, 2, v120 dst_sel:DWORD dst_unused:UNUSED_PAD src0_sel:DWORD src1_sel:WORD_0
    v_lshlrev_b32_sdwa v7, 2, v120 dst_sel:DWORD dst_unused:UNUSED_PAD src0_sel:DWORD src1_sel:WORD_1
    v_lshlrev_b32_sdwa v8, 2, v121 dst_sel:DWORD dst_unused:UNUSED_PAD src0_sel:DWORD src1_sel:WORD_0
    v_lshlrev_b32_sdwa v9, 2, v121 dst_sel:DWORD dst_unused:UNUSED_PAD src0_sel:DWORD src1_sel:WORD_1
    ds_write_b32 v6, v64
    ds_write_b32 v7, v65
    ds_write_b32 v8, v66
    ds_write_b32 v9, v68
    s_waitcnt vmcnt(8)
    v_lshlrev_b32 v10, 16, v104
    v_lshlrev_b32 v11, 16, v105
    v_and_b32 v104, 0xffff0000, v104
    v_and_b32 v105, 0xffff0000, v105
    v_mul_f32 v10, s41, v10
    v_mul_f32 v104, s41, v104
    v_mul_f32 v11, s41, v11
    v_mul_f32 v105, s41, v105
    v_fract_f32 v10, v10
    v_fract_f32 v104, v104
    v_fract_f32 v11, v11
    v_fract_f32 v105, v105
    v_cos_f32 v10, v10
    v_cos_f32 v104, v104
    v_cos_f32 v11, v11
    v_cos_f32 v105, v105
    v_fmaak_f32 v10, v12, v10, 1262486016
    v_fmaak_f32 v104, v12, v104, 1262486016
    v_fmaak_f32 v11, v12, v11, 1262486016
    v_fmaak_f32 v105, v12, v105, 1262486016
    v_or3_b32 v5, v10, v104, v5
    v_or3_b32 v5, v11, v105, v5
    v_perm_b32 v104, v104, v10, s43
    v_perm_b32 v105, v105, v11, s43
    s_add_u32 s35, s33, 40960000
    buffer_load_dwordx4 v[20:23], v1, s[12:15], s35 offen nt
    v_lshlrev_b32_sdwa v6, 2, v122 dst_sel:DWORD dst_unused:UNUSED_PAD src0_sel:DWORD src1_sel:WORD_0
    v_lshlrev_b32_sdwa v7, 2, v122 dst_sel:DWORD dst_unused:UNUSED_PAD src0_sel:DWORD src1_sel:WORD_1
    v_lshlrev_b32_sdwa v8, 2, v123 dst_sel:DWORD dst_unused:UNUSED_PAD src0_sel:DWORD src1_sel:WORD_0
    v_lshlrev_b32_sdwa v9, 2, v123 dst_sel:DWORD dst_unused:UNUSED_PAD src0_sel:DWORD src1_sel:WORD_1
    ds_write_b32 v6, v69
    ds_write_b32 v7, v70
    ds_write_b32 v8, v127
    ds_write_b32 v9, v72
    s_waitcnt vmcnt(8)
    v_lshlrev_b32 v10, 16, v106
    v_lshlrev_b32 v11, 16, v107
    v_and_b32 v106, 0xffff0000, v106
    v_and_b32 v107, 0xffff0000, v107
    v_mul_f32 v10, s41, v10
    v_mul_f32 v106, s41, v106
    v_mul_f32 v11, s41, v11
    v_mul_f32 v107, s41, v107
    v_fract_f32 v10, v10
    v_fract_f32 v106, v106
    v_fract_f32 v11, v11
    v_fract_f32 v107, v107
    v_cos_f32 v10, v10
    v_cos_f32 v106, v106
    v_cos_f32 v11, v11
    v_cos_f32 v107, v107
    v_fmaak_f32 v10, v12, v10, 1262486016
    v_fmaak_f32 v106, v12, v106, 1262486016
    v_fmaak_f32 v11, v12, v11, 1262486016
    v_fmaak_f32 v107, v12, v107, 1262486016
    v_or3_b32 v5, v10, v106, v5
    v_or3_b32 v5, v11, v107, v5
    v_perm_b32 v106, v106, v10, s43
    v_perm_b32 v107, v107, v11, s43
    v_lshlrev_b32_sdwa v6, 2, v124 dst_sel:DWORD dst_unused:UNUSED_PAD src0_sel:DWORD src1_sel:WORD_0
    v_lshlrev_b32_sdwa v7, 2, v124 dst_sel:DWORD dst_unused:UNUSED_PAD src0_sel:DWORD src1_sel:WORD_1
    v_lshlrev_b32_sdwa v8, 2, v125 dst_sel:DWORD dst_unused:UNUSED_PAD src0_sel:DWORD src1_sel:WORD_0
    v_lshlrev_b32_sdwa v9, 2, v125 dst_sel:DWORD dst_unused:UNUSED_PAD src0_sel:DWORD src1_sel:WORD_1
    ds_write_b32 v6, v73
    ds_write_b32 v7, v74
    ds_write_b32 v8, v76
    ds_write_b32 v9, v77
    v_lshlrev_b32_sdwa v6, 2, v126 dst_sel:DWORD dst_unused:UNUSED_PAD src0_sel:DWORD src1_sel:WORD_0
    v_lshlrev_b32_sdwa v7, 2, v126 dst_sel:DWORD dst_unused:UNUSED_PAD src0_sel:DWORD src1_sel:WORD_1
    v_lshlrev_b32_sdwa v8, 2, v75 dst_sel:DWORD dst_unused:UNUSED_PAD src0_sel:DWORD src1_sel:WORD_0
    v_lshlrev_b32_sdwa v9, 2, v75 dst_sel:DWORD dst_unused:UNUSED_PAD src0_sel:DWORD src1_sel:WORD_1
    ds_write_b32 v6, v78
    ds_write_b32 v7, v80
    ds_write_b32 v8, v81
    ds_write_b32 v9, v82
    s_waitcnt vmcnt(7)
    v_lshlrev_b32 v10, 16, v108
    v_lshlrev_b32 v11, 16, v109
    v_and_b32 v108, 0xffff0000, v108
    v_and_b32 v109, 0xffff0000, v109
    v_mul_f32 v10, s41, v10
    v_mul_f32 v108, s41, v108
    v_mul_f32 v11, s41, v11
    v_mul_f32 v109, s41, v109
    v_fract_f32 v10, v10
    v_fract_f32 v108, v108
    v_fract_f32 v11, v11
    v_fract_f32 v109, v109
    v_cos_f32 v10, v10
    v_cos_f32 v108, v108
    v_cos_f32 v11, v11
    v_cos_f32 v109, v109
    v_fmaak_f32 v10, v12, v10, 1262486016
    v_fmaak_f32 v108, v12, v108, 1262486016
    v_fmaak_f32 v11, v12, v11, 1262486016
    v_fmaak_f32 v109, v12, v109, 1262486016
    v_or3_b32 v5, v10, v108, v5
    v_or3_b32 v5, v11, v109, v5
    v_perm_b32 v108, v108, v10, s43
    v_perm_b32 v109, v109, v11, s43
    s_add_u32 s35, s33, 45154304
    buffer_load_dwordx4 v[24:27], v1, s[8:11], s35 offen nt
    v_lshlrev_b32_sdwa v6, 2, v79 dst_sel:DWORD dst_unused:UNUSED_PAD src0_sel:DWORD src1_sel:WORD_0
    v_lshlrev_b32_sdwa v7, 2, v79 dst_sel:DWORD dst_unused:UNUSED_PAD src0_sel:DWORD src1_sel:WORD_1
    v_lshlrev_b32_sdwa v8, 2, v83 dst_sel:DWORD dst_unused:UNUSED_PAD src0_sel:DWORD src1_sel:WORD_0
    v_lshlrev_b32_sdwa v9, 2, v83 dst_sel:DWORD dst_unused:UNUSED_PAD src0_sel:DWORD src1_sel:WORD_1
    ds_write_b32 v6, v84
    ds_write_b32 v7, v85
    ds_write_b32 v8, v86
    ds_write_b32 v9, v88
    s_waitcnt vmcnt(7)
    v_lshlrev_b32 v10, 16, v110
    v_lshlrev_b32 v11, 16, v111
    v_and_b32 v110, 0xffff0000, v110
    v_and_b32 v111, 0xffff0000, v111
    v_mul_f32 v10, s41, v10
    v_mul_f32 v110, s41, v110
    v_mul_f32 v11, s41, v11
    v_mul_f32 v111, s41, v111
    v_fract_f32 v10, v10
    v_fract_f32 v110, v110
    v_fract_f32 v11, v11
    v_fract_f32 v111, v111
    v_cos_f32 v10, v10
    v_cos_f32 v110, v110
    v_cos_f32 v11, v11
    v_cos_f32 v111, v111
    v_fmaak_f32 v10, v12, v10, 1262486016
    v_fmaak_f32 v110, v12, v110, 1262486016
    v_fmaak_f32 v11, v12, v11, 1262486016
    v_fmaak_f32 v111, v12, v111, 1262486016
    v_or3_b32 v5, v10, v110, v5
    v_or3_b32 v5, v11, v111, v5
    v_perm_b32 v110, v110, v10, s43
    v_perm_b32 v111, v111, v11, s43
    v_lshlrev_b32_sdwa v6, 2, v87 dst_sel:DWORD dst_unused:UNUSED_PAD src0_sel:DWORD src1_sel:WORD_0
    v_lshlrev_b32_sdwa v7, 2, v87 dst_sel:DWORD dst_unused:UNUSED_PAD src0_sel:DWORD src1_sel:WORD_1
    v_lshlrev_b32_sdwa v8, 2, v91 dst_sel:DWORD dst_unused:UNUSED_PAD src0_sel:DWORD src1_sel:WORD_0
    v_lshlrev_b32_sdwa v9, 2, v91 dst_sel:DWORD dst_unused:UNUSED_PAD src0_sel:DWORD src1_sel:WORD_1
    ds_write_b32 v6, v89
    ds_write_b32 v7, v90
    ds_write_b32 v8, v92
    ds_write_b32 v9, v93
    s_mov_b64 exec, s[44:45]
    v_lshlrev_b32_sdwa v6, 2, v95 dst_sel:DWORD dst_unused:UNUSED_PAD src0_sel:DWORD src1_sel:WORD_0
    v_lshlrev_b32_sdwa v7, 2, v95 dst_sel:DWORD dst_unused:UNUSED_PAD src0_sel:DWORD src1_sel:WORD_1
    v_lshlrev_b32_sdwa v8, 2, v99 dst_sel:DWORD dst_unused:UNUSED_PAD src0_sel:DWORD src1_sel:WORD_0
    v_lshlrev_b32_sdwa v9, 2, v99 dst_sel:DWORD dst_unused:UNUSED_PAD src0_sel:DWORD src1_sel:WORD_1
    ds_write_b32 v6, v94
    ds_write_b32 v7, v96
    ds_write_b32 v8, v97
    ds_write_b32 v9, v98
    s_mov_b64 exec, -1
    s_waitcnt vmcnt(6)
    v_lshlrev_b32 v10, 16, v112
    v_lshlrev_b32 v11, 16, v113
    v_and_b32 v112, 0xffff0000, v112
    v_and_b32 v113, 0xffff0000, v113
    v_mul_f32 v10, s41, v10
    v_mul_f32 v112, s41, v112
    v_mul_f32 v11, s41, v11
    v_mul_f32 v113, s41, v113
    v_fract_f32 v10, v10
    v_fract_f32 v112, v112
    v_fract_f32 v11, v11
    v_fract_f32 v113, v113
    v_cos_f32 v10, v10
    v_cos_f32 v112, v112
    v_cos_f32 v11, v11
    v_cos_f32 v113, v113
    v_fmaak_f32 v10, v12, v10, 1262486016
    v_fmaak_f32 v112, v12, v112, 1262486016
    v_fmaak_f32 v11, v12, v11, 1262486016
    v_fmaak_f32 v113, v12, v113, 1262486016
    v_or3_b32 v5, v10, v112, v5
    v_or3_b32 v5, v11, v113, v5
    v_perm_b32 v112, v112, v10, s43
    v_perm_b32 v113, v113, v11, s43
    s_mov_b64 exec, s[44:45]
    s_mov_b64 exec, -1
    s_add_u32 s35, s33, 45154304
    buffer_load_dwordx4 v[28:31], v1, s[12:15], s35 offen nt
    s_mul_i32 s35, s39, 9216
    v_mad_u32_u24 v6, v0, 12, s35
    s_waitcnt lgkmcnt(0)
    s_barrier
    s_cmp_lg_u32 s39, 15
    s_cbranch_scc1 L_p1_kernel_nox_11
    ds_read_b32 v12, v6 offset:9984
    ds_read_b32 v13, v6 offset:9988
    ds_read_b32 v14, v6 offset:9992
L_p1_kernel_nox_11:
    ds_read_b32 v48, v6 offset:1536
    ds_read_b32 v49, v6 offset:1540
    ds_read_b32 v50, v6 offset:1544
    ds_read_b32 v52, v6 offset:3072
    ds_read_b32 v53, v6 offset:3076
    ds_read_b32 v54, v6 offset:3080
    ds_read_b32 v56, v6 offset:4608
    ds_read_b32 v57, v6 offset:4612
    ds_read_b32 v58, v6 offset:4616
    ds_read_b32 v60, v6 offset:6144
    ds_read_b32 v61, v6 offset:6148
    ds_read_b32 v62, v6 offset:6152
    ds_read_b32 v64, v6 offset:7680
    ds_read_b32 v65, v6 offset:7684
    ds_read_b32 v66, v6 offset:7688
    ds_read_b32 v68, v6 offset:9216
    ds_read_b32 v69, v6 offset:9220
    ds_read_b32 v70, v6 offset:9224
    ds_read_b32 v72, v6 offset:0
    ds_read_b32 v73, v6 offset:4
    ds_read_b32 v74, v6 offset:8
    ds_read_b32 v76, v6 offset:768
    ds_read_b32 v77, v6 offset:772
    ds_read_b32 v78, v6 offset:776
    ds_read_b32 v80, v6 offset:2304
    ds_read_b32 v81, v6 offset:2308
    ds_read_b32 v82, v6 offset:2312
    ds_read_b32 v84, v6 offset:3840
    ds_read_b32 v85, v6 offset:3844
    ds_read_b32 v86, v6 offset:3848
    ds_read_b32 v88, v6 offset:5376
    ds_read_b32 v89, v6 offset:5380
    ds_read_b32 v90, v6 offset:5384
    ds_read_b32 v92, v6 offset:6912
    ds_read_b32 v93, v6 offset:6916
    ds_read_b32 v94, v6 offset:6920
    ds_read_b32 v96, v6 offset:8448
    ds_read_b32 v97, v6 offset:8452
    ds_read_b32 v98, v6 offset:8456
    s_add_u32 s35, s33, 49348608
    buffer_load_dwordx4 v[32:35], v1, s[8:11], s35 offen nt
    v_mov_b32 v8, 0
    v_mov_b32 v9, 0
    v_mov_b32 v10, 0
    v_mov_b32 v11, 0
    v_mov_b32 v15, 16384
    s_waitcnt lgkmcnt(0)
    s_barrier
    ds_write_b128 v1, v[8:11] offset:0
    s_nop 1
    v_mad_u32_u16 v6, v51, s50, v15 op_sel:[0,0,0,0]
    v_mad_u32_u16 v7, v51, s50, v15 op_sel:[1,0,0,0]
    v_mad_u32_u16 v8, v55, s50, v15 op_sel:[0,0,0,0]
    v_mad_u32_u16 v9, v55, s50, v15 op_sel:[1,0,0,0]
    v_add_u32_sdwa v6, v6, v51 dst_sel:DWORD dst_unused:UNUSED_PAD src0_sel:WORD_1 src1_sel:WORD_0
    v_add_u32_sdwa v7, v7, v51 dst_sel:DWORD dst_unused:UNUSED_PAD src0_sel:WORD_1 src1_sel:WORD_1
    v_add_u32_sdwa v8, v8, v55 dst_sel:DWORD dst_unused:UNUSED_PAD src0_sel:WORD_1 src1_sel:WORD_0
    v_add_u32_sdwa v9, v9, v55 dst_sel:DWORD dst_unused:UNUSED_PAD src0_sel:WORD_1 src1_sel:WORD_1
    v_add_u32 v6, v6, v6
    v_add_u32 v7, v7, v7
    v_add_u32 v8, v8, v8
    v_add_u32 v9, v9, v9
    ds_write_b16 v6, v100 offset:16384
    ds_write_b16_d16_hi v7, v100 offset:16384
    ds_write_b16 v8, v101 offset:16384
    ds_write_b16_d16_hi v9, v101 offset:16384
    v_mov_b32 v6, 1140817920
    s_waitcnt vmcnt(7)
    v_lshlrev_b32 v10, 16, v114
    v_lshlrev_b32 v11, 16, v115
    v_and_b32 v114, 0xffff0000, v114
    v_and_b32 v115, 0xffff0000, v115
    v_mul_f32 v10, s41, v10
    v_mul_f32 v114, s41, v114
    v_mul_f32 v11, s41, v11
    v_mul_f32 v115, s41, v115
    v_fract_f32 v10, v10
    v_fract_f32 v114, v114
    v_fract_f32 v11, v11
    v_fract_f32 v115, v115
    v_cos_f32 v10, v10
    v_cos_f32 v114, v114
    v_cos_f32 v11, v11
    v_cos_f32 v115, v115
    v_fmaak_f32 v10, v6, v10, 1262486016
    v_fmaak_f32 v114, v6, v114, 1262486016
    v_fmaak_f32 v11, v6, v11, 1262486016
    v_fmaak_f32 v115, v6, v115, 1262486016
    v_or3_b32 v5, v10, v114, v5
    v_or3_b32 v5, v11, v115, v5
    v_perm_b32 v114, v114, v10, s43
    v_perm_b32 v115, v115, v11, s43
    v_mad_u32_u16 v6, v59, s50, v15 op_sel:[0,0,0,0]
    v_mad_u32_u16 v7, v59, s50, v15 op_sel:[1,0,0,0]
    v_mad_u32_u16 v8, v63, s50, v15 op_sel:[0,0,0,0]
    v_mad_u32_u16 v9, v63, s50, v15 op_sel:[1,0,0,0]
    v_add_u32_sdwa v6, v6, v59 dst_sel:DWORD dst_unused:UNUSED_PAD src0_sel:WORD_1 src1_sel:WORD_0
    v_add_u32_sdwa v7, v7, v59 dst_sel:DWORD dst_unused:UNUSED_PAD src0_sel:WORD_1 src1_sel:WORD_1
    v_add_u32_sdwa v8, v8, v63 dst_sel:DWORD dst_unused:UNUSED_PAD src0_sel:WORD_1 src1_sel:WORD_0
    v_add_u32_sdwa v9, v9, v63 dst_sel:DWORD dst_unused:UNUSED_PAD src0_sel:WORD_1 src1_sel:WORD_1
    v_add_u32 v6, v6, v6
    v_add_u32 v7, v7, v7
    v_add_u32 v8, v8, v8
    v_add_u32 v9, v9, v9
    ds_write_b16 v6, v102 offset:16384
    ds_write_b16_d16_hi v7, v102 offset:16384
    ds_write_b16 v8, v103 offset:16384
    ds_write_b16_d16_hi v9, v103 offset:16384
    v_mad_u32_u16 v6, v67, s50, v15 op_sel:[0,0,0,0]
    v_mad_u32_u16 v7, v67, s50, v15 op_sel:[1,0,0,0]
    v_mad_u32_u16 v8, v71, s50, v15 op_sel:[0,0,0,0]
    v_mad_u32_u16 v9, v71, s50, v15 op_sel:[1,0,0,0]
    v_add_u32_sdwa v6, v6, v67 dst_sel:DWORD dst_unused:UNUSED_PAD src0_sel:WORD_1 src1_sel:WORD_0
    v_add_u32_sdwa v7, v7, v67 dst_sel:DWORD dst_unused:UNUSED_PAD src0_sel:WORD_1 src1_sel:WORD_1
    v_add_u32_sdwa v8, v8, v71 dst_sel:DWORD dst_unused:UNUSED_PAD src0_sel:WORD_1 src1_sel:WORD_0
    v_add_u32_sdwa v9, v9, v71 dst_sel:DWORD dst_unused:UNUSED_PAD src0_sel:WORD_1 src1_sel:WORD_1
    v_add_u32 v6, v6, v6
    v_add_u32 v7, v7, v7
    v_add_u32 v8, v8, v8
    v_add_u32 v9, v9, v9
    ds_write_b16 v6, v104 offset:16384
    ds_write_b16_d16_hi v7, v104 offset:16384
    ds_write_b16 v8, v105 offset:16384
    ds_write_b16_d16_hi v9, v105 offset:16384
    s_add_u32 s35, s33, 49348608
    buffer_load_dwordx4 v[36:39], v1, s[12:15], s35 offen nt
    v_mad_u32_u16 v6, v120, s50, v15 op_sel:[0,0,0,0]
    v_mad_u32_u16 v7, v120, s50, v15 op_sel:[1,0,0,0]
    v_mad_u32_u16 v8, v121, s50, v15 op_sel:[0,0,0,0]
    v_mad_u32_u16 v9, v121, s50, v15 op_sel:[1,0,0,0]
    v_add_u32_sdwa v6, v6, v120 dst_sel:DWORD dst_unused:UNUSED_PAD src0_sel:WORD_1 src1_sel:WORD_0
    v_add_u32_sdwa v7, v7, v120 dst_sel:DWORD dst_unused:UNUSED_PAD src0_sel:WORD_1 src1_sel:WORD_1
    v_add_u32_sdwa v8, v8, v121 dst_sel:DWORD dst_unused:UNUSED_PAD src0_sel:WORD_1 src1_sel:WORD_0
    v_add_u32_sdwa v9, v9, v121 dst_sel:DWORD dst_unused:UNUSED_PAD src0_sel:WORD_1 src1_sel:WORD_1
    v_add_u32 v6, v6, v6
    v_add_u32 v7, v7, v7
    v_add_u32 v8, v8, v8
    v_add_u32 v9, v9, v9
    ds_write_b16 v6, v106 offset:16384
    ds_write_b16_d16_hi v7, v106 offset:16384
    ds_write_b16 v8, v107 offset:16384
    ds_write_b16_d16_hi v9, v107 offset:16384
    v_mov_b32 v6, 1140817920
    s_waitcnt vmcnt(7)
    v_lshlrev_b32 v10, 16, v116
    v_lshlrev_b32 v11, 16, v117
    v_and_b32 v116, 0xffff0000, v116
    v_and_b32 v117, 0xffff0000, v117
    v_mul_f32 v10, s41, v10
    v_mul_f32 v116, s41, v116
    v_mul_f32 v11, s41, v11
    v_mul_f32 v117, s41, v117
    v_fract_f32 v10, v10
    v_fract_f32 v116, v116
    v_fract_f32 v11, v11
    v_fract_f32 v117, v117
    v_cos_f32 v10, v10
    v_cos_f32 v116, v116
    v_cos_f32 v11, v11
    v_cos_f32 v117, v117
    v_fmaak_f32 v10, v6, v10, 1262486016
    v_fmaak_f32 v116, v6, v116, 1262486016
    v_fmaak_f32 v11, v6, v11, 1262486016
    v_fmaak_f32 v117, v6, v117, 1262486016
    v_or3_b32 v5, v10, v116, v5
    v_or3_b32 v5, v11, v117, v5
    v_perm_b32 v116, v116, v10, s43
    v_perm_b32 v117, v117, v11, s43
    v_mad_u32_u16 v6, v122, s50, v15 op_sel:[0,0,0,0]
    v_mad_u32_u16 v7, v122, s50, v15 op_sel:[1,0,0,0]
    v_mad_u32_u16 v8, v123, s50, v15 op_sel:[0,0,0,0]
    v_mad_u32_u16 v9, v123, s50, v15 op_sel:[1,0,0,0]
    v_add_u32_sdwa v6, v6, v122 dst_sel:DWORD dst_unused:UNUSED_PAD src0_sel:WORD_1 src1_sel:WORD_0
    v_add_u32_sdwa v7, v7, v122 dst_sel:DWORD dst_unused:UNUSED_PAD src0_sel:WORD_1 src1_sel:WORD_1
    v_add_u32_sdwa v8, v8, v123 dst_sel:DWORD dst_unused:UNUSED_PAD src0_sel:WORD_1 src1_sel:WORD_0
    v_add_u32_sdwa v9, v9, v123 dst_sel:DWORD dst_unused:UNUSED_PAD src0_sel:WORD_1 src1_sel:WORD_1
    v_add_u32 v6, v6, v6
    v_add_u32 v7, v7, v7
    v_add_u32 v8, v8, v8
    v_add_u32 v9, v9, v9
    ds_write_b16 v6, v108 offset:16384
    ds_write_b16_d16_hi v7, v108 offset:16384
    ds_write_b16 v8, v109 offset:16384
    ds_write_b16_d16_hi v9, v109 offset:16384
    v_mad_u32_u16 v6, v124, s50, v15 op_sel:[0,0,0,0]
    v_mad_u32_u16 v7, v124, s50, v15 op_sel:[1,0,0,0]
    v_mad_u32_u16 v8, v125, s50, v15 op_sel:[0,0,0,0]
    v_mad_u32_u16 v9, v125, s50, v15 op_sel:[1,0,0,0]
    v_add_u32_sdwa v6, v6, v124 dst_sel:DWORD dst_unused:UNUSED_PAD src0_sel:WORD_1 src1_sel:WORD_0
    v_add_u32_sdwa v7, v7, v124 dst_sel:DWORD dst_unused:UNUSED_PAD src0_sel:WORD_1 src1_sel:WORD_1
    v_add_u32_sdwa v8, v8, v125 dst_sel:DWORD dst_unused:UNUSED_PAD src0_sel:WORD_1 src1_sel:WORD_0
    v_add_u32_sdwa v9, v9, v125 dst_sel:DWORD dst_unused:UNUSED_PAD src0_sel:WORD_1 src1_sel:WORD_1
    v_add_u32 v6, v6, v6
    v_add_u32 v7, v7, v7
    v_add_u32 v8, v8, v8
    v_add_u32 v9, v9, v9
    ds_write_b16 v6, v110 offset:16384
    ds_write_b16_d16_hi v7, v110 offset:16384
    ds_write_b16 v8, v111 offset:16384
    ds_write_b16_d16_hi v9, v111 offset:16384
    s_add_u32 s35, s33, 53542912
    buffer_load_dwordx4 v[40:43], v1, s[8:11], s35 offen nt
    v_mad_u32_u16 v6, v126, s50, v15 op_sel:[0,0,0,0]
    v_mad_u32_u16 v7, v126, s50, v15 op_sel:[1,0,0,0]
    v_mad_u32_u16 v8, v75, s50, v15 op_sel:[0,0,0,0]
    v_mad_u32_u16 v9, v75, s50, v15 op_sel:[1,0,0,0]
    v_add_u32_sdwa v6, v6, v126 dst_sel:DWORD dst_unused:UNUSED_PAD src0_sel:WORD_1 src1_sel:WORD_0
    v_add_u32_sdwa v7, v7, v126 dst_sel:DWORD dst_unused:UNUSED_PAD src0_sel:WORD_1 src1_sel:WORD_1
    v_add_u32_sdwa v8, v8, v75 dst_sel:DWORD dst_unused:UNUSED_PAD src0_sel:WORD_1 src1_sel:WORD_0
    v_add_u32_sdwa v9, v9, v75 dst_sel:DWORD dst_unused:UNUSED_PAD src0_sel:WORD_1 src1_sel:WORD_1
    v_add_u32 v6, v6, v6
    v_add_u32 v7, v7, v7
    v_add_u32 v8, v8, v8
    v_add_u32 v9, v9, v9
    ds_write_b16 v6, v112 offset:16384
    ds_write_b16_d16_hi v7, v112 offset:16384
    ds_write_b16 v8, v113 offset:16384
    ds_write_b16_d16_hi v9, v113 offset:16384
    v_mov_b32 v6, 1140817920
    s_mov_b64 exec, s[44:45]
    s_waitcnt vmcnt(7)
    v_lshlrev_b32 v10, 16, v118
    v_lshlrev_b32 v11, 16, v119
    v_and_b32 v118, 0xffff0000, v118
    v_and_b32 v119, 0xffff0000, v119
    v_mul_f32 v10, s41, v10
    v_mul_f32 v118, s41, v118
    v_mul_f32 v11, s41, v11
    v_mul_f32 v119, s41, v119
    v_fract_f32 v10, v10
    v_fract_f32 v118, v118
    v_fract_f32 v11, v11
    v_fract_f32 v119, v119
    v_cos_f32 v10, v10
    v_cos_f32 v118, v118
    v_cos_f32 v11, v11
    v_cos_f32 v119, v119
    v_fmaak_f32 v10, v6, v10, 1262486016
    v_fmaak_f32 v118, v6, v118, 1262486016
    v_fmaak_f32 v11, v6, v11, 1262486016
    v_fmaak_f32 v119, v6, v119, 1262486016
    v_or3_b32 v5, v10, v118, v5
    v_or3_b32 v5, v11, v119, v5
    v_perm_b32 v118, v118, v10, s43
    v_perm_b32 v119, v119, v11, s43
    s_mov_b64 exec, -1
    v_mad_u32_u16 v6, v79, s50, v15 op_sel:[0,0,0,0]
    v_mad_u32_u16 v7, v79, s50, v15 op_sel:[1,0,0,0]
    v_mad_u32_u16 v8, v83, s50, v15 op_sel:[0,0,0,0]
    v_mad_u32_u16 v9, v83, s50, v15 op_sel:[1,0,0,0]
    v_add_u32_sdwa v6, v6, v79 dst_sel:DWORD dst_unused:UNUSED_PAD src0_sel:WORD_1 src1_sel:WORD_0
    v_add_u32_sdwa v7, v7, v79 dst_sel:DWORD dst_unused:UNUSED_PAD src0_sel:WORD_1 src1_sel:WORD_1
    v_add_u32_sdwa v8, v8, v83 dst_sel:DWORD dst_unused:UNUSED_PAD src0_sel:WORD_1 src1_sel:WORD_0
    v_add_u32_sdwa v9, v9, v83 dst_sel:DWORD dst_unused:UNUSED_PAD src0_sel:WORD_1 src1_sel:WORD_1
    v_add_u32 v6, v6, v6
    v_add_u32 v7, v7, v7
    v_add_u32 v8, v8, v8
    v_add_u32 v9, v9, v9
    ds_write_b16 v6, v114 offset:16384
    ds_write_b16_d16_hi v7, v114 offset:16384
    ds_write_b16 v8, v115 offset:16384
    ds_write_b16_d16_hi v9, v115 offset:16384
    v_mad_u32_u16 v6, v87, s50, v15 op_sel:[0,0,0,0]
    v_mad_u32_u16 v7, v87, s50, v15 op_sel:[1,0,0,0]
    v_mad_u32_u16 v8, v91, s50, v15 op_sel:[0,0,0,0]
    v_mad_u32_u16 v9, v91, s50, v15 op_sel:[1,0,0,0]
    v_add_u32_sdwa v6, v6, v87 dst_sel:DWORD dst_unused:UNUSED_PAD src0_sel:WORD_1 src1_sel:WORD_0
    v_add_u32_sdwa v7, v7, v87 dst_sel:DWORD dst_unused:UNUSED_PAD src0_sel:WORD_1 src1_sel:WORD_1
    v_add_u32_sdwa v8, v8, v91 dst_sel:DWORD dst_unused:UNUSED_PAD src0_sel:WORD_1 src1_sel:WORD_0
    v_add_u32_sdwa v9, v9, v91 dst_sel:DWORD dst_unused:UNUSED_PAD src0_sel:WORD_1 src1_sel:WORD_1
    v_add_u32 v6, v6, v6
    v_add_u32 v7, v7, v7
    v_add_u32 v8, v8, v8
    v_add_u32 v9, v9, v9
    ds_write_b16 v6, v116 offset:16384
    ds_write_b16_d16_hi v7, v116 offset:16384
    ds_write_b16 v8, v117 offset:16384
    ds_write_b16_d16_hi v9, v117 offset:16384
    s_add_u32 s35, s33, 53542912
    buffer_load_dwordx4 v[44:47], v1, s[12:15], s35 offen nt
    s_mov_b64 exec, s[44:45]
    v_mad_u32_u16 v6, v95, s50, v15 op_sel:[0,0,0,0]
    v_mad_u32_u16 v7, v95, s50, v15 op_sel:[1,0,0,0]
    v_mad_u32_u16 v8, v99, s50, v15 op_sel:[0,0,0,0]
    v_mad_u32_u16 v9, v99, s50, v15 op_sel:[1,0,0,0]
    v_add_u32_sdwa v6, v6, v95 dst_sel:DWORD dst_unused:UNUSED_PAD src0_sel:WORD_1 src1_sel:WORD_0
    v_add_u32_sdwa v7, v7, v95 dst_sel:DWORD dst_unused:UNUSED_PAD src0_sel:WORD_1 src1_sel:WORD_1
    v_add_u32_sdwa v8, v8, v99 dst_sel:DWORD dst_unused:UNUSED_PAD src0_sel:WORD_1 src1_sel:WORD_0
    v_add_u32_sdwa v9, v9, v99 dst_sel:DWORD dst_unused:UNUSED_PAD src0_sel:WORD_1 src1_sel:WORD_1
    v_add_u32 v6, v6, v6
    v_add_u32 v7, v7, v7
    v_add_u32 v8, v8, v8
    v_add_u32 v9, v9, v9
    ds_write_b16 v6, v118 offset:16384
    ds_write_b16_d16_hi v7, v118 offset:16384
    ds_write_b16 v8, v119 offset:16384
    ds_write_b16_d16_hi v9, v119 offset:16384
    s_mov_b64 exec, -1
    s_mul_i32 s35, s39, 6144
    v_add_u32 v6, s35, v2
    s_waitcnt lgkmcnt(0)
    s_barrier
    ds_read_b64 v[100:101], v6 offset:23040
    ds_read_b64 v[102:103], v6 offset:16384
    ds_read_b64 v[104:105], v6 offset:16896
    ds_read_b64 v[106:107], v6 offset:17408
    ds_read_b64 v[108:109], v6 offset:17920
    ds_read_b64 v[110:111], v6 offset:18432
    ds_read_b64 v[112:113], v6 offset:18944
    ds_read_b64 v[114:115], v6 offset:19456
    ds_read_b64 v[116:117], v6 offset:19968
    ds_read_b64 v[118:119], v6 offset:20480
    ds_read_b64 v[120:121], v6 offset:20992
    ds_read_b64 v[122:123], v6 offset:21504
    ds_read_b64 v[124:125], v6 offset:22016
    ds_read_b64 v[126:127], v6 offset:22528
    s_add_u32 s32, s32, 256
    s_add_u32 s33, s33, 40960000
    s_add_u32 s34, s34, 20480000
    s_add_u32 s40, s40, 1
    s_cmp_lt_u32 s40, 4
    s_cbranch_scc1 L_p1_loop
    s_waitcnt lgkmcnt(13)
    v_lshlrev_b32 v15, 22, v100
    v_lshrrev_b32 v100, 16, v100
    v_alignbit_b32 v15, v100, v15, 10
    v_alignbit_b32 v15, v101, v15, 10
    v_xor_b32 v15, 0x80200800, v15
    s_cmp_lg_u32 s39, 15
    s_cbranch_scc1 L_p1_kernel_nox_12
    s_mov_b32 s36, 13631488
    buffer_store_dwordx4 v[12:15], v3, s[20:23], s36 offen sc1
L_p1_kernel_nox_12:
    s_waitcnt lgkmcnt(12)
    v_lshlrev_b32 v75, 22, v102
    v_lshrrev_b32 v102, 16, v102
    v_alignbit_b32 v75, v102, v75, 10
    v_alignbit_b32 v75, v103, v75, 10
    v_xor_b32 v75, 0x80200800, v75
    s_mov_b32 s36, 0
    buffer_store_dwordx4 v[72:75], v3, s[20:23], s36 offen sc1
    s_waitcnt lgkmcnt(11)
    v_lshlrev_b32 v79, 22, v104
    v_lshrrev_b32 v104, 16, v104
    v_alignbit_b32 v79, v104, v79, 10
    v_alignbit_b32 v79, v105, v79, 10
    v_xor_b32 v79, 0x80200800, v79
    s_mov_b32 s36, 1048576
    buffer_store_dwordx4 v[76:79], v3, s[20:23], s36 offen sc1
    s_waitcnt lgkmcnt(10)
    v_lshlrev_b32 v51, 22, v106
    v_lshrrev_b32 v106, 16, v106
    v_alignbit_b32 v51, v106, v51, 10
    v_alignbit_b32 v51, v107, v51, 10
    v_xor_b32 v51, 0x80200800, v51
    s_mov_b32 s36, 2097152
    buffer_store_dwordx4 v[48:51], v3, s[20:23], s36 offen sc1
    s_waitcnt lgkmcnt(9)
    v_lshlrev_b32 v83, 22, v108
    v_lshrrev_b32 v108, 16, v108
    v_alignbit_b32 v83, v108, v83, 10
    v_alignbit_b32 v83, v109, v83, 10
    v_xor_b32 v83, 0x80200800, v83
    s_mov_b32 s36, 3145728
    buffer_store_dwordx4 v[80:83], v3, s[20:23], s36 offen sc1
    s_waitcnt lgkmcnt(8)
    v_lshlrev_b32 v55, 22, v110
    v_lshrrev_b32 v110, 16, v110
    v_alignbit_b32 v55, v110, v55, 10
    v_alignbit_b32 v55, v111, v55, 10
    v_xor_b32 v55, 0x80200800, v55
    s_mov_b32 s36, 4194304
    buffer_store_dwordx4 v[52:55], v3, s[20:23], s36 offen sc1
    s_waitcnt lgkmcnt(7)
    v_lshlrev_b32 v87, 22, v112
    v_lshrrev_b32 v112, 16, v112
    v_alignbit_b32 v87, v112, v87, 10
    v_alignbit_b32 v87, v113, v87, 10
    v_xor_b32 v87, 0x80200800, v87
    s_mov_b32 s36, 5242880
    buffer_store_dwordx4 v[84:87], v3, s[20:23], s36 offen sc1
    s_waitcnt lgkmcnt(6)
    v_lshlrev_b32 v59, 22, v114
    v_lshrrev_b32 v114, 16, v114
    v_alignbit_b32 v59, v114, v59, 10
    v_alignbit_b32 v59, v115, v59, 10
    v_xor_b32 v59, 0x80200800, v59
    s_mov_b32 s36, 6291456
    buffer_store_dwordx4 v[56:59], v3, s[20:23], s36 offen sc1
    s_waitcnt lgkmcnt(5)
    v_lshlrev_b32 v91, 22, v116
    v_lshrrev_b32 v116, 16, v116
    v_alignbit_b32 v91, v116, v91, 10
    v_alignbit_b32 v91, v117, v91, 10
    v_xor_b32 v91, 0x80200800, v91
    s_mov_b32 s36, 7340032
    buffer_store_dwordx4 v[88:91], v3, s[20:23], s36 offen sc1
    s_waitcnt lgkmcnt(4)
    v_lshlrev_b32 v63, 22, v118
    v_lshrrev_b32 v118, 16, v118
    v_alignbit_b32 v63, v118, v63, 10
    v_alignbit_b32 v63, v119, v63, 10
    v_xor_b32 v63, 0x80200800, v63
    s_mov_b32 s36, 8388608
    buffer_store_dwordx4 v[60:63], v3, s[20:23], s36 offen sc1
    s_waitcnt lgkmcnt(3)
    v_lshlrev_b32 v95, 22, v120
    v_lshrrev_b32 v120, 16, v120
    v_alignbit_b32 v95, v120, v95, 10
    v_alignbit_b32 v95, v121, v95, 10
    v_xor_b32 v95, 0x80200800, v95
    s_mov_b32 s36, 9437184
    buffer_store_dwordx4 v[92:95], v3, s[20:23], s36 offen sc1
    s_waitcnt lgkmcnt(2)
    v_lshlrev_b32 v67, 22, v122
    v_lshrrev_b32 v122, 16, v122
    v_alignbit_b32 v67, v122, v67, 10
    v_alignbit_b32 v67, v123, v67, 10
    v_xor_b32 v67, 0x80200800, v67
    s_mov_b32 s36, 10485760
    buffer_store_dwordx4 v[64:67], v3, s[20:23], s36 offen sc1
    s_waitcnt lgkmcnt(1)
    v_lshlrev_b32 v99, 22, v124
    v_lshrrev_b32 v124, 16, v124
    v_alignbit_b32 v99, v124, v99, 10
    v_alignbit_b32 v99, v125, v99, 10
    v_xor_b32 v99, 0x80200800, v99
    s_mov_b32 s36, 11534336
    buffer_store_dwordx4 v[96:99], v3, s[20:23], s36 offen sc1
    s_waitcnt lgkmcnt(0)
    v_lshlrev_b32 v71, 22, v126
    v_lshrrev_b32 v126, 16, v126
    v_alignbit_b32 v71, v126, v71, 10
    v_alignbit_b32 v71, v127, v71, 10
    v_xor_b32 v71, 0x80200800, v71
    s_mov_b32 s36, 12582912
    buffer_store_dwordx4 v[68:71], v3, s[20:23], s36 offen sc1
    v_and_b32 v6, 0x34800000, v5
    v_cmp_ne_u32 vcc, 0, v6
    s_lshl_b32 s35, s39, 4
    s_add_u32 s35, s35, 160328
    v_mov_b32 v10, s35
    s_cmp_lg_u64 vcc, 0
    s_cselect_b32 s36, 1, s55
    v_mov_b32 v11, s36
    ds_write_b32 v10, v11
    s_waitcnt lgkmcnt(0)
    s_barrier
    s_cmp_lg_u32 s39, 0
    s_cbranch_scc1 L_p1_end
    v_and_b32 v6, 15, v0
    v_lshlrev_b32 v6, 4, v6
    v_add_u32 v6, 160320, v6
    ds_read_b128 v[8:11], v6
    s_waitcnt lgkmcnt(0)
    s_nop 1
    v_max_u32_dpp v8, v8, v8 row_shr:1 row_mask:0xf bank_mask:0xf bound_ctrl:0
    s_nop 1
    v_max_u32_dpp v8, v8, v8 row_shr:2 row_mask:0xf bank_mask:0xf bound_ctrl:0
    s_nop 1
    v_max_u32_dpp v8, v8, v8 row_shr:4 row_mask:0xf bank_mask:0xf bound_ctrl:0
    s_nop 1
    v_max_u32_dpp v8, v8, v8 row_shr:8 row_mask:0xf bank_mask:0xf bound_ctrl:0
    s_nop 1
    v_add_f32_dpp v9, v9, v9 row_shr:1 row_mask:0xf bank_mask:0xf bound_ctrl:0
    s_nop 1
    v_add_f32_dpp v9, v9, v9 row_shr:2 row_mask:0xf bank_mask:0xf bound_ctrl:0
    s_nop 1
    v_add_f32_dpp v9, v9, v9 row_shr:4 row_mask:0xf bank_mask:0xf bound_ctrl:0
    s_nop 1
    v_add_f32_dpp v9, v9, v9 row_shr:8 row_mask:0xf bank_mask:0xf bound_ctrl:0
    s_nop 1
    v_or_b32_dpp v10, v10, v10 row_shr:1 row_mask:0xf bank_mask:0xf bound_ctrl:0
    s_nop 1
    v_or_b32_dpp v10, v10, v10 row_shr:2 row_mask:0xf bank_mask:0xf bound_ctrl:0
    s_nop 1
    v_or_b32_dpp v10, v10, v10 row_shr:4 row_mask:0xf bank_mask:0xf bound_ctrl:0
    s_nop 1
    v_or_b32_dpp v10, v10, v10 row_shr:8 row_mask:0xf bank_mask:0xf bound_ctrl:0
    s_lshl_b32 s35, s2, 3
    s_mov_b32 s26, 8540160
    s_add_u32 s35, s35, 8519680
    v_mov_b32 v6, 0
    v_lshl_or_b32 v8, v10, 16, v8
    s_mov_b64 exec, 0x8000
    buffer_store_dwordx2 v[8:9], v6, s[24:27], s35 offen
    s_lshl_b32 s35, s2, 8
    s_add_u32 s35, s35, 8523776
    buffer_store_dword v6, v6, s[24:27], s35 offen
L_p1_end:
    s_endpgm
.globl p2_kernel
.p2align 8
.type p2_kernel,@function
p2_kernel:
    s_cmp_ge_u32 s2, 256
    s_cbranch_scc1 L_p2_end
    s_load_dwordx2 s[4:5], s[0:1], 104
    s_load_dwordx2 s[100:101], s[0:1], 24
    s_load_dwordx2 s[8:9], s[0:1], 0
    s_load_dwordx2 s[30:31], s[0:1], 40
    s_load_dwordx4 s[32:35], s[0:1], 56
    s_load_dwordx4 s[36:39], s[0:1], 72
    s_and_b32 s14, s2, 7
    s_lshr_b32 s49, s2, 3
    s_and_b32 s3, s14, 1
    s_lshl_b32 s3, s3, 5
    s_add_u32 s3, s3, s49
    s_lshr_b32 s12, s14, 1
    v_lshrrev_b32 v108, 6, v0
    v_lshlrev_b32 v1, 4, v0
    v_and_b32 v109, 63, v0
    v_readfirstlane_b32 s13, v108
    v_lshlrev_b32 v111, 4, v109
    v_lshrrev_b32 v110, 2, v109
    v_mul_u32_u24 v110, 8256, v110
    v_add_u32 v110, v110, v111
    s_mul_i32 s14, s12, 65
    s_add_u32 s14, s14, s3
    s_lshl_b32 s14, s14, 5
    s_mul_i32 s15, s13, 532480
    s_add_u32 s14, s14, s15
    s_add_u32 s25, s14, 0
    s_mul_i32 s22, s12, 1280000
    s_mov_b32 s2, 0
    s_waitcnt lgkmcnt(0)
    s_mov_b32 s6, 655360000
    s_mov_b32 s7, 0x00020000
    s_add_u32 s10, s22, 1280000
    s_mov_b32 s11, 0x00020000
    s_add_u32 s15, s25, 0
    buffer_load_dwordx4 v[28:31], v110, s[4:7], s15 offen
    s_add_u32 s15, s25, 133120
    buffer_load_dwordx4 v[32:35], v110, s[4:7], s15 offen
    s_add_u32 s15, s25, 266240
    buffer_load_dwordx4 v[36:39], v110, s[4:7], s15 offen
    s_add_u32 s15, s25, 399360
    buffer_load_dwordx4 v[40:43], v110, s[4:7], s15 offen
    s_load_dwordx4 s[40:43], s[30:31], 0
    s_load_dwordx16 s[52:67], s[32:33], 0
    s_load_dwordx16 s[68:83], s[34:35], 0
    s_load_dwordx8 s[84:91], s[36:37], 0
    s_load_dwordx8 s[92:99], s[38:39], 0
    v_mov_b32 v52, 0x100
    s_cmp_lg_u32 s13, 0
    s_cbranch_scc1 L_p2_noann
    s_lshl_b32 s14, s3, 8
    s_add_u32 s14, s14, 8523776
    s_mov_b64 exec, 1
    buffer_atomic_add v52, off, s[4:7], s14
    s_mov_b64 exec, -1
L_p2_noann:
    s_add_u32 s14, s22, 0
    buffer_load_dwordx4 v[88:91], v1, s[8:11], s14 offen
    s_add_u32 s14, s22, 16384
    buffer_load_dwordx4 v[92:95], v1, s[8:11], s14 offen
    s_add_u32 s14, s22, 32768
    buffer_load_dwordx4 v[96:99], v1, s[8:11], s14 offen
    s_add_u32 s14, s22, 49152
    buffer_load_dwordx4 v[100:103], v1, s[8:11], s14 offen
    s_add_u32 s14, s22, 65536
    buffer_load_dwordx4 v[104:107], v1, s[8:11], s14 offen
    s_mov_b32 s15, 8519680
    buffer_load_dwordx4 v[80:83], v111, s[4:7], s15 offen offset:0
    buffer_load_dwordx4 v[84:87], v111, s[4:7], s15 offen offset:1024
    v_lshlrev_b32 v2, 10, v109
    v_mov_b32 v50, 21845
    v_add_u32 v3, 80000, v1
    v_add_u32 v124, 145536, v1
    v_add_u32 v113, 65536, v1
    v_mov_b32 v112, 0x7f000000
    v_cmp_gt_u32 vcc, 904, v0
    s_mul_i32 s19, s13, 240
    s_add_u32 s19, s19, 160000
    v_cndmask_b32 v124, v112, v124, vcc
    v_cndmask_b32 v113, v112, v113, vcc
    v_lshl_add_u32 v6, v109, 2, s19
    v_lshl_add_u32 v126, v109, 1, s19
    v_cmp_gt_u32 vcc, 10, v109
    s_lshl_b32 s27, s13, 16
    s_mov_b32 s23, 1024
    v_cndmask_b32 v6, v112, v6, vcc
    s_add_u32 s44, s4, 4194304
    s_addc_u32 s45, s5, 1048576
    s_mov_b32 s46, 14024704
    s_mov_b32 s47, 0x00020000
    s_mov_b32 s18, 80000
    s_and_b32 s50, s3, 1
    s_lshl_b32 s50, s50, 18
    s_sub_u32 s18, s18, s50
    s_sub_u32 s50, 4294836224, s50
    v_lshlrev_b32 v116, 3, v0
    v_and_b32 v116, 16, v116
    v_and_b32 v117, 1, v0
    v_lshl_or_b32 v116, v117, 5, v116
    v_mov_b32 v58, 0x3f80
    v_mov_b32 v59, 0
    v_lshlrev_b64 v[58:59], v116, v[58:59]
    v_mov_b32 v4, 0
    v_mov_b32 v5, 0
    v_mov_b32 v114, 0xff00
    ds_write_b32 v6, v5 offset:160
    ds_write_b16 v126, v114 offset:2
    v_mov_b32 v44, 1073758208
    v_mov_b32 v45, 1073758208
    v_mov_b32 v46, 1073758208
    v_mov_b32 v47, 1073758208
    v_mov_b32 v48, 1073758208
    v_mov_b32 v49, 1073758208
    ds_write_b128 v113, v[44:47]
    v_lshrrev_b32 v115, 4, v109
    v_mul_u32_u24 v115, 15360, v115
    v_lshl_add_u32 v115, v109, 6, v115
    v_lshl_add_u32 v115, v108, 10, v115
    s_waitcnt lgkmcnt(0)
    v_mov_b32 v53, s40
    v_mov_b32 v54, s41
    v_mov_b32 v56, s42
    v_mov_b32 v57, s43
    s_mov_b32 s40, 20987904
    s_mov_b32 s41, 21031594
    s_pack_ll_b32_b16 s14, s52, s54
    s_pack_hh_b32_b16 s15, s52, s54
    s_pack_ll_b32_b16 s54, s53, s55
    s_pack_hh_b32_b16 s55, s53, s55
    s_mov_b32 s52, s14
    s_mov_b32 s53, s15
    s_pack_ll_b32_b16 s14, s56, s58
    s_pack_hh_b32_b16 s15, s56, s58
    s_pack_ll_b32_b16 s58, s57, s59
    s_pack_hh_b32_b16 s59, s57, s59
    s_mov_b32 s56, s14
    s_mov_b32 s57, s15
    s_pack_ll_b32_b16 s14, s60, s62
    s_pack_hh_b32_b16 s15, s60, s62
    s_pack_ll_b32_b16 s62, s61, s63
    s_pack_hh_b32_b16 s63, s61, s63
    s_mov_b32 s60, s14
    s_mov_b32 s61, s15
    s_pack_ll_b32_b16 s14, s64, s66
    s_pack_hh_b32_b16 s15, s64, s66
    s_pack_ll_b32_b16 s66, s65, s67
    s_pack_hh_b32_b16 s67, s65, s67
    s_mov_b32 s64, s14
    s_mov_b32 s65, s15
    s_pack_ll_b32_b16 s14, s68, s70
    s_pack_hh_b32_b16 s15, s68, s70
    s_pack_ll_b32_b16 s70, s69, s71
    s_pack_hh_b32_b16 s71, s69, s71
    s_mov_b32 s68, s14
    s_mov_b32 s69, s15
    s_pack_ll_b32_b16 s14, s72, s74
    s_pack_hh_b32_b16 s15, s72, s74
    s_pack_ll_b32_b16 s74, s73, s75
    s_pack_hh_b32_b16 s75, s73, s75
    s_mov_b32 s72, s14
    s_mov_b32 s73, s15
    s_pack_ll_b32_b16 s14, s76, s78
    s_pack_hh_b32_b16 s15, s76, s78
    s_pack_ll_b32_b16 s78, s77, s79
    s_pack_hh_b32_b16 s79, s77, s79
    s_mov_b32 s76, s14
    s_mov_b32 s77, s15
    s_pack_ll_b32_b16 s14, s80, s82
    s_pack_hh_b32_b16 s15, s80, s82
    s_pack_ll_b32_b16 s82, s81, s83
    s_pack_hh_b32_b16 s83, s81, s83
    s_mov_b32 s80, s14
    s_mov_b32 s81, s15
    s_waitcnt vmcnt(10)
    ds_write_b128 v1, v[28:31] offset:0
    s_waitcnt vmcnt(9)
    ds_write_b128 v1, v[32:35] offset:16384
    s_waitcnt vmcnt(8)
    ds_write_b128 v1, v[36:39] offset:32768
    s_waitcnt vmcnt(7)
    ds_write_b128 v1, v[40:43] offset:49152
    ds_read_b128 v[28:31], v115 offset:0
    ds_read_b128 v[36:39], v115 offset:32
    ds_read_b128 v[32:35], v115 offset:16
    ds_read_b128 v[40:43], v115 offset:48
    ds_write_b128 v1, v[44:47] offset:0
    ds_write_b128 v1, v[44:47] offset:16384
    ds_write_b128 v1, v[44:47] offset:32768
    ds_write_b128 v1, v[44:47] offset:49152
    s_waitcnt lgkmcnt(6)
    v_mad_u32_u16 v108, v28, v50, s40 op_sel:[0,0,0,0]
    v_mad_u32_u16 v109, v36, v50, s41 op_sel:[0,0,0,0]
    v_sub_u32_sdwa v110, v109, v108 dst_sel:DWORD dst_unused:UNUSED_PAD src0_sel:WORD_1 src1_sel:WORD_1
    s_nop 1
    v_add_u32_dpp v110, v110, v110 row_shr:1 row_mask:0xf bank_mask:0xf bound_ctrl:0
    s_nop 1
    v_add_u32_dpp v110, v110, v110 row_shr:2 row_mask:0xf bank_mask:0xf bound_ctrl:0
    s_nop 1
    v_add_u32_dpp v110, v110, v110 row_shr:4 row_mask:0xf bank_mask:0xf bound_ctrl:0
    s_nop 1
    v_add_u32_dpp v110, v110, v110 row_shr:8 row_mask:0xf bank_mask:0xf bound_ctrl:0
    s_nop 1
    v_add_u32_dpp v110, v110, v110 row_bcast:15 row_mask:0xa bank_mask:0xf
    s_nop 1
    v_add_u32_dpp v110, v110, v110 row_bcast:31 row_mask:0xc bank_mask:0xf
    v_sub_u32_sdwa v109, v109, v110 dst_sel:DWORD dst_unused:UNUSED_PAD src0_sel:WORD_1 src1_sel:DWORD
    v_readlane_b32 s29, v110, 63
    v_add_u32 v110, -1, v110
    ds_write_b16 v126, v109
    v_lshlrev_b32_e64 v111, v110, 1
    v_lshrrev_b32 v110, 5, v110
    v_lshl_add_u32 v110, v110, 2, s19
    s_cmp_gt_u32 s29, 320
    s_cselect_b32 s2, 1, s2
    s_cselect_b64 exec, 0, -1
    ds_or_b32 v110, v111 offset:160
    s_mov_b64 exec, -1
    ds_wrxchg_rtn_b32 v7, v6, v5 offset:160
    s_waitcnt lgkmcnt(0)
    v_readlane_b32 s30, v7, 0
    v_readlane_b32 s31, v7, 1
    v_readlane_b32 s32, v7, 2
    v_readlane_b32 s33, v7, 3
    v_readlane_b32 s34, v7, 4
    v_readlane_b32 s35, v7, 5
    v_readlane_b32 s36, v7, 6
    v_readlane_b32 s37, v7, 7
    s_mov_b32 s25, s19
    s_mov_b32 s26, s27
    s_mov_b32 s51, s28
    s_mov_b32 s28, s29
    v_mbcnt_lo_u32_b32 v8, s30, 0
    v_mbcnt_hi_u32_b32 v8, s31, v8
    s_bcnt1_i32_b64 s14, s[30:31]
    v_lshl_add_u32 v9, v8, 1, s25
    ds_read_u16 v9, v9
    s_add_u32 s30, s26, 0
    s_lshl1_add_u32 s25, s14, s25
    s_lshl_b32 s14, s14, 10
    s_add_u32 s26, s26, s14
    v_mbcnt_lo_u32_b32 v12, s32, 0
    v_mbcnt_hi_u32_b32 v12, s33, v12
    s_bcnt1_i32_b64 s14, s[32:33]
    v_lshl_add_u32 v13, v12, 1, s25
    ds_read_u16 v13, v13
    s_add_u32 s32, s26, 1048576
    s_lshl1_add_u32 s25, s14, s25
    s_lshl_b32 s14, s14, 10
    s_add_u32 s26, s26, s14
    v_mbcnt_lo_u32_b32 v16, s34, 0
    v_mbcnt_hi_u32_b32 v16, s35, v16
    s_bcnt1_i32_b64 s14, s[34:35]
    v_lshl_add_u32 v17, v16, 1, s25
    ds_read_u16 v17, v17
    s_add_u32 s34, s26, 2097152
    s_lshl1_add_u32 s25, s14, s25
    s_lshl_b32 s14, s14, 10
    s_add_u32 s26, s26, s14
    v_mbcnt_lo_u32_b32 v20, s36, 0
    v_mbcnt_hi_u32_b32 v20, s37, v20
    s_bcnt1_i32_b64 s14, s[36:37]
    v_lshl_add_u32 v21, v20, 1, s25
    ds_read_u16 v21, v21
    s_add_u32 s36, s26, 3145728
    s_lshl1_add_u32 s25, s14, s25
    s_lshl_b32 s14, s14, 10
    s_add_u32 s26, s26, s14
    s_waitcnt lgkmcnt(3)
    v_mad_u32_u16 v9, v9, s23, v2
    v_pk_lshrrev_b16 v9, 10, v9 op_sel_hi:[1,1]
    v_lshl_add_u32 v8, v8, 6, v9
    buffer_load_dwordx4 v[8:11], v8, s[44:47], s30 idxen
    s_waitcnt lgkmcnt(2)
    v_mad_u32_u16 v13, v13, s23, v2
    v_pk_lshrrev_b16 v13, 10, v13 op_sel_hi:[1,1]
    v_lshl_add_u32 v12, v12, 6, v13
    buffer_load_dwordx4 v[12:15], v12, s[44:47], s32 idxen
    s_waitcnt lgkmcnt(1)
    v_mad_u32_u16 v17, v17, s23, v2
    v_pk_lshrrev_b16 v17, 10, v17 op_sel_hi:[1,1]
    v_lshl_add_u32 v16, v16, 6, v17
    buffer_load_dwordx4 v[16:19], v16, s[44:47], s34 idxen
    s_waitcnt lgkmcnt(0)
    v_mad_u32_u16 v21, v21, s23, v2
    v_pk_lshrrev_b16 v21, 10, v21 op_sel_hi:[1,1]
    v_lshl_add_u32 v20, v20, 6, v21
    buffer_load_dwordx4 v[20:23], v20, s[44:47], s36 idxen
    s_cmp_le_u32 s28, 256
    s_cbranch_scc1 L_p2_kernel_noopt_1
    v_readlane_b32 s38, v7, 8
    v_readlane_b32 s39, v7, 9
    s_nop 1
    v_mbcnt_lo_u32_b32 v51, s38, 0
    v_mbcnt_hi_u32_b32 v51, s39, v51
    s_bcnt1_i32_b64 s14, s[38:39]
    v_lshl_add_u32 v55, v51, 1, s25
    ds_read_u16 v55, v55
    s_add_u32 s38, s26, 4194304
    s_lshl1_add_u32 s25, s14, s25
    s_lshl_b32 s14, s14, 10
    s_add_u32 s26, s26, s14
    s_waitcnt lgkmcnt(0)
    v_mad_u32_u16 v55, v55, s23, v2
    v_pk_lshrrev_b16 v55, 10, v55 op_sel_hi:[1,1]
    v_lshl_add_u32 v51, v51, 6, v55
    buffer_load_dwordx4 v[24:27], v51, s[44:47], s38 idxen
L_p2_kernel_noopt_1:
    s_waitcnt vmcnt(6)
    ds_write_b128 v3, v[88:91] offset:0
    ds_write_b128 v3, v[92:95] offset:16384
    ds_write_b128 v3, v[96:99] offset:32768
    ds_write_b128 v3, v[100:103] offset:49152
    ds_write_b128 v124, v[104:107] offset:0
    s_waitcnt vmcnt(4)
    v_max3_u32 v64, v80, v82, v84
    v_add_f32 v65, v81, v83
    v_add_f32 v66, v85, v87
    v_max_u32 v64, v64, v86
    v_add_f32 v65, v65, v66
    v_cmp_lt_u32 vcc, 0xffff, v64
    s_nop 1
    v_max_u32_dpp v64, v64, v64 row_shr:1 row_mask:0xf bank_mask:0xf bound_ctrl:0
    s_nop 1
    v_max_u32_dpp v64, v64, v64 row_shr:2 row_mask:0xf bank_mask:0xf bound_ctrl:0
    s_nop 1
    v_max_u32_dpp v64, v64, v64 row_shr:4 row_mask:0xf bank_mask:0xf bound_ctrl:0
    s_nop 1
    v_max_u32_dpp v64, v64, v64 row_shr:8 row_mask:0xf bank_mask:0xf bound_ctrl:0
    s_nop 1
    v_max_u32_dpp v64, v64, v64 row_bcast:15 row_mask:0xa bank_mask:0xf
    s_nop 1
    v_max_u32_dpp v64, v64, v64 row_bcast:31 row_mask:0xc bank_mask:0xf
    s_nop 1
    v_add_f32_dpp v65, v65, v65 row_shr:1 row_mask:0xf bank_mask:0xf bound_ctrl:0
    s_nop 1
    v_add_f32_dpp v65, v65, v65 row_shr:2 row_mask:0xf bank_mask:0xf bound_ctrl:0
    s_nop 1
    v_add_f32_dpp v65, v65, v65 row_shr:4 row_mask:0xf bank_mask:0xf bound_ctrl:0
    s_nop 1
    v_add_f32_dpp v65, v65, v65 row_shr:8 row_mask:0xf bank_mask:0xf bound_ctrl:0
    s_nop 1
    v_add_f32_dpp v65, v65, v65 row_bcast:15 row_mask:0xa bank_mask:0xf
    s_nop 1
    v_add_f32_dpp v65, v65, v65 row_bcast:31 row_mask:0xc bank_mask:0xf
    s_cmp_lg_u64 vcc, 0
    s_cselect_b32 s2, 1, s2
    v_lshlrev_b32 v64, 16, v64
    v_mul_f32 v66, 936490775, v65
    v_mul_f32 v65, 928531664, v65
    v_cmp_nle_f32 vcc, v64, v66
    v_max_u32 v64, v64, v65
    s_nop 0
    v_readlane_b32 s14, v64, 63
    s_bitcmp1_b32 vcc_hi, 31
    s_cselect_b32 s2, 1, s2
    s_lshr_b32 s14, s14, 23
    s_add_u32 s14, s14, 1
    s_cmp_lt_u32 s14, 40
    s_cselect_b32 s2, 1, s2
    s_cmp_gt_u32 s14, 230
    s_cselect_b32 s2, 1, s2
    s_sub_u32 s48, s14, 14
    s_lshl_b32 s48, s48, 23
    s_add_u32 s16, s48, 272629760
    s_lshr_b32 s15, s16, 16
    s_sub_u32 s15, 0x10000, s15
    s_add_u32 s20, s16, s15
    s_sub_u32 s17, s20, 1
    s_mov_b32 s21, s17
    s_or_b32 s48, s48, 16416
    s_sub_u32 s14, s14, 40
    s_cmp_gt_u32 s14, 190
    s_cselect_b32 s48, 0, s48
    s_waitcnt lgkmcnt(0)
    s_barrier
    s_add_u32 s14, s22, 80000
    buffer_load_dwordx4 v[88:91], v1, s[8:11], s14 offen
    s_add_u32 s14, s22, 96384
    buffer_load_dwordx4 v[92:95], v1, s[8:11], s14 offen
    v_mad_u32_u16 v108, v28, v50, s40 op_sel:[1,0,0,0]
    v_mad_u32_u16 v109, v36, v50, s41 op_sel:[1,0,0,0]
    v_sub_u32_sdwa v110, v109, v108 dst_sel:DWORD dst_unused:UNUSED_PAD src0_sel:WORD_1 src1_sel:WORD_1
    s_nop 1
    v_add_u32_dpp v110, v110, v110 row_shr:1 row_mask:0xf bank_mask:0xf bound_ctrl:0
    s_nop 1
    v_add_u32_dpp v110, v110, v110 row_shr:2 row_mask:0xf bank_mask:0xf bound_ctrl:0
    s_nop 1
    v_add_u32_dpp v110, v110, v110 row_shr:4 row_mask:0xf bank_mask:0xf bound_ctrl:0
    s_nop 1
    v_add_u32_dpp v110, v110, v110 row_shr:8 row_mask:0xf bank_mask:0xf bound_ctrl:0
    s_nop 1
    v_add_u32_dpp v110, v110, v110 row_bcast:15 row_mask:0xa bank_mask:0xf
    s_nop 1
    v_add_u32_dpp v110, v110, v110 row_bcast:31 row_mask:0xc bank_mask:0xf
    v_sub_u32_sdwa v109, v109, v110 dst_sel:DWORD dst_unused:UNUSED_PAD src0_sel:WORD_1 src1_sel:DWORD
    v_readlane_b32 s29, v110, 63
    v_add_u32 v110, -1, v110
    ds_write_b16 v126, v109
    v_lshlrev_b32_e64 v111, v110, 1
    v_lshrrev_b32 v110, 5, v110
    v_lshl_add_u32 v110, v110, 2, s19
    s_cmp_gt_u32 s29, 320
    s_cselect_b32 s2, 1, s2
    s_cselect_b64 exec, 0, -1
    ds_or_b32 v110, v111 offset:160
    s_mov_b64 exec, -1
    ds_wrxchg_rtn_b32 v7, v6, v5 offset:160
    s_mov_b32 s24, 0
L_p2_loop:
    s_add_u32 s22, s22, 80000
    s_lshl_b32 s14, s13, 4
    s_or_b32 s14, s14, s24
    s_cmp_lg_u32 s14, 5
    s_cbranch_scc1 L_p2_nost
    v_mov_b32 v52, 0
    s_lshl_b32 s14, s3, 8
    s_add_u32 s14, s14, 8523776
    s_mov_b64 exec, 1
    buffer_atomic_add v52, off, s[4:7], s14 sc0
    s_mov_b64 exec, -1
L_p2_nost:
    s_waitcnt vmcnt(5)
    v_mad_u32_u16 v64, v8, 8, s18
    v_mad_u32_u16 v66, v9, 8, s18
    v_mad_u32_u16 v68, v10, 8, s18
    ds_read_b64 v[64:65], v64
    ds_read_b64 v[66:67], v66
    ds_read_b64 v[68:69], v68
    s_add_u32 s14, s22, 32768
    buffer_load_dwordx4 v[96:99], v1, s[8:11], s14 offen
    s_waitcnt vmcnt(5)
    v_mad_u32_u16 v70, v12, 8, s18
    v_mad_u32_u16 v72, v13, 8, s18
    v_mad_u32_u16 v74, v14, 8, s18
    ds_read_b64 v[70:71], v70
    ds_read_b64 v[72:73], v72
    ds_read_b64 v[74:75], v74
    s_add_u32 s14, s22, 49152
    buffer_load_dwordx4 v[100:103], v1, s[8:11], s14 offen
    s_waitcnt lgkmcnt(6)
    v_readlane_b32 s30, v7, 0
    v_readlane_b32 s31, v7, 1
    v_readlane_b32 s32, v7, 2
    v_readlane_b32 s33, v7, 3
    v_readlane_b32 s34, v7, 4
    v_readlane_b32 s35, v7, 5
    v_readlane_b32 s36, v7, 6
    v_readlane_b32 s37, v7, 7
    s_mov_b32 s25, s19
    s_mov_b32 s26, s27
    s_mov_b32 s51, s28
    s_mov_b32 s28, s29
    v_mbcnt_lo_u32_b32 v51, s30, 0
    v_mbcnt_hi_u32_b32 v51, s31, v51
    s_bcnt1_i32_b64 s14, s[30:31]
    v_lshl_add_u32 v55, v51, 1, s25
    ds_read_u16 v55, v55
    s_add_u32 s30, s26, 0
    s_lshl1_add_u32 s25, s14, s25
    s_lshl_b32 s14, s14, 10
    s_add_u32 s26, s26, s14
    v_bfe_i32 v108, v11, 2, 10
    v_bfe_i32 v109, v11, 12, 10
    v_ashrrev_i32 v110, 22, v11
    v_cvt_f32_i32 v108, v108
    v_cvt_f32_i32 v109, v109
    v_cvt_f32_i32 v110, v110
    s_waitcnt lgkmcnt(4)
    v_mfma_f32_4x4x4_16b_bf16 v[112:115], v[58:59], v[64:65], 0
    v_mfma_f32_4x4x4_16b_bf16 v[116:119], v[58:59], v[66:67], 0
    v_mfma_f32_4x4x4_16b_bf16 v[120:123], v[58:59], v[68:69], 0
    v_mad_u32_u16 v8, v8, 8, s50 op_sel:[1,0,0,0]
    v_mad_u32_u16 v9, v9, 8, s50 op_sel:[1,0,0,0]
    v_mad_u32_u16 v10, v10, 8, s50 op_sel:[1,0,0,0]
    v_pk_fma_f32 v[114:115], v[114:115], v[108:109], s[20:21] op_sel:[0,0,0] op_sel_hi:[1,0,1]
    v_pk_fma_f32 v[112:113], v[112:113], v[108:109], s[16:17] op_sel:[0,0,0] op_sel_hi:[1,0,1]
    v_pk_fma_f32 v[118:119], v[118:119], v[108:109], s[20:21] op_sel:[0,1,0] op_sel_hi:[1,1,1]
    v_pk_fma_f32 v[116:117], v[116:117], v[108:109], s[16:17] op_sel:[0,1,0] op_sel_hi:[1,1,1]
    v_pk_fma_f32 v[122:123], v[122:123], v[110:111], s[20:21] op_sel:[0,0,0] op_sel_hi:[1,0,1]
    v_pk_fma_f32 v[120:121], v[120:121], v[110:111], s[16:17] op_sel:[0,0,0] op_sel_hi:[1,0,1]
    v_lshlrev_b64 v[114:115], 16, v[114:115]
    v_lshlrev_b64 v[118:119], 16, v[118:119]
    v_lshlrev_b64 v[122:123], 16, v[122:123]
    v_lshl_add_u64 v[64:65], v[112:113], 0, v[114:115]
    v_lshl_add_u64 v[66:67], v[116:117], 0, v[118:119]
    v_lshl_add_u64 v[68:69], v[120:121], 0, v[122:123]
    v_or3_b32 v4, v44, v45, v4
    v_or3_b32 v4, v46, v47, v4
    v_or3_b32 v4, v48, v49, v4
    ds_add_rtn_u64 v[44:45], v8, v[64:65]
    ds_add_rtn_u64 v[46:47], v9, v[66:67]
    ds_add_rtn_u64 v[48:49], v10, v[68:69]
    s_waitcnt lgkmcnt(3)
    v_mad_u32_u16 v55, v55, s23, v2
    v_pk_lshrrev_b16 v55, 10, v55 op_sel_hi:[1,1]
    v_lshl_add_u32 v51, v51, 6, v55
    buffer_load_dwordx4 v[8:11], v51, s[44:47], s30 idxen
    s_add_u32 s14, s22, 65536
    buffer_load_dwordx4 v[104:107], v1, s[8:11], s14 offen
    s_waitcnt vmcnt(7)
    v_mad_u32_u16 v76, v16, 8, s18
    v_mad_u32_u16 v78, v17, 8, s18
    v_mad_u32_u16 v80, v18, 8, s18
    ds_read_b64 v[76:77], v76
    ds_read_b64 v[78:79], v78
    ds_read_b64 v[80:81], v80
    s_waitcnt vmcnt(6)
    v_mad_u32_u16 v82, v20, 8, s18
    v_mad_u32_u16 v84, v21, 8, s18
    v_mad_u32_u16 v86, v22, 8, s18
    ds_read_b64 v[82:83], v82
    ds_read_b64 v[84:85], v84
    ds_read_b64 v[86:87], v86
    s_cmp_le_u32 s51, 256
    s_cbranch_scc1 L_p2_kernel_noopt3_2
    v_mad_u32_u16 v64, v24, 8, s18
    v_mad_u32_u16 v66, v25, 8, s18
    v_mad_u32_u16 v68, v26, 8, s18
    ds_read_b64 v[64:65], v64
    ds_read_b64 v[66:67], v66
    ds_read_b64 v[68:69], v68
L_p2_kernel_noopt3_2:
    v_mbcnt_lo_u32_b32 v51, s32, 0
    v_mbcnt_hi_u32_b32 v51, s33, v51
    s_bcnt1_i32_b64 s14, s[32:33]
    v_lshl_add_u32 v55, v51, 1, s25
    ds_read_u16 v55, v55
    s_add_u32 s32, s26, 1048576
    s_lshl1_add_u32 s25, s14, s25
    s_lshl_b32 s14, s14, 10
    s_add_u32 s26, s26, s14
    v_bfe_i32 v108, v15, 2, 10
    v_bfe_i32 v109, v15, 12, 10
    v_ashrrev_i32 v110, 22, v15
    v_cvt_f32_i32 v108, v108
    v_cvt_f32_i32 v109, v109
    v_cvt_f32_i32 v110, v110
    v_mfma_f32_4x4x4_16b_bf16 v[112:115], v[58:59], v[70:71], 0
    v_mfma_f32_4x4x4_16b_bf16 v[116:119], v[58:59], v[72:73], 0
    v_mfma_f32_4x4x4_16b_bf16 v[120:123], v[58:59], v[74:75], 0
    v_mad_u32_u16 v12, v12, 8, s50 op_sel:[1,0,0,0]
    v_mad_u32_u16 v13, v13, 8, s50 op_sel:[1,0,0,0]
    v_mad_u32_u16 v14, v14, 8, s50 op_sel:[1,0,0,0]
    v_pk_fma_f32 v[114:115], v[114:115], v[108:109], s[20:21] op_sel:[0,0,0] op_sel_hi:[1,0,1]
    v_pk_fma_f32 v[112:113], v[112:113], v[108:109], s[16:17] op_sel:[0,0,0] op_sel_hi:[1,0,1]
    v_pk_fma_f32 v[118:119], v[118:119], v[108:109], s[20:21] op_sel:[0,1,0] op_sel_hi:[1,1,1]
    v_pk_fma_f32 v[116:117], v[116:117], v[108:109], s[16:17] op_sel:[0,1,0] op_sel_hi:[1,1,1]
    v_pk_fma_f32 v[122:123], v[122:123], v[110:111], s[20:21] op_sel:[0,0,0] op_sel_hi:[1,0,1]
    v_pk_fma_f32 v[120:121], v[120:121], v[110:111], s[16:17] op_sel:[0,0,0] op_sel_hi:[1,0,1]
    v_lshlrev_b64 v[114:115], 16, v[114:115]
    v_lshlrev_b64 v[118:119], 16, v[118:119]
    v_lshlrev_b64 v[122:123], 16, v[122:123]
    v_lshl_add_u64 v[70:71], v[112:113], 0, v[114:115]
    v_lshl_add_u64 v[72:73], v[116:117], 0, v[118:119]
    v_lshl_add_u64 v[74:75], v[120:121], 0, v[122:123]
    s_waitcnt lgkmcnt(7)
    v_or3_b32 v4, v44, v45, v4
    v_or3_b32 v4, v46, v47, v4
    v_or3_b32 v4, v48, v49, v4
    ds_add_rtn_u64 v[44:45], v12, v[70:71]
    ds_add_rtn_u64 v[46:47], v13, v[72:73]
    ds_add_rtn_u64 v[48:49], v14, v[74:75]
    s_waitcnt lgkmcnt(3)
    v_mad_u32_u16 v55, v55, s23, v2
    v_pk_lshrrev_b16 v55, 10, v55 op_sel_hi:[1,1]
    v_lshl_add_u32 v51, v51, 6, v55
    buffer_load_dwordx4 v[12:15], v51, s[44:47], s32 idxen
    s_barrier
    s_waitcnt vmcnt(1)
    ds_write_b128 v3, v[88:91] offset:0
    ds_write_b128 v3, v[92:95] offset:16384
    ds_write_b128 v3, v[96:99] offset:32768
    ds_write_b128 v3, v[100:103] offset:49152
    ds_write_b128 v124, v[104:107] offset:0
    v_mbcnt_lo_u32_b32 v51, s34, 0
    v_mbcnt_hi_u32_b32 v51, s35, v51
    s_bcnt1_i32_b64 s14, s[34:35]
    v_lshl_add_u32 v55, v51, 1, s25
    ds_read_u16 v55, v55
    s_add_u32 s34, s26, 2097152
    s_lshl1_add_u32 s25, s14, s25
    s_lshl_b32 s14, s14, 10
    s_add_u32 s26, s26, s14
    v_bfe_i32 v108, v19, 2, 10
    v_bfe_i32 v109, v19, 12, 10
    v_ashrrev_i32 v110, 22, v19
    v_cvt_f32_i32 v108, v108
    v_cvt_f32_i32 v109, v109
    v_cvt_f32_i32 v110, v110
    v_mfma_f32_4x4x4_16b_bf16 v[112:115], v[58:59], v[76:77], 0
    v_mfma_f32_4x4x4_16b_bf16 v[116:119], v[58:59], v[78:79], 0
    v_mfma_f32_4x4x4_16b_bf16 v[120:123], v[58:59], v[80:81], 0
    v_mad_u32_u16 v16, v16, 8, s50 op_sel:[1,0,0,0]
    v_mad_u32_u16 v17, v17, 8, s50 op_sel:[1,0,0,0]
    v_mad_u32_u16 v18, v18, 8, s50 op_sel:[1,0,0,0]
    v_pk_fma_f32 v[114:115], v[114:115], v[108:109], s[20:21] op_sel:[0,0,0] op_sel_hi:[1,0,1]
    v_pk_fma_f32 v[112:113], v[112:113], v[108:109], s[16:17] op_sel:[0,0,0] op_sel_hi:[1,0,1]
    v_pk_fma_f32 v[118:119], v[118:119], v[108:109], s[20:21] op_sel:[0,1,0] op_sel_hi:[1,1,1]
    v_pk_fma_f32 v[116:117], v[116:117], v[108:109], s[16:17] op_sel:[0,1,0] op_sel_hi:[1,1,1]
    v_pk_fma_f32 v[122:123], v[122:123], v[110:111], s[20:21] op_sel:[0,0,0] op_sel_hi:[1,0,1]
    v_pk_fma_f32 v[120:121], v[120:121], v[110:111], s[16:17] op_sel:[0,0,0] op_sel_hi:[1,0,1]
    v_lshlrev_b64 v[114:115], 16, v[114:115]
    v_lshlrev_b64 v[118:119], 16, v[118:119]
    v_lshlrev_b64 v[122:123], 16, v[122:123]
    v_lshl_add_u64 v[76:77], v[112:113], 0, v[114:115]
    v_lshl_add_u64 v[78:79], v[116:117], 0, v[118:119]
    v_lshl_add_u64 v[80:81], v[120:121], 0, v[122:123]
    s_waitcnt lgkmcnt(6)
    v_or3_b32 v4, v44, v45, v4
    v_or3_b32 v4, v46, v47, v4
    v_or3_b32 v4, v48, v49, v4
    ds_add_rtn_u64 v[44:45], v16, v[76:77]
    ds_add_rtn_u64 v[46:47], v17, v[78:79]
    ds_add_rtn_u64 v[48:49], v18, v[80:81]
    s_waitcnt lgkmcnt(3)
    v_mad_u32_u16 v55, v55, s23, v2
    v_pk_lshrrev_b16 v55, 10, v55 op_sel_hi:[1,1]
    v_lshl_add_u32 v51, v51, 6, v55
    buffer_load_dwordx4 v[16:19], v51, s[44:47], s34 idxen
    s_cmp_le_u32 s51, 256
    s_cbranch_scc1 L_p2_kernel_noopt3_3
    v_bfe_i32 v108, v27, 2, 10
    v_bfe_i32 v109, v27, 12, 10
    v_ashrrev_i32 v110, 22, v27
    v_cvt_f32_i32 v108, v108
    v_cvt_f32_i32 v109, v109
    v_cvt_f32_i32 v110, v110
    v_mfma_f32_4x4x4_16b_bf16 v[112:115], v[58:59], v[64:65], 0
    v_mfma_f32_4x4x4_16b_bf16 v[116:119], v[58:59], v[66:67], 0
    v_mfma_f32_4x4x4_16b_bf16 v[120:123], v[58:59], v[68:69], 0
    v_mad_u32_u16 v24, v24, 8, s50 op_sel:[1,0,0,0]
    v_mad_u32_u16 v25, v25, 8, s50 op_sel:[1,0,0,0]
    v_mad_u32_u16 v26, v26, 8, s50 op_sel:[1,0,0,0]
    v_pk_fma_f32 v[114:115], v[114:115], v[108:109], s[20:21] op_sel:[0,0,0] op_sel_hi:[1,0,1]
    v_pk_fma_f32 v[112:113], v[112:113], v[108:109], s[16:17] op_sel:[0,0,0] op_sel_hi:[1,0,1]
    v_pk_fma_f32 v[118:119], v[118:119], v[108:109], s[20:21] op_sel:[0,1,0] op_sel_hi:[1,1,1]
    v_pk_fma_f32 v[116:117], v[116:117], v[108:109], s[16:17] op_sel:[0,1,0] op_sel_hi:[1,1,1]
    v_pk_fma_f32 v[122:123], v[122:123], v[110:111], s[20:21] op_sel:[0,0,0] op_sel_hi:[1,0,1]
    v_pk_fma_f32 v[120:121], v[120:121], v[110:111], s[16:17] op_sel:[0,0,0] op_sel_hi:[1,0,1]
    v_lshlrev_b64 v[114:115], 16, v[114:115]
    v_lshlrev_b64 v[118:119], 16, v[118:119]
    v_lshlrev_b64 v[122:123], 16, v[122:123]
    v_lshl_add_u64 v[64:65], v[112:113], 0, v[114:115]
    v_lshl_add_u64 v[66:67], v[116:117], 0, v[118:119]
    v_lshl_add_u64 v[68:69], v[120:121], 0, v[122:123]
    s_waitcnt lgkmcnt(0)
    v_or3_b32 v4, v44, v45, v4
    v_or3_b32 v4, v46, v47, v4
    v_or3_b32 v4, v48, v49, v4
    ds_add_rtn_u64 v[44:45], v24, v[64:65]
    ds_add_rtn_u64 v[46:47], v25, v[66:67]
    ds_add_rtn_u64 v[48:49], v26, v[68:69]
L_p2_kernel_noopt3_3:
    v_mbcnt_lo_u32_b32 v51, s36, 0
    v_mbcnt_hi_u32_b32 v51, s37, v51
    s_bcnt1_i32_b64 s14, s[36:37]
    v_lshl_add_u32 v55, v51, 1, s25
    ds_read_u16 v55, v55
    s_add_u32 s36, s26, 3145728
    s_lshl1_add_u32 s25, s14, s25
    s_lshl_b32 s14, s14, 10
    s_add_u32 s26, s26, s14
    s_cmp_le_u32 s28, 256
    s_cbranch_scc1 L_p2_kernel_noopt3_4
    v_readlane_b32 s38, v7, 8
    v_readlane_b32 s39, v7, 9
    s_nop 1
    v_mbcnt_lo_u32_b32 v62, s38, 0
    v_mbcnt_hi_u32_b32 v62, s39, v62
    s_bcnt1_i32_b64 s14, s[38:39]
    v_lshl_add_u32 v63, v62, 1, s25
    ds_read_u16 v63, v63
    s_add_u32 s38, s26, 4194304
    s_lshl1_add_u32 s25, s14, s25
    s_lshl_b32 s14, s14, 10
    s_add_u32 s26, s26, s14
L_p2_kernel_noopt3_4:
    v_bfe_i32 v108, v23, 2, 10
    v_bfe_i32 v109, v23, 12, 10
    v_ashrrev_i32 v110, 22, v23
    v_cvt_f32_i32 v108, v108
    v_cvt_f32_i32 v109, v109
    v_cvt_f32_i32 v110, v110
    v_mfma_f32_4x4x4_16b_bf16 v[112:115], v[58:59], v[82:83], 0
    v_mfma_f32_4x4x4_16b_bf16 v[116:119], v[58:59], v[84:85], 0
    v_mfma_f32_4x4x4_16b_bf16 v[120:123], v[58:59], v[86:87], 0
    v_mad_u32_u16 v20, v20, 8, s50 op_sel:[1,0,0,0]
    v_mad_u32_u16 v21, v21, 8, s50 op_sel:[1,0,0,0]
    v_mad_u32_u16 v22, v22, 8, s50 op_sel:[1,0,0,0]
    v_pk_fma_f32 v[114:115], v[114:115], v[108:109], s[20:21] op_sel:[0,0,0] op_sel_hi:[1,0,1]
    v_pk_fma_f32 v[112:113], v[112:113], v[108:109], s[16:17] op_sel:[0,0,0] op_sel_hi:[1,0,1]
    v_pk_fma_f32 v[118:119], v[118:119], v[108:109], s[20:21] op_sel:[0,1,0] op_sel_hi:[1,1,1]
    v_pk_fma_f32 v[116:117], v[116:117], v[108:109], s[16:17] op_sel:[0,1,0] op_sel_hi:[1,1,1]
    v_pk_fma_f32 v[122:123], v[122:123], v[110:111], s[20:21] op_sel:[0,0,0] op_sel_hi:[1,0,1]
    v_pk_fma_f32 v[120:121], v[120:121], v[110:111], s[16:17] op_sel:[0,0,0] op_sel_hi:[1,0,1]
    v_lshlrev_b64 v[114:115], 16, v[114:115]
    v_lshlrev_b64 v[118:119], 16, v[118:119]
    v_lshlrev_b64 v[122:123], 16, v[122:123]
    v_lshl_add_u64 v[82:83], v[112:113], 0, v[114:115]
    v_lshl_add_u64 v[84:85], v[116:117], 0, v[118:119]
    v_lshl_add_u64 v[86:87], v[120:121], 0, v[122:123]
    s_waitcnt lgkmcnt(1)
    v_or3_b32 v4, v44, v45, v4
    v_or3_b32 v4, v46, v47, v4
    v_or3_b32 v4, v48, v49, v4
    ds_add_rtn_u64 v[44:45], v20, v[82:83]
    ds_add_rtn_u64 v[46:47], v21, v[84:85]
    ds_add_rtn_u64 v[48:49], v22, v[86:87]
    s_waitcnt lgkmcnt(3)
    v_mad_u32_u16 v55, v55, s23, v2
    v_pk_lshrrev_b16 v55, 10, v55 op_sel_hi:[1,1]
    v_lshl_add_u32 v51, v51, 6, v55
    buffer_load_dwordx4 v[20:23], v51, s[44:47], s36 idxen
    s_cmp_le_u32 s28, 256
    s_cbranch_scc1 L_p2_kernel_noopt3_5
    v_mad_u32_u16 v63, v63, s23, v2
    v_pk_lshrrev_b16 v63, 10, v63 op_sel_hi:[1,1]
    v_lshl_add_u32 v62, v62, 6, v63
    buffer_load_dwordx4 v[24:27], v62, s[44:47], s38 idxen
L_p2_kernel_noopt3_5:
    v_pk_mov_b32 v[28:29], v[28:29], v[30:31] op_sel:[1,0]
    v_pk_mov_b32 v[30:31], v[30:31], v[32:33] op_sel:[1,0]
    v_pk_mov_b32 v[32:33], v[32:33], v[34:35] op_sel:[1,0]
    v_pk_mov_b32 v[34:35], v[34:35], v[4:5] op_sel:[1,1]
    v_pk_mov_b32 v[36:37], v[36:37], v[38:39] op_sel:[1,0]
    v_pk_mov_b32 v[38:39], v[38:39], v[40:41] op_sel:[1,0]
    v_pk_mov_b32 v[40:41], v[40:41], v[42:43] op_sel:[1,0]
    v_pk_mov_b32 v[42:43], v[42:43], v[4:5] op_sel:[1,1]
    v_mad_u32_u16 v108, v28, v50, s40 op_sel:[0,0,0,0]
    v_mad_u32_u16 v109, v36, v50, s41 op_sel:[0,0,0,0]
    v_sub_u32_sdwa v110, v109, v108 dst_sel:DWORD dst_unused:UNUSED_PAD src0_sel:WORD_1 src1_sel:WORD_1
    s_nop 1
    v_add_u32_dpp v110, v110, v110 row_shr:1 row_mask:0xf bank_mask:0xf bound_ctrl:0
    s_nop 1
    v_add_u32_dpp v110, v110, v110 row_shr:2 row_mask:0xf bank_mask:0xf bound_ctrl:0
    s_nop 1
    v_add_u32_dpp v110, v110, v110 row_shr:4 row_mask:0xf bank_mask:0xf bound_ctrl:0
    s_nop 1
    v_add_u32_dpp v110, v110, v110 row_shr:8 row_mask:0xf bank_mask:0xf bound_ctrl:0
    s_nop 1
    v_add_u32_dpp v110, v110, v110 row_bcast:15 row_mask:0xa bank_mask:0xf
    s_nop 1
    v_add_u32_dpp v110, v110, v110 row_bcast:31 row_mask:0xc bank_mask:0xf
    v_sub_u32_sdwa v109, v109, v110 dst_sel:DWORD dst_unused:UNUSED_PAD src0_sel:WORD_1 src1_sel:DWORD
    v_readlane_b32 s29, v110, 63
    v_add_u32 v110, -1, v110
    ds_write_b16 v126, v109
    v_lshlrev_b32_e64 v111, v110, 1
    v_lshrrev_b32 v110, 5, v110
    v_lshl_add_u32 v110, v110, 2, s19
    s_cmp_gt_u32 s29, 320
    s_cselect_b32 s2, 1, s2
    s_cselect_b64 exec, 0, -1
    ds_or_b32 v110, v111 offset:160
    s_mov_b64 exec, -1
    ds_wrxchg_rtn_b32 v7, v6, v5 offset:160
    s_add_u32 s14, s22, 80000
    buffer_load_dwordx4 v[88:91], v1, s[8:11], s14 offen
    s_add_u32 s14, s22, 96384
    buffer_load_dwordx4 v[92:95], v1, s[8:11], s14 offen
    s_barrier
    s_add_u32 s22, s22, 80000
    s_cmp_lg_u32 s24, 7
    s_cbranch_scc1 L_p2_nodist
    s_mov_b32 s46, 0
    s_lshl2_add_u32 s14, s3, s12
    s_mul_i32 s14, s14, 5000
    s_add_u32 s15, s14, 4096
    v_min_u32 v61, 225, v0
    v_lshl_add_u32 v60, v0, 2, s14
    v_lshl_add_u32 v61, v61, 2, s15
    global_load_dword v60, v60, s[100:101] nt
    global_load_dword v61, v61, s[100:101] nt
L_p2_nodist:
    v_mad_u32_u16 v64, v8, 8, s18
    v_mad_u32_u16 v66, v9, 8, s18
    v_mad_u32_u16 v68, v10, 8, s18
    ds_read_b64 v[64:65], v64
    ds_read_b64 v[66:67], v66
    ds_read_b64 v[68:69], v68
    s_add_u32 s14, s22, 32768
    buffer_load_dwordx4 v[96:99], v1, s[8:11], s14 offen
    s_waitcnt vmcnt(5)
    v_mad_u32_u16 v70, v12, 8, s18
    v_mad_u32_u16 v72, v13, 8, s18
    v_mad_u32_u16 v74, v14, 8, s18
    ds_read_b64 v[70:71], v70
    ds_read_b64 v[72:73], v72
    ds_read_b64 v[74:75], v74
    s_add_u32 s14, s22, 49152
    buffer_load_dwordx4 v[100:103], v1, s[8:11], s14 offen
    s_waitcnt lgkmcnt(6)
    v_readlane_b32 s30, v7, 0
    v_readlane_b32 s31, v7, 1
    v_readlane_b32 s32, v7, 2
    v_readlane_b32 s33, v7, 3
    v_readlane_b32 s34, v7, 4
    v_readlane_b32 s35, v7, 5
    v_readlane_b32 s36, v7, 6
    v_readlane_b32 s37, v7, 7
    s_mov_b32 s25, s19
    s_mov_b32 s26, s27
    s_mov_b32 s51, s28
    s_mov_b32 s28, s29
    v_mbcnt_lo_u32_b32 v51, s30, 0
    v_mbcnt_hi_u32_b32 v51, s31, v51
    s_bcnt1_i32_b64 s14, s[30:31]
    v_lshl_add_u32 v55, v51, 1, s25
    ds_read_u16 v55, v55
    s_add_u32 s30, s26, 0
    s_lshl1_add_u32 s25, s14, s25
    s_lshl_b32 s14, s14, 10
    s_add_u32 s26, s26, s14
    v_bfe_i32 v108, v11, 2, 10
    v_bfe_i32 v109, v11, 12, 10
    v_ashrrev_i32 v110, 22, v11
    v_cvt_f32_i32 v108, v108
    v_cvt_f32_i32 v109, v109
    v_cvt_f32_i32 v110, v110
    s_waitcnt lgkmcnt(4)
    v_mfma_f32_4x4x4_16b_bf16 v[112:115], v[58:59], v[64:65], 0
    v_mfma_f32_4x4x4_16b_bf16 v[116:119], v[58:59], v[66:67], 0
    v_mfma_f32_4x4x4_16b_bf16 v[120:123], v[58:59], v[68:69], 0
    v_mad_u32_u16 v8, v8, 8, s50 op_sel:[1,0,0,0]
    v_mad_u32_u16 v9, v9, 8, s50 op_sel:[1,0,0,0]
    v_mad_u32_u16 v10, v10, 8, s50 op_sel:[1,0,0,0]
    v_pk_fma_f32 v[114:115], v[114:115], v[108:109], s[20:21] op_sel:[0,0,0] op_sel_hi:[1,0,1]
    v_pk_fma_f32 v[112:113], v[112:113], v[108:109], s[16:17] op_sel:[0,0,0] op_sel_hi:[1,0,1]
    v_pk_fma_f32 v[118:119], v[118:119], v[108:109], s[20:21] op_sel:[0,1,0] op_sel_hi:[1,1,1]
    v_pk_fma_f32 v[116:117], v[116:117], v[108:109], s[16:17] op_sel:[0,1,0] op_sel_hi:[1,1,1]
    v_pk_fma_f32 v[122:123], v[122:123], v[110:111], s[20:21] op_sel:[0,0,0] op_sel_hi:[1,0,1]
    v_pk_fma_f32 v[120:121], v[120:121], v[110:111], s[16:17] op_sel:[0,0,0] op_sel_hi:[1,0,1]
    v_lshlrev_b64 v[114:115], 16, v[114:115]
    v_lshlrev_b64 v[118:119], 16, v[118:119]
    v_lshlrev_b64 v[122:123], 16, v[122:123]
    v_lshl_add_u64 v[64:65], v[112:113], 0, v[114:115]
    v_lshl_add_u64 v[66:67], v[116:117], 0, v[118:119]
    v_lshl_add_u64 v[68:69], v[120:121], 0, v[122:123]
    v_or3_b32 v4, v44, v45, v4
    v_or3_b32 v4, v46, v47, v4
    v_or3_b32 v4, v48, v49, v4
    ds_add_rtn_u64 v[44:45], v8, v[64:65]
    ds_add_rtn_u64 v[46:47], v9, v[66:67]
    ds_add_rtn_u64 v[48:49], v10, v[68:69]
    s_waitcnt lgkmcnt(3)
    v_mad_u32_u16 v55, v55, s23, v2
    v_pk_lshrrev_b16 v55, 10, v55 op_sel_hi:[1,1]
    v_lshl_add_u32 v51, v51, 6, v55
    buffer_load_dwordx4 v[8:11], v51, s[44:47], s30 idxen
    s_add_u32 s14, s22, 65536
    buffer_load_dwordx4 v[104:107], v1, s[8:11], s14 offen
    s_waitcnt vmcnt(7)
    v_mad_u32_u16 v76, v16, 8, s18
    v_mad_u32_u16 v78, v17, 8, s18
    v_mad_u32_u16 v80, v18, 8, s18
    ds_read_b64 v[76:77], v76
    ds_read_b64 v[78:79], v78
    ds_read_b64 v[80:81], v80
    s_waitcnt vmcnt(6)
    v_mad_u32_u16 v82, v20, 8, s18
    v_mad_u32_u16 v84, v21, 8, s18
    v_mad_u32_u16 v86, v22, 8, s18
    ds_read_b64 v[82:83], v82
    ds_read_b64 v[84:85], v84
    ds_read_b64 v[86:87], v86
    s_cmp_le_u32 s51, 256
    s_cbranch_scc1 L_p2_kernel_noopt3_6
    v_mad_u32_u16 v64, v24, 8, s18
    v_mad_u32_u16 v66, v25, 8, s18
    v_mad_u32_u16 v68, v26, 8, s18
    ds_read_b64 v[64:65], v64
    ds_read_b64 v[66:67], v66
    ds_read_b64 v[68:69], v68
L_p2_kernel_noopt3_6:
    v_mbcnt_lo_u32_b32 v51, s32, 0
    v_mbcnt_hi_u32_b32 v51, s33, v51
    s_bcnt1_i32_b64 s14, s[32:33]
    v_lshl_add_u32 v55, v51, 1, s25
    ds_read_u16 v55, v55
    s_add_u32 s32, s26, 1048576
    s_lshl1_add_u32 s25, s14, s25
    s_lshl_b32 s14, s14, 10
    s_add_u32 s26, s26, s14
    v_bfe_i32 v108, v15, 2, 10
    v_bfe_i32 v109, v15, 12, 10
    v_ashrrev_i32 v110, 22, v15
    v_cvt_f32_i32 v108, v108
    v_cvt_f32_i32 v109, v109
    v_cvt_f32_i32 v110, v110
    v_mfma_f32_4x4x4_16b_bf16 v[112:115], v[58:59], v[70:71], 0
    v_mfma_f32_4x4x4_16b_bf16 v[116:119], v[58:59], v[72:73], 0
    v_mfma_f32_4x4x4_16b_bf16 v[120:123], v[58:59], v[74:75], 0
    v_mad_u32_u16 v12, v12, 8, s50 op_sel:[1,0,0,0]
    v_mad_u32_u16 v13, v13, 8, s50 op_sel:[1,0,0,0]
    v_mad_u32_u16 v14, v14, 8, s50 op_sel:[1,0,0,0]
    v_pk_fma_f32 v[114:115], v[114:115], v[108:109], s[20:21] op_sel:[0,0,0] op_sel_hi:[1,0,1]
    v_pk_fma_f32 v[112:113], v[112:113], v[108:109], s[16:17] op_sel:[0,0,0] op_sel_hi:[1,0,1]
    v_pk_fma_f32 v[118:119], v[118:119], v[108:109], s[20:21] op_sel:[0,1,0] op_sel_hi:[1,1,1]
    v_pk_fma_f32 v[116:117], v[116:117], v[108:109], s[16:17] op_sel:[0,1,0] op_sel_hi:[1,1,1]
    v_pk_fma_f32 v[122:123], v[122:123], v[110:111], s[20:21] op_sel:[0,0,0] op_sel_hi:[1,0,1]
    v_pk_fma_f32 v[120:121], v[120:121], v[110:111], s[16:17] op_sel:[0,0,0] op_sel_hi:[1,0,1]
    v_lshlrev_b64 v[114:115], 16, v[114:115]
    v_lshlrev_b64 v[118:119], 16, v[118:119]
    v_lshlrev_b64 v[122:123], 16, v[122:123]
    v_lshl_add_u64 v[70:71], v[112:113], 0, v[114:115]
    v_lshl_add_u64 v[72:73], v[116:117], 0, v[118:119]
    v_lshl_add_u64 v[74:75], v[120:121], 0, v[122:123]
    s_waitcnt lgkmcnt(7)
    v_or3_b32 v4, v44, v45, v4
    v_or3_b32 v4, v46, v47, v4
    v_or3_b32 v4, v48, v49, v4
    ds_add_rtn_u64 v[44:45], v12, v[70:71]
    ds_add_rtn_u64 v[46:47], v13, v[72:73]
    ds_add_rtn_u64 v[48:49], v14, v[74:75]
    s_waitcnt lgkmcnt(3)
    v_mad_u32_u16 v55, v55, s23, v2
    v_pk_lshrrev_b16 v55, 10, v55 op_sel_hi:[1,1]
    v_lshl_add_u32 v51, v51, 6, v55
    buffer_load_dwordx4 v[12:15], v51, s[44:47], s32 idxen
    s_barrier
    s_waitcnt vmcnt(1)
    ds_write_b128 v3, v[88:91] offset:0
    ds_write_b128 v3, v[92:95] offset:16384
    ds_write_b128 v3, v[96:99] offset:32768
    ds_write_b128 v3, v[100:103] offset:49152
    ds_write_b128 v124, v[104:107] offset:0
    v_mbcnt_lo_u32_b32 v51, s34, 0
    v_mbcnt_hi_u32_b32 v51, s35, v51
    s_bcnt1_i32_b64 s14, s[34:35]
    v_lshl_add_u32 v55, v51, 1, s25
    ds_read_u16 v55, v55
    s_add_u32 s34, s26, 2097152
    s_lshl1_add_u32 s25, s14, s25
    s_lshl_b32 s14, s14, 10
    s_add_u32 s26, s26, s14
    v_bfe_i32 v108, v19, 2, 10
    v_bfe_i32 v109, v19, 12, 10
    v_ashrrev_i32 v110, 22, v19
    v_cvt_f32_i32 v108, v108
    v_cvt_f32_i32 v109, v109
    v_cvt_f32_i32 v110, v110
    v_mfma_f32_4x4x4_16b_bf16 v[112:115], v[58:59], v[76:77], 0
    v_mfma_f32_4x4x4_16b_bf16 v[116:119], v[58:59], v[78:79], 0
    v_mfma_f32_4x4x4_16b_bf16 v[120:123], v[58:59], v[80:81], 0
    v_mad_u32_u16 v16, v16, 8, s50 op_sel:[1,0,0,0]
    v_mad_u32_u16 v17, v17, 8, s50 op_sel:[1,0,0,0]
    v_mad_u32_u16 v18, v18, 8, s50 op_sel:[1,0,0,0]
    v_pk_fma_f32 v[114:115], v[114:115], v[108:109], s[20:21] op_sel:[0,0,0] op_sel_hi:[1,0,1]
    v_pk_fma_f32 v[112:113], v[112:113], v[108:109], s[16:17] op_sel:[0,0,0] op_sel_hi:[1,0,1]
    v_pk_fma_f32 v[118:119], v[118:119], v[108:109], s[20:21] op_sel:[0,1,0] op_sel_hi:[1,1,1]
    v_pk_fma_f32 v[116:117], v[116:117], v[108:109], s[16:17] op_sel:[0,1,0] op_sel_hi:[1,1,1]
    v_pk_fma_f32 v[122:123], v[122:123], v[110:111], s[20:21] op_sel:[0,0,0] op_sel_hi:[1,0,1]
    v_pk_fma_f32 v[120:121], v[120:121], v[110:111], s[16:17] op_sel:[0,0,0] op_sel_hi:[1,0,1]
    v_lshlrev_b64 v[114:115], 16, v[114:115]
    v_lshlrev_b64 v[118:119], 16, v[118:119]
    v_lshlrev_b64 v[122:123], 16, v[122:123]
    v_lshl_add_u64 v[76:77], v[112:113], 0, v[114:115]
    v_lshl_add_u64 v[78:79], v[116:117], 0, v[118:119]
    v_lshl_add_u64 v[80:81], v[120:121], 0, v[122:123]
    s_waitcnt lgkmcnt(6)
    v_or3_b32 v4, v44, v45, v4
    v_or3_b32 v4, v46, v47, v4
    v_or3_b32 v4, v48, v49, v4
    ds_add_rtn_u64 v[44:45], v16, v[76:77]
    ds_add_rtn_u64 v[46:47], v17, v[78:79]
    ds_add_rtn_u64 v[48:49], v18, v[80:81]
    s_waitcnt lgkmcnt(3)
    v_mad_u32_u16 v55, v55, s23, v2
    v_pk_lshrrev_b16 v55, 10, v55 op_sel_hi:[1,1]
    v_lshl_add_u32 v51, v51, 6, v55
    buffer_load_dwordx4 v[16:19], v51, s[44:47], s34 idxen
    s_cmp_le_u32 s51, 256
    s_cbranch_scc1 L_p2_kernel_noopt3_7
    v_bfe_i32 v108, v27, 2, 10
    v_bfe_i32 v109, v27, 12, 10
    v_ashrrev_i32 v110, 22, v27
    v_cvt_f32_i32 v108, v108
    v_cvt_f32_i32 v109, v109
    v_cvt_f32_i32 v110, v110
    v_mfma_f32_4x4x4_16b_bf16 v[112:115], v[58:59], v[64:65], 0
    v_mfma_f32_4x4x4_16b_bf16 v[116:119], v[58:59], v[66:67], 0
    v_mfma_f32_4x4x4_16b_bf16 v[120:123], v[58:59], v[68:69], 0
    v_mad_u32_u16 v24, v24, 8, s50 op_sel:[1,0,0,0]
    v_mad_u32_u16 v25, v25, 8, s50 op_sel:[1,0,0,0]
    v_mad_u32_u16 v26, v26, 8, s50 op_sel:[1,0,0,0]
    v_pk_fma_f32 v[114:115], v[114:115], v[108:109], s[20:21] op_sel:[0,0,0] op_sel_hi:[1,0,1]
    v_pk_fma_f32 v[112:113], v[112:113], v[108:109], s[16:17] op_sel:[0,0,0] op_sel_hi:[1,0,1]
    v_pk_fma_f32 v[118:119], v[118:119], v[108:109], s[20:21] op_sel:[0,1,0] op_sel_hi:[1,1,1]
    v_pk_fma_f32 v[116:117], v[116:117], v[108:109], s[16:17] op_sel:[0,1,0] op_sel_hi:[1,1,1]
    v_pk_fma_f32 v[122:123], v[122:123], v[110:111], s[20:21] op_sel:[0,0,0] op_sel_hi:[1,0,1]
    v_pk_fma_f32 v[120:121], v[120:121], v[110:111], s[16:17] op_sel:[0,0,0] op_sel_hi:[1,0,1]
    v_lshlrev_b64 v[114:115], 16, v[114:115]
    v_lshlrev_b64 v[118:119], 16, v[118:119]
    v_lshlrev_b64 v[122:123], 16, v[122:123]
    v_lshl_add_u64 v[64:65], v[112:113], 0, v[114:115]
    v_lshl_add_u64 v[66:67], v[116:117], 0, v[118:119]
    v_lshl_add_u64 v[68:69], v[120:121], 0, v[122:123]
    s_waitcnt lgkmcnt(0)
    v_or3_b32 v4, v44, v45, v4
    v_or3_b32 v4, v46, v47, v4
    v_or3_b32 v4, v48, v49, v4
    ds_add_rtn_u64 v[44:45], v24, v[64:65]
    ds_add_rtn_u64 v[46:47], v25, v[66:67]
    ds_add_rtn_u64 v[48:49], v26, v[68:69]
L_p2_kernel_noopt3_7:
    v_mbcnt_lo_u32_b32 v51, s36, 0
    v_mbcnt_hi_u32_b32 v51, s37, v51
    s_bcnt1_i32_b64 s14, s[36:37]
    v_lshl_add_u32 v55, v51, 1, s25
    ds_read_u16 v55, v55
    s_add_u32 s36, s26, 3145728
    s_lshl1_add_u32 s25, s14, s25
    s_lshl_b32 s14, s14, 10
    s_add_u32 s26, s26, s14
    s_cmp_le_u32 s28, 256
    s_cbranch_scc1 L_p2_kernel_noopt3_8
    v_readlane_b32 s38, v7, 8
    v_readlane_b32 s39, v7, 9
    s_nop 1
    v_mbcnt_lo_u32_b32 v62, s38, 0
    v_mbcnt_hi_u32_b32 v62, s39, v62
    s_bcnt1_i32_b64 s14, s[38:39]
    v_lshl_add_u32 v63, v62, 1, s25
    ds_read_u16 v63, v63
    s_add_u32 s38, s26, 4194304
    s_lshl1_add_u32 s25, s14, s25
    s_lshl_b32 s14, s14, 10
    s_add_u32 s26, s26, s14
L_p2_kernel_noopt3_8:
    v_bfe_i32 v108, v23, 2, 10
    v_bfe_i32 v109, v23, 12, 10
    v_ashrrev_i32 v110, 22, v23
    v_cvt_f32_i32 v108, v108
    v_cvt_f32_i32 v109, v109
    v_cvt_f32_i32 v110, v110
    v_mfma_f32_4x4x4_16b_bf16 v[112:115], v[58:59], v[82:83], 0
    v_mfma_f32_4x4x4_16b_bf16 v[116:119], v[58:59], v[84:85], 0
    v_mfma_f32_4x4x4_16b_bf16 v[120:123], v[58:59], v[86:87], 0
    v_mad_u32_u16 v20, v20, 8, s50 op_sel:[1,0,0,0]
    v_mad_u32_u16 v21, v21, 8, s50 op_sel:[1,0,0,0]
    v_mad_u32_u16 v22, v22, 8, s50 op_sel:[1,0,0,0]
    v_pk_fma_f32 v[114:115], v[114:115], v[108:109], s[20:21] op_sel:[0,0,0] op_sel_hi:[1,0,1]
    v_pk_fma_f32 v[112:113], v[112:113], v[108:109], s[16:17] op_sel:[0,0,0] op_sel_hi:[1,0,1]
    v_pk_fma_f32 v[118:119], v[118:119], v[108:109], s[20:21] op_sel:[0,1,0] op_sel_hi:[1,1,1]
    v_pk_fma_f32 v[116:117], v[116:117], v[108:109], s[16:17] op_sel:[0,1,0] op_sel_hi:[1,1,1]
    v_pk_fma_f32 v[122:123], v[122:123], v[110:111], s[20:21] op_sel:[0,0,0] op_sel_hi:[1,0,1]
    v_pk_fma_f32 v[120:121], v[120:121], v[110:111], s[16:17] op_sel:[0,0,0] op_sel_hi:[1,0,1]
    v_lshlrev_b64 v[114:115], 16, v[114:115]
    v_lshlrev_b64 v[118:119], 16, v[118:119]
    v_lshlrev_b64 v[122:123], 16, v[122:123]
    v_lshl_add_u64 v[82:83], v[112:113], 0, v[114:115]
    v_lshl_add_u64 v[84:85], v[116:117], 0, v[118:119]
    v_lshl_add_u64 v[86:87], v[120:121], 0, v[122:123]
    s_waitcnt lgkmcnt(1)
    v_or3_b32 v4, v44, v45, v4
    v_or3_b32 v4, v46, v47, v4
    v_or3_b32 v4, v48, v49, v4
    ds_add_rtn_u64 v[44:45], v20, v[82:83]
    ds_add_rtn_u64 v[46:47], v21, v[84:85]
    ds_add_rtn_u64 v[48:49], v22, v[86:87]
    s_waitcnt lgkmcnt(3)
    v_mad_u32_u16 v55, v55, s23, v2
    v_pk_lshrrev_b16 v55, 10, v55 op_sel_hi:[1,1]
    v_lshl_add_u32 v51, v51, 6, v55
    buffer_load_dwordx4 v[20:23], v51, s[44:47], s36 idxen
    s_cmp_le_u32 s28, 256
    s_cbranch_scc1 L_p2_kernel_noopt3_9
    v_mad_u32_u16 v63, v63, s23, v2
    v_pk_lshrrev_b16 v63, 10, v63 op_sel_hi:[1,1]
    v_lshl_add_u32 v62, v62, 6, v63
    buffer_load_dwordx4 v[24:27], v62, s[44:47], s38 idxen
L_p2_kernel_noopt3_9:
    v_mad_u32_u16 v108, v28, v50, s40 op_sel:[1,0,0,0]
    v_mad_u32_u16 v109, v36, v50, s41 op_sel:[1,0,0,0]
    v_sub_u32_sdwa v110, v109, v108 dst_sel:DWORD dst_unused:UNUSED_PAD src0_sel:WORD_1 src1_sel:WORD_1
    s_nop 1
    v_add_u32_dpp v110, v110, v110 row_shr:1 row_mask:0xf bank_mask:0xf bound_ctrl:0
    s_nop 1
    v_add_u32_dpp v110, v110, v110 row_shr:2 row_mask:0xf bank_mask:0xf bound_ctrl:0
    s_nop 1
    v_add_u32_dpp v110, v110, v110 row_shr:4 row_mask:0xf bank_mask:0xf bound_ctrl:0
    s_nop 1
    v_add_u32_dpp v110, v110, v110 row_shr:8 row_mask:0xf bank_mask:0xf bound_ctrl:0
    s_nop 1
    v_add_u32_dpp v110, v110, v110 row_bcast:15 row_mask:0xa bank_mask:0xf
    s_nop 1
    v_add_u32_dpp v110, v110, v110 row_bcast:31 row_mask:0xc bank_mask:0xf
    v_sub_u32_sdwa v109, v109, v110 dst_sel:DWORD dst_unused:UNUSED_PAD src0_sel:WORD_1 src1_sel:DWORD
    v_readlane_b32 s29, v110, 63
    v_add_u32 v110, -1, v110
    ds_write_b16 v126, v109
    v_lshlrev_b32_e64 v111, v110, 1
    v_lshrrev_b32 v110, 5, v110
    v_lshl_add_u32 v110, v110, 2, s19
    s_cmp_gt_u32 s29, 320
    s_cselect_b32 s2, 1, s2
    s_cselect_b64 exec, 0, -1
    ds_or_b32 v110, v111 offset:160
    s_mov_b64 exec, -1
    ds_wrxchg_rtn_b32 v7, v6, v5 offset:160
    s_add_u32 s14, s22, 80000
    buffer_load_dwordx4 v[88:91], v1, s[8:11], s14 offen
    s_add_u32 s14, s22, 96384
    buffer_load_dwordx4 v[92:95], v1, s[8:11], s14 offen
    s_add_u32 s24, s24, 1
    s_cmp_lt_u32 s24, 8
    s_barrier
    s_cbranch_scc1 L_p2_loop
    s_waitcnt lgkmcnt(3)
    v_or3_b32 v4, v44, v45, v4
    v_or3_b32 v4, v46, v47, v4
    v_or3_b32 v4, v48, v49, v4
    s_mov_b32 s27, s19
    s_waitcnt vmcnt(0)
    v_mov_b32 v8, 160232
    s_cmp_lg_u32 s13, 0
    s_cselect_b64 exec, 0, 1
    ds_write_b32 v8, v52
    s_mov_b64 exec, -1
    v_subrev_u32 v6, 80000, v124
    s_mul_i32 s24, s12, 20000
    v_subrev_u32 v10, s24, v1
    v_mov_b32 v11, 0x7f000000
    s_waitcnt vmcnt(0) lgkmcnt(0)
    s_barrier
    s_cmp_lt_u32 s13, 12
    s_cbranch_scc1 L_p2_ga
L_p2_ga:
    ds_read_b32 v9, v8
    ds_read_b128 v[88:91], v1 offset:0
    ds_read_b128 v[92:95], v1 offset:16384
    ds_read_b128 v[96:99], v1 offset:32768
    ds_read_b128 v[100:103], v1 offset:49152
    ds_read_b128 v[104:107], v6
    s_mul_i32 s14, s12, 5120000
    s_mul_i32 s15, s3, 80000
    s_add_u32 s25, s14, s15
    s_add_u32 s25, s25, 228589568
    s_waitcnt lgkmcnt(5)
    v_readfirstlane_b32 s21, v9
    s_nop 0
    s_bfe_u32 s21, s21, 524296
    s_cmp_lg_u32 s21, 4
    s_cselect_b32 s21, 1, 0
    s_cselect_b32 s24, 0, 20000
    v_cmp_le_u32 vcc, s24, v10
    v_add_u32 v10, 16384, v10
    s_add_u32 s14, s25, 0
    v_cndmask_b32 v12, v11, v1, vcc
    s_waitcnt lgkmcnt(4)
    buffer_store_dwordx4 v[88:91], v12, s[4:7], s14 offen sc1
    v_or3_b32 v4, v88, v89, v4
    v_or3_b32 v4, v90, v91, v4
    v_cmp_le_u32 vcc, s24, v10
    v_add_u32 v10, 16384, v10
    s_add_u32 s14, s25, 16384
    v_cndmask_b32 v12, v11, v1, vcc
    s_waitcnt lgkmcnt(3)
    buffer_store_dwordx4 v[92:95], v12, s[4:7], s14 offen sc1
    v_or3_b32 v4, v92, v93, v4
    v_or3_b32 v4, v94, v95, v4
    v_cmp_le_u32 vcc, s24, v10
    v_add_u32 v10, 16384, v10
    s_add_u32 s14, s25, 32768
    v_cndmask_b32 v12, v11, v1, vcc
    s_waitcnt lgkmcnt(2)
    buffer_store_dwordx4 v[96:99], v12, s[4:7], s14 offen sc1
    v_or3_b32 v4, v96, v97, v4
    v_or3_b32 v4, v98, v99, v4
    v_cmp_le_u32 vcc, s24, v10
    v_add_u32 v10, 16384, v10
    s_add_u32 s14, s25, 49152
    v_cndmask_b32 v12, v11, v1, vcc
    s_waitcnt lgkmcnt(1)
    buffer_store_dwordx4 v[100:103], v12, s[4:7], s14 offen sc1
    v_or3_b32 v4, v100, v101, v4
    v_or3_b32 v4, v102, v103, v4
    v_cmp_le_u32 vcc, s24, v10
    v_add_u32 v10, 16384, v10
    s_add_u32 s14, s25, 0
    v_cndmask_b32 v12, v11, v6, vcc
    s_waitcnt lgkmcnt(0)
    buffer_store_dwordx4 v[104:107], v12, s[4:7], s14 offen sc1
    v_or3_b32 v4, v104, v105, v4
    v_or3_b32 v4, v106, v107, v4
    s_load_dwordx2 s[16:17], s[0:1], 88
    s_cmp_ge_u32 s13, 12
    s_cbranch_scc1 L_p2_gb
    v_lshlrev_b32 v30, 16, v60
    v_and_b32 v31, 0xffff0000, v60
    v_lshlrev_b32 v36, 16, v53
    v_and_b32 v37, 0xffff0000, v53
    v_lshlrev_b32 v38, 16, v54
    v_and_b32 v39, 0xffff0000, v54
    v_lshlrev_b32 v40, 16, v56
    v_and_b32 v41, 0xffff0000, v56
    v_lshlrev_b32 v42, 16, v57
    v_and_b32 v43, 0xffff0000, v57
    v_pk_add_f32 v[14:15], v[30:31], v[36:37] op_sel:[0,0] op_sel_hi:[1,0] neg_lo:[0,1] neg_hi:[0,1]
    v_pk_add_f32 v[16:17], v[30:31], v[36:37] op_sel:[0,1] op_sel_hi:[1,1] neg_lo:[0,1] neg_hi:[0,1]
    v_pk_add_f32 v[18:19], v[30:31], v[38:39] op_sel:[0,0] op_sel_hi:[1,0] neg_lo:[0,1] neg_hi:[0,1]
    v_pk_add_f32 v[20:21], v[30:31], v[38:39] op_sel:[0,1] op_sel_hi:[1,1] neg_lo:[0,1] neg_hi:[0,1]
    v_pk_add_f32 v[22:23], v[30:31], v[40:41] op_sel:[0,0] op_sel_hi:[1,0] neg_lo:[0,1] neg_hi:[0,1]
    v_pk_add_f32 v[24:25], v[30:31], v[40:41] op_sel:[0,1] op_sel_hi:[1,1] neg_lo:[0,1] neg_hi:[0,1]
    v_pk_add_f32 v[26:27], v[30:31], v[42:43] op_sel:[0,0] op_sel_hi:[1,0] neg_lo:[0,1] neg_hi:[0,1]
    v_pk_add_f32 v[28:29], v[30:31], v[42:43] op_sel:[0,1] op_sel_hi:[1,1] neg_lo:[0,1] neg_hi:[0,1]
    v_cvt_pk_bf16_f32 v32, v14, v15
    v_lshlrev_b32 v14, 16, v32
    v_and_b32 v15, 0xffff0000, v32
    v_cvt_pk_bf16_f32 v32, v16, v17
    v_lshlrev_b32 v16, 16, v32
    v_and_b32 v17, 0xffff0000, v32
    v_cvt_pk_bf16_f32 v32, v18, v19
    v_lshlrev_b32 v18, 16, v32
    v_and_b32 v19, 0xffff0000, v32
    v_cvt_pk_bf16_f32 v32, v20, v21
    v_lshlrev_b32 v20, 16, v32
    v_and_b32 v21, 0xffff0000, v32
    v_cvt_pk_bf16_f32 v32, v22, v23
    v_lshlrev_b32 v22, 16, v32
    v_and_b32 v23, 0xffff0000, v32
    v_cvt_pk_bf16_f32 v32, v24, v25
    v_lshlrev_b32 v24, 16, v32
    v_and_b32 v25, 0xffff0000, v32
    v_cvt_pk_bf16_f32 v32, v26, v27
    v_lshlrev_b32 v26, 16, v32
    v_and_b32 v27, 0xffff0000, v32
    v_cvt_pk_bf16_f32 v32, v28, v29
    v_lshlrev_b32 v28, 16, v32
    v_and_b32 v29, 0xffff0000, v32
    v_pk_mul_f32 v[14:15], v[14:15], v[14:15]
    v_pk_mul_f32 v[16:17], v[16:17], v[16:17]
    v_pk_mul_f32 v[18:19], v[18:19], v[18:19]
    v_pk_mul_f32 v[20:21], v[20:21], v[20:21]
    v_pk_mul_f32 v[22:23], v[22:23], v[22:23]
    v_pk_mul_f32 v[24:25], v[24:25], v[24:25]
    v_pk_mul_f32 v[26:27], v[26:27], v[26:27]
    v_pk_mul_f32 v[28:29], v[28:29], v[28:29]
    v_cvt_pk_bf16_f32 v32, v14, v15
    v_lshlrev_b32 v14, 16, v32
    v_and_b32 v15, 0xffff0000, v32
    v_cvt_pk_bf16_f32 v32, v16, v17
    v_lshlrev_b32 v16, 16, v32
    v_and_b32 v17, 0xffff0000, v32
    v_cvt_pk_bf16_f32 v32, v18, v19
    v_lshlrev_b32 v18, 16, v32
    v_and_b32 v19, 0xffff0000, v32
    v_cvt_pk_bf16_f32 v32, v20, v21
    v_lshlrev_b32 v20, 16, v32
    v_and_b32 v21, 0xffff0000, v32
    v_cvt_pk_bf16_f32 v32, v22, v23
    v_lshlrev_b32 v22, 16, v32
    v_and_b32 v23, 0xffff0000, v32
    v_cvt_pk_bf16_f32 v32, v24, v25
    v_lshlrev_b32 v24, 16, v32
    v_and_b32 v25, 0xffff0000, v32
    v_cvt_pk_bf16_f32 v32, v26, v27
    v_lshlrev_b32 v26, 16, v32
    v_and_b32 v27, 0xffff0000, v32
    v_cvt_pk_bf16_f32 v32, v28, v29
    v_lshlrev_b32 v28, 16, v32
    v_and_b32 v29, 0xffff0000, v32
    v_mov_b32 v30, 1092616192
    v_mov_b32 v31, 0x3fb8aa3b
    v_pk_mul_f32 v[14:15], v[14:15], v[30:31] op_sel:[0,0] op_sel_hi:[1,0]
    v_pk_mul_f32 v[16:17], v[16:17], v[30:31] op_sel:[0,0] op_sel_hi:[1,0]
    v_pk_mul_f32 v[18:19], v[18:19], v[30:31] op_sel:[0,0] op_sel_hi:[1,0]
    v_pk_mul_f32 v[20:21], v[20:21], v[30:31] op_sel:[0,0] op_sel_hi:[1,0]
    v_pk_mul_f32 v[22:23], v[22:23], v[30:31] op_sel:[0,0] op_sel_hi:[1,0]
    v_pk_mul_f32 v[24:25], v[24:25], v[30:31] op_sel:[0,0] op_sel_hi:[1,0]
    v_pk_mul_f32 v[26:27], v[26:27], v[30:31] op_sel:[0,0] op_sel_hi:[1,0]
    v_pk_mul_f32 v[28:29], v[28:29], v[30:31] op_sel:[0,0] op_sel_hi:[1,0]
    v_cvt_pk_bf16_f32 v32, v14, v15
    v_lshlrev_b32 v14, 16, v32
    v_and_b32 v15, 0xffff0000, v32
    v_cvt_pk_bf16_f32 v32, v16, v17
    v_lshlrev_b32 v16, 16, v32
    v_and_b32 v17, 0xffff0000, v32
    v_cvt_pk_bf16_f32 v32, v18, v19
    v_lshlrev_b32 v18, 16, v32
    v_and_b32 v19, 0xffff0000, v32
    v_cvt_pk_bf16_f32 v32, v20, v21
    v_lshlrev_b32 v20, 16, v32
    v_and_b32 v21, 0xffff0000, v32
    v_cvt_pk_bf16_f32 v32, v22, v23
    v_lshlrev_b32 v22, 16, v32
    v_and_b32 v23, 0xffff0000, v32
    v_cvt_pk_bf16_f32 v32, v24, v25
    v_lshlrev_b32 v24, 16, v32
    v_and_b32 v25, 0xffff0000, v32
    v_cvt_pk_bf16_f32 v32, v26, v27
    v_lshlrev_b32 v26, 16, v32
    v_and_b32 v27, 0xffff0000, v32
    v_cvt_pk_bf16_f32 v32, v28, v29
    v_lshlrev_b32 v28, 16, v32
    v_and_b32 v29, 0xffff0000, v32
    v_pk_mul_f32 v[14:15], v[14:15], v[30:31] op_sel:[0,1] op_sel_hi:[1,1]
    v_pk_mul_f32 v[16:17], v[16:17], v[30:31] op_sel:[0,1] op_sel_hi:[1,1]
    v_pk_mul_f32 v[18:19], v[18:19], v[30:31] op_sel:[0,1] op_sel_hi:[1,1]
    v_pk_mul_f32 v[20:21], v[20:21], v[30:31] op_sel:[0,1] op_sel_hi:[1,1]
    v_pk_mul_f32 v[22:23], v[22:23], v[30:31] op_sel:[0,1] op_sel_hi:[1,1]
    v_pk_mul_f32 v[24:25], v[24:25], v[30:31] op_sel:[0,1] op_sel_hi:[1,1]
    v_pk_mul_f32 v[26:27], v[26:27], v[30:31] op_sel:[0,1] op_sel_hi:[1,1]
    v_pk_mul_f32 v[28:29], v[28:29], v[30:31] op_sel:[0,1] op_sel_hi:[1,1]
    v_exp_f32 v14, -v14
    v_exp_f32 v15, -v15
    v_exp_f32 v16, -v16
    v_exp_f32 v17, -v17
    v_exp_f32 v18, -v18
    v_exp_f32 v19, -v19
    v_exp_f32 v20, -v20
    v_exp_f32 v21, -v21
    v_exp_f32 v22, -v22
    v_exp_f32 v23, -v23
    v_exp_f32 v24, -v24
    v_exp_f32 v25, -v25
    v_exp_f32 v26, -v26
    v_exp_f32 v27, -v27
    v_exp_f32 v28, -v28
    v_exp_f32 v29, -v29
    v_cvt_pk_bf16_f32 v14, v14, v16
    v_cvt_pk_bf16_f32 v15, v15, v17
    v_cvt_pk_bf16_f32 v18, v18, v20
    v_cvt_pk_bf16_f32 v19, v19, v21
    v_cvt_pk_bf16_f32 v22, v22, v24
    v_cvt_pk_bf16_f32 v23, v23, v25
    v_cvt_pk_bf16_f32 v26, v26, v28
    v_cvt_pk_bf16_f32 v27, v27, v29
    v_dot2_f32_bf16 v72, v14, s68, 0
    v_dot2_f32_bf16 v73, v15, s68, 0
    v_dot2_f32_bf16 v74, v14, s69, 0
    v_dot2_f32_bf16 v75, v15, s69, 0
    v_dot2_f32_bf16 v76, v14, s70, 0
    v_dot2_f32_bf16 v77, v15, s70, 0
    v_dot2_f32_bf16 v78, v14, s71, 0
    v_dot2_f32_bf16 v79, v15, s71, 0
    v_dot2_f32_bf16 v80, v14, s52, 0
    v_dot2_f32_bf16 v81, v15, s52, 0
    v_dot2_f32_bf16 v82, v14, s53, 0
    v_dot2_f32_bf16 v83, v15, s53, 0
    v_dot2_f32_bf16 v84, v14, s54, 0
    v_dot2_f32_bf16 v85, v15, s54, 0
    v_dot2_f32_bf16 v86, v14, s55, 0
    v_dot2_f32_bf16 v87, v15, s55, 0
    v_dot2_f32_bf16 v72, v18, s72, v72
    v_dot2_f32_bf16 v73, v19, s72, v73
    v_dot2_f32_bf16 v74, v18, s73, v74
    v_dot2_f32_bf16 v75, v19, s73, v75
    v_dot2_f32_bf16 v76, v18, s74, v76
    v_dot2_f32_bf16 v77, v19, s74, v77
    v_dot2_f32_bf16 v78, v18, s75, v78
    v_dot2_f32_bf16 v79, v19, s75, v79
    v_dot2_f32_bf16 v80, v18, s56, v80
    v_dot2_f32_bf16 v81, v19, s56, v81
    v_dot2_f32_bf16 v82, v18, s57, v82
    v_dot2_f32_bf16 v83, v19, s57, v83
    v_dot2_f32_bf16 v84, v18, s58, v84
    v_dot2_f32_bf16 v85, v19, s58, v85
    v_dot2_f32_bf16 v86, v18, s59, v86
    v_dot2_f32_bf16 v87, v19, s59, v87
    v_dot2_f32_bf16 v72, v22, s76, v72
    v_dot2_f32_bf16 v73, v23, s76, v73
    v_dot2_f32_bf16 v74, v22, s77, v74
    v_dot2_f32_bf16 v75, v23, s77, v75
    v_dot2_f32_bf16 v76, v22, s78, v76
    v_dot2_f32_bf16 v77, v23, s78, v77
    v_dot2_f32_bf16 v78, v22, s79, v78
    v_dot2_f32_bf16 v79, v23, s79, v79
    v_dot2_f32_bf16 v80, v22, s60, v80
    v_dot2_f32_bf16 v81, v23, s60, v81
    v_dot2_f32_bf16 v82, v22, s61, v82
    v_dot2_f32_bf16 v83, v23, s61, v83
    v_dot2_f32_bf16 v84, v22, s62, v84
    v_dot2_f32_bf16 v85, v23, s62, v85
    v_dot2_f32_bf16 v86, v22, s63, v86
    v_dot2_f32_bf16 v87, v23, s63, v87
    v_dot2_f32_bf16 v72, v26, s80, v72
    v_dot2_f32_bf16 v73, v27, s80, v73
    v_dot2_f32_bf16 v74, v26, s81, v74
    v_dot2_f32_bf16 v75, v27, s81, v75
    v_dot2_f32_bf16 v76, v26, s82, v76
    v_dot2_f32_bf16 v77, v27, s82, v77
    v_dot2_f32_bf16 v78, v26, s83, v78
    v_dot2_f32_bf16 v79, v27, s83, v79
    v_dot2_f32_bf16 v80, v26, s64, v80
    v_dot2_f32_bf16 v81, v27, s64, v81
    v_dot2_f32_bf16 v82, v26, s65, v82
    v_dot2_f32_bf16 v83, v27, s65, v83
    v_dot2_f32_bf16 v84, v26, s66, v84
    v_dot2_f32_bf16 v85, v27, s66, v85
    v_dot2_f32_bf16 v86, v26, s67, v86
    v_dot2_f32_bf16 v87, v27, s67, v87
L_p2_gb:
    v_and_b32 v4, 0x80008000, v4
    v_cmp_ne_u32 vcc, 0, v4
    v_mov_b32 v8, s27
    v_and_b32 v10, 15, v0
    v_mul_u32_u24 v10, 240, v10
    v_add_u32 v10, 160000, v10
    s_cmp_lg_u64 vcc, 0
    s_cselect_b32 s2, 1, s2
    v_mov_b32 v9, s2
    s_mov_b64 exec, 1
    ds_write_b32 v8, v9
    s_mov_b64 exec, -1
    v_add_u32 v2, 16384, v1
    v_mov_b32 v9, 0x3f000000
    v_cmp_gt_u32 vcc, 226, v0
    s_mov_b32 s49, s12
    s_mov_b32 s51, 0
    v_cndmask_b32 v2, v9, v2, vcc
    s_waitcnt vmcnt(0) lgkmcnt(0)
    s_barrier
    ds_read_b32 v9, v10
    s_mov_b32 s18, 5120000
    s_mov_b32 s19, 0x00020000
    s_waitcnt lgkmcnt(0)
    v_cmp_ne_u32 vcc, 0, v9
    s_nop 1
    s_cmp_lg_u64 vcc, 0
    s_cselect_b32 s2, 1, 0
    s_cbranch_scc1 L_p2_slow
L_p2_signal:
    v_mov_b32 v8, 160228
    s_lshl_b32 s15, s2, 4
    s_or_b32 s15, s15, s21
    s_add_u32 s14, s12, 16
    s_lshl_b32 s20, s15, s14
    s_add_u32 s20, s20, 1
    v_mov_b32 v9, s20
    s_cmp_lg_u32 s13, 15
    s_cbranch_scc1 L_p2_nosig0
    s_lshl_b32 s14, s3, 8
    s_add_u32 s14, s14, 8523776
    s_mov_b64 exec, 1
    buffer_atomic_add v9, off, s[4:7], s14 sc0
    s_mov_b64 exec, -1
L_p2_nosig0:
    s_lshl2_add_u32 s14, s3, s49
    s_mul_i32 s26, s14, 20000
    s_mov_b32 s10, 5120000
    buffer_load_dwordx4 v[64:67], v1, s[8:11], s26 offen
    buffer_load_dwordx4 v[68:71], v2, s[8:11], s26 offen
    s_lshl_b32 s28, s92, 16
    s_and_b32 s29, s92, 0xffff0000
    s_lshl_b32 s30, s93, 16
    s_and_b32 s31, s93, 0xffff0000
    s_lshl_b32 s32, s94, 16
    s_and_b32 s33, s94, 0xffff0000
    s_lshl_b32 s34, s95, 16
    s_and_b32 s35, s95, 0xffff0000
    s_lshl_b32 s36, s96, 16
    s_and_b32 s37, s96, 0xffff0000
    s_lshl_b32 s38, s97, 16
    s_and_b32 s39, s97, 0xffff0000
    s_lshl_b32 s40, s98, 16
    s_and_b32 s41, s98, 0xffff0000
    s_lshl_b32 s42, s99, 16
    s_and_b32 s43, s99, 0xffff0000
    s_and_b32 s99, s91, 0xffff0000
    s_lshl_b32 s98, s91, 16
    s_and_b32 s97, s90, 0xffff0000
    s_lshl_b32 s96, s90, 16
    s_and_b32 s95, s89, 0xffff0000
    s_lshl_b32 s94, s89, 16
    s_and_b32 s93, s88, 0xffff0000
    s_lshl_b32 s92, s88, 16
    s_and_b32 s91, s87, 0xffff0000
    s_lshl_b32 s90, s87, 16
    s_and_b32 s89, s86, 0xffff0000
    s_lshl_b32 s88, s86, 16
    s_and_b32 s87, s85, 0xffff0000
    s_lshl_b32 s86, s85, 16
    s_and_b32 s85, s84, 0xffff0000
    s_lshl_b32 s84, s84, 16
    s_mov_b32 s44, s48
    s_add_u32 s45, s48, 2281701376
    s_cmp_eq_u32 s48, 0
    s_cselect_b32 s45, 0, s45
    s_cmp_lt_u32 s13, 12
    s_cbranch_scc1 L_p2_gc
    v_lshlrev_b32 v30, 16, v60
    v_and_b32 v31, 0xffff0000, v60
    v_lshlrev_b32 v36, 16, v53
    v_and_b32 v37, 0xffff0000, v53
    v_lshlrev_b32 v38, 16, v54
    v_and_b32 v39, 0xffff0000, v54
    v_lshlrev_b32 v40, 16, v56
    v_and_b32 v41, 0xffff0000, v56
    v_lshlrev_b32 v42, 16, v57
    v_and_b32 v43, 0xffff0000, v57
    v_pk_add_f32 v[14:15], v[30:31], v[36:37] op_sel:[0,0] op_sel_hi:[1,0] neg_lo:[0,1] neg_hi:[0,1]
    v_pk_add_f32 v[16:17], v[30:31], v[36:37] op_sel:[0,1] op_sel_hi:[1,1] neg_lo:[0,1] neg_hi:[0,1]
    v_pk_add_f32 v[18:19], v[30:31], v[38:39] op_sel:[0,0] op_sel_hi:[1,0] neg_lo:[0,1] neg_hi:[0,1]
    v_pk_add_f32 v[20:21], v[30:31], v[38:39] op_sel:[0,1] op_sel_hi:[1,1] neg_lo:[0,1] neg_hi:[0,1]
    v_pk_add_f32 v[22:23], v[30:31], v[40:41] op_sel:[0,0] op_sel_hi:[1,0] neg_lo:[0,1] neg_hi:[0,1]
    v_pk_add_f32 v[24:25], v[30:31], v[40:41] op_sel:[0,1] op_sel_hi:[1,1] neg_lo:[0,1] neg_hi:[0,1]
    v_pk_add_f32 v[26:27], v[30:31], v[42:43] op_sel:[0,0] op_sel_hi:[1,0] neg_lo:[0,1] neg_hi:[0,1]
    v_pk_add_f32 v[28:29], v[30:31], v[42:43] op_sel:[0,1] op_sel_hi:[1,1] neg_lo:[0,1] neg_hi:[0,1]
    v_cvt_pk_bf16_f32 v32, v14, v15
    v_lshlrev_b32 v14, 16, v32
    v_and_b32 v15, 0xffff0000, v32
    v_cvt_pk_bf16_f32 v32, v16, v17
    v_lshlrev_b32 v16, 16, v32
    v_and_b32 v17, 0xffff0000, v32
    v_cvt_pk_bf16_f32 v32, v18, v19
    v_lshlrev_b32 v18, 16, v32
    v_and_b32 v19, 0xffff0000, v32
    v_cvt_pk_bf16_f32 v32, v20, v21
    v_lshlrev_b32 v20, 16, v32
    v_and_b32 v21, 0xffff0000, v32
    v_cvt_pk_bf16_f32 v32, v22, v23
    v_lshlrev_b32 v22, 16, v32
    v_and_b32 v23, 0xffff0000, v32
    v_cvt_pk_bf16_f32 v32, v24, v25
    v_lshlrev_b32 v24, 16, v32
    v_and_b32 v25, 0xffff0000, v32
    v_cvt_pk_bf16_f32 v32, v26, v27
    v_lshlrev_b32 v26, 16, v32
    v_and_b32 v27, 0xffff0000, v32
    v_cvt_pk_bf16_f32 v32, v28, v29
    v_lshlrev_b32 v28, 16, v32
    v_and_b32 v29, 0xffff0000, v32
    v_pk_mul_f32 v[14:15], v[14:15], v[14:15]
    v_pk_mul_f32 v[16:17], v[16:17], v[16:17]
    v_pk_mul_f32 v[18:19], v[18:19], v[18:19]
    v_pk_mul_f32 v[20:21], v[20:21], v[20:21]
    v_pk_mul_f32 v[22:23], v[22:23], v[22:23]
    v_pk_mul_f32 v[24:25], v[24:25], v[24:25]
    v_pk_mul_f32 v[26:27], v[26:27], v[26:27]
    v_pk_mul_f32 v[28:29], v[28:29], v[28:29]
    v_cvt_pk_bf16_f32 v32, v14, v15
    v_lshlrev_b32 v14, 16, v32
    v_and_b32 v15, 0xffff0000, v32
    v_cvt_pk_bf16_f32 v32, v16, v17
    v_lshlrev_b32 v16, 16, v32
    v_and_b32 v17, 0xffff0000, v32
    v_cvt_pk_bf16_f32 v32, v18, v19
    v_lshlrev_b32 v18, 16, v32
    v_and_b32 v19, 0xffff0000, v32
    v_cvt_pk_bf16_f32 v32, v20, v21
    v_lshlrev_b32 v20, 16, v32
    v_and_b32 v21, 0xffff0000, v32
    v_cvt_pk_bf16_f32 v32, v22, v23
    v_lshlrev_b32 v22, 16, v32
    v_and_b32 v23, 0xffff0000, v32
    v_cvt_pk_bf16_f32 v32, v24, v25
    v_lshlrev_b32 v24, 16, v32
    v_and_b32 v25, 0xffff0000, v32
    v_cvt_pk_bf16_f32 v32, v26, v27
    v_lshlrev_b32 v26, 16, v32
    v_and_b32 v27, 0xffff0000, v32
    v_cvt_pk_bf16_f32 v32, v28, v29
    v_lshlrev_b32 v28, 16, v32
    v_and_b32 v29, 0xffff0000, v32
    v_mov_b32 v30, 1092616192
    v_mov_b32 v31, 0x3fb8aa3b
    v_pk_mul_f32 v[14:15], v[14:15], v[30:31] op_sel:[0,0] op_sel_hi:[1,0]
    v_pk_mul_f32 v[16:17], v[16:17], v[30:31] op_sel:[0,0] op_sel_hi:[1,0]
    v_pk_mul_f32 v[18:19], v[18:19], v[30:31] op_sel:[0,0] op_sel_hi:[1,0]
    v_pk_mul_f32 v[20:21], v[20:21], v[30:31] op_sel:[0,0] op_sel_hi:[1,0]
    v_pk_mul_f32 v[22:23], v[22:23], v[30:31] op_sel:[0,0] op_sel_hi:[1,0]
    v_pk_mul_f32 v[24:25], v[24:25], v[30:31] op_sel:[0,0] op_sel_hi:[1,0]
    v_pk_mul_f32 v[26:27], v[26:27], v[30:31] op_sel:[0,0] op_sel_hi:[1,0]
    v_pk_mul_f32 v[28:29], v[28:29], v[30:31] op_sel:[0,0] op_sel_hi:[1,0]
    v_cvt_pk_bf16_f32 v32, v14, v15
    v_lshlrev_b32 v14, 16, v32
    v_and_b32 v15, 0xffff0000, v32
    v_cvt_pk_bf16_f32 v32, v16, v17
    v_lshlrev_b32 v16, 16, v32
    v_and_b32 v17, 0xffff0000, v32
    v_cvt_pk_bf16_f32 v32, v18, v19
    v_lshlrev_b32 v18, 16, v32
    v_and_b32 v19, 0xffff0000, v32
    v_cvt_pk_bf16_f32 v32, v20, v21
    v_lshlrev_b32 v20, 16, v32
    v_and_b32 v21, 0xffff0000, v32
    v_cvt_pk_bf16_f32 v32, v22, v23
    v_lshlrev_b32 v22, 16, v32
    v_and_b32 v23, 0xffff0000, v32
    v_cvt_pk_bf16_f32 v32, v24, v25
    v_lshlrev_b32 v24, 16, v32
    v_and_b32 v25, 0xffff0000, v32
    v_cvt_pk_bf16_f32 v32, v26, v27
    v_lshlrev_b32 v26, 16, v32
    v_and_b32 v27, 0xffff0000, v32
    v_cvt_pk_bf16_f32 v32, v28, v29
    v_lshlrev_b32 v28, 16, v32
    v_and_b32 v29, 0xffff0000, v32
    v_pk_mul_f32 v[14:15], v[14:15], v[30:31] op_sel:[0,1] op_sel_hi:[1,1]
    v_pk_mul_f32 v[16:17], v[16:17], v[30:31] op_sel:[0,1] op_sel_hi:[1,1]
    v_pk_mul_f32 v[18:19], v[18:19], v[30:31] op_sel:[0,1] op_sel_hi:[1,1]
    v_pk_mul_f32 v[20:21], v[20:21], v[30:31] op_sel:[0,1] op_sel_hi:[1,1]
    v_pk_mul_f32 v[22:23], v[22:23], v[30:31] op_sel:[0,1] op_sel_hi:[1,1]
    v_pk_mul_f32 v[24:25], v[24:25], v[30:31] op_sel:[0,1] op_sel_hi:[1,1]
    v_pk_mul_f32 v[26:27], v[26:27], v[30:31] op_sel:[0,1] op_sel_hi:[1,1]
    v_pk_mul_f32 v[28:29], v[28:29], v[30:31] op_sel:[0,1] op_sel_hi:[1,1]
    v_exp_f32 v14, -v14
    v_exp_f32 v15, -v15
    v_exp_f32 v16, -v16
    v_exp_f32 v17, -v17
    v_exp_f32 v18, -v18
    v_exp_f32 v19, -v19
    v_exp_f32 v20, -v20
    v_exp_f32 v21, -v21
    v_exp_f32 v22, -v22
    v_exp_f32 v23, -v23
    v_exp_f32 v24, -v24
    v_exp_f32 v25, -v25
    v_exp_f32 v26, -v26
    v_exp_f32 v27, -v27
    v_exp_f32 v28, -v28
    v_exp_f32 v29, -v29
    v_cvt_pk_bf16_f32 v14, v14, v16
    v_cvt_pk_bf16_f32 v15, v15, v17
    v_cvt_pk_bf16_f32 v18, v18, v20
    v_cvt_pk_bf16_f32 v19, v19, v21
    v_cvt_pk_bf16_f32 v22, v22, v24
    v_cvt_pk_bf16_f32 v23, v23, v25
    v_cvt_pk_bf16_f32 v26, v26, v28
    v_cvt_pk_bf16_f32 v27, v27, v29
    v_dot2_f32_bf16 v72, v14, s68, 0
    v_dot2_f32_bf16 v73, v15, s68, 0
    v_dot2_f32_bf16 v74, v14, s69, 0
    v_dot2_f32_bf16 v75, v15, s69, 0
    v_dot2_f32_bf16 v76, v14, s70, 0
    v_dot2_f32_bf16 v77, v15, s70, 0
    v_dot2_f32_bf16 v78, v14, s71, 0
    v_dot2_f32_bf16 v79, v15, s71, 0
    v_dot2_f32_bf16 v80, v14, s52, 0
    v_dot2_f32_bf16 v81, v15, s52, 0
    v_dot2_f32_bf16 v82, v14, s53, 0
    v_dot2_f32_bf16 v83, v15, s53, 0
    v_dot2_f32_bf16 v84, v14, s54, 0
    v_dot2_f32_bf16 v85, v15, s54, 0
    v_dot2_f32_bf16 v86, v14, s55, 0
    v_dot2_f32_bf16 v87, v15, s55, 0
    v_dot2_f32_bf16 v72, v18, s72, v72
    v_dot2_f32_bf16 v73, v19, s72, v73
    v_dot2_f32_bf16 v74, v18, s73, v74
    v_dot2_f32_bf16 v75, v19, s73, v75
    v_dot2_f32_bf16 v76, v18, s74, v76
    v_dot2_f32_bf16 v77, v19, s74, v77
    v_dot2_f32_bf16 v78, v18, s75, v78
    v_dot2_f32_bf16 v79, v19, s75, v79
    v_dot2_f32_bf16 v80, v18, s56, v80
    v_dot2_f32_bf16 v81, v19, s56, v81
    v_dot2_f32_bf16 v82, v18, s57, v82
    v_dot2_f32_bf16 v83, v19, s57, v83
    v_dot2_f32_bf16 v84, v18, s58, v84
    v_dot2_f32_bf16 v85, v19, s58, v85
    v_dot2_f32_bf16 v86, v18, s59, v86
    v_dot2_f32_bf16 v87, v19, s59, v87
    v_dot2_f32_bf16 v72, v22, s76, v72
    v_dot2_f32_bf16 v73, v23, s76, v73
    v_dot2_f32_bf16 v74, v22, s77, v74
    v_dot2_f32_bf16 v75, v23, s77, v75
    v_dot2_f32_bf16 v76, v22, s78, v76
    v_dot2_f32_bf16 v77, v23, s78, v77
    v_dot2_f32_bf16 v78, v22, s79, v78
    v_dot2_f32_bf16 v79, v23, s79, v79
    v_dot2_f32_bf16 v80, v22, s60, v80
    v_dot2_f32_bf16 v81, v23, s60, v81
    v_dot2_f32_bf16 v82, v22, s61, v82
    v_dot2_f32_bf16 v83, v23, s61, v83
    v_dot2_f32_bf16 v84, v22, s62, v84
    v_dot2_f32_bf16 v85, v23, s62, v85
    v_dot2_f32_bf16 v86, v22, s63, v86
    v_dot2_f32_bf16 v87, v23, s63, v87
    v_dot2_f32_bf16 v72, v26, s80, v72
    v_dot2_f32_bf16 v73, v27, s80, v73
    v_dot2_f32_bf16 v74, v26, s81, v74
    v_dot2_f32_bf16 v75, v27, s81, v75
    v_dot2_f32_bf16 v76, v26, s82, v76
    v_dot2_f32_bf16 v77, v27, s82, v77
    v_dot2_f32_bf16 v78, v26, s83, v78
    v_dot2_f32_bf16 v79, v27, s83, v79
    v_dot2_f32_bf16 v80, v26, s64, v80
    v_dot2_f32_bf16 v81, v27, s64, v81
    v_dot2_f32_bf16 v82, v26, s65, v82
    v_dot2_f32_bf16 v83, v27, s65, v83
    v_dot2_f32_bf16 v84, v26, s66, v84
    v_dot2_f32_bf16 v85, v27, s66, v85
    v_dot2_f32_bf16 v86, v26, s67, v86
    v_dot2_f32_bf16 v87, v27, s67, v87
L_p2_gc:
    s_cmp_ge_u32 s13, 4
    s_cbranch_scc1 L_p2_gd
    v_lshlrev_b32 v30, 16, v61
    v_and_b32 v31, 0xffff0000, v61
    v_pk_add_f32 v[14:15], v[30:31], v[36:37] op_sel:[0,0] op_sel_hi:[1,0] neg_lo:[0,1] neg_hi:[0,1]
    v_pk_add_f32 v[16:17], v[30:31], v[36:37] op_sel:[0,1] op_sel_hi:[1,1] neg_lo:[0,1] neg_hi:[0,1]
    v_pk_add_f32 v[18:19], v[30:31], v[38:39] op_sel:[0,0] op_sel_hi:[1,0] neg_lo:[0,1] neg_hi:[0,1]
    v_pk_add_f32 v[20:21], v[30:31], v[38:39] op_sel:[0,1] op_sel_hi:[1,1] neg_lo:[0,1] neg_hi:[0,1]
    v_pk_add_f32 v[22:23], v[30:31], v[40:41] op_sel:[0,0] op_sel_hi:[1,0] neg_lo:[0,1] neg_hi:[0,1]
    v_pk_add_f32 v[24:25], v[30:31], v[40:41] op_sel:[0,1] op_sel_hi:[1,1] neg_lo:[0,1] neg_hi:[0,1]
    v_pk_add_f32 v[26:27], v[30:31], v[42:43] op_sel:[0,0] op_sel_hi:[1,0] neg_lo:[0,1] neg_hi:[0,1]
    v_pk_add_f32 v[28:29], v[30:31], v[42:43] op_sel:[0,1] op_sel_hi:[1,1] neg_lo:[0,1] neg_hi:[0,1]
    v_cvt_pk_bf16_f32 v32, v14, v15
    v_lshlrev_b32 v14, 16, v32
    v_and_b32 v15, 0xffff0000, v32
    v_cvt_pk_bf16_f32 v32, v16, v17
    v_lshlrev_b32 v16, 16, v32
    v_and_b32 v17, 0xffff0000, v32
    v_cvt_pk_bf16_f32 v32, v18, v19
    v_lshlrev_b32 v18, 16, v32
    v_and_b32 v19, 0xffff0000, v32
    v_cvt_pk_bf16_f32 v32, v20, v21
    v_lshlrev_b32 v20, 16, v32
    v_and_b32 v21, 0xffff0000, v32
    v_cvt_pk_bf16_f32 v32, v22, v23
    v_lshlrev_b32 v22, 16, v32
    v_and_b32 v23, 0xffff0000, v32
    v_cvt_pk_bf16_f32 v32, v24, v25
    v_lshlrev_b32 v24, 16, v32
    v_and_b32 v25, 0xffff0000, v32
    v_cvt_pk_bf16_f32 v32, v26, v27
    v_lshlrev_b32 v26, 16, v32
    v_and_b32 v27, 0xffff0000, v32
    v_cvt_pk_bf16_f32 v32, v28, v29
    v_lshlrev_b32 v28, 16, v32
    v_and_b32 v29, 0xffff0000, v32
    v_pk_mul_f32 v[14:15], v[14:15], v[14:15]
    v_pk_mul_f32 v[16:17], v[16:17], v[16:17]
    v_pk_mul_f32 v[18:19], v[18:19], v[18:19]
    v_pk_mul_f32 v[20:21], v[20:21], v[20:21]
    v_pk_mul_f32 v[22:23], v[22:23], v[22:23]
    v_pk_mul_f32 v[24:25], v[24:25], v[24:25]
    v_pk_mul_f32 v[26:27], v[26:27], v[26:27]
    v_pk_mul_f32 v[28:29], v[28:29], v[28:29]
    v_cvt_pk_bf16_f32 v32, v14, v15
    v_lshlrev_b32 v14, 16, v32
    v_and_b32 v15, 0xffff0000, v32
    v_cvt_pk_bf16_f32 v32, v16, v17
    v_lshlrev_b32 v16, 16, v32
    v_and_b32 v17, 0xffff0000, v32
    v_cvt_pk_bf16_f32 v32, v18, v19
    v_lshlrev_b32 v18, 16, v32
    v_and_b32 v19, 0xffff0000, v32
    v_cvt_pk_bf16_f32 v32, v20, v21
    v_lshlrev_b32 v20, 16, v32
    v_and_b32 v21, 0xffff0000, v32
    v_cvt_pk_bf16_f32 v32, v22, v23
    v_lshlrev_b32 v22, 16, v32
    v_and_b32 v23, 0xffff0000, v32
    v_cvt_pk_bf16_f32 v32, v24, v25
    v_lshlrev_b32 v24, 16, v32
    v_and_b32 v25, 0xffff0000, v32
    v_cvt_pk_bf16_f32 v32, v26, v27
    v_lshlrev_b32 v26, 16, v32
    v_and_b32 v27, 0xffff0000, v32
    v_cvt_pk_bf16_f32 v32, v28, v29
    v_lshlrev_b32 v28, 16, v32
    v_and_b32 v29, 0xffff0000, v32
    v_mov_b32 v30, 1092616192
    v_mov_b32 v31, 0x3fb8aa3b
    v_pk_mul_f32 v[14:15], v[14:15], v[30:31] op_sel:[0,0] op_sel_hi:[1,0]
    v_pk_mul_f32 v[16:17], v[16:17], v[30:31] op_sel:[0,0] op_sel_hi:[1,0]
    v_pk_mul_f32 v[18:19], v[18:19], v[30:31] op_sel:[0,0] op_sel_hi:[1,0]
    v_pk_mul_f32 v[20:21], v[20:21], v[30:31] op_sel:[0,0] op_sel_hi:[1,0]
    v_pk_mul_f32 v[22:23], v[22:23], v[30:31] op_sel:[0,0] op_sel_hi:[1,0]
    v_pk_mul_f32 v[24:25], v[24:25], v[30:31] op_sel:[0,0] op_sel_hi:[1,0]
    v_pk_mul_f32 v[26:27], v[26:27], v[30:31] op_sel:[0,0] op_sel_hi:[1,0]
    v_pk_mul_f32 v[28:29], v[28:29], v[30:31] op_sel:[0,0] op_sel_hi:[1,0]
    v_cvt_pk_bf16_f32 v32, v14, v15
    v_lshlrev_b32 v14, 16, v32
    v_and_b32 v15, 0xffff0000, v32
    v_cvt_pk_bf16_f32 v32, v16, v17
    v_lshlrev_b32 v16, 16, v32
    v_and_b32 v17, 0xffff0000, v32
    v_cvt_pk_bf16_f32 v32, v18, v19
    v_lshlrev_b32 v18, 16, v32
    v_and_b32 v19, 0xffff0000, v32
    v_cvt_pk_bf16_f32 v32, v20, v21
    v_lshlrev_b32 v20, 16, v32
    v_and_b32 v21, 0xffff0000, v32
    v_cvt_pk_bf16_f32 v32, v22, v23
    v_lshlrev_b32 v22, 16, v32
    v_and_b32 v23, 0xffff0000, v32
    v_cvt_pk_bf16_f32 v32, v24, v25
    v_lshlrev_b32 v24, 16, v32
    v_and_b32 v25, 0xffff0000, v32
    v_cvt_pk_bf16_f32 v32, v26, v27
    v_lshlrev_b32 v26, 16, v32
    v_and_b32 v27, 0xffff0000, v32
    v_cvt_pk_bf16_f32 v32, v28, v29
    v_lshlrev_b32 v28, 16, v32
    v_and_b32 v29, 0xffff0000, v32
    v_pk_mul_f32 v[14:15], v[14:15], v[30:31] op_sel:[0,1] op_sel_hi:[1,1]
    v_pk_mul_f32 v[16:17], v[16:17], v[30:31] op_sel:[0,1] op_sel_hi:[1,1]
    v_pk_mul_f32 v[18:19], v[18:19], v[30:31] op_sel:[0,1] op_sel_hi:[1,1]
    v_pk_mul_f32 v[20:21], v[20:21], v[30:31] op_sel:[0,1] op_sel_hi:[1,1]
    v_pk_mul_f32 v[22:23], v[22:23], v[30:31] op_sel:[0,1] op_sel_hi:[1,1]
    v_pk_mul_f32 v[24:25], v[24:25], v[30:31] op_sel:[0,1] op_sel_hi:[1,1]
    v_pk_mul_f32 v[26:27], v[26:27], v[30:31] op_sel:[0,1] op_sel_hi:[1,1]
    v_pk_mul_f32 v[28:29], v[28:29], v[30:31] op_sel:[0,1] op_sel_hi:[1,1]
    v_exp_f32 v14, -v14
    v_exp_f32 v15, -v15
    v_exp_f32 v16, -v16
    v_exp_f32 v17, -v17
    v_exp_f32 v18, -v18
    v_exp_f32 v19, -v19
    v_exp_f32 v20, -v20
    v_exp_f32 v21, -v21
    v_exp_f32 v22, -v22
    v_exp_f32 v23, -v23
    v_exp_f32 v24, -v24
    v_exp_f32 v25, -v25
    v_exp_f32 v26, -v26
    v_exp_f32 v27, -v27
    v_exp_f32 v28, -v28
    v_exp_f32 v29, -v29
    v_cvt_pk_bf16_f32 v14, v14, v16
    v_cvt_pk_bf16_f32 v15, v15, v17
    v_cvt_pk_bf16_f32 v18, v18, v20
    v_cvt_pk_bf16_f32 v19, v19, v21
    v_cvt_pk_bf16_f32 v22, v22, v24
    v_cvt_pk_bf16_f32 v23, v23, v25
    v_cvt_pk_bf16_f32 v26, v26, v28
    v_cvt_pk_bf16_f32 v27, v27, v29
    v_dot2_f32_bf16 v112, v14, s68, 0
    v_dot2_f32_bf16 v113, v15, s68, 0
    v_dot2_f32_bf16 v114, v14, s69, 0
    v_dot2_f32_bf16 v115, v15, s69, 0
    v_dot2_f32_bf16 v116, v14, s70, 0
    v_dot2_f32_bf16 v117, v15, s70, 0
    v_dot2_f32_bf16 v118, v14, s71, 0
    v_dot2_f32_bf16 v119, v15, s71, 0
    v_dot2_f32_bf16 v120, v14, s52, 0
    v_dot2_f32_bf16 v121, v15, s52, 0
    v_dot2_f32_bf16 v122, v14, s53, 0
    v_dot2_f32_bf16 v123, v15, s53, 0
    v_dot2_f32_bf16 v124, v14, s54, 0
    v_dot2_f32_bf16 v125, v15, s54, 0
    v_dot2_f32_bf16 v126, v14, s55, 0
    v_dot2_f32_bf16 v127, v15, s55, 0
    v_dot2_f32_bf16 v112, v18, s72, v112
    v_dot2_f32_bf16 v113, v19, s72, v113
    v_dot2_f32_bf16 v114, v18, s73, v114
    v_dot2_f32_bf16 v115, v19, s73, v115
    v_dot2_f32_bf16 v116, v18, s74, v116
    v_dot2_f32_bf16 v117, v19, s74, v117
    v_dot2_f32_bf16 v118, v18, s75, v118
    v_dot2_f32_bf16 v119, v19, s75, v119
    v_dot2_f32_bf16 v120, v18, s56, v120
    v_dot2_f32_bf16 v121, v19, s56, v121
    v_dot2_f32_bf16 v122, v18, s57, v122
    v_dot2_f32_bf16 v123, v19, s57, v123
    v_dot2_f32_bf16 v124, v18, s58, v124
    v_dot2_f32_bf16 v125, v19, s58, v125
    v_dot2_f32_bf16 v126, v18, s59, v126
    v_dot2_f32_bf16 v127, v19, s59, v127
    v_dot2_f32_bf16 v112, v22, s76, v112
    v_dot2_f32_bf16 v113, v23, s76, v113
    v_dot2_f32_bf16 v114, v22, s77, v114
    v_dot2_f32_bf16 v115, v23, s77, v115
    v_dot2_f32_bf16 v116, v22, s78, v116
    v_dot2_f32_bf16 v117, v23, s78, v117
    v_dot2_f32_bf16 v118, v22, s79, v118
    v_dot2_f32_bf16 v119, v23, s79, v119
    v_dot2_f32_bf16 v120, v22, s60, v120
    v_dot2_f32_bf16 v121, v23, s60, v121
    v_dot2_f32_bf16 v122, v22, s61, v122
    v_dot2_f32_bf16 v123, v23, s61, v123
    v_dot2_f32_bf16 v124, v22, s62, v124
    v_dot2_f32_bf16 v125, v23, s62, v125
    v_dot2_f32_bf16 v126, v22, s63, v126
    v_dot2_f32_bf16 v127, v23, s63, v127
    v_dot2_f32_bf16 v112, v26, s80, v112
    v_dot2_f32_bf16 v113, v27, s80, v113
    v_dot2_f32_bf16 v114, v26, s81, v114
    v_dot2_f32_bf16 v115, v27, s81, v115
    v_dot2_f32_bf16 v116, v26, s82, v116
    v_dot2_f32_bf16 v117, v27, s82, v117
    v_dot2_f32_bf16 v118, v26, s83, v118
    v_dot2_f32_bf16 v119, v27, s83, v119
    v_dot2_f32_bf16 v120, v26, s64, v120
    v_dot2_f32_bf16 v121, v27, s64, v121
    v_dot2_f32_bf16 v122, v26, s65, v122
    v_dot2_f32_bf16 v123, v27, s65, v123
    v_dot2_f32_bf16 v124, v26, s66, v124
    v_dot2_f32_bf16 v125, v27, s66, v125
    v_dot2_f32_bf16 v126, v26, s67, v126
    v_dot2_f32_bf16 v127, v27, s67, v127
L_p2_gd:
    s_cmp_lg_u32 s13, 15
    s_cbranch_scc1 L_p2_nosig
    s_waitcnt vmcnt(2)
    v_readfirstlane_b32 s15, v9
    s_lshl_b32 s51, 1, s12
    s_add_u32 s20, s20, s15
    s_and_b32 s15, s20, 0xff
    s_cmp_eq_u32 s15, 4
    s_cbranch_scc0 L_p2_notlast
    s_bfe_u32 s15, s20, 262160
    s_or_b32 s51, s51, s15
    s_branch L_p2_pub
L_p2_notlast:
    s_cmp_lg_u32 s21, 0
    s_cselect_b32 s51, 0, s51
    s_cbranch_scc1 L_p2_pub
L_p2_poll:
    v_mov_b32 v9, 0
    s_lshl_b32 s14, s3, 8
    s_add_u32 s14, s14, 8523776
    s_mov_b64 exec, 1
    buffer_atomic_add v9, off, s[4:7], s14 sc0
    s_mov_b64 exec, -1
    s_waitcnt vmcnt(0)
    v_readfirstlane_b32 s20, v9
    s_nop 0
    s_and_b32 s15, s20, 0xff
    s_cmp_lt_u32 s15, 4
    s_cbranch_scc1 L_p2_poll
L_p2_pub:
    s_lshl_b32 s15, s51, 24
    s_or_b32 s15, s15, s20
    v_mov_b32 v9, s15
    s_mov_b64 exec, 1
    ds_write_b32 v8, v9
    s_mov_b64 exec, -1
    s_waitcnt lgkmcnt(0)
L_p2_nosig:
    s_barrier
    ds_read_b32 v9, v8
    s_waitcnt lgkmcnt(0)
    v_readfirstlane_b32 s20, v9
    s_nop 0
    s_lshr_b32 s51, s20, 24
    s_cbranch_scc0 L_p2_end
L_p2_fin:
    s_mul_i32 s24, s49, 20000
    s_add_u32 s14, s12, 1
    s_and_b32 s14, s14, 3
    s_mul_i32 s15, s14, 5120000
    s_add_u32 s15, s15, 228589568
    s_add_u32 s15, s15, s26
    buffer_load_dwordx4 v[12:15], v1, s[4:7], s15 offen sc1
    buffer_load_dwordx4 v[92:95], v2, s[4:7], s15 offen sc1
    s_add_u32 s14, s12, 2
    s_and_b32 s14, s14, 3
    s_mul_i32 s15, s14, 5120000
    s_add_u32 s15, s15, 228589568
    s_add_u32 s15, s15, s26
    buffer_load_dwordx4 v[16:19], v1, s[4:7], s15 offen sc1
    buffer_load_dwordx4 v[96:99], v2, s[4:7], s15 offen sc1
    s_add_u32 s14, s12, 3
    s_and_b32 s14, s14, 3
    s_mul_i32 s15, s14, 5120000
    s_add_u32 s15, s15, 228589568
    s_add_u32 s15, s15, s26
    buffer_load_dwordx4 v[20:23], v1, s[4:7], s15 offen sc1
    buffer_load_dwordx4 v[100:103], v2, s[4:7], s15 offen sc1
    v_add_u32 v24, s24, v1
    ds_read_b128 v[8:11], v24
    v_add_u32 v25, s24, v2
    ds_read_b128 v[88:91], v25
    s_waitcnt vmcnt(0) lgkmcnt(0)
    s_bfe_u32 s14, s20, 262164
    s_cbranch_scc0 L_p2_kernel_nof32a_10
    s_add_u32 s14, s12, 0
    s_and_b32 s14, s14, 3
    s_add_u32 s14, s14, 20
    s_bitcmp1_b32 s20, s14
    s_cbranch_scc0 L_p2_kernel_q_11
    v_mov_b32 v8, 1073758208
    v_mov_b32 v9, 1073758208
    v_mov_b32 v10, 1073758208
    v_mov_b32 v11, 1073758208
L_p2_kernel_q_11:
    s_add_u32 s14, s12, 1
    s_and_b32 s14, s14, 3
    s_add_u32 s14, s14, 20
    s_bitcmp1_b32 s20, s14
    s_cbranch_scc0 L_p2_kernel_q_12
    v_mov_b32 v12, 1073758208
    v_mov_b32 v13, 1073758208
    v_mov_b32 v14, 1073758208
    v_mov_b32 v15, 1073758208
L_p2_kernel_q_12:
    s_add_u32 s14, s12, 2
    s_and_b32 s14, s14, 3
    s_add_u32 s14, s14, 20
    s_bitcmp1_b32 s20, s14
    s_cbranch_scc0 L_p2_kernel_q_13
    v_mov_b32 v16, 1073758208
    v_mov_b32 v17, 1073758208
    v_mov_b32 v18, 1073758208
    v_mov_b32 v19, 1073758208
L_p2_kernel_q_13:
    s_add_u32 s14, s12, 3
    s_and_b32 s14, s14, 3
    s_add_u32 s14, s14, 20
    s_bitcmp1_b32 s20, s14
    s_cbranch_scc0 L_p2_kernel_q_14
    v_mov_b32 v20, 1073758208
    v_mov_b32 v21, 1073758208
    v_mov_b32 v22, 1073758208
    v_mov_b32 v23, 1073758208
L_p2_kernel_q_14:
L_p2_kernel_nof32a_10:
    v_pk_add_u16 v8, v8, v12
    v_pk_add_u16 v16, v16, v20
    v_pk_add_u16 v9, v9, v13
    v_pk_add_u16 v17, v17, v21
    v_pk_add_u16 v10, v10, v14
    v_pk_add_u16 v18, v18, v22
    v_pk_add_u16 v11, v11, v15
    v_pk_add_u16 v19, v19, v23
    v_add_u32_sdwa v24, v8, v16 dst_sel:DWORD dst_unused:UNUSED_PAD src0_sel:WORD_0 src1_sel:WORD_0
    v_add_u32_sdwa v25, v10, v18 dst_sel:DWORD dst_unused:UNUSED_PAD src0_sel:WORD_0 src1_sel:WORD_0
    v_add_u32_sdwa v26, v8, v16 dst_sel:DWORD dst_unused:UNUSED_PAD src0_sel:WORD_1 src1_sel:WORD_1
    v_add_u32_sdwa v27, v10, v18 dst_sel:DWORD dst_unused:UNUSED_PAD src0_sel:WORD_1 src1_sel:WORD_1
    v_add_u32_sdwa v28, v9, v17 dst_sel:DWORD dst_unused:UNUSED_PAD src0_sel:WORD_0 src1_sel:WORD_0
    v_add_u32_sdwa v29, v11, v19 dst_sel:DWORD dst_unused:UNUSED_PAD src0_sel:WORD_0 src1_sel:WORD_0
    v_add_u32_sdwa v30, v9, v17 dst_sel:DWORD dst_unused:UNUSED_PAD src0_sel:WORD_1 src1_sel:WORD_1
    v_add_u32_sdwa v31, v11, v19 dst_sel:DWORD dst_unused:UNUSED_PAD src0_sel:WORD_1 src1_sel:WORD_1
    v_cvt_f32_u32 v24, v24
    v_cvt_f32_u32 v25, v25
    v_cvt_f32_u32 v26, v26
    v_cvt_f32_u32 v27, v27
    v_cvt_f32_u32 v28, v28
    v_cvt_f32_u32 v29, v29
    v_cvt_f32_u32 v30, v30
    v_cvt_f32_u32 v31, v31
    v_pk_fma_f32 v[24:25], v[24:25], s[44:45], s[44:45] op_sel:[0,0,1] op_sel_hi:[1,0,1]
    v_pk_fma_f32 v[26:27], v[26:27], s[44:45], s[44:45] op_sel:[0,0,1] op_sel_hi:[1,0,1]
    v_pk_fma_f32 v[28:29], v[28:29], s[44:45], s[44:45] op_sel:[0,0,1] op_sel_hi:[1,0,1]
    v_pk_fma_f32 v[30:31], v[30:31], s[44:45], s[44:45] op_sel:[0,0,1] op_sel_hi:[1,0,1]
    s_bfe_u32 s14, s20, 262164
    s_cbranch_scc0 L_p2_kernel_nof32b_15
    v_lshlrev_b32 v32, 1, v1
    s_bitcmp1_b32 s20, 20
    s_cbranch_scc0 L_p2_kernel_q_16
    s_lshl_b32 s15, s26, 1
    s_add_u32 s15, s15, 249069568
    buffer_load_dwordx4 v[8:11], v32, s[4:7], s15 offen sc1
    buffer_load_dwordx4 v[12:15], v32, s[4:7], s15 offen offset:16 sc1
    s_waitcnt vmcnt(0)
    v_add_f32 v24, v24, v8
    v_add_f32 v25, v25, v12
    v_add_f32 v26, v26, v9
    v_add_f32 v27, v27, v13
    v_add_f32 v28, v28, v10
    v_add_f32 v29, v29, v14
    v_add_f32 v30, v30, v11
    v_add_f32 v31, v31, v15
L_p2_kernel_q_16:
    s_bitcmp1_b32 s20, 21
    s_cbranch_scc0 L_p2_kernel_q_17
    s_lshl_b32 s15, s26, 1
    s_add_u32 s15, s15, 259309568
    buffer_load_dwordx4 v[8:11], v32, s[4:7], s15 offen sc1
    buffer_load_dwordx4 v[12:15], v32, s[4:7], s15 offen offset:16 sc1
    s_waitcnt vmcnt(0)
    v_add_f32 v24, v24, v8
    v_add_f32 v25, v25, v12
    v_add_f32 v26, v26, v9
    v_add_f32 v27, v27, v13
    v_add_f32 v28, v28, v10
    v_add_f32 v29, v29, v14
    v_add_f32 v30, v30, v11
    v_add_f32 v31, v31, v15
L_p2_kernel_q_17:
    s_bitcmp1_b32 s20, 22
    s_cbranch_scc0 L_p2_kernel_q_18
    s_lshl_b32 s15, s26, 1
    s_add_u32 s15, s15, 269549568
    buffer_load_dwordx4 v[8:11], v32, s[4:7], s15 offen sc1
    buffer_load_dwordx4 v[12:15], v32, s[4:7], s15 offen offset:16 sc1
    s_waitcnt vmcnt(0)
    v_add_f32 v24, v24, v8
    v_add_f32 v25, v25, v12
    v_add_f32 v26, v26, v9
    v_add_f32 v27, v27, v13
    v_add_f32 v28, v28, v10
    v_add_f32 v29, v29, v14
    v_add_f32 v30, v30, v11
    v_add_f32 v31, v31, v15
L_p2_kernel_q_18:
    s_bitcmp1_b32 s20, 23
    s_cbranch_scc0 L_p2_kernel_q_19
    s_lshl_b32 s15, s26, 1
    s_add_u32 s15, s15, 279789568
    buffer_load_dwordx4 v[8:11], v32, s[4:7], s15 offen sc1
    buffer_load_dwordx4 v[12:15], v32, s[4:7], s15 offen offset:16 sc1
    s_waitcnt vmcnt(0)
    v_add_f32 v24, v24, v8
    v_add_f32 v25, v25, v12
    v_add_f32 v26, v26, v9
    v_add_f32 v27, v27, v13
    v_add_f32 v28, v28, v10
    v_add_f32 v29, v29, v14
    v_add_f32 v30, v30, v11
    v_add_f32 v31, v31, v15
L_p2_kernel_q_19:
L_p2_kernel_nof32b_15:
    v_pk_mul_f32 v[8:9], v[24:25], s[84:85] op_sel:[0,0] op_sel_hi:[1,0]
    v_pk_mul_f32 v[10:11], v[24:25], s[84:85] op_sel:[0,1] op_sel_hi:[1,1]
    v_pk_mul_f32 v[12:13], v[24:25], s[86:87] op_sel:[0,0] op_sel_hi:[1,0]
    v_pk_mul_f32 v[14:15], v[24:25], s[86:87] op_sel:[0,1] op_sel_hi:[1,1]
    v_pk_fma_f32 v[8:9], v[26:27], s[88:89], v[8:9] op_sel:[0,0,0] op_sel_hi:[1,0,1]
    v_pk_fma_f32 v[10:11], v[26:27], s[88:89], v[10:11] op_sel:[0,1,0] op_sel_hi:[1,1,1]
    v_pk_fma_f32 v[12:13], v[26:27], s[90:91], v[12:13] op_sel:[0,0,0] op_sel_hi:[1,0,1]
    v_pk_fma_f32 v[14:15], v[26:27], s[90:91], v[14:15] op_sel:[0,1,0] op_sel_hi:[1,1,1]
    v_pk_fma_f32 v[8:9], v[28:29], s[92:93], v[8:9] op_sel:[0,0,0] op_sel_hi:[1,0,1]
    v_pk_fma_f32 v[10:11], v[28:29], s[92:93], v[10:11] op_sel:[0,1,0] op_sel_hi:[1,1,1]
    v_pk_fma_f32 v[12:13], v[28:29], s[94:95], v[12:13] op_sel:[0,0,0] op_sel_hi:[1,0,1]
    v_pk_fma_f32 v[14:15], v[28:29], s[94:95], v[14:15] op_sel:[0,1,0] op_sel_hi:[1,1,1]
    v_pk_fma_f32 v[8:9], v[30:31], s[96:97], v[8:9] op_sel:[0,0,0] op_sel_hi:[1,0,1]
    v_pk_fma_f32 v[10:11], v[30:31], s[96:97], v[10:11] op_sel:[0,1,0] op_sel_hi:[1,1,1]
    v_pk_fma_f32 v[12:13], v[30:31], s[98:99], v[12:13] op_sel:[0,0,0] op_sel_hi:[1,0,1]
    v_pk_fma_f32 v[14:15], v[30:31], s[98:99], v[14:15] op_sel:[0,1,0] op_sel_hi:[1,1,1]
    v_pk_mul_f32 v[8:9], v[8:9], v[72:73]
    v_pk_mul_f32 v[10:11], v[10:11], v[74:75]
    v_pk_mul_f32 v[12:13], v[12:13], v[76:77]
    v_pk_mul_f32 v[14:15], v[14:15], v[78:79]
    v_pk_mul_f32 v[24:25], v[8:9], s[28:29] op_sel:[0,0] op_sel_hi:[1,0]
    v_pk_mul_f32 v[26:27], v[8:9], s[28:29] op_sel:[0,1] op_sel_hi:[1,1]
    v_pk_mul_f32 v[28:29], v[8:9], s[30:31] op_sel:[0,0] op_sel_hi:[1,0]
    v_pk_mul_f32 v[30:31], v[8:9], s[30:31] op_sel:[0,1] op_sel_hi:[1,1]
    v_pk_fma_f32 v[24:25], v[10:11], s[32:33], v[24:25] op_sel:[0,0,0] op_sel_hi:[1,0,1]
    v_pk_fma_f32 v[26:27], v[10:11], s[32:33], v[26:27] op_sel:[0,1,0] op_sel_hi:[1,1,1]
    v_pk_fma_f32 v[28:29], v[10:11], s[34:35], v[28:29] op_sel:[0,0,0] op_sel_hi:[1,0,1]
    v_pk_fma_f32 v[30:31], v[10:11], s[34:35], v[30:31] op_sel:[0,1,0] op_sel_hi:[1,1,1]
    v_pk_fma_f32 v[24:25], v[12:13], s[36:37], v[24:25] op_sel:[0,0,0] op_sel_hi:[1,0,1]
    v_pk_fma_f32 v[26:27], v[12:13], s[36:37], v[26:27] op_sel:[0,1,0] op_sel_hi:[1,1,1]
    v_pk_fma_f32 v[28:29], v[12:13], s[38:39], v[28:29] op_sel:[0,0,0] op_sel_hi:[1,0,1]
    v_pk_fma_f32 v[30:31], v[12:13], s[38:39], v[30:31] op_sel:[0,1,0] op_sel_hi:[1,1,1]
    v_pk_fma_f32 v[24:25], v[14:15], s[40:41], v[24:25] op_sel:[0,0,0] op_sel_hi:[1,0,1]
    v_pk_fma_f32 v[26:27], v[14:15], s[40:41], v[26:27] op_sel:[0,1,0] op_sel_hi:[1,1,1]
    v_pk_fma_f32 v[28:29], v[14:15], s[42:43], v[28:29] op_sel:[0,0,0] op_sel_hi:[1,0,1]
    v_pk_fma_f32 v[30:31], v[14:15], s[42:43], v[30:31] op_sel:[0,1,0] op_sel_hi:[1,1,1]
    v_lshlrev_b32 v8, 16, v64
    v_and_b32 v10, 0xffff0000, v64
    v_lshlrev_b32 v12, 16, v65
    v_and_b32 v14, 0xffff0000, v65
    v_lshlrev_b32 v9, 16, v66
    v_and_b32 v11, 0xffff0000, v66
    v_lshlrev_b32 v13, 16, v67
    v_and_b32 v15, 0xffff0000, v67
    v_pk_fma_f32 v[8:9], v[24:25], v[80:81], v[8:9]
    v_pk_fma_f32 v[10:11], v[26:27], v[82:83], v[10:11]
    v_pk_fma_f32 v[12:13], v[28:29], v[84:85], v[12:13]
    v_pk_fma_f32 v[14:15], v[30:31], v[86:87], v[14:15]
    v_cvt_pk_bf16_f32 v16, v8, v10
    v_cvt_pk_bf16_f32 v17, v12, v14
    v_cvt_pk_bf16_f32 v18, v9, v11
    v_cvt_pk_bf16_f32 v19, v13, v15
    buffer_store_dwordx4 v[16:19], v1, s[16:19], s26 offen
    s_cmp_ge_u32 s13, 4
    s_cbranch_scc1 L_p2_f1
    s_bfe_u32 s14, s20, 262164
    s_cbranch_scc0 L_p2_kernel_nof32a_20
    s_add_u32 s14, s12, 0
    s_and_b32 s14, s14, 3
    s_add_u32 s14, s14, 20
    s_bitcmp1_b32 s20, s14
    s_cbranch_scc0 L_p2_kernel_q_21
    v_mov_b32 v88, 1073758208
    v_mov_b32 v89, 1073758208
    v_mov_b32 v90, 1073758208
    v_mov_b32 v91, 1073758208
L_p2_kernel_q_21:
    s_add_u32 s14, s12, 1
    s_and_b32 s14, s14, 3
    s_add_u32 s14, s14, 20
    s_bitcmp1_b32 s20, s14
    s_cbranch_scc0 L_p2_kernel_q_22
    v_mov_b32 v92, 1073758208
    v_mov_b32 v93, 1073758208
    v_mov_b32 v94, 1073758208
    v_mov_b32 v95, 1073758208
L_p2_kernel_q_22:
    s_add_u32 s14, s12, 2
    s_and_b32 s14, s14, 3
    s_add_u32 s14, s14, 20
    s_bitcmp1_b32 s20, s14
    s_cbranch_scc0 L_p2_kernel_q_23
    v_mov_b32 v96, 1073758208
    v_mov_b32 v97, 1073758208
    v_mov_b32 v98, 1073758208
    v_mov_b32 v99, 1073758208
L_p2_kernel_q_23:
    s_add_u32 s14, s12, 3
    s_and_b32 s14, s14, 3
    s_add_u32 s14, s14, 20
    s_bitcmp1_b32 s20, s14
    s_cbranch_scc0 L_p2_kernel_q_24
    v_mov_b32 v100, 1073758208
    v_mov_b32 v101, 1073758208
    v_mov_b32 v102, 1073758208
    v_mov_b32 v103, 1073758208
L_p2_kernel_q_24:
L_p2_kernel_nof32a_20:
    v_pk_add_u16 v88, v88, v92
    v_pk_add_u16 v96, v96, v100
    v_pk_add_u16 v89, v89, v93
    v_pk_add_u16 v97, v97, v101
    v_pk_add_u16 v90, v90, v94
    v_pk_add_u16 v98, v98, v102
    v_pk_add_u16 v91, v91, v95
    v_pk_add_u16 v99, v99, v103
    v_add_u32_sdwa v24, v88, v96 dst_sel:DWORD dst_unused:UNUSED_PAD src0_sel:WORD_0 src1_sel:WORD_0
    v_add_u32_sdwa v25, v90, v98 dst_sel:DWORD dst_unused:UNUSED_PAD src0_sel:WORD_0 src1_sel:WORD_0
    v_add_u32_sdwa v26, v88, v96 dst_sel:DWORD dst_unused:UNUSED_PAD src0_sel:WORD_1 src1_sel:WORD_1
    v_add_u32_sdwa v27, v90, v98 dst_sel:DWORD dst_unused:UNUSED_PAD src0_sel:WORD_1 src1_sel:WORD_1
    v_add_u32_sdwa v28, v89, v97 dst_sel:DWORD dst_unused:UNUSED_PAD src0_sel:WORD_0 src1_sel:WORD_0
    v_add_u32_sdwa v29, v91, v99 dst_sel:DWORD dst_unused:UNUSED_PAD src0_sel:WORD_0 src1_sel:WORD_0
    v_add_u32_sdwa v30, v89, v97 dst_sel:DWORD dst_unused:UNUSED_PAD src0_sel:WORD_1 src1_sel:WORD_1
    v_add_u32_sdwa v31, v91, v99 dst_sel:DWORD dst_unused:UNUSED_PAD src0_sel:WORD_1 src1_sel:WORD_1
    v_cvt_f32_u32 v24, v24
    v_cvt_f32_u32 v25, v25
    v_cvt_f32_u32 v26, v26
    v_cvt_f32_u32 v27, v27
    v_cvt_f32_u32 v28, v28
    v_cvt_f32_u32 v29, v29
    v_cvt_f32_u32 v30, v30
    v_cvt_f32_u32 v31, v31
    v_pk_fma_f32 v[24:25], v[24:25], s[44:45], s[44:45] op_sel:[0,0,1] op_sel_hi:[1,0,1]
    v_pk_fma_f32 v[26:27], v[26:27], s[44:45], s[44:45] op_sel:[0,0,1] op_sel_hi:[1,0,1]
    v_pk_fma_f32 v[28:29], v[28:29], s[44:45], s[44:45] op_sel:[0,0,1] op_sel_hi:[1,0,1]
    v_pk_fma_f32 v[30:31], v[30:31], s[44:45], s[44:45] op_sel:[0,0,1] op_sel_hi:[1,0,1]
    s_bfe_u32 s14, s20, 262164
    s_cbranch_scc0 L_p2_kernel_nof32b_25
    v_lshlrev_b32 v32, 1, v2
    s_bitcmp1_b32 s20, 20
    s_cbranch_scc0 L_p2_kernel_q_26
    s_lshl_b32 s15, s26, 1
    s_add_u32 s15, s15, 249069568
    buffer_load_dwordx4 v[88:91], v32, s[4:7], s15 offen sc1
    buffer_load_dwordx4 v[92:95], v32, s[4:7], s15 offen offset:16 sc1
    s_waitcnt vmcnt(0)
    v_add_f32 v24, v24, v88
    v_add_f32 v25, v25, v92
    v_add_f32 v26, v26, v89
    v_add_f32 v27, v27, v93
    v_add_f32 v28, v28, v90
    v_add_f32 v29, v29, v94
    v_add_f32 v30, v30, v91
    v_add_f32 v31, v31, v95
L_p2_kernel_q_26:
    s_bitcmp1_b32 s20, 21
    s_cbranch_scc0 L_p2_kernel_q_27
    s_lshl_b32 s15, s26, 1
    s_add_u32 s15, s15, 259309568
    buffer_load_dwordx4 v[88:91], v32, s[4:7], s15 offen sc1
    buffer_load_dwordx4 v[92:95], v32, s[4:7], s15 offen offset:16 sc1
    s_waitcnt vmcnt(0)
    v_add_f32 v24, v24, v88
    v_add_f32 v25, v25, v92
    v_add_f32 v26, v26, v89
    v_add_f32 v27, v27, v93
    v_add_f32 v28, v28, v90
    v_add_f32 v29, v29, v94
    v_add_f32 v30, v30, v91
    v_add_f32 v31, v31, v95
L_p2_kernel_q_27:
    s_bitcmp1_b32 s20, 22
    s_cbranch_scc0 L_p2_kernel_q_28
    s_lshl_b32 s15, s26, 1
    s_add_u32 s15, s15, 269549568
    buffer_load_dwordx4 v[88:91], v32, s[4:7], s15 offen sc1
    buffer_load_dwordx4 v[92:95], v32, s[4:7], s15 offen offset:16 sc1
    s_waitcnt vmcnt(0)
    v_add_f32 v24, v24, v88
    v_add_f32 v25, v25, v92
    v_add_f32 v26, v26, v89
    v_add_f32 v27, v27, v93
    v_add_f32 v28, v28, v90
    v_add_f32 v29, v29, v94
    v_add_f32 v30, v30, v91
    v_add_f32 v31, v31, v95
L_p2_kernel_q_28:
    s_bitcmp1_b32 s20, 23
    s_cbranch_scc0 L_p2_kernel_q_29
    s_lshl_b32 s15, s26, 1
    s_add_u32 s15, s15, 279789568
    buffer_load_dwordx4 v[88:91], v32, s[4:7], s15 offen sc1
    buffer_load_dwordx4 v[92:95], v32, s[4:7], s15 offen offset:16 sc1
    s_waitcnt vmcnt(0)
    v_add_f32 v24, v24, v88
    v_add_f32 v25, v25, v92
    v_add_f32 v26, v26, v89
    v_add_f32 v27, v27, v93
    v_add_f32 v28, v28, v90
    v_add_f32 v29, v29, v94
    v_add_f32 v30, v30, v91
    v_add_f32 v31, v31, v95
L_p2_kernel_q_29:
L_p2_kernel_nof32b_25:
    v_pk_mul_f32 v[88:89], v[24:25], s[84:85] op_sel:[0,0] op_sel_hi:[1,0]
    v_pk_mul_f32 v[90:91], v[24:25], s[84:85] op_sel:[0,1] op_sel_hi:[1,1]
    v_pk_mul_f32 v[92:93], v[24:25], s[86:87] op_sel:[0,0] op_sel_hi:[1,0]
    v_pk_mul_f32 v[94:95], v[24:25], s[86:87] op_sel:[0,1] op_sel_hi:[1,1]
    v_pk_fma_f32 v[88:89], v[26:27], s[88:89], v[88:89] op_sel:[0,0,0] op_sel_hi:[1,0,1]
    v_pk_fma_f32 v[90:91], v[26:27], s[88:89], v[90:91] op_sel:[0,1,0] op_sel_hi:[1,1,1]
    v_pk_fma_f32 v[92:93], v[26:27], s[90:91], v[92:93] op_sel:[0,0,0] op_sel_hi:[1,0,1]
    v_pk_fma_f32 v[94:95], v[26:27], s[90:91], v[94:95] op_sel:[0,1,0] op_sel_hi:[1,1,1]
    v_pk_fma_f32 v[88:89], v[28:29], s[92:93], v[88:89] op_sel:[0,0,0] op_sel_hi:[1,0,1]
    v_pk_fma_f32 v[90:91], v[28:29], s[92:93], v[90:91] op_sel:[0,1,0] op_sel_hi:[1,1,1]
    v_pk_fma_f32 v[92:93], v[28:29], s[94:95], v[92:93] op_sel:[0,0,0] op_sel_hi:[1,0,1]
    v_pk_fma_f32 v[94:95], v[28:29], s[94:95], v[94:95] op_sel:[0,1,0] op_sel_hi:[1,1,1]
    v_pk_fma_f32 v[88:89], v[30:31], s[96:97], v[88:89] op_sel:[0,0,0] op_sel_hi:[1,0,1]
    v_pk_fma_f32 v[90:91], v[30:31], s[96:97], v[90:91] op_sel:[0,1,0] op_sel_hi:[1,1,1]
    v_pk_fma_f32 v[92:93], v[30:31], s[98:99], v[92:93] op_sel:[0,0,0] op_sel_hi:[1,0,1]
    v_pk_fma_f32 v[94:95], v[30:31], s[98:99], v[94:95] op_sel:[0,1,0] op_sel_hi:[1,1,1]
    v_pk_mul_f32 v[88:89], v[88:89], v[112:113]
    v_pk_mul_f32 v[90:91], v[90:91], v[114:115]
    v_pk_mul_f32 v[92:93], v[92:93], v[116:117]
    v_pk_mul_f32 v[94:95], v[94:95], v[118:119]
    v_pk_mul_f32 v[24:25], v[88:89], s[28:29] op_sel:[0,0] op_sel_hi:[1,0]
    v_pk_mul_f32 v[26:27], v[88:89], s[28:29] op_sel:[0,1] op_sel_hi:[1,1]
    v_pk_mul_f32 v[28:29], v[88:89], s[30:31] op_sel:[0,0] op_sel_hi:[1,0]
    v_pk_mul_f32 v[30:31], v[88:89], s[30:31] op_sel:[0,1] op_sel_hi:[1,1]
    v_pk_fma_f32 v[24:25], v[90:91], s[32:33], v[24:25] op_sel:[0,0,0] op_sel_hi:[1,0,1]
    v_pk_fma_f32 v[26:27], v[90:91], s[32:33], v[26:27] op_sel:[0,1,0] op_sel_hi:[1,1,1]
    v_pk_fma_f32 v[28:29], v[90:91], s[34:35], v[28:29] op_sel:[0,0,0] op_sel_hi:[1,0,1]
    v_pk_fma_f32 v[30:31], v[90:91], s[34:35], v[30:31] op_sel:[0,1,0] op_sel_hi:[1,1,1]
    v_pk_fma_f32 v[24:25], v[92:93], s[36:37], v[24:25] op_sel:[0,0,0] op_sel_hi:[1,0,1]
    v_pk_fma_f32 v[26:27], v[92:93], s[36:37], v[26:27] op_sel:[0,1,0] op_sel_hi:[1,1,1]
    v_pk_fma_f32 v[28:29], v[92:93], s[38:39], v[28:29] op_sel:[0,0,0] op_sel_hi:[1,0,1]
    v_pk_fma_f32 v[30:31], v[92:93], s[38:39], v[30:31] op_sel:[0,1,0] op_sel_hi:[1,1,1]
    v_pk_fma_f32 v[24:25], v[94:95], s[40:41], v[24:25] op_sel:[0,0,0] op_sel_hi:[1,0,1]
    v_pk_fma_f32 v[26:27], v[94:95], s[40:41], v[26:27] op_sel:[0,1,0] op_sel_hi:[1,1,1]
    v_pk_fma_f32 v[28:29], v[94:95], s[42:43], v[28:29] op_sel:[0,0,0] op_sel_hi:[1,0,1]
    v_pk_fma_f32 v[30:31], v[94:95], s[42:43], v[30:31] op_sel:[0,1,0] op_sel_hi:[1,1,1]
    v_lshlrev_b32 v88, 16, v68
    v_and_b32 v90, 0xffff0000, v68
    v_lshlrev_b32 v92, 16, v69
    v_and_b32 v94, 0xffff0000, v69
    v_lshlrev_b32 v89, 16, v70
    v_and_b32 v91, 0xffff0000, v70
    v_lshlrev_b32 v93, 16, v71
    v_and_b32 v95, 0xffff0000, v71
    v_pk_fma_f32 v[88:89], v[24:25], v[120:121], v[88:89]
    v_pk_fma_f32 v[90:91], v[26:27], v[122:123], v[90:91]
    v_pk_fma_f32 v[92:93], v[28:29], v[124:125], v[92:93]
    v_pk_fma_f32 v[94:95], v[30:31], v[126:127], v[94:95]
    v_cvt_pk_bf16_f32 v96, v88, v90
    v_cvt_pk_bf16_f32 v97, v92, v94
    v_cvt_pk_bf16_f32 v98, v89, v91
    v_cvt_pk_bf16_f32 v99, v93, v95
    buffer_store_dwordx4 v[96:99], v2, s[16:19], s26 offen
L_p2_f1:
    s_bitset0_b32 s51, s49
    s_cmp_eq_u32 s51, 0
    s_cbranch_scc1 L_p2_done
    s_ff1_i32_b32 s49, s51
    s_lshl2_add_u32 s14, s3, s49
    s_mul_i32 s14, s14, 5000
    s_add_u32 s15, s14, 4096
    v_min_u32 v61, 225, v0
    v_lshl_add_u32 v60, v0, 2, s14
    v_lshl_add_u32 v61, v61, 2, s15
    global_load_dword v60, v60, s[100:101] nt
    global_load_dword v61, v61, s[100:101] nt
    s_waitcnt vmcnt(0)
    v_lshlrev_b32 v30, 16, v60
    v_and_b32 v31, 0xffff0000, v60
    v_lshlrev_b32 v36, 16, v53
    v_and_b32 v37, 0xffff0000, v53
    v_lshlrev_b32 v38, 16, v54
    v_and_b32 v39, 0xffff0000, v54
    v_lshlrev_b32 v40, 16, v56
    v_and_b32 v41, 0xffff0000, v56
    v_lshlrev_b32 v42, 16, v57
    v_and_b32 v43, 0xffff0000, v57
    v_pk_add_f32 v[14:15], v[30:31], v[36:37] op_sel:[0,0] op_sel_hi:[1,0] neg_lo:[0,1] neg_hi:[0,1]
    v_pk_add_f32 v[16:17], v[30:31], v[36:37] op_sel:[0,1] op_sel_hi:[1,1] neg_lo:[0,1] neg_hi:[0,1]
    v_pk_add_f32 v[18:19], v[30:31], v[38:39] op_sel:[0,0] op_sel_hi:[1,0] neg_lo:[0,1] neg_hi:[0,1]
    v_pk_add_f32 v[20:21], v[30:31], v[38:39] op_sel:[0,1] op_sel_hi:[1,1] neg_lo:[0,1] neg_hi:[0,1]
    v_pk_add_f32 v[22:23], v[30:31], v[40:41] op_sel:[0,0] op_sel_hi:[1,0] neg_lo:[0,1] neg_hi:[0,1]
    v_pk_add_f32 v[24:25], v[30:31], v[40:41] op_sel:[0,1] op_sel_hi:[1,1] neg_lo:[0,1] neg_hi:[0,1]
    v_pk_add_f32 v[26:27], v[30:31], v[42:43] op_sel:[0,0] op_sel_hi:[1,0] neg_lo:[0,1] neg_hi:[0,1]
    v_pk_add_f32 v[28:29], v[30:31], v[42:43] op_sel:[0,1] op_sel_hi:[1,1] neg_lo:[0,1] neg_hi:[0,1]
    v_cvt_pk_bf16_f32 v32, v14, v15
    v_lshlrev_b32 v14, 16, v32
    v_and_b32 v15, 0xffff0000, v32
    v_cvt_pk_bf16_f32 v32, v16, v17
    v_lshlrev_b32 v16, 16, v32
    v_and_b32 v17, 0xffff0000, v32
    v_cvt_pk_bf16_f32 v32, v18, v19
    v_lshlrev_b32 v18, 16, v32
    v_and_b32 v19, 0xffff0000, v32
    v_cvt_pk_bf16_f32 v32, v20, v21
    v_lshlrev_b32 v20, 16, v32
    v_and_b32 v21, 0xffff0000, v32
    v_cvt_pk_bf16_f32 v32, v22, v23
    v_lshlrev_b32 v22, 16, v32
    v_and_b32 v23, 0xffff0000, v32
    v_cvt_pk_bf16_f32 v32, v24, v25
    v_lshlrev_b32 v24, 16, v32
    v_and_b32 v25, 0xffff0000, v32
    v_cvt_pk_bf16_f32 v32, v26, v27
    v_lshlrev_b32 v26, 16, v32
    v_and_b32 v27, 0xffff0000, v32
    v_cvt_pk_bf16_f32 v32, v28, v29
    v_lshlrev_b32 v28, 16, v32
    v_and_b32 v29, 0xffff0000, v32
    v_pk_mul_f32 v[14:15], v[14:15], v[14:15]
    v_pk_mul_f32 v[16:17], v[16:17], v[16:17]
    v_pk_mul_f32 v[18:19], v[18:19], v[18:19]
    v_pk_mul_f32 v[20:21], v[20:21], v[20:21]
    v_pk_mul_f32 v[22:23], v[22:23], v[22:23]
    v_pk_mul_f32 v[24:25], v[24:25], v[24:25]
    v_pk_mul_f32 v[26:27], v[26:27], v[26:27]
    v_pk_mul_f32 v[28:29], v[28:29], v[28:29]
    v_cvt_pk_bf16_f32 v32, v14, v15
    v_lshlrev_b32 v14, 16, v32
    v_and_b32 v15, 0xffff0000, v32
    v_cvt_pk_bf16_f32 v32, v16, v17
    v_lshlrev_b32 v16, 16, v32
    v_and_b32 v17, 0xffff0000, v32
    v_cvt_pk_bf16_f32 v32, v18, v19
    v_lshlrev_b32 v18, 16, v32
    v_and_b32 v19, 0xffff0000, v32
    v_cvt_pk_bf16_f32 v32, v20, v21
    v_lshlrev_b32 v20, 16, v32
    v_and_b32 v21, 0xffff0000, v32
    v_cvt_pk_bf16_f32 v32, v22, v23
    v_lshlrev_b32 v22, 16, v32
    v_and_b32 v23, 0xffff0000, v32
    v_cvt_pk_bf16_f32 v32, v24, v25
    v_lshlrev_b32 v24, 16, v32
    v_and_b32 v25, 0xffff0000, v32
    v_cvt_pk_bf16_f32 v32, v26, v27
    v_lshlrev_b32 v26, 16, v32
    v_and_b32 v27, 0xffff0000, v32
    v_cvt_pk_bf16_f32 v32, v28, v29
    v_lshlrev_b32 v28, 16, v32
    v_and_b32 v29, 0xffff0000, v32
    v_mov_b32 v30, 1092616192
    v_mov_b32 v31, 0x3fb8aa3b
    v_pk_mul_f32 v[14:15], v[14:15], v[30:31] op_sel:[0,0] op_sel_hi:[1,0]
    v_pk_mul_f32 v[16:17], v[16:17], v[30:31] op_sel:[0,0] op_sel_hi:[1,0]
    v_pk_mul_f32 v[18:19], v[18:19], v[30:31] op_sel:[0,0] op_sel_hi:[1,0]
    v_pk_mul_f32 v[20:21], v[20:21], v[30:31] op_sel:[0,0] op_sel_hi:[1,0]
    v_pk_mul_f32 v[22:23], v[22:23], v[30:31] op_sel:[0,0] op_sel_hi:[1,0]
    v_pk_mul_f32 v[24:25], v[24:25], v[30:31] op_sel:[0,0] op_sel_hi:[1,0]
    v_pk_mul_f32 v[26:27], v[26:27], v[30:31] op_sel:[0,0] op_sel_hi:[1,0]
    v_pk_mul_f32 v[28:29], v[28:29], v[30:31] op_sel:[0,0] op_sel_hi:[1,0]
    v_cvt_pk_bf16_f32 v32, v14, v15
    v_lshlrev_b32 v14, 16, v32
    v_and_b32 v15, 0xffff0000, v32
    v_cvt_pk_bf16_f32 v32, v16, v17
    v_lshlrev_b32 v16, 16, v32
    v_and_b32 v17, 0xffff0000, v32
    v_cvt_pk_bf16_f32 v32, v18, v19
    v_lshlrev_b32 v18, 16, v32
    v_and_b32 v19, 0xffff0000, v32
    v_cvt_pk_bf16_f32 v32, v20, v21
    v_lshlrev_b32 v20, 16, v32
    v_and_b32 v21, 0xffff0000, v32
    v_cvt_pk_bf16_f32 v32, v22, v23
    v_lshlrev_b32 v22, 16, v32
    v_and_b32 v23, 0xffff0000, v32
    v_cvt_pk_bf16_f32 v32, v24, v25
    v_lshlrev_b32 v24, 16, v32
    v_and_b32 v25, 0xffff0000, v32
    v_cvt_pk_bf16_f32 v32, v26, v27
    v_lshlrev_b32 v26, 16, v32
    v_and_b32 v27, 0xffff0000, v32
    v_cvt_pk_bf16_f32 v32, v28, v29
    v_lshlrev_b32 v28, 16, v32
    v_and_b32 v29, 0xffff0000, v32
    v_pk_mul_f32 v[14:15], v[14:15], v[30:31] op_sel:[0,1] op_sel_hi:[1,1]
    v_pk_mul_f32 v[16:17], v[16:17], v[30:31] op_sel:[0,1] op_sel_hi:[1,1]
    v_pk_mul_f32 v[18:19], v[18:19], v[30:31] op_sel:[0,1] op_sel_hi:[1,1]
    v_pk_mul_f32 v[20:21], v[20:21], v[30:31] op_sel:[0,1] op_sel_hi:[1,1]
    v_pk_mul_f32 v[22:23], v[22:23], v[30:31] op_sel:[0,1] op_sel_hi:[1,1]
    v_pk_mul_f32 v[24:25], v[24:25], v[30:31] op_sel:[0,1] op_sel_hi:[1,1]
    v_pk_mul_f32 v[26:27], v[26:27], v[30:31] op_sel:[0,1] op_sel_hi:[1,1]
    v_pk_mul_f32 v[28:29], v[28:29], v[30:31] op_sel:[0,1] op_sel_hi:[1,1]
    v_exp_f32 v14, -v14
    v_exp_f32 v15, -v15
    v_exp_f32 v16, -v16
    v_exp_f32 v17, -v17
    v_exp_f32 v18, -v18
    v_exp_f32 v19, -v19
    v_exp_f32 v20, -v20
    v_exp_f32 v21, -v21
    v_exp_f32 v22, -v22
    v_exp_f32 v23, -v23
    v_exp_f32 v24, -v24
    v_exp_f32 v25, -v25
    v_exp_f32 v26, -v26
    v_exp_f32 v27, -v27
    v_exp_f32 v28, -v28
    v_exp_f32 v29, -v29
    v_cvt_pk_bf16_f32 v14, v14, v16
    v_cvt_pk_bf16_f32 v15, v15, v17
    v_cvt_pk_bf16_f32 v18, v18, v20
    v_cvt_pk_bf16_f32 v19, v19, v21
    v_cvt_pk_bf16_f32 v22, v22, v24
    v_cvt_pk_bf16_f32 v23, v23, v25
    v_cvt_pk_bf16_f32 v26, v26, v28
    v_cvt_pk_bf16_f32 v27, v27, v29
    v_dot2_f32_bf16 v72, v14, s68, 0
    v_dot2_f32_bf16 v73, v15, s68, 0
    v_dot2_f32_bf16 v74, v14, s69, 0
    v_dot2_f32_bf16 v75, v15, s69, 0
    v_dot2_f32_bf16 v76, v14, s70, 0
    v_dot2_f32_bf16 v77, v15, s70, 0
    v_dot2_f32_bf16 v78, v14, s71, 0
    v_dot2_f32_bf16 v79, v15, s71, 0
    v_dot2_f32_bf16 v80, v14, s52, 0
    v_dot2_f32_bf16 v81, v15, s52, 0
    v_dot2_f32_bf16 v82, v14, s53, 0
    v_dot2_f32_bf16 v83, v15, s53, 0
    v_dot2_f32_bf16 v84, v14, s54, 0
    v_dot2_f32_bf16 v85, v15, s54, 0
    v_dot2_f32_bf16 v86, v14, s55, 0
    v_dot2_f32_bf16 v87, v15, s55, 0
    v_dot2_f32_bf16 v72, v18, s72, v72
    v_dot2_f32_bf16 v73, v19, s72, v73
    v_dot2_f32_bf16 v74, v18, s73, v74
    v_dot2_f32_bf16 v75, v19, s73, v75
    v_dot2_f32_bf16 v76, v18, s74, v76
    v_dot2_f32_bf16 v77, v19, s74, v77
    v_dot2_f32_bf16 v78, v18, s75, v78
    v_dot2_f32_bf16 v79, v19, s75, v79
    v_dot2_f32_bf16 v80, v18, s56, v80
    v_dot2_f32_bf16 v81, v19, s56, v81
    v_dot2_f32_bf16 v82, v18, s57, v82
    v_dot2_f32_bf16 v83, v19, s57, v83
    v_dot2_f32_bf16 v84, v18, s58, v84
    v_dot2_f32_bf16 v85, v19, s58, v85
    v_dot2_f32_bf16 v86, v18, s59, v86
    v_dot2_f32_bf16 v87, v19, s59, v87
    v_dot2_f32_bf16 v72, v22, s76, v72
    v_dot2_f32_bf16 v73, v23, s76, v73
    v_dot2_f32_bf16 v74, v22, s77, v74
    v_dot2_f32_bf16 v75, v23, s77, v75
    v_dot2_f32_bf16 v76, v22, s78, v76
    v_dot2_f32_bf16 v77, v23, s78, v77
    v_dot2_f32_bf16 v78, v22, s79, v78
    v_dot2_f32_bf16 v79, v23, s79, v79
    v_dot2_f32_bf16 v80, v22, s60, v80
    v_dot2_f32_bf16 v81, v23, s60, v81
    v_dot2_f32_bf16 v82, v22, s61, v82
    v_dot2_f32_bf16 v83, v23, s61, v83
    v_dot2_f32_bf16 v84, v22, s62, v84
    v_dot2_f32_bf16 v85, v23, s62, v85
    v_dot2_f32_bf16 v86, v22, s63, v86
    v_dot2_f32_bf16 v87, v23, s63, v87
    v_dot2_f32_bf16 v72, v26, s80, v72
    v_dot2_f32_bf16 v73, v27, s80, v73
    v_dot2_f32_bf16 v74, v26, s81, v74
    v_dot2_f32_bf16 v75, v27, s81, v75
    v_dot2_f32_bf16 v76, v26, s82, v76
    v_dot2_f32_bf16 v77, v27, s82, v77
    v_dot2_f32_bf16 v78, v26, s83, v78
    v_dot2_f32_bf16 v79, v27, s83, v79
    v_dot2_f32_bf16 v80, v26, s64, v80
    v_dot2_f32_bf16 v81, v27, s64, v81
    v_dot2_f32_bf16 v82, v26, s65, v82
    v_dot2_f32_bf16 v83, v27, s65, v83
    v_dot2_f32_bf16 v84, v26, s66, v84
    v_dot2_f32_bf16 v85, v27, s66, v85
    v_dot2_f32_bf16 v86, v26, s67, v86
    v_dot2_f32_bf16 v87, v27, s67, v87
    s_cmp_ge_u32 s13, 4
    s_cbranch_scc1 L_p2_kernel_g1_30
    v_lshlrev_b32 v30, 16, v61
    v_and_b32 v31, 0xffff0000, v61
    v_pk_add_f32 v[14:15], v[30:31], v[36:37] op_sel:[0,0] op_sel_hi:[1,0] neg_lo:[0,1] neg_hi:[0,1]
    v_pk_add_f32 v[16:17], v[30:31], v[36:37] op_sel:[0,1] op_sel_hi:[1,1] neg_lo:[0,1] neg_hi:[0,1]
    v_pk_add_f32 v[18:19], v[30:31], v[38:39] op_sel:[0,0] op_sel_hi:[1,0] neg_lo:[0,1] neg_hi:[0,1]
    v_pk_add_f32 v[20:21], v[30:31], v[38:39] op_sel:[0,1] op_sel_hi:[1,1] neg_lo:[0,1] neg_hi:[0,1]
    v_pk_add_f32 v[22:23], v[30:31], v[40:41] op_sel:[0,0] op_sel_hi:[1,0] neg_lo:[0,1] neg_hi:[0,1]
    v_pk_add_f32 v[24:25], v[30:31], v[40:41] op_sel:[0,1] op_sel_hi:[1,1] neg_lo:[0,1] neg_hi:[0,1]
    v_pk_add_f32 v[26:27], v[30:31], v[42:43] op_sel:[0,0] op_sel_hi:[1,0] neg_lo:[0,1] neg_hi:[0,1]
    v_pk_add_f32 v[28:29], v[30:31], v[42:43] op_sel:[0,1] op_sel_hi:[1,1] neg_lo:[0,1] neg_hi:[0,1]
    v_cvt_pk_bf16_f32 v32, v14, v15
    v_lshlrev_b32 v14, 16, v32
    v_and_b32 v15, 0xffff0000, v32
    v_cvt_pk_bf16_f32 v32, v16, v17
    v_lshlrev_b32 v16, 16, v32
    v_and_b32 v17, 0xffff0000, v32
    v_cvt_pk_bf16_f32 v32, v18, v19
    v_lshlrev_b32 v18, 16, v32
    v_and_b32 v19, 0xffff0000, v32
    v_cvt_pk_bf16_f32 v32, v20, v21
    v_lshlrev_b32 v20, 16, v32
    v_and_b32 v21, 0xffff0000, v32
    v_cvt_pk_bf16_f32 v32, v22, v23
    v_lshlrev_b32 v22, 16, v32
    v_and_b32 v23, 0xffff0000, v32
    v_cvt_pk_bf16_f32 v32, v24, v25
    v_lshlrev_b32 v24, 16, v32
    v_and_b32 v25, 0xffff0000, v32
    v_cvt_pk_bf16_f32 v32, v26, v27
    v_lshlrev_b32 v26, 16, v32
    v_and_b32 v27, 0xffff0000, v32
    v_cvt_pk_bf16_f32 v32, v28, v29
    v_lshlrev_b32 v28, 16, v32
    v_and_b32 v29, 0xffff0000, v32
    v_pk_mul_f32 v[14:15], v[14:15], v[14:15]
    v_pk_mul_f32 v[16:17], v[16:17], v[16:17]
    v_pk_mul_f32 v[18:19], v[18:19], v[18:19]
    v_pk_mul_f32 v[20:21], v[20:21], v[20:21]
    v_pk_mul_f32 v[22:23], v[22:23], v[22:23]
    v_pk_mul_f32 v[24:25], v[24:25], v[24:25]
    v_pk_mul_f32 v[26:27], v[26:27], v[26:27]
    v_pk_mul_f32 v[28:29], v[28:29], v[28:29]
    v_cvt_pk_bf16_f32 v32, v14, v15
    v_lshlrev_b32 v14, 16, v32
    v_and_b32 v15, 0xffff0000, v32
    v_cvt_pk_bf16_f32 v32, v16, v17
    v_lshlrev_b32 v16, 16, v32
    v_and_b32 v17, 0xffff0000, v32
    v_cvt_pk_bf16_f32 v32, v18, v19
    v_lshlrev_b32 v18, 16, v32
    v_and_b32 v19, 0xffff0000, v32
    v_cvt_pk_bf16_f32 v32, v20, v21
    v_lshlrev_b32 v20, 16, v32
    v_and_b32 v21, 0xffff0000, v32
    v_cvt_pk_bf16_f32 v32, v22, v23
    v_lshlrev_b32 v22, 16, v32
    v_and_b32 v23, 0xffff0000, v32
    v_cvt_pk_bf16_f32 v32, v24, v25
    v_lshlrev_b32 v24, 16, v32
    v_and_b32 v25, 0xffff0000, v32
    v_cvt_pk_bf16_f32 v32, v26, v27
    v_lshlrev_b32 v26, 16, v32
    v_and_b32 v27, 0xffff0000, v32
    v_cvt_pk_bf16_f32 v32, v28, v29
    v_lshlrev_b32 v28, 16, v32
    v_and_b32 v29, 0xffff0000, v32
    v_mov_b32 v30, 1092616192
    v_mov_b32 v31, 0x3fb8aa3b
    v_pk_mul_f32 v[14:15], v[14:15], v[30:31] op_sel:[0,0] op_sel_hi:[1,0]
    v_pk_mul_f32 v[16:17], v[16:17], v[30:31] op_sel:[0,0] op_sel_hi:[1,0]
    v_pk_mul_f32 v[18:19], v[18:19], v[30:31] op_sel:[0,0] op_sel_hi:[1,0]
    v_pk_mul_f32 v[20:21], v[20:21], v[30:31] op_sel:[0,0] op_sel_hi:[1,0]
    v_pk_mul_f32 v[22:23], v[22:23], v[30:31] op_sel:[0,0] op_sel_hi:[1,0]
    v_pk_mul_f32 v[24:25], v[24:25], v[30:31] op_sel:[0,0] op_sel_hi:[1,0]
    v_pk_mul_f32 v[26:27], v[26:27], v[30:31] op_sel:[0,0] op_sel_hi:[1,0]
    v_pk_mul_f32 v[28:29], v[28:29], v[30:31] op_sel:[0,0] op_sel_hi:[1,0]
    v_cvt_pk_bf16_f32 v32, v14, v15
    v_lshlrev_b32 v14, 16, v32
    v_and_b32 v15, 0xffff0000, v32
    v_cvt_pk_bf16_f32 v32, v16, v17
    v_lshlrev_b32 v16, 16, v32
    v_and_b32 v17, 0xffff0000, v32
    v_cvt_pk_bf16_f32 v32, v18, v19
    v_lshlrev_b32 v18, 16, v32
    v_and_b32 v19, 0xffff0000, v32
    v_cvt_pk_bf16_f32 v32, v20, v21
    v_lshlrev_b32 v20, 16, v32
    v_and_b32 v21, 0xffff0000, v32
    v_cvt_pk_bf16_f32 v32, v22, v23
    v_lshlrev_b32 v22, 16, v32
    v_and_b32 v23, 0xffff0000, v32
    v_cvt_pk_bf16_f32 v32, v24, v25
    v_lshlrev_b32 v24, 16, v32
    v_and_b32 v25, 0xffff0000, v32
    v_cvt_pk_bf16_f32 v32, v26, v27
    v_lshlrev_b32 v26, 16, v32
    v_and_b32 v27, 0xffff0000, v32
    v_cvt_pk_bf16_f32 v32, v28, v29
    v_lshlrev_b32 v28, 16, v32
    v_and_b32 v29, 0xffff0000, v32
    v_pk_mul_f32 v[14:15], v[14:15], v[30:31] op_sel:[0,1] op_sel_hi:[1,1]
    v_pk_mul_f32 v[16:17], v[16:17], v[30:31] op_sel:[0,1] op_sel_hi:[1,1]
    v_pk_mul_f32 v[18:19], v[18:19], v[30:31] op_sel:[0,1] op_sel_hi:[1,1]
    v_pk_mul_f32 v[20:21], v[20:21], v[30:31] op_sel:[0,1] op_sel_hi:[1,1]
    v_pk_mul_f32 v[22:23], v[22:23], v[30:31] op_sel:[0,1] op_sel_hi:[1,1]
    v_pk_mul_f32 v[24:25], v[24:25], v[30:31] op_sel:[0,1] op_sel_hi:[1,1]
    v_pk_mul_f32 v[26:27], v[26:27], v[30:31] op_sel:[0,1] op_sel_hi:[1,1]
    v_pk_mul_f32 v[28:29], v[28:29], v[30:31] op_sel:[0,1] op_sel_hi:[1,1]
    v_exp_f32 v14, -v14
    v_exp_f32 v15, -v15
    v_exp_f32 v16, -v16
    v_exp_f32 v17, -v17
    v_exp_f32 v18, -v18
    v_exp_f32 v19, -v19
    v_exp_f32 v20, -v20
    v_exp_f32 v21, -v21
    v_exp_f32 v22, -v22
    v_exp_f32 v23, -v23
    v_exp_f32 v24, -v24
    v_exp_f32 v25, -v25
    v_exp_f32 v26, -v26
    v_exp_f32 v27, -v27
    v_exp_f32 v28, -v28
    v_exp_f32 v29, -v29
    v_cvt_pk_bf16_f32 v14, v14, v16
    v_cvt_pk_bf16_f32 v15, v15, v17
    v_cvt_pk_bf16_f32 v18, v18, v20
    v_cvt_pk_bf16_f32 v19, v19, v21
    v_cvt_pk_bf16_f32 v22, v22, v24
    v_cvt_pk_bf16_f32 v23, v23, v25
    v_cvt_pk_bf16_f32 v26, v26, v28
    v_cvt_pk_bf16_f32 v27, v27, v29
    v_dot2_f32_bf16 v112, v14, s68, 0
    v_dot2_f32_bf16 v113, v15, s68, 0
    v_dot2_f32_bf16 v114, v14, s69, 0
    v_dot2_f32_bf16 v115, v15, s69, 0
    v_dot2_f32_bf16 v116, v14, s70, 0
    v_dot2_f32_bf16 v117, v15, s70, 0
    v_dot2_f32_bf16 v118, v14, s71, 0
    v_dot2_f32_bf16 v119, v15, s71, 0
    v_dot2_f32_bf16 v120, v14, s52, 0
    v_dot2_f32_bf16 v121, v15, s52, 0
    v_dot2_f32_bf16 v122, v14, s53, 0
    v_dot2_f32_bf16 v123, v15, s53, 0
    v_dot2_f32_bf16 v124, v14, s54, 0
    v_dot2_f32_bf16 v125, v15, s54, 0
    v_dot2_f32_bf16 v126, v14, s55, 0
    v_dot2_f32_bf16 v127, v15, s55, 0
    v_dot2_f32_bf16 v112, v18, s72, v112
    v_dot2_f32_bf16 v113, v19, s72, v113
    v_dot2_f32_bf16 v114, v18, s73, v114
    v_dot2_f32_bf16 v115, v19, s73, v115
    v_dot2_f32_bf16 v116, v18, s74, v116
    v_dot2_f32_bf16 v117, v19, s74, v117
    v_dot2_f32_bf16 v118, v18, s75, v118
    v_dot2_f32_bf16 v119, v19, s75, v119
    v_dot2_f32_bf16 v120, v18, s56, v120
    v_dot2_f32_bf16 v121, v19, s56, v121
    v_dot2_f32_bf16 v122, v18, s57, v122
    v_dot2_f32_bf16 v123, v19, s57, v123
    v_dot2_f32_bf16 v124, v18, s58, v124
    v_dot2_f32_bf16 v125, v19, s58, v125
    v_dot2_f32_bf16 v126, v18, s59, v126
    v_dot2_f32_bf16 v127, v19, s59, v127
    v_dot2_f32_bf16 v112, v22, s76, v112
    v_dot2_f32_bf16 v113, v23, s76, v113
    v_dot2_f32_bf16 v114, v22, s77, v114
    v_dot2_f32_bf16 v115, v23, s77, v115
    v_dot2_f32_bf16 v116, v22, s78, v116
    v_dot2_f32_bf16 v117, v23, s78, v117
    v_dot2_f32_bf16 v118, v22, s79, v118
    v_dot2_f32_bf16 v119, v23, s79, v119
    v_dot2_f32_bf16 v120, v22, s60, v120
    v_dot2_f32_bf16 v121, v23, s60, v121
    v_dot2_f32_bf16 v122, v22, s61, v122
    v_dot2_f32_bf16 v123, v23, s61, v123
    v_dot2_f32_bf16 v124, v22, s62, v124
    v_dot2_f32_bf16 v125, v23, s62, v125
    v_dot2_f32_bf16 v126, v22, s63, v126
    v_dot2_f32_bf16 v127, v23, s63, v127
    v_dot2_f32_bf16 v112, v26, s80, v112
    v_dot2_f32_bf16 v113, v27, s80, v113
    v_dot2_f32_bf16 v114, v26, s81, v114
    v_dot2_f32_bf16 v115, v27, s81, v115
    v_dot2_f32_bf16 v116, v26, s82, v116
    v_dot2_f32_bf16 v117, v27, s82, v117
    v_dot2_f32_bf16 v118, v26, s83, v118
    v_dot2_f32_bf16 v119, v27, s83, v119
    v_dot2_f32_bf16 v120, v26, s64, v120
    v_dot2_f32_bf16 v121, v27, s64, v121
    v_dot2_f32_bf16 v122, v26, s65, v122
    v_dot2_f32_bf16 v123, v27, s65, v123
    v_dot2_f32_bf16 v124, v26, s66, v124
    v_dot2_f32_bf16 v125, v27, s66, v125
    v_dot2_f32_bf16 v126, v26, s67, v126
    v_dot2_f32_bf16 v127, v27, s67, v127
L_p2_kernel_g1_30:
    s_lshl2_add_u32 s14, s3, s49
    s_mul_i32 s26, s14, 20000
    s_mov_b32 s10, 5120000
    buffer_load_dwordx4 v[64:67], v1, s[8:11], s26 offen
    buffer_load_dwordx4 v[68:71], v2, s[8:11], s26 offen
    s_branch L_p2_fin
L_p2_done:
    s_branch L_p2_end
L_p2_slow:
    s_barrier
    v_mov_b32 v8, 0
    v_mov_b32 v9, 0
    v_mov_b32 v10, 0
    v_mov_b32 v11, 0
    v_mov_b32 v12, v1
    ds_write_b128 v12, v[8:11]
    v_add_u32 v12, 16384, v12
    ds_write_b128 v12, v[8:11]
    v_add_u32 v12, 16384, v12
    ds_write_b128 v12, v[8:11]
    v_add_u32 v12, 16384, v12
    ds_write_b128 v12, v[8:11]
    v_add_u32 v12, 16384, v12
    ds_write_b128 v12, v[8:11]
    v_add_u32 v12, 16384, v12
    ds_write_b128 v12, v[8:11]
    v_add_u32 v12, 16384, v12
    ds_write_b128 v12, v[8:11]
    v_add_u32 v12, 16384, v12
    ds_write_b128 v12, v[8:11]
    v_add_u32 v12, 16384, v12
    ds_write_b128 v12, v[8:11]
    v_add_u32 v12, 16384, v12
    ds_write_b128 v12, v[8:11]
    v_add_u32 v12, 16384, v12
    v_mul_u32_u24 v13, 8320, v0
    v_mov_b32 v29, 0x7fc00000
    v_add_u32 v28, 32, v13
    v_lshlrev_b32 v14, 10, v0
    v_add_u32 v14, 9437184, v14
    s_mul_i32 s25, s12, 65
    s_add_u32 s25, s25, s3
    s_lshl_b32 s25, s25, 5
    s_add_u32 s25, s25, 0
    s_lshl_b32 s50, s50, 1
    s_mul_i32 s22, s12, 1280000
    s_mov_b32 s24, 0
    s_waitcnt lgkmcnt(0)
    s_barrier
L_p2_sstep:
    buffer_load_ushort v15, v13, s[4:7], s25 offen
    buffer_load_ushort v16, v28, s[4:7], s25 offen
    s_waitcnt vmcnt(0)
L_p2_srec:
    v_cmp_lt_u32 vcc, v15, v16
    s_nop 1
    s_and_b64 exec, exec, vcc
    s_cbranch_execz L_p2_sdone
    v_mul_u32_u24 v17, 43691, v15
    v_lshrrev_b32 v17, 17, v17
    v_mad_i32_i24 v18, v17, -3, v15
    v_lshrrev_b32 v19, 6, v17
    v_lshl_add_u32 v19, v19, 20, v14
    v_and_b32 v17, 63, v17
    v_lshl_add_u32 v17, v17, 4, v19
    v_lshl_add_u32 v19, v18, 2, v17
    buffer_load_dword v20, v19, s[4:7], 0 offen
    buffer_load_dword v21, v17, s[4:7], 0 offen offset:12
    v_add_u32 v15, 1, v15
    v_mad_u32_u24 v18, v18, 10, 2
    s_waitcnt vmcnt(0)
    v_and_b32 v19, 0x3fff, v20
    v_lshlrev_b32 v19, 3, v19
    buffer_load_dwordx2 v[22:23], v19, s[8:11], s22 offen
    v_mad_u32_u16 v20, v20, 16, s50 op_sel:[1,0,0,0]
    v_bfe_i32 v21, v21, v18, 10
    v_cmp_eq_i32 vcc, -512, v21
    v_cvt_f32_i32 v21, v21
    v_mul_f32 v21, 989872160, v21
    v_cndmask_b32 v21, v21, v29, vcc
    s_waitcnt vmcnt(0)
    v_lshlrev_b32 v24, 16, v22
    v_and_b32 v25, 0xffff0000, v22
    v_lshlrev_b32 v26, 16, v23
    v_and_b32 v27, 0xffff0000, v23
    v_mul_f32 v24, v21, v24
    v_mul_f32 v25, v21, v25
    v_mul_f32 v26, v21, v26
    v_mul_f32 v27, v21, v27
    ds_add_f32 v20, v24
    ds_add_f32 v20, v25 offset:4
    ds_add_f32 v20, v26 offset:8
    ds_add_f32 v20, v27 offset:12
    s_branch L_p2_srec
L_p2_sdone:
    s_mov_b64 exec, -1
    s_add_u32 s25, s25, 2
    s_add_u32 s22, s22, 80000
    s_add_u32 s24, s24, 1
    s_cmp_lt_u32 s24, 16
    s_cbranch_scc1 L_p2_sstep
    s_waitcnt lgkmcnt(0)
    s_barrier
    s_mul_i32 s14, s12, 10240000
    s_mul_i32 s15, s3, 160000
    s_add_u32 s26, s14, s15
    s_add_u32 s26, s26, 249069568
    v_mov_b32 v12, v1
    s_mov_b32 s24, 0
L_p2_sout:
    v_cmp_gt_u32 vcc, 160000, v12
    ds_read_b128 v[8:11], v12
    s_nop 0
    s_and_b64 exec, exec, vcc
    s_cbranch_execz L_p2_sfin
    s_waitcnt lgkmcnt(0)
    buffer_store_dwordx4 v[8:11], v12, s[4:7], s26 offen sc1
    s_waitcnt vmcnt(0)
    v_add_u32 v12, 16384, v12
    s_branch L_p2_sout
L_p2_sfin:
    s_mov_b64 exec, -1
    s_waitcnt vmcnt(0) lgkmcnt(0)
    s_barrier
    s_branch L_p2_signal
L_p2_end:
    s_endpgm
.section .rodata,"a"
.p2align 6
.amdhsa_kernel p1_kernel
  .amdhsa_next_free_vgpr 128
  .amdhsa_next_free_sgpr 96
  .amdhsa_accum_offset 128
  .amdhsa_group_segment_fixed_size 0
  .amdhsa_kernarg_size 112
  .amdhsa_user_sgpr_count 2
  .amdhsa_user_sgpr_kernarg_segment_ptr 1
  .amdhsa_system_sgpr_workgroup_id_x 1
  .amdhsa_float_denorm_mode_32 0
.end_amdhsa_kernel
.p2align 6
.amdhsa_kernel p2_kernel
  .amdhsa_next_free_vgpr 128
  .amdhsa_next_free_sgpr 102
  .amdhsa_accum_offset 128
  .amdhsa_group_segment_fixed_size 0
  .amdhsa_kernarg_size 112
  .amdhsa_user_sgpr_count 2
  .amdhsa_user_sgpr_kernarg_segment_ptr 1
  .amdhsa_system_sgpr_workgroup_id_x 1
  .amdhsa_float_denorm_mode_32 0
.end_amdhsa_kernel
```

```asm
; @launch kernel=p1_kernel grid=(256,1,1) block=(1024,1,1) lds=163840
; @launch kernel=p2_kernel grid=(256,1,1) block=(1024,1,1) lds=163840
.amdgcn_target "amdgcn-amd-amdhsa--gfx950"
.text
.globl p1_kernel
.p2align 8
.type p1_kernel,@function
p1_kernel:
    s_cmp_ge_u32 s2, 256
    s_cbranch_scc1 L_p1_end
    s_load_dwordx2 s[4:5], s[0:1], 104
    s_load_dwordx2 s[8:9], s[0:1], 8
    s_load_dwordx2 s[12:13], s[0:1], 16
    s_load_dwordx2 s[16:17], s[0:1], 32
    s_load_dwordx2 s[28:29], s[0:1], 0
    s_load_dwordx2 s[6:7], s[0:1], 48
    v_cmp_gt_u32 vcc, 256, v0
    s_nop 1
    s_cbranch_vccz L_p1_nopf
    s_getpc_b64 s[72:73]
L_p1_kernel_pc_1:
    s_add_u32 s72, s72, L_p1_nopf-L_p1_kernel_pc_1
    s_addc_u32 s73, s73, 0
    v_lshlrev_b32 v14, 7, v0
    v_min_u32 v14, L_p2_end-L_p1_nopf, v14
    global_load_dword v15, v14, s[72:73]
L_p1_nopf:
    v_lshlrev_b32 v1, 4, v0
    v_lshlrev_b32 v2, 3, v0
    v_lshrrev_b32 v6, 6, v0
    v_mul_u32_u24 v3, 851904, v6
    v_add_lshl_u32 v3, v3, v0, 4
    v_mov_b32 v4, 1
    v_mov_b32 v5, 0
    v_readfirstlane_b32 s39, v6
    v_cmp_gt_u32 vcc, 784, v0
    s_and_b32 s51, s2, 7
    s_lshl_b32 s51, s51, 0
    s_bfe_u32 s35, s2, 3
    s_add_u32 s51, s51, s35
    s_and_b32 s35, s2, 248
    s_add_u32 s51, s51, s35
    s_and_b32 s32, s2, 7
    s_lshl_b32 s32, s32, 2
    s_bfe_u32 s35, s2, 131075
    s_add_u32 s32, s32, s35
    s_and_b32 s35, s2, 224
    s_add_u32 s32, s32, s35
    s_lshr_b32 s35, s39, 4
    s_mul_i32 s36, s35, 4177920
    s_lshl_b32 s33, s51, 14
    s_add_u32 s33, s33, s36
    s_lshr_b32 s34, s33, 1
    s_mul_i32 s48, s51, 3840
    s_cmp_ge_u32 s35, 0
    s_cselect_b32 s48, s48, 0
    s_lshr_b32 s49, s48, 1
    s_mov_b64 s[44:45], vcc
    s_waitcnt lgkmcnt(0)
    s_load_dword s3, s[6:7], 0
    s_mov_b32 s10, 163840000
    s_mov_b32 s11, 0x00020000
    s_mov_b32 s14, 163840000
    s_mov_b32 s15, 0x00020000
    s_mov_b32 s18, 81920000
    s_mov_b32 s19, 0x00020000
    s_mul_i32 s36, s2, 20000
    s_add_u32 s30, s36, 20000
    s_mov_b32 s31, 0x00020000
    s_add_u32 s35, s36, 16384
    buffer_load_dwordx4 v[48:51], v1, s[28:31], s36 offen
    buffer_load_dwordx4 v[52:55], v1, s[28:31], s35 offen
    s_add_u32 s35, s33, 0
    buffer_load_dwordx4 v[16:19], v1, s[8:11], s35 offen nt
    s_add_u32 s35, s33, 0
    buffer_load_dwordx4 v[20:23], v1, s[12:15], s35 offen nt
    s_add_u32 s35, s33, 4194304
    buffer_load_dwordx4 v[24:27], v1, s[8:11], s35 offen nt
    s_add_u32 s35, s33, 4194304
    buffer_load_dwordx4 v[28:31], v1, s[12:15], s35 offen nt
    s_add_u32 s35, s33, 8388608
    buffer_load_dwordx4 v[32:35], v1, s[8:11], s35 offen nt
    s_add_u32 s35, s33, 8388608
    buffer_load_dwordx4 v[36:39], v1, s[12:15], s35 offen nt
    s_add_u32 s35, s33, 12582912
    buffer_load_dwordx4 v[40:43], v1, s[8:11], s35 offen nt
    s_add_u32 s35, s33, 12582912
    buffer_load_dwordx4 v[44:47], v1, s[12:15], s35 offen nt
    s_add_u32 s35, s33, 16777216
    buffer_load_dwordx4 v[72:75], v1, s[8:11], s35 offen nt
    s_add_u32 s35, s33, 16777216
    buffer_load_dwordx4 v[76:79], v1, s[12:15], s35 offen nt
    s_mov_b32 s20, s4
    s_mov_b32 s21, s5
    s_mov_b32 s22, 0
    s_mov_b32 s23, 0x00020000
    s_add_u32 s24, s4, 0
    s_addc_u32 s25, s5, 0
    s_mov_b32 s26, 8540160
    s_mov_b32 s27, 0x00020000
    s_mov_b32 s37, 1492179184
    s_mov_b32 s55, 0
    s_mov_b32 s50, 21845
    s_mov_b32 s52, 0x8000
    s_mov_b32 s38, 262400
    s_mov_b32 s43, 0x05040100
    s_mov_b32 s40, 0
    v_mov_b32 v8, 0
    v_mov_b32 v9, 0
    v_mov_b32 v10, 0
    v_mov_b32 v11, 0
    ds_write_b128 v1, v[8:11] offset:0
    s_waitcnt lgkmcnt(0)
    s_lshl_b32 s3, s3, 16
    v_mov_b32 v12, s3
    v_mul_f32 v12, 0.15915494, v12
    s_nop 0
    v_readfirstlane_b32 s41, v12
    s_waitcnt vmcnt(10)
    v_mov_b32 v12, 0x3f803f80
    v_and_b32 v48, 0x7fff7fff, v48
    v_and_b32 v49, 0x7fff7fff, v49
    v_and_b32 v50, 0x7fff7fff, v50
    v_and_b32 v51, 0x7fff7fff, v51
    v_and_b32 v52, 0x7fff7fff, v52
    v_and_b32 v53, 0x7fff7fff, v53
    v_and_b32 v54, 0x7fff7fff, v54
    v_and_b32 v55, 0x7fff7fff, v55
    v_pk_max_u16 v8, v8, v48
    v_dot2c_f32_bf16 v9, v48, v12
    v_pk_max_u16 v8, v8, v49
    v_dot2c_f32_bf16 v9, v49, v12
    v_pk_max_u16 v8, v8, v50
    v_dot2c_f32_bf16 v9, v50, v12
    v_pk_max_u16 v8, v8, v51
    v_dot2c_f32_bf16 v9, v51, v12
    v_pk_max_u16 v8, v8, v52
    v_dot2c_f32_bf16 v9, v52, v12
    v_pk_max_u16 v8, v8, v53
    v_dot2c_f32_bf16 v9, v53, v12
    v_pk_max_u16 v8, v8, v54
    v_dot2c_f32_bf16 v9, v54, v12
    v_pk_max_u16 v8, v8, v55
    v_dot2c_f32_bf16 v9, v55, v12
    v_lshrrev_b32 v10, 16, v8
    v_and_b32 v8, 0xffff, v8
    v_max_u32 v8, v8, v10
    s_nop 0
    s_nop 1
    v_max_u32_dpp v8, v8, v8 row_shr:1 row_mask:0xf bank_mask:0xf bound_ctrl:0
    s_nop 1
    v_max_u32_dpp v8, v8, v8 row_shr:2 row_mask:0xf bank_mask:0xf bound_ctrl:0
    s_nop 1
    v_max_u32_dpp v8, v8, v8 row_shr:4 row_mask:0xf bank_mask:0xf bound_ctrl:0
    s_nop 1
    v_max_u32_dpp v8, v8, v8 row_shr:8 row_mask:0xf bank_mask:0xf bound_ctrl:0
    s_nop 1
    v_max_u32_dpp v8, v8, v8 row_bcast:15 row_mask:0xa bank_mask:0xf
    s_nop 1
    v_max_u32_dpp v8, v8, v8 row_bcast:31 row_mask:0xc bank_mask:0xf
    s_nop 1
    v_add_f32_dpp v9, v9, v9 row_shr:1 row_mask:0xf bank_mask:0xf bound_ctrl:0
    s_nop 1
    v_add_f32_dpp v9, v9, v9 row_shr:2 row_mask:0xf bank_mask:0xf bound_ctrl:0
    s_nop 1
    v_add_f32_dpp v9, v9, v9 row_shr:4 row_mask:0xf bank_mask:0xf bound_ctrl:0
    s_nop 1
    v_add_f32_dpp v9, v9, v9 row_shr:8 row_mask:0xf bank_mask:0xf bound_ctrl:0
    s_nop 1
    v_add_f32_dpp v9, v9, v9 row_bcast:15 row_mask:0xa bank_mask:0xf
    s_nop 1
    v_add_f32_dpp v9, v9, v9 row_bcast:31 row_mask:0xc bank_mask:0xf
    s_lshl_b32 s35, s39, 4
    s_add_u32 s35, s35, 160320
    v_mov_b32 v10, s35
    s_mov_b32 exec_lo, 0
    s_brev_b32 exec_hi, 1
    ds_write_b64 v10, v[8:9]
    s_mov_b64 exec, -1
    s_waitcnt lgkmcnt(0)
    s_barrier
    s_branch L_p1_first
L_p1_loop:
    s_getreg_b32 s51, hwreg(HW_REG_XCC_ID, 0, 1)
    s_cmp_eq_u32 s51, 0
    s_cselect_b64 vcc, -1, 0
    s_waitcnt lgkmcnt(13)
    v_lshlrev_b32 v15, 22, v100
    v_lshrrev_b32 v100, 16, v100
    v_alignbit_b32 v15, v100, v15, 10
    v_alignbit_b32 v15, v101, v15, 10
    v_xor_b32 v15, 0x80200800, v15
    s_cmp_lg_u32 s39, 15
    s_cbranch_scc1 L_p1_kernel_nox_2
    s_mov_b32 s36, 13631488
    buffer_store_dwordx4 v[12:15], v3, s[20:23], s36 offen sc1
L_p1_kernel_nox_2:
    s_waitcnt lgkmcnt(12)
    v_lshlrev_b32 v75, 22, v102
    v_lshrrev_b32 v102, 16, v102
    v_alignbit_b32 v75, v102, v75, 10
    v_alignbit_b32 v75, v103, v75, 10
    v_xor_b32 v75, 0x80200800, v75
    s_mov_b32 s36, 0
    buffer_store_dwordx4 v[72:75], v3, s[20:23], s36 offen sc1
    s_waitcnt lgkmcnt(11)
    v_lshlrev_b32 v79, 22, v104
    v_lshrrev_b32 v104, 16, v104
    v_alignbit_b32 v79, v104, v79, 10
    v_alignbit_b32 v79, v105, v79, 10
    v_xor_b32 v79, 0x80200800, v79
    s_mov_b32 s36, 1048576
    buffer_store_dwordx4 v[76:79], v3, s[20:23], s36 offen sc1
    s_waitcnt lgkmcnt(10)
    v_lshlrev_b32 v51, 22, v106
    v_lshrrev_b32 v106, 16, v106
    v_alignbit_b32 v51, v106, v51, 10
    v_alignbit_b32 v51, v107, v51, 10
    v_xor_b32 v51, 0x80200800, v51
    s_mov_b32 s36, 2097152
    buffer_store_dwordx4 v[48:51], v3, s[20:23], s36 offen sc1
    s_add_u32 s35, s33, 16777216
    buffer_load_dwordx4 v[72:75], v1, s[8:11], s35 offen nt
    s_add_u32 s35, s33, 16777216
    buffer_load_dwordx4 v[76:79], v1, s[12:15], s35 offen nt
    s_cbranch_vccz L_p1_kernel_thr_3
    s_waitcnt vmcnt(2)
L_p1_kernel_thr_3:
    s_waitcnt lgkmcnt(9)
    v_lshlrev_b32 v83, 22, v108
    v_lshrrev_b32 v108, 16, v108
    v_alignbit_b32 v83, v108, v83, 10
    v_alignbit_b32 v83, v109, v83, 10
    v_xor_b32 v83, 0x80200800, v83
    s_mov_b32 s36, 3145728
    buffer_store_dwordx4 v[80:83], v3, s[20:23], s36 offen sc1
    s_waitcnt lgkmcnt(8)
    v_lshlrev_b32 v55, 22, v110
    v_lshrrev_b32 v110, 16, v110
    v_alignbit_b32 v55, v110, v55, 10
    v_alignbit_b32 v55, v111, v55, 10
    v_xor_b32 v55, 0x80200800, v55
    s_mov_b32 s36, 4194304
    buffer_store_dwordx4 v[52:55], v3, s[20:23], s36 offen sc1
    s_add_u32 s35, s33, 20971520
    buffer_load_dwordx4 v[80:83], v1, s[8:11], s35 offen nt
    s_add_u32 s35, s33, 20971520
    buffer_load_dwordx4 v[100:103], v1, s[12:15], s35 offen nt
    s_cbranch_vccz L_p1_kernel_thr_4
    s_waitcnt vmcnt(2)
L_p1_kernel_thr_4:
    s_waitcnt lgkmcnt(7)
    v_lshlrev_b32 v87, 22, v112
    v_lshrrev_b32 v112, 16, v112
    v_alignbit_b32 v87, v112, v87, 10
    v_alignbit_b32 v87, v113, v87, 10
    v_xor_b32 v87, 0x80200800, v87
    s_mov_b32 s36, 5242880
    buffer_store_dwordx4 v[84:87], v3, s[20:23], s36 offen sc1
    s_waitcnt lgkmcnt(6)
    v_lshlrev_b32 v59, 22, v114
    v_lshrrev_b32 v114, 16, v114
    v_alignbit_b32 v59, v114, v59, 10
    v_alignbit_b32 v59, v115, v59, 10
    v_xor_b32 v59, 0x80200800, v59
    s_mov_b32 s36, 6291456
    buffer_store_dwordx4 v[56:59], v3, s[20:23], s36 offen sc1
    s_add_u32 s35, s33, 25165824
    buffer_load_dwordx4 v[84:87], v1, s[8:11], s35 offen nt
    s_add_u32 s35, s33, 25165824
    buffer_load_dwordx4 v[104:107], v1, s[12:15], s35 offen nt
    s_cbranch_vccz L_p1_kernel_thr_5
    s_waitcnt vmcnt(2)
L_p1_kernel_thr_5:
    s_waitcnt lgkmcnt(5)
    v_lshlrev_b32 v91, 22, v116
    v_lshrrev_b32 v116, 16, v116
    v_alignbit_b32 v91, v116, v91, 10
    v_alignbit_b32 v91, v117, v91, 10
    v_xor_b32 v91, 0x80200800, v91
    s_mov_b32 s36, 7340032
    buffer_store_dwordx4 v[88:91], v3, s[20:23], s36 offen sc1
    s_waitcnt lgkmcnt(4)
    v_lshlrev_b32 v63, 22, v118
    v_lshrrev_b32 v118, 16, v118
    v_alignbit_b32 v63, v118, v63, 10
    v_alignbit_b32 v63, v119, v63, 10
    v_xor_b32 v63, 0x80200800, v63
    s_mov_b32 s36, 8388608
    buffer_store_dwordx4 v[60:63], v3, s[20:23], s36 offen sc1
    s_add_u32 s35, s33, 29360128
    buffer_load_dwordx4 v[88:91], v1, s[8:11], s35 offen nt
    s_add_u32 s35, s33, 29360128
    buffer_load_dwordx4 v[108:111], v1, s[12:15], s35 offen nt
    s_cbranch_vccz L_p1_kernel_thr_6
    s_waitcnt vmcnt(2)
L_p1_kernel_thr_6:
    s_waitcnt lgkmcnt(3)
    v_lshlrev_b32 v95, 22, v120
    v_lshrrev_b32 v120, 16, v120
    v_alignbit_b32 v95, v120, v95, 10
    v_alignbit_b32 v95, v121, v95, 10
    v_xor_b32 v95, 0x80200800, v95
    s_mov_b32 s36, 9437184
    buffer_store_dwordx4 v[92:95], v3, s[20:23], s36 offen sc1
    s_waitcnt lgkmcnt(2)
    v_lshlrev_b32 v67, 22, v122
    v_lshrrev_b32 v122, 16, v122
    v_alignbit_b32 v67, v122, v67, 10
    v_alignbit_b32 v67, v123, v67, 10
    v_xor_b32 v67, 0x80200800, v67
    s_mov_b32 s36, 10485760
    buffer_store_dwordx4 v[64:67], v3, s[20:23], s36 offen sc1
    s_add_u32 s35, s33, 33554432
    buffer_load_dwordx4 v[92:95], v1, s[8:11], s35 offen nt
    s_add_u32 s35, s33, 33554432
    buffer_load_dwordx4 v[112:115], v1, s[12:15], s35 offen nt
    s_cbranch_vccz L_p1_kernel_thr_7
    s_waitcnt vmcnt(2)
L_p1_kernel_thr_7:
    s_waitcnt lgkmcnt(1)
    v_lshlrev_b32 v99, 22, v124
    v_lshrrev_b32 v124, 16, v124
    v_alignbit_b32 v99, v124, v99, 10
    v_alignbit_b32 v99, v125, v99, 10
    v_xor_b32 v99, 0x80200800, v99
    s_mov_b32 s36, 11534336
    buffer_store_dwordx4 v[96:99], v3, s[20:23], s36 offen sc1
    s_waitcnt lgkmcnt(0)
    v_lshlrev_b32 v71, 22, v126
    v_lshrrev_b32 v126, 16, v126
    v_alignbit_b32 v71, v126, v71, 10
    v_alignbit_b32 v71, v127, v71, 10
    v_xor_b32 v71, 0x80200800, v71
    s_mov_b32 s36, 12582912
    buffer_store_dwordx4 v[68:71], v3, s[20:23], s36 offen sc1
    s_add_u32 s35, s33, 37748736
    s_sub_u32 s35, s35, s48
    v_cndmask_b32 v96, 2.0, v1, s[44:45]
    buffer_load_dwordx4 v[96:99], v96, s[8:11], s35 offen nt
    s_add_u32 s35, s33, 37748736
    s_sub_u32 s35, s35, s48
    v_cndmask_b32 v116, 2.0, v1, s[44:45]
    buffer_load_dwordx4 v[116:119], v116, s[12:15], s35 offen nt
    s_cbranch_vccz L_p1_kernel_thr_8
    s_waitcnt vmcnt(2)
L_p1_kernel_thr_8:
    s_branch L_p1_join
L_p1_first:
    s_add_u32 s35, s33, 20971520
    buffer_load_dwordx4 v[80:83], v1, s[8:11], s35 offen nt
    s_add_u32 s35, s33, 20971520
    buffer_load_dwordx4 v[100:103], v1, s[12:15], s35 offen nt
    s_add_u32 s35, s33, 25165824
    buffer_load_dwordx4 v[84:87], v1, s[8:11], s35 offen nt
    s_add_u32 s35, s33, 25165824
    buffer_load_dwordx4 v[104:107], v1, s[12:15], s35 offen nt
    s_add_u32 s35, s33, 29360128
    buffer_load_dwordx4 v[88:91], v1, s[8:11], s35 offen nt
    s_add_u32 s35, s33, 29360128
    buffer_load_dwordx4 v[108:111], v1, s[12:15], s35 offen nt
    s_add_u32 s35, s33, 33554432
    buffer_load_dwordx4 v[92:95], v1, s[8:11], s35 offen nt
    s_add_u32 s35, s33, 33554432
    buffer_load_dwordx4 v[112:115], v1, s[12:15], s35 offen nt
    s_add_u32 s35, s33, 37748736
    s_sub_u32 s35, s35, s48
    v_cndmask_b32 v96, 2.0, v1, s[44:45]
    buffer_load_dwordx4 v[96:99], v96, s[8:11], s35 offen nt
    s_add_u32 s35, s33, 37748736
    s_sub_u32 s35, s35, s48
    v_cndmask_b32 v116, 2.0, v1, s[44:45]
    buffer_load_dwordx4 v[116:119], v116, s[12:15], s35 offen nt
L_p1_join:
    s_waitcnt vmcnt(18)
    v_perm_b32 v6, v20, v16, s43
    v_perm_b32 v7, v21, v17, s43
    v_perm_b32 v8, v22, v18, s43
    v_perm_b32 v9, v23, v19, s43
    v_mul_hi_u32_u24 v16, 429497, v16
    v_mul_hi_u32_u24 v20, 429497, v20
    v_mul_hi_u32_u24 v17, 429497, v17
    v_mul_hi_u32_u24 v21, 429497, v21
    v_mul_hi_u32_u24 v18, 429497, v18
    v_mul_hi_u32_u24 v22, 429497, v22
    v_mul_hi_u32_u24 v19, 429497, v19
    v_mul_hi_u32_u24 v23, 429497, v23
    v_lshl_or_b32 v16, v20, 16, v16
    v_lshl_or_b32 v17, v21, 16, v17
    v_lshl_or_b32 v18, v22, 16, v18
    v_lshl_or_b32 v19, v23, 16, v19
    v_dot2_u32_u16 v20, v16, s38, 0
    v_dot2_u32_u16 v21, v17, s38, 0
    v_dot2_u32_u16 v22, v18, s38, 0
    v_dot2_u32_u16 v23, v19, s38, 0
    v_pk_mad_u16 v6, v16, s37, v6
    v_pk_mad_u16 v7, v17, s37, v7
    v_pk_mad_u16 v8, v18, s37, v8
    v_pk_mad_u16 v9, v19, s37, v9
    ds_add_u32 v20, v4 offset:0
    ds_add_u32 v21, v4 offset:0
    ds_add_u32 v22, v4 offset:0
    ds_add_u32 v23, v4 offset:0
    v_pk_mad_u16 v6, v16, s52, v6 op_sel:[1,0,0] op_sel_hi:[1,1,1]
    v_pk_mad_u16 v7, v17, s52, v7 op_sel:[1,0,0] op_sel_hi:[1,1,1]
    v_pk_mad_u16 v8, v18, s52, v8 op_sel:[1,0,0] op_sel_hi:[1,1,1]
    v_pk_mad_u16 v9, v19, s52, v9 op_sel:[1,0,0] op_sel_hi:[1,1,1]
    v_perm_b32 v55, v23, v22, s43
    v_perm_b32 v51, v21, v20, s43
    v_or_b32 v48, 0x40000000, v6
    v_or_b32 v49, 0x40000000, v7
    v_or_b32 v50, 0x40000000, v8
    v_or_b32 v52, 0x40000000, v9
    s_waitcnt vmcnt(16)
    v_perm_b32 v6, v28, v24, s43
    v_perm_b32 v7, v29, v25, s43
    v_perm_b32 v8, v30, v26, s43
    v_perm_b32 v9, v31, v27, s43
    v_mul_hi_u32_u24 v24, 429497, v24
    v_mul_hi_u32_u24 v28, 429497, v28
    v_mul_hi_u32_u24 v25, 429497, v25
    v_mul_hi_u32_u24 v29, 429497, v29
    v_mul_hi_u32_u24 v26, 429497, v26
    v_mul_hi_u32_u24 v30, 429497, v30
    v_mul_hi_u32_u24 v27, 429497, v27
    v_mul_hi_u32_u24 v31, 429497, v31
    v_lshl_or_b32 v24, v28, 16, v24
    v_lshl_or_b32 v25, v29, 16, v25
    v_lshl_or_b32 v26, v30, 16, v26
    v_lshl_or_b32 v27, v31, 16, v27
    v_dot2_u32_u16 v28, v24, s38, 0
    v_dot2_u32_u16 v29, v25, s38, 0
    v_dot2_u32_u16 v30, v26, s38, 0
    v_dot2_u32_u16 v31, v27, s38, 0
    v_pk_mad_u16 v6, v24, s37, v6
    v_pk_mad_u16 v7, v25, s37, v7
    v_pk_mad_u16 v8, v26, s37, v8
    v_pk_mad_u16 v9, v27, s37, v9
    ds_add_u32 v28, v4 offset:0
    ds_add_u32 v29, v4 offset:0
    ds_add_u32 v30, v4 offset:0
    ds_add_u32 v31, v4 offset:0
    v_pk_mad_u16 v6, v24, s52, v6 op_sel:[1,0,0] op_sel_hi:[1,1,1]
    v_pk_mad_u16 v7, v25, s52, v7 op_sel:[1,0,0] op_sel_hi:[1,1,1]
    v_pk_mad_u16 v8, v26, s52, v8 op_sel:[1,0,0] op_sel_hi:[1,1,1]
    v_pk_mad_u16 v9, v27, s52, v9 op_sel:[1,0,0] op_sel_hi:[1,1,1]
    v_perm_b32 v63, v31, v30, s43
    v_perm_b32 v59, v29, v28, s43
    v_or_b32 v53, 0x40000000, v6
    v_or_b32 v54, 0x40000000, v7
    v_or_b32 v56, 0x40000000, v8
    v_or_b32 v57, 0x40000000, v9
    s_waitcnt vmcnt(14)
    v_perm_b32 v6, v36, v32, s43
    v_perm_b32 v7, v37, v33, s43
    v_perm_b32 v8, v38, v34, s43
    v_perm_b32 v9, v39, v35, s43
    v_mul_hi_u32_u24 v32, 429497, v32
    v_mul_hi_u32_u24 v36, 429497, v36
    v_mul_hi_u32_u24 v33, 429497, v33
    v_mul_hi_u32_u24 v37, 429497, v37
    v_mul_hi_u32_u24 v34, 429497, v34
    v_mul_hi_u32_u24 v38, 429497, v38
    v_mul_hi_u32_u24 v35, 429497, v35
    v_mul_hi_u32_u24 v39, 429497, v39
    v_lshl_or_b32 v32, v36, 16, v32
    v_lshl_or_b32 v33, v37, 16, v33
    v_lshl_or_b32 v34, v38, 16, v34
    v_lshl_or_b32 v35, v39, 16, v35
    v_dot2_u32_u16 v36, v32, s38, 0
    v_dot2_u32_u16 v37, v33, s38, 0
    v_dot2_u32_u16 v38, v34, s38, 0
    v_dot2_u32_u16 v39, v35, s38, 0
    v_pk_mad_u16 v6, v32, s37, v6
    v_pk_mad_u16 v7, v33, s37, v7
    v_pk_mad_u16 v8, v34, s37, v8
    v_pk_mad_u16 v9, v35, s37, v9
    ds_add_u32 v36, v4 offset:0
    ds_add_u32 v37, v4 offset:0
    ds_add_u32 v38, v4 offset:0
    ds_add_u32 v39, v4 offset:0
    v_pk_mad_u16 v6, v32, s52, v6 op_sel:[1,0,0] op_sel_hi:[1,1,1]
    v_pk_mad_u16 v7, v33, s52, v7 op_sel:[1,0,0] op_sel_hi:[1,1,1]
    v_pk_mad_u16 v8, v34, s52, v8 op_sel:[1,0,0] op_sel_hi:[1,1,1]
    v_pk_mad_u16 v9, v35, s52, v9 op_sel:[1,0,0] op_sel_hi:[1,1,1]
    v_perm_b32 v71, v39, v38, s43
    v_perm_b32 v67, v37, v36, s43
    v_or_b32 v58, 0x40000000, v6
    v_or_b32 v60, 0x40000000, v7
    v_or_b32 v61, 0x40000000, v8
    v_or_b32 v62, 0x40000000, v9
    s_waitcnt vmcnt(12)
    v_perm_b32 v6, v44, v40, s43
    v_perm_b32 v7, v45, v41, s43
    v_perm_b32 v8, v46, v42, s43
    v_perm_b32 v9, v47, v43, s43
    v_mul_hi_u32_u24 v40, 429497, v40
    v_mul_hi_u32_u24 v44, 429497, v44
    v_mul_hi_u32_u24 v41, 429497, v41
    v_mul_hi_u32_u24 v45, 429497, v45
    v_mul_hi_u32_u24 v42, 429497, v42
    v_mul_hi_u32_u24 v46, 429497, v46
    v_mul_hi_u32_u24 v43, 429497, v43
    v_mul_hi_u32_u24 v47, 429497, v47
    v_lshl_or_b32 v40, v44, 16, v40
    v_lshl_or_b32 v41, v45, 16, v41
    v_lshl_or_b32 v42, v46, 16, v42
    v_lshl_or_b32 v43, v47, 16, v43
    v_dot2_u32_u16 v44, v40, s38, 0
    v_dot2_u32_u16 v45, v41, s38, 0
    v_dot2_u32_u16 v46, v42, s38, 0
    v_dot2_u32_u16 v47, v43, s38, 0
    v_pk_mad_u16 v6, v40, s37, v6
    v_pk_mad_u16 v7, v41, s37, v7
    v_pk_mad_u16 v8, v42, s37, v8
    v_pk_mad_u16 v9, v43, s37, v9
    ds_add_u32 v44, v4 offset:0
    ds_add_u32 v45, v4 offset:0
    ds_add_u32 v46, v4 offset:0
    ds_add_u32 v47, v4 offset:0
    v_pk_mad_u16 v6, v40, s52, v6 op_sel:[1,0,0] op_sel_hi:[1,1,1]
    v_pk_mad_u16 v7, v41, s52, v7 op_sel:[1,0,0] op_sel_hi:[1,1,1]
    v_pk_mad_u16 v8, v42, s52, v8 op_sel:[1,0,0] op_sel_hi:[1,1,1]
    v_pk_mad_u16 v9, v43, s52, v9 op_sel:[1,0,0] op_sel_hi:[1,1,1]
    v_perm_b32 v121, v47, v46, s43
    v_perm_b32 v120, v45, v44, s43
    v_or_b32 v64, 0x40000000, v6
    v_or_b32 v65, 0x40000000, v7
    v_or_b32 v66, 0x40000000, v8
    v_or_b32 v68, 0x40000000, v9
    s_waitcnt vmcnt(10)
    v_perm_b32 v6, v76, v72, s43
    v_perm_b32 v7, v77, v73, s43
    v_perm_b32 v8, v78, v74, s43
    v_perm_b32 v9, v79, v75, s43
    v_mul_hi_u32_u24 v72, 429497, v72
    v_mul_hi_u32_u24 v76, 429497, v76
    v_mul_hi_u32_u24 v73, 429497, v73
    v_mul_hi_u32_u24 v77, 429497, v77
    v_mul_hi_u32_u24 v74, 429497, v74
    v_mul_hi_u32_u24 v78, 429497, v78
    v_mul_hi_u32_u24 v75, 429497, v75
    v_mul_hi_u32_u24 v79, 429497, v79
    v_lshl_or_b32 v72, v76, 16, v72
    v_lshl_or_b32 v73, v77, 16, v73
    v_lshl_or_b32 v74, v78, 16, v74
    v_lshl_or_b32 v75, v79, 16, v75
    v_dot2_u32_u16 v76, v72, s38, 0
    v_dot2_u32_u16 v77, v73, s38, 0
    v_dot2_u32_u16 v78, v74, s38, 0
    v_dot2_u32_u16 v79, v75, s38, 0
    v_pk_mad_u16 v6, v72, s37, v6
    v_pk_mad_u16 v7, v73, s37, v7
    v_pk_mad_u16 v8, v74, s37, v8
    v_pk_mad_u16 v9, v75, s37, v9
    ds_add_u32 v76, v4 offset:0
    ds_add_u32 v77, v4 offset:0
    ds_add_u32 v78, v4 offset:0
    ds_add_u32 v79, v4 offset:0
    v_pk_mad_u16 v6, v72, s52, v6 op_sel:[1,0,0] op_sel_hi:[1,1,1]
    v_pk_mad_u16 v7, v73, s52, v7 op_sel:[1,0,0] op_sel_hi:[1,1,1]
    v_pk_mad_u16 v8, v74, s52, v8 op_sel:[1,0,0] op_sel_hi:[1,1,1]
    v_pk_mad_u16 v9, v75, s52, v9 op_sel:[1,0,0] op_sel_hi:[1,1,1]
    v_perm_b32 v123, v79, v78, s43
    v_perm_b32 v122, v77, v76, s43
    v_or_b32 v69, 0x40000000, v6
    v_or_b32 v70, 0x40000000, v7
    v_or_b32 v127, 0x40000000, v8
    v_or_b32 v72, 0x40000000, v9
    s_waitcnt vmcnt(8)
    v_perm_b32 v6, v100, v80, s43
    v_perm_b32 v7, v101, v81, s43
    v_perm_b32 v8, v102, v82, s43
    v_perm_b32 v9, v103, v83, s43
    v_mul_hi_u32_u24 v80, 429497, v80
    v_mul_hi_u32_u24 v100, 429497, v100
    v_mul_hi_u32_u24 v81, 429497, v81
    v_mul_hi_u32_u24 v101, 429497, v101
    v_mul_hi_u32_u24 v82, 429497, v82
    v_mul_hi_u32_u24 v102, 429497, v102
    v_mul_hi_u32_u24 v83, 429497, v83
    v_mul_hi_u32_u24 v103, 429497, v103
    v_lshl_or_b32 v80, v100, 16, v80
    v_lshl_or_b32 v81, v101, 16, v81
    v_lshl_or_b32 v82, v102, 16, v82
    v_lshl_or_b32 v83, v103, 16, v83
    v_dot2_u32_u16 v100, v80, s38, 0
    v_dot2_u32_u16 v101, v81, s38, 0
    v_dot2_u32_u16 v102, v82, s38, 0
    v_dot2_u32_u16 v103, v83, s38, 0
    v_pk_mad_u16 v6, v80, s37, v6
    v_pk_mad_u16 v7, v81, s37, v7
    v_pk_mad_u16 v8, v82, s37, v8
    v_pk_mad_u16 v9, v83, s37, v9
    ds_add_u32 v100, v4 offset:0
    ds_add_u32 v101, v4 offset:0
    ds_add_u32 v102, v4 offset:0
    ds_add_u32 v103, v4 offset:0
    v_pk_mad_u16 v6, v80, s52, v6 op_sel:[1,0,0] op_sel_hi:[1,1,1]
    v_pk_mad_u16 v7, v81, s52, v7 op_sel:[1,0,0] op_sel_hi:[1,1,1]
    v_pk_mad_u16 v8, v82, s52, v8 op_sel:[1,0,0] op_sel_hi:[1,1,1]
    v_pk_mad_u16 v9, v83, s52, v9 op_sel:[1,0,0] op_sel_hi:[1,1,1]
    v_perm_b32 v125, v103, v102, s43
    v_perm_b32 v124, v101, v100, s43
    v_or_b32 v73, 0x40000000, v6
    v_or_b32 v74, 0x40000000, v7
    v_or_b32 v76, 0x40000000, v8
    v_or_b32 v77, 0x40000000, v9
    s_waitcnt vmcnt(6)
    v_perm_b32 v6, v104, v84, s43
    v_perm_b32 v7, v105, v85, s43
    v_perm_b32 v8, v106, v86, s43
    v_perm_b32 v9, v107, v87, s43
    v_mul_hi_u32_u24 v84, 429497, v84
    v_mul_hi_u32_u24 v104, 429497, v104
    v_mul_hi_u32_u24 v85, 429497, v85
    v_mul_hi_u32_u24 v105, 429497, v105
    v_mul_hi_u32_u24 v86, 429497, v86
    v_mul_hi_u32_u24 v106, 429497, v106
    v_mul_hi_u32_u24 v87, 429497, v87
    v_mul_hi_u32_u24 v107, 429497, v107
    v_lshl_or_b32 v84, v104, 16, v84
    v_lshl_or_b32 v85, v105, 16, v85
    v_lshl_or_b32 v86, v106, 16, v86
    v_lshl_or_b32 v87, v107, 16, v87
    v_dot2_u32_u16 v104, v84, s38, 0
    v_dot2_u32_u16 v105, v85, s38, 0
    v_dot2_u32_u16 v106, v86, s38, 0
    v_dot2_u32_u16 v107, v87, s38, 0
    v_pk_mad_u16 v6, v84, s37, v6
    v_pk_mad_u16 v7, v85, s37, v7
    v_pk_mad_u16 v8, v86, s37, v8
    v_pk_mad_u16 v9, v87, s37, v9
    ds_add_u32 v104, v4 offset:0
    ds_add_u32 v105, v4 offset:0
    ds_add_u32 v106, v4 offset:0
    ds_add_u32 v107, v4 offset:0
    v_pk_mad_u16 v6, v84, s52, v6 op_sel:[1,0,0] op_sel_hi:[1,1,1]
    v_pk_mad_u16 v7, v85, s52, v7 op_sel:[1,0,0] op_sel_hi:[1,1,1]
    v_pk_mad_u16 v8, v86, s52, v8 op_sel:[1,0,0] op_sel_hi:[1,1,1]
    v_pk_mad_u16 v9, v87, s52, v9 op_sel:[1,0,0] op_sel_hi:[1,1,1]
    v_perm_b32 v75, v107, v106, s43
    v_perm_b32 v126, v105, v104, s43
    v_or_b32 v78, 0x40000000, v6
    v_or_b32 v80, 0x40000000, v7
    v_or_b32 v81, 0x40000000, v8
    v_or_b32 v82, 0x40000000, v9
    s_waitcnt vmcnt(4)
    v_perm_b32 v6, v108, v88, s43
    v_perm_b32 v7, v109, v89, s43
    v_perm_b32 v8, v110, v90, s43
    v_perm_b32 v9, v111, v91, s43
    v_mul_hi_u32_u24 v88, 429497, v88
    v_mul_hi_u32_u24 v108, 429497, v108
    v_mul_hi_u32_u24 v89, 429497, v89
    v_mul_hi_u32_u24 v109, 429497, v109
    v_mul_hi_u32_u24 v90, 429497, v90
    v_mul_hi_u32_u24 v110, 429497, v110
    v_mul_hi_u32_u24 v91, 429497, v91
    v_mul_hi_u32_u24 v111, 429497, v111
    v_lshl_or_b32 v88, v108, 16, v88
    v_lshl_or_b32 v89, v109, 16, v89
    v_lshl_or_b32 v90, v110, 16, v90
    v_lshl_or_b32 v91, v111, 16, v91
    v_dot2_u32_u16 v108, v88, s38, 0
    v_dot2_u32_u16 v109, v89, s38, 0
    v_dot2_u32_u16 v110, v90, s38, 0
    v_dot2_u32_u16 v111, v91, s38, 0
    v_pk_mad_u16 v6, v88, s37, v6
    v_pk_mad_u16 v7, v89, s37, v7
    v_pk_mad_u16 v8, v90, s37, v8
    v_pk_mad_u16 v9, v91, s37, v9
    ds_add_u32 v108, v4 offset:0
    ds_add_u32 v109, v4 offset:0
    ds_add_u32 v110, v4 offset:0
    ds_add_u32 v111, v4 offset:0
    v_pk_mad_u16 v6, v88, s52, v6 op_sel:[1,0,0] op_sel_hi:[1,1,1]
    v_pk_mad_u16 v7, v89, s52, v7 op_sel:[1,0,0] op_sel_hi:[1,1,1]
    v_pk_mad_u16 v8, v90, s52, v8 op_sel:[1,0,0] op_sel_hi:[1,1,1]
    v_pk_mad_u16 v9, v91, s52, v9 op_sel:[1,0,0] op_sel_hi:[1,1,1]
    v_perm_b32 v83, v111, v110, s43
    v_perm_b32 v79, v109, v108, s43
    v_or_b32 v84, 0x40000000, v6
    v_or_b32 v85, 0x40000000, v7
    v_or_b32 v86, 0x40000000, v8
    v_or_b32 v88, 0x40000000, v9
    s_waitcnt vmcnt(2)
    v_perm_b32 v6, v112, v92, s43
    v_perm_b32 v7, v113, v93, s43
    v_perm_b32 v8, v114, v94, s43
    v_perm_b32 v9, v115, v95, s43
    v_mul_hi_u32_u24 v92, 429497, v92
    v_mul_hi_u32_u24 v112, 429497, v112
    v_mul_hi_u32_u24 v93, 429497, v93
    v_mul_hi_u32_u24 v113, 429497, v113
    v_mul_hi_u32_u24 v94, 429497, v94
    v_mul_hi_u32_u24 v114, 429497, v114
    v_mul_hi_u32_u24 v95, 429497, v95
    v_mul_hi_u32_u24 v115, 429497, v115
    v_lshl_or_b32 v92, v112, 16, v92
    v_lshl_or_b32 v93, v113, 16, v93
    v_lshl_or_b32 v94, v114, 16, v94
    v_lshl_or_b32 v95, v115, 16, v95
    v_dot2_u32_u16 v112, v92, s38, 0
    v_dot2_u32_u16 v113, v93, s38, 0
    v_dot2_u32_u16 v114, v94, s38, 0
    v_dot2_u32_u16 v115, v95, s38, 0
    v_pk_mad_u16 v6, v92, s37, v6
    v_pk_mad_u16 v7, v93, s37, v7
    v_pk_mad_u16 v8, v94, s37, v8
    v_pk_mad_u16 v9, v95, s37, v9
    ds_add_u32 v112, v4 offset:0
    ds_add_u32 v113, v4 offset:0
    ds_add_u32 v114, v4 offset:0
    ds_add_u32 v115, v4 offset:0
    v_pk_mad_u16 v6, v92, s52, v6 op_sel:[1,0,0] op_sel_hi:[1,1,1]
    v_pk_mad_u16 v7, v93, s52, v7 op_sel:[1,0,0] op_sel_hi:[1,1,1]
    v_pk_mad_u16 v8, v94, s52, v8 op_sel:[1,0,0] op_sel_hi:[1,1,1]
    v_pk_mad_u16 v9, v95, s52, v9 op_sel:[1,0,0] op_sel_hi:[1,1,1]
    v_perm_b32 v91, v115, v114, s43
    v_perm_b32 v87, v113, v112, s43
    v_or_b32 v89, 0x40000000, v6
    v_or_b32 v90, 0x40000000, v7
    v_or_b32 v92, 0x40000000, v8
    v_or_b32 v93, 0x40000000, v9
    s_waitcnt vmcnt(0)
    s_mov_b64 exec, s[44:45]
    v_perm_b32 v6, v116, v96, s43
    v_perm_b32 v7, v117, v97, s43
    v_perm_b32 v8, v118, v98, s43
    v_perm_b32 v9, v119, v99, s43
    v_mul_hi_u32_u24 v96, 429497, v96
    v_mul_hi_u32_u24 v116, 429497, v116
    v_mul_hi_u32_u24 v97, 429497, v97
    v_mul_hi_u32_u24 v117, 429497, v117
    v_mul_hi_u32_u24 v98, 429497, v98
    v_mul_hi_u32_u24 v118, 429497, v118
    v_mul_hi_u32_u24 v99, 429497, v99
    v_mul_hi_u32_u24 v119, 429497, v119
    v_lshl_or_b32 v96, v116, 16, v96
    v_lshl_or_b32 v97, v117, 16, v97
    v_lshl_or_b32 v98, v118, 16, v98
    v_lshl_or_b32 v99, v119, 16, v99
    v_dot2_u32_u16 v116, v96, s38, 0
    v_dot2_u32_u16 v117, v97, s38, 0
    v_dot2_u32_u16 v118, v98, s38, 0
    v_dot2_u32_u16 v119, v99, s38, 0
    v_pk_mad_u16 v6, v96, s37, v6
    v_pk_mad_u16 v7, v97, s37, v7
    v_pk_mad_u16 v8, v98, s37, v8
    v_pk_mad_u16 v9, v99, s37, v9
    ds_add_u32 v116, v4 offset:0
    ds_add_u32 v117, v4 offset:0
    ds_add_u32 v118, v4 offset:0
    ds_add_u32 v119, v4 offset:0
    v_pk_mad_u16 v6, v96, s52, v6 op_sel:[1,0,0] op_sel_hi:[1,1,1]
    v_pk_mad_u16 v7, v97, s52, v7 op_sel:[1,0,0] op_sel_hi:[1,1,1]
    v_pk_mad_u16 v8, v98, s52, v8 op_sel:[1,0,0] op_sel_hi:[1,1,1]
    v_pk_mad_u16 v9, v99, s52, v9 op_sel:[1,0,0] op_sel_hi:[1,1,1]
    v_perm_b32 v99, v119, v118, s43
    v_perm_b32 v95, v117, v116, s43
    v_or_b32 v94, 0x40000000, v6
    v_or_b32 v96, 0x40000000, v7
    v_or_b32 v97, 0x40000000, v8
    v_or_b32 v98, 0x40000000, v9
    s_mov_b64 exec, -1
    s_add_u32 s35, s34, 0
    buffer_load_dwordx2 v[100:101], v2, s[16:19], s35 offen nt
    s_lshl_b32 s35, s32, 10
    s_add_u32 s35, s35, 9437184
    s_add_u32 s20, s4, s35
    s_addc_u32 s21, s5, 0
    s_waitcnt lgkmcnt(0)
    s_barrier
    ds_read_b128 v[8:11], v1 offset:0
    s_add_u32 s35, s34, 2097152
    buffer_load_dwordx2 v[102:103], v2, s[16:19], s35 offen nt
    s_lshl_b32 s35, s39, 2
    s_add_u32 s35, s35, 160256
    v_mov_b32 v7, s35
    v_and_b32 v14, 15, v0
    v_lshlrev_b32 v14, 2, v14
    v_add_u32 v14, 160256, v14
    s_waitcnt lgkmcnt(0)
    v_cmp_eq_u32 s[56:57], 0, v8
    v_cmp_ge_u32 s[64:65], 1, v8
    v_max_u32 v12, 2, v8
    v_lshl_or_b32 v8, v8, 16, v12
    v_cmp_eq_u32 s[58:59], 0, v9
    v_cmp_ge_u32 s[66:67], 1, v9
    v_max_u32 v12, 2, v9
    v_lshl_or_b32 v9, v9, 16, v12
    v_cmp_eq_u32 s[60:61], 0, v10
    v_cmp_ge_u32 s[68:69], 1, v10
    v_max_u32 v12, 2, v10
    v_lshl_or_b32 v10, v10, 16, v12
    v_cmp_eq_u32 s[62:63], 0, v11
    v_cmp_ge_u32 s[70:71], 1, v11
    v_max_u32 v12, 2, v11
    v_lshl_or_b32 v11, v11, 16, v12
    v_add_u32 v9, v8, v9
    v_add_u32 v10, v9, v10
    v_add_u32 v11, v10, v11
    v_mov_b32 v6, v11
    s_nop 1
    v_add_u32_dpp v6, v6, v6 row_shr:1 row_mask:0xf bank_mask:0xf bound_ctrl:0
    s_nop 1
    v_add_u32_dpp v6, v6, v6 row_shr:2 row_mask:0xf bank_mask:0xf bound_ctrl:0
    s_nop 1
    v_add_u32_dpp v6, v6, v6 row_shr:4 row_mask:0xf bank_mask:0xf bound_ctrl:0
    s_nop 1
    v_add_u32_dpp v6, v6, v6 row_shr:8 row_mask:0xf bank_mask:0xf bound_ctrl:0
    s_nop 1
    v_add_u32_dpp v6, v6, v6 row_bcast:15 row_mask:0xa bank_mask:0xf
    s_nop 1
    v_add_u32_dpp v6, v6, v6 row_bcast:31 row_mask:0xc bank_mask:0xf
    s_mov_b32 exec_lo, 0
    s_brev_b32 exec_hi, 1
    ds_write_b32 v7, v6
    s_mov_b64 exec, -1
    v_sub_u32 v6, v6, v11
    s_or_b64 s[46:47], s[64:65], s[66:67]
    s_or_b64 vcc, s[68:69], s[70:71]
    s_or_b64 s[46:47], s[46:47], vcc
    s_waitcnt lgkmcnt(0)
    s_barrier
    ds_read_b32 v7, v14
    s_add_u32 s35, s34, 4194304
    buffer_load_dwordx2 v[104:105], v2, s[16:19], s35 offen nt
    s_waitcnt lgkmcnt(0)
    v_mov_b32 v15, v7
    s_nop 1
    v_add_u32_dpp v7, v7, v7 row_shr:1 row_mask:0xf bank_mask:0xf bound_ctrl:0
    s_nop 1
    v_add_u32_dpp v7, v7, v7 row_shr:2 row_mask:0xf bank_mask:0xf bound_ctrl:0
    s_nop 1
    v_add_u32_dpp v7, v7, v7 row_shr:4 row_mask:0xf bank_mask:0xf bound_ctrl:0
    s_nop 1
    v_add_u32_dpp v7, v7, v7 row_shr:8 row_mask:0xf bank_mask:0xf bound_ctrl:0
    s_nop 0
    v_readlane_b32 s54, v7, 15
    v_sub_u32 v7, v7, v15
    s_nop 0
    v_readlane_b32 s35, v7, s39
    s_and_b32 s54, s54, 0xffff
    s_cmp_ge_u32 s54, 40063
    s_cselect_b32 s36, 16, 0
    s_cselect_b32 s54, 40000, s54
    s_cselect_b32 s55, 1, s55
    s_cselect_b64 s[46:47], 0, s[46:47]
    v_add_u32 v12, s35, v6
    v_add_u32 v13, v12, v8
    v_add_u32 v14, v12, v9
    v_add_u32 v15, v12, v10
    v_bfe_u32 v12, v12, s36, 16
    v_bfe_u32 v13, v13, s36, 16
    v_bfe_u32 v14, v14, s36, 16
    v_bfe_u32 v15, v15, s36, 16
    ds_write_b128 v1, v[12:15] offset:0
    ds_write_b128 v1, v[12:15] offset:16384
    v_mov_b32 v6, 32768
    v_mov_b32 v7, s54
    s_mov_b64 exec, 1
    ds_write_b32 v6, v7
    s_mov_b64 exec, -1
    s_add_u32 s35, s54, 2
    s_mul_hi_u32 s35, s35, 1431655766
    s_lshl_b32 s35, s35, 4
    s_add_u32 s35, s35, 217890816
    s_min_u32 s22, s35, 218104832
    v_perm_b32 v15, v15, v14, s43
    v_perm_b32 v14, v13, v12, s43
    s_waitcnt lgkmcnt(0)
    s_barrier
    s_nop 0
    v_and_b32 v6, 0xffff, v51
    v_lshrrev_b32 v7, 16, v51
    v_and_b32 v8, 0xffff, v55
    v_lshrrev_b32 v9, 16, v55
    ds_add_rtn_u32 v6, v6, v4 offset:0
    ds_add_rtn_u32 v7, v7, v4 offset:0
    ds_add_rtn_u32 v8, v8, v4 offset:0
    ds_add_rtn_u32 v9, v9, v4 offset:0
    v_and_b32 v10, 0xffff, v59
    v_lshrrev_b32 v11, 16, v59
    v_and_b32 v12, 0xffff, v63
    v_lshrrev_b32 v13, 16, v63
    ds_add_rtn_u32 v10, v10, v4 offset:0
    ds_add_rtn_u32 v11, v11, v4 offset:0
    ds_add_rtn_u32 v12, v12, v4 offset:0
    ds_add_rtn_u32 v13, v13, v4 offset:0
    s_waitcnt lgkmcnt(4)
    v_perm_b32 v51, v7, v6, s43
    v_perm_b32 v55, v9, v8, s43
    v_and_b32 v6, 0xffff, v67
    v_lshrrev_b32 v7, 16, v67
    v_and_b32 v8, 0xffff, v71
    v_lshrrev_b32 v9, 16, v71
    ds_add_rtn_u32 v6, v6, v4 offset:0
    ds_add_rtn_u32 v7, v7, v4 offset:0
    ds_add_rtn_u32 v8, v8, v4 offset:0
    ds_add_rtn_u32 v9, v9, v4 offset:0
    s_waitcnt lgkmcnt(4)
    v_perm_b32 v59, v11, v10, s43
    v_perm_b32 v63, v13, v12, s43
    s_add_u32 s35, s34, 6291456
    buffer_load_dwordx2 v[106:107], v2, s[16:19], s35 offen nt
    v_and_b32 v10, 0xffff, v120
    v_lshrrev_b32 v11, 16, v120
    v_and_b32 v12, 0xffff, v121
    v_lshrrev_b32 v13, 16, v121
    ds_add_rtn_u32 v10, v10, v4 offset:0
    ds_add_rtn_u32 v11, v11, v4 offset:0
    ds_add_rtn_u32 v12, v12, v4 offset:0
    ds_add_rtn_u32 v13, v13, v4 offset:0
    s_waitcnt lgkmcnt(4)
    v_perm_b32 v67, v7, v6, s43
    v_perm_b32 v71, v9, v8, s43
    s_add_u32 s35, s34, 8388608
    buffer_load_dwordx2 v[108:109], v2, s[16:19], s35 offen nt
    v_and_b32 v6, 0xffff, v122
    v_lshrrev_b32 v7, 16, v122
    v_and_b32 v8, 0xffff, v123
    v_lshrrev_b32 v9, 16, v123
    ds_add_rtn_u32 v6, v6, v4 offset:0
    ds_add_rtn_u32 v7, v7, v4 offset:0
    ds_add_rtn_u32 v8, v8, v4 offset:0
    ds_add_rtn_u32 v9, v9, v4 offset:0
    s_waitcnt lgkmcnt(4)
    v_perm_b32 v120, v11, v10, s43
    v_perm_b32 v121, v13, v12, s43
    s_add_u32 s35, s34, 10485760
    buffer_load_dwordx2 v[110:111], v2, s[16:19], s35 offen nt
    v_and_b32 v10, 0xffff, v124
    v_lshrrev_b32 v11, 16, v124
    v_and_b32 v12, 0xffff, v125
    v_lshrrev_b32 v13, 16, v125
    ds_add_rtn_u32 v10, v10, v4 offset:0
    ds_add_rtn_u32 v11, v11, v4 offset:0
    ds_add_rtn_u32 v12, v12, v4 offset:0
    ds_add_rtn_u32 v13, v13, v4 offset:0
    s_waitcnt lgkmcnt(4)
    v_perm_b32 v122, v7, v6, s43
    v_perm_b32 v123, v9, v8, s43
    v_and_b32 v6, 0xffff, v126
    v_lshrrev_b32 v7, 16, v126
    v_and_b32 v8, 0xffff, v75
    v_lshrrev_b32 v9, 16, v75
    ds_add_rtn_u32 v6, v6, v4 offset:0
    ds_add_rtn_u32 v7, v7, v4 offset:0
    ds_add_rtn_u32 v8, v8, v4 offset:0
    ds_add_rtn_u32 v9, v9, v4 offset:0
    s_waitcnt lgkmcnt(4)
    v_perm_b32 v124, v11, v10, s43
    v_perm_b32 v125, v13, v12, s43
    s_add_u32 s35, s34, 12582912
    buffer_load_dwordx2 v[112:113], v2, s[16:19], s35 offen nt
    v_and_b32 v10, 0xffff, v79
    v_lshrrev_b32 v11, 16, v79
    v_and_b32 v12, 0xffff, v83
    v_lshrrev_b32 v13, 16, v83
    ds_add_rtn_u32 v10, v10, v4 offset:0
    ds_add_rtn_u32 v11, v11, v4 offset:0
    ds_add_rtn_u32 v12, v12, v4 offset:0
    ds_add_rtn_u32 v13, v13, v4 offset:0
    s_waitcnt lgkmcnt(4)
    v_perm_b32 v126, v7, v6, s43
    v_perm_b32 v75, v9, v8, s43
    s_add_u32 s35, s34, 14680064
    buffer_load_dwordx2 v[114:115], v2, s[16:19], s35 offen nt
    v_and_b32 v6, 0xffff, v87
    v_lshrrev_b32 v7, 16, v87
    v_and_b32 v8, 0xffff, v91
    v_lshrrev_b32 v9, 16, v91
    ds_add_rtn_u32 v6, v6, v4 offset:0
    ds_add_rtn_u32 v7, v7, v4 offset:0
    ds_add_rtn_u32 v8, v8, v4 offset:0
    ds_add_rtn_u32 v9, v9, v4 offset:0
    s_waitcnt lgkmcnt(4)
    v_perm_b32 v79, v11, v10, s43
    v_perm_b32 v83, v13, v12, s43
    s_add_u32 s35, s34, 16777216
    buffer_load_dwordx2 v[116:117], v2, s[16:19], s35 offen nt
    s_mov_b64 exec, s[44:45]
    v_and_b32 v10, 0xffff, v95
    v_lshrrev_b32 v11, 16, v95
    v_and_b32 v12, 0xffff, v99
    v_lshrrev_b32 v13, 16, v99
    ds_add_rtn_u32 v10, v10, v4 offset:0
    ds_add_rtn_u32 v11, v11, v4 offset:0
    ds_add_rtn_u32 v12, v12, v4 offset:0
    ds_add_rtn_u32 v13, v13, v4 offset:0
    s_mov_b64 exec, -1
    s_waitcnt lgkmcnt(4)
    v_perm_b32 v87, v7, v6, s43
    v_perm_b32 v91, v9, v8, s43
    s_add_u32 s35, s34, 18874368
    s_sub_u32 s35, s35, s49
    v_cndmask_b32 v118, 2.0, v2, s[44:45]
    buffer_load_dwordx2 v[118:119], v118, s[16:19], s35 offen nt
    s_waitcnt lgkmcnt(0)
    v_perm_b32 v95, v11, v10, s43
    v_perm_b32 v99, v13, v12, s43
    s_cmp_gt_u32 s39, 8
    s_cbranch_scc1 L_p1_kernel_notab_9
    v_lshrrev_b32 v6, 1, v0
    v_mul_u32_u24 v7, 1009, v6
    v_lshrrev_b32 v7, 16, v7
    v_mul_u32_u24 v7, 959, v7
    v_and_b32 v8, 1, v0
    v_lshl_add_u32 v7, v8, 9, v7
    v_add_lshl_u32 v13, v7, v6, 2
    ds_read2st64_b32 v[6:7], v13 offset0:64 offset1:65
    ds_read2st64_b32 v[8:9], v13 offset0:66 offset1:67
    ds_read2st64_b32 v[10:11], v13 offset0:68 offset1:69
    ds_read2st64_b32 v[12:13], v13 offset0:70 offset1:71
    s_mul_i32 s35, s32, 8320
    s_add_u32 s26, s35, 8320
    s_waitcnt lgkmcnt(3)
    v_perm_b32 v6, v7, v6, s43
    s_waitcnt lgkmcnt(2)
    v_perm_b32 v7, v9, v8, s43
    s_waitcnt lgkmcnt(1)
    v_perm_b32 v8, v11, v10, s43
    s_waitcnt lgkmcnt(0)
    v_perm_b32 v9, v13, v12, s43
    buffer_store_dwordx4 v[6:9], v1, s[24:27], s35 offen sc1
    s_nop 1
L_p1_kernel_notab_9:
    s_barrier
    s_lshl_b32 s35, s54, 2
    v_mov_b32 v6, s35
    v_mov_b32 v7, 0
    v_mov_b32 v12, 1140817920
    s_mov_b64 exec, 1
    ds_write2_b32 v6, v7, v7 offset0:0 offset1:1
    s_cmp_eq_u64 s[46:47], 0
    s_cbranch_scc1 L_p1_kernel_nonull_10
    s_mov_b64 exec, s[64:65]
    v_lshlrev_b32_sdwa v6, 2, v14 dst_sel:DWORD dst_unused:UNUSED_PAD src0_sel:DWORD src1_sel:WORD_0
    ds_write_b32 v6, v7 offset:4
    s_mov_b64 exec, s[56:57]
    ds_write_b32 v6, v7
    s_mov_b64 exec, s[66:67]
    v_lshlrev_b32_sdwa v6, 2, v14 dst_sel:DWORD dst_unused:UNUSED_PAD src0_sel:DWORD src1_sel:WORD_1
    ds_write_b32 v6, v7 offset:4
    s_mov_b64 exec, s[58:59]
    ds_write_b32 v6, v7
    s_mov_b64 exec, s[68:69]
    v_lshlrev_b32_sdwa v6, 2, v15 dst_sel:DWORD dst_unused:UNUSED_PAD src0_sel:DWORD src1_sel:WORD_0
    ds_write_b32 v6, v7 offset:4
    s_mov_b64 exec, s[60:61]
    ds_write_b32 v6, v7
    s_mov_b64 exec, s[70:71]
    v_lshlrev_b32_sdwa v6, 2, v15 dst_sel:DWORD dst_unused:UNUSED_PAD src0_sel:DWORD src1_sel:WORD_1
    ds_write_b32 v6, v7 offset:4
    s_mov_b64 exec, s[62:63]
    ds_write_b32 v6, v7
L_p1_kernel_nonull_10:
    s_mov_b64 exec, -1
    v_lshlrev_b32_sdwa v6, 2, v51 dst_sel:DWORD dst_unused:UNUSED_PAD src0_sel:DWORD src1_sel:WORD_0
    v_lshlrev_b32_sdwa v7, 2, v51 dst_sel:DWORD dst_unused:UNUSED_PAD src0_sel:DWORD src1_sel:WORD_1
    v_lshlrev_b32_sdwa v8, 2, v55 dst_sel:DWORD dst_unused:UNUSED_PAD src0_sel:DWORD src1_sel:WORD_0
    v_lshlrev_b32_sdwa v9, 2, v55 dst_sel:DWORD dst_unused:UNUSED_PAD src0_sel:DWORD src1_sel:WORD_1
    ds_write_b32 v6, v48
    ds_write_b32 v7, v49
    ds_write_b32 v8, v50
    ds_write_b32 v9, v52
    s_waitcnt vmcnt(9)
    v_lshlrev_b32 v10, 16, v100
    v_lshlrev_b32 v11, 16, v101
    v_and_b32 v100, 0xffff0000, v100
    v_and_b32 v101, 0xffff0000, v101
    v_mul_f32 v10, s41, v10
    v_mul_f32 v100, s41, v100
    v_mul_f32 v11, s41, v11
    v_mul_f32 v101, s41, v101
    v_fract_f32 v10, v10
    v_fract_f32 v100, v100
    v_fract_f32 v11, v11
    v_fract_f32 v101, v101
    v_cos_f32 v10, v10
    v_cos_f32 v100, v100
    v_cos_f32 v11, v11
    v_cos_f32 v101, v101
    v_fmaak_f32 v10, v12, v10, 1262486016
    v_fmaak_f32 v100, v12, v100, 1262486016
    v_fmaak_f32 v11, v12, v11, 1262486016
    v_fmaak_f32 v101, v12, v101, 1262486016
    v_or3_b32 v5, v10, v100, v5
    v_or3_b32 v5, v11, v101, v5
    v_perm_b32 v100, v100, v10, s43
    v_perm_b32 v101, v101, v11, s43
    s_add_u32 s35, s33, 40960000
    buffer_load_dwordx4 v[16:19], v1, s[8:11], s35 offen nt
    v_lshlrev_b32_sdwa v6, 2, v59 dst_sel:DWORD dst_unused:UNUSED_PAD src0_sel:DWORD src1_sel:WORD_0
    v_lshlrev_b32_sdwa v7, 2, v59 dst_sel:DWORD dst_unused:UNUSED_PAD src0_sel:DWORD src1_sel:WORD_1
    v_lshlrev_b32_sdwa v8, 2, v63 dst_sel:DWORD dst_unused:UNUSED_PAD src0_sel:DWORD src1_sel:WORD_0
    v_lshlrev_b32_sdwa v9, 2, v63 dst_sel:DWORD dst_unused:UNUSED_PAD src0_sel:DWORD src1_sel:WORD_1
    ds_write_b32 v6, v53
    ds_write_b32 v7, v54
    ds_write_b32 v8, v56
    ds_write_b32 v9, v57
    s_waitcnt vmcnt(9)
    v_lshlrev_b32 v10, 16, v102
    v_lshlrev_b32 v11, 16, v103
    v_and_b32 v102, 0xffff0000, v102
    v_and_b32 v103, 0xffff0000, v103
    v_mul_f32 v10, s41, v10
    v_mul_f32 v102, s41, v102
    v_mul_f32 v11, s41, v11
    v_mul_f32 v103, s41, v103
    v_fract_f32 v10, v10
    v_fract_f32 v102, v102
    v_fract_f32 v11, v11
    v_fract_f32 v103, v103
    v_cos_f32 v10, v10
    v_cos_f32 v102, v102
    v_cos_f32 v11, v11
    v_cos_f32 v103, v103
    v_fmaak_f32 v10, v12, v10, 1262486016
    v_fmaak_f32 v102, v12, v102, 1262486016
    v_fmaak_f32 v11, v12, v11, 1262486016
    v_fmaak_f32 v103, v12, v103, 1262486016
    v_or3_b32 v5, v10, v102, v5
    v_or3_b32 v5, v11, v103, v5
    v_perm_b32 v102, v102, v10, s43
    v_perm_b32 v103, v103, v11, s43
    v_lshlrev_b32_sdwa v6, 2, v67 dst_sel:DWORD dst_unused:UNUSED_PAD src0_sel:DWORD src1_sel:WORD_0
    v_lshlrev_b32_sdwa v7, 2, v67 dst_sel:DWORD dst_unused:UNUSED_PAD src0_sel:DWORD src1_sel:WORD_1
    v_lshlrev_b32_sdwa v8, 2, v71 dst_sel:DWORD dst_unused:UNUSED_PAD src0_sel:DWORD src1_sel:WORD_0
    v_lshlrev_b32_sdwa v9, 2, v71 dst_sel:DWORD dst_unused:UNUSED_PAD src0_sel:DWORD src1_sel:WORD_1
    ds_write_b32 v6, v58
    ds_write_b32 v7, v60
    ds_write_b32 v8, v61
    ds_write_b32 v9, v62
    v_lshlrev_b32_sdwa v6, 2, v120 dst_sel:DWORD dst_unused:UNUSED_PAD src0_sel:DWORD src1_sel:WORD_0
    v_lshlrev_b32_sdwa v7, 2, v120 dst_sel:DWORD dst_unused:UNUSED_PAD src0_sel:DWORD src1_sel:WORD_1
    v_lshlrev_b32_sdwa v8, 2, v121 dst_sel:DWORD dst_unused:UNUSED_PAD src0_sel:DWORD src1_sel:WORD_0
    v_lshlrev_b32_sdwa v9, 2, v121 dst_sel:DWORD dst_unused:UNUSED_PAD src0_sel:DWORD src1_sel:WORD_1
    ds_write_b32 v6, v64
    ds_write_b32 v7, v65
    ds_write_b32 v8, v66
    ds_write_b32 v9, v68
    s_waitcnt vmcnt(8)
    v_lshlrev_b32 v10, 16, v104
    v_lshlrev_b32 v11, 16, v105
    v_and_b32 v104, 0xffff0000, v104
    v_and_b32 v105, 0xffff0000, v105
    v_mul_f32 v10, s41, v10
    v_mul_f32 v104, s41, v104
    v_mul_f32 v11, s41, v11
    v_mul_f32 v105, s41, v105
    v_fract_f32 v10, v10
    v_fract_f32 v104, v104
    v_fract_f32 v11, v11
    v_fract_f32 v105, v105
    v_cos_f32 v10, v10
    v_cos_f32 v104, v104
    v_cos_f32 v11, v11
    v_cos_f32 v105, v105
    v_fmaak_f32 v10, v12, v10, 1262486016
    v_fmaak_f32 v104, v12, v104, 1262486016
    v_fmaak_f32 v11, v12, v11, 1262486016
    v_fmaak_f32 v105, v12, v105, 1262486016
    v_or3_b32 v5, v10, v104, v5
    v_or3_b32 v5, v11, v105, v5
    v_perm_b32 v104, v104, v10, s43
    v_perm_b32 v105, v105, v11, s43
    s_add_u32 s35, s33, 40960000
    buffer_load_dwordx4 v[20:23], v1, s[12:15], s35 offen nt
    v_lshlrev_b32_sdwa v6, 2, v122 dst_sel:DWORD dst_unused:UNUSED_PAD src0_sel:DWORD src1_sel:WORD_0
    v_lshlrev_b32_sdwa v7, 2, v122 dst_sel:DWORD dst_unused:UNUSED_PAD src0_sel:DWORD src1_sel:WORD_1
    v_lshlrev_b32_sdwa v8, 2, v123 dst_sel:DWORD dst_unused:UNUSED_PAD src0_sel:DWORD src1_sel:WORD_0
    v_lshlrev_b32_sdwa v9, 2, v123 dst_sel:DWORD dst_unused:UNUSED_PAD src0_sel:DWORD src1_sel:WORD_1
    ds_write_b32 v6, v69
    ds_write_b32 v7, v70
    ds_write_b32 v8, v127
    ds_write_b32 v9, v72
    s_waitcnt vmcnt(8)
    v_lshlrev_b32 v10, 16, v106
    v_lshlrev_b32 v11, 16, v107
    v_and_b32 v106, 0xffff0000, v106
    v_and_b32 v107, 0xffff0000, v107
    v_mul_f32 v10, s41, v10
    v_mul_f32 v106, s41, v106
    v_mul_f32 v11, s41, v11
    v_mul_f32 v107, s41, v107
    v_fract_f32 v10, v10
    v_fract_f32 v106, v106
    v_fract_f32 v11, v11
    v_fract_f32 v107, v107
    v_cos_f32 v10, v10
    v_cos_f32 v106, v106
    v_cos_f32 v11, v11
    v_cos_f32 v107, v107
    v_fmaak_f32 v10, v12, v10, 1262486016
    v_fmaak_f32 v106, v12, v106, 1262486016
    v_fmaak_f32 v11, v12, v11, 1262486016
    v_fmaak_f32 v107, v12, v107, 1262486016
    v_or3_b32 v5, v10, v106, v5
    v_or3_b32 v5, v11, v107, v5
    v_perm_b32 v106, v106, v10, s43
    v_perm_b32 v107, v107, v11, s43
    v_lshlrev_b32_sdwa v6, 2, v124 dst_sel:DWORD dst_unused:UNUSED_PAD src0_sel:DWORD src1_sel:WORD_0
    v_lshlrev_b32_sdwa v7, 2, v124 dst_sel:DWORD dst_unused:UNUSED_PAD src0_sel:DWORD src1_sel:WORD_1
    v_lshlrev_b32_sdwa v8, 2, v125 dst_sel:DWORD dst_unused:UNUSED_PAD src0_sel:DWORD src1_sel:WORD_0
    v_lshlrev_b32_sdwa v9, 2, v125 dst_sel:DWORD dst_unused:UNUSED_PAD src0_sel:DWORD src1_sel:WORD_1
    ds_write_b32 v6, v73
    ds_write_b32 v7, v74
    ds_write_b32 v8, v76
    ds_write_b32 v9, v77
    v_lshlrev_b32_sdwa v6, 2, v126 dst_sel:DWORD dst_unused:UNUSED_PAD src0_sel:DWORD src1_sel:WORD_0
    v_lshlrev_b32_sdwa v7, 2, v126 dst_sel:DWORD dst_unused:UNUSED_PAD src0_sel:DWORD src1_sel:WORD_1
    v_lshlrev_b32_sdwa v8, 2, v75 dst_sel:DWORD dst_unused:UNUSED_PAD src0_sel:DWORD src1_sel:WORD_0
    v_lshlrev_b32_sdwa v9, 2, v75 dst_sel:DWORD dst_unused:UNUSED_PAD src0_sel:DWORD src1_sel:WORD_1
    ds_write_b32 v6, v78
    ds_write_b32 v7, v80
    ds_write_b32 v8, v81
    ds_write_b32 v9, v82
    s_waitcnt vmcnt(7)
    v_lshlrev_b32 v10, 16, v108
    v_lshlrev_b32 v11, 16, v109
    v_and_b32 v108, 0xffff0000, v108
    v_and_b32 v109, 0xffff0000, v109
    v_mul_f32 v10, s41, v10
    v_mul_f32 v108, s41, v108
    v_mul_f32 v11, s41, v11
    v_mul_f32 v109, s41, v109
    v_fract_f32 v10, v10
    v_fract_f32 v108, v108
    v_fract_f32 v11, v11
    v_fract_f32 v109, v109
    v_cos_f32 v10, v10
    v_cos_f32 v108, v108
    v_cos_f32 v11, v11
    v_cos_f32 v109, v109
    v_fmaak_f32 v10, v12, v10, 1262486016
    v_fmaak_f32 v108, v12, v108, 1262486016
    v_fmaak_f32 v11, v12, v11, 1262486016
    v_fmaak_f32 v109, v12, v109, 1262486016
    v_or3_b32 v5, v10, v108, v5
    v_or3_b32 v5, v11, v109, v5
    v_perm_b32 v108, v108, v10, s43
    v_perm_b32 v109, v109, v11, s43
    s_add_u32 s35, s33, 45154304
    buffer_load_dwordx4 v[24:27], v1, s[8:11], s35 offen nt
    v_lshlrev_b32_sdwa v6, 2, v79 dst_sel:DWORD dst_unused:UNUSED_PAD src0_sel:DWORD src1_sel:WORD_0
    v_lshlrev_b32_sdwa v7, 2, v79 dst_sel:DWORD dst_unused:UNUSED_PAD src0_sel:DWORD src1_sel:WORD_1
    v_lshlrev_b32_sdwa v8, 2, v83 dst_sel:DWORD dst_unused:UNUSED_PAD src0_sel:DWORD src1_sel:WORD_0
    v_lshlrev_b32_sdwa v9, 2, v83 dst_sel:DWORD dst_unused:UNUSED_PAD src0_sel:DWORD src1_sel:WORD_1
    ds_write_b32 v6, v84
    ds_write_b32 v7, v85
    ds_write_b32 v8, v86
    ds_write_b32 v9, v88
    s_waitcnt vmcnt(7)
    v_lshlrev_b32 v10, 16, v110
    v_lshlrev_b32 v11, 16, v111
    v_and_b32 v110, 0xffff0000, v110
    v_and_b32 v111, 0xffff0000, v111
    v_mul_f32 v10, s41, v10
    v_mul_f32 v110, s41, v110
    v_mul_f32 v11, s41, v11
    v_mul_f32 v111, s41, v111
    v_fract_f32 v10, v10
    v_fract_f32 v110, v110
    v_fract_f32 v11, v11
    v_fract_f32 v111, v111
    v_cos_f32 v10, v10
    v_cos_f32 v110, v110
    v_cos_f32 v11, v11
    v_cos_f32 v111, v111
    v_fmaak_f32 v10, v12, v10, 1262486016
    v_fmaak_f32 v110, v12, v110, 1262486016
    v_fmaak_f32 v11, v12, v11, 1262486016
    v_fmaak_f32 v111, v12, v111, 1262486016
    v_or3_b32 v5, v10, v110, v5
    v_or3_b32 v5, v11, v111, v5
    v_perm_b32 v110, v110, v10, s43
    v_perm_b32 v111, v111, v11, s43
    v_lshlrev_b32_sdwa v6, 2, v87 dst_sel:DWORD dst_unused:UNUSED_PAD src0_sel:DWORD src1_sel:WORD_0
    v_lshlrev_b32_sdwa v7, 2, v87 dst_sel:DWORD dst_unused:UNUSED_PAD src0_sel:DWORD src1_sel:WORD_1
    v_lshlrev_b32_sdwa v8, 2, v91 dst_sel:DWORD dst_unused:UNUSED_PAD src0_sel:DWORD src1_sel:WORD_0
    v_lshlrev_b32_sdwa v9, 2, v91 dst_sel:DWORD dst_unused:UNUSED_PAD src0_sel:DWORD src1_sel:WORD_1
    ds_write_b32 v6, v89
    ds_write_b32 v7, v90
    ds_write_b32 v8, v92
    ds_write_b32 v9, v93
    s_mov_b64 exec, s[44:45]
    v_lshlrev_b32_sdwa v6, 2, v95 dst_sel:DWORD dst_unused:UNUSED_PAD src0_sel:DWORD src1_sel:WORD_0
    v_lshlrev_b32_sdwa v7, 2, v95 dst_sel:DWORD dst_unused:UNUSED_PAD src0_sel:DWORD src1_sel:WORD_1
    v_lshlrev_b32_sdwa v8, 2, v99 dst_sel:DWORD dst_unused:UNUSED_PAD src0_sel:DWORD src1_sel:WORD_0
    v_lshlrev_b32_sdwa v9, 2, v99 dst_sel:DWORD dst_unused:UNUSED_PAD src0_sel:DWORD src1_sel:WORD_1
    ds_write_b32 v6, v94
    ds_write_b32 v7, v96
    ds_write_b32 v8, v97
    ds_write_b32 v9, v98
    s_mov_b64 exec, -1
    s_waitcnt vmcnt(6)
    v_lshlrev_b32 v10, 16, v112
    v_lshlrev_b32 v11, 16, v113
    v_and_b32 v112, 0xffff0000, v112
    v_and_b32 v113, 0xffff0000, v113
    v_mul_f32 v10, s41, v10
    v_mul_f32 v112, s41, v112
    v_mul_f32 v11, s41, v11
    v_mul_f32 v113, s41, v113
    v_fract_f32 v10, v10
    v_fract_f32 v112, v112
    v_fract_f32 v11, v11
    v_fract_f32 v113, v113
    v_cos_f32 v10, v10
    v_cos_f32 v112, v112
    v_cos_f32 v11, v11
    v_cos_f32 v113, v113
    v_fmaak_f32 v10, v12, v10, 1262486016
    v_fmaak_f32 v112, v12, v112, 1262486016
    v_fmaak_f32 v11, v12, v11, 1262486016
    v_fmaak_f32 v113, v12, v113, 1262486016
    v_or3_b32 v5, v10, v112, v5
    v_or3_b32 v5, v11, v113, v5
    v_perm_b32 v112, v112, v10, s43
    v_perm_b32 v113, v113, v11, s43
    s_mov_b64 exec, s[44:45]
    s_mov_b64 exec, -1
    s_add_u32 s35, s33, 45154304
    buffer_load_dwordx4 v[28:31], v1, s[12:15], s35 offen nt
    s_mul_i32 s35, s39, 9216
    v_mad_u32_u24 v6, v0, 12, s35
    s_waitcnt lgkmcnt(0)
    s_barrier
    s_cmp_lg_u32 s39, 15
    s_cbranch_scc1 L_p1_kernel_nox_11
    ds_read_b32 v12, v6 offset:9984
    ds_read_b32 v13, v6 offset:9988
    ds_read_b32 v14, v6 offset:9992
L_p1_kernel_nox_11:
    ds_read_b32 v48, v6 offset:1536
    ds_read_b32 v49, v6 offset:1540
    ds_read_b32 v50, v6 offset:1544
    ds_read_b32 v52, v6 offset:3072
    ds_read_b32 v53, v6 offset:3076
    ds_read_b32 v54, v6 offset:3080
    ds_read_b32 v56, v6 offset:4608
    ds_read_b32 v57, v6 offset:4612
    ds_read_b32 v58, v6 offset:4616
    ds_read_b32 v60, v6 offset:6144
    ds_read_b32 v61, v6 offset:6148
    ds_read_b32 v62, v6 offset:6152
    ds_read_b32 v64, v6 offset:7680
    ds_read_b32 v65, v6 offset:7684
    ds_read_b32 v66, v6 offset:7688
    ds_read_b32 v68, v6 offset:9216
    ds_read_b32 v69, v6 offset:9220
    ds_read_b32 v70, v6 offset:9224
    ds_read_b32 v72, v6 offset:0
    ds_read_b32 v73, v6 offset:4
    ds_read_b32 v74, v6 offset:8
    ds_read_b32 v76, v6 offset:768
    ds_read_b32 v77, v6 offset:772
    ds_read_b32 v78, v6 offset:776
    ds_read_b32 v80, v6 offset:2304
    ds_read_b32 v81, v6 offset:2308
    ds_read_b32 v82, v6 offset:2312
    ds_read_b32 v84, v6 offset:3840
    ds_read_b32 v85, v6 offset:3844
    ds_read_b32 v86, v6 offset:3848
    ds_read_b32 v88, v6 offset:5376
    ds_read_b32 v89, v6 offset:5380
    ds_read_b32 v90, v6 offset:5384
    ds_read_b32 v92, v6 offset:6912
    ds_read_b32 v93, v6 offset:6916
    ds_read_b32 v94, v6 offset:6920
    ds_read_b32 v96, v6 offset:8448
    ds_read_b32 v97, v6 offset:8452
    ds_read_b32 v98, v6 offset:8456
    s_add_u32 s35, s33, 49348608
    buffer_load_dwordx4 v[32:35], v1, s[8:11], s35 offen nt
    v_mov_b32 v8, 0
    v_mov_b32 v9, 0
    v_mov_b32 v10, 0
    v_mov_b32 v11, 0
    v_mov_b32 v15, 16384
    s_waitcnt lgkmcnt(0)
    s_barrier
    ds_write_b128 v1, v[8:11] offset:0
    s_nop 1
    v_mad_u32_u16 v6, v51, s50, v15 op_sel:[0,0,0,0]
    v_mad_u32_u16 v7, v51, s50, v15 op_sel:[1,0,0,0]
    v_mad_u32_u16 v8, v55, s50, v15 op_sel:[0,0,0,0]
    v_mad_u32_u16 v9, v55, s50, v15 op_sel:[1,0,0,0]
    v_add_u32_sdwa v6, v6, v51 dst_sel:DWORD dst_unused:UNUSED_PAD src0_sel:WORD_1 src1_sel:WORD_0
    v_add_u32_sdwa v7, v7, v51 dst_sel:DWORD dst_unused:UNUSED_PAD src0_sel:WORD_1 src1_sel:WORD_1
    v_add_u32_sdwa v8, v8, v55 dst_sel:DWORD dst_unused:UNUSED_PAD src0_sel:WORD_1 src1_sel:WORD_0
    v_add_u32_sdwa v9, v9, v55 dst_sel:DWORD dst_unused:UNUSED_PAD src0_sel:WORD_1 src1_sel:WORD_1
    v_add_u32 v6, v6, v6
    v_add_u32 v7, v7, v7
    v_add_u32 v8, v8, v8
    v_add_u32 v9, v9, v9
    ds_write_b16 v6, v100 offset:16384
    ds_write_b16_d16_hi v7, v100 offset:16384
    ds_write_b16 v8, v101 offset:16384
    ds_write_b16_d16_hi v9, v101 offset:16384
    v_mov_b32 v6, 1140817920
    s_waitcnt vmcnt(7)
    v_lshlrev_b32 v10, 16, v114
    v_lshlrev_b32 v11, 16, v115
    v_and_b32 v114, 0xffff0000, v114
    v_and_b32 v115, 0xffff0000, v115
    v_mul_f32 v10, s41, v10
    v_mul_f32 v114, s41, v114
    v_mul_f32 v11, s41, v11
    v_mul_f32 v115, s41, v115
    v_fract_f32 v10, v10
    v_fract_f32 v114, v114
    v_fract_f32 v11, v11
    v_fract_f32 v115, v115
    v_cos_f32 v10, v10
    v_cos_f32 v114, v114
    v_cos_f32 v11, v11
    v_cos_f32 v115, v115
    v_fmaak_f32 v10, v6, v10, 1262486016
    v_fmaak_f32 v114, v6, v114, 1262486016
    v_fmaak_f32 v11, v6, v11, 1262486016
    v_fmaak_f32 v115, v6, v115, 1262486016
    v_or3_b32 v5, v10, v114, v5
    v_or3_b32 v5, v11, v115, v5
    v_perm_b32 v114, v114, v10, s43
    v_perm_b32 v115, v115, v11, s43
    v_mad_u32_u16 v6, v59, s50, v15 op_sel:[0,0,0,0]
    v_mad_u32_u16 v7, v59, s50, v15 op_sel:[1,0,0,0]
    v_mad_u32_u16 v8, v63, s50, v15 op_sel:[0,0,0,0]
    v_mad_u32_u16 v9, v63, s50, v15 op_sel:[1,0,0,0]
    v_add_u32_sdwa v6, v6, v59 dst_sel:DWORD dst_unused:UNUSED_PAD src0_sel:WORD_1 src1_sel:WORD_0
    v_add_u32_sdwa v7, v7, v59 dst_sel:DWORD dst_unused:UNUSED_PAD src0_sel:WORD_1 src1_sel:WORD_1
    v_add_u32_sdwa v8, v8, v63 dst_sel:DWORD dst_unused:UNUSED_PAD src0_sel:WORD_1 src1_sel:WORD_0
    v_add_u32_sdwa v9, v9, v63 dst_sel:DWORD dst_unused:UNUSED_PAD src0_sel:WORD_1 src1_sel:WORD_1
    v_add_u32 v6, v6, v6
    v_add_u32 v7, v7, v7
    v_add_u32 v8, v8, v8
    v_add_u32 v9, v9, v9
    ds_write_b16 v6, v102 offset:16384
    ds_write_b16_d16_hi v7, v102 offset:16384
    ds_write_b16 v8, v103 offset:16384
    ds_write_b16_d16_hi v9, v103 offset:16384
    v_mad_u32_u16 v6, v67, s50, v15 op_sel:[0,0,0,0]
    v_mad_u32_u16 v7, v67, s50, v15 op_sel:[1,0,0,0]
    v_mad_u32_u16 v8, v71, s50, v15 op_sel:[0,0,0,0]
    v_mad_u32_u16 v9, v71, s50, v15 op_sel:[1,0,0,0]
    v_add_u32_sdwa v6, v6, v67 dst_sel:DWORD dst_unused:UNUSED_PAD src0_sel:WORD_1 src1_sel:WORD_0
    v_add_u32_sdwa v7, v7, v67 dst_sel:DWORD dst_unused:UNUSED_PAD src0_sel:WORD_1 src1_sel:WORD_1
    v_add_u32_sdwa v8, v8, v71 dst_sel:DWORD dst_unused:UNUSED_PAD src0_sel:WORD_1 src1_sel:WORD_0
    v_add_u32_sdwa v9, v9, v71 dst_sel:DWORD dst_unused:UNUSED_PAD src0_sel:WORD_1 src1_sel:WORD_1
    v_add_u32 v6, v6, v6
    v_add_u32 v7, v7, v7
    v_add_u32 v8, v8, v8
    v_add_u32 v9, v9, v9
    ds_write_b16 v6, v104 offset:16384
    ds_write_b16_d16_hi v7, v104 offset:16384
    ds_write_b16 v8, v105 offset:16384
    ds_write_b16_d16_hi v9, v105 offset:16384
    s_add_u32 s35, s33, 49348608
    buffer_load_dwordx4 v[36:39], v1, s[12:15], s35 offen nt
    v_mad_u32_u16 v6, v120, s50, v15 op_sel:[0,0,0,0]
    v_mad_u32_u16 v7, v120, s50, v15 op_sel:[1,0,0,0]
    v_mad_u32_u16 v8, v121, s50, v15 op_sel:[0,0,0,0]
    v_mad_u32_u16 v9, v121, s50, v15 op_sel:[1,0,0,0]
    v_add_u32_sdwa v6, v6, v120 dst_sel:DWORD dst_unused:UNUSED_PAD src0_sel:WORD_1 src1_sel:WORD_0
    v_add_u32_sdwa v7, v7, v120 dst_sel:DWORD dst_unused:UNUSED_PAD src0_sel:WORD_1 src1_sel:WORD_1
    v_add_u32_sdwa v8, v8, v121 dst_sel:DWORD dst_unused:UNUSED_PAD src0_sel:WORD_1 src1_sel:WORD_0
    v_add_u32_sdwa v9, v9, v121 dst_sel:DWORD dst_unused:UNUSED_PAD src0_sel:WORD_1 src1_sel:WORD_1
    v_add_u32 v6, v6, v6
    v_add_u32 v7, v7, v7
    v_add_u32 v8, v8, v8
    v_add_u32 v9, v9, v9
    ds_write_b16 v6, v106 offset:16384
    ds_write_b16_d16_hi v7, v106 offset:16384
    ds_write_b16 v8, v107 offset:16384
    ds_write_b16_d16_hi v9, v107 offset:16384
    v_mov_b32 v6, 1140817920
    s_waitcnt vmcnt(7)
    v_lshlrev_b32 v10, 16, v116
    v_lshlrev_b32 v11, 16, v117
    v_and_b32 v116, 0xffff0000, v116
    v_and_b32 v117, 0xffff0000, v117
    v_mul_f32 v10, s41, v10
    v_mul_f32 v116, s41, v116
    v_mul_f32 v11, s41, v11
    v_mul_f32 v117, s41, v117
    v_fract_f32 v10, v10
    v_fract_f32 v116, v116
    v_fract_f32 v11, v11
    v_fract_f32 v117, v117
    v_cos_f32 v10, v10
    v_cos_f32 v116, v116
    v_cos_f32 v11, v11
    v_cos_f32 v117, v117
    v_fmaak_f32 v10, v6, v10, 1262486016
    v_fmaak_f32 v116, v6, v116, 1262486016
    v_fmaak_f32 v11, v6, v11, 1262486016
    v_fmaak_f32 v117, v6, v117, 1262486016
    v_or3_b32 v5, v10, v116, v5
    v_or3_b32 v5, v11, v117, v5
    v_perm_b32 v116, v116, v10, s43
    v_perm_b32 v117, v117, v11, s43
    v_mad_u32_u16 v6, v122, s50, v15 op_sel:[0,0,0,0]
    v_mad_u32_u16 v7, v122, s50, v15 op_sel:[1,0,0,0]
    v_mad_u32_u16 v8, v123, s50, v15 op_sel:[0,0,0,0]
    v_mad_u32_u16 v9, v123, s50, v15 op_sel:[1,0,0,0]
    v_add_u32_sdwa v6, v6, v122 dst_sel:DWORD dst_unused:UNUSED_PAD src0_sel:WORD_1 src1_sel:WORD_0
    v_add_u32_sdwa v7, v7, v122 dst_sel:DWORD dst_unused:UNUSED_PAD src0_sel:WORD_1 src1_sel:WORD_1
    v_add_u32_sdwa v8, v8, v123 dst_sel:DWORD dst_unused:UNUSED_PAD src0_sel:WORD_1 src1_sel:WORD_0
    v_add_u32_sdwa v9, v9, v123 dst_sel:DWORD dst_unused:UNUSED_PAD src0_sel:WORD_1 src1_sel:WORD_1
    v_add_u32 v6, v6, v6
    v_add_u32 v7, v7, v7
    v_add_u32 v8, v8, v8
    v_add_u32 v9, v9, v9
    ds_write_b16 v6, v108 offset:16384
    ds_write_b16_d16_hi v7, v108 offset:16384
    ds_write_b16 v8, v109 offset:16384
    ds_write_b16_d16_hi v9, v109 offset:16384
    v_mad_u32_u16 v6, v124, s50, v15 op_sel:[0,0,0,0]
    v_mad_u32_u16 v7, v124, s50, v15 op_sel:[1,0,0,0]
    v_mad_u32_u16 v8, v125, s50, v15 op_sel:[0,0,0,0]
    v_mad_u32_u16 v9, v125, s50, v15 op_sel:[1,0,0,0]
    v_add_u32_sdwa v6, v6, v124 dst_sel:DWORD dst_unused:UNUSED_PAD src0_sel:WORD_1 src1_sel:WORD_0
    v_add_u32_sdwa v7, v7, v124 dst_sel:DWORD dst_unused:UNUSED_PAD src0_sel:WORD_1 src1_sel:WORD_1
    v_add_u32_sdwa v8, v8, v125 dst_sel:DWORD dst_unused:UNUSED_PAD src0_sel:WORD_1 src1_sel:WORD_0
    v_add_u32_sdwa v9, v9, v125 dst_sel:DWORD dst_unused:UNUSED_PAD src0_sel:WORD_1 src1_sel:WORD_1
    v_add_u32 v6, v6, v6
    v_add_u32 v7, v7, v7
    v_add_u32 v8, v8, v8
    v_add_u32 v9, v9, v9
    ds_write_b16 v6, v110 offset:16384
    ds_write_b16_d16_hi v7, v110 offset:16384
    ds_write_b16 v8, v111 offset:16384
    ds_write_b16_d16_hi v9, v111 offset:16384
    s_add_u32 s35, s33, 53542912
    buffer_load_dwordx4 v[40:43], v1, s[8:11], s35 offen nt
    v_mad_u32_u16 v6, v126, s50, v15 op_sel:[0,0,0,0]
    v_mad_u32_u16 v7, v126, s50, v15 op_sel:[1,0,0,0]
    v_mad_u32_u16 v8, v75, s50, v15 op_sel:[0,0,0,0]
    v_mad_u32_u16 v9, v75, s50, v15 op_sel:[1,0,0,0]
    v_add_u32_sdwa v6, v6, v126 dst_sel:DWORD dst_unused:UNUSED_PAD src0_sel:WORD_1 src1_sel:WORD_0
    v_add_u32_sdwa v7, v7, v126 dst_sel:DWORD dst_unused:UNUSED_PAD src0_sel:WORD_1 src1_sel:WORD_1
    v_add_u32_sdwa v8, v8, v75 dst_sel:DWORD dst_unused:UNUSED_PAD src0_sel:WORD_1 src1_sel:WORD_0
    v_add_u32_sdwa v9, v9, v75 dst_sel:DWORD dst_unused:UNUSED_PAD src0_sel:WORD_1 src1_sel:WORD_1
    v_add_u32 v6, v6, v6
    v_add_u32 v7, v7, v7
    v_add_u32 v8, v8, v8
    v_add_u32 v9, v9, v9
    ds_write_b16 v6, v112 offset:16384
    ds_write_b16_d16_hi v7, v112 offset:16384
    ds_write_b16 v8, v113 offset:16384
    ds_write_b16_d16_hi v9, v113 offset:16384
    v_mov_b32 v6, 1140817920
    s_mov_b64 exec, s[44:45]
    s_waitcnt vmcnt(7)
    v_lshlrev_b32 v10, 16, v118
    v_lshlrev_b32 v11, 16, v119
    v_and_b32 v118, 0xffff0000, v118
    v_and_b32 v119, 0xffff0000, v119
    v_mul_f32 v10, s41, v10
    v_mul_f32 v118, s41, v118
    v_mul_f32 v11, s41, v11
    v_mul_f32 v119, s41, v119
    v_fract_f32 v10, v10
    v_fract_f32 v118, v118
    v_fract_f32 v11, v11
    v_fract_f32 v119, v119
    v_cos_f32 v10, v10
    v_cos_f32 v118, v118
    v_cos_f32 v11, v11
    v_cos_f32 v119, v119
    v_fmaak_f32 v10, v6, v10, 1262486016
    v_fmaak_f32 v118, v6, v118, 1262486016
    v_fmaak_f32 v11, v6, v11, 1262486016
    v_fmaak_f32 v119, v6, v119, 1262486016
    v_or3_b32 v5, v10, v118, v5
    v_or3_b32 v5, v11, v119, v5
    v_perm_b32 v118, v118, v10, s43
    v_perm_b32 v119, v119, v11, s43
    s_mov_b64 exec, -1
    v_mad_u32_u16 v6, v79, s50, v15 op_sel:[0,0,0,0]
    v_mad_u32_u16 v7, v79, s50, v15 op_sel:[1,0,0,0]
    v_mad_u32_u16 v8, v83, s50, v15 op_sel:[0,0,0,0]
    v_mad_u32_u16 v9, v83, s50, v15 op_sel:[1,0,0,0]
    v_add_u32_sdwa v6, v6, v79 dst_sel:DWORD dst_unused:UNUSED_PAD src0_sel:WORD_1 src1_sel:WORD_0
    v_add_u32_sdwa v7, v7, v79 dst_sel:DWORD dst_unused:UNUSED_PAD src0_sel:WORD_1 src1_sel:WORD_1
    v_add_u32_sdwa v8, v8, v83 dst_sel:DWORD dst_unused:UNUSED_PAD src0_sel:WORD_1 src1_sel:WORD_0
    v_add_u32_sdwa v9, v9, v83 dst_sel:DWORD dst_unused:UNUSED_PAD src0_sel:WORD_1 src1_sel:WORD_1
    v_add_u32 v6, v6, v6
    v_add_u32 v7, v7, v7
    v_add_u32 v8, v8, v8
    v_add_u32 v9, v9, v9
    ds_write_b16 v6, v114 offset:16384
    ds_write_b16_d16_hi v7, v114 offset:16384
    ds_write_b16 v8, v115 offset:16384
    ds_write_b16_d16_hi v9, v115 offset:16384
    v_mad_u32_u16 v6, v87, s50, v15 op_sel:[0,0,0,0]
    v_mad_u32_u16 v7, v87, s50, v15 op_sel:[1,0,0,0]
    v_mad_u32_u16 v8, v91, s50, v15 op_sel:[0,0,0,0]
    v_mad_u32_u16 v9, v91, s50, v15 op_sel:[1,0,0,0]
    v_add_u32_sdwa v6, v6, v87 dst_sel:DWORD dst_unused:UNUSED_PAD src0_sel:WORD_1 src1_sel:WORD_0
    v_add_u32_sdwa v7, v7, v87 dst_sel:DWORD dst_unused:UNUSED_PAD src0_sel:WORD_1 src1_sel:WORD_1
    v_add_u32_sdwa v8, v8, v91 dst_sel:DWORD dst_unused:UNUSED_PAD src0_sel:WORD_1 src1_sel:WORD_0
    v_add_u32_sdwa v9, v9, v91 dst_sel:DWORD dst_unused:UNUSED_PAD src0_sel:WORD_1 src1_sel:WORD_1
    v_add_u32 v6, v6, v6
    v_add_u32 v7, v7, v7
    v_add_u32 v8, v8, v8
    v_add_u32 v9, v9, v9
    ds_write_b16 v6, v116 offset:16384
    ds_write_b16_d16_hi v7, v116 offset:16384
    ds_write_b16 v8, v117 offset:16384
    ds_write_b16_d16_hi v9, v117 offset:16384
    s_add_u32 s35, s33, 53542912
    buffer_load_dwordx4 v[44:47], v1, s[12:15], s35 offen nt
    s_mov_b64 exec, s[44:45]
    v_mad_u32_u16 v6, v95, s50, v15 op_sel:[0,0,0,0]
    v_mad_u32_u16 v7, v95, s50, v15 op_sel:[1,0,0,0]
    v_mad_u32_u16 v8, v99, s50, v15 op_sel:[0,0,0,0]
    v_mad_u32_u16 v9, v99, s50, v15 op_sel:[1,0,0,0]
    v_add_u32_sdwa v6, v6, v95 dst_sel:DWORD dst_unused:UNUSED_PAD src0_sel:WORD_1 src1_sel:WORD_0
    v_add_u32_sdwa v7, v7, v95 dst_sel:DWORD dst_unused:UNUSED_PAD src0_sel:WORD_1 src1_sel:WORD_1
    v_add_u32_sdwa v8, v8, v99 dst_sel:DWORD dst_unused:UNUSED_PAD src0_sel:WORD_1 src1_sel:WORD_0
    v_add_u32_sdwa v9, v9, v99 dst_sel:DWORD dst_unused:UNUSED_PAD src0_sel:WORD_1 src1_sel:WORD_1
    v_add_u32 v6, v6, v6
    v_add_u32 v7, v7, v7
    v_add_u32 v8, v8, v8
    v_add_u32 v9, v9, v9
    ds_write_b16 v6, v118 offset:16384
    ds_write_b16_d16_hi v7, v118 offset:16384
    ds_write_b16 v8, v119 offset:16384
    ds_write_b16_d16_hi v9, v119 offset:16384
    s_mov_b64 exec, -1
    s_mul_i32 s35, s39, 6144
    v_add_u32 v6, s35, v2
    s_waitcnt lgkmcnt(0)
    s_barrier
    ds_read_b64 v[100:101], v6 offset:23040
    ds_read_b64 v[102:103], v6 offset:16384
    ds_read_b64 v[104:105], v6 offset:16896
    ds_read_b64 v[106:107], v6 offset:17408
    ds_read_b64 v[108:109], v6 offset:17920
    ds_read_b64 v[110:111], v6 offset:18432
    ds_read_b64 v[112:113], v6 offset:18944
    ds_read_b64 v[114:115], v6 offset:19456
    ds_read_b64 v[116:117], v6 offset:19968
    ds_read_b64 v[118:119], v6 offset:20480
    ds_read_b64 v[120:121], v6 offset:20992
    ds_read_b64 v[122:123], v6 offset:21504
    ds_read_b64 v[124:125], v6 offset:22016
    ds_read_b64 v[126:127], v6 offset:22528
    s_add_u32 s32, s32, 256
    s_add_u32 s33, s33, 40960000
    s_add_u32 s34, s34, 20480000
    s_add_u32 s40, s40, 1
    s_cmp_lt_u32 s40, 4
    s_cbranch_scc1 L_p1_loop
    s_waitcnt lgkmcnt(13)
    v_lshlrev_b32 v15, 22, v100
    v_lshrrev_b32 v100, 16, v100
    v_alignbit_b32 v15, v100, v15, 10
    v_alignbit_b32 v15, v101, v15, 10
    v_xor_b32 v15, 0x80200800, v15
    s_cmp_lg_u32 s39, 15
    s_cbranch_scc1 L_p1_kernel_nox_12
    s_mov_b32 s36, 13631488
    buffer_store_dwordx4 v[12:15], v3, s[20:23], s36 offen sc1
L_p1_kernel_nox_12:
    s_waitcnt lgkmcnt(12)
    v_lshlrev_b32 v75, 22, v102
    v_lshrrev_b32 v102, 16, v102
    v_alignbit_b32 v75, v102, v75, 10
    v_alignbit_b32 v75, v103, v75, 10
    v_xor_b32 v75, 0x80200800, v75
    s_mov_b32 s36, 0
    buffer_store_dwordx4 v[72:75], v3, s[20:23], s36 offen sc1
    s_waitcnt lgkmcnt(11)
    v_lshlrev_b32 v79, 22, v104
    v_lshrrev_b32 v104, 16, v104
    v_alignbit_b32 v79, v104, v79, 10
    v_alignbit_b32 v79, v105, v79, 10
    v_xor_b32 v79, 0x80200800, v79
    s_mov_b32 s36, 1048576
    buffer_store_dwordx4 v[76:79], v3, s[20:23], s36 offen sc1
    s_waitcnt lgkmcnt(10)
    v_lshlrev_b32 v51, 22, v106
    v_lshrrev_b32 v106, 16, v106
    v_alignbit_b32 v51, v106, v51, 10
    v_alignbit_b32 v51, v107, v51, 10
    v_xor_b32 v51, 0x80200800, v51
    s_mov_b32 s36, 2097152
    buffer_store_dwordx4 v[48:51], v3, s[20:23], s36 offen sc1
    s_waitcnt lgkmcnt(9)
    v_lshlrev_b32 v83, 22, v108
    v_lshrrev_b32 v108, 16, v108
    v_alignbit_b32 v83, v108, v83, 10
    v_alignbit_b32 v83, v109, v83, 10
    v_xor_b32 v83, 0x80200800, v83
    s_mov_b32 s36, 3145728
    buffer_store_dwordx4 v[80:83], v3, s[20:23], s36 offen sc1
    s_waitcnt lgkmcnt(8)
    v_lshlrev_b32 v55, 22, v110
    v_lshrrev_b32 v110, 16, v110
    v_alignbit_b32 v55, v110, v55, 10
    v_alignbit_b32 v55, v111, v55, 10
    v_xor_b32 v55, 0x80200800, v55
    s_mov_b32 s36, 4194304
    buffer_store_dwordx4 v[52:55], v3, s[20:23], s36 offen sc1
    s_waitcnt lgkmcnt(7)
    v_lshlrev_b32 v87, 22, v112
    v_lshrrev_b32 v112, 16, v112
    v_alignbit_b32 v87, v112, v87, 10
    v_alignbit_b32 v87, v113, v87, 10
    v_xor_b32 v87, 0x80200800, v87
    s_mov_b32 s36, 5242880
    buffer_store_dwordx4 v[84:87], v3, s[20:23], s36 offen sc1
    s_waitcnt lgkmcnt(6)
    v_lshlrev_b32 v59, 22, v114
    v_lshrrev_b32 v114, 16, v114
    v_alignbit_b32 v59, v114, v59, 10
    v_alignbit_b32 v59, v115, v59, 10
    v_xor_b32 v59, 0x80200800, v59
    s_mov_b32 s36, 6291456
    buffer_store_dwordx4 v[56:59], v3, s[20:23], s36 offen sc1
    s_waitcnt lgkmcnt(5)
    v_lshlrev_b32 v91, 22, v116
    v_lshrrev_b32 v116, 16, v116
    v_alignbit_b32 v91, v116, v91, 10
    v_alignbit_b32 v91, v117, v91, 10
    v_xor_b32 v91, 0x80200800, v91
    s_mov_b32 s36, 7340032
    buffer_store_dwordx4 v[88:91], v3, s[20:23], s36 offen sc1
    s_waitcnt lgkmcnt(4)
    v_lshlrev_b32 v63, 22, v118
    v_lshrrev_b32 v118, 16, v118
    v_alignbit_b32 v63, v118, v63, 10
    v_alignbit_b32 v63, v119, v63, 10
    v_xor_b32 v63, 0x80200800, v63
    s_mov_b32 s36, 8388608
    buffer_store_dwordx4 v[60:63], v3, s[20:23], s36 offen sc1
    s_waitcnt lgkmcnt(3)
    v_lshlrev_b32 v95, 22, v120
    v_lshrrev_b32 v120, 16, v120
    v_alignbit_b32 v95, v120, v95, 10
    v_alignbit_b32 v95, v121, v95, 10
    v_xor_b32 v95, 0x80200800, v95
    s_mov_b32 s36, 9437184
    buffer_store_dwordx4 v[92:95], v3, s[20:23], s36 offen sc1
    s_waitcnt lgkmcnt(2)
    v_lshlrev_b32 v67, 22, v122
    v_lshrrev_b32 v122, 16, v122
    v_alignbit_b32 v67, v122, v67, 10
    v_alignbit_b32 v67, v123, v67, 10
    v_xor_b32 v67, 0x80200800, v67
    s_mov_b32 s36, 10485760
    buffer_store_dwordx4 v[64:67], v3, s[20:23], s36 offen sc1
    s_waitcnt lgkmcnt(1)
    v_lshlrev_b32 v99, 22, v124
    v_lshrrev_b32 v124, 16, v124
    v_alignbit_b32 v99, v124, v99, 10
    v_alignbit_b32 v99, v125, v99, 10
    v_xor_b32 v99, 0x80200800, v99
    s_mov_b32 s36, 11534336
    buffer_store_dwordx4 v[96:99], v3, s[20:23], s36 offen sc1
    s_waitcnt lgkmcnt(0)
    v_lshlrev_b32 v71, 22, v126
    v_lshrrev_b32 v126, 16, v126
    v_alignbit_b32 v71, v126, v71, 10
    v_alignbit_b32 v71, v127, v71, 10
    v_xor_b32 v71, 0x80200800, v71
    s_mov_b32 s36, 12582912
    buffer_store_dwordx4 v[68:71], v3, s[20:23], s36 offen sc1
    v_and_b32 v6, 0x34800000, v5
    v_cmp_ne_u32 vcc, 0, v6
    s_lshl_b32 s35, s39, 4
    s_add_u32 s35, s35, 160328
    v_mov_b32 v10, s35
    s_cmp_lg_u64 vcc, 0
    s_cselect_b32 s36, 1, s55
    v_mov_b32 v11, s36
    ds_write_b32 v10, v11
    s_waitcnt lgkmcnt(0)
    s_barrier
    s_cmp_lg_u32 s39, 0
    s_cbranch_scc1 L_p1_end
    v_and_b32 v6, 15, v0
    v_lshlrev_b32 v6, 4, v6
    v_add_u32 v6, 160320, v6
    ds_read_b128 v[8:11], v6
    s_waitcnt lgkmcnt(0)
    s_nop 1
    v_max_u32_dpp v8, v8, v8 row_shr:1 row_mask:0xf bank_mask:0xf bound_ctrl:0
    s_nop 1
    v_max_u32_dpp v8, v8, v8 row_shr:2 row_mask:0xf bank_mask:0xf bound_ctrl:0
    s_nop 1
    v_max_u32_dpp v8, v8, v8 row_shr:4 row_mask:0xf bank_mask:0xf bound_ctrl:0
    s_nop 1
    v_max_u32_dpp v8, v8, v8 row_shr:8 row_mask:0xf bank_mask:0xf bound_ctrl:0
    s_nop 1
    v_add_f32_dpp v9, v9, v9 row_shr:1 row_mask:0xf bank_mask:0xf bound_ctrl:0
    s_nop 1
    v_add_f32_dpp v9, v9, v9 row_shr:2 row_mask:0xf bank_mask:0xf bound_ctrl:0
    s_nop 1
    v_add_f32_dpp v9, v9, v9 row_shr:4 row_mask:0xf bank_mask:0xf bound_ctrl:0
    s_nop 1
    v_add_f32_dpp v9, v9, v9 row_shr:8 row_mask:0xf bank_mask:0xf bound_ctrl:0
    s_nop 1
    v_or_b32_dpp v10, v10, v10 row_shr:1 row_mask:0xf bank_mask:0xf bound_ctrl:0
    s_nop 1
    v_or_b32_dpp v10, v10, v10 row_shr:2 row_mask:0xf bank_mask:0xf bound_ctrl:0
    s_nop 1
    v_or_b32_dpp v10, v10, v10 row_shr:4 row_mask:0xf bank_mask:0xf bound_ctrl:0
    s_nop 1
    v_or_b32_dpp v10, v10, v10 row_shr:8 row_mask:0xf bank_mask:0xf bound_ctrl:0
    s_lshl_b32 s35, s2, 3
    s_mov_b32 s26, 8540160
    s_add_u32 s35, s35, 8519680
    v_mov_b32 v6, 0
    v_lshl_or_b32 v8, v10, 16, v8
    s_mov_b64 exec, 0x8000
    buffer_store_dwordx2 v[8:9], v6, s[24:27], s35 offen
    s_lshl_b32 s35, s2, 8
    s_add_u32 s35, s35, 8523776
    buffer_store_dword v6, v6, s[24:27], s35 offen
L_p1_end:
    s_endpgm
.globl p2_kernel
.p2align 8
.type p2_kernel,@function
p2_kernel:
    s_cmp_ge_u32 s2, 256
    s_cbranch_scc1 L_p2_end
    s_load_dwordx2 s[4:5], s[0:1], 104
    s_load_dwordx2 s[100:101], s[0:1], 24
    s_load_dwordx2 s[8:9], s[0:1], 0
    s_load_dwordx2 s[30:31], s[0:1], 40
    s_load_dwordx4 s[32:35], s[0:1], 56
    s_load_dwordx4 s[36:39], s[0:1], 72
    s_and_b32 s14, s2, 7
    s_lshr_b32 s49, s2, 3
    s_and_b32 s3, s14, 1
    s_lshl_b32 s3, s3, 5
    s_add_u32 s3, s3, s49
    s_lshr_b32 s12, s14, 1
    v_lshrrev_b32 v108, 6, v0
    v_lshlrev_b32 v1, 4, v0
    v_and_b32 v109, 63, v0
    v_readfirstlane_b32 s13, v108
    v_lshlrev_b32 v111, 4, v109
    v_lshrrev_b32 v110, 2, v109
    v_mul_u32_u24 v110, 8256, v110
    v_add_u32 v110, v110, v111
    s_mul_i32 s14, s12, 65
    s_add_u32 s14, s14, s3
    s_lshl_b32 s14, s14, 5
    s_mul_i32 s15, s13, 532480
    s_add_u32 s14, s14, s15
    s_add_u32 s25, s14, 0
    s_mul_i32 s22, s12, 1280000
    s_mov_b32 s2, 0
    s_waitcnt lgkmcnt(0)
    s_mov_b32 s6, 655360000
    s_mov_b32 s7, 0x00020000
    s_add_u32 s10, s22, 1280000
    s_mov_b32 s11, 0x00020000
    s_add_u32 s15, s25, 0
    buffer_load_dwordx4 v[28:31], v110, s[4:7], s15 offen
    s_add_u32 s15, s25, 133120
    buffer_load_dwordx4 v[32:35], v110, s[4:7], s15 offen
    s_add_u32 s15, s25, 266240
    buffer_load_dwordx4 v[36:39], v110, s[4:7], s15 offen
    s_add_u32 s15, s25, 399360
    buffer_load_dwordx4 v[40:43], v110, s[4:7], s15 offen
    s_load_dwordx4 s[40:43], s[30:31], 0
    s_load_dwordx16 s[52:67], s[32:33], 0
    s_load_dwordx16 s[68:83], s[34:35], 0
    s_load_dwordx8 s[84:91], s[36:37], 0
    s_load_dwordx8 s[92:99], s[38:39], 0
    v_mov_b32 v52, 0x100
    s_cmp_lg_u32 s13, 0
    s_cbranch_scc1 L_p2_noann
    s_lshl_b32 s14, s3, 8
    s_add_u32 s14, s14, 8523776
    s_mov_b64 exec, 1
    buffer_atomic_add v52, off, s[4:7], s14
    s_mov_b64 exec, -1
L_p2_noann:
    s_add_u32 s14, s22, 0
    buffer_load_dwordx4 v[88:91], v1, s[8:11], s14 offen
    s_add_u32 s14, s22, 16384
    buffer_load_dwordx4 v[92:95], v1, s[8:11], s14 offen
    s_add_u32 s14, s22, 32768
    buffer_load_dwordx4 v[96:99], v1, s[8:11], s14 offen
    s_add_u32 s14, s22, 49152
    buffer_load_dwordx4 v[100:103], v1, s[8:11], s14 offen
    s_add_u32 s14, s22, 65536
    buffer_load_dwordx4 v[104:107], v1, s[8:11], s14 offen
    s_mov_b32 s15, 8519680
    buffer_load_dwordx4 v[80:83], v111, s[4:7], s15 offen offset:0
    buffer_load_dwordx4 v[84:87], v111, s[4:7], s15 offen offset:1024
    v_lshlrev_b32 v2, 10, v109
    v_mov_b32 v50, 21845
    v_add_u32 v3, 80000, v1
    v_add_u32 v124, 145536, v1
    v_add_u32 v113, 65536, v1
    v_mov_b32 v112, 0x7f000000
    v_cmp_gt_u32 vcc, 904, v0
    s_mul_i32 s19, s13, 240
    s_add_u32 s19, s19, 160000
    v_cndmask_b32 v124, v112, v124, vcc
    v_cndmask_b32 v113, v112, v113, vcc
    v_lshl_add_u32 v6, v109, 2, s19
    v_lshl_add_u32 v126, v109, 1, s19
    v_cmp_gt_u32 vcc, 10, v109
    s_lshl_b32 s27, s13, 16
    s_mov_b32 s23, 1024
    v_cndmask_b32 v6, v112, v6, vcc
    s_add_u32 s44, s4, 4194304
    s_addc_u32 s45, s5, 1048576
    s_mov_b32 s46, 14024704
    s_mov_b32 s47, 0x00020000
    s_mov_b32 s18, 80000
    s_and_b32 s50, s3, 1
    s_lshl_b32 s50, s50, 18
    s_sub_u32 s18, s18, s50
    s_sub_u32 s50, 4294836224, s50
    v_lshlrev_b32 v116, 3, v0
    v_and_b32 v116, 16, v116
    v_and_b32 v117, 1, v0
    v_lshl_or_b32 v116, v117, 5, v116
    v_mov_b32 v58, 0x3f80
    v_mov_b32 v59, 0
    v_lshlrev_b64 v[58:59], v116, v[58:59]
    v_mov_b32 v4, 0
    v_mov_b32 v5, 0
    v_mov_b32 v114, 0xff00
    v_bfe_u32 v127, v0, 0, 1
    v_mul_u32_u24 v127, 40, v127
    v_add_u32 v127, s19, v127
    ds_write2_b32 v6, v5, v5 offset0:34 offset1:44
    ds_write_b16 v126, v114 offset:2
    v_mov_b32 v44, 1073758208
    v_mov_b32 v45, 1073758208
    v_mov_b32 v46, 1073758208
    v_mov_b32 v47, 1073758208
    v_mov_b32 v48, 1073758208
    v_mov_b32 v49, 1073758208
    ds_write_b128 v113, v[44:47]
    v_lshrrev_b32 v115, 4, v109
    v_mul_u32_u24 v115, 15360, v115
    v_lshl_add_u32 v115, v109, 6, v115
    v_lshl_add_u32 v115, v108, 10, v115
    s_waitcnt lgkmcnt(0)
    v_mov_b32 v53, s40
    v_mov_b32 v54, s41
    v_mov_b32 v56, s42
    v_mov_b32 v57, s43
    s_mov_b32 s40, 20987904
    s_mov_b32 s41, 21031594
    s_pack_ll_b32_b16 s14, s52, s54
    s_pack_hh_b32_b16 s15, s52, s54
    s_pack_ll_b32_b16 s54, s53, s55
    s_pack_hh_b32_b16 s55, s53, s55
    s_mov_b32 s52, s14
    s_mov_b32 s53, s15
    s_pack_ll_b32_b16 s14, s56, s58
    s_pack_hh_b32_b16 s15, s56, s58
    s_pack_ll_b32_b16 s58, s57, s59
    s_pack_hh_b32_b16 s59, s57, s59
    s_mov_b32 s56, s14
    s_mov_b32 s57, s15
    s_pack_ll_b32_b16 s14, s60, s62
    s_pack_hh_b32_b16 s15, s60, s62
    s_pack_ll_b32_b16 s62, s61, s63
    s_pack_hh_b32_b16 s63, s61, s63
    s_mov_b32 s60, s14
    s_mov_b32 s61, s15
    s_pack_ll_b32_b16 s14, s64, s66
    s_pack_hh_b32_b16 s15, s64, s66
    s_pack_ll_b32_b16 s66, s65, s67
    s_pack_hh_b32_b16 s67, s65, s67
    s_mov_b32 s64, s14
    s_mov_b32 s65, s15
    s_pack_ll_b32_b16 s14, s68, s70
    s_pack_hh_b32_b16 s15, s68, s70
    s_pack_ll_b32_b16 s70, s69, s71
    s_pack_hh_b32_b16 s71, s69, s71
    s_mov_b32 s68, s14
    s_mov_b32 s69, s15
    s_pack_ll_b32_b16 s14, s72, s74
    s_pack_hh_b32_b16 s15, s72, s74
    s_pack_ll_b32_b16 s74, s73, s75
    s_pack_hh_b32_b16 s75, s73, s75
    s_mov_b32 s72, s14
    s_mov_b32 s73, s15
    s_pack_ll_b32_b16 s14, s76, s78
    s_pack_hh_b32_b16 s15, s76, s78
    s_pack_ll_b32_b16 s78, s77, s79
    s_pack_hh_b32_b16 s79, s77, s79
    s_mov_b32 s76, s14
    s_mov_b32 s77, s15
    s_pack_ll_b32_b16 s14, s80, s82
    s_pack_hh_b32_b16 s15, s80, s82
    s_pack_ll_b32_b16 s82, s81, s83
    s_pack_hh_b32_b16 s83, s81, s83
    s_mov_b32 s80, s14
    s_mov_b32 s81, s15
    s_waitcnt vmcnt(10)
    ds_write_b128 v1, v[28:31] offset:0
    s_waitcnt vmcnt(9)
    ds_write_b128 v1, v[32:35] offset:16384
    s_waitcnt vmcnt(8)
    ds_write_b128 v1, v[36:39] offset:32768
    s_waitcnt vmcnt(7)
    ds_write_b128 v1, v[40:43] offset:49152
    ds_read_b128 v[28:31], v115 offset:0
    ds_read_b128 v[36:39], v115 offset:32
    ds_read_b128 v[32:35], v115 offset:16
    ds_read_b128 v[40:43], v115 offset:48
    ds_write_b128 v1, v[44:47] offset:0
    ds_write_b128 v1, v[44:47] offset:16384
    ds_write_b128 v1, v[44:47] offset:32768
    ds_write_b128 v1, v[44:47] offset:49152
    s_waitcnt lgkmcnt(6)
    v_mad_u32_u16 v108, v28, v50, s40 op_sel:[0,0,0,0]
    v_mad_u32_u16 v109, v36, v50, s41 op_sel:[0,0,0,0]
    v_sub_u32_sdwa v110, v109, v108 dst_sel:DWORD dst_unused:UNUSED_PAD src0_sel:WORD_1 src1_sel:WORD_1
    s_nop 1
    v_add_u32_dpp v110, v110, v110 row_shr:1 row_mask:0xf bank_mask:0xf bound_ctrl:0
    s_nop 1
    v_add_u32_dpp v110, v110, v110 row_shr:2 row_mask:0xf bank_mask:0xf bound_ctrl:0
    s_nop 1
    v_add_u32_dpp v110, v110, v110 row_shr:4 row_mask:0xf bank_mask:0xf bound_ctrl:0
    s_nop 1
    v_add_u32_dpp v110, v110, v110 row_shr:8 row_mask:0xf bank_mask:0xf bound_ctrl:0
    s_nop 1
    v_add_u32_dpp v110, v110, v110 row_bcast:15 row_mask:0xa bank_mask:0xf
    s_nop 1
    v_add_u32_dpp v110, v110, v110 row_bcast:31 row_mask:0xc bank_mask:0xf
    v_sub_u32_sdwa v109, v109, v110 dst_sel:DWORD dst_unused:UNUSED_PAD src0_sel:WORD_1 src1_sel:DWORD
    v_readlane_b32 s29, v110, 63
    v_add_u32 v110, -1, v110
    ds_write_b16 v126, v109
    v_lshlrev_b32_e64 v111, v110, 1
    v_lshrrev_b32 v110, 5, v110
    s_cmp_gt_u32 s29, 320
    s_cselect_b32 s2, 1, s2
    v_lshl_add_u32 v110, v110, 2, v127
    s_cselect_b64 exec, 0, -1
    ds_or_b32 v110, v111 offset:136
    s_mov_b64 exec, -1
    ds_wrxchg2_rtn_b32 v[108:109], v6, v5, v5 offset0:34 offset1:44
    s_waitcnt lgkmcnt(0)
    v_or_b32 v7, v108, v109
    s_nop 0
    v_readlane_b32 s30, v7, 0
    v_readlane_b32 s31, v7, 1
    v_readlane_b32 s32, v7, 2
    v_readlane_b32 s33, v7, 3
    v_readlane_b32 s34, v7, 4
    v_readlane_b32 s35, v7, 5
    v_readlane_b32 s36, v7, 6
    v_readlane_b32 s37, v7, 7
    s_mov_b32 s25, s19
    s_mov_b32 s26, s27
    s_mov_b32 s51, s28
    s_mov_b32 s28, s29
    v_mbcnt_lo_u32_b32 v8, s30, 0
    v_mbcnt_hi_u32_b32 v8, s31, v8
    s_bcnt1_i32_b64 s14, s[30:31]
    v_lshl_add_u32 v9, v8, 1, s25
    ds_read_u16 v9, v9
    s_add_u32 s30, s26, 0
    s_lshl1_add_u32 s25, s14, s25
    s_lshl_b32 s14, s14, 10
    s_add_u32 s26, s26, s14
    v_mbcnt_lo_u32_b32 v12, s32, 0
    v_mbcnt_hi_u32_b32 v12, s33, v12
    s_bcnt1_i32_b64 s14, s[32:33]
    v_lshl_add_u32 v13, v12, 1, s25
    ds_read_u16 v13, v13
    s_add_u32 s32, s26, 1048576
    s_lshl1_add_u32 s25, s14, s25
    s_lshl_b32 s14, s14, 10
    s_add_u32 s26, s26, s14
    v_mbcnt_lo_u32_b32 v16, s34, 0
    v_mbcnt_hi_u32_b32 v16, s35, v16
    s_bcnt1_i32_b64 s14, s[34:35]
    v_lshl_add_u32 v17, v16, 1, s25
    ds_read_u16 v17, v17
    s_add_u32 s34, s26, 2097152
    s_lshl1_add_u32 s25, s14, s25
    s_lshl_b32 s14, s14, 10
    s_add_u32 s26, s26, s14
    v_mbcnt_lo_u32_b32 v20, s36, 0
    v_mbcnt_hi_u32_b32 v20, s37, v20
    s_bcnt1_i32_b64 s14, s[36:37]
    v_lshl_add_u32 v21, v20, 1, s25
    ds_read_u16 v21, v21
    s_add_u32 s36, s26, 3145728
    s_lshl1_add_u32 s25, s14, s25
    s_lshl_b32 s14, s14, 10
    s_add_u32 s26, s26, s14
    s_waitcnt lgkmcnt(3)
    v_mad_u32_u16 v9, v9, s23, v2
    v_pk_lshrrev_b16 v9, 10, v9 op_sel_hi:[1,1]
    v_lshl_add_u32 v8, v8, 6, v9
    buffer_load_dwordx4 v[8:11], v8, s[44:47], s30 idxen
    s_waitcnt lgkmcnt(2)
    v_mad_u32_u16 v13, v13, s23, v2
    v_pk_lshrrev_b16 v13, 10, v13 op_sel_hi:[1,1]
    v_lshl_add_u32 v12, v12, 6, v13
    buffer_load_dwordx4 v[12:15], v12, s[44:47], s32 idxen
    s_waitcnt lgkmcnt(1)
    v_mad_u32_u16 v17, v17, s23, v2
    v_pk_lshrrev_b16 v17, 10, v17 op_sel_hi:[1,1]
    v_lshl_add_u32 v16, v16, 6, v17
    buffer_load_dwordx4 v[16:19], v16, s[44:47], s34 idxen
    s_waitcnt lgkmcnt(0)
    v_mad_u32_u16 v21, v21, s23, v2
    v_pk_lshrrev_b16 v21, 10, v21 op_sel_hi:[1,1]
    v_lshl_add_u32 v20, v20, 6, v21
    buffer_load_dwordx4 v[20:23], v20, s[44:47], s36 idxen
    s_cmp_le_u32 s28, 256
    s_cbranch_scc1 L_p2_kernel_noopt_1
    v_readlane_b32 s38, v7, 8
    v_readlane_b32 s39, v7, 9
    s_nop 1
    v_mbcnt_lo_u32_b32 v51, s38, 0
    v_mbcnt_hi_u32_b32 v51, s39, v51
    s_bcnt1_i32_b64 s14, s[38:39]
    v_lshl_add_u32 v55, v51, 1, s25
    ds_read_u16 v55, v55
    s_add_u32 s38, s26, 4194304
    s_lshl1_add_u32 s25, s14, s25
    s_lshl_b32 s14, s14, 10
    s_add_u32 s26, s26, s14
    s_waitcnt lgkmcnt(0)
    v_mad_u32_u16 v55, v55, s23, v2
    v_pk_lshrrev_b16 v55, 10, v55 op_sel_hi:[1,1]
    v_lshl_add_u32 v51, v51, 6, v55
    buffer_load_dwordx4 v[24:27], v51, s[44:47], s38 idxen
L_p2_kernel_noopt_1:
    s_waitcnt vmcnt(6)
    ds_write_b128 v3, v[88:91] offset:0
    ds_write_b128 v3, v[92:95] offset:16384
    ds_write_b128 v3, v[96:99] offset:32768
    ds_write_b128 v3, v[100:103] offset:49152
    ds_write_b128 v124, v[104:107] offset:0
    s_waitcnt vmcnt(4)
    v_max3_u32 v64, v80, v82, v84
    v_add_f32 v65, v81, v83
    v_add_f32 v66, v85, v87
    v_max_u32 v64, v64, v86
    v_add_f32 v65, v65, v66
    v_cmp_lt_u32 vcc, 0xffff, v64
    s_nop 1
    v_max_u32_dpp v64, v64, v64 row_shr:1 row_mask:0xf bank_mask:0xf bound_ctrl:0
    s_nop 1
    v_max_u32_dpp v64, v64, v64 row_shr:2 row_mask:0xf bank_mask:0xf bound_ctrl:0
    s_nop 1
    v_max_u32_dpp v64, v64, v64 row_shr:4 row_mask:0xf bank_mask:0xf bound_ctrl:0
    s_nop 1
    v_max_u32_dpp v64, v64, v64 row_shr:8 row_mask:0xf bank_mask:0xf bound_ctrl:0
    s_nop 1
    v_max_u32_dpp v64, v64, v64 row_bcast:15 row_mask:0xa bank_mask:0xf
    s_nop 1
    v_max_u32_dpp v64, v64, v64 row_bcast:31 row_mask:0xc bank_mask:0xf
    s_nop 1
    v_add_f32_dpp v65, v65, v65 row_shr:1 row_mask:0xf bank_mask:0xf bound_ctrl:0
    s_nop 1
    v_add_f32_dpp v65, v65, v65 row_shr:2 row_mask:0xf bank_mask:0xf bound_ctrl:0
    s_nop 1
    v_add_f32_dpp v65, v65, v65 row_shr:4 row_mask:0xf bank_mask:0xf bound_ctrl:0
    s_nop 1
    v_add_f32_dpp v65, v65, v65 row_shr:8 row_mask:0xf bank_mask:0xf bound_ctrl:0
    s_nop 1
    v_add_f32_dpp v65, v65, v65 row_bcast:15 row_mask:0xa bank_mask:0xf
    s_nop 1
    v_add_f32_dpp v65, v65, v65 row_bcast:31 row_mask:0xc bank_mask:0xf
    s_cmp_lg_u64 vcc, 0
    s_cselect_b32 s2, 1, s2
    v_lshlrev_b32 v64, 16, v64
    v_mul_f32 v66, 936490775, v65
    v_mul_f32 v65, 928531664, v65
    v_cmp_nle_f32 vcc, v64, v66
    v_max_u32 v64, v64, v65
    s_nop 0
    v_readlane_b32 s14, v64, 63
    s_bitcmp1_b32 vcc_hi, 31
    s_cselect_b32 s2, 1, s2
    s_lshr_b32 s14, s14, 23
    s_add_u32 s14, s14, 1
    s_cmp_lt_u32 s14, 40
    s_cselect_b32 s2, 1, s2
    s_cmp_gt_u32 s14, 230
    s_cselect_b32 s2, 1, s2
    s_sub_u32 s48, s14, 14
    s_lshl_b32 s48, s48, 23
    s_add_u32 s16, s48, 272629760
    s_lshr_b32 s15, s16, 16
    s_sub_u32 s15, 0x10000, s15
    s_add_u32 s20, s16, s15
    s_sub_u32 s17, s20, 1
    s_mov_b32 s21, s17
    s_or_b32 s48, s48, 16416
    s_sub_u32 s14, s14, 40
    s_cmp_gt_u32 s14, 190
    s_cselect_b32 s48, 0, s48
    s_waitcnt lgkmcnt(0)
    s_barrier
    s_add_u32 s14, s22, 80000
    buffer_load_dwordx4 v[88:91], v1, s[8:11], s14 offen
    s_add_u32 s14, s22, 96384
    buffer_load_dwordx4 v[92:95], v1, s[8:11], s14 offen
    v_mad_u32_u16 v108, v28, v50, s40 op_sel:[1,0,0,0]
    v_mad_u32_u16 v109, v36, v50, s41 op_sel:[1,0,0,0]
    v_sub_u32_sdwa v110, v109, v108 dst_sel:DWORD dst_unused:UNUSED_PAD src0_sel:WORD_1 src1_sel:WORD_1
    s_nop 1
    v_add_u32_dpp v110, v110, v110 row_shr:1 row_mask:0xf bank_mask:0xf bound_ctrl:0
    s_nop 1
    v_add_u32_dpp v110, v110, v110 row_shr:2 row_mask:0xf bank_mask:0xf bound_ctrl:0
    s_nop 1
    v_add_u32_dpp v110, v110, v110 row_shr:4 row_mask:0xf bank_mask:0xf bound_ctrl:0
    s_nop 1
    v_add_u32_dpp v110, v110, v110 row_shr:8 row_mask:0xf bank_mask:0xf bound_ctrl:0
    s_nop 1
    v_add_u32_dpp v110, v110, v110 row_bcast:15 row_mask:0xa bank_mask:0xf
    s_nop 1
    v_add_u32_dpp v110, v110, v110 row_bcast:31 row_mask:0xc bank_mask:0xf
    v_sub_u32_sdwa v109, v109, v110 dst_sel:DWORD dst_unused:UNUSED_PAD src0_sel:WORD_1 src1_sel:DWORD
    v_readlane_b32 s29, v110, 63
    v_add_u32 v110, -1, v110
    ds_write_b16 v126, v109
    v_lshlrev_b32_e64 v111, v110, 1
    v_lshrrev_b32 v110, 5, v110
    s_cmp_gt_u32 s29, 320
    s_cselect_b32 s2, 1, s2
    v_lshl_add_u32 v110, v110, 2, v127
    s_cselect_b64 exec, 0, -1
    ds_or_b32 v110, v111 offset:136
    s_mov_b64 exec, -1
    ds_wrxchg2_rtn_b32 v[108:109], v6, v5, v5 offset0:34 offset1:44
    s_mov_b32 s24, 0
L_p2_loop:
    s_add_u32 s22, s22, 80000
    s_lshl_b32 s14, s13, 4
    s_or_b32 s14, s14, s24
    s_cmp_lg_u32 s14, 5
    s_cbranch_scc1 L_p2_nost
    v_mov_b32 v52, 0
    s_lshl_b32 s14, s3, 8
    s_add_u32 s14, s14, 8523776
    s_mov_b64 exec, 1
    buffer_atomic_add v52, off, s[4:7], s14 sc0
    s_mov_b64 exec, -1
L_p2_nost:
    s_waitcnt vmcnt(5)
    v_mad_u32_u16 v64, v8, 8, s18
    v_mad_u32_u16 v66, v9, 8, s18
    v_mad_u32_u16 v68, v10, 8, s18
    ds_read_b64 v[64:65], v64
    ds_read_b64 v[66:67], v66
    ds_read_b64 v[68:69], v68
    s_add_u32 s14, s22, 32768
    buffer_load_dwordx4 v[96:99], v1, s[8:11], s14 offen
    s_waitcnt vmcnt(5)
    v_mad_u32_u16 v70, v12, 8, s18
    v_mad_u32_u16 v72, v13, 8, s18
    v_mad_u32_u16 v74, v14, 8, s18
    ds_read_b64 v[70:71], v70
    ds_read_b64 v[72:73], v72
    ds_read_b64 v[74:75], v74
    s_add_u32 s14, s22, 49152
    buffer_load_dwordx4 v[100:103], v1, s[8:11], s14 offen
    s_waitcnt lgkmcnt(6)
    v_or_b32 v7, v108, v109
    s_nop 0
    v_readlane_b32 s30, v7, 0
    v_readlane_b32 s31, v7, 1
    v_readlane_b32 s32, v7, 2
    v_readlane_b32 s33, v7, 3
    v_readlane_b32 s34, v7, 4
    v_readlane_b32 s35, v7, 5
    v_readlane_b32 s36, v7, 6
    v_readlane_b32 s37, v7, 7
    s_mov_b32 s25, s19
    s_mov_b32 s26, s27
    s_mov_b32 s51, s28
    s_mov_b32 s28, s29
    v_mbcnt_lo_u32_b32 v51, s30, 0
    v_mbcnt_hi_u32_b32 v51, s31, v51
    s_bcnt1_i32_b64 s14, s[30:31]
    v_lshl_add_u32 v55, v51, 1, s25
    ds_read_u16 v55, v55
    s_add_u32 s30, s26, 0
    s_lshl1_add_u32 s25, s14, s25
    s_lshl_b32 s14, s14, 10
    s_add_u32 s26, s26, s14
    v_bfe_i32 v108, v11, 2, 10
    v_bfe_i32 v109, v11, 12, 10
    v_ashrrev_i32 v110, 22, v11
    v_cvt_f32_i32 v108, v108
    v_cvt_f32_i32 v109, v109
    v_cvt_f32_i32 v110, v110
    s_waitcnt lgkmcnt(4)
    v_mfma_f32_4x4x4_16b_bf16 v[112:115], v[58:59], v[64:65], 0
    v_mfma_f32_4x4x4_16b_bf16 v[116:119], v[58:59], v[66:67], 0
    v_mfma_f32_4x4x4_16b_bf16 v[120:123], v[58:59], v[68:69], 0
    v_mad_u32_u16 v8, v8, 8, s50 op_sel:[1,0,0,0]
    v_mad_u32_u16 v9, v9, 8, s50 op_sel:[1,0,0,0]
    v_mad_u32_u16 v10, v10, 8, s50 op_sel:[1,0,0,0]
    v_pk_fma_f32 v[114:115], v[114:115], v[108:109], s[20:21] op_sel:[0,0,0] op_sel_hi:[1,0,1]
    v_pk_fma_f32 v[112:113], v[112:113], v[108:109], s[16:17] op_sel:[0,0,0] op_sel_hi:[1,0,1]
    v_pk_fma_f32 v[118:119], v[118:119], v[108:109], s[20:21] op_sel:[0,1,0] op_sel_hi:[1,1,1]
    v_pk_fma_f32 v[116:117], v[116:117], v[108:109], s[16:17] op_sel:[0,1,0] op_sel_hi:[1,1,1]
    v_pk_fma_f32 v[122:123], v[122:123], v[110:111], s[20:21] op_sel:[0,0,0] op_sel_hi:[1,0,1]
    v_pk_fma_f32 v[120:121], v[120:121], v[110:111], s[16:17] op_sel:[0,0,0] op_sel_hi:[1,0,1]
    v_lshlrev_b64 v[114:115], 16, v[114:115]
    v_lshlrev_b64 v[118:119], 16, v[118:119]
    v_lshlrev_b64 v[122:123], 16, v[122:123]
    v_lshl_add_u64 v[64:65], v[112:113], 0, v[114:115]
    v_lshl_add_u64 v[66:67], v[116:117], 0, v[118:119]
    v_lshl_add_u64 v[68:69], v[120:121], 0, v[122:123]
    v_or3_b32 v4, v44, v45, v4
    v_or3_b32 v4, v46, v47, v4
    v_or3_b32 v4, v48, v49, v4
    ds_add_rtn_u64 v[44:45], v8, v[64:65]
    ds_add_rtn_u64 v[46:47], v9, v[66:67]
    ds_add_rtn_u64 v[48:49], v10, v[68:69]
    s_waitcnt lgkmcnt(3)
    v_mad_u32_u16 v55, v55, s23, v2
    v_pk_lshrrev_b16 v55, 10, v55 op_sel_hi:[1,1]
    v_lshl_add_u32 v51, v51, 6, v55
    buffer_load_dwordx4 v[8:11], v51, s[44:47], s30 idxen
    s_add_u32 s14, s22, 65536
    buffer_load_dwordx4 v[104:107], v1, s[8:11], s14 offen
    s_waitcnt vmcnt(7)
    v_mad_u32_u16 v76, v16, 8, s18
    v_mad_u32_u16 v78, v17, 8, s18
    v_mad_u32_u16 v80, v18, 8, s18
    ds_read_b64 v[76:77], v76
    ds_read_b64 v[78:79], v78
    ds_read_b64 v[80:81], v80
    s_waitcnt vmcnt(6)
    v_mad_u32_u16 v82, v20, 8, s18
    v_mad_u32_u16 v84, v21, 8, s18
    v_mad_u32_u16 v86, v22, 8, s18
    ds_read_b64 v[82:83], v82
    ds_read_b64 v[84:85], v84
    ds_read_b64 v[86:87], v86
    s_cmp_le_u32 s51, 256
    s_cbranch_scc1 L_p2_kernel_noopt3_2
    v_mad_u32_u16 v64, v24, 8, s18
    v_mad_u32_u16 v66, v25, 8, s18
    v_mad_u32_u16 v68, v26, 8, s18
    ds_read_b64 v[64:65], v64
    ds_read_b64 v[66:67], v66
    ds_read_b64 v[68:69], v68
L_p2_kernel_noopt3_2:
    v_mbcnt_lo_u32_b32 v51, s32, 0
    v_mbcnt_hi_u32_b32 v51, s33, v51
    s_bcnt1_i32_b64 s14, s[32:33]
    v_lshl_add_u32 v55, v51, 1, s25
    ds_read_u16 v55, v55
    s_add_u32 s32, s26, 1048576
    s_lshl1_add_u32 s25, s14, s25
    s_lshl_b32 s14, s14, 10
    s_add_u32 s26, s26, s14
    v_bfe_i32 v108, v15, 2, 10
    v_bfe_i32 v109, v15, 12, 10
    v_ashrrev_i32 v110, 22, v15
    v_cvt_f32_i32 v108, v108
    v_cvt_f32_i32 v109, v109
    v_cvt_f32_i32 v110, v110
    v_mfma_f32_4x4x4_16b_bf16 v[112:115], v[58:59], v[70:71], 0
    v_mfma_f32_4x4x4_16b_bf16 v[116:119], v[58:59], v[72:73], 0
    v_mfma_f32_4x4x4_16b_bf16 v[120:123], v[58:59], v[74:75], 0
    v_mad_u32_u16 v12, v12, 8, s50 op_sel:[1,0,0,0]
    v_mad_u32_u16 v13, v13, 8, s50 op_sel:[1,0,0,0]
    v_mad_u32_u16 v14, v14, 8, s50 op_sel:[1,0,0,0]
    v_pk_fma_f32 v[114:115], v[114:115], v[108:109], s[20:21] op_sel:[0,0,0] op_sel_hi:[1,0,1]
    v_pk_fma_f32 v[112:113], v[112:113], v[108:109], s[16:17] op_sel:[0,0,0] op_sel_hi:[1,0,1]
    v_pk_fma_f32 v[118:119], v[118:119], v[108:109], s[20:21] op_sel:[0,1,0] op_sel_hi:[1,1,1]
    v_pk_fma_f32 v[116:117], v[116:117], v[108:109], s[16:17] op_sel:[0,1,0] op_sel_hi:[1,1,1]
    v_pk_fma_f32 v[122:123], v[122:123], v[110:111], s[20:21] op_sel:[0,0,0] op_sel_hi:[1,0,1]
    v_pk_fma_f32 v[120:121], v[120:121], v[110:111], s[16:17] op_sel:[0,0,0] op_sel_hi:[1,0,1]
    v_lshlrev_b64 v[114:115], 16, v[114:115]
    v_lshlrev_b64 v[118:119], 16, v[118:119]
    v_lshlrev_b64 v[122:123], 16, v[122:123]
    v_lshl_add_u64 v[70:71], v[112:113], 0, v[114:115]
    v_lshl_add_u64 v[72:73], v[116:117], 0, v[118:119]
    v_lshl_add_u64 v[74:75], v[120:121], 0, v[122:123]
    s_waitcnt lgkmcnt(7)
    v_or3_b32 v4, v44, v45, v4
    v_or3_b32 v4, v46, v47, v4
    v_or3_b32 v4, v48, v49, v4
    ds_add_rtn_u64 v[44:45], v12, v[70:71]
    ds_add_rtn_u64 v[46:47], v13, v[72:73]
    ds_add_rtn_u64 v[48:49], v14, v[74:75]
    s_waitcnt lgkmcnt(3)
    v_mad_u32_u16 v55, v55, s23, v2
    v_pk_lshrrev_b16 v55, 10, v55 op_sel_hi:[1,1]
    v_lshl_add_u32 v51, v51, 6, v55
    buffer_load_dwordx4 v[12:15], v51, s[44:47], s32 idxen
    s_barrier
    s_waitcnt vmcnt(1)
    ds_write_b128 v3, v[88:91] offset:0
    ds_write_b128 v3, v[92:95] offset:16384
    ds_write_b128 v3, v[96:99] offset:32768
    ds_write_b128 v3, v[100:103] offset:49152
    ds_write_b128 v124, v[104:107] offset:0
    v_mbcnt_lo_u32_b32 v51, s34, 0
    v_mbcnt_hi_u32_b32 v51, s35, v51
    s_bcnt1_i32_b64 s14, s[34:35]
    v_lshl_add_u32 v55, v51, 1, s25
    ds_read_u16 v55, v55
    s_add_u32 s34, s26, 2097152
    s_lshl1_add_u32 s25, s14, s25
    s_lshl_b32 s14, s14, 10
    s_add_u32 s26, s26, s14
    v_bfe_i32 v108, v19, 2, 10
    v_bfe_i32 v109, v19, 12, 10
    v_ashrrev_i32 v110, 22, v19
    v_cvt_f32_i32 v108, v108
    v_cvt_f32_i32 v109, v109
    v_cvt_f32_i32 v110, v110
    v_mfma_f32_4x4x4_16b_bf16 v[112:115], v[58:59], v[76:77], 0
    v_mfma_f32_4x4x4_16b_bf16 v[116:119], v[58:59], v[78:79], 0
    v_mfma_f32_4x4x4_16b_bf16 v[120:123], v[58:59], v[80:81], 0
    v_mad_u32_u16 v16, v16, 8, s50 op_sel:[1,0,0,0]
    v_mad_u32_u16 v17, v17, 8, s50 op_sel:[1,0,0,0]
    v_mad_u32_u16 v18, v18, 8, s50 op_sel:[1,0,0,0]
    v_pk_fma_f32 v[114:115], v[114:115], v[108:109], s[20:21] op_sel:[0,0,0] op_sel_hi:[1,0,1]
    v_pk_fma_f32 v[112:113], v[112:113], v[108:109], s[16:17] op_sel:[0,0,0] op_sel_hi:[1,0,1]
    v_pk_fma_f32 v[118:119], v[118:119], v[108:109], s[20:21] op_sel:[0,1,0] op_sel_hi:[1,1,1]
    v_pk_fma_f32 v[116:117], v[116:117], v[108:109], s[16:17] op_sel:[0,1,0] op_sel_hi:[1,1,1]
    v_pk_fma_f32 v[122:123], v[122:123], v[110:111], s[20:21] op_sel:[0,0,0] op_sel_hi:[1,0,1]
    v_pk_fma_f32 v[120:121], v[120:121], v[110:111], s[16:17] op_sel:[0,0,0] op_sel_hi:[1,0,1]
    v_lshlrev_b64 v[114:115], 16, v[114:115]
    v_lshlrev_b64 v[118:119], 16, v[118:119]
    v_lshlrev_b64 v[122:123], 16, v[122:123]
    v_lshl_add_u64 v[76:77], v[112:113], 0, v[114:115]
    v_lshl_add_u64 v[78:79], v[116:117], 0, v[118:119]
    v_lshl_add_u64 v[80:81], v[120:121], 0, v[122:123]
    s_waitcnt lgkmcnt(6)
    v_or3_b32 v4, v44, v45, v4
    v_or3_b32 v4, v46, v47, v4
    v_or3_b32 v4, v48, v49, v4
    ds_add_rtn_u64 v[44:45], v16, v[76:77]
    ds_add_rtn_u64 v[46:47], v17, v[78:79]
    ds_add_rtn_u64 v[48:49], v18, v[80:81]
    s_waitcnt lgkmcnt(3)
    v_mad_u32_u16 v55, v55, s23, v2
    v_pk_lshrrev_b16 v55, 10, v55 op_sel_hi:[1,1]
    v_lshl_add_u32 v51, v51, 6, v55
    buffer_load_dwordx4 v[16:19], v51, s[44:47], s34 idxen
    s_cmp_le_u32 s51, 256
    s_cbranch_scc1 L_p2_kernel_noopt3_3
    v_bfe_i32 v108, v27, 2, 10
    v_bfe_i32 v109, v27, 12, 10
    v_ashrrev_i32 v110, 22, v27
    v_cvt_f32_i32 v108, v108
    v_cvt_f32_i32 v109, v109
    v_cvt_f32_i32 v110, v110
    v_mfma_f32_4x4x4_16b_bf16 v[112:115], v[58:59], v[64:65], 0
    v_mfma_f32_4x4x4_16b_bf16 v[116:119], v[58:59], v[66:67], 0
    v_mfma_f32_4x4x4_16b_bf16 v[120:123], v[58:59], v[68:69], 0
    v_mad_u32_u16 v24, v24, 8, s50 op_sel:[1,0,0,0]
    v_mad_u32_u16 v25, v25, 8, s50 op_sel:[1,0,0,0]
    v_mad_u32_u16 v26, v26, 8, s50 op_sel:[1,0,0,0]
    v_pk_fma_f32 v[114:115], v[114:115], v[108:109], s[20:21] op_sel:[0,0,0] op_sel_hi:[1,0,1]
    v_pk_fma_f32 v[112:113], v[112:113], v[108:109], s[16:17] op_sel:[0,0,0] op_sel_hi:[1,0,1]
    v_pk_fma_f32 v[118:119], v[118:119], v[108:109], s[20:21] op_sel:[0,1,0] op_sel_hi:[1,1,1]
    v_pk_fma_f32 v[116:117], v[116:117], v[108:109], s[16:17] op_sel:[0,1,0] op_sel_hi:[1,1,1]
    v_pk_fma_f32 v[122:123], v[122:123], v[110:111], s[20:21] op_sel:[0,0,0] op_sel_hi:[1,0,1]
    v_pk_fma_f32 v[120:121], v[120:121], v[110:111], s[16:17] op_sel:[0,0,0] op_sel_hi:[1,0,1]
    v_lshlrev_b64 v[114:115], 16, v[114:115]
    v_lshlrev_b64 v[118:119], 16, v[118:119]
    v_lshlrev_b64 v[122:123], 16, v[122:123]
    v_lshl_add_u64 v[64:65], v[112:113], 0, v[114:115]
    v_lshl_add_u64 v[66:67], v[116:117], 0, v[118:119]
    v_lshl_add_u64 v[68:69], v[120:121], 0, v[122:123]
    s_waitcnt lgkmcnt(0)
    v_or3_b32 v4, v44, v45, v4
    v_or3_b32 v4, v46, v47, v4
    v_or3_b32 v4, v48, v49, v4
    ds_add_rtn_u64 v[44:45], v24, v[64:65]
    ds_add_rtn_u64 v[46:47], v25, v[66:67]
    ds_add_rtn_u64 v[48:49], v26, v[68:69]
L_p2_kernel_noopt3_3:
    v_mbcnt_lo_u32_b32 v51, s36, 0
    v_mbcnt_hi_u32_b32 v51, s37, v51
    s_bcnt1_i32_b64 s14, s[36:37]
    v_lshl_add_u32 v55, v51, 1, s25
    ds_read_u16 v55, v55
    s_add_u32 s36, s26, 3145728
    s_lshl1_add_u32 s25, s14, s25
    s_lshl_b32 s14, s14, 10
    s_add_u32 s26, s26, s14
    s_cmp_le_u32 s28, 256
    s_cbranch_scc1 L_p2_kernel_noopt3_4
    v_readlane_b32 s38, v7, 8
    v_readlane_b32 s39, v7, 9
    s_nop 1
    v_mbcnt_lo_u32_b32 v62, s38, 0
    v_mbcnt_hi_u32_b32 v62, s39, v62
    s_bcnt1_i32_b64 s14, s[38:39]
    v_lshl_add_u32 v63, v62, 1, s25
    ds_read_u16 v63, v63
    s_add_u32 s38, s26, 4194304
    s_lshl1_add_u32 s25, s14, s25
    s_lshl_b32 s14, s14, 10
    s_add_u32 s26, s26, s14
L_p2_kernel_noopt3_4:
    v_bfe_i32 v108, v23, 2, 10
    v_bfe_i32 v109, v23, 12, 10
    v_ashrrev_i32 v110, 22, v23
    v_cvt_f32_i32 v108, v108
    v_cvt_f32_i32 v109, v109
    v_cvt_f32_i32 v110, v110
    v_mfma_f32_4x4x4_16b_bf16 v[112:115], v[58:59], v[82:83], 0
    v_mfma_f32_4x4x4_16b_bf16 v[116:119], v[58:59], v[84:85], 0
    v_mfma_f32_4x4x4_16b_bf16 v[120:123], v[58:59], v[86:87], 0
    v_mad_u32_u16 v20, v20, 8, s50 op_sel:[1,0,0,0]
    v_mad_u32_u16 v21, v21, 8, s50 op_sel:[1,0,0,0]
    v_mad_u32_u16 v22, v22, 8, s50 op_sel:[1,0,0,0]
    v_pk_fma_f32 v[114:115], v[114:115], v[108:109], s[20:21] op_sel:[0,0,0] op_sel_hi:[1,0,1]
    v_pk_fma_f32 v[112:113], v[112:113], v[108:109], s[16:17] op_sel:[0,0,0] op_sel_hi:[1,0,1]
    v_pk_fma_f32 v[118:119], v[118:119], v[108:109], s[20:21] op_sel:[0,1,0] op_sel_hi:[1,1,1]
    v_pk_fma_f32 v[116:117], v[116:117], v[108:109], s[16:17] op_sel:[0,1,0] op_sel_hi:[1,1,1]
    v_pk_fma_f32 v[122:123], v[122:123], v[110:111], s[20:21] op_sel:[0,0,0] op_sel_hi:[1,0,1]
    v_pk_fma_f32 v[120:121], v[120:121], v[110:111], s[16:17] op_sel:[0,0,0] op_sel_hi:[1,0,1]
    v_lshlrev_b64 v[114:115], 16, v[114:115]
    v_lshlrev_b64 v[118:119], 16, v[118:119]
    v_lshlrev_b64 v[122:123], 16, v[122:123]
    v_lshl_add_u64 v[82:83], v[112:113], 0, v[114:115]
    v_lshl_add_u64 v[84:85], v[116:117], 0, v[118:119]
    v_lshl_add_u64 v[86:87], v[120:121], 0, v[122:123]
    s_waitcnt lgkmcnt(1)
    v_or3_b32 v4, v44, v45, v4
    v_or3_b32 v4, v46, v47, v4
    v_or3_b32 v4, v48, v49, v4
    ds_add_rtn_u64 v[44:45], v20, v[82:83]
    ds_add_rtn_u64 v[46:47], v21, v[84:85]
    ds_add_rtn_u64 v[48:49], v22, v[86:87]
    s_waitcnt lgkmcnt(3)
    v_mad_u32_u16 v55, v55, s23, v2
    v_pk_lshrrev_b16 v55, 10, v55 op_sel_hi:[1,1]
    v_lshl_add_u32 v51, v51, 6, v55
    buffer_load_dwordx4 v[20:23], v51, s[44:47], s36 idxen
    s_cmp_le_u32 s28, 256
    s_cbranch_scc1 L_p2_kernel_noopt3_5
    v_mad_u32_u16 v63, v63, s23, v2
    v_pk_lshrrev_b16 v63, 10, v63 op_sel_hi:[1,1]
    v_lshl_add_u32 v62, v62, 6, v63
    buffer_load_dwordx4 v[24:27], v62, s[44:47], s38 idxen
L_p2_kernel_noopt3_5:
    s_add_u32 s14, s22, 80000
    buffer_load_dwordx4 v[88:91], v1, s[8:11], s14 offen
    v_pk_mov_b32 v[28:29], v[28:29], v[30:31] op_sel:[1,0]
    v_pk_mov_b32 v[30:31], v[30:31], v[32:33] op_sel:[1,0]
    v_pk_mov_b32 v[32:33], v[32:33], v[34:35] op_sel:[1,0]
    v_pk_mov_b32 v[34:35], v[34:35], v[4:5] op_sel:[1,1]
    v_pk_mov_b32 v[36:37], v[36:37], v[38:39] op_sel:[1,0]
    v_pk_mov_b32 v[38:39], v[38:39], v[40:41] op_sel:[1,0]
    v_pk_mov_b32 v[40:41], v[40:41], v[42:43] op_sel:[1,0]
    v_pk_mov_b32 v[42:43], v[42:43], v[4:5] op_sel:[1,1]
    v_mad_u32_u16 v108, v28, v50, s40 op_sel:[0,0,0,0]
    v_mad_u32_u16 v109, v36, v50, s41 op_sel:[0,0,0,0]
    v_sub_u32_sdwa v110, v109, v108 dst_sel:DWORD dst_unused:UNUSED_PAD src0_sel:WORD_1 src1_sel:WORD_1
    s_nop 1
    v_add_u32_dpp v110, v110, v110 row_shr:1 row_mask:0xf bank_mask:0xf bound_ctrl:0
    s_nop 1
    v_add_u32_dpp v110, v110, v110 row_shr:2 row_mask:0xf bank_mask:0xf bound_ctrl:0
    s_nop 1
    v_add_u32_dpp v110, v110, v110 row_shr:4 row_mask:0xf bank_mask:0xf bound_ctrl:0
    s_nop 1
    v_add_u32_dpp v110, v110, v110 row_shr:8 row_mask:0xf bank_mask:0xf bound_ctrl:0
    s_nop 1
    v_add_u32_dpp v110, v110, v110 row_bcast:15 row_mask:0xa bank_mask:0xf
    s_nop 1
    v_add_u32_dpp v110, v110, v110 row_bcast:31 row_mask:0xc bank_mask:0xf
    v_sub_u32_sdwa v109, v109, v110 dst_sel:DWORD dst_unused:UNUSED_PAD src0_sel:WORD_1 src1_sel:DWORD
    v_readlane_b32 s29, v110, 63
    v_add_u32 v110, -1, v110
    ds_write_b16 v126, v109
    v_lshlrev_b32_e64 v111, v110, 1
    v_lshrrev_b32 v110, 5, v110
    s_cmp_gt_u32 s29, 320
    s_cselect_b32 s2, 1, s2
    v_lshl_add_u32 v110, v110, 2, v127
    s_cselect_b64 exec, 0, -1
    ds_or_b32 v110, v111 offset:136
    s_mov_b64 exec, -1
    ds_wrxchg2_rtn_b32 v[108:109], v6, v5, v5 offset0:34 offset1:44
    s_add_u32 s14, s22, 96384
    buffer_load_dwordx4 v[92:95], v1, s[8:11], s14 offen
    s_barrier
    s_add_u32 s22, s22, 80000
    s_cmp_lg_u32 s24, 7
    s_cbranch_scc1 L_p2_nodist
    s_mov_b32 s46, 0
    s_lshl2_add_u32 s14, s3, s12
    s_mul_i32 s14, s14, 5000
    s_add_u32 s15, s14, 4096
    v_min_u32 v61, 225, v0
    v_lshl_add_u32 v60, v0, 2, s14
    v_lshl_add_u32 v61, v61, 2, s15
    global_load_dword v60, v60, s[100:101] nt
    global_load_dword v61, v61, s[100:101] nt
L_p2_nodist:
    v_mad_u32_u16 v64, v8, 8, s18
    v_mad_u32_u16 v66, v9, 8, s18
    v_mad_u32_u16 v68, v10, 8, s18
    ds_read_b64 v[64:65], v64
    ds_read_b64 v[66:67], v66
    ds_read_b64 v[68:69], v68
    s_add_u32 s14, s22, 32768
    buffer_load_dwordx4 v[96:99], v1, s[8:11], s14 offen
    s_waitcnt vmcnt(5)
    v_mad_u32_u16 v70, v12, 8, s18
    v_mad_u32_u16 v72, v13, 8, s18
    v_mad_u32_u16 v74, v14, 8, s18
    ds_read_b64 v[70:71], v70
    ds_read_b64 v[72:73], v72
    ds_read_b64 v[74:75], v74
    s_add_u32 s14, s22, 49152
    buffer_load_dwordx4 v[100:103], v1, s[8:11], s14 offen
    s_waitcnt lgkmcnt(6)
    v_or_b32 v7, v108, v109
    s_nop 0
    v_readlane_b32 s30, v7, 0
    v_readlane_b32 s31, v7, 1
    v_readlane_b32 s32, v7, 2
    v_readlane_b32 s33, v7, 3
    v_readlane_b32 s34, v7, 4
    v_readlane_b32 s35, v7, 5
    v_readlane_b32 s36, v7, 6
    v_readlane_b32 s37, v7, 7
    s_mov_b32 s25, s19
    s_mov_b32 s26, s27
    s_mov_b32 s51, s28
    s_mov_b32 s28, s29
    v_mbcnt_lo_u32_b32 v51, s30, 0
    v_mbcnt_hi_u32_b32 v51, s31, v51
    s_bcnt1_i32_b64 s14, s[30:31]
    v_lshl_add_u32 v55, v51, 1, s25
    ds_read_u16 v55, v55
    s_add_u32 s30, s26, 0
    s_lshl1_add_u32 s25, s14, s25
    s_lshl_b32 s14, s14, 10
    s_add_u32 s26, s26, s14
    v_bfe_i32 v108, v11, 2, 10
    v_bfe_i32 v109, v11, 12, 10
    v_ashrrev_i32 v110, 22, v11
    v_cvt_f32_i32 v108, v108
    v_cvt_f32_i32 v109, v109
    v_cvt_f32_i32 v110, v110
    s_waitcnt lgkmcnt(4)
    v_mfma_f32_4x4x4_16b_bf16 v[112:115], v[58:59], v[64:65], 0
    v_mfma_f32_4x4x4_16b_bf16 v[116:119], v[58:59], v[66:67], 0
    v_mfma_f32_4x4x4_16b_bf16 v[120:123], v[58:59], v[68:69], 0
    v_mad_u32_u16 v8, v8, 8, s50 op_sel:[1,0,0,0]
    v_mad_u32_u16 v9, v9, 8, s50 op_sel:[1,0,0,0]
    v_mad_u32_u16 v10, v10, 8, s50 op_sel:[1,0,0,0]
    v_pk_fma_f32 v[114:115], v[114:115], v[108:109], s[20:21] op_sel:[0,0,0] op_sel_hi:[1,0,1]
    v_pk_fma_f32 v[112:113], v[112:113], v[108:109], s[16:17] op_sel:[0,0,0] op_sel_hi:[1,0,1]
    v_pk_fma_f32 v[118:119], v[118:119], v[108:109], s[20:21] op_sel:[0,1,0] op_sel_hi:[1,1,1]
    v_pk_fma_f32 v[116:117], v[116:117], v[108:109], s[16:17] op_sel:[0,1,0] op_sel_hi:[1,1,1]
    v_pk_fma_f32 v[122:123], v[122:123], v[110:111], s[20:21] op_sel:[0,0,0] op_sel_hi:[1,0,1]
    v_pk_fma_f32 v[120:121], v[120:121], v[110:111], s[16:17] op_sel:[0,0,0] op_sel_hi:[1,0,1]
    v_lshlrev_b64 v[114:115], 16, v[114:115]
    v_lshlrev_b64 v[118:119], 16, v[118:119]
    v_lshlrev_b64 v[122:123], 16, v[122:123]
    v_lshl_add_u64 v[64:65], v[112:113], 0, v[114:115]
    v_lshl_add_u64 v[66:67], v[116:117], 0, v[118:119]
    v_lshl_add_u64 v[68:69], v[120:121], 0, v[122:123]
    v_or3_b32 v4, v44, v45, v4
    v_or3_b32 v4, v46, v47, v4
    v_or3_b32 v4, v48, v49, v4
    ds_add_rtn_u64 v[44:45], v8, v[64:65]
    ds_add_rtn_u64 v[46:47], v9, v[66:67]
    ds_add_rtn_u64 v[48:49], v10, v[68:69]
    s_waitcnt lgkmcnt(3)
    v_mad_u32_u16 v55, v55, s23, v2
    v_pk_lshrrev_b16 v55, 10, v55 op_sel_hi:[1,1]
    v_lshl_add_u32 v51, v51, 6, v55
    buffer_load_dwordx4 v[8:11], v51, s[44:47], s30 idxen
    s_add_u32 s14, s22, 65536
    buffer_load_dwordx4 v[104:107], v1, s[8:11], s14 offen
    s_waitcnt vmcnt(7)
    v_mad_u32_u16 v76, v16, 8, s18
    v_mad_u32_u16 v78, v17, 8, s18
    v_mad_u32_u16 v80, v18, 8, s18
    ds_read_b64 v[76:77], v76
    ds_read_b64 v[78:79], v78
    ds_read_b64 v[80:81], v80
    s_waitcnt vmcnt(6)
    v_mad_u32_u16 v82, v20, 8, s18
    v_mad_u32_u16 v84, v21, 8, s18
    v_mad_u32_u16 v86, v22, 8, s18
    ds_read_b64 v[82:83], v82
    ds_read_b64 v[84:85], v84
    ds_read_b64 v[86:87], v86
    s_cmp_le_u32 s51, 256
    s_cbranch_scc1 L_p2_kernel_noopt3_6
    v_mad_u32_u16 v64, v24, 8, s18
    v_mad_u32_u16 v66, v25, 8, s18
    v_mad_u32_u16 v68, v26, 8, s18
    ds_read_b64 v[64:65], v64
    ds_read_b64 v[66:67], v66
    ds_read_b64 v[68:69], v68
L_p2_kernel_noopt3_6:
    v_mbcnt_lo_u32_b32 v51, s32, 0
    v_mbcnt_hi_u32_b32 v51, s33, v51
    s_bcnt1_i32_b64 s14, s[32:33]
    v_lshl_add_u32 v55, v51, 1, s25
    ds_read_u16 v55, v55
    s_add_u32 s32, s26, 1048576
    s_lshl1_add_u32 s25, s14, s25
    s_lshl_b32 s14, s14, 10
    s_add_u32 s26, s26, s14
    v_bfe_i32 v108, v15, 2, 10
    v_bfe_i32 v109, v15, 12, 10
    v_ashrrev_i32 v110, 22, v15
    v_cvt_f32_i32 v108, v108
    v_cvt_f32_i32 v109, v109
    v_cvt_f32_i32 v110, v110
    v_mfma_f32_4x4x4_16b_bf16 v[112:115], v[58:59], v[70:71], 0
    v_mfma_f32_4x4x4_16b_bf16 v[116:119], v[58:59], v[72:73], 0
    v_mfma_f32_4x4x4_16b_bf16 v[120:123], v[58:59], v[74:75], 0
    v_mad_u32_u16 v12, v12, 8, s50 op_sel:[1,0,0,0]
    v_mad_u32_u16 v13, v13, 8, s50 op_sel:[1,0,0,0]
    v_mad_u32_u16 v14, v14, 8, s50 op_sel:[1,0,0,0]
    v_pk_fma_f32 v[114:115], v[114:115], v[108:109], s[20:21] op_sel:[0,0,0] op_sel_hi:[1,0,1]
    v_pk_fma_f32 v[112:113], v[112:113], v[108:109], s[16:17] op_sel:[0,0,0] op_sel_hi:[1,0,1]
    v_pk_fma_f32 v[118:119], v[118:119], v[108:109], s[20:21] op_sel:[0,1,0] op_sel_hi:[1,1,1]
    v_pk_fma_f32 v[116:117], v[116:117], v[108:109], s[16:17] op_sel:[0,1,0] op_sel_hi:[1,1,1]
    v_pk_fma_f32 v[122:123], v[122:123], v[110:111], s[20:21] op_sel:[0,0,0] op_sel_hi:[1,0,1]
    v_pk_fma_f32 v[120:121], v[120:121], v[110:111], s[16:17] op_sel:[0,0,0] op_sel_hi:[1,0,1]
    v_lshlrev_b64 v[114:115], 16, v[114:115]
    v_lshlrev_b64 v[118:119], 16, v[118:119]
    v_lshlrev_b64 v[122:123], 16, v[122:123]
    v_lshl_add_u64 v[70:71], v[112:113], 0, v[114:115]
    v_lshl_add_u64 v[72:73], v[116:117], 0, v[118:119]
    v_lshl_add_u64 v[74:75], v[120:121], 0, v[122:123]
    s_waitcnt lgkmcnt(7)
    v_or3_b32 v4, v44, v45, v4
    v_or3_b32 v4, v46, v47, v4
    v_or3_b32 v4, v48, v49, v4
    ds_add_rtn_u64 v[44:45], v12, v[70:71]
    ds_add_rtn_u64 v[46:47], v13, v[72:73]
    ds_add_rtn_u64 v[48:49], v14, v[74:75]
    s_waitcnt lgkmcnt(3)
    v_mad_u32_u16 v55, v55, s23, v2
    v_pk_lshrrev_b16 v55, 10, v55 op_sel_hi:[1,1]
    v_lshl_add_u32 v51, v51, 6, v55
    buffer_load_dwordx4 v[12:15], v51, s[44:47], s32 idxen
    s_barrier
    s_waitcnt vmcnt(1)
    ds_write_b128 v3, v[88:91] offset:0
    ds_write_b128 v3, v[92:95] offset:16384
    ds_write_b128 v3, v[96:99] offset:32768
    ds_write_b128 v3, v[100:103] offset:49152
    ds_write_b128 v124, v[104:107] offset:0
    v_mbcnt_lo_u32_b32 v51, s34, 0
    v_mbcnt_hi_u32_b32 v51, s35, v51
    s_bcnt1_i32_b64 s14, s[34:35]
    v_lshl_add_u32 v55, v51, 1, s25
    ds_read_u16 v55, v55
    s_add_u32 s34, s26, 2097152
    s_lshl1_add_u32 s25, s14, s25
    s_lshl_b32 s14, s14, 10
    s_add_u32 s26, s26, s14
    v_bfe_i32 v108, v19, 2, 10
    v_bfe_i32 v109, v19, 12, 10
    v_ashrrev_i32 v110, 22, v19
    v_cvt_f32_i32 v108, v108
    v_cvt_f32_i32 v109, v109
    v_cvt_f32_i32 v110, v110
    v_mfma_f32_4x4x4_16b_bf16 v[112:115], v[58:59], v[76:77], 0
    v_mfma_f32_4x4x4_16b_bf16 v[116:119], v[58:59], v[78:79], 0
    v_mfma_f32_4x4x4_16b_bf16 v[120:123], v[58:59], v[80:81], 0
    v_mad_u32_u16 v16, v16, 8, s50 op_sel:[1,0,0,0]
    v_mad_u32_u16 v17, v17, 8, s50 op_sel:[1,0,0,0]
    v_mad_u32_u16 v18, v18, 8, s50 op_sel:[1,0,0,0]
    v_pk_fma_f32 v[114:115], v[114:115], v[108:109], s[20:21] op_sel:[0,0,0] op_sel_hi:[1,0,1]
    v_pk_fma_f32 v[112:113], v[112:113], v[108:109], s[16:17] op_sel:[0,0,0] op_sel_hi:[1,0,1]
    v_pk_fma_f32 v[118:119], v[118:119], v[108:109], s[20:21] op_sel:[0,1,0] op_sel_hi:[1,1,1]
    v_pk_fma_f32 v[116:117], v[116:117], v[108:109], s[16:17] op_sel:[0,1,0] op_sel_hi:[1,1,1]
    v_pk_fma_f32 v[122:123], v[122:123], v[110:111], s[20:21] op_sel:[0,0,0] op_sel_hi:[1,0,1]
    v_pk_fma_f32 v[120:121], v[120:121], v[110:111], s[16:17] op_sel:[0,0,0] op_sel_hi:[1,0,1]
    v_lshlrev_b64 v[114:115], 16, v[114:115]
    v_lshlrev_b64 v[118:119], 16, v[118:119]
    v_lshlrev_b64 v[122:123], 16, v[122:123]
    v_lshl_add_u64 v[76:77], v[112:113], 0, v[114:115]
    v_lshl_add_u64 v[78:79], v[116:117], 0, v[118:119]
    v_lshl_add_u64 v[80:81], v[120:121], 0, v[122:123]
    s_waitcnt lgkmcnt(6)
    v_or3_b32 v4, v44, v45, v4
    v_or3_b32 v4, v46, v47, v4
    v_or3_b32 v4, v48, v49, v4
    ds_add_rtn_u64 v[44:45], v16, v[76:77]
    ds_add_rtn_u64 v[46:47], v17, v[78:79]
    ds_add_rtn_u64 v[48:49], v18, v[80:81]
    s_waitcnt lgkmcnt(3)
    v_mad_u32_u16 v55, v55, s23, v2
    v_pk_lshrrev_b16 v55, 10, v55 op_sel_hi:[1,1]
    v_lshl_add_u32 v51, v51, 6, v55
    buffer_load_dwordx4 v[16:19], v51, s[44:47], s34 idxen
    s_cmp_le_u32 s51, 256
    s_cbranch_scc1 L_p2_kernel_noopt3_7
    v_bfe_i32 v108, v27, 2, 10
    v_bfe_i32 v109, v27, 12, 10
    v_ashrrev_i32 v110, 22, v27
    v_cvt_f32_i32 v108, v108
    v_cvt_f32_i32 v109, v109
    v_cvt_f32_i32 v110, v110
    v_mfma_f32_4x4x4_16b_bf16 v[112:115], v[58:59], v[64:65], 0
    v_mfma_f32_4x4x4_16b_bf16 v[116:119], v[58:59], v[66:67], 0
    v_mfma_f32_4x4x4_16b_bf16 v[120:123], v[58:59], v[68:69], 0
    v_mad_u32_u16 v24, v24, 8, s50 op_sel:[1,0,0,0]
    v_mad_u32_u16 v25, v25, 8, s50 op_sel:[1,0,0,0]
    v_mad_u32_u16 v26, v26, 8, s50 op_sel:[1,0,0,0]
    v_pk_fma_f32 v[114:115], v[114:115], v[108:109], s[20:21] op_sel:[0,0,0] op_sel_hi:[1,0,1]
    v_pk_fma_f32 v[112:113], v[112:113], v[108:109], s[16:17] op_sel:[0,0,0] op_sel_hi:[1,0,1]
    v_pk_fma_f32 v[118:119], v[118:119], v[108:109], s[20:21] op_sel:[0,1,0] op_sel_hi:[1,1,1]
    v_pk_fma_f32 v[116:117], v[116:117], v[108:109], s[16:17] op_sel:[0,1,0] op_sel_hi:[1,1,1]
    v_pk_fma_f32 v[122:123], v[122:123], v[110:111], s[20:21] op_sel:[0,0,0] op_sel_hi:[1,0,1]
    v_pk_fma_f32 v[120:121], v[120:121], v[110:111], s[16:17] op_sel:[0,0,0] op_sel_hi:[1,0,1]
    v_lshlrev_b64 v[114:115], 16, v[114:115]
    v_lshlrev_b64 v[118:119], 16, v[118:119]
    v_lshlrev_b64 v[122:123], 16, v[122:123]
    v_lshl_add_u64 v[64:65], v[112:113], 0, v[114:115]
    v_lshl_add_u64 v[66:67], v[116:117], 0, v[118:119]
    v_lshl_add_u64 v[68:69], v[120:121], 0, v[122:123]
    s_waitcnt lgkmcnt(0)
    v_or3_b32 v4, v44, v45, v4
    v_or3_b32 v4, v46, v47, v4
    v_or3_b32 v4, v48, v49, v4
    ds_add_rtn_u64 v[44:45], v24, v[64:65]
    ds_add_rtn_u64 v[46:47], v25, v[66:67]
    ds_add_rtn_u64 v[48:49], v26, v[68:69]
L_p2_kernel_noopt3_7:
    v_mbcnt_lo_u32_b32 v51, s36, 0
    v_mbcnt_hi_u32_b32 v51, s37, v51
    s_bcnt1_i32_b64 s14, s[36:37]
    v_lshl_add_u32 v55, v51, 1, s25
    ds_read_u16 v55, v55
    s_add_u32 s36, s26, 3145728
    s_lshl1_add_u32 s25, s14, s25
    s_lshl_b32 s14, s14, 10
    s_add_u32 s26, s26, s14
    s_cmp_le_u32 s28, 256
    s_cbranch_scc1 L_p2_kernel_noopt3_8
    v_readlane_b32 s38, v7, 8
    v_readlane_b32 s39, v7, 9
    s_nop 1
    v_mbcnt_lo_u32_b32 v62, s38, 0
    v_mbcnt_hi_u32_b32 v62, s39, v62
    s_bcnt1_i32_b64 s14, s[38:39]
    v_lshl_add_u32 v63, v62, 1, s25
    ds_read_u16 v63, v63
    s_add_u32 s38, s26, 4194304
    s_lshl1_add_u32 s25, s14, s25
    s_lshl_b32 s14, s14, 10
    s_add_u32 s26, s26, s14
L_p2_kernel_noopt3_8:
    v_bfe_i32 v108, v23, 2, 10
    v_bfe_i32 v109, v23, 12, 10
    v_ashrrev_i32 v110, 22, v23
    v_cvt_f32_i32 v108, v108
    v_cvt_f32_i32 v109, v109
    v_cvt_f32_i32 v110, v110
    v_mfma_f32_4x4x4_16b_bf16 v[112:115], v[58:59], v[82:83], 0
    v_mfma_f32_4x4x4_16b_bf16 v[116:119], v[58:59], v[84:85], 0
    v_mfma_f32_4x4x4_16b_bf16 v[120:123], v[58:59], v[86:87], 0
    v_mad_u32_u16 v20, v20, 8, s50 op_sel:[1,0,0,0]
    v_mad_u32_u16 v21, v21, 8, s50 op_sel:[1,0,0,0]
    v_mad_u32_u16 v22, v22, 8, s50 op_sel:[1,0,0,0]
    v_pk_fma_f32 v[114:115], v[114:115], v[108:109], s[20:21] op_sel:[0,0,0] op_sel_hi:[1,0,1]
    v_pk_fma_f32 v[112:113], v[112:113], v[108:109], s[16:17] op_sel:[0,0,0] op_sel_hi:[1,0,1]
    v_pk_fma_f32 v[118:119], v[118:119], v[108:109], s[20:21] op_sel:[0,1,0] op_sel_hi:[1,1,1]
    v_pk_fma_f32 v[116:117], v[116:117], v[108:109], s[16:17] op_sel:[0,1,0] op_sel_hi:[1,1,1]
    v_pk_fma_f32 v[122:123], v[122:123], v[110:111], s[20:21] op_sel:[0,0,0] op_sel_hi:[1,0,1]
    v_pk_fma_f32 v[120:121], v[120:121], v[110:111], s[16:17] op_sel:[0,0,0] op_sel_hi:[1,0,1]
    v_lshlrev_b64 v[114:115], 16, v[114:115]
    v_lshlrev_b64 v[118:119], 16, v[118:119]
    v_lshlrev_b64 v[122:123], 16, v[122:123]
    v_lshl_add_u64 v[82:83], v[112:113], 0, v[114:115]
    v_lshl_add_u64 v[84:85], v[116:117], 0, v[118:119]
    v_lshl_add_u64 v[86:87], v[120:121], 0, v[122:123]
    s_waitcnt lgkmcnt(1)
    v_or3_b32 v4, v44, v45, v4
    v_or3_b32 v4, v46, v47, v4
    v_or3_b32 v4, v48, v49, v4
    ds_add_rtn_u64 v[44:45], v20, v[82:83]
    ds_add_rtn_u64 v[46:47], v21, v[84:85]
    ds_add_rtn_u64 v[48:49], v22, v[86:87]
    s_waitcnt lgkmcnt(3)
    v_mad_u32_u16 v55, v55, s23, v2
    v_pk_lshrrev_b16 v55, 10, v55 op_sel_hi:[1,1]
    v_lshl_add_u32 v51, v51, 6, v55
    buffer_load_dwordx4 v[20:23], v51, s[44:47], s36 idxen
    s_cmp_le_u32 s28, 256
    s_cbranch_scc1 L_p2_kernel_noopt3_9
    v_mad_u32_u16 v63, v63, s23, v2
    v_pk_lshrrev_b16 v63, 10, v63 op_sel_hi:[1,1]
    v_lshl_add_u32 v62, v62, 6, v63
    buffer_load_dwordx4 v[24:27], v62, s[44:47], s38 idxen
L_p2_kernel_noopt3_9:
    s_add_u32 s14, s22, 80000
    buffer_load_dwordx4 v[88:91], v1, s[8:11], s14 offen
    v_mad_u32_u16 v108, v28, v50, s40 op_sel:[1,0,0,0]
    v_mad_u32_u16 v109, v36, v50, s41 op_sel:[1,0,0,0]
    v_sub_u32_sdwa v110, v109, v108 dst_sel:DWORD dst_unused:UNUSED_PAD src0_sel:WORD_1 src1_sel:WORD_1
    s_nop 1
    v_add_u32_dpp v110, v110, v110 row_shr:1 row_mask:0xf bank_mask:0xf bound_ctrl:0
    s_nop 1
    v_add_u32_dpp v110, v110, v110 row_shr:2 row_mask:0xf bank_mask:0xf bound_ctrl:0
    s_nop 1
    v_add_u32_dpp v110, v110, v110 row_shr:4 row_mask:0xf bank_mask:0xf bound_ctrl:0
    s_nop 1
    v_add_u32_dpp v110, v110, v110 row_shr:8 row_mask:0xf bank_mask:0xf bound_ctrl:0
    s_nop 1
    v_add_u32_dpp v110, v110, v110 row_bcast:15 row_mask:0xa bank_mask:0xf
    s_nop 1
    v_add_u32_dpp v110, v110, v110 row_bcast:31 row_mask:0xc bank_mask:0xf
    v_sub_u32_sdwa v109, v109, v110 dst_sel:DWORD dst_unused:UNUSED_PAD src0_sel:WORD_1 src1_sel:DWORD
    v_readlane_b32 s29, v110, 63
    v_add_u32 v110, -1, v110
    ds_write_b16 v126, v109
    v_lshlrev_b32_e64 v111, v110, 1
    v_lshrrev_b32 v110, 5, v110
    s_cmp_gt_u32 s29, 320
    s_cselect_b32 s2, 1, s2
    v_lshl_add_u32 v110, v110, 2, v127
    s_cselect_b64 exec, 0, -1
    ds_or_b32 v110, v111 offset:136
    s_mov_b64 exec, -1
    ds_wrxchg2_rtn_b32 v[108:109], v6, v5, v5 offset0:34 offset1:44
    s_add_u32 s14, s22, 96384
    buffer_load_dwordx4 v[92:95], v1, s[8:11], s14 offen
    s_add_u32 s24, s24, 1
    s_cmp_lt_u32 s24, 8
    s_barrier
    s_cbranch_scc1 L_p2_loop
    s_waitcnt lgkmcnt(3)
    v_or3_b32 v4, v44, v45, v4
    v_or3_b32 v4, v46, v47, v4
    v_or3_b32 v4, v48, v49, v4
    s_mov_b32 s27, s19
    s_waitcnt vmcnt(0)
    v_mov_b32 v8, 160232
    s_cmp_lg_u32 s13, 0
    s_cselect_b64 exec, 0, 1
    ds_write_b32 v8, v52
    s_mov_b64 exec, -1
    v_subrev_u32 v6, 80000, v124
    s_mul_i32 s24, s12, 20000
    v_subrev_u32 v10, s24, v1
    v_mov_b32 v11, 0x7f000000
    s_waitcnt vmcnt(0) lgkmcnt(0)
    s_barrier
    s_cmp_lt_u32 s13, 12
    s_cbranch_scc1 L_p2_ga
L_p2_ga:
    ds_read_b32 v9, v8
    ds_read_b128 v[88:91], v1 offset:0
    ds_read_b128 v[92:95], v1 offset:16384
    ds_read_b128 v[96:99], v1 offset:32768
    ds_read_b128 v[100:103], v1 offset:49152
    ds_read_b128 v[104:107], v6
    s_mul_i32 s14, s12, 5120000
    s_mul_i32 s15, s3, 80000
    s_add_u32 s25, s14, s15
    s_add_u32 s25, s25, 228589568
    s_waitcnt lgkmcnt(5)
    v_readfirstlane_b32 s21, v9
    s_nop 0
    s_bfe_u32 s21, s21, 524296
    s_cmp_lg_u32 s21, 4
    s_cselect_b32 s21, 1, 0
    s_cselect_b32 s24, 0, 20000
    v_cmp_le_u32 vcc, s24, v10
    v_add_u32 v10, 16384, v10
    s_add_u32 s14, s25, 0
    v_cndmask_b32 v12, v11, v1, vcc
    s_waitcnt lgkmcnt(4)
    buffer_store_dwordx4 v[88:91], v12, s[4:7], s14 offen sc1
    v_or3_b32 v4, v88, v89, v4
    v_or3_b32 v4, v90, v91, v4
    v_cmp_le_u32 vcc, s24, v10
    v_add_u32 v10, 16384, v10
    s_add_u32 s14, s25, 16384
    v_cndmask_b32 v12, v11, v1, vcc
    s_waitcnt lgkmcnt(3)
    buffer_store_dwordx4 v[92:95], v12, s[4:7], s14 offen sc1
    v_or3_b32 v4, v92, v93, v4
    v_or3_b32 v4, v94, v95, v4
    v_cmp_le_u32 vcc, s24, v10
    v_add_u32 v10, 16384, v10
    s_add_u32 s14, s25, 32768
    v_cndmask_b32 v12, v11, v1, vcc
    s_waitcnt lgkmcnt(2)
    buffer_store_dwordx4 v[96:99], v12, s[4:7], s14 offen sc1
    v_or3_b32 v4, v96, v97, v4
    v_or3_b32 v4, v98, v99, v4
    v_cmp_le_u32 vcc, s24, v10
    v_add_u32 v10, 16384, v10
    s_add_u32 s14, s25, 49152
    v_cndmask_b32 v12, v11, v1, vcc
    s_waitcnt lgkmcnt(1)
    buffer_store_dwordx4 v[100:103], v12, s[4:7], s14 offen sc1
    v_or3_b32 v4, v100, v101, v4
    v_or3_b32 v4, v102, v103, v4
    v_cmp_le_u32 vcc, s24, v10
    v_add_u32 v10, 16384, v10
    s_add_u32 s14, s25, 0
    v_cndmask_b32 v12, v11, v6, vcc
    s_waitcnt lgkmcnt(0)
    buffer_store_dwordx4 v[104:107], v12, s[4:7], s14 offen sc1
    v_or3_b32 v4, v104, v105, v4
    v_or3_b32 v4, v106, v107, v4
    s_load_dwordx2 s[16:17], s[0:1], 88
    s_cmp_ge_u32 s13, 12
    s_cbranch_scc1 L_p2_gb
    v_lshlrev_b32 v30, 16, v60
    v_and_b32 v31, 0xffff0000, v60
    v_lshlrev_b32 v36, 16, v53
    v_and_b32 v37, 0xffff0000, v53
    v_lshlrev_b32 v38, 16, v54
    v_and_b32 v39, 0xffff0000, v54
    v_lshlrev_b32 v40, 16, v56
    v_and_b32 v41, 0xffff0000, v56
    v_lshlrev_b32 v42, 16, v57
    v_and_b32 v43, 0xffff0000, v57
    v_pk_add_f32 v[14:15], v[30:31], v[36:37] op_sel:[0,0] op_sel_hi:[1,0] neg_lo:[0,1] neg_hi:[0,1]
    v_pk_add_f32 v[16:17], v[30:31], v[36:37] op_sel:[0,1] op_sel_hi:[1,1] neg_lo:[0,1] neg_hi:[0,1]
    v_pk_add_f32 v[18:19], v[30:31], v[38:39] op_sel:[0,0] op_sel_hi:[1,0] neg_lo:[0,1] neg_hi:[0,1]
    v_pk_add_f32 v[20:21], v[30:31], v[38:39] op_sel:[0,1] op_sel_hi:[1,1] neg_lo:[0,1] neg_hi:[0,1]
    v_pk_add_f32 v[22:23], v[30:31], v[40:41] op_sel:[0,0] op_sel_hi:[1,0] neg_lo:[0,1] neg_hi:[0,1]
    v_pk_add_f32 v[24:25], v[30:31], v[40:41] op_sel:[0,1] op_sel_hi:[1,1] neg_lo:[0,1] neg_hi:[0,1]
    v_pk_add_f32 v[26:27], v[30:31], v[42:43] op_sel:[0,0] op_sel_hi:[1,0] neg_lo:[0,1] neg_hi:[0,1]
    v_pk_add_f32 v[28:29], v[30:31], v[42:43] op_sel:[0,1] op_sel_hi:[1,1] neg_lo:[0,1] neg_hi:[0,1]
    v_cvt_pk_bf16_f32 v32, v14, v15
    v_lshlrev_b32 v14, 16, v32
    v_and_b32 v15, 0xffff0000, v32
    v_cvt_pk_bf16_f32 v32, v16, v17
    v_lshlrev_b32 v16, 16, v32
    v_and_b32 v17, 0xffff0000, v32
    v_cvt_pk_bf16_f32 v32, v18, v19
    v_lshlrev_b32 v18, 16, v32
    v_and_b32 v19, 0xffff0000, v32
    v_cvt_pk_bf16_f32 v32, v20, v21
    v_lshlrev_b32 v20, 16, v32
    v_and_b32 v21, 0xffff0000, v32
    v_cvt_pk_bf16_f32 v32, v22, v23
    v_lshlrev_b32 v22, 16, v32
    v_and_b32 v23, 0xffff0000, v32
    v_cvt_pk_bf16_f32 v32, v24, v25
    v_lshlrev_b32 v24, 16, v32
    v_and_b32 v25, 0xffff0000, v32
    v_cvt_pk_bf16_f32 v32, v26, v27
    v_lshlrev_b32 v26, 16, v32
    v_and_b32 v27, 0xffff0000, v32
    v_cvt_pk_bf16_f32 v32, v28, v29
    v_lshlrev_b32 v28, 16, v32
    v_and_b32 v29, 0xffff0000, v32
    v_pk_mul_f32 v[14:15], v[14:15], v[14:15]
    v_pk_mul_f32 v[16:17], v[16:17], v[16:17]
    v_pk_mul_f32 v[18:19], v[18:19], v[18:19]
    v_pk_mul_f32 v[20:21], v[20:21], v[20:21]
    v_pk_mul_f32 v[22:23], v[22:23], v[22:23]
    v_pk_mul_f32 v[24:25], v[24:25], v[24:25]
    v_pk_mul_f32 v[26:27], v[26:27], v[26:27]
    v_pk_mul_f32 v[28:29], v[28:29], v[28:29]
    v_cvt_pk_bf16_f32 v32, v14, v15
    v_lshlrev_b32 v14, 16, v32
    v_and_b32 v15, 0xffff0000, v32
    v_cvt_pk_bf16_f32 v32, v16, v17
    v_lshlrev_b32 v16, 16, v32
    v_and_b32 v17, 0xffff0000, v32
    v_cvt_pk_bf16_f32 v32, v18, v19
    v_lshlrev_b32 v18, 16, v32
    v_and_b32 v19, 0xffff0000, v32
    v_cvt_pk_bf16_f32 v32, v20, v21
    v_lshlrev_b32 v20, 16, v32
    v_and_b32 v21, 0xffff0000, v32
    v_cvt_pk_bf16_f32 v32, v22, v23
    v_lshlrev_b32 v22, 16, v32
    v_and_b32 v23, 0xffff0000, v32
    v_cvt_pk_bf16_f32 v32, v24, v25
    v_lshlrev_b32 v24, 16, v32
    v_and_b32 v25, 0xffff0000, v32
    v_cvt_pk_bf16_f32 v32, v26, v27
    v_lshlrev_b32 v26, 16, v32
    v_and_b32 v27, 0xffff0000, v32
    v_cvt_pk_bf16_f32 v32, v28, v29
    v_lshlrev_b32 v28, 16, v32
    v_and_b32 v29, 0xffff0000, v32
    v_mov_b32 v30, 1092616192
    v_mov_b32 v31, 0x3fb8aa3b
    v_pk_mul_f32 v[14:15], v[14:15], v[30:31] op_sel:[0,0] op_sel_hi:[1,0]
    v_pk_mul_f32 v[16:17], v[16:17], v[30:31] op_sel:[0,0] op_sel_hi:[1,0]
    v_pk_mul_f32 v[18:19], v[18:19], v[30:31] op_sel:[0,0] op_sel_hi:[1,0]
    v_pk_mul_f32 v[20:21], v[20:21], v[30:31] op_sel:[0,0] op_sel_hi:[1,0]
    v_pk_mul_f32 v[22:23], v[22:23], v[30:31] op_sel:[0,0] op_sel_hi:[1,0]
    v_pk_mul_f32 v[24:25], v[24:25], v[30:31] op_sel:[0,0] op_sel_hi:[1,0]
    v_pk_mul_f32 v[26:27], v[26:27], v[30:31] op_sel:[0,0] op_sel_hi:[1,0]
    v_pk_mul_f32 v[28:29], v[28:29], v[30:31] op_sel:[0,0] op_sel_hi:[1,0]
    v_cvt_pk_bf16_f32 v32, v14, v15
    v_lshlrev_b32 v14, 16, v32
    v_and_b32 v15, 0xffff0000, v32
    v_cvt_pk_bf16_f32 v32, v16, v17
    v_lshlrev_b32 v16, 16, v32
    v_and_b32 v17, 0xffff0000, v32
    v_cvt_pk_bf16_f32 v32, v18, v19
    v_lshlrev_b32 v18, 16, v32
    v_and_b32 v19, 0xffff0000, v32
    v_cvt_pk_bf16_f32 v32, v20, v21
    v_lshlrev_b32 v20, 16, v32
    v_and_b32 v21, 0xffff0000, v32
    v_cvt_pk_bf16_f32 v32, v22, v23
    v_lshlrev_b32 v22, 16, v32
    v_and_b32 v23, 0xffff0000, v32
    v_cvt_pk_bf16_f32 v32, v24, v25
    v_lshlrev_b32 v24, 16, v32
    v_and_b32 v25, 0xffff0000, v32
    v_cvt_pk_bf16_f32 v32, v26, v27
    v_lshlrev_b32 v26, 16, v32
    v_and_b32 v27, 0xffff0000, v32
    v_cvt_pk_bf16_f32 v32, v28, v29
    v_lshlrev_b32 v28, 16, v32
    v_and_b32 v29, 0xffff0000, v32
    v_pk_mul_f32 v[14:15], v[14:15], v[30:31] op_sel:[0,1] op_sel_hi:[1,1]
    v_pk_mul_f32 v[16:17], v[16:17], v[30:31] op_sel:[0,1] op_sel_hi:[1,1]
    v_pk_mul_f32 v[18:19], v[18:19], v[30:31] op_sel:[0,1] op_sel_hi:[1,1]
    v_pk_mul_f32 v[20:21], v[20:21], v[30:31] op_sel:[0,1] op_sel_hi:[1,1]
    v_pk_mul_f32 v[22:23], v[22:23], v[30:31] op_sel:[0,1] op_sel_hi:[1,1]
    v_pk_mul_f32 v[24:25], v[24:25], v[30:31] op_sel:[0,1] op_sel_hi:[1,1]
    v_pk_mul_f32 v[26:27], v[26:27], v[30:31] op_sel:[0,1] op_sel_hi:[1,1]
    v_pk_mul_f32 v[28:29], v[28:29], v[30:31] op_sel:[0,1] op_sel_hi:[1,1]
    v_exp_f32 v14, -v14
    v_exp_f32 v15, -v15
    v_exp_f32 v16, -v16
    v_exp_f32 v17, -v17
    v_exp_f32 v18, -v18
    v_exp_f32 v19, -v19
    v_exp_f32 v20, -v20
    v_exp_f32 v21, -v21
    v_exp_f32 v22, -v22
    v_exp_f32 v23, -v23
    v_exp_f32 v24, -v24
    v_exp_f32 v25, -v25
    v_exp_f32 v26, -v26
    v_exp_f32 v27, -v27
    v_exp_f32 v28, -v28
    v_exp_f32 v29, -v29
    v_cvt_pk_bf16_f32 v14, v14, v16
    v_cvt_pk_bf16_f32 v15, v15, v17
    v_cvt_pk_bf16_f32 v18, v18, v20
    v_cvt_pk_bf16_f32 v19, v19, v21
    v_cvt_pk_bf16_f32 v22, v22, v24
    v_cvt_pk_bf16_f32 v23, v23, v25
    v_cvt_pk_bf16_f32 v26, v26, v28
    v_cvt_pk_bf16_f32 v27, v27, v29
    v_dot2_f32_bf16 v72, v14, s68, 0
    v_dot2_f32_bf16 v73, v15, s68, 0
    v_dot2_f32_bf16 v74, v14, s69, 0
    v_dot2_f32_bf16 v75, v15, s69, 0
    v_dot2_f32_bf16 v76, v14, s70, 0
    v_dot2_f32_bf16 v77, v15, s70, 0
    v_dot2_f32_bf16 v78, v14, s71, 0
    v_dot2_f32_bf16 v79, v15, s71, 0
    v_dot2_f32_bf16 v80, v14, s52, 0
    v_dot2_f32_bf16 v81, v15, s52, 0
    v_dot2_f32_bf16 v82, v14, s53, 0
    v_dot2_f32_bf16 v83, v15, s53, 0
    v_dot2_f32_bf16 v84, v14, s54, 0
    v_dot2_f32_bf16 v85, v15, s54, 0
    v_dot2_f32_bf16 v86, v14, s55, 0
    v_dot2_f32_bf16 v87, v15, s55, 0
    v_dot2_f32_bf16 v72, v18, s72, v72
    v_dot2_f32_bf16 v73, v19, s72, v73
    v_dot2_f32_bf16 v74, v18, s73, v74
    v_dot2_f32_bf16 v75, v19, s73, v75
    v_dot2_f32_bf16 v76, v18, s74, v76
    v_dot2_f32_bf16 v77, v19, s74, v77
    v_dot2_f32_bf16 v78, v18, s75, v78
    v_dot2_f32_bf16 v79, v19, s75, v79
    v_dot2_f32_bf16 v80, v18, s56, v80
    v_dot2_f32_bf16 v81, v19, s56, v81
    v_dot2_f32_bf16 v82, v18, s57, v82
    v_dot2_f32_bf16 v83, v19, s57, v83
    v_dot2_f32_bf16 v84, v18, s58, v84
    v_dot2_f32_bf16 v85, v19, s58, v85
    v_dot2_f32_bf16 v86, v18, s59, v86
    v_dot2_f32_bf16 v87, v19, s59, v87
    v_dot2_f32_bf16 v72, v22, s76, v72
    v_dot2_f32_bf16 v73, v23, s76, v73
    v_dot2_f32_bf16 v74, v22, s77, v74
    v_dot2_f32_bf16 v75, v23, s77, v75
    v_dot2_f32_bf16 v76, v22, s78, v76
    v_dot2_f32_bf16 v77, v23, s78, v77
    v_dot2_f32_bf16 v78, v22, s79, v78
    v_dot2_f32_bf16 v79, v23, s79, v79
    v_dot2_f32_bf16 v80, v22, s60, v80
    v_dot2_f32_bf16 v81, v23, s60, v81
    v_dot2_f32_bf16 v82, v22, s61, v82
    v_dot2_f32_bf16 v83, v23, s61, v83
    v_dot2_f32_bf16 v84, v22, s62, v84
    v_dot2_f32_bf16 v85, v23, s62, v85
    v_dot2_f32_bf16 v86, v22, s63, v86
    v_dot2_f32_bf16 v87, v23, s63, v87
    v_dot2_f32_bf16 v72, v26, s80, v72
    v_dot2_f32_bf16 v73, v27, s80, v73
    v_dot2_f32_bf16 v74, v26, s81, v74
    v_dot2_f32_bf16 v75, v27, s81, v75
    v_dot2_f32_bf16 v76, v26, s82, v76
    v_dot2_f32_bf16 v77, v27, s82, v77
    v_dot2_f32_bf16 v78, v26, s83, v78
    v_dot2_f32_bf16 v79, v27, s83, v79
    v_dot2_f32_bf16 v80, v26, s64, v80
    v_dot2_f32_bf16 v81, v27, s64, v81
    v_dot2_f32_bf16 v82, v26, s65, v82
    v_dot2_f32_bf16 v83, v27, s65, v83
    v_dot2_f32_bf16 v84, v26, s66, v84
    v_dot2_f32_bf16 v85, v27, s66, v85
    v_dot2_f32_bf16 v86, v26, s67, v86
    v_dot2_f32_bf16 v87, v27, s67, v87
L_p2_gb:
    v_and_b32 v4, 0x80008000, v4
    v_cmp_ne_u32 vcc, 0, v4
    v_mov_b32 v8, s27
    v_and_b32 v10, 15, v0
    v_mul_u32_u24 v10, 240, v10
    v_add_u32 v10, 160000, v10
    s_cmp_lg_u64 vcc, 0
    s_cselect_b32 s2, 1, s2
    v_mov_b32 v9, s2
    s_mov_b64 exec, 1
    ds_write_b32 v8, v9
    s_mov_b64 exec, -1
    v_add_u32 v2, 16384, v1
    v_mov_b32 v9, 0x3f000000
    v_cmp_gt_u32 vcc, 226, v0
    s_mov_b32 s49, s12
    s_mov_b32 s51, 0
    v_cndmask_b32 v2, v9, v2, vcc
    s_waitcnt vmcnt(0) lgkmcnt(0)
    s_barrier
    ds_read_b32 v9, v10
    s_mov_b32 s18, 5120000
    s_mov_b32 s19, 0x00020000
    s_waitcnt lgkmcnt(0)
    v_cmp_ne_u32 vcc, 0, v9
    s_nop 1
    s_cmp_lg_u64 vcc, 0
    s_cselect_b32 s2, 1, 0
    s_cbranch_scc1 L_p2_slow
L_p2_signal:
    v_mov_b32 v8, 160228
    s_lshl_b32 s15, s2, 4
    s_or_b32 s15, s15, s21
    s_add_u32 s14, s12, 16
    s_lshl_b32 s20, s15, s14
    s_add_u32 s20, s20, 1
    v_mov_b32 v9, s20
    s_cmp_lg_u32 s13, 15
    s_cbranch_scc1 L_p2_nosig0
    s_lshl_b32 s14, s3, 8
    s_add_u32 s14, s14, 8523776
    s_mov_b64 exec, 1
    buffer_atomic_add v9, off, s[4:7], s14 sc0
    s_mov_b64 exec, -1
L_p2_nosig0:
    s_lshl2_add_u32 s14, s3, s49
    s_mul_i32 s26, s14, 20000
    s_mov_b32 s10, 5120000
    buffer_load_dwordx4 v[64:67], v1, s[8:11], s26 offen
    buffer_load_dwordx4 v[68:71], v2, s[8:11], s26 offen
    s_lshl_b32 s28, s92, 16
    s_and_b32 s29, s92, 0xffff0000
    s_lshl_b32 s30, s93, 16
    s_and_b32 s31, s93, 0xffff0000
    s_lshl_b32 s32, s94, 16
    s_and_b32 s33, s94, 0xffff0000
    s_lshl_b32 s34, s95, 16
    s_and_b32 s35, s95, 0xffff0000
    s_lshl_b32 s36, s96, 16
    s_and_b32 s37, s96, 0xffff0000
    s_lshl_b32 s38, s97, 16
    s_and_b32 s39, s97, 0xffff0000
    s_lshl_b32 s40, s98, 16
    s_and_b32 s41, s98, 0xffff0000
    s_lshl_b32 s42, s99, 16
    s_and_b32 s43, s99, 0xffff0000
    s_and_b32 s99, s91, 0xffff0000
    s_lshl_b32 s98, s91, 16
    s_and_b32 s97, s90, 0xffff0000
    s_lshl_b32 s96, s90, 16
    s_and_b32 s95, s89, 0xffff0000
    s_lshl_b32 s94, s89, 16
    s_and_b32 s93, s88, 0xffff0000
    s_lshl_b32 s92, s88, 16
    s_and_b32 s91, s87, 0xffff0000
    s_lshl_b32 s90, s87, 16
    s_and_b32 s89, s86, 0xffff0000
    s_lshl_b32 s88, s86, 16
    s_and_b32 s87, s85, 0xffff0000
    s_lshl_b32 s86, s85, 16
    s_and_b32 s85, s84, 0xffff0000
    s_lshl_b32 s84, s84, 16
    s_mov_b32 s44, s48
    s_add_u32 s45, s48, 2281701376
    s_cmp_eq_u32 s48, 0
    s_cselect_b32 s45, 0, s45
    s_cmp_lt_u32 s13, 12
    s_cbranch_scc1 L_p2_gc
    v_lshlrev_b32 v30, 16, v60
    v_and_b32 v31, 0xffff0000, v60
    v_lshlrev_b32 v36, 16, v53
    v_and_b32 v37, 0xffff0000, v53
    v_lshlrev_b32 v38, 16, v54
    v_and_b32 v39, 0xffff0000, v54
    v_lshlrev_b32 v40, 16, v56
    v_and_b32 v41, 0xffff0000, v56
    v_lshlrev_b32 v42, 16, v57
    v_and_b32 v43, 0xffff0000, v57
    v_pk_add_f32 v[14:15], v[30:31], v[36:37] op_sel:[0,0] op_sel_hi:[1,0] neg_lo:[0,1] neg_hi:[0,1]
    v_pk_add_f32 v[16:17], v[30:31], v[36:37] op_sel:[0,1] op_sel_hi:[1,1] neg_lo:[0,1] neg_hi:[0,1]
    v_pk_add_f32 v[18:19], v[30:31], v[38:39] op_sel:[0,0] op_sel_hi:[1,0] neg_lo:[0,1] neg_hi:[0,1]
    v_pk_add_f32 v[20:21], v[30:31], v[38:39] op_sel:[0,1] op_sel_hi:[1,1] neg_lo:[0,1] neg_hi:[0,1]
    v_pk_add_f32 v[22:23], v[30:31], v[40:41] op_sel:[0,0] op_sel_hi:[1,0] neg_lo:[0,1] neg_hi:[0,1]
    v_pk_add_f32 v[24:25], v[30:31], v[40:41] op_sel:[0,1] op_sel_hi:[1,1] neg_lo:[0,1] neg_hi:[0,1]
    v_pk_add_f32 v[26:27], v[30:31], v[42:43] op_sel:[0,0] op_sel_hi:[1,0] neg_lo:[0,1] neg_hi:[0,1]
    v_pk_add_f32 v[28:29], v[30:31], v[42:43] op_sel:[0,1] op_sel_hi:[1,1] neg_lo:[0,1] neg_hi:[0,1]
    v_cvt_pk_bf16_f32 v32, v14, v15
    v_lshlrev_b32 v14, 16, v32
    v_and_b32 v15, 0xffff0000, v32
    v_cvt_pk_bf16_f32 v32, v16, v17
    v_lshlrev_b32 v16, 16, v32
    v_and_b32 v17, 0xffff0000, v32
    v_cvt_pk_bf16_f32 v32, v18, v19
    v_lshlrev_b32 v18, 16, v32
    v_and_b32 v19, 0xffff0000, v32
    v_cvt_pk_bf16_f32 v32, v20, v21
    v_lshlrev_b32 v20, 16, v32
    v_and_b32 v21, 0xffff0000, v32
    v_cvt_pk_bf16_f32 v32, v22, v23
    v_lshlrev_b32 v22, 16, v32
    v_and_b32 v23, 0xffff0000, v32
    v_cvt_pk_bf16_f32 v32, v24, v25
    v_lshlrev_b32 v24, 16, v32
    v_and_b32 v25, 0xffff0000, v32
    v_cvt_pk_bf16_f32 v32, v26, v27
    v_lshlrev_b32 v26, 16, v32
    v_and_b32 v27, 0xffff0000, v32
    v_cvt_pk_bf16_f32 v32, v28, v29
    v_lshlrev_b32 v28, 16, v32
    v_and_b32 v29, 0xffff0000, v32
    v_pk_mul_f32 v[14:15], v[14:15], v[14:15]
    v_pk_mul_f32 v[16:17], v[16:17], v[16:17]
    v_pk_mul_f32 v[18:19], v[18:19], v[18:19]
    v_pk_mul_f32 v[20:21], v[20:21], v[20:21]
    v_pk_mul_f32 v[22:23], v[22:23], v[22:23]
    v_pk_mul_f32 v[24:25], v[24:25], v[24:25]
    v_pk_mul_f32 v[26:27], v[26:27], v[26:27]
    v_pk_mul_f32 v[28:29], v[28:29], v[28:29]
    v_cvt_pk_bf16_f32 v32, v14, v15
    v_lshlrev_b32 v14, 16, v32
    v_and_b32 v15, 0xffff0000, v32
    v_cvt_pk_bf16_f32 v32, v16, v17
    v_lshlrev_b32 v16, 16, v32
    v_and_b32 v17, 0xffff0000, v32
    v_cvt_pk_bf16_f32 v32, v18, v19
    v_lshlrev_b32 v18, 16, v32
    v_and_b32 v19, 0xffff0000, v32
    v_cvt_pk_bf16_f32 v32, v20, v21
    v_lshlrev_b32 v20, 16, v32
    v_and_b32 v21, 0xffff0000, v32
    v_cvt_pk_bf16_f32 v32, v22, v23
    v_lshlrev_b32 v22, 16, v32
    v_and_b32 v23, 0xffff0000, v32
    v_cvt_pk_bf16_f32 v32, v24, v25
    v_lshlrev_b32 v24, 16, v32
    v_and_b32 v25, 0xffff0000, v32
    v_cvt_pk_bf16_f32 v32, v26, v27
    v_lshlrev_b32 v26, 16, v32
    v_and_b32 v27, 0xffff0000, v32
    v_cvt_pk_bf16_f32 v32, v28, v29
    v_lshlrev_b32 v28, 16, v32
    v_and_b32 v29, 0xffff0000, v32
    v_mov_b32 v30, 1092616192
    v_mov_b32 v31, 0x3fb8aa3b
    v_pk_mul_f32 v[14:15], v[14:15], v[30:31] op_sel:[0,0] op_sel_hi:[1,0]
    v_pk_mul_f32 v[16:17], v[16:17], v[30:31] op_sel:[0,0] op_sel_hi:[1,0]
    v_pk_mul_f32 v[18:19], v[18:19], v[30:31] op_sel:[0,0] op_sel_hi:[1,0]
    v_pk_mul_f32 v[20:21], v[20:21], v[30:31] op_sel:[0,0] op_sel_hi:[1,0]
    v_pk_mul_f32 v[22:23], v[22:23], v[30:31] op_sel:[0,0] op_sel_hi:[1,0]
    v_pk_mul_f32 v[24:25], v[24:25], v[30:31] op_sel:[0,0] op_sel_hi:[1,0]
    v_pk_mul_f32 v[26:27], v[26:27], v[30:31] op_sel:[0,0] op_sel_hi:[1,0]
    v_pk_mul_f32 v[28:29], v[28:29], v[30:31] op_sel:[0,0] op_sel_hi:[1,0]
    v_cvt_pk_bf16_f32 v32, v14, v15
    v_lshlrev_b32 v14, 16, v32
    v_and_b32 v15, 0xffff0000, v32
    v_cvt_pk_bf16_f32 v32, v16, v17
    v_lshlrev_b32 v16, 16, v32
    v_and_b32 v17, 0xffff0000, v32
    v_cvt_pk_bf16_f32 v32, v18, v19
    v_lshlrev_b32 v18, 16, v32
    v_and_b32 v19, 0xffff0000, v32
    v_cvt_pk_bf16_f32 v32, v20, v21
    v_lshlrev_b32 v20, 16, v32
    v_and_b32 v21, 0xffff0000, v32
    v_cvt_pk_bf16_f32 v32, v22, v23
    v_lshlrev_b32 v22, 16, v32
    v_and_b32 v23, 0xffff0000, v32
    v_cvt_pk_bf16_f32 v32, v24, v25
    v_lshlrev_b32 v24, 16, v32
    v_and_b32 v25, 0xffff0000, v32
    v_cvt_pk_bf16_f32 v32, v26, v27
    v_lshlrev_b32 v26, 16, v32
    v_and_b32 v27, 0xffff0000, v32
    v_cvt_pk_bf16_f32 v32, v28, v29
    v_lshlrev_b32 v28, 16, v32
    v_and_b32 v29, 0xffff0000, v32
    v_pk_mul_f32 v[14:15], v[14:15], v[30:31] op_sel:[0,1] op_sel_hi:[1,1]
    v_pk_mul_f32 v[16:17], v[16:17], v[30:31] op_sel:[0,1] op_sel_hi:[1,1]
    v_pk_mul_f32 v[18:19], v[18:19], v[30:31] op_sel:[0,1] op_sel_hi:[1,1]
    v_pk_mul_f32 v[20:21], v[20:21], v[30:31] op_sel:[0,1] op_sel_hi:[1,1]
    v_pk_mul_f32 v[22:23], v[22:23], v[30:31] op_sel:[0,1] op_sel_hi:[1,1]
    v_pk_mul_f32 v[24:25], v[24:25], v[30:31] op_sel:[0,1] op_sel_hi:[1,1]
    v_pk_mul_f32 v[26:27], v[26:27], v[30:31] op_sel:[0,1] op_sel_hi:[1,1]
    v_pk_mul_f32 v[28:29], v[28:29], v[30:31] op_sel:[0,1] op_sel_hi:[1,1]
    v_exp_f32 v14, -v14
    v_exp_f32 v15, -v15
    v_exp_f32 v16, -v16
    v_exp_f32 v17, -v17
    v_exp_f32 v18, -v18
    v_exp_f32 v19, -v19
    v_exp_f32 v20, -v20
    v_exp_f32 v21, -v21
    v_exp_f32 v22, -v22
    v_exp_f32 v23, -v23
    v_exp_f32 v24, -v24
    v_exp_f32 v25, -v25
    v_exp_f32 v26, -v26
    v_exp_f32 v27, -v27
    v_exp_f32 v28, -v28
    v_exp_f32 v29, -v29
    v_cvt_pk_bf16_f32 v14, v14, v16
    v_cvt_pk_bf16_f32 v15, v15, v17
    v_cvt_pk_bf16_f32 v18, v18, v20
    v_cvt_pk_bf16_f32 v19, v19, v21
    v_cvt_pk_bf16_f32 v22, v22, v24
    v_cvt_pk_bf16_f32 v23, v23, v25
    v_cvt_pk_bf16_f32 v26, v26, v28
    v_cvt_pk_bf16_f32 v27, v27, v29
    v_dot2_f32_bf16 v72, v14, s68, 0
    v_dot2_f32_bf16 v73, v15, s68, 0
    v_dot2_f32_bf16 v74, v14, s69, 0
    v_dot2_f32_bf16 v75, v15, s69, 0
    v_dot2_f32_bf16 v76, v14, s70, 0
    v_dot2_f32_bf16 v77, v15, s70, 0
    v_dot2_f32_bf16 v78, v14, s71, 0
    v_dot2_f32_bf16 v79, v15, s71, 0
    v_dot2_f32_bf16 v80, v14, s52, 0
    v_dot2_f32_bf16 v81, v15, s52, 0
    v_dot2_f32_bf16 v82, v14, s53, 0
    v_dot2_f32_bf16 v83, v15, s53, 0
    v_dot2_f32_bf16 v84, v14, s54, 0
    v_dot2_f32_bf16 v85, v15, s54, 0
    v_dot2_f32_bf16 v86, v14, s55, 0
    v_dot2_f32_bf16 v87, v15, s55, 0
    v_dot2_f32_bf16 v72, v18, s72, v72
    v_dot2_f32_bf16 v73, v19, s72, v73
    v_dot2_f32_bf16 v74, v18, s73, v74
    v_dot2_f32_bf16 v75, v19, s73, v75
    v_dot2_f32_bf16 v76, v18, s74, v76
    v_dot2_f32_bf16 v77, v19, s74, v77
    v_dot2_f32_bf16 v78, v18, s75, v78
    v_dot2_f32_bf16 v79, v19, s75, v79
    v_dot2_f32_bf16 v80, v18, s56, v80
    v_dot2_f32_bf16 v81, v19, s56, v81
    v_dot2_f32_bf16 v82, v18, s57, v82
    v_dot2_f32_bf16 v83, v19, s57, v83
    v_dot2_f32_bf16 v84, v18, s58, v84
    v_dot2_f32_bf16 v85, v19, s58, v85
    v_dot2_f32_bf16 v86, v18, s59, v86
    v_dot2_f32_bf16 v87, v19, s59, v87
    v_dot2_f32_bf16 v72, v22, s76, v72
    v_dot2_f32_bf16 v73, v23, s76, v73
    v_dot2_f32_bf16 v74, v22, s77, v74
    v_dot2_f32_bf16 v75, v23, s77, v75
    v_dot2_f32_bf16 v76, v22, s78, v76
    v_dot2_f32_bf16 v77, v23, s78, v77
    v_dot2_f32_bf16 v78, v22, s79, v78
    v_dot2_f32_bf16 v79, v23, s79, v79
    v_dot2_f32_bf16 v80, v22, s60, v80
    v_dot2_f32_bf16 v81, v23, s60, v81
    v_dot2_f32_bf16 v82, v22, s61, v82
    v_dot2_f32_bf16 v83, v23, s61, v83
    v_dot2_f32_bf16 v84, v22, s62, v84
    v_dot2_f32_bf16 v85, v23, s62, v85
    v_dot2_f32_bf16 v86, v22, s63, v86
    v_dot2_f32_bf16 v87, v23, s63, v87
    v_dot2_f32_bf16 v72, v26, s80, v72
    v_dot2_f32_bf16 v73, v27, s80, v73
    v_dot2_f32_bf16 v74, v26, s81, v74
    v_dot2_f32_bf16 v75, v27, s81, v75
    v_dot2_f32_bf16 v76, v26, s82, v76
    v_dot2_f32_bf16 v77, v27, s82, v77
    v_dot2_f32_bf16 v78, v26, s83, v78
    v_dot2_f32_bf16 v79, v27, s83, v79
    v_dot2_f32_bf16 v80, v26, s64, v80
    v_dot2_f32_bf16 v81, v27, s64, v81
    v_dot2_f32_bf16 v82, v26, s65, v82
    v_dot2_f32_bf16 v83, v27, s65, v83
    v_dot2_f32_bf16 v84, v26, s66, v84
    v_dot2_f32_bf16 v85, v27, s66, v85
    v_dot2_f32_bf16 v86, v26, s67, v86
    v_dot2_f32_bf16 v87, v27, s67, v87
L_p2_gc:
    s_cmp_ge_u32 s13, 4
    s_cbranch_scc1 L_p2_gd
    v_lshlrev_b32 v30, 16, v61
    v_and_b32 v31, 0xffff0000, v61
    v_pk_add_f32 v[14:15], v[30:31], v[36:37] op_sel:[0,0] op_sel_hi:[1,0] neg_lo:[0,1] neg_hi:[0,1]
    v_pk_add_f32 v[16:17], v[30:31], v[36:37] op_sel:[0,1] op_sel_hi:[1,1] neg_lo:[0,1] neg_hi:[0,1]
    v_pk_add_f32 v[18:19], v[30:31], v[38:39] op_sel:[0,0] op_sel_hi:[1,0] neg_lo:[0,1] neg_hi:[0,1]
    v_pk_add_f32 v[20:21], v[30:31], v[38:39] op_sel:[0,1] op_sel_hi:[1,1] neg_lo:[0,1] neg_hi:[0,1]
    v_pk_add_f32 v[22:23], v[30:31], v[40:41] op_sel:[0,0] op_sel_hi:[1,0] neg_lo:[0,1] neg_hi:[0,1]
    v_pk_add_f32 v[24:25], v[30:31], v[40:41] op_sel:[0,1] op_sel_hi:[1,1] neg_lo:[0,1] neg_hi:[0,1]
    v_pk_add_f32 v[26:27], v[30:31], v[42:43] op_sel:[0,0] op_sel_hi:[1,0] neg_lo:[0,1] neg_hi:[0,1]
    v_pk_add_f32 v[28:29], v[30:31], v[42:43] op_sel:[0,1] op_sel_hi:[1,1] neg_lo:[0,1] neg_hi:[0,1]
    v_cvt_pk_bf16_f32 v32, v14, v15
    v_lshlrev_b32 v14, 16, v32
    v_and_b32 v15, 0xffff0000, v32
    v_cvt_pk_bf16_f32 v32, v16, v17
    v_lshlrev_b32 v16, 16, v32
    v_and_b32 v17, 0xffff0000, v32
    v_cvt_pk_bf16_f32 v32, v18, v19
    v_lshlrev_b32 v18, 16, v32
    v_and_b32 v19, 0xffff0000, v32
    v_cvt_pk_bf16_f32 v32, v20, v21
    v_lshlrev_b32 v20, 16, v32
    v_and_b32 v21, 0xffff0000, v32
    v_cvt_pk_bf16_f32 v32, v22, v23
    v_lshlrev_b32 v22, 16, v32
    v_and_b32 v23, 0xffff0000, v32
    v_cvt_pk_bf16_f32 v32, v24, v25
    v_lshlrev_b32 v24, 16, v32
    v_and_b32 v25, 0xffff0000, v32
    v_cvt_pk_bf16_f32 v32, v26, v27
    v_lshlrev_b32 v26, 16, v32
    v_and_b32 v27, 0xffff0000, v32
    v_cvt_pk_bf16_f32 v32, v28, v29
    v_lshlrev_b32 v28, 16, v32
    v_and_b32 v29, 0xffff0000, v32
    v_pk_mul_f32 v[14:15], v[14:15], v[14:15]
    v_pk_mul_f32 v[16:17], v[16:17], v[16:17]
    v_pk_mul_f32 v[18:19], v[18:19], v[18:19]
    v_pk_mul_f32 v[20:21], v[20:21], v[20:21]
    v_pk_mul_f32 v[22:23], v[22:23], v[22:23]
    v_pk_mul_f32 v[24:25], v[24:25], v[24:25]
    v_pk_mul_f32 v[26:27], v[26:27], v[26:27]
    v_pk_mul_f32 v[28:29], v[28:29], v[28:29]
    v_cvt_pk_bf16_f32 v32, v14, v15
    v_lshlrev_b32 v14, 16, v32
    v_and_b32 v15, 0xffff0000, v32
    v_cvt_pk_bf16_f32 v32, v16, v17
    v_lshlrev_b32 v16, 16, v32
    v_and_b32 v17, 0xffff0000, v32
    v_cvt_pk_bf16_f32 v32, v18, v19
    v_lshlrev_b32 v18, 16, v32
    v_and_b32 v19, 0xffff0000, v32
    v_cvt_pk_bf16_f32 v32, v20, v21
    v_lshlrev_b32 v20, 16, v32
    v_and_b32 v21, 0xffff0000, v32
    v_cvt_pk_bf16_f32 v32, v22, v23
    v_lshlrev_b32 v22, 16, v32
    v_and_b32 v23, 0xffff0000, v32
    v_cvt_pk_bf16_f32 v32, v24, v25
    v_lshlrev_b32 v24, 16, v32
    v_and_b32 v25, 0xffff0000, v32
    v_cvt_pk_bf16_f32 v32, v26, v27
    v_lshlrev_b32 v26, 16, v32
    v_and_b32 v27, 0xffff0000, v32
    v_cvt_pk_bf16_f32 v32, v28, v29
    v_lshlrev_b32 v28, 16, v32
    v_and_b32 v29, 0xffff0000, v32
    v_mov_b32 v30, 1092616192
    v_mov_b32 v31, 0x3fb8aa3b
    v_pk_mul_f32 v[14:15], v[14:15], v[30:31] op_sel:[0,0] op_sel_hi:[1,0]
    v_pk_mul_f32 v[16:17], v[16:17], v[30:31] op_sel:[0,0] op_sel_hi:[1,0]
    v_pk_mul_f32 v[18:19], v[18:19], v[30:31] op_sel:[0,0] op_sel_hi:[1,0]
    v_pk_mul_f32 v[20:21], v[20:21], v[30:31] op_sel:[0,0] op_sel_hi:[1,0]
    v_pk_mul_f32 v[22:23], v[22:23], v[30:31] op_sel:[0,0] op_sel_hi:[1,0]
    v_pk_mul_f32 v[24:25], v[24:25], v[30:31] op_sel:[0,0] op_sel_hi:[1,0]
    v_pk_mul_f32 v[26:27], v[26:27], v[30:31] op_sel:[0,0] op_sel_hi:[1,0]
    v_pk_mul_f32 v[28:29], v[28:29], v[30:31] op_sel:[0,0] op_sel_hi:[1,0]
    v_cvt_pk_bf16_f32 v32, v14, v15
    v_lshlrev_b32 v14, 16, v32
    v_and_b32 v15, 0xffff0000, v32
    v_cvt_pk_bf16_f32 v32, v16, v17
    v_lshlrev_b32 v16, 16, v32
    v_and_b32 v17, 0xffff0000, v32
    v_cvt_pk_bf16_f32 v32, v18, v19
    v_lshlrev_b32 v18, 16, v32
    v_and_b32 v19, 0xffff0000, v32
    v_cvt_pk_bf16_f32 v32, v20, v21
    v_lshlrev_b32 v20, 16, v32
    v_and_b32 v21, 0xffff0000, v32
    v_cvt_pk_bf16_f32 v32, v22, v23
    v_lshlrev_b32 v22, 16, v32
    v_and_b32 v23, 0xffff0000, v32
    v_cvt_pk_bf16_f32 v32, v24, v25
    v_lshlrev_b32 v24, 16, v32
    v_and_b32 v25, 0xffff0000, v32
    v_cvt_pk_bf16_f32 v32, v26, v27
    v_lshlrev_b32 v26, 16, v32
    v_and_b32 v27, 0xffff0000, v32
    v_cvt_pk_bf16_f32 v32, v28, v29
    v_lshlrev_b32 v28, 16, v32
    v_and_b32 v29, 0xffff0000, v32
    v_pk_mul_f32 v[14:15], v[14:15], v[30:31] op_sel:[0,1] op_sel_hi:[1,1]
    v_pk_mul_f32 v[16:17], v[16:17], v[30:31] op_sel:[0,1] op_sel_hi:[1,1]
    v_pk_mul_f32 v[18:19], v[18:19], v[30:31] op_sel:[0,1] op_sel_hi:[1,1]
    v_pk_mul_f32 v[20:21], v[20:21], v[30:31] op_sel:[0,1] op_sel_hi:[1,1]
    v_pk_mul_f32 v[22:23], v[22:23], v[30:31] op_sel:[0,1] op_sel_hi:[1,1]
    v_pk_mul_f32 v[24:25], v[24:25], v[30:31] op_sel:[0,1] op_sel_hi:[1,1]
    v_pk_mul_f32 v[26:27], v[26:27], v[30:31] op_sel:[0,1] op_sel_hi:[1,1]
    v_pk_mul_f32 v[28:29], v[28:29], v[30:31] op_sel:[0,1] op_sel_hi:[1,1]
    v_exp_f32 v14, -v14
    v_exp_f32 v15, -v15
    v_exp_f32 v16, -v16
    v_exp_f32 v17, -v17
    v_exp_f32 v18, -v18
    v_exp_f32 v19, -v19
    v_exp_f32 v20, -v20
    v_exp_f32 v21, -v21
    v_exp_f32 v22, -v22
    v_exp_f32 v23, -v23
    v_exp_f32 v24, -v24
    v_exp_f32 v25, -v25
    v_exp_f32 v26, -v26
    v_exp_f32 v27, -v27
    v_exp_f32 v28, -v28
    v_exp_f32 v29, -v29
    v_cvt_pk_bf16_f32 v14, v14, v16
    v_cvt_pk_bf16_f32 v15, v15, v17
    v_cvt_pk_bf16_f32 v18, v18, v20
    v_cvt_pk_bf16_f32 v19, v19, v21
    v_cvt_pk_bf16_f32 v22, v22, v24
    v_cvt_pk_bf16_f32 v23, v23, v25
    v_cvt_pk_bf16_f32 v26, v26, v28
    v_cvt_pk_bf16_f32 v27, v27, v29
    v_dot2_f32_bf16 v112, v14, s68, 0
    v_dot2_f32_bf16 v113, v15, s68, 0
    v_dot2_f32_bf16 v114, v14, s69, 0
    v_dot2_f32_bf16 v115, v15, s69, 0
    v_dot2_f32_bf16 v116, v14, s70, 0
    v_dot2_f32_bf16 v117, v15, s70, 0
    v_dot2_f32_bf16 v118, v14, s71, 0
    v_dot2_f32_bf16 v119, v15, s71, 0
    v_dot2_f32_bf16 v120, v14, s52, 0
    v_dot2_f32_bf16 v121, v15, s52, 0
    v_dot2_f32_bf16 v122, v14, s53, 0
    v_dot2_f32_bf16 v123, v15, s53, 0
    v_dot2_f32_bf16 v124, v14, s54, 0
    v_dot2_f32_bf16 v125, v15, s54, 0
    v_dot2_f32_bf16 v126, v14, s55, 0
    v_dot2_f32_bf16 v127, v15, s55, 0
    v_dot2_f32_bf16 v112, v18, s72, v112
    v_dot2_f32_bf16 v113, v19, s72, v113
    v_dot2_f32_bf16 v114, v18, s73, v114
    v_dot2_f32_bf16 v115, v19, s73, v115
    v_dot2_f32_bf16 v116, v18, s74, v116
    v_dot2_f32_bf16 v117, v19, s74, v117
    v_dot2_f32_bf16 v118, v18, s75, v118
    v_dot2_f32_bf16 v119, v19, s75, v119
    v_dot2_f32_bf16 v120, v18, s56, v120
    v_dot2_f32_bf16 v121, v19, s56, v121
    v_dot2_f32_bf16 v122, v18, s57, v122
    v_dot2_f32_bf16 v123, v19, s57, v123
    v_dot2_f32_bf16 v124, v18, s58, v124
    v_dot2_f32_bf16 v125, v19, s58, v125
    v_dot2_f32_bf16 v126, v18, s59, v126
    v_dot2_f32_bf16 v127, v19, s59, v127
    v_dot2_f32_bf16 v112, v22, s76, v112
    v_dot2_f32_bf16 v113, v23, s76, v113
    v_dot2_f32_bf16 v114, v22, s77, v114
    v_dot2_f32_bf16 v115, v23, s77, v115
    v_dot2_f32_bf16 v116, v22, s78, v116
    v_dot2_f32_bf16 v117, v23, s78, v117
    v_dot2_f32_bf16 v118, v22, s79, v118
    v_dot2_f32_bf16 v119, v23, s79, v119
    v_dot2_f32_bf16 v120, v22, s60, v120
    v_dot2_f32_bf16 v121, v23, s60, v121
    v_dot2_f32_bf16 v122, v22, s61, v122
    v_dot2_f32_bf16 v123, v23, s61, v123
    v_dot2_f32_bf16 v124, v22, s62, v124
    v_dot2_f32_bf16 v125, v23, s62, v125
    v_dot2_f32_bf16 v126, v22, s63, v126
    v_dot2_f32_bf16 v127, v23, s63, v127
    v_dot2_f32_bf16 v112, v26, s80, v112
    v_dot2_f32_bf16 v113, v27, s80, v113
    v_dot2_f32_bf16 v114, v26, s81, v114
    v_dot2_f32_bf16 v115, v27, s81, v115
    v_dot2_f32_bf16 v116, v26, s82, v116
    v_dot2_f32_bf16 v117, v27, s82, v117
    v_dot2_f32_bf16 v118, v26, s83, v118
    v_dot2_f32_bf16 v119, v27, s83, v119
    v_dot2_f32_bf16 v120, v26, s64, v120
    v_dot2_f32_bf16 v121, v27, s64, v121
    v_dot2_f32_bf16 v122, v26, s65, v122
    v_dot2_f32_bf16 v123, v27, s65, v123
    v_dot2_f32_bf16 v124, v26, s66, v124
    v_dot2_f32_bf16 v125, v27, s66, v125
    v_dot2_f32_bf16 v126, v26, s67, v126
    v_dot2_f32_bf16 v127, v27, s67, v127
L_p2_gd:
    s_cmp_lg_u32 s13, 15
    s_cbranch_scc1 L_p2_nosig
    s_waitcnt vmcnt(2)
    v_readfirstlane_b32 s15, v9
    s_lshl_b32 s51, 1, s12
    s_add_u32 s20, s20, s15
    s_and_b32 s15, s20, 0xff
    s_cmp_eq_u32 s15, 4
    s_cbranch_scc0 L_p2_notlast
    s_bfe_u32 s15, s20, 262160
    s_or_b32 s51, s51, s15
    s_branch L_p2_pub
L_p2_notlast:
    s_cmp_lg_u32 s21, 0
    s_cselect_b32 s51, 0, s51
    s_cbranch_scc1 L_p2_pub
L_p2_poll:
    v_mov_b32 v9, 0
    s_lshl_b32 s14, s3, 8
    s_add_u32 s14, s14, 8523776
    s_mov_b64 exec, 1
    buffer_atomic_add v9, off, s[4:7], s14 sc0
    s_mov_b64 exec, -1
    s_waitcnt vmcnt(0)
    v_readfirstlane_b32 s20, v9
    s_nop 0
    s_and_b32 s15, s20, 0xff
    s_cmp_lt_u32 s15, 4
    s_cbranch_scc1 L_p2_poll
L_p2_pub:
    s_lshl_b32 s15, s51, 24
    s_or_b32 s15, s15, s20
    v_mov_b32 v9, s15
    s_mov_b64 exec, 1
    ds_write_b32 v8, v9
    s_mov_b64 exec, -1
    s_waitcnt lgkmcnt(0)
L_p2_nosig:
    s_barrier
    ds_read_b32 v9, v8
    s_waitcnt lgkmcnt(0)
    v_readfirstlane_b32 s20, v9
    s_nop 0
    s_lshr_b32 s51, s20, 24
    s_cbranch_scc0 L_p2_end
L_p2_fin:
    s_mul_i32 s24, s49, 20000
    s_add_u32 s14, s12, 1
    s_and_b32 s14, s14, 3
    s_mul_i32 s15, s14, 5120000
    s_add_u32 s15, s15, 228589568
    s_add_u32 s15, s15, s26
    buffer_load_dwordx4 v[12:15], v1, s[4:7], s15 offen sc1
    buffer_load_dwordx4 v[92:95], v2, s[4:7], s15 offen sc1
    s_add_u32 s14, s12, 2
    s_and_b32 s14, s14, 3
    s_mul_i32 s15, s14, 5120000
    s_add_u32 s15, s15, 228589568
    s_add_u32 s15, s15, s26
    buffer_load_dwordx4 v[16:19], v1, s[4:7], s15 offen sc1
    buffer_load_dwordx4 v[96:99], v2, s[4:7], s15 offen sc1
    s_add_u32 s14, s12, 3
    s_and_b32 s14, s14, 3
    s_mul_i32 s15, s14, 5120000
    s_add_u32 s15, s15, 228589568
    s_add_u32 s15, s15, s26
    buffer_load_dwordx4 v[20:23], v1, s[4:7], s15 offen sc1
    buffer_load_dwordx4 v[100:103], v2, s[4:7], s15 offen sc1
    v_add_u32 v24, s24, v1
    ds_read_b128 v[8:11], v24
    v_add_u32 v25, s24, v2
    ds_read_b128 v[88:91], v25
    s_waitcnt vmcnt(0) lgkmcnt(0)
    s_bfe_u32 s14, s20, 262164
    s_cbranch_scc0 L_p2_kernel_nof32a_10
    s_add_u32 s14, s12, 0
    s_and_b32 s14, s14, 3
    s_add_u32 s14, s14, 20
    s_bitcmp1_b32 s20, s14
    s_cbranch_scc0 L_p2_kernel_q_11
    v_mov_b32 v8, 1073758208
    v_mov_b32 v9, 1073758208
    v_mov_b32 v10, 1073758208
    v_mov_b32 v11, 1073758208
L_p2_kernel_q_11:
    s_add_u32 s14, s12, 1
    s_and_b32 s14, s14, 3
    s_add_u32 s14, s14, 20
    s_bitcmp1_b32 s20, s14
    s_cbranch_scc0 L_p2_kernel_q_12
    v_mov_b32 v12, 1073758208
    v_mov_b32 v13, 1073758208
    v_mov_b32 v14, 1073758208
    v_mov_b32 v15, 1073758208
L_p2_kernel_q_12:
    s_add_u32 s14, s12, 2
    s_and_b32 s14, s14, 3
    s_add_u32 s14, s14, 20
    s_bitcmp1_b32 s20, s14
    s_cbranch_scc0 L_p2_kernel_q_13
    v_mov_b32 v16, 1073758208
    v_mov_b32 v17, 1073758208
    v_mov_b32 v18, 1073758208
    v_mov_b32 v19, 1073758208
L_p2_kernel_q_13:
    s_add_u32 s14, s12, 3
    s_and_b32 s14, s14, 3
    s_add_u32 s14, s14, 20
    s_bitcmp1_b32 s20, s14
    s_cbranch_scc0 L_p2_kernel_q_14
    v_mov_b32 v20, 1073758208
    v_mov_b32 v21, 1073758208
    v_mov_b32 v22, 1073758208
    v_mov_b32 v23, 1073758208
L_p2_kernel_q_14:
L_p2_kernel_nof32a_10:
    v_pk_add_u16 v8, v8, v12
    v_pk_add_u16 v16, v16, v20
    v_pk_add_u16 v9, v9, v13
    v_pk_add_u16 v17, v17, v21
    v_pk_add_u16 v10, v10, v14
    v_pk_add_u16 v18, v18, v22
    v_pk_add_u16 v11, v11, v15
    v_pk_add_u16 v19, v19, v23
    v_add_u32_sdwa v24, v8, v16 dst_sel:DWORD dst_unused:UNUSED_PAD src0_sel:WORD_0 src1_sel:WORD_0
    v_add_u32_sdwa v25, v10, v18 dst_sel:DWORD dst_unused:UNUSED_PAD src0_sel:WORD_0 src1_sel:WORD_0
    v_add_u32_sdwa v26, v8, v16 dst_sel:DWORD dst_unused:UNUSED_PAD src0_sel:WORD_1 src1_sel:WORD_1
    v_add_u32_sdwa v27, v10, v18 dst_sel:DWORD dst_unused:UNUSED_PAD src0_sel:WORD_1 src1_sel:WORD_1
    v_add_u32_sdwa v28, v9, v17 dst_sel:DWORD dst_unused:UNUSED_PAD src0_sel:WORD_0 src1_sel:WORD_0
    v_add_u32_sdwa v29, v11, v19 dst_sel:DWORD dst_unused:UNUSED_PAD src0_sel:WORD_0 src1_sel:WORD_0
    v_add_u32_sdwa v30, v9, v17 dst_sel:DWORD dst_unused:UNUSED_PAD src0_sel:WORD_1 src1_sel:WORD_1
    v_add_u32_sdwa v31, v11, v19 dst_sel:DWORD dst_unused:UNUSED_PAD src0_sel:WORD_1 src1_sel:WORD_1
    v_cvt_f32_u32 v24, v24
    v_cvt_f32_u32 v25, v25
    v_cvt_f32_u32 v26, v26
    v_cvt_f32_u32 v27, v27
    v_cvt_f32_u32 v28, v28
    v_cvt_f32_u32 v29, v29
    v_cvt_f32_u32 v30, v30
    v_cvt_f32_u32 v31, v31
    v_pk_fma_f32 v[24:25], v[24:25], s[44:45], s[44:45] op_sel:[0,0,1] op_sel_hi:[1,0,1]
    v_pk_fma_f32 v[26:27], v[26:27], s[44:45], s[44:45] op_sel:[0,0,1] op_sel_hi:[1,0,1]
    v_pk_fma_f32 v[28:29], v[28:29], s[44:45], s[44:45] op_sel:[0,0,1] op_sel_hi:[1,0,1]
    v_pk_fma_f32 v[30:31], v[30:31], s[44:45], s[44:45] op_sel:[0,0,1] op_sel_hi:[1,0,1]
    s_bfe_u32 s14, s20, 262164
    s_cbranch_scc0 L_p2_kernel_nof32b_15
    v_lshlrev_b32 v32, 1, v1
    s_bitcmp1_b32 s20, 20
    s_cbranch_scc0 L_p2_kernel_q_16
    s_lshl_b32 s15, s26, 1
    s_add_u32 s15, s15, 249069568
    buffer_load_dwordx4 v[8:11], v32, s[4:7], s15 offen sc1
    buffer_load_dwordx4 v[12:15], v32, s[4:7], s15 offen offset:16 sc1
    s_waitcnt vmcnt(0)
    v_add_f32 v24, v24, v8
    v_add_f32 v25, v25, v12
    v_add_f32 v26, v26, v9
    v_add_f32 v27, v27, v13
    v_add_f32 v28, v28, v10
    v_add_f32 v29, v29, v14
    v_add_f32 v30, v30, v11
    v_add_f32 v31, v31, v15
L_p2_kernel_q_16:
    s_bitcmp1_b32 s20, 21
    s_cbranch_scc0 L_p2_kernel_q_17
    s_lshl_b32 s15, s26, 1
    s_add_u32 s15, s15, 259309568
    buffer_load_dwordx4 v[8:11], v32, s[4:7], s15 offen sc1
    buffer_load_dwordx4 v[12:15], v32, s[4:7], s15 offen offset:16 sc1
    s_waitcnt vmcnt(0)
    v_add_f32 v24, v24, v8
    v_add_f32 v25, v25, v12
    v_add_f32 v26, v26, v9
    v_add_f32 v27, v27, v13
    v_add_f32 v28, v28, v10
    v_add_f32 v29, v29, v14
    v_add_f32 v30, v30, v11
    v_add_f32 v31, v31, v15
L_p2_kernel_q_17:
    s_bitcmp1_b32 s20, 22
    s_cbranch_scc0 L_p2_kernel_q_18
    s_lshl_b32 s15, s26, 1
    s_add_u32 s15, s15, 269549568
    buffer_load_dwordx4 v[8:11], v32, s[4:7], s15 offen sc1
    buffer_load_dwordx4 v[12:15], v32, s[4:7], s15 offen offset:16 sc1
    s_waitcnt vmcnt(0)
    v_add_f32 v24, v24, v8
    v_add_f32 v25, v25, v12
    v_add_f32 v26, v26, v9
    v_add_f32 v27, v27, v13
    v_add_f32 v28, v28, v10
    v_add_f32 v29, v29, v14
    v_add_f32 v30, v30, v11
    v_add_f32 v31, v31, v15
L_p2_kernel_q_18:
    s_bitcmp1_b32 s20, 23
    s_cbranch_scc0 L_p2_kernel_q_19
    s_lshl_b32 s15, s26, 1
    s_add_u32 s15, s15, 279789568
    buffer_load_dwordx4 v[8:11], v32, s[4:7], s15 offen sc1
    buffer_load_dwordx4 v[12:15], v32, s[4:7], s15 offen offset:16 sc1
    s_waitcnt vmcnt(0)
    v_add_f32 v24, v24, v8
    v_add_f32 v25, v25, v12
    v_add_f32 v26, v26, v9
    v_add_f32 v27, v27, v13
    v_add_f32 v28, v28, v10
    v_add_f32 v29, v29, v14
    v_add_f32 v30, v30, v11
    v_add_f32 v31, v31, v15
L_p2_kernel_q_19:
L_p2_kernel_nof32b_15:
    v_pk_mul_f32 v[8:9], v[24:25], s[84:85] op_sel:[0,0] op_sel_hi:[1,0]
    v_pk_mul_f32 v[10:11], v[24:25], s[84:85] op_sel:[0,1] op_sel_hi:[1,1]
    v_pk_mul_f32 v[12:13], v[24:25], s[86:87] op_sel:[0,0] op_sel_hi:[1,0]
    v_pk_mul_f32 v[14:15], v[24:25], s[86:87] op_sel:[0,1] op_sel_hi:[1,1]
    v_pk_fma_f32 v[8:9], v[26:27], s[88:89], v[8:9] op_sel:[0,0,0] op_sel_hi:[1,0,1]
    v_pk_fma_f32 v[10:11], v[26:27], s[88:89], v[10:11] op_sel:[0,1,0] op_sel_hi:[1,1,1]
    v_pk_fma_f32 v[12:13], v[26:27], s[90:91], v[12:13] op_sel:[0,0,0] op_sel_hi:[1,0,1]
    v_pk_fma_f32 v[14:15], v[26:27], s[90:91], v[14:15] op_sel:[0,1,0] op_sel_hi:[1,1,1]
    v_pk_fma_f32 v[8:9], v[28:29], s[92:93], v[8:9] op_sel:[0,0,0] op_sel_hi:[1,0,1]
    v_pk_fma_f32 v[10:11], v[28:29], s[92:93], v[10:11] op_sel:[0,1,0] op_sel_hi:[1,1,1]
    v_pk_fma_f32 v[12:13], v[28:29], s[94:95], v[12:13] op_sel:[0,0,0] op_sel_hi:[1,0,1]
    v_pk_fma_f32 v[14:15], v[28:29], s[94:95], v[14:15] op_sel:[0,1,0] op_sel_hi:[1,1,1]
    v_pk_fma_f32 v[8:9], v[30:31], s[96:97], v[8:9] op_sel:[0,0,0] op_sel_hi:[1,0,1]
    v_pk_fma_f32 v[10:11], v[30:31], s[96:97], v[10:11] op_sel:[0,1,0] op_sel_hi:[1,1,1]
    v_pk_fma_f32 v[12:13], v[30:31], s[98:99], v[12:13] op_sel:[0,0,0] op_sel_hi:[1,0,1]
    v_pk_fma_f32 v[14:15], v[30:31], s[98:99], v[14:15] op_sel:[0,1,0] op_sel_hi:[1,1,1]
    v_pk_mul_f32 v[8:9], v[8:9], v[72:73]
    v_pk_mul_f32 v[10:11], v[10:11], v[74:75]
    v_pk_mul_f32 v[12:13], v[12:13], v[76:77]
    v_pk_mul_f32 v[14:15], v[14:15], v[78:79]
    v_pk_mul_f32 v[24:25], v[8:9], s[28:29] op_sel:[0,0] op_sel_hi:[1,0]
    v_pk_mul_f32 v[26:27], v[8:9], s[28:29] op_sel:[0,1] op_sel_hi:[1,1]
    v_pk_mul_f32 v[28:29], v[8:9], s[30:31] op_sel:[0,0] op_sel_hi:[1,0]
    v_pk_mul_f32 v[30:31], v[8:9], s[30:31] op_sel:[0,1] op_sel_hi:[1,1]
    v_pk_fma_f32 v[24:25], v[10:11], s[32:33], v[24:25] op_sel:[0,0,0] op_sel_hi:[1,0,1]
    v_pk_fma_f32 v[26:27], v[10:11], s[32:33], v[26:27] op_sel:[0,1,0] op_sel_hi:[1,1,1]
    v_pk_fma_f32 v[28:29], v[10:11], s[34:35], v[28:29] op_sel:[0,0,0] op_sel_hi:[1,0,1]
    v_pk_fma_f32 v[30:31], v[10:11], s[34:35], v[30:31] op_sel:[0,1,0] op_sel_hi:[1,1,1]
    v_pk_fma_f32 v[24:25], v[12:13], s[36:37], v[24:25] op_sel:[0,0,0] op_sel_hi:[1,0,1]
    v_pk_fma_f32 v[26:27], v[12:13], s[36:37], v[26:27] op_sel:[0,1,0] op_sel_hi:[1,1,1]
    v_pk_fma_f32 v[28:29], v[12:13], s[38:39], v[28:29] op_sel:[0,0,0] op_sel_hi:[1,0,1]
    v_pk_fma_f32 v[30:31], v[12:13], s[38:39], v[30:31] op_sel:[0,1,0] op_sel_hi:[1,1,1]
    v_pk_fma_f32 v[24:25], v[14:15], s[40:41], v[24:25] op_sel:[0,0,0] op_sel_hi:[1,0,1]
    v_pk_fma_f32 v[26:27], v[14:15], s[40:41], v[26:27] op_sel:[0,1,0] op_sel_hi:[1,1,1]
    v_pk_fma_f32 v[28:29], v[14:15], s[42:43], v[28:29] op_sel:[0,0,0] op_sel_hi:[1,0,1]
    v_pk_fma_f32 v[30:31], v[14:15], s[42:43], v[30:31] op_sel:[0,1,0] op_sel_hi:[1,1,1]
    v_lshlrev_b32 v8, 16, v64
    v_and_b32 v10, 0xffff0000, v64
    v_lshlrev_b32 v12, 16, v65
    v_and_b32 v14, 0xffff0000, v65
    v_lshlrev_b32 v9, 16, v66
    v_and_b32 v11, 0xffff0000, v66
    v_lshlrev_b32 v13, 16, v67
    v_and_b32 v15, 0xffff0000, v67
    v_pk_fma_f32 v[8:9], v[24:25], v[80:81], v[8:9]
    v_pk_fma_f32 v[10:11], v[26:27], v[82:83], v[10:11]
    v_pk_fma_f32 v[12:13], v[28:29], v[84:85], v[12:13]
    v_pk_fma_f32 v[14:15], v[30:31], v[86:87], v[14:15]
    v_cvt_pk_bf16_f32 v16, v8, v10
    v_cvt_pk_bf16_f32 v17, v12, v14
    v_cvt_pk_bf16_f32 v18, v9, v11
    v_cvt_pk_bf16_f32 v19, v13, v15
    buffer_store_dwordx4 v[16:19], v1, s[16:19], s26 offen
    s_cmp_ge_u32 s13, 4
    s_cbranch_scc1 L_p2_f1
    s_bfe_u32 s14, s20, 262164
    s_cbranch_scc0 L_p2_kernel_nof32a_20
    s_add_u32 s14, s12, 0
    s_and_b32 s14, s14, 3
    s_add_u32 s14, s14, 20
    s_bitcmp1_b32 s20, s14
    s_cbranch_scc0 L_p2_kernel_q_21
    v_mov_b32 v88, 1073758208
    v_mov_b32 v89, 1073758208
    v_mov_b32 v90, 1073758208
    v_mov_b32 v91, 1073758208
L_p2_kernel_q_21:
    s_add_u32 s14, s12, 1
    s_and_b32 s14, s14, 3
    s_add_u32 s14, s14, 20
    s_bitcmp1_b32 s20, s14
    s_cbranch_scc0 L_p2_kernel_q_22
    v_mov_b32 v92, 1073758208
    v_mov_b32 v93, 1073758208
    v_mov_b32 v94, 1073758208
    v_mov_b32 v95, 1073758208
L_p2_kernel_q_22:
    s_add_u32 s14, s12, 2
    s_and_b32 s14, s14, 3
    s_add_u32 s14, s14, 20
    s_bitcmp1_b32 s20, s14
    s_cbranch_scc0 L_p2_kernel_q_23
    v_mov_b32 v96, 1073758208
    v_mov_b32 v97, 1073758208
    v_mov_b32 v98, 1073758208
    v_mov_b32 v99, 1073758208
L_p2_kernel_q_23:
    s_add_u32 s14, s12, 3
    s_and_b32 s14, s14, 3
    s_add_u32 s14, s14, 20
    s_bitcmp1_b32 s20, s14
    s_cbranch_scc0 L_p2_kernel_q_24
    v_mov_b32 v100, 1073758208
    v_mov_b32 v101, 1073758208
    v_mov_b32 v102, 1073758208
    v_mov_b32 v103, 1073758208
L_p2_kernel_q_24:
L_p2_kernel_nof32a_20:
    v_pk_add_u16 v88, v88, v92
    v_pk_add_u16 v96, v96, v100
    v_pk_add_u16 v89, v89, v93
    v_pk_add_u16 v97, v97, v101
    v_pk_add_u16 v90, v90, v94
    v_pk_add_u16 v98, v98, v102
    v_pk_add_u16 v91, v91, v95
    v_pk_add_u16 v99, v99, v103
    v_add_u32_sdwa v24, v88, v96 dst_sel:DWORD dst_unused:UNUSED_PAD src0_sel:WORD_0 src1_sel:WORD_0
    v_add_u32_sdwa v25, v90, v98 dst_sel:DWORD dst_unused:UNUSED_PAD src0_sel:WORD_0 src1_sel:WORD_0
    v_add_u32_sdwa v26, v88, v96 dst_sel:DWORD dst_unused:UNUSED_PAD src0_sel:WORD_1 src1_sel:WORD_1
    v_add_u32_sdwa v27, v90, v98 dst_sel:DWORD dst_unused:UNUSED_PAD src0_sel:WORD_1 src1_sel:WORD_1
    v_add_u32_sdwa v28, v89, v97 dst_sel:DWORD dst_unused:UNUSED_PAD src0_sel:WORD_0 src1_sel:WORD_0
    v_add_u32_sdwa v29, v91, v99 dst_sel:DWORD dst_unused:UNUSED_PAD src0_sel:WORD_0 src1_sel:WORD_0
    v_add_u32_sdwa v30, v89, v97 dst_sel:DWORD dst_unused:UNUSED_PAD src0_sel:WORD_1 src1_sel:WORD_1
    v_add_u32_sdwa v31, v91, v99 dst_sel:DWORD dst_unused:UNUSED_PAD src0_sel:WORD_1 src1_sel:WORD_1
    v_cvt_f32_u32 v24, v24
    v_cvt_f32_u32 v25, v25
    v_cvt_f32_u32 v26, v26
    v_cvt_f32_u32 v27, v27
    v_cvt_f32_u32 v28, v28
    v_cvt_f32_u32 v29, v29
    v_cvt_f32_u32 v30, v30
    v_cvt_f32_u32 v31, v31
    v_pk_fma_f32 v[24:25], v[24:25], s[44:45], s[44:45] op_sel:[0,0,1] op_sel_hi:[1,0,1]
    v_pk_fma_f32 v[26:27], v[26:27], s[44:45], s[44:45] op_sel:[0,0,1] op_sel_hi:[1,0,1]
    v_pk_fma_f32 v[28:29], v[28:29], s[44:45], s[44:45] op_sel:[0,0,1] op_sel_hi:[1,0,1]
    v_pk_fma_f32 v[30:31], v[30:31], s[44:45], s[44:45] op_sel:[0,0,1] op_sel_hi:[1,0,1]
    s_bfe_u32 s14, s20, 262164
    s_cbranch_scc0 L_p2_kernel_nof32b_25
    v_lshlrev_b32 v32, 1, v2
    s_bitcmp1_b32 s20, 20
    s_cbranch_scc0 L_p2_kernel_q_26
    s_lshl_b32 s15, s26, 1
    s_add_u32 s15, s15, 249069568
    buffer_load_dwordx4 v[88:91], v32, s[4:7], s15 offen sc1
    buffer_load_dwordx4 v[92:95], v32, s[4:7], s15 offen offset:16 sc1
    s_waitcnt vmcnt(0)
    v_add_f32 v24, v24, v88
    v_add_f32 v25, v25, v92
    v_add_f32 v26, v26, v89
    v_add_f32 v27, v27, v93
    v_add_f32 v28, v28, v90
    v_add_f32 v29, v29, v94
    v_add_f32 v30, v30, v91
    v_add_f32 v31, v31, v95
L_p2_kernel_q_26:
    s_bitcmp1_b32 s20, 21
    s_cbranch_scc0 L_p2_kernel_q_27
    s_lshl_b32 s15, s26, 1
    s_add_u32 s15, s15, 259309568
    buffer_load_dwordx4 v[88:91], v32, s[4:7], s15 offen sc1
    buffer_load_dwordx4 v[92:95], v32, s[4:7], s15 offen offset:16 sc1
    s_waitcnt vmcnt(0)
    v_add_f32 v24, v24, v88
    v_add_f32 v25, v25, v92
    v_add_f32 v26, v26, v89
    v_add_f32 v27, v27, v93
    v_add_f32 v28, v28, v90
    v_add_f32 v29, v29, v94
    v_add_f32 v30, v30, v91
    v_add_f32 v31, v31, v95
L_p2_kernel_q_27:
    s_bitcmp1_b32 s20, 22
    s_cbranch_scc0 L_p2_kernel_q_28
    s_lshl_b32 s15, s26, 1
    s_add_u32 s15, s15, 269549568
    buffer_load_dwordx4 v[88:91], v32, s[4:7], s15 offen sc1
    buffer_load_dwordx4 v[92:95], v32, s[4:7], s15 offen offset:16 sc1
    s_waitcnt vmcnt(0)
    v_add_f32 v24, v24, v88
    v_add_f32 v25, v25, v92
    v_add_f32 v26, v26, v89
    v_add_f32 v27, v27, v93
    v_add_f32 v28, v28, v90
    v_add_f32 v29, v29, v94
    v_add_f32 v30, v30, v91
    v_add_f32 v31, v31, v95
L_p2_kernel_q_28:
    s_bitcmp1_b32 s20, 23
    s_cbranch_scc0 L_p2_kernel_q_29
    s_lshl_b32 s15, s26, 1
    s_add_u32 s15, s15, 279789568
    buffer_load_dwordx4 v[88:91], v32, s[4:7], s15 offen sc1
    buffer_load_dwordx4 v[92:95], v32, s[4:7], s15 offen offset:16 sc1
    s_waitcnt vmcnt(0)
    v_add_f32 v24, v24, v88
    v_add_f32 v25, v25, v92
    v_add_f32 v26, v26, v89
    v_add_f32 v27, v27, v93
    v_add_f32 v28, v28, v90
    v_add_f32 v29, v29, v94
    v_add_f32 v30, v30, v91
    v_add_f32 v31, v31, v95
L_p2_kernel_q_29:
L_p2_kernel_nof32b_25:
    v_pk_mul_f32 v[88:89], v[24:25], s[84:85] op_sel:[0,0] op_sel_hi:[1,0]
    v_pk_mul_f32 v[90:91], v[24:25], s[84:85] op_sel:[0,1] op_sel_hi:[1,1]
    v_pk_mul_f32 v[92:93], v[24:25], s[86:87] op_sel:[0,0] op_sel_hi:[1,0]
    v_pk_mul_f32 v[94:95], v[24:25], s[86:87] op_sel:[0,1] op_sel_hi:[1,1]
    v_pk_fma_f32 v[88:89], v[26:27], s[88:89], v[88:89] op_sel:[0,0,0] op_sel_hi:[1,0,1]
    v_pk_fma_f32 v[90:91], v[26:27], s[88:89], v[90:91] op_sel:[0,1,0] op_sel_hi:[1,1,1]
    v_pk_fma_f32 v[92:93], v[26:27], s[90:91], v[92:93] op_sel:[0,0,0] op_sel_hi:[1,0,1]
    v_pk_fma_f32 v[94:95], v[26:27], s[90:91], v[94:95] op_sel:[0,1,0] op_sel_hi:[1,1,1]
    v_pk_fma_f32 v[88:89], v[28:29], s[92:93], v[88:89] op_sel:[0,0,0] op_sel_hi:[1,0,1]
    v_pk_fma_f32 v[90:91], v[28:29], s[92:93], v[90:91] op_sel:[0,1,0] op_sel_hi:[1,1,1]
    v_pk_fma_f32 v[92:93], v[28:29], s[94:95], v[92:93] op_sel:[0,0,0] op_sel_hi:[1,0,1]
    v_pk_fma_f32 v[94:95], v[28:29], s[94:95], v[94:95] op_sel:[0,1,0] op_sel_hi:[1,1,1]
    v_pk_fma_f32 v[88:89], v[30:31], s[96:97], v[88:89] op_sel:[0,0,0] op_sel_hi:[1,0,1]
    v_pk_fma_f32 v[90:91], v[30:31], s[96:97], v[90:91] op_sel:[0,1,0] op_sel_hi:[1,1,1]
    v_pk_fma_f32 v[92:93], v[30:31], s[98:99], v[92:93] op_sel:[0,0,0] op_sel_hi:[1,0,1]
    v_pk_fma_f32 v[94:95], v[30:31], s[98:99], v[94:95] op_sel:[0,1,0] op_sel_hi:[1,1,1]
    v_pk_mul_f32 v[88:89], v[88:89], v[112:113]
    v_pk_mul_f32 v[90:91], v[90:91], v[114:115]
    v_pk_mul_f32 v[92:93], v[92:93], v[116:117]
    v_pk_mul_f32 v[94:95], v[94:95], v[118:119]
    v_pk_mul_f32 v[24:25], v[88:89], s[28:29] op_sel:[0,0] op_sel_hi:[1,0]
    v_pk_mul_f32 v[26:27], v[88:89], s[28:29] op_sel:[0,1] op_sel_hi:[1,1]
    v_pk_mul_f32 v[28:29], v[88:89], s[30:31] op_sel:[0,0] op_sel_hi:[1,0]
    v_pk_mul_f32 v[30:31], v[88:89], s[30:31] op_sel:[0,1] op_sel_hi:[1,1]
    v_pk_fma_f32 v[24:25], v[90:91], s[32:33], v[24:25] op_sel:[0,0,0] op_sel_hi:[1,0,1]
    v_pk_fma_f32 v[26:27], v[90:91], s[32:33], v[26:27] op_sel:[0,1,0] op_sel_hi:[1,1,1]
    v_pk_fma_f32 v[28:29], v[90:91], s[34:35], v[28:29] op_sel:[0,0,0] op_sel_hi:[1,0,1]
    v_pk_fma_f32 v[30:31], v[90:91], s[34:35], v[30:31] op_sel:[0,1,0] op_sel_hi:[1,1,1]
    v_pk_fma_f32 v[24:25], v[92:93], s[36:37], v[24:25] op_sel:[0,0,0] op_sel_hi:[1,0,1]
    v_pk_fma_f32 v[26:27], v[92:93], s[36:37], v[26:27] op_sel:[0,1,0] op_sel_hi:[1,1,1]
    v_pk_fma_f32 v[28:29], v[92:93], s[38:39], v[28:29] op_sel:[0,0,0] op_sel_hi:[1,0,1]
    v_pk_fma_f32 v[30:31], v[92:93], s[38:39], v[30:31] op_sel:[0,1,0] op_sel_hi:[1,1,1]
    v_pk_fma_f32 v[24:25], v[94:95], s[40:41], v[24:25] op_sel:[0,0,0] op_sel_hi:[1,0,1]
    v_pk_fma_f32 v[26:27], v[94:95], s[40:41], v[26:27] op_sel:[0,1,0] op_sel_hi:[1,1,1]
    v_pk_fma_f32 v[28:29], v[94:95], s[42:43], v[28:29] op_sel:[0,0,0] op_sel_hi:[1,0,1]
    v_pk_fma_f32 v[30:31], v[94:95], s[42:43], v[30:31] op_sel:[0,1,0] op_sel_hi:[1,1,1]
    v_lshlrev_b32 v88, 16, v68
    v_and_b32 v90, 0xffff0000, v68
    v_lshlrev_b32 v92, 16, v69
    v_and_b32 v94, 0xffff0000, v69
    v_lshlrev_b32 v89, 16, v70
    v_and_b32 v91, 0xffff0000, v70
    v_lshlrev_b32 v93, 16, v71
    v_and_b32 v95, 0xffff0000, v71
    v_pk_fma_f32 v[88:89], v[24:25], v[120:121], v[88:89]
    v_pk_fma_f32 v[90:91], v[26:27], v[122:123], v[90:91]
    v_pk_fma_f32 v[92:93], v[28:29], v[124:125], v[92:93]
    v_pk_fma_f32 v[94:95], v[30:31], v[126:127], v[94:95]
    v_cvt_pk_bf16_f32 v96, v88, v90
    v_cvt_pk_bf16_f32 v97, v92, v94
    v_cvt_pk_bf16_f32 v98, v89, v91
    v_cvt_pk_bf16_f32 v99, v93, v95
    buffer_store_dwordx4 v[96:99], v2, s[16:19], s26 offen
L_p2_f1:
    s_bitset0_b32 s51, s49
    s_cmp_eq_u32 s51, 0
    s_cbranch_scc1 L_p2_done
    s_ff1_i32_b32 s49, s51
    s_lshl2_add_u32 s14, s3, s49
    s_mul_i32 s14, s14, 5000
    s_add_u32 s15, s14, 4096
    v_min_u32 v61, 225, v0
    v_lshl_add_u32 v60, v0, 2, s14
    v_lshl_add_u32 v61, v61, 2, s15
    global_load_dword v60, v60, s[100:101] nt
    global_load_dword v61, v61, s[100:101] nt
    s_waitcnt vmcnt(0)
    v_lshlrev_b32 v30, 16, v60
    v_and_b32 v31, 0xffff0000, v60
    v_lshlrev_b32 v36, 16, v53
    v_and_b32 v37, 0xffff0000, v53
    v_lshlrev_b32 v38, 16, v54
    v_and_b32 v39, 0xffff0000, v54
    v_lshlrev_b32 v40, 16, v56
    v_and_b32 v41, 0xffff0000, v56
    v_lshlrev_b32 v42, 16, v57
    v_and_b32 v43, 0xffff0000, v57
    v_pk_add_f32 v[14:15], v[30:31], v[36:37] op_sel:[0,0] op_sel_hi:[1,0] neg_lo:[0,1] neg_hi:[0,1]
    v_pk_add_f32 v[16:17], v[30:31], v[36:37] op_sel:[0,1] op_sel_hi:[1,1] neg_lo:[0,1] neg_hi:[0,1]
    v_pk_add_f32 v[18:19], v[30:31], v[38:39] op_sel:[0,0] op_sel_hi:[1,0] neg_lo:[0,1] neg_hi:[0,1]
    v_pk_add_f32 v[20:21], v[30:31], v[38:39] op_sel:[0,1] op_sel_hi:[1,1] neg_lo:[0,1] neg_hi:[0,1]
    v_pk_add_f32 v[22:23], v[30:31], v[40:41] op_sel:[0,0] op_sel_hi:[1,0] neg_lo:[0,1] neg_hi:[0,1]
    v_pk_add_f32 v[24:25], v[30:31], v[40:41] op_sel:[0,1] op_sel_hi:[1,1] neg_lo:[0,1] neg_hi:[0,1]
    v_pk_add_f32 v[26:27], v[30:31], v[42:43] op_sel:[0,0] op_sel_hi:[1,0] neg_lo:[0,1] neg_hi:[0,1]
    v_pk_add_f32 v[28:29], v[30:31], v[42:43] op_sel:[0,1] op_sel_hi:[1,1] neg_lo:[0,1] neg_hi:[0,1]
    v_cvt_pk_bf16_f32 v32, v14, v15
    v_lshlrev_b32 v14, 16, v32
    v_and_b32 v15, 0xffff0000, v32
    v_cvt_pk_bf16_f32 v32, v16, v17
    v_lshlrev_b32 v16, 16, v32
    v_and_b32 v17, 0xffff0000, v32
    v_cvt_pk_bf16_f32 v32, v18, v19
    v_lshlrev_b32 v18, 16, v32
    v_and_b32 v19, 0xffff0000, v32
    v_cvt_pk_bf16_f32 v32, v20, v21
    v_lshlrev_b32 v20, 16, v32
    v_and_b32 v21, 0xffff0000, v32
    v_cvt_pk_bf16_f32 v32, v22, v23
    v_lshlrev_b32 v22, 16, v32
    v_and_b32 v23, 0xffff0000, v32
    v_cvt_pk_bf16_f32 v32, v24, v25
    v_lshlrev_b32 v24, 16, v32
    v_and_b32 v25, 0xffff0000, v32
    v_cvt_pk_bf16_f32 v32, v26, v27
    v_lshlrev_b32 v26, 16, v32
    v_and_b32 v27, 0xffff0000, v32
    v_cvt_pk_bf16_f32 v32, v28, v29
    v_lshlrev_b32 v28, 16, v32
    v_and_b32 v29, 0xffff0000, v32
    v_pk_mul_f32 v[14:15], v[14:15], v[14:15]
    v_pk_mul_f32 v[16:17], v[16:17], v[16:17]
    v_pk_mul_f32 v[18:19], v[18:19], v[18:19]
    v_pk_mul_f32 v[20:21], v[20:21], v[20:21]
    v_pk_mul_f32 v[22:23], v[22:23], v[22:23]
    v_pk_mul_f32 v[24:25], v[24:25], v[24:25]
    v_pk_mul_f32 v[26:27], v[26:27], v[26:27]
    v_pk_mul_f32 v[28:29], v[28:29], v[28:29]
    v_cvt_pk_bf16_f32 v32, v14, v15
    v_lshlrev_b32 v14, 16, v32
    v_and_b32 v15, 0xffff0000, v32
    v_cvt_pk_bf16_f32 v32, v16, v17
    v_lshlrev_b32 v16, 16, v32
    v_and_b32 v17, 0xffff0000, v32
    v_cvt_pk_bf16_f32 v32, v18, v19
    v_lshlrev_b32 v18, 16, v32
    v_and_b32 v19, 0xffff0000, v32
    v_cvt_pk_bf16_f32 v32, v20, v21
    v_lshlrev_b32 v20, 16, v32
    v_and_b32 v21, 0xffff0000, v32
    v_cvt_pk_bf16_f32 v32, v22, v23
    v_lshlrev_b32 v22, 16, v32
    v_and_b32 v23, 0xffff0000, v32
    v_cvt_pk_bf16_f32 v32, v24, v25
    v_lshlrev_b32 v24, 16, v32
    v_and_b32 v25, 0xffff0000, v32
    v_cvt_pk_bf16_f32 v32, v26, v27
    v_lshlrev_b32 v26, 16, v32
    v_and_b32 v27, 0xffff0000, v32
    v_cvt_pk_bf16_f32 v32, v28, v29
    v_lshlrev_b32 v28, 16, v32
    v_and_b32 v29, 0xffff0000, v32
    v_mov_b32 v30, 1092616192
    v_mov_b32 v31, 0x3fb8aa3b
    v_pk_mul_f32 v[14:15], v[14:15], v[30:31] op_sel:[0,0] op_sel_hi:[1,0]
    v_pk_mul_f32 v[16:17], v[16:17], v[30:31] op_sel:[0,0] op_sel_hi:[1,0]
    v_pk_mul_f32 v[18:19], v[18:19], v[30:31] op_sel:[0,0] op_sel_hi:[1,0]
    v_pk_mul_f32 v[20:21], v[20:21], v[30:31] op_sel:[0,0] op_sel_hi:[1,0]
    v_pk_mul_f32 v[22:23], v[22:23], v[30:31] op_sel:[0,0] op_sel_hi:[1,0]
    v_pk_mul_f32 v[24:25], v[24:25], v[30:31] op_sel:[0,0] op_sel_hi:[1,0]
    v_pk_mul_f32 v[26:27], v[26:27], v[30:31] op_sel:[0,0] op_sel_hi:[1,0]
    v_pk_mul_f32 v[28:29], v[28:29], v[30:31] op_sel:[0,0] op_sel_hi:[1,0]
    v_cvt_pk_bf16_f32 v32, v14, v15
    v_lshlrev_b32 v14, 16, v32
    v_and_b32 v15, 0xffff0000, v32
    v_cvt_pk_bf16_f32 v32, v16, v17
    v_lshlrev_b32 v16, 16, v32
    v_and_b32 v17, 0xffff0000, v32
    v_cvt_pk_bf16_f32 v32, v18, v19
    v_lshlrev_b32 v18, 16, v32
    v_and_b32 v19, 0xffff0000, v32
    v_cvt_pk_bf16_f32 v32, v20, v21
    v_lshlrev_b32 v20, 16, v32
    v_and_b32 v21, 0xffff0000, v32
    v_cvt_pk_bf16_f32 v32, v22, v23
    v_lshlrev_b32 v22, 16, v32
    v_and_b32 v23, 0xffff0000, v32
    v_cvt_pk_bf16_f32 v32, v24, v25
    v_lshlrev_b32 v24, 16, v32
    v_and_b32 v25, 0xffff0000, v32
    v_cvt_pk_bf16_f32 v32, v26, v27
    v_lshlrev_b32 v26, 16, v32
    v_and_b32 v27, 0xffff0000, v32
    v_cvt_pk_bf16_f32 v32, v28, v29
    v_lshlrev_b32 v28, 16, v32
    v_and_b32 v29, 0xffff0000, v32
    v_pk_mul_f32 v[14:15], v[14:15], v[30:31] op_sel:[0,1] op_sel_hi:[1,1]
    v_pk_mul_f32 v[16:17], v[16:17], v[30:31] op_sel:[0,1] op_sel_hi:[1,1]
    v_pk_mul_f32 v[18:19], v[18:19], v[30:31] op_sel:[0,1] op_sel_hi:[1,1]
    v_pk_mul_f32 v[20:21], v[20:21], v[30:31] op_sel:[0,1] op_sel_hi:[1,1]
    v_pk_mul_f32 v[22:23], v[22:23], v[30:31] op_sel:[0,1] op_sel_hi:[1,1]
    v_pk_mul_f32 v[24:25], v[24:25], v[30:31] op_sel:[0,1] op_sel_hi:[1,1]
    v_pk_mul_f32 v[26:27], v[26:27], v[30:31] op_sel:[0,1] op_sel_hi:[1,1]
    v_pk_mul_f32 v[28:29], v[28:29], v[30:31] op_sel:[0,1] op_sel_hi:[1,1]
    v_exp_f32 v14, -v14
    v_exp_f32 v15, -v15
    v_exp_f32 v16, -v16
    v_exp_f32 v17, -v17
    v_exp_f32 v18, -v18
    v_exp_f32 v19, -v19
    v_exp_f32 v20, -v20
    v_exp_f32 v21, -v21
    v_exp_f32 v22, -v22
    v_exp_f32 v23, -v23
    v_exp_f32 v24, -v24
    v_exp_f32 v25, -v25
    v_exp_f32 v26, -v26
    v_exp_f32 v27, -v27
    v_exp_f32 v28, -v28
    v_exp_f32 v29, -v29
    v_cvt_pk_bf16_f32 v14, v14, v16
    v_cvt_pk_bf16_f32 v15, v15, v17
    v_cvt_pk_bf16_f32 v18, v18, v20
    v_cvt_pk_bf16_f32 v19, v19, v21
    v_cvt_pk_bf16_f32 v22, v22, v24
    v_cvt_pk_bf16_f32 v23, v23, v25
    v_cvt_pk_bf16_f32 v26, v26, v28
    v_cvt_pk_bf16_f32 v27, v27, v29
    v_dot2_f32_bf16 v72, v14, s68, 0
    v_dot2_f32_bf16 v73, v15, s68, 0
    v_dot2_f32_bf16 v74, v14, s69, 0
    v_dot2_f32_bf16 v75, v15, s69, 0
    v_dot2_f32_bf16 v76, v14, s70, 0
    v_dot2_f32_bf16 v77, v15, s70, 0
    v_dot2_f32_bf16 v78, v14, s71, 0
    v_dot2_f32_bf16 v79, v15, s71, 0
    v_dot2_f32_bf16 v80, v14, s52, 0
    v_dot2_f32_bf16 v81, v15, s52, 0
    v_dot2_f32_bf16 v82, v14, s53, 0
    v_dot2_f32_bf16 v83, v15, s53, 0
    v_dot2_f32_bf16 v84, v14, s54, 0
    v_dot2_f32_bf16 v85, v15, s54, 0
    v_dot2_f32_bf16 v86, v14, s55, 0
    v_dot2_f32_bf16 v87, v15, s55, 0
    v_dot2_f32_bf16 v72, v18, s72, v72
    v_dot2_f32_bf16 v73, v19, s72, v73
    v_dot2_f32_bf16 v74, v18, s73, v74
    v_dot2_f32_bf16 v75, v19, s73, v75
    v_dot2_f32_bf16 v76, v18, s74, v76
    v_dot2_f32_bf16 v77, v19, s74, v77
    v_dot2_f32_bf16 v78, v18, s75, v78
    v_dot2_f32_bf16 v79, v19, s75, v79
    v_dot2_f32_bf16 v80, v18, s56, v80
    v_dot2_f32_bf16 v81, v19, s56, v81
    v_dot2_f32_bf16 v82, v18, s57, v82
    v_dot2_f32_bf16 v83, v19, s57, v83
    v_dot2_f32_bf16 v84, v18, s58, v84
    v_dot2_f32_bf16 v85, v19, s58, v85
    v_dot2_f32_bf16 v86, v18, s59, v86
    v_dot2_f32_bf16 v87, v19, s59, v87
    v_dot2_f32_bf16 v72, v22, s76, v72
    v_dot2_f32_bf16 v73, v23, s76, v73
    v_dot2_f32_bf16 v74, v22, s77, v74
    v_dot2_f32_bf16 v75, v23, s77, v75
    v_dot2_f32_bf16 v76, v22, s78, v76
    v_dot2_f32_bf16 v77, v23, s78, v77
    v_dot2_f32_bf16 v78, v22, s79, v78
    v_dot2_f32_bf16 v79, v23, s79, v79
    v_dot2_f32_bf16 v80, v22, s60, v80
    v_dot2_f32_bf16 v81, v23, s60, v81
    v_dot2_f32_bf16 v82, v22, s61, v82
    v_dot2_f32_bf16 v83, v23, s61, v83
    v_dot2_f32_bf16 v84, v22, s62, v84
    v_dot2_f32_bf16 v85, v23, s62, v85
    v_dot2_f32_bf16 v86, v22, s63, v86
    v_dot2_f32_bf16 v87, v23, s63, v87
    v_dot2_f32_bf16 v72, v26, s80, v72
    v_dot2_f32_bf16 v73, v27, s80, v73
    v_dot2_f32_bf16 v74, v26, s81, v74
    v_dot2_f32_bf16 v75, v27, s81, v75
    v_dot2_f32_bf16 v76, v26, s82, v76
    v_dot2_f32_bf16 v77, v27, s82, v77
    v_dot2_f32_bf16 v78, v26, s83, v78
    v_dot2_f32_bf16 v79, v27, s83, v79
    v_dot2_f32_bf16 v80, v26, s64, v80
    v_dot2_f32_bf16 v81, v27, s64, v81
    v_dot2_f32_bf16 v82, v26, s65, v82
    v_dot2_f32_bf16 v83, v27, s65, v83
    v_dot2_f32_bf16 v84, v26, s66, v84
    v_dot2_f32_bf16 v85, v27, s66, v85
    v_dot2_f32_bf16 v86, v26, s67, v86
    v_dot2_f32_bf16 v87, v27, s67, v87
    s_cmp_ge_u32 s13, 4
    s_cbranch_scc1 L_p2_kernel_g1_30
    v_lshlrev_b32 v30, 16, v61
    v_and_b32 v31, 0xffff0000, v61
    v_pk_add_f32 v[14:15], v[30:31], v[36:37] op_sel:[0,0] op_sel_hi:[1,0] neg_lo:[0,1] neg_hi:[0,1]
    v_pk_add_f32 v[16:17], v[30:31], v[36:37] op_sel:[0,1] op_sel_hi:[1,1] neg_lo:[0,1] neg_hi:[0,1]
    v_pk_add_f32 v[18:19], v[30:31], v[38:39] op_sel:[0,0] op_sel_hi:[1,0] neg_lo:[0,1] neg_hi:[0,1]
    v_pk_add_f32 v[20:21], v[30:31], v[38:39] op_sel:[0,1] op_sel_hi:[1,1] neg_lo:[0,1] neg_hi:[0,1]
    v_pk_add_f32 v[22:23], v[30:31], v[40:41] op_sel:[0,0] op_sel_hi:[1,0] neg_lo:[0,1] neg_hi:[0,1]
    v_pk_add_f32 v[24:25], v[30:31], v[40:41] op_sel:[0,1] op_sel_hi:[1,1] neg_lo:[0,1] neg_hi:[0,1]
    v_pk_add_f32 v[26:27], v[30:31], v[42:43] op_sel:[0,0] op_sel_hi:[1,0] neg_lo:[0,1] neg_hi:[0,1]
    v_pk_add_f32 v[28:29], v[30:31], v[42:43] op_sel:[0,1] op_sel_hi:[1,1] neg_lo:[0,1] neg_hi:[0,1]
    v_cvt_pk_bf16_f32 v32, v14, v15
    v_lshlrev_b32 v14, 16, v32
    v_and_b32 v15, 0xffff0000, v32
    v_cvt_pk_bf16_f32 v32, v16, v17
    v_lshlrev_b32 v16, 16, v32
    v_and_b32 v17, 0xffff0000, v32
    v_cvt_pk_bf16_f32 v32, v18, v19
    v_lshlrev_b32 v18, 16, v32
    v_and_b32 v19, 0xffff0000, v32
    v_cvt_pk_bf16_f32 v32, v20, v21
    v_lshlrev_b32 v20, 16, v32
    v_and_b32 v21, 0xffff0000, v32
    v_cvt_pk_bf16_f32 v32, v22, v23
    v_lshlrev_b32 v22, 16, v32
    v_and_b32 v23, 0xffff0000, v32
    v_cvt_pk_bf16_f32 v32, v24, v25
    v_lshlrev_b32 v24, 16, v32
    v_and_b32 v25, 0xffff0000, v32
    v_cvt_pk_bf16_f32 v32, v26, v27
    v_lshlrev_b32 v26, 16, v32
    v_and_b32 v27, 0xffff0000, v32
    v_cvt_pk_bf16_f32 v32, v28, v29
    v_lshlrev_b32 v28, 16, v32
    v_and_b32 v29, 0xffff0000, v32
    v_pk_mul_f32 v[14:15], v[14:15], v[14:15]
    v_pk_mul_f32 v[16:17], v[16:17], v[16:17]
    v_pk_mul_f32 v[18:19], v[18:19], v[18:19]
    v_pk_mul_f32 v[20:21], v[20:21], v[20:21]
    v_pk_mul_f32 v[22:23], v[22:23], v[22:23]
    v_pk_mul_f32 v[24:25], v[24:25], v[24:25]
    v_pk_mul_f32 v[26:27], v[26:27], v[26:27]
    v_pk_mul_f32 v[28:29], v[28:29], v[28:29]
    v_cvt_pk_bf16_f32 v32, v14, v15
    v_lshlrev_b32 v14, 16, v32
    v_and_b32 v15, 0xffff0000, v32
    v_cvt_pk_bf16_f32 v32, v16, v17
    v_lshlrev_b32 v16, 16, v32
    v_and_b32 v17, 0xffff0000, v32
    v_cvt_pk_bf16_f32 v32, v18, v19
    v_lshlrev_b32 v18, 16, v32
    v_and_b32 v19, 0xffff0000, v32
    v_cvt_pk_bf16_f32 v32, v20, v21
    v_lshlrev_b32 v20, 16, v32
    v_and_b32 v21, 0xffff0000, v32
    v_cvt_pk_bf16_f32 v32, v22, v23
    v_lshlrev_b32 v22, 16, v32
    v_and_b32 v23, 0xffff0000, v32
    v_cvt_pk_bf16_f32 v32, v24, v25
    v_lshlrev_b32 v24, 16, v32
    v_and_b32 v25, 0xffff0000, v32
    v_cvt_pk_bf16_f32 v32, v26, v27
    v_lshlrev_b32 v26, 16, v32
    v_and_b32 v27, 0xffff0000, v32
    v_cvt_pk_bf16_f32 v32, v28, v29
    v_lshlrev_b32 v28, 16, v32
    v_and_b32 v29, 0xffff0000, v32
    v_mov_b32 v30, 1092616192
    v_mov_b32 v31, 0x3fb8aa3b
    v_pk_mul_f32 v[14:15], v[14:15], v[30:31] op_sel:[0,0] op_sel_hi:[1,0]
    v_pk_mul_f32 v[16:17], v[16:17], v[30:31] op_sel:[0,0] op_sel_hi:[1,0]
    v_pk_mul_f32 v[18:19], v[18:19], v[30:31] op_sel:[0,0] op_sel_hi:[1,0]
    v_pk_mul_f32 v[20:21], v[20:21], v[30:31] op_sel:[0,0] op_sel_hi:[1,0]
    v_pk_mul_f32 v[22:23], v[22:23], v[30:31] op_sel:[0,0] op_sel_hi:[1,0]
    v_pk_mul_f32 v[24:25], v[24:25], v[30:31] op_sel:[0,0] op_sel_hi:[1,0]
    v_pk_mul_f32 v[26:27], v[26:27], v[30:31] op_sel:[0,0] op_sel_hi:[1,0]
    v_pk_mul_f32 v[28:29], v[28:29], v[30:31] op_sel:[0,0] op_sel_hi:[1,0]
    v_cvt_pk_bf16_f32 v32, v14, v15
    v_lshlrev_b32 v14, 16, v32
    v_and_b32 v15, 0xffff0000, v32
    v_cvt_pk_bf16_f32 v32, v16, v17
    v_lshlrev_b32 v16, 16, v32
    v_and_b32 v17, 0xffff0000, v32
    v_cvt_pk_bf16_f32 v32, v18, v19
    v_lshlrev_b32 v18, 16, v32
    v_and_b32 v19, 0xffff0000, v32
    v_cvt_pk_bf16_f32 v32, v20, v21
    v_lshlrev_b32 v20, 16, v32
    v_and_b32 v21, 0xffff0000, v32
    v_cvt_pk_bf16_f32 v32, v22, v23
    v_lshlrev_b32 v22, 16, v32
    v_and_b32 v23, 0xffff0000, v32
    v_cvt_pk_bf16_f32 v32, v24, v25
    v_lshlrev_b32 v24, 16, v32
    v_and_b32 v25, 0xffff0000, v32
    v_cvt_pk_bf16_f32 v32, v26, v27
    v_lshlrev_b32 v26, 16, v32
    v_and_b32 v27, 0xffff0000, v32
    v_cvt_pk_bf16_f32 v32, v28, v29
    v_lshlrev_b32 v28, 16, v32
    v_and_b32 v29, 0xffff0000, v32
    v_pk_mul_f32 v[14:15], v[14:15], v[30:31] op_sel:[0,1] op_sel_hi:[1,1]
    v_pk_mul_f32 v[16:17], v[16:17], v[30:31] op_sel:[0,1] op_sel_hi:[1,1]
    v_pk_mul_f32 v[18:19], v[18:19], v[30:31] op_sel:[0,1] op_sel_hi:[1,1]
    v_pk_mul_f32 v[20:21], v[20:21], v[30:31] op_sel:[0,1] op_sel_hi:[1,1]
    v_pk_mul_f32 v[22:23], v[22:23], v[30:31] op_sel:[0,1] op_sel_hi:[1,1]
    v_pk_mul_f32 v[24:25], v[24:25], v[30:31] op_sel:[0,1] op_sel_hi:[1,1]
    v_pk_mul_f32 v[26:27], v[26:27], v[30:31] op_sel:[0,1] op_sel_hi:[1,1]
    v_pk_mul_f32 v[28:29], v[28:29], v[30:31] op_sel:[0,1] op_sel_hi:[1,1]
    v_exp_f32 v14, -v14
    v_exp_f32 v15, -v15
    v_exp_f32 v16, -v16
    v_exp_f32 v17, -v17
    v_exp_f32 v18, -v18
    v_exp_f32 v19, -v19
    v_exp_f32 v20, -v20
    v_exp_f32 v21, -v21
    v_exp_f32 v22, -v22
    v_exp_f32 v23, -v23
    v_exp_f32 v24, -v24
    v_exp_f32 v25, -v25
    v_exp_f32 v26, -v26
    v_exp_f32 v27, -v27
    v_exp_f32 v28, -v28
    v_exp_f32 v29, -v29
    v_cvt_pk_bf16_f32 v14, v14, v16
    v_cvt_pk_bf16_f32 v15, v15, v17
    v_cvt_pk_bf16_f32 v18, v18, v20
    v_cvt_pk_bf16_f32 v19, v19, v21
    v_cvt_pk_bf16_f32 v22, v22, v24
    v_cvt_pk_bf16_f32 v23, v23, v25
    v_cvt_pk_bf16_f32 v26, v26, v28
    v_cvt_pk_bf16_f32 v27, v27, v29
    v_dot2_f32_bf16 v112, v14, s68, 0
    v_dot2_f32_bf16 v113, v15, s68, 0
    v_dot2_f32_bf16 v114, v14, s69, 0
    v_dot2_f32_bf16 v115, v15, s69, 0
    v_dot2_f32_bf16 v116, v14, s70, 0
    v_dot2_f32_bf16 v117, v15, s70, 0
    v_dot2_f32_bf16 v118, v14, s71, 0
    v_dot2_f32_bf16 v119, v15, s71, 0
    v_dot2_f32_bf16 v120, v14, s52, 0
    v_dot2_f32_bf16 v121, v15, s52, 0
    v_dot2_f32_bf16 v122, v14, s53, 0
    v_dot2_f32_bf16 v123, v15, s53, 0
    v_dot2_f32_bf16 v124, v14, s54, 0
    v_dot2_f32_bf16 v125, v15, s54, 0
    v_dot2_f32_bf16 v126, v14, s55, 0
    v_dot2_f32_bf16 v127, v15, s55, 0
    v_dot2_f32_bf16 v112, v18, s72, v112
    v_dot2_f32_bf16 v113, v19, s72, v113
    v_dot2_f32_bf16 v114, v18, s73, v114
    v_dot2_f32_bf16 v115, v19, s73, v115
    v_dot2_f32_bf16 v116, v18, s74, v116
    v_dot2_f32_bf16 v117, v19, s74, v117
    v_dot2_f32_bf16 v118, v18, s75, v118
    v_dot2_f32_bf16 v119, v19, s75, v119
    v_dot2_f32_bf16 v120, v18, s56, v120
    v_dot2_f32_bf16 v121, v19, s56, v121
    v_dot2_f32_bf16 v122, v18, s57, v122
    v_dot2_f32_bf16 v123, v19, s57, v123
    v_dot2_f32_bf16 v124, v18, s58, v124
    v_dot2_f32_bf16 v125, v19, s58, v125
    v_dot2_f32_bf16 v126, v18, s59, v126
    v_dot2_f32_bf16 v127, v19, s59, v127
    v_dot2_f32_bf16 v112, v22, s76, v112
    v_dot2_f32_bf16 v113, v23, s76, v113
    v_dot2_f32_bf16 v114, v22, s77, v114
    v_dot2_f32_bf16 v115, v23, s77, v115
    v_dot2_f32_bf16 v116, v22, s78, v116
    v_dot2_f32_bf16 v117, v23, s78, v117
    v_dot2_f32_bf16 v118, v22, s79, v118
    v_dot2_f32_bf16 v119, v23, s79, v119
    v_dot2_f32_bf16 v120, v22, s60, v120
    v_dot2_f32_bf16 v121, v23, s60, v121
    v_dot2_f32_bf16 v122, v22, s61, v122
    v_dot2_f32_bf16 v123, v23, s61, v123
    v_dot2_f32_bf16 v124, v22, s62, v124
    v_dot2_f32_bf16 v125, v23, s62, v125
    v_dot2_f32_bf16 v126, v22, s63, v126
    v_dot2_f32_bf16 v127, v23, s63, v127
    v_dot2_f32_bf16 v112, v26, s80, v112
    v_dot2_f32_bf16 v113, v27, s80, v113
    v_dot2_f32_bf16 v114, v26, s81, v114
    v_dot2_f32_bf16 v115, v27, s81, v115
    v_dot2_f32_bf16 v116, v26, s82, v116
    v_dot2_f32_bf16 v117, v27, s82, v117
    v_dot2_f32_bf16 v118, v26, s83, v118
    v_dot2_f32_bf16 v119, v27, s83, v119
    v_dot2_f32_bf16 v120, v26, s64, v120
    v_dot2_f32_bf16 v121, v27, s64, v121
    v_dot2_f32_bf16 v122, v26, s65, v122
    v_dot2_f32_bf16 v123, v27, s65, v123
    v_dot2_f32_bf16 v124, v26, s66, v124
    v_dot2_f32_bf16 v125, v27, s66, v125
    v_dot2_f32_bf16 v126, v26, s67, v126
    v_dot2_f32_bf16 v127, v27, s67, v127
L_p2_kernel_g1_30:
    s_lshl2_add_u32 s14, s3, s49
    s_mul_i32 s26, s14, 20000
    s_mov_b32 s10, 5120000
    buffer_load_dwordx4 v[64:67], v1, s[8:11], s26 offen
    buffer_load_dwordx4 v[68:71], v2, s[8:11], s26 offen
    s_branch L_p2_fin
L_p2_done:
    s_branch L_p2_end
L_p2_slow:
    s_barrier
    v_mov_b32 v8, 0
    v_mov_b32 v9, 0
    v_mov_b32 v10, 0
    v_mov_b32 v11, 0
    v_mov_b32 v12, v1
    ds_write_b128 v12, v[8:11]
    v_add_u32 v12, 16384, v12
    ds_write_b128 v12, v[8:11]
    v_add_u32 v12, 16384, v12
    ds_write_b128 v12, v[8:11]
    v_add_u32 v12, 16384, v12
    ds_write_b128 v12, v[8:11]
    v_add_u32 v12, 16384, v12
    ds_write_b128 v12, v[8:11]
    v_add_u32 v12, 16384, v12
    ds_write_b128 v12, v[8:11]
    v_add_u32 v12, 16384, v12
    ds_write_b128 v12, v[8:11]
    v_add_u32 v12, 16384, v12
    ds_write_b128 v12, v[8:11]
    v_add_u32 v12, 16384, v12
    ds_write_b128 v12, v[8:11]
    v_add_u32 v12, 16384, v12
    ds_write_b128 v12, v[8:11]
    v_add_u32 v12, 16384, v12
    v_mul_u32_u24 v13, 8320, v0
    v_mov_b32 v29, 0x7fc00000
    v_add_u32 v28, 32, v13
    v_lshlrev_b32 v14, 10, v0
    v_add_u32 v14, 9437184, v14
    s_mul_i32 s25, s12, 65
    s_add_u32 s25, s25, s3
    s_lshl_b32 s25, s25, 5
    s_add_u32 s25, s25, 0
    s_lshl_b32 s50, s50, 1
    s_mul_i32 s22, s12, 1280000
    s_mov_b32 s24, 0
    s_waitcnt lgkmcnt(0)
    s_barrier
L_p2_sstep:
    buffer_load_ushort v15, v13, s[4:7], s25 offen
    buffer_load_ushort v16, v28, s[4:7], s25 offen
    s_waitcnt vmcnt(0)
L_p2_srec:
    v_cmp_lt_u32 vcc, v15, v16
    s_nop 1
    s_and_b64 exec, exec, vcc
    s_cbranch_execz L_p2_sdone
    v_mul_u32_u24 v17, 43691, v15
    v_lshrrev_b32 v17, 17, v17
    v_mad_i32_i24 v18, v17, -3, v15
    v_lshrrev_b32 v19, 6, v17
    v_lshl_add_u32 v19, v19, 20, v14
    v_and_b32 v17, 63, v17
    v_lshl_add_u32 v17, v17, 4, v19
    v_lshl_add_u32 v19, v18, 2, v17
    buffer_load_dword v20, v19, s[4:7], 0 offen
    buffer_load_dword v21, v17, s[4:7], 0 offen offset:12
    v_add_u32 v15, 1, v15
    v_mad_u32_u24 v18, v18, 10, 2
    s_waitcnt vmcnt(0)
    v_and_b32 v19, 0x3fff, v20
    v_lshlrev_b32 v19, 3, v19
    buffer_load_dwordx2 v[22:23], v19, s[8:11], s22 offen
    v_mad_u32_u16 v20, v20, 16, s50 op_sel:[1,0,0,0]
    v_bfe_i32 v21, v21, v18, 10
    v_cmp_eq_i32 vcc, -512, v21
    v_cvt_f32_i32 v21, v21
    v_mul_f32 v21, 989872160, v21
    v_cndmask_b32 v21, v21, v29, vcc
    s_waitcnt vmcnt(0)
    v_lshlrev_b32 v24, 16, v22
    v_and_b32 v25, 0xffff0000, v22
    v_lshlrev_b32 v26, 16, v23
    v_and_b32 v27, 0xffff0000, v23
    v_mul_f32 v24, v21, v24
    v_mul_f32 v25, v21, v25
    v_mul_f32 v26, v21, v26
    v_mul_f32 v27, v21, v27
    ds_add_f32 v20, v24
    ds_add_f32 v20, v25 offset:4
    ds_add_f32 v20, v26 offset:8
    ds_add_f32 v20, v27 offset:12
    s_branch L_p2_srec
L_p2_sdone:
    s_mov_b64 exec, -1
    s_add_u32 s25, s25, 2
    s_add_u32 s22, s22, 80000
    s_add_u32 s24, s24, 1
    s_cmp_lt_u32 s24, 16
    s_cbranch_scc1 L_p2_sstep
    s_waitcnt lgkmcnt(0)
    s_barrier
    s_mul_i32 s14, s12, 10240000
    s_mul_i32 s15, s3, 160000
    s_add_u32 s26, s14, s15
    s_add_u32 s26, s26, 249069568
    v_mov_b32 v12, v1
    s_mov_b32 s24, 0
L_p2_sout:
    v_cmp_gt_u32 vcc, 160000, v12
    ds_read_b128 v[8:11], v12
    s_nop 0
    s_and_b64 exec, exec, vcc
    s_cbranch_execz L_p2_sfin
    s_waitcnt lgkmcnt(0)
    buffer_store_dwordx4 v[8:11], v12, s[4:7], s26 offen sc1
    s_waitcnt vmcnt(0)
    v_add_u32 v12, 16384, v12
    s_branch L_p2_sout
L_p2_sfin:
    s_mov_b64 exec, -1
    s_waitcnt vmcnt(0) lgkmcnt(0)
    s_barrier
    s_branch L_p2_signal
L_p2_end:
    s_endpgm
.section .rodata,"a"
.p2align 6
.amdhsa_kernel p1_kernel
  .amdhsa_next_free_vgpr 128
  .amdhsa_next_free_sgpr 96
  .amdhsa_accum_offset 128
  .amdhsa_group_segment_fixed_size 0
  .amdhsa_kernarg_size 112
  .amdhsa_user_sgpr_count 2
  .amdhsa_user_sgpr_kernarg_segment_ptr 1
  .amdhsa_system_sgpr_workgroup_id_x 1
  .amdhsa_float_denorm_mode_32 0
.end_amdhsa_kernel
.p2align 6
.amdhsa_kernel p2_kernel
  .amdhsa_next_free_vgpr 128
  .amdhsa_next_free_sgpr 102
  .amdhsa_accum_offset 128
  .amdhsa_group_segment_fixed_size 0
  .amdhsa_kernarg_size 112
  .amdhsa_user_sgpr_count 2
  .amdhsa_user_sgpr_kernarg_segment_ptr 1
  .amdhsa_system_sgpr_workgroup_id_x 1
  .amdhsa_float_denorm_mode_32 0
.end_amdhsa_kernel
```

```asm
; @launch kernel=p1_kernel grid=(256,1,1) block=(1024,1,1) lds=163840
; @launch kernel=p2_kernel grid=(256,1,1) block=(1024,1,1) lds=163840
.amdgcn_target "amdgcn-amd-amdhsa--gfx950"
.text
.globl p1_kernel
.p2align 8
.type p1_kernel,@function
p1_kernel:
    s_cmp_ge_u32 s2, 256
    s_cbranch_scc1 L_p1_end
    s_load_dwordx2 s[4:5], s[0:1], 104
    s_load_dwordx2 s[8:9], s[0:1], 8
    s_load_dwordx2 s[12:13], s[0:1], 16
    s_load_dwordx2 s[16:17], s[0:1], 32
    s_load_dwordx2 s[28:29], s[0:1], 0
    s_load_dwordx2 s[6:7], s[0:1], 48
    v_cmp_gt_u32 vcc, 256, v0
    s_nop 1
    s_cbranch_vccz L_p1_nopf
    s_getpc_b64 s[72:73]
L_p1_kernel_pc_1:
    s_add_u32 s72, s72, L_p1_nopf-L_p1_kernel_pc_1
    s_addc_u32 s73, s73, 0
    v_lshlrev_b32 v14, 7, v0
    v_min_u32 v14, L_p2_end-L_p1_nopf, v14
    global_load_dword v15, v14, s[72:73]
L_p1_nopf:
    v_lshlrev_b32 v1, 4, v0
    v_lshlrev_b32 v2, 3, v0
    v_lshrrev_b32 v6, 6, v0
    v_mul_u32_u24 v3, 851904, v6
    v_add_lshl_u32 v3, v3, v0, 4
    v_mov_b32 v4, 1
    v_mov_b32 v5, 0
    v_readfirstlane_b32 s39, v6
    v_cmp_gt_u32 vcc, 784, v0
    s_and_b32 s51, s2, 7
    s_lshl_b32 s51, s51, 0
    s_bfe_u32 s35, s2, 3
    s_add_u32 s51, s51, s35
    s_and_b32 s35, s2, 248
    s_add_u32 s51, s51, s35
    s_and_b32 s32, s2, 7
    s_lshl_b32 s32, s32, 2
    s_bfe_u32 s35, s2, 131075
    s_add_u32 s32, s32, s35
    s_and_b32 s35, s2, 224
    s_add_u32 s32, s32, s35
    s_lshr_b32 s35, s39, 4
    s_mul_i32 s36, s35, 4177920
    s_lshl_b32 s33, s51, 14
    s_add_u32 s33, s33, s36
    s_lshr_b32 s34, s33, 1
    s_mul_i32 s48, s51, 3840
    s_cmp_ge_u32 s35, 0
    s_cselect_b32 s48, s48, 0
    s_lshr_b32 s49, s48, 1
    s_mov_b64 s[44:45], vcc
    s_waitcnt lgkmcnt(0)
    s_load_dword s3, s[6:7], 0
    s_mov_b32 s10, 163840000
    s_mov_b32 s11, 0x00020000
    s_mov_b32 s14, 163840000
    s_mov_b32 s15, 0x00020000
    s_mov_b32 s18, 81920000
    s_mov_b32 s19, 0x00020000
    s_mul_i32 s36, s2, 20000
    s_add_u32 s30, s36, 20000
    s_mov_b32 s31, 0x00020000
    s_add_u32 s35, s36, 16384
    buffer_load_dwordx4 v[48:51], v1, s[28:31], s36 offen
    buffer_load_dwordx4 v[52:55], v1, s[28:31], s35 offen
    s_add_u32 s35, s33, 0
    buffer_load_dwordx4 v[16:19], v1, s[8:11], s35 offen nt
    s_add_u32 s35, s33, 0
    buffer_load_dwordx4 v[20:23], v1, s[12:15], s35 offen nt
    s_add_u32 s35, s33, 4194304
    buffer_load_dwordx4 v[24:27], v1, s[8:11], s35 offen nt
    s_add_u32 s35, s33, 4194304
    buffer_load_dwordx4 v[28:31], v1, s[12:15], s35 offen nt
    s_add_u32 s35, s33, 8388608
    buffer_load_dwordx4 v[32:35], v1, s[8:11], s35 offen nt
    s_add_u32 s35, s33, 8388608
    buffer_load_dwordx4 v[36:39], v1, s[12:15], s35 offen nt
    s_add_u32 s35, s33, 12582912
    buffer_load_dwordx4 v[40:43], v1, s[8:11], s35 offen nt
    s_add_u32 s35, s33, 12582912
    buffer_load_dwordx4 v[44:47], v1, s[12:15], s35 offen nt
    s_add_u32 s35, s33, 16777216
    buffer_load_dwordx4 v[72:75], v1, s[8:11], s35 offen nt
    s_add_u32 s35, s33, 16777216
    buffer_load_dwordx4 v[76:79], v1, s[12:15], s35 offen nt
    s_mov_b32 s20, s4
    s_mov_b32 s21, s5
    s_mov_b32 s22, 0
    s_mov_b32 s23, 0x00020000
    s_add_u32 s24, s4, 0
    s_addc_u32 s25, s5, 0
    s_mov_b32 s26, 8540160
    s_mov_b32 s27, 0x00020000
    s_mov_b32 s37, 1492179184
    s_mov_b32 s55, 0
    s_mov_b32 s50, 21845
    s_mov_b32 s52, 0x8000
    s_mov_b32 s38, 262400
    s_mov_b32 s43, 0x05040100
    s_mov_b32 s40, 0
    v_mov_b32 v8, 0
    v_mov_b32 v9, 0
    v_mov_b32 v10, 0
    v_mov_b32 v11, 0
    ds_write_b128 v1, v[8:11] offset:0
    s_waitcnt lgkmcnt(0)
    s_lshl_b32 s3, s3, 16
    v_mov_b32 v12, s3
    v_mul_f32 v12, 0.15915494, v12
    s_nop 0
    v_readfirstlane_b32 s41, v12
    s_waitcnt vmcnt(10)
    v_mov_b32 v12, 0x3f803f80
    v_and_b32 v48, 0x7fff7fff, v48
    v_and_b32 v49, 0x7fff7fff, v49
    v_and_b32 v50, 0x7fff7fff, v50
    v_and_b32 v51, 0x7fff7fff, v51
    v_and_b32 v52, 0x7fff7fff, v52
    v_and_b32 v53, 0x7fff7fff, v53
    v_and_b32 v54, 0x7fff7fff, v54
    v_and_b32 v55, 0x7fff7fff, v55
    v_pk_max_u16 v8, v8, v48
    v_dot2c_f32_bf16 v9, v48, v12
    v_pk_max_u16 v8, v8, v49
    v_dot2c_f32_bf16 v9, v49, v12
    v_pk_max_u16 v8, v8, v50
    v_dot2c_f32_bf16 v9, v50, v12
    v_pk_max_u16 v8, v8, v51
    v_dot2c_f32_bf16 v9, v51, v12
    v_pk_max_u16 v8, v8, v52
    v_dot2c_f32_bf16 v9, v52, v12
    v_pk_max_u16 v8, v8, v53
    v_dot2c_f32_bf16 v9, v53, v12
    v_pk_max_u16 v8, v8, v54
    v_dot2c_f32_bf16 v9, v54, v12
    v_pk_max_u16 v8, v8, v55
    v_dot2c_f32_bf16 v9, v55, v12
    v_lshrrev_b32 v10, 16, v8
    v_and_b32 v8, 0xffff, v8
    v_max_u32 v8, v8, v10
    s_nop 0
    s_nop 1
    v_max_u32_dpp v8, v8, v8 row_shr:1 row_mask:0xf bank_mask:0xf bound_ctrl:0
    s_nop 1
    v_max_u32_dpp v8, v8, v8 row_shr:2 row_mask:0xf bank_mask:0xf bound_ctrl:0
    s_nop 1
    v_max_u32_dpp v8, v8, v8 row_shr:4 row_mask:0xf bank_mask:0xf bound_ctrl:0
    s_nop 1
    v_max_u32_dpp v8, v8, v8 row_shr:8 row_mask:0xf bank_mask:0xf bound_ctrl:0
    s_nop 1
    v_max_u32_dpp v8, v8, v8 row_bcast:15 row_mask:0xa bank_mask:0xf
    s_nop 1
    v_max_u32_dpp v8, v8, v8 row_bcast:31 row_mask:0xc bank_mask:0xf
    s_nop 1
    v_add_f32_dpp v9, v9, v9 row_shr:1 row_mask:0xf bank_mask:0xf bound_ctrl:0
    s_nop 1
    v_add_f32_dpp v9, v9, v9 row_shr:2 row_mask:0xf bank_mask:0xf bound_ctrl:0
    s_nop 1
    v_add_f32_dpp v9, v9, v9 row_shr:4 row_mask:0xf bank_mask:0xf bound_ctrl:0
    s_nop 1
    v_add_f32_dpp v9, v9, v9 row_shr:8 row_mask:0xf bank_mask:0xf bound_ctrl:0
    s_nop 1
    v_add_f32_dpp v9, v9, v9 row_bcast:15 row_mask:0xa bank_mask:0xf
    s_nop 1
    v_add_f32_dpp v9, v9, v9 row_bcast:31 row_mask:0xc bank_mask:0xf
    s_lshl_b32 s35, s39, 4
    s_add_u32 s35, s35, 160320
    v_mov_b32 v10, s35
    s_mov_b32 exec_lo, 0
    s_brev_b32 exec_hi, 1
    ds_write_b64 v10, v[8:9]
    s_mov_b64 exec, -1
    s_waitcnt lgkmcnt(0)
    s_barrier
    s_branch L_p1_first
L_p1_loop:
    s_getreg_b32 s51, hwreg(HW_REG_XCC_ID, 0, 1)
    s_cmp_eq_u32 s51, 0
    s_cselect_b64 vcc, -1, 0
    s_cmp_lg_u32 s39, 15
    s_cbranch_scc1 L_p1_kernel_nox_2
    s_waitcnt lgkmcnt(13)
    v_lshlrev_b32 v15, 16, v100
    v_and_b32 v100, 0xffff0000, v100
    v_lshlrev_b32 v101, 16, v101
    v_mul_f32 v15, s41, v15
    v_mul_f32 v100, s41, v100
    v_mul_f32 v101, s41, v101
    v_fract_f32 v15, v15
    v_fract_f32 v100, v100
    v_fract_f32 v101, v101
    v_cos_f32 v15, v15
    v_cos_f32 v100, v100
    v_cos_f32 v101, v101
    v_fmaak_f32 v15, v7, v15, 1262486016
    v_fmaak_f32 v100, v7, v100, 1262486016
    v_fmaak_f32 v101, v7, v101, 1262486016
    v_lshlrev_b32 v15, 22, v15
    v_alignbit_b32 v15, v100, v15, 10
    v_alignbit_b32 v15, v101, v15, 10
    v_xor_b32 v15, 0x80200800, v15
    s_mov_b32 s36, 13631488
    buffer_store_dwordx4 v[12:15], v3, s[20:23], s36 offen sc1
L_p1_kernel_nox_2:
    s_waitcnt lgkmcnt(12)
    v_lshlrev_b32 v75, 16, v102
    v_and_b32 v102, 0xffff0000, v102
    v_lshlrev_b32 v103, 16, v103
    v_mul_f32 v75, s41, v75
    v_mul_f32 v102, s41, v102
    v_mul_f32 v103, s41, v103
    v_fract_f32 v75, v75
    v_fract_f32 v102, v102
    v_fract_f32 v103, v103
    v_cos_f32 v75, v75
    v_cos_f32 v102, v102
    v_cos_f32 v103, v103
    v_fmaak_f32 v75, v7, v75, 1262486016
    v_fmaak_f32 v102, v7, v102, 1262486016
    v_fmaak_f32 v103, v7, v103, 1262486016
    v_lshlrev_b32 v75, 22, v75
    v_alignbit_b32 v75, v102, v75, 10
    v_alignbit_b32 v75, v103, v75, 10
    v_xor_b32 v75, 0x80200800, v75
    s_mov_b32 s36, 0
    buffer_store_dwordx4 v[72:75], v3, s[20:23], s36 offen sc1
    s_waitcnt lgkmcnt(11)
    v_lshlrev_b32 v79, 16, v104
    v_and_b32 v104, 0xffff0000, v104
    v_lshlrev_b32 v105, 16, v105
    v_mul_f32 v79, s41, v79
    v_mul_f32 v104, s41, v104
    v_mul_f32 v105, s41, v105
    v_fract_f32 v79, v79
    v_fract_f32 v104, v104
    v_fract_f32 v105, v105
    v_cos_f32 v79, v79
    v_cos_f32 v104, v104
    v_cos_f32 v105, v105
    v_fmaak_f32 v79, v7, v79, 1262486016
    v_fmaak_f32 v104, v7, v104, 1262486016
    v_fmaak_f32 v105, v7, v105, 1262486016
    v_lshlrev_b32 v79, 22, v79
    v_alignbit_b32 v79, v104, v79, 10
    v_alignbit_b32 v79, v105, v79, 10
    v_xor_b32 v79, 0x80200800, v79
    s_mov_b32 s36, 1048576
    buffer_store_dwordx4 v[76:79], v3, s[20:23], s36 offen sc1
    s_waitcnt lgkmcnt(10)
    v_lshlrev_b32 v51, 16, v106
    v_and_b32 v106, 0xffff0000, v106
    v_lshlrev_b32 v107, 16, v107
    v_mul_f32 v51, s41, v51
    v_mul_f32 v106, s41, v106
    v_mul_f32 v107, s41, v107
    v_fract_f32 v51, v51
    v_fract_f32 v106, v106
    v_fract_f32 v107, v107
    v_cos_f32 v51, v51
    v_cos_f32 v106, v106
    v_cos_f32 v107, v107
    v_fmaak_f32 v51, v7, v51, 1262486016
    v_fmaak_f32 v106, v7, v106, 1262486016
    v_fmaak_f32 v107, v7, v107, 1262486016
    v_lshlrev_b32 v51, 22, v51
    v_alignbit_b32 v51, v106, v51, 10
    v_alignbit_b32 v51, v107, v51, 10
    v_xor_b32 v51, 0x80200800, v51
    s_mov_b32 s36, 2097152
    buffer_store_dwordx4 v[48:51], v3, s[20:23], s36 offen sc1
    s_add_u32 s35, s33, 16777216
    buffer_load_dwordx4 v[72:75], v1, s[8:11], s35 offen nt
    s_add_u32 s35, s33, 16777216
    buffer_load_dwordx4 v[76:79], v1, s[12:15], s35 offen nt
    s_cbranch_vccz L_p1_kernel_thr_3
    s_waitcnt vmcnt(2)
L_p1_kernel_thr_3:
    s_waitcnt lgkmcnt(9)
    v_lshlrev_b32 v83, 16, v108
    v_and_b32 v108, 0xffff0000, v108
    v_lshlrev_b32 v109, 16, v109
    v_mul_f32 v83, s41, v83
    v_mul_f32 v108, s41, v108
    v_mul_f32 v109, s41, v109
    v_fract_f32 v83, v83
    v_fract_f32 v108, v108
    v_fract_f32 v109, v109
    v_cos_f32 v83, v83
    v_cos_f32 v108, v108
    v_cos_f32 v109, v109
    v_fmaak_f32 v83, v7, v83, 1262486016
    v_fmaak_f32 v108, v7, v108, 1262486016
    v_fmaak_f32 v109, v7, v109, 1262486016
    v_lshlrev_b32 v83, 22, v83
    v_alignbit_b32 v83, v108, v83, 10
    v_alignbit_b32 v83, v109, v83, 10
    v_xor_b32 v83, 0x80200800, v83
    s_mov_b32 s36, 3145728
    buffer_store_dwordx4 v[80:83], v3, s[20:23], s36 offen sc1
    s_waitcnt lgkmcnt(8)
    v_lshlrev_b32 v55, 16, v110
    v_and_b32 v110, 0xffff0000, v110
    v_lshlrev_b32 v111, 16, v111
    v_mul_f32 v55, s41, v55
    v_mul_f32 v110, s41, v110
    v_mul_f32 v111, s41, v111
    v_fract_f32 v55, v55
    v_fract_f32 v110, v110
    v_fract_f32 v111, v111
    v_cos_f32 v55, v55
    v_cos_f32 v110, v110
    v_cos_f32 v111, v111
    v_fmaak_f32 v55, v7, v55, 1262486016
    v_fmaak_f32 v110, v7, v110, 1262486016
    v_fmaak_f32 v111, v7, v111, 1262486016
    v_lshlrev_b32 v55, 22, v55
    v_alignbit_b32 v55, v110, v55, 10
    v_alignbit_b32 v55, v111, v55, 10
    v_xor_b32 v55, 0x80200800, v55
    s_mov_b32 s36, 4194304
    buffer_store_dwordx4 v[52:55], v3, s[20:23], s36 offen sc1
    s_add_u32 s35, s33, 20971520
    buffer_load_dwordx4 v[80:83], v1, s[8:11], s35 offen nt
    s_add_u32 s35, s33, 20971520
    buffer_load_dwordx4 v[100:103], v1, s[12:15], s35 offen nt
    s_cbranch_vccz L_p1_kernel_thr_4
    s_waitcnt vmcnt(2)
L_p1_kernel_thr_4:
    s_waitcnt lgkmcnt(7)
    v_lshlrev_b32 v87, 16, v112
    v_and_b32 v112, 0xffff0000, v112
    v_lshlrev_b32 v113, 16, v113
    v_mul_f32 v87, s41, v87
    v_mul_f32 v112, s41, v112
    v_mul_f32 v113, s41, v113
    v_fract_f32 v87, v87
    v_fract_f32 v112, v112
    v_fract_f32 v113, v113
    v_cos_f32 v87, v87
    v_cos_f32 v112, v112
    v_cos_f32 v113, v113
    v_fmaak_f32 v87, v7, v87, 1262486016
    v_fmaak_f32 v112, v7, v112, 1262486016
    v_fmaak_f32 v113, v7, v113, 1262486016
    v_lshlrev_b32 v87, 22, v87
    v_alignbit_b32 v87, v112, v87, 10
    v_alignbit_b32 v87, v113, v87, 10
    v_xor_b32 v87, 0x80200800, v87
    s_mov_b32 s36, 5242880
    buffer_store_dwordx4 v[84:87], v3, s[20:23], s36 offen sc1
    s_waitcnt lgkmcnt(6)
    v_lshlrev_b32 v59, 16, v114
    v_and_b32 v114, 0xffff0000, v114
    v_lshlrev_b32 v115, 16, v115
    v_mul_f32 v59, s41, v59
    v_mul_f32 v114, s41, v114
    v_mul_f32 v115, s41, v115
    v_fract_f32 v59, v59
    v_fract_f32 v114, v114
    v_fract_f32 v115, v115
    v_cos_f32 v59, v59
    v_cos_f32 v114, v114
    v_cos_f32 v115, v115
    v_fmaak_f32 v59, v7, v59, 1262486016
    v_fmaak_f32 v114, v7, v114, 1262486016
    v_fmaak_f32 v115, v7, v115, 1262486016
    v_lshlrev_b32 v59, 22, v59
    v_alignbit_b32 v59, v114, v59, 10
    v_alignbit_b32 v59, v115, v59, 10
    v_xor_b32 v59, 0x80200800, v59
    s_mov_b32 s36, 6291456
    buffer_store_dwordx4 v[56:59], v3, s[20:23], s36 offen sc1
    s_add_u32 s35, s33, 25165824
    buffer_load_dwordx4 v[84:87], v1, s[8:11], s35 offen nt
    s_add_u32 s35, s33, 25165824
    buffer_load_dwordx4 v[104:107], v1, s[12:15], s35 offen nt
    s_cbranch_vccz L_p1_kernel_thr_5
    s_waitcnt vmcnt(2)
L_p1_kernel_thr_5:
    s_waitcnt lgkmcnt(5)
    v_lshlrev_b32 v91, 16, v116
    v_and_b32 v116, 0xffff0000, v116
    v_lshlrev_b32 v117, 16, v117
    v_mul_f32 v91, s41, v91
    v_mul_f32 v116, s41, v116
    v_mul_f32 v117, s41, v117
    v_fract_f32 v91, v91
    v_fract_f32 v116, v116
    v_fract_f32 v117, v117
    v_cos_f32 v91, v91
    v_cos_f32 v116, v116
    v_cos_f32 v117, v117
    v_fmaak_f32 v91, v7, v91, 1262486016
    v_fmaak_f32 v116, v7, v116, 1262486016
    v_fmaak_f32 v117, v7, v117, 1262486016
    v_lshlrev_b32 v91, 22, v91
    v_alignbit_b32 v91, v116, v91, 10
    v_alignbit_b32 v91, v117, v91, 10
    v_xor_b32 v91, 0x80200800, v91
    s_mov_b32 s36, 7340032
    buffer_store_dwordx4 v[88:91], v3, s[20:23], s36 offen sc1
    s_waitcnt lgkmcnt(4)
    v_lshlrev_b32 v63, 16, v118
    v_and_b32 v118, 0xffff0000, v118
    v_lshlrev_b32 v119, 16, v119
    v_mul_f32 v63, s41, v63
    v_mul_f32 v118, s41, v118
    v_mul_f32 v119, s41, v119
    v_fract_f32 v63, v63
    v_fract_f32 v118, v118
    v_fract_f32 v119, v119
    v_cos_f32 v63, v63
    v_cos_f32 v118, v118
    v_cos_f32 v119, v119
    v_fmaak_f32 v63, v7, v63, 1262486016
    v_fmaak_f32 v118, v7, v118, 1262486016
    v_fmaak_f32 v119, v7, v119, 1262486016
    v_lshlrev_b32 v63, 22, v63
    v_alignbit_b32 v63, v118, v63, 10
    v_alignbit_b32 v63, v119, v63, 10
    v_xor_b32 v63, 0x80200800, v63
    s_mov_b32 s36, 8388608
    buffer_store_dwordx4 v[60:63], v3, s[20:23], s36 offen sc1
    s_add_u32 s35, s33, 29360128
    buffer_load_dwordx4 v[88:91], v1, s[8:11], s35 offen nt
    s_add_u32 s35, s33, 29360128
    buffer_load_dwordx4 v[108:111], v1, s[12:15], s35 offen nt
    s_cbranch_vccz L_p1_kernel_thr_6
    s_waitcnt vmcnt(2)
L_p1_kernel_thr_6:
    s_waitcnt lgkmcnt(3)
    v_lshlrev_b32 v95, 16, v120
    v_and_b32 v120, 0xffff0000, v120
    v_lshlrev_b32 v121, 16, v121
    v_mul_f32 v95, s41, v95
    v_mul_f32 v120, s41, v120
    v_mul_f32 v121, s41, v121
    v_fract_f32 v95, v95
    v_fract_f32 v120, v120
    v_fract_f32 v121, v121
    v_cos_f32 v95, v95
    v_cos_f32 v120, v120
    v_cos_f32 v121, v121
    v_fmaak_f32 v95, v7, v95, 1262486016
    v_fmaak_f32 v120, v7, v120, 1262486016
    v_fmaak_f32 v121, v7, v121, 1262486016
    v_lshlrev_b32 v95, 22, v95
    v_alignbit_b32 v95, v120, v95, 10
    v_alignbit_b32 v95, v121, v95, 10
    v_xor_b32 v95, 0x80200800, v95
    s_mov_b32 s36, 9437184
    buffer_store_dwordx4 v[92:95], v3, s[20:23], s36 offen sc1
    s_waitcnt lgkmcnt(2)
    v_lshlrev_b32 v67, 16, v122
    v_and_b32 v122, 0xffff0000, v122
    v_lshlrev_b32 v123, 16, v123
    v_mul_f32 v67, s41, v67
    v_mul_f32 v122, s41, v122
    v_mul_f32 v123, s41, v123
    v_fract_f32 v67, v67
    v_fract_f32 v122, v122
    v_fract_f32 v123, v123
    v_cos_f32 v67, v67
    v_cos_f32 v122, v122
    v_cos_f32 v123, v123
    v_fmaak_f32 v67, v7, v67, 1262486016
    v_fmaak_f32 v122, v7, v122, 1262486016
    v_fmaak_f32 v123, v7, v123, 1262486016
    v_lshlrev_b32 v67, 22, v67
    v_alignbit_b32 v67, v122, v67, 10
    v_alignbit_b32 v67, v123, v67, 10
    v_xor_b32 v67, 0x80200800, v67
    s_mov_b32 s36, 10485760
    buffer_store_dwordx4 v[64:67], v3, s[20:23], s36 offen sc1
    s_add_u32 s35, s33, 33554432
    buffer_load_dwordx4 v[92:95], v1, s[8:11], s35 offen nt
    s_add_u32 s35, s33, 33554432
    buffer_load_dwordx4 v[112:115], v1, s[12:15], s35 offen nt
    s_cbranch_vccz L_p1_kernel_thr_7
    s_waitcnt vmcnt(2)
L_p1_kernel_thr_7:
    s_waitcnt lgkmcnt(1)
    v_lshlrev_b32 v99, 16, v124
    v_and_b32 v124, 0xffff0000, v124
    v_lshlrev_b32 v125, 16, v125
    v_mul_f32 v99, s41, v99
    v_mul_f32 v124, s41, v124
    v_mul_f32 v125, s41, v125
    v_fract_f32 v99, v99
    v_fract_f32 v124, v124
    v_fract_f32 v125, v125
    v_cos_f32 v99, v99
    v_cos_f32 v124, v124
    v_cos_f32 v125, v125
    v_fmaak_f32 v99, v7, v99, 1262486016
    v_fmaak_f32 v124, v7, v124, 1262486016
    v_fmaak_f32 v125, v7, v125, 1262486016
    v_lshlrev_b32 v99, 22, v99
    v_alignbit_b32 v99, v124, v99, 10
    v_alignbit_b32 v99, v125, v99, 10
    v_xor_b32 v99, 0x80200800, v99
    s_mov_b32 s36, 11534336
    buffer_store_dwordx4 v[96:99], v3, s[20:23], s36 offen sc1
    s_waitcnt lgkmcnt(0)
    v_lshlrev_b32 v71, 16, v126
    v_and_b32 v126, 0xffff0000, v126
    v_lshlrev_b32 v127, 16, v127
    v_mul_f32 v71, s41, v71
    v_mul_f32 v126, s41, v126
    v_mul_f32 v127, s41, v127
    v_fract_f32 v71, v71
    v_fract_f32 v126, v126
    v_fract_f32 v127, v127
    v_cos_f32 v71, v71
    v_cos_f32 v126, v126
    v_cos_f32 v127, v127
    v_fmaak_f32 v71, v7, v71, 1262486016
    v_fmaak_f32 v126, v7, v126, 1262486016
    v_fmaak_f32 v127, v7, v127, 1262486016
    v_lshlrev_b32 v71, 22, v71
    v_alignbit_b32 v71, v126, v71, 10
    v_alignbit_b32 v71, v127, v71, 10
    v_xor_b32 v71, 0x80200800, v71
    s_mov_b32 s36, 12582912
    buffer_store_dwordx4 v[68:71], v3, s[20:23], s36 offen sc1
    s_add_u32 s35, s33, 37748736
    s_sub_u32 s35, s35, s48
    v_cndmask_b32 v96, 2.0, v1, s[44:45]
    buffer_load_dwordx4 v[96:99], v96, s[8:11], s35 offen nt
    s_add_u32 s35, s33, 37748736
    s_sub_u32 s35, s35, s48
    v_cndmask_b32 v116, 2.0, v1, s[44:45]
    buffer_load_dwordx4 v[116:119], v116, s[12:15], s35 offen nt
    s_cbranch_vccz L_p1_kernel_thr_8
    s_waitcnt vmcnt(2)
L_p1_kernel_thr_8:
    s_branch L_p1_join
L_p1_first:
    s_add_u32 s35, s33, 20971520
    buffer_load_dwordx4 v[80:83], v1, s[8:11], s35 offen nt
    s_add_u32 s35, s33, 20971520
    buffer_load_dwordx4 v[100:103], v1, s[12:15], s35 offen nt
    s_add_u32 s35, s33, 25165824
    buffer_load_dwordx4 v[84:87], v1, s[8:11], s35 offen nt
    s_add_u32 s35, s33, 25165824
    buffer_load_dwordx4 v[104:107], v1, s[12:15], s35 offen nt
    s_add_u32 s35, s33, 29360128
    buffer_load_dwordx4 v[88:91], v1, s[8:11], s35 offen nt
    s_add_u32 s35, s33, 29360128
    buffer_load_dwordx4 v[108:111], v1, s[12:15], s35 offen nt
    s_add_u32 s35, s33, 33554432
    buffer_load_dwordx4 v[92:95], v1, s[8:11], s35 offen nt
    s_add_u32 s35, s33, 33554432
    buffer_load_dwordx4 v[112:115], v1, s[12:15], s35 offen nt
    s_add_u32 s35, s33, 37748736
    s_sub_u32 s35, s35, s48
    v_cndmask_b32 v96, 2.0, v1, s[44:45]
    buffer_load_dwordx4 v[96:99], v96, s[8:11], s35 offen nt
    s_add_u32 s35, s33, 37748736
    s_sub_u32 s35, s35, s48
    v_cndmask_b32 v116, 2.0, v1, s[44:45]
    buffer_load_dwordx4 v[116:119], v116, s[12:15], s35 offen nt
L_p1_join:
    s_waitcnt vmcnt(18)
    v_perm_b32 v6, v20, v16, s43
    v_perm_b32 v7, v21, v17, s43
    v_perm_b32 v8, v22, v18, s43
    v_perm_b32 v9, v23, v19, s43
    v_mul_hi_u32_u24 v16, 429497, v16
    v_mul_hi_u32_u24 v20, 429497, v20
    v_mul_hi_u32_u24 v17, 429497, v17
    v_mul_hi_u32_u24 v21, 429497, v21
    v_mul_hi_u32_u24 v18, 429497, v18
    v_mul_hi_u32_u24 v22, 429497, v22
    v_mul_hi_u32_u24 v19, 429497, v19
    v_mul_hi_u32_u24 v23, 429497, v23
    v_lshl_or_b32 v16, v20, 16, v16
    v_lshl_or_b32 v17, v21, 16, v17
    v_lshl_or_b32 v18, v22, 16, v18
    v_lshl_or_b32 v19, v23, 16, v19
    v_dot2_u32_u16 v20, v16, s38, 0
    v_dot2_u32_u16 v21, v17, s38, 0
    v_dot2_u32_u16 v22, v18, s38, 0
    v_dot2_u32_u16 v23, v19, s38, 0
    v_pk_mad_u16 v6, v16, s37, v6
    v_pk_mad_u16 v7, v17, s37, v7
    v_pk_mad_u16 v8, v18, s37, v8
    v_pk_mad_u16 v9, v19, s37, v9
    ds_add_u32 v20, v4 offset:0
    ds_add_u32 v21, v4 offset:0
    ds_add_u32 v22, v4 offset:0
    ds_add_u32 v23, v4 offset:0
    v_pk_mad_u16 v6, v16, s52, v6 op_sel:[1,0,0] op_sel_hi:[1,1,1]
    v_pk_mad_u16 v7, v17, s52, v7 op_sel:[1,0,0] op_sel_hi:[1,1,1]
    v_pk_mad_u16 v8, v18, s52, v8 op_sel:[1,0,0] op_sel_hi:[1,1,1]
    v_pk_mad_u16 v9, v19, s52, v9 op_sel:[1,0,0] op_sel_hi:[1,1,1]
    v_perm_b32 v55, v23, v22, s43
    v_perm_b32 v51, v21, v20, s43
    v_or_b32 v48, 0x40000000, v6
    v_or_b32 v49, 0x40000000, v7
    v_or_b32 v50, 0x40000000, v8
    v_or_b32 v52, 0x40000000, v9
    s_waitcnt vmcnt(16)
    v_perm_b32 v6, v28, v24, s43
    v_perm_b32 v7, v29, v25, s43
    v_perm_b32 v8, v30, v26, s43
    v_perm_b32 v9, v31, v27, s43
    v_mul_hi_u32_u24 v24, 429497, v24
    v_mul_hi_u32_u24 v28, 429497, v28
    v_mul_hi_u32_u24 v25, 429497, v25
    v_mul_hi_u32_u24 v29, 429497, v29
    v_mul_hi_u32_u24 v26, 429497, v26
    v_mul_hi_u32_u24 v30, 429497, v30
    v_mul_hi_u32_u24 v27, 429497, v27
    v_mul_hi_u32_u24 v31, 429497, v31
    v_lshl_or_b32 v24, v28, 16, v24
    v_lshl_or_b32 v25, v29, 16, v25
    v_lshl_or_b32 v26, v30, 16, v26
    v_lshl_or_b32 v27, v31, 16, v27
    v_dot2_u32_u16 v28, v24, s38, 0
    v_dot2_u32_u16 v29, v25, s38, 0
    v_dot2_u32_u16 v30, v26, s38, 0
    v_dot2_u32_u16 v31, v27, s38, 0
    v_pk_mad_u16 v6, v24, s37, v6
    v_pk_mad_u16 v7, v25, s37, v7
    v_pk_mad_u16 v8, v26, s37, v8
    v_pk_mad_u16 v9, v27, s37, v9
    ds_add_u32 v28, v4 offset:0
    ds_add_u32 v29, v4 offset:0
    ds_add_u32 v30, v4 offset:0
    ds_add_u32 v31, v4 offset:0
    v_pk_mad_u16 v6, v24, s52, v6 op_sel:[1,0,0] op_sel_hi:[1,1,1]
    v_pk_mad_u16 v7, v25, s52, v7 op_sel:[1,0,0] op_sel_hi:[1,1,1]
    v_pk_mad_u16 v8, v26, s52, v8 op_sel:[1,0,0] op_sel_hi:[1,1,1]
    v_pk_mad_u16 v9, v27, s52, v9 op_sel:[1,0,0] op_sel_hi:[1,1,1]
    v_perm_b32 v63, v31, v30, s43
    v_perm_b32 v59, v29, v28, s43
    v_or_b32 v53, 0x40000000, v6
    v_or_b32 v54, 0x40000000, v7
    v_or_b32 v56, 0x40000000, v8
    v_or_b32 v57, 0x40000000, v9
    s_waitcnt vmcnt(14)
    v_perm_b32 v6, v36, v32, s43
    v_perm_b32 v7, v37, v33, s43
    v_perm_b32 v8, v38, v34, s43
    v_perm_b32 v9, v39, v35, s43
    v_mul_hi_u32_u24 v32, 429497, v32
    v_mul_hi_u32_u24 v36, 429497, v36
    v_mul_hi_u32_u24 v33, 429497, v33
    v_mul_hi_u32_u24 v37, 429497, v37
    v_mul_hi_u32_u24 v34, 429497, v34
    v_mul_hi_u32_u24 v38, 429497, v38
    v_mul_hi_u32_u24 v35, 429497, v35
    v_mul_hi_u32_u24 v39, 429497, v39
    v_lshl_or_b32 v32, v36, 16, v32
    v_lshl_or_b32 v33, v37, 16, v33
    v_lshl_or_b32 v34, v38, 16, v34
    v_lshl_or_b32 v35, v39, 16, v35
    v_dot2_u32_u16 v36, v32, s38, 0
    v_dot2_u32_u16 v37, v33, s38, 0
    v_dot2_u32_u16 v38, v34, s38, 0
    v_dot2_u32_u16 v39, v35, s38, 0
    v_pk_mad_u16 v6, v32, s37, v6
    v_pk_mad_u16 v7, v33, s37, v7
    v_pk_mad_u16 v8, v34, s37, v8
    v_pk_mad_u16 v9, v35, s37, v9
    ds_add_u32 v36, v4 offset:0
    ds_add_u32 v37, v4 offset:0
    ds_add_u32 v38, v4 offset:0
    ds_add_u32 v39, v4 offset:0
    v_pk_mad_u16 v6, v32, s52, v6 op_sel:[1,0,0] op_sel_hi:[1,1,1]
    v_pk_mad_u16 v7, v33, s52, v7 op_sel:[1,0,0] op_sel_hi:[1,1,1]
    v_pk_mad_u16 v8, v34, s52, v8 op_sel:[1,0,0] op_sel_hi:[1,1,1]
    v_pk_mad_u16 v9, v35, s52, v9 op_sel:[1,0,0] op_sel_hi:[1,1,1]
    v_perm_b32 v71, v39, v38, s43
    v_perm_b32 v67, v37, v36, s43
    v_or_b32 v58, 0x40000000, v6
    v_or_b32 v60, 0x40000000, v7
    v_or_b32 v61, 0x40000000, v8
    v_or_b32 v62, 0x40000000, v9
    s_waitcnt vmcnt(12)
    v_perm_b32 v6, v44, v40, s43
    v_perm_b32 v7, v45, v41, s43
    v_perm_b32 v8, v46, v42, s43
    v_perm_b32 v9, v47, v43, s43
    v_mul_hi_u32_u24 v40, 429497, v40
    v_mul_hi_u32_u24 v44, 429497, v44
    v_mul_hi_u32_u24 v41, 429497, v41
    v_mul_hi_u32_u24 v45, 429497, v45
    v_mul_hi_u32_u24 v42, 429497, v42
    v_mul_hi_u32_u24 v46, 429497, v46
    v_mul_hi_u32_u24 v43, 429497, v43
    v_mul_hi_u32_u24 v47, 429497, v47
    v_lshl_or_b32 v40, v44, 16, v40
    v_lshl_or_b32 v41, v45, 16, v41
    v_lshl_or_b32 v42, v46, 16, v42
    v_lshl_or_b32 v43, v47, 16, v43
    v_dot2_u32_u16 v44, v40, s38, 0
    v_dot2_u32_u16 v45, v41, s38, 0
    v_dot2_u32_u16 v46, v42, s38, 0
    v_dot2_u32_u16 v47, v43, s38, 0
    v_pk_mad_u16 v6, v40, s37, v6
    v_pk_mad_u16 v7, v41, s37, v7
    v_pk_mad_u16 v8, v42, s37, v8
    v_pk_mad_u16 v9, v43, s37, v9
    ds_add_u32 v44, v4 offset:0
    ds_add_u32 v45, v4 offset:0
    ds_add_u32 v46, v4 offset:0
    ds_add_u32 v47, v4 offset:0
    v_pk_mad_u16 v6, v40, s52, v6 op_sel:[1,0,0] op_sel_hi:[1,1,1]
    v_pk_mad_u16 v7, v41, s52, v7 op_sel:[1,0,0] op_sel_hi:[1,1,1]
    v_pk_mad_u16 v8, v42, s52, v8 op_sel:[1,0,0] op_sel_hi:[1,1,1]
    v_pk_mad_u16 v9, v43, s52, v9 op_sel:[1,0,0] op_sel_hi:[1,1,1]
    v_perm_b32 v121, v47, v46, s43
    v_perm_b32 v120, v45, v44, s43
    v_or_b32 v64, 0x40000000, v6
    v_or_b32 v65, 0x40000000, v7
    v_or_b32 v66, 0x40000000, v8
    v_or_b32 v68, 0x40000000, v9
    s_waitcnt vmcnt(10)
    v_perm_b32 v6, v76, v72, s43
    v_perm_b32 v7, v77, v73, s43
    v_perm_b32 v8, v78, v74, s43
    v_perm_b32 v9, v79, v75, s43
    v_mul_hi_u32_u24 v72, 429497, v72
    v_mul_hi_u32_u24 v76, 429497, v76
    v_mul_hi_u32_u24 v73, 429497, v73
    v_mul_hi_u32_u24 v77, 429497, v77
    v_mul_hi_u32_u24 v74, 429497, v74
    v_mul_hi_u32_u24 v78, 429497, v78
    v_mul_hi_u32_u24 v75, 429497, v75
    v_mul_hi_u32_u24 v79, 429497, v79
    v_lshl_or_b32 v72, v76, 16, v72
    v_lshl_or_b32 v73, v77, 16, v73
    v_lshl_or_b32 v74, v78, 16, v74
    v_lshl_or_b32 v75, v79, 16, v75
    v_dot2_u32_u16 v76, v72, s38, 0
    v_dot2_u32_u16 v77, v73, s38, 0
    v_dot2_u32_u16 v78, v74, s38, 0
    v_dot2_u32_u16 v79, v75, s38, 0
    v_pk_mad_u16 v6, v72, s37, v6
    v_pk_mad_u16 v7, v73, s37, v7
    v_pk_mad_u16 v8, v74, s37, v8
    v_pk_mad_u16 v9, v75, s37, v9
    ds_add_u32 v76, v4 offset:0
    ds_add_u32 v77, v4 offset:0
    ds_add_u32 v78, v4 offset:0
    ds_add_u32 v79, v4 offset:0
    v_pk_mad_u16 v6, v72, s52, v6 op_sel:[1,0,0] op_sel_hi:[1,1,1]
    v_pk_mad_u16 v7, v73, s52, v7 op_sel:[1,0,0] op_sel_hi:[1,1,1]
    v_pk_mad_u16 v8, v74, s52, v8 op_sel:[1,0,0] op_sel_hi:[1,1,1]
    v_pk_mad_u16 v9, v75, s52, v9 op_sel:[1,0,0] op_sel_hi:[1,1,1]
    v_perm_b32 v123, v79, v78, s43
    v_perm_b32 v122, v77, v76, s43
    v_or_b32 v69, 0x40000000, v6
    v_or_b32 v70, 0x40000000, v7
    v_or_b32 v127, 0x40000000, v8
    v_or_b32 v72, 0x40000000, v9
    s_waitcnt vmcnt(8)
    v_perm_b32 v6, v100, v80, s43
    v_perm_b32 v7, v101, v81, s43
    v_perm_b32 v8, v102, v82, s43
    v_perm_b32 v9, v103, v83, s43
    v_mul_hi_u32_u24 v80, 429497, v80
    v_mul_hi_u32_u24 v100, 429497, v100
    v_mul_hi_u32_u24 v81, 429497, v81
    v_mul_hi_u32_u24 v101, 429497, v101
    v_mul_hi_u32_u24 v82, 429497, v82
    v_mul_hi_u32_u24 v102, 429497, v102
    v_mul_hi_u32_u24 v83, 429497, v83
    v_mul_hi_u32_u24 v103, 429497, v103
    v_lshl_or_b32 v80, v100, 16, v80
    v_lshl_or_b32 v81, v101, 16, v81
    v_lshl_or_b32 v82, v102, 16, v82
    v_lshl_or_b32 v83, v103, 16, v83
    v_dot2_u32_u16 v100, v80, s38, 0
    v_dot2_u32_u16 v101, v81, s38, 0
    v_dot2_u32_u16 v102, v82, s38, 0
    v_dot2_u32_u16 v103, v83, s38, 0
    v_pk_mad_u16 v6, v80, s37, v6
    v_pk_mad_u16 v7, v81, s37, v7
    v_pk_mad_u16 v8, v82, s37, v8
    v_pk_mad_u16 v9, v83, s37, v9
    ds_add_u32 v100, v4 offset:0
    ds_add_u32 v101, v4 offset:0
    ds_add_u32 v102, v4 offset:0
    ds_add_u32 v103, v4 offset:0
    v_pk_mad_u16 v6, v80, s52, v6 op_sel:[1,0,0] op_sel_hi:[1,1,1]
    v_pk_mad_u16 v7, v81, s52, v7 op_sel:[1,0,0] op_sel_hi:[1,1,1]
    v_pk_mad_u16 v8, v82, s52, v8 op_sel:[1,0,0] op_sel_hi:[1,1,1]
    v_pk_mad_u16 v9, v83, s52, v9 op_sel:[1,0,0] op_sel_hi:[1,1,1]
    v_perm_b32 v125, v103, v102, s43
    v_perm_b32 v124, v101, v100, s43
    v_or_b32 v73, 0x40000000, v6
    v_or_b32 v74, 0x40000000, v7
    v_or_b32 v76, 0x40000000, v8
    v_or_b32 v77, 0x40000000, v9
    s_waitcnt vmcnt(6)
    v_perm_b32 v6, v104, v84, s43
    v_perm_b32 v7, v105, v85, s43
    v_perm_b32 v8, v106, v86, s43
    v_perm_b32 v9, v107, v87, s43
    v_mul_hi_u32_u24 v84, 429497, v84
    v_mul_hi_u32_u24 v104, 429497, v104
    v_mul_hi_u32_u24 v85, 429497, v85
    v_mul_hi_u32_u24 v105, 429497, v105
    v_mul_hi_u32_u24 v86, 429497, v86
    v_mul_hi_u32_u24 v106, 429497, v106
    v_mul_hi_u32_u24 v87, 429497, v87
    v_mul_hi_u32_u24 v107, 429497, v107
    v_lshl_or_b32 v84, v104, 16, v84
    v_lshl_or_b32 v85, v105, 16, v85
    v_lshl_or_b32 v86, v106, 16, v86
    v_lshl_or_b32 v87, v107, 16, v87
    v_dot2_u32_u16 v104, v84, s38, 0
    v_dot2_u32_u16 v105, v85, s38, 0
    v_dot2_u32_u16 v106, v86, s38, 0
    v_dot2_u32_u16 v107, v87, s38, 0
    v_pk_mad_u16 v6, v84, s37, v6
    v_pk_mad_u16 v7, v85, s37, v7
    v_pk_mad_u16 v8, v86, s37, v8
    v_pk_mad_u16 v9, v87, s37, v9
    ds_add_u32 v104, v4 offset:0
    ds_add_u32 v105, v4 offset:0
    ds_add_u32 v106, v4 offset:0
    ds_add_u32 v107, v4 offset:0
    v_pk_mad_u16 v6, v84, s52, v6 op_sel:[1,0,0] op_sel_hi:[1,1,1]
    v_pk_mad_u16 v7, v85, s52, v7 op_sel:[1,0,0] op_sel_hi:[1,1,1]
    v_pk_mad_u16 v8, v86, s52, v8 op_sel:[1,0,0] op_sel_hi:[1,1,1]
    v_pk_mad_u16 v9, v87, s52, v9 op_sel:[1,0,0] op_sel_hi:[1,1,1]
    v_perm_b32 v75, v107, v106, s43
    v_perm_b32 v126, v105, v104, s43
    v_or_b32 v78, 0x40000000, v6
    v_or_b32 v80, 0x40000000, v7
    v_or_b32 v81, 0x40000000, v8
    v_or_b32 v82, 0x40000000, v9
    s_waitcnt vmcnt(4)
    v_perm_b32 v6, v108, v88, s43
    v_perm_b32 v7, v109, v89, s43
    v_perm_b32 v8, v110, v90, s43
    v_perm_b32 v9, v111, v91, s43
    v_mul_hi_u32_u24 v88, 429497, v88
    v_mul_hi_u32_u24 v108, 429497, v108
    v_mul_hi_u32_u24 v89, 429497, v89
    v_mul_hi_u32_u24 v109, 429497, v109
    v_mul_hi_u32_u24 v90, 429497, v90
    v_mul_hi_u32_u24 v110, 429497, v110
    v_mul_hi_u32_u24 v91, 429497, v91
    v_mul_hi_u32_u24 v111, 429497, v111
    v_lshl_or_b32 v88, v108, 16, v88
    v_lshl_or_b32 v89, v109, 16, v89
    v_lshl_or_b32 v90, v110, 16, v90
    v_lshl_or_b32 v91, v111, 16, v91
    v_dot2_u32_u16 v108, v88, s38, 0
    v_dot2_u32_u16 v109, v89, s38, 0
    v_dot2_u32_u16 v110, v90, s38, 0
    v_dot2_u32_u16 v111, v91, s38, 0
    v_pk_mad_u16 v6, v88, s37, v6
    v_pk_mad_u16 v7, v89, s37, v7
    v_pk_mad_u16 v8, v90, s37, v8
    v_pk_mad_u16 v9, v91, s37, v9
    ds_add_u32 v108, v4 offset:0
    ds_add_u32 v109, v4 offset:0
    ds_add_u32 v110, v4 offset:0
    ds_add_u32 v111, v4 offset:0
    v_pk_mad_u16 v6, v88, s52, v6 op_sel:[1,0,0] op_sel_hi:[1,1,1]
    v_pk_mad_u16 v7, v89, s52, v7 op_sel:[1,0,0] op_sel_hi:[1,1,1]
    v_pk_mad_u16 v8, v90, s52, v8 op_sel:[1,0,0] op_sel_hi:[1,1,1]
    v_pk_mad_u16 v9, v91, s52, v9 op_sel:[1,0,0] op_sel_hi:[1,1,1]
    v_perm_b32 v83, v111, v110, s43
    v_perm_b32 v79, v109, v108, s43
    v_or_b32 v84, 0x40000000, v6
    v_or_b32 v85, 0x40000000, v7
    v_or_b32 v86, 0x40000000, v8
    v_or_b32 v88, 0x40000000, v9
    s_waitcnt vmcnt(2)
    v_perm_b32 v6, v112, v92, s43
    v_perm_b32 v7, v113, v93, s43
    v_perm_b32 v8, v114, v94, s43
    v_perm_b32 v9, v115, v95, s43
    v_mul_hi_u32_u24 v92, 429497, v92
    v_mul_hi_u32_u24 v112, 429497, v112
    v_mul_hi_u32_u24 v93, 429497, v93
    v_mul_hi_u32_u24 v113, 429497, v113
    v_mul_hi_u32_u24 v94, 429497, v94
    v_mul_hi_u32_u24 v114, 429497, v114
    v_mul_hi_u32_u24 v95, 429497, v95
    v_mul_hi_u32_u24 v115, 429497, v115
    v_lshl_or_b32 v92, v112, 16, v92
    v_lshl_or_b32 v93, v113, 16, v93
    v_lshl_or_b32 v94, v114, 16, v94
    v_lshl_or_b32 v95, v115, 16, v95
    v_dot2_u32_u16 v112, v92, s38, 0
    v_dot2_u32_u16 v113, v93, s38, 0
    v_dot2_u32_u16 v114, v94, s38, 0
    v_dot2_u32_u16 v115, v95, s38, 0
    v_pk_mad_u16 v6, v92, s37, v6
    v_pk_mad_u16 v7, v93, s37, v7
    v_pk_mad_u16 v8, v94, s37, v8
    v_pk_mad_u16 v9, v95, s37, v9
    ds_add_u32 v112, v4 offset:0
    ds_add_u32 v113, v4 offset:0
    ds_add_u32 v114, v4 offset:0
    ds_add_u32 v115, v4 offset:0
    v_pk_mad_u16 v6, v92, s52, v6 op_sel:[1,0,0] op_sel_hi:[1,1,1]
    v_pk_mad_u16 v7, v93, s52, v7 op_sel:[1,0,0] op_sel_hi:[1,1,1]
    v_pk_mad_u16 v8, v94, s52, v8 op_sel:[1,0,0] op_sel_hi:[1,1,1]
    v_pk_mad_u16 v9, v95, s52, v9 op_sel:[1,0,0] op_sel_hi:[1,1,1]
    v_perm_b32 v91, v115, v114, s43
    v_perm_b32 v87, v113, v112, s43
    v_or_b32 v89, 0x40000000, v6
    v_or_b32 v90, 0x40000000, v7
    v_or_b32 v92, 0x40000000, v8
    v_or_b32 v93, 0x40000000, v9
    s_waitcnt vmcnt(0)
    s_mov_b64 exec, s[44:45]
    v_perm_b32 v6, v116, v96, s43
    v_perm_b32 v7, v117, v97, s43
    v_perm_b32 v8, v118, v98, s43
    v_perm_b32 v9, v119, v99, s43
    v_mul_hi_u32_u24 v96, 429497, v96
    v_mul_hi_u32_u24 v116, 429497, v116
    v_mul_hi_u32_u24 v97, 429497, v97
    v_mul_hi_u32_u24 v117, 429497, v117
    v_mul_hi_u32_u24 v98, 429497, v98
    v_mul_hi_u32_u24 v118, 429497, v118
    v_mul_hi_u32_u24 v99, 429497, v99
    v_mul_hi_u32_u24 v119, 429497, v119
    v_lshl_or_b32 v96, v116, 16, v96
    v_lshl_or_b32 v97, v117, 16, v97
    v_lshl_or_b32 v98, v118, 16, v98
    v_lshl_or_b32 v99, v119, 16, v99
    v_dot2_u32_u16 v116, v96, s38, 0
    v_dot2_u32_u16 v117, v97, s38, 0
    v_dot2_u32_u16 v118, v98, s38, 0
    v_dot2_u32_u16 v119, v99, s38, 0
    v_pk_mad_u16 v6, v96, s37, v6
    v_pk_mad_u16 v7, v97, s37, v7
    v_pk_mad_u16 v8, v98, s37, v8
    v_pk_mad_u16 v9, v99, s37, v9
    ds_add_u32 v116, v4 offset:0
    ds_add_u32 v117, v4 offset:0
    ds_add_u32 v118, v4 offset:0
    ds_add_u32 v119, v4 offset:0
    v_pk_mad_u16 v6, v96, s52, v6 op_sel:[1,0,0] op_sel_hi:[1,1,1]
    v_pk_mad_u16 v7, v97, s52, v7 op_sel:[1,0,0] op_sel_hi:[1,1,1]
    v_pk_mad_u16 v8, v98, s52, v8 op_sel:[1,0,0] op_sel_hi:[1,1,1]
    v_pk_mad_u16 v9, v99, s52, v9 op_sel:[1,0,0] op_sel_hi:[1,1,1]
    v_perm_b32 v99, v119, v118, s43
    v_perm_b32 v95, v117, v116, s43
    v_or_b32 v94, 0x40000000, v6
    v_or_b32 v96, 0x40000000, v7
    v_or_b32 v97, 0x40000000, v8
    v_or_b32 v98, 0x40000000, v9
    s_mov_b64 exec, -1
    s_add_u32 s35, s34, 0
    buffer_load_dwordx2 v[100:101], v2, s[16:19], s35 offen nt
    s_lshl_b32 s35, s32, 10
    s_add_u32 s35, s35, 9437184
    s_add_u32 s20, s4, s35
    s_addc_u32 s21, s5, 0
    s_waitcnt lgkmcnt(0)
    s_barrier
    ds_read_b128 v[8:11], v1 offset:0
    s_add_u32 s35, s34, 2097152
    buffer_load_dwordx2 v[102:103], v2, s[16:19], s35 offen nt
    s_lshl_b32 s35, s39, 2
    s_add_u32 s35, s35, 160256
    v_mov_b32 v7, s35
    v_and_b32 v14, 15, v0
    v_lshlrev_b32 v14, 2, v14
    v_add_u32 v14, 160256, v14
    s_waitcnt lgkmcnt(0)
    v_cmp_eq_u32 s[56:57], 0, v8
    v_cmp_ge_u32 s[64:65], 1, v8
    v_max_u32 v12, 2, v8
    v_lshl_or_b32 v8, v8, 16, v12
    v_cmp_eq_u32 s[58:59], 0, v9
    v_cmp_ge_u32 s[66:67], 1, v9
    v_max_u32 v12, 2, v9
    v_lshl_or_b32 v9, v9, 16, v12
    v_cmp_eq_u32 s[60:61], 0, v10
    v_cmp_ge_u32 s[68:69], 1, v10
    v_max_u32 v12, 2, v10
    v_lshl_or_b32 v10, v10, 16, v12
    v_cmp_eq_u32 s[62:63], 0, v11
    v_cmp_ge_u32 s[70:71], 1, v11
    v_max_u32 v12, 2, v11
    v_lshl_or_b32 v11, v11, 16, v12
    v_add_u32 v9, v8, v9
    v_add_u32 v10, v9, v10
    v_add_u32 v11, v10, v11
    v_mov_b32 v6, v11
    s_nop 1
    v_add_u32_dpp v6, v6, v6 row_shr:1 row_mask:0xf bank_mask:0xf bound_ctrl:0
    s_nop 1
    v_add_u32_dpp v6, v6, v6 row_shr:2 row_mask:0xf bank_mask:0xf bound_ctrl:0
    s_nop 1
    v_add_u32_dpp v6, v6, v6 row_shr:4 row_mask:0xf bank_mask:0xf bound_ctrl:0
    s_nop 1
    v_add_u32_dpp v6, v6, v6 row_shr:8 row_mask:0xf bank_mask:0xf bound_ctrl:0
    s_nop 1
    v_add_u32_dpp v6, v6, v6 row_bcast:15 row_mask:0xa bank_mask:0xf
    s_nop 1
    v_add_u32_dpp v6, v6, v6 row_bcast:31 row_mask:0xc bank_mask:0xf
    s_mov_b32 exec_lo, 0
    s_brev_b32 exec_hi, 1
    ds_write_b32 v7, v6
    s_mov_b64 exec, -1
    v_sub_u32 v6, v6, v11
    s_or_b64 s[46:47], s[64:65], s[66:67]
    s_or_b64 vcc, s[68:69], s[70:71]
    s_or_b64 s[46:47], s[46:47], vcc
    s_waitcnt lgkmcnt(0)
    s_barrier
    ds_read_b32 v7, v14
    s_add_u32 s35, s34, 4194304
    buffer_load_dwordx2 v[104:105], v2, s[16:19], s35 offen nt
    s_waitcnt lgkmcnt(0)
    v_mov_b32 v15, v7
    s_nop 1
    v_add_u32_dpp v7, v7, v7 row_shr:1 row_mask:0xf bank_mask:0xf bound_ctrl:0
    s_nop 1
    v_add_u32_dpp v7, v7, v7 row_shr:2 row_mask:0xf bank_mask:0xf bound_ctrl:0
    s_nop 1
    v_add_u32_dpp v7, v7, v7 row_shr:4 row_mask:0xf bank_mask:0xf bound_ctrl:0
    s_nop 1
    v_add_u32_dpp v7, v7, v7 row_shr:8 row_mask:0xf bank_mask:0xf bound_ctrl:0
    s_nop 0
    v_readlane_b32 s54, v7, 15
    v_sub_u32 v7, v7, v15
    s_nop 0
    v_readlane_b32 s35, v7, s39
    s_and_b32 s54, s54, 0xffff
    s_cmp_ge_u32 s54, 40063
    s_cselect_b32 s36, 16, 0
    s_cselect_b32 s54, 40000, s54
    s_cselect_b32 s55, 1, s55
    s_cselect_b64 s[46:47], 0, s[46:47]
    v_add_u32 v12, s35, v6
    v_add_u32 v13, v12, v8
    v_add_u32 v14, v12, v9
    v_add_u32 v15, v12, v10
    v_bfe_u32 v12, v12, s36, 16
    v_bfe_u32 v13, v13, s36, 16
    v_bfe_u32 v14, v14, s36, 16
    v_bfe_u32 v15, v15, s36, 16
    ds_write_b128 v1, v[12:15] offset:0
    ds_write_b128 v1, v[12:15] offset:16384
    v_mov_b32 v6, 32768
    v_mov_b32 v7, s54
    s_mov_b64 exec, 1
    ds_write_b32 v6, v7
    s_mov_b64 exec, -1
    s_add_u32 s35, s54, 2
    s_mul_hi_u32 s35, s35, 1431655766
    s_lshl_b32 s35, s35, 4
    s_add_u32 s35, s35, 217890816
    s_min_u32 s22, s35, 218104832
    v_perm_b32 v15, v15, v14, s43
    v_perm_b32 v14, v13, v12, s43
    s_waitcnt lgkmcnt(0)
    s_barrier
    s_nop 0
    v_and_b32 v6, 0xffff, v51
    v_lshrrev_b32 v7, 16, v51
    v_and_b32 v8, 0xffff, v55
    v_lshrrev_b32 v9, 16, v55
    ds_add_rtn_u32 v6, v6, v4 offset:0
    ds_add_rtn_u32 v7, v7, v4 offset:0
    ds_add_rtn_u32 v8, v8, v4 offset:0
    ds_add_rtn_u32 v9, v9, v4 offset:0
    v_and_b32 v10, 0xffff, v59
    v_lshrrev_b32 v11, 16, v59
    v_and_b32 v12, 0xffff, v63
    v_lshrrev_b32 v13, 16, v63
    ds_add_rtn_u32 v10, v10, v4 offset:0
    ds_add_rtn_u32 v11, v11, v4 offset:0
    ds_add_rtn_u32 v12, v12, v4 offset:0
    ds_add_rtn_u32 v13, v13, v4 offset:0
    s_waitcnt lgkmcnt(4)
    v_perm_b32 v51, v7, v6, s43
    v_perm_b32 v55, v9, v8, s43
    v_and_b32 v6, 0xffff, v67
    v_lshrrev_b32 v7, 16, v67
    v_and_b32 v8, 0xffff, v71
    v_lshrrev_b32 v9, 16, v71
    ds_add_rtn_u32 v6, v6, v4 offset:0
    ds_add_rtn_u32 v7, v7, v4 offset:0
    ds_add_rtn_u32 v8, v8, v4 offset:0
    ds_add_rtn_u32 v9, v9, v4 offset:0
    s_waitcnt lgkmcnt(4)
    v_perm_b32 v59, v11, v10, s43
    v_perm_b32 v63, v13, v12, s43
    s_add_u32 s35, s34, 6291456
    buffer_load_dwordx2 v[106:107], v2, s[16:19], s35 offen nt
    v_and_b32 v10, 0xffff, v120
    v_lshrrev_b32 v11, 16, v120
    v_and_b32 v12, 0xffff, v121
    v_lshrrev_b32 v13, 16, v121
    ds_add_rtn_u32 v10, v10, v4 offset:0
    ds_add_rtn_u32 v11, v11, v4 offset:0
    ds_add_rtn_u32 v12, v12, v4 offset:0
    ds_add_rtn_u32 v13, v13, v4 offset:0
    s_waitcnt lgkmcnt(4)
    v_perm_b32 v67, v7, v6, s43
    v_perm_b32 v71, v9, v8, s43
    s_add_u32 s35, s34, 8388608
    buffer_load_dwordx2 v[108:109], v2, s[16:19], s35 offen nt
    v_and_b32 v6, 0xffff, v122
    v_lshrrev_b32 v7, 16, v122
    v_and_b32 v8, 0xffff, v123
    v_lshrrev_b32 v9, 16, v123
    ds_add_rtn_u32 v6, v6, v4 offset:0
    ds_add_rtn_u32 v7, v7, v4 offset:0
    ds_add_rtn_u32 v8, v8, v4 offset:0
    ds_add_rtn_u32 v9, v9, v4 offset:0
    s_waitcnt lgkmcnt(4)
    v_perm_b32 v120, v11, v10, s43
    v_perm_b32 v121, v13, v12, s43
    s_add_u32 s35, s34, 10485760
    buffer_load_dwordx2 v[110:111], v2, s[16:19], s35 offen nt
    v_and_b32 v10, 0xffff, v124
    v_lshrrev_b32 v11, 16, v124
    v_and_b32 v12, 0xffff, v125
    v_lshrrev_b32 v13, 16, v125
    ds_add_rtn_u32 v10, v10, v4 offset:0
    ds_add_rtn_u32 v11, v11, v4 offset:0
    ds_add_rtn_u32 v12, v12, v4 offset:0
    ds_add_rtn_u32 v13, v13, v4 offset:0
    s_waitcnt lgkmcnt(4)
    v_perm_b32 v122, v7, v6, s43
    v_perm_b32 v123, v9, v8, s43
    v_and_b32 v6, 0xffff, v126
    v_lshrrev_b32 v7, 16, v126
    v_and_b32 v8, 0xffff, v75
    v_lshrrev_b32 v9, 16, v75
    ds_add_rtn_u32 v6, v6, v4 offset:0
    ds_add_rtn_u32 v7, v7, v4 offset:0
    ds_add_rtn_u32 v8, v8, v4 offset:0
    ds_add_rtn_u32 v9, v9, v4 offset:0
    s_waitcnt lgkmcnt(4)
    v_perm_b32 v124, v11, v10, s43
    v_perm_b32 v125, v13, v12, s43
    s_add_u32 s35, s34, 12582912
    buffer_load_dwordx2 v[112:113], v2, s[16:19], s35 offen nt
    v_and_b32 v10, 0xffff, v79
    v_lshrrev_b32 v11, 16, v79
    v_and_b32 v12, 0xffff, v83
    v_lshrrev_b32 v13, 16, v83
    ds_add_rtn_u32 v10, v10, v4 offset:0
    ds_add_rtn_u32 v11, v11, v4 offset:0
    ds_add_rtn_u32 v12, v12, v4 offset:0
    ds_add_rtn_u32 v13, v13, v4 offset:0
    s_waitcnt lgkmcnt(4)
    v_perm_b32 v126, v7, v6, s43
    v_perm_b32 v75, v9, v8, s43
    s_add_u32 s35, s34, 14680064
    buffer_load_dwordx2 v[114:115], v2, s[16:19], s35 offen nt
    v_and_b32 v6, 0xffff, v87
    v_lshrrev_b32 v7, 16, v87
    v_and_b32 v8, 0xffff, v91
    v_lshrrev_b32 v9, 16, v91
    ds_add_rtn_u32 v6, v6, v4 offset:0
    ds_add_rtn_u32 v7, v7, v4 offset:0
    ds_add_rtn_u32 v8, v8, v4 offset:0
    ds_add_rtn_u32 v9, v9, v4 offset:0
    s_waitcnt lgkmcnt(4)
    v_perm_b32 v79, v11, v10, s43
    v_perm_b32 v83, v13, v12, s43
    s_add_u32 s35, s34, 16777216
    buffer_load_dwordx2 v[116:117], v2, s[16:19], s35 offen nt
    s_mov_b64 exec, s[44:45]
    v_and_b32 v10, 0xffff, v95
    v_lshrrev_b32 v11, 16, v95
    v_and_b32 v12, 0xffff, v99
    v_lshrrev_b32 v13, 16, v99
    ds_add_rtn_u32 v10, v10, v4 offset:0
    ds_add_rtn_u32 v11, v11, v4 offset:0
    ds_add_rtn_u32 v12, v12, v4 offset:0
    ds_add_rtn_u32 v13, v13, v4 offset:0
    s_mov_b64 exec, -1
    s_waitcnt lgkmcnt(4)
    v_perm_b32 v87, v7, v6, s43
    v_perm_b32 v91, v9, v8, s43
    s_add_u32 s35, s34, 18874368
    s_sub_u32 s35, s35, s49
    v_cndmask_b32 v118, 2.0, v2, s[44:45]
    buffer_load_dwordx2 v[118:119], v118, s[16:19], s35 offen nt
    s_waitcnt lgkmcnt(0)
    v_perm_b32 v95, v11, v10, s43
    v_perm_b32 v99, v13, v12, s43
    s_cmp_gt_u32 s39, 8
    s_cbranch_scc1 L_p1_kernel_notab_9
    v_lshrrev_b32 v6, 1, v0
    v_mul_u32_u24 v7, 1009, v6
    v_lshrrev_b32 v7, 16, v7
    v_mul_u32_u24 v7, 959, v7
    v_and_b32 v8, 1, v0
    v_lshl_add_u32 v7, v8, 9, v7
    v_add_lshl_u32 v13, v7, v6, 2
    ds_read2st64_b32 v[6:7], v13 offset0:64 offset1:65
    ds_read2st64_b32 v[8:9], v13 offset0:66 offset1:67
    ds_read2st64_b32 v[10:11], v13 offset0:68 offset1:69
    ds_read2st64_b32 v[12:13], v13 offset0:70 offset1:71
    s_mul_i32 s35, s32, 8320
    s_add_u32 s26, s35, 8320
    s_waitcnt lgkmcnt(3)
    v_perm_b32 v6, v7, v6, s43
    s_waitcnt lgkmcnt(2)
    v_perm_b32 v7, v9, v8, s43
    s_waitcnt lgkmcnt(1)
    v_perm_b32 v8, v11, v10, s43
    s_waitcnt lgkmcnt(0)
    v_perm_b32 v9, v13, v12, s43
    buffer_store_dwordx4 v[6:9], v1, s[24:27], s35 offen sc1
    s_nop 1
L_p1_kernel_notab_9:
    s_barrier
    s_lshl_b32 s35, s54, 2
    v_mov_b32 v6, s35
    v_mov_b32 v7, 0
    v_mov_b32 v12, 1140817920
    s_mov_b64 exec, 1
    ds_write2_b32 v6, v7, v7 offset0:0 offset1:1
    s_cmp_eq_u64 s[46:47], 0
    s_cbranch_scc1 L_p1_kernel_nonull_10
    s_mov_b64 exec, s[64:65]
    v_lshlrev_b32_sdwa v6, 2, v14 dst_sel:DWORD dst_unused:UNUSED_PAD src0_sel:DWORD src1_sel:WORD_0
    ds_write_b32 v6, v7 offset:4
    s_mov_b64 exec, s[56:57]
    ds_write_b32 v6, v7
    s_mov_b64 exec, s[66:67]
    v_lshlrev_b32_sdwa v6, 2, v14 dst_sel:DWORD dst_unused:UNUSED_PAD src0_sel:DWORD src1_sel:WORD_1
    ds_write_b32 v6, v7 offset:4
    s_mov_b64 exec, s[58:59]
    ds_write_b32 v6, v7
    s_mov_b64 exec, s[68:69]
    v_lshlrev_b32_sdwa v6, 2, v15 dst_sel:DWORD dst_unused:UNUSED_PAD src0_sel:DWORD src1_sel:WORD_0
    ds_write_b32 v6, v7 offset:4
    s_mov_b64 exec, s[60:61]
    ds_write_b32 v6, v7
    s_mov_b64 exec, s[70:71]
    v_lshlrev_b32_sdwa v6, 2, v15 dst_sel:DWORD dst_unused:UNUSED_PAD src0_sel:DWORD src1_sel:WORD_1
    ds_write_b32 v6, v7 offset:4
    s_mov_b64 exec, s[62:63]
    ds_write_b32 v6, v7
L_p1_kernel_nonull_10:
    s_mov_b64 exec, -1
    v_lshlrev_b32_sdwa v6, 2, v51 dst_sel:DWORD dst_unused:UNUSED_PAD src0_sel:DWORD src1_sel:WORD_0
    v_lshlrev_b32_sdwa v7, 2, v51 dst_sel:DWORD dst_unused:UNUSED_PAD src0_sel:DWORD src1_sel:WORD_1
    v_lshlrev_b32_sdwa v8, 2, v55 dst_sel:DWORD dst_unused:UNUSED_PAD src0_sel:DWORD src1_sel:WORD_0
    v_lshlrev_b32_sdwa v9, 2, v55 dst_sel:DWORD dst_unused:UNUSED_PAD src0_sel:DWORD src1_sel:WORD_1
    ds_write_b32 v6, v48
    ds_write_b32 v7, v49
    ds_write_b32 v8, v50
    ds_write_b32 v9, v52
    s_add_u32 s35, s33, 40960000
    buffer_load_dwordx4 v[16:19], v1, s[8:11], s35 offen nt
    v_lshlrev_b32_sdwa v6, 2, v59 dst_sel:DWORD dst_unused:UNUSED_PAD src0_sel:DWORD src1_sel:WORD_0
    v_lshlrev_b32_sdwa v7, 2, v59 dst_sel:DWORD dst_unused:UNUSED_PAD src0_sel:DWORD src1_sel:WORD_1
    v_lshlrev_b32_sdwa v8, 2, v63 dst_sel:DWORD dst_unused:UNUSED_PAD src0_sel:DWORD src1_sel:WORD_0
    v_lshlrev_b32_sdwa v9, 2, v63 dst_sel:DWORD dst_unused:UNUSED_PAD src0_sel:DWORD src1_sel:WORD_1
    ds_write_b32 v6, v53
    ds_write_b32 v7, v54
    ds_write_b32 v8, v56
    ds_write_b32 v9, v57
    v_lshlrev_b32_sdwa v6, 2, v67 dst_sel:DWORD dst_unused:UNUSED_PAD src0_sel:DWORD src1_sel:WORD_0
    v_lshlrev_b32_sdwa v7, 2, v67 dst_sel:DWORD dst_unused:UNUSED_PAD src0_sel:DWORD src1_sel:WORD_1
    v_lshlrev_b32_sdwa v8, 2, v71 dst_sel:DWORD dst_unused:UNUSED_PAD src0_sel:DWORD src1_sel:WORD_0
    v_lshlrev_b32_sdwa v9, 2, v71 dst_sel:DWORD dst_unused:UNUSED_PAD src0_sel:DWORD src1_sel:WORD_1
    ds_write_b32 v6, v58
    ds_write_b32 v7, v60
    ds_write_b32 v8, v61
    ds_write_b32 v9, v62
    v_lshlrev_b32_sdwa v6, 2, v120 dst_sel:DWORD dst_unused:UNUSED_PAD src0_sel:DWORD src1_sel:WORD_0
    v_lshlrev_b32_sdwa v7, 2, v120 dst_sel:DWORD dst_unused:UNUSED_PAD src0_sel:DWORD src1_sel:WORD_1
    v_lshlrev_b32_sdwa v8, 2, v121 dst_sel:DWORD dst_unused:UNUSED_PAD src0_sel:DWORD src1_sel:WORD_0
    v_lshlrev_b32_sdwa v9, 2, v121 dst_sel:DWORD dst_unused:UNUSED_PAD src0_sel:DWORD src1_sel:WORD_1
    ds_write_b32 v6, v64
    ds_write_b32 v7, v65
    ds_write_b32 v8, v66
    ds_write_b32 v9, v68
    s_add_u32 s35, s33, 40960000
    buffer_load_dwordx4 v[20:23], v1, s[12:15], s35 offen nt
    v_lshlrev_b32_sdwa v6, 2, v122 dst_sel:DWORD dst_unused:UNUSED_PAD src0_sel:DWORD src1_sel:WORD_0
    v_lshlrev_b32_sdwa v7, 2, v122 dst_sel:DWORD dst_unused:UNUSED_PAD src0_sel:DWORD src1_sel:WORD_1
    v_lshlrev_b32_sdwa v8, 2, v123 dst_sel:DWORD dst_unused:UNUSED_PAD src0_sel:DWORD src1_sel:WORD_0
    v_lshlrev_b32_sdwa v9, 2, v123 dst_sel:DWORD dst_unused:UNUSED_PAD src0_sel:DWORD src1_sel:WORD_1
    ds_write_b32 v6, v69
    ds_write_b32 v7, v70
    ds_write_b32 v8, v127
    ds_write_b32 v9, v72
    v_lshlrev_b32_sdwa v6, 2, v124 dst_sel:DWORD dst_unused:UNUSED_PAD src0_sel:DWORD src1_sel:WORD_0
    v_lshlrev_b32_sdwa v7, 2, v124 dst_sel:DWORD dst_unused:UNUSED_PAD src0_sel:DWORD src1_sel:WORD_1
    v_lshlrev_b32_sdwa v8, 2, v125 dst_sel:DWORD dst_unused:UNUSED_PAD src0_sel:DWORD src1_sel:WORD_0
    v_lshlrev_b32_sdwa v9, 2, v125 dst_sel:DWORD dst_unused:UNUSED_PAD src0_sel:DWORD src1_sel:WORD_1
    ds_write_b32 v6, v73
    ds_write_b32 v7, v74
    ds_write_b32 v8, v76
    ds_write_b32 v9, v77
    v_lshlrev_b32_sdwa v6, 2, v126 dst_sel:DWORD dst_unused:UNUSED_PAD src0_sel:DWORD src1_sel:WORD_0
    v_lshlrev_b32_sdwa v7, 2, v126 dst_sel:DWORD dst_unused:UNUSED_PAD src0_sel:DWORD src1_sel:WORD_1
    v_lshlrev_b32_sdwa v8, 2, v75 dst_sel:DWORD dst_unused:UNUSED_PAD src0_sel:DWORD src1_sel:WORD_0
    v_lshlrev_b32_sdwa v9, 2, v75 dst_sel:DWORD dst_unused:UNUSED_PAD src0_sel:DWORD src1_sel:WORD_1
    ds_write_b32 v6, v78
    ds_write_b32 v7, v80
    ds_write_b32 v8, v81
    ds_write_b32 v9, v82
    s_add_u32 s35, s33, 45154304
    buffer_load_dwordx4 v[24:27], v1, s[8:11], s35 offen nt
    v_lshlrev_b32_sdwa v6, 2, v79 dst_sel:DWORD dst_unused:UNUSED_PAD src0_sel:DWORD src1_sel:WORD_0
    v_lshlrev_b32_sdwa v7, 2, v79 dst_sel:DWORD dst_unused:UNUSED_PAD src0_sel:DWORD src1_sel:WORD_1
    v_lshlrev_b32_sdwa v8, 2, v83 dst_sel:DWORD dst_unused:UNUSED_PAD src0_sel:DWORD src1_sel:WORD_0
    v_lshlrev_b32_sdwa v9, 2, v83 dst_sel:DWORD dst_unused:UNUSED_PAD src0_sel:DWORD src1_sel:WORD_1
    ds_write_b32 v6, v84
    ds_write_b32 v7, v85
    ds_write_b32 v8, v86
    ds_write_b32 v9, v88
    v_lshlrev_b32_sdwa v6, 2, v87 dst_sel:DWORD dst_unused:UNUSED_PAD src0_sel:DWORD src1_sel:WORD_0
    v_lshlrev_b32_sdwa v7, 2, v87 dst_sel:DWORD dst_unused:UNUSED_PAD src0_sel:DWORD src1_sel:WORD_1
    v_lshlrev_b32_sdwa v8, 2, v91 dst_sel:DWORD dst_unused:UNUSED_PAD src0_sel:DWORD src1_sel:WORD_0
    v_lshlrev_b32_sdwa v9, 2, v91 dst_sel:DWORD dst_unused:UNUSED_PAD src0_sel:DWORD src1_sel:WORD_1
    ds_write_b32 v6, v89
    ds_write_b32 v7, v90
    ds_write_b32 v8, v92
    ds_write_b32 v9, v93
    s_mov_b64 exec, s[44:45]
    v_lshlrev_b32_sdwa v6, 2, v95 dst_sel:DWORD dst_unused:UNUSED_PAD src0_sel:DWORD src1_sel:WORD_0
    v_lshlrev_b32_sdwa v7, 2, v95 dst_sel:DWORD dst_unused:UNUSED_PAD src0_sel:DWORD src1_sel:WORD_1
    v_lshlrev_b32_sdwa v8, 2, v99 dst_sel:DWORD dst_unused:UNUSED_PAD src0_sel:DWORD src1_sel:WORD_0
    v_lshlrev_b32_sdwa v9, 2, v99 dst_sel:DWORD dst_unused:UNUSED_PAD src0_sel:DWORD src1_sel:WORD_1
    ds_write_b32 v6, v94
    ds_write_b32 v7, v96
    ds_write_b32 v8, v97
    ds_write_b32 v9, v98
    s_mov_b64 exec, -1
    s_add_u32 s35, s33, 45154304
    buffer_load_dwordx4 v[28:31], v1, s[12:15], s35 offen nt
    s_mul_i32 s35, s39, 9216
    v_mad_u32_u24 v6, v0, 12, s35
    s_waitcnt lgkmcnt(0)
    s_barrier
    s_cmp_lg_u32 s39, 15
    s_cbranch_scc1 L_p1_kernel_nox_11
    ds_read_b32 v12, v6 offset:9984
    ds_read_b32 v13, v6 offset:9988
    ds_read_b32 v14, v6 offset:9992
L_p1_kernel_nox_11:
    ds_read_b32 v48, v6 offset:1536
    ds_read_b32 v49, v6 offset:1540
    ds_read_b32 v50, v6 offset:1544
    ds_read_b32 v52, v6 offset:3072
    ds_read_b32 v53, v6 offset:3076
    ds_read_b32 v54, v6 offset:3080
    ds_read_b32 v56, v6 offset:4608
    ds_read_b32 v57, v6 offset:4612
    ds_read_b32 v58, v6 offset:4616
    ds_read_b32 v60, v6 offset:6144
    ds_read_b32 v61, v6 offset:6148
    ds_read_b32 v62, v6 offset:6152
    ds_read_b32 v64, v6 offset:7680
    ds_read_b32 v65, v6 offset:7684
    ds_read_b32 v66, v6 offset:7688
    ds_read_b32 v68, v6 offset:9216
    ds_read_b32 v69, v6 offset:9220
    ds_read_b32 v70, v6 offset:9224
    ds_read_b32 v72, v6 offset:0
    ds_read_b32 v73, v6 offset:4
    ds_read_b32 v74, v6 offset:8
    ds_read_b32 v76, v6 offset:768
    ds_read_b32 v77, v6 offset:772
    ds_read_b32 v78, v6 offset:776
    ds_read_b32 v80, v6 offset:2304
    ds_read_b32 v81, v6 offset:2308
    ds_read_b32 v82, v6 offset:2312
    ds_read_b32 v84, v6 offset:3840
    ds_read_b32 v85, v6 offset:3844
    ds_read_b32 v86, v6 offset:3848
    ds_read_b32 v88, v6 offset:5376
    ds_read_b32 v89, v6 offset:5380
    ds_read_b32 v90, v6 offset:5384
    ds_read_b32 v92, v6 offset:6912
    ds_read_b32 v93, v6 offset:6916
    ds_read_b32 v94, v6 offset:6920
    ds_read_b32 v96, v6 offset:8448
    ds_read_b32 v97, v6 offset:8452
    ds_read_b32 v98, v6 offset:8456
    s_add_u32 s35, s33, 49348608
    buffer_load_dwordx4 v[32:35], v1, s[8:11], s35 offen nt
    v_mov_b32 v8, 0
    v_mov_b32 v9, 0
    v_mov_b32 v10, 0
    v_mov_b32 v11, 0
    v_mov_b32 v15, 16384
    s_waitcnt lgkmcnt(0)
    s_barrier
    ds_write_b128 v1, v[8:11] offset:0
    s_nop 1
    v_mov_b32 v6, 1140817920
    s_waitcnt vmcnt(14)
    v_pk_maximum3_f16 v5, v100, v101, v5
    v_mad_u32_u16 v6, v51, s50, v15 op_sel:[0,0,0,0]
    v_mad_u32_u16 v7, v51, s50, v15 op_sel:[1,0,0,0]
    v_mad_u32_u16 v8, v55, s50, v15 op_sel:[0,0,0,0]
    v_mad_u32_u16 v9, v55, s50, v15 op_sel:[1,0,0,0]
    v_add_u32_sdwa v6, v6, v51 dst_sel:DWORD dst_unused:UNUSED_PAD src0_sel:WORD_1 src1_sel:WORD_0
    v_add_u32_sdwa v7, v7, v51 dst_sel:DWORD dst_unused:UNUSED_PAD src0_sel:WORD_1 src1_sel:WORD_1
    v_add_u32_sdwa v8, v8, v55 dst_sel:DWORD dst_unused:UNUSED_PAD src0_sel:WORD_1 src1_sel:WORD_0
    v_add_u32_sdwa v9, v9, v55 dst_sel:DWORD dst_unused:UNUSED_PAD src0_sel:WORD_1 src1_sel:WORD_1
    v_add_u32 v6, v6, v6
    v_add_u32 v7, v7, v7
    v_add_u32 v8, v8, v8
    v_add_u32 v9, v9, v9
    ds_write_b16 v6, v100 offset:16384
    ds_write_b16_d16_hi v7, v100 offset:16384
    ds_write_b16 v8, v101 offset:16384
    ds_write_b16_d16_hi v9, v101 offset:16384
    v_mov_b32 v6, 1140817920
    s_waitcnt vmcnt(13)
    v_pk_maximum3_f16 v5, v102, v103, v5
    v_mad_u32_u16 v6, v59, s50, v15 op_sel:[0,0,0,0]
    v_mad_u32_u16 v7, v59, s50, v15 op_sel:[1,0,0,0]
    v_mad_u32_u16 v8, v63, s50, v15 op_sel:[0,0,0,0]
    v_mad_u32_u16 v9, v63, s50, v15 op_sel:[1,0,0,0]
    v_add_u32_sdwa v6, v6, v59 dst_sel:DWORD dst_unused:UNUSED_PAD src0_sel:WORD_1 src1_sel:WORD_0
    v_add_u32_sdwa v7, v7, v59 dst_sel:DWORD dst_unused:UNUSED_PAD src0_sel:WORD_1 src1_sel:WORD_1
    v_add_u32_sdwa v8, v8, v63 dst_sel:DWORD dst_unused:UNUSED_PAD src0_sel:WORD_1 src1_sel:WORD_0
    v_add_u32_sdwa v9, v9, v63 dst_sel:DWORD dst_unused:UNUSED_PAD src0_sel:WORD_1 src1_sel:WORD_1
    v_add_u32 v6, v6, v6
    v_add_u32 v7, v7, v7
    v_add_u32 v8, v8, v8
    v_add_u32 v9, v9, v9
    ds_write_b16 v6, v102 offset:16384
    ds_write_b16_d16_hi v7, v102 offset:16384
    ds_write_b16 v8, v103 offset:16384
    ds_write_b16_d16_hi v9, v103 offset:16384
    v_mov_b32 v6, 1140817920
    s_waitcnt vmcnt(12)
    v_pk_maximum3_f16 v5, v104, v105, v5
    v_mad_u32_u16 v6, v67, s50, v15 op_sel:[0,0,0,0]
    v_mad_u32_u16 v7, v67, s50, v15 op_sel:[1,0,0,0]
    v_mad_u32_u16 v8, v71, s50, v15 op_sel:[0,0,0,0]
    v_mad_u32_u16 v9, v71, s50, v15 op_sel:[1,0,0,0]
    v_add_u32_sdwa v6, v6, v67 dst_sel:DWORD dst_unused:UNUSED_PAD src0_sel:WORD_1 src1_sel:WORD_0
    v_add_u32_sdwa v7, v7, v67 dst_sel:DWORD dst_unused:UNUSED_PAD src0_sel:WORD_1 src1_sel:WORD_1
    v_add_u32_sdwa v8, v8, v71 dst_sel:DWORD dst_unused:UNUSED_PAD src0_sel:WORD_1 src1_sel:WORD_0
    v_add_u32_sdwa v9, v9, v71 dst_sel:DWORD dst_unused:UNUSED_PAD src0_sel:WORD_1 src1_sel:WORD_1
    v_add_u32 v6, v6, v6
    v_add_u32 v7, v7, v7
    v_add_u32 v8, v8, v8
    v_add_u32 v9, v9, v9
    ds_write_b16 v6, v104 offset:16384
    ds_write_b16_d16_hi v7, v104 offset:16384
    ds_write_b16 v8, v105 offset:16384
    ds_write_b16_d16_hi v9, v105 offset:16384
    s_add_u32 s35, s33, 49348608
    buffer_load_dwordx4 v[36:39], v1, s[12:15], s35 offen nt
    v_mov_b32 v6, 1140817920
    s_waitcnt vmcnt(12)
    v_pk_maximum3_f16 v5, v106, v107, v5
    v_mad_u32_u16 v6, v120, s50, v15 op_sel:[0,0,0,0]
    v_mad_u32_u16 v7, v120, s50, v15 op_sel:[1,0,0,0]
    v_mad_u32_u16 v8, v121, s50, v15 op_sel:[0,0,0,0]
    v_mad_u32_u16 v9, v121, s50, v15 op_sel:[1,0,0,0]
    v_add_u32_sdwa v6, v6, v120 dst_sel:DWORD dst_unused:UNUSED_PAD src0_sel:WORD_1 src1_sel:WORD_0
    v_add_u32_sdwa v7, v7, v120 dst_sel:DWORD dst_unused:UNUSED_PAD src0_sel:WORD_1 src1_sel:WORD_1
    v_add_u32_sdwa v8, v8, v121 dst_sel:DWORD dst_unused:UNUSED_PAD src0_sel:WORD_1 src1_sel:WORD_0
    v_add_u32_sdwa v9, v9, v121 dst_sel:DWORD dst_unused:UNUSED_PAD src0_sel:WORD_1 src1_sel:WORD_1
    v_add_u32 v6, v6, v6
    v_add_u32 v7, v7, v7
    v_add_u32 v8, v8, v8
    v_add_u32 v9, v9, v9
    ds_write_b16 v6, v106 offset:16384
    ds_write_b16_d16_hi v7, v106 offset:16384
    ds_write_b16 v8, v107 offset:16384
    ds_write_b16_d16_hi v9, v107 offset:16384
    v_mov_b32 v6, 1140817920
    s_waitcnt vmcnt(11)
    v_pk_maximum3_f16 v5, v108, v109, v5
    v_mad_u32_u16 v6, v122, s50, v15 op_sel:[0,0,0,0]
    v_mad_u32_u16 v7, v122, s50, v15 op_sel:[1,0,0,0]
    v_mad_u32_u16 v8, v123, s50, v15 op_sel:[0,0,0,0]
    v_mad_u32_u16 v9, v123, s50, v15 op_sel:[1,0,0,0]
    v_add_u32_sdwa v6, v6, v122 dst_sel:DWORD dst_unused:UNUSED_PAD src0_sel:WORD_1 src1_sel:WORD_0
    v_add_u32_sdwa v7, v7, v122 dst_sel:DWORD dst_unused:UNUSED_PAD src0_sel:WORD_1 src1_sel:WORD_1
    v_add_u32_sdwa v8, v8, v123 dst_sel:DWORD dst_unused:UNUSED_PAD src0_sel:WORD_1 src1_sel:WORD_0
    v_add_u32_sdwa v9, v9, v123 dst_sel:DWORD dst_unused:UNUSED_PAD src0_sel:WORD_1 src1_sel:WORD_1
    v_add_u32 v6, v6, v6
    v_add_u32 v7, v7, v7
    v_add_u32 v8, v8, v8
    v_add_u32 v9, v9, v9
    ds_write_b16 v6, v108 offset:16384
    ds_write_b16_d16_hi v7, v108 offset:16384
    ds_write_b16 v8, v109 offset:16384
    ds_write_b16_d16_hi v9, v109 offset:16384
    v_mov_b32 v6, 1140817920
    s_waitcnt vmcnt(10)
    v_pk_maximum3_f16 v5, v110, v111, v5
    v_mad_u32_u16 v6, v124, s50, v15 op_sel:[0,0,0,0]
    v_mad_u32_u16 v7, v124, s50, v15 op_sel:[1,0,0,0]
    v_mad_u32_u16 v8, v125, s50, v15 op_sel:[0,0,0,0]
    v_mad_u32_u16 v9, v125, s50, v15 op_sel:[1,0,0,0]
    v_add_u32_sdwa v6, v6, v124 dst_sel:DWORD dst_unused:UNUSED_PAD src0_sel:WORD_1 src1_sel:WORD_0
    v_add_u32_sdwa v7, v7, v124 dst_sel:DWORD dst_unused:UNUSED_PAD src0_sel:WORD_1 src1_sel:WORD_1
    v_add_u32_sdwa v8, v8, v125 dst_sel:DWORD dst_unused:UNUSED_PAD src0_sel:WORD_1 src1_sel:WORD_0
    v_add_u32_sdwa v9, v9, v125 dst_sel:DWORD dst_unused:UNUSED_PAD src0_sel:WORD_1 src1_sel:WORD_1
    v_add_u32 v6, v6, v6
    v_add_u32 v7, v7, v7
    v_add_u32 v8, v8, v8
    v_add_u32 v9, v9, v9
    ds_write_b16 v6, v110 offset:16384
    ds_write_b16_d16_hi v7, v110 offset:16384
    ds_write_b16 v8, v111 offset:16384
    ds_write_b16_d16_hi v9, v111 offset:16384
    s_add_u32 s35, s33, 53542912
    buffer_load_dwordx4 v[40:43], v1, s[8:11], s35 offen nt
    v_mov_b32 v6, 1140817920
    s_waitcnt vmcnt(10)
    v_pk_maximum3_f16 v5, v112, v113, v5
    v_mad_u32_u16 v6, v126, s50, v15 op_sel:[0,0,0,0]
    v_mad_u32_u16 v7, v126, s50, v15 op_sel:[1,0,0,0]
    v_mad_u32_u16 v8, v75, s50, v15 op_sel:[0,0,0,0]
    v_mad_u32_u16 v9, v75, s50, v15 op_sel:[1,0,0,0]
    v_add_u32_sdwa v6, v6, v126 dst_sel:DWORD dst_unused:UNUSED_PAD src0_sel:WORD_1 src1_sel:WORD_0
    v_add_u32_sdwa v7, v7, v126 dst_sel:DWORD dst_unused:UNUSED_PAD src0_sel:WORD_1 src1_sel:WORD_1
    v_add_u32_sdwa v8, v8, v75 dst_sel:DWORD dst_unused:UNUSED_PAD src0_sel:WORD_1 src1_sel:WORD_0
    v_add_u32_sdwa v9, v9, v75 dst_sel:DWORD dst_unused:UNUSED_PAD src0_sel:WORD_1 src1_sel:WORD_1
    v_add_u32 v6, v6, v6
    v_add_u32 v7, v7, v7
    v_add_u32 v8, v8, v8
    v_add_u32 v9, v9, v9
    ds_write_b16 v6, v112 offset:16384
    ds_write_b16_d16_hi v7, v112 offset:16384
    ds_write_b16 v8, v113 offset:16384
    ds_write_b16_d16_hi v9, v113 offset:16384
    v_mov_b32 v6, 1140817920
    s_waitcnt vmcnt(9)
    v_pk_maximum3_f16 v5, v114, v115, v5
    v_mad_u32_u16 v6, v79, s50, v15 op_sel:[0,0,0,0]
    v_mad_u32_u16 v7, v79, s50, v15 op_sel:[1,0,0,0]
    v_mad_u32_u16 v8, v83, s50, v15 op_sel:[0,0,0,0]
    v_mad_u32_u16 v9, v83, s50, v15 op_sel:[1,0,0,0]
    v_add_u32_sdwa v6, v6, v79 dst_sel:DWORD dst_unused:UNUSED_PAD src0_sel:WORD_1 src1_sel:WORD_0
    v_add_u32_sdwa v7, v7, v79 dst_sel:DWORD dst_unused:UNUSED_PAD src0_sel:WORD_1 src1_sel:WORD_1
    v_add_u32_sdwa v8, v8, v83 dst_sel:DWORD dst_unused:UNUSED_PAD src0_sel:WORD_1 src1_sel:WORD_0
    v_add_u32_sdwa v9, v9, v83 dst_sel:DWORD dst_unused:UNUSED_PAD src0_sel:WORD_1 src1_sel:WORD_1
    v_add_u32 v6, v6, v6
    v_add_u32 v7, v7, v7
    v_add_u32 v8, v8, v8
    v_add_u32 v9, v9, v9
    ds_write_b16 v6, v114 offset:16384
    ds_write_b16_d16_hi v7, v114 offset:16384
    ds_write_b16 v8, v115 offset:16384
    ds_write_b16_d16_hi v9, v115 offset:16384
    v_mov_b32 v6, 1140817920
    s_waitcnt vmcnt(8)
    v_pk_maximum3_f16 v5, v116, v117, v5
    v_mad_u32_u16 v6, v87, s50, v15 op_sel:[0,0,0,0]
    v_mad_u32_u16 v7, v87, s50, v15 op_sel:[1,0,0,0]
    v_mad_u32_u16 v8, v91, s50, v15 op_sel:[0,0,0,0]
    v_mad_u32_u16 v9, v91, s50, v15 op_sel:[1,0,0,0]
    v_add_u32_sdwa v6, v6, v87 dst_sel:DWORD dst_unused:UNUSED_PAD src0_sel:WORD_1 src1_sel:WORD_0
    v_add_u32_sdwa v7, v7, v87 dst_sel:DWORD dst_unused:UNUSED_PAD src0_sel:WORD_1 src1_sel:WORD_1
    v_add_u32_sdwa v8, v8, v91 dst_sel:DWORD dst_unused:UNUSED_PAD src0_sel:WORD_1 src1_sel:WORD_0
    v_add_u32_sdwa v9, v9, v91 dst_sel:DWORD dst_unused:UNUSED_PAD src0_sel:WORD_1 src1_sel:WORD_1
    v_add_u32 v6, v6, v6
    v_add_u32 v7, v7, v7
    v_add_u32 v8, v8, v8
    v_add_u32 v9, v9, v9
    ds_write_b16 v6, v116 offset:16384
    ds_write_b16_d16_hi v7, v116 offset:16384
    ds_write_b16 v8, v117 offset:16384
    ds_write_b16_d16_hi v9, v117 offset:16384
    s_add_u32 s35, s33, 53542912
    buffer_load_dwordx4 v[44:47], v1, s[12:15], s35 offen nt
    v_mov_b32 v6, 1140817920
    s_mov_b64 exec, s[44:45]
    s_waitcnt vmcnt(8)
    v_pk_maximum3_f16 v5, v118, v119, v5
    s_mov_b64 exec, -1
    s_mov_b64 exec, s[44:45]
    v_mad_u32_u16 v6, v95, s50, v15 op_sel:[0,0,0,0]
    v_mad_u32_u16 v7, v95, s50, v15 op_sel:[1,0,0,0]
    v_mad_u32_u16 v8, v99, s50, v15 op_sel:[0,0,0,0]
    v_mad_u32_u16 v9, v99, s50, v15 op_sel:[1,0,0,0]
    v_add_u32_sdwa v6, v6, v95 dst_sel:DWORD dst_unused:UNUSED_PAD src0_sel:WORD_1 src1_sel:WORD_0
    v_add_u32_sdwa v7, v7, v95 dst_sel:DWORD dst_unused:UNUSED_PAD src0_sel:WORD_1 src1_sel:WORD_1
    v_add_u32_sdwa v8, v8, v99 dst_sel:DWORD dst_unused:UNUSED_PAD src0_sel:WORD_1 src1_sel:WORD_0
    v_add_u32_sdwa v9, v9, v99 dst_sel:DWORD dst_unused:UNUSED_PAD src0_sel:WORD_1 src1_sel:WORD_1
    v_add_u32 v6, v6, v6
    v_add_u32 v7, v7, v7
    v_add_u32 v8, v8, v8
    v_add_u32 v9, v9, v9
    ds_write_b16 v6, v118 offset:16384
    ds_write_b16_d16_hi v7, v118 offset:16384
    ds_write_b16 v8, v119 offset:16384
    ds_write_b16_d16_hi v9, v119 offset:16384
    s_mov_b64 exec, -1
    s_mul_i32 s35, s39, 6144
    v_add_u32 v6, s35, v2
    v_mov_b32 v7, 1140817920
    s_waitcnt lgkmcnt(0)
    s_barrier
    ds_read_b64 v[100:101], v6 offset:23040
    ds_read_b64 v[102:103], v6 offset:16384
    ds_read_b64 v[104:105], v6 offset:16896
    ds_read_b64 v[106:107], v6 offset:17408
    ds_read_b64 v[108:109], v6 offset:17920
    ds_read_b64 v[110:111], v6 offset:18432
    ds_read_b64 v[112:113], v6 offset:18944
    ds_read_b64 v[114:115], v6 offset:19456
    ds_read_b64 v[116:117], v6 offset:19968
    ds_read_b64 v[118:119], v6 offset:20480
    ds_read_b64 v[120:121], v6 offset:20992
    ds_read_b64 v[122:123], v6 offset:21504
    ds_read_b64 v[124:125], v6 offset:22016
    ds_read_b64 v[126:127], v6 offset:22528
    s_add_u32 s32, s32, 256
    s_add_u32 s33, s33, 40960000
    s_add_u32 s34, s34, 20480000
    s_add_u32 s40, s40, 1
    s_cmp_lt_u32 s40, 4
    s_cbranch_scc1 L_p1_loop
    s_cmp_lg_u32 s39, 15
    s_cbranch_scc1 L_p1_kernel_nox_12
    s_waitcnt lgkmcnt(13)
    v_lshlrev_b32 v15, 16, v100
    v_and_b32 v100, 0xffff0000, v100
    v_lshlrev_b32 v101, 16, v101
    v_mul_f32 v15, s41, v15
    v_mul_f32 v100, s41, v100
    v_mul_f32 v101, s41, v101
    v_fract_f32 v15, v15
    v_fract_f32 v100, v100
    v_fract_f32 v101, v101
    v_cos_f32 v15, v15
    v_cos_f32 v100, v100
    v_cos_f32 v101, v101
    v_fmaak_f32 v15, v7, v15, 1262486016
    v_fmaak_f32 v100, v7, v100, 1262486016
    v_fmaak_f32 v101, v7, v101, 1262486016
    v_lshlrev_b32 v15, 22, v15
    v_alignbit_b32 v15, v100, v15, 10
    v_alignbit_b32 v15, v101, v15, 10
    v_xor_b32 v15, 0x80200800, v15
    s_mov_b32 s36, 13631488
    buffer_store_dwordx4 v[12:15], v3, s[20:23], s36 offen sc1
L_p1_kernel_nox_12:
    s_waitcnt lgkmcnt(12)
    v_lshlrev_b32 v75, 16, v102
    v_and_b32 v102, 0xffff0000, v102
    v_lshlrev_b32 v103, 16, v103
    v_mul_f32 v75, s41, v75
    v_mul_f32 v102, s41, v102
    v_mul_f32 v103, s41, v103
    v_fract_f32 v75, v75
    v_fract_f32 v102, v102
    v_fract_f32 v103, v103
    v_cos_f32 v75, v75
    v_cos_f32 v102, v102
    v_cos_f32 v103, v103
    v_fmaak_f32 v75, v7, v75, 1262486016
    v_fmaak_f32 v102, v7, v102, 1262486016
    v_fmaak_f32 v103, v7, v103, 1262486016
    v_lshlrev_b32 v75, 22, v75
    v_alignbit_b32 v75, v102, v75, 10
    v_alignbit_b32 v75, v103, v75, 10
    v_xor_b32 v75, 0x80200800, v75
    s_mov_b32 s36, 0
    buffer_store_dwordx4 v[72:75], v3, s[20:23], s36 offen sc1
    s_waitcnt lgkmcnt(11)
    v_lshlrev_b32 v79, 16, v104
    v_and_b32 v104, 0xffff0000, v104
    v_lshlrev_b32 v105, 16, v105
    v_mul_f32 v79, s41, v79
    v_mul_f32 v104, s41, v104
    v_mul_f32 v105, s41, v105
    v_fract_f32 v79, v79
    v_fract_f32 v104, v104
    v_fract_f32 v105, v105
    v_cos_f32 v79, v79
    v_cos_f32 v104, v104
    v_cos_f32 v105, v105
    v_fmaak_f32 v79, v7, v79, 1262486016
    v_fmaak_f32 v104, v7, v104, 1262486016
    v_fmaak_f32 v105, v7, v105, 1262486016
    v_lshlrev_b32 v79, 22, v79
    v_alignbit_b32 v79, v104, v79, 10
    v_alignbit_b32 v79, v105, v79, 10
    v_xor_b32 v79, 0x80200800, v79
    s_mov_b32 s36, 1048576
    buffer_store_dwordx4 v[76:79], v3, s[20:23], s36 offen sc1
    s_waitcnt lgkmcnt(10)
    v_lshlrev_b32 v51, 16, v106
    v_and_b32 v106, 0xffff0000, v106
    v_lshlrev_b32 v107, 16, v107
    v_mul_f32 v51, s41, v51
    v_mul_f32 v106, s41, v106
    v_mul_f32 v107, s41, v107
    v_fract_f32 v51, v51
    v_fract_f32 v106, v106
    v_fract_f32 v107, v107
    v_cos_f32 v51, v51
    v_cos_f32 v106, v106
    v_cos_f32 v107, v107
    v_fmaak_f32 v51, v7, v51, 1262486016
    v_fmaak_f32 v106, v7, v106, 1262486016
    v_fmaak_f32 v107, v7, v107, 1262486016
    v_lshlrev_b32 v51, 22, v51
    v_alignbit_b32 v51, v106, v51, 10
    v_alignbit_b32 v51, v107, v51, 10
    v_xor_b32 v51, 0x80200800, v51
    s_mov_b32 s36, 2097152
    buffer_store_dwordx4 v[48:51], v3, s[20:23], s36 offen sc1
    s_waitcnt lgkmcnt(9)
    v_lshlrev_b32 v83, 16, v108
    v_and_b32 v108, 0xffff0000, v108
    v_lshlrev_b32 v109, 16, v109
    v_mul_f32 v83, s41, v83
    v_mul_f32 v108, s41, v108
    v_mul_f32 v109, s41, v109
    v_fract_f32 v83, v83
    v_fract_f32 v108, v108
    v_fract_f32 v109, v109
    v_cos_f32 v83, v83
    v_cos_f32 v108, v108
    v_cos_f32 v109, v109
    v_fmaak_f32 v83, v7, v83, 1262486016
    v_fmaak_f32 v108, v7, v108, 1262486016
    v_fmaak_f32 v109, v7, v109, 1262486016
    v_lshlrev_b32 v83, 22, v83
    v_alignbit_b32 v83, v108, v83, 10
    v_alignbit_b32 v83, v109, v83, 10
    v_xor_b32 v83, 0x80200800, v83
    s_mov_b32 s36, 3145728
    buffer_store_dwordx4 v[80:83], v3, s[20:23], s36 offen sc1
    s_waitcnt lgkmcnt(8)
    v_lshlrev_b32 v55, 16, v110
    v_and_b32 v110, 0xffff0000, v110
    v_lshlrev_b32 v111, 16, v111
    v_mul_f32 v55, s41, v55
    v_mul_f32 v110, s41, v110
    v_mul_f32 v111, s41, v111
    v_fract_f32 v55, v55
    v_fract_f32 v110, v110
    v_fract_f32 v111, v111
    v_cos_f32 v55, v55
    v_cos_f32 v110, v110
    v_cos_f32 v111, v111
    v_fmaak_f32 v55, v7, v55, 1262486016
    v_fmaak_f32 v110, v7, v110, 1262486016
    v_fmaak_f32 v111, v7, v111, 1262486016
    v_lshlrev_b32 v55, 22, v55
    v_alignbit_b32 v55, v110, v55, 10
    v_alignbit_b32 v55, v111, v55, 10
    v_xor_b32 v55, 0x80200800, v55
    s_mov_b32 s36, 4194304
    buffer_store_dwordx4 v[52:55], v3, s[20:23], s36 offen sc1
    s_waitcnt lgkmcnt(7)
    v_lshlrev_b32 v87, 16, v112
    v_and_b32 v112, 0xffff0000, v112
    v_lshlrev_b32 v113, 16, v113
    v_mul_f32 v87, s41, v87
    v_mul_f32 v112, s41, v112
    v_mul_f32 v113, s41, v113
    v_fract_f32 v87, v87
    v_fract_f32 v112, v112
    v_fract_f32 v113, v113
    v_cos_f32 v87, v87
    v_cos_f32 v112, v112
    v_cos_f32 v113, v113
    v_fmaak_f32 v87, v7, v87, 1262486016
    v_fmaak_f32 v112, v7, v112, 1262486016
    v_fmaak_f32 v113, v7, v113, 1262486016
    v_lshlrev_b32 v87, 22, v87
    v_alignbit_b32 v87, v112, v87, 10
    v_alignbit_b32 v87, v113, v87, 10
    v_xor_b32 v87, 0x80200800, v87
    s_mov_b32 s36, 5242880
    buffer_store_dwordx4 v[84:87], v3, s[20:23], s36 offen sc1
    s_waitcnt lgkmcnt(6)
    v_lshlrev_b32 v59, 16, v114
    v_and_b32 v114, 0xffff0000, v114
    v_lshlrev_b32 v115, 16, v115
    v_mul_f32 v59, s41, v59
    v_mul_f32 v114, s41, v114
    v_mul_f32 v115, s41, v115
    v_fract_f32 v59, v59
    v_fract_f32 v114, v114
    v_fract_f32 v115, v115
    v_cos_f32 v59, v59
    v_cos_f32 v114, v114
    v_cos_f32 v115, v115
    v_fmaak_f32 v59, v7, v59, 1262486016
    v_fmaak_f32 v114, v7, v114, 1262486016
    v_fmaak_f32 v115, v7, v115, 1262486016
    v_lshlrev_b32 v59, 22, v59
    v_alignbit_b32 v59, v114, v59, 10
    v_alignbit_b32 v59, v115, v59, 10
    v_xor_b32 v59, 0x80200800, v59
    s_mov_b32 s36, 6291456
    buffer_store_dwordx4 v[56:59], v3, s[20:23], s36 offen sc1
    s_waitcnt lgkmcnt(5)
    v_lshlrev_b32 v91, 16, v116
    v_and_b32 v116, 0xffff0000, v116
    v_lshlrev_b32 v117, 16, v117
    v_mul_f32 v91, s41, v91
    v_mul_f32 v116, s41, v116
    v_mul_f32 v117, s41, v117
    v_fract_f32 v91, v91
    v_fract_f32 v116, v116
    v_fract_f32 v117, v117
    v_cos_f32 v91, v91
    v_cos_f32 v116, v116
    v_cos_f32 v117, v117
    v_fmaak_f32 v91, v7, v91, 1262486016
    v_fmaak_f32 v116, v7, v116, 1262486016
    v_fmaak_f32 v117, v7, v117, 1262486016
    v_lshlrev_b32 v91, 22, v91
    v_alignbit_b32 v91, v116, v91, 10
    v_alignbit_b32 v91, v117, v91, 10
    v_xor_b32 v91, 0x80200800, v91
    s_mov_b32 s36, 7340032
    buffer_store_dwordx4 v[88:91], v3, s[20:23], s36 offen sc1
    s_waitcnt lgkmcnt(4)
    v_lshlrev_b32 v63, 16, v118
    v_and_b32 v118, 0xffff0000, v118
    v_lshlrev_b32 v119, 16, v119
    v_mul_f32 v63, s41, v63
    v_mul_f32 v118, s41, v118
    v_mul_f32 v119, s41, v119
    v_fract_f32 v63, v63
    v_fract_f32 v118, v118
    v_fract_f32 v119, v119
    v_cos_f32 v63, v63
    v_cos_f32 v118, v118
    v_cos_f32 v119, v119
    v_fmaak_f32 v63, v7, v63, 1262486016
    v_fmaak_f32 v118, v7, v118, 1262486016
    v_fmaak_f32 v119, v7, v119, 1262486016
    v_lshlrev_b32 v63, 22, v63
    v_alignbit_b32 v63, v118, v63, 10
    v_alignbit_b32 v63, v119, v63, 10
    v_xor_b32 v63, 0x80200800, v63
    s_mov_b32 s36, 8388608
    buffer_store_dwordx4 v[60:63], v3, s[20:23], s36 offen sc1
    s_waitcnt lgkmcnt(3)
    v_lshlrev_b32 v95, 16, v120
    v_and_b32 v120, 0xffff0000, v120
    v_lshlrev_b32 v121, 16, v121
    v_mul_f32 v95, s41, v95
    v_mul_f32 v120, s41, v120
    v_mul_f32 v121, s41, v121
    v_fract_f32 v95, v95
    v_fract_f32 v120, v120
    v_fract_f32 v121, v121
    v_cos_f32 v95, v95
    v_cos_f32 v120, v120
    v_cos_f32 v121, v121
    v_fmaak_f32 v95, v7, v95, 1262486016
    v_fmaak_f32 v120, v7, v120, 1262486016
    v_fmaak_f32 v121, v7, v121, 1262486016
    v_lshlrev_b32 v95, 22, v95
    v_alignbit_b32 v95, v120, v95, 10
    v_alignbit_b32 v95, v121, v95, 10
    v_xor_b32 v95, 0x80200800, v95
    s_mov_b32 s36, 9437184
    buffer_store_dwordx4 v[92:95], v3, s[20:23], s36 offen sc1
    s_waitcnt lgkmcnt(2)
    v_lshlrev_b32 v67, 16, v122
    v_and_b32 v122, 0xffff0000, v122
    v_lshlrev_b32 v123, 16, v123
    v_mul_f32 v67, s41, v67
    v_mul_f32 v122, s41, v122
    v_mul_f32 v123, s41, v123
    v_fract_f32 v67, v67
    v_fract_f32 v122, v122
    v_fract_f32 v123, v123
    v_cos_f32 v67, v67
    v_cos_f32 v122, v122
    v_cos_f32 v123, v123
    v_fmaak_f32 v67, v7, v67, 1262486016
    v_fmaak_f32 v122, v7, v122, 1262486016
    v_fmaak_f32 v123, v7, v123, 1262486016
    v_lshlrev_b32 v67, 22, v67
    v_alignbit_b32 v67, v122, v67, 10
    v_alignbit_b32 v67, v123, v67, 10
    v_xor_b32 v67, 0x80200800, v67
    s_mov_b32 s36, 10485760
    buffer_store_dwordx4 v[64:67], v3, s[20:23], s36 offen sc1
    s_waitcnt lgkmcnt(1)
    v_lshlrev_b32 v99, 16, v124
    v_and_b32 v124, 0xffff0000, v124
    v_lshlrev_b32 v125, 16, v125
    v_mul_f32 v99, s41, v99
    v_mul_f32 v124, s41, v124
    v_mul_f32 v125, s41, v125
    v_fract_f32 v99, v99
    v_fract_f32 v124, v124
    v_fract_f32 v125, v125
    v_cos_f32 v99, v99
    v_cos_f32 v124, v124
    v_cos_f32 v125, v125
    v_fmaak_f32 v99, v7, v99, 1262486016
    v_fmaak_f32 v124, v7, v124, 1262486016
    v_fmaak_f32 v125, v7, v125, 1262486016
    v_lshlrev_b32 v99, 22, v99
    v_alignbit_b32 v99, v124, v99, 10
    v_alignbit_b32 v99, v125, v99, 10
    v_xor_b32 v99, 0x80200800, v99
    s_mov_b32 s36, 11534336
    buffer_store_dwordx4 v[96:99], v3, s[20:23], s36 offen sc1
    s_waitcnt lgkmcnt(0)
    v_lshlrev_b32 v71, 16, v126
    v_and_b32 v126, 0xffff0000, v126
    v_lshlrev_b32 v127, 16, v127
    v_mul_f32 v71, s41, v71
    v_mul_f32 v126, s41, v126
    v_mul_f32 v127, s41, v127
    v_fract_f32 v71, v71
    v_fract_f32 v126, v126
    v_fract_f32 v127, v127
    v_cos_f32 v71, v71
    v_cos_f32 v126, v126
    v_cos_f32 v127, v127
    v_fmaak_f32 v71, v7, v71, 1262486016
    v_fmaak_f32 v126, v7, v126, 1262486016
    v_fmaak_f32 v127, v7, v127, 1262486016
    v_lshlrev_b32 v71, 22, v71
    v_alignbit_b32 v71, v126, v71, 10
    v_alignbit_b32 v71, v127, v71, 10
    v_xor_b32 v71, 0x80200800, v71
    s_mov_b32 s36, 12582912
    buffer_store_dwordx4 v[68:71], v3, s[20:23], s36 offen sc1
    v_and_b32 v6, 0x7c007c00, v5
    v_add_u32 v6, 0x04000400, v6
    v_and_b32 v6, 0x80008000, v6
    v_cmp_ne_u32 vcc, 0, v6
    s_lshl_b32 s35, s39, 4
    s_add_u32 s35, s35, 160328
    v_mov_b32 v10, s35
    s_cmp_lg_u64 vcc, 0
    s_cselect_b32 s36, 1, s55
    v_mov_b32 v11, s36
    ds_write_b32 v10, v11
    s_waitcnt lgkmcnt(0)
    s_barrier
    s_cmp_lg_u32 s39, 0
    s_cbranch_scc1 L_p1_end
    v_and_b32 v6, 15, v0
    v_lshlrev_b32 v6, 4, v6
    v_add_u32 v6, 160320, v6
    ds_read_b128 v[8:11], v6
    s_waitcnt lgkmcnt(0)
    s_nop 1
    v_max_u32_dpp v8, v8, v8 row_shr:1 row_mask:0xf bank_mask:0xf bound_ctrl:0
    s_nop 1
    v_max_u32_dpp v8, v8, v8 row_shr:2 row_mask:0xf bank_mask:0xf bound_ctrl:0
    s_nop 1
    v_max_u32_dpp v8, v8, v8 row_shr:4 row_mask:0xf bank_mask:0xf bound_ctrl:0
    s_nop 1
    v_max_u32_dpp v8, v8, v8 row_shr:8 row_mask:0xf bank_mask:0xf bound_ctrl:0
    s_nop 1
    v_add_f32_dpp v9, v9, v9 row_shr:1 row_mask:0xf bank_mask:0xf bound_ctrl:0
    s_nop 1
    v_add_f32_dpp v9, v9, v9 row_shr:2 row_mask:0xf bank_mask:0xf bound_ctrl:0
    s_nop 1
    v_add_f32_dpp v9, v9, v9 row_shr:4 row_mask:0xf bank_mask:0xf bound_ctrl:0
    s_nop 1
    v_add_f32_dpp v9, v9, v9 row_shr:8 row_mask:0xf bank_mask:0xf bound_ctrl:0
    s_nop 1
    v_or_b32_dpp v10, v10, v10 row_shr:1 row_mask:0xf bank_mask:0xf bound_ctrl:0
    s_nop 1
    v_or_b32_dpp v10, v10, v10 row_shr:2 row_mask:0xf bank_mask:0xf bound_ctrl:0
    s_nop 1
    v_or_b32_dpp v10, v10, v10 row_shr:4 row_mask:0xf bank_mask:0xf bound_ctrl:0
    s_nop 1
    v_or_b32_dpp v10, v10, v10 row_shr:8 row_mask:0xf bank_mask:0xf bound_ctrl:0
    s_lshl_b32 s35, s2, 3
    s_mov_b32 s26, 8540160
    s_add_u32 s35, s35, 8519680
    v_mov_b32 v6, 0
    v_lshl_or_b32 v8, v10, 16, v8
    s_mov_b64 exec, 0x8000
    buffer_store_dwordx2 v[8:9], v6, s[24:27], s35 offen
    s_lshl_b32 s35, s2, 8
    s_add_u32 s35, s35, 8523776
    buffer_store_dword v6, v6, s[24:27], s35 offen
L_p1_end:
    s_endpgm
.globl p2_kernel
.p2align 8
.type p2_kernel,@function
p2_kernel:
    s_cmp_ge_u32 s2, 256
    s_cbranch_scc1 L_p2_end
    s_load_dwordx2 s[4:5], s[0:1], 104
    s_load_dwordx2 s[100:101], s[0:1], 24
    s_load_dwordx2 s[8:9], s[0:1], 0
    s_load_dwordx2 s[30:31], s[0:1], 40
    s_load_dwordx4 s[32:35], s[0:1], 56
    s_load_dwordx4 s[36:39], s[0:1], 72
    s_and_b32 s14, s2, 7
    s_lshr_b32 s49, s2, 3
    s_and_b32 s3, s14, 1
    s_lshl_b32 s3, s3, 5
    s_add_u32 s3, s3, s49
    s_lshr_b32 s12, s14, 1
    v_lshrrev_b32 v108, 6, v0
    v_lshlrev_b32 v1, 4, v0
    v_and_b32 v109, 63, v0
    v_readfirstlane_b32 s13, v108
    v_lshlrev_b32 v111, 4, v109
    v_lshrrev_b32 v110, 2, v109
    v_mul_u32_u24 v110, 8256, v110
    v_add_u32 v110, v110, v111
    s_mul_i32 s14, s12, 65
    s_add_u32 s14, s14, s3
    s_lshl_b32 s14, s14, 5
    s_mul_i32 s15, s13, 532480
    s_add_u32 s14, s14, s15
    s_add_u32 s25, s14, 0
    s_mul_i32 s22, s12, 1280000
    s_mov_b32 s2, 0
    s_waitcnt lgkmcnt(0)
    s_mov_b32 s6, 655360000
    s_mov_b32 s7, 0x00020000
    s_add_u32 s10, s22, 1280000
    s_mov_b32 s11, 0x00020000
    s_add_u32 s15, s25, 0
    buffer_load_dwordx4 v[28:31], v110, s[4:7], s15 offen
    s_add_u32 s15, s25, 133120
    buffer_load_dwordx4 v[32:35], v110, s[4:7], s15 offen
    s_add_u32 s15, s25, 266240
    buffer_load_dwordx4 v[36:39], v110, s[4:7], s15 offen
    s_add_u32 s15, s25, 399360
    buffer_load_dwordx4 v[40:43], v110, s[4:7], s15 offen
    s_load_dwordx4 s[40:43], s[30:31], 0
    s_load_dwordx16 s[52:67], s[32:33], 0
    s_load_dwordx16 s[68:83], s[34:35], 0
    s_load_dwordx8 s[84:91], s[36:37], 0
    s_load_dwordx8 s[92:99], s[38:39], 0
    v_mov_b32 v52, 0x100
    s_cmp_lg_u32 s13, 0
    s_cbranch_scc1 L_p2_noann
    s_lshl_b32 s14, s3, 8
    s_add_u32 s14, s14, 8523776
    s_mov_b64 exec, 1
    buffer_atomic_add v52, off, s[4:7], s14
    s_mov_b64 exec, -1
L_p2_noann:
    s_add_u32 s14, s22, 0
    buffer_load_dwordx4 v[88:91], v1, s[8:11], s14 offen
    s_add_u32 s14, s22, 16384
    buffer_load_dwordx4 v[92:95], v1, s[8:11], s14 offen
    s_add_u32 s14, s22, 32768
    buffer_load_dwordx4 v[96:99], v1, s[8:11], s14 offen
    s_add_u32 s14, s22, 49152
    buffer_load_dwordx4 v[100:103], v1, s[8:11], s14 offen
    s_add_u32 s14, s22, 65536
    buffer_load_dwordx4 v[104:107], v1, s[8:11], s14 offen
    s_mov_b32 s15, 8519680
    buffer_load_dwordx4 v[80:83], v111, s[4:7], s15 offen offset:0
    buffer_load_dwordx4 v[84:87], v111, s[4:7], s15 offen offset:1024
    v_lshlrev_b32 v2, 10, v109
    v_mov_b32 v50, 21845
    v_add_u32 v3, 80000, v1
    v_add_u32 v124, 145536, v1
    v_add_u32 v113, 65536, v1
    v_mov_b32 v112, 0x7f000000
    v_cmp_gt_u32 vcc, 904, v0
    s_mul_i32 s19, s13, 240
    s_add_u32 s19, s19, 160000
    v_cndmask_b32 v124, v112, v124, vcc
    v_cndmask_b32 v113, v112, v113, vcc
    v_lshl_add_u32 v6, v109, 2, s19
    v_lshl_add_u32 v126, v109, 1, s19
    v_cmp_gt_u32 vcc, 10, v109
    s_lshl_b32 s27, s13, 16
    s_mov_b32 s23, 1024
    v_cndmask_b32 v6, v112, v6, vcc
    s_add_u32 s44, s4, 4194304
    s_addc_u32 s45, s5, 1048576
    s_mov_b32 s46, 14024704
    s_mov_b32 s47, 0x00020000
    s_mov_b32 s18, 80000
    s_and_b32 s50, s3, 1
    s_lshl_b32 s50, s50, 18
    s_sub_u32 s18, s18, s50
    s_sub_u32 s50, 4294836224, s50
    v_lshlrev_b32 v116, 3, v0
    v_and_b32 v116, 16, v116
    v_and_b32 v117, 1, v0
    v_lshl_or_b32 v116, v117, 5, v116
    v_mov_b32 v58, 0x3f80
    v_mov_b32 v59, 0
    v_lshlrev_b64 v[58:59], v116, v[58:59]
    v_mov_b32 v4, 0
    v_mov_b32 v5, 0
    v_mov_b32 v114, 0xff00
    v_bfe_u32 v127, v0, 0, 1
    v_mul_u32_u24 v127, 40, v127
    v_add_u32 v127, s19, v127
    ds_write2_b32 v6, v5, v5 offset0:34 offset1:44
    ds_write_b16 v126, v114 offset:2
    v_mov_b32 v44, 1073758208
    v_mov_b32 v45, 1073758208
    v_mov_b32 v46, 1073758208
    v_mov_b32 v47, 1073758208
    v_mov_b32 v48, 1073758208
    v_mov_b32 v49, 1073758208
    ds_write_b128 v113, v[44:47]
    v_lshrrev_b32 v115, 4, v109
    v_mul_u32_u24 v115, 15360, v115
    v_lshl_add_u32 v115, v109, 6, v115
    v_lshl_add_u32 v115, v108, 10, v115
    s_waitcnt lgkmcnt(0)
    v_mov_b32 v53, s40
    v_mov_b32 v54, s41
    v_mov_b32 v56, s42
    v_mov_b32 v57, s43
    s_mov_b32 s40, 20987904
    s_mov_b32 s41, 21031594
    s_pack_ll_b32_b16 s14, s52, s54
    s_pack_hh_b32_b16 s15, s52, s54
    s_pack_ll_b32_b16 s54, s53, s55
    s_pack_hh_b32_b16 s55, s53, s55
    s_mov_b32 s52, s14
    s_mov_b32 s53, s15
    s_pack_ll_b32_b16 s14, s56, s58
    s_pack_hh_b32_b16 s15, s56, s58
    s_pack_ll_b32_b16 s58, s57, s59
    s_pack_hh_b32_b16 s59, s57, s59
    s_mov_b32 s56, s14
    s_mov_b32 s57, s15
    s_pack_ll_b32_b16 s14, s60, s62
    s_pack_hh_b32_b16 s15, s60, s62
    s_pack_ll_b32_b16 s62, s61, s63
    s_pack_hh_b32_b16 s63, s61, s63
    s_mov_b32 s60, s14
    s_mov_b32 s61, s15
    s_pack_ll_b32_b16 s14, s64, s66
    s_pack_hh_b32_b16 s15, s64, s66
    s_pack_ll_b32_b16 s66, s65, s67
    s_pack_hh_b32_b16 s67, s65, s67
    s_mov_b32 s64, s14
    s_mov_b32 s65, s15
    s_pack_ll_b32_b16 s14, s68, s70
    s_pack_hh_b32_b16 s15, s68, s70
    s_pack_ll_b32_b16 s70, s69, s71
    s_pack_hh_b32_b16 s71, s69, s71
    s_mov_b32 s68, s14
    s_mov_b32 s69, s15
    s_pack_ll_b32_b16 s14, s72, s74
    s_pack_hh_b32_b16 s15, s72, s74
    s_pack_ll_b32_b16 s74, s73, s75
    s_pack_hh_b32_b16 s75, s73, s75
    s_mov_b32 s72, s14
    s_mov_b32 s73, s15
    s_pack_ll_b32_b16 s14, s76, s78
    s_pack_hh_b32_b16 s15, s76, s78
    s_pack_ll_b32_b16 s78, s77, s79
    s_pack_hh_b32_b16 s79, s77, s79
    s_mov_b32 s76, s14
    s_mov_b32 s77, s15
    s_pack_ll_b32_b16 s14, s80, s82
    s_pack_hh_b32_b16 s15, s80, s82
    s_pack_ll_b32_b16 s82, s81, s83
    s_pack_hh_b32_b16 s83, s81, s83
    s_mov_b32 s80, s14
    s_mov_b32 s81, s15
    s_waitcnt vmcnt(10)
    ds_write_b128 v1, v[28:31] offset:0
    s_waitcnt vmcnt(9)
    ds_write_b128 v1, v[32:35] offset:16384
    s_waitcnt vmcnt(8)
    ds_write_b128 v1, v[36:39] offset:32768
    s_waitcnt vmcnt(7)
    ds_write_b128 v1, v[40:43] offset:49152
    ds_read_b128 v[28:31], v115 offset:0
    ds_read_b128 v[36:39], v115 offset:32
    ds_read_b128 v[32:35], v115 offset:16
    ds_read_b128 v[40:43], v115 offset:48
    ds_write_b128 v1, v[44:47] offset:0
    ds_write_b128 v1, v[44:47] offset:16384
    ds_write_b128 v1, v[44:47] offset:32768
    ds_write_b128 v1, v[44:47] offset:49152
    s_waitcnt lgkmcnt(6)
    v_mad_u32_u16 v108, v28, v50, s40 op_sel:[0,0,0,0]
    v_mad_u32_u16 v109, v36, v50, s41 op_sel:[0,0,0,0]
    v_sub_u32_sdwa v110, v109, v108 dst_sel:DWORD dst_unused:UNUSED_PAD src0_sel:WORD_1 src1_sel:WORD_1
    s_nop 1
    v_add_u32_dpp v110, v110, v110 row_shr:1 row_mask:0xf bank_mask:0xf bound_ctrl:0
    s_nop 1
    v_add_u32_dpp v110, v110, v110 row_shr:2 row_mask:0xf bank_mask:0xf bound_ctrl:0
    s_nop 1
    v_add_u32_dpp v110, v110, v110 row_shr:4 row_mask:0xf bank_mask:0xf bound_ctrl:0
    s_nop 1
    v_add_u32_dpp v110, v110, v110 row_shr:8 row_mask:0xf bank_mask:0xf bound_ctrl:0
    s_nop 1
    v_add_u32_dpp v110, v110, v110 row_bcast:15 row_mask:0xa bank_mask:0xf
    s_nop 1
    v_add_u32_dpp v110, v110, v110 row_bcast:31 row_mask:0xc bank_mask:0xf
    v_sub_u32_sdwa v109, v109, v110 dst_sel:DWORD dst_unused:UNUSED_PAD src0_sel:WORD_1 src1_sel:DWORD
    v_readlane_b32 s29, v110, 63
    v_add_u32 v110, -1, v110
    ds_write_b16 v126, v109
    v_lshlrev_b32_e64 v111, v110, 1
    v_lshrrev_b32 v110, 5, v110
    s_cmp_gt_u32 s29, 320
    s_cselect_b32 s2, 1, s2
    v_lshl_add_u32 v110, v110, 2, v127
    s_cselect_b64 exec, 0, -1
    ds_or_b32 v110, v111 offset:136
    s_mov_b64 exec, -1
    ds_wrxchg2_rtn_b32 v[108:109], v6, v5, v5 offset0:34 offset1:44
    s_waitcnt lgkmcnt(0)
    v_or_b32 v7, v108, v109
    s_nop 0
    v_readlane_b32 s30, v7, 0
    v_readlane_b32 s31, v7, 1
    v_readlane_b32 s32, v7, 2
    v_readlane_b32 s33, v7, 3
    v_readlane_b32 s34, v7, 4
    v_readlane_b32 s35, v7, 5
    v_readlane_b32 s36, v7, 6
    v_readlane_b32 s37, v7, 7
    s_mov_b32 s25, s19
    s_mov_b32 s26, s27
    s_mov_b32 s51, s28
    s_mov_b32 s28, s29
    v_mbcnt_lo_u32_b32 v8, s30, 0
    v_mbcnt_hi_u32_b32 v8, s31, v8
    s_bcnt1_i32_b64 s14, s[30:31]
    v_lshl_add_u32 v9, v8, 1, s25
    ds_read_u16 v9, v9
    s_add_u32 s30, s26, 0
    s_lshl1_add_u32 s25, s14, s25
    s_lshl_b32 s14, s14, 10
    s_add_u32 s26, s26, s14
    v_mbcnt_lo_u32_b32 v12, s32, 0
    v_mbcnt_hi_u32_b32 v12, s33, v12
    s_bcnt1_i32_b64 s14, s[32:33]
    v_lshl_add_u32 v13, v12, 1, s25
    ds_read_u16 v13, v13
    s_add_u32 s32, s26, 1048576
    s_lshl1_add_u32 s25, s14, s25
    s_lshl_b32 s14, s14, 10
    s_add_u32 s26, s26, s14
    v_mbcnt_lo_u32_b32 v16, s34, 0
    v_mbcnt_hi_u32_b32 v16, s35, v16
    s_bcnt1_i32_b64 s14, s[34:35]
    v_lshl_add_u32 v17, v16, 1, s25
    ds_read_u16 v17, v17
    s_add_u32 s34, s26, 2097152
    s_lshl1_add_u32 s25, s14, s25
    s_lshl_b32 s14, s14, 10
    s_add_u32 s26, s26, s14
    v_mbcnt_lo_u32_b32 v20, s36, 0
    v_mbcnt_hi_u32_b32 v20, s37, v20
    s_bcnt1_i32_b64 s14, s[36:37]
    v_lshl_add_u32 v21, v20, 1, s25
    ds_read_u16 v21, v21
    s_add_u32 s36, s26, 3145728
    s_lshl1_add_u32 s25, s14, s25
    s_lshl_b32 s14, s14, 10
    s_add_u32 s26, s26, s14
    s_waitcnt lgkmcnt(3)
    v_mad_u32_u16 v9, v9, s23, v2
    v_pk_lshrrev_b16 v9, 10, v9 op_sel_hi:[1,1]
    v_lshl_add_u32 v8, v8, 6, v9
    buffer_load_dwordx4 v[8:11], v8, s[44:47], s30 idxen
    s_waitcnt lgkmcnt(2)
    v_mad_u32_u16 v13, v13, s23, v2
    v_pk_lshrrev_b16 v13, 10, v13 op_sel_hi:[1,1]
    v_lshl_add_u32 v12, v12, 6, v13
    buffer_load_dwordx4 v[12:15], v12, s[44:47], s32 idxen
    s_waitcnt lgkmcnt(1)
    v_mad_u32_u16 v17, v17, s23, v2
    v_pk_lshrrev_b16 v17, 10, v17 op_sel_hi:[1,1]
    v_lshl_add_u32 v16, v16, 6, v17
    buffer_load_dwordx4 v[16:19], v16, s[44:47], s34 idxen
    s_waitcnt lgkmcnt(0)
    v_mad_u32_u16 v21, v21, s23, v2
    v_pk_lshrrev_b16 v21, 10, v21 op_sel_hi:[1,1]
    v_lshl_add_u32 v20, v20, 6, v21
    buffer_load_dwordx4 v[20:23], v20, s[44:47], s36 idxen
    s_cmp_le_u32 s28, 256
    s_cbranch_scc1 L_p2_kernel_noopt_1
    v_readlane_b32 s38, v7, 8
    v_readlane_b32 s39, v7, 9
    s_nop 1
    v_mbcnt_lo_u32_b32 v51, s38, 0
    v_mbcnt_hi_u32_b32 v51, s39, v51
    s_bcnt1_i32_b64 s14, s[38:39]
    v_lshl_add_u32 v55, v51, 1, s25
    ds_read_u16 v55, v55
    s_add_u32 s38, s26, 4194304
    s_lshl1_add_u32 s25, s14, s25
    s_lshl_b32 s14, s14, 10
    s_add_u32 s26, s26, s14
    s_waitcnt lgkmcnt(0)
    v_mad_u32_u16 v55, v55, s23, v2
    v_pk_lshrrev_b16 v55, 10, v55 op_sel_hi:[1,1]
    v_lshl_add_u32 v51, v51, 6, v55
    buffer_load_dwordx4 v[24:27], v51, s[44:47], s38 idxen
L_p2_kernel_noopt_1:
    s_waitcnt vmcnt(6)
    ds_write_b128 v3, v[88:91] offset:0
    ds_write_b128 v3, v[92:95] offset:16384
    ds_write_b128 v3, v[96:99] offset:32768
    ds_write_b128 v3, v[100:103] offset:49152
    ds_write_b128 v124, v[104:107] offset:0
    s_waitcnt vmcnt(4)
    v_max3_u32 v64, v80, v82, v84
    v_add_f32 v65, v81, v83
    v_add_f32 v66, v85, v87
    v_max_u32 v64, v64, v86
    v_add_f32 v65, v65, v66
    v_cmp_lt_u32 vcc, 0xffff, v64
    s_nop 1
    v_max_u32_dpp v64, v64, v64 row_shr:1 row_mask:0xf bank_mask:0xf bound_ctrl:0
    s_nop 1
    v_max_u32_dpp v64, v64, v64 row_shr:2 row_mask:0xf bank_mask:0xf bound_ctrl:0
    s_nop 1
    v_max_u32_dpp v64, v64, v64 row_shr:4 row_mask:0xf bank_mask:0xf bound_ctrl:0
    s_nop 1
    v_max_u32_dpp v64, v64, v64 row_shr:8 row_mask:0xf bank_mask:0xf bound_ctrl:0
    s_nop 1
    v_max_u32_dpp v64, v64, v64 row_bcast:15 row_mask:0xa bank_mask:0xf
    s_nop 1
    v_max_u32_dpp v64, v64, v64 row_bcast:31 row_mask:0xc bank_mask:0xf
    s_nop 1
    v_add_f32_dpp v65, v65, v65 row_shr:1 row_mask:0xf bank_mask:0xf bound_ctrl:0
    s_nop 1
    v_add_f32_dpp v65, v65, v65 row_shr:2 row_mask:0xf bank_mask:0xf bound_ctrl:0
    s_nop 1
    v_add_f32_dpp v65, v65, v65 row_shr:4 row_mask:0xf bank_mask:0xf bound_ctrl:0
    s_nop 1
    v_add_f32_dpp v65, v65, v65 row_shr:8 row_mask:0xf bank_mask:0xf bound_ctrl:0
    s_nop 1
    v_add_f32_dpp v65, v65, v65 row_bcast:15 row_mask:0xa bank_mask:0xf
    s_nop 1
    v_add_f32_dpp v65, v65, v65 row_bcast:31 row_mask:0xc bank_mask:0xf
    s_cmp_lg_u64 vcc, 0
    s_cselect_b32 s2, 1, s2
    v_lshlrev_b32 v64, 16, v64
    v_mul_f32 v66, 936490775, v65
    v_mul_f32 v65, 928531664, v65
    v_cmp_nle_f32 vcc, v64, v66
    v_max_u32 v64, v64, v65
    s_nop 0
    v_readlane_b32 s14, v64, 63
    s_bitcmp1_b32 vcc_hi, 31
    s_cselect_b32 s2, 1, s2
    s_lshr_b32 s14, s14, 23
    s_add_u32 s14, s14, 1
    s_cmp_lt_u32 s14, 40
    s_cselect_b32 s2, 1, s2
    s_cmp_gt_u32 s14, 230
    s_cselect_b32 s2, 1, s2
    s_sub_u32 s48, s14, 14
    s_lshl_b32 s48, s48, 23
    s_add_u32 s16, s48, 272629760
    s_lshr_b32 s15, s16, 16
    s_sub_u32 s15, 0x10000, s15
    s_add_u32 s20, s16, s15
    s_sub_u32 s17, s20, 1
    s_mov_b32 s21, s17
    s_or_b32 s48, s48, 16416
    s_sub_u32 s14, s14, 40
    s_cmp_gt_u32 s14, 190
    s_cselect_b32 s48, 0, s48
    s_waitcnt lgkmcnt(0)
    s_barrier
    s_add_u32 s14, s22, 80000
    buffer_load_dwordx4 v[88:91], v1, s[8:11], s14 offen
    s_add_u32 s14, s22, 96384
    buffer_load_dwordx4 v[92:95], v1, s[8:11], s14 offen
    v_mad_u32_u16 v108, v28, v50, s40 op_sel:[1,0,0,0]
    v_mad_u32_u16 v109, v36, v50, s41 op_sel:[1,0,0,0]
    v_sub_u32_sdwa v110, v109, v108 dst_sel:DWORD dst_unused:UNUSED_PAD src0_sel:WORD_1 src1_sel:WORD_1
    s_nop 1
    v_add_u32_dpp v110, v110, v110 row_shr:1 row_mask:0xf bank_mask:0xf bound_ctrl:0
    s_nop 1
    v_add_u32_dpp v110, v110, v110 row_shr:2 row_mask:0xf bank_mask:0xf bound_ctrl:0
    s_nop 1
    v_add_u32_dpp v110, v110, v110 row_shr:4 row_mask:0xf bank_mask:0xf bound_ctrl:0
    s_nop 1
    v_add_u32_dpp v110, v110, v110 row_shr:8 row_mask:0xf bank_mask:0xf bound_ctrl:0
    s_nop 1
    v_add_u32_dpp v110, v110, v110 row_bcast:15 row_mask:0xa bank_mask:0xf
    s_nop 1
    v_add_u32_dpp v110, v110, v110 row_bcast:31 row_mask:0xc bank_mask:0xf
    v_sub_u32_sdwa v109, v109, v110 dst_sel:DWORD dst_unused:UNUSED_PAD src0_sel:WORD_1 src1_sel:DWORD
    v_readlane_b32 s29, v110, 63
    v_add_u32 v110, -1, v110
    ds_write_b16 v126, v109
    v_lshlrev_b32_e64 v111, v110, 1
    v_lshrrev_b32 v110, 5, v110
    s_cmp_gt_u32 s29, 320
    s_cselect_b32 s2, 1, s2
    v_lshl_add_u32 v110, v110, 2, v127
    s_cselect_b64 exec, 0, -1
    ds_or_b32 v110, v111 offset:136
    s_mov_b64 exec, -1
    ds_wrxchg2_rtn_b32 v[108:109], v6, v5, v5 offset0:34 offset1:44
    s_mov_b32 s24, 0
L_p2_loop:
    s_add_u32 s22, s22, 80000
    s_lshl_b32 s14, s13, 4
    s_or_b32 s14, s14, s24
    s_cmp_lg_u32 s14, 5
    s_cbranch_scc1 L_p2_nost
    v_mov_b32 v52, 0
    s_lshl_b32 s14, s3, 8
    s_add_u32 s14, s14, 8523776
    s_mov_b64 exec, 1
    buffer_atomic_add v52, off, s[4:7], s14 sc0
    s_mov_b64 exec, -1
L_p2_nost:
    s_waitcnt vmcnt(5)
    v_mad_u32_u16 v64, v8, 8, s18
    v_mad_u32_u16 v66, v9, 8, s18
    v_mad_u32_u16 v68, v10, 8, s18
    ds_read_b64 v[64:65], v64
    ds_read_b64 v[66:67], v66
    ds_read_b64 v[68:69], v68
    s_add_u32 s14, s22, 32768
    buffer_load_dwordx4 v[96:99], v1, s[8:11], s14 offen
    s_waitcnt vmcnt(5)
    v_mad_u32_u16 v70, v12, 8, s18
    v_mad_u32_u16 v72, v13, 8, s18
    v_mad_u32_u16 v74, v14, 8, s18
    ds_read_b64 v[70:71], v70
    ds_read_b64 v[72:73], v72
    ds_read_b64 v[74:75], v74
    s_add_u32 s14, s22, 49152
    buffer_load_dwordx4 v[100:103], v1, s[8:11], s14 offen
    s_waitcnt lgkmcnt(6)
    v_or_b32 v7, v108, v109
    s_nop 0
    v_readlane_b32 s30, v7, 0
    v_readlane_b32 s31, v7, 1
    v_readlane_b32 s32, v7, 2
    v_readlane_b32 s33, v7, 3
    v_readlane_b32 s34, v7, 4
    v_readlane_b32 s35, v7, 5
    v_readlane_b32 s36, v7, 6
    v_readlane_b32 s37, v7, 7
    s_mov_b32 s25, s19
    s_mov_b32 s26, s27
    s_mov_b32 s51, s28
    s_mov_b32 s28, s29
    v_mbcnt_lo_u32_b32 v51, s30, 0
    v_mbcnt_hi_u32_b32 v51, s31, v51
    s_bcnt1_i32_b64 s14, s[30:31]
    v_lshl_add_u32 v55, v51, 1, s25
    ds_read_u16 v55, v55
    s_add_u32 s30, s26, 0
    s_lshl1_add_u32 s25, s14, s25
    s_lshl_b32 s14, s14, 10
    s_add_u32 s26, s26, s14
    v_bfe_i32 v108, v11, 2, 10
    v_bfe_i32 v109, v11, 12, 10
    v_ashrrev_i32 v110, 22, v11
    v_cvt_f32_i32 v108, v108
    v_cvt_f32_i32 v109, v109
    v_cvt_f32_i32 v110, v110
    s_waitcnt lgkmcnt(4)
    v_mfma_f32_4x4x4_16b_bf16 v[112:115], v[58:59], v[64:65], 0
    v_mfma_f32_4x4x4_16b_bf16 v[116:119], v[58:59], v[66:67], 0
    v_mfma_f32_4x4x4_16b_bf16 v[120:123], v[58:59], v[68:69], 0
    v_mad_u32_u16 v8, v8, 8, s50 op_sel:[1,0,0,0]
    v_mad_u32_u16 v9, v9, 8, s50 op_sel:[1,0,0,0]
    v_mad_u32_u16 v10, v10, 8, s50 op_sel:[1,0,0,0]
    v_pk_fma_f32 v[114:115], v[114:115], v[108:109], s[20:21] op_sel:[0,0,0] op_sel_hi:[1,0,1]
    v_pk_fma_f32 v[112:113], v[112:113], v[108:109], s[16:17] op_sel:[0,0,0] op_sel_hi:[1,0,1]
    v_pk_fma_f32 v[118:119], v[118:119], v[108:109], s[20:21] op_sel:[0,1,0] op_sel_hi:[1,1,1]
    v_pk_fma_f32 v[116:117], v[116:117], v[108:109], s[16:17] op_sel:[0,1,0] op_sel_hi:[1,1,1]
    v_pk_fma_f32 v[122:123], v[122:123], v[110:111], s[20:21] op_sel:[0,0,0] op_sel_hi:[1,0,1]
    v_pk_fma_f32 v[120:121], v[120:121], v[110:111], s[16:17] op_sel:[0,0,0] op_sel_hi:[1,0,1]
    v_lshlrev_b64 v[114:115], 16, v[114:115]
    v_lshlrev_b64 v[118:119], 16, v[118:119]
    v_lshlrev_b64 v[122:123], 16, v[122:123]
    v_lshl_add_u64 v[64:65], v[112:113], 0, v[114:115]
    v_lshl_add_u64 v[66:67], v[116:117], 0, v[118:119]
    v_lshl_add_u64 v[68:69], v[120:121], 0, v[122:123]
    v_or3_b32 v4, v44, v45, v4
    v_or3_b32 v4, v46, v47, v4
    v_or3_b32 v4, v48, v49, v4
    ds_add_rtn_u64 v[44:45], v8, v[64:65]
    ds_add_rtn_u64 v[46:47], v9, v[66:67]
    ds_add_rtn_u64 v[48:49], v10, v[68:69]
    s_waitcnt lgkmcnt(3)
    v_mad_u32_u16 v55, v55, s23, v2
    v_pk_lshrrev_b16 v55, 10, v55 op_sel_hi:[1,1]
    v_lshl_add_u32 v51, v51, 6, v55
    buffer_load_dwordx4 v[8:11], v51, s[44:47], s30 idxen
    s_add_u32 s14, s22, 65536
    buffer_load_dwordx4 v[104:107], v1, s[8:11], s14 offen
    s_waitcnt vmcnt(7)
    v_mad_u32_u16 v76, v16, 8, s18
    v_mad_u32_u16 v78, v17, 8, s18
    v_mad_u32_u16 v80, v18, 8, s18
    ds_read_b64 v[76:77], v76
    ds_read_b64 v[78:79], v78
    ds_read_b64 v[80:81], v80
    s_waitcnt vmcnt(6)
    v_mad_u32_u16 v82, v20, 8, s18
    v_mad_u32_u16 v84, v21, 8, s18
    v_mad_u32_u16 v86, v22, 8, s18
    ds_read_b64 v[82:83], v82
    ds_read_b64 v[84:85], v84
    ds_read_b64 v[86:87], v86
    s_cmp_le_u32 s51, 256
    s_cbranch_scc1 L_p2_kernel_noopt3_2
    v_mad_u32_u16 v64, v24, 8, s18
    v_mad_u32_u16 v66, v25, 8, s18
    v_mad_u32_u16 v68, v26, 8, s18
    ds_read_b64 v[64:65], v64
    ds_read_b64 v[66:67], v66
    ds_read_b64 v[68:69], v68
L_p2_kernel_noopt3_2:
    v_mbcnt_lo_u32_b32 v51, s32, 0
    v_mbcnt_hi_u32_b32 v51, s33, v51
    s_bcnt1_i32_b64 s14, s[32:33]
    v_lshl_add_u32 v55, v51, 1, s25
    ds_read_u16 v55, v55
    s_add_u32 s32, s26, 1048576
    s_lshl1_add_u32 s25, s14, s25
    s_lshl_b32 s14, s14, 10
    s_add_u32 s26, s26, s14
    v_bfe_i32 v108, v15, 2, 10
    v_bfe_i32 v109, v15, 12, 10
    v_ashrrev_i32 v110, 22, v15
    v_cvt_f32_i32 v108, v108
    v_cvt_f32_i32 v109, v109
    v_cvt_f32_i32 v110, v110
    v_mfma_f32_4x4x4_16b_bf16 v[112:115], v[58:59], v[70:71], 0
    v_mfma_f32_4x4x4_16b_bf16 v[116:119], v[58:59], v[72:73], 0
    v_mfma_f32_4x4x4_16b_bf16 v[120:123], v[58:59], v[74:75], 0
    v_mad_u32_u16 v12, v12, 8, s50 op_sel:[1,0,0,0]
    v_mad_u32_u16 v13, v13, 8, s50 op_sel:[1,0,0,0]
    v_mad_u32_u16 v14, v14, 8, s50 op_sel:[1,0,0,0]
    v_pk_fma_f32 v[114:115], v[114:115], v[108:109], s[20:21] op_sel:[0,0,0] op_sel_hi:[1,0,1]
    v_pk_fma_f32 v[112:113], v[112:113], v[108:109], s[16:17] op_sel:[0,0,0] op_sel_hi:[1,0,1]
    v_pk_fma_f32 v[118:119], v[118:119], v[108:109], s[20:21] op_sel:[0,1,0] op_sel_hi:[1,1,1]
    v_pk_fma_f32 v[116:117], v[116:117], v[108:109], s[16:17] op_sel:[0,1,0] op_sel_hi:[1,1,1]
    v_pk_fma_f32 v[122:123], v[122:123], v[110:111], s[20:21] op_sel:[0,0,0] op_sel_hi:[1,0,1]
    v_pk_fma_f32 v[120:121], v[120:121], v[110:111], s[16:17] op_sel:[0,0,0] op_sel_hi:[1,0,1]
    v_lshlrev_b64 v[114:115], 16, v[114:115]
    v_lshlrev_b64 v[118:119], 16, v[118:119]
    v_lshlrev_b64 v[122:123], 16, v[122:123]
    v_lshl_add_u64 v[70:71], v[112:113], 0, v[114:115]
    v_lshl_add_u64 v[72:73], v[116:117], 0, v[118:119]
    v_lshl_add_u64 v[74:75], v[120:121], 0, v[122:123]
    s_waitcnt lgkmcnt(7)
    v_or3_b32 v4, v44, v45, v4
    v_or3_b32 v4, v46, v47, v4
    v_or3_b32 v4, v48, v49, v4
    ds_add_rtn_u64 v[44:45], v12, v[70:71]
    ds_add_rtn_u64 v[46:47], v13, v[72:73]
    ds_add_rtn_u64 v[48:49], v14, v[74:75]
    s_waitcnt lgkmcnt(3)
    v_mad_u32_u16 v55, v55, s23, v2
    v_pk_lshrrev_b16 v55, 10, v55 op_sel_hi:[1,1]
    v_lshl_add_u32 v51, v51, 6, v55
    buffer_load_dwordx4 v[12:15], v51, s[44:47], s32 idxen
    s_barrier
    s_waitcnt vmcnt(1)
    ds_write_b128 v3, v[88:91] offset:0
    ds_write_b128 v3, v[92:95] offset:16384
    ds_write_b128 v3, v[96:99] offset:32768
    ds_write_b128 v3, v[100:103] offset:49152
    ds_write_b128 v124, v[104:107] offset:0
    v_mbcnt_lo_u32_b32 v51, s34, 0
    v_mbcnt_hi_u32_b32 v51, s35, v51
    s_bcnt1_i32_b64 s14, s[34:35]
    v_lshl_add_u32 v55, v51, 1, s25
    ds_read_u16 v55, v55
    s_add_u32 s34, s26, 2097152
    s_lshl1_add_u32 s25, s14, s25
    s_lshl_b32 s14, s14, 10
    s_add_u32 s26, s26, s14
    v_bfe_i32 v108, v19, 2, 10
    v_bfe_i32 v109, v19, 12, 10
    v_ashrrev_i32 v110, 22, v19
    v_cvt_f32_i32 v108, v108
    v_cvt_f32_i32 v109, v109
    v_cvt_f32_i32 v110, v110
    v_mfma_f32_4x4x4_16b_bf16 v[112:115], v[58:59], v[76:77], 0
    v_mfma_f32_4x4x4_16b_bf16 v[116:119], v[58:59], v[78:79], 0
    v_mfma_f32_4x4x4_16b_bf16 v[120:123], v[58:59], v[80:81], 0
    v_mad_u32_u16 v16, v16, 8, s50 op_sel:[1,0,0,0]
    v_mad_u32_u16 v17, v17, 8, s50 op_sel:[1,0,0,0]
    v_mad_u32_u16 v18, v18, 8, s50 op_sel:[1,0,0,0]
    v_pk_fma_f32 v[114:115], v[114:115], v[108:109], s[20:21] op_sel:[0,0,0] op_sel_hi:[1,0,1]
    v_pk_fma_f32 v[112:113], v[112:113], v[108:109], s[16:17] op_sel:[0,0,0] op_sel_hi:[1,0,1]
    v_pk_fma_f32 v[118:119], v[118:119], v[108:109], s[20:21] op_sel:[0,1,0] op_sel_hi:[1,1,1]
    v_pk_fma_f32 v[116:117], v[116:117], v[108:109], s[16:17] op_sel:[0,1,0] op_sel_hi:[1,1,1]
    v_pk_fma_f32 v[122:123], v[122:123], v[110:111], s[20:21] op_sel:[0,0,0] op_sel_hi:[1,0,1]
    v_pk_fma_f32 v[120:121], v[120:121], v[110:111], s[16:17] op_sel:[0,0,0] op_sel_hi:[1,0,1]
    v_lshlrev_b64 v[114:115], 16, v[114:115]
    v_lshlrev_b64 v[118:119], 16, v[118:119]
    v_lshlrev_b64 v[122:123], 16, v[122:123]
    v_lshl_add_u64 v[76:77], v[112:113], 0, v[114:115]
    v_lshl_add_u64 v[78:79], v[116:117], 0, v[118:119]
    v_lshl_add_u64 v[80:81], v[120:121], 0, v[122:123]
    s_waitcnt lgkmcnt(6)
    v_or3_b32 v4, v44, v45, v4
    v_or3_b32 v4, v46, v47, v4
    v_or3_b32 v4, v48, v49, v4
    ds_add_rtn_u64 v[44:45], v16, v[76:77]
    ds_add_rtn_u64 v[46:47], v17, v[78:79]
    ds_add_rtn_u64 v[48:49], v18, v[80:81]
    s_waitcnt lgkmcnt(3)
    v_mad_u32_u16 v55, v55, s23, v2
    v_pk_lshrrev_b16 v55, 10, v55 op_sel_hi:[1,1]
    v_lshl_add_u32 v51, v51, 6, v55
    buffer_load_dwordx4 v[16:19], v51, s[44:47], s34 idxen
    s_cmp_le_u32 s51, 256
    s_cbranch_scc1 L_p2_kernel_noopt3_3
    v_bfe_i32 v108, v27, 2, 10
    v_bfe_i32 v109, v27, 12, 10
    v_ashrrev_i32 v110, 22, v27
    v_cvt_f32_i32 v108, v108
    v_cvt_f32_i32 v109, v109
    v_cvt_f32_i32 v110, v110
    v_mfma_f32_4x4x4_16b_bf16 v[112:115], v[58:59], v[64:65], 0
    v_mfma_f32_4x4x4_16b_bf16 v[116:119], v[58:59], v[66:67], 0
    v_mfma_f32_4x4x4_16b_bf16 v[120:123], v[58:59], v[68:69], 0
    v_mad_u32_u16 v24, v24, 8, s50 op_sel:[1,0,0,0]
    v_mad_u32_u16 v25, v25, 8, s50 op_sel:[1,0,0,0]
    v_mad_u32_u16 v26, v26, 8, s50 op_sel:[1,0,0,0]
    v_pk_fma_f32 v[114:115], v[114:115], v[108:109], s[20:21] op_sel:[0,0,0] op_sel_hi:[1,0,1]
    v_pk_fma_f32 v[112:113], v[112:113], v[108:109], s[16:17] op_sel:[0,0,0] op_sel_hi:[1,0,1]
    v_pk_fma_f32 v[118:119], v[118:119], v[108:109], s[20:21] op_sel:[0,1,0] op_sel_hi:[1,1,1]
    v_pk_fma_f32 v[116:117], v[116:117], v[108:109], s[16:17] op_sel:[0,1,0] op_sel_hi:[1,1,1]
    v_pk_fma_f32 v[122:123], v[122:123], v[110:111], s[20:21] op_sel:[0,0,0] op_sel_hi:[1,0,1]
    v_pk_fma_f32 v[120:121], v[120:121], v[110:111], s[16:17] op_sel:[0,0,0] op_sel_hi:[1,0,1]
    v_lshlrev_b64 v[114:115], 16, v[114:115]
    v_lshlrev_b64 v[118:119], 16, v[118:119]
    v_lshlrev_b64 v[122:123], 16, v[122:123]
    v_lshl_add_u64 v[64:65], v[112:113], 0, v[114:115]
    v_lshl_add_u64 v[66:67], v[116:117], 0, v[118:119]
    v_lshl_add_u64 v[68:69], v[120:121], 0, v[122:123]
    s_waitcnt lgkmcnt(0)
    v_or3_b32 v4, v44, v45, v4
    v_or3_b32 v4, v46, v47, v4
    v_or3_b32 v4, v48, v49, v4
    ds_add_rtn_u64 v[44:45], v24, v[64:65]
    ds_add_rtn_u64 v[46:47], v25, v[66:67]
    ds_add_rtn_u64 v[48:49], v26, v[68:69]
L_p2_kernel_noopt3_3:
    v_mbcnt_lo_u32_b32 v51, s36, 0
    v_mbcnt_hi_u32_b32 v51, s37, v51
    s_bcnt1_i32_b64 s14, s[36:37]
    v_lshl_add_u32 v55, v51, 1, s25
    ds_read_u16 v55, v55
    s_add_u32 s36, s26, 3145728
    s_lshl1_add_u32 s25, s14, s25
    s_lshl_b32 s14, s14, 10
    s_add_u32 s26, s26, s14
    s_cmp_le_u32 s28, 256
    s_cbranch_scc1 L_p2_kernel_noopt3_4
    v_readlane_b32 s38, v7, 8
    v_readlane_b32 s39, v7, 9
    s_nop 1
    v_mbcnt_lo_u32_b32 v62, s38, 0
    v_mbcnt_hi_u32_b32 v62, s39, v62
    s_bcnt1_i32_b64 s14, s[38:39]
    v_lshl_add_u32 v63, v62, 1, s25
    ds_read_u16 v63, v63
    s_add_u32 s38, s26, 4194304
    s_lshl1_add_u32 s25, s14, s25
    s_lshl_b32 s14, s14, 10
    s_add_u32 s26, s26, s14
L_p2_kernel_noopt3_4:
    v_bfe_i32 v108, v23, 2, 10
    v_bfe_i32 v109, v23, 12, 10
    v_ashrrev_i32 v110, 22, v23
    v_cvt_f32_i32 v108, v108
    v_cvt_f32_i32 v109, v109
    v_cvt_f32_i32 v110, v110
    v_mfma_f32_4x4x4_16b_bf16 v[112:115], v[58:59], v[82:83], 0
    v_mfma_f32_4x4x4_16b_bf16 v[116:119], v[58:59], v[84:85], 0
    v_mfma_f32_4x4x4_16b_bf16 v[120:123], v[58:59], v[86:87], 0
    v_mad_u32_u16 v20, v20, 8, s50 op_sel:[1,0,0,0]
    v_mad_u32_u16 v21, v21, 8, s50 op_sel:[1,0,0,0]
    v_mad_u32_u16 v22, v22, 8, s50 op_sel:[1,0,0,0]
    v_pk_fma_f32 v[114:115], v[114:115], v[108:109], s[20:21] op_sel:[0,0,0] op_sel_hi:[1,0,1]
    v_pk_fma_f32 v[112:113], v[112:113], v[108:109], s[16:17] op_sel:[0,0,0] op_sel_hi:[1,0,1]
    v_pk_fma_f32 v[118:119], v[118:119], v[108:109], s[20:21] op_sel:[0,1,0] op_sel_hi:[1,1,1]
    v_pk_fma_f32 v[116:117], v[116:117], v[108:109], s[16:17] op_sel:[0,1,0] op_sel_hi:[1,1,1]
    v_pk_fma_f32 v[122:123], v[122:123], v[110:111], s[20:21] op_sel:[0,0,0] op_sel_hi:[1,0,1]
    v_pk_fma_f32 v[120:121], v[120:121], v[110:111], s[16:17] op_sel:[0,0,0] op_sel_hi:[1,0,1]
    v_lshlrev_b64 v[114:115], 16, v[114:115]
    v_lshlrev_b64 v[118:119], 16, v[118:119]
    v_lshlrev_b64 v[122:123], 16, v[122:123]
    v_lshl_add_u64 v[82:83], v[112:113], 0, v[114:115]
    v_lshl_add_u64 v[84:85], v[116:117], 0, v[118:119]
    v_lshl_add_u64 v[86:87], v[120:121], 0, v[122:123]
    s_waitcnt lgkmcnt(1)
    v_or3_b32 v4, v44, v45, v4
    v_or3_b32 v4, v46, v47, v4
    v_or3_b32 v4, v48, v49, v4
    ds_add_rtn_u64 v[44:45], v20, v[82:83]
    ds_add_rtn_u64 v[46:47], v21, v[84:85]
    ds_add_rtn_u64 v[48:49], v22, v[86:87]
    s_waitcnt lgkmcnt(3)
    v_mad_u32_u16 v55, v55, s23, v2
    v_pk_lshrrev_b16 v55, 10, v55 op_sel_hi:[1,1]
    v_lshl_add_u32 v51, v51, 6, v55
    buffer_load_dwordx4 v[20:23], v51, s[44:47], s36 idxen
    s_cmp_le_u32 s28, 256
    s_cbranch_scc1 L_p2_kernel_noopt3_5
    v_mad_u32_u16 v63, v63, s23, v2
    v_pk_lshrrev_b16 v63, 10, v63 op_sel_hi:[1,1]
    v_lshl_add_u32 v62, v62, 6, v63
    buffer_load_dwordx4 v[24:27], v62, s[44:47], s38 idxen
L_p2_kernel_noopt3_5:
    s_add_u32 s14, s22, 80000
    buffer_load_dwordx4 v[88:91], v1, s[8:11], s14 offen
    v_pk_mov_b32 v[28:29], v[28:29], v[30:31] op_sel:[1,0]
    v_pk_mov_b32 v[30:31], v[30:31], v[32:33] op_sel:[1,0]
    v_pk_mov_b32 v[32:33], v[32:33], v[34:35] op_sel:[1,0]
    v_pk_mov_b32 v[34:35], v[34:35], v[4:5] op_sel:[1,1]
    v_pk_mov_b32 v[36:37], v[36:37], v[38:39] op_sel:[1,0]
    v_pk_mov_b32 v[38:39], v[38:39], v[40:41] op_sel:[1,0]
    v_pk_mov_b32 v[40:41], v[40:41], v[42:43] op_sel:[1,0]
    v_pk_mov_b32 v[42:43], v[42:43], v[4:5] op_sel:[1,1]
    v_mad_u32_u16 v108, v28, v50, s40 op_sel:[0,0,0,0]
    v_mad_u32_u16 v109, v36, v50, s41 op_sel:[0,0,0,0]
    v_sub_u32_sdwa v110, v109, v108 dst_sel:DWORD dst_unused:UNUSED_PAD src0_sel:WORD_1 src1_sel:WORD_1
    s_nop 1
    v_add_u32_dpp v110, v110, v110 row_shr:1 row_mask:0xf bank_mask:0xf bound_ctrl:0
    s_nop 1
    v_add_u32_dpp v110, v110, v110 row_shr:2 row_mask:0xf bank_mask:0xf bound_ctrl:0
    s_nop 1
    v_add_u32_dpp v110, v110, v110 row_shr:4 row_mask:0xf bank_mask:0xf bound_ctrl:0
    s_nop 1
    v_add_u32_dpp v110, v110, v110 row_shr:8 row_mask:0xf bank_mask:0xf bound_ctrl:0
    s_nop 1
    v_add_u32_dpp v110, v110, v110 row_bcast:15 row_mask:0xa bank_mask:0xf
    s_nop 1
    v_add_u32_dpp v110, v110, v110 row_bcast:31 row_mask:0xc bank_mask:0xf
    v_sub_u32_sdwa v109, v109, v110 dst_sel:DWORD dst_unused:UNUSED_PAD src0_sel:WORD_1 src1_sel:DWORD
    v_readlane_b32 s29, v110, 63
    v_add_u32 v110, -1, v110
    ds_write_b16 v126, v109
    v_lshlrev_b32_e64 v111, v110, 1
    v_lshrrev_b32 v110, 5, v110
    s_cmp_gt_u32 s29, 320
    s_cselect_b32 s2, 1, s2
    v_lshl_add_u32 v110, v110, 2, v127
    s_cselect_b64 exec, 0, -1
    ds_or_b32 v110, v111 offset:136
    s_mov_b64 exec, -1
    ds_wrxchg2_rtn_b32 v[108:109], v6, v5, v5 offset0:34 offset1:44
    s_add_u32 s14, s22, 96384
    buffer_load_dwordx4 v[92:95], v1, s[8:11], s14 offen
    s_barrier
    s_add_u32 s22, s22, 80000
    s_cmp_lg_u32 s24, 7
    s_cbranch_scc1 L_p2_nodist
    s_mov_b32 s46, 0
    s_lshl2_add_u32 s14, s3, s12
    s_mul_i32 s14, s14, 5000
    s_add_u32 s15, s14, 4096
    v_min_u32 v61, 225, v0
    v_lshl_add_u32 v60, v0, 2, s14
    v_lshl_add_u32 v61, v61, 2, s15
    global_load_dword v60, v60, s[100:101] nt
    global_load_dword v61, v61, s[100:101] nt
L_p2_nodist:
    v_mad_u32_u16 v64, v8, 8, s18
    v_mad_u32_u16 v66, v9, 8, s18
    v_mad_u32_u16 v68, v10, 8, s18
    ds_read_b64 v[64:65], v64
    ds_read_b64 v[66:67], v66
    ds_read_b64 v[68:69], v68
    s_add_u32 s14, s22, 32768
    buffer_load_dwordx4 v[96:99], v1, s[8:11], s14 offen
    s_waitcnt vmcnt(5)
    v_mad_u32_u16 v70, v12, 8, s18
    v_mad_u32_u16 v72, v13, 8, s18
    v_mad_u32_u16 v74, v14, 8, s18
    ds_read_b64 v[70:71], v70
    ds_read_b64 v[72:73], v72
    ds_read_b64 v[74:75], v74
    s_add_u32 s14, s22, 49152
    buffer_load_dwordx4 v[100:103], v1, s[8:11], s14 offen
    s_waitcnt lgkmcnt(6)
    v_or_b32 v7, v108, v109
    s_nop 0
    v_readlane_b32 s30, v7, 0
    v_readlane_b32 s31, v7, 1
    v_readlane_b32 s32, v7, 2
    v_readlane_b32 s33, v7, 3
    v_readlane_b32 s34, v7, 4
    v_readlane_b32 s35, v7, 5
    v_readlane_b32 s36, v7, 6
    v_readlane_b32 s37, v7, 7
    s_mov_b32 s25, s19
    s_mov_b32 s26, s27
    s_mov_b32 s51, s28
    s_mov_b32 s28, s29
    v_mbcnt_lo_u32_b32 v51, s30, 0
    v_mbcnt_hi_u32_b32 v51, s31, v51
    s_bcnt1_i32_b64 s14, s[30:31]
    v_lshl_add_u32 v55, v51, 1, s25
    ds_read_u16 v55, v55
    s_add_u32 s30, s26, 0
    s_lshl1_add_u32 s25, s14, s25
    s_lshl_b32 s14, s14, 10
    s_add_u32 s26, s26, s14
    v_bfe_i32 v108, v11, 2, 10
    v_bfe_i32 v109, v11, 12, 10
    v_ashrrev_i32 v110, 22, v11
    v_cvt_f32_i32 v108, v108
    v_cvt_f32_i32 v109, v109
    v_cvt_f32_i32 v110, v110
    s_waitcnt lgkmcnt(4)
    v_mfma_f32_4x4x4_16b_bf16 v[112:115], v[58:59], v[64:65], 0
    v_mfma_f32_4x4x4_16b_bf16 v[116:119], v[58:59], v[66:67], 0
    v_mfma_f32_4x4x4_16b_bf16 v[120:123], v[58:59], v[68:69], 0
    v_mad_u32_u16 v8, v8, 8, s50 op_sel:[1,0,0,0]
    v_mad_u32_u16 v9, v9, 8, s50 op_sel:[1,0,0,0]
    v_mad_u32_u16 v10, v10, 8, s50 op_sel:[1,0,0,0]
    v_pk_fma_f32 v[114:115], v[114:115], v[108:109], s[20:21] op_sel:[0,0,0] op_sel_hi:[1,0,1]
    v_pk_fma_f32 v[112:113], v[112:113], v[108:109], s[16:17] op_sel:[0,0,0] op_sel_hi:[1,0,1]
    v_pk_fma_f32 v[118:119], v[118:119], v[108:109], s[20:21] op_sel:[0,1,0] op_sel_hi:[1,1,1]
    v_pk_fma_f32 v[116:117], v[116:117], v[108:109], s[16:17] op_sel:[0,1,0] op_sel_hi:[1,1,1]
    v_pk_fma_f32 v[122:123], v[122:123], v[110:111], s[20:21] op_sel:[0,0,0] op_sel_hi:[1,0,1]
    v_pk_fma_f32 v[120:121], v[120:121], v[110:111], s[16:17] op_sel:[0,0,0] op_sel_hi:[1,0,1]
    v_lshlrev_b64 v[114:115], 16, v[114:115]
    v_lshlrev_b64 v[118:119], 16, v[118:119]
    v_lshlrev_b64 v[122:123], 16, v[122:123]
    v_lshl_add_u64 v[64:65], v[112:113], 0, v[114:115]
    v_lshl_add_u64 v[66:67], v[116:117], 0, v[118:119]
    v_lshl_add_u64 v[68:69], v[120:121], 0, v[122:123]
    v_or3_b32 v4, v44, v45, v4
    v_or3_b32 v4, v46, v47, v4
    v_or3_b32 v4, v48, v49, v4
    ds_add_rtn_u64 v[44:45], v8, v[64:65]
    ds_add_rtn_u64 v[46:47], v9, v[66:67]
    ds_add_rtn_u64 v[48:49], v10, v[68:69]
    s_waitcnt lgkmcnt(3)
    v_mad_u32_u16 v55, v55, s23, v2
    v_pk_lshrrev_b16 v55, 10, v55 op_sel_hi:[1,1]
    v_lshl_add_u32 v51, v51, 6, v55
    buffer_load_dwordx4 v[8:11], v51, s[44:47], s30 idxen
    s_add_u32 s14, s22, 65536
    buffer_load_dwordx4 v[104:107], v1, s[8:11], s14 offen
    s_waitcnt vmcnt(7)
    v_mad_u32_u16 v76, v16, 8, s18
    v_mad_u32_u16 v78, v17, 8, s18
    v_mad_u32_u16 v80, v18, 8, s18
    ds_read_b64 v[76:77], v76
    ds_read_b64 v[78:79], v78
    ds_read_b64 v[80:81], v80
    s_waitcnt vmcnt(6)
    v_mad_u32_u16 v82, v20, 8, s18
    v_mad_u32_u16 v84, v21, 8, s18
    v_mad_u32_u16 v86, v22, 8, s18
    ds_read_b64 v[82:83], v82
    ds_read_b64 v[84:85], v84
    ds_read_b64 v[86:87], v86
    s_cmp_le_u32 s51, 256
    s_cbranch_scc1 L_p2_kernel_noopt3_6
    v_mad_u32_u16 v64, v24, 8, s18
    v_mad_u32_u16 v66, v25, 8, s18
    v_mad_u32_u16 v68, v26, 8, s18
    ds_read_b64 v[64:65], v64
    ds_read_b64 v[66:67], v66
    ds_read_b64 v[68:69], v68
L_p2_kernel_noopt3_6:
    v_mbcnt_lo_u32_b32 v51, s32, 0
    v_mbcnt_hi_u32_b32 v51, s33, v51
    s_bcnt1_i32_b64 s14, s[32:33]
    v_lshl_add_u32 v55, v51, 1, s25
    ds_read_u16 v55, v55
    s_add_u32 s32, s26, 1048576
    s_lshl1_add_u32 s25, s14, s25
    s_lshl_b32 s14, s14, 10
    s_add_u32 s26, s26, s14
    v_bfe_i32 v108, v15, 2, 10
    v_bfe_i32 v109, v15, 12, 10
    v_ashrrev_i32 v110, 22, v15
    v_cvt_f32_i32 v108, v108
    v_cvt_f32_i32 v109, v109
    v_cvt_f32_i32 v110, v110
    v_mfma_f32_4x4x4_16b_bf16 v[112:115], v[58:59], v[70:71], 0
    v_mfma_f32_4x4x4_16b_bf16 v[116:119], v[58:59], v[72:73], 0
    v_mfma_f32_4x4x4_16b_bf16 v[120:123], v[58:59], v[74:75], 0
    v_mad_u32_u16 v12, v12, 8, s50 op_sel:[1,0,0,0]
    v_mad_u32_u16 v13, v13, 8, s50 op_sel:[1,0,0,0]
    v_mad_u32_u16 v14, v14, 8, s50 op_sel:[1,0,0,0]
    v_pk_fma_f32 v[114:115], v[114:115], v[108:109], s[20:21] op_sel:[0,0,0] op_sel_hi:[1,0,1]
    v_pk_fma_f32 v[112:113], v[112:113], v[108:109], s[16:17] op_sel:[0,0,0] op_sel_hi:[1,0,1]
    v_pk_fma_f32 v[118:119], v[118:119], v[108:109], s[20:21] op_sel:[0,1,0] op_sel_hi:[1,1,1]
    v_pk_fma_f32 v[116:117], v[116:117], v[108:109], s[16:17] op_sel:[0,1,0] op_sel_hi:[1,1,1]
    v_pk_fma_f32 v[122:123], v[122:123], v[110:111], s[20:21] op_sel:[0,0,0] op_sel_hi:[1,0,1]
    v_pk_fma_f32 v[120:121], v[120:121], v[110:111], s[16:17] op_sel:[0,0,0] op_sel_hi:[1,0,1]
    v_lshlrev_b64 v[114:115], 16, v[114:115]
    v_lshlrev_b64 v[118:119], 16, v[118:119]
    v_lshlrev_b64 v[122:123], 16, v[122:123]
    v_lshl_add_u64 v[70:71], v[112:113], 0, v[114:115]
    v_lshl_add_u64 v[72:73], v[116:117], 0, v[118:119]
    v_lshl_add_u64 v[74:75], v[120:121], 0, v[122:123]
    s_waitcnt lgkmcnt(7)
    v_or3_b32 v4, v44, v45, v4
    v_or3_b32 v4, v46, v47, v4
    v_or3_b32 v4, v48, v49, v4
    ds_add_rtn_u64 v[44:45], v12, v[70:71]
    ds_add_rtn_u64 v[46:47], v13, v[72:73]
    ds_add_rtn_u64 v[48:49], v14, v[74:75]
    s_waitcnt lgkmcnt(3)
    v_mad_u32_u16 v55, v55, s23, v2
    v_pk_lshrrev_b16 v55, 10, v55 op_sel_hi:[1,1]
    v_lshl_add_u32 v51, v51, 6, v55
    buffer_load_dwordx4 v[12:15], v51, s[44:47], s32 idxen
    s_barrier
    s_waitcnt vmcnt(1)
    ds_write_b128 v3, v[88:91] offset:0
    ds_write_b128 v3, v[92:95] offset:16384
    ds_write_b128 v3, v[96:99] offset:32768
    ds_write_b128 v3, v[100:103] offset:49152
    ds_write_b128 v124, v[104:107] offset:0
    v_mbcnt_lo_u32_b32 v51, s34, 0
    v_mbcnt_hi_u32_b32 v51, s35, v51
    s_bcnt1_i32_b64 s14, s[34:35]
    v_lshl_add_u32 v55, v51, 1, s25
    ds_read_u16 v55, v55
    s_add_u32 s34, s26, 2097152
    s_lshl1_add_u32 s25, s14, s25
    s_lshl_b32 s14, s14, 10
    s_add_u32 s26, s26, s14
    v_bfe_i32 v108, v19, 2, 10
    v_bfe_i32 v109, v19, 12, 10
    v_ashrrev_i32 v110, 22, v19
    v_cvt_f32_i32 v108, v108
    v_cvt_f32_i32 v109, v109
    v_cvt_f32_i32 v110, v110
    v_mfma_f32_4x4x4_16b_bf16 v[112:115], v[58:59], v[76:77], 0
    v_mfma_f32_4x4x4_16b_bf16 v[116:119], v[58:59], v[78:79], 0
    v_mfma_f32_4x4x4_16b_bf16 v[120:123], v[58:59], v[80:81], 0
    v_mad_u32_u16 v16, v16, 8, s50 op_sel:[1,0,0,0]
    v_mad_u32_u16 v17, v17, 8, s50 op_sel:[1,0,0,0]
    v_mad_u32_u16 v18, v18, 8, s50 op_sel:[1,0,0,0]
    v_pk_fma_f32 v[114:115], v[114:115], v[108:109], s[20:21] op_sel:[0,0,0] op_sel_hi:[1,0,1]
    v_pk_fma_f32 v[112:113], v[112:113], v[108:109], s[16:17] op_sel:[0,0,0] op_sel_hi:[1,0,1]
    v_pk_fma_f32 v[118:119], v[118:119], v[108:109], s[20:21] op_sel:[0,1,0] op_sel_hi:[1,1,1]
    v_pk_fma_f32 v[116:117], v[116:117], v[108:109], s[16:17] op_sel:[0,1,0] op_sel_hi:[1,1,1]
    v_pk_fma_f32 v[122:123], v[122:123], v[110:111], s[20:21] op_sel:[0,0,0] op_sel_hi:[1,0,1]
    v_pk_fma_f32 v[120:121], v[120:121], v[110:111], s[16:17] op_sel:[0,0,0] op_sel_hi:[1,0,1]
    v_lshlrev_b64 v[114:115], 16, v[114:115]
    v_lshlrev_b64 v[118:119], 16, v[118:119]
    v_lshlrev_b64 v[122:123], 16, v[122:123]
    v_lshl_add_u64 v[76:77], v[112:113], 0, v[114:115]
    v_lshl_add_u64 v[78:79], v[116:117], 0, v[118:119]
    v_lshl_add_u64 v[80:81], v[120:121], 0, v[122:123]
    s_waitcnt lgkmcnt(6)
    v_or3_b32 v4, v44, v45, v4
    v_or3_b32 v4, v46, v47, v4
    v_or3_b32 v4, v48, v49, v4
    ds_add_rtn_u64 v[44:45], v16, v[76:77]
    ds_add_rtn_u64 v[46:47], v17, v[78:79]
    ds_add_rtn_u64 v[48:49], v18, v[80:81]
    s_waitcnt lgkmcnt(3)
    v_mad_u32_u16 v55, v55, s23, v2
    v_pk_lshrrev_b16 v55, 10, v55 op_sel_hi:[1,1]
    v_lshl_add_u32 v51, v51, 6, v55
    buffer_load_dwordx4 v[16:19], v51, s[44:47], s34 idxen
    s_cmp_le_u32 s51, 256
    s_cbranch_scc1 L_p2_kernel_noopt3_7
    v_bfe_i32 v108, v27, 2, 10
    v_bfe_i32 v109, v27, 12, 10
    v_ashrrev_i32 v110, 22, v27
    v_cvt_f32_i32 v108, v108
    v_cvt_f32_i32 v109, v109
    v_cvt_f32_i32 v110, v110
    v_mfma_f32_4x4x4_16b_bf16 v[112:115], v[58:59], v[64:65], 0
    v_mfma_f32_4x4x4_16b_bf16 v[116:119], v[58:59], v[66:67], 0
    v_mfma_f32_4x4x4_16b_bf16 v[120:123], v[58:59], v[68:69], 0
    v_mad_u32_u16 v24, v24, 8, s50 op_sel:[1,0,0,0]
    v_mad_u32_u16 v25, v25, 8, s50 op_sel:[1,0,0,0]
    v_mad_u32_u16 v26, v26, 8, s50 op_sel:[1,0,0,0]
    v_pk_fma_f32 v[114:115], v[114:115], v[108:109], s[20:21] op_sel:[0,0,0] op_sel_hi:[1,0,1]
    v_pk_fma_f32 v[112:113], v[112:113], v[108:109], s[16:17] op_sel:[0,0,0] op_sel_hi:[1,0,1]
    v_pk_fma_f32 v[118:119], v[118:119], v[108:109], s[20:21] op_sel:[0,1,0] op_sel_hi:[1,1,1]
    v_pk_fma_f32 v[116:117], v[116:117], v[108:109], s[16:17] op_sel:[0,1,0] op_sel_hi:[1,1,1]
    v_pk_fma_f32 v[122:123], v[122:123], v[110:111], s[20:21] op_sel:[0,0,0] op_sel_hi:[1,0,1]
    v_pk_fma_f32 v[120:121], v[120:121], v[110:111], s[16:17] op_sel:[0,0,0] op_sel_hi:[1,0,1]
    v_lshlrev_b64 v[114:115], 16, v[114:115]
    v_lshlrev_b64 v[118:119], 16, v[118:119]
    v_lshlrev_b64 v[122:123], 16, v[122:123]
    v_lshl_add_u64 v[64:65], v[112:113], 0, v[114:115]
    v_lshl_add_u64 v[66:67], v[116:117], 0, v[118:119]
    v_lshl_add_u64 v[68:69], v[120:121], 0, v[122:123]
    s_waitcnt lgkmcnt(0)
    v_or3_b32 v4, v44, v45, v4
    v_or3_b32 v4, v46, v47, v4
    v_or3_b32 v4, v48, v49, v4
    ds_add_rtn_u64 v[44:45], v24, v[64:65]
    ds_add_rtn_u64 v[46:47], v25, v[66:67]
    ds_add_rtn_u64 v[48:49], v26, v[68:69]
L_p2_kernel_noopt3_7:
    v_mbcnt_lo_u32_b32 v51, s36, 0
    v_mbcnt_hi_u32_b32 v51, s37, v51
    s_bcnt1_i32_b64 s14, s[36:37]
    v_lshl_add_u32 v55, v51, 1, s25
    ds_read_u16 v55, v55
    s_add_u32 s36, s26, 3145728
    s_lshl1_add_u32 s25, s14, s25
    s_lshl_b32 s14, s14, 10
    s_add_u32 s26, s26, s14
    s_cmp_le_u32 s28, 256
    s_cbranch_scc1 L_p2_kernel_noopt3_8
    v_readlane_b32 s38, v7, 8
    v_readlane_b32 s39, v7, 9
    s_nop 1
    v_mbcnt_lo_u32_b32 v62, s38, 0
    v_mbcnt_hi_u32_b32 v62, s39, v62
    s_bcnt1_i32_b64 s14, s[38:39]
    v_lshl_add_u32 v63, v62, 1, s25
    ds_read_u16 v63, v63
    s_add_u32 s38, s26, 4194304
    s_lshl1_add_u32 s25, s14, s25
    s_lshl_b32 s14, s14, 10
    s_add_u32 s26, s26, s14
L_p2_kernel_noopt3_8:
    v_bfe_i32 v108, v23, 2, 10
    v_bfe_i32 v109, v23, 12, 10
    v_ashrrev_i32 v110, 22, v23
    v_cvt_f32_i32 v108, v108
    v_cvt_f32_i32 v109, v109
    v_cvt_f32_i32 v110, v110
    v_mfma_f32_4x4x4_16b_bf16 v[112:115], v[58:59], v[82:83], 0
    v_mfma_f32_4x4x4_16b_bf16 v[116:119], v[58:59], v[84:85], 0
    v_mfma_f32_4x4x4_16b_bf16 v[120:123], v[58:59], v[86:87], 0
    v_mad_u32_u16 v20, v20, 8, s50 op_sel:[1,0,0,0]
    v_mad_u32_u16 v21, v21, 8, s50 op_sel:[1,0,0,0]
    v_mad_u32_u16 v22, v22, 8, s50 op_sel:[1,0,0,0]
    v_pk_fma_f32 v[114:115], v[114:115], v[108:109], s[20:21] op_sel:[0,0,0] op_sel_hi:[1,0,1]
    v_pk_fma_f32 v[112:113], v[112:113], v[108:109], s[16:17] op_sel:[0,0,0] op_sel_hi:[1,0,1]
    v_pk_fma_f32 v[118:119], v[118:119], v[108:109], s[20:21] op_sel:[0,1,0] op_sel_hi:[1,1,1]
    v_pk_fma_f32 v[116:117], v[116:117], v[108:109], s[16:17] op_sel:[0,1,0] op_sel_hi:[1,1,1]
    v_pk_fma_f32 v[122:123], v[122:123], v[110:111], s[20:21] op_sel:[0,0,0] op_sel_hi:[1,0,1]
    v_pk_fma_f32 v[120:121], v[120:121], v[110:111], s[16:17] op_sel:[0,0,0] op_sel_hi:[1,0,1]
    v_lshlrev_b64 v[114:115], 16, v[114:115]
    v_lshlrev_b64 v[118:119], 16, v[118:119]
    v_lshlrev_b64 v[122:123], 16, v[122:123]
    v_lshl_add_u64 v[82:83], v[112:113], 0, v[114:115]
    v_lshl_add_u64 v[84:85], v[116:117], 0, v[118:119]
    v_lshl_add_u64 v[86:87], v[120:121], 0, v[122:123]
    s_waitcnt lgkmcnt(1)
    v_or3_b32 v4, v44, v45, v4
    v_or3_b32 v4, v46, v47, v4
    v_or3_b32 v4, v48, v49, v4
    ds_add_rtn_u64 v[44:45], v20, v[82:83]
    ds_add_rtn_u64 v[46:47], v21, v[84:85]
    ds_add_rtn_u64 v[48:49], v22, v[86:87]
    s_waitcnt lgkmcnt(3)
    v_mad_u32_u16 v55, v55, s23, v2
    v_pk_lshrrev_b16 v55, 10, v55 op_sel_hi:[1,1]
    v_lshl_add_u32 v51, v51, 6, v55
    buffer_load_dwordx4 v[20:23], v51, s[44:47], s36 idxen
    s_cmp_le_u32 s28, 256
    s_cbranch_scc1 L_p2_kernel_noopt3_9
    v_mad_u32_u16 v63, v63, s23, v2
    v_pk_lshrrev_b16 v63, 10, v63 op_sel_hi:[1,1]
    v_lshl_add_u32 v62, v62, 6, v63
    buffer_load_dwordx4 v[24:27], v62, s[44:47], s38 idxen
L_p2_kernel_noopt3_9:
    s_add_u32 s14, s22, 80000
    buffer_load_dwordx4 v[88:91], v1, s[8:11], s14 offen
    v_mad_u32_u16 v108, v28, v50, s40 op_sel:[1,0,0,0]
    v_mad_u32_u16 v109, v36, v50, s41 op_sel:[1,0,0,0]
    v_sub_u32_sdwa v110, v109, v108 dst_sel:DWORD dst_unused:UNUSED_PAD src0_sel:WORD_1 src1_sel:WORD_1
    s_nop 1
    v_add_u32_dpp v110, v110, v110 row_shr:1 row_mask:0xf bank_mask:0xf bound_ctrl:0
    s_nop 1
    v_add_u32_dpp v110, v110, v110 row_shr:2 row_mask:0xf bank_mask:0xf bound_ctrl:0
    s_nop 1
    v_add_u32_dpp v110, v110, v110 row_shr:4 row_mask:0xf bank_mask:0xf bound_ctrl:0
    s_nop 1
    v_add_u32_dpp v110, v110, v110 row_shr:8 row_mask:0xf bank_mask:0xf bound_ctrl:0
    s_nop 1
    v_add_u32_dpp v110, v110, v110 row_bcast:15 row_mask:0xa bank_mask:0xf
    s_nop 1
    v_add_u32_dpp v110, v110, v110 row_bcast:31 row_mask:0xc bank_mask:0xf
    v_sub_u32_sdwa v109, v109, v110 dst_sel:DWORD dst_unused:UNUSED_PAD src0_sel:WORD_1 src1_sel:DWORD
    v_readlane_b32 s29, v110, 63
    v_add_u32 v110, -1, v110
    ds_write_b16 v126, v109
    v_lshlrev_b32_e64 v111, v110, 1
    v_lshrrev_b32 v110, 5, v110
    s_cmp_gt_u32 s29, 320
    s_cselect_b32 s2, 1, s2
    v_lshl_add_u32 v110, v110, 2, v127
    s_cselect_b64 exec, 0, -1
    ds_or_b32 v110, v111 offset:136
    s_mov_b64 exec, -1
    ds_wrxchg2_rtn_b32 v[108:109], v6, v5, v5 offset0:34 offset1:44
    s_add_u32 s14, s22, 96384
    buffer_load_dwordx4 v[92:95], v1, s[8:11], s14 offen
    s_add_u32 s24, s24, 1
    s_cmp_lt_u32 s24, 8
    s_barrier
    s_cbranch_scc1 L_p2_loop
    s_waitcnt lgkmcnt(3)
    v_or3_b32 v4, v44, v45, v4
    v_or3_b32 v4, v46, v47, v4
    v_or3_b32 v4, v48, v49, v4
    s_mov_b32 s27, s19
    s_waitcnt vmcnt(0)
    v_mov_b32 v8, 160232
    s_cmp_lg_u32 s13, 0
    s_cselect_b64 exec, 0, 1
    ds_write_b32 v8, v52
    s_mov_b64 exec, -1
    v_subrev_u32 v6, 80000, v124
    s_mul_i32 s24, s12, 20000
    v_subrev_u32 v10, s24, v1
    v_mov_b32 v11, 0x7f000000
    s_waitcnt vmcnt(0) lgkmcnt(0)
    s_barrier
    s_cmp_lt_u32 s13, 12
    s_cbranch_scc1 L_p2_ga
L_p2_ga:
    ds_read_b32 v9, v8
    ds_read_b128 v[88:91], v1 offset:0
    ds_read_b128 v[92:95], v1 offset:16384
    ds_read_b128 v[96:99], v1 offset:32768
    ds_read_b128 v[100:103], v1 offset:49152
    ds_read_b128 v[104:107], v6
    s_mul_i32 s14, s12, 5120000
    s_mul_i32 s15, s3, 80000
    s_add_u32 s25, s14, s15
    s_add_u32 s25, s25, 228589568
    s_waitcnt lgkmcnt(5)
    v_readfirstlane_b32 s21, v9
    s_nop 0
    s_bfe_u32 s21, s21, 524296
    s_cmp_lg_u32 s21, 4
    s_cselect_b32 s21, 1, 0
    s_cselect_b32 s24, 0, 20000
    v_cmp_le_u32 vcc, s24, v10
    v_add_u32 v10, 16384, v10
    s_add_u32 s14, s25, 0
    v_cndmask_b32 v12, v11, v1, vcc
    s_waitcnt lgkmcnt(4)
    buffer_store_dwordx4 v[88:91], v12, s[4:7], s14 offen sc1
    v_or3_b32 v4, v88, v89, v4
    v_or3_b32 v4, v90, v91, v4
    v_cmp_le_u32 vcc, s24, v10
    v_add_u32 v10, 16384, v10
    s_add_u32 s14, s25, 16384
    v_cndmask_b32 v12, v11, v1, vcc
    s_waitcnt lgkmcnt(3)
    buffer_store_dwordx4 v[92:95], v12, s[4:7], s14 offen sc1
    v_or3_b32 v4, v92, v93, v4
    v_or3_b32 v4, v94, v95, v4
    v_cmp_le_u32 vcc, s24, v10
    v_add_u32 v10, 16384, v10
    s_add_u32 s14, s25, 32768
    v_cndmask_b32 v12, v11, v1, vcc
    s_waitcnt lgkmcnt(2)
    buffer_store_dwordx4 v[96:99], v12, s[4:7], s14 offen sc1
    v_or3_b32 v4, v96, v97, v4
    v_or3_b32 v4, v98, v99, v4
    v_cmp_le_u32 vcc, s24, v10
    v_add_u32 v10, 16384, v10
    s_add_u32 s14, s25, 49152
    v_cndmask_b32 v12, v11, v1, vcc
    s_waitcnt lgkmcnt(1)
    buffer_store_dwordx4 v[100:103], v12, s[4:7], s14 offen sc1
    v_or3_b32 v4, v100, v101, v4
    v_or3_b32 v4, v102, v103, v4
    v_cmp_le_u32 vcc, s24, v10
    v_add_u32 v10, 16384, v10
    s_add_u32 s14, s25, 0
    v_cndmask_b32 v12, v11, v6, vcc
    s_waitcnt lgkmcnt(0)
    buffer_store_dwordx4 v[104:107], v12, s[4:7], s14 offen sc1
    v_or3_b32 v4, v104, v105, v4
    v_or3_b32 v4, v106, v107, v4
    s_load_dwordx2 s[16:17], s[0:1], 88
    s_cmp_ge_u32 s13, 12
    s_cbranch_scc1 L_p2_gb
    v_lshlrev_b32 v30, 16, v60
    v_and_b32 v31, 0xffff0000, v60
    v_lshlrev_b32 v36, 16, v53
    v_and_b32 v37, 0xffff0000, v53
    v_lshlrev_b32 v38, 16, v54
    v_and_b32 v39, 0xffff0000, v54
    v_lshlrev_b32 v40, 16, v56
    v_and_b32 v41, 0xffff0000, v56
    v_lshlrev_b32 v42, 16, v57
    v_and_b32 v43, 0xffff0000, v57
    v_pk_add_f32 v[14:15], v[30:31], v[36:37] op_sel:[0,0] op_sel_hi:[1,0] neg_lo:[0,1] neg_hi:[0,1]
    v_pk_add_f32 v[16:17], v[30:31], v[36:37] op_sel:[0,1] op_sel_hi:[1,1] neg_lo:[0,1] neg_hi:[0,1]
    v_pk_add_f32 v[18:19], v[30:31], v[38:39] op_sel:[0,0] op_sel_hi:[1,0] neg_lo:[0,1] neg_hi:[0,1]
    v_pk_add_f32 v[20:21], v[30:31], v[38:39] op_sel:[0,1] op_sel_hi:[1,1] neg_lo:[0,1] neg_hi:[0,1]
    v_pk_add_f32 v[22:23], v[30:31], v[40:41] op_sel:[0,0] op_sel_hi:[1,0] neg_lo:[0,1] neg_hi:[0,1]
    v_pk_add_f32 v[24:25], v[30:31], v[40:41] op_sel:[0,1] op_sel_hi:[1,1] neg_lo:[0,1] neg_hi:[0,1]
    v_pk_add_f32 v[26:27], v[30:31], v[42:43] op_sel:[0,0] op_sel_hi:[1,0] neg_lo:[0,1] neg_hi:[0,1]
    v_pk_add_f32 v[28:29], v[30:31], v[42:43] op_sel:[0,1] op_sel_hi:[1,1] neg_lo:[0,1] neg_hi:[0,1]
    v_cvt_pk_bf16_f32 v32, v14, v15
    v_lshlrev_b32 v14, 16, v32
    v_and_b32 v15, 0xffff0000, v32
    v_cvt_pk_bf16_f32 v32, v16, v17
    v_lshlrev_b32 v16, 16, v32
    v_and_b32 v17, 0xffff0000, v32
    v_cvt_pk_bf16_f32 v32, v18, v19
    v_lshlrev_b32 v18, 16, v32
    v_and_b32 v19, 0xffff0000, v32
    v_cvt_pk_bf16_f32 v32, v20, v21
    v_lshlrev_b32 v20, 16, v32
    v_and_b32 v21, 0xffff0000, v32
    v_cvt_pk_bf16_f32 v32, v22, v23
    v_lshlrev_b32 v22, 16, v32
    v_and_b32 v23, 0xffff0000, v32
    v_cvt_pk_bf16_f32 v32, v24, v25
    v_lshlrev_b32 v24, 16, v32
    v_and_b32 v25, 0xffff0000, v32
    v_cvt_pk_bf16_f32 v32, v26, v27
    v_lshlrev_b32 v26, 16, v32
    v_and_b32 v27, 0xffff0000, v32
    v_cvt_pk_bf16_f32 v32, v28, v29
    v_lshlrev_b32 v28, 16, v32
    v_and_b32 v29, 0xffff0000, v32
    v_pk_mul_f32 v[14:15], v[14:15], v[14:15]
    v_pk_mul_f32 v[16:17], v[16:17], v[16:17]
    v_pk_mul_f32 v[18:19], v[18:19], v[18:19]
    v_pk_mul_f32 v[20:21], v[20:21], v[20:21]
    v_pk_mul_f32 v[22:23], v[22:23], v[22:23]
    v_pk_mul_f32 v[24:25], v[24:25], v[24:25]
    v_pk_mul_f32 v[26:27], v[26:27], v[26:27]
    v_pk_mul_f32 v[28:29], v[28:29], v[28:29]
    v_cvt_pk_bf16_f32 v32, v14, v15
    v_lshlrev_b32 v14, 16, v32
    v_and_b32 v15, 0xffff0000, v32
    v_cvt_pk_bf16_f32 v32, v16, v17
    v_lshlrev_b32 v16, 16, v32
    v_and_b32 v17, 0xffff0000, v32
    v_cvt_pk_bf16_f32 v32, v18, v19
    v_lshlrev_b32 v18, 16, v32
    v_and_b32 v19, 0xffff0000, v32
    v_cvt_pk_bf16_f32 v32, v20, v21
    v_lshlrev_b32 v20, 16, v32
    v_and_b32 v21, 0xffff0000, v32
    v_cvt_pk_bf16_f32 v32, v22, v23
    v_lshlrev_b32 v22, 16, v32
    v_and_b32 v23, 0xffff0000, v32
    v_cvt_pk_bf16_f32 v32, v24, v25
    v_lshlrev_b32 v24, 16, v32
    v_and_b32 v25, 0xffff0000, v32
    v_cvt_pk_bf16_f32 v32, v26, v27
    v_lshlrev_b32 v26, 16, v32
    v_and_b32 v27, 0xffff0000, v32
    v_cvt_pk_bf16_f32 v32, v28, v29
    v_lshlrev_b32 v28, 16, v32
    v_and_b32 v29, 0xffff0000, v32
    v_mov_b32 v30, 1092616192
    v_mov_b32 v31, 0x3fb8aa3b
    v_pk_mul_f32 v[14:15], v[14:15], v[30:31] op_sel:[0,0] op_sel_hi:[1,0]
    v_pk_mul_f32 v[16:17], v[16:17], v[30:31] op_sel:[0,0] op_sel_hi:[1,0]
    v_pk_mul_f32 v[18:19], v[18:19], v[30:31] op_sel:[0,0] op_sel_hi:[1,0]
    v_pk_mul_f32 v[20:21], v[20:21], v[30:31] op_sel:[0,0] op_sel_hi:[1,0]
    v_pk_mul_f32 v[22:23], v[22:23], v[30:31] op_sel:[0,0] op_sel_hi:[1,0]
    v_pk_mul_f32 v[24:25], v[24:25], v[30:31] op_sel:[0,0] op_sel_hi:[1,0]
    v_pk_mul_f32 v[26:27], v[26:27], v[30:31] op_sel:[0,0] op_sel_hi:[1,0]
    v_pk_mul_f32 v[28:29], v[28:29], v[30:31] op_sel:[0,0] op_sel_hi:[1,0]
    v_cvt_pk_bf16_f32 v32, v14, v15
    v_lshlrev_b32 v14, 16, v32
    v_and_b32 v15, 0xffff0000, v32
    v_cvt_pk_bf16_f32 v32, v16, v17
    v_lshlrev_b32 v16, 16, v32
    v_and_b32 v17, 0xffff0000, v32
    v_cvt_pk_bf16_f32 v32, v18, v19
    v_lshlrev_b32 v18, 16, v32
    v_and_b32 v19, 0xffff0000, v32
    v_cvt_pk_bf16_f32 v32, v20, v21
    v_lshlrev_b32 v20, 16, v32
    v_and_b32 v21, 0xffff0000, v32
    v_cvt_pk_bf16_f32 v32, v22, v23
    v_lshlrev_b32 v22, 16, v32
    v_and_b32 v23, 0xffff0000, v32
    v_cvt_pk_bf16_f32 v32, v24, v25
    v_lshlrev_b32 v24, 16, v32
    v_and_b32 v25, 0xffff0000, v32
    v_cvt_pk_bf16_f32 v32, v26, v27
    v_lshlrev_b32 v26, 16, v32
    v_and_b32 v27, 0xffff0000, v32
    v_cvt_pk_bf16_f32 v32, v28, v29
    v_lshlrev_b32 v28, 16, v32
    v_and_b32 v29, 0xffff0000, v32
    v_pk_mul_f32 v[14:15], v[14:15], v[30:31] op_sel:[0,1] op_sel_hi:[1,1]
    v_pk_mul_f32 v[16:17], v[16:17], v[30:31] op_sel:[0,1] op_sel_hi:[1,1]
    v_pk_mul_f32 v[18:19], v[18:19], v[30:31] op_sel:[0,1] op_sel_hi:[1,1]
    v_pk_mul_f32 v[20:21], v[20:21], v[30:31] op_sel:[0,1] op_sel_hi:[1,1]
    v_pk_mul_f32 v[22:23], v[22:23], v[30:31] op_sel:[0,1] op_sel_hi:[1,1]
    v_pk_mul_f32 v[24:25], v[24:25], v[30:31] op_sel:[0,1] op_sel_hi:[1,1]
    v_pk_mul_f32 v[26:27], v[26:27], v[30:31] op_sel:[0,1] op_sel_hi:[1,1]
    v_pk_mul_f32 v[28:29], v[28:29], v[30:31] op_sel:[0,1] op_sel_hi:[1,1]
    v_exp_f32 v14, -v14
    v_exp_f32 v15, -v15
    v_exp_f32 v16, -v16
    v_exp_f32 v17, -v17
    v_exp_f32 v18, -v18
    v_exp_f32 v19, -v19
    v_exp_f32 v20, -v20
    v_exp_f32 v21, -v21
    v_exp_f32 v22, -v22
    v_exp_f32 v23, -v23
    v_exp_f32 v24, -v24
    v_exp_f32 v25, -v25
    v_exp_f32 v26, -v26
    v_exp_f32 v27, -v27
    v_exp_f32 v28, -v28
    v_exp_f32 v29, -v29
    v_cvt_pk_bf16_f32 v14, v14, v16
    v_cvt_pk_bf16_f32 v15, v15, v17
    v_cvt_pk_bf16_f32 v18, v18, v20
    v_cvt_pk_bf16_f32 v19, v19, v21
    v_cvt_pk_bf16_f32 v22, v22, v24
    v_cvt_pk_bf16_f32 v23, v23, v25
    v_cvt_pk_bf16_f32 v26, v26, v28
    v_cvt_pk_bf16_f32 v27, v27, v29
    v_dot2_f32_bf16 v72, v14, s68, 0
    v_dot2_f32_bf16 v73, v15, s68, 0
    v_dot2_f32_bf16 v74, v14, s69, 0
    v_dot2_f32_bf16 v75, v15, s69, 0
    v_dot2_f32_bf16 v76, v14, s70, 0
    v_dot2_f32_bf16 v77, v15, s70, 0
    v_dot2_f32_bf16 v78, v14, s71, 0
    v_dot2_f32_bf16 v79, v15, s71, 0
    v_dot2_f32_bf16 v80, v14, s52, 0
    v_dot2_f32_bf16 v81, v15, s52, 0
    v_dot2_f32_bf16 v82, v14, s53, 0
    v_dot2_f32_bf16 v83, v15, s53, 0
    v_dot2_f32_bf16 v84, v14, s54, 0
    v_dot2_f32_bf16 v85, v15, s54, 0
    v_dot2_f32_bf16 v86, v14, s55, 0
    v_dot2_f32_bf16 v87, v15, s55, 0
    v_dot2_f32_bf16 v72, v18, s72, v72
    v_dot2_f32_bf16 v73, v19, s72, v73
    v_dot2_f32_bf16 v74, v18, s73, v74
    v_dot2_f32_bf16 v75, v19, s73, v75
    v_dot2_f32_bf16 v76, v18, s74, v76
    v_dot2_f32_bf16 v77, v19, s74, v77
    v_dot2_f32_bf16 v78, v18, s75, v78
    v_dot2_f32_bf16 v79, v19, s75, v79
    v_dot2_f32_bf16 v80, v18, s56, v80
    v_dot2_f32_bf16 v81, v19, s56, v81
    v_dot2_f32_bf16 v82, v18, s57, v82
    v_dot2_f32_bf16 v83, v19, s57, v83
    v_dot2_f32_bf16 v84, v18, s58, v84
    v_dot2_f32_bf16 v85, v19, s58, v85
    v_dot2_f32_bf16 v86, v18, s59, v86
    v_dot2_f32_bf16 v87, v19, s59, v87
    v_dot2_f32_bf16 v72, v22, s76, v72
    v_dot2_f32_bf16 v73, v23, s76, v73
    v_dot2_f32_bf16 v74, v22, s77, v74
    v_dot2_f32_bf16 v75, v23, s77, v75
    v_dot2_f32_bf16 v76, v22, s78, v76
    v_dot2_f32_bf16 v77, v23, s78, v77
    v_dot2_f32_bf16 v78, v22, s79, v78
    v_dot2_f32_bf16 v79, v23, s79, v79
    v_dot2_f32_bf16 v80, v22, s60, v80
    v_dot2_f32_bf16 v81, v23, s60, v81
    v_dot2_f32_bf16 v82, v22, s61, v82
    v_dot2_f32_bf16 v83, v23, s61, v83
    v_dot2_f32_bf16 v84, v22, s62, v84
    v_dot2_f32_bf16 v85, v23, s62, v85
    v_dot2_f32_bf16 v86, v22, s63, v86
    v_dot2_f32_bf16 v87, v23, s63, v87
    v_dot2_f32_bf16 v72, v26, s80, v72
    v_dot2_f32_bf16 v73, v27, s80, v73
    v_dot2_f32_bf16 v74, v26, s81, v74
    v_dot2_f32_bf16 v75, v27, s81, v75
    v_dot2_f32_bf16 v76, v26, s82, v76
    v_dot2_f32_bf16 v77, v27, s82, v77
    v_dot2_f32_bf16 v78, v26, s83, v78
    v_dot2_f32_bf16 v79, v27, s83, v79
    v_dot2_f32_bf16 v80, v26, s64, v80
    v_dot2_f32_bf16 v81, v27, s64, v81
    v_dot2_f32_bf16 v82, v26, s65, v82
    v_dot2_f32_bf16 v83, v27, s65, v83
    v_dot2_f32_bf16 v84, v26, s66, v84
    v_dot2_f32_bf16 v85, v27, s66, v85
    v_dot2_f32_bf16 v86, v26, s67, v86
    v_dot2_f32_bf16 v87, v27, s67, v87
L_p2_gb:
    v_and_b32 v4, 0x80008000, v4
    v_cmp_ne_u32 vcc, 0, v4
    v_mov_b32 v8, s27
    v_and_b32 v10, 15, v0
    v_mul_u32_u24 v10, 240, v10
    v_add_u32 v10, 160000, v10
    s_cmp_lg_u64 vcc, 0
    s_cselect_b32 s2, 1, s2
    v_mov_b32 v9, s2
    s_mov_b64 exec, 1
    ds_write_b32 v8, v9
    s_mov_b64 exec, -1
    v_add_u32 v2, 16384, v1
    v_mov_b32 v9, 0x3f000000
    v_cmp_gt_u32 vcc, 226, v0
    s_mov_b32 s49, s12
    s_mov_b32 s51, 0
    v_cndmask_b32 v2, v9, v2, vcc
    s_waitcnt vmcnt(0) lgkmcnt(0)
    s_barrier
    ds_read_b32 v9, v10
    s_mov_b32 s18, 5120000
    s_mov_b32 s19, 0x00020000
    s_waitcnt lgkmcnt(0)
    v_cmp_ne_u32 vcc, 0, v9
    s_nop 1
    s_cmp_lg_u64 vcc, 0
    s_cselect_b32 s2, 1, 0
    s_cbranch_scc1 L_p2_slow
L_p2_signal:
    v_mov_b32 v8, 160228
    s_lshl_b32 s15, s2, 4
    s_or_b32 s15, s15, s21
    s_add_u32 s14, s12, 16
    s_lshl_b32 s20, s15, s14
    s_add_u32 s20, s20, 1
    v_mov_b32 v9, s20
    s_cmp_lg_u32 s13, 15
    s_cbranch_scc1 L_p2_nosig0
    s_lshl_b32 s14, s3, 8
    s_add_u32 s14, s14, 8523776
    s_mov_b64 exec, 1
    buffer_atomic_add v9, off, s[4:7], s14 sc0
    s_mov_b64 exec, -1
L_p2_nosig0:
    s_lshl2_add_u32 s14, s3, s49
    s_mul_i32 s26, s14, 20000
    s_mov_b32 s10, 5120000
    buffer_load_dwordx4 v[64:67], v1, s[8:11], s26 offen
    buffer_load_dwordx4 v[68:71], v2, s[8:11], s26 offen
    s_lshl_b32 s28, s92, 16
    s_and_b32 s29, s92, 0xffff0000
    s_lshl_b32 s30, s93, 16
    s_and_b32 s31, s93, 0xffff0000
    s_lshl_b32 s32, s94, 16
    s_and_b32 s33, s94, 0xffff0000
    s_lshl_b32 s34, s95, 16
    s_and_b32 s35, s95, 0xffff0000
    s_lshl_b32 s36, s96, 16
    s_and_b32 s37, s96, 0xffff0000
    s_lshl_b32 s38, s97, 16
    s_and_b32 s39, s97, 0xffff0000
    s_lshl_b32 s40, s98, 16
    s_and_b32 s41, s98, 0xffff0000
    s_lshl_b32 s42, s99, 16
    s_and_b32 s43, s99, 0xffff0000
    s_and_b32 s99, s91, 0xffff0000
    s_lshl_b32 s98, s91, 16
    s_and_b32 s97, s90, 0xffff0000
    s_lshl_b32 s96, s90, 16
    s_and_b32 s95, s89, 0xffff0000
    s_lshl_b32 s94, s89, 16
    s_and_b32 s93, s88, 0xffff0000
    s_lshl_b32 s92, s88, 16
    s_and_b32 s91, s87, 0xffff0000
    s_lshl_b32 s90, s87, 16
    s_and_b32 s89, s86, 0xffff0000
    s_lshl_b32 s88, s86, 16
    s_and_b32 s87, s85, 0xffff0000
    s_lshl_b32 s86, s85, 16
    s_and_b32 s85, s84, 0xffff0000
    s_lshl_b32 s84, s84, 16
    s_mov_b32 s44, s48
    s_add_u32 s45, s48, 2281701376
    s_cmp_eq_u32 s48, 0
    s_cselect_b32 s45, 0, s45
    s_cmp_lt_u32 s13, 12
    s_cbranch_scc1 L_p2_gc
    v_lshlrev_b32 v30, 16, v60
    v_and_b32 v31, 0xffff0000, v60
    v_lshlrev_b32 v36, 16, v53
    v_and_b32 v37, 0xffff0000, v53
    v_lshlrev_b32 v38, 16, v54
    v_and_b32 v39, 0xffff0000, v54
    v_lshlrev_b32 v40, 16, v56
    v_and_b32 v41, 0xffff0000, v56
    v_lshlrev_b32 v42, 16, v57
    v_and_b32 v43, 0xffff0000, v57
    v_pk_add_f32 v[14:15], v[30:31], v[36:37] op_sel:[0,0] op_sel_hi:[1,0] neg_lo:[0,1] neg_hi:[0,1]
    v_pk_add_f32 v[16:17], v[30:31], v[36:37] op_sel:[0,1] op_sel_hi:[1,1] neg_lo:[0,1] neg_hi:[0,1]
    v_pk_add_f32 v[18:19], v[30:31], v[38:39] op_sel:[0,0] op_sel_hi:[1,0] neg_lo:[0,1] neg_hi:[0,1]
    v_pk_add_f32 v[20:21], v[30:31], v[38:39] op_sel:[0,1] op_sel_hi:[1,1] neg_lo:[0,1] neg_hi:[0,1]
    v_pk_add_f32 v[22:23], v[30:31], v[40:41] op_sel:[0,0] op_sel_hi:[1,0] neg_lo:[0,1] neg_hi:[0,1]
    v_pk_add_f32 v[24:25], v[30:31], v[40:41] op_sel:[0,1] op_sel_hi:[1,1] neg_lo:[0,1] neg_hi:[0,1]
    v_pk_add_f32 v[26:27], v[30:31], v[42:43] op_sel:[0,0] op_sel_hi:[1,0] neg_lo:[0,1] neg_hi:[0,1]
    v_pk_add_f32 v[28:29], v[30:31], v[42:43] op_sel:[0,1] op_sel_hi:[1,1] neg_lo:[0,1] neg_hi:[0,1]
    v_cvt_pk_bf16_f32 v32, v14, v15
    v_lshlrev_b32 v14, 16, v32
    v_and_b32 v15, 0xffff0000, v32
    v_cvt_pk_bf16_f32 v32, v16, v17
    v_lshlrev_b32 v16, 16, v32
    v_and_b32 v17, 0xffff0000, v32
    v_cvt_pk_bf16_f32 v32, v18, v19
    v_lshlrev_b32 v18, 16, v32
    v_and_b32 v19, 0xffff0000, v32
    v_cvt_pk_bf16_f32 v32, v20, v21
    v_lshlrev_b32 v20, 16, v32
    v_and_b32 v21, 0xffff0000, v32
    v_cvt_pk_bf16_f32 v32, v22, v23
    v_lshlrev_b32 v22, 16, v32
    v_and_b32 v23, 0xffff0000, v32
    v_cvt_pk_bf16_f32 v32, v24, v25
    v_lshlrev_b32 v24, 16, v32
    v_and_b32 v25, 0xffff0000, v32
    v_cvt_pk_bf16_f32 v32, v26, v27
    v_lshlrev_b32 v26, 16, v32
    v_and_b32 v27, 0xffff0000, v32
    v_cvt_pk_bf16_f32 v32, v28, v29
    v_lshlrev_b32 v28, 16, v32
    v_and_b32 v29, 0xffff0000, v32
    v_pk_mul_f32 v[14:15], v[14:15], v[14:15]
    v_pk_mul_f32 v[16:17], v[16:17], v[16:17]
    v_pk_mul_f32 v[18:19], v[18:19], v[18:19]
    v_pk_mul_f32 v[20:21], v[20:21], v[20:21]
    v_pk_mul_f32 v[22:23], v[22:23], v[22:23]
    v_pk_mul_f32 v[24:25], v[24:25], v[24:25]
    v_pk_mul_f32 v[26:27], v[26:27], v[26:27]
    v_pk_mul_f32 v[28:29], v[28:29], v[28:29]
    v_cvt_pk_bf16_f32 v32, v14, v15
    v_lshlrev_b32 v14, 16, v32
    v_and_b32 v15, 0xffff0000, v32
    v_cvt_pk_bf16_f32 v32, v16, v17
    v_lshlrev_b32 v16, 16, v32
    v_and_b32 v17, 0xffff0000, v32
    v_cvt_pk_bf16_f32 v32, v18, v19
    v_lshlrev_b32 v18, 16, v32
    v_and_b32 v19, 0xffff0000, v32
    v_cvt_pk_bf16_f32 v32, v20, v21
    v_lshlrev_b32 v20, 16, v32
    v_and_b32 v21, 0xffff0000, v32
    v_cvt_pk_bf16_f32 v32, v22, v23
    v_lshlrev_b32 v22, 16, v32
    v_and_b32 v23, 0xffff0000, v32
    v_cvt_pk_bf16_f32 v32, v24, v25
    v_lshlrev_b32 v24, 16, v32
    v_and_b32 v25, 0xffff0000, v32
    v_cvt_pk_bf16_f32 v32, v26, v27
    v_lshlrev_b32 v26, 16, v32
    v_and_b32 v27, 0xffff0000, v32
    v_cvt_pk_bf16_f32 v32, v28, v29
    v_lshlrev_b32 v28, 16, v32
    v_and_b32 v29, 0xffff0000, v32
    v_mov_b32 v30, 1092616192
    v_mov_b32 v31, 0x3fb8aa3b
    v_pk_mul_f32 v[14:15], v[14:15], v[30:31] op_sel:[0,0] op_sel_hi:[1,0]
    v_pk_mul_f32 v[16:17], v[16:17], v[30:31] op_sel:[0,0] op_sel_hi:[1,0]
    v_pk_mul_f32 v[18:19], v[18:19], v[30:31] op_sel:[0,0] op_sel_hi:[1,0]
    v_pk_mul_f32 v[20:21], v[20:21], v[30:31] op_sel:[0,0] op_sel_hi:[1,0]
    v_pk_mul_f32 v[22:23], v[22:23], v[30:31] op_sel:[0,0] op_sel_hi:[1,0]
    v_pk_mul_f32 v[24:25], v[24:25], v[30:31] op_sel:[0,0] op_sel_hi:[1,0]
    v_pk_mul_f32 v[26:27], v[26:27], v[30:31] op_sel:[0,0] op_sel_hi:[1,0]
    v_pk_mul_f32 v[28:29], v[28:29], v[30:31] op_sel:[0,0] op_sel_hi:[1,0]
    v_cvt_pk_bf16_f32 v32, v14, v15
    v_lshlrev_b32 v14, 16, v32
    v_and_b32 v15, 0xffff0000, v32
    v_cvt_pk_bf16_f32 v32, v16, v17
    v_lshlrev_b32 v16, 16, v32
    v_and_b32 v17, 0xffff0000, v32
    v_cvt_pk_bf16_f32 v32, v18, v19
    v_lshlrev_b32 v18, 16, v32
    v_and_b32 v19, 0xffff0000, v32
    v_cvt_pk_bf16_f32 v32, v20, v21
    v_lshlrev_b32 v20, 16, v32
    v_and_b32 v21, 0xffff0000, v32
    v_cvt_pk_bf16_f32 v32, v22, v23
    v_lshlrev_b32 v22, 16, v32
    v_and_b32 v23, 0xffff0000, v32
    v_cvt_pk_bf16_f32 v32, v24, v25
    v_lshlrev_b32 v24, 16, v32
    v_and_b32 v25, 0xffff0000, v32
    v_cvt_pk_bf16_f32 v32, v26, v27
    v_lshlrev_b32 v26, 16, v32
    v_and_b32 v27, 0xffff0000, v32
    v_cvt_pk_bf16_f32 v32, v28, v29
    v_lshlrev_b32 v28, 16, v32
    v_and_b32 v29, 0xffff0000, v32
    v_pk_mul_f32 v[14:15], v[14:15], v[30:31] op_sel:[0,1] op_sel_hi:[1,1]
    v_pk_mul_f32 v[16:17], v[16:17], v[30:31] op_sel:[0,1] op_sel_hi:[1,1]
    v_pk_mul_f32 v[18:19], v[18:19], v[30:31] op_sel:[0,1] op_sel_hi:[1,1]
    v_pk_mul_f32 v[20:21], v[20:21], v[30:31] op_sel:[0,1] op_sel_hi:[1,1]
    v_pk_mul_f32 v[22:23], v[22:23], v[30:31] op_sel:[0,1] op_sel_hi:[1,1]
    v_pk_mul_f32 v[24:25], v[24:25], v[30:31] op_sel:[0,1] op_sel_hi:[1,1]
    v_pk_mul_f32 v[26:27], v[26:27], v[30:31] op_sel:[0,1] op_sel_hi:[1,1]
    v_pk_mul_f32 v[28:29], v[28:29], v[30:31] op_sel:[0,1] op_sel_hi:[1,1]
    v_exp_f32 v14, -v14
    v_exp_f32 v15, -v15
    v_exp_f32 v16, -v16
    v_exp_f32 v17, -v17
    v_exp_f32 v18, -v18
    v_exp_f32 v19, -v19
    v_exp_f32 v20, -v20
    v_exp_f32 v21, -v21
    v_exp_f32 v22, -v22
    v_exp_f32 v23, -v23
    v_exp_f32 v24, -v24
    v_exp_f32 v25, -v25
    v_exp_f32 v26, -v26
    v_exp_f32 v27, -v27
    v_exp_f32 v28, -v28
    v_exp_f32 v29, -v29
    v_cvt_pk_bf16_f32 v14, v14, v16
    v_cvt_pk_bf16_f32 v15, v15, v17
    v_cvt_pk_bf16_f32 v18, v18, v20
    v_cvt_pk_bf16_f32 v19, v19, v21
    v_cvt_pk_bf16_f32 v22, v22, v24
    v_cvt_pk_bf16_f32 v23, v23, v25
    v_cvt_pk_bf16_f32 v26, v26, v28
    v_cvt_pk_bf16_f32 v27, v27, v29
    v_dot2_f32_bf16 v72, v14, s68, 0
    v_dot2_f32_bf16 v73, v15, s68, 0
    v_dot2_f32_bf16 v74, v14, s69, 0
    v_dot2_f32_bf16 v75, v15, s69, 0
    v_dot2_f32_bf16 v76, v14, s70, 0
    v_dot2_f32_bf16 v77, v15, s70, 0
    v_dot2_f32_bf16 v78, v14, s71, 0
    v_dot2_f32_bf16 v79, v15, s71, 0
    v_dot2_f32_bf16 v80, v14, s52, 0
    v_dot2_f32_bf16 v81, v15, s52, 0
    v_dot2_f32_bf16 v82, v14, s53, 0
    v_dot2_f32_bf16 v83, v15, s53, 0
    v_dot2_f32_bf16 v84, v14, s54, 0
    v_dot2_f32_bf16 v85, v15, s54, 0
    v_dot2_f32_bf16 v86, v14, s55, 0
    v_dot2_f32_bf16 v87, v15, s55, 0
    v_dot2_f32_bf16 v72, v18, s72, v72
    v_dot2_f32_bf16 v73, v19, s72, v73
    v_dot2_f32_bf16 v74, v18, s73, v74
    v_dot2_f32_bf16 v75, v19, s73, v75
    v_dot2_f32_bf16 v76, v18, s74, v76
    v_dot2_f32_bf16 v77, v19, s74, v77
    v_dot2_f32_bf16 v78, v18, s75, v78
    v_dot2_f32_bf16 v79, v19, s75, v79
    v_dot2_f32_bf16 v80, v18, s56, v80
    v_dot2_f32_bf16 v81, v19, s56, v81
    v_dot2_f32_bf16 v82, v18, s57, v82
    v_dot2_f32_bf16 v83, v19, s57, v83
    v_dot2_f32_bf16 v84, v18, s58, v84
    v_dot2_f32_bf16 v85, v19, s58, v85
    v_dot2_f32_bf16 v86, v18, s59, v86
    v_dot2_f32_bf16 v87, v19, s59, v87
    v_dot2_f32_bf16 v72, v22, s76, v72
    v_dot2_f32_bf16 v73, v23, s76, v73
    v_dot2_f32_bf16 v74, v22, s77, v74
    v_dot2_f32_bf16 v75, v23, s77, v75
    v_dot2_f32_bf16 v76, v22, s78, v76
    v_dot2_f32_bf16 v77, v23, s78, v77
    v_dot2_f32_bf16 v78, v22, s79, v78
    v_dot2_f32_bf16 v79, v23, s79, v79
    v_dot2_f32_bf16 v80, v22, s60, v80
    v_dot2_f32_bf16 v81, v23, s60, v81
    v_dot2_f32_bf16 v82, v22, s61, v82
    v_dot2_f32_bf16 v83, v23, s61, v83
    v_dot2_f32_bf16 v84, v22, s62, v84
    v_dot2_f32_bf16 v85, v23, s62, v85
    v_dot2_f32_bf16 v86, v22, s63, v86
    v_dot2_f32_bf16 v87, v23, s63, v87
    v_dot2_f32_bf16 v72, v26, s80, v72
    v_dot2_f32_bf16 v73, v27, s80, v73
    v_dot2_f32_bf16 v74, v26, s81, v74
    v_dot2_f32_bf16 v75, v27, s81, v75
    v_dot2_f32_bf16 v76, v26, s82, v76
    v_dot2_f32_bf16 v77, v27, s82, v77
    v_dot2_f32_bf16 v78, v26, s83, v78
    v_dot2_f32_bf16 v79, v27, s83, v79
    v_dot2_f32_bf16 v80, v26, s64, v80
    v_dot2_f32_bf16 v81, v27, s64, v81
    v_dot2_f32_bf16 v82, v26, s65, v82
    v_dot2_f32_bf16 v83, v27, s65, v83
    v_dot2_f32_bf16 v84, v26, s66, v84
    v_dot2_f32_bf16 v85, v27, s66, v85
    v_dot2_f32_bf16 v86, v26, s67, v86
    v_dot2_f32_bf16 v87, v27, s67, v87
L_p2_gc:
    s_cmp_ge_u32 s13, 4
    s_cbranch_scc1 L_p2_gd
    v_lshlrev_b32 v30, 16, v61
    v_and_b32 v31, 0xffff0000, v61
    v_pk_add_f32 v[14:15], v[30:31], v[36:37] op_sel:[0,0] op_sel_hi:[1,0] neg_lo:[0,1] neg_hi:[0,1]
    v_pk_add_f32 v[16:17], v[30:31], v[36:37] op_sel:[0,1] op_sel_hi:[1,1] neg_lo:[0,1] neg_hi:[0,1]
    v_pk_add_f32 v[18:19], v[30:31], v[38:39] op_sel:[0,0] op_sel_hi:[1,0] neg_lo:[0,1] neg_hi:[0,1]
    v_pk_add_f32 v[20:21], v[30:31], v[38:39] op_sel:[0,1] op_sel_hi:[1,1] neg_lo:[0,1] neg_hi:[0,1]
    v_pk_add_f32 v[22:23], v[30:31], v[40:41] op_sel:[0,0] op_sel_hi:[1,0] neg_lo:[0,1] neg_hi:[0,1]
    v_pk_add_f32 v[24:25], v[30:31], v[40:41] op_sel:[0,1] op_sel_hi:[1,1] neg_lo:[0,1] neg_hi:[0,1]
    v_pk_add_f32 v[26:27], v[30:31], v[42:43] op_sel:[0,0] op_sel_hi:[1,0] neg_lo:[0,1] neg_hi:[0,1]
    v_pk_add_f32 v[28:29], v[30:31], v[42:43] op_sel:[0,1] op_sel_hi:[1,1] neg_lo:[0,1] neg_hi:[0,1]
    v_cvt_pk_bf16_f32 v32, v14, v15
    v_lshlrev_b32 v14, 16, v32
    v_and_b32 v15, 0xffff0000, v32
    v_cvt_pk_bf16_f32 v32, v16, v17
    v_lshlrev_b32 v16, 16, v32
    v_and_b32 v17, 0xffff0000, v32
    v_cvt_pk_bf16_f32 v32, v18, v19
    v_lshlrev_b32 v18, 16, v32
    v_and_b32 v19, 0xffff0000, v32
    v_cvt_pk_bf16_f32 v32, v20, v21
    v_lshlrev_b32 v20, 16, v32
    v_and_b32 v21, 0xffff0000, v32
    v_cvt_pk_bf16_f32 v32, v22, v23
    v_lshlrev_b32 v22, 16, v32
    v_and_b32 v23, 0xffff0000, v32
    v_cvt_pk_bf16_f32 v32, v24, v25
    v_lshlrev_b32 v24, 16, v32
    v_and_b32 v25, 0xffff0000, v32
    v_cvt_pk_bf16_f32 v32, v26, v27
    v_lshlrev_b32 v26, 16, v32
    v_and_b32 v27, 0xffff0000, v32
    v_cvt_pk_bf16_f32 v32, v28, v29
    v_lshlrev_b32 v28, 16, v32
    v_and_b32 v29, 0xffff0000, v32
    v_pk_mul_f32 v[14:15], v[14:15], v[14:15]
    v_pk_mul_f32 v[16:17], v[16:17], v[16:17]
    v_pk_mul_f32 v[18:19], v[18:19], v[18:19]
    v_pk_mul_f32 v[20:21], v[20:21], v[20:21]
    v_pk_mul_f32 v[22:23], v[22:23], v[22:23]
    v_pk_mul_f32 v[24:25], v[24:25], v[24:25]
    v_pk_mul_f32 v[26:27], v[26:27], v[26:27]
    v_pk_mul_f32 v[28:29], v[28:29], v[28:29]
    v_cvt_pk_bf16_f32 v32, v14, v15
    v_lshlrev_b32 v14, 16, v32
    v_and_b32 v15, 0xffff0000, v32
    v_cvt_pk_bf16_f32 v32, v16, v17
    v_lshlrev_b32 v16, 16, v32
    v_and_b32 v17, 0xffff0000, v32
    v_cvt_pk_bf16_f32 v32, v18, v19
    v_lshlrev_b32 v18, 16, v32
    v_and_b32 v19, 0xffff0000, v32
    v_cvt_pk_bf16_f32 v32, v20, v21
    v_lshlrev_b32 v20, 16, v32
    v_and_b32 v21, 0xffff0000, v32
    v_cvt_pk_bf16_f32 v32, v22, v23
    v_lshlrev_b32 v22, 16, v32
    v_and_b32 v23, 0xffff0000, v32
    v_cvt_pk_bf16_f32 v32, v24, v25
    v_lshlrev_b32 v24, 16, v32
    v_and_b32 v25, 0xffff0000, v32
    v_cvt_pk_bf16_f32 v32, v26, v27
    v_lshlrev_b32 v26, 16, v32
    v_and_b32 v27, 0xffff0000, v32
    v_cvt_pk_bf16_f32 v32, v28, v29
    v_lshlrev_b32 v28, 16, v32
    v_and_b32 v29, 0xffff0000, v32
    v_mov_b32 v30, 1092616192
    v_mov_b32 v31, 0x3fb8aa3b
    v_pk_mul_f32 v[14:15], v[14:15], v[30:31] op_sel:[0,0] op_sel_hi:[1,0]
    v_pk_mul_f32 v[16:17], v[16:17], v[30:31] op_sel:[0,0] op_sel_hi:[1,0]
    v_pk_mul_f32 v[18:19], v[18:19], v[30:31] op_sel:[0,0] op_sel_hi:[1,0]
    v_pk_mul_f32 v[20:21], v[20:21], v[30:31] op_sel:[0,0] op_sel_hi:[1,0]
    v_pk_mul_f32 v[22:23], v[22:23], v[30:31] op_sel:[0,0] op_sel_hi:[1,0]
    v_pk_mul_f32 v[24:25], v[24:25], v[30:31] op_sel:[0,0] op_sel_hi:[1,0]
    v_pk_mul_f32 v[26:27], v[26:27], v[30:31] op_sel:[0,0] op_sel_hi:[1,0]
    v_pk_mul_f32 v[28:29], v[28:29], v[30:31] op_sel:[0,0] op_sel_hi:[1,0]
    v_cvt_pk_bf16_f32 v32, v14, v15
    v_lshlrev_b32 v14, 16, v32
    v_and_b32 v15, 0xffff0000, v32
    v_cvt_pk_bf16_f32 v32, v16, v17
    v_lshlrev_b32 v16, 16, v32
    v_and_b32 v17, 0xffff0000, v32
    v_cvt_pk_bf16_f32 v32, v18, v19
    v_lshlrev_b32 v18, 16, v32
    v_and_b32 v19, 0xffff0000, v32
    v_cvt_pk_bf16_f32 v32, v20, v21
    v_lshlrev_b32 v20, 16, v32
    v_and_b32 v21, 0xffff0000, v32
    v_cvt_pk_bf16_f32 v32, v22, v23
    v_lshlrev_b32 v22, 16, v32
    v_and_b32 v23, 0xffff0000, v32
    v_cvt_pk_bf16_f32 v32, v24, v25
    v_lshlrev_b32 v24, 16, v32
    v_and_b32 v25, 0xffff0000, v32
    v_cvt_pk_bf16_f32 v32, v26, v27
    v_lshlrev_b32 v26, 16, v32
    v_and_b32 v27, 0xffff0000, v32
    v_cvt_pk_bf16_f32 v32, v28, v29
    v_lshlrev_b32 v28, 16, v32
    v_and_b32 v29, 0xffff0000, v32
    v_pk_mul_f32 v[14:15], v[14:15], v[30:31] op_sel:[0,1] op_sel_hi:[1,1]
    v_pk_mul_f32 v[16:17], v[16:17], v[30:31] op_sel:[0,1] op_sel_hi:[1,1]
    v_pk_mul_f32 v[18:19], v[18:19], v[30:31] op_sel:[0,1] op_sel_hi:[1,1]
    v_pk_mul_f32 v[20:21], v[20:21], v[30:31] op_sel:[0,1] op_sel_hi:[1,1]
    v_pk_mul_f32 v[22:23], v[22:23], v[30:31] op_sel:[0,1] op_sel_hi:[1,1]
    v_pk_mul_f32 v[24:25], v[24:25], v[30:31] op_sel:[0,1] op_sel_hi:[1,1]
    v_pk_mul_f32 v[26:27], v[26:27], v[30:31] op_sel:[0,1] op_sel_hi:[1,1]
    v_pk_mul_f32 v[28:29], v[28:29], v[30:31] op_sel:[0,1] op_sel_hi:[1,1]
    v_exp_f32 v14, -v14
    v_exp_f32 v15, -v15
    v_exp_f32 v16, -v16
    v_exp_f32 v17, -v17
    v_exp_f32 v18, -v18
    v_exp_f32 v19, -v19
    v_exp_f32 v20, -v20
    v_exp_f32 v21, -v21
    v_exp_f32 v22, -v22
    v_exp_f32 v23, -v23
    v_exp_f32 v24, -v24
    v_exp_f32 v25, -v25
    v_exp_f32 v26, -v26
    v_exp_f32 v27, -v27
    v_exp_f32 v28, -v28
    v_exp_f32 v29, -v29
    v_cvt_pk_bf16_f32 v14, v14, v16
    v_cvt_pk_bf16_f32 v15, v15, v17
    v_cvt_pk_bf16_f32 v18, v18, v20
    v_cvt_pk_bf16_f32 v19, v19, v21
    v_cvt_pk_bf16_f32 v22, v22, v24
    v_cvt_pk_bf16_f32 v23, v23, v25
    v_cvt_pk_bf16_f32 v26, v26, v28
    v_cvt_pk_bf16_f32 v27, v27, v29
    v_dot2_f32_bf16 v112, v14, s68, 0
    v_dot2_f32_bf16 v113, v15, s68, 0
    v_dot2_f32_bf16 v114, v14, s69, 0
    v_dot2_f32_bf16 v115, v15, s69, 0
    v_dot2_f32_bf16 v116, v14, s70, 0
    v_dot2_f32_bf16 v117, v15, s70, 0
    v_dot2_f32_bf16 v118, v14, s71, 0
    v_dot2_f32_bf16 v119, v15, s71, 0
    v_dot2_f32_bf16 v120, v14, s52, 0
    v_dot2_f32_bf16 v121, v15, s52, 0
    v_dot2_f32_bf16 v122, v14, s53, 0
    v_dot2_f32_bf16 v123, v15, s53, 0
    v_dot2_f32_bf16 v124, v14, s54, 0
    v_dot2_f32_bf16 v125, v15, s54, 0
    v_dot2_f32_bf16 v126, v14, s55, 0
    v_dot2_f32_bf16 v127, v15, s55, 0
    v_dot2_f32_bf16 v112, v18, s72, v112
    v_dot2_f32_bf16 v113, v19, s72, v113
    v_dot2_f32_bf16 v114, v18, s73, v114
    v_dot2_f32_bf16 v115, v19, s73, v115
    v_dot2_f32_bf16 v116, v18, s74, v116
    v_dot2_f32_bf16 v117, v19, s74, v117
    v_dot2_f32_bf16 v118, v18, s75, v118
    v_dot2_f32_bf16 v119, v19, s75, v119
    v_dot2_f32_bf16 v120, v18, s56, v120
    v_dot2_f32_bf16 v121, v19, s56, v121
    v_dot2_f32_bf16 v122, v18, s57, v122
    v_dot2_f32_bf16 v123, v19, s57, v123
    v_dot2_f32_bf16 v124, v18, s58, v124
    v_dot2_f32_bf16 v125, v19, s58, v125
    v_dot2_f32_bf16 v126, v18, s59, v126
    v_dot2_f32_bf16 v127, v19, s59, v127
    v_dot2_f32_bf16 v112, v22, s76, v112
    v_dot2_f32_bf16 v113, v23, s76, v113
    v_dot2_f32_bf16 v114, v22, s77, v114
    v_dot2_f32_bf16 v115, v23, s77, v115
    v_dot2_f32_bf16 v116, v22, s78, v116
    v_dot2_f32_bf16 v117, v23, s78, v117
    v_dot2_f32_bf16 v118, v22, s79, v118
    v_dot2_f32_bf16 v119, v23, s79, v119
    v_dot2_f32_bf16 v120, v22, s60, v120
    v_dot2_f32_bf16 v121, v23, s60, v121
    v_dot2_f32_bf16 v122, v22, s61, v122
    v_dot2_f32_bf16 v123, v23, s61, v123
    v_dot2_f32_bf16 v124, v22, s62, v124
    v_dot2_f32_bf16 v125, v23, s62, v125
    v_dot2_f32_bf16 v126, v22, s63, v126
    v_dot2_f32_bf16 v127, v23, s63, v127
    v_dot2_f32_bf16 v112, v26, s80, v112
    v_dot2_f32_bf16 v113, v27, s80, v113
    v_dot2_f32_bf16 v114, v26, s81, v114
    v_dot2_f32_bf16 v115, v27, s81, v115
    v_dot2_f32_bf16 v116, v26, s82, v116
    v_dot2_f32_bf16 v117, v27, s82, v117
    v_dot2_f32_bf16 v118, v26, s83, v118
    v_dot2_f32_bf16 v119, v27, s83, v119
    v_dot2_f32_bf16 v120, v26, s64, v120
    v_dot2_f32_bf16 v121, v27, s64, v121
    v_dot2_f32_bf16 v122, v26, s65, v122
    v_dot2_f32_bf16 v123, v27, s65, v123
    v_dot2_f32_bf16 v124, v26, s66, v124
    v_dot2_f32_bf16 v125, v27, s66, v125
    v_dot2_f32_bf16 v126, v26, s67, v126
    v_dot2_f32_bf16 v127, v27, s67, v127
L_p2_gd:
    s_cmp_lg_u32 s13, 15
    s_cbranch_scc1 L_p2_nosig
    s_waitcnt vmcnt(2)
    v_readfirstlane_b32 s15, v9
    s_lshl_b32 s51, 1, s12
    s_add_u32 s20, s20, s15
    s_and_b32 s15, s20, 0xff
    s_cmp_eq_u32 s15, 4
    s_cbranch_scc0 L_p2_notlast
    s_bfe_u32 s15, s20, 262160
    s_or_b32 s51, s51, s15
    s_branch L_p2_pub
L_p2_notlast:
    s_cmp_lg_u32 s21, 0
    s_cselect_b32 s51, 0, s51
    s_cbranch_scc1 L_p2_pub
L_p2_poll:
    v_mov_b32 v9, 0
    s_lshl_b32 s14, s3, 8
    s_add_u32 s14, s14, 8523776
    s_mov_b64 exec, 1
    buffer_atomic_add v9, off, s[4:7], s14 sc0
    s_mov_b64 exec, -1
    s_waitcnt vmcnt(0)
    v_readfirstlane_b32 s20, v9
    s_nop 0
    s_and_b32 s15, s20, 0xff
    s_cmp_lt_u32 s15, 4
    s_cbranch_scc1 L_p2_poll
L_p2_pub:
    s_lshl_b32 s15, s51, 24
    s_or_b32 s15, s15, s20
    v_mov_b32 v9, s15
    s_mov_b64 exec, 1
    ds_write_b32 v8, v9
    s_mov_b64 exec, -1
    s_waitcnt lgkmcnt(0)
L_p2_nosig:
    s_barrier
    ds_read_b32 v9, v8
    s_waitcnt lgkmcnt(0)
    v_readfirstlane_b32 s20, v9
    s_nop 0
    s_lshr_b32 s51, s20, 24
    s_cbranch_scc0 L_p2_end
L_p2_fin:
    s_mul_i32 s24, s49, 20000
    s_add_u32 s14, s12, 1
    s_and_b32 s14, s14, 3
    s_mul_i32 s15, s14, 5120000
    s_add_u32 s15, s15, 228589568
    s_add_u32 s15, s15, s26
    buffer_load_dwordx4 v[12:15], v1, s[4:7], s15 offen sc1
    buffer_load_dwordx4 v[92:95], v2, s[4:7], s15 offen sc1
    s_add_u32 s14, s12, 2
    s_and_b32 s14, s14, 3
    s_mul_i32 s15, s14, 5120000
    s_add_u32 s15, s15, 228589568
    s_add_u32 s15, s15, s26
    buffer_load_dwordx4 v[16:19], v1, s[4:7], s15 offen sc1
    buffer_load_dwordx4 v[96:99], v2, s[4:7], s15 offen sc1
    s_add_u32 s14, s12, 3
    s_and_b32 s14, s14, 3
    s_mul_i32 s15, s14, 5120000
    s_add_u32 s15, s15, 228589568
    s_add_u32 s15, s15, s26
    buffer_load_dwordx4 v[20:23], v1, s[4:7], s15 offen sc1
    buffer_load_dwordx4 v[100:103], v2, s[4:7], s15 offen sc1
    v_add_u32 v24, s24, v1
    ds_read_b128 v[8:11], v24
    v_add_u32 v25, s24, v2
    ds_read_b128 v[88:91], v25
    s_waitcnt vmcnt(0) lgkmcnt(0)
    s_bfe_u32 s14, s20, 262164
    s_cbranch_scc0 L_p2_kernel_nof32a_10
    s_add_u32 s14, s12, 0
    s_and_b32 s14, s14, 3
    s_add_u32 s14, s14, 20
    s_bitcmp1_b32 s20, s14
    s_cbranch_scc0 L_p2_kernel_q_11
    v_mov_b32 v8, 1073758208
    v_mov_b32 v9, 1073758208
    v_mov_b32 v10, 1073758208
    v_mov_b32 v11, 1073758208
L_p2_kernel_q_11:
    s_add_u32 s14, s12, 1
    s_and_b32 s14, s14, 3
    s_add_u32 s14, s14, 20
    s_bitcmp1_b32 s20, s14
    s_cbranch_scc0 L_p2_kernel_q_12
    v_mov_b32 v12, 1073758208
    v_mov_b32 v13, 1073758208
    v_mov_b32 v14, 1073758208
    v_mov_b32 v15, 1073758208
L_p2_kernel_q_12:
    s_add_u32 s14, s12, 2
    s_and_b32 s14, s14, 3
    s_add_u32 s14, s14, 20
    s_bitcmp1_b32 s20, s14
    s_cbranch_scc0 L_p2_kernel_q_13
    v_mov_b32 v16, 1073758208
    v_mov_b32 v17, 1073758208
    v_mov_b32 v18, 1073758208
    v_mov_b32 v19, 1073758208
L_p2_kernel_q_13:
    s_add_u32 s14, s12, 3
    s_and_b32 s14, s14, 3
    s_add_u32 s14, s14, 20
    s_bitcmp1_b32 s20, s14
    s_cbranch_scc0 L_p2_kernel_q_14
    v_mov_b32 v20, 1073758208
    v_mov_b32 v21, 1073758208
    v_mov_b32 v22, 1073758208
    v_mov_b32 v23, 1073758208
L_p2_kernel_q_14:
L_p2_kernel_nof32a_10:
    v_pk_add_u16 v8, v8, v12
    v_pk_add_u16 v16, v16, v20
    v_pk_add_u16 v9, v9, v13
    v_pk_add_u16 v17, v17, v21
    v_pk_add_u16 v10, v10, v14
    v_pk_add_u16 v18, v18, v22
    v_pk_add_u16 v11, v11, v15
    v_pk_add_u16 v19, v19, v23
    v_add_u32_sdwa v24, v8, v16 dst_sel:DWORD dst_unused:UNUSED_PAD src0_sel:WORD_0 src1_sel:WORD_0
    v_add_u32_sdwa v25, v10, v18 dst_sel:DWORD dst_unused:UNUSED_PAD src0_sel:WORD_0 src1_sel:WORD_0
    v_add_u32_sdwa v26, v8, v16 dst_sel:DWORD dst_unused:UNUSED_PAD src0_sel:WORD_1 src1_sel:WORD_1
    v_add_u32_sdwa v27, v10, v18 dst_sel:DWORD dst_unused:UNUSED_PAD src0_sel:WORD_1 src1_sel:WORD_1
    v_add_u32_sdwa v28, v9, v17 dst_sel:DWORD dst_unused:UNUSED_PAD src0_sel:WORD_0 src1_sel:WORD_0
    v_add_u32_sdwa v29, v11, v19 dst_sel:DWORD dst_unused:UNUSED_PAD src0_sel:WORD_0 src1_sel:WORD_0
    v_add_u32_sdwa v30, v9, v17 dst_sel:DWORD dst_unused:UNUSED_PAD src0_sel:WORD_1 src1_sel:WORD_1
    v_add_u32_sdwa v31, v11, v19 dst_sel:DWORD dst_unused:UNUSED_PAD src0_sel:WORD_1 src1_sel:WORD_1
    v_cvt_f32_u32 v24, v24
    v_cvt_f32_u32 v25, v25
    v_cvt_f32_u32 v26, v26
    v_cvt_f32_u32 v27, v27
    v_cvt_f32_u32 v28, v28
    v_cvt_f32_u32 v29, v29
    v_cvt_f32_u32 v30, v30
    v_cvt_f32_u32 v31, v31
    v_pk_fma_f32 v[24:25], v[24:25], s[44:45], s[44:45] op_sel:[0,0,1] op_sel_hi:[1,0,1]
    v_pk_fma_f32 v[26:27], v[26:27], s[44:45], s[44:45] op_sel:[0,0,1] op_sel_hi:[1,0,1]
    v_pk_fma_f32 v[28:29], v[28:29], s[44:45], s[44:45] op_sel:[0,0,1] op_sel_hi:[1,0,1]
    v_pk_fma_f32 v[30:31], v[30:31], s[44:45], s[44:45] op_sel:[0,0,1] op_sel_hi:[1,0,1]
    s_bfe_u32 s14, s20, 262164
    s_cbranch_scc0 L_p2_kernel_nof32b_15
    v_lshlrev_b32 v32, 1, v1
    s_bitcmp1_b32 s20, 20
    s_cbranch_scc0 L_p2_kernel_q_16
    s_lshl_b32 s15, s26, 1
    s_add_u32 s15, s15, 249069568
    buffer_load_dwordx4 v[8:11], v32, s[4:7], s15 offen sc1
    buffer_load_dwordx4 v[12:15], v32, s[4:7], s15 offen offset:16 sc1
    s_waitcnt vmcnt(0)
    v_add_f32 v24, v24, v8
    v_add_f32 v25, v25, v12
    v_add_f32 v26, v26, v9
    v_add_f32 v27, v27, v13
    v_add_f32 v28, v28, v10
    v_add_f32 v29, v29, v14
    v_add_f32 v30, v30, v11
    v_add_f32 v31, v31, v15
L_p2_kernel_q_16:
    s_bitcmp1_b32 s20, 21
    s_cbranch_scc0 L_p2_kernel_q_17
    s_lshl_b32 s15, s26, 1
    s_add_u32 s15, s15, 259309568
    buffer_load_dwordx4 v[8:11], v32, s[4:7], s15 offen sc1
    buffer_load_dwordx4 v[12:15], v32, s[4:7], s15 offen offset:16 sc1
    s_waitcnt vmcnt(0)
    v_add_f32 v24, v24, v8
    v_add_f32 v25, v25, v12
    v_add_f32 v26, v26, v9
    v_add_f32 v27, v27, v13
    v_add_f32 v28, v28, v10
    v_add_f32 v29, v29, v14
    v_add_f32 v30, v30, v11
    v_add_f32 v31, v31, v15
L_p2_kernel_q_17:
    s_bitcmp1_b32 s20, 22
    s_cbranch_scc0 L_p2_kernel_q_18
    s_lshl_b32 s15, s26, 1
    s_add_u32 s15, s15, 269549568
    buffer_load_dwordx4 v[8:11], v32, s[4:7], s15 offen sc1
    buffer_load_dwordx4 v[12:15], v32, s[4:7], s15 offen offset:16 sc1
    s_waitcnt vmcnt(0)
    v_add_f32 v24, v24, v8
    v_add_f32 v25, v25, v12
    v_add_f32 v26, v26, v9
    v_add_f32 v27, v27, v13
    v_add_f32 v28, v28, v10
    v_add_f32 v29, v29, v14
    v_add_f32 v30, v30, v11
    v_add_f32 v31, v31, v15
L_p2_kernel_q_18:
    s_bitcmp1_b32 s20, 23
    s_cbranch_scc0 L_p2_kernel_q_19
    s_lshl_b32 s15, s26, 1
    s_add_u32 s15, s15, 279789568
    buffer_load_dwordx4 v[8:11], v32, s[4:7], s15 offen sc1
    buffer_load_dwordx4 v[12:15], v32, s[4:7], s15 offen offset:16 sc1
    s_waitcnt vmcnt(0)
    v_add_f32 v24, v24, v8
    v_add_f32 v25, v25, v12
    v_add_f32 v26, v26, v9
    v_add_f32 v27, v27, v13
    v_add_f32 v28, v28, v10
    v_add_f32 v29, v29, v14
    v_add_f32 v30, v30, v11
    v_add_f32 v31, v31, v15
L_p2_kernel_q_19:
L_p2_kernel_nof32b_15:
    v_pk_mul_f32 v[8:9], v[24:25], s[84:85] op_sel:[0,0] op_sel_hi:[1,0]
    v_pk_mul_f32 v[10:11], v[24:25], s[84:85] op_sel:[0,1] op_sel_hi:[1,1]
    v_pk_mul_f32 v[12:13], v[24:25], s[86:87] op_sel:[0,0] op_sel_hi:[1,0]
    v_pk_mul_f32 v[14:15], v[24:25], s[86:87] op_sel:[0,1] op_sel_hi:[1,1]
    v_pk_fma_f32 v[8:9], v[26:27], s[88:89], v[8:9] op_sel:[0,0,0] op_sel_hi:[1,0,1]
    v_pk_fma_f32 v[10:11], v[26:27], s[88:89], v[10:11] op_sel:[0,1,0] op_sel_hi:[1,1,1]
    v_pk_fma_f32 v[12:13], v[26:27], s[90:91], v[12:13] op_sel:[0,0,0] op_sel_hi:[1,0,1]
    v_pk_fma_f32 v[14:15], v[26:27], s[90:91], v[14:15] op_sel:[0,1,0] op_sel_hi:[1,1,1]
    v_pk_fma_f32 v[8:9], v[28:29], s[92:93], v[8:9] op_sel:[0,0,0] op_sel_hi:[1,0,1]
    v_pk_fma_f32 v[10:11], v[28:29], s[92:93], v[10:11] op_sel:[0,1,0] op_sel_hi:[1,1,1]
    v_pk_fma_f32 v[12:13], v[28:29], s[94:95], v[12:13] op_sel:[0,0,0] op_sel_hi:[1,0,1]
    v_pk_fma_f32 v[14:15], v[28:29], s[94:95], v[14:15] op_sel:[0,1,0] op_sel_hi:[1,1,1]
    v_pk_fma_f32 v[8:9], v[30:31], s[96:97], v[8:9] op_sel:[0,0,0] op_sel_hi:[1,0,1]
    v_pk_fma_f32 v[10:11], v[30:31], s[96:97], v[10:11] op_sel:[0,1,0] op_sel_hi:[1,1,1]
    v_pk_fma_f32 v[12:13], v[30:31], s[98:99], v[12:13] op_sel:[0,0,0] op_sel_hi:[1,0,1]
    v_pk_fma_f32 v[14:15], v[30:31], s[98:99], v[14:15] op_sel:[0,1,0] op_sel_hi:[1,1,1]
    v_pk_mul_f32 v[8:9], v[8:9], v[72:73]
    v_pk_mul_f32 v[10:11], v[10:11], v[74:75]
    v_pk_mul_f32 v[12:13], v[12:13], v[76:77]
    v_pk_mul_f32 v[14:15], v[14:15], v[78:79]
    v_pk_mul_f32 v[24:25], v[8:9], s[28:29] op_sel:[0,0] op_sel_hi:[1,0]
    v_pk_mul_f32 v[26:27], v[8:9], s[28:29] op_sel:[0,1] op_sel_hi:[1,1]
    v_pk_mul_f32 v[28:29], v[8:9], s[30:31] op_sel:[0,0] op_sel_hi:[1,0]
    v_pk_mul_f32 v[30:31], v[8:9], s[30:31] op_sel:[0,1] op_sel_hi:[1,1]
    v_pk_fma_f32 v[24:25], v[10:11], s[32:33], v[24:25] op_sel:[0,0,0] op_sel_hi:[1,0,1]
    v_pk_fma_f32 v[26:27], v[10:11], s[32:33], v[26:27] op_sel:[0,1,0] op_sel_hi:[1,1,1]
    v_pk_fma_f32 v[28:29], v[10:11], s[34:35], v[28:29] op_sel:[0,0,0] op_sel_hi:[1,0,1]
    v_pk_fma_f32 v[30:31], v[10:11], s[34:35], v[30:31] op_sel:[0,1,0] op_sel_hi:[1,1,1]
    v_pk_fma_f32 v[24:25], v[12:13], s[36:37], v[24:25] op_sel:[0,0,0] op_sel_hi:[1,0,1]
    v_pk_fma_f32 v[26:27], v[12:13], s[36:37], v[26:27] op_sel:[0,1,0] op_sel_hi:[1,1,1]
    v_pk_fma_f32 v[28:29], v[12:13], s[38:39], v[28:29] op_sel:[0,0,0] op_sel_hi:[1,0,1]
    v_pk_fma_f32 v[30:31], v[12:13], s[38:39], v[30:31] op_sel:[0,1,0] op_sel_hi:[1,1,1]
    v_pk_fma_f32 v[24:25], v[14:15], s[40:41], v[24:25] op_sel:[0,0,0] op_sel_hi:[1,0,1]
    v_pk_fma_f32 v[26:27], v[14:15], s[40:41], v[26:27] op_sel:[0,1,0] op_sel_hi:[1,1,1]
    v_pk_fma_f32 v[28:29], v[14:15], s[42:43], v[28:29] op_sel:[0,0,0] op_sel_hi:[1,0,1]
    v_pk_fma_f32 v[30:31], v[14:15], s[42:43], v[30:31] op_sel:[0,1,0] op_sel_hi:[1,1,1]
    v_lshlrev_b32 v8, 16, v64
    v_and_b32 v10, 0xffff0000, v64
    v_lshlrev_b32 v12, 16, v65
    v_and_b32 v14, 0xffff0000, v65
    v_lshlrev_b32 v9, 16, v66
    v_and_b32 v11, 0xffff0000, v66
    v_lshlrev_b32 v13, 16, v67
    v_and_b32 v15, 0xffff0000, v67
    v_pk_fma_f32 v[8:9], v[24:25], v[80:81], v[8:9]
    v_pk_fma_f32 v[10:11], v[26:27], v[82:83], v[10:11]
    v_pk_fma_f32 v[12:13], v[28:29], v[84:85], v[12:13]
    v_pk_fma_f32 v[14:15], v[30:31], v[86:87], v[14:15]
    v_cvt_pk_bf16_f32 v16, v8, v10
    v_cvt_pk_bf16_f32 v17, v12, v14
    v_cvt_pk_bf16_f32 v18, v9, v11
    v_cvt_pk_bf16_f32 v19, v13, v15
    buffer_store_dwordx4 v[16:19], v1, s[16:19], s26 offen
    s_cmp_ge_u32 s13, 4
    s_cbranch_scc1 L_p2_f1
    s_bfe_u32 s14, s20, 262164
    s_cbranch_scc0 L_p2_kernel_nof32a_20
    s_add_u32 s14, s12, 0
    s_and_b32 s14, s14, 3
    s_add_u32 s14, s14, 20
    s_bitcmp1_b32 s20, s14
    s_cbranch_scc0 L_p2_kernel_q_21
    v_mov_b32 v88, 1073758208
    v_mov_b32 v89, 1073758208
    v_mov_b32 v90, 1073758208
    v_mov_b32 v91, 1073758208
L_p2_kernel_q_21:
    s_add_u32 s14, s12, 1
    s_and_b32 s14, s14, 3
    s_add_u32 s14, s14, 20
    s_bitcmp1_b32 s20, s14
    s_cbranch_scc0 L_p2_kernel_q_22
    v_mov_b32 v92, 1073758208
    v_mov_b32 v93, 1073758208
    v_mov_b32 v94, 1073758208
    v_mov_b32 v95, 1073758208
L_p2_kernel_q_22:
    s_add_u32 s14, s12, 2
    s_and_b32 s14, s14, 3
    s_add_u32 s14, s14, 20
    s_bitcmp1_b32 s20, s14
    s_cbranch_scc0 L_p2_kernel_q_23
    v_mov_b32 v96, 1073758208
    v_mov_b32 v97, 1073758208
    v_mov_b32 v98, 1073758208
    v_mov_b32 v99, 1073758208
L_p2_kernel_q_23:
    s_add_u32 s14, s12, 3
    s_and_b32 s14, s14, 3
    s_add_u32 s14, s14, 20
    s_bitcmp1_b32 s20, s14
    s_cbranch_scc0 L_p2_kernel_q_24
    v_mov_b32 v100, 1073758208
    v_mov_b32 v101, 1073758208
    v_mov_b32 v102, 1073758208
    v_mov_b32 v103, 1073758208
L_p2_kernel_q_24:
L_p2_kernel_nof32a_20:
    v_pk_add_u16 v88, v88, v92
    v_pk_add_u16 v96, v96, v100
    v_pk_add_u16 v89, v89, v93
    v_pk_add_u16 v97, v97, v101
    v_pk_add_u16 v90, v90, v94
    v_pk_add_u16 v98, v98, v102
    v_pk_add_u16 v91, v91, v95
    v_pk_add_u16 v99, v99, v103
    v_add_u32_sdwa v24, v88, v96 dst_sel:DWORD dst_unused:UNUSED_PAD src0_sel:WORD_0 src1_sel:WORD_0
    v_add_u32_sdwa v25, v90, v98 dst_sel:DWORD dst_unused:UNUSED_PAD src0_sel:WORD_0 src1_sel:WORD_0
    v_add_u32_sdwa v26, v88, v96 dst_sel:DWORD dst_unused:UNUSED_PAD src0_sel:WORD_1 src1_sel:WORD_1
    v_add_u32_sdwa v27, v90, v98 dst_sel:DWORD dst_unused:UNUSED_PAD src0_sel:WORD_1 src1_sel:WORD_1
    v_add_u32_sdwa v28, v89, v97 dst_sel:DWORD dst_unused:UNUSED_PAD src0_sel:WORD_0 src1_sel:WORD_0
    v_add_u32_sdwa v29, v91, v99 dst_sel:DWORD dst_unused:UNUSED_PAD src0_sel:WORD_0 src1_sel:WORD_0
    v_add_u32_sdwa v30, v89, v97 dst_sel:DWORD dst_unused:UNUSED_PAD src0_sel:WORD_1 src1_sel:WORD_1
    v_add_u32_sdwa v31, v91, v99 dst_sel:DWORD dst_unused:UNUSED_PAD src0_sel:WORD_1 src1_sel:WORD_1
    v_cvt_f32_u32 v24, v24
    v_cvt_f32_u32 v25, v25
    v_cvt_f32_u32 v26, v26
    v_cvt_f32_u32 v27, v27
    v_cvt_f32_u32 v28, v28
    v_cvt_f32_u32 v29, v29
    v_cvt_f32_u32 v30, v30
    v_cvt_f32_u32 v31, v31
    v_pk_fma_f32 v[24:25], v[24:25], s[44:45], s[44:45] op_sel:[0,0,1] op_sel_hi:[1,0,1]
    v_pk_fma_f32 v[26:27], v[26:27], s[44:45], s[44:45] op_sel:[0,0,1] op_sel_hi:[1,0,1]
    v_pk_fma_f32 v[28:29], v[28:29], s[44:45], s[44:45] op_sel:[0,0,1] op_sel_hi:[1,0,1]
    v_pk_fma_f32 v[30:31], v[30:31], s[44:45], s[44:45] op_sel:[0,0,1] op_sel_hi:[1,0,1]
    s_bfe_u32 s14, s20, 262164
    s_cbranch_scc0 L_p2_kernel_nof32b_25
    v_lshlrev_b32 v32, 1, v2
    s_bitcmp1_b32 s20, 20
    s_cbranch_scc0 L_p2_kernel_q_26
    s_lshl_b32 s15, s26, 1
    s_add_u32 s15, s15, 249069568
    buffer_load_dwordx4 v[88:91], v32, s[4:7], s15 offen sc1
    buffer_load_dwordx4 v[92:95], v32, s[4:7], s15 offen offset:16 sc1
    s_waitcnt vmcnt(0)
    v_add_f32 v24, v24, v88
    v_add_f32 v25, v25, v92
    v_add_f32 v26, v26, v89
    v_add_f32 v27, v27, v93
    v_add_f32 v28, v28, v90
    v_add_f32 v29, v29, v94
    v_add_f32 v30, v30, v91
    v_add_f32 v31, v31, v95
L_p2_kernel_q_26:
    s_bitcmp1_b32 s20, 21
    s_cbranch_scc0 L_p2_kernel_q_27
    s_lshl_b32 s15, s26, 1
    s_add_u32 s15, s15, 259309568
    buffer_load_dwordx4 v[88:91], v32, s[4:7], s15 offen sc1
    buffer_load_dwordx4 v[92:95], v32, s[4:7], s15 offen offset:16 sc1
    s_waitcnt vmcnt(0)
    v_add_f32 v24, v24, v88
    v_add_f32 v25, v25, v92
    v_add_f32 v26, v26, v89
    v_add_f32 v27, v27, v93
    v_add_f32 v28, v28, v90
    v_add_f32 v29, v29, v94
    v_add_f32 v30, v30, v91
    v_add_f32 v31, v31, v95
L_p2_kernel_q_27:
    s_bitcmp1_b32 s20, 22
    s_cbranch_scc0 L_p2_kernel_q_28
    s_lshl_b32 s15, s26, 1
    s_add_u32 s15, s15, 269549568
    buffer_load_dwordx4 v[88:91], v32, s[4:7], s15 offen sc1
    buffer_load_dwordx4 v[92:95], v32, s[4:7], s15 offen offset:16 sc1
    s_waitcnt vmcnt(0)
    v_add_f32 v24, v24, v88
    v_add_f32 v25, v25, v92
    v_add_f32 v26, v26, v89
    v_add_f32 v27, v27, v93
    v_add_f32 v28, v28, v90
    v_add_f32 v29, v29, v94
    v_add_f32 v30, v30, v91
    v_add_f32 v31, v31, v95
L_p2_kernel_q_28:
    s_bitcmp1_b32 s20, 23
    s_cbranch_scc0 L_p2_kernel_q_29
    s_lshl_b32 s15, s26, 1
    s_add_u32 s15, s15, 279789568
    buffer_load_dwordx4 v[88:91], v32, s[4:7], s15 offen sc1
    buffer_load_dwordx4 v[92:95], v32, s[4:7], s15 offen offset:16 sc1
    s_waitcnt vmcnt(0)
    v_add_f32 v24, v24, v88
    v_add_f32 v25, v25, v92
    v_add_f32 v26, v26, v89
    v_add_f32 v27, v27, v93
    v_add_f32 v28, v28, v90
    v_add_f32 v29, v29, v94
    v_add_f32 v30, v30, v91
    v_add_f32 v31, v31, v95
L_p2_kernel_q_29:
L_p2_kernel_nof32b_25:
    v_pk_mul_f32 v[88:89], v[24:25], s[84:85] op_sel:[0,0] op_sel_hi:[1,0]
    v_pk_mul_f32 v[90:91], v[24:25], s[84:85] op_sel:[0,1] op_sel_hi:[1,1]
    v_pk_mul_f32 v[92:93], v[24:25], s[86:87] op_sel:[0,0] op_sel_hi:[1,0]
    v_pk_mul_f32 v[94:95], v[24:25], s[86:87] op_sel:[0,1] op_sel_hi:[1,1]
    v_pk_fma_f32 v[88:89], v[26:27], s[88:89], v[88:89] op_sel:[0,0,0] op_sel_hi:[1,0,1]
    v_pk_fma_f32 v[90:91], v[26:27], s[88:89], v[90:91] op_sel:[0,1,0] op_sel_hi:[1,1,1]
    v_pk_fma_f32 v[92:93], v[26:27], s[90:91], v[92:93] op_sel:[0,0,0] op_sel_hi:[1,0,1]
    v_pk_fma_f32 v[94:95], v[26:27], s[90:91], v[94:95] op_sel:[0,1,0] op_sel_hi:[1,1,1]
    v_pk_fma_f32 v[88:89], v[28:29], s[92:93], v[88:89] op_sel:[0,0,0] op_sel_hi:[1,0,1]
    v_pk_fma_f32 v[90:91], v[28:29], s[92:93], v[90:91] op_sel:[0,1,0] op_sel_hi:[1,1,1]
    v_pk_fma_f32 v[92:93], v[28:29], s[94:95], v[92:93] op_sel:[0,0,0] op_sel_hi:[1,0,1]
    v_pk_fma_f32 v[94:95], v[28:29], s[94:95], v[94:95] op_sel:[0,1,0] op_sel_hi:[1,1,1]
    v_pk_fma_f32 v[88:89], v[30:31], s[96:97], v[88:89] op_sel:[0,0,0] op_sel_hi:[1,0,1]
    v_pk_fma_f32 v[90:91], v[30:31], s[96:97], v[90:91] op_sel:[0,1,0] op_sel_hi:[1,1,1]
    v_pk_fma_f32 v[92:93], v[30:31], s[98:99], v[92:93] op_sel:[0,0,0] op_sel_hi:[1,0,1]
    v_pk_fma_f32 v[94:95], v[30:31], s[98:99], v[94:95] op_sel:[0,1,0] op_sel_hi:[1,1,1]
    v_pk_mul_f32 v[88:89], v[88:89], v[112:113]
    v_pk_mul_f32 v[90:91], v[90:91], v[114:115]
    v_pk_mul_f32 v[92:93], v[92:93], v[116:117]
    v_pk_mul_f32 v[94:95], v[94:95], v[118:119]
    v_pk_mul_f32 v[24:25], v[88:89], s[28:29] op_sel:[0,0] op_sel_hi:[1,0]
    v_pk_mul_f32 v[26:27], v[88:89], s[28:29] op_sel:[0,1] op_sel_hi:[1,1]
    v_pk_mul_f32 v[28:29], v[88:89], s[30:31] op_sel:[0,0] op_sel_hi:[1,0]
    v_pk_mul_f32 v[30:31], v[88:89], s[30:31] op_sel:[0,1] op_sel_hi:[1,1]
    v_pk_fma_f32 v[24:25], v[90:91], s[32:33], v[24:25] op_sel:[0,0,0] op_sel_hi:[1,0,1]
    v_pk_fma_f32 v[26:27], v[90:91], s[32:33], v[26:27] op_sel:[0,1,0] op_sel_hi:[1,1,1]
    v_pk_fma_f32 v[28:29], v[90:91], s[34:35], v[28:29] op_sel:[0,0,0] op_sel_hi:[1,0,1]
    v_pk_fma_f32 v[30:31], v[90:91], s[34:35], v[30:31] op_sel:[0,1,0] op_sel_hi:[1,1,1]
    v_pk_fma_f32 v[24:25], v[92:93], s[36:37], v[24:25] op_sel:[0,0,0] op_sel_hi:[1,0,1]
    v_pk_fma_f32 v[26:27], v[92:93], s[36:37], v[26:27] op_sel:[0,1,0] op_sel_hi:[1,1,1]
    v_pk_fma_f32 v[28:29], v[92:93], s[38:39], v[28:29] op_sel:[0,0,0] op_sel_hi:[1,0,1]
    v_pk_fma_f32 v[30:31], v[92:93], s[38:39], v[30:31] op_sel:[0,1,0] op_sel_hi:[1,1,1]
    v_pk_fma_f32 v[24:25], v[94:95], s[40:41], v[24:25] op_sel:[0,0,0] op_sel_hi:[1,0,1]
    v_pk_fma_f32 v[26:27], v[94:95], s[40:41], v[26:27] op_sel:[0,1,0] op_sel_hi:[1,1,1]
    v_pk_fma_f32 v[28:29], v[94:95], s[42:43], v[28:29] op_sel:[0,0,0] op_sel_hi:[1,0,1]
    v_pk_fma_f32 v[30:31], v[94:95], s[42:43], v[30:31] op_sel:[0,1,0] op_sel_hi:[1,1,1]
    v_lshlrev_b32 v88, 16, v68
    v_and_b32 v90, 0xffff0000, v68
    v_lshlrev_b32 v92, 16, v69
    v_and_b32 v94, 0xffff0000, v69
    v_lshlrev_b32 v89, 16, v70
    v_and_b32 v91, 0xffff0000, v70
    v_lshlrev_b32 v93, 16, v71
    v_and_b32 v95, 0xffff0000, v71
    v_pk_fma_f32 v[88:89], v[24:25], v[120:121], v[88:89]
    v_pk_fma_f32 v[90:91], v[26:27], v[122:123], v[90:91]
    v_pk_fma_f32 v[92:93], v[28:29], v[124:125], v[92:93]
    v_pk_fma_f32 v[94:95], v[30:31], v[126:127], v[94:95]
    v_cvt_pk_bf16_f32 v96, v88, v90
    v_cvt_pk_bf16_f32 v97, v92, v94
    v_cvt_pk_bf16_f32 v98, v89, v91
    v_cvt_pk_bf16_f32 v99, v93, v95
    buffer_store_dwordx4 v[96:99], v2, s[16:19], s26 offen
L_p2_f1:
    s_bitset0_b32 s51, s49
    s_cmp_eq_u32 s51, 0
    s_cbranch_scc1 L_p2_done
    s_ff1_i32_b32 s49, s51
    s_lshl2_add_u32 s14, s3, s49
    s_mul_i32 s14, s14, 5000
    s_add_u32 s15, s14, 4096
    v_min_u32 v61, 225, v0
    v_lshl_add_u32 v60, v0, 2, s14
    v_lshl_add_u32 v61, v61, 2, s15
    global_load_dword v60, v60, s[100:101] nt
    global_load_dword v61, v61, s[100:101] nt
    s_waitcnt vmcnt(0)
    v_lshlrev_b32 v30, 16, v60
    v_and_b32 v31, 0xffff0000, v60
    v_lshlrev_b32 v36, 16, v53
    v_and_b32 v37, 0xffff0000, v53
    v_lshlrev_b32 v38, 16, v54
    v_and_b32 v39, 0xffff0000, v54
    v_lshlrev_b32 v40, 16, v56
    v_and_b32 v41, 0xffff0000, v56
    v_lshlrev_b32 v42, 16, v57
    v_and_b32 v43, 0xffff0000, v57
    v_pk_add_f32 v[14:15], v[30:31], v[36:37] op_sel:[0,0] op_sel_hi:[1,0] neg_lo:[0,1] neg_hi:[0,1]
    v_pk_add_f32 v[16:17], v[30:31], v[36:37] op_sel:[0,1] op_sel_hi:[1,1] neg_lo:[0,1] neg_hi:[0,1]
    v_pk_add_f32 v[18:19], v[30:31], v[38:39] op_sel:[0,0] op_sel_hi:[1,0] neg_lo:[0,1] neg_hi:[0,1]
    v_pk_add_f32 v[20:21], v[30:31], v[38:39] op_sel:[0,1] op_sel_hi:[1,1] neg_lo:[0,1] neg_hi:[0,1]
    v_pk_add_f32 v[22:23], v[30:31], v[40:41] op_sel:[0,0] op_sel_hi:[1,0] neg_lo:[0,1] neg_hi:[0,1]
    v_pk_add_f32 v[24:25], v[30:31], v[40:41] op_sel:[0,1] op_sel_hi:[1,1] neg_lo:[0,1] neg_hi:[0,1]
    v_pk_add_f32 v[26:27], v[30:31], v[42:43] op_sel:[0,0] op_sel_hi:[1,0] neg_lo:[0,1] neg_hi:[0,1]
    v_pk_add_f32 v[28:29], v[30:31], v[42:43] op_sel:[0,1] op_sel_hi:[1,1] neg_lo:[0,1] neg_hi:[0,1]
    v_cvt_pk_bf16_f32 v32, v14, v15
    v_lshlrev_b32 v14, 16, v32
    v_and_b32 v15, 0xffff0000, v32
    v_cvt_pk_bf16_f32 v32, v16, v17
    v_lshlrev_b32 v16, 16, v32
    v_and_b32 v17, 0xffff0000, v32
    v_cvt_pk_bf16_f32 v32, v18, v19
    v_lshlrev_b32 v18, 16, v32
    v_and_b32 v19, 0xffff0000, v32
    v_cvt_pk_bf16_f32 v32, v20, v21
    v_lshlrev_b32 v20, 16, v32
    v_and_b32 v21, 0xffff0000, v32
    v_cvt_pk_bf16_f32 v32, v22, v23
    v_lshlrev_b32 v22, 16, v32
    v_and_b32 v23, 0xffff0000, v32
    v_cvt_pk_bf16_f32 v32, v24, v25
    v_lshlrev_b32 v24, 16, v32
    v_and_b32 v25, 0xffff0000, v32
    v_cvt_pk_bf16_f32 v32, v26, v27
    v_lshlrev_b32 v26, 16, v32
    v_and_b32 v27, 0xffff0000, v32
    v_cvt_pk_bf16_f32 v32, v28, v29
    v_lshlrev_b32 v28, 16, v32
    v_and_b32 v29, 0xffff0000, v32
    v_pk_mul_f32 v[14:15], v[14:15], v[14:15]
    v_pk_mul_f32 v[16:17], v[16:17], v[16:17]
    v_pk_mul_f32 v[18:19], v[18:19], v[18:19]
    v_pk_mul_f32 v[20:21], v[20:21], v[20:21]
    v_pk_mul_f32 v[22:23], v[22:23], v[22:23]
    v_pk_mul_f32 v[24:25], v[24:25], v[24:25]
    v_pk_mul_f32 v[26:27], v[26:27], v[26:27]
    v_pk_mul_f32 v[28:29], v[28:29], v[28:29]
    v_cvt_pk_bf16_f32 v32, v14, v15
    v_lshlrev_b32 v14, 16, v32
    v_and_b32 v15, 0xffff0000, v32
    v_cvt_pk_bf16_f32 v32, v16, v17
    v_lshlrev_b32 v16, 16, v32
    v_and_b32 v17, 0xffff0000, v32
    v_cvt_pk_bf16_f32 v32, v18, v19
    v_lshlrev_b32 v18, 16, v32
    v_and_b32 v19, 0xffff0000, v32
    v_cvt_pk_bf16_f32 v32, v20, v21
    v_lshlrev_b32 v20, 16, v32
    v_and_b32 v21, 0xffff0000, v32
    v_cvt_pk_bf16_f32 v32, v22, v23
    v_lshlrev_b32 v22, 16, v32
    v_and_b32 v23, 0xffff0000, v32
    v_cvt_pk_bf16_f32 v32, v24, v25
    v_lshlrev_b32 v24, 16, v32
    v_and_b32 v25, 0xffff0000, v32
    v_cvt_pk_bf16_f32 v32, v26, v27
    v_lshlrev_b32 v26, 16, v32
    v_and_b32 v27, 0xffff0000, v32
    v_cvt_pk_bf16_f32 v32, v28, v29
    v_lshlrev_b32 v28, 16, v32
    v_and_b32 v29, 0xffff0000, v32
    v_mov_b32 v30, 1092616192
    v_mov_b32 v31, 0x3fb8aa3b
    v_pk_mul_f32 v[14:15], v[14:15], v[30:31] op_sel:[0,0] op_sel_hi:[1,0]
    v_pk_mul_f32 v[16:17], v[16:17], v[30:31] op_sel:[0,0] op_sel_hi:[1,0]
    v_pk_mul_f32 v[18:19], v[18:19], v[30:31] op_sel:[0,0] op_sel_hi:[1,0]
    v_pk_mul_f32 v[20:21], v[20:21], v[30:31] op_sel:[0,0] op_sel_hi:[1,0]
    v_pk_mul_f32 v[22:23], v[22:23], v[30:31] op_sel:[0,0] op_sel_hi:[1,0]
    v_pk_mul_f32 v[24:25], v[24:25], v[30:31] op_sel:[0,0] op_sel_hi:[1,0]
    v_pk_mul_f32 v[26:27], v[26:27], v[30:31] op_sel:[0,0] op_sel_hi:[1,0]
    v_pk_mul_f32 v[28:29], v[28:29], v[30:31] op_sel:[0,0] op_sel_hi:[1,0]
    v_cvt_pk_bf16_f32 v32, v14, v15
    v_lshlrev_b32 v14, 16, v32
    v_and_b32 v15, 0xffff0000, v32
    v_cvt_pk_bf16_f32 v32, v16, v17
    v_lshlrev_b32 v16, 16, v32
    v_and_b32 v17, 0xffff0000, v32
    v_cvt_pk_bf16_f32 v32, v18, v19
    v_lshlrev_b32 v18, 16, v32
    v_and_b32 v19, 0xffff0000, v32
    v_cvt_pk_bf16_f32 v32, v20, v21
    v_lshlrev_b32 v20, 16, v32
    v_and_b32 v21, 0xffff0000, v32
    v_cvt_pk_bf16_f32 v32, v22, v23
    v_lshlrev_b32 v22, 16, v32
    v_and_b32 v23, 0xffff0000, v32
    v_cvt_pk_bf16_f32 v32, v24, v25
    v_lshlrev_b32 v24, 16, v32
    v_and_b32 v25, 0xffff0000, v32
    v_cvt_pk_bf16_f32 v32, v26, v27
    v_lshlrev_b32 v26, 16, v32
    v_and_b32 v27, 0xffff0000, v32
    v_cvt_pk_bf16_f32 v32, v28, v29
    v_lshlrev_b32 v28, 16, v32
    v_and_b32 v29, 0xffff0000, v32
    v_pk_mul_f32 v[14:15], v[14:15], v[30:31] op_sel:[0,1] op_sel_hi:[1,1]
    v_pk_mul_f32 v[16:17], v[16:17], v[30:31] op_sel:[0,1] op_sel_hi:[1,1]
    v_pk_mul_f32 v[18:19], v[18:19], v[30:31] op_sel:[0,1] op_sel_hi:[1,1]
    v_pk_mul_f32 v[20:21], v[20:21], v[30:31] op_sel:[0,1] op_sel_hi:[1,1]
    v_pk_mul_f32 v[22:23], v[22:23], v[30:31] op_sel:[0,1] op_sel_hi:[1,1]
    v_pk_mul_f32 v[24:25], v[24:25], v[30:31] op_sel:[0,1] op_sel_hi:[1,1]
    v_pk_mul_f32 v[26:27], v[26:27], v[30:31] op_sel:[0,1] op_sel_hi:[1,1]
    v_pk_mul_f32 v[28:29], v[28:29], v[30:31] op_sel:[0,1] op_sel_hi:[1,1]
    v_exp_f32 v14, -v14
    v_exp_f32 v15, -v15
    v_exp_f32 v16, -v16
    v_exp_f32 v17, -v17
    v_exp_f32 v18, -v18
    v_exp_f32 v19, -v19
    v_exp_f32 v20, -v20
    v_exp_f32 v21, -v21
    v_exp_f32 v22, -v22
    v_exp_f32 v23, -v23
    v_exp_f32 v24, -v24
    v_exp_f32 v25, -v25
    v_exp_f32 v26, -v26
    v_exp_f32 v27, -v27
    v_exp_f32 v28, -v28
    v_exp_f32 v29, -v29
    v_cvt_pk_bf16_f32 v14, v14, v16
    v_cvt_pk_bf16_f32 v15, v15, v17
    v_cvt_pk_bf16_f32 v18, v18, v20
    v_cvt_pk_bf16_f32 v19, v19, v21
    v_cvt_pk_bf16_f32 v22, v22, v24
    v_cvt_pk_bf16_f32 v23, v23, v25
    v_cvt_pk_bf16_f32 v26, v26, v28
    v_cvt_pk_bf16_f32 v27, v27, v29
    v_dot2_f32_bf16 v72, v14, s68, 0
    v_dot2_f32_bf16 v73, v15, s68, 0
    v_dot2_f32_bf16 v74, v14, s69, 0
    v_dot2_f32_bf16 v75, v15, s69, 0
    v_dot2_f32_bf16 v76, v14, s70, 0
    v_dot2_f32_bf16 v77, v15, s70, 0
    v_dot2_f32_bf16 v78, v14, s71, 0
    v_dot2_f32_bf16 v79, v15, s71, 0
    v_dot2_f32_bf16 v80, v14, s52, 0
    v_dot2_f32_bf16 v81, v15, s52, 0
    v_dot2_f32_bf16 v82, v14, s53, 0
    v_dot2_f32_bf16 v83, v15, s53, 0
    v_dot2_f32_bf16 v84, v14, s54, 0
    v_dot2_f32_bf16 v85, v15, s54, 0
    v_dot2_f32_bf16 v86, v14, s55, 0
    v_dot2_f32_bf16 v87, v15, s55, 0
    v_dot2_f32_bf16 v72, v18, s72, v72
    v_dot2_f32_bf16 v73, v19, s72, v73
    v_dot2_f32_bf16 v74, v18, s73, v74
    v_dot2_f32_bf16 v75, v19, s73, v75
    v_dot2_f32_bf16 v76, v18, s74, v76
    v_dot2_f32_bf16 v77, v19, s74, v77
    v_dot2_f32_bf16 v78, v18, s75, v78
    v_dot2_f32_bf16 v79, v19, s75, v79
    v_dot2_f32_bf16 v80, v18, s56, v80
    v_dot2_f32_bf16 v81, v19, s56, v81
    v_dot2_f32_bf16 v82, v18, s57, v82
    v_dot2_f32_bf16 v83, v19, s57, v83
    v_dot2_f32_bf16 v84, v18, s58, v84
    v_dot2_f32_bf16 v85, v19, s58, v85
    v_dot2_f32_bf16 v86, v18, s59, v86
    v_dot2_f32_bf16 v87, v19, s59, v87
    v_dot2_f32_bf16 v72, v22, s76, v72
    v_dot2_f32_bf16 v73, v23, s76, v73
    v_dot2_f32_bf16 v74, v22, s77, v74
    v_dot2_f32_bf16 v75, v23, s77, v75
    v_dot2_f32_bf16 v76, v22, s78, v76
    v_dot2_f32_bf16 v77, v23, s78, v77
    v_dot2_f32_bf16 v78, v22, s79, v78
    v_dot2_f32_bf16 v79, v23, s79, v79
    v_dot2_f32_bf16 v80, v22, s60, v80
    v_dot2_f32_bf16 v81, v23, s60, v81
    v_dot2_f32_bf16 v82, v22, s61, v82
    v_dot2_f32_bf16 v83, v23, s61, v83
    v_dot2_f32_bf16 v84, v22, s62, v84
    v_dot2_f32_bf16 v85, v23, s62, v85
    v_dot2_f32_bf16 v86, v22, s63, v86
    v_dot2_f32_bf16 v87, v23, s63, v87
    v_dot2_f32_bf16 v72, v26, s80, v72
    v_dot2_f32_bf16 v73, v27, s80, v73
    v_dot2_f32_bf16 v74, v26, s81, v74
    v_dot2_f32_bf16 v75, v27, s81, v75
    v_dot2_f32_bf16 v76, v26, s82, v76
    v_dot2_f32_bf16 v77, v27, s82, v77
    v_dot2_f32_bf16 v78, v26, s83, v78
    v_dot2_f32_bf16 v79, v27, s83, v79
    v_dot2_f32_bf16 v80, v26, s64, v80
    v_dot2_f32_bf16 v81, v27, s64, v81
    v_dot2_f32_bf16 v82, v26, s65, v82
    v_dot2_f32_bf16 v83, v27, s65, v83
    v_dot2_f32_bf16 v84, v26, s66, v84
    v_dot2_f32_bf16 v85, v27, s66, v85
    v_dot2_f32_bf16 v86, v26, s67, v86
    v_dot2_f32_bf16 v87, v27, s67, v87
    s_cmp_ge_u32 s13, 4
    s_cbranch_scc1 L_p2_kernel_g1_30
    v_lshlrev_b32 v30, 16, v61
    v_and_b32 v31, 0xffff0000, v61
    v_pk_add_f32 v[14:15], v[30:31], v[36:37] op_sel:[0,0] op_sel_hi:[1,0] neg_lo:[0,1] neg_hi:[0,1]
    v_pk_add_f32 v[16:17], v[30:31], v[36:37] op_sel:[0,1] op_sel_hi:[1,1] neg_lo:[0,1] neg_hi:[0,1]
    v_pk_add_f32 v[18:19], v[30:31], v[38:39] op_sel:[0,0] op_sel_hi:[1,0] neg_lo:[0,1] neg_hi:[0,1]
    v_pk_add_f32 v[20:21], v[30:31], v[38:39] op_sel:[0,1] op_sel_hi:[1,1] neg_lo:[0,1] neg_hi:[0,1]
    v_pk_add_f32 v[22:23], v[30:31], v[40:41] op_sel:[0,0] op_sel_hi:[1,0] neg_lo:[0,1] neg_hi:[0,1]
    v_pk_add_f32 v[24:25], v[30:31], v[40:41] op_sel:[0,1] op_sel_hi:[1,1] neg_lo:[0,1] neg_hi:[0,1]
    v_pk_add_f32 v[26:27], v[30:31], v[42:43] op_sel:[0,0] op_sel_hi:[1,0] neg_lo:[0,1] neg_hi:[0,1]
    v_pk_add_f32 v[28:29], v[30:31], v[42:43] op_sel:[0,1] op_sel_hi:[1,1] neg_lo:[0,1] neg_hi:[0,1]
    v_cvt_pk_bf16_f32 v32, v14, v15
    v_lshlrev_b32 v14, 16, v32
    v_and_b32 v15, 0xffff0000, v32
    v_cvt_pk_bf16_f32 v32, v16, v17
    v_lshlrev_b32 v16, 16, v32
    v_and_b32 v17, 0xffff0000, v32
    v_cvt_pk_bf16_f32 v32, v18, v19
    v_lshlrev_b32 v18, 16, v32
    v_and_b32 v19, 0xffff0000, v32
    v_cvt_pk_bf16_f32 v32, v20, v21
    v_lshlrev_b32 v20, 16, v32
    v_and_b32 v21, 0xffff0000, v32
    v_cvt_pk_bf16_f32 v32, v22, v23
    v_lshlrev_b32 v22, 16, v32
    v_and_b32 v23, 0xffff0000, v32
    v_cvt_pk_bf16_f32 v32, v24, v25
    v_lshlrev_b32 v24, 16, v32
    v_and_b32 v25, 0xffff0000, v32
    v_cvt_pk_bf16_f32 v32, v26, v27
    v_lshlrev_b32 v26, 16, v32
    v_and_b32 v27, 0xffff0000, v32
    v_cvt_pk_bf16_f32 v32, v28, v29
    v_lshlrev_b32 v28, 16, v32
    v_and_b32 v29, 0xffff0000, v32
    v_pk_mul_f32 v[14:15], v[14:15], v[14:15]
    v_pk_mul_f32 v[16:17], v[16:17], v[16:17]
    v_pk_mul_f32 v[18:19], v[18:19], v[18:19]
    v_pk_mul_f32 v[20:21], v[20:21], v[20:21]
    v_pk_mul_f32 v[22:23], v[22:23], v[22:23]
    v_pk_mul_f32 v[24:25], v[24:25], v[24:25]
    v_pk_mul_f32 v[26:27], v[26:27], v[26:27]
    v_pk_mul_f32 v[28:29], v[28:29], v[28:29]
    v_cvt_pk_bf16_f32 v32, v14, v15
    v_lshlrev_b32 v14, 16, v32
    v_and_b32 v15, 0xffff0000, v32
    v_cvt_pk_bf16_f32 v32, v16, v17
    v_lshlrev_b32 v16, 16, v32
    v_and_b32 v17, 0xffff0000, v32
    v_cvt_pk_bf16_f32 v32, v18, v19
    v_lshlrev_b32 v18, 16, v32
    v_and_b32 v19, 0xffff0000, v32
    v_cvt_pk_bf16_f32 v32, v20, v21
    v_lshlrev_b32 v20, 16, v32
    v_and_b32 v21, 0xffff0000, v32
    v_cvt_pk_bf16_f32 v32, v22, v23
    v_lshlrev_b32 v22, 16, v32
    v_and_b32 v23, 0xffff0000, v32
    v_cvt_pk_bf16_f32 v32, v24, v25
    v_lshlrev_b32 v24, 16, v32
    v_and_b32 v25, 0xffff0000, v32
    v_cvt_pk_bf16_f32 v32, v26, v27
    v_lshlrev_b32 v26, 16, v32
    v_and_b32 v27, 0xffff0000, v32
    v_cvt_pk_bf16_f32 v32, v28, v29
    v_lshlrev_b32 v28, 16, v32
    v_and_b32 v29, 0xffff0000, v32
    v_mov_b32 v30, 1092616192
    v_mov_b32 v31, 0x3fb8aa3b
    v_pk_mul_f32 v[14:15], v[14:15], v[30:31] op_sel:[0,0] op_sel_hi:[1,0]
    v_pk_mul_f32 v[16:17], v[16:17], v[30:31] op_sel:[0,0] op_sel_hi:[1,0]
    v_pk_mul_f32 v[18:19], v[18:19], v[30:31] op_sel:[0,0] op_sel_hi:[1,0]
    v_pk_mul_f32 v[20:21], v[20:21], v[30:31] op_sel:[0,0] op_sel_hi:[1,0]
    v_pk_mul_f32 v[22:23], v[22:23], v[30:31] op_sel:[0,0] op_sel_hi:[1,0]
    v_pk_mul_f32 v[24:25], v[24:25], v[30:31] op_sel:[0,0] op_sel_hi:[1,0]
    v_pk_mul_f32 v[26:27], v[26:27], v[30:31] op_sel:[0,0] op_sel_hi:[1,0]
    v_pk_mul_f32 v[28:29], v[28:29], v[30:31] op_sel:[0,0] op_sel_hi:[1,0]
    v_cvt_pk_bf16_f32 v32, v14, v15
    v_lshlrev_b32 v14, 16, v32
    v_and_b32 v15, 0xffff0000, v32
    v_cvt_pk_bf16_f32 v32, v16, v17
    v_lshlrev_b32 v16, 16, v32
    v_and_b32 v17, 0xffff0000, v32
    v_cvt_pk_bf16_f32 v32, v18, v19
    v_lshlrev_b32 v18, 16, v32
    v_and_b32 v19, 0xffff0000, v32
    v_cvt_pk_bf16_f32 v32, v20, v21
    v_lshlrev_b32 v20, 16, v32
    v_and_b32 v21, 0xffff0000, v32
    v_cvt_pk_bf16_f32 v32, v22, v23
    v_lshlrev_b32 v22, 16, v32
    v_and_b32 v23, 0xffff0000, v32
    v_cvt_pk_bf16_f32 v32, v24, v25
    v_lshlrev_b32 v24, 16, v32
    v_and_b32 v25, 0xffff0000, v32
    v_cvt_pk_bf16_f32 v32, v26, v27
    v_lshlrev_b32 v26, 16, v32
    v_and_b32 v27, 0xffff0000, v32
    v_cvt_pk_bf16_f32 v32, v28, v29
    v_lshlrev_b32 v28, 16, v32
    v_and_b32 v29, 0xffff0000, v32
    v_pk_mul_f32 v[14:15], v[14:15], v[30:31] op_sel:[0,1] op_sel_hi:[1,1]
    v_pk_mul_f32 v[16:17], v[16:17], v[30:31] op_sel:[0,1] op_sel_hi:[1,1]
    v_pk_mul_f32 v[18:19], v[18:19], v[30:31] op_sel:[0,1] op_sel_hi:[1,1]
    v_pk_mul_f32 v[20:21], v[20:21], v[30:31] op_sel:[0,1] op_sel_hi:[1,1]
    v_pk_mul_f32 v[22:23], v[22:23], v[30:31] op_sel:[0,1] op_sel_hi:[1,1]
    v_pk_mul_f32 v[24:25], v[24:25], v[30:31] op_sel:[0,1] op_sel_hi:[1,1]
    v_pk_mul_f32 v[26:27], v[26:27], v[30:31] op_sel:[0,1] op_sel_hi:[1,1]
    v_pk_mul_f32 v[28:29], v[28:29], v[30:31] op_sel:[0,1] op_sel_hi:[1,1]
    v_exp_f32 v14, -v14
    v_exp_f32 v15, -v15
    v_exp_f32 v16, -v16
    v_exp_f32 v17, -v17
    v_exp_f32 v18, -v18
    v_exp_f32 v19, -v19
    v_exp_f32 v20, -v20
    v_exp_f32 v21, -v21
    v_exp_f32 v22, -v22
    v_exp_f32 v23, -v23
    v_exp_f32 v24, -v24
    v_exp_f32 v25, -v25
    v_exp_f32 v26, -v26
    v_exp_f32 v27, -v27
    v_exp_f32 v28, -v28
    v_exp_f32 v29, -v29
    v_cvt_pk_bf16_f32 v14, v14, v16
    v_cvt_pk_bf16_f32 v15, v15, v17
    v_cvt_pk_bf16_f32 v18, v18, v20
    v_cvt_pk_bf16_f32 v19, v19, v21
    v_cvt_pk_bf16_f32 v22, v22, v24
    v_cvt_pk_bf16_f32 v23, v23, v25
    v_cvt_pk_bf16_f32 v26, v26, v28
    v_cvt_pk_bf16_f32 v27, v27, v29
    v_dot2_f32_bf16 v112, v14, s68, 0
    v_dot2_f32_bf16 v113, v15, s68, 0
    v_dot2_f32_bf16 v114, v14, s69, 0
    v_dot2_f32_bf16 v115, v15, s69, 0
    v_dot2_f32_bf16 v116, v14, s70, 0
    v_dot2_f32_bf16 v117, v15, s70, 0
    v_dot2_f32_bf16 v118, v14, s71, 0
    v_dot2_f32_bf16 v119, v15, s71, 0
    v_dot2_f32_bf16 v120, v14, s52, 0
    v_dot2_f32_bf16 v121, v15, s52, 0
    v_dot2_f32_bf16 v122, v14, s53, 0
    v_dot2_f32_bf16 v123, v15, s53, 0
    v_dot2_f32_bf16 v124, v14, s54, 0
    v_dot2_f32_bf16 v125, v15, s54, 0
    v_dot2_f32_bf16 v126, v14, s55, 0
    v_dot2_f32_bf16 v127, v15, s55, 0
    v_dot2_f32_bf16 v112, v18, s72, v112
    v_dot2_f32_bf16 v113, v19, s72, v113
    v_dot2_f32_bf16 v114, v18, s73, v114
    v_dot2_f32_bf16 v115, v19, s73, v115
    v_dot2_f32_bf16 v116, v18, s74, v116
    v_dot2_f32_bf16 v117, v19, s74, v117
    v_dot2_f32_bf16 v118, v18, s75, v118
    v_dot2_f32_bf16 v119, v19, s75, v119
    v_dot2_f32_bf16 v120, v18, s56, v120
    v_dot2_f32_bf16 v121, v19, s56, v121
    v_dot2_f32_bf16 v122, v18, s57, v122
    v_dot2_f32_bf16 v123, v19, s57, v123
    v_dot2_f32_bf16 v124, v18, s58, v124
    v_dot2_f32_bf16 v125, v19, s58, v125
    v_dot2_f32_bf16 v126, v18, s59, v126
    v_dot2_f32_bf16 v127, v19, s59, v127
    v_dot2_f32_bf16 v112, v22, s76, v112
    v_dot2_f32_bf16 v113, v23, s76, v113
    v_dot2_f32_bf16 v114, v22, s77, v114
    v_dot2_f32_bf16 v115, v23, s77, v115
    v_dot2_f32_bf16 v116, v22, s78, v116
    v_dot2_f32_bf16 v117, v23, s78, v117
    v_dot2_f32_bf16 v118, v22, s79, v118
    v_dot2_f32_bf16 v119, v23, s79, v119
    v_dot2_f32_bf16 v120, v22, s60, v120
    v_dot2_f32_bf16 v121, v23, s60, v121
    v_dot2_f32_bf16 v122, v22, s61, v122
    v_dot2_f32_bf16 v123, v23, s61, v123
    v_dot2_f32_bf16 v124, v22, s62, v124
    v_dot2_f32_bf16 v125, v23, s62, v125
    v_dot2_f32_bf16 v126, v22, s63, v126
    v_dot2_f32_bf16 v127, v23, s63, v127
    v_dot2_f32_bf16 v112, v26, s80, v112
    v_dot2_f32_bf16 v113, v27, s80, v113
    v_dot2_f32_bf16 v114, v26, s81, v114
    v_dot2_f32_bf16 v115, v27, s81, v115
    v_dot2_f32_bf16 v116, v26, s82, v116
    v_dot2_f32_bf16 v117, v27, s82, v117
    v_dot2_f32_bf16 v118, v26, s83, v118
    v_dot2_f32_bf16 v119, v27, s83, v119
    v_dot2_f32_bf16 v120, v26, s64, v120
    v_dot2_f32_bf16 v121, v27, s64, v121
    v_dot2_f32_bf16 v122, v26, s65, v122
    v_dot2_f32_bf16 v123, v27, s65, v123
    v_dot2_f32_bf16 v124, v26, s66, v124
    v_dot2_f32_bf16 v125, v27, s66, v125
    v_dot2_f32_bf16 v126, v26, s67, v126
    v_dot2_f32_bf16 v127, v27, s67, v127
L_p2_kernel_g1_30:
    s_lshl2_add_u32 s14, s3, s49
    s_mul_i32 s26, s14, 20000
    s_mov_b32 s10, 5120000
    buffer_load_dwordx4 v[64:67], v1, s[8:11], s26 offen
    buffer_load_dwordx4 v[68:71], v2, s[8:11], s26 offen
    s_branch L_p2_fin
L_p2_done:
    s_branch L_p2_end
L_p2_slow:
    s_barrier
    v_mov_b32 v8, 0
    v_mov_b32 v9, 0
    v_mov_b32 v10, 0
    v_mov_b32 v11, 0
    v_mov_b32 v12, v1
    ds_write_b128 v12, v[8:11]
    v_add_u32 v12, 16384, v12
    ds_write_b128 v12, v[8:11]
    v_add_u32 v12, 16384, v12
    ds_write_b128 v12, v[8:11]
    v_add_u32 v12, 16384, v12
    ds_write_b128 v12, v[8:11]
    v_add_u32 v12, 16384, v12
    ds_write_b128 v12, v[8:11]
    v_add_u32 v12, 16384, v12
    ds_write_b128 v12, v[8:11]
    v_add_u32 v12, 16384, v12
    ds_write_b128 v12, v[8:11]
    v_add_u32 v12, 16384, v12
    ds_write_b128 v12, v[8:11]
    v_add_u32 v12, 16384, v12
    ds_write_b128 v12, v[8:11]
    v_add_u32 v12, 16384, v12
    ds_write_b128 v12, v[8:11]
    v_add_u32 v12, 16384, v12
    v_mul_u32_u24 v13, 8320, v0
    v_mov_b32 v29, 0x7fc00000
    v_add_u32 v28, 32, v13
    v_lshlrev_b32 v14, 10, v0
    v_add_u32 v14, 9437184, v14
    s_mul_i32 s25, s12, 65
    s_add_u32 s25, s25, s3
    s_lshl_b32 s25, s25, 5
    s_add_u32 s25, s25, 0
    s_lshl_b32 s50, s50, 1
    s_mul_i32 s22, s12, 1280000
    s_mov_b32 s24, 0
    s_waitcnt lgkmcnt(0)
    s_barrier
L_p2_sstep:
    buffer_load_ushort v15, v13, s[4:7], s25 offen
    buffer_load_ushort v16, v28, s[4:7], s25 offen
    s_waitcnt vmcnt(0)
L_p2_srec:
    v_cmp_lt_u32 vcc, v15, v16
    s_nop 1
    s_and_b64 exec, exec, vcc
    s_cbranch_execz L_p2_sdone
    v_mul_u32_u24 v17, 43691, v15
    v_lshrrev_b32 v17, 17, v17
    v_mad_i32_i24 v18, v17, -3, v15
    v_lshrrev_b32 v19, 6, v17
    v_lshl_add_u32 v19, v19, 20, v14
    v_and_b32 v17, 63, v17
    v_lshl_add_u32 v17, v17, 4, v19
    v_lshl_add_u32 v19, v18, 2, v17
    buffer_load_dword v20, v19, s[4:7], 0 offen
    buffer_load_dword v21, v17, s[4:7], 0 offen offset:12
    v_add_u32 v15, 1, v15
    v_mad_u32_u24 v18, v18, 10, 2
    s_waitcnt vmcnt(0)
    v_and_b32 v19, 0x3fff, v20
    v_lshlrev_b32 v19, 3, v19
    buffer_load_dwordx2 v[22:23], v19, s[8:11], s22 offen
    v_mad_u32_u16 v20, v20, 16, s50 op_sel:[1,0,0,0]
    v_bfe_i32 v21, v21, v18, 10
    v_cmp_eq_i32 vcc, -512, v21
    v_cvt_f32_i32 v21, v21
    v_mul_f32 v21, 989872160, v21
    v_cndmask_b32 v21, v21, v29, vcc
    s_waitcnt vmcnt(0)
    v_lshlrev_b32 v24, 16, v22
    v_and_b32 v25, 0xffff0000, v22
    v_lshlrev_b32 v26, 16, v23
    v_and_b32 v27, 0xffff0000, v23
    v_mul_f32 v24, v21, v24
    v_mul_f32 v25, v21, v25
    v_mul_f32 v26, v21, v26
    v_mul_f32 v27, v21, v27
    ds_add_f32 v20, v24
    ds_add_f32 v20, v25 offset:4
    ds_add_f32 v20, v26 offset:8
    ds_add_f32 v20, v27 offset:12
    s_branch L_p2_srec
L_p2_sdone:
    s_mov_b64 exec, -1
    s_add_u32 s25, s25, 2
    s_add_u32 s22, s22, 80000
    s_add_u32 s24, s24, 1
    s_cmp_lt_u32 s24, 16
    s_cbranch_scc1 L_p2_sstep
    s_waitcnt lgkmcnt(0)
    s_barrier
    s_mul_i32 s14, s12, 10240000
    s_mul_i32 s15, s3, 160000
    s_add_u32 s26, s14, s15
    s_add_u32 s26, s26, 249069568
    v_mov_b32 v12, v1
    s_mov_b32 s24, 0
L_p2_sout:
    v_cmp_gt_u32 vcc, 160000, v12
    ds_read_b128 v[8:11], v12
    s_nop 0
    s_and_b64 exec, exec, vcc
    s_cbranch_execz L_p2_sfin
    s_waitcnt lgkmcnt(0)
    buffer_store_dwordx4 v[8:11], v12, s[4:7], s26 offen sc1
    s_waitcnt vmcnt(0)
    v_add_u32 v12, 16384, v12
    s_branch L_p2_sout
L_p2_sfin:
    s_mov_b64 exec, -1
    s_waitcnt vmcnt(0) lgkmcnt(0)
    s_barrier
    s_branch L_p2_signal
L_p2_end:
    s_endpgm
.section .rodata,"a"
.p2align 6
.amdhsa_kernel p1_kernel
  .amdhsa_next_free_vgpr 128
  .amdhsa_next_free_sgpr 96
  .amdhsa_accum_offset 128
  .amdhsa_group_segment_fixed_size 0
  .amdhsa_kernarg_size 112
  .amdhsa_user_sgpr_count 2
  .amdhsa_user_sgpr_kernarg_segment_ptr 1
  .amdhsa_system_sgpr_workgroup_id_x 1
  .amdhsa_float_denorm_mode_32 0
.end_amdhsa_kernel
.p2align 6
.amdhsa_kernel p2_kernel
  .amdhsa_next_free_vgpr 128
  .amdhsa_next_free_sgpr 102
  .amdhsa_accum_offset 128
  .amdhsa_group_segment_fixed_size 0
  .amdhsa_kernarg_size 112
  .amdhsa_user_sgpr_count 2
  .amdhsa_user_sgpr_kernarg_segment_ptr 1
  .amdhsa_system_sgpr_workgroup_id_x 1
  .amdhsa_float_denorm_mode_32 0
.end_amdhsa_kernel
```

```asm
; @launch kernel=p1_kernel grid=(256,1,1) block=(1024,1,1) lds=163840
; @launch kernel=p2_kernel grid=(256,1,1) block=(1024,1,1) lds=163840
.amdgcn_target "amdgcn-amd-amdhsa--gfx950"
.text
.globl p1_kernel
.p2align 8
.type p1_kernel,@function
p1_kernel:
    s_cmp_ge_u32 s2, 256
    s_cbranch_scc1 L_p1_end
    s_load_dwordx2 s[4:5], s[0:1], 104
    s_load_dwordx2 s[8:9], s[0:1], 8
    s_load_dwordx2 s[12:13], s[0:1], 16
    s_load_dwordx2 s[16:17], s[0:1], 32
    s_load_dwordx2 s[28:29], s[0:1], 0
    s_load_dwordx2 s[6:7], s[0:1], 48
    v_cmp_gt_u32 vcc, 256, v0
    s_nop 1
    s_cbranch_vccz L_p1_nopf
    s_getpc_b64 s[72:73]
L_p1_kernel_pc_1:
    s_add_u32 s72, s72, L_p1_nopf-L_p1_kernel_pc_1
    s_addc_u32 s73, s73, 0
    v_lshlrev_b32 v14, 7, v0
    v_min_u32 v14, L_p2_end-L_p1_nopf, v14
    global_load_dword v15, v14, s[72:73]
L_p1_nopf:
    v_lshlrev_b32 v1, 4, v0
    v_lshlrev_b32 v2, 3, v0
    v_lshrrev_b32 v6, 6, v0
    v_mul_u32_u24 v3, 851904, v6
    v_add_lshl_u32 v3, v3, v0, 4
    v_mov_b32 v4, 1
    v_mov_b32 v5, 0
    v_readfirstlane_b32 s39, v6
    v_cmp_gt_u32 vcc, 784, v0
    s_and_b32 s51, s2, 7
    s_lshl_b32 s51, s51, 0
    s_bfe_u32 s35, s2, 3
    s_add_u32 s51, s51, s35
    s_and_b32 s35, s2, 248
    s_add_u32 s51, s51, s35
    s_and_b32 s32, s2, 7
    s_lshl_b32 s32, s32, 2
    s_bfe_u32 s35, s2, 131075
    s_add_u32 s32, s32, s35
    s_and_b32 s35, s2, 224
    s_add_u32 s32, s32, s35
    s_lshr_b32 s35, s39, 4
    s_mul_i32 s36, s35, 4177920
    s_lshl_b32 s33, s51, 14
    s_add_u32 s33, s33, s36
    s_lshr_b32 s34, s33, 1
    s_mul_i32 s48, s51, 3840
    s_cmp_ge_u32 s35, 0
    s_cselect_b32 s48, s48, 0
    s_lshr_b32 s49, s48, 1
    s_mov_b64 s[44:45], vcc
    s_waitcnt lgkmcnt(0)
    s_load_dword s3, s[6:7], 0
    s_mov_b32 s10, 163840000
    s_mov_b32 s11, 0x00020000
    s_mov_b32 s14, 163840000
    s_mov_b32 s15, 0x00020000
    s_mov_b32 s18, 81920000
    s_mov_b32 s19, 0x00020000
    s_mul_i32 s36, s2, 20000
    s_add_u32 s30, s36, 20000
    s_mov_b32 s31, 0x00020000
    s_add_u32 s35, s36, 16384
    buffer_load_dwordx4 v[48:51], v1, s[28:31], s36 offen
    buffer_load_dwordx4 v[52:55], v1, s[28:31], s35 offen
    s_add_u32 s35, s33, 0
    buffer_load_dwordx4 v[16:19], v1, s[8:11], s35 offen nt
    s_add_u32 s35, s33, 0
    buffer_load_dwordx4 v[20:23], v1, s[12:15], s35 offen nt
    s_add_u32 s35, s33, 4194304
    buffer_load_dwordx4 v[24:27], v1, s[8:11], s35 offen nt
    s_add_u32 s35, s33, 4194304
    buffer_load_dwordx4 v[28:31], v1, s[12:15], s35 offen nt
    s_add_u32 s35, s33, 8388608
    buffer_load_dwordx4 v[32:35], v1, s[8:11], s35 offen nt
    s_add_u32 s35, s33, 8388608
    buffer_load_dwordx4 v[36:39], v1, s[12:15], s35 offen nt
    s_add_u32 s35, s33, 12582912
    buffer_load_dwordx4 v[40:43], v1, s[8:11], s35 offen nt
    s_add_u32 s35, s33, 12582912
    buffer_load_dwordx4 v[44:47], v1, s[12:15], s35 offen nt
    s_add_u32 s35, s33, 16777216
    buffer_load_dwordx4 v[72:75], v1, s[8:11], s35 offen nt
    s_add_u32 s35, s33, 16777216
    buffer_load_dwordx4 v[76:79], v1, s[12:15], s35 offen nt
    s_mov_b32 s20, s4
    s_mov_b32 s21, s5
    s_mov_b32 s22, 0
    s_mov_b32 s23, 0x00020000
    s_add_u32 s24, s4, 0
    s_addc_u32 s25, s5, 0
    s_mov_b32 s26, 8540160
    s_mov_b32 s27, 0x00020000
    s_mov_b32 s37, 1492179184
    s_mov_b32 s55, 0
    s_mov_b32 s50, 21845
    s_mov_b32 s52, 0x8000
    s_mov_b32 s38, 262400
    s_mov_b32 s43, 0x05040100
    s_mov_b32 s40, 0
    v_mov_b32 v8, 0
    v_mov_b32 v9, 0
    v_mov_b32 v10, 0
    v_mov_b32 v11, 0
    ds_write_b128 v1, v[8:11] offset:0
    v_min_u32 v7, 16, v0
    v_lshlrev_b32 v7, 2, v7
    v_add_u32 v7, 160768, v7
    ds_write_b32 v7, v8
    s_waitcnt lgkmcnt(0)
    s_lshl_b32 s3, s3, 16
    v_mov_b32 v12, s3
    v_mul_f32 v12, 0.15915494, v12
    s_nop 0
    v_readfirstlane_b32 s41, v12
    s_waitcnt vmcnt(10)
    v_mov_b32 v12, 0x3f803f80
    v_and_b32 v48, 0x7fff7fff, v48
    v_and_b32 v49, 0x7fff7fff, v49
    v_and_b32 v50, 0x7fff7fff, v50
    v_and_b32 v51, 0x7fff7fff, v51
    v_and_b32 v52, 0x7fff7fff, v52
    v_and_b32 v53, 0x7fff7fff, v53
    v_and_b32 v54, 0x7fff7fff, v54
    v_and_b32 v55, 0x7fff7fff, v55
    v_pk_max_u16 v8, v8, v48
    v_dot2c_f32_bf16 v9, v48, v12
    v_pk_max_u16 v8, v8, v49
    v_dot2c_f32_bf16 v9, v49, v12
    v_pk_max_u16 v8, v8, v50
    v_dot2c_f32_bf16 v9, v50, v12
    v_pk_max_u16 v8, v8, v51
    v_dot2c_f32_bf16 v9, v51, v12
    v_pk_max_u16 v8, v8, v52
    v_dot2c_f32_bf16 v9, v52, v12
    v_pk_max_u16 v8, v8, v53
    v_dot2c_f32_bf16 v9, v53, v12
    v_pk_max_u16 v8, v8, v54
    v_dot2c_f32_bf16 v9, v54, v12
    v_pk_max_u16 v8, v8, v55
    v_dot2c_f32_bf16 v9, v55, v12
    v_lshrrev_b32 v10, 16, v8
    v_and_b32 v8, 0xffff, v8
    v_max_u32 v8, v8, v10
    s_nop 0
    s_nop 1
    v_max_u32_dpp v8, v8, v8 row_shr:1 row_mask:0xf bank_mask:0xf bound_ctrl:0
    s_nop 1
    v_max_u32_dpp v8, v8, v8 row_shr:2 row_mask:0xf bank_mask:0xf bound_ctrl:0
    s_nop 1
    v_max_u32_dpp v8, v8, v8 row_shr:4 row_mask:0xf bank_mask:0xf bound_ctrl:0
    s_nop 1
    v_max_u32_dpp v8, v8, v8 row_shr:8 row_mask:0xf bank_mask:0xf bound_ctrl:0
    s_nop 1
    v_max_u32_dpp v8, v8, v8 row_bcast:15 row_mask:0xa bank_mask:0xf
    s_nop 1
    v_max_u32_dpp v8, v8, v8 row_bcast:31 row_mask:0xc bank_mask:0xf
    s_nop 1
    v_add_f32_dpp v9, v9, v9 row_shr:1 row_mask:0xf bank_mask:0xf bound_ctrl:0
    s_nop 1
    v_add_f32_dpp v9, v9, v9 row_shr:2 row_mask:0xf bank_mask:0xf bound_ctrl:0
    s_nop 1
    v_add_f32_dpp v9, v9, v9 row_shr:4 row_mask:0xf bank_mask:0xf bound_ctrl:0
    s_nop 1
    v_add_f32_dpp v9, v9, v9 row_shr:8 row_mask:0xf bank_mask:0xf bound_ctrl:0
    s_nop 1
    v_add_f32_dpp v9, v9, v9 row_bcast:15 row_mask:0xa bank_mask:0xf
    s_nop 1
    v_add_f32_dpp v9, v9, v9 row_bcast:31 row_mask:0xc bank_mask:0xf
    s_lshl_b32 s35, s39, 4
    s_add_u32 s35, s35, 160320
    v_mov_b32 v10, s35
    s_mov_b32 exec_lo, 0
    s_brev_b32 exec_hi, 1
    ds_write_b64 v10, v[8:9]
    s_mov_b64 exec, -1
    s_waitcnt lgkmcnt(0)
    s_barrier
    s_branch L_p1_first
L_p1_loop:
    s_getreg_b32 s51, hwreg(HW_REG_XCC_ID, 0, 1)
    s_cmp_eq_u32 s51, 0
    s_cselect_b64 vcc, -1, 0
    s_cmp_lg_u32 s39, 15
    s_cbranch_scc1 L_p1_kernel_nox_2
    s_waitcnt lgkmcnt(13)
    v_lshlrev_b32 v15, 16, v120
    v_and_b32 v120, 0xffff0000, v120
    v_lshlrev_b32 v121, 16, v121
    v_mul_f32 v15, s41, v15
    v_mul_f32 v120, s41, v120
    v_mul_f32 v121, s41, v121
    v_fract_f32 v15, v15
    v_fract_f32 v120, v120
    v_fract_f32 v121, v121
    v_cos_f32 v15, v15
    v_cos_f32 v120, v120
    v_cos_f32 v121, v121
    v_fmaak_f32 v15, v10, v15, 1262486016
    v_fmaak_f32 v120, v10, v120, 1262486016
    v_fmaak_f32 v121, v10, v121, 1262486016
    v_lshlrev_b32 v15, 22, v15
    v_alignbit_b32 v15, v120, v15, 10
    v_alignbit_b32 v15, v121, v15, 10
    v_xor_b32 v15, 0x80200800, v15
    s_mov_b32 s36, 13631488
    buffer_store_dwordx4 v[12:15], v3, s[20:23], s36 offen sc1
L_p1_kernel_nox_2:
    s_waitcnt lgkmcnt(12)
    v_lshlrev_b32 v75, 16, v122
    v_and_b32 v122, 0xffff0000, v122
    v_lshlrev_b32 v123, 16, v123
    v_mul_f32 v75, s41, v75
    v_mul_f32 v122, s41, v122
    v_mul_f32 v123, s41, v123
    v_fract_f32 v75, v75
    v_fract_f32 v122, v122
    v_fract_f32 v123, v123
    v_cos_f32 v75, v75
    v_cos_f32 v122, v122
    v_cos_f32 v123, v123
    v_fmaak_f32 v75, v10, v75, 1262486016
    v_fmaak_f32 v122, v10, v122, 1262486016
    v_fmaak_f32 v123, v10, v123, 1262486016
    v_lshlrev_b32 v75, 22, v75
    v_alignbit_b32 v75, v122, v75, 10
    v_alignbit_b32 v75, v123, v75, 10
    v_xor_b32 v75, 0x80200800, v75
    s_mov_b32 s36, 0
    buffer_store_dwordx4 v[72:75], v3, s[20:23], s36 offen sc1
    s_waitcnt lgkmcnt(11)
    v_lshlrev_b32 v79, 16, v124
    v_and_b32 v124, 0xffff0000, v124
    v_lshlrev_b32 v125, 16, v125
    v_mul_f32 v79, s41, v79
    v_mul_f32 v124, s41, v124
    v_mul_f32 v125, s41, v125
    v_fract_f32 v79, v79
    v_fract_f32 v124, v124
    v_fract_f32 v125, v125
    v_cos_f32 v79, v79
    v_cos_f32 v124, v124
    v_cos_f32 v125, v125
    v_fmaak_f32 v79, v10, v79, 1262486016
    v_fmaak_f32 v124, v10, v124, 1262486016
    v_fmaak_f32 v125, v10, v125, 1262486016
    v_lshlrev_b32 v79, 22, v79
    v_alignbit_b32 v79, v124, v79, 10
    v_alignbit_b32 v79, v125, v79, 10
    v_xor_b32 v79, 0x80200800, v79
    s_mov_b32 s36, 1048576
    buffer_store_dwordx4 v[76:79], v3, s[20:23], s36 offen sc1
    s_waitcnt lgkmcnt(0)
    v_lshlrev_b32 v51, 16, v126
    v_and_b32 v126, 0xffff0000, v126
    v_lshlrev_b32 v127, 16, v127
    v_mul_f32 v51, s41, v51
    v_mul_f32 v126, s41, v126
    v_mul_f32 v127, s41, v127
    v_fract_f32 v51, v51
    v_fract_f32 v126, v126
    v_fract_f32 v127, v127
    v_cos_f32 v51, v51
    v_cos_f32 v126, v126
    v_cos_f32 v127, v127
    v_fmaak_f32 v51, v10, v51, 1262486016
    v_fmaak_f32 v126, v10, v126, 1262486016
    v_fmaak_f32 v127, v10, v127, 1262486016
    v_lshlrev_b32 v51, 22, v51
    v_alignbit_b32 v51, v126, v51, 10
    v_alignbit_b32 v51, v127, v51, 10
    v_xor_b32 v51, 0x80200800, v51
    s_mov_b32 s36, 2097152
    buffer_store_dwordx4 v[48:51], v3, s[20:23], s36 offen sc1
    s_add_u32 s35, s33, 16777216
    buffer_load_dwordx4 v[72:75], v1, s[8:11], s35 offen nt
    s_add_u32 s35, s33, 16777216
    buffer_load_dwordx4 v[76:79], v1, s[12:15], s35 offen nt
    s_cbranch_vccz L_p1_kernel_thr_3
    s_waitcnt vmcnt(2)
L_p1_kernel_thr_3:
    v_lshlrev_b32 v83, 16, v100
    v_and_b32 v100, 0xffff0000, v100
    v_lshlrev_b32 v101, 16, v101
    v_mul_f32 v83, s41, v83
    v_mul_f32 v100, s41, v100
    v_mul_f32 v101, s41, v101
    v_fract_f32 v83, v83
    v_fract_f32 v100, v100
    v_fract_f32 v101, v101
    v_cos_f32 v83, v83
    v_cos_f32 v100, v100
    v_cos_f32 v101, v101
    v_fmaak_f32 v83, v10, v83, 1262486016
    v_fmaak_f32 v100, v10, v100, 1262486016
    v_fmaak_f32 v101, v10, v101, 1262486016
    v_lshlrev_b32 v83, 22, v83
    v_alignbit_b32 v83, v100, v83, 10
    v_alignbit_b32 v83, v101, v83, 10
    v_xor_b32 v83, 0x80200800, v83
    s_mov_b32 s36, 3145728
    buffer_store_dwordx4 v[80:83], v3, s[20:23], s36 offen sc1
    v_lshlrev_b32 v55, 16, v102
    v_and_b32 v102, 0xffff0000, v102
    v_lshlrev_b32 v103, 16, v103
    v_mul_f32 v55, s41, v55
    v_mul_f32 v102, s41, v102
    v_mul_f32 v103, s41, v103
    v_fract_f32 v55, v55
    v_fract_f32 v102, v102
    v_fract_f32 v103, v103
    v_cos_f32 v55, v55
    v_cos_f32 v102, v102
    v_cos_f32 v103, v103
    v_fmaak_f32 v55, v10, v55, 1262486016
    v_fmaak_f32 v102, v10, v102, 1262486016
    v_fmaak_f32 v103, v10, v103, 1262486016
    v_lshlrev_b32 v55, 22, v55
    v_alignbit_b32 v55, v102, v55, 10
    v_alignbit_b32 v55, v103, v55, 10
    v_xor_b32 v55, 0x80200800, v55
    s_mov_b32 s36, 4194304
    buffer_store_dwordx4 v[52:55], v3, s[20:23], s36 offen sc1
    s_add_u32 s35, s33, 20971520
    buffer_load_dwordx4 v[80:83], v1, s[8:11], s35 offen nt
    s_add_u32 s35, s33, 20971520
    buffer_load_dwordx4 v[100:103], v1, s[12:15], s35 offen nt
    s_cbranch_vccz L_p1_kernel_thr_4
    s_waitcnt vmcnt(2)
L_p1_kernel_thr_4:
    v_lshlrev_b32 v87, 16, v104
    v_and_b32 v104, 0xffff0000, v104
    v_lshlrev_b32 v105, 16, v105
    v_mul_f32 v87, s41, v87
    v_mul_f32 v104, s41, v104
    v_mul_f32 v105, s41, v105
    v_fract_f32 v87, v87
    v_fract_f32 v104, v104
    v_fract_f32 v105, v105
    v_cos_f32 v87, v87
    v_cos_f32 v104, v104
    v_cos_f32 v105, v105
    v_fmaak_f32 v87, v10, v87, 1262486016
    v_fmaak_f32 v104, v10, v104, 1262486016
    v_fmaak_f32 v105, v10, v105, 1262486016
    v_lshlrev_b32 v87, 22, v87
    v_alignbit_b32 v87, v104, v87, 10
    v_alignbit_b32 v87, v105, v87, 10
    v_xor_b32 v87, 0x80200800, v87
    s_mov_b32 s36, 5242880
    buffer_store_dwordx4 v[84:87], v3, s[20:23], s36 offen sc1
    v_lshlrev_b32 v59, 16, v106
    v_and_b32 v106, 0xffff0000, v106
    v_lshlrev_b32 v107, 16, v107
    v_mul_f32 v59, s41, v59
    v_mul_f32 v106, s41, v106
    v_mul_f32 v107, s41, v107
    v_fract_f32 v59, v59
    v_fract_f32 v106, v106
    v_fract_f32 v107, v107
    v_cos_f32 v59, v59
    v_cos_f32 v106, v106
    v_cos_f32 v107, v107
    v_fmaak_f32 v59, v10, v59, 1262486016
    v_fmaak_f32 v106, v10, v106, 1262486016
    v_fmaak_f32 v107, v10, v107, 1262486016
    v_lshlrev_b32 v59, 22, v59
    v_alignbit_b32 v59, v106, v59, 10
    v_alignbit_b32 v59, v107, v59, 10
    v_xor_b32 v59, 0x80200800, v59
    s_mov_b32 s36, 6291456
    buffer_store_dwordx4 v[56:59], v3, s[20:23], s36 offen sc1
    s_add_u32 s35, s33, 25165824
    buffer_load_dwordx4 v[84:87], v1, s[8:11], s35 offen nt
    s_add_u32 s35, s33, 25165824
    buffer_load_dwordx4 v[104:107], v1, s[12:15], s35 offen nt
    s_cbranch_vccz L_p1_kernel_thr_5
    s_waitcnt vmcnt(2)
L_p1_kernel_thr_5:
    v_lshlrev_b32 v91, 16, v108
    v_and_b32 v108, 0xffff0000, v108
    v_lshlrev_b32 v109, 16, v109
    v_mul_f32 v91, s41, v91
    v_mul_f32 v108, s41, v108
    v_mul_f32 v109, s41, v109
    v_fract_f32 v91, v91
    v_fract_f32 v108, v108
    v_fract_f32 v109, v109
    v_cos_f32 v91, v91
    v_cos_f32 v108, v108
    v_cos_f32 v109, v109
    v_fmaak_f32 v91, v10, v91, 1262486016
    v_fmaak_f32 v108, v10, v108, 1262486016
    v_fmaak_f32 v109, v10, v109, 1262486016
    v_lshlrev_b32 v91, 22, v91
    v_alignbit_b32 v91, v108, v91, 10
    v_alignbit_b32 v91, v109, v91, 10
    v_xor_b32 v91, 0x80200800, v91
    s_mov_b32 s36, 7340032
    buffer_store_dwordx4 v[88:91], v3, s[20:23], s36 offen sc1
    v_lshlrev_b32 v63, 16, v110
    v_and_b32 v110, 0xffff0000, v110
    v_lshlrev_b32 v111, 16, v111
    v_mul_f32 v63, s41, v63
    v_mul_f32 v110, s41, v110
    v_mul_f32 v111, s41, v111
    v_fract_f32 v63, v63
    v_fract_f32 v110, v110
    v_fract_f32 v111, v111
    v_cos_f32 v63, v63
    v_cos_f32 v110, v110
    v_cos_f32 v111, v111
    v_fmaak_f32 v63, v10, v63, 1262486016
    v_fmaak_f32 v110, v10, v110, 1262486016
    v_fmaak_f32 v111, v10, v111, 1262486016
    v_lshlrev_b32 v63, 22, v63
    v_alignbit_b32 v63, v110, v63, 10
    v_alignbit_b32 v63, v111, v63, 10
    v_xor_b32 v63, 0x80200800, v63
    s_mov_b32 s36, 8388608
    buffer_store_dwordx4 v[60:63], v3, s[20:23], s36 offen sc1
    s_add_u32 s35, s33, 29360128
    buffer_load_dwordx4 v[88:91], v1, s[8:11], s35 offen nt
    s_add_u32 s35, s33, 29360128
    buffer_load_dwordx4 v[108:111], v1, s[12:15], s35 offen nt
    s_cbranch_vccz L_p1_kernel_thr_6
    s_waitcnt vmcnt(2)
L_p1_kernel_thr_6:
    v_lshlrev_b32 v95, 16, v112
    v_and_b32 v112, 0xffff0000, v112
    v_lshlrev_b32 v113, 16, v113
    v_mul_f32 v95, s41, v95
    v_mul_f32 v112, s41, v112
    v_mul_f32 v113, s41, v113
    v_fract_f32 v95, v95
    v_fract_f32 v112, v112
    v_fract_f32 v113, v113
    v_cos_f32 v95, v95
    v_cos_f32 v112, v112
    v_cos_f32 v113, v113
    v_fmaak_f32 v95, v10, v95, 1262486016
    v_fmaak_f32 v112, v10, v112, 1262486016
    v_fmaak_f32 v113, v10, v113, 1262486016
    v_lshlrev_b32 v95, 22, v95
    v_alignbit_b32 v95, v112, v95, 10
    v_alignbit_b32 v95, v113, v95, 10
    v_xor_b32 v95, 0x80200800, v95
    s_mov_b32 s36, 9437184
    buffer_store_dwordx4 v[92:95], v3, s[20:23], s36 offen sc1
    v_lshlrev_b32 v67, 16, v114
    v_and_b32 v114, 0xffff0000, v114
    v_lshlrev_b32 v115, 16, v115
    v_mul_f32 v67, s41, v67
    v_mul_f32 v114, s41, v114
    v_mul_f32 v115, s41, v115
    v_fract_f32 v67, v67
    v_fract_f32 v114, v114
    v_fract_f32 v115, v115
    v_cos_f32 v67, v67
    v_cos_f32 v114, v114
    v_cos_f32 v115, v115
    v_fmaak_f32 v67, v10, v67, 1262486016
    v_fmaak_f32 v114, v10, v114, 1262486016
    v_fmaak_f32 v115, v10, v115, 1262486016
    v_lshlrev_b32 v67, 22, v67
    v_alignbit_b32 v67, v114, v67, 10
    v_alignbit_b32 v67, v115, v67, 10
    v_xor_b32 v67, 0x80200800, v67
    s_mov_b32 s36, 10485760
    buffer_store_dwordx4 v[64:67], v3, s[20:23], s36 offen sc1
    s_add_u32 s35, s33, 33554432
    buffer_load_dwordx4 v[92:95], v1, s[8:11], s35 offen nt
    s_add_u32 s35, s33, 33554432
    buffer_load_dwordx4 v[112:115], v1, s[12:15], s35 offen nt
    s_cbranch_vccz L_p1_kernel_thr_7
    s_waitcnt vmcnt(2)
L_p1_kernel_thr_7:
    v_lshlrev_b32 v99, 16, v116
    v_and_b32 v116, 0xffff0000, v116
    v_lshlrev_b32 v117, 16, v117
    v_mul_f32 v99, s41, v99
    v_mul_f32 v116, s41, v116
    v_mul_f32 v117, s41, v117
    v_fract_f32 v99, v99
    v_fract_f32 v116, v116
    v_fract_f32 v117, v117
    v_cos_f32 v99, v99
    v_cos_f32 v116, v116
    v_cos_f32 v117, v117
    v_fmaak_f32 v99, v10, v99, 1262486016
    v_fmaak_f32 v116, v10, v116, 1262486016
    v_fmaak_f32 v117, v10, v117, 1262486016
    v_lshlrev_b32 v99, 22, v99
    v_alignbit_b32 v99, v116, v99, 10
    v_alignbit_b32 v99, v117, v99, 10
    v_xor_b32 v99, 0x80200800, v99
    s_mov_b32 s36, 11534336
    buffer_store_dwordx4 v[96:99], v3, s[20:23], s36 offen sc1
    v_lshlrev_b32 v71, 16, v118
    v_and_b32 v118, 0xffff0000, v118
    v_lshlrev_b32 v119, 16, v119
    v_mul_f32 v71, s41, v71
    v_mul_f32 v118, s41, v118
    v_mul_f32 v119, s41, v119
    v_fract_f32 v71, v71
    v_fract_f32 v118, v118
    v_fract_f32 v119, v119
    v_cos_f32 v71, v71
    v_cos_f32 v118, v118
    v_cos_f32 v119, v119
    v_fmaak_f32 v71, v10, v71, 1262486016
    v_fmaak_f32 v118, v10, v118, 1262486016
    v_fmaak_f32 v119, v10, v119, 1262486016
    v_lshlrev_b32 v71, 22, v71
    v_alignbit_b32 v71, v118, v71, 10
    v_alignbit_b32 v71, v119, v71, 10
    v_xor_b32 v71, 0x80200800, v71
    s_mov_b32 s36, 12582912
    buffer_store_dwordx4 v[68:71], v3, s[20:23], s36 offen sc1
    s_add_u32 s35, s33, 37748736
    s_sub_u32 s35, s35, s48
    v_cndmask_b32 v96, 2.0, v1, s[44:45]
    buffer_load_dwordx4 v[96:99], v96, s[8:11], s35 offen nt
    s_add_u32 s35, s33, 37748736
    s_sub_u32 s35, s35, s48
    v_cndmask_b32 v116, 2.0, v1, s[44:45]
    buffer_load_dwordx4 v[116:119], v116, s[12:15], s35 offen nt
    s_cbranch_vccz L_p1_kernel_thr_8
    s_waitcnt vmcnt(2)
L_p1_kernel_thr_8:
    s_branch L_p1_join
L_p1_first:
    s_add_u32 s35, s33, 20971520
    buffer_load_dwordx4 v[80:83], v1, s[8:11], s35 offen nt
    s_add_u32 s35, s33, 20971520
    buffer_load_dwordx4 v[100:103], v1, s[12:15], s35 offen nt
    s_add_u32 s35, s33, 25165824
    buffer_load_dwordx4 v[84:87], v1, s[8:11], s35 offen nt
    s_add_u32 s35, s33, 25165824
    buffer_load_dwordx4 v[104:107], v1, s[12:15], s35 offen nt
    s_add_u32 s35, s33, 29360128
    buffer_load_dwordx4 v[88:91], v1, s[8:11], s35 offen nt
    s_add_u32 s35, s33, 29360128
    buffer_load_dwordx4 v[108:111], v1, s[12:15], s35 offen nt
    s_add_u32 s35, s33, 33554432
    buffer_load_dwordx4 v[92:95], v1, s[8:11], s35 offen nt
    s_add_u32 s35, s33, 33554432
    buffer_load_dwordx4 v[112:115], v1, s[12:15], s35 offen nt
    s_add_u32 s35, s33, 37748736
    s_sub_u32 s35, s35, s48
    v_cndmask_b32 v96, 2.0, v1, s[44:45]
    buffer_load_dwordx4 v[96:99], v96, s[8:11], s35 offen nt
    s_add_u32 s35, s33, 37748736
    s_sub_u32 s35, s35, s48
    v_cndmask_b32 v116, 2.0, v1, s[44:45]
    buffer_load_dwordx4 v[116:119], v116, s[12:15], s35 offen nt
L_p1_join:
    s_waitcnt vmcnt(18)
    v_perm_b32 v6, v20, v16, s43
    v_perm_b32 v7, v21, v17, s43
    v_perm_b32 v8, v22, v18, s43
    v_perm_b32 v9, v23, v19, s43
    v_mul_hi_u32_u24 v16, 429497, v16
    v_mul_hi_u32_u24 v20, 429497, v20
    v_mul_hi_u32_u24 v17, 429497, v17
    v_mul_hi_u32_u24 v21, 429497, v21
    v_mul_hi_u32_u24 v18, 429497, v18
    v_mul_hi_u32_u24 v22, 429497, v22
    v_mul_hi_u32_u24 v19, 429497, v19
    v_mul_hi_u32_u24 v23, 429497, v23
    v_lshl_or_b32 v16, v20, 16, v16
    v_lshl_or_b32 v17, v21, 16, v17
    v_lshl_or_b32 v18, v22, 16, v18
    v_lshl_or_b32 v19, v23, 16, v19
    v_dot2_u32_u16 v20, v16, s38, 0
    v_dot2_u32_u16 v21, v17, s38, 0
    v_dot2_u32_u16 v22, v18, s38, 0
    v_dot2_u32_u16 v23, v19, s38, 0
    v_pk_mad_u16 v6, v16, s37, v6
    v_pk_mad_u16 v7, v17, s37, v7
    v_pk_mad_u16 v8, v18, s37, v8
    v_pk_mad_u16 v9, v19, s37, v9
    ds_add_u32 v20, v4 offset:0
    ds_add_u32 v21, v4 offset:0
    ds_add_u32 v22, v4 offset:0
    ds_add_u32 v23, v4 offset:0
    v_pk_mad_u16 v6, v16, s52, v6 op_sel:[1,0,0] op_sel_hi:[1,1,1]
    v_pk_mad_u16 v7, v17, s52, v7 op_sel:[1,0,0] op_sel_hi:[1,1,1]
    v_pk_mad_u16 v8, v18, s52, v8 op_sel:[1,0,0] op_sel_hi:[1,1,1]
    v_pk_mad_u16 v9, v19, s52, v9 op_sel:[1,0,0] op_sel_hi:[1,1,1]
    v_perm_b32 v121, v23, v22, s43
    v_perm_b32 v120, v21, v20, s43
    v_or_b32 v127, 0x40000000, v6
    v_or_b32 v48, 0x40000000, v7
    v_or_b32 v49, 0x40000000, v8
    v_or_b32 v50, 0x40000000, v9
    s_waitcnt vmcnt(16)
    v_perm_b32 v6, v28, v24, s43
    v_perm_b32 v7, v29, v25, s43
    v_perm_b32 v8, v30, v26, s43
    v_perm_b32 v9, v31, v27, s43
    v_mul_hi_u32_u24 v24, 429497, v24
    v_mul_hi_u32_u24 v28, 429497, v28
    v_mul_hi_u32_u24 v25, 429497, v25
    v_mul_hi_u32_u24 v29, 429497, v29
    v_mul_hi_u32_u24 v26, 429497, v26
    v_mul_hi_u32_u24 v30, 429497, v30
    v_mul_hi_u32_u24 v27, 429497, v27
    v_mul_hi_u32_u24 v31, 429497, v31
    v_lshl_or_b32 v24, v28, 16, v24
    v_lshl_or_b32 v25, v29, 16, v25
    v_lshl_or_b32 v26, v30, 16, v26
    v_lshl_or_b32 v27, v31, 16, v27
    v_dot2_u32_u16 v28, v24, s38, 0
    v_dot2_u32_u16 v29, v25, s38, 0
    v_dot2_u32_u16 v30, v26, s38, 0
    v_dot2_u32_u16 v31, v27, s38, 0
    v_pk_mad_u16 v6, v24, s37, v6
    v_pk_mad_u16 v7, v25, s37, v7
    v_pk_mad_u16 v8, v26, s37, v8
    v_pk_mad_u16 v9, v27, s37, v9
    ds_add_u32 v28, v4 offset:0
    ds_add_u32 v29, v4 offset:0
    ds_add_u32 v30, v4 offset:0
    ds_add_u32 v31, v4 offset:0
    v_pk_mad_u16 v6, v24, s52, v6 op_sel:[1,0,0] op_sel_hi:[1,1,1]
    v_pk_mad_u16 v7, v25, s52, v7 op_sel:[1,0,0] op_sel_hi:[1,1,1]
    v_pk_mad_u16 v8, v26, s52, v8 op_sel:[1,0,0] op_sel_hi:[1,1,1]
    v_pk_mad_u16 v9, v27, s52, v9 op_sel:[1,0,0] op_sel_hi:[1,1,1]
    v_perm_b32 v123, v31, v30, s43
    v_perm_b32 v122, v29, v28, s43
    v_or_b32 v52, 0x40000000, v6
    v_or_b32 v53, 0x40000000, v7
    v_or_b32 v54, 0x40000000, v8
    v_or_b32 v56, 0x40000000, v9
    s_waitcnt vmcnt(14)
    v_perm_b32 v6, v36, v32, s43
    v_perm_b32 v7, v37, v33, s43
    v_perm_b32 v8, v38, v34, s43
    v_perm_b32 v9, v39, v35, s43
    v_mul_hi_u32_u24 v32, 429497, v32
    v_mul_hi_u32_u24 v36, 429497, v36
    v_mul_hi_u32_u24 v33, 429497, v33
    v_mul_hi_u32_u24 v37, 429497, v37
    v_mul_hi_u32_u24 v34, 429497, v34
    v_mul_hi_u32_u24 v38, 429497, v38
    v_mul_hi_u32_u24 v35, 429497, v35
    v_mul_hi_u32_u24 v39, 429497, v39
    v_lshl_or_b32 v32, v36, 16, v32
    v_lshl_or_b32 v33, v37, 16, v33
    v_lshl_or_b32 v34, v38, 16, v34
    v_lshl_or_b32 v35, v39, 16, v35
    v_dot2_u32_u16 v36, v32, s38, 0
    v_dot2_u32_u16 v37, v33, s38, 0
    v_dot2_u32_u16 v38, v34, s38, 0
    v_dot2_u32_u16 v39, v35, s38, 0
    v_pk_mad_u16 v6, v32, s37, v6
    v_pk_mad_u16 v7, v33, s37, v7
    v_pk_mad_u16 v8, v34, s37, v8
    v_pk_mad_u16 v9, v35, s37, v9
    ds_add_u32 v36, v4 offset:0
    ds_add_u32 v37, v4 offset:0
    ds_add_u32 v38, v4 offset:0
    ds_add_u32 v39, v4 offset:0
    v_pk_mad_u16 v6, v32, s52, v6 op_sel:[1,0,0] op_sel_hi:[1,1,1]
    v_pk_mad_u16 v7, v33, s52, v7 op_sel:[1,0,0] op_sel_hi:[1,1,1]
    v_pk_mad_u16 v8, v34, s52, v8 op_sel:[1,0,0] op_sel_hi:[1,1,1]
    v_pk_mad_u16 v9, v35, s52, v9 op_sel:[1,0,0] op_sel_hi:[1,1,1]
    v_perm_b32 v125, v39, v38, s43
    v_perm_b32 v124, v37, v36, s43
    v_or_b32 v57, 0x40000000, v6
    v_or_b32 v58, 0x40000000, v7
    v_or_b32 v60, 0x40000000, v8
    v_or_b32 v61, 0x40000000, v9
    s_waitcnt vmcnt(12)
    v_perm_b32 v6, v44, v40, s43
    v_perm_b32 v7, v45, v41, s43
    v_perm_b32 v8, v46, v42, s43
    v_perm_b32 v9, v47, v43, s43
    v_mul_hi_u32_u24 v40, 429497, v40
    v_mul_hi_u32_u24 v44, 429497, v44
    v_mul_hi_u32_u24 v41, 429497, v41
    v_mul_hi_u32_u24 v45, 429497, v45
    v_mul_hi_u32_u24 v42, 429497, v42
    v_mul_hi_u32_u24 v46, 429497, v46
    v_mul_hi_u32_u24 v43, 429497, v43
    v_mul_hi_u32_u24 v47, 429497, v47
    v_lshl_or_b32 v40, v44, 16, v40
    v_lshl_or_b32 v41, v45, 16, v41
    v_lshl_or_b32 v42, v46, 16, v42
    v_lshl_or_b32 v43, v47, 16, v43
    v_dot2_u32_u16 v44, v40, s38, 0
    v_dot2_u32_u16 v45, v41, s38, 0
    v_dot2_u32_u16 v46, v42, s38, 0
    v_dot2_u32_u16 v47, v43, s38, 0
    v_pk_mad_u16 v6, v40, s37, v6
    v_pk_mad_u16 v7, v41, s37, v7
    v_pk_mad_u16 v8, v42, s37, v8
    v_pk_mad_u16 v9, v43, s37, v9
    ds_add_u32 v44, v4 offset:0
    ds_add_u32 v45, v4 offset:0
    ds_add_u32 v46, v4 offset:0
    ds_add_u32 v47, v4 offset:0
    v_pk_mad_u16 v6, v40, s52, v6 op_sel:[1,0,0] op_sel_hi:[1,1,1]
    v_pk_mad_u16 v7, v41, s52, v7 op_sel:[1,0,0] op_sel_hi:[1,1,1]
    v_pk_mad_u16 v8, v42, s52, v8 op_sel:[1,0,0] op_sel_hi:[1,1,1]
    v_pk_mad_u16 v9, v43, s52, v9 op_sel:[1,0,0] op_sel_hi:[1,1,1]
    v_perm_b32 v51, v47, v46, s43
    v_perm_b32 v126, v45, v44, s43
    v_or_b32 v62, 0x40000000, v6
    v_or_b32 v64, 0x40000000, v7
    v_or_b32 v65, 0x40000000, v8
    v_or_b32 v66, 0x40000000, v9
    s_waitcnt vmcnt(10)
    v_perm_b32 v6, v76, v72, s43
    v_perm_b32 v7, v77, v73, s43
    v_perm_b32 v8, v78, v74, s43
    v_perm_b32 v9, v79, v75, s43
    v_mul_hi_u32_u24 v72, 429497, v72
    v_mul_hi_u32_u24 v76, 429497, v76
    v_mul_hi_u32_u24 v73, 429497, v73
    v_mul_hi_u32_u24 v77, 429497, v77
    v_mul_hi_u32_u24 v74, 429497, v74
    v_mul_hi_u32_u24 v78, 429497, v78
    v_mul_hi_u32_u24 v75, 429497, v75
    v_mul_hi_u32_u24 v79, 429497, v79
    v_lshl_or_b32 v72, v76, 16, v72
    v_lshl_or_b32 v73, v77, 16, v73
    v_lshl_or_b32 v74, v78, 16, v74
    v_lshl_or_b32 v75, v79, 16, v75
    v_dot2_u32_u16 v76, v72, s38, 0
    v_dot2_u32_u16 v77, v73, s38, 0
    v_dot2_u32_u16 v78, v74, s38, 0
    v_dot2_u32_u16 v79, v75, s38, 0
    v_pk_mad_u16 v6, v72, s37, v6
    v_pk_mad_u16 v7, v73, s37, v7
    v_pk_mad_u16 v8, v74, s37, v8
    v_pk_mad_u16 v9, v75, s37, v9
    ds_add_u32 v76, v4 offset:0
    ds_add_u32 v77, v4 offset:0
    ds_add_u32 v78, v4 offset:0
    ds_add_u32 v79, v4 offset:0
    v_pk_mad_u16 v6, v72, s52, v6 op_sel:[1,0,0] op_sel_hi:[1,1,1]
    v_pk_mad_u16 v7, v73, s52, v7 op_sel:[1,0,0] op_sel_hi:[1,1,1]
    v_pk_mad_u16 v8, v74, s52, v8 op_sel:[1,0,0] op_sel_hi:[1,1,1]
    v_pk_mad_u16 v9, v75, s52, v9 op_sel:[1,0,0] op_sel_hi:[1,1,1]
    v_perm_b32 v59, v79, v78, s43
    v_perm_b32 v55, v77, v76, s43
    v_or_b32 v68, 0x40000000, v6
    v_or_b32 v69, 0x40000000, v7
    v_or_b32 v70, 0x40000000, v8
    v_or_b32 v72, 0x40000000, v9
    s_waitcnt vmcnt(8)
    v_perm_b32 v6, v100, v80, s43
    v_perm_b32 v7, v101, v81, s43
    v_perm_b32 v8, v102, v82, s43
    v_perm_b32 v9, v103, v83, s43
    v_mul_hi_u32_u24 v80, 429497, v80
    v_mul_hi_u32_u24 v100, 429497, v100
    v_mul_hi_u32_u24 v81, 429497, v81
    v_mul_hi_u32_u24 v101, 429497, v101
    v_mul_hi_u32_u24 v82, 429497, v82
    v_mul_hi_u32_u24 v102, 429497, v102
    v_mul_hi_u32_u24 v83, 429497, v83
    v_mul_hi_u32_u24 v103, 429497, v103
    v_lshl_or_b32 v80, v100, 16, v80
    v_lshl_or_b32 v81, v101, 16, v81
    v_lshl_or_b32 v82, v102, 16, v82
    v_lshl_or_b32 v83, v103, 16, v83
    v_dot2_u32_u16 v100, v80, s38, 0
    v_dot2_u32_u16 v101, v81, s38, 0
    v_dot2_u32_u16 v102, v82, s38, 0
    v_dot2_u32_u16 v103, v83, s38, 0
    v_pk_mad_u16 v6, v80, s37, v6
    v_pk_mad_u16 v7, v81, s37, v7
    v_pk_mad_u16 v8, v82, s37, v8
    v_pk_mad_u16 v9, v83, s37, v9
    ds_add_u32 v100, v4 offset:0
    ds_add_u32 v101, v4 offset:0
    ds_add_u32 v102, v4 offset:0
    ds_add_u32 v103, v4 offset:0
    v_pk_mad_u16 v6, v80, s52, v6 op_sel:[1,0,0] op_sel_hi:[1,1,1]
    v_pk_mad_u16 v7, v81, s52, v7 op_sel:[1,0,0] op_sel_hi:[1,1,1]
    v_pk_mad_u16 v8, v82, s52, v8 op_sel:[1,0,0] op_sel_hi:[1,1,1]
    v_pk_mad_u16 v9, v83, s52, v9 op_sel:[1,0,0] op_sel_hi:[1,1,1]
    v_perm_b32 v67, v103, v102, s43
    v_perm_b32 v63, v101, v100, s43
    v_or_b32 v73, 0x40000000, v6
    v_or_b32 v74, 0x40000000, v7
    v_or_b32 v76, 0x40000000, v8
    v_or_b32 v77, 0x40000000, v9
    s_waitcnt vmcnt(6)
    v_perm_b32 v6, v104, v84, s43
    v_perm_b32 v7, v105, v85, s43
    v_perm_b32 v8, v106, v86, s43
    v_perm_b32 v9, v107, v87, s43
    v_mul_hi_u32_u24 v84, 429497, v84
    v_mul_hi_u32_u24 v104, 429497, v104
    v_mul_hi_u32_u24 v85, 429497, v85
    v_mul_hi_u32_u24 v105, 429497, v105
    v_mul_hi_u32_u24 v86, 429497, v86
    v_mul_hi_u32_u24 v106, 429497, v106
    v_mul_hi_u32_u24 v87, 429497, v87
    v_mul_hi_u32_u24 v107, 429497, v107
    v_lshl_or_b32 v84, v104, 16, v84
    v_lshl_or_b32 v85, v105, 16, v85
    v_lshl_or_b32 v86, v106, 16, v86
    v_lshl_or_b32 v87, v107, 16, v87
    v_dot2_u32_u16 v104, v84, s38, 0
    v_dot2_u32_u16 v105, v85, s38, 0
    v_dot2_u32_u16 v106, v86, s38, 0
    v_dot2_u32_u16 v107, v87, s38, 0
    v_pk_mad_u16 v6, v84, s37, v6
    v_pk_mad_u16 v7, v85, s37, v7
    v_pk_mad_u16 v8, v86, s37, v8
    v_pk_mad_u16 v9, v87, s37, v9
    ds_add_u32 v104, v4 offset:0
    ds_add_u32 v105, v4 offset:0
    ds_add_u32 v106, v4 offset:0
    ds_add_u32 v107, v4 offset:0
    v_pk_mad_u16 v6, v84, s52, v6 op_sel:[1,0,0] op_sel_hi:[1,1,1]
    v_pk_mad_u16 v7, v85, s52, v7 op_sel:[1,0,0] op_sel_hi:[1,1,1]
    v_pk_mad_u16 v8, v86, s52, v8 op_sel:[1,0,0] op_sel_hi:[1,1,1]
    v_pk_mad_u16 v9, v87, s52, v9 op_sel:[1,0,0] op_sel_hi:[1,1,1]
    v_perm_b32 v75, v107, v106, s43
    v_perm_b32 v71, v105, v104, s43
    v_or_b32 v78, 0x40000000, v6
    v_or_b32 v80, 0x40000000, v7
    v_or_b32 v81, 0x40000000, v8
    v_or_b32 v82, 0x40000000, v9
    s_waitcnt vmcnt(4)
    v_perm_b32 v6, v108, v88, s43
    v_perm_b32 v7, v109, v89, s43
    v_perm_b32 v8, v110, v90, s43
    v_perm_b32 v9, v111, v91, s43
    v_mul_hi_u32_u24 v88, 429497, v88
    v_mul_hi_u32_u24 v108, 429497, v108
    v_mul_hi_u32_u24 v89, 429497, v89
    v_mul_hi_u32_u24 v109, 429497, v109
    v_mul_hi_u32_u24 v90, 429497, v90
    v_mul_hi_u32_u24 v110, 429497, v110
    v_mul_hi_u32_u24 v91, 429497, v91
    v_mul_hi_u32_u24 v111, 429497, v111
    v_lshl_or_b32 v88, v108, 16, v88
    v_lshl_or_b32 v89, v109, 16, v89
    v_lshl_or_b32 v90, v110, 16, v90
    v_lshl_or_b32 v91, v111, 16, v91
    v_dot2_u32_u16 v108, v88, s38, 0
    v_dot2_u32_u16 v109, v89, s38, 0
    v_dot2_u32_u16 v110, v90, s38, 0
    v_dot2_u32_u16 v111, v91, s38, 0
    v_pk_mad_u16 v6, v88, s37, v6
    v_pk_mad_u16 v7, v89, s37, v7
    v_pk_mad_u16 v8, v90, s37, v8
    v_pk_mad_u16 v9, v91, s37, v9
    ds_add_u32 v108, v4 offset:0
    ds_add_u32 v109, v4 offset:0
    ds_add_u32 v110, v4 offset:0
    ds_add_u32 v111, v4 offset:0
    v_pk_mad_u16 v6, v88, s52, v6 op_sel:[1,0,0] op_sel_hi:[1,1,1]
    v_pk_mad_u16 v7, v89, s52, v7 op_sel:[1,0,0] op_sel_hi:[1,1,1]
    v_pk_mad_u16 v8, v90, s52, v8 op_sel:[1,0,0] op_sel_hi:[1,1,1]
    v_pk_mad_u16 v9, v91, s52, v9 op_sel:[1,0,0] op_sel_hi:[1,1,1]
    v_perm_b32 v83, v111, v110, s43
    v_perm_b32 v79, v109, v108, s43
    v_or_b32 v84, 0x40000000, v6
    v_or_b32 v85, 0x40000000, v7
    v_or_b32 v86, 0x40000000, v8
    v_or_b32 v88, 0x40000000, v9
    s_waitcnt vmcnt(2)
    v_perm_b32 v6, v112, v92, s43
    v_perm_b32 v7, v113, v93, s43
    v_perm_b32 v8, v114, v94, s43
    v_perm_b32 v9, v115, v95, s43
    v_mul_hi_u32_u24 v92, 429497, v92
    v_mul_hi_u32_u24 v112, 429497, v112
    v_mul_hi_u32_u24 v93, 429497, v93
    v_mul_hi_u32_u24 v113, 429497, v113
    v_mul_hi_u32_u24 v94, 429497, v94
    v_mul_hi_u32_u24 v114, 429497, v114
    v_mul_hi_u32_u24 v95, 429497, v95
    v_mul_hi_u32_u24 v115, 429497, v115
    v_lshl_or_b32 v92, v112, 16, v92
    v_lshl_or_b32 v93, v113, 16, v93
    v_lshl_or_b32 v94, v114, 16, v94
    v_lshl_or_b32 v95, v115, 16, v95
    v_dot2_u32_u16 v112, v92, s38, 0
    v_dot2_u32_u16 v113, v93, s38, 0
    v_dot2_u32_u16 v114, v94, s38, 0
    v_dot2_u32_u16 v115, v95, s38, 0
    v_pk_mad_u16 v6, v92, s37, v6
    v_pk_mad_u16 v7, v93, s37, v7
    v_pk_mad_u16 v8, v94, s37, v8
    v_pk_mad_u16 v9, v95, s37, v9
    ds_add_u32 v112, v4 offset:0
    ds_add_u32 v113, v4 offset:0
    ds_add_u32 v114, v4 offset:0
    ds_add_u32 v115, v4 offset:0
    v_pk_mad_u16 v6, v92, s52, v6 op_sel:[1,0,0] op_sel_hi:[1,1,1]
    v_pk_mad_u16 v7, v93, s52, v7 op_sel:[1,0,0] op_sel_hi:[1,1,1]
    v_pk_mad_u16 v8, v94, s52, v8 op_sel:[1,0,0] op_sel_hi:[1,1,1]
    v_pk_mad_u16 v9, v95, s52, v9 op_sel:[1,0,0] op_sel_hi:[1,1,1]
    v_perm_b32 v91, v115, v114, s43
    v_perm_b32 v87, v113, v112, s43
    v_or_b32 v89, 0x40000000, v6
    v_or_b32 v90, 0x40000000, v7
    v_or_b32 v92, 0x40000000, v8
    v_or_b32 v93, 0x40000000, v9
    s_waitcnt vmcnt(0)
    s_mov_b64 exec, s[44:45]
    v_perm_b32 v6, v116, v96, s43
    v_perm_b32 v7, v117, v97, s43
    v_perm_b32 v8, v118, v98, s43
    v_perm_b32 v9, v119, v99, s43
    v_mul_hi_u32_u24 v96, 429497, v96
    v_mul_hi_u32_u24 v116, 429497, v116
    v_mul_hi_u32_u24 v97, 429497, v97
    v_mul_hi_u32_u24 v117, 429497, v117
    v_mul_hi_u32_u24 v98, 429497, v98
    v_mul_hi_u32_u24 v118, 429497, v118
    v_mul_hi_u32_u24 v99, 429497, v99
    v_mul_hi_u32_u24 v119, 429497, v119
    v_lshl_or_b32 v96, v116, 16, v96
    v_lshl_or_b32 v97, v117, 16, v97
    v_lshl_or_b32 v98, v118, 16, v98
    v_lshl_or_b32 v99, v119, 16, v99
    v_dot2_u32_u16 v116, v96, s38, 0
    v_dot2_u32_u16 v117, v97, s38, 0
    v_dot2_u32_u16 v118, v98, s38, 0
    v_dot2_u32_u16 v119, v99, s38, 0
    v_pk_mad_u16 v6, v96, s37, v6
    v_pk_mad_u16 v7, v97, s37, v7
    v_pk_mad_u16 v8, v98, s37, v8
    v_pk_mad_u16 v9, v99, s37, v9
    ds_add_u32 v116, v4 offset:0
    ds_add_u32 v117, v4 offset:0
    ds_add_u32 v118, v4 offset:0
    ds_add_u32 v119, v4 offset:0
    v_pk_mad_u16 v6, v96, s52, v6 op_sel:[1,0,0] op_sel_hi:[1,1,1]
    v_pk_mad_u16 v7, v97, s52, v7 op_sel:[1,0,0] op_sel_hi:[1,1,1]
    v_pk_mad_u16 v8, v98, s52, v8 op_sel:[1,0,0] op_sel_hi:[1,1,1]
    v_pk_mad_u16 v9, v99, s52, v9 op_sel:[1,0,0] op_sel_hi:[1,1,1]
    v_perm_b32 v99, v119, v118, s43
    v_perm_b32 v95, v117, v116, s43
    v_or_b32 v94, 0x40000000, v6
    v_or_b32 v96, 0x40000000, v7
    v_or_b32 v97, 0x40000000, v8
    v_or_b32 v98, 0x40000000, v9
    s_mov_b64 exec, -1
    s_add_u32 s35, s34, 0
    buffer_load_dwordx2 v[100:101], v2, s[16:19], s35 offen nt
    s_lshl_b32 s35, s32, 10
    s_add_u32 s35, s35, 9437184
    s_add_u32 s20, s4, s35
    s_addc_u32 s21, s5, 0
    s_lshl2_add_u32 s35, s39, 160768
    v_mov_b32 v13, s35
    v_mov_b32 v7, 2.0
    v_and_b32 v6, 63, v0
    s_mov_b32 s36, 160768
    s_lshl_b32 s35, 0x1fffe, s39
    s_and_b32 s35, s35, 0x1ffff
    s_mov_b32 exec_hi, 0
    s_mov_b32 exec_lo, s35
    v_lshl_add_u32 v7, v6, 2, s36
    s_mov_b64 exec, -1
    v_mov_b32 v14, 160832
    s_mov_b32 s53, 2
    s_waitcnt lgkmcnt(0)
    s_barrier
    ds_read_b128 v[8:11], v1 offset:0
    s_add_u32 s35, s34, 2097152
    buffer_load_dwordx2 v[102:103], v2, s[16:19], s35 offen nt
L_p1_redo:
    s_waitcnt lgkmcnt(0)
    v_min3_u32 v12, v8, v9, v10
    v_min_u32 v12, v12, v11
    v_cmp_gt_u32 vcc, s53, v12
    s_nop 0
    s_mov_b64 s[46:47], vcc
    s_cbranch_vccz L_p1_kernel_nomask_9
    v_cmp_eq_u32 s[56:57], 0, v8
    v_cmp_ge_u32 s[64:65], 1, v8
    v_max_u32 v8, 2, v8
    v_cmp_eq_u32 s[58:59], 0, v9
    v_cmp_ge_u32 s[66:67], 1, v9
    v_max_u32 v9, 2, v9
    v_cmp_eq_u32 s[60:61], 0, v10
    v_cmp_ge_u32 s[68:69], 1, v10
    v_max_u32 v10, 2, v10
    v_cmp_eq_u32 s[62:63], 0, v11
    v_cmp_ge_u32 s[70:71], 1, v11
    v_max_u32 v11, 2, v11
L_p1_kernel_nomask_9:
    v_add_u32 v9, v8, v9
    v_add_u32 v10, v9, v10
    v_add_u32 v11, v10, v11
    s_nop 1
    v_add_u32_dpp v6, v11, v11 row_shr:1 row_mask:0xf bank_mask:0xf bound_ctrl:0
    s_nop 1
    v_add_u32_dpp v6, v6, v6 row_shr:2 row_mask:0xf bank_mask:0xf bound_ctrl:0
    s_nop 1
    v_add_u32_dpp v6, v6, v6 row_shr:4 row_mask:0xf bank_mask:0xf bound_ctrl:0
    s_nop 1
    v_add_u32_dpp v6, v6, v6 row_shr:8 row_mask:0xf bank_mask:0xf bound_ctrl:0
    s_nop 1
    v_add_u32_dpp v6, v6, v6 row_bcast:15 row_mask:0xa bank_mask:0xf
    s_nop 1
    v_add_u32_dpp v6, v6, v6 row_bcast:31 row_mask:0xc bank_mask:0xf
    s_nop 0
    v_readlane_b32 s35, v6, 63
    v_sub_u32 v6, v6, v11
    v_add_u32 v8, v8, v6
    v_mov_b32 v12, s35
    ds_add_u32 v7, v12
    v_add_u32 v9, v9, v6
    v_add_u32 v10, v10, v6
    s_waitcnt lgkmcnt(0)
    s_barrier
    ds_read_b32 v12, v14
    ds_read_b32 v11, v13
    s_add_u32 s35, s34, 4194304
    buffer_load_dwordx2 v[104:105], v2, s[16:19], s35 offen nt
    s_waitcnt lgkmcnt(1)
    v_readfirstlane_b32 s54, v12
    s_waitcnt lgkmcnt(0)
    s_cmp_ge_u32 s54, 40063
    s_cbranch_scc0 L_p1_fits
    s_barrier
    v_mov_b32 v12, 0
    ds_write_b32 v7, v12
    s_mov_b32 s53, 0
    s_mov_b32 s55, 1
    s_waitcnt lgkmcnt(0)
    s_barrier
    ds_read_b128 v[8:11], v1 offset:0
    s_branch L_p1_redo
L_p1_fits:
    s_mov_b64 exec, 1
    v_mov_b32 v7, 24576
    ds_write_b16 v7, v12
    s_mov_b64 exec, -1
    v_add_u32 v12, v11, v6
    v_add_u32 v13, v11, v8
    v_add_u32 v14, v11, v9
    v_add_u32 v15, v11, v10
    ds_write_b128 v1, v[12:15] offset:0
    s_add_u32 s35, s54, 2
    s_mul_hi_u32 s35, s35, 1431655766
    v_perm_b32 v15, v15, v14, s43
    v_perm_b32 v14, v13, v12, s43
    ds_write_b64 v2, v[14:15] offset:16384
    s_lshl_b32 s35, s35, 4
    s_add_u32 s35, s35, 217890816
    s_min_u32 s22, s35, 218104832
    s_waitcnt lgkmcnt(0)
    s_barrier
    s_nop 0
    v_and_b32 v6, 0xffff, v120
    v_lshrrev_b32 v7, 16, v120
    v_and_b32 v8, 0xffff, v121
    v_lshrrev_b32 v9, 16, v121
    ds_add_rtn_u32 v6, v6, v4 offset:0
    ds_add_rtn_u32 v7, v7, v4 offset:0
    ds_add_rtn_u32 v8, v8, v4 offset:0
    ds_add_rtn_u32 v9, v9, v4 offset:0
    v_and_b32 v10, 0xffff, v122
    v_lshrrev_b32 v11, 16, v122
    v_and_b32 v12, 0xffff, v123
    v_lshrrev_b32 v13, 16, v123
    ds_add_rtn_u32 v10, v10, v4 offset:0
    ds_add_rtn_u32 v11, v11, v4 offset:0
    ds_add_rtn_u32 v12, v12, v4 offset:0
    ds_add_rtn_u32 v13, v13, v4 offset:0
    s_waitcnt lgkmcnt(4)
    v_perm_b32 v120, v7, v6, s43
    v_perm_b32 v121, v9, v8, s43
    v_and_b32 v6, 0xffff, v124
    v_lshrrev_b32 v7, 16, v124
    v_and_b32 v8, 0xffff, v125
    v_lshrrev_b32 v9, 16, v125
    ds_add_rtn_u32 v6, v6, v4 offset:0
    ds_add_rtn_u32 v7, v7, v4 offset:0
    ds_add_rtn_u32 v8, v8, v4 offset:0
    ds_add_rtn_u32 v9, v9, v4 offset:0
    s_waitcnt lgkmcnt(4)
    v_perm_b32 v122, v11, v10, s43
    v_perm_b32 v123, v13, v12, s43
    s_add_u32 s35, s34, 6291456
    buffer_load_dwordx2 v[106:107], v2, s[16:19], s35 offen nt
    v_and_b32 v10, 0xffff, v126
    v_lshrrev_b32 v11, 16, v126
    v_and_b32 v12, 0xffff, v51
    v_lshrrev_b32 v13, 16, v51
    ds_add_rtn_u32 v10, v10, v4 offset:0
    ds_add_rtn_u32 v11, v11, v4 offset:0
    ds_add_rtn_u32 v12, v12, v4 offset:0
    ds_add_rtn_u32 v13, v13, v4 offset:0
    s_waitcnt lgkmcnt(4)
    v_perm_b32 v124, v7, v6, s43
    v_perm_b32 v125, v9, v8, s43
    s_add_u32 s35, s34, 8388608
    buffer_load_dwordx2 v[108:109], v2, s[16:19], s35 offen nt
    v_and_b32 v6, 0xffff, v55
    v_lshrrev_b32 v7, 16, v55
    v_and_b32 v8, 0xffff, v59
    v_lshrrev_b32 v9, 16, v59
    ds_add_rtn_u32 v6, v6, v4 offset:0
    ds_add_rtn_u32 v7, v7, v4 offset:0
    ds_add_rtn_u32 v8, v8, v4 offset:0
    ds_add_rtn_u32 v9, v9, v4 offset:0
    s_waitcnt lgkmcnt(4)
    v_perm_b32 v126, v11, v10, s43
    v_perm_b32 v51, v13, v12, s43
    s_add_u32 s35, s34, 10485760
    buffer_load_dwordx2 v[110:111], v2, s[16:19], s35 offen nt
    v_and_b32 v10, 0xffff, v63
    v_lshrrev_b32 v11, 16, v63
    v_and_b32 v12, 0xffff, v67
    v_lshrrev_b32 v13, 16, v67
    ds_add_rtn_u32 v10, v10, v4 offset:0
    ds_add_rtn_u32 v11, v11, v4 offset:0
    ds_add_rtn_u32 v12, v12, v4 offset:0
    ds_add_rtn_u32 v13, v13, v4 offset:0
    s_waitcnt lgkmcnt(4)
    v_perm_b32 v55, v7, v6, s43
    v_perm_b32 v59, v9, v8, s43
    v_and_b32 v6, 0xffff, v71
    v_lshrrev_b32 v7, 16, v71
    v_and_b32 v8, 0xffff, v75
    v_lshrrev_b32 v9, 16, v75
    ds_add_rtn_u32 v6, v6, v4 offset:0
    ds_add_rtn_u32 v7, v7, v4 offset:0
    ds_add_rtn_u32 v8, v8, v4 offset:0
    ds_add_rtn_u32 v9, v9, v4 offset:0
    s_waitcnt lgkmcnt(4)
    v_perm_b32 v63, v11, v10, s43
    v_perm_b32 v67, v13, v12, s43
    s_add_u32 s35, s34, 12582912
    buffer_load_dwordx2 v[112:113], v2, s[16:19], s35 offen nt
    v_and_b32 v10, 0xffff, v79
    v_lshrrev_b32 v11, 16, v79
    v_and_b32 v12, 0xffff, v83
    v_lshrrev_b32 v13, 16, v83
    ds_add_rtn_u32 v10, v10, v4 offset:0
    ds_add_rtn_u32 v11, v11, v4 offset:0
    ds_add_rtn_u32 v12, v12, v4 offset:0
    ds_add_rtn_u32 v13, v13, v4 offset:0
    s_waitcnt lgkmcnt(4)
    v_perm_b32 v71, v7, v6, s43
    v_perm_b32 v75, v9, v8, s43
    s_add_u32 s35, s34, 14680064
    buffer_load_dwordx2 v[114:115], v2, s[16:19], s35 offen nt
    v_and_b32 v6, 0xffff, v87
    v_lshrrev_b32 v7, 16, v87
    v_and_b32 v8, 0xffff, v91
    v_lshrrev_b32 v9, 16, v91
    ds_add_rtn_u32 v6, v6, v4 offset:0
    ds_add_rtn_u32 v7, v7, v4 offset:0
    ds_add_rtn_u32 v8, v8, v4 offset:0
    ds_add_rtn_u32 v9, v9, v4 offset:0
    s_waitcnt lgkmcnt(4)
    v_perm_b32 v79, v11, v10, s43
    v_perm_b32 v83, v13, v12, s43
    s_add_u32 s35, s34, 16777216
    buffer_load_dwordx2 v[116:117], v2, s[16:19], s35 offen nt
    s_mov_b64 exec, s[44:45]
    v_and_b32 v10, 0xffff, v95
    v_lshrrev_b32 v11, 16, v95
    v_and_b32 v12, 0xffff, v99
    v_lshrrev_b32 v13, 16, v99
    ds_add_rtn_u32 v10, v10, v4 offset:0
    ds_add_rtn_u32 v11, v11, v4 offset:0
    ds_add_rtn_u32 v12, v12, v4 offset:0
    ds_add_rtn_u32 v13, v13, v4 offset:0
    s_mov_b64 exec, -1
    s_waitcnt lgkmcnt(4)
    v_perm_b32 v87, v7, v6, s43
    v_perm_b32 v91, v9, v8, s43
    s_add_u32 s35, s34, 18874368
    s_sub_u32 s35, s35, s49
    v_cndmask_b32 v118, 2.0, v2, s[44:45]
    buffer_load_dwordx2 v[118:119], v118, s[16:19], s35 offen nt
    s_waitcnt lgkmcnt(0)
    v_perm_b32 v95, v11, v10, s43
    v_perm_b32 v99, v13, v12, s43
    s_cmp_gt_u32 s39, 8
    s_cbranch_scc1 L_p1_kernel_notab_10
    v_lshrrev_b32 v6, 1, v0
    v_mul_u32_u24 v7, 1009, v6
    v_lshrrev_b32 v7, 16, v7
    v_mul_u32_u24 v7, 959, v7
    v_and_b32 v8, 1, v0
    v_lshl_add_u32 v7, v8, 9, v7
    v_add_lshl_u32 v13, v7, v6, 1
    ds_read_u16 v6, v13 offset:16384
    ds_read_u16 v7, v13 offset:16512
    ds_read_u16 v8, v13 offset:16640
    ds_read_u16 v9, v13 offset:16768
    ds_read_u16 v10, v13 offset:16896
    ds_read_u16 v11, v13 offset:17024
    ds_read_u16 v12, v13 offset:17152
    ds_read_u16 v13, v13 offset:17280
    s_mul_i32 s35, s32, 8320
    s_add_u32 s26, s35, 8320
    s_waitcnt lgkmcnt(6)
    v_perm_b32 v6, v7, v6, s43
    s_waitcnt lgkmcnt(4)
    v_perm_b32 v7, v9, v8, s43
    s_waitcnt lgkmcnt(2)
    v_perm_b32 v8, v11, v10, s43
    s_waitcnt lgkmcnt(0)
    v_perm_b32 v9, v13, v12, s43
    buffer_store_dwordx4 v[6:9], v1, s[24:27], s35 offen sc1
    s_nop 1
L_p1_kernel_notab_10:
    s_barrier
    s_lshl_b32 s35, s54, 2
    v_mov_b32 v6, s35
    v_mov_b32 v7, 0
    v_mov_b32 v12, 1140817920
    s_mov_b64 exec, 1
    ds_write2_b32 v6, v7, v7 offset0:0 offset1:1
    s_cmp_eq_u64 s[46:47], 0
    s_cbranch_scc1 L_p1_kernel_nonull_11
    s_mov_b64 exec, s[64:65]
    v_lshlrev_b32_sdwa v6, 2, v14 dst_sel:DWORD dst_unused:UNUSED_PAD src0_sel:DWORD src1_sel:WORD_0
    ds_write_b32 v6, v7 offset:4
    s_mov_b64 exec, s[56:57]
    ds_write_b32 v6, v7
    s_mov_b64 exec, s[66:67]
    v_lshlrev_b32_sdwa v6, 2, v14 dst_sel:DWORD dst_unused:UNUSED_PAD src0_sel:DWORD src1_sel:WORD_1
    ds_write_b32 v6, v7 offset:4
    s_mov_b64 exec, s[58:59]
    ds_write_b32 v6, v7
    s_mov_b64 exec, s[68:69]
    v_lshlrev_b32_sdwa v6, 2, v15 dst_sel:DWORD dst_unused:UNUSED_PAD src0_sel:DWORD src1_sel:WORD_0
    ds_write_b32 v6, v7 offset:4
    s_mov_b64 exec, s[60:61]
    ds_write_b32 v6, v7
    s_mov_b64 exec, s[70:71]
    v_lshlrev_b32_sdwa v6, 2, v15 dst_sel:DWORD dst_unused:UNUSED_PAD src0_sel:DWORD src1_sel:WORD_1
    ds_write_b32 v6, v7 offset:4
    s_mov_b64 exec, s[62:63]
    ds_write_b32 v6, v7
L_p1_kernel_nonull_11:
    s_mov_b64 exec, -1
    v_lshlrev_b32_sdwa v6, 2, v120 dst_sel:DWORD dst_unused:UNUSED_PAD src0_sel:DWORD src1_sel:WORD_0
    v_lshlrev_b32_sdwa v7, 2, v120 dst_sel:DWORD dst_unused:UNUSED_PAD src0_sel:DWORD src1_sel:WORD_1
    v_lshlrev_b32_sdwa v8, 2, v121 dst_sel:DWORD dst_unused:UNUSED_PAD src0_sel:DWORD src1_sel:WORD_0
    v_lshlrev_b32_sdwa v9, 2, v121 dst_sel:DWORD dst_unused:UNUSED_PAD src0_sel:DWORD src1_sel:WORD_1
    ds_write_b32 v6, v127
    ds_write_b32 v7, v48
    ds_write_b32 v8, v49
    ds_write_b32 v9, v50
    s_add_u32 s35, s33, 40960000
    buffer_load_dwordx4 v[16:19], v1, s[8:11], s35 offen nt
    v_lshlrev_b32_sdwa v6, 2, v122 dst_sel:DWORD dst_unused:UNUSED_PAD src0_sel:DWORD src1_sel:WORD_0
    v_lshlrev_b32_sdwa v7, 2, v122 dst_sel:DWORD dst_unused:UNUSED_PAD src0_sel:DWORD src1_sel:WORD_1
    v_lshlrev_b32_sdwa v8, 2, v123 dst_sel:DWORD dst_unused:UNUSED_PAD src0_sel:DWORD src1_sel:WORD_0
    v_lshlrev_b32_sdwa v9, 2, v123 dst_sel:DWORD dst_unused:UNUSED_PAD src0_sel:DWORD src1_sel:WORD_1
    ds_write_b32 v6, v52
    ds_write_b32 v7, v53
    ds_write_b32 v8, v54
    ds_write_b32 v9, v56
    v_lshlrev_b32_sdwa v6, 2, v124 dst_sel:DWORD dst_unused:UNUSED_PAD src0_sel:DWORD src1_sel:WORD_0
    v_lshlrev_b32_sdwa v7, 2, v124 dst_sel:DWORD dst_unused:UNUSED_PAD src0_sel:DWORD src1_sel:WORD_1
    v_lshlrev_b32_sdwa v8, 2, v125 dst_sel:DWORD dst_unused:UNUSED_PAD src0_sel:DWORD src1_sel:WORD_0
    v_lshlrev_b32_sdwa v9, 2, v125 dst_sel:DWORD dst_unused:UNUSED_PAD src0_sel:DWORD src1_sel:WORD_1
    ds_write_b32 v6, v57
    ds_write_b32 v7, v58
    ds_write_b32 v8, v60
    ds_write_b32 v9, v61
    v_lshlrev_b32_sdwa v6, 2, v126 dst_sel:DWORD dst_unused:UNUSED_PAD src0_sel:DWORD src1_sel:WORD_0
    v_lshlrev_b32_sdwa v7, 2, v126 dst_sel:DWORD dst_unused:UNUSED_PAD src0_sel:DWORD src1_sel:WORD_1
    v_lshlrev_b32_sdwa v8, 2, v51 dst_sel:DWORD dst_unused:UNUSED_PAD src0_sel:DWORD src1_sel:WORD_0
    v_lshlrev_b32_sdwa v9, 2, v51 dst_sel:DWORD dst_unused:UNUSED_PAD src0_sel:DWORD src1_sel:WORD_1
    ds_write_b32 v6, v62
    ds_write_b32 v7, v64
    ds_write_b32 v8, v65
    ds_write_b32 v9, v66
    s_add_u32 s35, s33, 40960000
    buffer_load_dwordx4 v[20:23], v1, s[12:15], s35 offen nt
    v_lshlrev_b32_sdwa v6, 2, v55 dst_sel:DWORD dst_unused:UNUSED_PAD src0_sel:DWORD src1_sel:WORD_0
    v_lshlrev_b32_sdwa v7, 2, v55 dst_sel:DWORD dst_unused:UNUSED_PAD src0_sel:DWORD src1_sel:WORD_1
    v_lshlrev_b32_sdwa v8, 2, v59 dst_sel:DWORD dst_unused:UNUSED_PAD src0_sel:DWORD src1_sel:WORD_0
    v_lshlrev_b32_sdwa v9, 2, v59 dst_sel:DWORD dst_unused:UNUSED_PAD src0_sel:DWORD src1_sel:WORD_1
    ds_write_b32 v6, v68
    ds_write_b32 v7, v69
    ds_write_b32 v8, v70
    ds_write_b32 v9, v72
    v_lshlrev_b32_sdwa v6, 2, v63 dst_sel:DWORD dst_unused:UNUSED_PAD src0_sel:DWORD src1_sel:WORD_0
    v_lshlrev_b32_sdwa v7, 2, v63 dst_sel:DWORD dst_unused:UNUSED_PAD src0_sel:DWORD src1_sel:WORD_1
    v_lshlrev_b32_sdwa v8, 2, v67 dst_sel:DWORD dst_unused:UNUSED_PAD src0_sel:DWORD src1_sel:WORD_0
    v_lshlrev_b32_sdwa v9, 2, v67 dst_sel:DWORD dst_unused:UNUSED_PAD src0_sel:DWORD src1_sel:WORD_1
    ds_write_b32 v6, v73
    ds_write_b32 v7, v74
    ds_write_b32 v8, v76
    ds_write_b32 v9, v77
    v_lshlrev_b32_sdwa v6, 2, v71 dst_sel:DWORD dst_unused:UNUSED_PAD src0_sel:DWORD src1_sel:WORD_0
    v_lshlrev_b32_sdwa v7, 2, v71 dst_sel:DWORD dst_unused:UNUSED_PAD src0_sel:DWORD src1_sel:WORD_1
    v_lshlrev_b32_sdwa v8, 2, v75 dst_sel:DWORD dst_unused:UNUSED_PAD src0_sel:DWORD src1_sel:WORD_0
    v_lshlrev_b32_sdwa v9, 2, v75 dst_sel:DWORD dst_unused:UNUSED_PAD src0_sel:DWORD src1_sel:WORD_1
    ds_write_b32 v6, v78
    ds_write_b32 v7, v80
    ds_write_b32 v8, v81
    ds_write_b32 v9, v82
    s_add_u32 s35, s33, 45154304
    buffer_load_dwordx4 v[24:27], v1, s[8:11], s35 offen nt
    v_lshlrev_b32_sdwa v6, 2, v79 dst_sel:DWORD dst_unused:UNUSED_PAD src0_sel:DWORD src1_sel:WORD_0
    v_lshlrev_b32_sdwa v7, 2, v79 dst_sel:DWORD dst_unused:UNUSED_PAD src0_sel:DWORD src1_sel:WORD_1
    v_lshlrev_b32_sdwa v8, 2, v83 dst_sel:DWORD dst_unused:UNUSED_PAD src0_sel:DWORD src1_sel:WORD_0
    v_lshlrev_b32_sdwa v9, 2, v83 dst_sel:DWORD dst_unused:UNUSED_PAD src0_sel:DWORD src1_sel:WORD_1
    ds_write_b32 v6, v84
    ds_write_b32 v7, v85
    ds_write_b32 v8, v86
    ds_write_b32 v9, v88
    v_lshlrev_b32_sdwa v6, 2, v87 dst_sel:DWORD dst_unused:UNUSED_PAD src0_sel:DWORD src1_sel:WORD_0
    v_lshlrev_b32_sdwa v7, 2, v87 dst_sel:DWORD dst_unused:UNUSED_PAD src0_sel:DWORD src1_sel:WORD_1
    v_lshlrev_b32_sdwa v8, 2, v91 dst_sel:DWORD dst_unused:UNUSED_PAD src0_sel:DWORD src1_sel:WORD_0
    v_lshlrev_b32_sdwa v9, 2, v91 dst_sel:DWORD dst_unused:UNUSED_PAD src0_sel:DWORD src1_sel:WORD_1
    ds_write_b32 v6, v89
    ds_write_b32 v7, v90
    ds_write_b32 v8, v92
    ds_write_b32 v9, v93
    s_mov_b64 exec, s[44:45]
    v_lshlrev_b32_sdwa v6, 2, v95 dst_sel:DWORD dst_unused:UNUSED_PAD src0_sel:DWORD src1_sel:WORD_0
    v_lshlrev_b32_sdwa v7, 2, v95 dst_sel:DWORD dst_unused:UNUSED_PAD src0_sel:DWORD src1_sel:WORD_1
    v_lshlrev_b32_sdwa v8, 2, v99 dst_sel:DWORD dst_unused:UNUSED_PAD src0_sel:DWORD src1_sel:WORD_0
    v_lshlrev_b32_sdwa v9, 2, v99 dst_sel:DWORD dst_unused:UNUSED_PAD src0_sel:DWORD src1_sel:WORD_1
    ds_write_b32 v6, v94
    ds_write_b32 v7, v96
    ds_write_b32 v8, v97
    ds_write_b32 v9, v98
    s_mov_b64 exec, -1
    s_add_u32 s35, s33, 45154304
    buffer_load_dwordx4 v[28:31], v1, s[12:15], s35 offen nt
    s_mul_i32 s35, s39, 9216
    v_mad_u32_u24 v6, v0, 12, s35
    s_waitcnt lgkmcnt(0)
    s_barrier
    s_cmp_lg_u32 s39, 15
    s_cbranch_scc1 L_p1_kernel_nox_12
    ds_read_b32 v12, v6 offset:9984
    ds_read_b32 v13, v6 offset:9988
    ds_read_b32 v14, v6 offset:9992
L_p1_kernel_nox_12:
    ds_read_b32 v48, v6 offset:1536
    ds_read_b32 v49, v6 offset:1540
    ds_read_b32 v50, v6 offset:1544
    ds_read_b32 v52, v6 offset:3072
    ds_read_b32 v53, v6 offset:3076
    ds_read_b32 v54, v6 offset:3080
    ds_read_b32 v56, v6 offset:4608
    ds_read_b32 v57, v6 offset:4612
    ds_read_b32 v58, v6 offset:4616
    ds_read_b32 v60, v6 offset:6144
    ds_read_b32 v61, v6 offset:6148
    ds_read_b32 v62, v6 offset:6152
    ds_read_b32 v64, v6 offset:7680
    ds_read_b32 v65, v6 offset:7684
    ds_read_b32 v66, v6 offset:7688
    ds_read_b32 v68, v6 offset:9216
    ds_read_b32 v69, v6 offset:9220
    ds_read_b32 v70, v6 offset:9224
    ds_read_b32 v72, v6 offset:0
    ds_read_b32 v73, v6 offset:4
    ds_read_b32 v74, v6 offset:8
    ds_read_b32 v76, v6 offset:768
    ds_read_b32 v77, v6 offset:772
    ds_read_b32 v78, v6 offset:776
    ds_read_b32 v80, v6 offset:2304
    ds_read_b32 v81, v6 offset:2308
    ds_read_b32 v82, v6 offset:2312
    ds_read_b32 v84, v6 offset:3840
    ds_read_b32 v85, v6 offset:3844
    ds_read_b32 v86, v6 offset:3848
    ds_read_b32 v88, v6 offset:5376
    ds_read_b32 v89, v6 offset:5380
    ds_read_b32 v90, v6 offset:5384
    ds_read_b32 v92, v6 offset:6912
    ds_read_b32 v93, v6 offset:6916
    ds_read_b32 v94, v6 offset:6920
    ds_read_b32 v96, v6 offset:8448
    ds_read_b32 v97, v6 offset:8452
    ds_read_b32 v98, v6 offset:8456
    s_add_u32 s35, s33, 49348608
    buffer_load_dwordx4 v[32:35], v1, s[8:11], s35 offen nt
    v_mov_b32 v8, 0
    v_mov_b32 v9, 0
    v_mov_b32 v10, 0
    v_mov_b32 v11, 0
    v_mov_b32 v15, 16384
    v_min_u32 v7, 16, v0
    v_lshlrev_b32 v7, 2, v7
    v_add_u32 v7, 160768, v7
    s_waitcnt lgkmcnt(0)
    s_barrier
    ds_write_b128 v1, v[8:11] offset:0
    ds_write_b32 v7, v8
    s_nop 1
    v_mov_b32 v6, 1140817920
    s_waitcnt vmcnt(14)
    v_pk_maximum3_f16 v5, v100, v101, v5
    v_mad_u32_u16 v6, v120, s50, v15 op_sel:[0,0,0,0]
    v_mad_u32_u16 v7, v120, s50, v15 op_sel:[1,0,0,0]
    v_mad_u32_u16 v8, v121, s50, v15 op_sel:[0,0,0,0]
    v_mad_u32_u16 v9, v121, s50, v15 op_sel:[1,0,0,0]
    v_add_u32_sdwa v6, v6, v120 dst_sel:DWORD dst_unused:UNUSED_PAD src0_sel:WORD_1 src1_sel:WORD_0
    v_add_u32_sdwa v7, v7, v120 dst_sel:DWORD dst_unused:UNUSED_PAD src0_sel:WORD_1 src1_sel:WORD_1
    v_add_u32_sdwa v8, v8, v121 dst_sel:DWORD dst_unused:UNUSED_PAD src0_sel:WORD_1 src1_sel:WORD_0
    v_add_u32_sdwa v9, v9, v121 dst_sel:DWORD dst_unused:UNUSED_PAD src0_sel:WORD_1 src1_sel:WORD_1
    v_add_u32 v6, v6, v6
    v_add_u32 v7, v7, v7
    v_add_u32 v8, v8, v8
    v_add_u32 v9, v9, v9
    ds_write_b16 v6, v100 offset:16384
    ds_write_b16_d16_hi v7, v100 offset:16384
    ds_write_b16 v8, v101 offset:16384
    ds_write_b16_d16_hi v9, v101 offset:16384
    v_mov_b32 v6, 1140817920
    s_waitcnt vmcnt(13)
    v_pk_maximum3_f16 v5, v102, v103, v5
    v_mad_u32_u16 v6, v122, s50, v15 op_sel:[0,0,0,0]
    v_mad_u32_u16 v7, v122, s50, v15 op_sel:[1,0,0,0]
    v_mad_u32_u16 v8, v123, s50, v15 op_sel:[0,0,0,0]
    v_mad_u32_u16 v9, v123, s50, v15 op_sel:[1,0,0,0]
    v_add_u32_sdwa v6, v6, v122 dst_sel:DWORD dst_unused:UNUSED_PAD src0_sel:WORD_1 src1_sel:WORD_0
    v_add_u32_sdwa v7, v7, v122 dst_sel:DWORD dst_unused:UNUSED_PAD src0_sel:WORD_1 src1_sel:WORD_1
    v_add_u32_sdwa v8, v8, v123 dst_sel:DWORD dst_unused:UNUSED_PAD src0_sel:WORD_1 src1_sel:WORD_0
    v_add_u32_sdwa v9, v9, v123 dst_sel:DWORD dst_unused:UNUSED_PAD src0_sel:WORD_1 src1_sel:WORD_1
    v_add_u32 v6, v6, v6
    v_add_u32 v7, v7, v7
    v_add_u32 v8, v8, v8
    v_add_u32 v9, v9, v9
    ds_write_b16 v6, v102 offset:16384
    ds_write_b16_d16_hi v7, v102 offset:16384
    ds_write_b16 v8, v103 offset:16384
    ds_write_b16_d16_hi v9, v103 offset:16384
    v_mov_b32 v6, 1140817920
    s_waitcnt vmcnt(12)
    v_pk_maximum3_f16 v5, v104, v105, v5
    v_mad_u32_u16 v6, v124, s50, v15 op_sel:[0,0,0,0]
    v_mad_u32_u16 v7, v124, s50, v15 op_sel:[1,0,0,0]
    v_mad_u32_u16 v8, v125, s50, v15 op_sel:[0,0,0,0]
    v_mad_u32_u16 v9, v125, s50, v15 op_sel:[1,0,0,0]
    v_add_u32_sdwa v6, v6, v124 dst_sel:DWORD dst_unused:UNUSED_PAD src0_sel:WORD_1 src1_sel:WORD_0
    v_add_u32_sdwa v7, v7, v124 dst_sel:DWORD dst_unused:UNUSED_PAD src0_sel:WORD_1 src1_sel:WORD_1
    v_add_u32_sdwa v8, v8, v125 dst_sel:DWORD dst_unused:UNUSED_PAD src0_sel:WORD_1 src1_sel:WORD_0
    v_add_u32_sdwa v9, v9, v125 dst_sel:DWORD dst_unused:UNUSED_PAD src0_sel:WORD_1 src1_sel:WORD_1
    v_add_u32 v6, v6, v6
    v_add_u32 v7, v7, v7
    v_add_u32 v8, v8, v8
    v_add_u32 v9, v9, v9
    ds_write_b16 v6, v104 offset:16384
    ds_write_b16_d16_hi v7, v104 offset:16384
    ds_write_b16 v8, v105 offset:16384
    ds_write_b16_d16_hi v9, v105 offset:16384
    s_add_u32 s35, s33, 49348608
    buffer_load_dwordx4 v[36:39], v1, s[12:15], s35 offen nt
    v_mov_b32 v6, 1140817920
    s_waitcnt vmcnt(12)
    v_pk_maximum3_f16 v5, v106, v107, v5
    v_mad_u32_u16 v6, v126, s50, v15 op_sel:[0,0,0,0]
    v_mad_u32_u16 v7, v126, s50, v15 op_sel:[1,0,0,0]
    v_mad_u32_u16 v8, v51, s50, v15 op_sel:[0,0,0,0]
    v_mad_u32_u16 v9, v51, s50, v15 op_sel:[1,0,0,0]
    v_add_u32_sdwa v6, v6, v126 dst_sel:DWORD dst_unused:UNUSED_PAD src0_sel:WORD_1 src1_sel:WORD_0
    v_add_u32_sdwa v7, v7, v126 dst_sel:DWORD dst_unused:UNUSED_PAD src0_sel:WORD_1 src1_sel:WORD_1
    v_add_u32_sdwa v8, v8, v51 dst_sel:DWORD dst_unused:UNUSED_PAD src0_sel:WORD_1 src1_sel:WORD_0
    v_add_u32_sdwa v9, v9, v51 dst_sel:DWORD dst_unused:UNUSED_PAD src0_sel:WORD_1 src1_sel:WORD_1
    v_add_u32 v6, v6, v6
    v_add_u32 v7, v7, v7
    v_add_u32 v8, v8, v8
    v_add_u32 v9, v9, v9
    ds_write_b16 v6, v106 offset:16384
    ds_write_b16_d16_hi v7, v106 offset:16384
    ds_write_b16 v8, v107 offset:16384
    ds_write_b16_d16_hi v9, v107 offset:16384
    v_mov_b32 v6, 1140817920
    s_waitcnt vmcnt(11)
    v_pk_maximum3_f16 v5, v108, v109, v5
    v_mad_u32_u16 v6, v55, s50, v15 op_sel:[0,0,0,0]
    v_mad_u32_u16 v7, v55, s50, v15 op_sel:[1,0,0,0]
    v_mad_u32_u16 v8, v59, s50, v15 op_sel:[0,0,0,0]
    v_mad_u32_u16 v9, v59, s50, v15 op_sel:[1,0,0,0]
    v_add_u32_sdwa v6, v6, v55 dst_sel:DWORD dst_unused:UNUSED_PAD src0_sel:WORD_1 src1_sel:WORD_0
    v_add_u32_sdwa v7, v7, v55 dst_sel:DWORD dst_unused:UNUSED_PAD src0_sel:WORD_1 src1_sel:WORD_1
    v_add_u32_sdwa v8, v8, v59 dst_sel:DWORD dst_unused:UNUSED_PAD src0_sel:WORD_1 src1_sel:WORD_0
    v_add_u32_sdwa v9, v9, v59 dst_sel:DWORD dst_unused:UNUSED_PAD src0_sel:WORD_1 src1_sel:WORD_1
    v_add_u32 v6, v6, v6
    v_add_u32 v7, v7, v7
    v_add_u32 v8, v8, v8
    v_add_u32 v9, v9, v9
    ds_write_b16 v6, v108 offset:16384
    ds_write_b16_d16_hi v7, v108 offset:16384
    ds_write_b16 v8, v109 offset:16384
    ds_write_b16_d16_hi v9, v109 offset:16384
    v_mov_b32 v6, 1140817920
    s_waitcnt vmcnt(10)
    v_pk_maximum3_f16 v5, v110, v111, v5
    v_mad_u32_u16 v6, v63, s50, v15 op_sel:[0,0,0,0]
    v_mad_u32_u16 v7, v63, s50, v15 op_sel:[1,0,0,0]
    v_mad_u32_u16 v8, v67, s50, v15 op_sel:[0,0,0,0]
    v_mad_u32_u16 v9, v67, s50, v15 op_sel:[1,0,0,0]
    v_add_u32_sdwa v6, v6, v63 dst_sel:DWORD dst_unused:UNUSED_PAD src0_sel:WORD_1 src1_sel:WORD_0
    v_add_u32_sdwa v7, v7, v63 dst_sel:DWORD dst_unused:UNUSED_PAD src0_sel:WORD_1 src1_sel:WORD_1
    v_add_u32_sdwa v8, v8, v67 dst_sel:DWORD dst_unused:UNUSED_PAD src0_sel:WORD_1 src1_sel:WORD_0
    v_add_u32_sdwa v9, v9, v67 dst_sel:DWORD dst_unused:UNUSED_PAD src0_sel:WORD_1 src1_sel:WORD_1
    v_add_u32 v6, v6, v6
    v_add_u32 v7, v7, v7
    v_add_u32 v8, v8, v8
    v_add_u32 v9, v9, v9
    ds_write_b16 v6, v110 offset:16384
    ds_write_b16_d16_hi v7, v110 offset:16384
    ds_write_b16 v8, v111 offset:16384
    ds_write_b16_d16_hi v9, v111 offset:16384
    s_add_u32 s35, s33, 53542912
    buffer_load_dwordx4 v[40:43], v1, s[8:11], s35 offen nt
    v_mov_b32 v6, 1140817920
    s_waitcnt vmcnt(10)
    v_pk_maximum3_f16 v5, v112, v113, v5
    v_mad_u32_u16 v6, v71, s50, v15 op_sel:[0,0,0,0]
    v_mad_u32_u16 v7, v71, s50, v15 op_sel:[1,0,0,0]
    v_mad_u32_u16 v8, v75, s50, v15 op_sel:[0,0,0,0]
    v_mad_u32_u16 v9, v75, s50, v15 op_sel:[1,0,0,0]
    v_add_u32_sdwa v6, v6, v71 dst_sel:DWORD dst_unused:UNUSED_PAD src0_sel:WORD_1 src1_sel:WORD_0
    v_add_u32_sdwa v7, v7, v71 dst_sel:DWORD dst_unused:UNUSED_PAD src0_sel:WORD_1 src1_sel:WORD_1
    v_add_u32_sdwa v8, v8, v75 dst_sel:DWORD dst_unused:UNUSED_PAD src0_sel:WORD_1 src1_sel:WORD_0
    v_add_u32_sdwa v9, v9, v75 dst_sel:DWORD dst_unused:UNUSED_PAD src0_sel:WORD_1 src1_sel:WORD_1
    v_add_u32 v6, v6, v6
    v_add_u32 v7, v7, v7
    v_add_u32 v8, v8, v8
    v_add_u32 v9, v9, v9
    ds_write_b16 v6, v112 offset:16384
    ds_write_b16_d16_hi v7, v112 offset:16384
    ds_write_b16 v8, v113 offset:16384
    ds_write_b16_d16_hi v9, v113 offset:16384
    v_mov_b32 v6, 1140817920
    s_waitcnt vmcnt(9)
    v_pk_maximum3_f16 v5, v114, v115, v5
    v_mad_u32_u16 v6, v79, s50, v15 op_sel:[0,0,0,0]
    v_mad_u32_u16 v7, v79, s50, v15 op_sel:[1,0,0,0]
    v_mad_u32_u16 v8, v83, s50, v15 op_sel:[0,0,0,0]
    v_mad_u32_u16 v9, v83, s50, v15 op_sel:[1,0,0,0]
    v_add_u32_sdwa v6, v6, v79 dst_sel:DWORD dst_unused:UNUSED_PAD src0_sel:WORD_1 src1_sel:WORD_0
    v_add_u32_sdwa v7, v7, v79 dst_sel:DWORD dst_unused:UNUSED_PAD src0_sel:WORD_1 src1_sel:WORD_1
    v_add_u32_sdwa v8, v8, v83 dst_sel:DWORD dst_unused:UNUSED_PAD src0_sel:WORD_1 src1_sel:WORD_0
    v_add_u32_sdwa v9, v9, v83 dst_sel:DWORD dst_unused:UNUSED_PAD src0_sel:WORD_1 src1_sel:WORD_1
    v_add_u32 v6, v6, v6
    v_add_u32 v7, v7, v7
    v_add_u32 v8, v8, v8
    v_add_u32 v9, v9, v9
    ds_write_b16 v6, v114 offset:16384
    ds_write_b16_d16_hi v7, v114 offset:16384
    ds_write_b16 v8, v115 offset:16384
    ds_write_b16_d16_hi v9, v115 offset:16384
    v_mov_b32 v6, 1140817920
    s_waitcnt vmcnt(8)
    v_pk_maximum3_f16 v5, v116, v117, v5
    v_mad_u32_u16 v6, v87, s50, v15 op_sel:[0,0,0,0]
    v_mad_u32_u16 v7, v87, s50, v15 op_sel:[1,0,0,0]
    v_mad_u32_u16 v8, v91, s50, v15 op_sel:[0,0,0,0]
    v_mad_u32_u16 v9, v91, s50, v15 op_sel:[1,0,0,0]
    v_add_u32_sdwa v6, v6, v87 dst_sel:DWORD dst_unused:UNUSED_PAD src0_sel:WORD_1 src1_sel:WORD_0
    v_add_u32_sdwa v7, v7, v87 dst_sel:DWORD dst_unused:UNUSED_PAD src0_sel:WORD_1 src1_sel:WORD_1
    v_add_u32_sdwa v8, v8, v91 dst_sel:DWORD dst_unused:UNUSED_PAD src0_sel:WORD_1 src1_sel:WORD_0
    v_add_u32_sdwa v9, v9, v91 dst_sel:DWORD dst_unused:UNUSED_PAD src0_sel:WORD_1 src1_sel:WORD_1
    v_add_u32 v6, v6, v6
    v_add_u32 v7, v7, v7
    v_add_u32 v8, v8, v8
    v_add_u32 v9, v9, v9
    ds_write_b16 v6, v116 offset:16384
    ds_write_b16_d16_hi v7, v116 offset:16384
    ds_write_b16 v8, v117 offset:16384
    ds_write_b16_d16_hi v9, v117 offset:16384
    s_add_u32 s35, s33, 53542912
    buffer_load_dwordx4 v[44:47], v1, s[12:15], s35 offen nt
    v_mov_b32 v6, 1140817920
    s_mov_b64 exec, s[44:45]
    s_waitcnt vmcnt(8)
    v_pk_maximum3_f16 v5, v118, v119, v5
    s_mov_b64 exec, -1
    s_mov_b64 exec, s[44:45]
    v_mad_u32_u16 v6, v95, s50, v15 op_sel:[0,0,0,0]
    v_mad_u32_u16 v7, v95, s50, v15 op_sel:[1,0,0,0]
    v_mad_u32_u16 v8, v99, s50, v15 op_sel:[0,0,0,0]
    v_mad_u32_u16 v9, v99, s50, v15 op_sel:[1,0,0,0]
    v_add_u32_sdwa v6, v6, v95 dst_sel:DWORD dst_unused:UNUSED_PAD src0_sel:WORD_1 src1_sel:WORD_0
    v_add_u32_sdwa v7, v7, v95 dst_sel:DWORD dst_unused:UNUSED_PAD src0_sel:WORD_1 src1_sel:WORD_1
    v_add_u32_sdwa v8, v8, v99 dst_sel:DWORD dst_unused:UNUSED_PAD src0_sel:WORD_1 src1_sel:WORD_0
    v_add_u32_sdwa v9, v9, v99 dst_sel:DWORD dst_unused:UNUSED_PAD src0_sel:WORD_1 src1_sel:WORD_1
    v_add_u32 v6, v6, v6
    v_add_u32 v7, v7, v7
    v_add_u32 v8, v8, v8
    v_add_u32 v9, v9, v9
    ds_write_b16 v6, v118 offset:16384
    ds_write_b16_d16_hi v7, v118 offset:16384
    ds_write_b16 v8, v119 offset:16384
    ds_write_b16_d16_hi v9, v119 offset:16384
    s_mov_b64 exec, -1
    s_mul_i32 s35, s39, 6144
    v_add_u32 v6, s35, v2
    v_mov_b32 v10, 1140817920
    s_waitcnt lgkmcnt(0)
    s_barrier
    ds_read_b64 v[120:121], v6 offset:23040
    ds_read_b64 v[122:123], v6 offset:16384
    ds_read_b64 v[124:125], v6 offset:16896
    ds_read_b64 v[126:127], v6 offset:17408
    ds_read_b64 v[100:101], v6 offset:17920
    ds_read_b64 v[102:103], v6 offset:18432
    ds_read_b64 v[104:105], v6 offset:18944
    ds_read_b64 v[106:107], v6 offset:19456
    ds_read_b64 v[108:109], v6 offset:19968
    ds_read_b64 v[110:111], v6 offset:20480
    ds_read_b64 v[112:113], v6 offset:20992
    ds_read_b64 v[114:115], v6 offset:21504
    ds_read_b64 v[116:117], v6 offset:22016
    ds_read_b64 v[118:119], v6 offset:22528
    s_add_u32 s32, s32, 256
    s_add_u32 s33, s33, 40960000
    s_add_u32 s34, s34, 20480000
    s_add_u32 s40, s40, 1
    s_cmp_lt_u32 s40, 4
    s_cbranch_scc1 L_p1_loop
    s_cmp_lg_u32 s39, 15
    s_cbranch_scc1 L_p1_kernel_nox_13
    s_waitcnt lgkmcnt(13)
    v_lshlrev_b32 v15, 16, v120
    v_and_b32 v120, 0xffff0000, v120
    v_lshlrev_b32 v121, 16, v121
    v_mul_f32 v15, s41, v15
    v_mul_f32 v120, s41, v120
    v_mul_f32 v121, s41, v121
    v_fract_f32 v15, v15
    v_fract_f32 v120, v120
    v_fract_f32 v121, v121
    v_cos_f32 v15, v15
    v_cos_f32 v120, v120
    v_cos_f32 v121, v121
    v_fmaak_f32 v15, v10, v15, 1262486016
    v_fmaak_f32 v120, v10, v120, 1262486016
    v_fmaak_f32 v121, v10, v121, 1262486016
    v_lshlrev_b32 v15, 22, v15
    v_alignbit_b32 v15, v120, v15, 10
    v_alignbit_b32 v15, v121, v15, 10
    v_xor_b32 v15, 0x80200800, v15
    s_mov_b32 s36, 13631488
    buffer_store_dwordx4 v[12:15], v3, s[20:23], s36 offen sc1
L_p1_kernel_nox_13:
    s_waitcnt lgkmcnt(12)
    v_lshlrev_b32 v75, 16, v122
    v_and_b32 v122, 0xffff0000, v122
    v_lshlrev_b32 v123, 16, v123
    v_mul_f32 v75, s41, v75
    v_mul_f32 v122, s41, v122
    v_mul_f32 v123, s41, v123
    v_fract_f32 v75, v75
    v_fract_f32 v122, v122
    v_fract_f32 v123, v123
    v_cos_f32 v75, v75
    v_cos_f32 v122, v122
    v_cos_f32 v123, v123
    v_fmaak_f32 v75, v10, v75, 1262486016
    v_fmaak_f32 v122, v10, v122, 1262486016
    v_fmaak_f32 v123, v10, v123, 1262486016
    v_lshlrev_b32 v75, 22, v75
    v_alignbit_b32 v75, v122, v75, 10
    v_alignbit_b32 v75, v123, v75, 10
    v_xor_b32 v75, 0x80200800, v75
    s_mov_b32 s36, 0
    buffer_store_dwordx4 v[72:75], v3, s[20:23], s36 offen sc1
    s_waitcnt lgkmcnt(11)
    v_lshlrev_b32 v79, 16, v124
    v_and_b32 v124, 0xffff0000, v124
    v_lshlrev_b32 v125, 16, v125
    v_mul_f32 v79, s41, v79
    v_mul_f32 v124, s41, v124
    v_mul_f32 v125, s41, v125
    v_fract_f32 v79, v79
    v_fract_f32 v124, v124
    v_fract_f32 v125, v125
    v_cos_f32 v79, v79
    v_cos_f32 v124, v124
    v_cos_f32 v125, v125
    v_fmaak_f32 v79, v10, v79, 1262486016
    v_fmaak_f32 v124, v10, v124, 1262486016
    v_fmaak_f32 v125, v10, v125, 1262486016
    v_lshlrev_b32 v79, 22, v79
    v_alignbit_b32 v79, v124, v79, 10
    v_alignbit_b32 v79, v125, v79, 10
    v_xor_b32 v79, 0x80200800, v79
    s_mov_b32 s36, 1048576
    buffer_store_dwordx4 v[76:79], v3, s[20:23], s36 offen sc1
    s_waitcnt lgkmcnt(0)
    v_lshlrev_b32 v51, 16, v126
    v_and_b32 v126, 0xffff0000, v126
    v_lshlrev_b32 v127, 16, v127
    v_mul_f32 v51, s41, v51
    v_mul_f32 v126, s41, v126
    v_mul_f32 v127, s41, v127
    v_fract_f32 v51, v51
    v_fract_f32 v126, v126
    v_fract_f32 v127, v127
    v_cos_f32 v51, v51
    v_cos_f32 v126, v126
    v_cos_f32 v127, v127
    v_fmaak_f32 v51, v10, v51, 1262486016
    v_fmaak_f32 v126, v10, v126, 1262486016
    v_fmaak_f32 v127, v10, v127, 1262486016
    v_lshlrev_b32 v51, 22, v51
    v_alignbit_b32 v51, v126, v51, 10
    v_alignbit_b32 v51, v127, v51, 10
    v_xor_b32 v51, 0x80200800, v51
    s_mov_b32 s36, 2097152
    buffer_store_dwordx4 v[48:51], v3, s[20:23], s36 offen sc1
    v_lshlrev_b32 v83, 16, v100
    v_and_b32 v100, 0xffff0000, v100
    v_lshlrev_b32 v101, 16, v101
    v_mul_f32 v83, s41, v83
    v_mul_f32 v100, s41, v100
    v_mul_f32 v101, s41, v101
    v_fract_f32 v83, v83
    v_fract_f32 v100, v100
    v_fract_f32 v101, v101
    v_cos_f32 v83, v83
    v_cos_f32 v100, v100
    v_cos_f32 v101, v101
    v_fmaak_f32 v83, v10, v83, 1262486016
    v_fmaak_f32 v100, v10, v100, 1262486016
    v_fmaak_f32 v101, v10, v101, 1262486016
    v_lshlrev_b32 v83, 22, v83
    v_alignbit_b32 v83, v100, v83, 10
    v_alignbit_b32 v83, v101, v83, 10
    v_xor_b32 v83, 0x80200800, v83
    s_mov_b32 s36, 3145728
    buffer_store_dwordx4 v[80:83], v3, s[20:23], s36 offen sc1
    v_lshlrev_b32 v55, 16, v102
    v_and_b32 v102, 0xffff0000, v102
    v_lshlrev_b32 v103, 16, v103
    v_mul_f32 v55, s41, v55
    v_mul_f32 v102, s41, v102
    v_mul_f32 v103, s41, v103
    v_fract_f32 v55, v55
    v_fract_f32 v102, v102
    v_fract_f32 v103, v103
    v_cos_f32 v55, v55
    v_cos_f32 v102, v102
    v_cos_f32 v103, v103
    v_fmaak_f32 v55, v10, v55, 1262486016
    v_fmaak_f32 v102, v10, v102, 1262486016
    v_fmaak_f32 v103, v10, v103, 1262486016
    v_lshlrev_b32 v55, 22, v55
    v_alignbit_b32 v55, v102, v55, 10
    v_alignbit_b32 v55, v103, v55, 10
    v_xor_b32 v55, 0x80200800, v55
    s_mov_b32 s36, 4194304
    buffer_store_dwordx4 v[52:55], v3, s[20:23], s36 offen sc1
    v_lshlrev_b32 v87, 16, v104
    v_and_b32 v104, 0xffff0000, v104
    v_lshlrev_b32 v105, 16, v105
    v_mul_f32 v87, s41, v87
    v_mul_f32 v104, s41, v104
    v_mul_f32 v105, s41, v105
    v_fract_f32 v87, v87
    v_fract_f32 v104, v104
    v_fract_f32 v105, v105
    v_cos_f32 v87, v87
    v_cos_f32 v104, v104
    v_cos_f32 v105, v105
    v_fmaak_f32 v87, v10, v87, 1262486016
    v_fmaak_f32 v104, v10, v104, 1262486016
    v_fmaak_f32 v105, v10, v105, 1262486016
    v_lshlrev_b32 v87, 22, v87
    v_alignbit_b32 v87, v104, v87, 10
    v_alignbit_b32 v87, v105, v87, 10
    v_xor_b32 v87, 0x80200800, v87
    s_mov_b32 s36, 5242880
    buffer_store_dwordx4 v[84:87], v3, s[20:23], s36 offen sc1
    v_lshlrev_b32 v59, 16, v106
    v_and_b32 v106, 0xffff0000, v106
    v_lshlrev_b32 v107, 16, v107
    v_mul_f32 v59, s41, v59
    v_mul_f32 v106, s41, v106
    v_mul_f32 v107, s41, v107
    v_fract_f32 v59, v59
    v_fract_f32 v106, v106
    v_fract_f32 v107, v107
    v_cos_f32 v59, v59
    v_cos_f32 v106, v106
    v_cos_f32 v107, v107
    v_fmaak_f32 v59, v10, v59, 1262486016
    v_fmaak_f32 v106, v10, v106, 1262486016
    v_fmaak_f32 v107, v10, v107, 1262486016
    v_lshlrev_b32 v59, 22, v59
    v_alignbit_b32 v59, v106, v59, 10
    v_alignbit_b32 v59, v107, v59, 10
    v_xor_b32 v59, 0x80200800, v59
    s_mov_b32 s36, 6291456
    buffer_store_dwordx4 v[56:59], v3, s[20:23], s36 offen sc1
    v_lshlrev_b32 v91, 16, v108
    v_and_b32 v108, 0xffff0000, v108
    v_lshlrev_b32 v109, 16, v109
    v_mul_f32 v91, s41, v91
    v_mul_f32 v108, s41, v108
    v_mul_f32 v109, s41, v109
    v_fract_f32 v91, v91
    v_fract_f32 v108, v108
    v_fract_f32 v109, v109
    v_cos_f32 v91, v91
    v_cos_f32 v108, v108
    v_cos_f32 v109, v109
    v_fmaak_f32 v91, v10, v91, 1262486016
    v_fmaak_f32 v108, v10, v108, 1262486016
    v_fmaak_f32 v109, v10, v109, 1262486016
    v_lshlrev_b32 v91, 22, v91
    v_alignbit_b32 v91, v108, v91, 10
    v_alignbit_b32 v91, v109, v91, 10
    v_xor_b32 v91, 0x80200800, v91
    s_mov_b32 s36, 7340032
    buffer_store_dwordx4 v[88:91], v3, s[20:23], s36 offen sc1
    v_lshlrev_b32 v63, 16, v110
    v_and_b32 v110, 0xffff0000, v110
    v_lshlrev_b32 v111, 16, v111
    v_mul_f32 v63, s41, v63
    v_mul_f32 v110, s41, v110
    v_mul_f32 v111, s41, v111
    v_fract_f32 v63, v63
    v_fract_f32 v110, v110
    v_fract_f32 v111, v111
    v_cos_f32 v63, v63
    v_cos_f32 v110, v110
    v_cos_f32 v111, v111
    v_fmaak_f32 v63, v10, v63, 1262486016
    v_fmaak_f32 v110, v10, v110, 1262486016
    v_fmaak_f32 v111, v10, v111, 1262486016
    v_lshlrev_b32 v63, 22, v63
    v_alignbit_b32 v63, v110, v63, 10
    v_alignbit_b32 v63, v111, v63, 10
    v_xor_b32 v63, 0x80200800, v63
    s_mov_b32 s36, 8388608
    buffer_store_dwordx4 v[60:63], v3, s[20:23], s36 offen sc1
    v_lshlrev_b32 v95, 16, v112
    v_and_b32 v112, 0xffff0000, v112
    v_lshlrev_b32 v113, 16, v113
    v_mul_f32 v95, s41, v95
    v_mul_f32 v112, s41, v112
    v_mul_f32 v113, s41, v113
    v_fract_f32 v95, v95
    v_fract_f32 v112, v112
    v_fract_f32 v113, v113
    v_cos_f32 v95, v95
    v_cos_f32 v112, v112
    v_cos_f32 v113, v113
    v_fmaak_f32 v95, v10, v95, 1262486016
    v_fmaak_f32 v112, v10, v112, 1262486016
    v_fmaak_f32 v113, v10, v113, 1262486016
    v_lshlrev_b32 v95, 22, v95
    v_alignbit_b32 v95, v112, v95, 10
    v_alignbit_b32 v95, v113, v95, 10
    v_xor_b32 v95, 0x80200800, v95
    s_mov_b32 s36, 9437184
    buffer_store_dwordx4 v[92:95], v3, s[20:23], s36 offen sc1
    v_lshlrev_b32 v67, 16, v114
    v_and_b32 v114, 0xffff0000, v114
    v_lshlrev_b32 v115, 16, v115
    v_mul_f32 v67, s41, v67
    v_mul_f32 v114, s41, v114
    v_mul_f32 v115, s41, v115
    v_fract_f32 v67, v67
    v_fract_f32 v114, v114
    v_fract_f32 v115, v115
    v_cos_f32 v67, v67
    v_cos_f32 v114, v114
    v_cos_f32 v115, v115
    v_fmaak_f32 v67, v10, v67, 1262486016
    v_fmaak_f32 v114, v10, v114, 1262486016
    v_fmaak_f32 v115, v10, v115, 1262486016
    v_lshlrev_b32 v67, 22, v67
    v_alignbit_b32 v67, v114, v67, 10
    v_alignbit_b32 v67, v115, v67, 10
    v_xor_b32 v67, 0x80200800, v67
    s_mov_b32 s36, 10485760
    buffer_store_dwordx4 v[64:67], v3, s[20:23], s36 offen sc1
    v_lshlrev_b32 v99, 16, v116
    v_and_b32 v116, 0xffff0000, v116
    v_lshlrev_b32 v117, 16, v117
    v_mul_f32 v99, s41, v99
    v_mul_f32 v116, s41, v116
    v_mul_f32 v117, s41, v117
    v_fract_f32 v99, v99
    v_fract_f32 v116, v116
    v_fract_f32 v117, v117
    v_cos_f32 v99, v99
    v_cos_f32 v116, v116
    v_cos_f32 v117, v117
    v_fmaak_f32 v99, v10, v99, 1262486016
    v_fmaak_f32 v116, v10, v116, 1262486016
    v_fmaak_f32 v117, v10, v117, 1262486016
    v_lshlrev_b32 v99, 22, v99
    v_alignbit_b32 v99, v116, v99, 10
    v_alignbit_b32 v99, v117, v99, 10
    v_xor_b32 v99, 0x80200800, v99
    s_mov_b32 s36, 11534336
    buffer_store_dwordx4 v[96:99], v3, s[20:23], s36 offen sc1
    v_lshlrev_b32 v71, 16, v118
    v_and_b32 v118, 0xffff0000, v118
    v_lshlrev_b32 v119, 16, v119
    v_mul_f32 v71, s41, v71
    v_mul_f32 v118, s41, v118
    v_mul_f32 v119, s41, v119
    v_fract_f32 v71, v71
    v_fract_f32 v118, v118
    v_fract_f32 v119, v119
    v_cos_f32 v71, v71
    v_cos_f32 v118, v118
    v_cos_f32 v119, v119
    v_fmaak_f32 v71, v10, v71, 1262486016
    v_fmaak_f32 v118, v10, v118, 1262486016
    v_fmaak_f32 v119, v10, v119, 1262486016
    v_lshlrev_b32 v71, 22, v71
    v_alignbit_b32 v71, v118, v71, 10
    v_alignbit_b32 v71, v119, v71, 10
    v_xor_b32 v71, 0x80200800, v71
    s_mov_b32 s36, 12582912
    buffer_store_dwordx4 v[68:71], v3, s[20:23], s36 offen sc1
    v_and_b32 v6, 0x7c007c00, v5
    v_add_u32 v6, 0x04000400, v6
    v_and_b32 v6, 0x80008000, v6
    v_cmp_ne_u32 vcc, 0, v6
    s_lshl_b32 s35, s39, 4
    s_add_u32 s35, s35, 160328
    v_mov_b32 v10, s35
    s_cmp_lg_u64 vcc, 0
    s_cselect_b32 s36, 1, s55
    v_mov_b32 v11, s36
    ds_write_b32 v10, v11
    s_waitcnt lgkmcnt(0)
    s_barrier
    s_cmp_lg_u32 s39, 0
    s_cbranch_scc1 L_p1_end
    v_and_b32 v6, 15, v0
    v_lshlrev_b32 v6, 4, v6
    v_add_u32 v6, 160320, v6
    ds_read_b128 v[8:11], v6
    s_waitcnt lgkmcnt(0)
    s_nop 1
    v_max_u32_dpp v8, v8, v8 row_shr:1 row_mask:0xf bank_mask:0xf bound_ctrl:0
    s_nop 1
    v_max_u32_dpp v8, v8, v8 row_shr:2 row_mask:0xf bank_mask:0xf bound_ctrl:0
    s_nop 1
    v_max_u32_dpp v8, v8, v8 row_shr:4 row_mask:0xf bank_mask:0xf bound_ctrl:0
    s_nop 1
    v_max_u32_dpp v8, v8, v8 row_shr:8 row_mask:0xf bank_mask:0xf bound_ctrl:0
    s_nop 1
    v_add_f32_dpp v9, v9, v9 row_shr:1 row_mask:0xf bank_mask:0xf bound_ctrl:0
    s_nop 1
    v_add_f32_dpp v9, v9, v9 row_shr:2 row_mask:0xf bank_mask:0xf bound_ctrl:0
    s_nop 1
    v_add_f32_dpp v9, v9, v9 row_shr:4 row_mask:0xf bank_mask:0xf bound_ctrl:0
    s_nop 1
    v_add_f32_dpp v9, v9, v9 row_shr:8 row_mask:0xf bank_mask:0xf bound_ctrl:0
    s_nop 1
    v_or_b32_dpp v10, v10, v10 row_shr:1 row_mask:0xf bank_mask:0xf bound_ctrl:0
    s_nop 1
    v_or_b32_dpp v10, v10, v10 row_shr:2 row_mask:0xf bank_mask:0xf bound_ctrl:0
    s_nop 1
    v_or_b32_dpp v10, v10, v10 row_shr:4 row_mask:0xf bank_mask:0xf bound_ctrl:0
    s_nop 1
    v_or_b32_dpp v10, v10, v10 row_shr:8 row_mask:0xf bank_mask:0xf bound_ctrl:0
    s_lshl_b32 s35, s2, 3
    s_mov_b32 s26, 8540160
    s_add_u32 s35, s35, 8519680
    v_mov_b32 v6, 0
    v_lshl_or_b32 v8, v10, 16, v8
    s_mov_b64 exec, 0x8000
    buffer_store_dwordx2 v[8:9], v6, s[24:27], s35 offen
    s_lshl_b32 s35, s2, 8
    s_add_u32 s35, s35, 8523776
    buffer_store_dword v6, v6, s[24:27], s35 offen
L_p1_end:
    s_endpgm
.globl p2_kernel
.p2align 8
.type p2_kernel,@function
p2_kernel:
    s_cmp_ge_u32 s2, 256
    s_cbranch_scc1 L_p2_end
    s_load_dwordx2 s[4:5], s[0:1], 104
    s_load_dwordx2 s[100:101], s[0:1], 24
    s_load_dwordx2 s[8:9], s[0:1], 0
    s_load_dwordx2 s[30:31], s[0:1], 40
    s_load_dwordx4 s[32:35], s[0:1], 56
    s_load_dwordx4 s[36:39], s[0:1], 72
    s_and_b32 s14, s2, 7
    s_lshr_b32 s49, s2, 3
    s_and_b32 s3, s14, 1
    s_lshl_b32 s3, s3, 5
    s_add_u32 s3, s3, s49
    s_lshr_b32 s12, s14, 1
    v_lshrrev_b32 v108, 6, v0
    v_lshlrev_b32 v1, 4, v0
    v_and_b32 v109, 63, v0
    v_readfirstlane_b32 s13, v108
    v_lshlrev_b32 v111, 4, v109
    v_lshrrev_b32 v110, 2, v109
    v_mul_u32_u24 v110, 8256, v110
    v_add_u32 v110, v110, v111
    s_mul_i32 s14, s12, 65
    s_add_u32 s14, s14, s3
    s_lshl_b32 s14, s14, 5
    s_mul_i32 s15, s13, 532480
    s_add_u32 s14, s14, s15
    s_add_u32 s25, s14, 0
    s_mul_i32 s22, s12, 1280000
    s_mov_b32 s2, 0
    s_waitcnt lgkmcnt(0)
    s_mov_b32 s6, 655360000
    s_mov_b32 s7, 0x00020000
    s_add_u32 s10, s22, 1280000
    s_mov_b32 s11, 0x00020000
    s_add_u32 s15, s25, 0
    buffer_load_dwordx4 v[28:31], v110, s[4:7], s15 offen
    s_add_u32 s15, s25, 133120
    buffer_load_dwordx4 v[32:35], v110, s[4:7], s15 offen
    s_add_u32 s15, s25, 266240
    buffer_load_dwordx4 v[36:39], v110, s[4:7], s15 offen
    s_add_u32 s15, s25, 399360
    buffer_load_dwordx4 v[40:43], v110, s[4:7], s15 offen
    s_load_dwordx4 s[40:43], s[30:31], 0
    s_load_dwordx16 s[52:67], s[32:33], 0
    s_load_dwordx16 s[68:83], s[34:35], 0
    s_load_dwordx8 s[84:91], s[36:37], 0
    s_load_dwordx8 s[92:99], s[38:39], 0
    v_mov_b32 v52, 0x100
    s_cmp_lg_u32 s13, 0
    s_cbranch_scc1 L_p2_noann
    s_lshl_b32 s14, s3, 8
    s_add_u32 s14, s14, 8523776
    s_mov_b64 exec, 1
    buffer_atomic_add v52, off, s[4:7], s14
    s_mov_b64 exec, -1
L_p2_noann:
    s_add_u32 s14, s22, 0
    buffer_load_dwordx4 v[88:91], v1, s[8:11], s14 offen
    s_add_u32 s14, s22, 16384
    buffer_load_dwordx4 v[92:95], v1, s[8:11], s14 offen
    s_add_u32 s14, s22, 32768
    buffer_load_dwordx4 v[96:99], v1, s[8:11], s14 offen
    s_add_u32 s14, s22, 49152
    buffer_load_dwordx4 v[100:103], v1, s[8:11], s14 offen
    s_add_u32 s14, s22, 65536
    buffer_load_dwordx4 v[104:107], v1, s[8:11], s14 offen
    s_mov_b32 s15, 8519680
    buffer_load_dwordx4 v[80:83], v111, s[4:7], s15 offen offset:0
    buffer_load_dwordx4 v[84:87], v111, s[4:7], s15 offen offset:1024
    v_lshlrev_b32 v2, 10, v109
    v_mov_b32 v50, 21845
    v_add_u32 v3, 80000, v1
    v_add_u32 v124, 145536, v1
    v_add_u32 v113, 65536, v1
    v_mov_b32 v112, 0x7f000000
    v_cmp_gt_u32 vcc, 904, v0
    s_mul_i32 s19, s13, 240
    s_add_u32 s19, s19, 160000
    v_cndmask_b32 v124, v112, v124, vcc
    v_cndmask_b32 v113, v112, v113, vcc
    v_lshl_add_u32 v6, v109, 2, s19
    v_lshl_add_u32 v126, v109, 1, s19
    v_cmp_gt_u32 vcc, 10, v109
    s_lshl_b32 s27, s13, 16
    s_mov_b32 s23, 1024
    v_cndmask_b32 v6, v112, v6, vcc
    s_add_u32 s44, s4, 4194304
    s_addc_u32 s45, s5, 1048576
    s_mov_b32 s46, 14024704
    s_mov_b32 s47, 0x00020000
    s_mov_b32 s18, 80000
    s_and_b32 s50, s3, 1
    s_lshl_b32 s50, s50, 18
    s_sub_u32 s18, s18, s50
    s_sub_u32 s50, 4294836224, s50
    v_lshlrev_b32 v116, 3, v0
    v_and_b32 v116, 16, v116
    v_and_b32 v117, 1, v0
    v_lshl_or_b32 v116, v117, 5, v116
    v_mov_b32 v58, 0x3f80
    v_mov_b32 v59, 0
    v_lshlrev_b64 v[58:59], v116, v[58:59]
    v_mov_b32 v4, 0
    v_mov_b32 v5, 0
    v_mov_b32 v114, 0xff00
    v_bfe_u32 v127, v0, 0, 1
    v_mul_u32_u24 v127, 40, v127
    v_add_u32 v127, s19, v127
    ds_write2_b32 v6, v5, v5 offset0:34 offset1:44
    ds_write_b16 v126, v114 offset:2
    v_mov_b32 v44, 1073758208
    v_mov_b32 v45, 1073758208
    v_mov_b32 v46, 1073758208
    v_mov_b32 v47, 1073758208
    v_mov_b32 v48, 1073758208
    v_mov_b32 v49, 1073758208
    ds_write_b128 v113, v[44:47]
    v_lshrrev_b32 v115, 4, v109
    v_mul_u32_u24 v115, 15360, v115
    v_lshl_add_u32 v115, v109, 6, v115
    v_lshl_add_u32 v115, v108, 10, v115
    s_waitcnt lgkmcnt(0)
    v_mov_b32 v53, s40
    v_mov_b32 v54, s41
    v_mov_b32 v56, s42
    v_mov_b32 v57, s43
    s_mov_b32 s40, 20987904
    s_mov_b32 s41, 21031594
    s_pack_ll_b32_b16 s14, s52, s54
    s_pack_hh_b32_b16 s15, s52, s54
    s_pack_ll_b32_b16 s54, s53, s55
    s_pack_hh_b32_b16 s55, s53, s55
    s_mov_b32 s52, s14
    s_mov_b32 s53, s15
    s_pack_ll_b32_b16 s14, s56, s58
    s_pack_hh_b32_b16 s15, s56, s58
    s_pack_ll_b32_b16 s58, s57, s59
    s_pack_hh_b32_b16 s59, s57, s59
    s_mov_b32 s56, s14
    s_mov_b32 s57, s15
    s_pack_ll_b32_b16 s14, s60, s62
    s_pack_hh_b32_b16 s15, s60, s62
    s_pack_ll_b32_b16 s62, s61, s63
    s_pack_hh_b32_b16 s63, s61, s63
    s_mov_b32 s60, s14
    s_mov_b32 s61, s15
    s_pack_ll_b32_b16 s14, s64, s66
    s_pack_hh_b32_b16 s15, s64, s66
    s_pack_ll_b32_b16 s66, s65, s67
    s_pack_hh_b32_b16 s67, s65, s67
    s_mov_b32 s64, s14
    s_mov_b32 s65, s15
    s_pack_ll_b32_b16 s14, s68, s70
    s_pack_hh_b32_b16 s15, s68, s70
    s_pack_ll_b32_b16 s70, s69, s71
    s_pack_hh_b32_b16 s71, s69, s71
    s_mov_b32 s68, s14
    s_mov_b32 s69, s15
    s_pack_ll_b32_b16 s14, s72, s74
    s_pack_hh_b32_b16 s15, s72, s74
    s_pack_ll_b32_b16 s74, s73, s75
    s_pack_hh_b32_b16 s75, s73, s75
    s_mov_b32 s72, s14
    s_mov_b32 s73, s15
    s_pack_ll_b32_b16 s14, s76, s78
    s_pack_hh_b32_b16 s15, s76, s78
    s_pack_ll_b32_b16 s78, s77, s79
    s_pack_hh_b32_b16 s79, s77, s79
    s_mov_b32 s76, s14
    s_mov_b32 s77, s15
    s_pack_ll_b32_b16 s14, s80, s82
    s_pack_hh_b32_b16 s15, s80, s82
    s_pack_ll_b32_b16 s82, s81, s83
    s_pack_hh_b32_b16 s83, s81, s83
    s_mov_b32 s80, s14
    s_mov_b32 s81, s15
    s_waitcnt vmcnt(10)
    ds_write_b128 v1, v[28:31] offset:0
    s_waitcnt vmcnt(9)
    ds_write_b128 v1, v[32:35] offset:16384
    s_waitcnt vmcnt(8)
    ds_write_b128 v1, v[36:39] offset:32768
    s_waitcnt vmcnt(7)
    ds_write_b128 v1, v[40:43] offset:49152
    ds_read_b128 v[28:31], v115 offset:0
    ds_read_b128 v[36:39], v115 offset:32
    ds_read_b128 v[32:35], v115 offset:16
    ds_read_b128 v[40:43], v115 offset:48
    ds_write_b128 v1, v[44:47] offset:0
    ds_write_b128 v1, v[44:47] offset:16384
    ds_write_b128 v1, v[44:47] offset:32768
    ds_write_b128 v1, v[44:47] offset:49152
    s_waitcnt lgkmcnt(6)
    v_mad_u32_u16 v108, v28, v50, s40 op_sel:[0,0,0,0]
    v_mad_u32_u16 v109, v36, v50, s41 op_sel:[0,0,0,0]
    v_sub_u32_sdwa v110, v109, v108 dst_sel:DWORD dst_unused:UNUSED_PAD src0_sel:WORD_1 src1_sel:WORD_1
    s_nop 1
    v_add_u32_dpp v110, v110, v110 row_shr:1 row_mask:0xf bank_mask:0xf bound_ctrl:0
    s_nop 1
    v_add_u32_dpp v110, v110, v110 row_shr:2 row_mask:0xf bank_mask:0xf bound_ctrl:0
    s_nop 1
    v_add_u32_dpp v110, v110, v110 row_shr:4 row_mask:0xf bank_mask:0xf bound_ctrl:0
    s_nop 1
    v_add_u32_dpp v110, v110, v110 row_shr:8 row_mask:0xf bank_mask:0xf bound_ctrl:0
    s_nop 1
    v_add_u32_dpp v110, v110, v110 row_bcast:15 row_mask:0xa bank_mask:0xf
    s_nop 1
    v_add_u32_dpp v110, v110, v110 row_bcast:31 row_mask:0xc bank_mask:0xf
    v_sub_u32_sdwa v109, v109, v110 dst_sel:DWORD dst_unused:UNUSED_PAD src0_sel:WORD_1 src1_sel:DWORD
    v_readlane_b32 s29, v110, 63
    v_add_u32 v110, -1, v110
    ds_write_b16 v126, v109
    v_lshlrev_b32_e64 v111, v110, 1
    v_lshrrev_b32 v110, 5, v110
    s_cmp_gt_u32 s29, 320
    s_cselect_b32 s2, 1, s2
    v_lshl_add_u32 v110, v110, 2, v127
    s_cselect_b64 exec, 0, -1
    ds_or_b32 v110, v111 offset:136
    s_mov_b64 exec, -1
    ds_wrxchg2_rtn_b32 v[108:109], v6, v5, v5 offset0:34 offset1:44
    s_waitcnt lgkmcnt(0)
    v_or_b32 v7, v108, v109
    s_nop 0
    v_readlane_b32 s30, v7, 0
    v_readlane_b32 s31, v7, 1
    v_readlane_b32 s32, v7, 2
    v_readlane_b32 s33, v7, 3
    v_readlane_b32 s34, v7, 4
    v_readlane_b32 s35, v7, 5
    v_readlane_b32 s36, v7, 6
    v_readlane_b32 s37, v7, 7
    s_mov_b32 s25, s19
    s_mov_b32 s26, s27
    s_mov_b32 s51, s28
    s_mov_b32 s28, s29
    v_mbcnt_lo_u32_b32 v8, s30, 0
    v_mbcnt_hi_u32_b32 v8, s31, v8
    s_bcnt1_i32_b64 s14, s[30:31]
    v_lshl_add_u32 v9, v8, 1, s25
    ds_read_u16 v9, v9
    s_add_u32 s30, s26, 0
    s_lshl1_add_u32 s25, s14, s25
    s_lshl_b32 s14, s14, 10
    s_add_u32 s26, s26, s14
    v_mbcnt_lo_u32_b32 v12, s32, 0
    v_mbcnt_hi_u32_b32 v12, s33, v12
    s_bcnt1_i32_b64 s14, s[32:33]
    v_lshl_add_u32 v13, v12, 1, s25
    ds_read_u16 v13, v13
    s_add_u32 s32, s26, 1048576
    s_lshl1_add_u32 s25, s14, s25
    s_lshl_b32 s14, s14, 10
    s_add_u32 s26, s26, s14
    v_mbcnt_lo_u32_b32 v16, s34, 0
    v_mbcnt_hi_u32_b32 v16, s35, v16
    s_bcnt1_i32_b64 s14, s[34:35]
    v_lshl_add_u32 v17, v16, 1, s25
    ds_read_u16 v17, v17
    s_add_u32 s34, s26, 2097152
    s_lshl1_add_u32 s25, s14, s25
    s_lshl_b32 s14, s14, 10
    s_add_u32 s26, s26, s14
    v_mbcnt_lo_u32_b32 v20, s36, 0
    v_mbcnt_hi_u32_b32 v20, s37, v20
    s_bcnt1_i32_b64 s14, s[36:37]
    v_lshl_add_u32 v21, v20, 1, s25
    ds_read_u16 v21, v21
    s_add_u32 s36, s26, 3145728
    s_lshl1_add_u32 s25, s14, s25
    s_lshl_b32 s14, s14, 10
    s_add_u32 s26, s26, s14
    s_waitcnt lgkmcnt(3)
    v_mad_u32_u16 v9, v9, s23, v2
    v_pk_lshrrev_b16 v9, 10, v9 op_sel_hi:[1,1]
    v_lshl_add_u32 v8, v8, 6, v9
    buffer_load_dwordx4 v[8:11], v8, s[44:47], s30 idxen
    s_waitcnt lgkmcnt(2)
    v_mad_u32_u16 v13, v13, s23, v2
    v_pk_lshrrev_b16 v13, 10, v13 op_sel_hi:[1,1]
    v_lshl_add_u32 v12, v12, 6, v13
    buffer_load_dwordx4 v[12:15], v12, s[44:47], s32 idxen
    s_waitcnt lgkmcnt(1)
    v_mad_u32_u16 v17, v17, s23, v2
    v_pk_lshrrev_b16 v17, 10, v17 op_sel_hi:[1,1]
    v_lshl_add_u32 v16, v16, 6, v17
    buffer_load_dwordx4 v[16:19], v16, s[44:47], s34 idxen
    s_waitcnt lgkmcnt(0)
    v_mad_u32_u16 v21, v21, s23, v2
    v_pk_lshrrev_b16 v21, 10, v21 op_sel_hi:[1,1]
    v_lshl_add_u32 v20, v20, 6, v21
    buffer_load_dwordx4 v[20:23], v20, s[44:47], s36 idxen
    s_cmp_le_u32 s28, 256
    s_cbranch_scc1 L_p2_kernel_noopt_1
    v_readlane_b32 s38, v7, 8
    v_readlane_b32 s39, v7, 9
    s_nop 1
    v_mbcnt_lo_u32_b32 v51, s38, 0
    v_mbcnt_hi_u32_b32 v51, s39, v51
    s_bcnt1_i32_b64 s14, s[38:39]
    v_lshl_add_u32 v55, v51, 1, s25
    ds_read_u16 v55, v55
    s_add_u32 s38, s26, 4194304
    s_lshl1_add_u32 s25, s14, s25
    s_lshl_b32 s14, s14, 10
    s_add_u32 s26, s26, s14
    s_waitcnt lgkmcnt(0)
    v_mad_u32_u16 v55, v55, s23, v2
    v_pk_lshrrev_b16 v55, 10, v55 op_sel_hi:[1,1]
    v_lshl_add_u32 v51, v51, 6, v55
    buffer_load_dwordx4 v[24:27], v51, s[44:47], s38 idxen
L_p2_kernel_noopt_1:
    s_waitcnt vmcnt(6)
    ds_write_b128 v3, v[88:91] offset:0
    ds_write_b128 v3, v[92:95] offset:16384
    ds_write_b128 v3, v[96:99] offset:32768
    ds_write_b128 v3, v[100:103] offset:49152
    ds_write_b128 v124, v[104:107] offset:0
    s_waitcnt vmcnt(4)
    v_max3_u32 v64, v80, v82, v84
    v_add_f32 v65, v81, v83
    v_add_f32 v66, v85, v87
    v_max_u32 v64, v64, v86
    v_add_f32 v65, v65, v66
    v_cmp_lt_u32 vcc, 0xffff, v64
    s_nop 1
    v_max_u32_dpp v64, v64, v64 row_shr:1 row_mask:0xf bank_mask:0xf bound_ctrl:0
    s_nop 1
    v_max_u32_dpp v64, v64, v64 row_shr:2 row_mask:0xf bank_mask:0xf bound_ctrl:0
    s_nop 1
    v_max_u32_dpp v64, v64, v64 row_shr:4 row_mask:0xf bank_mask:0xf bound_ctrl:0
    s_nop 1
    v_max_u32_dpp v64, v64, v64 row_shr:8 row_mask:0xf bank_mask:0xf bound_ctrl:0
    s_nop 1
    v_max_u32_dpp v64, v64, v64 row_bcast:15 row_mask:0xa bank_mask:0xf
    s_nop 1
    v_max_u32_dpp v64, v64, v64 row_bcast:31 row_mask:0xc bank_mask:0xf
    s_nop 1
    v_add_f32_dpp v65, v65, v65 row_shr:1 row_mask:0xf bank_mask:0xf bound_ctrl:0
    s_nop 1
    v_add_f32_dpp v65, v65, v65 row_shr:2 row_mask:0xf bank_mask:0xf bound_ctrl:0
    s_nop 1
    v_add_f32_dpp v65, v65, v65 row_shr:4 row_mask:0xf bank_mask:0xf bound_ctrl:0
    s_nop 1
    v_add_f32_dpp v65, v65, v65 row_shr:8 row_mask:0xf bank_mask:0xf bound_ctrl:0
    s_nop 1
    v_add_f32_dpp v65, v65, v65 row_bcast:15 row_mask:0xa bank_mask:0xf
    s_nop 1
    v_add_f32_dpp v65, v65, v65 row_bcast:31 row_mask:0xc bank_mask:0xf
    s_cmp_lg_u64 vcc, 0
    s_cselect_b32 s2, 1, s2
    v_lshlrev_b32 v64, 16, v64
    v_mul_f32 v66, 936490775, v65
    v_mul_f32 v65, 928531664, v65
    v_cmp_nle_f32 vcc, v64, v66
    v_max_u32 v64, v64, v65
    s_nop 0
    v_readlane_b32 s14, v64, 63
    s_bitcmp1_b32 vcc_hi, 31
    s_cselect_b32 s2, 1, s2
    s_lshr_b32 s14, s14, 23
    s_add_u32 s14, s14, 1
    s_cmp_lt_u32 s14, 40
    s_cselect_b32 s2, 1, s2
    s_cmp_gt_u32 s14, 230
    s_cselect_b32 s2, 1, s2
    s_sub_u32 s48, s14, 14
    s_lshl_b32 s48, s48, 23
    s_add_u32 s16, s48, 272629760
    s_lshr_b32 s15, s16, 16
    s_sub_u32 s15, 0x10000, s15
    s_add_u32 s20, s16, s15
    s_sub_u32 s17, s20, 1
    s_mov_b32 s21, s17
    s_or_b32 s48, s48, 16416
    s_sub_u32 s14, s14, 40
    s_cmp_gt_u32 s14, 190
    s_cselect_b32 s48, 0, s48
    s_waitcnt lgkmcnt(0)
    s_barrier
    s_add_u32 s14, s22, 80000
    buffer_load_dwordx4 v[88:91], v1, s[8:11], s14 offen
    s_add_u32 s14, s22, 96384
    buffer_load_dwordx4 v[92:95], v1, s[8:11], s14 offen
    v_mad_u32_u16 v108, v28, v50, s40 op_sel:[1,0,0,0]
    v_mad_u32_u16 v109, v36, v50, s41 op_sel:[1,0,0,0]
    v_sub_u32_sdwa v110, v109, v108 dst_sel:DWORD dst_unused:UNUSED_PAD src0_sel:WORD_1 src1_sel:WORD_1
    s_nop 1
    v_add_u32_dpp v110, v110, v110 row_shr:1 row_mask:0xf bank_mask:0xf bound_ctrl:0
    s_nop 1
    v_add_u32_dpp v110, v110, v110 row_shr:2 row_mask:0xf bank_mask:0xf bound_ctrl:0
    s_nop 1
    v_add_u32_dpp v110, v110, v110 row_shr:4 row_mask:0xf bank_mask:0xf bound_ctrl:0
    s_nop 1
    v_add_u32_dpp v110, v110, v110 row_shr:8 row_mask:0xf bank_mask:0xf bound_ctrl:0
    s_nop 1
    v_add_u32_dpp v110, v110, v110 row_bcast:15 row_mask:0xa bank_mask:0xf
    s_nop 1
    v_add_u32_dpp v110, v110, v110 row_bcast:31 row_mask:0xc bank_mask:0xf
    v_sub_u32_sdwa v109, v109, v110 dst_sel:DWORD dst_unused:UNUSED_PAD src0_sel:WORD_1 src1_sel:DWORD
    v_readlane_b32 s29, v110, 63
    v_add_u32 v110, -1, v110
    ds_write_b16 v126, v109
    v_lshlrev_b32_e64 v111, v110, 1
    v_lshrrev_b32 v110, 5, v110
    s_cmp_gt_u32 s29, 320
    s_cselect_b32 s2, 1, s2
    v_lshl_add_u32 v110, v110, 2, v127
    s_cselect_b64 exec, 0, -1
    ds_or_b32 v110, v111 offset:136
    s_mov_b64 exec, -1
    ds_wrxchg2_rtn_b32 v[108:109], v6, v5, v5 offset0:34 offset1:44
    s_mov_b32 s24, 0
L_p2_loop:
    s_add_u32 s22, s22, 80000
    s_lshl_b32 s14, s13, 4
    s_or_b32 s14, s14, s24
    s_cmp_lg_u32 s14, 5
    s_cbranch_scc1 L_p2_nost
    v_mov_b32 v52, 0
    s_lshl_b32 s14, s3, 8
    s_add_u32 s14, s14, 8523776
    s_mov_b64 exec, 1
    buffer_atomic_add v52, off, s[4:7], s14 sc0
    s_mov_b64 exec, -1
L_p2_nost:
    s_waitcnt vmcnt(5)
    v_mad_u32_u16 v64, v8, 8, s18
    v_mad_u32_u16 v66, v9, 8, s18
    v_mad_u32_u16 v68, v10, 8, s18
    ds_read_b64 v[64:65], v64
    ds_read_b64 v[66:67], v66
    ds_read_b64 v[68:69], v68
    s_add_u32 s14, s22, 32768
    buffer_load_dwordx4 v[96:99], v1, s[8:11], s14 offen
    s_waitcnt vmcnt(5)
    v_mad_u32_u16 v70, v12, 8, s18
    v_mad_u32_u16 v72, v13, 8, s18
    v_mad_u32_u16 v74, v14, 8, s18
    ds_read_b64 v[70:71], v70
    ds_read_b64 v[72:73], v72
    ds_read_b64 v[74:75], v74
    s_add_u32 s14, s22, 49152
    buffer_load_dwordx4 v[100:103], v1, s[8:11], s14 offen
    s_waitcnt lgkmcnt(6)
    v_or_b32 v7, v108, v109
    s_nop 0
    v_readlane_b32 s30, v7, 0
    v_readlane_b32 s31, v7, 1
    v_readlane_b32 s32, v7, 2
    v_readlane_b32 s33, v7, 3
    v_readlane_b32 s34, v7, 4
    v_readlane_b32 s35, v7, 5
    v_readlane_b32 s36, v7, 6
    v_readlane_b32 s37, v7, 7
    s_mov_b32 s25, s19
    s_mov_b32 s26, s27
    s_mov_b32 s51, s28
    s_mov_b32 s28, s29
    v_mbcnt_lo_u32_b32 v51, s30, 0
    v_mbcnt_hi_u32_b32 v51, s31, v51
    s_bcnt1_i32_b64 s14, s[30:31]
    v_lshl_add_u32 v55, v51, 1, s25
    ds_read_u16 v55, v55
    s_add_u32 s30, s26, 0
    s_lshl1_add_u32 s25, s14, s25
    s_lshl_b32 s14, s14, 10
    s_add_u32 s26, s26, s14
    v_bfe_i32 v108, v11, 2, 10
    v_bfe_i32 v109, v11, 12, 10
    v_ashrrev_i32 v110, 22, v11
    v_cvt_f32_i32 v108, v108
    v_cvt_f32_i32 v109, v109
    v_cvt_f32_i32 v110, v110
    s_waitcnt lgkmcnt(4)
    v_mfma_f32_4x4x4_16b_bf16 v[112:115], v[58:59], v[64:65], 0
    v_mfma_f32_4x4x4_16b_bf16 v[116:119], v[58:59], v[66:67], 0
    v_mfma_f32_4x4x4_16b_bf16 v[120:123], v[58:59], v[68:69], 0
    v_mad_u32_u16 v8, v8, 8, s50 op_sel:[1,0,0,0]
    v_mad_u32_u16 v9, v9, 8, s50 op_sel:[1,0,0,0]
    v_mad_u32_u16 v10, v10, 8, s50 op_sel:[1,0,0,0]
    v_pk_fma_f32 v[114:115], v[114:115], v[108:109], s[20:21] op_sel:[0,0,0] op_sel_hi:[1,0,1]
    v_pk_fma_f32 v[112:113], v[112:113], v[108:109], s[16:17] op_sel:[0,0,0] op_sel_hi:[1,0,1]
    v_pk_fma_f32 v[118:119], v[118:119], v[108:109], s[20:21] op_sel:[0,1,0] op_sel_hi:[1,1,1]
    v_pk_fma_f32 v[116:117], v[116:117], v[108:109], s[16:17] op_sel:[0,1,0] op_sel_hi:[1,1,1]
    v_pk_fma_f32 v[122:123], v[122:123], v[110:111], s[20:21] op_sel:[0,0,0] op_sel_hi:[1,0,1]
    v_pk_fma_f32 v[120:121], v[120:121], v[110:111], s[16:17] op_sel:[0,0,0] op_sel_hi:[1,0,1]
    v_lshlrev_b64 v[114:115], 16, v[114:115]
    v_lshlrev_b64 v[118:119], 16, v[118:119]
    v_lshlrev_b64 v[122:123], 16, v[122:123]
    v_lshl_add_u64 v[64:65], v[112:113], 0, v[114:115]
    v_lshl_add_u64 v[66:67], v[116:117], 0, v[118:119]
    v_lshl_add_u64 v[68:69], v[120:121], 0, v[122:123]
    v_or3_b32 v4, v44, v45, v4
    v_or3_b32 v4, v46, v47, v4
    v_or3_b32 v4, v48, v49, v4
    ds_add_rtn_u64 v[44:45], v8, v[64:65]
    ds_add_rtn_u64 v[46:47], v9, v[66:67]
    ds_add_rtn_u64 v[48:49], v10, v[68:69]
    s_waitcnt lgkmcnt(3)
    v_mad_u32_u16 v55, v55, s23, v2
    v_pk_lshrrev_b16 v55, 10, v55 op_sel_hi:[1,1]
    v_lshl_add_u32 v51, v51, 6, v55
    buffer_load_dwordx4 v[8:11], v51, s[44:47], s30 idxen
    s_add_u32 s14, s22, 65536
    buffer_load_dwordx4 v[104:107], v1, s[8:11], s14 offen
    s_waitcnt vmcnt(7)
    v_mad_u32_u16 v76, v16, 8, s18
    v_mad_u32_u16 v78, v17, 8, s18
    v_mad_u32_u16 v80, v18, 8, s18
    ds_read_b64 v[76:77], v76
    ds_read_b64 v[78:79], v78
    ds_read_b64 v[80:81], v80
    s_waitcnt vmcnt(6)
    v_mad_u32_u16 v82, v20, 8, s18
    v_mad_u32_u16 v84, v21, 8, s18
    v_mad_u32_u16 v86, v22, 8, s18
    ds_read_b64 v[82:83], v82
    ds_read_b64 v[84:85], v84
    ds_read_b64 v[86:87], v86
    s_cmp_le_u32 s51, 256
    s_cbranch_scc1 L_p2_kernel_noopt3_2
    v_mad_u32_u16 v64, v24, 8, s18
    v_mad_u32_u16 v66, v25, 8, s18
    v_mad_u32_u16 v68, v26, 8, s18
    ds_read_b64 v[64:65], v64
    ds_read_b64 v[66:67], v66
    ds_read_b64 v[68:69], v68
L_p2_kernel_noopt3_2:
    v_mbcnt_lo_u32_b32 v51, s32, 0
    v_mbcnt_hi_u32_b32 v51, s33, v51
    s_bcnt1_i32_b64 s14, s[32:33]
    v_lshl_add_u32 v55, v51, 1, s25
    ds_read_u16 v55, v55
    s_add_u32 s32, s26, 1048576
    s_lshl1_add_u32 s25, s14, s25
    s_lshl_b32 s14, s14, 10
    s_add_u32 s26, s26, s14
    v_bfe_i32 v108, v15, 2, 10
    v_bfe_i32 v109, v15, 12, 10
    v_ashrrev_i32 v110, 22, v15
    v_cvt_f32_i32 v108, v108
    v_cvt_f32_i32 v109, v109
    v_cvt_f32_i32 v110, v110
    v_mfma_f32_4x4x4_16b_bf16 v[112:115], v[58:59], v[70:71], 0
    v_mfma_f32_4x4x4_16b_bf16 v[116:119], v[58:59], v[72:73], 0
    v_mfma_f32_4x4x4_16b_bf16 v[120:123], v[58:59], v[74:75], 0
    v_mad_u32_u16 v12, v12, 8, s50 op_sel:[1,0,0,0]
    v_mad_u32_u16 v13, v13, 8, s50 op_sel:[1,0,0,0]
    v_mad_u32_u16 v14, v14, 8, s50 op_sel:[1,0,0,0]
    v_pk_fma_f32 v[114:115], v[114:115], v[108:109], s[20:21] op_sel:[0,0,0] op_sel_hi:[1,0,1]
    v_pk_fma_f32 v[112:113], v[112:113], v[108:109], s[16:17] op_sel:[0,0,0] op_sel_hi:[1,0,1]
    v_pk_fma_f32 v[118:119], v[118:119], v[108:109], s[20:21] op_sel:[0,1,0] op_sel_hi:[1,1,1]
    v_pk_fma_f32 v[116:117], v[116:117], v[108:109], s[16:17] op_sel:[0,1,0] op_sel_hi:[1,1,1]
    v_pk_fma_f32 v[122:123], v[122:123], v[110:111], s[20:21] op_sel:[0,0,0] op_sel_hi:[1,0,1]
    v_pk_fma_f32 v[120:121], v[120:121], v[110:111], s[16:17] op_sel:[0,0,0] op_sel_hi:[1,0,1]
    v_lshlrev_b64 v[114:115], 16, v[114:115]
    v_lshlrev_b64 v[118:119], 16, v[118:119]
    v_lshlrev_b64 v[122:123], 16, v[122:123]
    v_lshl_add_u64 v[70:71], v[112:113], 0, v[114:115]
    v_lshl_add_u64 v[72:73], v[116:117], 0, v[118:119]
    v_lshl_add_u64 v[74:75], v[120:121], 0, v[122:123]
    s_waitcnt lgkmcnt(7)
    v_or3_b32 v4, v44, v45, v4
    v_or3_b32 v4, v46, v47, v4
    v_or3_b32 v4, v48, v49, v4
    ds_add_rtn_u64 v[44:45], v12, v[70:71]
    ds_add_rtn_u64 v[46:47], v13, v[72:73]
    ds_add_rtn_u64 v[48:49], v14, v[74:75]
    s_waitcnt lgkmcnt(3)
    v_mad_u32_u16 v55, v55, s23, v2
    v_pk_lshrrev_b16 v55, 10, v55 op_sel_hi:[1,1]
    v_lshl_add_u32 v51, v51, 6, v55
    buffer_load_dwordx4 v[12:15], v51, s[44:47], s32 idxen
    s_barrier
    s_waitcnt vmcnt(1)
    ds_write_b128 v3, v[88:91] offset:0
    ds_write_b128 v3, v[92:95] offset:16384
    ds_write_b128 v3, v[96:99] offset:32768
    ds_write_b128 v3, v[100:103] offset:49152
    ds_write_b128 v124, v[104:107] offset:0
    v_mbcnt_lo_u32_b32 v51, s34, 0
    v_mbcnt_hi_u32_b32 v51, s35, v51
    s_bcnt1_i32_b64 s14, s[34:35]
    v_lshl_add_u32 v55, v51, 1, s25
    ds_read_u16 v55, v55
    s_add_u32 s34, s26, 2097152
    s_lshl1_add_u32 s25, s14, s25
    s_lshl_b32 s14, s14, 10
    s_add_u32 s26, s26, s14
    v_bfe_i32 v108, v19, 2, 10
    v_bfe_i32 v109, v19, 12, 10
    v_ashrrev_i32 v110, 22, v19
    v_cvt_f32_i32 v108, v108
    v_cvt_f32_i32 v109, v109
    v_cvt_f32_i32 v110, v110
    v_mfma_f32_4x4x4_16b_bf16 v[112:115], v[58:59], v[76:77], 0
    v_mfma_f32_4x4x4_16b_bf16 v[116:119], v[58:59], v[78:79], 0
    v_mfma_f32_4x4x4_16b_bf16 v[120:123], v[58:59], v[80:81], 0
    v_mad_u32_u16 v16, v16, 8, s50 op_sel:[1,0,0,0]
    v_mad_u32_u16 v17, v17, 8, s50 op_sel:[1,0,0,0]
    v_mad_u32_u16 v18, v18, 8, s50 op_sel:[1,0,0,0]
    v_pk_fma_f32 v[114:115], v[114:115], v[108:109], s[20:21] op_sel:[0,0,0] op_sel_hi:[1,0,1]
    v_pk_fma_f32 v[112:113], v[112:113], v[108:109], s[16:17] op_sel:[0,0,0] op_sel_hi:[1,0,1]
    v_pk_fma_f32 v[118:119], v[118:119], v[108:109], s[20:21] op_sel:[0,1,0] op_sel_hi:[1,1,1]
    v_pk_fma_f32 v[116:117], v[116:117], v[108:109], s[16:17] op_sel:[0,1,0] op_sel_hi:[1,1,1]
    v_pk_fma_f32 v[122:123], v[122:123], v[110:111], s[20:21] op_sel:[0,0,0] op_sel_hi:[1,0,1]
    v_pk_fma_f32 v[120:121], v[120:121], v[110:111], s[16:17] op_sel:[0,0,0] op_sel_hi:[1,0,1]
    v_lshlrev_b64 v[114:115], 16, v[114:115]
    v_lshlrev_b64 v[118:119], 16, v[118:119]
    v_lshlrev_b64 v[122:123], 16, v[122:123]
    v_lshl_add_u64 v[76:77], v[112:113], 0, v[114:115]
    v_lshl_add_u64 v[78:79], v[116:117], 0, v[118:119]
    v_lshl_add_u64 v[80:81], v[120:121], 0, v[122:123]
    s_waitcnt lgkmcnt(6)
    v_or3_b32 v4, v44, v45, v4
    v_or3_b32 v4, v46, v47, v4
    v_or3_b32 v4, v48, v49, v4
    ds_add_rtn_u64 v[44:45], v16, v[76:77]
    ds_add_rtn_u64 v[46:47], v17, v[78:79]
    ds_add_rtn_u64 v[48:49], v18, v[80:81]
    s_waitcnt lgkmcnt(3)
    v_mad_u32_u16 v55, v55, s23, v2
    v_pk_lshrrev_b16 v55, 10, v55 op_sel_hi:[1,1]
    v_lshl_add_u32 v51, v51, 6, v55
    buffer_load_dwordx4 v[16:19], v51, s[44:47], s34 idxen
    s_cmp_le_u32 s51, 256
    s_cbranch_scc1 L_p2_kernel_noopt3_3
    v_bfe_i32 v108, v27, 2, 10
    v_bfe_i32 v109, v27, 12, 10
    v_ashrrev_i32 v110, 22, v27
    v_cvt_f32_i32 v108, v108
    v_cvt_f32_i32 v109, v109
    v_cvt_f32_i32 v110, v110
    v_mfma_f32_4x4x4_16b_bf16 v[112:115], v[58:59], v[64:65], 0
    v_mfma_f32_4x4x4_16b_bf16 v[116:119], v[58:59], v[66:67], 0
    v_mfma_f32_4x4x4_16b_bf16 v[120:123], v[58:59], v[68:69], 0
    v_mad_u32_u16 v24, v24, 8, s50 op_sel:[1,0,0,0]
    v_mad_u32_u16 v25, v25, 8, s50 op_sel:[1,0,0,0]
    v_mad_u32_u16 v26, v26, 8, s50 op_sel:[1,0,0,0]
    v_pk_fma_f32 v[114:115], v[114:115], v[108:109], s[20:21] op_sel:[0,0,0] op_sel_hi:[1,0,1]
    v_pk_fma_f32 v[112:113], v[112:113], v[108:109], s[16:17] op_sel:[0,0,0] op_sel_hi:[1,0,1]
    v_pk_fma_f32 v[118:119], v[118:119], v[108:109], s[20:21] op_sel:[0,1,0] op_sel_hi:[1,1,1]
    v_pk_fma_f32 v[116:117], v[116:117], v[108:109], s[16:17] op_sel:[0,1,0] op_sel_hi:[1,1,1]
    v_pk_fma_f32 v[122:123], v[122:123], v[110:111], s[20:21] op_sel:[0,0,0] op_sel_hi:[1,0,1]
    v_pk_fma_f32 v[120:121], v[120:121], v[110:111], s[16:17] op_sel:[0,0,0] op_sel_hi:[1,0,1]
    v_lshlrev_b64 v[114:115], 16, v[114:115]
    v_lshlrev_b64 v[118:119], 16, v[118:119]
    v_lshlrev_b64 v[122:123], 16, v[122:123]
    v_lshl_add_u64 v[64:65], v[112:113], 0, v[114:115]
    v_lshl_add_u64 v[66:67], v[116:117], 0, v[118:119]
    v_lshl_add_u64 v[68:69], v[120:121], 0, v[122:123]
    s_waitcnt lgkmcnt(0)
    v_or3_b32 v4, v44, v45, v4
    v_or3_b32 v4, v46, v47, v4
    v_or3_b32 v4, v48, v49, v4
    ds_add_rtn_u64 v[44:45], v24, v[64:65]
    ds_add_rtn_u64 v[46:47], v25, v[66:67]
    ds_add_rtn_u64 v[48:49], v26, v[68:69]
L_p2_kernel_noopt3_3:
    v_mbcnt_lo_u32_b32 v51, s36, 0
    v_mbcnt_hi_u32_b32 v51, s37, v51
    s_bcnt1_i32_b64 s14, s[36:37]
    v_lshl_add_u32 v55, v51, 1, s25
    ds_read_u16 v55, v55
    s_add_u32 s36, s26, 3145728
    s_lshl1_add_u32 s25, s14, s25
    s_lshl_b32 s14, s14, 10
    s_add_u32 s26, s26, s14
    s_cmp_le_u32 s28, 256
    s_cbranch_scc1 L_p2_kernel_noopt3_4
    v_readlane_b32 s38, v7, 8
    v_readlane_b32 s39, v7, 9
    s_nop 1
    v_mbcnt_lo_u32_b32 v62, s38, 0
    v_mbcnt_hi_u32_b32 v62, s39, v62
    s_bcnt1_i32_b64 s14, s[38:39]
    v_lshl_add_u32 v63, v62, 1, s25
    ds_read_u16 v63, v63
    s_add_u32 s38, s26, 4194304
    s_lshl1_add_u32 s25, s14, s25
    s_lshl_b32 s14, s14, 10
    s_add_u32 s26, s26, s14
L_p2_kernel_noopt3_4:
    v_bfe_i32 v108, v23, 2, 10
    v_bfe_i32 v109, v23, 12, 10
    v_ashrrev_i32 v110, 22, v23
    v_cvt_f32_i32 v108, v108
    v_cvt_f32_i32 v109, v109
    v_cvt_f32_i32 v110, v110
    v_mfma_f32_4x4x4_16b_bf16 v[112:115], v[58:59], v[82:83], 0
    v_mfma_f32_4x4x4_16b_bf16 v[116:119], v[58:59], v[84:85], 0
    v_mfma_f32_4x4x4_16b_bf16 v[120:123], v[58:59], v[86:87], 0
    v_mad_u32_u16 v20, v20, 8, s50 op_sel:[1,0,0,0]
    v_mad_u32_u16 v21, v21, 8, s50 op_sel:[1,0,0,0]
    v_mad_u32_u16 v22, v22, 8, s50 op_sel:[1,0,0,0]
    v_pk_fma_f32 v[114:115], v[114:115], v[108:109], s[20:21] op_sel:[0,0,0] op_sel_hi:[1,0,1]
    v_pk_fma_f32 v[112:113], v[112:113], v[108:109], s[16:17] op_sel:[0,0,0] op_sel_hi:[1,0,1]
    v_pk_fma_f32 v[118:119], v[118:119], v[108:109], s[20:21] op_sel:[0,1,0] op_sel_hi:[1,1,1]
    v_pk_fma_f32 v[116:117], v[116:117], v[108:109], s[16:17] op_sel:[0,1,0] op_sel_hi:[1,1,1]
    v_pk_fma_f32 v[122:123], v[122:123], v[110:111], s[20:21] op_sel:[0,0,0] op_sel_hi:[1,0,1]
    v_pk_fma_f32 v[120:121], v[120:121], v[110:111], s[16:17] op_sel:[0,0,0] op_sel_hi:[1,0,1]
    v_lshlrev_b64 v[114:115], 16, v[114:115]
    v_lshlrev_b64 v[118:119], 16, v[118:119]
    v_lshlrev_b64 v[122:123], 16, v[122:123]
    v_lshl_add_u64 v[82:83], v[112:113], 0, v[114:115]
    v_lshl_add_u64 v[84:85], v[116:117], 0, v[118:119]
    v_lshl_add_u64 v[86:87], v[120:121], 0, v[122:123]
    s_waitcnt lgkmcnt(1)
    v_or3_b32 v4, v44, v45, v4
    v_or3_b32 v4, v46, v47, v4
    v_or3_b32 v4, v48, v49, v4
    ds_add_rtn_u64 v[44:45], v20, v[82:83]
    ds_add_rtn_u64 v[46:47], v21, v[84:85]
    ds_add_rtn_u64 v[48:49], v22, v[86:87]
    s_waitcnt lgkmcnt(3)
    v_mad_u32_u16 v55, v55, s23, v2
    v_pk_lshrrev_b16 v55, 10, v55 op_sel_hi:[1,1]
    v_lshl_add_u32 v51, v51, 6, v55
    buffer_load_dwordx4 v[20:23], v51, s[44:47], s36 idxen
    s_cmp_le_u32 s28, 256
    s_cbranch_scc1 L_p2_kernel_noopt3_5
    v_mad_u32_u16 v63, v63, s23, v2
    v_pk_lshrrev_b16 v63, 10, v63 op_sel_hi:[1,1]
    v_lshl_add_u32 v62, v62, 6, v63
    buffer_load_dwordx4 v[24:27], v62, s[44:47], s38 idxen
L_p2_kernel_noopt3_5:
    s_add_u32 s14, s22, 80000
    buffer_load_dwordx4 v[88:91], v1, s[8:11], s14 offen
    v_pk_mov_b32 v[28:29], v[28:29], v[30:31] op_sel:[1,0]
    v_pk_mov_b32 v[30:31], v[30:31], v[32:33] op_sel:[1,0]
    v_pk_mov_b32 v[32:33], v[32:33], v[34:35] op_sel:[1,0]
    v_pk_mov_b32 v[34:35], v[34:35], v[4:5] op_sel:[1,1]
    v_pk_mov_b32 v[36:37], v[36:37], v[38:39] op_sel:[1,0]
    v_pk_mov_b32 v[38:39], v[38:39], v[40:41] op_sel:[1,0]
    v_pk_mov_b32 v[40:41], v[40:41], v[42:43] op_sel:[1,0]
    v_pk_mov_b32 v[42:43], v[42:43], v[4:5] op_sel:[1,1]
    v_mad_u32_u16 v108, v28, v50, s40 op_sel:[0,0,0,0]
    v_mad_u32_u16 v109, v36, v50, s41 op_sel:[0,0,0,0]
    v_sub_u32_sdwa v110, v109, v108 dst_sel:DWORD dst_unused:UNUSED_PAD src0_sel:WORD_1 src1_sel:WORD_1
    s_nop 1
    v_add_u32_dpp v110, v110, v110 row_shr:1 row_mask:0xf bank_mask:0xf bound_ctrl:0
    s_nop 1
    v_add_u32_dpp v110, v110, v110 row_shr:2 row_mask:0xf bank_mask:0xf bound_ctrl:0
    s_nop 1
    v_add_u32_dpp v110, v110, v110 row_shr:4 row_mask:0xf bank_mask:0xf bound_ctrl:0
    s_nop 1
    v_add_u32_dpp v110, v110, v110 row_shr:8 row_mask:0xf bank_mask:0xf bound_ctrl:0
    s_nop 1
    v_add_u32_dpp v110, v110, v110 row_bcast:15 row_mask:0xa bank_mask:0xf
    s_nop 1
    v_add_u32_dpp v110, v110, v110 row_bcast:31 row_mask:0xc bank_mask:0xf
    v_sub_u32_sdwa v109, v109, v110 dst_sel:DWORD dst_unused:UNUSED_PAD src0_sel:WORD_1 src1_sel:DWORD
    v_readlane_b32 s29, v110, 63
    v_add_u32 v110, -1, v110
    ds_write_b16 v126, v109
    v_lshlrev_b32_e64 v111, v110, 1
    v_lshrrev_b32 v110, 5, v110
    s_cmp_gt_u32 s29, 320
    s_cselect_b32 s2, 1, s2
    v_lshl_add_u32 v110, v110, 2, v127
    s_cselect_b64 exec, 0, -1
    ds_or_b32 v110, v111 offset:136
    s_mov_b64 exec, -1
    ds_wrxchg2_rtn_b32 v[108:109], v6, v5, v5 offset0:34 offset1:44
    s_add_u32 s14, s22, 96384
    buffer_load_dwordx4 v[92:95], v1, s[8:11], s14 offen
    s_barrier
    s_add_u32 s22, s22, 80000
    s_cmp_lg_u32 s24, 7
    s_cbranch_scc1 L_p2_nodist
    s_mov_b32 s46, 0
    s_lshl2_add_u32 s14, s3, s12
    s_mul_i32 s14, s14, 5000
    s_add_u32 s15, s14, 4096
    v_min_u32 v61, 225, v0
    v_lshl_add_u32 v60, v0, 2, s14
    v_lshl_add_u32 v61, v61, 2, s15
    global_load_dword v60, v60, s[100:101] nt
    global_load_dword v61, v61, s[100:101] nt
L_p2_nodist:
    v_mad_u32_u16 v64, v8, 8, s18
    v_mad_u32_u16 v66, v9, 8, s18
    v_mad_u32_u16 v68, v10, 8, s18
    ds_read_b64 v[64:65], v64
    ds_read_b64 v[66:67], v66
    ds_read_b64 v[68:69], v68
    s_add_u32 s14, s22, 32768
    buffer_load_dwordx4 v[96:99], v1, s[8:11], s14 offen
    s_waitcnt vmcnt(5)
    v_mad_u32_u16 v70, v12, 8, s18
    v_mad_u32_u16 v72, v13, 8, s18
    v_mad_u32_u16 v74, v14, 8, s18
    ds_read_b64 v[70:71], v70
    ds_read_b64 v[72:73], v72
    ds_read_b64 v[74:75], v74
    s_add_u32 s14, s22, 49152
    buffer_load_dwordx4 v[100:103], v1, s[8:11], s14 offen
    s_waitcnt lgkmcnt(6)
    v_or_b32 v7, v108, v109
    s_nop 0
    v_readlane_b32 s30, v7, 0
    v_readlane_b32 s31, v7, 1
    v_readlane_b32 s32, v7, 2
    v_readlane_b32 s33, v7, 3
    v_readlane_b32 s34, v7, 4
    v_readlane_b32 s35, v7, 5
    v_readlane_b32 s36, v7, 6
    v_readlane_b32 s37, v7, 7
    s_mov_b32 s25, s19
    s_mov_b32 s26, s27
    s_mov_b32 s51, s28
    s_mov_b32 s28, s29
    v_mbcnt_lo_u32_b32 v51, s30, 0
    v_mbcnt_hi_u32_b32 v51, s31, v51
    s_bcnt1_i32_b64 s14, s[30:31]
    v_lshl_add_u32 v55, v51, 1, s25
    ds_read_u16 v55, v55
    s_add_u32 s30, s26, 0
    s_lshl1_add_u32 s25, s14, s25
    s_lshl_b32 s14, s14, 10
    s_add_u32 s26, s26, s14
    v_bfe_i32 v108, v11, 2, 10
    v_bfe_i32 v109, v11, 12, 10
    v_ashrrev_i32 v110, 22, v11
    v_cvt_f32_i32 v108, v108
    v_cvt_f32_i32 v109, v109
    v_cvt_f32_i32 v110, v110
    s_waitcnt lgkmcnt(4)
    v_mfma_f32_4x4x4_16b_bf16 v[112:115], v[58:59], v[64:65], 0
    v_mfma_f32_4x4x4_16b_bf16 v[116:119], v[58:59], v[66:67], 0
    v_mfma_f32_4x4x4_16b_bf16 v[120:123], v[58:59], v[68:69], 0
    v_mad_u32_u16 v8, v8, 8, s50 op_sel:[1,0,0,0]
    v_mad_u32_u16 v9, v9, 8, s50 op_sel:[1,0,0,0]
    v_mad_u32_u16 v10, v10, 8, s50 op_sel:[1,0,0,0]
    v_pk_fma_f32 v[114:115], v[114:115], v[108:109], s[20:21] op_sel:[0,0,0] op_sel_hi:[1,0,1]
    v_pk_fma_f32 v[112:113], v[112:113], v[108:109], s[16:17] op_sel:[0,0,0] op_sel_hi:[1,0,1]
    v_pk_fma_f32 v[118:119], v[118:119], v[108:109], s[20:21] op_sel:[0,1,0] op_sel_hi:[1,1,1]
    v_pk_fma_f32 v[116:117], v[116:117], v[108:109], s[16:17] op_sel:[0,1,0] op_sel_hi:[1,1,1]
    v_pk_fma_f32 v[122:123], v[122:123], v[110:111], s[20:21] op_sel:[0,0,0] op_sel_hi:[1,0,1]
    v_pk_fma_f32 v[120:121], v[120:121], v[110:111], s[16:17] op_sel:[0,0,0] op_sel_hi:[1,0,1]
    v_lshlrev_b64 v[114:115], 16, v[114:115]
    v_lshlrev_b64 v[118:119], 16, v[118:119]
    v_lshlrev_b64 v[122:123], 16, v[122:123]
    v_lshl_add_u64 v[64:65], v[112:113], 0, v[114:115]
    v_lshl_add_u64 v[66:67], v[116:117], 0, v[118:119]
    v_lshl_add_u64 v[68:69], v[120:121], 0, v[122:123]
    v_or3_b32 v4, v44, v45, v4
    v_or3_b32 v4, v46, v47, v4
    v_or3_b32 v4, v48, v49, v4
    ds_add_rtn_u64 v[44:45], v8, v[64:65]
    ds_add_rtn_u64 v[46:47], v9, v[66:67]
    ds_add_rtn_u64 v[48:49], v10, v[68:69]
    s_waitcnt lgkmcnt(3)
    v_mad_u32_u16 v55, v55, s23, v2
    v_pk_lshrrev_b16 v55, 10, v55 op_sel_hi:[1,1]
    v_lshl_add_u32 v51, v51, 6, v55
    buffer_load_dwordx4 v[8:11], v51, s[44:47], s30 idxen
    s_add_u32 s14, s22, 65536
    buffer_load_dwordx4 v[104:107], v1, s[8:11], s14 offen
    s_waitcnt vmcnt(7)
    v_mad_u32_u16 v76, v16, 8, s18
    v_mad_u32_u16 v78, v17, 8, s18
    v_mad_u32_u16 v80, v18, 8, s18
    ds_read_b64 v[76:77], v76
    ds_read_b64 v[78:79], v78
    ds_read_b64 v[80:81], v80
    s_waitcnt vmcnt(6)
    v_mad_u32_u16 v82, v20, 8, s18
    v_mad_u32_u16 v84, v21, 8, s18
    v_mad_u32_u16 v86, v22, 8, s18
    ds_read_b64 v[82:83], v82
    ds_read_b64 v[84:85], v84
    ds_read_b64 v[86:87], v86
    s_cmp_le_u32 s51, 256
    s_cbranch_scc1 L_p2_kernel_noopt3_6
    v_mad_u32_u16 v64, v24, 8, s18
    v_mad_u32_u16 v66, v25, 8, s18
    v_mad_u32_u16 v68, v26, 8, s18
    ds_read_b64 v[64:65], v64
    ds_read_b64 v[66:67], v66
    ds_read_b64 v[68:69], v68
L_p2_kernel_noopt3_6:
    v_mbcnt_lo_u32_b32 v51, s32, 0
    v_mbcnt_hi_u32_b32 v51, s33, v51
    s_bcnt1_i32_b64 s14, s[32:33]
    v_lshl_add_u32 v55, v51, 1, s25
    ds_read_u16 v55, v55
    s_add_u32 s32, s26, 1048576
    s_lshl1_add_u32 s25, s14, s25
    s_lshl_b32 s14, s14, 10
    s_add_u32 s26, s26, s14
    v_bfe_i32 v108, v15, 2, 10
    v_bfe_i32 v109, v15, 12, 10
    v_ashrrev_i32 v110, 22, v15
    v_cvt_f32_i32 v108, v108
    v_cvt_f32_i32 v109, v109
    v_cvt_f32_i32 v110, v110
    v_mfma_f32_4x4x4_16b_bf16 v[112:115], v[58:59], v[70:71], 0
    v_mfma_f32_4x4x4_16b_bf16 v[116:119], v[58:59], v[72:73], 0
    v_mfma_f32_4x4x4_16b_bf16 v[120:123], v[58:59], v[74:75], 0
    v_mad_u32_u16 v12, v12, 8, s50 op_sel:[1,0,0,0]
    v_mad_u32_u16 v13, v13, 8, s50 op_sel:[1,0,0,0]
    v_mad_u32_u16 v14, v14, 8, s50 op_sel:[1,0,0,0]
    v_pk_fma_f32 v[114:115], v[114:115], v[108:109], s[20:21] op_sel:[0,0,0] op_sel_hi:[1,0,1]
    v_pk_fma_f32 v[112:113], v[112:113], v[108:109], s[16:17] op_sel:[0,0,0] op_sel_hi:[1,0,1]
    v_pk_fma_f32 v[118:119], v[118:119], v[108:109], s[20:21] op_sel:[0,1,0] op_sel_hi:[1,1,1]
    v_pk_fma_f32 v[116:117], v[116:117], v[108:109], s[16:17] op_sel:[0,1,0] op_sel_hi:[1,1,1]
    v_pk_fma_f32 v[122:123], v[122:123], v[110:111], s[20:21] op_sel:[0,0,0] op_sel_hi:[1,0,1]
    v_pk_fma_f32 v[120:121], v[120:121], v[110:111], s[16:17] op_sel:[0,0,0] op_sel_hi:[1,0,1]
    v_lshlrev_b64 v[114:115], 16, v[114:115]
    v_lshlrev_b64 v[118:119], 16, v[118:119]
    v_lshlrev_b64 v[122:123], 16, v[122:123]
    v_lshl_add_u64 v[70:71], v[112:113], 0, v[114:115]
    v_lshl_add_u64 v[72:73], v[116:117], 0, v[118:119]
    v_lshl_add_u64 v[74:75], v[120:121], 0, v[122:123]
    s_waitcnt lgkmcnt(7)
    v_or3_b32 v4, v44, v45, v4
    v_or3_b32 v4, v46, v47, v4
    v_or3_b32 v4, v48, v49, v4
    ds_add_rtn_u64 v[44:45], v12, v[70:71]
    ds_add_rtn_u64 v[46:47], v13, v[72:73]
    ds_add_rtn_u64 v[48:49], v14, v[74:75]
    s_waitcnt lgkmcnt(3)
    v_mad_u32_u16 v55, v55, s23, v2
    v_pk_lshrrev_b16 v55, 10, v55 op_sel_hi:[1,1]
    v_lshl_add_u32 v51, v51, 6, v55
    buffer_load_dwordx4 v[12:15], v51, s[44:47], s32 idxen
    s_barrier
    s_waitcnt vmcnt(1)
    ds_write_b128 v3, v[88:91] offset:0
    ds_write_b128 v3, v[92:95] offset:16384
    ds_write_b128 v3, v[96:99] offset:32768
    ds_write_b128 v3, v[100:103] offset:49152
    ds_write_b128 v124, v[104:107] offset:0
    v_mbcnt_lo_u32_b32 v51, s34, 0
    v_mbcnt_hi_u32_b32 v51, s35, v51
    s_bcnt1_i32_b64 s14, s[34:35]
    v_lshl_add_u32 v55, v51, 1, s25
    ds_read_u16 v55, v55
    s_add_u32 s34, s26, 2097152
    s_lshl1_add_u32 s25, s14, s25
    s_lshl_b32 s14, s14, 10
    s_add_u32 s26, s26, s14
    v_bfe_i32 v108, v19, 2, 10
    v_bfe_i32 v109, v19, 12, 10
    v_ashrrev_i32 v110, 22, v19
    v_cvt_f32_i32 v108, v108
    v_cvt_f32_i32 v109, v109
    v_cvt_f32_i32 v110, v110
    v_mfma_f32_4x4x4_16b_bf16 v[112:115], v[58:59], v[76:77], 0
    v_mfma_f32_4x4x4_16b_bf16 v[116:119], v[58:59], v[78:79], 0
    v_mfma_f32_4x4x4_16b_bf16 v[120:123], v[58:59], v[80:81], 0
    v_mad_u32_u16 v16, v16, 8, s50 op_sel:[1,0,0,0]
    v_mad_u32_u16 v17, v17, 8, s50 op_sel:[1,0,0,0]
    v_mad_u32_u16 v18, v18, 8, s50 op_sel:[1,0,0,0]
    v_pk_fma_f32 v[114:115], v[114:115], v[108:109], s[20:21] op_sel:[0,0,0] op_sel_hi:[1,0,1]
    v_pk_fma_f32 v[112:113], v[112:113], v[108:109], s[16:17] op_sel:[0,0,0] op_sel_hi:[1,0,1]
    v_pk_fma_f32 v[118:119], v[118:119], v[108:109], s[20:21] op_sel:[0,1,0] op_sel_hi:[1,1,1]
    v_pk_fma_f32 v[116:117], v[116:117], v[108:109], s[16:17] op_sel:[0,1,0] op_sel_hi:[1,1,1]
    v_pk_fma_f32 v[122:123], v[122:123], v[110:111], s[20:21] op_sel:[0,0,0] op_sel_hi:[1,0,1]
    v_pk_fma_f32 v[120:121], v[120:121], v[110:111], s[16:17] op_sel:[0,0,0] op_sel_hi:[1,0,1]
    v_lshlrev_b64 v[114:115], 16, v[114:115]
    v_lshlrev_b64 v[118:119], 16, v[118:119]
    v_lshlrev_b64 v[122:123], 16, v[122:123]
    v_lshl_add_u64 v[76:77], v[112:113], 0, v[114:115]
    v_lshl_add_u64 v[78:79], v[116:117], 0, v[118:119]
    v_lshl_add_u64 v[80:81], v[120:121], 0, v[122:123]
    s_waitcnt lgkmcnt(6)
    v_or3_b32 v4, v44, v45, v4
    v_or3_b32 v4, v46, v47, v4
    v_or3_b32 v4, v48, v49, v4
    ds_add_rtn_u64 v[44:45], v16, v[76:77]
    ds_add_rtn_u64 v[46:47], v17, v[78:79]
    ds_add_rtn_u64 v[48:49], v18, v[80:81]
    s_waitcnt lgkmcnt(3)
    v_mad_u32_u16 v55, v55, s23, v2
    v_pk_lshrrev_b16 v55, 10, v55 op_sel_hi:[1,1]
    v_lshl_add_u32 v51, v51, 6, v55
    buffer_load_dwordx4 v[16:19], v51, s[44:47], s34 idxen
    s_cmp_le_u32 s51, 256
    s_cbranch_scc1 L_p2_kernel_noopt3_7
    v_bfe_i32 v108, v27, 2, 10
    v_bfe_i32 v109, v27, 12, 10
    v_ashrrev_i32 v110, 22, v27
    v_cvt_f32_i32 v108, v108
    v_cvt_f32_i32 v109, v109
    v_cvt_f32_i32 v110, v110
    v_mfma_f32_4x4x4_16b_bf16 v[112:115], v[58:59], v[64:65], 0
    v_mfma_f32_4x4x4_16b_bf16 v[116:119], v[58:59], v[66:67], 0
    v_mfma_f32_4x4x4_16b_bf16 v[120:123], v[58:59], v[68:69], 0
    v_mad_u32_u16 v24, v24, 8, s50 op_sel:[1,0,0,0]
    v_mad_u32_u16 v25, v25, 8, s50 op_sel:[1,0,0,0]
    v_mad_u32_u16 v26, v26, 8, s50 op_sel:[1,0,0,0]
    v_pk_fma_f32 v[114:115], v[114:115], v[108:109], s[20:21] op_sel:[0,0,0] op_sel_hi:[1,0,1]
    v_pk_fma_f32 v[112:113], v[112:113], v[108:109], s[16:17] op_sel:[0,0,0] op_sel_hi:[1,0,1]
    v_pk_fma_f32 v[118:119], v[118:119], v[108:109], s[20:21] op_sel:[0,1,0] op_sel_hi:[1,1,1]
    v_pk_fma_f32 v[116:117], v[116:117], v[108:109], s[16:17] op_sel:[0,1,0] op_sel_hi:[1,1,1]
    v_pk_fma_f32 v[122:123], v[122:123], v[110:111], s[20:21] op_sel:[0,0,0] op_sel_hi:[1,0,1]
    v_pk_fma_f32 v[120:121], v[120:121], v[110:111], s[16:17] op_sel:[0,0,0] op_sel_hi:[1,0,1]
    v_lshlrev_b64 v[114:115], 16, v[114:115]
    v_lshlrev_b64 v[118:119], 16, v[118:119]
    v_lshlrev_b64 v[122:123], 16, v[122:123]
    v_lshl_add_u64 v[64:65], v[112:113], 0, v[114:115]
    v_lshl_add_u64 v[66:67], v[116:117], 0, v[118:119]
    v_lshl_add_u64 v[68:69], v[120:121], 0, v[122:123]
    s_waitcnt lgkmcnt(0)
    v_or3_b32 v4, v44, v45, v4
    v_or3_b32 v4, v46, v47, v4
    v_or3_b32 v4, v48, v49, v4
    ds_add_rtn_u64 v[44:45], v24, v[64:65]
    ds_add_rtn_u64 v[46:47], v25, v[66:67]
    ds_add_rtn_u64 v[48:49], v26, v[68:69]
L_p2_kernel_noopt3_7:
    v_mbcnt_lo_u32_b32 v51, s36, 0
    v_mbcnt_hi_u32_b32 v51, s37, v51
    s_bcnt1_i32_b64 s14, s[36:37]
    v_lshl_add_u32 v55, v51, 1, s25
    ds_read_u16 v55, v55
    s_add_u32 s36, s26, 3145728
    s_lshl1_add_u32 s25, s14, s25
    s_lshl_b32 s14, s14, 10
    s_add_u32 s26, s26, s14
    s_cmp_le_u32 s28, 256
    s_cbranch_scc1 L_p2_kernel_noopt3_8
    v_readlane_b32 s38, v7, 8
    v_readlane_b32 s39, v7, 9
    s_nop 1
    v_mbcnt_lo_u32_b32 v62, s38, 0
    v_mbcnt_hi_u32_b32 v62, s39, v62
    s_bcnt1_i32_b64 s14, s[38:39]
    v_lshl_add_u32 v63, v62, 1, s25
    ds_read_u16 v63, v63
    s_add_u32 s38, s26, 4194304
    s_lshl1_add_u32 s25, s14, s25
    s_lshl_b32 s14, s14, 10
    s_add_u32 s26, s26, s14
L_p2_kernel_noopt3_8:
    v_bfe_i32 v108, v23, 2, 10
    v_bfe_i32 v109, v23, 12, 10
    v_ashrrev_i32 v110, 22, v23
    v_cvt_f32_i32 v108, v108
    v_cvt_f32_i32 v109, v109
    v_cvt_f32_i32 v110, v110
    v_mfma_f32_4x4x4_16b_bf16 v[112:115], v[58:59], v[82:83], 0
    v_mfma_f32_4x4x4_16b_bf16 v[116:119], v[58:59], v[84:85], 0
    v_mfma_f32_4x4x4_16b_bf16 v[120:123], v[58:59], v[86:87], 0
    v_mad_u32_u16 v20, v20, 8, s50 op_sel:[1,0,0,0]
    v_mad_u32_u16 v21, v21, 8, s50 op_sel:[1,0,0,0]
    v_mad_u32_u16 v22, v22, 8, s50 op_sel:[1,0,0,0]
    v_pk_fma_f32 v[114:115], v[114:115], v[108:109], s[20:21] op_sel:[0,0,0] op_sel_hi:[1,0,1]
    v_pk_fma_f32 v[112:113], v[112:113], v[108:109], s[16:17] op_sel:[0,0,0] op_sel_hi:[1,0,1]
    v_pk_fma_f32 v[118:119], v[118:119], v[108:109], s[20:21] op_sel:[0,1,0] op_sel_hi:[1,1,1]
    v_pk_fma_f32 v[116:117], v[116:117], v[108:109], s[16:17] op_sel:[0,1,0] op_sel_hi:[1,1,1]
    v_pk_fma_f32 v[122:123], v[122:123], v[110:111], s[20:21] op_sel:[0,0,0] op_sel_hi:[1,0,1]
    v_pk_fma_f32 v[120:121], v[120:121], v[110:111], s[16:17] op_sel:[0,0,0] op_sel_hi:[1,0,1]
    v_lshlrev_b64 v[114:115], 16, v[114:115]
    v_lshlrev_b64 v[118:119], 16, v[118:119]
    v_lshlrev_b64 v[122:123], 16, v[122:123]
    v_lshl_add_u64 v[82:83], v[112:113], 0, v[114:115]
    v_lshl_add_u64 v[84:85], v[116:117], 0, v[118:119]
    v_lshl_add_u64 v[86:87], v[120:121], 0, v[122:123]
    s_waitcnt lgkmcnt(1)
    v_or3_b32 v4, v44, v45, v4
    v_or3_b32 v4, v46, v47, v4
    v_or3_b32 v4, v48, v49, v4
    ds_add_rtn_u64 v[44:45], v20, v[82:83]
    ds_add_rtn_u64 v[46:47], v21, v[84:85]
    ds_add_rtn_u64 v[48:49], v22, v[86:87]
    s_waitcnt lgkmcnt(3)
    v_mad_u32_u16 v55, v55, s23, v2
    v_pk_lshrrev_b16 v55, 10, v55 op_sel_hi:[1,1]
    v_lshl_add_u32 v51, v51, 6, v55
    buffer_load_dwordx4 v[20:23], v51, s[44:47], s36 idxen
    s_cmp_le_u32 s28, 256
    s_cbranch_scc1 L_p2_kernel_noopt3_9
    v_mad_u32_u16 v63, v63, s23, v2
    v_pk_lshrrev_b16 v63, 10, v63 op_sel_hi:[1,1]
    v_lshl_add_u32 v62, v62, 6, v63
    buffer_load_dwordx4 v[24:27], v62, s[44:47], s38 idxen
L_p2_kernel_noopt3_9:
    s_add_u32 s14, s22, 80000
    buffer_load_dwordx4 v[88:91], v1, s[8:11], s14 offen
    v_mad_u32_u16 v108, v28, v50, s40 op_sel:[1,0,0,0]
    v_mad_u32_u16 v109, v36, v50, s41 op_sel:[1,0,0,0]
    v_sub_u32_sdwa v110, v109, v108 dst_sel:DWORD dst_unused:UNUSED_PAD src0_sel:WORD_1 src1_sel:WORD_1
    s_nop 1
    v_add_u32_dpp v110, v110, v110 row_shr:1 row_mask:0xf bank_mask:0xf bound_ctrl:0
    s_nop 1
    v_add_u32_dpp v110, v110, v110 row_shr:2 row_mask:0xf bank_mask:0xf bound_ctrl:0
    s_nop 1
    v_add_u32_dpp v110, v110, v110 row_shr:4 row_mask:0xf bank_mask:0xf bound_ctrl:0
    s_nop 1
    v_add_u32_dpp v110, v110, v110 row_shr:8 row_mask:0xf bank_mask:0xf bound_ctrl:0
    s_nop 1
    v_add_u32_dpp v110, v110, v110 row_bcast:15 row_mask:0xa bank_mask:0xf
    s_nop 1
    v_add_u32_dpp v110, v110, v110 row_bcast:31 row_mask:0xc bank_mask:0xf
    v_sub_u32_sdwa v109, v109, v110 dst_sel:DWORD dst_unused:UNUSED_PAD src0_sel:WORD_1 src1_sel:DWORD
    v_readlane_b32 s29, v110, 63
    v_add_u32 v110, -1, v110
    ds_write_b16 v126, v109
    v_lshlrev_b32_e64 v111, v110, 1
    v_lshrrev_b32 v110, 5, v110
    s_cmp_gt_u32 s29, 320
    s_cselect_b32 s2, 1, s2
    v_lshl_add_u32 v110, v110, 2, v127
    s_cselect_b64 exec, 0, -1
    ds_or_b32 v110, v111 offset:136
    s_mov_b64 exec, -1
    ds_wrxchg2_rtn_b32 v[108:109], v6, v5, v5 offset0:34 offset1:44
    s_add_u32 s14, s22, 96384
    buffer_load_dwordx4 v[92:95], v1, s[8:11], s14 offen
    s_add_u32 s24, s24, 1
    s_cmp_lt_u32 s24, 8
    s_barrier
    s_cbranch_scc1 L_p2_loop
    s_waitcnt lgkmcnt(3)
    v_or3_b32 v4, v44, v45, v4
    v_or3_b32 v4, v46, v47, v4
    v_or3_b32 v4, v48, v49, v4
    s_mov_b32 s27, s19
    s_waitcnt vmcnt(0)
    v_mov_b32 v8, 160232
    s_cmp_lg_u32 s13, 0
    s_cselect_b64 exec, 0, 1
    ds_write_b32 v8, v52
    s_mov_b64 exec, -1
    v_subrev_u32 v6, 80000, v124
    s_mul_i32 s24, s12, 20000
    v_subrev_u32 v10, s24, v1
    v_mov_b32 v11, 0x7f000000
    s_waitcnt vmcnt(0) lgkmcnt(0)
    s_barrier
    s_cmp_lt_u32 s13, 12
    s_cbranch_scc1 L_p2_ga
L_p2_ga:
    ds_read_b32 v9, v8
    ds_read_b128 v[88:91], v1 offset:0
    ds_read_b128 v[92:95], v1 offset:16384
    ds_read_b128 v[96:99], v1 offset:32768
    ds_read_b128 v[100:103], v1 offset:49152
    ds_read_b128 v[104:107], v6
    s_mul_i32 s14, s12, 5120000
    s_mul_i32 s15, s3, 80000
    s_add_u32 s25, s14, s15
    s_add_u32 s25, s25, 228589568
    s_waitcnt lgkmcnt(5)
    v_readfirstlane_b32 s21, v9
    s_nop 0
    s_bfe_u32 s21, s21, 524296
    s_cmp_lg_u32 s21, 4
    s_cselect_b32 s21, 1, 0
    s_cselect_b32 s24, 0, 20000
    v_cmp_le_u32 vcc, s24, v10
    v_add_u32 v10, 16384, v10
    s_add_u32 s14, s25, 0
    v_cndmask_b32 v12, v11, v1, vcc
    s_waitcnt lgkmcnt(4)
    buffer_store_dwordx4 v[88:91], v12, s[4:7], s14 offen sc1
    v_or3_b32 v4, v88, v89, v4
    v_or3_b32 v4, v90, v91, v4
    v_cmp_le_u32 vcc, s24, v10
    v_add_u32 v10, 16384, v10
    s_add_u32 s14, s25, 16384
    v_cndmask_b32 v12, v11, v1, vcc
    s_waitcnt lgkmcnt(3)
    buffer_store_dwordx4 v[92:95], v12, s[4:7], s14 offen sc1
    v_or3_b32 v4, v92, v93, v4
    v_or3_b32 v4, v94, v95, v4
    v_cmp_le_u32 vcc, s24, v10
    v_add_u32 v10, 16384, v10
    s_add_u32 s14, s25, 32768
    v_cndmask_b32 v12, v11, v1, vcc
    s_waitcnt lgkmcnt(2)
    buffer_store_dwordx4 v[96:99], v12, s[4:7], s14 offen sc1
    v_or3_b32 v4, v96, v97, v4
    v_or3_b32 v4, v98, v99, v4
    v_cmp_le_u32 vcc, s24, v10
    v_add_u32 v10, 16384, v10
    s_add_u32 s14, s25, 49152
    v_cndmask_b32 v12, v11, v1, vcc
    s_waitcnt lgkmcnt(1)
    buffer_store_dwordx4 v[100:103], v12, s[4:7], s14 offen sc1
    v_or3_b32 v4, v100, v101, v4
    v_or3_b32 v4, v102, v103, v4
    v_cmp_le_u32 vcc, s24, v10
    v_add_u32 v10, 16384, v10
    s_add_u32 s14, s25, 0
    v_cndmask_b32 v12, v11, v6, vcc
    s_waitcnt lgkmcnt(0)
    buffer_store_dwordx4 v[104:107], v12, s[4:7], s14 offen sc1
    v_or3_b32 v4, v104, v105, v4
    v_or3_b32 v4, v106, v107, v4
    s_load_dwordx2 s[16:17], s[0:1], 88
    s_cmp_ge_u32 s13, 12
    s_cbranch_scc1 L_p2_gb
    v_lshlrev_b32 v30, 16, v60
    v_and_b32 v31, 0xffff0000, v60
    v_lshlrev_b32 v36, 16, v53
    v_and_b32 v37, 0xffff0000, v53
    v_lshlrev_b32 v38, 16, v54
    v_and_b32 v39, 0xffff0000, v54
    v_lshlrev_b32 v40, 16, v56
    v_and_b32 v41, 0xffff0000, v56
    v_lshlrev_b32 v42, 16, v57
    v_and_b32 v43, 0xffff0000, v57
    v_pk_add_f32 v[14:15], v[30:31], v[36:37] op_sel:[0,0] op_sel_hi:[1,0] neg_lo:[0,1] neg_hi:[0,1]
    v_pk_add_f32 v[16:17], v[30:31], v[36:37] op_sel:[0,1] op_sel_hi:[1,1] neg_lo:[0,1] neg_hi:[0,1]
    v_pk_add_f32 v[18:19], v[30:31], v[38:39] op_sel:[0,0] op_sel_hi:[1,0] neg_lo:[0,1] neg_hi:[0,1]
    v_pk_add_f32 v[20:21], v[30:31], v[38:39] op_sel:[0,1] op_sel_hi:[1,1] neg_lo:[0,1] neg_hi:[0,1]
    v_pk_add_f32 v[22:23], v[30:31], v[40:41] op_sel:[0,0] op_sel_hi:[1,0] neg_lo:[0,1] neg_hi:[0,1]
    v_pk_add_f32 v[24:25], v[30:31], v[40:41] op_sel:[0,1] op_sel_hi:[1,1] neg_lo:[0,1] neg_hi:[0,1]
    v_pk_add_f32 v[26:27], v[30:31], v[42:43] op_sel:[0,0] op_sel_hi:[1,0] neg_lo:[0,1] neg_hi:[0,1]
    v_pk_add_f32 v[28:29], v[30:31], v[42:43] op_sel:[0,1] op_sel_hi:[1,1] neg_lo:[0,1] neg_hi:[0,1]
    v_cvt_pk_bf16_f32 v32, v14, v15
    v_lshlrev_b32 v14, 16, v32
    v_and_b32 v15, 0xffff0000, v32
    v_cvt_pk_bf16_f32 v32, v16, v17
    v_lshlrev_b32 v16, 16, v32
    v_and_b32 v17, 0xffff0000, v32
    v_cvt_pk_bf16_f32 v32, v18, v19
    v_lshlrev_b32 v18, 16, v32
    v_and_b32 v19, 0xffff0000, v32
    v_cvt_pk_bf16_f32 v32, v20, v21
    v_lshlrev_b32 v20, 16, v32
    v_and_b32 v21, 0xffff0000, v32
    v_cvt_pk_bf16_f32 v32, v22, v23
    v_lshlrev_b32 v22, 16, v32
    v_and_b32 v23, 0xffff0000, v32
    v_cvt_pk_bf16_f32 v32, v24, v25
    v_lshlrev_b32 v24, 16, v32
    v_and_b32 v25, 0xffff0000, v32
    v_cvt_pk_bf16_f32 v32, v26, v27
    v_lshlrev_b32 v26, 16, v32
    v_and_b32 v27, 0xffff0000, v32
    v_cvt_pk_bf16_f32 v32, v28, v29
    v_lshlrev_b32 v28, 16, v32
    v_and_b32 v29, 0xffff0000, v32
    v_pk_mul_f32 v[14:15], v[14:15], v[14:15]
    v_pk_mul_f32 v[16:17], v[16:17], v[16:17]
    v_pk_mul_f32 v[18:19], v[18:19], v[18:19]
    v_pk_mul_f32 v[20:21], v[20:21], v[20:21]
    v_pk_mul_f32 v[22:23], v[22:23], v[22:23]
    v_pk_mul_f32 v[24:25], v[24:25], v[24:25]
    v_pk_mul_f32 v[26:27], v[26:27], v[26:27]
    v_pk_mul_f32 v[28:29], v[28:29], v[28:29]
    v_cvt_pk_bf16_f32 v32, v14, v15
    v_lshlrev_b32 v14, 16, v32
    v_and_b32 v15, 0xffff0000, v32
    v_cvt_pk_bf16_f32 v32, v16, v17
    v_lshlrev_b32 v16, 16, v32
    v_and_b32 v17, 0xffff0000, v32
    v_cvt_pk_bf16_f32 v32, v18, v19
    v_lshlrev_b32 v18, 16, v32
    v_and_b32 v19, 0xffff0000, v32
    v_cvt_pk_bf16_f32 v32, v20, v21
    v_lshlrev_b32 v20, 16, v32
    v_and_b32 v21, 0xffff0000, v32
    v_cvt_pk_bf16_f32 v32, v22, v23
    v_lshlrev_b32 v22, 16, v32
    v_and_b32 v23, 0xffff0000, v32
    v_cvt_pk_bf16_f32 v32, v24, v25
    v_lshlrev_b32 v24, 16, v32
    v_and_b32 v25, 0xffff0000, v32
    v_cvt_pk_bf16_f32 v32, v26, v27
    v_lshlrev_b32 v26, 16, v32
    v_and_b32 v27, 0xffff0000, v32
    v_cvt_pk_bf16_f32 v32, v28, v29
    v_lshlrev_b32 v28, 16, v32
    v_and_b32 v29, 0xffff0000, v32
    v_mov_b32 v30, 1092616192
    v_mov_b32 v31, 0x3fb8aa3b
    v_pk_mul_f32 v[14:15], v[14:15], v[30:31] op_sel:[0,0] op_sel_hi:[1,0]
    v_pk_mul_f32 v[16:17], v[16:17], v[30:31] op_sel:[0,0] op_sel_hi:[1,0]
    v_pk_mul_f32 v[18:19], v[18:19], v[30:31] op_sel:[0,0] op_sel_hi:[1,0]
    v_pk_mul_f32 v[20:21], v[20:21], v[30:31] op_sel:[0,0] op_sel_hi:[1,0]
    v_pk_mul_f32 v[22:23], v[22:23], v[30:31] op_sel:[0,0] op_sel_hi:[1,0]
    v_pk_mul_f32 v[24:25], v[24:25], v[30:31] op_sel:[0,0] op_sel_hi:[1,0]
    v_pk_mul_f32 v[26:27], v[26:27], v[30:31] op_sel:[0,0] op_sel_hi:[1,0]
    v_pk_mul_f32 v[28:29], v[28:29], v[30:31] op_sel:[0,0] op_sel_hi:[1,0]
    v_cvt_pk_bf16_f32 v32, v14, v15
    v_lshlrev_b32 v14, 16, v32
    v_and_b32 v15, 0xffff0000, v32
    v_cvt_pk_bf16_f32 v32, v16, v17
    v_lshlrev_b32 v16, 16, v32
    v_and_b32 v17, 0xffff0000, v32
    v_cvt_pk_bf16_f32 v32, v18, v19
    v_lshlrev_b32 v18, 16, v32
    v_and_b32 v19, 0xffff0000, v32
    v_cvt_pk_bf16_f32 v32, v20, v21
    v_lshlrev_b32 v20, 16, v32
    v_and_b32 v21, 0xffff0000, v32
    v_cvt_pk_bf16_f32 v32, v22, v23
    v_lshlrev_b32 v22, 16, v32
    v_and_b32 v23, 0xffff0000, v32
    v_cvt_pk_bf16_f32 v32, v24, v25
    v_lshlrev_b32 v24, 16, v32
    v_and_b32 v25, 0xffff0000, v32
    v_cvt_pk_bf16_f32 v32, v26, v27
    v_lshlrev_b32 v26, 16, v32
    v_and_b32 v27, 0xffff0000, v32
    v_cvt_pk_bf16_f32 v32, v28, v29
    v_lshlrev_b32 v28, 16, v32
    v_and_b32 v29, 0xffff0000, v32
    v_pk_mul_f32 v[14:15], v[14:15], v[30:31] op_sel:[0,1] op_sel_hi:[1,1]
    v_pk_mul_f32 v[16:17], v[16:17], v[30:31] op_sel:[0,1] op_sel_hi:[1,1]
    v_pk_mul_f32 v[18:19], v[18:19], v[30:31] op_sel:[0,1] op_sel_hi:[1,1]
    v_pk_mul_f32 v[20:21], v[20:21], v[30:31] op_sel:[0,1] op_sel_hi:[1,1]
    v_pk_mul_f32 v[22:23], v[22:23], v[30:31] op_sel:[0,1] op_sel_hi:[1,1]
    v_pk_mul_f32 v[24:25], v[24:25], v[30:31] op_sel:[0,1] op_sel_hi:[1,1]
    v_pk_mul_f32 v[26:27], v[26:27], v[30:31] op_sel:[0,1] op_sel_hi:[1,1]
    v_pk_mul_f32 v[28:29], v[28:29], v[30:31] op_sel:[0,1] op_sel_hi:[1,1]
    v_exp_f32 v14, -v14
    v_exp_f32 v15, -v15
    v_exp_f32 v16, -v16
    v_exp_f32 v17, -v17
    v_exp_f32 v18, -v18
    v_exp_f32 v19, -v19
    v_exp_f32 v20, -v20
    v_exp_f32 v21, -v21
    v_exp_f32 v22, -v22
    v_exp_f32 v23, -v23
    v_exp_f32 v24, -v24
    v_exp_f32 v25, -v25
    v_exp_f32 v26, -v26
    v_exp_f32 v27, -v27
    v_exp_f32 v28, -v28
    v_exp_f32 v29, -v29
    v_cvt_pk_bf16_f32 v14, v14, v16
    v_cvt_pk_bf16_f32 v15, v15, v17
    v_cvt_pk_bf16_f32 v18, v18, v20
    v_cvt_pk_bf16_f32 v19, v19, v21
    v_cvt_pk_bf16_f32 v22, v22, v24
    v_cvt_pk_bf16_f32 v23, v23, v25
    v_cvt_pk_bf16_f32 v26, v26, v28
    v_cvt_pk_bf16_f32 v27, v27, v29
    v_dot2_f32_bf16 v72, v14, s68, 0
    v_dot2_f32_bf16 v73, v15, s68, 0
    v_dot2_f32_bf16 v74, v14, s69, 0
    v_dot2_f32_bf16 v75, v15, s69, 0
    v_dot2_f32_bf16 v76, v14, s70, 0
    v_dot2_f32_bf16 v77, v15, s70, 0
    v_dot2_f32_bf16 v78, v14, s71, 0
    v_dot2_f32_bf16 v79, v15, s71, 0
    v_dot2_f32_bf16 v80, v14, s52, 0
    v_dot2_f32_bf16 v81, v15, s52, 0
    v_dot2_f32_bf16 v82, v14, s53, 0
    v_dot2_f32_bf16 v83, v15, s53, 0
    v_dot2_f32_bf16 v84, v14, s54, 0
    v_dot2_f32_bf16 v85, v15, s54, 0
    v_dot2_f32_bf16 v86, v14, s55, 0
    v_dot2_f32_bf16 v87, v15, s55, 0
    v_dot2_f32_bf16 v72, v18, s72, v72
    v_dot2_f32_bf16 v73, v19, s72, v73
    v_dot2_f32_bf16 v74, v18, s73, v74
    v_dot2_f32_bf16 v75, v19, s73, v75
    v_dot2_f32_bf16 v76, v18, s74, v76
    v_dot2_f32_bf16 v77, v19, s74, v77
    v_dot2_f32_bf16 v78, v18, s75, v78
    v_dot2_f32_bf16 v79, v19, s75, v79
    v_dot2_f32_bf16 v80, v18, s56, v80
    v_dot2_f32_bf16 v81, v19, s56, v81
    v_dot2_f32_bf16 v82, v18, s57, v82
    v_dot2_f32_bf16 v83, v19, s57, v83
    v_dot2_f32_bf16 v84, v18, s58, v84
    v_dot2_f32_bf16 v85, v19, s58, v85
    v_dot2_f32_bf16 v86, v18, s59, v86
    v_dot2_f32_bf16 v87, v19, s59, v87
    v_dot2_f32_bf16 v72, v22, s76, v72
    v_dot2_f32_bf16 v73, v23, s76, v73
    v_dot2_f32_bf16 v74, v22, s77, v74
    v_dot2_f32_bf16 v75, v23, s77, v75
    v_dot2_f32_bf16 v76, v22, s78, v76
    v_dot2_f32_bf16 v77, v23, s78, v77
    v_dot2_f32_bf16 v78, v22, s79, v78
    v_dot2_f32_bf16 v79, v23, s79, v79
    v_dot2_f32_bf16 v80, v22, s60, v80
    v_dot2_f32_bf16 v81, v23, s60, v81
    v_dot2_f32_bf16 v82, v22, s61, v82
    v_dot2_f32_bf16 v83, v23, s61, v83
    v_dot2_f32_bf16 v84, v22, s62, v84
    v_dot2_f32_bf16 v85, v23, s62, v85
    v_dot2_f32_bf16 v86, v22, s63, v86
    v_dot2_f32_bf16 v87, v23, s63, v87
    v_dot2_f32_bf16 v72, v26, s80, v72
    v_dot2_f32_bf16 v73, v27, s80, v73
    v_dot2_f32_bf16 v74, v26, s81, v74
    v_dot2_f32_bf16 v75, v27, s81, v75
    v_dot2_f32_bf16 v76, v26, s82, v76
    v_dot2_f32_bf16 v77, v27, s82, v77
    v_dot2_f32_bf16 v78, v26, s83, v78
    v_dot2_f32_bf16 v79, v27, s83, v79
    v_dot2_f32_bf16 v80, v26, s64, v80
    v_dot2_f32_bf16 v81, v27, s64, v81
    v_dot2_f32_bf16 v82, v26, s65, v82
    v_dot2_f32_bf16 v83, v27, s65, v83
    v_dot2_f32_bf16 v84, v26, s66, v84
    v_dot2_f32_bf16 v85, v27, s66, v85
    v_dot2_f32_bf16 v86, v26, s67, v86
    v_dot2_f32_bf16 v87, v27, s67, v87
L_p2_gb:
    v_and_b32 v4, 0x80008000, v4
    v_cmp_ne_u32 vcc, 0, v4
    v_mov_b32 v8, s27
    v_and_b32 v10, 15, v0
    v_mul_u32_u24 v10, 240, v10
    v_add_u32 v10, 160000, v10
    s_cmp_lg_u64 vcc, 0
    s_cselect_b32 s2, 1, s2
    v_mov_b32 v9, s2
    s_mov_b64 exec, 1
    ds_write_b32 v8, v9
    s_mov_b64 exec, -1
    v_add_u32 v2, 16384, v1
    v_mov_b32 v9, 0x3f000000
    v_cmp_gt_u32 vcc, 226, v0
    s_mov_b32 s49, s12
    s_mov_b32 s51, 0
    v_cndmask_b32 v2, v9, v2, vcc
    s_waitcnt vmcnt(0) lgkmcnt(0)
    s_barrier
    ds_read_b32 v9, v10
    s_mov_b32 s18, 5120000
    s_mov_b32 s19, 0x00020000
    s_waitcnt lgkmcnt(0)
    v_cmp_ne_u32 vcc, 0, v9
    s_nop 1
    s_cmp_lg_u64 vcc, 0
    s_cselect_b32 s2, 1, 0
    s_cbranch_scc1 L_p2_slow
L_p2_signal:
    v_mov_b32 v8, 160228
    s_lshl_b32 s15, s2, 4
    s_or_b32 s15, s15, s21
    s_add_u32 s14, s12, 16
    s_lshl_b32 s20, s15, s14
    s_add_u32 s20, s20, 1
    v_mov_b32 v9, s20
    s_cmp_lg_u32 s13, 15
    s_cbranch_scc1 L_p2_nosig0
    s_lshl_b32 s14, s3, 8
    s_add_u32 s14, s14, 8523776
    s_mov_b64 exec, 1
    buffer_atomic_add v9, off, s[4:7], s14 sc0
    s_mov_b64 exec, -1
L_p2_nosig0:
    s_lshl2_add_u32 s14, s3, s49
    s_mul_i32 s26, s14, 20000
    s_mov_b32 s10, 5120000
    buffer_load_dwordx4 v[64:67], v1, s[8:11], s26 offen
    buffer_load_dwordx4 v[68:71], v2, s[8:11], s26 offen
    s_lshl_b32 s28, s92, 16
    s_and_b32 s29, s92, 0xffff0000
    s_lshl_b32 s30, s93, 16
    s_and_b32 s31, s93, 0xffff0000
    s_lshl_b32 s32, s94, 16
    s_and_b32 s33, s94, 0xffff0000
    s_lshl_b32 s34, s95, 16
    s_and_b32 s35, s95, 0xffff0000
    s_lshl_b32 s36, s96, 16
    s_and_b32 s37, s96, 0xffff0000
    s_lshl_b32 s38, s97, 16
    s_and_b32 s39, s97, 0xffff0000
    s_lshl_b32 s40, s98, 16
    s_and_b32 s41, s98, 0xffff0000
    s_lshl_b32 s42, s99, 16
    s_and_b32 s43, s99, 0xffff0000
    s_and_b32 s99, s91, 0xffff0000
    s_lshl_b32 s98, s91, 16
    s_and_b32 s97, s90, 0xffff0000
    s_lshl_b32 s96, s90, 16
    s_and_b32 s95, s89, 0xffff0000
    s_lshl_b32 s94, s89, 16
    s_and_b32 s93, s88, 0xffff0000
    s_lshl_b32 s92, s88, 16
    s_and_b32 s91, s87, 0xffff0000
    s_lshl_b32 s90, s87, 16
    s_and_b32 s89, s86, 0xffff0000
    s_lshl_b32 s88, s86, 16
    s_and_b32 s87, s85, 0xffff0000
    s_lshl_b32 s86, s85, 16
    s_and_b32 s85, s84, 0xffff0000
    s_lshl_b32 s84, s84, 16
    s_mov_b32 s44, s48
    s_add_u32 s45, s48, 2281701376
    s_cmp_eq_u32 s48, 0
    s_cselect_b32 s45, 0, s45
    s_cmp_lt_u32 s13, 12
    s_cbranch_scc1 L_p2_gc
    v_lshlrev_b32 v30, 16, v60
    v_and_b32 v31, 0xffff0000, v60
    v_lshlrev_b32 v36, 16, v53
    v_and_b32 v37, 0xffff0000, v53
    v_lshlrev_b32 v38, 16, v54
    v_and_b32 v39, 0xffff0000, v54
    v_lshlrev_b32 v40, 16, v56
    v_and_b32 v41, 0xffff0000, v56
    v_lshlrev_b32 v42, 16, v57
    v_and_b32 v43, 0xffff0000, v57
    v_pk_add_f32 v[14:15], v[30:31], v[36:37] op_sel:[0,0] op_sel_hi:[1,0] neg_lo:[0,1] neg_hi:[0,1]
    v_pk_add_f32 v[16:17], v[30:31], v[36:37] op_sel:[0,1] op_sel_hi:[1,1] neg_lo:[0,1] neg_hi:[0,1]
    v_pk_add_f32 v[18:19], v[30:31], v[38:39] op_sel:[0,0] op_sel_hi:[1,0] neg_lo:[0,1] neg_hi:[0,1]
    v_pk_add_f32 v[20:21], v[30:31], v[38:39] op_sel:[0,1] op_sel_hi:[1,1] neg_lo:[0,1] neg_hi:[0,1]
    v_pk_add_f32 v[22:23], v[30:31], v[40:41] op_sel:[0,0] op_sel_hi:[1,0] neg_lo:[0,1] neg_hi:[0,1]
    v_pk_add_f32 v[24:25], v[30:31], v[40:41] op_sel:[0,1] op_sel_hi:[1,1] neg_lo:[0,1] neg_hi:[0,1]
    v_pk_add_f32 v[26:27], v[30:31], v[42:43] op_sel:[0,0] op_sel_hi:[1,0] neg_lo:[0,1] neg_hi:[0,1]
    v_pk_add_f32 v[28:29], v[30:31], v[42:43] op_sel:[0,1] op_sel_hi:[1,1] neg_lo:[0,1] neg_hi:[0,1]
    v_cvt_pk_bf16_f32 v32, v14, v15
    v_lshlrev_b32 v14, 16, v32
    v_and_b32 v15, 0xffff0000, v32
    v_cvt_pk_bf16_f32 v32, v16, v17
    v_lshlrev_b32 v16, 16, v32
    v_and_b32 v17, 0xffff0000, v32
    v_cvt_pk_bf16_f32 v32, v18, v19
    v_lshlrev_b32 v18, 16, v32
    v_and_b32 v19, 0xffff0000, v32
    v_cvt_pk_bf16_f32 v32, v20, v21
    v_lshlrev_b32 v20, 16, v32
    v_and_b32 v21, 0xffff0000, v32
    v_cvt_pk_bf16_f32 v32, v22, v23
    v_lshlrev_b32 v22, 16, v32
    v_and_b32 v23, 0xffff0000, v32
    v_cvt_pk_bf16_f32 v32, v24, v25
    v_lshlrev_b32 v24, 16, v32
    v_and_b32 v25, 0xffff0000, v32
    v_cvt_pk_bf16_f32 v32, v26, v27
    v_lshlrev_b32 v26, 16, v32
    v_and_b32 v27, 0xffff0000, v32
    v_cvt_pk_bf16_f32 v32, v28, v29
    v_lshlrev_b32 v28, 16, v32
    v_and_b32 v29, 0xffff0000, v32
    v_pk_mul_f32 v[14:15], v[14:15], v[14:15]
    v_pk_mul_f32 v[16:17], v[16:17], v[16:17]
    v_pk_mul_f32 v[18:19], v[18:19], v[18:19]
    v_pk_mul_f32 v[20:21], v[20:21], v[20:21]
    v_pk_mul_f32 v[22:23], v[22:23], v[22:23]
    v_pk_mul_f32 v[24:25], v[24:25], v[24:25]
    v_pk_mul_f32 v[26:27], v[26:27], v[26:27]
    v_pk_mul_f32 v[28:29], v[28:29], v[28:29]
    v_cvt_pk_bf16_f32 v32, v14, v15
    v_lshlrev_b32 v14, 16, v32
    v_and_b32 v15, 0xffff0000, v32
    v_cvt_pk_bf16_f32 v32, v16, v17
    v_lshlrev_b32 v16, 16, v32
    v_and_b32 v17, 0xffff0000, v32
    v_cvt_pk_bf16_f32 v32, v18, v19
    v_lshlrev_b32 v18, 16, v32
    v_and_b32 v19, 0xffff0000, v32
    v_cvt_pk_bf16_f32 v32, v20, v21
    v_lshlrev_b32 v20, 16, v32
    v_and_b32 v21, 0xffff0000, v32
    v_cvt_pk_bf16_f32 v32, v22, v23
    v_lshlrev_b32 v22, 16, v32
    v_and_b32 v23, 0xffff0000, v32
    v_cvt_pk_bf16_f32 v32, v24, v25
    v_lshlrev_b32 v24, 16, v32
    v_and_b32 v25, 0xffff0000, v32
    v_cvt_pk_bf16_f32 v32, v26, v27
    v_lshlrev_b32 v26, 16, v32
    v_and_b32 v27, 0xffff0000, v32
    v_cvt_pk_bf16_f32 v32, v28, v29
    v_lshlrev_b32 v28, 16, v32
    v_and_b32 v29, 0xffff0000, v32
    v_mov_b32 v30, 1092616192
    v_mov_b32 v31, 0x3fb8aa3b
    v_pk_mul_f32 v[14:15], v[14:15], v[30:31] op_sel:[0,0] op_sel_hi:[1,0]
    v_pk_mul_f32 v[16:17], v[16:17], v[30:31] op_sel:[0,0] op_sel_hi:[1,0]
    v_pk_mul_f32 v[18:19], v[18:19], v[30:31] op_sel:[0,0] op_sel_hi:[1,0]
    v_pk_mul_f32 v[20:21], v[20:21], v[30:31] op_sel:[0,0] op_sel_hi:[1,0]
    v_pk_mul_f32 v[22:23], v[22:23], v[30:31] op_sel:[0,0] op_sel_hi:[1,0]
    v_pk_mul_f32 v[24:25], v[24:25], v[30:31] op_sel:[0,0] op_sel_hi:[1,0]
    v_pk_mul_f32 v[26:27], v[26:27], v[30:31] op_sel:[0,0] op_sel_hi:[1,0]
    v_pk_mul_f32 v[28:29], v[28:29], v[30:31] op_sel:[0,0] op_sel_hi:[1,0]
    v_cvt_pk_bf16_f32 v32, v14, v15
    v_lshlrev_b32 v14, 16, v32
    v_and_b32 v15, 0xffff0000, v32
    v_cvt_pk_bf16_f32 v32, v16, v17
    v_lshlrev_b32 v16, 16, v32
    v_and_b32 v17, 0xffff0000, v32
    v_cvt_pk_bf16_f32 v32, v18, v19
    v_lshlrev_b32 v18, 16, v32
    v_and_b32 v19, 0xffff0000, v32
    v_cvt_pk_bf16_f32 v32, v20, v21
    v_lshlrev_b32 v20, 16, v32
    v_and_b32 v21, 0xffff0000, v32
    v_cvt_pk_bf16_f32 v32, v22, v23
    v_lshlrev_b32 v22, 16, v32
    v_and_b32 v23, 0xffff0000, v32
    v_cvt_pk_bf16_f32 v32, v24, v25
    v_lshlrev_b32 v24, 16, v32
    v_and_b32 v25, 0xffff0000, v32
    v_cvt_pk_bf16_f32 v32, v26, v27
    v_lshlrev_b32 v26, 16, v32
    v_and_b32 v27, 0xffff0000, v32
    v_cvt_pk_bf16_f32 v32, v28, v29
    v_lshlrev_b32 v28, 16, v32
    v_and_b32 v29, 0xffff0000, v32
    v_pk_mul_f32 v[14:15], v[14:15], v[30:31] op_sel:[0,1] op_sel_hi:[1,1]
    v_pk_mul_f32 v[16:17], v[16:17], v[30:31] op_sel:[0,1] op_sel_hi:[1,1]
    v_pk_mul_f32 v[18:19], v[18:19], v[30:31] op_sel:[0,1] op_sel_hi:[1,1]
    v_pk_mul_f32 v[20:21], v[20:21], v[30:31] op_sel:[0,1] op_sel_hi:[1,1]
    v_pk_mul_f32 v[22:23], v[22:23], v[30:31] op_sel:[0,1] op_sel_hi:[1,1]
    v_pk_mul_f32 v[24:25], v[24:25], v[30:31] op_sel:[0,1] op_sel_hi:[1,1]
    v_pk_mul_f32 v[26:27], v[26:27], v[30:31] op_sel:[0,1] op_sel_hi:[1,1]
    v_pk_mul_f32 v[28:29], v[28:29], v[30:31] op_sel:[0,1] op_sel_hi:[1,1]
    v_exp_f32 v14, -v14
    v_exp_f32 v15, -v15
    v_exp_f32 v16, -v16
    v_exp_f32 v17, -v17
    v_exp_f32 v18, -v18
    v_exp_f32 v19, -v19
    v_exp_f32 v20, -v20
    v_exp_f32 v21, -v21
    v_exp_f32 v22, -v22
    v_exp_f32 v23, -v23
    v_exp_f32 v24, -v24
    v_exp_f32 v25, -v25
    v_exp_f32 v26, -v26
    v_exp_f32 v27, -v27
    v_exp_f32 v28, -v28
    v_exp_f32 v29, -v29
    v_cvt_pk_bf16_f32 v14, v14, v16
    v_cvt_pk_bf16_f32 v15, v15, v17
    v_cvt_pk_bf16_f32 v18, v18, v20
    v_cvt_pk_bf16_f32 v19, v19, v21
    v_cvt_pk_bf16_f32 v22, v22, v24
    v_cvt_pk_bf16_f32 v23, v23, v25
    v_cvt_pk_bf16_f32 v26, v26, v28
    v_cvt_pk_bf16_f32 v27, v27, v29
    v_dot2_f32_bf16 v72, v14, s68, 0
    v_dot2_f32_bf16 v73, v15, s68, 0
    v_dot2_f32_bf16 v74, v14, s69, 0
    v_dot2_f32_bf16 v75, v15, s69, 0
    v_dot2_f32_bf16 v76, v14, s70, 0
    v_dot2_f32_bf16 v77, v15, s70, 0
    v_dot2_f32_bf16 v78, v14, s71, 0
    v_dot2_f32_bf16 v79, v15, s71, 0
    v_dot2_f32_bf16 v80, v14, s52, 0
    v_dot2_f32_bf16 v81, v15, s52, 0
    v_dot2_f32_bf16 v82, v14, s53, 0
    v_dot2_f32_bf16 v83, v15, s53, 0
    v_dot2_f32_bf16 v84, v14, s54, 0
    v_dot2_f32_bf16 v85, v15, s54, 0
    v_dot2_f32_bf16 v86, v14, s55, 0
    v_dot2_f32_bf16 v87, v15, s55, 0
    v_dot2_f32_bf16 v72, v18, s72, v72
    v_dot2_f32_bf16 v73, v19, s72, v73
    v_dot2_f32_bf16 v74, v18, s73, v74
    v_dot2_f32_bf16 v75, v19, s73, v75
    v_dot2_f32_bf16 v76, v18, s74, v76
    v_dot2_f32_bf16 v77, v19, s74, v77
    v_dot2_f32_bf16 v78, v18, s75, v78
    v_dot2_f32_bf16 v79, v19, s75, v79
    v_dot2_f32_bf16 v80, v18, s56, v80
    v_dot2_f32_bf16 v81, v19, s56, v81
    v_dot2_f32_bf16 v82, v18, s57, v82
    v_dot2_f32_bf16 v83, v19, s57, v83
    v_dot2_f32_bf16 v84, v18, s58, v84
    v_dot2_f32_bf16 v85, v19, s58, v85
    v_dot2_f32_bf16 v86, v18, s59, v86
    v_dot2_f32_bf16 v87, v19, s59, v87
    v_dot2_f32_bf16 v72, v22, s76, v72
    v_dot2_f32_bf16 v73, v23, s76, v73
    v_dot2_f32_bf16 v74, v22, s77, v74
    v_dot2_f32_bf16 v75, v23, s77, v75
    v_dot2_f32_bf16 v76, v22, s78, v76
    v_dot2_f32_bf16 v77, v23, s78, v77
    v_dot2_f32_bf16 v78, v22, s79, v78
    v_dot2_f32_bf16 v79, v23, s79, v79
    v_dot2_f32_bf16 v80, v22, s60, v80
    v_dot2_f32_bf16 v81, v23, s60, v81
    v_dot2_f32_bf16 v82, v22, s61, v82
    v_dot2_f32_bf16 v83, v23, s61, v83
    v_dot2_f32_bf16 v84, v22, s62, v84
    v_dot2_f32_bf16 v85, v23, s62, v85
    v_dot2_f32_bf16 v86, v22, s63, v86
    v_dot2_f32_bf16 v87, v23, s63, v87
    v_dot2_f32_bf16 v72, v26, s80, v72
    v_dot2_f32_bf16 v73, v27, s80, v73
    v_dot2_f32_bf16 v74, v26, s81, v74
    v_dot2_f32_bf16 v75, v27, s81, v75
    v_dot2_f32_bf16 v76, v26, s82, v76
    v_dot2_f32_bf16 v77, v27, s82, v77
    v_dot2_f32_bf16 v78, v26, s83, v78
    v_dot2_f32_bf16 v79, v27, s83, v79
    v_dot2_f32_bf16 v80, v26, s64, v80
    v_dot2_f32_bf16 v81, v27, s64, v81
    v_dot2_f32_bf16 v82, v26, s65, v82
    v_dot2_f32_bf16 v83, v27, s65, v83
    v_dot2_f32_bf16 v84, v26, s66, v84
    v_dot2_f32_bf16 v85, v27, s66, v85
    v_dot2_f32_bf16 v86, v26, s67, v86
    v_dot2_f32_bf16 v87, v27, s67, v87
L_p2_gc:
    s_cmp_ge_u32 s13, 4
    s_cbranch_scc1 L_p2_gd
    v_lshlrev_b32 v30, 16, v61
    v_and_b32 v31, 0xffff0000, v61
    v_pk_add_f32 v[14:15], v[30:31], v[36:37] op_sel:[0,0] op_sel_hi:[1,0] neg_lo:[0,1] neg_hi:[0,1]
    v_pk_add_f32 v[16:17], v[30:31], v[36:37] op_sel:[0,1] op_sel_hi:[1,1] neg_lo:[0,1] neg_hi:[0,1]
    v_pk_add_f32 v[18:19], v[30:31], v[38:39] op_sel:[0,0] op_sel_hi:[1,0] neg_lo:[0,1] neg_hi:[0,1]
    v_pk_add_f32 v[20:21], v[30:31], v[38:39] op_sel:[0,1] op_sel_hi:[1,1] neg_lo:[0,1] neg_hi:[0,1]
    v_pk_add_f32 v[22:23], v[30:31], v[40:41] op_sel:[0,0] op_sel_hi:[1,0] neg_lo:[0,1] neg_hi:[0,1]
    v_pk_add_f32 v[24:25], v[30:31], v[40:41] op_sel:[0,1] op_sel_hi:[1,1] neg_lo:[0,1] neg_hi:[0,1]
    v_pk_add_f32 v[26:27], v[30:31], v[42:43] op_sel:[0,0] op_sel_hi:[1,0] neg_lo:[0,1] neg_hi:[0,1]
    v_pk_add_f32 v[28:29], v[30:31], v[42:43] op_sel:[0,1] op_sel_hi:[1,1] neg_lo:[0,1] neg_hi:[0,1]
    v_cvt_pk_bf16_f32 v32, v14, v15
    v_lshlrev_b32 v14, 16, v32
    v_and_b32 v15, 0xffff0000, v32
    v_cvt_pk_bf16_f32 v32, v16, v17
    v_lshlrev_b32 v16, 16, v32
    v_and_b32 v17, 0xffff0000, v32
    v_cvt_pk_bf16_f32 v32, v18, v19
    v_lshlrev_b32 v18, 16, v32
    v_and_b32 v19, 0xffff0000, v32
    v_cvt_pk_bf16_f32 v32, v20, v21
    v_lshlrev_b32 v20, 16, v32
    v_and_b32 v21, 0xffff0000, v32
    v_cvt_pk_bf16_f32 v32, v22, v23
    v_lshlrev_b32 v22, 16, v32
    v_and_b32 v23, 0xffff0000, v32
    v_cvt_pk_bf16_f32 v32, v24, v25
    v_lshlrev_b32 v24, 16, v32
    v_and_b32 v25, 0xffff0000, v32
    v_cvt_pk_bf16_f32 v32, v26, v27
    v_lshlrev_b32 v26, 16, v32
    v_and_b32 v27, 0xffff0000, v32
    v_cvt_pk_bf16_f32 v32, v28, v29
    v_lshlrev_b32 v28, 16, v32
    v_and_b32 v29, 0xffff0000, v32
    v_pk_mul_f32 v[14:15], v[14:15], v[14:15]
    v_pk_mul_f32 v[16:17], v[16:17], v[16:17]
    v_pk_mul_f32 v[18:19], v[18:19], v[18:19]
    v_pk_mul_f32 v[20:21], v[20:21], v[20:21]
    v_pk_mul_f32 v[22:23], v[22:23], v[22:23]
    v_pk_mul_f32 v[24:25], v[24:25], v[24:25]
    v_pk_mul_f32 v[26:27], v[26:27], v[26:27]
    v_pk_mul_f32 v[28:29], v[28:29], v[28:29]
    v_cvt_pk_bf16_f32 v32, v14, v15
    v_lshlrev_b32 v14, 16, v32
    v_and_b32 v15, 0xffff0000, v32
    v_cvt_pk_bf16_f32 v32, v16, v17
    v_lshlrev_b32 v16, 16, v32
    v_and_b32 v17, 0xffff0000, v32
    v_cvt_pk_bf16_f32 v32, v18, v19
    v_lshlrev_b32 v18, 16, v32
    v_and_b32 v19, 0xffff0000, v32
    v_cvt_pk_bf16_f32 v32, v20, v21
    v_lshlrev_b32 v20, 16, v32
    v_and_b32 v21, 0xffff0000, v32
    v_cvt_pk_bf16_f32 v32, v22, v23
    v_lshlrev_b32 v22, 16, v32
    v_and_b32 v23, 0xffff0000, v32
    v_cvt_pk_bf16_f32 v32, v24, v25
    v_lshlrev_b32 v24, 16, v32
    v_and_b32 v25, 0xffff0000, v32
    v_cvt_pk_bf16_f32 v32, v26, v27
    v_lshlrev_b32 v26, 16, v32
    v_and_b32 v27, 0xffff0000, v32
    v_cvt_pk_bf16_f32 v32, v28, v29
    v_lshlrev_b32 v28, 16, v32
    v_and_b32 v29, 0xffff0000, v32
    v_mov_b32 v30, 1092616192
    v_mov_b32 v31, 0x3fb8aa3b
    v_pk_mul_f32 v[14:15], v[14:15], v[30:31] op_sel:[0,0] op_sel_hi:[1,0]
    v_pk_mul_f32 v[16:17], v[16:17], v[30:31] op_sel:[0,0] op_sel_hi:[1,0]
    v_pk_mul_f32 v[18:19], v[18:19], v[30:31] op_sel:[0,0] op_sel_hi:[1,0]
    v_pk_mul_f32 v[20:21], v[20:21], v[30:31] op_sel:[0,0] op_sel_hi:[1,0]
    v_pk_mul_f32 v[22:23], v[22:23], v[30:31] op_sel:[0,0] op_sel_hi:[1,0]
    v_pk_mul_f32 v[24:25], v[24:25], v[30:31] op_sel:[0,0] op_sel_hi:[1,0]
    v_pk_mul_f32 v[26:27], v[26:27], v[30:31] op_sel:[0,0] op_sel_hi:[1,0]
    v_pk_mul_f32 v[28:29], v[28:29], v[30:31] op_sel:[0,0] op_sel_hi:[1,0]
    v_cvt_pk_bf16_f32 v32, v14, v15
    v_lshlrev_b32 v14, 16, v32
    v_and_b32 v15, 0xffff0000, v32
    v_cvt_pk_bf16_f32 v32, v16, v17
    v_lshlrev_b32 v16, 16, v32
    v_and_b32 v17, 0xffff0000, v32
    v_cvt_pk_bf16_f32 v32, v18, v19
    v_lshlrev_b32 v18, 16, v32
    v_and_b32 v19, 0xffff0000, v32
    v_cvt_pk_bf16_f32 v32, v20, v21
    v_lshlrev_b32 v20, 16, v32
    v_and_b32 v21, 0xffff0000, v32
    v_cvt_pk_bf16_f32 v32, v22, v23
    v_lshlrev_b32 v22, 16, v32
    v_and_b32 v23, 0xffff0000, v32
    v_cvt_pk_bf16_f32 v32, v24, v25
    v_lshlrev_b32 v24, 16, v32
    v_and_b32 v25, 0xffff0000, v32
    v_cvt_pk_bf16_f32 v32, v26, v27
    v_lshlrev_b32 v26, 16, v32
    v_and_b32 v27, 0xffff0000, v32
    v_cvt_pk_bf16_f32 v32, v28, v29
    v_lshlrev_b32 v28, 16, v32
    v_and_b32 v29, 0xffff0000, v32
    v_pk_mul_f32 v[14:15], v[14:15], v[30:31] op_sel:[0,1] op_sel_hi:[1,1]
    v_pk_mul_f32 v[16:17], v[16:17], v[30:31] op_sel:[0,1] op_sel_hi:[1,1]
    v_pk_mul_f32 v[18:19], v[18:19], v[30:31] op_sel:[0,1] op_sel_hi:[1,1]
    v_pk_mul_f32 v[20:21], v[20:21], v[30:31] op_sel:[0,1] op_sel_hi:[1,1]
    v_pk_mul_f32 v[22:23], v[22:23], v[30:31] op_sel:[0,1] op_sel_hi:[1,1]
    v_pk_mul_f32 v[24:25], v[24:25], v[30:31] op_sel:[0,1] op_sel_hi:[1,1]
    v_pk_mul_f32 v[26:27], v[26:27], v[30:31] op_sel:[0,1] op_sel_hi:[1,1]
    v_pk_mul_f32 v[28:29], v[28:29], v[30:31] op_sel:[0,1] op_sel_hi:[1,1]
    v_exp_f32 v14, -v14
    v_exp_f32 v15, -v15
    v_exp_f32 v16, -v16
    v_exp_f32 v17, -v17
    v_exp_f32 v18, -v18
    v_exp_f32 v19, -v19
    v_exp_f32 v20, -v20
    v_exp_f32 v21, -v21
    v_exp_f32 v22, -v22
    v_exp_f32 v23, -v23
    v_exp_f32 v24, -v24
    v_exp_f32 v25, -v25
    v_exp_f32 v26, -v26
    v_exp_f32 v27, -v27
    v_exp_f32 v28, -v28
    v_exp_f32 v29, -v29
    v_cvt_pk_bf16_f32 v14, v14, v16
    v_cvt_pk_bf16_f32 v15, v15, v17
    v_cvt_pk_bf16_f32 v18, v18, v20
    v_cvt_pk_bf16_f32 v19, v19, v21
    v_cvt_pk_bf16_f32 v22, v22, v24
    v_cvt_pk_bf16_f32 v23, v23, v25
    v_cvt_pk_bf16_f32 v26, v26, v28
    v_cvt_pk_bf16_f32 v27, v27, v29
    v_dot2_f32_bf16 v112, v14, s68, 0
    v_dot2_f32_bf16 v113, v15, s68, 0
    v_dot2_f32_bf16 v114, v14, s69, 0
    v_dot2_f32_bf16 v115, v15, s69, 0
    v_dot2_f32_bf16 v116, v14, s70, 0
    v_dot2_f32_bf16 v117, v15, s70, 0
    v_dot2_f32_bf16 v118, v14, s71, 0
    v_dot2_f32_bf16 v119, v15, s71, 0
    v_dot2_f32_bf16 v120, v14, s52, 0
    v_dot2_f32_bf16 v121, v15, s52, 0
    v_dot2_f32_bf16 v122, v14, s53, 0
    v_dot2_f32_bf16 v123, v15, s53, 0
    v_dot2_f32_bf16 v124, v14, s54, 0
    v_dot2_f32_bf16 v125, v15, s54, 0
    v_dot2_f32_bf16 v126, v14, s55, 0
    v_dot2_f32_bf16 v127, v15, s55, 0
    v_dot2_f32_bf16 v112, v18, s72, v112
    v_dot2_f32_bf16 v113, v19, s72, v113
    v_dot2_f32_bf16 v114, v18, s73, v114
    v_dot2_f32_bf16 v115, v19, s73, v115
    v_dot2_f32_bf16 v116, v18, s74, v116
    v_dot2_f32_bf16 v117, v19, s74, v117
    v_dot2_f32_bf16 v118, v18, s75, v118
    v_dot2_f32_bf16 v119, v19, s75, v119
    v_dot2_f32_bf16 v120, v18, s56, v120
    v_dot2_f32_bf16 v121, v19, s56, v121
    v_dot2_f32_bf16 v122, v18, s57, v122
    v_dot2_f32_bf16 v123, v19, s57, v123
    v_dot2_f32_bf16 v124, v18, s58, v124
    v_dot2_f32_bf16 v125, v19, s58, v125
    v_dot2_f32_bf16 v126, v18, s59, v126
    v_dot2_f32_bf16 v127, v19, s59, v127
    v_dot2_f32_bf16 v112, v22, s76, v112
    v_dot2_f32_bf16 v113, v23, s76, v113
    v_dot2_f32_bf16 v114, v22, s77, v114
    v_dot2_f32_bf16 v115, v23, s77, v115
    v_dot2_f32_bf16 v116, v22, s78, v116
    v_dot2_f32_bf16 v117, v23, s78, v117
    v_dot2_f32_bf16 v118, v22, s79, v118
    v_dot2_f32_bf16 v119, v23, s79, v119
    v_dot2_f32_bf16 v120, v22, s60, v120
    v_dot2_f32_bf16 v121, v23, s60, v121
    v_dot2_f32_bf16 v122, v22, s61, v122
    v_dot2_f32_bf16 v123, v23, s61, v123
    v_dot2_f32_bf16 v124, v22, s62, v124
    v_dot2_f32_bf16 v125, v23, s62, v125
    v_dot2_f32_bf16 v126, v22, s63, v126
    v_dot2_f32_bf16 v127, v23, s63, v127
    v_dot2_f32_bf16 v112, v26, s80, v112
    v_dot2_f32_bf16 v113, v27, s80, v113
    v_dot2_f32_bf16 v114, v26, s81, v114
    v_dot2_f32_bf16 v115, v27, s81, v115
    v_dot2_f32_bf16 v116, v26, s82, v116
    v_dot2_f32_bf16 v117, v27, s82, v117
    v_dot2_f32_bf16 v118, v26, s83, v118
    v_dot2_f32_bf16 v119, v27, s83, v119
    v_dot2_f32_bf16 v120, v26, s64, v120
    v_dot2_f32_bf16 v121, v27, s64, v121
    v_dot2_f32_bf16 v122, v26, s65, v122
    v_dot2_f32_bf16 v123, v27, s65, v123
    v_dot2_f32_bf16 v124, v26, s66, v124
    v_dot2_f32_bf16 v125, v27, s66, v125
    v_dot2_f32_bf16 v126, v26, s67, v126
    v_dot2_f32_bf16 v127, v27, s67, v127
L_p2_gd:
    s_cmp_lg_u32 s13, 15
    s_cbranch_scc1 L_p2_nosig
    s_waitcnt vmcnt(2)
    v_readfirstlane_b32 s15, v9
    s_lshl_b32 s51, 1, s12
    s_add_u32 s20, s20, s15
    s_and_b32 s15, s20, 0xff
    s_cmp_eq_u32 s15, 4
    s_cbranch_scc0 L_p2_notlast
    s_bfe_u32 s15, s20, 262160
    s_or_b32 s51, s51, s15
    s_branch L_p2_pub
L_p2_notlast:
    s_cmp_lg_u32 s21, 0
    s_cselect_b32 s51, 0, s51
    s_cbranch_scc1 L_p2_pub
L_p2_poll:
    v_mov_b32 v9, 0
    s_lshl_b32 s14, s3, 8
    s_add_u32 s14, s14, 8523776
    s_mov_b64 exec, 1
    buffer_atomic_add v9, off, s[4:7], s14 sc0
    s_mov_b64 exec, -1
    s_waitcnt vmcnt(0)
    v_readfirstlane_b32 s20, v9
    s_nop 0
    s_and_b32 s15, s20, 0xff
    s_cmp_lt_u32 s15, 4
    s_cbranch_scc1 L_p2_poll
L_p2_pub:
    s_lshl_b32 s15, s51, 24
    s_or_b32 s15, s15, s20
    v_mov_b32 v9, s15
    s_mov_b64 exec, 1
    ds_write_b32 v8, v9
    s_mov_b64 exec, -1
    s_waitcnt lgkmcnt(0)
L_p2_nosig:
    s_barrier
    ds_read_b32 v9, v8
    s_waitcnt lgkmcnt(0)
    v_readfirstlane_b32 s20, v9
    s_nop 0
    s_lshr_b32 s51, s20, 24
    s_cbranch_scc0 L_p2_end
L_p2_fin:
    s_mul_i32 s24, s49, 20000
    s_add_u32 s14, s12, 1
    s_and_b32 s14, s14, 3
    s_mul_i32 s15, s14, 5120000
    s_add_u32 s15, s15, 228589568
    s_add_u32 s15, s15, s26
    buffer_load_dwordx4 v[12:15], v1, s[4:7], s15 offen sc1
    buffer_load_dwordx4 v[92:95], v2, s[4:7], s15 offen sc1
    s_add_u32 s14, s12, 2
    s_and_b32 s14, s14, 3
    s_mul_i32 s15, s14, 5120000
    s_add_u32 s15, s15, 228589568
    s_add_u32 s15, s15, s26
    buffer_load_dwordx4 v[16:19], v1, s[4:7], s15 offen sc1
    buffer_load_dwordx4 v[96:99], v2, s[4:7], s15 offen sc1
    s_add_u32 s14, s12, 3
    s_and_b32 s14, s14, 3
    s_mul_i32 s15, s14, 5120000
    s_add_u32 s15, s15, 228589568
    s_add_u32 s15, s15, s26
    buffer_load_dwordx4 v[20:23], v1, s[4:7], s15 offen sc1
    buffer_load_dwordx4 v[100:103], v2, s[4:7], s15 offen sc1
    v_add_u32 v24, s24, v1
    ds_read_b128 v[8:11], v24
    v_add_u32 v25, s24, v2
    ds_read_b128 v[88:91], v25
    s_waitcnt vmcnt(0) lgkmcnt(0)
    s_bfe_u32 s14, s20, 262164
    s_cbranch_scc0 L_p2_kernel_nof32a_10
    s_add_u32 s14, s12, 0
    s_and_b32 s14, s14, 3
    s_add_u32 s14, s14, 20
    s_bitcmp1_b32 s20, s14
    s_cbranch_scc0 L_p2_kernel_q_11
    v_mov_b32 v8, 1073758208
    v_mov_b32 v9, 1073758208
    v_mov_b32 v10, 1073758208
    v_mov_b32 v11, 1073758208
L_p2_kernel_q_11:
    s_add_u32 s14, s12, 1
    s_and_b32 s14, s14, 3
    s_add_u32 s14, s14, 20
    s_bitcmp1_b32 s20, s14
    s_cbranch_scc0 L_p2_kernel_q_12
    v_mov_b32 v12, 1073758208
    v_mov_b32 v13, 1073758208
    v_mov_b32 v14, 1073758208
    v_mov_b32 v15, 1073758208
L_p2_kernel_q_12:
    s_add_u32 s14, s12, 2
    s_and_b32 s14, s14, 3
    s_add_u32 s14, s14, 20
    s_bitcmp1_b32 s20, s14
    s_cbranch_scc0 L_p2_kernel_q_13
    v_mov_b32 v16, 1073758208
    v_mov_b32 v17, 1073758208
    v_mov_b32 v18, 1073758208
    v_mov_b32 v19, 1073758208
L_p2_kernel_q_13:
    s_add_u32 s14, s12, 3
    s_and_b32 s14, s14, 3
    s_add_u32 s14, s14, 20
    s_bitcmp1_b32 s20, s14
    s_cbranch_scc0 L_p2_kernel_q_14
    v_mov_b32 v20, 1073758208
    v_mov_b32 v21, 1073758208
    v_mov_b32 v22, 1073758208
    v_mov_b32 v23, 1073758208
L_p2_kernel_q_14:
L_p2_kernel_nof32a_10:
    v_pk_add_u16 v8, v8, v12
    v_pk_add_u16 v16, v16, v20
    v_pk_add_u16 v9, v9, v13
    v_pk_add_u16 v17, v17, v21
    v_pk_add_u16 v10, v10, v14
    v_pk_add_u16 v18, v18, v22
    v_pk_add_u16 v11, v11, v15
    v_pk_add_u16 v19, v19, v23
    v_add_u32_sdwa v24, v8, v16 dst_sel:DWORD dst_unused:UNUSED_PAD src0_sel:WORD_0 src1_sel:WORD_0
    v_add_u32_sdwa v25, v10, v18 dst_sel:DWORD dst_unused:UNUSED_PAD src0_sel:WORD_0 src1_sel:WORD_0
    v_add_u32_sdwa v26, v8, v16 dst_sel:DWORD dst_unused:UNUSED_PAD src0_sel:WORD_1 src1_sel:WORD_1
    v_add_u32_sdwa v27, v10, v18 dst_sel:DWORD dst_unused:UNUSED_PAD src0_sel:WORD_1 src1_sel:WORD_1
    v_add_u32_sdwa v28, v9, v17 dst_sel:DWORD dst_unused:UNUSED_PAD src0_sel:WORD_0 src1_sel:WORD_0
    v_add_u32_sdwa v29, v11, v19 dst_sel:DWORD dst_unused:UNUSED_PAD src0_sel:WORD_0 src1_sel:WORD_0
    v_add_u32_sdwa v30, v9, v17 dst_sel:DWORD dst_unused:UNUSED_PAD src0_sel:WORD_1 src1_sel:WORD_1
    v_add_u32_sdwa v31, v11, v19 dst_sel:DWORD dst_unused:UNUSED_PAD src0_sel:WORD_1 src1_sel:WORD_1
    v_cvt_f32_u32 v24, v24
    v_cvt_f32_u32 v25, v25
    v_cvt_f32_u32 v26, v26
    v_cvt_f32_u32 v27, v27
    v_cvt_f32_u32 v28, v28
    v_cvt_f32_u32 v29, v29
    v_cvt_f32_u32 v30, v30
    v_cvt_f32_u32 v31, v31
    v_pk_fma_f32 v[24:25], v[24:25], s[44:45], s[44:45] op_sel:[0,0,1] op_sel_hi:[1,0,1]
    v_pk_fma_f32 v[26:27], v[26:27], s[44:45], s[44:45] op_sel:[0,0,1] op_sel_hi:[1,0,1]
    v_pk_fma_f32 v[28:29], v[28:29], s[44:45], s[44:45] op_sel:[0,0,1] op_sel_hi:[1,0,1]
    v_pk_fma_f32 v[30:31], v[30:31], s[44:45], s[44:45] op_sel:[0,0,1] op_sel_hi:[1,0,1]
    s_bfe_u32 s14, s20, 262164
    s_cbranch_scc0 L_p2_kernel_nof32b_15
    v_lshlrev_b32 v32, 1, v1
    s_bitcmp1_b32 s20, 20
    s_cbranch_scc0 L_p2_kernel_q_16
    s_lshl_b32 s15, s26, 1
    s_add_u32 s15, s15, 249069568
    buffer_load_dwordx4 v[8:11], v32, s[4:7], s15 offen sc1
    buffer_load_dwordx4 v[12:15], v32, s[4:7], s15 offen offset:16 sc1
    s_waitcnt vmcnt(0)
    v_add_f32 v24, v24, v8
    v_add_f32 v25, v25, v12
    v_add_f32 v26, v26, v9
    v_add_f32 v27, v27, v13
    v_add_f32 v28, v28, v10
    v_add_f32 v29, v29, v14
    v_add_f32 v30, v30, v11
    v_add_f32 v31, v31, v15
L_p2_kernel_q_16:
    s_bitcmp1_b32 s20, 21
    s_cbranch_scc0 L_p2_kernel_q_17
    s_lshl_b32 s15, s26, 1
    s_add_u32 s15, s15, 259309568
    buffer_load_dwordx4 v[8:11], v32, s[4:7], s15 offen sc1
    buffer_load_dwordx4 v[12:15], v32, s[4:7], s15 offen offset:16 sc1
    s_waitcnt vmcnt(0)
    v_add_f32 v24, v24, v8
    v_add_f32 v25, v25, v12
    v_add_f32 v26, v26, v9
    v_add_f32 v27, v27, v13
    v_add_f32 v28, v28, v10
    v_add_f32 v29, v29, v14
    v_add_f32 v30, v30, v11
    v_add_f32 v31, v31, v15
L_p2_kernel_q_17:
    s_bitcmp1_b32 s20, 22
    s_cbranch_scc0 L_p2_kernel_q_18
    s_lshl_b32 s15, s26, 1
    s_add_u32 s15, s15, 269549568
    buffer_load_dwordx4 v[8:11], v32, s[4:7], s15 offen sc1
    buffer_load_dwordx4 v[12:15], v32, s[4:7], s15 offen offset:16 sc1
    s_waitcnt vmcnt(0)
    v_add_f32 v24, v24, v8
    v_add_f32 v25, v25, v12
    v_add_f32 v26, v26, v9
    v_add_f32 v27, v27, v13
    v_add_f32 v28, v28, v10
    v_add_f32 v29, v29, v14
    v_add_f32 v30, v30, v11
    v_add_f32 v31, v31, v15
L_p2_kernel_q_18:
    s_bitcmp1_b32 s20, 23
    s_cbranch_scc0 L_p2_kernel_q_19
    s_lshl_b32 s15, s26, 1
    s_add_u32 s15, s15, 279789568
    buffer_load_dwordx4 v[8:11], v32, s[4:7], s15 offen sc1
    buffer_load_dwordx4 v[12:15], v32, s[4:7], s15 offen offset:16 sc1
    s_waitcnt vmcnt(0)
    v_add_f32 v24, v24, v8
    v_add_f32 v25, v25, v12
    v_add_f32 v26, v26, v9
    v_add_f32 v27, v27, v13
    v_add_f32 v28, v28, v10
    v_add_f32 v29, v29, v14
    v_add_f32 v30, v30, v11
    v_add_f32 v31, v31, v15
L_p2_kernel_q_19:
L_p2_kernel_nof32b_15:
    v_pk_mul_f32 v[8:9], v[24:25], s[84:85] op_sel:[0,0] op_sel_hi:[1,0]
    v_pk_mul_f32 v[10:11], v[24:25], s[84:85] op_sel:[0,1] op_sel_hi:[1,1]
    v_pk_mul_f32 v[12:13], v[24:25], s[86:87] op_sel:[0,0] op_sel_hi:[1,0]
    v_pk_mul_f32 v[14:15], v[24:25], s[86:87] op_sel:[0,1] op_sel_hi:[1,1]
    v_pk_fma_f32 v[8:9], v[26:27], s[88:89], v[8:9] op_sel:[0,0,0] op_sel_hi:[1,0,1]
    v_pk_fma_f32 v[10:11], v[26:27], s[88:89], v[10:11] op_sel:[0,1,0] op_sel_hi:[1,1,1]
    v_pk_fma_f32 v[12:13], v[26:27], s[90:91], v[12:13] op_sel:[0,0,0] op_sel_hi:[1,0,1]
    v_pk_fma_f32 v[14:15], v[26:27], s[90:91], v[14:15] op_sel:[0,1,0] op_sel_hi:[1,1,1]
    v_pk_fma_f32 v[8:9], v[28:29], s[92:93], v[8:9] op_sel:[0,0,0] op_sel_hi:[1,0,1]
    v_pk_fma_f32 v[10:11], v[28:29], s[92:93], v[10:11] op_sel:[0,1,0] op_sel_hi:[1,1,1]
    v_pk_fma_f32 v[12:13], v[28:29], s[94:95], v[12:13] op_sel:[0,0,0] op_sel_hi:[1,0,1]
    v_pk_fma_f32 v[14:15], v[28:29], s[94:95], v[14:15] op_sel:[0,1,0] op_sel_hi:[1,1,1]
    v_pk_fma_f32 v[8:9], v[30:31], s[96:97], v[8:9] op_sel:[0,0,0] op_sel_hi:[1,0,1]
    v_pk_fma_f32 v[10:11], v[30:31], s[96:97], v[10:11] op_sel:[0,1,0] op_sel_hi:[1,1,1]
    v_pk_fma_f32 v[12:13], v[30:31], s[98:99], v[12:13] op_sel:[0,0,0] op_sel_hi:[1,0,1]
    v_pk_fma_f32 v[14:15], v[30:31], s[98:99], v[14:15] op_sel:[0,1,0] op_sel_hi:[1,1,1]
    v_pk_mul_f32 v[8:9], v[8:9], v[72:73]
    v_pk_mul_f32 v[10:11], v[10:11], v[74:75]
    v_pk_mul_f32 v[12:13], v[12:13], v[76:77]
    v_pk_mul_f32 v[14:15], v[14:15], v[78:79]
    v_pk_mul_f32 v[24:25], v[8:9], s[28:29] op_sel:[0,0] op_sel_hi:[1,0]
    v_pk_mul_f32 v[26:27], v[8:9], s[28:29] op_sel:[0,1] op_sel_hi:[1,1]
    v_pk_mul_f32 v[28:29], v[8:9], s[30:31] op_sel:[0,0] op_sel_hi:[1,0]
    v_pk_mul_f32 v[30:31], v[8:9], s[30:31] op_sel:[0,1] op_sel_hi:[1,1]
    v_pk_fma_f32 v[24:25], v[10:11], s[32:33], v[24:25] op_sel:[0,0,0] op_sel_hi:[1,0,1]
    v_pk_fma_f32 v[26:27], v[10:11], s[32:33], v[26:27] op_sel:[0,1,0] op_sel_hi:[1,1,1]
    v_pk_fma_f32 v[28:29], v[10:11], s[34:35], v[28:29] op_sel:[0,0,0] op_sel_hi:[1,0,1]
    v_pk_fma_f32 v[30:31], v[10:11], s[34:35], v[30:31] op_sel:[0,1,0] op_sel_hi:[1,1,1]
    v_pk_fma_f32 v[24:25], v[12:13], s[36:37], v[24:25] op_sel:[0,0,0] op_sel_hi:[1,0,1]
    v_pk_fma_f32 v[26:27], v[12:13], s[36:37], v[26:27] op_sel:[0,1,0] op_sel_hi:[1,1,1]
    v_pk_fma_f32 v[28:29], v[12:13], s[38:39], v[28:29] op_sel:[0,0,0] op_sel_hi:[1,0,1]
    v_pk_fma_f32 v[30:31], v[12:13], s[38:39], v[30:31] op_sel:[0,1,0] op_sel_hi:[1,1,1]
    v_pk_fma_f32 v[24:25], v[14:15], s[40:41], v[24:25] op_sel:[0,0,0] op_sel_hi:[1,0,1]
    v_pk_fma_f32 v[26:27], v[14:15], s[40:41], v[26:27] op_sel:[0,1,0] op_sel_hi:[1,1,1]
    v_pk_fma_f32 v[28:29], v[14:15], s[42:43], v[28:29] op_sel:[0,0,0] op_sel_hi:[1,0,1]
    v_pk_fma_f32 v[30:31], v[14:15], s[42:43], v[30:31] op_sel:[0,1,0] op_sel_hi:[1,1,1]
    v_lshlrev_b32 v8, 16, v64
    v_and_b32 v10, 0xffff0000, v64
    v_lshlrev_b32 v12, 16, v65
    v_and_b32 v14, 0xffff0000, v65
    v_lshlrev_b32 v9, 16, v66
    v_and_b32 v11, 0xffff0000, v66
    v_lshlrev_b32 v13, 16, v67
    v_and_b32 v15, 0xffff0000, v67
    v_pk_fma_f32 v[8:9], v[24:25], v[80:81], v[8:9]
    v_pk_fma_f32 v[10:11], v[26:27], v[82:83], v[10:11]
    v_pk_fma_f32 v[12:13], v[28:29], v[84:85], v[12:13]
    v_pk_fma_f32 v[14:15], v[30:31], v[86:87], v[14:15]
    v_cvt_pk_bf16_f32 v16, v8, v10
    v_cvt_pk_bf16_f32 v17, v12, v14
    v_cvt_pk_bf16_f32 v18, v9, v11
    v_cvt_pk_bf16_f32 v19, v13, v15
    buffer_store_dwordx4 v[16:19], v1, s[16:19], s26 offen
    s_cmp_ge_u32 s13, 4
    s_cbranch_scc1 L_p2_f1
    s_bfe_u32 s14, s20, 262164
    s_cbranch_scc0 L_p2_kernel_nof32a_20
    s_add_u32 s14, s12, 0
    s_and_b32 s14, s14, 3
    s_add_u32 s14, s14, 20
    s_bitcmp1_b32 s20, s14
    s_cbranch_scc0 L_p2_kernel_q_21
    v_mov_b32 v88, 1073758208
    v_mov_b32 v89, 1073758208
    v_mov_b32 v90, 1073758208
    v_mov_b32 v91, 1073758208
L_p2_kernel_q_21:
    s_add_u32 s14, s12, 1
    s_and_b32 s14, s14, 3
    s_add_u32 s14, s14, 20
    s_bitcmp1_b32 s20, s14
    s_cbranch_scc0 L_p2_kernel_q_22
    v_mov_b32 v92, 1073758208
    v_mov_b32 v93, 1073758208
    v_mov_b32 v94, 1073758208
    v_mov_b32 v95, 1073758208
L_p2_kernel_q_22:
    s_add_u32 s14, s12, 2
    s_and_b32 s14, s14, 3
    s_add_u32 s14, s14, 20
    s_bitcmp1_b32 s20, s14
    s_cbranch_scc0 L_p2_kernel_q_23
    v_mov_b32 v96, 1073758208
    v_mov_b32 v97, 1073758208
    v_mov_b32 v98, 1073758208
    v_mov_b32 v99, 1073758208
L_p2_kernel_q_23:
    s_add_u32 s14, s12, 3
    s_and_b32 s14, s14, 3
    s_add_u32 s14, s14, 20
    s_bitcmp1_b32 s20, s14
    s_cbranch_scc0 L_p2_kernel_q_24
    v_mov_b32 v100, 1073758208
    v_mov_b32 v101, 1073758208
    v_mov_b32 v102, 1073758208
    v_mov_b32 v103, 1073758208
L_p2_kernel_q_24:
L_p2_kernel_nof32a_20:
    v_pk_add_u16 v88, v88, v92
    v_pk_add_u16 v96, v96, v100
    v_pk_add_u16 v89, v89, v93
    v_pk_add_u16 v97, v97, v101
    v_pk_add_u16 v90, v90, v94
    v_pk_add_u16 v98, v98, v102
    v_pk_add_u16 v91, v91, v95
    v_pk_add_u16 v99, v99, v103
    v_add_u32_sdwa v24, v88, v96 dst_sel:DWORD dst_unused:UNUSED_PAD src0_sel:WORD_0 src1_sel:WORD_0
    v_add_u32_sdwa v25, v90, v98 dst_sel:DWORD dst_unused:UNUSED_PAD src0_sel:WORD_0 src1_sel:WORD_0
    v_add_u32_sdwa v26, v88, v96 dst_sel:DWORD dst_unused:UNUSED_PAD src0_sel:WORD_1 src1_sel:WORD_1
    v_add_u32_sdwa v27, v90, v98 dst_sel:DWORD dst_unused:UNUSED_PAD src0_sel:WORD_1 src1_sel:WORD_1
    v_add_u32_sdwa v28, v89, v97 dst_sel:DWORD dst_unused:UNUSED_PAD src0_sel:WORD_0 src1_sel:WORD_0
    v_add_u32_sdwa v29, v91, v99 dst_sel:DWORD dst_unused:UNUSED_PAD src0_sel:WORD_0 src1_sel:WORD_0
    v_add_u32_sdwa v30, v89, v97 dst_sel:DWORD dst_unused:UNUSED_PAD src0_sel:WORD_1 src1_sel:WORD_1
    v_add_u32_sdwa v31, v91, v99 dst_sel:DWORD dst_unused:UNUSED_PAD src0_sel:WORD_1 src1_sel:WORD_1
    v_cvt_f32_u32 v24, v24
    v_cvt_f32_u32 v25, v25
    v_cvt_f32_u32 v26, v26
    v_cvt_f32_u32 v27, v27
    v_cvt_f32_u32 v28, v28
    v_cvt_f32_u32 v29, v29
    v_cvt_f32_u32 v30, v30
    v_cvt_f32_u32 v31, v31
    v_pk_fma_f32 v[24:25], v[24:25], s[44:45], s[44:45] op_sel:[0,0,1] op_sel_hi:[1,0,1]
    v_pk_fma_f32 v[26:27], v[26:27], s[44:45], s[44:45] op_sel:[0,0,1] op_sel_hi:[1,0,1]
    v_pk_fma_f32 v[28:29], v[28:29], s[44:45], s[44:45] op_sel:[0,0,1] op_sel_hi:[1,0,1]
    v_pk_fma_f32 v[30:31], v[30:31], s[44:45], s[44:45] op_sel:[0,0,1] op_sel_hi:[1,0,1]
    s_bfe_u32 s14, s20, 262164
    s_cbranch_scc0 L_p2_kernel_nof32b_25
    v_lshlrev_b32 v32, 1, v2
    s_bitcmp1_b32 s20, 20
    s_cbranch_scc0 L_p2_kernel_q_26
    s_lshl_b32 s15, s26, 1
    s_add_u32 s15, s15, 249069568
    buffer_load_dwordx4 v[88:91], v32, s[4:7], s15 offen sc1
    buffer_load_dwordx4 v[92:95], v32, s[4:7], s15 offen offset:16 sc1
    s_waitcnt vmcnt(0)
    v_add_f32 v24, v24, v88
    v_add_f32 v25, v25, v92
    v_add_f32 v26, v26, v89
    v_add_f32 v27, v27, v93
    v_add_f32 v28, v28, v90
    v_add_f32 v29, v29, v94
    v_add_f32 v30, v30, v91
    v_add_f32 v31, v31, v95
L_p2_kernel_q_26:
    s_bitcmp1_b32 s20, 21
    s_cbranch_scc0 L_p2_kernel_q_27
    s_lshl_b32 s15, s26, 1
    s_add_u32 s15, s15, 259309568
    buffer_load_dwordx4 v[88:91], v32, s[4:7], s15 offen sc1
    buffer_load_dwordx4 v[92:95], v32, s[4:7], s15 offen offset:16 sc1
    s_waitcnt vmcnt(0)
    v_add_f32 v24, v24, v88
    v_add_f32 v25, v25, v92
    v_add_f32 v26, v26, v89
    v_add_f32 v27, v27, v93
    v_add_f32 v28, v28, v90
    v_add_f32 v29, v29, v94
    v_add_f32 v30, v30, v91
    v_add_f32 v31, v31, v95
L_p2_kernel_q_27:
    s_bitcmp1_b32 s20, 22
    s_cbranch_scc0 L_p2_kernel_q_28
    s_lshl_b32 s15, s26, 1
    s_add_u32 s15, s15, 269549568
    buffer_load_dwordx4 v[88:91], v32, s[4:7], s15 offen sc1
    buffer_load_dwordx4 v[92:95], v32, s[4:7], s15 offen offset:16 sc1
    s_waitcnt vmcnt(0)
    v_add_f32 v24, v24, v88
    v_add_f32 v25, v25, v92
    v_add_f32 v26, v26, v89
    v_add_f32 v27, v27, v93
    v_add_f32 v28, v28, v90
    v_add_f32 v29, v29, v94
    v_add_f32 v30, v30, v91
    v_add_f32 v31, v31, v95
L_p2_kernel_q_28:
    s_bitcmp1_b32 s20, 23
    s_cbranch_scc0 L_p2_kernel_q_29
    s_lshl_b32 s15, s26, 1
    s_add_u32 s15, s15, 279789568
    buffer_load_dwordx4 v[88:91], v32, s[4:7], s15 offen sc1
    buffer_load_dwordx4 v[92:95], v32, s[4:7], s15 offen offset:16 sc1
    s_waitcnt vmcnt(0)
    v_add_f32 v24, v24, v88
    v_add_f32 v25, v25, v92
    v_add_f32 v26, v26, v89
    v_add_f32 v27, v27, v93
    v_add_f32 v28, v28, v90
    v_add_f32 v29, v29, v94
    v_add_f32 v30, v30, v91
    v_add_f32 v31, v31, v95
L_p2_kernel_q_29:
L_p2_kernel_nof32b_25:
    v_pk_mul_f32 v[88:89], v[24:25], s[84:85] op_sel:[0,0] op_sel_hi:[1,0]
    v_pk_mul_f32 v[90:91], v[24:25], s[84:85] op_sel:[0,1] op_sel_hi:[1,1]
    v_pk_mul_f32 v[92:93], v[24:25], s[86:87] op_sel:[0,0] op_sel_hi:[1,0]
    v_pk_mul_f32 v[94:95], v[24:25], s[86:87] op_sel:[0,1] op_sel_hi:[1,1]
    v_pk_fma_f32 v[88:89], v[26:27], s[88:89], v[88:89] op_sel:[0,0,0] op_sel_hi:[1,0,1]
    v_pk_fma_f32 v[90:91], v[26:27], s[88:89], v[90:91] op_sel:[0,1,0] op_sel_hi:[1,1,1]
    v_pk_fma_f32 v[92:93], v[26:27], s[90:91], v[92:93] op_sel:[0,0,0] op_sel_hi:[1,0,1]
    v_pk_fma_f32 v[94:95], v[26:27], s[90:91], v[94:95] op_sel:[0,1,0] op_sel_hi:[1,1,1]
    v_pk_fma_f32 v[88:89], v[28:29], s[92:93], v[88:89] op_sel:[0,0,0] op_sel_hi:[1,0,1]
    v_pk_fma_f32 v[90:91], v[28:29], s[92:93], v[90:91] op_sel:[0,1,0] op_sel_hi:[1,1,1]
    v_pk_fma_f32 v[92:93], v[28:29], s[94:95], v[92:93] op_sel:[0,0,0] op_sel_hi:[1,0,1]
    v_pk_fma_f32 v[94:95], v[28:29], s[94:95], v[94:95] op_sel:[0,1,0] op_sel_hi:[1,1,1]
    v_pk_fma_f32 v[88:89], v[30:31], s[96:97], v[88:89] op_sel:[0,0,0] op_sel_hi:[1,0,1]
    v_pk_fma_f32 v[90:91], v[30:31], s[96:97], v[90:91] op_sel:[0,1,0] op_sel_hi:[1,1,1]
    v_pk_fma_f32 v[92:93], v[30:31], s[98:99], v[92:93] op_sel:[0,0,0] op_sel_hi:[1,0,1]
    v_pk_fma_f32 v[94:95], v[30:31], s[98:99], v[94:95] op_sel:[0,1,0] op_sel_hi:[1,1,1]
    v_pk_mul_f32 v[88:89], v[88:89], v[112:113]
    v_pk_mul_f32 v[90:91], v[90:91], v[114:115]
    v_pk_mul_f32 v[92:93], v[92:93], v[116:117]
    v_pk_mul_f32 v[94:95], v[94:95], v[118:119]
    v_pk_mul_f32 v[24:25], v[88:89], s[28:29] op_sel:[0,0] op_sel_hi:[1,0]
    v_pk_mul_f32 v[26:27], v[88:89], s[28:29] op_sel:[0,1] op_sel_hi:[1,1]
    v_pk_mul_f32 v[28:29], v[88:89], s[30:31] op_sel:[0,0] op_sel_hi:[1,0]
    v_pk_mul_f32 v[30:31], v[88:89], s[30:31] op_sel:[0,1] op_sel_hi:[1,1]
    v_pk_fma_f32 v[24:25], v[90:91], s[32:33], v[24:25] op_sel:[0,0,0] op_sel_hi:[1,0,1]
    v_pk_fma_f32 v[26:27], v[90:91], s[32:33], v[26:27] op_sel:[0,1,0] op_sel_hi:[1,1,1]
    v_pk_fma_f32 v[28:29], v[90:91], s[34:35], v[28:29] op_sel:[0,0,0] op_sel_hi:[1,0,1]
    v_pk_fma_f32 v[30:31], v[90:91], s[34:35], v[30:31] op_sel:[0,1,0] op_sel_hi:[1,1,1]
    v_pk_fma_f32 v[24:25], v[92:93], s[36:37], v[24:25] op_sel:[0,0,0] op_sel_hi:[1,0,1]
    v_pk_fma_f32 v[26:27], v[92:93], s[36:37], v[26:27] op_sel:[0,1,0] op_sel_hi:[1,1,1]
    v_pk_fma_f32 v[28:29], v[92:93], s[38:39], v[28:29] op_sel:[0,0,0] op_sel_hi:[1,0,1]
    v_pk_fma_f32 v[30:31], v[92:93], s[38:39], v[30:31] op_sel:[0,1,0] op_sel_hi:[1,1,1]
    v_pk_fma_f32 v[24:25], v[94:95], s[40:41], v[24:25] op_sel:[0,0,0] op_sel_hi:[1,0,1]
    v_pk_fma_f32 v[26:27], v[94:95], s[40:41], v[26:27] op_sel:[0,1,0] op_sel_hi:[1,1,1]
    v_pk_fma_f32 v[28:29], v[94:95], s[42:43], v[28:29] op_sel:[0,0,0] op_sel_hi:[1,0,1]
    v_pk_fma_f32 v[30:31], v[94:95], s[42:43], v[30:31] op_sel:[0,1,0] op_sel_hi:[1,1,1]
    v_lshlrev_b32 v88, 16, v68
    v_and_b32 v90, 0xffff0000, v68
    v_lshlrev_b32 v92, 16, v69
    v_and_b32 v94, 0xffff0000, v69
    v_lshlrev_b32 v89, 16, v70
    v_and_b32 v91, 0xffff0000, v70
    v_lshlrev_b32 v93, 16, v71
    v_and_b32 v95, 0xffff0000, v71
    v_pk_fma_f32 v[88:89], v[24:25], v[120:121], v[88:89]
    v_pk_fma_f32 v[90:91], v[26:27], v[122:123], v[90:91]
    v_pk_fma_f32 v[92:93], v[28:29], v[124:125], v[92:93]
    v_pk_fma_f32 v[94:95], v[30:31], v[126:127], v[94:95]
    v_cvt_pk_bf16_f32 v96, v88, v90
    v_cvt_pk_bf16_f32 v97, v92, v94
    v_cvt_pk_bf16_f32 v98, v89, v91
    v_cvt_pk_bf16_f32 v99, v93, v95
    buffer_store_dwordx4 v[96:99], v2, s[16:19], s26 offen
L_p2_f1:
    s_bitset0_b32 s51, s49
    s_cmp_eq_u32 s51, 0
    s_cbranch_scc1 L_p2_done
    s_ff1_i32_b32 s49, s51
    s_lshl2_add_u32 s14, s3, s49
    s_mul_i32 s14, s14, 5000
    s_add_u32 s15, s14, 4096
    v_min_u32 v61, 225, v0
    v_lshl_add_u32 v60, v0, 2, s14
    v_lshl_add_u32 v61, v61, 2, s15
    global_load_dword v60, v60, s[100:101] nt
    global_load_dword v61, v61, s[100:101] nt
    s_waitcnt vmcnt(0)
    v_lshlrev_b32 v30, 16, v60
    v_and_b32 v31, 0xffff0000, v60
    v_lshlrev_b32 v36, 16, v53
    v_and_b32 v37, 0xffff0000, v53
    v_lshlrev_b32 v38, 16, v54
    v_and_b32 v39, 0xffff0000, v54
    v_lshlrev_b32 v40, 16, v56
    v_and_b32 v41, 0xffff0000, v56
    v_lshlrev_b32 v42, 16, v57
    v_and_b32 v43, 0xffff0000, v57
    v_pk_add_f32 v[14:15], v[30:31], v[36:37] op_sel:[0,0] op_sel_hi:[1,0] neg_lo:[0,1] neg_hi:[0,1]
    v_pk_add_f32 v[16:17], v[30:31], v[36:37] op_sel:[0,1] op_sel_hi:[1,1] neg_lo:[0,1] neg_hi:[0,1]
    v_pk_add_f32 v[18:19], v[30:31], v[38:39] op_sel:[0,0] op_sel_hi:[1,0] neg_lo:[0,1] neg_hi:[0,1]
    v_pk_add_f32 v[20:21], v[30:31], v[38:39] op_sel:[0,1] op_sel_hi:[1,1] neg_lo:[0,1] neg_hi:[0,1]
    v_pk_add_f32 v[22:23], v[30:31], v[40:41] op_sel:[0,0] op_sel_hi:[1,0] neg_lo:[0,1] neg_hi:[0,1]
    v_pk_add_f32 v[24:25], v[30:31], v[40:41] op_sel:[0,1] op_sel_hi:[1,1] neg_lo:[0,1] neg_hi:[0,1]
    v_pk_add_f32 v[26:27], v[30:31], v[42:43] op_sel:[0,0] op_sel_hi:[1,0] neg_lo:[0,1] neg_hi:[0,1]
    v_pk_add_f32 v[28:29], v[30:31], v[42:43] op_sel:[0,1] op_sel_hi:[1,1] neg_lo:[0,1] neg_hi:[0,1]
    v_cvt_pk_bf16_f32 v32, v14, v15
    v_lshlrev_b32 v14, 16, v32
    v_and_b32 v15, 0xffff0000, v32
    v_cvt_pk_bf16_f32 v32, v16, v17
    v_lshlrev_b32 v16, 16, v32
    v_and_b32 v17, 0xffff0000, v32
    v_cvt_pk_bf16_f32 v32, v18, v19
    v_lshlrev_b32 v18, 16, v32
    v_and_b32 v19, 0xffff0000, v32
    v_cvt_pk_bf16_f32 v32, v20, v21
    v_lshlrev_b32 v20, 16, v32
    v_and_b32 v21, 0xffff0000, v32
    v_cvt_pk_bf16_f32 v32, v22, v23
    v_lshlrev_b32 v22, 16, v32
    v_and_b32 v23, 0xffff0000, v32
    v_cvt_pk_bf16_f32 v32, v24, v25
    v_lshlrev_b32 v24, 16, v32
    v_and_b32 v25, 0xffff0000, v32
    v_cvt_pk_bf16_f32 v32, v26, v27
    v_lshlrev_b32 v26, 16, v32
    v_and_b32 v27, 0xffff0000, v32
    v_cvt_pk_bf16_f32 v32, v28, v29
    v_lshlrev_b32 v28, 16, v32
    v_and_b32 v29, 0xffff0000, v32
    v_pk_mul_f32 v[14:15], v[14:15], v[14:15]
    v_pk_mul_f32 v[16:17], v[16:17], v[16:17]
    v_pk_mul_f32 v[18:19], v[18:19], v[18:19]
    v_pk_mul_f32 v[20:21], v[20:21], v[20:21]
    v_pk_mul_f32 v[22:23], v[22:23], v[22:23]
    v_pk_mul_f32 v[24:25], v[24:25], v[24:25]
    v_pk_mul_f32 v[26:27], v[26:27], v[26:27]
    v_pk_mul_f32 v[28:29], v[28:29], v[28:29]
    v_cvt_pk_bf16_f32 v32, v14, v15
    v_lshlrev_b32 v14, 16, v32
    v_and_b32 v15, 0xffff0000, v32
    v_cvt_pk_bf16_f32 v32, v16, v17
    v_lshlrev_b32 v16, 16, v32
    v_and_b32 v17, 0xffff0000, v32
    v_cvt_pk_bf16_f32 v32, v18, v19
    v_lshlrev_b32 v18, 16, v32
    v_and_b32 v19, 0xffff0000, v32
    v_cvt_pk_bf16_f32 v32, v20, v21
    v_lshlrev_b32 v20, 16, v32
    v_and_b32 v21, 0xffff0000, v32
    v_cvt_pk_bf16_f32 v32, v22, v23
    v_lshlrev_b32 v22, 16, v32
    v_and_b32 v23, 0xffff0000, v32
    v_cvt_pk_bf16_f32 v32, v24, v25
    v_lshlrev_b32 v24, 16, v32
    v_and_b32 v25, 0xffff0000, v32
    v_cvt_pk_bf16_f32 v32, v26, v27
    v_lshlrev_b32 v26, 16, v32
    v_and_b32 v27, 0xffff0000, v32
    v_cvt_pk_bf16_f32 v32, v28, v29
    v_lshlrev_b32 v28, 16, v32
    v_and_b32 v29, 0xffff0000, v32
    v_mov_b32 v30, 1092616192
    v_mov_b32 v31, 0x3fb8aa3b
    v_pk_mul_f32 v[14:15], v[14:15], v[30:31] op_sel:[0,0] op_sel_hi:[1,0]
    v_pk_mul_f32 v[16:17], v[16:17], v[30:31] op_sel:[0,0] op_sel_hi:[1,0]
    v_pk_mul_f32 v[18:19], v[18:19], v[30:31] op_sel:[0,0] op_sel_hi:[1,0]
    v_pk_mul_f32 v[20:21], v[20:21], v[30:31] op_sel:[0,0] op_sel_hi:[1,0]
    v_pk_mul_f32 v[22:23], v[22:23], v[30:31] op_sel:[0,0] op_sel_hi:[1,0]
    v_pk_mul_f32 v[24:25], v[24:25], v[30:31] op_sel:[0,0] op_sel_hi:[1,0]
    v_pk_mul_f32 v[26:27], v[26:27], v[30:31] op_sel:[0,0] op_sel_hi:[1,0]
    v_pk_mul_f32 v[28:29], v[28:29], v[30:31] op_sel:[0,0] op_sel_hi:[1,0]
    v_cvt_pk_bf16_f32 v32, v14, v15
    v_lshlrev_b32 v14, 16, v32
    v_and_b32 v15, 0xffff0000, v32
    v_cvt_pk_bf16_f32 v32, v16, v17
    v_lshlrev_b32 v16, 16, v32
    v_and_b32 v17, 0xffff0000, v32
    v_cvt_pk_bf16_f32 v32, v18, v19
    v_lshlrev_b32 v18, 16, v32
    v_and_b32 v19, 0xffff0000, v32
    v_cvt_pk_bf16_f32 v32, v20, v21
    v_lshlrev_b32 v20, 16, v32
    v_and_b32 v21, 0xffff0000, v32
    v_cvt_pk_bf16_f32 v32, v22, v23
    v_lshlrev_b32 v22, 16, v32
    v_and_b32 v23, 0xffff0000, v32
    v_cvt_pk_bf16_f32 v32, v24, v25
    v_lshlrev_b32 v24, 16, v32
    v_and_b32 v25, 0xffff0000, v32
    v_cvt_pk_bf16_f32 v32, v26, v27
    v_lshlrev_b32 v26, 16, v32
    v_and_b32 v27, 0xffff0000, v32
    v_cvt_pk_bf16_f32 v32, v28, v29
    v_lshlrev_b32 v28, 16, v32
    v_and_b32 v29, 0xffff0000, v32
    v_pk_mul_f32 v[14:15], v[14:15], v[30:31] op_sel:[0,1] op_sel_hi:[1,1]
    v_pk_mul_f32 v[16:17], v[16:17], v[30:31] op_sel:[0,1] op_sel_hi:[1,1]
    v_pk_mul_f32 v[18:19], v[18:19], v[30:31] op_sel:[0,1] op_sel_hi:[1,1]
    v_pk_mul_f32 v[20:21], v[20:21], v[30:31] op_sel:[0,1] op_sel_hi:[1,1]
    v_pk_mul_f32 v[22:23], v[22:23], v[30:31] op_sel:[0,1] op_sel_hi:[1,1]
    v_pk_mul_f32 v[24:25], v[24:25], v[30:31] op_sel:[0,1] op_sel_hi:[1,1]
    v_pk_mul_f32 v[26:27], v[26:27], v[30:31] op_sel:[0,1] op_sel_hi:[1,1]
    v_pk_mul_f32 v[28:29], v[28:29], v[30:31] op_sel:[0,1] op_sel_hi:[1,1]
    v_exp_f32 v14, -v14
    v_exp_f32 v15, -v15
    v_exp_f32 v16, -v16
    v_exp_f32 v17, -v17
    v_exp_f32 v18, -v18
    v_exp_f32 v19, -v19
    v_exp_f32 v20, -v20
    v_exp_f32 v21, -v21
    v_exp_f32 v22, -v22
    v_exp_f32 v23, -v23
    v_exp_f32 v24, -v24
    v_exp_f32 v25, -v25
    v_exp_f32 v26, -v26
    v_exp_f32 v27, -v27
    v_exp_f32 v28, -v28
    v_exp_f32 v29, -v29
    v_cvt_pk_bf16_f32 v14, v14, v16
    v_cvt_pk_bf16_f32 v15, v15, v17
    v_cvt_pk_bf16_f32 v18, v18, v20
    v_cvt_pk_bf16_f32 v19, v19, v21
    v_cvt_pk_bf16_f32 v22, v22, v24
    v_cvt_pk_bf16_f32 v23, v23, v25
    v_cvt_pk_bf16_f32 v26, v26, v28
    v_cvt_pk_bf16_f32 v27, v27, v29
    v_dot2_f32_bf16 v72, v14, s68, 0
    v_dot2_f32_bf16 v73, v15, s68, 0
    v_dot2_f32_bf16 v74, v14, s69, 0
    v_dot2_f32_bf16 v75, v15, s69, 0
    v_dot2_f32_bf16 v76, v14, s70, 0
    v_dot2_f32_bf16 v77, v15, s70, 0
    v_dot2_f32_bf16 v78, v14, s71, 0
    v_dot2_f32_bf16 v79, v15, s71, 0
    v_dot2_f32_bf16 v80, v14, s52, 0
    v_dot2_f32_bf16 v81, v15, s52, 0
    v_dot2_f32_bf16 v82, v14, s53, 0
    v_dot2_f32_bf16 v83, v15, s53, 0
    v_dot2_f32_bf16 v84, v14, s54, 0
    v_dot2_f32_bf16 v85, v15, s54, 0
    v_dot2_f32_bf16 v86, v14, s55, 0
    v_dot2_f32_bf16 v87, v15, s55, 0
    v_dot2_f32_bf16 v72, v18, s72, v72
    v_dot2_f32_bf16 v73, v19, s72, v73
    v_dot2_f32_bf16 v74, v18, s73, v74
    v_dot2_f32_bf16 v75, v19, s73, v75
    v_dot2_f32_bf16 v76, v18, s74, v76
    v_dot2_f32_bf16 v77, v19, s74, v77
    v_dot2_f32_bf16 v78, v18, s75, v78
    v_dot2_f32_bf16 v79, v19, s75, v79
    v_dot2_f32_bf16 v80, v18, s56, v80
    v_dot2_f32_bf16 v81, v19, s56, v81
    v_dot2_f32_bf16 v82, v18, s57, v82
    v_dot2_f32_bf16 v83, v19, s57, v83
    v_dot2_f32_bf16 v84, v18, s58, v84
    v_dot2_f32_bf16 v85, v19, s58, v85
    v_dot2_f32_bf16 v86, v18, s59, v86
    v_dot2_f32_bf16 v87, v19, s59, v87
    v_dot2_f32_bf16 v72, v22, s76, v72
    v_dot2_f32_bf16 v73, v23, s76, v73
    v_dot2_f32_bf16 v74, v22, s77, v74
    v_dot2_f32_bf16 v75, v23, s77, v75
    v_dot2_f32_bf16 v76, v22, s78, v76
    v_dot2_f32_bf16 v77, v23, s78, v77
    v_dot2_f32_bf16 v78, v22, s79, v78
    v_dot2_f32_bf16 v79, v23, s79, v79
    v_dot2_f32_bf16 v80, v22, s60, v80
    v_dot2_f32_bf16 v81, v23, s60, v81
    v_dot2_f32_bf16 v82, v22, s61, v82
    v_dot2_f32_bf16 v83, v23, s61, v83
    v_dot2_f32_bf16 v84, v22, s62, v84
    v_dot2_f32_bf16 v85, v23, s62, v85
    v_dot2_f32_bf16 v86, v22, s63, v86
    v_dot2_f32_bf16 v87, v23, s63, v87
    v_dot2_f32_bf16 v72, v26, s80, v72
    v_dot2_f32_bf16 v73, v27, s80, v73
    v_dot2_f32_bf16 v74, v26, s81, v74
    v_dot2_f32_bf16 v75, v27, s81, v75
    v_dot2_f32_bf16 v76, v26, s82, v76
    v_dot2_f32_bf16 v77, v27, s82, v77
    v_dot2_f32_bf16 v78, v26, s83, v78
    v_dot2_f32_bf16 v79, v27, s83, v79
    v_dot2_f32_bf16 v80, v26, s64, v80
    v_dot2_f32_bf16 v81, v27, s64, v81
    v_dot2_f32_bf16 v82, v26, s65, v82
    v_dot2_f32_bf16 v83, v27, s65, v83
    v_dot2_f32_bf16 v84, v26, s66, v84
    v_dot2_f32_bf16 v85, v27, s66, v85
    v_dot2_f32_bf16 v86, v26, s67, v86
    v_dot2_f32_bf16 v87, v27, s67, v87
    s_cmp_ge_u32 s13, 4
    s_cbranch_scc1 L_p2_kernel_g1_30
    v_lshlrev_b32 v30, 16, v61
    v_and_b32 v31, 0xffff0000, v61
    v_pk_add_f32 v[14:15], v[30:31], v[36:37] op_sel:[0,0] op_sel_hi:[1,0] neg_lo:[0,1] neg_hi:[0,1]
    v_pk_add_f32 v[16:17], v[30:31], v[36:37] op_sel:[0,1] op_sel_hi:[1,1] neg_lo:[0,1] neg_hi:[0,1]
    v_pk_add_f32 v[18:19], v[30:31], v[38:39] op_sel:[0,0] op_sel_hi:[1,0] neg_lo:[0,1] neg_hi:[0,1]
    v_pk_add_f32 v[20:21], v[30:31], v[38:39] op_sel:[0,1] op_sel_hi:[1,1] neg_lo:[0,1] neg_hi:[0,1]
    v_pk_add_f32 v[22:23], v[30:31], v[40:41] op_sel:[0,0] op_sel_hi:[1,0] neg_lo:[0,1] neg_hi:[0,1]
    v_pk_add_f32 v[24:25], v[30:31], v[40:41] op_sel:[0,1] op_sel_hi:[1,1] neg_lo:[0,1] neg_hi:[0,1]
    v_pk_add_f32 v[26:27], v[30:31], v[42:43] op_sel:[0,0] op_sel_hi:[1,0] neg_lo:[0,1] neg_hi:[0,1]
    v_pk_add_f32 v[28:29], v[30:31], v[42:43] op_sel:[0,1] op_sel_hi:[1,1] neg_lo:[0,1] neg_hi:[0,1]
    v_cvt_pk_bf16_f32 v32, v14, v15
    v_lshlrev_b32 v14, 16, v32
    v_and_b32 v15, 0xffff0000, v32
    v_cvt_pk_bf16_f32 v32, v16, v17
    v_lshlrev_b32 v16, 16, v32
    v_and_b32 v17, 0xffff0000, v32
    v_cvt_pk_bf16_f32 v32, v18, v19
    v_lshlrev_b32 v18, 16, v32
    v_and_b32 v19, 0xffff0000, v32
    v_cvt_pk_bf16_f32 v32, v20, v21
    v_lshlrev_b32 v20, 16, v32
    v_and_b32 v21, 0xffff0000, v32
    v_cvt_pk_bf16_f32 v32, v22, v23
    v_lshlrev_b32 v22, 16, v32
    v_and_b32 v23, 0xffff0000, v32
    v_cvt_pk_bf16_f32 v32, v24, v25
    v_lshlrev_b32 v24, 16, v32
    v_and_b32 v25, 0xffff0000, v32
    v_cvt_pk_bf16_f32 v32, v26, v27
    v_lshlrev_b32 v26, 16, v32
    v_and_b32 v27, 0xffff0000, v32
    v_cvt_pk_bf16_f32 v32, v28, v29
    v_lshlrev_b32 v28, 16, v32
    v_and_b32 v29, 0xffff0000, v32
    v_pk_mul_f32 v[14:15], v[14:15], v[14:15]
    v_pk_mul_f32 v[16:17], v[16:17], v[16:17]
    v_pk_mul_f32 v[18:19], v[18:19], v[18:19]
    v_pk_mul_f32 v[20:21], v[20:21], v[20:21]
    v_pk_mul_f32 v[22:23], v[22:23], v[22:23]
    v_pk_mul_f32 v[24:25], v[24:25], v[24:25]
    v_pk_mul_f32 v[26:27], v[26:27], v[26:27]
    v_pk_mul_f32 v[28:29], v[28:29], v[28:29]
    v_cvt_pk_bf16_f32 v32, v14, v15
    v_lshlrev_b32 v14, 16, v32
    v_and_b32 v15, 0xffff0000, v32
    v_cvt_pk_bf16_f32 v32, v16, v17
    v_lshlrev_b32 v16, 16, v32
    v_and_b32 v17, 0xffff0000, v32
    v_cvt_pk_bf16_f32 v32, v18, v19
    v_lshlrev_b32 v18, 16, v32
    v_and_b32 v19, 0xffff0000, v32
    v_cvt_pk_bf16_f32 v32, v20, v21
    v_lshlrev_b32 v20, 16, v32
    v_and_b32 v21, 0xffff0000, v32
    v_cvt_pk_bf16_f32 v32, v22, v23
    v_lshlrev_b32 v22, 16, v32
    v_and_b32 v23, 0xffff0000, v32
    v_cvt_pk_bf16_f32 v32, v24, v25
    v_lshlrev_b32 v24, 16, v32
    v_and_b32 v25, 0xffff0000, v32
    v_cvt_pk_bf16_f32 v32, v26, v27
    v_lshlrev_b32 v26, 16, v32
    v_and_b32 v27, 0xffff0000, v32
    v_cvt_pk_bf16_f32 v32, v28, v29
    v_lshlrev_b32 v28, 16, v32
    v_and_b32 v29, 0xffff0000, v32
    v_mov_b32 v30, 1092616192
    v_mov_b32 v31, 0x3fb8aa3b
    v_pk_mul_f32 v[14:15], v[14:15], v[30:31] op_sel:[0,0] op_sel_hi:[1,0]
    v_pk_mul_f32 v[16:17], v[16:17], v[30:31] op_sel:[0,0] op_sel_hi:[1,0]
    v_pk_mul_f32 v[18:19], v[18:19], v[30:31] op_sel:[0,0] op_sel_hi:[1,0]
    v_pk_mul_f32 v[20:21], v[20:21], v[30:31] op_sel:[0,0] op_sel_hi:[1,0]
    v_pk_mul_f32 v[22:23], v[22:23], v[30:31] op_sel:[0,0] op_sel_hi:[1,0]
    v_pk_mul_f32 v[24:25], v[24:25], v[30:31] op_sel:[0,0] op_sel_hi:[1,0]
    v_pk_mul_f32 v[26:27], v[26:27], v[30:31] op_sel:[0,0] op_sel_hi:[1,0]
    v_pk_mul_f32 v[28:29], v[28:29], v[30:31] op_sel:[0,0] op_sel_hi:[1,0]
    v_cvt_pk_bf16_f32 v32, v14, v15
    v_lshlrev_b32 v14, 16, v32
    v_and_b32 v15, 0xffff0000, v32
    v_cvt_pk_bf16_f32 v32, v16, v17
    v_lshlrev_b32 v16, 16, v32
    v_and_b32 v17, 0xffff0000, v32
    v_cvt_pk_bf16_f32 v32, v18, v19
    v_lshlrev_b32 v18, 16, v32
    v_and_b32 v19, 0xffff0000, v32
    v_cvt_pk_bf16_f32 v32, v20, v21
    v_lshlrev_b32 v20, 16, v32
    v_and_b32 v21, 0xffff0000, v32
    v_cvt_pk_bf16_f32 v32, v22, v23
    v_lshlrev_b32 v22, 16, v32
    v_and_b32 v23, 0xffff0000, v32
    v_cvt_pk_bf16_f32 v32, v24, v25
    v_lshlrev_b32 v24, 16, v32
    v_and_b32 v25, 0xffff0000, v32
    v_cvt_pk_bf16_f32 v32, v26, v27
    v_lshlrev_b32 v26, 16, v32
    v_and_b32 v27, 0xffff0000, v32
    v_cvt_pk_bf16_f32 v32, v28, v29
    v_lshlrev_b32 v28, 16, v32
    v_and_b32 v29, 0xffff0000, v32
    v_pk_mul_f32 v[14:15], v[14:15], v[30:31] op_sel:[0,1] op_sel_hi:[1,1]
    v_pk_mul_f32 v[16:17], v[16:17], v[30:31] op_sel:[0,1] op_sel_hi:[1,1]
    v_pk_mul_f32 v[18:19], v[18:19], v[30:31] op_sel:[0,1] op_sel_hi:[1,1]
    v_pk_mul_f32 v[20:21], v[20:21], v[30:31] op_sel:[0,1] op_sel_hi:[1,1]
    v_pk_mul_f32 v[22:23], v[22:23], v[30:31] op_sel:[0,1] op_sel_hi:[1,1]
    v_pk_mul_f32 v[24:25], v[24:25], v[30:31] op_sel:[0,1] op_sel_hi:[1,1]
    v_pk_mul_f32 v[26:27], v[26:27], v[30:31] op_sel:[0,1] op_sel_hi:[1,1]
    v_pk_mul_f32 v[28:29], v[28:29], v[30:31] op_sel:[0,1] op_sel_hi:[1,1]
    v_exp_f32 v14, -v14
    v_exp_f32 v15, -v15
    v_exp_f32 v16, -v16
    v_exp_f32 v17, -v17
    v_exp_f32 v18, -v18
    v_exp_f32 v19, -v19
    v_exp_f32 v20, -v20
    v_exp_f32 v21, -v21
    v_exp_f32 v22, -v22
    v_exp_f32 v23, -v23
    v_exp_f32 v24, -v24
    v_exp_f32 v25, -v25
    v_exp_f32 v26, -v26
    v_exp_f32 v27, -v27
    v_exp_f32 v28, -v28
    v_exp_f32 v29, -v29
    v_cvt_pk_bf16_f32 v14, v14, v16
    v_cvt_pk_bf16_f32 v15, v15, v17
    v_cvt_pk_bf16_f32 v18, v18, v20
    v_cvt_pk_bf16_f32 v19, v19, v21
    v_cvt_pk_bf16_f32 v22, v22, v24
    v_cvt_pk_bf16_f32 v23, v23, v25
    v_cvt_pk_bf16_f32 v26, v26, v28
    v_cvt_pk_bf16_f32 v27, v27, v29
    v_dot2_f32_bf16 v112, v14, s68, 0
    v_dot2_f32_bf16 v113, v15, s68, 0
    v_dot2_f32_bf16 v114, v14, s69, 0
    v_dot2_f32_bf16 v115, v15, s69, 0
    v_dot2_f32_bf16 v116, v14, s70, 0
    v_dot2_f32_bf16 v117, v15, s70, 0
    v_dot2_f32_bf16 v118, v14, s71, 0
    v_dot2_f32_bf16 v119, v15, s71, 0
    v_dot2_f32_bf16 v120, v14, s52, 0
    v_dot2_f32_bf16 v121, v15, s52, 0
    v_dot2_f32_bf16 v122, v14, s53, 0
    v_dot2_f32_bf16 v123, v15, s53, 0
    v_dot2_f32_bf16 v124, v14, s54, 0
    v_dot2_f32_bf16 v125, v15, s54, 0
    v_dot2_f32_bf16 v126, v14, s55, 0
    v_dot2_f32_bf16 v127, v15, s55, 0
    v_dot2_f32_bf16 v112, v18, s72, v112
    v_dot2_f32_bf16 v113, v19, s72, v113
    v_dot2_f32_bf16 v114, v18, s73, v114
    v_dot2_f32_bf16 v115, v19, s73, v115
    v_dot2_f32_bf16 v116, v18, s74, v116
    v_dot2_f32_bf16 v117, v19, s74, v117
    v_dot2_f32_bf16 v118, v18, s75, v118
    v_dot2_f32_bf16 v119, v19, s75, v119
    v_dot2_f32_bf16 v120, v18, s56, v120
    v_dot2_f32_bf16 v121, v19, s56, v121
    v_dot2_f32_bf16 v122, v18, s57, v122
    v_dot2_f32_bf16 v123, v19, s57, v123
    v_dot2_f32_bf16 v124, v18, s58, v124
    v_dot2_f32_bf16 v125, v19, s58, v125
    v_dot2_f32_bf16 v126, v18, s59, v126
    v_dot2_f32_bf16 v127, v19, s59, v127
    v_dot2_f32_bf16 v112, v22, s76, v112
    v_dot2_f32_bf16 v113, v23, s76, v113
    v_dot2_f32_bf16 v114, v22, s77, v114
    v_dot2_f32_bf16 v115, v23, s77, v115
    v_dot2_f32_bf16 v116, v22, s78, v116
    v_dot2_f32_bf16 v117, v23, s78, v117
    v_dot2_f32_bf16 v118, v22, s79, v118
    v_dot2_f32_bf16 v119, v23, s79, v119
    v_dot2_f32_bf16 v120, v22, s60, v120
    v_dot2_f32_bf16 v121, v23, s60, v121
    v_dot2_f32_bf16 v122, v22, s61, v122
    v_dot2_f32_bf16 v123, v23, s61, v123
    v_dot2_f32_bf16 v124, v22, s62, v124
    v_dot2_f32_bf16 v125, v23, s62, v125
    v_dot2_f32_bf16 v126, v22, s63, v126
    v_dot2_f32_bf16 v127, v23, s63, v127
    v_dot2_f32_bf16 v112, v26, s80, v112
    v_dot2_f32_bf16 v113, v27, s80, v113
    v_dot2_f32_bf16 v114, v26, s81, v114
    v_dot2_f32_bf16 v115, v27, s81, v115
    v_dot2_f32_bf16 v116, v26, s82, v116
    v_dot2_f32_bf16 v117, v27, s82, v117
    v_dot2_f32_bf16 v118, v26, s83, v118
    v_dot2_f32_bf16 v119, v27, s83, v119
    v_dot2_f32_bf16 v120, v26, s64, v120
    v_dot2_f32_bf16 v121, v27, s64, v121
    v_dot2_f32_bf16 v122, v26, s65, v122
    v_dot2_f32_bf16 v123, v27, s65, v123
    v_dot2_f32_bf16 v124, v26, s66, v124
    v_dot2_f32_bf16 v125, v27, s66, v125
    v_dot2_f32_bf16 v126, v26, s67, v126
    v_dot2_f32_bf16 v127, v27, s67, v127
L_p2_kernel_g1_30:
    s_lshl2_add_u32 s14, s3, s49
    s_mul_i32 s26, s14, 20000
    s_mov_b32 s10, 5120000
    buffer_load_dwordx4 v[64:67], v1, s[8:11], s26 offen
    buffer_load_dwordx4 v[68:71], v2, s[8:11], s26 offen
    s_branch L_p2_fin
L_p2_done:
    s_branch L_p2_end
L_p2_slow:
    s_barrier
    v_mov_b32 v8, 0
    v_mov_b32 v9, 0
    v_mov_b32 v10, 0
    v_mov_b32 v11, 0
    v_mov_b32 v12, v1
    ds_write_b128 v12, v[8:11]
    v_add_u32 v12, 16384, v12
    ds_write_b128 v12, v[8:11]
    v_add_u32 v12, 16384, v12
    ds_write_b128 v12, v[8:11]
    v_add_u32 v12, 16384, v12
    ds_write_b128 v12, v[8:11]
    v_add_u32 v12, 16384, v12
    ds_write_b128 v12, v[8:11]
    v_add_u32 v12, 16384, v12
    ds_write_b128 v12, v[8:11]
    v_add_u32 v12, 16384, v12
    ds_write_b128 v12, v[8:11]
    v_add_u32 v12, 16384, v12
    ds_write_b128 v12, v[8:11]
    v_add_u32 v12, 16384, v12
    ds_write_b128 v12, v[8:11]
    v_add_u32 v12, 16384, v12
    ds_write_b128 v12, v[8:11]
    v_add_u32 v12, 16384, v12
    v_mul_u32_u24 v13, 8320, v0
    v_mov_b32 v29, 0x7fc00000
    v_add_u32 v28, 32, v13
    v_lshlrev_b32 v14, 10, v0
    v_add_u32 v14, 9437184, v14
    s_mul_i32 s25, s12, 65
    s_add_u32 s25, s25, s3
    s_lshl_b32 s25, s25, 5
    s_add_u32 s25, s25, 0
    s_lshl_b32 s50, s50, 1
    s_mul_i32 s22, s12, 1280000
    s_mov_b32 s24, 0
    s_waitcnt lgkmcnt(0)
    s_barrier
L_p2_sstep:
    buffer_load_ushort v15, v13, s[4:7], s25 offen
    buffer_load_ushort v16, v28, s[4:7], s25 offen
    s_waitcnt vmcnt(0)
L_p2_srec:
    v_cmp_lt_u32 vcc, v15, v16
    s_nop 1
    s_and_b64 exec, exec, vcc
    s_cbranch_execz L_p2_sdone
    v_mul_u32_u24 v17, 43691, v15
    v_lshrrev_b32 v17, 17, v17
    v_mad_i32_i24 v18, v17, -3, v15
    v_lshrrev_b32 v19, 6, v17
    v_lshl_add_u32 v19, v19, 20, v14
    v_and_b32 v17, 63, v17
    v_lshl_add_u32 v17, v17, 4, v19
    v_lshl_add_u32 v19, v18, 2, v17
    buffer_load_dword v20, v19, s[4:7], 0 offen
    buffer_load_dword v21, v17, s[4:7], 0 offen offset:12
    v_add_u32 v15, 1, v15
    v_mad_u32_u24 v18, v18, 10, 2
    s_waitcnt vmcnt(0)
    v_and_b32 v19, 0x3fff, v20
    v_lshlrev_b32 v19, 3, v19
    buffer_load_dwordx2 v[22:23], v19, s[8:11], s22 offen
    v_mad_u32_u16 v20, v20, 16, s50 op_sel:[1,0,0,0]
    v_bfe_i32 v21, v21, v18, 10
    v_cmp_eq_i32 vcc, -512, v21
    v_cvt_f32_i32 v21, v21
    v_mul_f32 v21, 989872160, v21
    v_cndmask_b32 v21, v21, v29, vcc
    s_waitcnt vmcnt(0)
    v_lshlrev_b32 v24, 16, v22
    v_and_b32 v25, 0xffff0000, v22
    v_lshlrev_b32 v26, 16, v23
    v_and_b32 v27, 0xffff0000, v23
    v_mul_f32 v24, v21, v24
    v_mul_f32 v25, v21, v25
    v_mul_f32 v26, v21, v26
    v_mul_f32 v27, v21, v27
    ds_add_f32 v20, v24
    ds_add_f32 v20, v25 offset:4
    ds_add_f32 v20, v26 offset:8
    ds_add_f32 v20, v27 offset:12
    s_branch L_p2_srec
L_p2_sdone:
    s_mov_b64 exec, -1
    s_add_u32 s25, s25, 2
    s_add_u32 s22, s22, 80000
    s_add_u32 s24, s24, 1
    s_cmp_lt_u32 s24, 16
    s_cbranch_scc1 L_p2_sstep
    s_waitcnt lgkmcnt(0)
    s_barrier
    s_mul_i32 s14, s12, 10240000
    s_mul_i32 s15, s3, 160000
    s_add_u32 s26, s14, s15
    s_add_u32 s26, s26, 249069568
    v_mov_b32 v12, v1
    s_mov_b32 s24, 0
L_p2_sout:
    v_cmp_gt_u32 vcc, 160000, v12
    ds_read_b128 v[8:11], v12
    s_nop 0
    s_and_b64 exec, exec, vcc
    s_cbranch_execz L_p2_sfin
    s_waitcnt lgkmcnt(0)
    buffer_store_dwordx4 v[8:11], v12, s[4:7], s26 offen sc1
    s_waitcnt vmcnt(0)
    v_add_u32 v12, 16384, v12
    s_branch L_p2_sout
L_p2_sfin:
    s_mov_b64 exec, -1
    s_waitcnt vmcnt(0) lgkmcnt(0)
    s_barrier
    s_branch L_p2_signal
L_p2_end:
    s_endpgm
.section .rodata,"a"
.p2align 6
.amdhsa_kernel p1_kernel
  .amdhsa_next_free_vgpr 128
  .amdhsa_next_free_sgpr 96
  .amdhsa_accum_offset 128
  .amdhsa_group_segment_fixed_size 0
  .amdhsa_kernarg_size 112
  .amdhsa_user_sgpr_count 2
  .amdhsa_user_sgpr_kernarg_segment_ptr 1
  .amdhsa_system_sgpr_workgroup_id_x 1
  .amdhsa_float_denorm_mode_32 0
.end_amdhsa_kernel
.p2align 6
.amdhsa_kernel p2_kernel
  .amdhsa_next_free_vgpr 128
  .amdhsa_next_free_sgpr 102
  .amdhsa_accum_offset 128
  .amdhsa_group_segment_fixed_size 0
  .amdhsa_kernarg_size 112
  .amdhsa_user_sgpr_count 2
  .amdhsa_user_sgpr_kernarg_segment_ptr 1
  .amdhsa_system_sgpr_workgroup_id_x 1
  .amdhsa_float_denorm_mode_32 0
.end_amdhsa_kernel
```

```asm
; @launch kernel=p1_kernel grid=(256,1,1) block=(1024,1,1) lds=163840
; @launch kernel=p2_kernel grid=(256,1,1) block=(1024,1,1) lds=163840
.amdgcn_target "amdgcn-amd-amdhsa--gfx950"
.text
.globl p1_kernel
.p2align 8
.type p1_kernel,@function
p1_kernel:
    s_cmp_ge_u32 s2, 256
    s_cbranch_scc1 L_p1_end
    s_load_dwordx2 s[4:5], s[0:1], 104
    s_load_dwordx2 s[8:9], s[0:1], 8
    s_load_dwordx2 s[12:13], s[0:1], 16
    s_load_dwordx2 s[16:17], s[0:1], 32
    s_load_dwordx2 s[28:29], s[0:1], 0
    s_load_dwordx2 s[6:7], s[0:1], 48
    v_cmp_gt_u32 vcc, 256, v0
    s_nop 1
    s_cbranch_vccz L_p1_nopf
    s_getpc_b64 s[72:73]
L_p1_kernel_pc_1:
    s_add_u32 s72, s72, L_p1_nopf-L_p1_kernel_pc_1
    s_addc_u32 s73, s73, 0
    v_lshlrev_b32 v14, 7, v0
    v_min_u32 v14, L_p2_end-L_p1_nopf, v14
    global_load_dword v15, v14, s[72:73]
L_p1_nopf:
    v_lshlrev_b32 v1, 4, v0
    v_lshlrev_b32 v2, 3, v0
    v_lshrrev_b32 v6, 6, v0
    v_mul_u32_u24 v3, 851904, v6
    v_add_lshl_u32 v3, v3, v0, 4
    v_mov_b32 v4, 1
    v_mov_b32 v5, 0
    v_readfirstlane_b32 s39, v6
    v_cmp_gt_u32 vcc, 784, v0
    s_and_b32 s51, s2, 7
    s_lshl_b32 s51, s51, 0
    s_bfe_u32 s35, s2, 3
    s_add_u32 s51, s51, s35
    s_and_b32 s35, s2, 248
    s_add_u32 s51, s51, s35
    s_and_b32 s32, s2, 7
    s_lshl_b32 s32, s32, 2
    s_bfe_u32 s35, s2, 131075
    s_add_u32 s32, s32, s35
    s_and_b32 s35, s2, 224
    s_add_u32 s32, s32, s35
    s_lshr_b32 s35, s39, 4
    s_mul_i32 s36, s35, 4177920
    s_lshl_b32 s33, s51, 14
    s_add_u32 s33, s33, s36
    s_lshr_b32 s34, s33, 1
    s_mul_i32 s48, s51, 3840
    s_cmp_ge_u32 s35, 0
    s_cselect_b32 s48, s48, 0
    s_lshr_b32 s49, s48, 1
    s_mov_b64 s[44:45], vcc
    s_waitcnt lgkmcnt(0)
    s_load_dword s3, s[6:7], 0
    s_mov_b32 s10, 163840000
    s_mov_b32 s11, 0x00020000
    s_mov_b32 s14, 163840000
    s_mov_b32 s15, 0x00020000
    s_mov_b32 s18, 81920000
    s_mov_b32 s19, 0x00020000
    s_mul_i32 s36, s2, 20000
    s_add_u32 s30, s36, 20000
    s_mov_b32 s31, 0x00020000
    s_add_u32 s35, s36, 16384
    buffer_load_dwordx4 v[48:51], v1, s[28:31], s36 offen
    buffer_load_dwordx4 v[52:55], v1, s[28:31], s35 offen
    s_add_u32 s35, s33, 0
    buffer_load_dwordx4 v[16:19], v1, s[8:11], s35 offen nt
    s_add_u32 s35, s33, 0
    buffer_load_dwordx4 v[20:23], v1, s[12:15], s35 offen nt
    s_add_u32 s35, s33, 4194304
    buffer_load_dwordx4 v[24:27], v1, s[8:11], s35 offen nt
    s_add_u32 s35, s33, 4194304
    buffer_load_dwordx4 v[28:31], v1, s[12:15], s35 offen nt
    s_add_u32 s35, s33, 8388608
    buffer_load_dwordx4 v[32:35], v1, s[8:11], s35 offen nt
    s_add_u32 s35, s33, 8388608
    buffer_load_dwordx4 v[36:39], v1, s[12:15], s35 offen nt
    s_add_u32 s35, s33, 12582912
    buffer_load_dwordx4 v[40:43], v1, s[8:11], s35 offen nt
    s_add_u32 s35, s33, 12582912
    buffer_load_dwordx4 v[44:47], v1, s[12:15], s35 offen nt
    s_add_u32 s35, s33, 16777216
    buffer_load_dwordx4 v[72:75], v1, s[8:11], s35 offen nt
    s_add_u32 s35, s33, 16777216
    buffer_load_dwordx4 v[76:79], v1, s[12:15], s35 offen nt
    s_mov_b32 s20, s4
    s_mov_b32 s21, s5
    s_mov_b32 s22, 0
    s_mov_b32 s23, 0x00020000
    s_add_u32 s24, s4, 0
    s_addc_u32 s25, s5, 0
    s_mov_b32 s26, 8540160
    s_mov_b32 s27, 0x00020000
    s_mov_b32 s37, 1492179184
    s_mov_b32 s55, 0
    s_mov_b64 s[72:73], s[4:5]
    s_mov_b32 s74, 0
    s_mov_b32 s75, 0x00020000
    s_mov_b32 s50, 21845
    s_mov_b32 s52, 0x8000
    s_mov_b32 s38, 262400
    s_mov_b32 s43, 0x05040100
    s_mov_b32 s40, 0
    v_mov_b32 v8, 0
    v_mov_b32 v9, 0
    v_mov_b32 v10, 0
    v_mov_b32 v11, 0
    ds_write_b128 v1, v[8:11] offset:0
    v_min_u32 v7, 16, v0
    v_lshlrev_b32 v7, 2, v7
    v_add_u32 v7, 160768, v7
    ds_write_b32 v7, v8
    s_waitcnt lgkmcnt(0)
    s_lshl_b32 s3, s3, 16
    v_mov_b32 v12, s3
    v_mul_f32 v12, 0.15915494, v12
    s_nop 0
    v_readfirstlane_b32 s41, v12
    s_waitcnt vmcnt(10)
    v_mov_b32 v12, 0x3f803f80
    v_and_b32 v48, 0x7fff7fff, v48
    v_and_b32 v49, 0x7fff7fff, v49
    v_and_b32 v50, 0x7fff7fff, v50
    v_and_b32 v51, 0x7fff7fff, v51
    v_and_b32 v52, 0x7fff7fff, v52
    v_and_b32 v53, 0x7fff7fff, v53
    v_and_b32 v54, 0x7fff7fff, v54
    v_and_b32 v55, 0x7fff7fff, v55
    v_pk_max_u16 v8, v8, v48
    v_dot2c_f32_bf16 v9, v48, v12
    v_pk_max_u16 v8, v8, v49
    v_dot2c_f32_bf16 v9, v49, v12
    v_pk_max_u16 v8, v8, v50
    v_dot2c_f32_bf16 v9, v50, v12
    v_pk_max_u16 v8, v8, v51
    v_dot2c_f32_bf16 v9, v51, v12
    v_pk_max_u16 v8, v8, v52
    v_dot2c_f32_bf16 v9, v52, v12
    v_pk_max_u16 v8, v8, v53
    v_dot2c_f32_bf16 v9, v53, v12
    v_pk_max_u16 v8, v8, v54
    v_dot2c_f32_bf16 v9, v54, v12
    v_pk_max_u16 v8, v8, v55
    v_dot2c_f32_bf16 v9, v55, v12
    v_lshrrev_b32 v10, 16, v8
    v_and_b32 v8, 0xffff, v8
    v_max_u32 v8, v8, v10
    s_nop 0
    s_nop 1
    v_max_u32_dpp v8, v8, v8 row_shr:1 row_mask:0xf bank_mask:0xf bound_ctrl:0
    s_nop 1
    v_max_u32_dpp v8, v8, v8 row_shr:2 row_mask:0xf bank_mask:0xf bound_ctrl:0
    s_nop 1
    v_max_u32_dpp v8, v8, v8 row_shr:4 row_mask:0xf bank_mask:0xf bound_ctrl:0
    s_nop 1
    v_max_u32_dpp v8, v8, v8 row_shr:8 row_mask:0xf bank_mask:0xf bound_ctrl:0
    s_nop 1
    v_max_u32_dpp v8, v8, v8 row_bcast:15 row_mask:0xa bank_mask:0xf
    s_nop 1
    v_max_u32_dpp v8, v8, v8 row_bcast:31 row_mask:0xc bank_mask:0xf
    s_nop 1
    v_add_f32_dpp v9, v9, v9 row_shr:1 row_mask:0xf bank_mask:0xf bound_ctrl:0
    s_nop 1
    v_add_f32_dpp v9, v9, v9 row_shr:2 row_mask:0xf bank_mask:0xf bound_ctrl:0
    s_nop 1
    v_add_f32_dpp v9, v9, v9 row_shr:4 row_mask:0xf bank_mask:0xf bound_ctrl:0
    s_nop 1
    v_add_f32_dpp v9, v9, v9 row_shr:8 row_mask:0xf bank_mask:0xf bound_ctrl:0
    s_nop 1
    v_add_f32_dpp v9, v9, v9 row_bcast:15 row_mask:0xa bank_mask:0xf
    s_nop 1
    v_add_f32_dpp v9, v9, v9 row_bcast:31 row_mask:0xc bank_mask:0xf
    s_lshl_b32 s35, s39, 4
    s_add_u32 s35, s35, 160320
    v_mov_b32 v10, s35
    s_mov_b32 exec_lo, 0
    s_brev_b32 exec_hi, 1
    ds_write_b64 v10, v[8:9]
    s_mov_b64 exec, -1
    s_waitcnt lgkmcnt(0)
    s_barrier
    s_branch L_p1_first
L_p1_loop:
    s_mov_b64 s[72:73], s[20:21]
    s_mov_b32 s74, s22
    s_getreg_b32 s51, hwreg(HW_REG_XCC_ID, 0, 1)
    s_cmp_eq_u32 s51, 0
    s_cselect_b64 vcc, -1, 0
    s_cmp_lg_u32 s39, 15
    s_cbranch_scc1 L_p1_kernel_nox_2
    s_waitcnt lgkmcnt(13)
    v_lshlrev_b32 v15, 16, v120
    v_and_b32 v120, 0xffff0000, v120
    v_lshlrev_b32 v121, 16, v121
    v_mul_f32 v15, s41, v15
    v_mul_f32 v120, s41, v120
    v_mul_f32 v121, s41, v121
    v_fract_f32 v15, v15
    v_fract_f32 v120, v120
    v_fract_f32 v121, v121
    v_cos_f32 v15, v15
    v_cos_f32 v120, v120
    v_cos_f32 v121, v121
    v_fmaak_f32 v15, v10, v15, 1262486016
    v_fmaak_f32 v120, v10, v120, 1262486016
    v_fmaak_f32 v121, v10, v121, 1262486016
    v_lshlrev_b32 v15, 22, v15
    v_alignbit_b32 v15, v120, v15, 10
    v_alignbit_b32 v15, v121, v15, 10
    v_xor_b32 v15, 0x80200800, v15
    s_mov_b32 s36, 13631488
    buffer_store_dwordx4 v[12:15], v3, s[20:23], s36 offen sc1
L_p1_kernel_nox_2:
    s_waitcnt lgkmcnt(12)
    v_lshlrev_b32 v75, 16, v122
    v_and_b32 v122, 0xffff0000, v122
    v_lshlrev_b32 v123, 16, v123
    v_mul_f32 v75, s41, v75
    v_mul_f32 v122, s41, v122
    v_mul_f32 v123, s41, v123
    v_fract_f32 v75, v75
    v_fract_f32 v122, v122
    v_fract_f32 v123, v123
    v_cos_f32 v75, v75
    v_cos_f32 v122, v122
    v_cos_f32 v123, v123
    v_fmaak_f32 v75, v10, v75, 1262486016
    v_fmaak_f32 v122, v10, v122, 1262486016
    v_fmaak_f32 v123, v10, v123, 1262486016
    v_lshlrev_b32 v75, 22, v75
    v_alignbit_b32 v75, v122, v75, 10
    v_alignbit_b32 v75, v123, v75, 10
    v_xor_b32 v75, 0x80200800, v75
    s_mov_b32 s36, 0
    buffer_store_dwordx4 v[72:75], v3, s[20:23], s36 offen sc1
    s_waitcnt lgkmcnt(11)
    v_lshlrev_b32 v79, 16, v124
    v_and_b32 v124, 0xffff0000, v124
    v_lshlrev_b32 v125, 16, v125
    v_mul_f32 v79, s41, v79
    v_mul_f32 v124, s41, v124
    v_mul_f32 v125, s41, v125
    v_fract_f32 v79, v79
    v_fract_f32 v124, v124
    v_fract_f32 v125, v125
    v_cos_f32 v79, v79
    v_cos_f32 v124, v124
    v_cos_f32 v125, v125
    v_fmaak_f32 v79, v10, v79, 1262486016
    v_fmaak_f32 v124, v10, v124, 1262486016
    v_fmaak_f32 v125, v10, v125, 1262486016
    v_lshlrev_b32 v79, 22, v79
    v_alignbit_b32 v79, v124, v79, 10
    v_alignbit_b32 v79, v125, v79, 10
    v_xor_b32 v79, 0x80200800, v79
    s_mov_b32 s36, 1048576
    buffer_store_dwordx4 v[76:79], v3, s[20:23], s36 offen sc1
    s_waitcnt lgkmcnt(0)
    v_lshlrev_b32 v51, 16, v126
    v_and_b32 v126, 0xffff0000, v126
    v_lshlrev_b32 v127, 16, v127
    v_mul_f32 v51, s41, v51
    v_mul_f32 v126, s41, v126
    v_mul_f32 v127, s41, v127
    v_fract_f32 v51, v51
    v_fract_f32 v126, v126
    v_fract_f32 v127, v127
    v_cos_f32 v51, v51
    v_cos_f32 v126, v126
    v_cos_f32 v127, v127
    v_fmaak_f32 v51, v10, v51, 1262486016
    v_fmaak_f32 v126, v10, v126, 1262486016
    v_fmaak_f32 v127, v10, v127, 1262486016
    v_lshlrev_b32 v51, 22, v51
    v_alignbit_b32 v51, v126, v51, 10
    v_alignbit_b32 v51, v127, v51, 10
    v_xor_b32 v51, 0x80200800, v51
    s_mov_b32 s36, 2097152
    buffer_store_dwordx4 v[48:51], v3, s[20:23], s36 offen sc1
    s_add_u32 s35, s33, 16777216
    buffer_load_dwordx4 v[72:75], v1, s[8:11], s35 offen nt
    s_add_u32 s35, s33, 16777216
    buffer_load_dwordx4 v[76:79], v1, s[12:15], s35 offen nt
    s_cbranch_vccz L_p1_kernel_thr_3
    s_waitcnt vmcnt(2)
L_p1_kernel_thr_3:
    s_waitcnt vmcnt(11)
    v_perm_b32 v6, v20, v16, s43
    v_perm_b32 v7, v21, v17, s43
    v_perm_b32 v8, v22, v18, s43
    v_perm_b32 v9, v23, v19, s43
    v_mul_hi_u32_u24 v16, 429497, v16
    v_mul_hi_u32_u24 v20, 429497, v20
    v_mul_hi_u32_u24 v17, 429497, v17
    v_mul_hi_u32_u24 v21, 429497, v21
    v_mul_hi_u32_u24 v18, 429497, v18
    v_mul_hi_u32_u24 v22, 429497, v22
    v_mul_hi_u32_u24 v19, 429497, v19
    v_mul_hi_u32_u24 v23, 429497, v23
    v_lshl_or_b32 v16, v20, 16, v16
    v_lshl_or_b32 v17, v21, 16, v17
    v_lshl_or_b32 v18, v22, 16, v18
    v_lshl_or_b32 v19, v23, 16, v19
    v_dot2_u32_u16 v20, v16, s38, 0
    v_dot2_u32_u16 v21, v17, s38, 0
    v_dot2_u32_u16 v22, v18, s38, 0
    v_dot2_u32_u16 v23, v19, s38, 0
    v_pk_mad_u16 v6, v16, s37, v6
    v_pk_mad_u16 v7, v17, s37, v7
    v_pk_mad_u16 v8, v18, s37, v8
    v_pk_mad_u16 v9, v19, s37, v9
    ds_add_u32 v20, v4 offset:0
    ds_add_u32 v21, v4 offset:0
    ds_add_u32 v22, v4 offset:0
    ds_add_u32 v23, v4 offset:0
    v_pk_mad_u16 v6, v16, s52, v6 op_sel:[1,0,0] op_sel_hi:[1,1,1]
    v_pk_mad_u16 v7, v17, s52, v7 op_sel:[1,0,0] op_sel_hi:[1,1,1]
    v_pk_mad_u16 v8, v18, s52, v8 op_sel:[1,0,0] op_sel_hi:[1,1,1]
    v_pk_mad_u16 v9, v19, s52, v9 op_sel:[1,0,0] op_sel_hi:[1,1,1]
    v_perm_b32 v121, v23, v22, s43
    v_perm_b32 v120, v21, v20, s43
    v_or_b32 v127, 0x40000000, v6
    v_or_b32 v48, 0x40000000, v7
    v_or_b32 v49, 0x40000000, v8
    v_or_b32 v50, 0x40000000, v9
    v_lshlrev_b32 v83, 16, v100
    v_and_b32 v100, 0xffff0000, v100
    v_lshlrev_b32 v101, 16, v101
    v_mul_f32 v83, s41, v83
    v_mul_f32 v100, s41, v100
    v_mul_f32 v101, s41, v101
    v_fract_f32 v83, v83
    v_fract_f32 v100, v100
    v_fract_f32 v101, v101
    v_cos_f32 v83, v83
    v_cos_f32 v100, v100
    v_cos_f32 v101, v101
    v_fmaak_f32 v83, v10, v83, 1262486016
    v_fmaak_f32 v100, v10, v100, 1262486016
    v_fmaak_f32 v101, v10, v101, 1262486016
    v_lshlrev_b32 v83, 22, v83
    v_alignbit_b32 v83, v100, v83, 10
    v_alignbit_b32 v83, v101, v83, 10
    v_xor_b32 v83, 0x80200800, v83
    s_mov_b32 s36, 3145728
    buffer_store_dwordx4 v[80:83], v3, s[20:23], s36 offen sc1
    v_lshlrev_b32 v55, 16, v102
    v_and_b32 v102, 0xffff0000, v102
    v_lshlrev_b32 v103, 16, v103
    v_mul_f32 v55, s41, v55
    v_mul_f32 v102, s41, v102
    v_mul_f32 v103, s41, v103
    v_fract_f32 v55, v55
    v_fract_f32 v102, v102
    v_fract_f32 v103, v103
    v_cos_f32 v55, v55
    v_cos_f32 v102, v102
    v_cos_f32 v103, v103
    v_fmaak_f32 v55, v10, v55, 1262486016
    v_fmaak_f32 v102, v10, v102, 1262486016
    v_fmaak_f32 v103, v10, v103, 1262486016
    v_lshlrev_b32 v55, 22, v55
    v_alignbit_b32 v55, v102, v55, 10
    v_alignbit_b32 v55, v103, v55, 10
    v_xor_b32 v55, 0x80200800, v55
    s_cmp_lg_u32 s40, 3
    s_cbranch_scc1 L_p1_kernel_now_4
    v_mov_b64 v[16:17], v[52:53]
    v_mov_b64 v[18:19], v[54:55]
    s_branch L_p1_kernel_held_5
L_p1_kernel_now_4:
    s_mov_b32 s36, 4194304
    buffer_store_dwordx4 v[52:55], v3, s[20:23], s36 offen sc1
L_p1_kernel_held_5:
    s_add_u32 s35, s33, 20971520
    buffer_load_dwordx4 v[80:83], v1, s[8:11], s35 offen nt
    s_add_u32 s35, s33, 20971520
    buffer_load_dwordx4 v[100:103], v1, s[12:15], s35 offen nt
    s_cbranch_vccz L_p1_kernel_thr_6
    s_waitcnt vmcnt(2)
L_p1_kernel_thr_6:
    v_lshlrev_b32 v87, 16, v104
    v_and_b32 v104, 0xffff0000, v104
    v_lshlrev_b32 v105, 16, v105
    v_mul_f32 v87, s41, v87
    v_mul_f32 v104, s41, v104
    v_mul_f32 v105, s41, v105
    v_fract_f32 v87, v87
    v_fract_f32 v104, v104
    v_fract_f32 v105, v105
    v_cos_f32 v87, v87
    v_cos_f32 v104, v104
    v_cos_f32 v105, v105
    v_fmaak_f32 v87, v10, v87, 1262486016
    v_fmaak_f32 v104, v10, v104, 1262486016
    v_fmaak_f32 v105, v10, v105, 1262486016
    v_lshlrev_b32 v87, 22, v87
    v_alignbit_b32 v87, v104, v87, 10
    v_alignbit_b32 v87, v105, v87, 10
    v_xor_b32 v87, 0x80200800, v87
    s_mov_b32 s36, 5242880
    buffer_store_dwordx4 v[84:87], v3, s[20:23], s36 offen sc1
    v_lshlrev_b32 v59, 16, v106
    v_and_b32 v106, 0xffff0000, v106
    v_lshlrev_b32 v107, 16, v107
    v_mul_f32 v59, s41, v59
    v_mul_f32 v106, s41, v106
    v_mul_f32 v107, s41, v107
    v_fract_f32 v59, v59
    v_fract_f32 v106, v106
    v_fract_f32 v107, v107
    v_cos_f32 v59, v59
    v_cos_f32 v106, v106
    v_cos_f32 v107, v107
    v_fmaak_f32 v59, v10, v59, 1262486016
    v_fmaak_f32 v106, v10, v106, 1262486016
    v_fmaak_f32 v107, v10, v107, 1262486016
    v_lshlrev_b32 v59, 22, v59
    v_alignbit_b32 v59, v106, v59, 10
    v_alignbit_b32 v59, v107, v59, 10
    v_xor_b32 v59, 0x80200800, v59
    s_cmp_lg_u32 s40, 3
    s_cbranch_scc1 L_p1_kernel_now_7
    v_mov_b64 v[20:21], v[56:57]
    v_mov_b64 v[22:23], v[58:59]
    s_branch L_p1_kernel_held_8
L_p1_kernel_now_7:
    s_mov_b32 s36, 6291456
    buffer_store_dwordx4 v[56:59], v3, s[20:23], s36 offen sc1
L_p1_kernel_held_8:
    s_add_u32 s35, s33, 25165824
    buffer_load_dwordx4 v[84:87], v1, s[8:11], s35 offen nt
    s_add_u32 s35, s33, 25165824
    buffer_load_dwordx4 v[104:107], v1, s[12:15], s35 offen nt
    s_cbranch_vccz L_p1_kernel_thr_9
    s_waitcnt vmcnt(2)
L_p1_kernel_thr_9:
    s_waitcnt vmcnt(15)
    v_perm_b32 v6, v28, v24, s43
    v_perm_b32 v7, v29, v25, s43
    v_perm_b32 v8, v30, v26, s43
    v_perm_b32 v9, v31, v27, s43
    v_mul_hi_u32_u24 v24, 429497, v24
    v_mul_hi_u32_u24 v28, 429497, v28
    v_mul_hi_u32_u24 v25, 429497, v25
    v_mul_hi_u32_u24 v29, 429497, v29
    v_mul_hi_u32_u24 v26, 429497, v26
    v_mul_hi_u32_u24 v30, 429497, v30
    v_mul_hi_u32_u24 v27, 429497, v27
    v_mul_hi_u32_u24 v31, 429497, v31
    v_lshl_or_b32 v24, v28, 16, v24
    v_lshl_or_b32 v25, v29, 16, v25
    v_lshl_or_b32 v26, v30, 16, v26
    v_lshl_or_b32 v27, v31, 16, v27
    v_dot2_u32_u16 v28, v24, s38, 0
    v_dot2_u32_u16 v29, v25, s38, 0
    v_dot2_u32_u16 v30, v26, s38, 0
    v_dot2_u32_u16 v31, v27, s38, 0
    v_pk_mad_u16 v6, v24, s37, v6
    v_pk_mad_u16 v7, v25, s37, v7
    v_pk_mad_u16 v8, v26, s37, v8
    v_pk_mad_u16 v9, v27, s37, v9
    ds_add_u32 v28, v4 offset:0
    ds_add_u32 v29, v4 offset:0
    ds_add_u32 v30, v4 offset:0
    ds_add_u32 v31, v4 offset:0
    v_pk_mad_u16 v6, v24, s52, v6 op_sel:[1,0,0] op_sel_hi:[1,1,1]
    v_pk_mad_u16 v7, v25, s52, v7 op_sel:[1,0,0] op_sel_hi:[1,1,1]
    v_pk_mad_u16 v8, v26, s52, v8 op_sel:[1,0,0] op_sel_hi:[1,1,1]
    v_pk_mad_u16 v9, v27, s52, v9 op_sel:[1,0,0] op_sel_hi:[1,1,1]
    v_perm_b32 v123, v31, v30, s43
    v_perm_b32 v122, v29, v28, s43
    v_or_b32 v52, 0x40000000, v6
    v_or_b32 v53, 0x40000000, v7
    v_or_b32 v54, 0x40000000, v8
    v_or_b32 v56, 0x40000000, v9
    v_lshlrev_b32 v91, 16, v108
    v_and_b32 v108, 0xffff0000, v108
    v_lshlrev_b32 v109, 16, v109
    v_mul_f32 v91, s41, v91
    v_mul_f32 v108, s41, v108
    v_mul_f32 v109, s41, v109
    v_fract_f32 v91, v91
    v_fract_f32 v108, v108
    v_fract_f32 v109, v109
    v_cos_f32 v91, v91
    v_cos_f32 v108, v108
    v_cos_f32 v109, v109
    v_fmaak_f32 v91, v10, v91, 1262486016
    v_fmaak_f32 v108, v10, v108, 1262486016
    v_fmaak_f32 v109, v10, v109, 1262486016
    v_lshlrev_b32 v91, 22, v91
    v_alignbit_b32 v91, v108, v91, 10
    v_alignbit_b32 v91, v109, v91, 10
    v_xor_b32 v91, 0x80200800, v91
    s_cmp_lg_u32 s40, 3
    s_cbranch_scc1 L_p1_kernel_now_10
    v_mov_b64 v[24:25], v[88:89]
    v_mov_b64 v[26:27], v[90:91]
    s_branch L_p1_kernel_held_11
L_p1_kernel_now_10:
    s_mov_b32 s36, 7340032
    buffer_store_dwordx4 v[88:91], v3, s[20:23], s36 offen sc1
L_p1_kernel_held_11:
    v_lshlrev_b32 v63, 16, v110
    v_and_b32 v110, 0xffff0000, v110
    v_lshlrev_b32 v111, 16, v111
    v_mul_f32 v63, s41, v63
    v_mul_f32 v110, s41, v110
    v_mul_f32 v111, s41, v111
    v_fract_f32 v63, v63
    v_fract_f32 v110, v110
    v_fract_f32 v111, v111
    v_cos_f32 v63, v63
    v_cos_f32 v110, v110
    v_cos_f32 v111, v111
    v_fmaak_f32 v63, v10, v63, 1262486016
    v_fmaak_f32 v110, v10, v110, 1262486016
    v_fmaak_f32 v111, v10, v111, 1262486016
    v_lshlrev_b32 v63, 22, v63
    v_alignbit_b32 v63, v110, v63, 10
    v_alignbit_b32 v63, v111, v63, 10
    v_xor_b32 v63, 0x80200800, v63
    s_cmp_lg_u32 s40, 3
    s_cbranch_scc1 L_p1_kernel_now_12
    v_mov_b64 v[28:29], v[60:61]
    v_mov_b64 v[30:31], v[62:63]
    s_branch L_p1_kernel_held_13
L_p1_kernel_now_12:
    s_mov_b32 s36, 8388608
    buffer_store_dwordx4 v[60:63], v3, s[20:23], s36 offen sc1
L_p1_kernel_held_13:
    s_add_u32 s35, s33, 29360128
    buffer_load_dwordx4 v[88:91], v1, s[8:11], s35 offen nt
    s_add_u32 s35, s33, 29360128
    buffer_load_dwordx4 v[108:111], v1, s[12:15], s35 offen nt
    s_cbranch_vccz L_p1_kernel_thr_14
    s_waitcnt vmcnt(2)
L_p1_kernel_thr_14:
    s_waitcnt vmcnt(15)
    v_perm_b32 v6, v36, v32, s43
    v_perm_b32 v7, v37, v33, s43
    v_perm_b32 v8, v38, v34, s43
    v_perm_b32 v9, v39, v35, s43
    v_mul_hi_u32_u24 v32, 429497, v32
    v_mul_hi_u32_u24 v36, 429497, v36
    v_mul_hi_u32_u24 v33, 429497, v33
    v_mul_hi_u32_u24 v37, 429497, v37
    v_mul_hi_u32_u24 v34, 429497, v34
    v_mul_hi_u32_u24 v38, 429497, v38
    v_mul_hi_u32_u24 v35, 429497, v35
    v_mul_hi_u32_u24 v39, 429497, v39
    v_lshl_or_b32 v32, v36, 16, v32
    v_lshl_or_b32 v33, v37, 16, v33
    v_lshl_or_b32 v34, v38, 16, v34
    v_lshl_or_b32 v35, v39, 16, v35
    v_dot2_u32_u16 v36, v32, s38, 0
    v_dot2_u32_u16 v37, v33, s38, 0
    v_dot2_u32_u16 v38, v34, s38, 0
    v_dot2_u32_u16 v39, v35, s38, 0
    v_pk_mad_u16 v6, v32, s37, v6
    v_pk_mad_u16 v7, v33, s37, v7
    v_pk_mad_u16 v8, v34, s37, v8
    v_pk_mad_u16 v9, v35, s37, v9
    ds_add_u32 v36, v4 offset:0
    ds_add_u32 v37, v4 offset:0
    ds_add_u32 v38, v4 offset:0
    ds_add_u32 v39, v4 offset:0
    v_pk_mad_u16 v6, v32, s52, v6 op_sel:[1,0,0] op_sel_hi:[1,1,1]
    v_pk_mad_u16 v7, v33, s52, v7 op_sel:[1,0,0] op_sel_hi:[1,1,1]
    v_pk_mad_u16 v8, v34, s52, v8 op_sel:[1,0,0] op_sel_hi:[1,1,1]
    v_pk_mad_u16 v9, v35, s52, v9 op_sel:[1,0,0] op_sel_hi:[1,1,1]
    v_perm_b32 v125, v39, v38, s43
    v_perm_b32 v124, v37, v36, s43
    v_or_b32 v57, 0x40000000, v6
    v_or_b32 v58, 0x40000000, v7
    v_or_b32 v60, 0x40000000, v8
    v_or_b32 v61, 0x40000000, v9
    v_lshlrev_b32 v95, 16, v112
    v_and_b32 v112, 0xffff0000, v112
    v_lshlrev_b32 v113, 16, v113
    v_mul_f32 v95, s41, v95
    v_mul_f32 v112, s41, v112
    v_mul_f32 v113, s41, v113
    v_fract_f32 v95, v95
    v_fract_f32 v112, v112
    v_fract_f32 v113, v113
    v_cos_f32 v95, v95
    v_cos_f32 v112, v112
    v_cos_f32 v113, v113
    v_fmaak_f32 v95, v10, v95, 1262486016
    v_fmaak_f32 v112, v10, v112, 1262486016
    v_fmaak_f32 v113, v10, v113, 1262486016
    v_lshlrev_b32 v95, 22, v95
    v_alignbit_b32 v95, v112, v95, 10
    v_alignbit_b32 v95, v113, v95, 10
    v_xor_b32 v95, 0x80200800, v95
    s_cmp_lg_u32 s40, 3
    s_cbranch_scc1 L_p1_kernel_now_15
    v_mov_b64 v[32:33], v[92:93]
    v_mov_b64 v[34:35], v[94:95]
    s_branch L_p1_kernel_held_16
L_p1_kernel_now_15:
    s_mov_b32 s36, 9437184
    buffer_store_dwordx4 v[92:95], v3, s[20:23], s36 offen sc1
L_p1_kernel_held_16:
    v_lshlrev_b32 v67, 16, v114
    v_and_b32 v114, 0xffff0000, v114
    v_lshlrev_b32 v115, 16, v115
    v_mul_f32 v67, s41, v67
    v_mul_f32 v114, s41, v114
    v_mul_f32 v115, s41, v115
    v_fract_f32 v67, v67
    v_fract_f32 v114, v114
    v_fract_f32 v115, v115
    v_cos_f32 v67, v67
    v_cos_f32 v114, v114
    v_cos_f32 v115, v115
    v_fmaak_f32 v67, v10, v67, 1262486016
    v_fmaak_f32 v114, v10, v114, 1262486016
    v_fmaak_f32 v115, v10, v115, 1262486016
    v_lshlrev_b32 v67, 22, v67
    v_alignbit_b32 v67, v114, v67, 10
    v_alignbit_b32 v67, v115, v67, 10
    v_xor_b32 v67, 0x80200800, v67
    s_cmp_lg_u32 s40, 3
    s_cbranch_scc1 L_p1_kernel_now_17
    v_mov_b64 v[36:37], v[64:65]
    v_mov_b64 v[38:39], v[66:67]
    s_branch L_p1_kernel_held_18
L_p1_kernel_now_17:
    s_mov_b32 s36, 10485760
    buffer_store_dwordx4 v[64:67], v3, s[20:23], s36 offen sc1
L_p1_kernel_held_18:
    s_add_u32 s35, s33, 33554432
    buffer_load_dwordx4 v[92:95], v1, s[8:11], s35 offen nt
    s_add_u32 s35, s33, 33554432
    buffer_load_dwordx4 v[112:115], v1, s[12:15], s35 offen nt
    s_cbranch_vccz L_p1_kernel_thr_19
    s_waitcnt vmcnt(2)
L_p1_kernel_thr_19:
    s_waitcnt vmcnt(15)
    v_perm_b32 v6, v44, v40, s43
    v_perm_b32 v7, v45, v41, s43
    v_perm_b32 v8, v46, v42, s43
    v_perm_b32 v9, v47, v43, s43
    v_mul_hi_u32_u24 v40, 429497, v40
    v_mul_hi_u32_u24 v44, 429497, v44
    v_mul_hi_u32_u24 v41, 429497, v41
    v_mul_hi_u32_u24 v45, 429497, v45
    v_mul_hi_u32_u24 v42, 429497, v42
    v_mul_hi_u32_u24 v46, 429497, v46
    v_mul_hi_u32_u24 v43, 429497, v43
    v_mul_hi_u32_u24 v47, 429497, v47
    v_lshl_or_b32 v40, v44, 16, v40
    v_lshl_or_b32 v41, v45, 16, v41
    v_lshl_or_b32 v42, v46, 16, v42
    v_lshl_or_b32 v43, v47, 16, v43
    v_dot2_u32_u16 v44, v40, s38, 0
    v_dot2_u32_u16 v45, v41, s38, 0
    v_dot2_u32_u16 v46, v42, s38, 0
    v_dot2_u32_u16 v47, v43, s38, 0
    v_pk_mad_u16 v6, v40, s37, v6
    v_pk_mad_u16 v7, v41, s37, v7
    v_pk_mad_u16 v8, v42, s37, v8
    v_pk_mad_u16 v9, v43, s37, v9
    ds_add_u32 v44, v4 offset:0
    ds_add_u32 v45, v4 offset:0
    ds_add_u32 v46, v4 offset:0
    ds_add_u32 v47, v4 offset:0
    v_pk_mad_u16 v6, v40, s52, v6 op_sel:[1,0,0] op_sel_hi:[1,1,1]
    v_pk_mad_u16 v7, v41, s52, v7 op_sel:[1,0,0] op_sel_hi:[1,1,1]
    v_pk_mad_u16 v8, v42, s52, v8 op_sel:[1,0,0] op_sel_hi:[1,1,1]
    v_pk_mad_u16 v9, v43, s52, v9 op_sel:[1,0,0] op_sel_hi:[1,1,1]
    v_perm_b32 v51, v47, v46, s43
    v_perm_b32 v126, v45, v44, s43
    v_or_b32 v62, 0x40000000, v6
    v_or_b32 v64, 0x40000000, v7
    v_or_b32 v65, 0x40000000, v8
    v_or_b32 v66, 0x40000000, v9
    v_lshlrev_b32 v99, 16, v116
    v_and_b32 v116, 0xffff0000, v116
    v_lshlrev_b32 v117, 16, v117
    v_mul_f32 v99, s41, v99
    v_mul_f32 v116, s41, v116
    v_mul_f32 v117, s41, v117
    v_fract_f32 v99, v99
    v_fract_f32 v116, v116
    v_fract_f32 v117, v117
    v_cos_f32 v99, v99
    v_cos_f32 v116, v116
    v_cos_f32 v117, v117
    v_fmaak_f32 v99, v10, v99, 1262486016
    v_fmaak_f32 v116, v10, v116, 1262486016
    v_fmaak_f32 v117, v10, v117, 1262486016
    v_lshlrev_b32 v99, 22, v99
    v_alignbit_b32 v99, v116, v99, 10
    v_alignbit_b32 v99, v117, v99, 10
    v_xor_b32 v99, 0x80200800, v99
    s_cmp_lg_u32 s40, 3
    s_cbranch_scc1 L_p1_kernel_now_20
    v_mov_b64 v[40:41], v[96:97]
    v_mov_b64 v[42:43], v[98:99]
    s_branch L_p1_kernel_held_21
L_p1_kernel_now_20:
    s_mov_b32 s36, 11534336
    buffer_store_dwordx4 v[96:99], v3, s[20:23], s36 offen sc1
L_p1_kernel_held_21:
    v_lshlrev_b32 v71, 16, v118
    v_and_b32 v118, 0xffff0000, v118
    v_lshlrev_b32 v119, 16, v119
    v_mul_f32 v71, s41, v71
    v_mul_f32 v118, s41, v118
    v_mul_f32 v119, s41, v119
    v_fract_f32 v71, v71
    v_fract_f32 v118, v118
    v_fract_f32 v119, v119
    v_cos_f32 v71, v71
    v_cos_f32 v118, v118
    v_cos_f32 v119, v119
    v_fmaak_f32 v71, v10, v71, 1262486016
    v_fmaak_f32 v118, v10, v118, 1262486016
    v_fmaak_f32 v119, v10, v119, 1262486016
    v_lshlrev_b32 v71, 22, v71
    v_alignbit_b32 v71, v118, v71, 10
    v_alignbit_b32 v71, v119, v71, 10
    v_xor_b32 v71, 0x80200800, v71
    s_cmp_lg_u32 s40, 3
    s_cbranch_scc1 L_p1_kernel_now_22
    v_mov_b64 v[44:45], v[68:69]
    v_mov_b64 v[46:47], v[70:71]
    s_branch L_p1_kernel_held_23
L_p1_kernel_now_22:
    s_mov_b32 s36, 12582912
    buffer_store_dwordx4 v[68:71], v3, s[20:23], s36 offen sc1
L_p1_kernel_held_23:
    s_add_u32 s35, s33, 37748736
    s_sub_u32 s35, s35, s48
    v_cndmask_b32 v96, 2.0, v1, s[44:45]
    buffer_load_dwordx4 v[96:99], v96, s[8:11], s35 offen nt
    s_add_u32 s35, s33, 37748736
    s_sub_u32 s35, s35, s48
    v_cndmask_b32 v116, 2.0, v1, s[44:45]
    buffer_load_dwordx4 v[116:119], v116, s[12:15], s35 offen nt
    s_cbranch_vccz L_p1_kernel_thr_24
    s_waitcnt vmcnt(2)
L_p1_kernel_thr_24:
    s_branch L_p1_join
L_p1_first:
    s_add_u32 s35, s33, 20971520
    buffer_load_dwordx4 v[80:83], v1, s[8:11], s35 offen nt
    s_add_u32 s35, s33, 20971520
    buffer_load_dwordx4 v[100:103], v1, s[12:15], s35 offen nt
    s_add_u32 s35, s33, 25165824
    buffer_load_dwordx4 v[84:87], v1, s[8:11], s35 offen nt
    s_add_u32 s35, s33, 25165824
    buffer_load_dwordx4 v[104:107], v1, s[12:15], s35 offen nt
    s_add_u32 s35, s33, 29360128
    buffer_load_dwordx4 v[88:91], v1, s[8:11], s35 offen nt
    s_add_u32 s35, s33, 29360128
    buffer_load_dwordx4 v[108:111], v1, s[12:15], s35 offen nt
    s_add_u32 s35, s33, 33554432
    buffer_load_dwordx4 v[92:95], v1, s[8:11], s35 offen nt
    s_add_u32 s35, s33, 33554432
    buffer_load_dwordx4 v[112:115], v1, s[12:15], s35 offen nt
    s_add_u32 s35, s33, 37748736
    s_sub_u32 s35, s35, s48
    v_cndmask_b32 v96, 2.0, v1, s[44:45]
    buffer_load_dwordx4 v[96:99], v96, s[8:11], s35 offen nt
    s_add_u32 s35, s33, 37748736
    s_sub_u32 s35, s35, s48
    v_cndmask_b32 v116, 2.0, v1, s[44:45]
    buffer_load_dwordx4 v[116:119], v116, s[12:15], s35 offen nt
    s_waitcnt vmcnt(18)
    v_perm_b32 v6, v20, v16, s43
    v_perm_b32 v7, v21, v17, s43
    v_perm_b32 v8, v22, v18, s43
    v_perm_b32 v9, v23, v19, s43
    v_mul_hi_u32_u24 v16, 429497, v16
    v_mul_hi_u32_u24 v20, 429497, v20
    v_mul_hi_u32_u24 v17, 429497, v17
    v_mul_hi_u32_u24 v21, 429497, v21
    v_mul_hi_u32_u24 v18, 429497, v18
    v_mul_hi_u32_u24 v22, 429497, v22
    v_mul_hi_u32_u24 v19, 429497, v19
    v_mul_hi_u32_u24 v23, 429497, v23
    v_lshl_or_b32 v16, v20, 16, v16
    v_lshl_or_b32 v17, v21, 16, v17
    v_lshl_or_b32 v18, v22, 16, v18
    v_lshl_or_b32 v19, v23, 16, v19
    v_dot2_u32_u16 v20, v16, s38, 0
    v_dot2_u32_u16 v21, v17, s38, 0
    v_dot2_u32_u16 v22, v18, s38, 0
    v_dot2_u32_u16 v23, v19, s38, 0
    v_pk_mad_u16 v6, v16, s37, v6
    v_pk_mad_u16 v7, v17, s37, v7
    v_pk_mad_u16 v8, v18, s37, v8
    v_pk_mad_u16 v9, v19, s37, v9
    ds_add_u32 v20, v4 offset:0
    ds_add_u32 v21, v4 offset:0
    ds_add_u32 v22, v4 offset:0
    ds_add_u32 v23, v4 offset:0
    v_pk_mad_u16 v6, v16, s52, v6 op_sel:[1,0,0] op_sel_hi:[1,1,1]
    v_pk_mad_u16 v7, v17, s52, v7 op_sel:[1,0,0] op_sel_hi:[1,1,1]
    v_pk_mad_u16 v8, v18, s52, v8 op_sel:[1,0,0] op_sel_hi:[1,1,1]
    v_pk_mad_u16 v9, v19, s52, v9 op_sel:[1,0,0] op_sel_hi:[1,1,1]
    v_perm_b32 v121, v23, v22, s43
    v_perm_b32 v120, v21, v20, s43
    v_or_b32 v127, 0x40000000, v6
    v_or_b32 v48, 0x40000000, v7
    v_or_b32 v49, 0x40000000, v8
    v_or_b32 v50, 0x40000000, v9
    s_waitcnt vmcnt(16)
    v_perm_b32 v6, v28, v24, s43
    v_perm_b32 v7, v29, v25, s43
    v_perm_b32 v8, v30, v26, s43
    v_perm_b32 v9, v31, v27, s43
    v_mul_hi_u32_u24 v24, 429497, v24
    v_mul_hi_u32_u24 v28, 429497, v28
    v_mul_hi_u32_u24 v25, 429497, v25
    v_mul_hi_u32_u24 v29, 429497, v29
    v_mul_hi_u32_u24 v26, 429497, v26
    v_mul_hi_u32_u24 v30, 429497, v30
    v_mul_hi_u32_u24 v27, 429497, v27
    v_mul_hi_u32_u24 v31, 429497, v31
    v_lshl_or_b32 v24, v28, 16, v24
    v_lshl_or_b32 v25, v29, 16, v25
    v_lshl_or_b32 v26, v30, 16, v26
    v_lshl_or_b32 v27, v31, 16, v27
    v_dot2_u32_u16 v28, v24, s38, 0
    v_dot2_u32_u16 v29, v25, s38, 0
    v_dot2_u32_u16 v30, v26, s38, 0
    v_dot2_u32_u16 v31, v27, s38, 0
    v_pk_mad_u16 v6, v24, s37, v6
    v_pk_mad_u16 v7, v25, s37, v7
    v_pk_mad_u16 v8, v26, s37, v8
    v_pk_mad_u16 v9, v27, s37, v9
    ds_add_u32 v28, v4 offset:0
    ds_add_u32 v29, v4 offset:0
    ds_add_u32 v30, v4 offset:0
    ds_add_u32 v31, v4 offset:0
    v_pk_mad_u16 v6, v24, s52, v6 op_sel:[1,0,0] op_sel_hi:[1,1,1]
    v_pk_mad_u16 v7, v25, s52, v7 op_sel:[1,0,0] op_sel_hi:[1,1,1]
    v_pk_mad_u16 v8, v26, s52, v8 op_sel:[1,0,0] op_sel_hi:[1,1,1]
    v_pk_mad_u16 v9, v27, s52, v9 op_sel:[1,0,0] op_sel_hi:[1,1,1]
    v_perm_b32 v123, v31, v30, s43
    v_perm_b32 v122, v29, v28, s43
    v_or_b32 v52, 0x40000000, v6
    v_or_b32 v53, 0x40000000, v7
    v_or_b32 v54, 0x40000000, v8
    v_or_b32 v56, 0x40000000, v9
    s_waitcnt vmcnt(14)
    v_perm_b32 v6, v36, v32, s43
    v_perm_b32 v7, v37, v33, s43
    v_perm_b32 v8, v38, v34, s43
    v_perm_b32 v9, v39, v35, s43
    v_mul_hi_u32_u24 v32, 429497, v32
    v_mul_hi_u32_u24 v36, 429497, v36
    v_mul_hi_u32_u24 v33, 429497, v33
    v_mul_hi_u32_u24 v37, 429497, v37
    v_mul_hi_u32_u24 v34, 429497, v34
    v_mul_hi_u32_u24 v38, 429497, v38
    v_mul_hi_u32_u24 v35, 429497, v35
    v_mul_hi_u32_u24 v39, 429497, v39
    v_lshl_or_b32 v32, v36, 16, v32
    v_lshl_or_b32 v33, v37, 16, v33
    v_lshl_or_b32 v34, v38, 16, v34
    v_lshl_or_b32 v35, v39, 16, v35
    v_dot2_u32_u16 v36, v32, s38, 0
    v_dot2_u32_u16 v37, v33, s38, 0
    v_dot2_u32_u16 v38, v34, s38, 0
    v_dot2_u32_u16 v39, v35, s38, 0
    v_pk_mad_u16 v6, v32, s37, v6
    v_pk_mad_u16 v7, v33, s37, v7
    v_pk_mad_u16 v8, v34, s37, v8
    v_pk_mad_u16 v9, v35, s37, v9
    ds_add_u32 v36, v4 offset:0
    ds_add_u32 v37, v4 offset:0
    ds_add_u32 v38, v4 offset:0
    ds_add_u32 v39, v4 offset:0
    v_pk_mad_u16 v6, v32, s52, v6 op_sel:[1,0,0] op_sel_hi:[1,1,1]
    v_pk_mad_u16 v7, v33, s52, v7 op_sel:[1,0,0] op_sel_hi:[1,1,1]
    v_pk_mad_u16 v8, v34, s52, v8 op_sel:[1,0,0] op_sel_hi:[1,1,1]
    v_pk_mad_u16 v9, v35, s52, v9 op_sel:[1,0,0] op_sel_hi:[1,1,1]
    v_perm_b32 v125, v39, v38, s43
    v_perm_b32 v124, v37, v36, s43
    v_or_b32 v57, 0x40000000, v6
    v_or_b32 v58, 0x40000000, v7
    v_or_b32 v60, 0x40000000, v8
    v_or_b32 v61, 0x40000000, v9
    s_waitcnt vmcnt(12)
    v_perm_b32 v6, v44, v40, s43
    v_perm_b32 v7, v45, v41, s43
    v_perm_b32 v8, v46, v42, s43
    v_perm_b32 v9, v47, v43, s43
    v_mul_hi_u32_u24 v40, 429497, v40
    v_mul_hi_u32_u24 v44, 429497, v44
    v_mul_hi_u32_u24 v41, 429497, v41
    v_mul_hi_u32_u24 v45, 429497, v45
    v_mul_hi_u32_u24 v42, 429497, v42
    v_mul_hi_u32_u24 v46, 429497, v46
    v_mul_hi_u32_u24 v43, 429497, v43
    v_mul_hi_u32_u24 v47, 429497, v47
    v_lshl_or_b32 v40, v44, 16, v40
    v_lshl_or_b32 v41, v45, 16, v41
    v_lshl_or_b32 v42, v46, 16, v42
    v_lshl_or_b32 v43, v47, 16, v43
    v_dot2_u32_u16 v44, v40, s38, 0
    v_dot2_u32_u16 v45, v41, s38, 0
    v_dot2_u32_u16 v46, v42, s38, 0
    v_dot2_u32_u16 v47, v43, s38, 0
    v_pk_mad_u16 v6, v40, s37, v6
    v_pk_mad_u16 v7, v41, s37, v7
    v_pk_mad_u16 v8, v42, s37, v8
    v_pk_mad_u16 v9, v43, s37, v9
    ds_add_u32 v44, v4 offset:0
    ds_add_u32 v45, v4 offset:0
    ds_add_u32 v46, v4 offset:0
    ds_add_u32 v47, v4 offset:0
    v_pk_mad_u16 v6, v40, s52, v6 op_sel:[1,0,0] op_sel_hi:[1,1,1]
    v_pk_mad_u16 v7, v41, s52, v7 op_sel:[1,0,0] op_sel_hi:[1,1,1]
    v_pk_mad_u16 v8, v42, s52, v8 op_sel:[1,0,0] op_sel_hi:[1,1,1]
    v_pk_mad_u16 v9, v43, s52, v9 op_sel:[1,0,0] op_sel_hi:[1,1,1]
    v_perm_b32 v51, v47, v46, s43
    v_perm_b32 v126, v45, v44, s43
    v_or_b32 v62, 0x40000000, v6
    v_or_b32 v64, 0x40000000, v7
    v_or_b32 v65, 0x40000000, v8
    v_or_b32 v66, 0x40000000, v9
L_p1_join:
    s_waitcnt vmcnt(10)
    v_perm_b32 v6, v76, v72, s43
    v_perm_b32 v7, v77, v73, s43
    v_perm_b32 v8, v78, v74, s43
    v_perm_b32 v9, v79, v75, s43
    v_mul_hi_u32_u24 v72, 429497, v72
    v_mul_hi_u32_u24 v76, 429497, v76
    v_mul_hi_u32_u24 v73, 429497, v73
    v_mul_hi_u32_u24 v77, 429497, v77
    v_mul_hi_u32_u24 v74, 429497, v74
    v_mul_hi_u32_u24 v78, 429497, v78
    v_mul_hi_u32_u24 v75, 429497, v75
    v_mul_hi_u32_u24 v79, 429497, v79
    v_lshl_or_b32 v72, v76, 16, v72
    v_lshl_or_b32 v73, v77, 16, v73
    v_lshl_or_b32 v74, v78, 16, v74
    v_lshl_or_b32 v75, v79, 16, v75
    v_dot2_u32_u16 v76, v72, s38, 0
    v_dot2_u32_u16 v77, v73, s38, 0
    v_dot2_u32_u16 v78, v74, s38, 0
    v_dot2_u32_u16 v79, v75, s38, 0
    v_pk_mad_u16 v6, v72, s37, v6
    v_pk_mad_u16 v7, v73, s37, v7
    v_pk_mad_u16 v8, v74, s37, v8
    v_pk_mad_u16 v9, v75, s37, v9
    ds_add_u32 v76, v4 offset:0
    ds_add_u32 v77, v4 offset:0
    ds_add_u32 v78, v4 offset:0
    ds_add_u32 v79, v4 offset:0
    v_pk_mad_u16 v6, v72, s52, v6 op_sel:[1,0,0] op_sel_hi:[1,1,1]
    v_pk_mad_u16 v7, v73, s52, v7 op_sel:[1,0,0] op_sel_hi:[1,1,1]
    v_pk_mad_u16 v8, v74, s52, v8 op_sel:[1,0,0] op_sel_hi:[1,1,1]
    v_pk_mad_u16 v9, v75, s52, v9 op_sel:[1,0,0] op_sel_hi:[1,1,1]
    v_perm_b32 v59, v79, v78, s43
    v_perm_b32 v55, v77, v76, s43
    v_or_b32 v68, 0x40000000, v6
    v_or_b32 v69, 0x40000000, v7
    v_or_b32 v70, 0x40000000, v8
    v_or_b32 v72, 0x40000000, v9
    s_waitcnt vmcnt(8)
    v_perm_b32 v6, v100, v80, s43
    v_perm_b32 v7, v101, v81, s43
    v_perm_b32 v8, v102, v82, s43
    v_perm_b32 v9, v103, v83, s43
    v_mul_hi_u32_u24 v80, 429497, v80
    v_mul_hi_u32_u24 v100, 429497, v100
    v_mul_hi_u32_u24 v81, 429497, v81
    v_mul_hi_u32_u24 v101, 429497, v101
    v_mul_hi_u32_u24 v82, 429497, v82
    v_mul_hi_u32_u24 v102, 429497, v102
    v_mul_hi_u32_u24 v83, 429497, v83
    v_mul_hi_u32_u24 v103, 429497, v103
    v_lshl_or_b32 v80, v100, 16, v80
    v_lshl_or_b32 v81, v101, 16, v81
    v_lshl_or_b32 v82, v102, 16, v82
    v_lshl_or_b32 v83, v103, 16, v83
    v_dot2_u32_u16 v100, v80, s38, 0
    v_dot2_u32_u16 v101, v81, s38, 0
    v_dot2_u32_u16 v102, v82, s38, 0
    v_dot2_u32_u16 v103, v83, s38, 0
    v_pk_mad_u16 v6, v80, s37, v6
    v_pk_mad_u16 v7, v81, s37, v7
    v_pk_mad_u16 v8, v82, s37, v8
    v_pk_mad_u16 v9, v83, s37, v9
    ds_add_u32 v100, v4 offset:0
    ds_add_u32 v101, v4 offset:0
    ds_add_u32 v102, v4 offset:0
    ds_add_u32 v103, v4 offset:0
    v_pk_mad_u16 v6, v80, s52, v6 op_sel:[1,0,0] op_sel_hi:[1,1,1]
    v_pk_mad_u16 v7, v81, s52, v7 op_sel:[1,0,0] op_sel_hi:[1,1,1]
    v_pk_mad_u16 v8, v82, s52, v8 op_sel:[1,0,0] op_sel_hi:[1,1,1]
    v_pk_mad_u16 v9, v83, s52, v9 op_sel:[1,0,0] op_sel_hi:[1,1,1]
    v_perm_b32 v67, v103, v102, s43
    v_perm_b32 v63, v101, v100, s43
    v_or_b32 v73, 0x40000000, v6
    v_or_b32 v74, 0x40000000, v7
    v_or_b32 v76, 0x40000000, v8
    v_or_b32 v77, 0x40000000, v9
    s_waitcnt vmcnt(6)
    v_perm_b32 v6, v104, v84, s43
    v_perm_b32 v7, v105, v85, s43
    v_perm_b32 v8, v106, v86, s43
    v_perm_b32 v9, v107, v87, s43
    v_mul_hi_u32_u24 v84, 429497, v84
    v_mul_hi_u32_u24 v104, 429497, v104
    v_mul_hi_u32_u24 v85, 429497, v85
    v_mul_hi_u32_u24 v105, 429497, v105
    v_mul_hi_u32_u24 v86, 429497, v86
    v_mul_hi_u32_u24 v106, 429497, v106
    v_mul_hi_u32_u24 v87, 429497, v87
    v_mul_hi_u32_u24 v107, 429497, v107
    v_lshl_or_b32 v84, v104, 16, v84
    v_lshl_or_b32 v85, v105, 16, v85
    v_lshl_or_b32 v86, v106, 16, v86
    v_lshl_or_b32 v87, v107, 16, v87
    v_dot2_u32_u16 v104, v84, s38, 0
    v_dot2_u32_u16 v105, v85, s38, 0
    v_dot2_u32_u16 v106, v86, s38, 0
    v_dot2_u32_u16 v107, v87, s38, 0
    v_pk_mad_u16 v6, v84, s37, v6
    v_pk_mad_u16 v7, v85, s37, v7
    v_pk_mad_u16 v8, v86, s37, v8
    v_pk_mad_u16 v9, v87, s37, v9
    ds_add_u32 v104, v4 offset:0
    ds_add_u32 v105, v4 offset:0
    ds_add_u32 v106, v4 offset:0
    ds_add_u32 v107, v4 offset:0
    v_pk_mad_u16 v6, v84, s52, v6 op_sel:[1,0,0] op_sel_hi:[1,1,1]
    v_pk_mad_u16 v7, v85, s52, v7 op_sel:[1,0,0] op_sel_hi:[1,1,1]
    v_pk_mad_u16 v8, v86, s52, v8 op_sel:[1,0,0] op_sel_hi:[1,1,1]
    v_pk_mad_u16 v9, v87, s52, v9 op_sel:[1,0,0] op_sel_hi:[1,1,1]
    v_perm_b32 v75, v107, v106, s43
    v_perm_b32 v71, v105, v104, s43
    v_or_b32 v78, 0x40000000, v6
    v_or_b32 v80, 0x40000000, v7
    v_or_b32 v81, 0x40000000, v8
    v_or_b32 v82, 0x40000000, v9
    s_waitcnt vmcnt(4)
    v_perm_b32 v6, v108, v88, s43
    v_perm_b32 v7, v109, v89, s43
    v_perm_b32 v8, v110, v90, s43
    v_perm_b32 v9, v111, v91, s43
    v_mul_hi_u32_u24 v88, 429497, v88
    v_mul_hi_u32_u24 v108, 429497, v108
    v_mul_hi_u32_u24 v89, 429497, v89
    v_mul_hi_u32_u24 v109, 429497, v109
    v_mul_hi_u32_u24 v90, 429497, v90
    v_mul_hi_u32_u24 v110, 429497, v110
    v_mul_hi_u32_u24 v91, 429497, v91
    v_mul_hi_u32_u24 v111, 429497, v111
    v_lshl_or_b32 v88, v108, 16, v88
    v_lshl_or_b32 v89, v109, 16, v89
    v_lshl_or_b32 v90, v110, 16, v90
    v_lshl_or_b32 v91, v111, 16, v91
    v_dot2_u32_u16 v108, v88, s38, 0
    v_dot2_u32_u16 v109, v89, s38, 0
    v_dot2_u32_u16 v110, v90, s38, 0
    v_dot2_u32_u16 v111, v91, s38, 0
    v_pk_mad_u16 v6, v88, s37, v6
    v_pk_mad_u16 v7, v89, s37, v7
    v_pk_mad_u16 v8, v90, s37, v8
    v_pk_mad_u16 v9, v91, s37, v9
    ds_add_u32 v108, v4 offset:0
    ds_add_u32 v109, v4 offset:0
    ds_add_u32 v110, v4 offset:0
    ds_add_u32 v111, v4 offset:0
    v_pk_mad_u16 v6, v88, s52, v6 op_sel:[1,0,0] op_sel_hi:[1,1,1]
    v_pk_mad_u16 v7, v89, s52, v7 op_sel:[1,0,0] op_sel_hi:[1,1,1]
    v_pk_mad_u16 v8, v90, s52, v8 op_sel:[1,0,0] op_sel_hi:[1,1,1]
    v_pk_mad_u16 v9, v91, s52, v9 op_sel:[1,0,0] op_sel_hi:[1,1,1]
    v_perm_b32 v83, v111, v110, s43
    v_perm_b32 v79, v109, v108, s43
    v_or_b32 v84, 0x40000000, v6
    v_or_b32 v85, 0x40000000, v7
    v_or_b32 v86, 0x40000000, v8
    v_or_b32 v88, 0x40000000, v9
    s_waitcnt vmcnt(2)
    v_perm_b32 v6, v112, v92, s43
    v_perm_b32 v7, v113, v93, s43
    v_perm_b32 v8, v114, v94, s43
    v_perm_b32 v9, v115, v95, s43
    v_mul_hi_u32_u24 v92, 429497, v92
    v_mul_hi_u32_u24 v112, 429497, v112
    v_mul_hi_u32_u24 v93, 429497, v93
    v_mul_hi_u32_u24 v113, 429497, v113
    v_mul_hi_u32_u24 v94, 429497, v94
    v_mul_hi_u32_u24 v114, 429497, v114
    v_mul_hi_u32_u24 v95, 429497, v95
    v_mul_hi_u32_u24 v115, 429497, v115
    v_lshl_or_b32 v92, v112, 16, v92
    v_lshl_or_b32 v93, v113, 16, v93
    v_lshl_or_b32 v94, v114, 16, v94
    v_lshl_or_b32 v95, v115, 16, v95
    v_dot2_u32_u16 v112, v92, s38, 0
    v_dot2_u32_u16 v113, v93, s38, 0
    v_dot2_u32_u16 v114, v94, s38, 0
    v_dot2_u32_u16 v115, v95, s38, 0
    v_pk_mad_u16 v6, v92, s37, v6
    v_pk_mad_u16 v7, v93, s37, v7
    v_pk_mad_u16 v8, v94, s37, v8
    v_pk_mad_u16 v9, v95, s37, v9
    ds_add_u32 v112, v4 offset:0
    ds_add_u32 v113, v4 offset:0
    ds_add_u32 v114, v4 offset:0
    ds_add_u32 v115, v4 offset:0
    v_pk_mad_u16 v6, v92, s52, v6 op_sel:[1,0,0] op_sel_hi:[1,1,1]
    v_pk_mad_u16 v7, v93, s52, v7 op_sel:[1,0,0] op_sel_hi:[1,1,1]
    v_pk_mad_u16 v8, v94, s52, v8 op_sel:[1,0,0] op_sel_hi:[1,1,1]
    v_pk_mad_u16 v9, v95, s52, v9 op_sel:[1,0,0] op_sel_hi:[1,1,1]
    v_perm_b32 v91, v115, v114, s43
    v_perm_b32 v87, v113, v112, s43
    v_or_b32 v89, 0x40000000, v6
    v_or_b32 v90, 0x40000000, v7
    v_or_b32 v92, 0x40000000, v8
    v_or_b32 v93, 0x40000000, v9
    s_waitcnt vmcnt(0)
    s_mov_b64 exec, s[44:45]
    v_perm_b32 v6, v116, v96, s43
    v_perm_b32 v7, v117, v97, s43
    v_perm_b32 v8, v118, v98, s43
    v_perm_b32 v9, v119, v99, s43
    v_mul_hi_u32_u24 v96, 429497, v96
    v_mul_hi_u32_u24 v116, 429497, v116
    v_mul_hi_u32_u24 v97, 429497, v97
    v_mul_hi_u32_u24 v117, 429497, v117
    v_mul_hi_u32_u24 v98, 429497, v98
    v_mul_hi_u32_u24 v118, 429497, v118
    v_mul_hi_u32_u24 v99, 429497, v99
    v_mul_hi_u32_u24 v119, 429497, v119
    v_lshl_or_b32 v96, v116, 16, v96
    v_lshl_or_b32 v97, v117, 16, v97
    v_lshl_or_b32 v98, v118, 16, v98
    v_lshl_or_b32 v99, v119, 16, v99
    v_dot2_u32_u16 v116, v96, s38, 0
    v_dot2_u32_u16 v117, v97, s38, 0
    v_dot2_u32_u16 v118, v98, s38, 0
    v_dot2_u32_u16 v119, v99, s38, 0
    v_pk_mad_u16 v6, v96, s37, v6
    v_pk_mad_u16 v7, v97, s37, v7
    v_pk_mad_u16 v8, v98, s37, v8
    v_pk_mad_u16 v9, v99, s37, v9
    ds_add_u32 v116, v4 offset:0
    ds_add_u32 v117, v4 offset:0
    ds_add_u32 v118, v4 offset:0
    ds_add_u32 v119, v4 offset:0
    v_pk_mad_u16 v6, v96, s52, v6 op_sel:[1,0,0] op_sel_hi:[1,1,1]
    v_pk_mad_u16 v7, v97, s52, v7 op_sel:[1,0,0] op_sel_hi:[1,1,1]
    v_pk_mad_u16 v8, v98, s52, v8 op_sel:[1,0,0] op_sel_hi:[1,1,1]
    v_pk_mad_u16 v9, v99, s52, v9 op_sel:[1,0,0] op_sel_hi:[1,1,1]
    v_perm_b32 v99, v119, v118, s43
    v_perm_b32 v95, v117, v116, s43
    v_or_b32 v94, 0x40000000, v6
    v_or_b32 v96, 0x40000000, v7
    v_or_b32 v97, 0x40000000, v8
    v_or_b32 v98, 0x40000000, v9
    s_mov_b64 exec, -1
    s_add_u32 s35, s34, 0
    buffer_load_dwordx2 v[100:101], v2, s[16:19], s35 offen nt
    s_lshl_b32 s35, s32, 10
    s_add_u32 s35, s35, 9437184
    s_add_u32 s20, s4, s35
    s_addc_u32 s21, s5, 0
    s_lshl2_add_u32 s35, s39, 160768
    v_mov_b32 v13, s35
    v_mov_b32 v7, 2.0
    v_and_b32 v6, 63, v0
    s_mov_b32 s36, 160768
    s_lshl_b32 s35, 0x1fffe, s39
    s_and_b32 s35, s35, 0x1ffff
    s_mov_b32 exec_hi, 0
    s_mov_b32 exec_lo, s35
    v_lshl_add_u32 v7, v6, 2, s36
    s_mov_b64 exec, -1
    v_mov_b32 v14, 160832
    s_mov_b32 s53, 2
    s_waitcnt lgkmcnt(0)
    s_barrier
    ds_read_b128 v[8:11], v1 offset:0
    s_add_u32 s35, s34, 2097152
    buffer_load_dwordx2 v[102:103], v2, s[16:19], s35 offen nt
L_p1_redo:
    s_waitcnt lgkmcnt(0)
    v_min3_u32 v12, v8, v9, v10
    v_min_u32 v12, v12, v11
    v_cmp_gt_u32 vcc, s53, v12
    s_nop 0
    s_mov_b64 s[46:47], vcc
    s_cbranch_vccz L_p1_kernel_nomask_25
    v_cmp_eq_u32 s[56:57], 0, v8
    v_cmp_ge_u32 s[64:65], 1, v8
    v_max_u32 v8, 2, v8
    v_cmp_eq_u32 s[58:59], 0, v9
    v_cmp_ge_u32 s[66:67], 1, v9
    v_max_u32 v9, 2, v9
    v_cmp_eq_u32 s[60:61], 0, v10
    v_cmp_ge_u32 s[68:69], 1, v10
    v_max_u32 v10, 2, v10
    v_cmp_eq_u32 s[62:63], 0, v11
    v_cmp_ge_u32 s[70:71], 1, v11
    v_max_u32 v11, 2, v11
L_p1_kernel_nomask_25:
    v_add_u32 v9, v8, v9
    v_add_u32 v10, v9, v10
    v_add_u32 v11, v10, v11
    s_nop 1
    v_add_u32_dpp v6, v11, v11 row_shr:1 row_mask:0xf bank_mask:0xf bound_ctrl:0
    s_nop 1
    v_add_u32_dpp v6, v6, v6 row_shr:2 row_mask:0xf bank_mask:0xf bound_ctrl:0
    s_nop 1
    v_add_u32_dpp v6, v6, v6 row_shr:4 row_mask:0xf bank_mask:0xf bound_ctrl:0
    s_nop 1
    v_add_u32_dpp v6, v6, v6 row_shr:8 row_mask:0xf bank_mask:0xf bound_ctrl:0
    s_nop 1
    v_add_u32_dpp v6, v6, v6 row_bcast:15 row_mask:0xa bank_mask:0xf
    s_nop 1
    v_add_u32_dpp v6, v6, v6 row_bcast:31 row_mask:0xc bank_mask:0xf
    s_nop 0
    v_readlane_b32 s35, v6, 63
    v_sub_u32 v6, v6, v11
    v_add_u32 v8, v8, v6
    v_mov_b32 v12, s35
    ds_add_u32 v7, v12
    v_add_u32 v9, v9, v6
    v_add_u32 v10, v10, v6
    s_waitcnt lgkmcnt(0)
    s_barrier
    ds_read_b32 v12, v14
    ds_read_b32 v11, v13
    s_add_u32 s35, s34, 4194304
    buffer_load_dwordx2 v[104:105], v2, s[16:19], s35 offen nt
    s_waitcnt lgkmcnt(1)
    v_readfirstlane_b32 s54, v12
    s_waitcnt lgkmcnt(0)
    s_cmp_ge_u32 s54, 40063
    s_cbranch_scc0 L_p1_fits
    s_barrier
    v_mov_b32 v12, 0
    ds_write_b32 v7, v12
    s_mov_b32 s53, 0
    s_mov_b32 s55, 1
    s_waitcnt lgkmcnt(0)
    s_barrier
    ds_read_b128 v[8:11], v1 offset:0
    s_branch L_p1_redo
L_p1_fits:
    s_mov_b64 exec, 1
    v_mov_b32 v7, 24576
    ds_write_b16 v7, v12
    s_mov_b64 exec, -1
    v_add_u32 v12, v11, v6
    v_add_u32 v13, v11, v8
    v_add_u32 v14, v11, v9
    v_add_u32 v15, v11, v10
    ds_write_b128 v1, v[12:15] offset:0
    s_add_u32 s35, s54, 2
    s_mul_hi_u32 s35, s35, 1431655766
    v_perm_b32 v15, v15, v14, s43
    v_perm_b32 v14, v13, v12, s43
    ds_write_b64 v2, v[14:15] offset:16384
    s_lshl_b32 s35, s35, 4
    s_add_u32 s35, s35, 217890816
    s_min_u32 s22, s35, 218104832
    s_waitcnt lgkmcnt(0)
    s_barrier
    s_nop 0
    v_and_b32 v6, 0xffff, v120
    v_lshrrev_b32 v7, 16, v120
    v_and_b32 v8, 0xffff, v121
    v_lshrrev_b32 v9, 16, v121
    ds_add_rtn_u32 v6, v6, v4 offset:0
    ds_add_rtn_u32 v7, v7, v4 offset:0
    ds_add_rtn_u32 v8, v8, v4 offset:0
    ds_add_rtn_u32 v9, v9, v4 offset:0
    v_and_b32 v10, 0xffff, v122
    v_lshrrev_b32 v11, 16, v122
    v_and_b32 v12, 0xffff, v123
    v_lshrrev_b32 v13, 16, v123
    ds_add_rtn_u32 v10, v10, v4 offset:0
    ds_add_rtn_u32 v11, v11, v4 offset:0
    ds_add_rtn_u32 v12, v12, v4 offset:0
    ds_add_rtn_u32 v13, v13, v4 offset:0
    s_waitcnt lgkmcnt(4)
    v_perm_b32 v120, v7, v6, s43
    v_perm_b32 v121, v9, v8, s43
    v_and_b32 v6, 0xffff, v124
    v_lshrrev_b32 v7, 16, v124
    v_and_b32 v8, 0xffff, v125
    v_lshrrev_b32 v9, 16, v125
    ds_add_rtn_u32 v6, v6, v4 offset:0
    ds_add_rtn_u32 v7, v7, v4 offset:0
    ds_add_rtn_u32 v8, v8, v4 offset:0
    ds_add_rtn_u32 v9, v9, v4 offset:0
    s_waitcnt lgkmcnt(4)
    v_perm_b32 v122, v11, v10, s43
    v_perm_b32 v123, v13, v12, s43
    s_add_u32 s35, s34, 6291456
    buffer_load_dwordx2 v[106:107], v2, s[16:19], s35 offen nt
    v_and_b32 v10, 0xffff, v126
    v_lshrrev_b32 v11, 16, v126
    v_and_b32 v12, 0xffff, v51
    v_lshrrev_b32 v13, 16, v51
    ds_add_rtn_u32 v10, v10, v4 offset:0
    ds_add_rtn_u32 v11, v11, v4 offset:0
    ds_add_rtn_u32 v12, v12, v4 offset:0
    ds_add_rtn_u32 v13, v13, v4 offset:0
    s_waitcnt lgkmcnt(4)
    v_perm_b32 v124, v7, v6, s43
    v_perm_b32 v125, v9, v8, s43
    s_add_u32 s35, s34, 8388608
    buffer_load_dwordx2 v[108:109], v2, s[16:19], s35 offen nt
    v_and_b32 v6, 0xffff, v55
    v_lshrrev_b32 v7, 16, v55
    v_and_b32 v8, 0xffff, v59
    v_lshrrev_b32 v9, 16, v59
    ds_add_rtn_u32 v6, v6, v4 offset:0
    ds_add_rtn_u32 v7, v7, v4 offset:0
    ds_add_rtn_u32 v8, v8, v4 offset:0
    ds_add_rtn_u32 v9, v9, v4 offset:0
    s_waitcnt lgkmcnt(4)
    v_perm_b32 v126, v11, v10, s43
    v_perm_b32 v51, v13, v12, s43
    s_add_u32 s35, s34, 10485760
    buffer_load_dwordx2 v[110:111], v2, s[16:19], s35 offen nt
    v_and_b32 v10, 0xffff, v63
    v_lshrrev_b32 v11, 16, v63
    v_and_b32 v12, 0xffff, v67
    v_lshrrev_b32 v13, 16, v67
    ds_add_rtn_u32 v10, v10, v4 offset:0
    ds_add_rtn_u32 v11, v11, v4 offset:0
    ds_add_rtn_u32 v12, v12, v4 offset:0
    ds_add_rtn_u32 v13, v13, v4 offset:0
    s_waitcnt lgkmcnt(4)
    v_perm_b32 v55, v7, v6, s43
    v_perm_b32 v59, v9, v8, s43
    v_and_b32 v6, 0xffff, v71
    v_lshrrev_b32 v7, 16, v71
    v_and_b32 v8, 0xffff, v75
    v_lshrrev_b32 v9, 16, v75
    ds_add_rtn_u32 v6, v6, v4 offset:0
    ds_add_rtn_u32 v7, v7, v4 offset:0
    ds_add_rtn_u32 v8, v8, v4 offset:0
    ds_add_rtn_u32 v9, v9, v4 offset:0
    s_waitcnt lgkmcnt(4)
    v_perm_b32 v63, v11, v10, s43
    v_perm_b32 v67, v13, v12, s43
    s_add_u32 s35, s34, 12582912
    buffer_load_dwordx2 v[112:113], v2, s[16:19], s35 offen nt
    v_and_b32 v10, 0xffff, v79
    v_lshrrev_b32 v11, 16, v79
    v_and_b32 v12, 0xffff, v83
    v_lshrrev_b32 v13, 16, v83
    ds_add_rtn_u32 v10, v10, v4 offset:0
    ds_add_rtn_u32 v11, v11, v4 offset:0
    ds_add_rtn_u32 v12, v12, v4 offset:0
    ds_add_rtn_u32 v13, v13, v4 offset:0
    s_waitcnt lgkmcnt(4)
    v_perm_b32 v71, v7, v6, s43
    v_perm_b32 v75, v9, v8, s43
    s_add_u32 s35, s34, 14680064
    buffer_load_dwordx2 v[114:115], v2, s[16:19], s35 offen nt
    v_and_b32 v6, 0xffff, v87
    v_lshrrev_b32 v7, 16, v87
    v_and_b32 v8, 0xffff, v91
    v_lshrrev_b32 v9, 16, v91
    ds_add_rtn_u32 v6, v6, v4 offset:0
    ds_add_rtn_u32 v7, v7, v4 offset:0
    ds_add_rtn_u32 v8, v8, v4 offset:0
    ds_add_rtn_u32 v9, v9, v4 offset:0
    s_waitcnt lgkmcnt(4)
    v_perm_b32 v79, v11, v10, s43
    v_perm_b32 v83, v13, v12, s43
    s_add_u32 s35, s34, 16777216
    buffer_load_dwordx2 v[116:117], v2, s[16:19], s35 offen nt
    s_mov_b64 exec, s[44:45]
    v_and_b32 v10, 0xffff, v95
    v_lshrrev_b32 v11, 16, v95
    v_and_b32 v12, 0xffff, v99
    v_lshrrev_b32 v13, 16, v99
    ds_add_rtn_u32 v10, v10, v4 offset:0
    ds_add_rtn_u32 v11, v11, v4 offset:0
    ds_add_rtn_u32 v12, v12, v4 offset:0
    ds_add_rtn_u32 v13, v13, v4 offset:0
    s_mov_b64 exec, -1
    s_waitcnt lgkmcnt(4)
    v_perm_b32 v87, v7, v6, s43
    v_perm_b32 v91, v9, v8, s43
    s_add_u32 s35, s34, 18874368
    s_sub_u32 s35, s35, s49
    v_cndmask_b32 v118, 2.0, v2, s[44:45]
    buffer_load_dwordx2 v[118:119], v118, s[16:19], s35 offen nt
    s_waitcnt lgkmcnt(0)
    v_perm_b32 v95, v11, v10, s43
    v_perm_b32 v99, v13, v12, s43
    s_cmp_gt_u32 s39, 8
    s_cbranch_scc1 L_p1_kernel_notab_26
    v_lshrrev_b32 v6, 1, v0
    v_mul_u32_u24 v7, 1009, v6
    v_lshrrev_b32 v7, 16, v7
    v_mul_u32_u24 v7, 959, v7
    v_and_b32 v8, 1, v0
    v_lshl_add_u32 v7, v8, 9, v7
    v_add_lshl_u32 v13, v7, v6, 1
    ds_read_u16 v6, v13 offset:16384
    ds_read_u16 v7, v13 offset:16512
    ds_read_u16 v8, v13 offset:16640
    ds_read_u16 v9, v13 offset:16768
    ds_read_u16 v10, v13 offset:16896
    ds_read_u16 v11, v13 offset:17024
    ds_read_u16 v12, v13 offset:17152
    ds_read_u16 v13, v13 offset:17280
    s_mul_i32 s35, s32, 8320
    s_add_u32 s26, s35, 8320
    s_waitcnt lgkmcnt(6)
    v_perm_b32 v6, v7, v6, s43
    s_waitcnt lgkmcnt(4)
    v_perm_b32 v7, v9, v8, s43
    s_waitcnt lgkmcnt(2)
    v_perm_b32 v8, v11, v10, s43
    s_waitcnt lgkmcnt(0)
    v_perm_b32 v9, v13, v12, s43
    buffer_store_dwordx4 v[6:9], v1, s[24:27], s35 offen sc1
    s_nop 1
L_p1_kernel_notab_26:
    s_barrier
    s_lshl_b32 s35, s54, 2
    v_mov_b32 v6, s35
    v_mov_b32 v7, 0
    v_mov_b32 v12, 1140817920
    s_mov_b64 exec, 1
    ds_write2_b32 v6, v7, v7 offset0:0 offset1:1
    s_cmp_eq_u64 s[46:47], 0
    s_cbranch_scc1 L_p1_kernel_nonull_27
    s_mov_b64 exec, s[64:65]
    v_lshlrev_b32_sdwa v6, 2, v14 dst_sel:DWORD dst_unused:UNUSED_PAD src0_sel:DWORD src1_sel:WORD_0
    ds_write_b32 v6, v7 offset:4
    s_mov_b64 exec, s[56:57]
    ds_write_b32 v6, v7
    s_mov_b64 exec, s[66:67]
    v_lshlrev_b32_sdwa v6, 2, v14 dst_sel:DWORD dst_unused:UNUSED_PAD src0_sel:DWORD src1_sel:WORD_1
    ds_write_b32 v6, v7 offset:4
    s_mov_b64 exec, s[58:59]
    ds_write_b32 v6, v7
    s_mov_b64 exec, s[68:69]
    v_lshlrev_b32_sdwa v6, 2, v15 dst_sel:DWORD dst_unused:UNUSED_PAD src0_sel:DWORD src1_sel:WORD_0
    ds_write_b32 v6, v7 offset:4
    s_mov_b64 exec, s[60:61]
    ds_write_b32 v6, v7
    s_mov_b64 exec, s[70:71]
    v_lshlrev_b32_sdwa v6, 2, v15 dst_sel:DWORD dst_unused:UNUSED_PAD src0_sel:DWORD src1_sel:WORD_1
    ds_write_b32 v6, v7 offset:4
    s_mov_b64 exec, s[62:63]
    ds_write_b32 v6, v7
L_p1_kernel_nonull_27:
    s_mov_b64 exec, -1
    v_lshlrev_b32_sdwa v6, 2, v120 dst_sel:DWORD dst_unused:UNUSED_PAD src0_sel:DWORD src1_sel:WORD_0
    v_lshlrev_b32_sdwa v7, 2, v120 dst_sel:DWORD dst_unused:UNUSED_PAD src0_sel:DWORD src1_sel:WORD_1
    v_lshlrev_b32_sdwa v8, 2, v121 dst_sel:DWORD dst_unused:UNUSED_PAD src0_sel:DWORD src1_sel:WORD_0
    v_lshlrev_b32_sdwa v9, 2, v121 dst_sel:DWORD dst_unused:UNUSED_PAD src0_sel:DWORD src1_sel:WORD_1
    ds_write_b32 v6, v127
    ds_write_b32 v7, v48
    ds_write_b32 v8, v49
    ds_write_b32 v9, v50
    s_cmp_lg_u32 s40, 3
    s_cbranch_scc1 L_p1_kernel_ld_28
    s_mov_b32 s36, 4194304
    buffer_store_dwordx4 v[16:19], v3, s[72:75], s36 offen sc1
    s_branch L_p1_kernel_st_29
L_p1_kernel_ld_28:
    s_add_u32 s35, s33, 40960000
    buffer_load_dwordx4 v[16:19], v1, s[8:11], s35 offen nt
L_p1_kernel_st_29:
    v_lshlrev_b32_sdwa v6, 2, v122 dst_sel:DWORD dst_unused:UNUSED_PAD src0_sel:DWORD src1_sel:WORD_0
    v_lshlrev_b32_sdwa v7, 2, v122 dst_sel:DWORD dst_unused:UNUSED_PAD src0_sel:DWORD src1_sel:WORD_1
    v_lshlrev_b32_sdwa v8, 2, v123 dst_sel:DWORD dst_unused:UNUSED_PAD src0_sel:DWORD src1_sel:WORD_0
    v_lshlrev_b32_sdwa v9, 2, v123 dst_sel:DWORD dst_unused:UNUSED_PAD src0_sel:DWORD src1_sel:WORD_1
    ds_write_b32 v6, v52
    ds_write_b32 v7, v53
    ds_write_b32 v8, v54
    ds_write_b32 v9, v56
    v_lshlrev_b32_sdwa v6, 2, v124 dst_sel:DWORD dst_unused:UNUSED_PAD src0_sel:DWORD src1_sel:WORD_0
    v_lshlrev_b32_sdwa v7, 2, v124 dst_sel:DWORD dst_unused:UNUSED_PAD src0_sel:DWORD src1_sel:WORD_1
    v_lshlrev_b32_sdwa v8, 2, v125 dst_sel:DWORD dst_unused:UNUSED_PAD src0_sel:DWORD src1_sel:WORD_0
    v_lshlrev_b32_sdwa v9, 2, v125 dst_sel:DWORD dst_unused:UNUSED_PAD src0_sel:DWORD src1_sel:WORD_1
    ds_write_b32 v6, v57
    ds_write_b32 v7, v58
    ds_write_b32 v8, v60
    ds_write_b32 v9, v61
    v_lshlrev_b32_sdwa v6, 2, v126 dst_sel:DWORD dst_unused:UNUSED_PAD src0_sel:DWORD src1_sel:WORD_0
    v_lshlrev_b32_sdwa v7, 2, v126 dst_sel:DWORD dst_unused:UNUSED_PAD src0_sel:DWORD src1_sel:WORD_1
    v_lshlrev_b32_sdwa v8, 2, v51 dst_sel:DWORD dst_unused:UNUSED_PAD src0_sel:DWORD src1_sel:WORD_0
    v_lshlrev_b32_sdwa v9, 2, v51 dst_sel:DWORD dst_unused:UNUSED_PAD src0_sel:DWORD src1_sel:WORD_1
    ds_write_b32 v6, v62
    ds_write_b32 v7, v64
    ds_write_b32 v8, v65
    ds_write_b32 v9, v66
    s_cmp_lg_u32 s40, 3
    s_cbranch_scc1 L_p1_kernel_ld_30
    s_mov_b32 s36, 6291456
    buffer_store_dwordx4 v[20:23], v3, s[72:75], s36 offen sc1
    s_branch L_p1_kernel_st_31
L_p1_kernel_ld_30:
    s_add_u32 s35, s33, 40960000
    buffer_load_dwordx4 v[20:23], v1, s[12:15], s35 offen nt
L_p1_kernel_st_31:
    v_lshlrev_b32_sdwa v6, 2, v55 dst_sel:DWORD dst_unused:UNUSED_PAD src0_sel:DWORD src1_sel:WORD_0
    v_lshlrev_b32_sdwa v7, 2, v55 dst_sel:DWORD dst_unused:UNUSED_PAD src0_sel:DWORD src1_sel:WORD_1
    v_lshlrev_b32_sdwa v8, 2, v59 dst_sel:DWORD dst_unused:UNUSED_PAD src0_sel:DWORD src1_sel:WORD_0
    v_lshlrev_b32_sdwa v9, 2, v59 dst_sel:DWORD dst_unused:UNUSED_PAD src0_sel:DWORD src1_sel:WORD_1
    ds_write_b32 v6, v68
    ds_write_b32 v7, v69
    ds_write_b32 v8, v70
    ds_write_b32 v9, v72
    v_lshlrev_b32_sdwa v6, 2, v63 dst_sel:DWORD dst_unused:UNUSED_PAD src0_sel:DWORD src1_sel:WORD_0
    v_lshlrev_b32_sdwa v7, 2, v63 dst_sel:DWORD dst_unused:UNUSED_PAD src0_sel:DWORD src1_sel:WORD_1
    v_lshlrev_b32_sdwa v8, 2, v67 dst_sel:DWORD dst_unused:UNUSED_PAD src0_sel:DWORD src1_sel:WORD_0
    v_lshlrev_b32_sdwa v9, 2, v67 dst_sel:DWORD dst_unused:UNUSED_PAD src0_sel:DWORD src1_sel:WORD_1
    ds_write_b32 v6, v73
    ds_write_b32 v7, v74
    ds_write_b32 v8, v76
    ds_write_b32 v9, v77
    v_lshlrev_b32_sdwa v6, 2, v71 dst_sel:DWORD dst_unused:UNUSED_PAD src0_sel:DWORD src1_sel:WORD_0
    v_lshlrev_b32_sdwa v7, 2, v71 dst_sel:DWORD dst_unused:UNUSED_PAD src0_sel:DWORD src1_sel:WORD_1
    v_lshlrev_b32_sdwa v8, 2, v75 dst_sel:DWORD dst_unused:UNUSED_PAD src0_sel:DWORD src1_sel:WORD_0
    v_lshlrev_b32_sdwa v9, 2, v75 dst_sel:DWORD dst_unused:UNUSED_PAD src0_sel:DWORD src1_sel:WORD_1
    ds_write_b32 v6, v78
    ds_write_b32 v7, v80
    ds_write_b32 v8, v81
    ds_write_b32 v9, v82
    s_cmp_lg_u32 s40, 3
    s_cbranch_scc1 L_p1_kernel_ld_32
    s_mov_b32 s36, 7340032
    buffer_store_dwordx4 v[24:27], v3, s[72:75], s36 offen sc1
    s_branch L_p1_kernel_st_33
L_p1_kernel_ld_32:
    s_add_u32 s35, s33, 45154304
    buffer_load_dwordx4 v[24:27], v1, s[8:11], s35 offen nt
L_p1_kernel_st_33:
    v_lshlrev_b32_sdwa v6, 2, v79 dst_sel:DWORD dst_unused:UNUSED_PAD src0_sel:DWORD src1_sel:WORD_0
    v_lshlrev_b32_sdwa v7, 2, v79 dst_sel:DWORD dst_unused:UNUSED_PAD src0_sel:DWORD src1_sel:WORD_1
    v_lshlrev_b32_sdwa v8, 2, v83 dst_sel:DWORD dst_unused:UNUSED_PAD src0_sel:DWORD src1_sel:WORD_0
    v_lshlrev_b32_sdwa v9, 2, v83 dst_sel:DWORD dst_unused:UNUSED_PAD src0_sel:DWORD src1_sel:WORD_1
    ds_write_b32 v6, v84
    ds_write_b32 v7, v85
    ds_write_b32 v8, v86
    ds_write_b32 v9, v88
    v_lshlrev_b32_sdwa v6, 2, v87 dst_sel:DWORD dst_unused:UNUSED_PAD src0_sel:DWORD src1_sel:WORD_0
    v_lshlrev_b32_sdwa v7, 2, v87 dst_sel:DWORD dst_unused:UNUSED_PAD src0_sel:DWORD src1_sel:WORD_1
    v_lshlrev_b32_sdwa v8, 2, v91 dst_sel:DWORD dst_unused:UNUSED_PAD src0_sel:DWORD src1_sel:WORD_0
    v_lshlrev_b32_sdwa v9, 2, v91 dst_sel:DWORD dst_unused:UNUSED_PAD src0_sel:DWORD src1_sel:WORD_1
    ds_write_b32 v6, v89
    ds_write_b32 v7, v90
    ds_write_b32 v8, v92
    ds_write_b32 v9, v93
    s_mov_b64 exec, s[44:45]
    v_lshlrev_b32_sdwa v6, 2, v95 dst_sel:DWORD dst_unused:UNUSED_PAD src0_sel:DWORD src1_sel:WORD_0
    v_lshlrev_b32_sdwa v7, 2, v95 dst_sel:DWORD dst_unused:UNUSED_PAD src0_sel:DWORD src1_sel:WORD_1
    v_lshlrev_b32_sdwa v8, 2, v99 dst_sel:DWORD dst_unused:UNUSED_PAD src0_sel:DWORD src1_sel:WORD_0
    v_lshlrev_b32_sdwa v9, 2, v99 dst_sel:DWORD dst_unused:UNUSED_PAD src0_sel:DWORD src1_sel:WORD_1
    ds_write_b32 v6, v94
    ds_write_b32 v7, v96
    ds_write_b32 v8, v97
    ds_write_b32 v9, v98
    s_mov_b64 exec, -1
    s_cmp_lg_u32 s40, 3
    s_cbranch_scc1 L_p1_kernel_ld_34
    s_mov_b32 s36, 8388608
    buffer_store_dwordx4 v[28:31], v3, s[72:75], s36 offen sc1
    s_branch L_p1_kernel_st_35
L_p1_kernel_ld_34:
    s_add_u32 s35, s33, 45154304
    buffer_load_dwordx4 v[28:31], v1, s[12:15], s35 offen nt
L_p1_kernel_st_35:
    s_mul_i32 s35, s39, 9216
    v_mad_u32_u24 v6, v0, 12, s35
    s_waitcnt lgkmcnt(0)
    s_barrier
    s_cmp_lg_u32 s39, 15
    s_cbranch_scc1 L_p1_kernel_nox_36
    ds_read_b32 v12, v6 offset:9984
    ds_read_b32 v13, v6 offset:9988
    ds_read_b32 v14, v6 offset:9992
L_p1_kernel_nox_36:
    ds_read_b32 v48, v6 offset:1536
    ds_read_b32 v49, v6 offset:1540
    ds_read_b32 v50, v6 offset:1544
    ds_read_b32 v52, v6 offset:3072
    ds_read_b32 v53, v6 offset:3076
    ds_read_b32 v54, v6 offset:3080
    ds_read_b32 v56, v6 offset:4608
    ds_read_b32 v57, v6 offset:4612
    ds_read_b32 v58, v6 offset:4616
    ds_read_b32 v60, v6 offset:6144
    ds_read_b32 v61, v6 offset:6148
    ds_read_b32 v62, v6 offset:6152
    ds_read_b32 v64, v6 offset:7680
    ds_read_b32 v65, v6 offset:7684
    ds_read_b32 v66, v6 offset:7688
    ds_read_b32 v68, v6 offset:9216
    ds_read_b32 v69, v6 offset:9220
    ds_read_b32 v70, v6 offset:9224
    ds_read_b32 v72, v6 offset:0
    ds_read_b32 v73, v6 offset:4
    ds_read_b32 v74, v6 offset:8
    ds_read_b32 v76, v6 offset:768
    ds_read_b32 v77, v6 offset:772
    ds_read_b32 v78, v6 offset:776
    ds_read_b32 v80, v6 offset:2304
    ds_read_b32 v81, v6 offset:2308
    ds_read_b32 v82, v6 offset:2312
    ds_read_b32 v84, v6 offset:3840
    ds_read_b32 v85, v6 offset:3844
    ds_read_b32 v86, v6 offset:3848
    ds_read_b32 v88, v6 offset:5376
    ds_read_b32 v89, v6 offset:5380
    ds_read_b32 v90, v6 offset:5384
    ds_read_b32 v92, v6 offset:6912
    ds_read_b32 v93, v6 offset:6916
    ds_read_b32 v94, v6 offset:6920
    ds_read_b32 v96, v6 offset:8448
    ds_read_b32 v97, v6 offset:8452
    ds_read_b32 v98, v6 offset:8456
    s_cmp_lg_u32 s40, 3
    s_cbranch_scc1 L_p1_kernel_ld_37
    s_mov_b32 s36, 9437184
    buffer_store_dwordx4 v[32:35], v3, s[72:75], s36 offen sc1
    s_branch L_p1_kernel_st_38
L_p1_kernel_ld_37:
    s_add_u32 s35, s33, 49348608
    buffer_load_dwordx4 v[32:35], v1, s[8:11], s35 offen nt
L_p1_kernel_st_38:
    v_mov_b32 v8, 0
    v_mov_b32 v9, 0
    v_mov_b32 v10, 0
    v_mov_b32 v11, 0
    v_mov_b32 v15, 16384
    v_min_u32 v7, 16, v0
    v_lshlrev_b32 v7, 2, v7
    v_add_u32 v7, 160768, v7
    s_waitcnt lgkmcnt(0)
    s_barrier
    ds_write_b128 v1, v[8:11] offset:0
    ds_write_b32 v7, v8
    s_nop 1
    v_mov_b32 v6, 1140817920
    s_waitcnt vmcnt(14)
    v_pk_maximum3_f16 v5, v100, v101, v5
    v_mad_u32_u16 v6, v120, s50, v15 op_sel:[0,0,0,0]
    v_mad_u32_u16 v7, v120, s50, v15 op_sel:[1,0,0,0]
    v_mad_u32_u16 v8, v121, s50, v15 op_sel:[0,0,0,0]
    v_mad_u32_u16 v9, v121, s50, v15 op_sel:[1,0,0,0]
    v_add_u32_sdwa v6, v6, v120 dst_sel:DWORD dst_unused:UNUSED_PAD src0_sel:WORD_1 src1_sel:WORD_0
    v_add_u32_sdwa v7, v7, v120 dst_sel:DWORD dst_unused:UNUSED_PAD src0_sel:WORD_1 src1_sel:WORD_1
    v_add_u32_sdwa v8, v8, v121 dst_sel:DWORD dst_unused:UNUSED_PAD src0_sel:WORD_1 src1_sel:WORD_0
    v_add_u32_sdwa v9, v9, v121 dst_sel:DWORD dst_unused:UNUSED_PAD src0_sel:WORD_1 src1_sel:WORD_1
    v_add_u32 v6, v6, v6
    v_add_u32 v7, v7, v7
    v_add_u32 v8, v8, v8
    v_add_u32 v9, v9, v9
    ds_write_b16 v6, v100 offset:16384
    ds_write_b16_d16_hi v7, v100 offset:16384
    ds_write_b16 v8, v101 offset:16384
    ds_write_b16_d16_hi v9, v101 offset:16384
    v_mov_b32 v6, 1140817920
    s_waitcnt vmcnt(13)
    v_pk_maximum3_f16 v5, v102, v103, v5
    v_mad_u32_u16 v6, v122, s50, v15 op_sel:[0,0,0,0]
    v_mad_u32_u16 v7, v122, s50, v15 op_sel:[1,0,0,0]
    v_mad_u32_u16 v8, v123, s50, v15 op_sel:[0,0,0,0]
    v_mad_u32_u16 v9, v123, s50, v15 op_sel:[1,0,0,0]
    v_add_u32_sdwa v6, v6, v122 dst_sel:DWORD dst_unused:UNUSED_PAD src0_sel:WORD_1 src1_sel:WORD_0
    v_add_u32_sdwa v7, v7, v122 dst_sel:DWORD dst_unused:UNUSED_PAD src0_sel:WORD_1 src1_sel:WORD_1
    v_add_u32_sdwa v8, v8, v123 dst_sel:DWORD dst_unused:UNUSED_PAD src0_sel:WORD_1 src1_sel:WORD_0
    v_add_u32_sdwa v9, v9, v123 dst_sel:DWORD dst_unused:UNUSED_PAD src0_sel:WORD_1 src1_sel:WORD_1
    v_add_u32 v6, v6, v6
    v_add_u32 v7, v7, v7
    v_add_u32 v8, v8, v8
    v_add_u32 v9, v9, v9
    ds_write_b16 v6, v102 offset:16384
    ds_write_b16_d16_hi v7, v102 offset:16384
    ds_write_b16 v8, v103 offset:16384
    ds_write_b16_d16_hi v9, v103 offset:16384
    v_mov_b32 v6, 1140817920
    s_waitcnt vmcnt(12)
    v_pk_maximum3_f16 v5, v104, v105, v5
    v_mad_u32_u16 v6, v124, s50, v15 op_sel:[0,0,0,0]
    v_mad_u32_u16 v7, v124, s50, v15 op_sel:[1,0,0,0]
    v_mad_u32_u16 v8, v125, s50, v15 op_sel:[0,0,0,0]
    v_mad_u32_u16 v9, v125, s50, v15 op_sel:[1,0,0,0]
    v_add_u32_sdwa v6, v6, v124 dst_sel:DWORD dst_unused:UNUSED_PAD src0_sel:WORD_1 src1_sel:WORD_0
    v_add_u32_sdwa v7, v7, v124 dst_sel:DWORD dst_unused:UNUSED_PAD src0_sel:WORD_1 src1_sel:WORD_1
    v_add_u32_sdwa v8, v8, v125 dst_sel:DWORD dst_unused:UNUSED_PAD src0_sel:WORD_1 src1_sel:WORD_0
    v_add_u32_sdwa v9, v9, v125 dst_sel:DWORD dst_unused:UNUSED_PAD src0_sel:WORD_1 src1_sel:WORD_1
    v_add_u32 v6, v6, v6
    v_add_u32 v7, v7, v7
    v_add_u32 v8, v8, v8
    v_add_u32 v9, v9, v9
    ds_write_b16 v6, v104 offset:16384
    ds_write_b16_d16_hi v7, v104 offset:16384
    ds_write_b16 v8, v105 offset:16384
    ds_write_b16_d16_hi v9, v105 offset:16384
    s_cmp_lg_u32 s40, 3
    s_cbranch_scc1 L_p1_kernel_ld_39
    s_mov_b32 s36, 10485760
    buffer_store_dwordx4 v[36:39], v3, s[72:75], s36 offen sc1
    s_branch L_p1_kernel_st_40
L_p1_kernel_ld_39:
    s_add_u32 s35, s33, 49348608
    buffer_load_dwordx4 v[36:39], v1, s[12:15], s35 offen nt
L_p1_kernel_st_40:
    v_mov_b32 v6, 1140817920
    s_waitcnt vmcnt(12)
    v_pk_maximum3_f16 v5, v106, v107, v5
    v_mad_u32_u16 v6, v126, s50, v15 op_sel:[0,0,0,0]
    v_mad_u32_u16 v7, v126, s50, v15 op_sel:[1,0,0,0]
    v_mad_u32_u16 v8, v51, s50, v15 op_sel:[0,0,0,0]
    v_mad_u32_u16 v9, v51, s50, v15 op_sel:[1,0,0,0]
    v_add_u32_sdwa v6, v6, v126 dst_sel:DWORD dst_unused:UNUSED_PAD src0_sel:WORD_1 src1_sel:WORD_0
    v_add_u32_sdwa v7, v7, v126 dst_sel:DWORD dst_unused:UNUSED_PAD src0_sel:WORD_1 src1_sel:WORD_1
    v_add_u32_sdwa v8, v8, v51 dst_sel:DWORD dst_unused:UNUSED_PAD src0_sel:WORD_1 src1_sel:WORD_0
    v_add_u32_sdwa v9, v9, v51 dst_sel:DWORD dst_unused:UNUSED_PAD src0_sel:WORD_1 src1_sel:WORD_1
    v_add_u32 v6, v6, v6
    v_add_u32 v7, v7, v7
    v_add_u32 v8, v8, v8
    v_add_u32 v9, v9, v9
    ds_write_b16 v6, v106 offset:16384
    ds_write_b16_d16_hi v7, v106 offset:16384
    ds_write_b16 v8, v107 offset:16384
    ds_write_b16_d16_hi v9, v107 offset:16384
    v_mov_b32 v6, 1140817920
    s_waitcnt vmcnt(11)
    v_pk_maximum3_f16 v5, v108, v109, v5
    v_mad_u32_u16 v6, v55, s50, v15 op_sel:[0,0,0,0]
    v_mad_u32_u16 v7, v55, s50, v15 op_sel:[1,0,0,0]
    v_mad_u32_u16 v8, v59, s50, v15 op_sel:[0,0,0,0]
    v_mad_u32_u16 v9, v59, s50, v15 op_sel:[1,0,0,0]
    v_add_u32_sdwa v6, v6, v55 dst_sel:DWORD dst_unused:UNUSED_PAD src0_sel:WORD_1 src1_sel:WORD_0
    v_add_u32_sdwa v7, v7, v55 dst_sel:DWORD dst_unused:UNUSED_PAD src0_sel:WORD_1 src1_sel:WORD_1
    v_add_u32_sdwa v8, v8, v59 dst_sel:DWORD dst_unused:UNUSED_PAD src0_sel:WORD_1 src1_sel:WORD_0
    v_add_u32_sdwa v9, v9, v59 dst_sel:DWORD dst_unused:UNUSED_PAD src0_sel:WORD_1 src1_sel:WORD_1
    v_add_u32 v6, v6, v6
    v_add_u32 v7, v7, v7
    v_add_u32 v8, v8, v8
    v_add_u32 v9, v9, v9
    ds_write_b16 v6, v108 offset:16384
    ds_write_b16_d16_hi v7, v108 offset:16384
    ds_write_b16 v8, v109 offset:16384
    ds_write_b16_d16_hi v9, v109 offset:16384
    v_mov_b32 v6, 1140817920
    s_waitcnt vmcnt(10)
    v_pk_maximum3_f16 v5, v110, v111, v5
    v_mad_u32_u16 v6, v63, s50, v15 op_sel:[0,0,0,0]
    v_mad_u32_u16 v7, v63, s50, v15 op_sel:[1,0,0,0]
    v_mad_u32_u16 v8, v67, s50, v15 op_sel:[0,0,0,0]
    v_mad_u32_u16 v9, v67, s50, v15 op_sel:[1,0,0,0]
    v_add_u32_sdwa v6, v6, v63 dst_sel:DWORD dst_unused:UNUSED_PAD src0_sel:WORD_1 src1_sel:WORD_0
    v_add_u32_sdwa v7, v7, v63 dst_sel:DWORD dst_unused:UNUSED_PAD src0_sel:WORD_1 src1_sel:WORD_1
    v_add_u32_sdwa v8, v8, v67 dst_sel:DWORD dst_unused:UNUSED_PAD src0_sel:WORD_1 src1_sel:WORD_0
    v_add_u32_sdwa v9, v9, v67 dst_sel:DWORD dst_unused:UNUSED_PAD src0_sel:WORD_1 src1_sel:WORD_1
    v_add_u32 v6, v6, v6
    v_add_u32 v7, v7, v7
    v_add_u32 v8, v8, v8
    v_add_u32 v9, v9, v9
    ds_write_b16 v6, v110 offset:16384
    ds_write_b16_d16_hi v7, v110 offset:16384
    ds_write_b16 v8, v111 offset:16384
    ds_write_b16_d16_hi v9, v111 offset:16384
    s_cmp_lg_u32 s40, 3
    s_cbranch_scc1 L_p1_kernel_ld_41
    s_mov_b32 s36, 11534336
    buffer_store_dwordx4 v[40:43], v3, s[72:75], s36 offen sc1
    s_branch L_p1_kernel_st_42
L_p1_kernel_ld_41:
    s_add_u32 s35, s33, 53542912
    buffer_load_dwordx4 v[40:43], v1, s[8:11], s35 offen nt
L_p1_kernel_st_42:
    v_mov_b32 v6, 1140817920
    s_waitcnt vmcnt(10)
    v_pk_maximum3_f16 v5, v112, v113, v5
    v_mad_u32_u16 v6, v71, s50, v15 op_sel:[0,0,0,0]
    v_mad_u32_u16 v7, v71, s50, v15 op_sel:[1,0,0,0]
    v_mad_u32_u16 v8, v75, s50, v15 op_sel:[0,0,0,0]
    v_mad_u32_u16 v9, v75, s50, v15 op_sel:[1,0,0,0]
    v_add_u32_sdwa v6, v6, v71 dst_sel:DWORD dst_unused:UNUSED_PAD src0_sel:WORD_1 src1_sel:WORD_0
    v_add_u32_sdwa v7, v7, v71 dst_sel:DWORD dst_unused:UNUSED_PAD src0_sel:WORD_1 src1_sel:WORD_1
    v_add_u32_sdwa v8, v8, v75 dst_sel:DWORD dst_unused:UNUSED_PAD src0_sel:WORD_1 src1_sel:WORD_0
    v_add_u32_sdwa v9, v9, v75 dst_sel:DWORD dst_unused:UNUSED_PAD src0_sel:WORD_1 src1_sel:WORD_1
    v_add_u32 v6, v6, v6
    v_add_u32 v7, v7, v7
    v_add_u32 v8, v8, v8
    v_add_u32 v9, v9, v9
    ds_write_b16 v6, v112 offset:16384
    ds_write_b16_d16_hi v7, v112 offset:16384
    ds_write_b16 v8, v113 offset:16384
    ds_write_b16_d16_hi v9, v113 offset:16384
    v_mov_b32 v6, 1140817920
    s_waitcnt vmcnt(9)
    v_pk_maximum3_f16 v5, v114, v115, v5
    v_mad_u32_u16 v6, v79, s50, v15 op_sel:[0,0,0,0]
    v_mad_u32_u16 v7, v79, s50, v15 op_sel:[1,0,0,0]
    v_mad_u32_u16 v8, v83, s50, v15 op_sel:[0,0,0,0]
    v_mad_u32_u16 v9, v83, s50, v15 op_sel:[1,0,0,0]
    v_add_u32_sdwa v6, v6, v79 dst_sel:DWORD dst_unused:UNUSED_PAD src0_sel:WORD_1 src1_sel:WORD_0
    v_add_u32_sdwa v7, v7, v79 dst_sel:DWORD dst_unused:UNUSED_PAD src0_sel:WORD_1 src1_sel:WORD_1
    v_add_u32_sdwa v8, v8, v83 dst_sel:DWORD dst_unused:UNUSED_PAD src0_sel:WORD_1 src1_sel:WORD_0
    v_add_u32_sdwa v9, v9, v83 dst_sel:DWORD dst_unused:UNUSED_PAD src0_sel:WORD_1 src1_sel:WORD_1
    v_add_u32 v6, v6, v6
    v_add_u32 v7, v7, v7
    v_add_u32 v8, v8, v8
    v_add_u32 v9, v9, v9
    ds_write_b16 v6, v114 offset:16384
    ds_write_b16_d16_hi v7, v114 offset:16384
    ds_write_b16 v8, v115 offset:16384
    ds_write_b16_d16_hi v9, v115 offset:16384
    v_mov_b32 v6, 1140817920
    s_waitcnt vmcnt(8)
    v_pk_maximum3_f16 v5, v116, v117, v5
    v_mad_u32_u16 v6, v87, s50, v15 op_sel:[0,0,0,0]
    v_mad_u32_u16 v7, v87, s50, v15 op_sel:[1,0,0,0]
    v_mad_u32_u16 v8, v91, s50, v15 op_sel:[0,0,0,0]
    v_mad_u32_u16 v9, v91, s50, v15 op_sel:[1,0,0,0]
    v_add_u32_sdwa v6, v6, v87 dst_sel:DWORD dst_unused:UNUSED_PAD src0_sel:WORD_1 src1_sel:WORD_0
    v_add_u32_sdwa v7, v7, v87 dst_sel:DWORD dst_unused:UNUSED_PAD src0_sel:WORD_1 src1_sel:WORD_1
    v_add_u32_sdwa v8, v8, v91 dst_sel:DWORD dst_unused:UNUSED_PAD src0_sel:WORD_1 src1_sel:WORD_0
    v_add_u32_sdwa v9, v9, v91 dst_sel:DWORD dst_unused:UNUSED_PAD src0_sel:WORD_1 src1_sel:WORD_1
    v_add_u32 v6, v6, v6
    v_add_u32 v7, v7, v7
    v_add_u32 v8, v8, v8
    v_add_u32 v9, v9, v9
    ds_write_b16 v6, v116 offset:16384
    ds_write_b16_d16_hi v7, v116 offset:16384
    ds_write_b16 v8, v117 offset:16384
    ds_write_b16_d16_hi v9, v117 offset:16384
    s_cmp_lg_u32 s40, 3
    s_cbranch_scc1 L_p1_kernel_ld_43
    s_mov_b32 s36, 12582912
    buffer_store_dwordx4 v[44:47], v3, s[72:75], s36 offen sc1
    s_branch L_p1_kernel_st_44
L_p1_kernel_ld_43:
    s_add_u32 s35, s33, 53542912
    buffer_load_dwordx4 v[44:47], v1, s[12:15], s35 offen nt
L_p1_kernel_st_44:
    v_mov_b32 v6, 1140817920
    s_mov_b64 exec, s[44:45]
    s_waitcnt vmcnt(8)
    v_pk_maximum3_f16 v5, v118, v119, v5
    s_mov_b64 exec, -1
    s_mov_b64 exec, s[44:45]
    v_mad_u32_u16 v6, v95, s50, v15 op_sel:[0,0,0,0]
    v_mad_u32_u16 v7, v95, s50, v15 op_sel:[1,0,0,0]
    v_mad_u32_u16 v8, v99, s50, v15 op_sel:[0,0,0,0]
    v_mad_u32_u16 v9, v99, s50, v15 op_sel:[1,0,0,0]
    v_add_u32_sdwa v6, v6, v95 dst_sel:DWORD dst_unused:UNUSED_PAD src0_sel:WORD_1 src1_sel:WORD_0
    v_add_u32_sdwa v7, v7, v95 dst_sel:DWORD dst_unused:UNUSED_PAD src0_sel:WORD_1 src1_sel:WORD_1
    v_add_u32_sdwa v8, v8, v99 dst_sel:DWORD dst_unused:UNUSED_PAD src0_sel:WORD_1 src1_sel:WORD_0
    v_add_u32_sdwa v9, v9, v99 dst_sel:DWORD dst_unused:UNUSED_PAD src0_sel:WORD_1 src1_sel:WORD_1
    v_add_u32 v6, v6, v6
    v_add_u32 v7, v7, v7
    v_add_u32 v8, v8, v8
    v_add_u32 v9, v9, v9
    ds_write_b16 v6, v118 offset:16384
    ds_write_b16_d16_hi v7, v118 offset:16384
    ds_write_b16 v8, v119 offset:16384
    ds_write_b16_d16_hi v9, v119 offset:16384
    s_mov_b64 exec, -1
    s_mul_i32 s35, s39, 6144
    v_add_u32 v6, s35, v2
    v_mov_b32 v10, 1140817920
    s_waitcnt lgkmcnt(0)
    s_barrier
    ds_read_b64 v[120:121], v6 offset:23040
    ds_read_b64 v[122:123], v6 offset:16384
    ds_read_b64 v[124:125], v6 offset:16896
    ds_read_b64 v[126:127], v6 offset:17408
    ds_read_b64 v[100:101], v6 offset:17920
    ds_read_b64 v[102:103], v6 offset:18432
    ds_read_b64 v[104:105], v6 offset:18944
    ds_read_b64 v[106:107], v6 offset:19456
    ds_read_b64 v[108:109], v6 offset:19968
    ds_read_b64 v[110:111], v6 offset:20480
    ds_read_b64 v[112:113], v6 offset:20992
    ds_read_b64 v[114:115], v6 offset:21504
    ds_read_b64 v[116:117], v6 offset:22016
    ds_read_b64 v[118:119], v6 offset:22528
    s_add_u32 s32, s32, 256
    s_add_u32 s33, s33, 40960000
    s_add_u32 s34, s34, 20480000
    s_add_u32 s40, s40, 1
    s_cmp_lt_u32 s40, 4
    s_cbranch_scc1 L_p1_loop
    s_cmp_lg_u32 s39, 15
    s_cbranch_scc1 L_p1_kernel_nox_45
    s_waitcnt lgkmcnt(13)
    v_lshlrev_b32 v15, 16, v120
    v_and_b32 v120, 0xffff0000, v120
    v_lshlrev_b32 v121, 16, v121
    v_mul_f32 v15, s41, v15
    v_mul_f32 v120, s41, v120
    v_mul_f32 v121, s41, v121
    v_fract_f32 v15, v15
    v_fract_f32 v120, v120
    v_fract_f32 v121, v121
    v_cos_f32 v15, v15
    v_cos_f32 v120, v120
    v_cos_f32 v121, v121
    v_fmaak_f32 v15, v10, v15, 1262486016
    v_fmaak_f32 v120, v10, v120, 1262486016
    v_fmaak_f32 v121, v10, v121, 1262486016
    v_lshlrev_b32 v15, 22, v15
    v_alignbit_b32 v15, v120, v15, 10
    v_alignbit_b32 v15, v121, v15, 10
    v_xor_b32 v15, 0x80200800, v15
    s_mov_b32 s36, 13631488
    buffer_store_dwordx4 v[12:15], v3, s[20:23], s36 offen sc1
L_p1_kernel_nox_45:
    s_waitcnt lgkmcnt(12)
    v_lshlrev_b32 v75, 16, v122
    v_and_b32 v122, 0xffff0000, v122
    v_lshlrev_b32 v123, 16, v123
    v_mul_f32 v75, s41, v75
    v_mul_f32 v122, s41, v122
    v_mul_f32 v123, s41, v123
    v_fract_f32 v75, v75
    v_fract_f32 v122, v122
    v_fract_f32 v123, v123
    v_cos_f32 v75, v75
    v_cos_f32 v122, v122
    v_cos_f32 v123, v123
    v_fmaak_f32 v75, v10, v75, 1262486016
    v_fmaak_f32 v122, v10, v122, 1262486016
    v_fmaak_f32 v123, v10, v123, 1262486016
    v_lshlrev_b32 v75, 22, v75
    v_alignbit_b32 v75, v122, v75, 10
    v_alignbit_b32 v75, v123, v75, 10
    v_xor_b32 v75, 0x80200800, v75
    s_mov_b32 s36, 0
    buffer_store_dwordx4 v[72:75], v3, s[20:23], s36 offen sc1
    s_waitcnt lgkmcnt(11)
    v_lshlrev_b32 v79, 16, v124
    v_and_b32 v124, 0xffff0000, v124
    v_lshlrev_b32 v125, 16, v125
    v_mul_f32 v79, s41, v79
    v_mul_f32 v124, s41, v124
    v_mul_f32 v125, s41, v125
    v_fract_f32 v79, v79
    v_fract_f32 v124, v124
    v_fract_f32 v125, v125
    v_cos_f32 v79, v79
    v_cos_f32 v124, v124
    v_cos_f32 v125, v125
    v_fmaak_f32 v79, v10, v79, 1262486016
    v_fmaak_f32 v124, v10, v124, 1262486016
    v_fmaak_f32 v125, v10, v125, 1262486016
    v_lshlrev_b32 v79, 22, v79
    v_alignbit_b32 v79, v124, v79, 10
    v_alignbit_b32 v79, v125, v79, 10
    v_xor_b32 v79, 0x80200800, v79
    s_mov_b32 s36, 1048576
    buffer_store_dwordx4 v[76:79], v3, s[20:23], s36 offen sc1
    s_waitcnt lgkmcnt(0)
    v_lshlrev_b32 v51, 16, v126
    v_and_b32 v126, 0xffff0000, v126
    v_lshlrev_b32 v127, 16, v127
    v_mul_f32 v51, s41, v51
    v_mul_f32 v126, s41, v126
    v_mul_f32 v127, s41, v127
    v_fract_f32 v51, v51
    v_fract_f32 v126, v126
    v_fract_f32 v127, v127
    v_cos_f32 v51, v51
    v_cos_f32 v126, v126
    v_cos_f32 v127, v127
    v_fmaak_f32 v51, v10, v51, 1262486016
    v_fmaak_f32 v126, v10, v126, 1262486016
    v_fmaak_f32 v127, v10, v127, 1262486016
    v_lshlrev_b32 v51, 22, v51
    v_alignbit_b32 v51, v126, v51, 10
    v_alignbit_b32 v51, v127, v51, 10
    v_xor_b32 v51, 0x80200800, v51
    s_mov_b32 s36, 2097152
    buffer_store_dwordx4 v[48:51], v3, s[20:23], s36 offen sc1
    v_lshlrev_b32 v83, 16, v100
    v_and_b32 v100, 0xffff0000, v100
    v_lshlrev_b32 v101, 16, v101
    v_mul_f32 v83, s41, v83
    v_mul_f32 v100, s41, v100
    v_mul_f32 v101, s41, v101
    v_fract_f32 v83, v83
    v_fract_f32 v100, v100
    v_fract_f32 v101, v101
    v_cos_f32 v83, v83
    v_cos_f32 v100, v100
    v_cos_f32 v101, v101
    v_fmaak_f32 v83, v10, v83, 1262486016
    v_fmaak_f32 v100, v10, v100, 1262486016
    v_fmaak_f32 v101, v10, v101, 1262486016
    v_lshlrev_b32 v83, 22, v83
    v_alignbit_b32 v83, v100, v83, 10
    v_alignbit_b32 v83, v101, v83, 10
    v_xor_b32 v83, 0x80200800, v83
    s_mov_b32 s36, 3145728
    buffer_store_dwordx4 v[80:83], v3, s[20:23], s36 offen sc1
    v_lshlrev_b32 v55, 16, v102
    v_and_b32 v102, 0xffff0000, v102
    v_lshlrev_b32 v103, 16, v103
    v_mul_f32 v55, s41, v55
    v_mul_f32 v102, s41, v102
    v_mul_f32 v103, s41, v103
    v_fract_f32 v55, v55
    v_fract_f32 v102, v102
    v_fract_f32 v103, v103
    v_cos_f32 v55, v55
    v_cos_f32 v102, v102
    v_cos_f32 v103, v103
    v_fmaak_f32 v55, v10, v55, 1262486016
    v_fmaak_f32 v102, v10, v102, 1262486016
    v_fmaak_f32 v103, v10, v103, 1262486016
    v_lshlrev_b32 v55, 22, v55
    v_alignbit_b32 v55, v102, v55, 10
    v_alignbit_b32 v55, v103, v55, 10
    v_xor_b32 v55, 0x80200800, v55
    s_mov_b32 s36, 4194304
    buffer_store_dwordx4 v[52:55], v3, s[20:23], s36 offen sc1
    v_lshlrev_b32 v87, 16, v104
    v_and_b32 v104, 0xffff0000, v104
    v_lshlrev_b32 v105, 16, v105
    v_mul_f32 v87, s41, v87
    v_mul_f32 v104, s41, v104
    v_mul_f32 v105, s41, v105
    v_fract_f32 v87, v87
    v_fract_f32 v104, v104
    v_fract_f32 v105, v105
    v_cos_f32 v87, v87
    v_cos_f32 v104, v104
    v_cos_f32 v105, v105
    v_fmaak_f32 v87, v10, v87, 1262486016
    v_fmaak_f32 v104, v10, v104, 1262486016
    v_fmaak_f32 v105, v10, v105, 1262486016
    v_lshlrev_b32 v87, 22, v87
    v_alignbit_b32 v87, v104, v87, 10
    v_alignbit_b32 v87, v105, v87, 10
    v_xor_b32 v87, 0x80200800, v87
    s_mov_b32 s36, 5242880
    buffer_store_dwordx4 v[84:87], v3, s[20:23], s36 offen sc1
    v_lshlrev_b32 v59, 16, v106
    v_and_b32 v106, 0xffff0000, v106
    v_lshlrev_b32 v107, 16, v107
    v_mul_f32 v59, s41, v59
    v_mul_f32 v106, s41, v106
    v_mul_f32 v107, s41, v107
    v_fract_f32 v59, v59
    v_fract_f32 v106, v106
    v_fract_f32 v107, v107
    v_cos_f32 v59, v59
    v_cos_f32 v106, v106
    v_cos_f32 v107, v107
    v_fmaak_f32 v59, v10, v59, 1262486016
    v_fmaak_f32 v106, v10, v106, 1262486016
    v_fmaak_f32 v107, v10, v107, 1262486016
    v_lshlrev_b32 v59, 22, v59
    v_alignbit_b32 v59, v106, v59, 10
    v_alignbit_b32 v59, v107, v59, 10
    v_xor_b32 v59, 0x80200800, v59
    s_mov_b32 s36, 6291456
    buffer_store_dwordx4 v[56:59], v3, s[20:23], s36 offen sc1
    v_lshlrev_b32 v91, 16, v108
    v_and_b32 v108, 0xffff0000, v108
    v_lshlrev_b32 v109, 16, v109
    v_mul_f32 v91, s41, v91
    v_mul_f32 v108, s41, v108
    v_mul_f32 v109, s41, v109
    v_fract_f32 v91, v91
    v_fract_f32 v108, v108
    v_fract_f32 v109, v109
    v_cos_f32 v91, v91
    v_cos_f32 v108, v108
    v_cos_f32 v109, v109
    v_fmaak_f32 v91, v10, v91, 1262486016
    v_fmaak_f32 v108, v10, v108, 1262486016
    v_fmaak_f32 v109, v10, v109, 1262486016
    v_lshlrev_b32 v91, 22, v91
    v_alignbit_b32 v91, v108, v91, 10
    v_alignbit_b32 v91, v109, v91, 10
    v_xor_b32 v91, 0x80200800, v91
    s_mov_b32 s36, 7340032
    buffer_store_dwordx4 v[88:91], v3, s[20:23], s36 offen sc1
    v_lshlrev_b32 v63, 16, v110
    v_and_b32 v110, 0xffff0000, v110
    v_lshlrev_b32 v111, 16, v111
    v_mul_f32 v63, s41, v63
    v_mul_f32 v110, s41, v110
    v_mul_f32 v111, s41, v111
    v_fract_f32 v63, v63
    v_fract_f32 v110, v110
    v_fract_f32 v111, v111
    v_cos_f32 v63, v63
    v_cos_f32 v110, v110
    v_cos_f32 v111, v111
    v_fmaak_f32 v63, v10, v63, 1262486016
    v_fmaak_f32 v110, v10, v110, 1262486016
    v_fmaak_f32 v111, v10, v111, 1262486016
    v_lshlrev_b32 v63, 22, v63
    v_alignbit_b32 v63, v110, v63, 10
    v_alignbit_b32 v63, v111, v63, 10
    v_xor_b32 v63, 0x80200800, v63
    s_mov_b32 s36, 8388608
    buffer_store_dwordx4 v[60:63], v3, s[20:23], s36 offen sc1
    v_lshlrev_b32 v95, 16, v112
    v_and_b32 v112, 0xffff0000, v112
    v_lshlrev_b32 v113, 16, v113
    v_mul_f32 v95, s41, v95
    v_mul_f32 v112, s41, v112
    v_mul_f32 v113, s41, v113
    v_fract_f32 v95, v95
    v_fract_f32 v112, v112
    v_fract_f32 v113, v113
    v_cos_f32 v95, v95
    v_cos_f32 v112, v112
    v_cos_f32 v113, v113
    v_fmaak_f32 v95, v10, v95, 1262486016
    v_fmaak_f32 v112, v10, v112, 1262486016
    v_fmaak_f32 v113, v10, v113, 1262486016
    v_lshlrev_b32 v95, 22, v95
    v_alignbit_b32 v95, v112, v95, 10
    v_alignbit_b32 v95, v113, v95, 10
    v_xor_b32 v95, 0x80200800, v95
    s_mov_b32 s36, 9437184
    buffer_store_dwordx4 v[92:95], v3, s[20:23], s36 offen sc1
    v_lshlrev_b32 v67, 16, v114
    v_and_b32 v114, 0xffff0000, v114
    v_lshlrev_b32 v115, 16, v115
    v_mul_f32 v67, s41, v67
    v_mul_f32 v114, s41, v114
    v_mul_f32 v115, s41, v115
    v_fract_f32 v67, v67
    v_fract_f32 v114, v114
    v_fract_f32 v115, v115
    v_cos_f32 v67, v67
    v_cos_f32 v114, v114
    v_cos_f32 v115, v115
    v_fmaak_f32 v67, v10, v67, 1262486016
    v_fmaak_f32 v114, v10, v114, 1262486016
    v_fmaak_f32 v115, v10, v115, 1262486016
    v_lshlrev_b32 v67, 22, v67
    v_alignbit_b32 v67, v114, v67, 10
    v_alignbit_b32 v67, v115, v67, 10
    v_xor_b32 v67, 0x80200800, v67
    s_mov_b32 s36, 10485760
    buffer_store_dwordx4 v[64:67], v3, s[20:23], s36 offen sc1
    v_lshlrev_b32 v99, 16, v116
    v_and_b32 v116, 0xffff0000, v116
    v_lshlrev_b32 v117, 16, v117
    v_mul_f32 v99, s41, v99
    v_mul_f32 v116, s41, v116
    v_mul_f32 v117, s41, v117
    v_fract_f32 v99, v99
    v_fract_f32 v116, v116
    v_fract_f32 v117, v117
    v_cos_f32 v99, v99
    v_cos_f32 v116, v116
    v_cos_f32 v117, v117
    v_fmaak_f32 v99, v10, v99, 1262486016
    v_fmaak_f32 v116, v10, v116, 1262486016
    v_fmaak_f32 v117, v10, v117, 1262486016
    v_lshlrev_b32 v99, 22, v99
    v_alignbit_b32 v99, v116, v99, 10
    v_alignbit_b32 v99, v117, v99, 10
    v_xor_b32 v99, 0x80200800, v99
    s_mov_b32 s36, 11534336
    buffer_store_dwordx4 v[96:99], v3, s[20:23], s36 offen sc1
    v_lshlrev_b32 v71, 16, v118
    v_and_b32 v118, 0xffff0000, v118
    v_lshlrev_b32 v119, 16, v119
    v_mul_f32 v71, s41, v71
    v_mul_f32 v118, s41, v118
    v_mul_f32 v119, s41, v119
    v_fract_f32 v71, v71
    v_fract_f32 v118, v118
    v_fract_f32 v119, v119
    v_cos_f32 v71, v71
    v_cos_f32 v118, v118
    v_cos_f32 v119, v119
    v_fmaak_f32 v71, v10, v71, 1262486016
    v_fmaak_f32 v118, v10, v118, 1262486016
    v_fmaak_f32 v119, v10, v119, 1262486016
    v_lshlrev_b32 v71, 22, v71
    v_alignbit_b32 v71, v118, v71, 10
    v_alignbit_b32 v71, v119, v71, 10
    v_xor_b32 v71, 0x80200800, v71
    s_mov_b32 s36, 12582912
    buffer_store_dwordx4 v[68:71], v3, s[20:23], s36 offen sc1
    v_and_b32 v6, 0x7c007c00, v5
    v_add_u32 v6, 0x04000400, v6
    v_and_b32 v6, 0x80008000, v6
    v_cmp_ne_u32 vcc, 0, v6
    s_lshl_b32 s35, s39, 4
    s_add_u32 s35, s35, 160328
    v_mov_b32 v10, s35
    s_cmp_lg_u64 vcc, 0
    s_cselect_b32 s36, 1, s55
    v_mov_b32 v11, s36
    ds_write_b32 v10, v11
    s_waitcnt lgkmcnt(0)
    s_barrier
    s_cmp_lg_u32 s39, 0
    s_cbranch_scc1 L_p1_end
    v_and_b32 v6, 15, v0
    v_lshlrev_b32 v6, 4, v6
    v_add_u32 v6, 160320, v6
    ds_read_b128 v[8:11], v6
    s_waitcnt lgkmcnt(0)
    s_nop 1
    v_max_u32_dpp v8, v8, v8 row_shr:1 row_mask:0xf bank_mask:0xf bound_ctrl:0
    s_nop 1
    v_max_u32_dpp v8, v8, v8 row_shr:2 row_mask:0xf bank_mask:0xf bound_ctrl:0
    s_nop 1
    v_max_u32_dpp v8, v8, v8 row_shr:4 row_mask:0xf bank_mask:0xf bound_ctrl:0
    s_nop 1
    v_max_u32_dpp v8, v8, v8 row_shr:8 row_mask:0xf bank_mask:0xf bound_ctrl:0
    s_nop 1
    v_add_f32_dpp v9, v9, v9 row_shr:1 row_mask:0xf bank_mask:0xf bound_ctrl:0
    s_nop 1
    v_add_f32_dpp v9, v9, v9 row_shr:2 row_mask:0xf bank_mask:0xf bound_ctrl:0
    s_nop 1
    v_add_f32_dpp v9, v9, v9 row_shr:4 row_mask:0xf bank_mask:0xf bound_ctrl:0
    s_nop 1
    v_add_f32_dpp v9, v9, v9 row_shr:8 row_mask:0xf bank_mask:0xf bound_ctrl:0
    s_nop 1
    v_or_b32_dpp v10, v10, v10 row_shr:1 row_mask:0xf bank_mask:0xf bound_ctrl:0
    s_nop 1
    v_or_b32_dpp v10, v10, v10 row_shr:2 row_mask:0xf bank_mask:0xf bound_ctrl:0
    s_nop 1
    v_or_b32_dpp v10, v10, v10 row_shr:4 row_mask:0xf bank_mask:0xf bound_ctrl:0
    s_nop 1
    v_or_b32_dpp v10, v10, v10 row_shr:8 row_mask:0xf bank_mask:0xf bound_ctrl:0
    s_lshl_b32 s35, s2, 3
    s_mov_b32 s26, 8540160
    s_add_u32 s35, s35, 8519680
    v_mov_b32 v6, 0
    v_lshl_or_b32 v8, v10, 16, v8
    s_mov_b64 exec, 0x8000
    buffer_store_dwordx2 v[8:9], v6, s[24:27], s35 offen
    s_lshl_b32 s35, s2, 8
    s_add_u32 s35, s35, 8523776
    buffer_store_dword v6, v6, s[24:27], s35 offen
L_p1_end:
    s_endpgm
.globl p2_kernel
.p2align 8
.type p2_kernel,@function
p2_kernel:
    s_cmp_ge_u32 s2, 256
    s_cbranch_scc1 L_p2_end
    s_load_dwordx2 s[4:5], s[0:1], 104
    s_load_dwordx2 s[100:101], s[0:1], 24
    s_load_dwordx2 s[8:9], s[0:1], 0
    s_load_dwordx2 s[30:31], s[0:1], 40
    s_load_dwordx4 s[32:35], s[0:1], 56
    s_load_dwordx4 s[36:39], s[0:1], 72
    s_and_b32 s14, s2, 7
    s_lshr_b32 s49, s2, 3
    s_and_b32 s3, s14, 1
    s_lshl_b32 s3, s3, 5
    s_add_u32 s3, s3, s49
    s_lshr_b32 s12, s14, 1
    v_lshrrev_b32 v108, 6, v0
    v_lshlrev_b32 v1, 4, v0
    v_and_b32 v109, 63, v0
    v_readfirstlane_b32 s13, v108
    v_lshlrev_b32 v111, 4, v109
    v_lshrrev_b32 v110, 2, v109
    v_mul_u32_u24 v110, 8256, v110
    v_add_u32 v110, v110, v111
    s_mul_i32 s14, s12, 65
    s_add_u32 s14, s14, s3
    s_lshl_b32 s14, s14, 5
    s_mul_i32 s15, s13, 532480
    s_add_u32 s14, s14, s15
    s_add_u32 s25, s14, 0
    s_mul_i32 s22, s12, 1280000
    s_mov_b32 s2, 0
    s_waitcnt lgkmcnt(0)
    s_mov_b32 s6, 655360000
    s_mov_b32 s7, 0x00020000
    s_add_u32 s10, s22, 1280000
    s_mov_b32 s11, 0x00020000
    s_add_u32 s15, s25, 0
    buffer_load_dwordx4 v[28:31], v110, s[4:7], s15 offen
    s_add_u32 s15, s25, 133120
    buffer_load_dwordx4 v[32:35], v110, s[4:7], s15 offen
    s_add_u32 s15, s25, 266240
    buffer_load_dwordx4 v[36:39], v110, s[4:7], s15 offen
    s_add_u32 s15, s25, 399360
    buffer_load_dwordx4 v[40:43], v110, s[4:7], s15 offen
    s_load_dwordx4 s[40:43], s[30:31], 0
    s_load_dwordx16 s[52:67], s[32:33], 0
    s_load_dwordx16 s[68:83], s[34:35], 0
    s_load_dwordx8 s[84:91], s[36:37], 0
    s_load_dwordx8 s[92:99], s[38:39], 0
    v_mov_b32 v52, 0x100
    s_cmp_lg_u32 s13, 0
    s_cbranch_scc1 L_p2_noann
    s_lshl_b32 s14, s3, 8
    s_add_u32 s14, s14, 8523776
    s_mov_b64 exec, 1
    buffer_atomic_add v52, off, s[4:7], s14
    s_mov_b64 exec, -1
L_p2_noann:
    s_add_u32 s14, s22, 0
    buffer_load_dwordx4 v[88:91], v1, s[8:11], s14 offen
    s_add_u32 s14, s22, 16384
    buffer_load_dwordx4 v[92:95], v1, s[8:11], s14 offen
    s_add_u32 s14, s22, 32768
    buffer_load_dwordx4 v[96:99], v1, s[8:11], s14 offen
    s_add_u32 s14, s22, 49152
    buffer_load_dwordx4 v[100:103], v1, s[8:11], s14 offen
    s_add_u32 s14, s22, 65536
    buffer_load_dwordx4 v[104:107], v1, s[8:11], s14 offen
    s_mov_b32 s15, 8519680
    buffer_load_dwordx4 v[80:83], v111, s[4:7], s15 offen offset:0
    buffer_load_dwordx4 v[84:87], v111, s[4:7], s15 offen offset:1024
    v_lshlrev_b32 v2, 10, v109
    v_mov_b32 v50, 21845
    v_add_u32 v3, 80000, v1
    v_add_u32 v124, 145536, v1
    v_add_u32 v113, 65536, v1
    v_mov_b32 v112, 0x7f000000
    v_cmp_gt_u32 vcc, 904, v0
    s_mul_i32 s19, s13, 240
    s_add_u32 s19, s19, 160000
    v_cndmask_b32 v124, v112, v124, vcc
    v_cndmask_b32 v113, v112, v113, vcc
    v_lshl_add_u32 v6, v109, 2, s19
    v_lshl_add_u32 v126, v109, 1, s19
    v_cmp_gt_u32 vcc, 10, v109
    s_lshl_b32 s27, s13, 16
    s_mov_b32 s23, 1024
    v_cndmask_b32 v6, v112, v6, vcc
    s_add_u32 s44, s4, 4194304
    s_addc_u32 s45, s5, 1048576
    s_mov_b32 s46, 14024704
    s_mov_b32 s47, 0x00020000
    s_mov_b32 s18, 80000
    s_and_b32 s50, s3, 1
    s_lshl_b32 s50, s50, 18
    s_sub_u32 s18, s18, s50
    s_sub_u32 s50, 4294836224, s50
    v_lshlrev_b32 v116, 3, v0
    v_and_b32 v116, 16, v116
    v_and_b32 v117, 1, v0
    v_lshl_or_b32 v116, v117, 5, v116
    v_mov_b32 v58, 0x3f80
    v_mov_b32 v59, 0
    v_lshlrev_b64 v[58:59], v116, v[58:59]
    v_mov_b32 v4, 0
    v_mov_b32 v5, 0
    v_mov_b32 v114, 0xff00
    v_bfe_u32 v127, v0, 0, 1
    v_mul_u32_u24 v127, 40, v127
    v_add_u32 v127, s19, v127
    ds_write2_b32 v6, v5, v5 offset0:34 offset1:44
    ds_write_b16 v126, v114 offset:2
    v_mov_b32 v44, 1073758208
    v_mov_b32 v45, 1073758208
    v_mov_b32 v46, 1073758208
    v_mov_b32 v47, 1073758208
    v_mov_b32 v48, 1073758208
    v_mov_b32 v49, 1073758208
    ds_write_b128 v113, v[44:47]
    v_lshrrev_b32 v115, 4, v109
    v_mul_u32_u24 v115, 15360, v115
    v_lshl_add_u32 v115, v109, 6, v115
    v_lshl_add_u32 v115, v108, 10, v115
    s_waitcnt lgkmcnt(0)
    v_mov_b32 v53, s40
    v_mov_b32 v54, s41
    v_mov_b32 v56, s42
    v_mov_b32 v57, s43
    s_mov_b32 s40, 20987904
    s_mov_b32 s41, 21031594
    s_pack_ll_b32_b16 s14, s52, s54
    s_pack_hh_b32_b16 s15, s52, s54
    s_pack_ll_b32_b16 s54, s53, s55
    s_pack_hh_b32_b16 s55, s53, s55
    s_mov_b32 s52, s14
    s_mov_b32 s53, s15
    s_pack_ll_b32_b16 s14, s56, s58
    s_pack_hh_b32_b16 s15, s56, s58
    s_pack_ll_b32_b16 s58, s57, s59
    s_pack_hh_b32_b16 s59, s57, s59
    s_mov_b32 s56, s14
    s_mov_b32 s57, s15
    s_pack_ll_b32_b16 s14, s60, s62
    s_pack_hh_b32_b16 s15, s60, s62
    s_pack_ll_b32_b16 s62, s61, s63
    s_pack_hh_b32_b16 s63, s61, s63
    s_mov_b32 s60, s14
    s_mov_b32 s61, s15
    s_pack_ll_b32_b16 s14, s64, s66
    s_pack_hh_b32_b16 s15, s64, s66
    s_pack_ll_b32_b16 s66, s65, s67
    s_pack_hh_b32_b16 s67, s65, s67
    s_mov_b32 s64, s14
    s_mov_b32 s65, s15
    s_pack_ll_b32_b16 s14, s68, s70
    s_pack_hh_b32_b16 s15, s68, s70
    s_pack_ll_b32_b16 s70, s69, s71
    s_pack_hh_b32_b16 s71, s69, s71
    s_mov_b32 s68, s14
    s_mov_b32 s69, s15
    s_pack_ll_b32_b16 s14, s72, s74
    s_pack_hh_b32_b16 s15, s72, s74
    s_pack_ll_b32_b16 s74, s73, s75
    s_pack_hh_b32_b16 s75, s73, s75
    s_mov_b32 s72, s14
    s_mov_b32 s73, s15
    s_pack_ll_b32_b16 s14, s76, s78
    s_pack_hh_b32_b16 s15, s76, s78
    s_pack_ll_b32_b16 s78, s77, s79
    s_pack_hh_b32_b16 s79, s77, s79
    s_mov_b32 s76, s14
    s_mov_b32 s77, s15
    s_pack_ll_b32_b16 s14, s80, s82
    s_pack_hh_b32_b16 s15, s80, s82
    s_pack_ll_b32_b16 s82, s81, s83
    s_pack_hh_b32_b16 s83, s81, s83
    s_mov_b32 s80, s14
    s_mov_b32 s81, s15
    s_waitcnt vmcnt(10)
    ds_write_b128 v1, v[28:31] offset:0
    s_waitcnt vmcnt(9)
    ds_write_b128 v1, v[32:35] offset:16384
    s_waitcnt vmcnt(8)
    ds_write_b128 v1, v[36:39] offset:32768
    s_waitcnt vmcnt(7)
    ds_write_b128 v1, v[40:43] offset:49152
    ds_read_b128 v[28:31], v115 offset:0
    ds_read_b128 v[36:39], v115 offset:32
    ds_read_b128 v[32:35], v115 offset:16
    ds_read_b128 v[40:43], v115 offset:48
    ds_write_b128 v1, v[44:47] offset:0
    ds_write_b128 v1, v[44:47] offset:16384
    ds_write_b128 v1, v[44:47] offset:32768
    ds_write_b128 v1, v[44:47] offset:49152
    s_waitcnt lgkmcnt(6)
    v_mad_u32_u16 v108, v28, v50, s40 op_sel:[0,0,0,0]
    v_mad_u32_u16 v109, v36, v50, s41 op_sel:[0,0,0,0]
    v_sub_u32_sdwa v110, v109, v108 dst_sel:DWORD dst_unused:UNUSED_PAD src0_sel:WORD_1 src1_sel:WORD_1
    s_nop 1
    v_add_u32_dpp v110, v110, v110 row_shr:1 row_mask:0xf bank_mask:0xf bound_ctrl:0
    s_nop 1
    v_add_u32_dpp v110, v110, v110 row_shr:2 row_mask:0xf bank_mask:0xf bound_ctrl:0
    s_nop 1
    v_add_u32_dpp v110, v110, v110 row_shr:4 row_mask:0xf bank_mask:0xf bound_ctrl:0
    s_nop 1
    v_add_u32_dpp v110, v110, v110 row_shr:8 row_mask:0xf bank_mask:0xf bound_ctrl:0
    s_nop 1
    v_add_u32_dpp v110, v110, v110 row_bcast:15 row_mask:0xa bank_mask:0xf
    s_nop 1
    v_add_u32_dpp v110, v110, v110 row_bcast:31 row_mask:0xc bank_mask:0xf
    v_sub_u32_sdwa v109, v109, v110 dst_sel:DWORD dst_unused:UNUSED_PAD src0_sel:WORD_1 src1_sel:DWORD
    v_readlane_b32 s29, v110, 63
    v_add_u32 v110, -1, v110
    ds_write_b16 v126, v109
    v_lshlrev_b32_e64 v111, v110, 1
    v_lshrrev_b32 v110, 5, v110
    s_cmp_gt_u32 s29, 320
    s_cselect_b32 s2, 1, s2
    v_lshl_add_u32 v110, v110, 2, v127
    s_cselect_b64 exec, 0, -1
    ds_or_b32 v110, v111 offset:136
    s_mov_b64 exec, -1
    ds_wrxchg2_rtn_b32 v[108:109], v6, v5, v5 offset0:34 offset1:44
    s_waitcnt lgkmcnt(0)
    v_or_b32 v7, v108, v109
    s_nop 0
    v_readlane_b32 s30, v7, 0
    v_readlane_b32 s31, v7, 1
    v_readlane_b32 s32, v7, 2
    v_readlane_b32 s33, v7, 3
    v_readlane_b32 s34, v7, 4
    v_readlane_b32 s35, v7, 5
    v_readlane_b32 s36, v7, 6
    v_readlane_b32 s37, v7, 7
    s_mov_b32 s25, s19
    s_mov_b32 s26, s27
    s_mov_b32 s51, s28
    s_mov_b32 s28, s29
    v_mbcnt_lo_u32_b32 v8, s30, 0
    v_mbcnt_hi_u32_b32 v8, s31, v8
    s_bcnt1_i32_b64 s14, s[30:31]
    v_lshl_add_u32 v9, v8, 1, s25
    ds_read_u16 v9, v9
    s_add_u32 s30, s26, 0
    s_lshl1_add_u32 s25, s14, s25
    s_lshl_b32 s14, s14, 10
    s_add_u32 s26, s26, s14
    v_mbcnt_lo_u32_b32 v12, s32, 0
    v_mbcnt_hi_u32_b32 v12, s33, v12
    s_bcnt1_i32_b64 s14, s[32:33]
    v_lshl_add_u32 v13, v12, 1, s25
    ds_read_u16 v13, v13
    s_add_u32 s32, s26, 1048576
    s_lshl1_add_u32 s25, s14, s25
    s_lshl_b32 s14, s14, 10
    s_add_u32 s26, s26, s14
    v_mbcnt_lo_u32_b32 v16, s34, 0
    v_mbcnt_hi_u32_b32 v16, s35, v16
    s_bcnt1_i32_b64 s14, s[34:35]
    v_lshl_add_u32 v17, v16, 1, s25
    ds_read_u16 v17, v17
    s_add_u32 s34, s26, 2097152
    s_lshl1_add_u32 s25, s14, s25
    s_lshl_b32 s14, s14, 10
    s_add_u32 s26, s26, s14
    v_mbcnt_lo_u32_b32 v20, s36, 0
    v_mbcnt_hi_u32_b32 v20, s37, v20
    s_bcnt1_i32_b64 s14, s[36:37]
    v_lshl_add_u32 v21, v20, 1, s25
    ds_read_u16 v21, v21
    s_add_u32 s36, s26, 3145728
    s_lshl1_add_u32 s25, s14, s25
    s_lshl_b32 s14, s14, 10
    s_add_u32 s26, s26, s14
    s_waitcnt lgkmcnt(3)
    v_mad_u32_u16 v9, v9, s23, v2
    v_pk_lshrrev_b16 v9, 10, v9 op_sel_hi:[1,1]
    v_lshl_add_u32 v8, v8, 6, v9
    buffer_load_dwordx4 v[8:11], v8, s[44:47], s30 idxen
    s_waitcnt lgkmcnt(2)
    v_mad_u32_u16 v13, v13, s23, v2
    v_pk_lshrrev_b16 v13, 10, v13 op_sel_hi:[1,1]
    v_lshl_add_u32 v12, v12, 6, v13
    buffer_load_dwordx4 v[12:15], v12, s[44:47], s32 idxen
    s_waitcnt lgkmcnt(1)
    v_mad_u32_u16 v17, v17, s23, v2
    v_pk_lshrrev_b16 v17, 10, v17 op_sel_hi:[1,1]
    v_lshl_add_u32 v16, v16, 6, v17
    buffer_load_dwordx4 v[16:19], v16, s[44:47], s34 idxen
    s_waitcnt lgkmcnt(0)
    v_mad_u32_u16 v21, v21, s23, v2
    v_pk_lshrrev_b16 v21, 10, v21 op_sel_hi:[1,1]
    v_lshl_add_u32 v20, v20, 6, v21
    buffer_load_dwordx4 v[20:23], v20, s[44:47], s36 idxen
    s_cmp_le_u32 s28, 256
    s_cbranch_scc1 L_p2_kernel_noopt_1
    v_readlane_b32 s38, v7, 8
    v_readlane_b32 s39, v7, 9
    s_nop 1
    v_mbcnt_lo_u32_b32 v51, s38, 0
    v_mbcnt_hi_u32_b32 v51, s39, v51
    s_bcnt1_i32_b64 s14, s[38:39]
    v_lshl_add_u32 v55, v51, 1, s25
    ds_read_u16 v55, v55
    s_add_u32 s38, s26, 4194304
    s_lshl1_add_u32 s25, s14, s25
    s_lshl_b32 s14, s14, 10
    s_add_u32 s26, s26, s14
    s_waitcnt lgkmcnt(0)
    v_mad_u32_u16 v55, v55, s23, v2
    v_pk_lshrrev_b16 v55, 10, v55 op_sel_hi:[1,1]
    v_lshl_add_u32 v51, v51, 6, v55
    buffer_load_dwordx4 v[24:27], v51, s[44:47], s38 idxen
L_p2_kernel_noopt_1:
    s_waitcnt vmcnt(6)
    ds_write_b128 v3, v[88:91] offset:0
    ds_write_b128 v3, v[92:95] offset:16384
    ds_write_b128 v3, v[96:99] offset:32768
    ds_write_b128 v3, v[100:103] offset:49152
    ds_write_b128 v124, v[104:107] offset:0
    s_waitcnt vmcnt(4)
    v_max3_u32 v64, v80, v82, v84
    v_add_f32 v65, v81, v83
    v_add_f32 v66, v85, v87
    v_max_u32 v64, v64, v86
    v_add_f32 v65, v65, v66
    v_cmp_lt_u32 vcc, 0xffff, v64
    s_nop 1
    v_max_u32_dpp v64, v64, v64 row_shr:1 row_mask:0xf bank_mask:0xf bound_ctrl:0
    s_nop 1
    v_max_u32_dpp v64, v64, v64 row_shr:2 row_mask:0xf bank_mask:0xf bound_ctrl:0
    s_nop 1
    v_max_u32_dpp v64, v64, v64 row_shr:4 row_mask:0xf bank_mask:0xf bound_ctrl:0
    s_nop 1
    v_max_u32_dpp v64, v64, v64 row_shr:8 row_mask:0xf bank_mask:0xf bound_ctrl:0
    s_nop 1
    v_max_u32_dpp v64, v64, v64 row_bcast:15 row_mask:0xa bank_mask:0xf
    s_nop 1
    v_max_u32_dpp v64, v64, v64 row_bcast:31 row_mask:0xc bank_mask:0xf
    s_nop 1
    v_add_f32_dpp v65, v65, v65 row_shr:1 row_mask:0xf bank_mask:0xf bound_ctrl:0
    s_nop 1
    v_add_f32_dpp v65, v65, v65 row_shr:2 row_mask:0xf bank_mask:0xf bound_ctrl:0
    s_nop 1
    v_add_f32_dpp v65, v65, v65 row_shr:4 row_mask:0xf bank_mask:0xf bound_ctrl:0
    s_nop 1
    v_add_f32_dpp v65, v65, v65 row_shr:8 row_mask:0xf bank_mask:0xf bound_ctrl:0
    s_nop 1
    v_add_f32_dpp v65, v65, v65 row_bcast:15 row_mask:0xa bank_mask:0xf
    s_nop 1
    v_add_f32_dpp v65, v65, v65 row_bcast:31 row_mask:0xc bank_mask:0xf
    s_cmp_lg_u64 vcc, 0
    s_cselect_b32 s2, 1, s2
    v_lshlrev_b32 v64, 16, v64
    v_mul_f32 v66, 936490775, v65
    v_mul_f32 v65, 928531664, v65
    v_cmp_nle_f32 vcc, v64, v66
    v_max_u32 v64, v64, v65
    s_nop 0
    v_readlane_b32 s14, v64, 63
    s_bitcmp1_b32 vcc_hi, 31
    s_cselect_b32 s2, 1, s2
    s_lshr_b32 s14, s14, 23
    s_add_u32 s14, s14, 1
    s_cmp_lt_u32 s14, 40
    s_cselect_b32 s2, 1, s2
    s_cmp_gt_u32 s14, 230
    s_cselect_b32 s2, 1, s2
    s_sub_u32 s48, s14, 14
    s_lshl_b32 s48, s48, 23
    s_add_u32 s16, s48, 272629760
    s_lshr_b32 s15, s16, 16
    s_sub_u32 s15, 0x10000, s15
    s_add_u32 s20, s16, s15
    s_sub_u32 s17, s20, 1
    s_mov_b32 s21, s17
    s_or_b32 s48, s48, 16416
    s_sub_u32 s14, s14, 40
    s_cmp_gt_u32 s14, 190
    s_cselect_b32 s48, 0, s48
    s_waitcnt lgkmcnt(0)
    s_barrier
    s_add_u32 s14, s22, 80000
    buffer_load_dwordx4 v[88:91], v1, s[8:11], s14 offen
    s_add_u32 s14, s22, 96384
    buffer_load_dwordx4 v[92:95], v1, s[8:11], s14 offen
    v_mad_u32_u16 v108, v28, v50, s40 op_sel:[1,0,0,0]
    v_mad_u32_u16 v109, v36, v50, s41 op_sel:[1,0,0,0]
    v_sub_u32_sdwa v110, v109, v108 dst_sel:DWORD dst_unused:UNUSED_PAD src0_sel:WORD_1 src1_sel:WORD_1
    s_nop 1
    v_add_u32_dpp v110, v110, v110 row_shr:1 row_mask:0xf bank_mask:0xf bound_ctrl:0
    s_nop 1
    v_add_u32_dpp v110, v110, v110 row_shr:2 row_mask:0xf bank_mask:0xf bound_ctrl:0
    s_nop 1
    v_add_u32_dpp v110, v110, v110 row_shr:4 row_mask:0xf bank_mask:0xf bound_ctrl:0
    s_nop 1
    v_add_u32_dpp v110, v110, v110 row_shr:8 row_mask:0xf bank_mask:0xf bound_ctrl:0
    s_nop 1
    v_add_u32_dpp v110, v110, v110 row_bcast:15 row_mask:0xa bank_mask:0xf
    s_nop 1
    v_add_u32_dpp v110, v110, v110 row_bcast:31 row_mask:0xc bank_mask:0xf
    v_sub_u32_sdwa v109, v109, v110 dst_sel:DWORD dst_unused:UNUSED_PAD src0_sel:WORD_1 src1_sel:DWORD
    v_readlane_b32 s29, v110, 63
    v_add_u32 v110, -1, v110
    ds_write_b16 v126, v109
    v_lshlrev_b32_e64 v111, v110, 1
    v_lshrrev_b32 v110, 5, v110
    s_cmp_gt_u32 s29, 320
    s_cselect_b32 s2, 1, s2
    v_lshl_add_u32 v110, v110, 2, v127
    s_cselect_b64 exec, 0, -1
    ds_or_b32 v110, v111 offset:136
    s_mov_b64 exec, -1
    ds_wrxchg2_rtn_b32 v[108:109], v6, v5, v5 offset0:34 offset1:44
    s_mov_b32 s24, 0
L_p2_loop:
    s_add_u32 s22, s22, 80000
    s_lshl_b32 s14, s13, 4
    s_or_b32 s14, s14, s24
    s_cmp_lg_u32 s14, 5
    s_cbranch_scc1 L_p2_nost
    v_mov_b32 v52, 0
    s_lshl_b32 s14, s3, 8
    s_add_u32 s14, s14, 8523776
    s_mov_b64 exec, 1
    buffer_atomic_add v52, off, s[4:7], s14 sc0
    s_mov_b64 exec, -1
L_p2_nost:
    s_waitcnt vmcnt(5)
    v_mad_u32_u16 v64, v8, 8, s18
    v_mad_u32_u16 v66, v9, 8, s18
    v_mad_u32_u16 v68, v10, 8, s18
    ds_read_b64 v[64:65], v64
    ds_read_b64 v[66:67], v66
    ds_read_b64 v[68:69], v68
    s_add_u32 s14, s22, 32768
    buffer_load_dwordx4 v[96:99], v1, s[8:11], s14 offen
    s_waitcnt vmcnt(5)
    v_mad_u32_u16 v70, v12, 8, s18
    v_mad_u32_u16 v72, v13, 8, s18
    v_mad_u32_u16 v74, v14, 8, s18
    ds_read_b64 v[70:71], v70
    ds_read_b64 v[72:73], v72
    ds_read_b64 v[74:75], v74
    s_add_u32 s14, s22, 49152
    buffer_load_dwordx4 v[100:103], v1, s[8:11], s14 offen
    s_waitcnt lgkmcnt(6)
    v_or_b32 v7, v108, v109
    s_nop 0
    v_readlane_b32 s30, v7, 0
    v_readlane_b32 s31, v7, 1
    v_readlane_b32 s32, v7, 2
    v_readlane_b32 s33, v7, 3
    v_readlane_b32 s34, v7, 4
    v_readlane_b32 s35, v7, 5
    v_readlane_b32 s36, v7, 6
    v_readlane_b32 s37, v7, 7
    s_mov_b32 s25, s19
    s_mov_b32 s26, s27
    s_mov_b32 s51, s28
    s_mov_b32 s28, s29
    v_mbcnt_lo_u32_b32 v51, s30, 0
    v_mbcnt_hi_u32_b32 v51, s31, v51
    s_bcnt1_i32_b64 s14, s[30:31]
    v_lshl_add_u32 v55, v51, 1, s25
    ds_read_u16 v55, v55
    s_add_u32 s30, s26, 0
    s_lshl1_add_u32 s25, s14, s25
    s_lshl_b32 s14, s14, 10
    s_add_u32 s26, s26, s14
    v_bfe_i32 v108, v11, 2, 10
    v_bfe_i32 v109, v11, 12, 10
    v_ashrrev_i32 v110, 22, v11
    v_cvt_f32_i32 v108, v108
    v_cvt_f32_i32 v109, v109
    v_cvt_f32_i32 v110, v110
    s_waitcnt lgkmcnt(4)
    v_mfma_f32_4x4x4_16b_bf16 v[112:115], v[58:59], v[64:65], 0
    v_mfma_f32_4x4x4_16b_bf16 v[116:119], v[58:59], v[66:67], 0
    v_mfma_f32_4x4x4_16b_bf16 v[120:123], v[58:59], v[68:69], 0
    v_mad_u32_u16 v8, v8, 8, s50 op_sel:[1,0,0,0]
    v_mad_u32_u16 v9, v9, 8, s50 op_sel:[1,0,0,0]
    v_mad_u32_u16 v10, v10, 8, s50 op_sel:[1,0,0,0]
    v_pk_fma_f32 v[114:115], v[114:115], v[108:109], s[20:21] op_sel:[0,0,0] op_sel_hi:[1,0,1]
    v_pk_fma_f32 v[112:113], v[112:113], v[108:109], s[16:17] op_sel:[0,0,0] op_sel_hi:[1,0,1]
    v_pk_fma_f32 v[118:119], v[118:119], v[108:109], s[20:21] op_sel:[0,1,0] op_sel_hi:[1,1,1]
    v_pk_fma_f32 v[116:117], v[116:117], v[108:109], s[16:17] op_sel:[0,1,0] op_sel_hi:[1,1,1]
    v_pk_fma_f32 v[122:123], v[122:123], v[110:111], s[20:21] op_sel:[0,0,0] op_sel_hi:[1,0,1]
    v_pk_fma_f32 v[120:121], v[120:121], v[110:111], s[16:17] op_sel:[0,0,0] op_sel_hi:[1,0,1]
    v_lshlrev_b64 v[114:115], 16, v[114:115]
    v_lshlrev_b64 v[118:119], 16, v[118:119]
    v_lshlrev_b64 v[122:123], 16, v[122:123]
    v_lshl_add_u64 v[64:65], v[112:113], 0, v[114:115]
    v_lshl_add_u64 v[66:67], v[116:117], 0, v[118:119]
    v_lshl_add_u64 v[68:69], v[120:121], 0, v[122:123]
    v_or3_b32 v4, v44, v45, v4
    v_or3_b32 v4, v46, v47, v4
    v_or3_b32 v4, v48, v49, v4
    ds_add_rtn_u64 v[44:45], v8, v[64:65]
    ds_add_rtn_u64 v[46:47], v9, v[66:67]
    ds_add_rtn_u64 v[48:49], v10, v[68:69]
    s_waitcnt lgkmcnt(3)
    v_mad_u32_u16 v55, v55, s23, v2
    v_pk_lshrrev_b16 v55, 10, v55 op_sel_hi:[1,1]
    v_lshl_add_u32 v51, v51, 6, v55
    buffer_load_dwordx4 v[8:11], v51, s[44:47], s30 idxen
    s_add_u32 s14, s22, 65536
    buffer_load_dwordx4 v[104:107], v1, s[8:11], s14 offen
    s_waitcnt vmcnt(7)
    v_mad_u32_u16 v76, v16, 8, s18
    v_mad_u32_u16 v78, v17, 8, s18
    v_mad_u32_u16 v80, v18, 8, s18
    ds_read_b64 v[76:77], v76
    ds_read_b64 v[78:79], v78
    ds_read_b64 v[80:81], v80
    s_waitcnt vmcnt(6)
    v_mad_u32_u16 v82, v20, 8, s18
    v_mad_u32_u16 v84, v21, 8, s18
    v_mad_u32_u16 v86, v22, 8, s18
    ds_read_b64 v[82:83], v82
    ds_read_b64 v[84:85], v84
    ds_read_b64 v[86:87], v86
    s_cmp_le_u32 s51, 256
    s_cbranch_scc1 L_p2_kernel_noopt3_2
    v_mad_u32_u16 v64, v24, 8, s18
    v_mad_u32_u16 v66, v25, 8, s18
    v_mad_u32_u16 v68, v26, 8, s18
    ds_read_b64 v[64:65], v64
    ds_read_b64 v[66:67], v66
    ds_read_b64 v[68:69], v68
L_p2_kernel_noopt3_2:
    v_mbcnt_lo_u32_b32 v51, s32, 0
    v_mbcnt_hi_u32_b32 v51, s33, v51
    s_bcnt1_i32_b64 s14, s[32:33]
    v_lshl_add_u32 v55, v51, 1, s25
    ds_read_u16 v55, v55
    s_add_u32 s32, s26, 1048576
    s_lshl1_add_u32 s25, s14, s25
    s_lshl_b32 s14, s14, 10
    s_add_u32 s26, s26, s14
    v_bfe_i32 v108, v15, 2, 10
    v_bfe_i32 v109, v15, 12, 10
    v_ashrrev_i32 v110, 22, v15
    v_cvt_f32_i32 v108, v108
    v_cvt_f32_i32 v109, v109
    v_cvt_f32_i32 v110, v110
    v_mfma_f32_4x4x4_16b_bf16 v[112:115], v[58:59], v[70:71], 0
    v_mfma_f32_4x4x4_16b_bf16 v[116:119], v[58:59], v[72:73], 0
    v_mfma_f32_4x4x4_16b_bf16 v[120:123], v[58:59], v[74:75], 0
    v_mad_u32_u16 v12, v12, 8, s50 op_sel:[1,0,0,0]
    v_mad_u32_u16 v13, v13, 8, s50 op_sel:[1,0,0,0]
    v_mad_u32_u16 v14, v14, 8, s50 op_sel:[1,0,0,0]
    v_pk_fma_f32 v[114:115], v[114:115], v[108:109], s[20:21] op_sel:[0,0,0] op_sel_hi:[1,0,1]
    v_pk_fma_f32 v[112:113], v[112:113], v[108:109], s[16:17] op_sel:[0,0,0] op_sel_hi:[1,0,1]
    v_pk_fma_f32 v[118:119], v[118:119], v[108:109], s[20:21] op_sel:[0,1,0] op_sel_hi:[1,1,1]
    v_pk_fma_f32 v[116:117], v[116:117], v[108:109], s[16:17] op_sel:[0,1,0] op_sel_hi:[1,1,1]
    v_pk_fma_f32 v[122:123], v[122:123], v[110:111], s[20:21] op_sel:[0,0,0] op_sel_hi:[1,0,1]
    v_pk_fma_f32 v[120:121], v[120:121], v[110:111], s[16:17] op_sel:[0,0,0] op_sel_hi:[1,0,1]
    v_lshlrev_b64 v[114:115], 16, v[114:115]
    v_lshlrev_b64 v[118:119], 16, v[118:119]
    v_lshlrev_b64 v[122:123], 16, v[122:123]
    v_lshl_add_u64 v[70:71], v[112:113], 0, v[114:115]
    v_lshl_add_u64 v[72:73], v[116:117], 0, v[118:119]
    v_lshl_add_u64 v[74:75], v[120:121], 0, v[122:123]
    s_waitcnt lgkmcnt(7)
    v_or3_b32 v4, v44, v45, v4
    v_or3_b32 v4, v46, v47, v4
    v_or3_b32 v4, v48, v49, v4
    ds_add_rtn_u64 v[44:45], v12, v[70:71]
    ds_add_rtn_u64 v[46:47], v13, v[72:73]
    ds_add_rtn_u64 v[48:49], v14, v[74:75]
    s_waitcnt lgkmcnt(3)
    v_mad_u32_u16 v55, v55, s23, v2
    v_pk_lshrrev_b16 v55, 10, v55 op_sel_hi:[1,1]
    v_lshl_add_u32 v51, v51, 6, v55
    buffer_load_dwordx4 v[12:15], v51, s[44:47], s32 idxen
    s_barrier
    s_waitcnt vmcnt(1)
    ds_write_b128 v3, v[88:91] offset:0
    ds_write_b128 v3, v[92:95] offset:16384
    ds_write_b128 v3, v[96:99] offset:32768
    ds_write_b128 v3, v[100:103] offset:49152
    ds_write_b128 v124, v[104:107] offset:0
    v_mbcnt_lo_u32_b32 v51, s34, 0
    v_mbcnt_hi_u32_b32 v51, s35, v51
    s_bcnt1_i32_b64 s14, s[34:35]
    v_lshl_add_u32 v55, v51, 1, s25
    ds_read_u16 v55, v55
    s_add_u32 s34, s26, 2097152
    s_lshl1_add_u32 s25, s14, s25
    s_lshl_b32 s14, s14, 10
    s_add_u32 s26, s26, s14
    v_bfe_i32 v108, v19, 2, 10
    v_bfe_i32 v109, v19, 12, 10
    v_ashrrev_i32 v110, 22, v19
    v_cvt_f32_i32 v108, v108
    v_cvt_f32_i32 v109, v109
    v_cvt_f32_i32 v110, v110
    v_mfma_f32_4x4x4_16b_bf16 v[112:115], v[58:59], v[76:77], 0
    v_mfma_f32_4x4x4_16b_bf16 v[116:119], v[58:59], v[78:79], 0
    v_mfma_f32_4x4x4_16b_bf16 v[120:123], v[58:59], v[80:81], 0
    v_mad_u32_u16 v16, v16, 8, s50 op_sel:[1,0,0,0]
    v_mad_u32_u16 v17, v17, 8, s50 op_sel:[1,0,0,0]
    v_mad_u32_u16 v18, v18, 8, s50 op_sel:[1,0,0,0]
    v_pk_fma_f32 v[114:115], v[114:115], v[108:109], s[20:21] op_sel:[0,0,0] op_sel_hi:[1,0,1]
    v_pk_fma_f32 v[112:113], v[112:113], v[108:109], s[16:17] op_sel:[0,0,0] op_sel_hi:[1,0,1]
    v_pk_fma_f32 v[118:119], v[118:119], v[108:109], s[20:21] op_sel:[0,1,0] op_sel_hi:[1,1,1]
    v_pk_fma_f32 v[116:117], v[116:117], v[108:109], s[16:17] op_sel:[0,1,0] op_sel_hi:[1,1,1]
    v_pk_fma_f32 v[122:123], v[122:123], v[110:111], s[20:21] op_sel:[0,0,0] op_sel_hi:[1,0,1]
    v_pk_fma_f32 v[120:121], v[120:121], v[110:111], s[16:17] op_sel:[0,0,0] op_sel_hi:[1,0,1]
    v_lshlrev_b64 v[114:115], 16, v[114:115]
    v_lshlrev_b64 v[118:119], 16, v[118:119]
    v_lshlrev_b64 v[122:123], 16, v[122:123]
    v_lshl_add_u64 v[76:77], v[112:113], 0, v[114:115]
    v_lshl_add_u64 v[78:79], v[116:117], 0, v[118:119]
    v_lshl_add_u64 v[80:81], v[120:121], 0, v[122:123]
    s_waitcnt lgkmcnt(6)
    v_or3_b32 v4, v44, v45, v4
    v_or3_b32 v4, v46, v47, v4
    v_or3_b32 v4, v48, v49, v4
    ds_add_rtn_u64 v[44:45], v16, v[76:77]
    ds_add_rtn_u64 v[46:47], v17, v[78:79]
    ds_add_rtn_u64 v[48:49], v18, v[80:81]
    s_waitcnt lgkmcnt(3)
    v_mad_u32_u16 v55, v55, s23, v2
    v_pk_lshrrev_b16 v55, 10, v55 op_sel_hi:[1,1]
    v_lshl_add_u32 v51, v51, 6, v55
    buffer_load_dwordx4 v[16:19], v51, s[44:47], s34 idxen
    s_cmp_le_u32 s51, 256
    s_cbranch_scc1 L_p2_kernel_noopt3_3
    v_bfe_i32 v108, v27, 2, 10
    v_bfe_i32 v109, v27, 12, 10
    v_ashrrev_i32 v110, 22, v27
    v_cvt_f32_i32 v108, v108
    v_cvt_f32_i32 v109, v109
    v_cvt_f32_i32 v110, v110
    v_mfma_f32_4x4x4_16b_bf16 v[112:115], v[58:59], v[64:65], 0
    v_mfma_f32_4x4x4_16b_bf16 v[116:119], v[58:59], v[66:67], 0
    v_mfma_f32_4x4x4_16b_bf16 v[120:123], v[58:59], v[68:69], 0
    v_mad_u32_u16 v24, v24, 8, s50 op_sel:[1,0,0,0]
    v_mad_u32_u16 v25, v25, 8, s50 op_sel:[1,0,0,0]
    v_mad_u32_u16 v26, v26, 8, s50 op_sel:[1,0,0,0]
    v_pk_fma_f32 v[114:115], v[114:115], v[108:109], s[20:21] op_sel:[0,0,0] op_sel_hi:[1,0,1]
    v_pk_fma_f32 v[112:113], v[112:113], v[108:109], s[16:17] op_sel:[0,0,0] op_sel_hi:[1,0,1]
    v_pk_fma_f32 v[118:119], v[118:119], v[108:109], s[20:21] op_sel:[0,1,0] op_sel_hi:[1,1,1]
    v_pk_fma_f32 v[116:117], v[116:117], v[108:109], s[16:17] op_sel:[0,1,0] op_sel_hi:[1,1,1]
    v_pk_fma_f32 v[122:123], v[122:123], v[110:111], s[20:21] op_sel:[0,0,0] op_sel_hi:[1,0,1]
    v_pk_fma_f32 v[120:121], v[120:121], v[110:111], s[16:17] op_sel:[0,0,0] op_sel_hi:[1,0,1]
    v_lshlrev_b64 v[114:115], 16, v[114:115]
    v_lshlrev_b64 v[118:119], 16, v[118:119]
    v_lshlrev_b64 v[122:123], 16, v[122:123]
    v_lshl_add_u64 v[64:65], v[112:113], 0, v[114:115]
    v_lshl_add_u64 v[66:67], v[116:117], 0, v[118:119]
    v_lshl_add_u64 v[68:69], v[120:121], 0, v[122:123]
    s_waitcnt lgkmcnt(0)
    v_or3_b32 v4, v44, v45, v4
    v_or3_b32 v4, v46, v47, v4
    v_or3_b32 v4, v48, v49, v4
    ds_add_rtn_u64 v[44:45], v24, v[64:65]
    ds_add_rtn_u64 v[46:47], v25, v[66:67]
    ds_add_rtn_u64 v[48:49], v26, v[68:69]
L_p2_kernel_noopt3_3:
    v_mbcnt_lo_u32_b32 v51, s36, 0
    v_mbcnt_hi_u32_b32 v51, s37, v51
    s_bcnt1_i32_b64 s14, s[36:37]
    v_lshl_add_u32 v55, v51, 1, s25
    ds_read_u16 v55, v55
    s_add_u32 s36, s26, 3145728
    s_lshl1_add_u32 s25, s14, s25
    s_lshl_b32 s14, s14, 10
    s_add_u32 s26, s26, s14
    s_cmp_le_u32 s28, 256
    s_cbranch_scc1 L_p2_kernel_noopt3_4
    v_readlane_b32 s38, v7, 8
    v_readlane_b32 s39, v7, 9
    s_nop 1
    v_mbcnt_lo_u32_b32 v62, s38, 0
    v_mbcnt_hi_u32_b32 v62, s39, v62
    s_bcnt1_i32_b64 s14, s[38:39]
    v_lshl_add_u32 v63, v62, 1, s25
    ds_read_u16 v63, v63
    s_add_u32 s38, s26, 4194304
    s_lshl1_add_u32 s25, s14, s25
    s_lshl_b32 s14, s14, 10
    s_add_u32 s26, s26, s14
L_p2_kernel_noopt3_4:
    v_bfe_i32 v108, v23, 2, 10
    v_bfe_i32 v109, v23, 12, 10
    v_ashrrev_i32 v110, 22, v23
    v_cvt_f32_i32 v108, v108
    v_cvt_f32_i32 v109, v109
    v_cvt_f32_i32 v110, v110
    v_mfma_f32_4x4x4_16b_bf16 v[112:115], v[58:59], v[82:83], 0
    v_mfma_f32_4x4x4_16b_bf16 v[116:119], v[58:59], v[84:85], 0
    v_mfma_f32_4x4x4_16b_bf16 v[120:123], v[58:59], v[86:87], 0
    v_mad_u32_u16 v20, v20, 8, s50 op_sel:[1,0,0,0]
    v_mad_u32_u16 v21, v21, 8, s50 op_sel:[1,0,0,0]
    v_mad_u32_u16 v22, v22, 8, s50 op_sel:[1,0,0,0]
    v_pk_fma_f32 v[114:115], v[114:115], v[108:109], s[20:21] op_sel:[0,0,0] op_sel_hi:[1,0,1]
    v_pk_fma_f32 v[112:113], v[112:113], v[108:109], s[16:17] op_sel:[0,0,0] op_sel_hi:[1,0,1]
    v_pk_fma_f32 v[118:119], v[118:119], v[108:109], s[20:21] op_sel:[0,1,0] op_sel_hi:[1,1,1]
    v_pk_fma_f32 v[116:117], v[116:117], v[108:109], s[16:17] op_sel:[0,1,0] op_sel_hi:[1,1,1]
    v_pk_fma_f32 v[122:123], v[122:123], v[110:111], s[20:21] op_sel:[0,0,0] op_sel_hi:[1,0,1]
    v_pk_fma_f32 v[120:121], v[120:121], v[110:111], s[16:17] op_sel:[0,0,0] op_sel_hi:[1,0,1]
    v_lshlrev_b64 v[114:115], 16, v[114:115]
    v_lshlrev_b64 v[118:119], 16, v[118:119]
    v_lshlrev_b64 v[122:123], 16, v[122:123]
    v_lshl_add_u64 v[82:83], v[112:113], 0, v[114:115]
    v_lshl_add_u64 v[84:85], v[116:117], 0, v[118:119]
    v_lshl_add_u64 v[86:87], v[120:121], 0, v[122:123]
    s_waitcnt lgkmcnt(1)
    v_or3_b32 v4, v44, v45, v4
    v_or3_b32 v4, v46, v47, v4
    v_or3_b32 v4, v48, v49, v4
    ds_add_rtn_u64 v[44:45], v20, v[82:83]
    ds_add_rtn_u64 v[46:47], v21, v[84:85]
    ds_add_rtn_u64 v[48:49], v22, v[86:87]
    s_waitcnt lgkmcnt(3)
    v_mad_u32_u16 v55, v55, s23, v2
    v_pk_lshrrev_b16 v55, 10, v55 op_sel_hi:[1,1]
    v_lshl_add_u32 v51, v51, 6, v55
    buffer_load_dwordx4 v[20:23], v51, s[44:47], s36 idxen
    s_cmp_le_u32 s28, 256
    s_cbranch_scc1 L_p2_kernel_noopt3_5
    v_mad_u32_u16 v63, v63, s23, v2
    v_pk_lshrrev_b16 v63, 10, v63 op_sel_hi:[1,1]
    v_lshl_add_u32 v62, v62, 6, v63
    buffer_load_dwordx4 v[24:27], v62, s[44:47], s38 idxen
L_p2_kernel_noopt3_5:
    s_add_u32 s14, s22, 80000
    buffer_load_dwordx4 v[88:91], v1, s[8:11], s14 offen
    v_pk_mov_b32 v[28:29], v[28:29], v[30:31] op_sel:[1,0]
    v_pk_mov_b32 v[30:31], v[30:31], v[32:33] op_sel:[1,0]
    v_pk_mov_b32 v[32:33], v[32:33], v[34:35] op_sel:[1,0]
    v_pk_mov_b32 v[34:35], v[34:35], v[4:5] op_sel:[1,1]
    v_pk_mov_b32 v[36:37], v[36:37], v[38:39] op_sel:[1,0]
    v_pk_mov_b32 v[38:39], v[38:39], v[40:41] op_sel:[1,0]
    v_pk_mov_b32 v[40:41], v[40:41], v[42:43] op_sel:[1,0]
    v_pk_mov_b32 v[42:43], v[42:43], v[4:5] op_sel:[1,1]
    v_mad_u32_u16 v108, v28, v50, s40 op_sel:[0,0,0,0]
    v_mad_u32_u16 v109, v36, v50, s41 op_sel:[0,0,0,0]
    v_sub_u32_sdwa v110, v109, v108 dst_sel:DWORD dst_unused:UNUSED_PAD src0_sel:WORD_1 src1_sel:WORD_1
    s_nop 1
    v_add_u32_dpp v110, v110, v110 row_shr:1 row_mask:0xf bank_mask:0xf bound_ctrl:0
    s_nop 1
    v_add_u32_dpp v110, v110, v110 row_shr:2 row_mask:0xf bank_mask:0xf bound_ctrl:0
    s_nop 1
    v_add_u32_dpp v110, v110, v110 row_shr:4 row_mask:0xf bank_mask:0xf bound_ctrl:0
    s_nop 1
    v_add_u32_dpp v110, v110, v110 row_shr:8 row_mask:0xf bank_mask:0xf bound_ctrl:0
    s_nop 1
    v_add_u32_dpp v110, v110, v110 row_bcast:15 row_mask:0xa bank_mask:0xf
    s_nop 1
    v_add_u32_dpp v110, v110, v110 row_bcast:31 row_mask:0xc bank_mask:0xf
    v_sub_u32_sdwa v109, v109, v110 dst_sel:DWORD dst_unused:UNUSED_PAD src0_sel:WORD_1 src1_sel:DWORD
    v_readlane_b32 s29, v110, 63
    v_add_u32 v110, -1, v110
    ds_write_b16 v126, v109
    v_lshlrev_b32_e64 v111, v110, 1
    v_lshrrev_b32 v110, 5, v110
    s_cmp_gt_u32 s29, 320
    s_cselect_b32 s2, 1, s2
    v_lshl_add_u32 v110, v110, 2, v127
    s_cselect_b64 exec, 0, -1
    ds_or_b32 v110, v111 offset:136
    s_mov_b64 exec, -1
    ds_wrxchg2_rtn_b32 v[108:109], v6, v5, v5 offset0:34 offset1:44
    s_add_u32 s14, s22, 96384
    buffer_load_dwordx4 v[92:95], v1, s[8:11], s14 offen
    s_barrier
    s_add_u32 s22, s22, 80000
    s_cmp_lg_u32 s24, 7
    s_cbranch_scc1 L_p2_nodist
    s_mov_b32 s46, 0
    s_lshl2_add_u32 s14, s3, s12
    s_mul_i32 s14, s14, 5000
    s_add_u32 s15, s14, 4096
    v_min_u32 v61, 225, v0
    v_lshl_add_u32 v60, v0, 2, s14
    v_lshl_add_u32 v61, v61, 2, s15
    global_load_dword v60, v60, s[100:101] nt
    global_load_dword v61, v61, s[100:101] nt
L_p2_nodist:
    v_mad_u32_u16 v64, v8, 8, s18
    v_mad_u32_u16 v66, v9, 8, s18
    v_mad_u32_u16 v68, v10, 8, s18
    ds_read_b64 v[64:65], v64
    ds_read_b64 v[66:67], v66
    ds_read_b64 v[68:69], v68
    s_add_u32 s14, s22, 32768
    buffer_load_dwordx4 v[96:99], v1, s[8:11], s14 offen
    s_waitcnt vmcnt(5)
    v_mad_u32_u16 v70, v12, 8, s18
    v_mad_u32_u16 v72, v13, 8, s18
    v_mad_u32_u16 v74, v14, 8, s18
    ds_read_b64 v[70:71], v70
    ds_read_b64 v[72:73], v72
    ds_read_b64 v[74:75], v74
    s_add_u32 s14, s22, 49152
    buffer_load_dwordx4 v[100:103], v1, s[8:11], s14 offen
    s_waitcnt lgkmcnt(6)
    v_or_b32 v7, v108, v109
    s_nop 0
    v_readlane_b32 s30, v7, 0
    v_readlane_b32 s31, v7, 1
    v_readlane_b32 s32, v7, 2
    v_readlane_b32 s33, v7, 3
    v_readlane_b32 s34, v7, 4
    v_readlane_b32 s35, v7, 5
    v_readlane_b32 s36, v7, 6
    v_readlane_b32 s37, v7, 7
    s_mov_b32 s25, s19
    s_mov_b32 s26, s27
    s_mov_b32 s51, s28
    s_mov_b32 s28, s29
    v_mbcnt_lo_u32_b32 v51, s30, 0
    v_mbcnt_hi_u32_b32 v51, s31, v51
    s_bcnt1_i32_b64 s14, s[30:31]
    v_lshl_add_u32 v55, v51, 1, s25
    ds_read_u16 v55, v55
    s_add_u32 s30, s26, 0
    s_lshl1_add_u32 s25, s14, s25
    s_lshl_b32 s14, s14, 10
    s_add_u32 s26, s26, s14
    v_bfe_i32 v108, v11, 2, 10
    v_bfe_i32 v109, v11, 12, 10
    v_ashrrev_i32 v110, 22, v11
    v_cvt_f32_i32 v108, v108
    v_cvt_f32_i32 v109, v109
    v_cvt_f32_i32 v110, v110
    s_waitcnt lgkmcnt(4)
    v_mfma_f32_4x4x4_16b_bf16 v[112:115], v[58:59], v[64:65], 0
    v_mfma_f32_4x4x4_16b_bf16 v[116:119], v[58:59], v[66:67], 0
    v_mfma_f32_4x4x4_16b_bf16 v[120:123], v[58:59], v[68:69], 0
    v_mad_u32_u16 v8, v8, 8, s50 op_sel:[1,0,0,0]
    v_mad_u32_u16 v9, v9, 8, s50 op_sel:[1,0,0,0]
    v_mad_u32_u16 v10, v10, 8, s50 op_sel:[1,0,0,0]
    v_pk_fma_f32 v[114:115], v[114:115], v[108:109], s[20:21] op_sel:[0,0,0] op_sel_hi:[1,0,1]
    v_pk_fma_f32 v[112:113], v[112:113], v[108:109], s[16:17] op_sel:[0,0,0] op_sel_hi:[1,0,1]
    v_pk_fma_f32 v[118:119], v[118:119], v[108:109], s[20:21] op_sel:[0,1,0] op_sel_hi:[1,1,1]
    v_pk_fma_f32 v[116:117], v[116:117], v[108:109], s[16:17] op_sel:[0,1,0] op_sel_hi:[1,1,1]
    v_pk_fma_f32 v[122:123], v[122:123], v[110:111], s[20:21] op_sel:[0,0,0] op_sel_hi:[1,0,1]
    v_pk_fma_f32 v[120:121], v[120:121], v[110:111], s[16:17] op_sel:[0,0,0] op_sel_hi:[1,0,1]
    v_lshlrev_b64 v[114:115], 16, v[114:115]
    v_lshlrev_b64 v[118:119], 16, v[118:119]
    v_lshlrev_b64 v[122:123], 16, v[122:123]
    v_lshl_add_u64 v[64:65], v[112:113], 0, v[114:115]
    v_lshl_add_u64 v[66:67], v[116:117], 0, v[118:119]
    v_lshl_add_u64 v[68:69], v[120:121], 0, v[122:123]
    v_or3_b32 v4, v44, v45, v4
    v_or3_b32 v4, v46, v47, v4
    v_or3_b32 v4, v48, v49, v4
    ds_add_rtn_u64 v[44:45], v8, v[64:65]
    ds_add_rtn_u64 v[46:47], v9, v[66:67]
    ds_add_rtn_u64 v[48:49], v10, v[68:69]
    s_waitcnt lgkmcnt(3)
    v_mad_u32_u16 v55, v55, s23, v2
    v_pk_lshrrev_b16 v55, 10, v55 op_sel_hi:[1,1]
    v_lshl_add_u32 v51, v51, 6, v55
    buffer_load_dwordx4 v[8:11], v51, s[44:47], s30 idxen
    s_add_u32 s14, s22, 65536
    buffer_load_dwordx4 v[104:107], v1, s[8:11], s14 offen
    s_waitcnt vmcnt(7)
    v_mad_u32_u16 v76, v16, 8, s18
    v_mad_u32_u16 v78, v17, 8, s18
    v_mad_u32_u16 v80, v18, 8, s18
    ds_read_b64 v[76:77], v76
    ds_read_b64 v[78:79], v78
    ds_read_b64 v[80:81], v80
    s_waitcnt vmcnt(6)
    v_mad_u32_u16 v82, v20, 8, s18
    v_mad_u32_u16 v84, v21, 8, s18
    v_mad_u32_u16 v86, v22, 8, s18
    ds_read_b64 v[82:83], v82
    ds_read_b64 v[84:85], v84
    ds_read_b64 v[86:87], v86
    s_cmp_le_u32 s51, 256
    s_cbranch_scc1 L_p2_kernel_noopt3_6
    v_mad_u32_u16 v64, v24, 8, s18
    v_mad_u32_u16 v66, v25, 8, s18
    v_mad_u32_u16 v68, v26, 8, s18
    ds_read_b64 v[64:65], v64
    ds_read_b64 v[66:67], v66
    ds_read_b64 v[68:69], v68
L_p2_kernel_noopt3_6:
    v_mbcnt_lo_u32_b32 v51, s32, 0
    v_mbcnt_hi_u32_b32 v51, s33, v51
    s_bcnt1_i32_b64 s14, s[32:33]
    v_lshl_add_u32 v55, v51, 1, s25
    ds_read_u16 v55, v55
    s_add_u32 s32, s26, 1048576
    s_lshl1_add_u32 s25, s14, s25
    s_lshl_b32 s14, s14, 10
    s_add_u32 s26, s26, s14
    v_bfe_i32 v108, v15, 2, 10
    v_bfe_i32 v109, v15, 12, 10
    v_ashrrev_i32 v110, 22, v15
    v_cvt_f32_i32 v108, v108
    v_cvt_f32_i32 v109, v109
    v_cvt_f32_i32 v110, v110
    v_mfma_f32_4x4x4_16b_bf16 v[112:115], v[58:59], v[70:71], 0
    v_mfma_f32_4x4x4_16b_bf16 v[116:119], v[58:59], v[72:73], 0
    v_mfma_f32_4x4x4_16b_bf16 v[120:123], v[58:59], v[74:75], 0
    v_mad_u32_u16 v12, v12, 8, s50 op_sel:[1,0,0,0]
    v_mad_u32_u16 v13, v13, 8, s50 op_sel:[1,0,0,0]
    v_mad_u32_u16 v14, v14, 8, s50 op_sel:[1,0,0,0]
    v_pk_fma_f32 v[114:115], v[114:115], v[108:109], s[20:21] op_sel:[0,0,0] op_sel_hi:[1,0,1]
    v_pk_fma_f32 v[112:113], v[112:113], v[108:109], s[16:17] op_sel:[0,0,0] op_sel_hi:[1,0,1]
    v_pk_fma_f32 v[118:119], v[118:119], v[108:109], s[20:21] op_sel:[0,1,0] op_sel_hi:[1,1,1]
    v_pk_fma_f32 v[116:117], v[116:117], v[108:109], s[16:17] op_sel:[0,1,0] op_sel_hi:[1,1,1]
    v_pk_fma_f32 v[122:123], v[122:123], v[110:111], s[20:21] op_sel:[0,0,0] op_sel_hi:[1,0,1]
    v_pk_fma_f32 v[120:121], v[120:121], v[110:111], s[16:17] op_sel:[0,0,0] op_sel_hi:[1,0,1]
    v_lshlrev_b64 v[114:115], 16, v[114:115]
    v_lshlrev_b64 v[118:119], 16, v[118:119]
    v_lshlrev_b64 v[122:123], 16, v[122:123]
    v_lshl_add_u64 v[70:71], v[112:113], 0, v[114:115]
    v_lshl_add_u64 v[72:73], v[116:117], 0, v[118:119]
    v_lshl_add_u64 v[74:75], v[120:121], 0, v[122:123]
    s_waitcnt lgkmcnt(7)
    v_or3_b32 v4, v44, v45, v4
    v_or3_b32 v4, v46, v47, v4
    v_or3_b32 v4, v48, v49, v4
    ds_add_rtn_u64 v[44:45], v12, v[70:71]
    ds_add_rtn_u64 v[46:47], v13, v[72:73]
    ds_add_rtn_u64 v[48:49], v14, v[74:75]
    s_waitcnt lgkmcnt(3)
    v_mad_u32_u16 v55, v55, s23, v2
    v_pk_lshrrev_b16 v55, 10, v55 op_sel_hi:[1,1]
    v_lshl_add_u32 v51, v51, 6, v55
    buffer_load_dwordx4 v[12:15], v51, s[44:47], s32 idxen
    s_barrier
    s_waitcnt vmcnt(1)
    ds_write_b128 v3, v[88:91] offset:0
    ds_write_b128 v3, v[92:95] offset:16384
    ds_write_b128 v3, v[96:99] offset:32768
    ds_write_b128 v3, v[100:103] offset:49152
    ds_write_b128 v124, v[104:107] offset:0
    v_mbcnt_lo_u32_b32 v51, s34, 0
    v_mbcnt_hi_u32_b32 v51, s35, v51
    s_bcnt1_i32_b64 s14, s[34:35]
    v_lshl_add_u32 v55, v51, 1, s25
    ds_read_u16 v55, v55
    s_add_u32 s34, s26, 2097152
    s_lshl1_add_u32 s25, s14, s25
    s_lshl_b32 s14, s14, 10
    s_add_u32 s26, s26, s14
    v_bfe_i32 v108, v19, 2, 10
    v_bfe_i32 v109, v19, 12, 10
    v_ashrrev_i32 v110, 22, v19
    v_cvt_f32_i32 v108, v108
    v_cvt_f32_i32 v109, v109
    v_cvt_f32_i32 v110, v110
    v_mfma_f32_4x4x4_16b_bf16 v[112:115], v[58:59], v[76:77], 0
    v_mfma_f32_4x4x4_16b_bf16 v[116:119], v[58:59], v[78:79], 0
    v_mfma_f32_4x4x4_16b_bf16 v[120:123], v[58:59], v[80:81], 0
    v_mad_u32_u16 v16, v16, 8, s50 op_sel:[1,0,0,0]
    v_mad_u32_u16 v17, v17, 8, s50 op_sel:[1,0,0,0]
    v_mad_u32_u16 v18, v18, 8, s50 op_sel:[1,0,0,0]
    v_pk_fma_f32 v[114:115], v[114:115], v[108:109], s[20:21] op_sel:[0,0,0] op_sel_hi:[1,0,1]
    v_pk_fma_f32 v[112:113], v[112:113], v[108:109], s[16:17] op_sel:[0,0,0] op_sel_hi:[1,0,1]
    v_pk_fma_f32 v[118:119], v[118:119], v[108:109], s[20:21] op_sel:[0,1,0] op_sel_hi:[1,1,1]
    v_pk_fma_f32 v[116:117], v[116:117], v[108:109], s[16:17] op_sel:[0,1,0] op_sel_hi:[1,1,1]
    v_pk_fma_f32 v[122:123], v[122:123], v[110:111], s[20:21] op_sel:[0,0,0] op_sel_hi:[1,0,1]
    v_pk_fma_f32 v[120:121], v[120:121], v[110:111], s[16:17] op_sel:[0,0,0] op_sel_hi:[1,0,1]
    v_lshlrev_b64 v[114:115], 16, v[114:115]
    v_lshlrev_b64 v[118:119], 16, v[118:119]
    v_lshlrev_b64 v[122:123], 16, v[122:123]
    v_lshl_add_u64 v[76:77], v[112:113], 0, v[114:115]
    v_lshl_add_u64 v[78:79], v[116:117], 0, v[118:119]
    v_lshl_add_u64 v[80:81], v[120:121], 0, v[122:123]
    s_waitcnt lgkmcnt(6)
    v_or3_b32 v4, v44, v45, v4
    v_or3_b32 v4, v46, v47, v4
    v_or3_b32 v4, v48, v49, v4
    ds_add_rtn_u64 v[44:45], v16, v[76:77]
    ds_add_rtn_u64 v[46:47], v17, v[78:79]
    ds_add_rtn_u64 v[48:49], v18, v[80:81]
    s_waitcnt lgkmcnt(3)
    v_mad_u32_u16 v55, v55, s23, v2
    v_pk_lshrrev_b16 v55, 10, v55 op_sel_hi:[1,1]
    v_lshl_add_u32 v51, v51, 6, v55
    buffer_load_dwordx4 v[16:19], v51, s[44:47], s34 idxen
    s_cmp_le_u32 s51, 256
    s_cbranch_scc1 L_p2_kernel_noopt3_7
    v_bfe_i32 v108, v27, 2, 10
    v_bfe_i32 v109, v27, 12, 10
    v_ashrrev_i32 v110, 22, v27
    v_cvt_f32_i32 v108, v108
    v_cvt_f32_i32 v109, v109
    v_cvt_f32_i32 v110, v110
    v_mfma_f32_4x4x4_16b_bf16 v[112:115], v[58:59], v[64:65], 0
    v_mfma_f32_4x4x4_16b_bf16 v[116:119], v[58:59], v[66:67], 0
    v_mfma_f32_4x4x4_16b_bf16 v[120:123], v[58:59], v[68:69], 0
    v_mad_u32_u16 v24, v24, 8, s50 op_sel:[1,0,0,0]
    v_mad_u32_u16 v25, v25, 8, s50 op_sel:[1,0,0,0]
    v_mad_u32_u16 v26, v26, 8, s50 op_sel:[1,0,0,0]
    v_pk_fma_f32 v[114:115], v[114:115], v[108:109], s[20:21] op_sel:[0,0,0] op_sel_hi:[1,0,1]
    v_pk_fma_f32 v[112:113], v[112:113], v[108:109], s[16:17] op_sel:[0,0,0] op_sel_hi:[1,0,1]
    v_pk_fma_f32 v[118:119], v[118:119], v[108:109], s[20:21] op_sel:[0,1,0] op_sel_hi:[1,1,1]
    v_pk_fma_f32 v[116:117], v[116:117], v[108:109], s[16:17] op_sel:[0,1,0] op_sel_hi:[1,1,1]
    v_pk_fma_f32 v[122:123], v[122:123], v[110:111], s[20:21] op_sel:[0,0,0] op_sel_hi:[1,0,1]
    v_pk_fma_f32 v[120:121], v[120:121], v[110:111], s[16:17] op_sel:[0,0,0] op_sel_hi:[1,0,1]
    v_lshlrev_b64 v[114:115], 16, v[114:115]
    v_lshlrev_b64 v[118:119], 16, v[118:119]
    v_lshlrev_b64 v[122:123], 16, v[122:123]
    v_lshl_add_u64 v[64:65], v[112:113], 0, v[114:115]
    v_lshl_add_u64 v[66:67], v[116:117], 0, v[118:119]
    v_lshl_add_u64 v[68:69], v[120:121], 0, v[122:123]
    s_waitcnt lgkmcnt(0)
    v_or3_b32 v4, v44, v45, v4
    v_or3_b32 v4, v46, v47, v4
    v_or3_b32 v4, v48, v49, v4
    ds_add_rtn_u64 v[44:45], v24, v[64:65]
    ds_add_rtn_u64 v[46:47], v25, v[66:67]
    ds_add_rtn_u64 v[48:49], v26, v[68:69]
L_p2_kernel_noopt3_7:
    v_mbcnt_lo_u32_b32 v51, s36, 0
    v_mbcnt_hi_u32_b32 v51, s37, v51
    s_bcnt1_i32_b64 s14, s[36:37]
    v_lshl_add_u32 v55, v51, 1, s25
    ds_read_u16 v55, v55
    s_add_u32 s36, s26, 3145728
    s_lshl1_add_u32 s25, s14, s25
    s_lshl_b32 s14, s14, 10
    s_add_u32 s26, s26, s14
    s_cmp_le_u32 s28, 256
    s_cbranch_scc1 L_p2_kernel_noopt3_8
    v_readlane_b32 s38, v7, 8
    v_readlane_b32 s39, v7, 9
    s_nop 1
    v_mbcnt_lo_u32_b32 v62, s38, 0
    v_mbcnt_hi_u32_b32 v62, s39, v62
    s_bcnt1_i32_b64 s14, s[38:39]
    v_lshl_add_u32 v63, v62, 1, s25
    ds_read_u16 v63, v63
    s_add_u32 s38, s26, 4194304
    s_lshl1_add_u32 s25, s14, s25
    s_lshl_b32 s14, s14, 10
    s_add_u32 s26, s26, s14
L_p2_kernel_noopt3_8:
    v_bfe_i32 v108, v23, 2, 10
    v_bfe_i32 v109, v23, 12, 10
    v_ashrrev_i32 v110, 22, v23
    v_cvt_f32_i32 v108, v108
    v_cvt_f32_i32 v109, v109
    v_cvt_f32_i32 v110, v110
    v_mfma_f32_4x4x4_16b_bf16 v[112:115], v[58:59], v[82:83], 0
    v_mfma_f32_4x4x4_16b_bf16 v[116:119], v[58:59], v[84:85], 0
    v_mfma_f32_4x4x4_16b_bf16 v[120:123], v[58:59], v[86:87], 0
    v_mad_u32_u16 v20, v20, 8, s50 op_sel:[1,0,0,0]
    v_mad_u32_u16 v21, v21, 8, s50 op_sel:[1,0,0,0]
    v_mad_u32_u16 v22, v22, 8, s50 op_sel:[1,0,0,0]
    v_pk_fma_f32 v[114:115], v[114:115], v[108:109], s[20:21] op_sel:[0,0,0] op_sel_hi:[1,0,1]
    v_pk_fma_f32 v[112:113], v[112:113], v[108:109], s[16:17] op_sel:[0,0,0] op_sel_hi:[1,0,1]
    v_pk_fma_f32 v[118:119], v[118:119], v[108:109], s[20:21] op_sel:[0,1,0] op_sel_hi:[1,1,1]
    v_pk_fma_f32 v[116:117], v[116:117], v[108:109], s[16:17] op_sel:[0,1,0] op_sel_hi:[1,1,1]
    v_pk_fma_f32 v[122:123], v[122:123], v[110:111], s[20:21] op_sel:[0,0,0] op_sel_hi:[1,0,1]
    v_pk_fma_f32 v[120:121], v[120:121], v[110:111], s[16:17] op_sel:[0,0,0] op_sel_hi:[1,0,1]
    v_lshlrev_b64 v[114:115], 16, v[114:115]
    v_lshlrev_b64 v[118:119], 16, v[118:119]
    v_lshlrev_b64 v[122:123], 16, v[122:123]
    v_lshl_add_u64 v[82:83], v[112:113], 0, v[114:115]
    v_lshl_add_u64 v[84:85], v[116:117], 0, v[118:119]
    v_lshl_add_u64 v[86:87], v[120:121], 0, v[122:123]
    s_waitcnt lgkmcnt(1)
    v_or3_b32 v4, v44, v45, v4
    v_or3_b32 v4, v46, v47, v4
    v_or3_b32 v4, v48, v49, v4
    ds_add_rtn_u64 v[44:45], v20, v[82:83]
    ds_add_rtn_u64 v[46:47], v21, v[84:85]
    ds_add_rtn_u64 v[48:49], v22, v[86:87]
    s_waitcnt lgkmcnt(3)
    v_mad_u32_u16 v55, v55, s23, v2
    v_pk_lshrrev_b16 v55, 10, v55 op_sel_hi:[1,1]
    v_lshl_add_u32 v51, v51, 6, v55
    buffer_load_dwordx4 v[20:23], v51, s[44:47], s36 idxen
    s_cmp_le_u32 s28, 256
    s_cbranch_scc1 L_p2_kernel_noopt3_9
    v_mad_u32_u16 v63, v63, s23, v2
    v_pk_lshrrev_b16 v63, 10, v63 op_sel_hi:[1,1]
    v_lshl_add_u32 v62, v62, 6, v63
    buffer_load_dwordx4 v[24:27], v62, s[44:47], s38 idxen
L_p2_kernel_noopt3_9:
    s_add_u32 s14, s22, 80000
    buffer_load_dwordx4 v[88:91], v1, s[8:11], s14 offen
    v_mad_u32_u16 v108, v28, v50, s40 op_sel:[1,0,0,0]
    v_mad_u32_u16 v109, v36, v50, s41 op_sel:[1,0,0,0]
    v_sub_u32_sdwa v110, v109, v108 dst_sel:DWORD dst_unused:UNUSED_PAD src0_sel:WORD_1 src1_sel:WORD_1
    s_nop 1
    v_add_u32_dpp v110, v110, v110 row_shr:1 row_mask:0xf bank_mask:0xf bound_ctrl:0
    s_nop 1
    v_add_u32_dpp v110, v110, v110 row_shr:2 row_mask:0xf bank_mask:0xf bound_ctrl:0
    s_nop 1
    v_add_u32_dpp v110, v110, v110 row_shr:4 row_mask:0xf bank_mask:0xf bound_ctrl:0
    s_nop 1
    v_add_u32_dpp v110, v110, v110 row_shr:8 row_mask:0xf bank_mask:0xf bound_ctrl:0
    s_nop 1
    v_add_u32_dpp v110, v110, v110 row_bcast:15 row_mask:0xa bank_mask:0xf
    s_nop 1
    v_add_u32_dpp v110, v110, v110 row_bcast:31 row_mask:0xc bank_mask:0xf
    v_sub_u32_sdwa v109, v109, v110 dst_sel:DWORD dst_unused:UNUSED_PAD src0_sel:WORD_1 src1_sel:DWORD
    v_readlane_b32 s29, v110, 63
    v_add_u32 v110, -1, v110
    ds_write_b16 v126, v109
    v_lshlrev_b32_e64 v111, v110, 1
    v_lshrrev_b32 v110, 5, v110
    s_cmp_gt_u32 s29, 320
    s_cselect_b32 s2, 1, s2
    v_lshl_add_u32 v110, v110, 2, v127
    s_cselect_b64 exec, 0, -1
    ds_or_b32 v110, v111 offset:136
    s_mov_b64 exec, -1
    ds_wrxchg2_rtn_b32 v[108:109], v6, v5, v5 offset0:34 offset1:44
    s_add_u32 s14, s22, 96384
    buffer_load_dwordx4 v[92:95], v1, s[8:11], s14 offen
    s_add_u32 s24, s24, 1
    s_cmp_lt_u32 s24, 8
    s_barrier
    s_cbranch_scc1 L_p2_loop
    s_waitcnt lgkmcnt(3)
    v_or3_b32 v4, v44, v45, v4
    v_or3_b32 v4, v46, v47, v4
    v_or3_b32 v4, v48, v49, v4
    s_mov_b32 s27, s19
    s_waitcnt vmcnt(0)
    v_mov_b32 v8, 160232
    s_cmp_lg_u32 s13, 0
    s_cselect_b64 exec, 0, 1
    ds_write_b32 v8, v52
    s_mov_b64 exec, -1
    v_subrev_u32 v6, 80000, v124
    s_mul_i32 s24, s12, 20000
    v_subrev_u32 v10, s24, v1
    v_mov_b32 v11, 0x7f000000
    s_waitcnt vmcnt(0) lgkmcnt(0)
    s_barrier
    s_cmp_lt_u32 s13, 12
    s_cbranch_scc1 L_p2_ga
L_p2_ga:
    ds_read_b32 v9, v8
    ds_read_b128 v[88:91], v1 offset:0
    ds_read_b128 v[92:95], v1 offset:16384
    ds_read_b128 v[96:99], v1 offset:32768
    ds_read_b128 v[100:103], v1 offset:49152
    ds_read_b128 v[104:107], v6
    s_mul_i32 s14, s12, 5120000
    s_mul_i32 s15, s3, 80000
    s_add_u32 s25, s14, s15
    s_add_u32 s25, s25, 228589568
    s_waitcnt lgkmcnt(5)
    v_readfirstlane_b32 s21, v9
    s_nop 0
    s_bfe_u32 s21, s21, 524296
    s_cmp_lg_u32 s21, 4
    s_cselect_b32 s21, 1, 0
    s_cselect_b32 s24, 0, 20000
    v_cmp_le_u32 vcc, s24, v10
    v_add_u32 v10, 16384, v10
    s_add_u32 s14, s25, 0
    v_cndmask_b32 v12, v11, v1, vcc
    s_waitcnt lgkmcnt(4)
    buffer_store_dwordx4 v[88:91], v12, s[4:7], s14 offen sc1
    v_or3_b32 v4, v88, v89, v4
    v_or3_b32 v4, v90, v91, v4
    v_cmp_le_u32 vcc, s24, v10
    v_add_u32 v10, 16384, v10
    s_add_u32 s14, s25, 16384
    v_cndmask_b32 v12, v11, v1, vcc
    s_waitcnt lgkmcnt(3)
    buffer_store_dwordx4 v[92:95], v12, s[4:7], s14 offen sc1
    v_or3_b32 v4, v92, v93, v4
    v_or3_b32 v4, v94, v95, v4
    v_cmp_le_u32 vcc, s24, v10
    v_add_u32 v10, 16384, v10
    s_add_u32 s14, s25, 32768
    v_cndmask_b32 v12, v11, v1, vcc
    s_waitcnt lgkmcnt(2)
    buffer_store_dwordx4 v[96:99], v12, s[4:7], s14 offen sc1
    v_or3_b32 v4, v96, v97, v4
    v_or3_b32 v4, v98, v99, v4
    v_cmp_le_u32 vcc, s24, v10
    v_add_u32 v10, 16384, v10
    s_add_u32 s14, s25, 49152
    v_cndmask_b32 v12, v11, v1, vcc
    s_waitcnt lgkmcnt(1)
    buffer_store_dwordx4 v[100:103], v12, s[4:7], s14 offen sc1
    v_or3_b32 v4, v100, v101, v4
    v_or3_b32 v4, v102, v103, v4
    v_cmp_le_u32 vcc, s24, v10
    v_add_u32 v10, 16384, v10
    s_add_u32 s14, s25, 0
    v_cndmask_b32 v12, v11, v6, vcc
    s_waitcnt lgkmcnt(0)
    buffer_store_dwordx4 v[104:107], v12, s[4:7], s14 offen sc1
    v_or3_b32 v4, v104, v105, v4
    v_or3_b32 v4, v106, v107, v4
    s_load_dwordx2 s[16:17], s[0:1], 88
    s_cmp_ge_u32 s13, 12
    s_cbranch_scc1 L_p2_gb
    v_lshlrev_b32 v30, 16, v60
    v_and_b32 v31, 0xffff0000, v60
    v_lshlrev_b32 v36, 16, v53
    v_and_b32 v37, 0xffff0000, v53
    v_lshlrev_b32 v38, 16, v54
    v_and_b32 v39, 0xffff0000, v54
    v_lshlrev_b32 v40, 16, v56
    v_and_b32 v41, 0xffff0000, v56
    v_lshlrev_b32 v42, 16, v57
    v_and_b32 v43, 0xffff0000, v57
    v_pk_add_f32 v[14:15], v[30:31], v[36:37] op_sel:[0,0] op_sel_hi:[1,0] neg_lo:[0,1] neg_hi:[0,1]
    v_pk_add_f32 v[16:17], v[30:31], v[36:37] op_sel:[0,1] op_sel_hi:[1,1] neg_lo:[0,1] neg_hi:[0,1]
    v_pk_add_f32 v[18:19], v[30:31], v[38:39] op_sel:[0,0] op_sel_hi:[1,0] neg_lo:[0,1] neg_hi:[0,1]
    v_pk_add_f32 v[20:21], v[30:31], v[38:39] op_sel:[0,1] op_sel_hi:[1,1] neg_lo:[0,1] neg_hi:[0,1]
    v_pk_add_f32 v[22:23], v[30:31], v[40:41] op_sel:[0,0] op_sel_hi:[1,0] neg_lo:[0,1] neg_hi:[0,1]
    v_pk_add_f32 v[24:25], v[30:31], v[40:41] op_sel:[0,1] op_sel_hi:[1,1] neg_lo:[0,1] neg_hi:[0,1]
    v_pk_add_f32 v[26:27], v[30:31], v[42:43] op_sel:[0,0] op_sel_hi:[1,0] neg_lo:[0,1] neg_hi:[0,1]
    v_pk_add_f32 v[28:29], v[30:31], v[42:43] op_sel:[0,1] op_sel_hi:[1,1] neg_lo:[0,1] neg_hi:[0,1]
    v_cvt_pk_bf16_f32 v32, v14, v15
    v_lshlrev_b32 v14, 16, v32
    v_and_b32 v15, 0xffff0000, v32
    v_cvt_pk_bf16_f32 v32, v16, v17
    v_lshlrev_b32 v16, 16, v32
    v_and_b32 v17, 0xffff0000, v32
    v_cvt_pk_bf16_f32 v32, v18, v19
    v_lshlrev_b32 v18, 16, v32
    v_and_b32 v19, 0xffff0000, v32
    v_cvt_pk_bf16_f32 v32, v20, v21
    v_lshlrev_b32 v20, 16, v32
    v_and_b32 v21, 0xffff0000, v32
    v_cvt_pk_bf16_f32 v32, v22, v23
    v_lshlrev_b32 v22, 16, v32
    v_and_b32 v23, 0xffff0000, v32
    v_cvt_pk_bf16_f32 v32, v24, v25
    v_lshlrev_b32 v24, 16, v32
    v_and_b32 v25, 0xffff0000, v32
    v_cvt_pk_bf16_f32 v32, v26, v27
    v_lshlrev_b32 v26, 16, v32
    v_and_b32 v27, 0xffff0000, v32
    v_cvt_pk_bf16_f32 v32, v28, v29
    v_lshlrev_b32 v28, 16, v32
    v_and_b32 v29, 0xffff0000, v32
    v_pk_mul_f32 v[14:15], v[14:15], v[14:15]
    v_pk_mul_f32 v[16:17], v[16:17], v[16:17]
    v_pk_mul_f32 v[18:19], v[18:19], v[18:19]
    v_pk_mul_f32 v[20:21], v[20:21], v[20:21]
    v_pk_mul_f32 v[22:23], v[22:23], v[22:23]
    v_pk_mul_f32 v[24:25], v[24:25], v[24:25]
    v_pk_mul_f32 v[26:27], v[26:27], v[26:27]
    v_pk_mul_f32 v[28:29], v[28:29], v[28:29]
    v_cvt_pk_bf16_f32 v32, v14, v15
    v_lshlrev_b32 v14, 16, v32
    v_and_b32 v15, 0xffff0000, v32
    v_cvt_pk_bf16_f32 v32, v16, v17
    v_lshlrev_b32 v16, 16, v32
    v_and_b32 v17, 0xffff0000, v32
    v_cvt_pk_bf16_f32 v32, v18, v19
    v_lshlrev_b32 v18, 16, v32
    v_and_b32 v19, 0xffff0000, v32
    v_cvt_pk_bf16_f32 v32, v20, v21
    v_lshlrev_b32 v20, 16, v32
    v_and_b32 v21, 0xffff0000, v32
    v_cvt_pk_bf16_f32 v32, v22, v23
    v_lshlrev_b32 v22, 16, v32
    v_and_b32 v23, 0xffff0000, v32
    v_cvt_pk_bf16_f32 v32, v24, v25
    v_lshlrev_b32 v24, 16, v32
    v_and_b32 v25, 0xffff0000, v32
    v_cvt_pk_bf16_f32 v32, v26, v27
    v_lshlrev_b32 v26, 16, v32
    v_and_b32 v27, 0xffff0000, v32
    v_cvt_pk_bf16_f32 v32, v28, v29
    v_lshlrev_b32 v28, 16, v32
    v_and_b32 v29, 0xffff0000, v32
    v_mov_b32 v30, 1092616192
    v_mov_b32 v31, 0x3fb8aa3b
    v_pk_mul_f32 v[14:15], v[14:15], v[30:31] op_sel:[0,0] op_sel_hi:[1,0]
    v_pk_mul_f32 v[16:17], v[16:17], v[30:31] op_sel:[0,0] op_sel_hi:[1,0]
    v_pk_mul_f32 v[18:19], v[18:19], v[30:31] op_sel:[0,0] op_sel_hi:[1,0]
    v_pk_mul_f32 v[20:21], v[20:21], v[30:31] op_sel:[0,0] op_sel_hi:[1,0]
    v_pk_mul_f32 v[22:23], v[22:23], v[30:31] op_sel:[0,0] op_sel_hi:[1,0]
    v_pk_mul_f32 v[24:25], v[24:25], v[30:31] op_sel:[0,0] op_sel_hi:[1,0]
    v_pk_mul_f32 v[26:27], v[26:27], v[30:31] op_sel:[0,0] op_sel_hi:[1,0]
    v_pk_mul_f32 v[28:29], v[28:29], v[30:31] op_sel:[0,0] op_sel_hi:[1,0]
    v_cvt_pk_bf16_f32 v32, v14, v15
    v_lshlrev_b32 v14, 16, v32
    v_and_b32 v15, 0xffff0000, v32
    v_cvt_pk_bf16_f32 v32, v16, v17
    v_lshlrev_b32 v16, 16, v32
    v_and_b32 v17, 0xffff0000, v32
    v_cvt_pk_bf16_f32 v32, v18, v19
    v_lshlrev_b32 v18, 16, v32
    v_and_b32 v19, 0xffff0000, v32
    v_cvt_pk_bf16_f32 v32, v20, v21
    v_lshlrev_b32 v20, 16, v32
    v_and_b32 v21, 0xffff0000, v32
    v_cvt_pk_bf16_f32 v32, v22, v23
    v_lshlrev_b32 v22, 16, v32
    v_and_b32 v23, 0xffff0000, v32
    v_cvt_pk_bf16_f32 v32, v24, v25
    v_lshlrev_b32 v24, 16, v32
    v_and_b32 v25, 0xffff0000, v32
    v_cvt_pk_bf16_f32 v32, v26, v27
    v_lshlrev_b32 v26, 16, v32
    v_and_b32 v27, 0xffff0000, v32
    v_cvt_pk_bf16_f32 v32, v28, v29
    v_lshlrev_b32 v28, 16, v32
    v_and_b32 v29, 0xffff0000, v32
    v_pk_mul_f32 v[14:15], v[14:15], v[30:31] op_sel:[0,1] op_sel_hi:[1,1]
    v_pk_mul_f32 v[16:17], v[16:17], v[30:31] op_sel:[0,1] op_sel_hi:[1,1]
    v_pk_mul_f32 v[18:19], v[18:19], v[30:31] op_sel:[0,1] op_sel_hi:[1,1]
    v_pk_mul_f32 v[20:21], v[20:21], v[30:31] op_sel:[0,1] op_sel_hi:[1,1]
    v_pk_mul_f32 v[22:23], v[22:23], v[30:31] op_sel:[0,1] op_sel_hi:[1,1]
    v_pk_mul_f32 v[24:25], v[24:25], v[30:31] op_sel:[0,1] op_sel_hi:[1,1]
    v_pk_mul_f32 v[26:27], v[26:27], v[30:31] op_sel:[0,1] op_sel_hi:[1,1]
    v_pk_mul_f32 v[28:29], v[28:29], v[30:31] op_sel:[0,1] op_sel_hi:[1,1]
    v_exp_f32 v14, -v14
    v_exp_f32 v15, -v15
    v_exp_f32 v16, -v16
    v_exp_f32 v17, -v17
    v_exp_f32 v18, -v18
    v_exp_f32 v19, -v19
    v_exp_f32 v20, -v20
    v_exp_f32 v21, -v21
    v_exp_f32 v22, -v22
    v_exp_f32 v23, -v23
    v_exp_f32 v24, -v24
    v_exp_f32 v25, -v25
    v_exp_f32 v26, -v26
    v_exp_f32 v27, -v27
    v_exp_f32 v28, -v28
    v_exp_f32 v29, -v29
    v_cvt_pk_bf16_f32 v14, v14, v16
    v_cvt_pk_bf16_f32 v15, v15, v17
    v_cvt_pk_bf16_f32 v18, v18, v20
    v_cvt_pk_bf16_f32 v19, v19, v21
    v_cvt_pk_bf16_f32 v22, v22, v24
    v_cvt_pk_bf16_f32 v23, v23, v25
    v_cvt_pk_bf16_f32 v26, v26, v28
    v_cvt_pk_bf16_f32 v27, v27, v29
    v_dot2_f32_bf16 v72, v14, s68, 0
    v_dot2_f32_bf16 v73, v15, s68, 0
    v_dot2_f32_bf16 v74, v14, s69, 0
    v_dot2_f32_bf16 v75, v15, s69, 0
    v_dot2_f32_bf16 v76, v14, s70, 0
    v_dot2_f32_bf16 v77, v15, s70, 0
    v_dot2_f32_bf16 v78, v14, s71, 0
    v_dot2_f32_bf16 v79, v15, s71, 0
    v_dot2_f32_bf16 v80, v14, s52, 0
    v_dot2_f32_bf16 v81, v15, s52, 0
    v_dot2_f32_bf16 v82, v14, s53, 0
    v_dot2_f32_bf16 v83, v15, s53, 0
    v_dot2_f32_bf16 v84, v14, s54, 0
    v_dot2_f32_bf16 v85, v15, s54, 0
    v_dot2_f32_bf16 v86, v14, s55, 0
    v_dot2_f32_bf16 v87, v15, s55, 0
    v_dot2_f32_bf16 v72, v18, s72, v72
    v_dot2_f32_bf16 v73, v19, s72, v73
    v_dot2_f32_bf16 v74, v18, s73, v74
    v_dot2_f32_bf16 v75, v19, s73, v75
    v_dot2_f32_bf16 v76, v18, s74, v76
    v_dot2_f32_bf16 v77, v19, s74, v77
    v_dot2_f32_bf16 v78, v18, s75, v78
    v_dot2_f32_bf16 v79, v19, s75, v79
    v_dot2_f32_bf16 v80, v18, s56, v80
    v_dot2_f32_bf16 v81, v19, s56, v81
    v_dot2_f32_bf16 v82, v18, s57, v82
    v_dot2_f32_bf16 v83, v19, s57, v83
    v_dot2_f32_bf16 v84, v18, s58, v84
    v_dot2_f32_bf16 v85, v19, s58, v85
    v_dot2_f32_bf16 v86, v18, s59, v86
    v_dot2_f32_bf16 v87, v19, s59, v87
    v_dot2_f32_bf16 v72, v22, s76, v72
    v_dot2_f32_bf16 v73, v23, s76, v73
    v_dot2_f32_bf16 v74, v22, s77, v74
    v_dot2_f32_bf16 v75, v23, s77, v75
    v_dot2_f32_bf16 v76, v22, s78, v76
    v_dot2_f32_bf16 v77, v23, s78, v77
    v_dot2_f32_bf16 v78, v22, s79, v78
    v_dot2_f32_bf16 v79, v23, s79, v79
    v_dot2_f32_bf16 v80, v22, s60, v80
    v_dot2_f32_bf16 v81, v23, s60, v81
    v_dot2_f32_bf16 v82, v22, s61, v82
    v_dot2_f32_bf16 v83, v23, s61, v83
    v_dot2_f32_bf16 v84, v22, s62, v84
    v_dot2_f32_bf16 v85, v23, s62, v85
    v_dot2_f32_bf16 v86, v22, s63, v86
    v_dot2_f32_bf16 v87, v23, s63, v87
    v_dot2_f32_bf16 v72, v26, s80, v72
    v_dot2_f32_bf16 v73, v27, s80, v73
    v_dot2_f32_bf16 v74, v26, s81, v74
    v_dot2_f32_bf16 v75, v27, s81, v75
    v_dot2_f32_bf16 v76, v26, s82, v76
    v_dot2_f32_bf16 v77, v27, s82, v77
    v_dot2_f32_bf16 v78, v26, s83, v78
    v_dot2_f32_bf16 v79, v27, s83, v79
    v_dot2_f32_bf16 v80, v26, s64, v80
    v_dot2_f32_bf16 v81, v27, s64, v81
    v_dot2_f32_bf16 v82, v26, s65, v82
    v_dot2_f32_bf16 v83, v27, s65, v83
    v_dot2_f32_bf16 v84, v26, s66, v84
    v_dot2_f32_bf16 v85, v27, s66, v85
    v_dot2_f32_bf16 v86, v26, s67, v86
    v_dot2_f32_bf16 v87, v27, s67, v87
L_p2_gb:
    v_and_b32 v4, 0x80008000, v4
    v_cmp_ne_u32 vcc, 0, v4
    v_mov_b32 v8, s27
    v_and_b32 v10, 15, v0
    v_mul_u32_u24 v10, 240, v10
    v_add_u32 v10, 160000, v10
    s_cmp_lg_u64 vcc, 0
    s_cselect_b32 s2, 1, s2
    v_mov_b32 v9, s2
    s_mov_b64 exec, 1
    ds_write_b32 v8, v9
    s_mov_b64 exec, -1
    v_add_u32 v2, 16384, v1
    v_mov_b32 v9, 0x3f000000
    v_cmp_gt_u32 vcc, 226, v0
    s_mov_b32 s49, s12
    s_mov_b32 s51, 0
    v_cndmask_b32 v2, v9, v2, vcc
    s_waitcnt vmcnt(0) lgkmcnt(0)
    s_barrier
    ds_read_b32 v9, v10
    s_mov_b32 s18, 5120000
    s_mov_b32 s19, 0x00020000
    s_waitcnt lgkmcnt(0)
    v_cmp_ne_u32 vcc, 0, v9
    s_nop 1
    s_cmp_lg_u64 vcc, 0
    s_cselect_b32 s2, 1, 0
    s_cbranch_scc1 L_p2_slow
L_p2_signal:
    v_mov_b32 v8, 160228
    s_lshl_b32 s15, s2, 4
    s_or_b32 s15, s15, s21
    s_add_u32 s14, s12, 16
    s_lshl_b32 s20, s15, s14
    s_add_u32 s20, s20, 1
    v_mov_b32 v9, s20
    s_cmp_lg_u32 s13, 15
    s_cbranch_scc1 L_p2_nosig0
    s_lshl_b32 s14, s3, 8
    s_add_u32 s14, s14, 8523776
    s_mov_b64 exec, 1
    buffer_atomic_add v9, off, s[4:7], s14 sc0
    s_mov_b64 exec, -1
L_p2_nosig0:
    s_lshl2_add_u32 s14, s3, s49
    s_mul_i32 s26, s14, 20000
    s_mov_b32 s10, 5120000
    buffer_load_dwordx4 v[64:67], v1, s[8:11], s26 offen
    buffer_load_dwordx4 v[68:71], v2, s[8:11], s26 offen
    s_lshl_b32 s28, s92, 16
    s_and_b32 s29, s92, 0xffff0000
    s_lshl_b32 s30, s93, 16
    s_and_b32 s31, s93, 0xffff0000
    s_lshl_b32 s32, s94, 16
    s_and_b32 s33, s94, 0xffff0000
    s_lshl_b32 s34, s95, 16
    s_and_b32 s35, s95, 0xffff0000
    s_lshl_b32 s36, s96, 16
    s_and_b32 s37, s96, 0xffff0000
    s_lshl_b32 s38, s97, 16
    s_and_b32 s39, s97, 0xffff0000
    s_lshl_b32 s40, s98, 16
    s_and_b32 s41, s98, 0xffff0000
    s_lshl_b32 s42, s99, 16
    s_and_b32 s43, s99, 0xffff0000
    s_and_b32 s99, s91, 0xffff0000
    s_lshl_b32 s98, s91, 16
    s_and_b32 s97, s90, 0xffff0000
    s_lshl_b32 s96, s90, 16
    s_and_b32 s95, s89, 0xffff0000
    s_lshl_b32 s94, s89, 16
    s_and_b32 s93, s88, 0xffff0000
    s_lshl_b32 s92, s88, 16
    s_and_b32 s91, s87, 0xffff0000
    s_lshl_b32 s90, s87, 16
    s_and_b32 s89, s86, 0xffff0000
    s_lshl_b32 s88, s86, 16
    s_and_b32 s87, s85, 0xffff0000
    s_lshl_b32 s86, s85, 16
    s_and_b32 s85, s84, 0xffff0000
    s_lshl_b32 s84, s84, 16
    s_mov_b32 s44, s48
    s_add_u32 s45, s48, 2281701376
    s_cmp_eq_u32 s48, 0
    s_cselect_b32 s45, 0, s45
    s_cmp_lt_u32 s13, 12
    s_cbranch_scc1 L_p2_gc
    v_lshlrev_b32 v30, 16, v60
    v_and_b32 v31, 0xffff0000, v60
    v_lshlrev_b32 v36, 16, v53
    v_and_b32 v37, 0xffff0000, v53
    v_lshlrev_b32 v38, 16, v54
    v_and_b32 v39, 0xffff0000, v54
    v_lshlrev_b32 v40, 16, v56
    v_and_b32 v41, 0xffff0000, v56
    v_lshlrev_b32 v42, 16, v57
    v_and_b32 v43, 0xffff0000, v57
    v_pk_add_f32 v[14:15], v[30:31], v[36:37] op_sel:[0,0] op_sel_hi:[1,0] neg_lo:[0,1] neg_hi:[0,1]
    v_pk_add_f32 v[16:17], v[30:31], v[36:37] op_sel:[0,1] op_sel_hi:[1,1] neg_lo:[0,1] neg_hi:[0,1]
    v_pk_add_f32 v[18:19], v[30:31], v[38:39] op_sel:[0,0] op_sel_hi:[1,0] neg_lo:[0,1] neg_hi:[0,1]
    v_pk_add_f32 v[20:21], v[30:31], v[38:39] op_sel:[0,1] op_sel_hi:[1,1] neg_lo:[0,1] neg_hi:[0,1]
    v_pk_add_f32 v[22:23], v[30:31], v[40:41] op_sel:[0,0] op_sel_hi:[1,0] neg_lo:[0,1] neg_hi:[0,1]
    v_pk_add_f32 v[24:25], v[30:31], v[40:41] op_sel:[0,1] op_sel_hi:[1,1] neg_lo:[0,1] neg_hi:[0,1]
    v_pk_add_f32 v[26:27], v[30:31], v[42:43] op_sel:[0,0] op_sel_hi:[1,0] neg_lo:[0,1] neg_hi:[0,1]
    v_pk_add_f32 v[28:29], v[30:31], v[42:43] op_sel:[0,1] op_sel_hi:[1,1] neg_lo:[0,1] neg_hi:[0,1]
    v_cvt_pk_bf16_f32 v32, v14, v15
    v_lshlrev_b32 v14, 16, v32
    v_and_b32 v15, 0xffff0000, v32
    v_cvt_pk_bf16_f32 v32, v16, v17
    v_lshlrev_b32 v16, 16, v32
    v_and_b32 v17, 0xffff0000, v32
    v_cvt_pk_bf16_f32 v32, v18, v19
    v_lshlrev_b32 v18, 16, v32
    v_and_b32 v19, 0xffff0000, v32
    v_cvt_pk_bf16_f32 v32, v20, v21
    v_lshlrev_b32 v20, 16, v32
    v_and_b32 v21, 0xffff0000, v32
    v_cvt_pk_bf16_f32 v32, v22, v23
    v_lshlrev_b32 v22, 16, v32
    v_and_b32 v23, 0xffff0000, v32
    v_cvt_pk_bf16_f32 v32, v24, v25
    v_lshlrev_b32 v24, 16, v32
    v_and_b32 v25, 0xffff0000, v32
    v_cvt_pk_bf16_f32 v32, v26, v27
    v_lshlrev_b32 v26, 16, v32
    v_and_b32 v27, 0xffff0000, v32
    v_cvt_pk_bf16_f32 v32, v28, v29
    v_lshlrev_b32 v28, 16, v32
    v_and_b32 v29, 0xffff0000, v32
    v_pk_mul_f32 v[14:15], v[14:15], v[14:15]
    v_pk_mul_f32 v[16:17], v[16:17], v[16:17]
    v_pk_mul_f32 v[18:19], v[18:19], v[18:19]
    v_pk_mul_f32 v[20:21], v[20:21], v[20:21]
    v_pk_mul_f32 v[22:23], v[22:23], v[22:23]
    v_pk_mul_f32 v[24:25], v[24:25], v[24:25]
    v_pk_mul_f32 v[26:27], v[26:27], v[26:27]
    v_pk_mul_f32 v[28:29], v[28:29], v[28:29]
    v_cvt_pk_bf16_f32 v32, v14, v15
    v_lshlrev_b32 v14, 16, v32
    v_and_b32 v15, 0xffff0000, v32
    v_cvt_pk_bf16_f32 v32, v16, v17
    v_lshlrev_b32 v16, 16, v32
    v_and_b32 v17, 0xffff0000, v32
    v_cvt_pk_bf16_f32 v32, v18, v19
    v_lshlrev_b32 v18, 16, v32
    v_and_b32 v19, 0xffff0000, v32
    v_cvt_pk_bf16_f32 v32, v20, v21
    v_lshlrev_b32 v20, 16, v32
    v_and_b32 v21, 0xffff0000, v32
    v_cvt_pk_bf16_f32 v32, v22, v23
    v_lshlrev_b32 v22, 16, v32
    v_and_b32 v23, 0xffff0000, v32
    v_cvt_pk_bf16_f32 v32, v24, v25
    v_lshlrev_b32 v24, 16, v32
    v_and_b32 v25, 0xffff0000, v32
    v_cvt_pk_bf16_f32 v32, v26, v27
    v_lshlrev_b32 v26, 16, v32
    v_and_b32 v27, 0xffff0000, v32
    v_cvt_pk_bf16_f32 v32, v28, v29
    v_lshlrev_b32 v28, 16, v32
    v_and_b32 v29, 0xffff0000, v32
    v_mov_b32 v30, 1092616192
    v_mov_b32 v31, 0x3fb8aa3b
    v_pk_mul_f32 v[14:15], v[14:15], v[30:31] op_sel:[0,0] op_sel_hi:[1,0]
    v_pk_mul_f32 v[16:17], v[16:17], v[30:31] op_sel:[0,0] op_sel_hi:[1,0]
    v_pk_mul_f32 v[18:19], v[18:19], v[30:31] op_sel:[0,0] op_sel_hi:[1,0]
    v_pk_mul_f32 v[20:21], v[20:21], v[30:31] op_sel:[0,0] op_sel_hi:[1,0]
    v_pk_mul_f32 v[22:23], v[22:23], v[30:31] op_sel:[0,0] op_sel_hi:[1,0]
    v_pk_mul_f32 v[24:25], v[24:25], v[30:31] op_sel:[0,0] op_sel_hi:[1,0]
    v_pk_mul_f32 v[26:27], v[26:27], v[30:31] op_sel:[0,0] op_sel_hi:[1,0]
    v_pk_mul_f32 v[28:29], v[28:29], v[30:31] op_sel:[0,0] op_sel_hi:[1,0]
    v_cvt_pk_bf16_f32 v32, v14, v15
    v_lshlrev_b32 v14, 16, v32
    v_and_b32 v15, 0xffff0000, v32
    v_cvt_pk_bf16_f32 v32, v16, v17
    v_lshlrev_b32 v16, 16, v32
    v_and_b32 v17, 0xffff0000, v32
    v_cvt_pk_bf16_f32 v32, v18, v19
    v_lshlrev_b32 v18, 16, v32
    v_and_b32 v19, 0xffff0000, v32
    v_cvt_pk_bf16_f32 v32, v20, v21
    v_lshlrev_b32 v20, 16, v32
    v_and_b32 v21, 0xffff0000, v32
    v_cvt_pk_bf16_f32 v32, v22, v23
    v_lshlrev_b32 v22, 16, v32
    v_and_b32 v23, 0xffff0000, v32
    v_cvt_pk_bf16_f32 v32, v24, v25
    v_lshlrev_b32 v24, 16, v32
    v_and_b32 v25, 0xffff0000, v32
    v_cvt_pk_bf16_f32 v32, v26, v27
    v_lshlrev_b32 v26, 16, v32
    v_and_b32 v27, 0xffff0000, v32
    v_cvt_pk_bf16_f32 v32, v28, v29
    v_lshlrev_b32 v28, 16, v32
    v_and_b32 v29, 0xffff0000, v32
    v_pk_mul_f32 v[14:15], v[14:15], v[30:31] op_sel:[0,1] op_sel_hi:[1,1]
    v_pk_mul_f32 v[16:17], v[16:17], v[30:31] op_sel:[0,1] op_sel_hi:[1,1]
    v_pk_mul_f32 v[18:19], v[18:19], v[30:31] op_sel:[0,1] op_sel_hi:[1,1]
    v_pk_mul_f32 v[20:21], v[20:21], v[30:31] op_sel:[0,1] op_sel_hi:[1,1]
    v_pk_mul_f32 v[22:23], v[22:23], v[30:31] op_sel:[0,1] op_sel_hi:[1,1]
    v_pk_mul_f32 v[24:25], v[24:25], v[30:31] op_sel:[0,1] op_sel_hi:[1,1]
    v_pk_mul_f32 v[26:27], v[26:27], v[30:31] op_sel:[0,1] op_sel_hi:[1,1]
    v_pk_mul_f32 v[28:29], v[28:29], v[30:31] op_sel:[0,1] op_sel_hi:[1,1]
    v_exp_f32 v14, -v14
    v_exp_f32 v15, -v15
    v_exp_f32 v16, -v16
    v_exp_f32 v17, -v17
    v_exp_f32 v18, -v18
    v_exp_f32 v19, -v19
    v_exp_f32 v20, -v20
    v_exp_f32 v21, -v21
    v_exp_f32 v22, -v22
    v_exp_f32 v23, -v23
    v_exp_f32 v24, -v24
    v_exp_f32 v25, -v25
    v_exp_f32 v26, -v26
    v_exp_f32 v27, -v27
    v_exp_f32 v28, -v28
    v_exp_f32 v29, -v29
    v_cvt_pk_bf16_f32 v14, v14, v16
    v_cvt_pk_bf16_f32 v15, v15, v17
    v_cvt_pk_bf16_f32 v18, v18, v20
    v_cvt_pk_bf16_f32 v19, v19, v21
    v_cvt_pk_bf16_f32 v22, v22, v24
    v_cvt_pk_bf16_f32 v23, v23, v25
    v_cvt_pk_bf16_f32 v26, v26, v28
    v_cvt_pk_bf16_f32 v27, v27, v29
    v_dot2_f32_bf16 v72, v14, s68, 0
    v_dot2_f32_bf16 v73, v15, s68, 0
    v_dot2_f32_bf16 v74, v14, s69, 0
    v_dot2_f32_bf16 v75, v15, s69, 0
    v_dot2_f32_bf16 v76, v14, s70, 0
    v_dot2_f32_bf16 v77, v15, s70, 0
    v_dot2_f32_bf16 v78, v14, s71, 0
    v_dot2_f32_bf16 v79, v15, s71, 0
    v_dot2_f32_bf16 v80, v14, s52, 0
    v_dot2_f32_bf16 v81, v15, s52, 0
    v_dot2_f32_bf16 v82, v14, s53, 0
    v_dot2_f32_bf16 v83, v15, s53, 0
    v_dot2_f32_bf16 v84, v14, s54, 0
    v_dot2_f32_bf16 v85, v15, s54, 0
    v_dot2_f32_bf16 v86, v14, s55, 0
    v_dot2_f32_bf16 v87, v15, s55, 0
    v_dot2_f32_bf16 v72, v18, s72, v72
    v_dot2_f32_bf16 v73, v19, s72, v73
    v_dot2_f32_bf16 v74, v18, s73, v74
    v_dot2_f32_bf16 v75, v19, s73, v75
    v_dot2_f32_bf16 v76, v18, s74, v76
    v_dot2_f32_bf16 v77, v19, s74, v77
    v_dot2_f32_bf16 v78, v18, s75, v78
    v_dot2_f32_bf16 v79, v19, s75, v79
    v_dot2_f32_bf16 v80, v18, s56, v80
    v_dot2_f32_bf16 v81, v19, s56, v81
    v_dot2_f32_bf16 v82, v18, s57, v82
    v_dot2_f32_bf16 v83, v19, s57, v83
    v_dot2_f32_bf16 v84, v18, s58, v84
    v_dot2_f32_bf16 v85, v19, s58, v85
    v_dot2_f32_bf16 v86, v18, s59, v86
    v_dot2_f32_bf16 v87, v19, s59, v87
    v_dot2_f32_bf16 v72, v22, s76, v72
    v_dot2_f32_bf16 v73, v23, s76, v73
    v_dot2_f32_bf16 v74, v22, s77, v74
    v_dot2_f32_bf16 v75, v23, s77, v75
    v_dot2_f32_bf16 v76, v22, s78, v76
    v_dot2_f32_bf16 v77, v23, s78, v77
    v_dot2_f32_bf16 v78, v22, s79, v78
    v_dot2_f32_bf16 v79, v23, s79, v79
    v_dot2_f32_bf16 v80, v22, s60, v80
    v_dot2_f32_bf16 v81, v23, s60, v81
    v_dot2_f32_bf16 v82, v22, s61, v82
    v_dot2_f32_bf16 v83, v23, s61, v83
    v_dot2_f32_bf16 v84, v22, s62, v84
    v_dot2_f32_bf16 v85, v23, s62, v85
    v_dot2_f32_bf16 v86, v22, s63, v86
    v_dot2_f32_bf16 v87, v23, s63, v87
    v_dot2_f32_bf16 v72, v26, s80, v72
    v_dot2_f32_bf16 v73, v27, s80, v73
    v_dot2_f32_bf16 v74, v26, s81, v74
    v_dot2_f32_bf16 v75, v27, s81, v75
    v_dot2_f32_bf16 v76, v26, s82, v76
    v_dot2_f32_bf16 v77, v27, s82, v77
    v_dot2_f32_bf16 v78, v26, s83, v78
    v_dot2_f32_bf16 v79, v27, s83, v79
    v_dot2_f32_bf16 v80, v26, s64, v80
    v_dot2_f32_bf16 v81, v27, s64, v81
    v_dot2_f32_bf16 v82, v26, s65, v82
    v_dot2_f32_bf16 v83, v27, s65, v83
    v_dot2_f32_bf16 v84, v26, s66, v84
    v_dot2_f32_bf16 v85, v27, s66, v85
    v_dot2_f32_bf16 v86, v26, s67, v86
    v_dot2_f32_bf16 v87, v27, s67, v87
L_p2_gc:
    s_cmp_ge_u32 s13, 4
    s_cbranch_scc1 L_p2_gd
    v_lshlrev_b32 v30, 16, v61
    v_and_b32 v31, 0xffff0000, v61
    v_pk_add_f32 v[14:15], v[30:31], v[36:37] op_sel:[0,0] op_sel_hi:[1,0] neg_lo:[0,1] neg_hi:[0,1]
    v_pk_add_f32 v[16:17], v[30:31], v[36:37] op_sel:[0,1] op_sel_hi:[1,1] neg_lo:[0,1] neg_hi:[0,1]
    v_pk_add_f32 v[18:19], v[30:31], v[38:39] op_sel:[0,0] op_sel_hi:[1,0] neg_lo:[0,1] neg_hi:[0,1]
    v_pk_add_f32 v[20:21], v[30:31], v[38:39] op_sel:[0,1] op_sel_hi:[1,1] neg_lo:[0,1] neg_hi:[0,1]
    v_pk_add_f32 v[22:23], v[30:31], v[40:41] op_sel:[0,0] op_sel_hi:[1,0] neg_lo:[0,1] neg_hi:[0,1]
    v_pk_add_f32 v[24:25], v[30:31], v[40:41] op_sel:[0,1] op_sel_hi:[1,1] neg_lo:[0,1] neg_hi:[0,1]
    v_pk_add_f32 v[26:27], v[30:31], v[42:43] op_sel:[0,0] op_sel_hi:[1,0] neg_lo:[0,1] neg_hi:[0,1]
    v_pk_add_f32 v[28:29], v[30:31], v[42:43] op_sel:[0,1] op_sel_hi:[1,1] neg_lo:[0,1] neg_hi:[0,1]
    v_cvt_pk_bf16_f32 v32, v14, v15
    v_lshlrev_b32 v14, 16, v32
    v_and_b32 v15, 0xffff0000, v32
    v_cvt_pk_bf16_f32 v32, v16, v17
    v_lshlrev_b32 v16, 16, v32
    v_and_b32 v17, 0xffff0000, v32
    v_cvt_pk_bf16_f32 v32, v18, v19
    v_lshlrev_b32 v18, 16, v32
    v_and_b32 v19, 0xffff0000, v32
    v_cvt_pk_bf16_f32 v32, v20, v21
    v_lshlrev_b32 v20, 16, v32
    v_and_b32 v21, 0xffff0000, v32
    v_cvt_pk_bf16_f32 v32, v22, v23
    v_lshlrev_b32 v22, 16, v32
    v_and_b32 v23, 0xffff0000, v32
    v_cvt_pk_bf16_f32 v32, v24, v25
    v_lshlrev_b32 v24, 16, v32
    v_and_b32 v25, 0xffff0000, v32
    v_cvt_pk_bf16_f32 v32, v26, v27
    v_lshlrev_b32 v26, 16, v32
    v_and_b32 v27, 0xffff0000, v32
    v_cvt_pk_bf16_f32 v32, v28, v29
    v_lshlrev_b32 v28, 16, v32
    v_and_b32 v29, 0xffff0000, v32
    v_pk_mul_f32 v[14:15], v[14:15], v[14:15]
    v_pk_mul_f32 v[16:17], v[16:17], v[16:17]
    v_pk_mul_f32 v[18:19], v[18:19], v[18:19]
    v_pk_mul_f32 v[20:21], v[20:21], v[20:21]
    v_pk_mul_f32 v[22:23], v[22:23], v[22:23]
    v_pk_mul_f32 v[24:25], v[24:25], v[24:25]
    v_pk_mul_f32 v[26:27], v[26:27], v[26:27]
    v_pk_mul_f32 v[28:29], v[28:29], v[28:29]
    v_cvt_pk_bf16_f32 v32, v14, v15
    v_lshlrev_b32 v14, 16, v32
    v_and_b32 v15, 0xffff0000, v32
    v_cvt_pk_bf16_f32 v32, v16, v17
    v_lshlrev_b32 v16, 16, v32
    v_and_b32 v17, 0xffff0000, v32
    v_cvt_pk_bf16_f32 v32, v18, v19
    v_lshlrev_b32 v18, 16, v32
    v_and_b32 v19, 0xffff0000, v32
    v_cvt_pk_bf16_f32 v32, v20, v21
    v_lshlrev_b32 v20, 16, v32
    v_and_b32 v21, 0xffff0000, v32
    v_cvt_pk_bf16_f32 v32, v22, v23
    v_lshlrev_b32 v22, 16, v32
    v_and_b32 v23, 0xffff0000, v32
    v_cvt_pk_bf16_f32 v32, v24, v25
    v_lshlrev_b32 v24, 16, v32
    v_and_b32 v25, 0xffff0000, v32
    v_cvt_pk_bf16_f32 v32, v26, v27
    v_lshlrev_b32 v26, 16, v32
    v_and_b32 v27, 0xffff0000, v32
    v_cvt_pk_bf16_f32 v32, v28, v29
    v_lshlrev_b32 v28, 16, v32
    v_and_b32 v29, 0xffff0000, v32
    v_mov_b32 v30, 1092616192
    v_mov_b32 v31, 0x3fb8aa3b
    v_pk_mul_f32 v[14:15], v[14:15], v[30:31] op_sel:[0,0] op_sel_hi:[1,0]
    v_pk_mul_f32 v[16:17], v[16:17], v[30:31] op_sel:[0,0] op_sel_hi:[1,0]
    v_pk_mul_f32 v[18:19], v[18:19], v[30:31] op_sel:[0,0] op_sel_hi:[1,0]
    v_pk_mul_f32 v[20:21], v[20:21], v[30:31] op_sel:[0,0] op_sel_hi:[1,0]
    v_pk_mul_f32 v[22:23], v[22:23], v[30:31] op_sel:[0,0] op_sel_hi:[1,0]
    v_pk_mul_f32 v[24:25], v[24:25], v[30:31] op_sel:[0,0] op_sel_hi:[1,0]
    v_pk_mul_f32 v[26:27], v[26:27], v[30:31] op_sel:[0,0] op_sel_hi:[1,0]
    v_pk_mul_f32 v[28:29], v[28:29], v[30:31] op_sel:[0,0] op_sel_hi:[1,0]
    v_cvt_pk_bf16_f32 v32, v14, v15
    v_lshlrev_b32 v14, 16, v32
    v_and_b32 v15, 0xffff0000, v32
    v_cvt_pk_bf16_f32 v32, v16, v17
    v_lshlrev_b32 v16, 16, v32
    v_and_b32 v17, 0xffff0000, v32
    v_cvt_pk_bf16_f32 v32, v18, v19
    v_lshlrev_b32 v18, 16, v32
    v_and_b32 v19, 0xffff0000, v32
    v_cvt_pk_bf16_f32 v32, v20, v21
    v_lshlrev_b32 v20, 16, v32
    v_and_b32 v21, 0xffff0000, v32
    v_cvt_pk_bf16_f32 v32, v22, v23
    v_lshlrev_b32 v22, 16, v32
    v_and_b32 v23, 0xffff0000, v32
    v_cvt_pk_bf16_f32 v32, v24, v25
    v_lshlrev_b32 v24, 16, v32
    v_and_b32 v25, 0xffff0000, v32
    v_cvt_pk_bf16_f32 v32, v26, v27
    v_lshlrev_b32 v26, 16, v32
    v_and_b32 v27, 0xffff0000, v32
    v_cvt_pk_bf16_f32 v32, v28, v29
    v_lshlrev_b32 v28, 16, v32
    v_and_b32 v29, 0xffff0000, v32
    v_pk_mul_f32 v[14:15], v[14:15], v[30:31] op_sel:[0,1] op_sel_hi:[1,1]
    v_pk_mul_f32 v[16:17], v[16:17], v[30:31] op_sel:[0,1] op_sel_hi:[1,1]
    v_pk_mul_f32 v[18:19], v[18:19], v[30:31] op_sel:[0,1] op_sel_hi:[1,1]
    v_pk_mul_f32 v[20:21], v[20:21], v[30:31] op_sel:[0,1] op_sel_hi:[1,1]
    v_pk_mul_f32 v[22:23], v[22:23], v[30:31] op_sel:[0,1] op_sel_hi:[1,1]
    v_pk_mul_f32 v[24:25], v[24:25], v[30:31] op_sel:[0,1] op_sel_hi:[1,1]
    v_pk_mul_f32 v[26:27], v[26:27], v[30:31] op_sel:[0,1] op_sel_hi:[1,1]
    v_pk_mul_f32 v[28:29], v[28:29], v[30:31] op_sel:[0,1] op_sel_hi:[1,1]
    v_exp_f32 v14, -v14
    v_exp_f32 v15, -v15
    v_exp_f32 v16, -v16
    v_exp_f32 v17, -v17
    v_exp_f32 v18, -v18
    v_exp_f32 v19, -v19
    v_exp_f32 v20, -v20
    v_exp_f32 v21, -v21
    v_exp_f32 v22, -v22
    v_exp_f32 v23, -v23
    v_exp_f32 v24, -v24
    v_exp_f32 v25, -v25
    v_exp_f32 v26, -v26
    v_exp_f32 v27, -v27
    v_exp_f32 v28, -v28
    v_exp_f32 v29, -v29
    v_cvt_pk_bf16_f32 v14, v14, v16
    v_cvt_pk_bf16_f32 v15, v15, v17
    v_cvt_pk_bf16_f32 v18, v18, v20
    v_cvt_pk_bf16_f32 v19, v19, v21
    v_cvt_pk_bf16_f32 v22, v22, v24
    v_cvt_pk_bf16_f32 v23, v23, v25
    v_cvt_pk_bf16_f32 v26, v26, v28
    v_cvt_pk_bf16_f32 v27, v27, v29
    v_dot2_f32_bf16 v112, v14, s68, 0
    v_dot2_f32_bf16 v113, v15, s68, 0
    v_dot2_f32_bf16 v114, v14, s69, 0
    v_dot2_f32_bf16 v115, v15, s69, 0
    v_dot2_f32_bf16 v116, v14, s70, 0
    v_dot2_f32_bf16 v117, v15, s70, 0
    v_dot2_f32_bf16 v118, v14, s71, 0
    v_dot2_f32_bf16 v119, v15, s71, 0
    v_dot2_f32_bf16 v120, v14, s52, 0
    v_dot2_f32_bf16 v121, v15, s52, 0
    v_dot2_f32_bf16 v122, v14, s53, 0
    v_dot2_f32_bf16 v123, v15, s53, 0
    v_dot2_f32_bf16 v124, v14, s54, 0
    v_dot2_f32_bf16 v125, v15, s54, 0
    v_dot2_f32_bf16 v126, v14, s55, 0
    v_dot2_f32_bf16 v127, v15, s55, 0
    v_dot2_f32_bf16 v112, v18, s72, v112
    v_dot2_f32_bf16 v113, v19, s72, v113
    v_dot2_f32_bf16 v114, v18, s73, v114
    v_dot2_f32_bf16 v115, v19, s73, v115
    v_dot2_f32_bf16 v116, v18, s74, v116
    v_dot2_f32_bf16 v117, v19, s74, v117
    v_dot2_f32_bf16 v118, v18, s75, v118
    v_dot2_f32_bf16 v119, v19, s75, v119
    v_dot2_f32_bf16 v120, v18, s56, v120
    v_dot2_f32_bf16 v121, v19, s56, v121
    v_dot2_f32_bf16 v122, v18, s57, v122
    v_dot2_f32_bf16 v123, v19, s57, v123
    v_dot2_f32_bf16 v124, v18, s58, v124
    v_dot2_f32_bf16 v125, v19, s58, v125
    v_dot2_f32_bf16 v126, v18, s59, v126
    v_dot2_f32_bf16 v127, v19, s59, v127
    v_dot2_f32_bf16 v112, v22, s76, v112
    v_dot2_f32_bf16 v113, v23, s76, v113
    v_dot2_f32_bf16 v114, v22, s77, v114
    v_dot2_f32_bf16 v115, v23, s77, v115
    v_dot2_f32_bf16 v116, v22, s78, v116
    v_dot2_f32_bf16 v117, v23, s78, v117
    v_dot2_f32_bf16 v118, v22, s79, v118
    v_dot2_f32_bf16 v119, v23, s79, v119
    v_dot2_f32_bf16 v120, v22, s60, v120
    v_dot2_f32_bf16 v121, v23, s60, v121
    v_dot2_f32_bf16 v122, v22, s61, v122
    v_dot2_f32_bf16 v123, v23, s61, v123
    v_dot2_f32_bf16 v124, v22, s62, v124
    v_dot2_f32_bf16 v125, v23, s62, v125
    v_dot2_f32_bf16 v126, v22, s63, v126
    v_dot2_f32_bf16 v127, v23, s63, v127
    v_dot2_f32_bf16 v112, v26, s80, v112
    v_dot2_f32_bf16 v113, v27, s80, v113
    v_dot2_f32_bf16 v114, v26, s81, v114
    v_dot2_f32_bf16 v115, v27, s81, v115
    v_dot2_f32_bf16 v116, v26, s82, v116
    v_dot2_f32_bf16 v117, v27, s82, v117
    v_dot2_f32_bf16 v118, v26, s83, v118
    v_dot2_f32_bf16 v119, v27, s83, v119
    v_dot2_f32_bf16 v120, v26, s64, v120
    v_dot2_f32_bf16 v121, v27, s64, v121
    v_dot2_f32_bf16 v122, v26, s65, v122
    v_dot2_f32_bf16 v123, v27, s65, v123
    v_dot2_f32_bf16 v124, v26, s66, v124
    v_dot2_f32_bf16 v125, v27, s66, v125
    v_dot2_f32_bf16 v126, v26, s67, v126
    v_dot2_f32_bf16 v127, v27, s67, v127
L_p2_gd:
    s_cmp_lg_u32 s13, 15
    s_cbranch_scc1 L_p2_nosig
    s_waitcnt vmcnt(2)
    v_readfirstlane_b32 s15, v9
    s_lshl_b32 s51, 1, s12
    s_add_u32 s20, s20, s15
    s_and_b32 s15, s20, 0xff
    s_cmp_eq_u32 s15, 4
    s_cbranch_scc0 L_p2_notlast
    s_bfe_u32 s15, s20, 262160
    s_or_b32 s51, s51, s15
    s_branch L_p2_pub
L_p2_notlast:
    s_cmp_lg_u32 s21, 0
    s_cselect_b32 s51, 0, s51
    s_cbranch_scc1 L_p2_pub
L_p2_poll:
    v_mov_b32 v9, 0
    s_lshl_b32 s14, s3, 8
    s_add_u32 s14, s14, 8523776
    s_mov_b64 exec, 1
    buffer_atomic_add v9, off, s[4:7], s14 sc0
    s_mov_b64 exec, -1
    s_waitcnt vmcnt(0)
    v_readfirstlane_b32 s20, v9
    s_nop 0
    s_and_b32 s15, s20, 0xff
    s_cmp_lt_u32 s15, 4
    s_cbranch_scc1 L_p2_poll
L_p2_pub:
    s_lshl_b32 s15, s51, 24
    s_or_b32 s15, s15, s20
    v_mov_b32 v9, s15
    s_mov_b64 exec, 1
    ds_write_b32 v8, v9
    s_mov_b64 exec, -1
    s_waitcnt lgkmcnt(0)
L_p2_nosig:
    s_barrier
    ds_read_b32 v9, v8
    s_waitcnt lgkmcnt(0)
    v_readfirstlane_b32 s20, v9
    s_nop 0
    s_lshr_b32 s51, s20, 24
    s_cbranch_scc0 L_p2_end
L_p2_fin:
    s_mul_i32 s24, s49, 20000
    s_add_u32 s14, s12, 1
    s_and_b32 s14, s14, 3
    s_mul_i32 s15, s14, 5120000
    s_add_u32 s15, s15, 228589568
    s_add_u32 s15, s15, s26
    buffer_load_dwordx4 v[12:15], v1, s[4:7], s15 offen sc1
    buffer_load_dwordx4 v[92:95], v2, s[4:7], s15 offen sc1
    s_add_u32 s14, s12, 2
    s_and_b32 s14, s14, 3
    s_mul_i32 s15, s14, 5120000
    s_add_u32 s15, s15, 228589568
    s_add_u32 s15, s15, s26
    buffer_load_dwordx4 v[16:19], v1, s[4:7], s15 offen sc1
    buffer_load_dwordx4 v[96:99], v2, s[4:7], s15 offen sc1
    s_add_u32 s14, s12, 3
    s_and_b32 s14, s14, 3
    s_mul_i32 s15, s14, 5120000
    s_add_u32 s15, s15, 228589568
    s_add_u32 s15, s15, s26
    buffer_load_dwordx4 v[20:23], v1, s[4:7], s15 offen sc1
    buffer_load_dwordx4 v[100:103], v2, s[4:7], s15 offen sc1
    v_add_u32 v24, s24, v1
    ds_read_b128 v[8:11], v24
    v_add_u32 v25, s24, v2
    ds_read_b128 v[88:91], v25
    s_waitcnt vmcnt(0) lgkmcnt(0)
    s_bfe_u32 s14, s20, 262164
    s_cbranch_scc0 L_p2_kernel_nof32a_10
    s_add_u32 s14, s12, 0
    s_and_b32 s14, s14, 3
    s_add_u32 s14, s14, 20
    s_bitcmp1_b32 s20, s14
    s_cbranch_scc0 L_p2_kernel_q_11
    v_mov_b32 v8, 1073758208
    v_mov_b32 v9, 1073758208
    v_mov_b32 v10, 1073758208
    v_mov_b32 v11, 1073758208
L_p2_kernel_q_11:
    s_add_u32 s14, s12, 1
    s_and_b32 s14, s14, 3
    s_add_u32 s14, s14, 20
    s_bitcmp1_b32 s20, s14
    s_cbranch_scc0 L_p2_kernel_q_12
    v_mov_b32 v12, 1073758208
    v_mov_b32 v13, 1073758208
    v_mov_b32 v14, 1073758208
    v_mov_b32 v15, 1073758208
L_p2_kernel_q_12:
    s_add_u32 s14, s12, 2
    s_and_b32 s14, s14, 3
    s_add_u32 s14, s14, 20
    s_bitcmp1_b32 s20, s14
    s_cbranch_scc0 L_p2_kernel_q_13
    v_mov_b32 v16, 1073758208
    v_mov_b32 v17, 1073758208
    v_mov_b32 v18, 1073758208
    v_mov_b32 v19, 1073758208
L_p2_kernel_q_13:
    s_add_u32 s14, s12, 3
    s_and_b32 s14, s14, 3
    s_add_u32 s14, s14, 20
    s_bitcmp1_b32 s20, s14
    s_cbranch_scc0 L_p2_kernel_q_14
    v_mov_b32 v20, 1073758208
    v_mov_b32 v21, 1073758208
    v_mov_b32 v22, 1073758208
    v_mov_b32 v23, 1073758208
L_p2_kernel_q_14:
L_p2_kernel_nof32a_10:
    v_pk_add_u16 v8, v8, v12
    v_pk_add_u16 v16, v16, v20
    v_pk_add_u16 v9, v9, v13
    v_pk_add_u16 v17, v17, v21
    v_pk_add_u16 v10, v10, v14
    v_pk_add_u16 v18, v18, v22
    v_pk_add_u16 v11, v11, v15
    v_pk_add_u16 v19, v19, v23
    v_add_u32_sdwa v24, v8, v16 dst_sel:DWORD dst_unused:UNUSED_PAD src0_sel:WORD_0 src1_sel:WORD_0
    v_add_u32_sdwa v25, v10, v18 dst_sel:DWORD dst_unused:UNUSED_PAD src0_sel:WORD_0 src1_sel:WORD_0
    v_add_u32_sdwa v26, v8, v16 dst_sel:DWORD dst_unused:UNUSED_PAD src0_sel:WORD_1 src1_sel:WORD_1
    v_add_u32_sdwa v27, v10, v18 dst_sel:DWORD dst_unused:UNUSED_PAD src0_sel:WORD_1 src1_sel:WORD_1
    v_add_u32_sdwa v28, v9, v17 dst_sel:DWORD dst_unused:UNUSED_PAD src0_sel:WORD_0 src1_sel:WORD_0
    v_add_u32_sdwa v29, v11, v19 dst_sel:DWORD dst_unused:UNUSED_PAD src0_sel:WORD_0 src1_sel:WORD_0
    v_add_u32_sdwa v30, v9, v17 dst_sel:DWORD dst_unused:UNUSED_PAD src0_sel:WORD_1 src1_sel:WORD_1
    v_add_u32_sdwa v31, v11, v19 dst_sel:DWORD dst_unused:UNUSED_PAD src0_sel:WORD_1 src1_sel:WORD_1
    v_cvt_f32_u32 v24, v24
    v_cvt_f32_u32 v25, v25
    v_cvt_f32_u32 v26, v26
    v_cvt_f32_u32 v27, v27
    v_cvt_f32_u32 v28, v28
    v_cvt_f32_u32 v29, v29
    v_cvt_f32_u32 v30, v30
    v_cvt_f32_u32 v31, v31
    v_pk_fma_f32 v[24:25], v[24:25], s[44:45], s[44:45] op_sel:[0,0,1] op_sel_hi:[1,0,1]
    v_pk_fma_f32 v[26:27], v[26:27], s[44:45], s[44:45] op_sel:[0,0,1] op_sel_hi:[1,0,1]
    v_pk_fma_f32 v[28:29], v[28:29], s[44:45], s[44:45] op_sel:[0,0,1] op_sel_hi:[1,0,1]
    v_pk_fma_f32 v[30:31], v[30:31], s[44:45], s[44:45] op_sel:[0,0,1] op_sel_hi:[1,0,1]
    s_bfe_u32 s14, s20, 262164
    s_cbranch_scc0 L_p2_kernel_nof32b_15
    v_lshlrev_b32 v32, 1, v1
    s_bitcmp1_b32 s20, 20
    s_cbranch_scc0 L_p2_kernel_q_16
    s_lshl_b32 s15, s26, 1
    s_add_u32 s15, s15, 249069568
    buffer_load_dwordx4 v[8:11], v32, s[4:7], s15 offen sc1
    buffer_load_dwordx4 v[12:15], v32, s[4:7], s15 offen offset:16 sc1
    s_waitcnt vmcnt(0)
    v_add_f32 v24, v24, v8
    v_add_f32 v25, v25, v12
    v_add_f32 v26, v26, v9
    v_add_f32 v27, v27, v13
    v_add_f32 v28, v28, v10
    v_add_f32 v29, v29, v14
    v_add_f32 v30, v30, v11
    v_add_f32 v31, v31, v15
L_p2_kernel_q_16:
    s_bitcmp1_b32 s20, 21
    s_cbranch_scc0 L_p2_kernel_q_17
    s_lshl_b32 s15, s26, 1
    s_add_u32 s15, s15, 259309568
    buffer_load_dwordx4 v[8:11], v32, s[4:7], s15 offen sc1
    buffer_load_dwordx4 v[12:15], v32, s[4:7], s15 offen offset:16 sc1
    s_waitcnt vmcnt(0)
    v_add_f32 v24, v24, v8
    v_add_f32 v25, v25, v12
    v_add_f32 v26, v26, v9
    v_add_f32 v27, v27, v13
    v_add_f32 v28, v28, v10
    v_add_f32 v29, v29, v14
    v_add_f32 v30, v30, v11
    v_add_f32 v31, v31, v15
L_p2_kernel_q_17:
    s_bitcmp1_b32 s20, 22
    s_cbranch_scc0 L_p2_kernel_q_18
    s_lshl_b32 s15, s26, 1
    s_add_u32 s15, s15, 269549568
    buffer_load_dwordx4 v[8:11], v32, s[4:7], s15 offen sc1
    buffer_load_dwordx4 v[12:15], v32, s[4:7], s15 offen offset:16 sc1
    s_waitcnt vmcnt(0)
    v_add_f32 v24, v24, v8
    v_add_f32 v25, v25, v12
    v_add_f32 v26, v26, v9
    v_add_f32 v27, v27, v13
    v_add_f32 v28, v28, v10
    v_add_f32 v29, v29, v14
    v_add_f32 v30, v30, v11
    v_add_f32 v31, v31, v15
L_p2_kernel_q_18:
    s_bitcmp1_b32 s20, 23
    s_cbranch_scc0 L_p2_kernel_q_19
    s_lshl_b32 s15, s26, 1
    s_add_u32 s15, s15, 279789568
    buffer_load_dwordx4 v[8:11], v32, s[4:7], s15 offen sc1
    buffer_load_dwordx4 v[12:15], v32, s[4:7], s15 offen offset:16 sc1
    s_waitcnt vmcnt(0)
    v_add_f32 v24, v24, v8
    v_add_f32 v25, v25, v12
    v_add_f32 v26, v26, v9
    v_add_f32 v27, v27, v13
    v_add_f32 v28, v28, v10
    v_add_f32 v29, v29, v14
    v_add_f32 v30, v30, v11
    v_add_f32 v31, v31, v15
L_p2_kernel_q_19:
L_p2_kernel_nof32b_15:
    v_pk_mul_f32 v[8:9], v[24:25], s[84:85] op_sel:[0,0] op_sel_hi:[1,0]
    v_pk_mul_f32 v[10:11], v[24:25], s[84:85] op_sel:[0,1] op_sel_hi:[1,1]
    v_pk_mul_f32 v[12:13], v[24:25], s[86:87] op_sel:[0,0] op_sel_hi:[1,0]
    v_pk_mul_f32 v[14:15], v[24:25], s[86:87] op_sel:[0,1] op_sel_hi:[1,1]
    v_pk_fma_f32 v[8:9], v[26:27], s[88:89], v[8:9] op_sel:[0,0,0] op_sel_hi:[1,0,1]
    v_pk_fma_f32 v[10:11], v[26:27], s[88:89], v[10:11] op_sel:[0,1,0] op_sel_hi:[1,1,1]
    v_pk_fma_f32 v[12:13], v[26:27], s[90:91], v[12:13] op_sel:[0,0,0] op_sel_hi:[1,0,1]
    v_pk_fma_f32 v[14:15], v[26:27], s[90:91], v[14:15] op_sel:[0,1,0] op_sel_hi:[1,1,1]
    v_pk_fma_f32 v[8:9], v[28:29], s[92:93], v[8:9] op_sel:[0,0,0] op_sel_hi:[1,0,1]
    v_pk_fma_f32 v[10:11], v[28:29], s[92:93], v[10:11] op_sel:[0,1,0] op_sel_hi:[1,1,1]
    v_pk_fma_f32 v[12:13], v[28:29], s[94:95], v[12:13] op_sel:[0,0,0] op_sel_hi:[1,0,1]
    v_pk_fma_f32 v[14:15], v[28:29], s[94:95], v[14:15] op_sel:[0,1,0] op_sel_hi:[1,1,1]
    v_pk_fma_f32 v[8:9], v[30:31], s[96:97], v[8:9] op_sel:[0,0,0] op_sel_hi:[1,0,1]
    v_pk_fma_f32 v[10:11], v[30:31], s[96:97], v[10:11] op_sel:[0,1,0] op_sel_hi:[1,1,1]
    v_pk_fma_f32 v[12:13], v[30:31], s[98:99], v[12:13] op_sel:[0,0,0] op_sel_hi:[1,0,1]
    v_pk_fma_f32 v[14:15], v[30:31], s[98:99], v[14:15] op_sel:[0,1,0] op_sel_hi:[1,1,1]
    v_pk_mul_f32 v[8:9], v[8:9], v[72:73]
    v_pk_mul_f32 v[10:11], v[10:11], v[74:75]
    v_pk_mul_f32 v[12:13], v[12:13], v[76:77]
    v_pk_mul_f32 v[14:15], v[14:15], v[78:79]
    v_pk_mul_f32 v[24:25], v[8:9], s[28:29] op_sel:[0,0] op_sel_hi:[1,0]
    v_pk_mul_f32 v[26:27], v[8:9], s[28:29] op_sel:[0,1] op_sel_hi:[1,1]
    v_pk_mul_f32 v[28:29], v[8:9], s[30:31] op_sel:[0,0] op_sel_hi:[1,0]
    v_pk_mul_f32 v[30:31], v[8:9], s[30:31] op_sel:[0,1] op_sel_hi:[1,1]
    v_pk_fma_f32 v[24:25], v[10:11], s[32:33], v[24:25] op_sel:[0,0,0] op_sel_hi:[1,0,1]
    v_pk_fma_f32 v[26:27], v[10:11], s[32:33], v[26:27] op_sel:[0,1,0] op_sel_hi:[1,1,1]
    v_pk_fma_f32 v[28:29], v[10:11], s[34:35], v[28:29] op_sel:[0,0,0] op_sel_hi:[1,0,1]
    v_pk_fma_f32 v[30:31], v[10:11], s[34:35], v[30:31] op_sel:[0,1,0] op_sel_hi:[1,1,1]
    v_pk_fma_f32 v[24:25], v[12:13], s[36:37], v[24:25] op_sel:[0,0,0] op_sel_hi:[1,0,1]
    v_pk_fma_f32 v[26:27], v[12:13], s[36:37], v[26:27] op_sel:[0,1,0] op_sel_hi:[1,1,1]
    v_pk_fma_f32 v[28:29], v[12:13], s[38:39], v[28:29] op_sel:[0,0,0] op_sel_hi:[1,0,1]
    v_pk_fma_f32 v[30:31], v[12:13], s[38:39], v[30:31] op_sel:[0,1,0] op_sel_hi:[1,1,1]
    v_pk_fma_f32 v[24:25], v[14:15], s[40:41], v[24:25] op_sel:[0,0,0] op_sel_hi:[1,0,1]
    v_pk_fma_f32 v[26:27], v[14:15], s[40:41], v[26:27] op_sel:[0,1,0] op_sel_hi:[1,1,1]
    v_pk_fma_f32 v[28:29], v[14:15], s[42:43], v[28:29] op_sel:[0,0,0] op_sel_hi:[1,0,1]
    v_pk_fma_f32 v[30:31], v[14:15], s[42:43], v[30:31] op_sel:[0,1,0] op_sel_hi:[1,1,1]
    v_lshlrev_b32 v8, 16, v64
    v_and_b32 v10, 0xffff0000, v64
    v_lshlrev_b32 v12, 16, v65
    v_and_b32 v14, 0xffff0000, v65
    v_lshlrev_b32 v9, 16, v66
    v_and_b32 v11, 0xffff0000, v66
    v_lshlrev_b32 v13, 16, v67
    v_and_b32 v15, 0xffff0000, v67
    v_pk_fma_f32 v[8:9], v[24:25], v[80:81], v[8:9]
    v_pk_fma_f32 v[10:11], v[26:27], v[82:83], v[10:11]
    v_pk_fma_f32 v[12:13], v[28:29], v[84:85], v[12:13]
    v_pk_fma_f32 v[14:15], v[30:31], v[86:87], v[14:15]
    v_cvt_pk_bf16_f32 v16, v8, v10
    v_cvt_pk_bf16_f32 v17, v12, v14
    v_cvt_pk_bf16_f32 v18, v9, v11
    v_cvt_pk_bf16_f32 v19, v13, v15
    buffer_store_dwordx4 v[16:19], v1, s[16:19], s26 offen
    s_cmp_ge_u32 s13, 4
    s_cbranch_scc1 L_p2_f1
    s_bfe_u32 s14, s20, 262164
    s_cbranch_scc0 L_p2_kernel_nof32a_20
    s_add_u32 s14, s12, 0
    s_and_b32 s14, s14, 3
    s_add_u32 s14, s14, 20
    s_bitcmp1_b32 s20, s14
    s_cbranch_scc0 L_p2_kernel_q_21
    v_mov_b32 v88, 1073758208
    v_mov_b32 v89, 1073758208
    v_mov_b32 v90, 1073758208
    v_mov_b32 v91, 1073758208
L_p2_kernel_q_21:
    s_add_u32 s14, s12, 1
    s_and_b32 s14, s14, 3
    s_add_u32 s14, s14, 20
    s_bitcmp1_b32 s20, s14
    s_cbranch_scc0 L_p2_kernel_q_22
    v_mov_b32 v92, 1073758208
    v_mov_b32 v93, 1073758208
    v_mov_b32 v94, 1073758208
    v_mov_b32 v95, 1073758208
L_p2_kernel_q_22:
    s_add_u32 s14, s12, 2
    s_and_b32 s14, s14, 3
    s_add_u32 s14, s14, 20
    s_bitcmp1_b32 s20, s14
    s_cbranch_scc0 L_p2_kernel_q_23
    v_mov_b32 v96, 1073758208
    v_mov_b32 v97, 1073758208
    v_mov_b32 v98, 1073758208
    v_mov_b32 v99, 1073758208
L_p2_kernel_q_23:
    s_add_u32 s14, s12, 3
    s_and_b32 s14, s14, 3
    s_add_u32 s14, s14, 20
    s_bitcmp1_b32 s20, s14
    s_cbranch_scc0 L_p2_kernel_q_24
    v_mov_b32 v100, 1073758208
    v_mov_b32 v101, 1073758208
    v_mov_b32 v102, 1073758208
    v_mov_b32 v103, 1073758208
L_p2_kernel_q_24:
L_p2_kernel_nof32a_20:
    v_pk_add_u16 v88, v88, v92
    v_pk_add_u16 v96, v96, v100
    v_pk_add_u16 v89, v89, v93
    v_pk_add_u16 v97, v97, v101
    v_pk_add_u16 v90, v90, v94
    v_pk_add_u16 v98, v98, v102
    v_pk_add_u16 v91, v91, v95
    v_pk_add_u16 v99, v99, v103
    v_add_u32_sdwa v24, v88, v96 dst_sel:DWORD dst_unused:UNUSED_PAD src0_sel:WORD_0 src1_sel:WORD_0
    v_add_u32_sdwa v25, v90, v98 dst_sel:DWORD dst_unused:UNUSED_PAD src0_sel:WORD_0 src1_sel:WORD_0
    v_add_u32_sdwa v26, v88, v96 dst_sel:DWORD dst_unused:UNUSED_PAD src0_sel:WORD_1 src1_sel:WORD_1
    v_add_u32_sdwa v27, v90, v98 dst_sel:DWORD dst_unused:UNUSED_PAD src0_sel:WORD_1 src1_sel:WORD_1
    v_add_u32_sdwa v28, v89, v97 dst_sel:DWORD dst_unused:UNUSED_PAD src0_sel:WORD_0 src1_sel:WORD_0
    v_add_u32_sdwa v29, v91, v99 dst_sel:DWORD dst_unused:UNUSED_PAD src0_sel:WORD_0 src1_sel:WORD_0
    v_add_u32_sdwa v30, v89, v97 dst_sel:DWORD dst_unused:UNUSED_PAD src0_sel:WORD_1 src1_sel:WORD_1
    v_add_u32_sdwa v31, v91, v99 dst_sel:DWORD dst_unused:UNUSED_PAD src0_sel:WORD_1 src1_sel:WORD_1
    v_cvt_f32_u32 v24, v24
    v_cvt_f32_u32 v25, v25
    v_cvt_f32_u32 v26, v26
    v_cvt_f32_u32 v27, v27
    v_cvt_f32_u32 v28, v28
    v_cvt_f32_u32 v29, v29
    v_cvt_f32_u32 v30, v30
    v_cvt_f32_u32 v31, v31
    v_pk_fma_f32 v[24:25], v[24:25], s[44:45], s[44:45] op_sel:[0,0,1] op_sel_hi:[1,0,1]
    v_pk_fma_f32 v[26:27], v[26:27], s[44:45], s[44:45] op_sel:[0,0,1] op_sel_hi:[1,0,1]
    v_pk_fma_f32 v[28:29], v[28:29], s[44:45], s[44:45] op_sel:[0,0,1] op_sel_hi:[1,0,1]
    v_pk_fma_f32 v[30:31], v[30:31], s[44:45], s[44:45] op_sel:[0,0,1] op_sel_hi:[1,0,1]
    s_bfe_u32 s14, s20, 262164
    s_cbranch_scc0 L_p2_kernel_nof32b_25
    v_lshlrev_b32 v32, 1, v2
    s_bitcmp1_b32 s20, 20
    s_cbranch_scc0 L_p2_kernel_q_26
    s_lshl_b32 s15, s26, 1
    s_add_u32 s15, s15, 249069568
    buffer_load_dwordx4 v[88:91], v32, s[4:7], s15 offen sc1
    buffer_load_dwordx4 v[92:95], v32, s[4:7], s15 offen offset:16 sc1
    s_waitcnt vmcnt(0)
    v_add_f32 v24, v24, v88
    v_add_f32 v25, v25, v92
    v_add_f32 v26, v26, v89
    v_add_f32 v27, v27, v93
    v_add_f32 v28, v28, v90
    v_add_f32 v29, v29, v94
    v_add_f32 v30, v30, v91
    v_add_f32 v31, v31, v95
L_p2_kernel_q_26:
    s_bitcmp1_b32 s20, 21
    s_cbranch_scc0 L_p2_kernel_q_27
    s_lshl_b32 s15, s26, 1
    s_add_u32 s15, s15, 259309568
    buffer_load_dwordx4 v[88:91], v32, s[4:7], s15 offen sc1
    buffer_load_dwordx4 v[92:95], v32, s[4:7], s15 offen offset:16 sc1
    s_waitcnt vmcnt(0)
    v_add_f32 v24, v24, v88
    v_add_f32 v25, v25, v92
    v_add_f32 v26, v26, v89
    v_add_f32 v27, v27, v93
    v_add_f32 v28, v28, v90
    v_add_f32 v29, v29, v94
    v_add_f32 v30, v30, v91
    v_add_f32 v31, v31, v95
L_p2_kernel_q_27:
    s_bitcmp1_b32 s20, 22
    s_cbranch_scc0 L_p2_kernel_q_28
    s_lshl_b32 s15, s26, 1
    s_add_u32 s15, s15, 269549568
    buffer_load_dwordx4 v[88:91], v32, s[4:7], s15 offen sc1
    buffer_load_dwordx4 v[92:95], v32, s[4:7], s15 offen offset:16 sc1
    s_waitcnt vmcnt(0)
    v_add_f32 v24, v24, v88
    v_add_f32 v25, v25, v92
    v_add_f32 v26, v26, v89
    v_add_f32 v27, v27, v93
    v_add_f32 v28, v28, v90
    v_add_f32 v29, v29, v94
    v_add_f32 v30, v30, v91
    v_add_f32 v31, v31, v95
L_p2_kernel_q_28:
    s_bitcmp1_b32 s20, 23
    s_cbranch_scc0 L_p2_kernel_q_29
    s_lshl_b32 s15, s26, 1
    s_add_u32 s15, s15, 279789568
    buffer_load_dwordx4 v[88:91], v32, s[4:7], s15 offen sc1
    buffer_load_dwordx4 v[92:95], v32, s[4:7], s15 offen offset:16 sc1
    s_waitcnt vmcnt(0)
    v_add_f32 v24, v24, v88
    v_add_f32 v25, v25, v92
    v_add_f32 v26, v26, v89
    v_add_f32 v27, v27, v93
    v_add_f32 v28, v28, v90
    v_add_f32 v29, v29, v94
    v_add_f32 v30, v30, v91
    v_add_f32 v31, v31, v95
L_p2_kernel_q_29:
L_p2_kernel_nof32b_25:
    v_pk_mul_f32 v[88:89], v[24:25], s[84:85] op_sel:[0,0] op_sel_hi:[1,0]
    v_pk_mul_f32 v[90:91], v[24:25], s[84:85] op_sel:[0,1] op_sel_hi:[1,1]
    v_pk_mul_f32 v[92:93], v[24:25], s[86:87] op_sel:[0,0] op_sel_hi:[1,0]
    v_pk_mul_f32 v[94:95], v[24:25], s[86:87] op_sel:[0,1] op_sel_hi:[1,1]
    v_pk_fma_f32 v[88:89], v[26:27], s[88:89], v[88:89] op_sel:[0,0,0] op_sel_hi:[1,0,1]
    v_pk_fma_f32 v[90:91], v[26:27], s[88:89], v[90:91] op_sel:[0,1,0] op_sel_hi:[1,1,1]
    v_pk_fma_f32 v[92:93], v[26:27], s[90:91], v[92:93] op_sel:[0,0,0] op_sel_hi:[1,0,1]
    v_pk_fma_f32 v[94:95], v[26:27], s[90:91], v[94:95] op_sel:[0,1,0] op_sel_hi:[1,1,1]
    v_pk_fma_f32 v[88:89], v[28:29], s[92:93], v[88:89] op_sel:[0,0,0] op_sel_hi:[1,0,1]
    v_pk_fma_f32 v[90:91], v[28:29], s[92:93], v[90:91] op_sel:[0,1,0] op_sel_hi:[1,1,1]
    v_pk_fma_f32 v[92:93], v[28:29], s[94:95], v[92:93] op_sel:[0,0,0] op_sel_hi:[1,0,1]
    v_pk_fma_f32 v[94:95], v[28:29], s[94:95], v[94:95] op_sel:[0,1,0] op_sel_hi:[1,1,1]
    v_pk_fma_f32 v[88:89], v[30:31], s[96:97], v[88:89] op_sel:[0,0,0] op_sel_hi:[1,0,1]
    v_pk_fma_f32 v[90:91], v[30:31], s[96:97], v[90:91] op_sel:[0,1,0] op_sel_hi:[1,1,1]
    v_pk_fma_f32 v[92:93], v[30:31], s[98:99], v[92:93] op_sel:[0,0,0] op_sel_hi:[1,0,1]
    v_pk_fma_f32 v[94:95], v[30:31], s[98:99], v[94:95] op_sel:[0,1,0] op_sel_hi:[1,1,1]
    v_pk_mul_f32 v[88:89], v[88:89], v[112:113]
    v_pk_mul_f32 v[90:91], v[90:91], v[114:115]
    v_pk_mul_f32 v[92:93], v[92:93], v[116:117]
    v_pk_mul_f32 v[94:95], v[94:95], v[118:119]
    v_pk_mul_f32 v[24:25], v[88:89], s[28:29] op_sel:[0,0] op_sel_hi:[1,0]
    v_pk_mul_f32 v[26:27], v[88:89], s[28:29] op_sel:[0,1] op_sel_hi:[1,1]
    v_pk_mul_f32 v[28:29], v[88:89], s[30:31] op_sel:[0,0] op_sel_hi:[1,0]
    v_pk_mul_f32 v[30:31], v[88:89], s[30:31] op_sel:[0,1] op_sel_hi:[1,1]
    v_pk_fma_f32 v[24:25], v[90:91], s[32:33], v[24:25] op_sel:[0,0,0] op_sel_hi:[1,0,1]
    v_pk_fma_f32 v[26:27], v[90:91], s[32:33], v[26:27] op_sel:[0,1,0] op_sel_hi:[1,1,1]
    v_pk_fma_f32 v[28:29], v[90:91], s[34:35], v[28:29] op_sel:[0,0,0] op_sel_hi:[1,0,1]
    v_pk_fma_f32 v[30:31], v[90:91], s[34:35], v[30:31] op_sel:[0,1,0] op_sel_hi:[1,1,1]
    v_pk_fma_f32 v[24:25], v[92:93], s[36:37], v[24:25] op_sel:[0,0,0] op_sel_hi:[1,0,1]
    v_pk_fma_f32 v[26:27], v[92:93], s[36:37], v[26:27] op_sel:[0,1,0] op_sel_hi:[1,1,1]
    v_pk_fma_f32 v[28:29], v[92:93], s[38:39], v[28:29] op_sel:[0,0,0] op_sel_hi:[1,0,1]
    v_pk_fma_f32 v[30:31], v[92:93], s[38:39], v[30:31] op_sel:[0,1,0] op_sel_hi:[1,1,1]
    v_pk_fma_f32 v[24:25], v[94:95], s[40:41], v[24:25] op_sel:[0,0,0] op_sel_hi:[1,0,1]
    v_pk_fma_f32 v[26:27], v[94:95], s[40:41], v[26:27] op_sel:[0,1,0] op_sel_hi:[1,1,1]
    v_pk_fma_f32 v[28:29], v[94:95], s[42:43], v[28:29] op_sel:[0,0,0] op_sel_hi:[1,0,1]
    v_pk_fma_f32 v[30:31], v[94:95], s[42:43], v[30:31] op_sel:[0,1,0] op_sel_hi:[1,1,1]
    v_lshlrev_b32 v88, 16, v68
    v_and_b32 v90, 0xffff0000, v68
    v_lshlrev_b32 v92, 16, v69
    v_and_b32 v94, 0xffff0000, v69
    v_lshlrev_b32 v89, 16, v70
    v_and_b32 v91, 0xffff0000, v70
    v_lshlrev_b32 v93, 16, v71
    v_and_b32 v95, 0xffff0000, v71
    v_pk_fma_f32 v[88:89], v[24:25], v[120:121], v[88:89]
    v_pk_fma_f32 v[90:91], v[26:27], v[122:123], v[90:91]
    v_pk_fma_f32 v[92:93], v[28:29], v[124:125], v[92:93]
    v_pk_fma_f32 v[94:95], v[30:31], v[126:127], v[94:95]
    v_cvt_pk_bf16_f32 v96, v88, v90
    v_cvt_pk_bf16_f32 v97, v92, v94
    v_cvt_pk_bf16_f32 v98, v89, v91
    v_cvt_pk_bf16_f32 v99, v93, v95
    buffer_store_dwordx4 v[96:99], v2, s[16:19], s26 offen
L_p2_f1:
    s_bitset0_b32 s51, s49
    s_cmp_eq_u32 s51, 0
    s_cbranch_scc1 L_p2_done
    s_ff1_i32_b32 s49, s51
    s_lshl2_add_u32 s14, s3, s49
    s_mul_i32 s14, s14, 5000
    s_add_u32 s15, s14, 4096
    v_min_u32 v61, 225, v0
    v_lshl_add_u32 v60, v0, 2, s14
    v_lshl_add_u32 v61, v61, 2, s15
    global_load_dword v60, v60, s[100:101] nt
    global_load_dword v61, v61, s[100:101] nt
    s_waitcnt vmcnt(0)
    v_lshlrev_b32 v30, 16, v60
    v_and_b32 v31, 0xffff0000, v60
    v_lshlrev_b32 v36, 16, v53
    v_and_b32 v37, 0xffff0000, v53
    v_lshlrev_b32 v38, 16, v54
    v_and_b32 v39, 0xffff0000, v54
    v_lshlrev_b32 v40, 16, v56
    v_and_b32 v41, 0xffff0000, v56
    v_lshlrev_b32 v42, 16, v57
    v_and_b32 v43, 0xffff0000, v57
    v_pk_add_f32 v[14:15], v[30:31], v[36:37] op_sel:[0,0] op_sel_hi:[1,0] neg_lo:[0,1] neg_hi:[0,1]
    v_pk_add_f32 v[16:17], v[30:31], v[36:37] op_sel:[0,1] op_sel_hi:[1,1] neg_lo:[0,1] neg_hi:[0,1]
    v_pk_add_f32 v[18:19], v[30:31], v[38:39] op_sel:[0,0] op_sel_hi:[1,0] neg_lo:[0,1] neg_hi:[0,1]
    v_pk_add_f32 v[20:21], v[30:31], v[38:39] op_sel:[0,1] op_sel_hi:[1,1] neg_lo:[0,1] neg_hi:[0,1]
    v_pk_add_f32 v[22:23], v[30:31], v[40:41] op_sel:[0,0] op_sel_hi:[1,0] neg_lo:[0,1] neg_hi:[0,1]
    v_pk_add_f32 v[24:25], v[30:31], v[40:41] op_sel:[0,1] op_sel_hi:[1,1] neg_lo:[0,1] neg_hi:[0,1]
    v_pk_add_f32 v[26:27], v[30:31], v[42:43] op_sel:[0,0] op_sel_hi:[1,0] neg_lo:[0,1] neg_hi:[0,1]
    v_pk_add_f32 v[28:29], v[30:31], v[42:43] op_sel:[0,1] op_sel_hi:[1,1] neg_lo:[0,1] neg_hi:[0,1]
    v_cvt_pk_bf16_f32 v32, v14, v15
    v_lshlrev_b32 v14, 16, v32
    v_and_b32 v15, 0xffff0000, v32
    v_cvt_pk_bf16_f32 v32, v16, v17
    v_lshlrev_b32 v16, 16, v32
    v_and_b32 v17, 0xffff0000, v32
    v_cvt_pk_bf16_f32 v32, v18, v19
    v_lshlrev_b32 v18, 16, v32
    v_and_b32 v19, 0xffff0000, v32
    v_cvt_pk_bf16_f32 v32, v20, v21
    v_lshlrev_b32 v20, 16, v32
    v_and_b32 v21, 0xffff0000, v32
    v_cvt_pk_bf16_f32 v32, v22, v23
    v_lshlrev_b32 v22, 16, v32
    v_and_b32 v23, 0xffff0000, v32
    v_cvt_pk_bf16_f32 v32, v24, v25
    v_lshlrev_b32 v24, 16, v32
    v_and_b32 v25, 0xffff0000, v32
    v_cvt_pk_bf16_f32 v32, v26, v27
    v_lshlrev_b32 v26, 16, v32
    v_and_b32 v27, 0xffff0000, v32
    v_cvt_pk_bf16_f32 v32, v28, v29
    v_lshlrev_b32 v28, 16, v32
    v_and_b32 v29, 0xffff0000, v32
    v_pk_mul_f32 v[14:15], v[14:15], v[14:15]
    v_pk_mul_f32 v[16:17], v[16:17], v[16:17]
    v_pk_mul_f32 v[18:19], v[18:19], v[18:19]
    v_pk_mul_f32 v[20:21], v[20:21], v[20:21]
    v_pk_mul_f32 v[22:23], v[22:23], v[22:23]
    v_pk_mul_f32 v[24:25], v[24:25], v[24:25]
    v_pk_mul_f32 v[26:27], v[26:27], v[26:27]
    v_pk_mul_f32 v[28:29], v[28:29], v[28:29]
    v_cvt_pk_bf16_f32 v32, v14, v15
    v_lshlrev_b32 v14, 16, v32
    v_and_b32 v15, 0xffff0000, v32
    v_cvt_pk_bf16_f32 v32, v16, v17
    v_lshlrev_b32 v16, 16, v32
    v_and_b32 v17, 0xffff0000, v32
    v_cvt_pk_bf16_f32 v32, v18, v19
    v_lshlrev_b32 v18, 16, v32
    v_and_b32 v19, 0xffff0000, v32
    v_cvt_pk_bf16_f32 v32, v20, v21
    v_lshlrev_b32 v20, 16, v32
    v_and_b32 v21, 0xffff0000, v32
    v_cvt_pk_bf16_f32 v32, v22, v23
    v_lshlrev_b32 v22, 16, v32
    v_and_b32 v23, 0xffff0000, v32
    v_cvt_pk_bf16_f32 v32, v24, v25
    v_lshlrev_b32 v24, 16, v32
    v_and_b32 v25, 0xffff0000, v32
    v_cvt_pk_bf16_f32 v32, v26, v27
    v_lshlrev_b32 v26, 16, v32
    v_and_b32 v27, 0xffff0000, v32
    v_cvt_pk_bf16_f32 v32, v28, v29
    v_lshlrev_b32 v28, 16, v32
    v_and_b32 v29, 0xffff0000, v32
    v_mov_b32 v30, 1092616192
    v_mov_b32 v31, 0x3fb8aa3b
    v_pk_mul_f32 v[14:15], v[14:15], v[30:31] op_sel:[0,0] op_sel_hi:[1,0]
    v_pk_mul_f32 v[16:17], v[16:17], v[30:31] op_sel:[0,0] op_sel_hi:[1,0]
    v_pk_mul_f32 v[18:19], v[18:19], v[30:31] op_sel:[0,0] op_sel_hi:[1,0]
    v_pk_mul_f32 v[20:21], v[20:21], v[30:31] op_sel:[0,0] op_sel_hi:[1,0]
    v_pk_mul_f32 v[22:23], v[22:23], v[30:31] op_sel:[0,0] op_sel_hi:[1,0]
    v_pk_mul_f32 v[24:25], v[24:25], v[30:31] op_sel:[0,0] op_sel_hi:[1,0]
    v_pk_mul_f32 v[26:27], v[26:27], v[30:31] op_sel:[0,0] op_sel_hi:[1,0]
    v_pk_mul_f32 v[28:29], v[28:29], v[30:31] op_sel:[0,0] op_sel_hi:[1,0]
    v_cvt_pk_bf16_f32 v32, v14, v15
    v_lshlrev_b32 v14, 16, v32
    v_and_b32 v15, 0xffff0000, v32
    v_cvt_pk_bf16_f32 v32, v16, v17
    v_lshlrev_b32 v16, 16, v32
    v_and_b32 v17, 0xffff0000, v32
    v_cvt_pk_bf16_f32 v32, v18, v19
    v_lshlrev_b32 v18, 16, v32
    v_and_b32 v19, 0xffff0000, v32
    v_cvt_pk_bf16_f32 v32, v20, v21
    v_lshlrev_b32 v20, 16, v32
    v_and_b32 v21, 0xffff0000, v32
    v_cvt_pk_bf16_f32 v32, v22, v23
    v_lshlrev_b32 v22, 16, v32
    v_and_b32 v23, 0xffff0000, v32
    v_cvt_pk_bf16_f32 v32, v24, v25
    v_lshlrev_b32 v24, 16, v32
    v_and_b32 v25, 0xffff0000, v32
    v_cvt_pk_bf16_f32 v32, v26, v27
    v_lshlrev_b32 v26, 16, v32
    v_and_b32 v27, 0xffff0000, v32
    v_cvt_pk_bf16_f32 v32, v28, v29
    v_lshlrev_b32 v28, 16, v32
    v_and_b32 v29, 0xffff0000, v32
    v_pk_mul_f32 v[14:15], v[14:15], v[30:31] op_sel:[0,1] op_sel_hi:[1,1]
    v_pk_mul_f32 v[16:17], v[16:17], v[30:31] op_sel:[0,1] op_sel_hi:[1,1]
    v_pk_mul_f32 v[18:19], v[18:19], v[30:31] op_sel:[0,1] op_sel_hi:[1,1]
    v_pk_mul_f32 v[20:21], v[20:21], v[30:31] op_sel:[0,1] op_sel_hi:[1,1]
    v_pk_mul_f32 v[22:23], v[22:23], v[30:31] op_sel:[0,1] op_sel_hi:[1,1]
    v_pk_mul_f32 v[24:25], v[24:25], v[30:31] op_sel:[0,1] op_sel_hi:[1,1]
    v_pk_mul_f32 v[26:27], v[26:27], v[30:31] op_sel:[0,1] op_sel_hi:[1,1]
    v_pk_mul_f32 v[28:29], v[28:29], v[30:31] op_sel:[0,1] op_sel_hi:[1,1]
    v_exp_f32 v14, -v14
    v_exp_f32 v15, -v15
    v_exp_f32 v16, -v16
    v_exp_f32 v17, -v17
    v_exp_f32 v18, -v18
    v_exp_f32 v19, -v19
    v_exp_f32 v20, -v20
    v_exp_f32 v21, -v21
    v_exp_f32 v22, -v22
    v_exp_f32 v23, -v23
    v_exp_f32 v24, -v24
    v_exp_f32 v25, -v25
    v_exp_f32 v26, -v26
    v_exp_f32 v27, -v27
    v_exp_f32 v28, -v28
    v_exp_f32 v29, -v29
    v_cvt_pk_bf16_f32 v14, v14, v16
    v_cvt_pk_bf16_f32 v15, v15, v17
    v_cvt_pk_bf16_f32 v18, v18, v20
    v_cvt_pk_bf16_f32 v19, v19, v21
    v_cvt_pk_bf16_f32 v22, v22, v24
    v_cvt_pk_bf16_f32 v23, v23, v25
    v_cvt_pk_bf16_f32 v26, v26, v28
    v_cvt_pk_bf16_f32 v27, v27, v29
    v_dot2_f32_bf16 v72, v14, s68, 0
    v_dot2_f32_bf16 v73, v15, s68, 0
    v_dot2_f32_bf16 v74, v14, s69, 0
    v_dot2_f32_bf16 v75, v15, s69, 0
    v_dot2_f32_bf16 v76, v14, s70, 0
    v_dot2_f32_bf16 v77, v15, s70, 0
    v_dot2_f32_bf16 v78, v14, s71, 0
    v_dot2_f32_bf16 v79, v15, s71, 0
    v_dot2_f32_bf16 v80, v14, s52, 0
    v_dot2_f32_bf16 v81, v15, s52, 0
    v_dot2_f32_bf16 v82, v14, s53, 0
    v_dot2_f32_bf16 v83, v15, s53, 0
    v_dot2_f32_bf16 v84, v14, s54, 0
    v_dot2_f32_bf16 v85, v15, s54, 0
    v_dot2_f32_bf16 v86, v14, s55, 0
    v_dot2_f32_bf16 v87, v15, s55, 0
    v_dot2_f32_bf16 v72, v18, s72, v72
    v_dot2_f32_bf16 v73, v19, s72, v73
    v_dot2_f32_bf16 v74, v18, s73, v74
    v_dot2_f32_bf16 v75, v19, s73, v75
    v_dot2_f32_bf16 v76, v18, s74, v76
    v_dot2_f32_bf16 v77, v19, s74, v77
    v_dot2_f32_bf16 v78, v18, s75, v78
    v_dot2_f32_bf16 v79, v19, s75, v79
    v_dot2_f32_bf16 v80, v18, s56, v80
    v_dot2_f32_bf16 v81, v19, s56, v81
    v_dot2_f32_bf16 v82, v18, s57, v82
    v_dot2_f32_bf16 v83, v19, s57, v83
    v_dot2_f32_bf16 v84, v18, s58, v84
    v_dot2_f32_bf16 v85, v19, s58, v85
    v_dot2_f32_bf16 v86, v18, s59, v86
    v_dot2_f32_bf16 v87, v19, s59, v87
    v_dot2_f32_bf16 v72, v22, s76, v72
    v_dot2_f32_bf16 v73, v23, s76, v73
    v_dot2_f32_bf16 v74, v22, s77, v74
    v_dot2_f32_bf16 v75, v23, s77, v75
    v_dot2_f32_bf16 v76, v22, s78, v76
    v_dot2_f32_bf16 v77, v23, s78, v77
    v_dot2_f32_bf16 v78, v22, s79, v78
    v_dot2_f32_bf16 v79, v23, s79, v79
    v_dot2_f32_bf16 v80, v22, s60, v80
    v_dot2_f32_bf16 v81, v23, s60, v81
    v_dot2_f32_bf16 v82, v22, s61, v82
    v_dot2_f32_bf16 v83, v23, s61, v83
    v_dot2_f32_bf16 v84, v22, s62, v84
    v_dot2_f32_bf16 v85, v23, s62, v85
    v_dot2_f32_bf16 v86, v22, s63, v86
    v_dot2_f32_bf16 v87, v23, s63, v87
    v_dot2_f32_bf16 v72, v26, s80, v72
    v_dot2_f32_bf16 v73, v27, s80, v73
    v_dot2_f32_bf16 v74, v26, s81, v74
    v_dot2_f32_bf16 v75, v27, s81, v75
    v_dot2_f32_bf16 v76, v26, s82, v76
    v_dot2_f32_bf16 v77, v27, s82, v77
    v_dot2_f32_bf16 v78, v26, s83, v78
    v_dot2_f32_bf16 v79, v27, s83, v79
    v_dot2_f32_bf16 v80, v26, s64, v80
    v_dot2_f32_bf16 v81, v27, s64, v81
    v_dot2_f32_bf16 v82, v26, s65, v82
    v_dot2_f32_bf16 v83, v27, s65, v83
    v_dot2_f32_bf16 v84, v26, s66, v84
    v_dot2_f32_bf16 v85, v27, s66, v85
    v_dot2_f32_bf16 v86, v26, s67, v86
    v_dot2_f32_bf16 v87, v27, s67, v87
    s_cmp_ge_u32 s13, 4
    s_cbranch_scc1 L_p2_kernel_g1_30
    v_lshlrev_b32 v30, 16, v61
    v_and_b32 v31, 0xffff0000, v61
    v_pk_add_f32 v[14:15], v[30:31], v[36:37] op_sel:[0,0] op_sel_hi:[1,0] neg_lo:[0,1] neg_hi:[0,1]
    v_pk_add_f32 v[16:17], v[30:31], v[36:37] op_sel:[0,1] op_sel_hi:[1,1] neg_lo:[0,1] neg_hi:[0,1]
    v_pk_add_f32 v[18:19], v[30:31], v[38:39] op_sel:[0,0] op_sel_hi:[1,0] neg_lo:[0,1] neg_hi:[0,1]
    v_pk_add_f32 v[20:21], v[30:31], v[38:39] op_sel:[0,1] op_sel_hi:[1,1] neg_lo:[0,1] neg_hi:[0,1]
    v_pk_add_f32 v[22:23], v[30:31], v[40:41] op_sel:[0,0] op_sel_hi:[1,0] neg_lo:[0,1] neg_hi:[0,1]
    v_pk_add_f32 v[24:25], v[30:31], v[40:41] op_sel:[0,1] op_sel_hi:[1,1] neg_lo:[0,1] neg_hi:[0,1]
    v_pk_add_f32 v[26:27], v[30:31], v[42:43] op_sel:[0,0] op_sel_hi:[1,0] neg_lo:[0,1] neg_hi:[0,1]
    v_pk_add_f32 v[28:29], v[30:31], v[42:43] op_sel:[0,1] op_sel_hi:[1,1] neg_lo:[0,1] neg_hi:[0,1]
    v_cvt_pk_bf16_f32 v32, v14, v15
    v_lshlrev_b32 v14, 16, v32
    v_and_b32 v15, 0xffff0000, v32
    v_cvt_pk_bf16_f32 v32, v16, v17
    v_lshlrev_b32 v16, 16, v32
    v_and_b32 v17, 0xffff0000, v32
    v_cvt_pk_bf16_f32 v32, v18, v19
    v_lshlrev_b32 v18, 16, v32
    v_and_b32 v19, 0xffff0000, v32
    v_cvt_pk_bf16_f32 v32, v20, v21
    v_lshlrev_b32 v20, 16, v32
    v_and_b32 v21, 0xffff0000, v32
    v_cvt_pk_bf16_f32 v32, v22, v23
    v_lshlrev_b32 v22, 16, v32
    v_and_b32 v23, 0xffff0000, v32
    v_cvt_pk_bf16_f32 v32, v24, v25
    v_lshlrev_b32 v24, 16, v32
    v_and_b32 v25, 0xffff0000, v32
    v_cvt_pk_bf16_f32 v32, v26, v27
    v_lshlrev_b32 v26, 16, v32
    v_and_b32 v27, 0xffff0000, v32
    v_cvt_pk_bf16_f32 v32, v28, v29
    v_lshlrev_b32 v28, 16, v32
    v_and_b32 v29, 0xffff0000, v32
    v_pk_mul_f32 v[14:15], v[14:15], v[14:15]
    v_pk_mul_f32 v[16:17], v[16:17], v[16:17]
    v_pk_mul_f32 v[18:19], v[18:19], v[18:19]
    v_pk_mul_f32 v[20:21], v[20:21], v[20:21]
    v_pk_mul_f32 v[22:23], v[22:23], v[22:23]
    v_pk_mul_f32 v[24:25], v[24:25], v[24:25]
    v_pk_mul_f32 v[26:27], v[26:27], v[26:27]
    v_pk_mul_f32 v[28:29], v[28:29], v[28:29]
    v_cvt_pk_bf16_f32 v32, v14, v15
    v_lshlrev_b32 v14, 16, v32
    v_and_b32 v15, 0xffff0000, v32
    v_cvt_pk_bf16_f32 v32, v16, v17
    v_lshlrev_b32 v16, 16, v32
    v_and_b32 v17, 0xffff0000, v32
    v_cvt_pk_bf16_f32 v32, v18, v19
    v_lshlrev_b32 v18, 16, v32
    v_and_b32 v19, 0xffff0000, v32
    v_cvt_pk_bf16_f32 v32, v20, v21
    v_lshlrev_b32 v20, 16, v32
    v_and_b32 v21, 0xffff0000, v32
    v_cvt_pk_bf16_f32 v32, v22, v23
    v_lshlrev_b32 v22, 16, v32
    v_and_b32 v23, 0xffff0000, v32
    v_cvt_pk_bf16_f32 v32, v24, v25
    v_lshlrev_b32 v24, 16, v32
    v_and_b32 v25, 0xffff0000, v32
    v_cvt_pk_bf16_f32 v32, v26, v27
    v_lshlrev_b32 v26, 16, v32
    v_and_b32 v27, 0xffff0000, v32
    v_cvt_pk_bf16_f32 v32, v28, v29
    v_lshlrev_b32 v28, 16, v32
    v_and_b32 v29, 0xffff0000, v32
    v_mov_b32 v30, 1092616192
    v_mov_b32 v31, 0x3fb8aa3b
    v_pk_mul_f32 v[14:15], v[14:15], v[30:31] op_sel:[0,0] op_sel_hi:[1,0]
    v_pk_mul_f32 v[16:17], v[16:17], v[30:31] op_sel:[0,0] op_sel_hi:[1,0]
    v_pk_mul_f32 v[18:19], v[18:19], v[30:31] op_sel:[0,0] op_sel_hi:[1,0]
    v_pk_mul_f32 v[20:21], v[20:21], v[30:31] op_sel:[0,0] op_sel_hi:[1,0]
    v_pk_mul_f32 v[22:23], v[22:23], v[30:31] op_sel:[0,0] op_sel_hi:[1,0]
    v_pk_mul_f32 v[24:25], v[24:25], v[30:31] op_sel:[0,0] op_sel_hi:[1,0]
    v_pk_mul_f32 v[26:27], v[26:27], v[30:31] op_sel:[0,0] op_sel_hi:[1,0]
    v_pk_mul_f32 v[28:29], v[28:29], v[30:31] op_sel:[0,0] op_sel_hi:[1,0]
    v_cvt_pk_bf16_f32 v32, v14, v15
    v_lshlrev_b32 v14, 16, v32
    v_and_b32 v15, 0xffff0000, v32
    v_cvt_pk_bf16_f32 v32, v16, v17
    v_lshlrev_b32 v16, 16, v32
    v_and_b32 v17, 0xffff0000, v32
    v_cvt_pk_bf16_f32 v32, v18, v19
    v_lshlrev_b32 v18, 16, v32
    v_and_b32 v19, 0xffff0000, v32
    v_cvt_pk_bf16_f32 v32, v20, v21
    v_lshlrev_b32 v20, 16, v32
    v_and_b32 v21, 0xffff0000, v32
    v_cvt_pk_bf16_f32 v32, v22, v23
    v_lshlrev_b32 v22, 16, v32
    v_and_b32 v23, 0xffff0000, v32
    v_cvt_pk_bf16_f32 v32, v24, v25
    v_lshlrev_b32 v24, 16, v32
    v_and_b32 v25, 0xffff0000, v32
    v_cvt_pk_bf16_f32 v32, v26, v27
    v_lshlrev_b32 v26, 16, v32
    v_and_b32 v27, 0xffff0000, v32
    v_cvt_pk_bf16_f32 v32, v28, v29
    v_lshlrev_b32 v28, 16, v32
    v_and_b32 v29, 0xffff0000, v32
    v_pk_mul_f32 v[14:15], v[14:15], v[30:31] op_sel:[0,1] op_sel_hi:[1,1]
    v_pk_mul_f32 v[16:17], v[16:17], v[30:31] op_sel:[0,1] op_sel_hi:[1,1]
    v_pk_mul_f32 v[18:19], v[18:19], v[30:31] op_sel:[0,1] op_sel_hi:[1,1]
    v_pk_mul_f32 v[20:21], v[20:21], v[30:31] op_sel:[0,1] op_sel_hi:[1,1]
    v_pk_mul_f32 v[22:23], v[22:23], v[30:31] op_sel:[0,1] op_sel_hi:[1,1]
    v_pk_mul_f32 v[24:25], v[24:25], v[30:31] op_sel:[0,1] op_sel_hi:[1,1]
    v_pk_mul_f32 v[26:27], v[26:27], v[30:31] op_sel:[0,1] op_sel_hi:[1,1]
    v_pk_mul_f32 v[28:29], v[28:29], v[30:31] op_sel:[0,1] op_sel_hi:[1,1]
    v_exp_f32 v14, -v14
    v_exp_f32 v15, -v15
    v_exp_f32 v16, -v16
    v_exp_f32 v17, -v17
    v_exp_f32 v18, -v18
    v_exp_f32 v19, -v19
    v_exp_f32 v20, -v20
    v_exp_f32 v21, -v21
    v_exp_f32 v22, -v22
    v_exp_f32 v23, -v23
    v_exp_f32 v24, -v24
    v_exp_f32 v25, -v25
    v_exp_f32 v26, -v26
    v_exp_f32 v27, -v27
    v_exp_f32 v28, -v28
    v_exp_f32 v29, -v29
    v_cvt_pk_bf16_f32 v14, v14, v16
    v_cvt_pk_bf16_f32 v15, v15, v17
    v_cvt_pk_bf16_f32 v18, v18, v20
    v_cvt_pk_bf16_f32 v19, v19, v21
    v_cvt_pk_bf16_f32 v22, v22, v24
    v_cvt_pk_bf16_f32 v23, v23, v25
    v_cvt_pk_bf16_f32 v26, v26, v28
    v_cvt_pk_bf16_f32 v27, v27, v29
    v_dot2_f32_bf16 v112, v14, s68, 0
    v_dot2_f32_bf16 v113, v15, s68, 0
    v_dot2_f32_bf16 v114, v14, s69, 0
    v_dot2_f32_bf16 v115, v15, s69, 0
    v_dot2_f32_bf16 v116, v14, s70, 0
    v_dot2_f32_bf16 v117, v15, s70, 0
    v_dot2_f32_bf16 v118, v14, s71, 0
    v_dot2_f32_bf16 v119, v15, s71, 0
    v_dot2_f32_bf16 v120, v14, s52, 0
    v_dot2_f32_bf16 v121, v15, s52, 0
    v_dot2_f32_bf16 v122, v14, s53, 0
    v_dot2_f32_bf16 v123, v15, s53, 0
    v_dot2_f32_bf16 v124, v14, s54, 0
    v_dot2_f32_bf16 v125, v15, s54, 0
    v_dot2_f32_bf16 v126, v14, s55, 0
    v_dot2_f32_bf16 v127, v15, s55, 0
    v_dot2_f32_bf16 v112, v18, s72, v112
    v_dot2_f32_bf16 v113, v19, s72, v113
    v_dot2_f32_bf16 v114, v18, s73, v114
    v_dot2_f32_bf16 v115, v19, s73, v115
    v_dot2_f32_bf16 v116, v18, s74, v116
    v_dot2_f32_bf16 v117, v19, s74, v117
    v_dot2_f32_bf16 v118, v18, s75, v118
    v_dot2_f32_bf16 v119, v19, s75, v119
    v_dot2_f32_bf16 v120, v18, s56, v120
    v_dot2_f32_bf16 v121, v19, s56, v121
    v_dot2_f32_bf16 v122, v18, s57, v122
    v_dot2_f32_bf16 v123, v19, s57, v123
    v_dot2_f32_bf16 v124, v18, s58, v124
    v_dot2_f32_bf16 v125, v19, s58, v125
    v_dot2_f32_bf16 v126, v18, s59, v126
    v_dot2_f32_bf16 v127, v19, s59, v127
    v_dot2_f32_bf16 v112, v22, s76, v112
    v_dot2_f32_bf16 v113, v23, s76, v113
    v_dot2_f32_bf16 v114, v22, s77, v114
    v_dot2_f32_bf16 v115, v23, s77, v115
    v_dot2_f32_bf16 v116, v22, s78, v116
    v_dot2_f32_bf16 v117, v23, s78, v117
    v_dot2_f32_bf16 v118, v22, s79, v118
    v_dot2_f32_bf16 v119, v23, s79, v119
    v_dot2_f32_bf16 v120, v22, s60, v120
    v_dot2_f32_bf16 v121, v23, s60, v121
    v_dot2_f32_bf16 v122, v22, s61, v122
    v_dot2_f32_bf16 v123, v23, s61, v123
    v_dot2_f32_bf16 v124, v22, s62, v124
    v_dot2_f32_bf16 v125, v23, s62, v125
    v_dot2_f32_bf16 v126, v22, s63, v126
    v_dot2_f32_bf16 v127, v23, s63, v127
    v_dot2_f32_bf16 v112, v26, s80, v112
    v_dot2_f32_bf16 v113, v27, s80, v113
    v_dot2_f32_bf16 v114, v26, s81, v114
    v_dot2_f32_bf16 v115, v27, s81, v115
    v_dot2_f32_bf16 v116, v26, s82, v116
    v_dot2_f32_bf16 v117, v27, s82, v117
    v_dot2_f32_bf16 v118, v26, s83, v118
    v_dot2_f32_bf16 v119, v27, s83, v119
    v_dot2_f32_bf16 v120, v26, s64, v120
    v_dot2_f32_bf16 v121, v27, s64, v121
    v_dot2_f32_bf16 v122, v26, s65, v122
    v_dot2_f32_bf16 v123, v27, s65, v123
    v_dot2_f32_bf16 v124, v26, s66, v124
    v_dot2_f32_bf16 v125, v27, s66, v125
    v_dot2_f32_bf16 v126, v26, s67, v126
    v_dot2_f32_bf16 v127, v27, s67, v127
L_p2_kernel_g1_30:
    s_lshl2_add_u32 s14, s3, s49
    s_mul_i32 s26, s14, 20000
    s_mov_b32 s10, 5120000
    buffer_load_dwordx4 v[64:67], v1, s[8:11], s26 offen
    buffer_load_dwordx4 v[68:71], v2, s[8:11], s26 offen
    s_branch L_p2_fin
L_p2_done:
    s_branch L_p2_end
L_p2_slow:
    s_barrier
    v_mov_b32 v8, 0
    v_mov_b32 v9, 0
    v_mov_b32 v10, 0
    v_mov_b32 v11, 0
    v_mov_b32 v12, v1
    ds_write_b128 v12, v[8:11]
    v_add_u32 v12, 16384, v12
    ds_write_b128 v12, v[8:11]
    v_add_u32 v12, 16384, v12
    ds_write_b128 v12, v[8:11]
    v_add_u32 v12, 16384, v12
    ds_write_b128 v12, v[8:11]
    v_add_u32 v12, 16384, v12
    ds_write_b128 v12, v[8:11]
    v_add_u32 v12, 16384, v12
    ds_write_b128 v12, v[8:11]
    v_add_u32 v12, 16384, v12
    ds_write_b128 v12, v[8:11]
    v_add_u32 v12, 16384, v12
    ds_write_b128 v12, v[8:11]
    v_add_u32 v12, 16384, v12
    ds_write_b128 v12, v[8:11]
    v_add_u32 v12, 16384, v12
    ds_write_b128 v12, v[8:11]
    v_add_u32 v12, 16384, v12
    v_mul_u32_u24 v13, 8320, v0
    v_mov_b32 v29, 0x7fc00000
    v_add_u32 v28, 32, v13
    v_lshlrev_b32 v14, 10, v0
    v_add_u32 v14, 9437184, v14
    s_mul_i32 s25, s12, 65
    s_add_u32 s25, s25, s3
    s_lshl_b32 s25, s25, 5
    s_add_u32 s25, s25, 0
    s_lshl_b32 s50, s50, 1
    s_mul_i32 s22, s12, 1280000
    s_mov_b32 s24, 0
    s_waitcnt lgkmcnt(0)
    s_barrier
L_p2_sstep:
    buffer_load_ushort v15, v13, s[4:7], s25 offen
    buffer_load_ushort v16, v28, s[4:7], s25 offen
    s_waitcnt vmcnt(0)
L_p2_srec:
    v_cmp_lt_u32 vcc, v15, v16
    s_nop 1
    s_and_b64 exec, exec, vcc
    s_cbranch_execz L_p2_sdone
    v_mul_u32_u24 v17, 43691, v15
    v_lshrrev_b32 v17, 17, v17
    v_mad_i32_i24 v18, v17, -3, v15
    v_lshrrev_b32 v19, 6, v17
    v_lshl_add_u32 v19, v19, 20, v14
    v_and_b32 v17, 63, v17
    v_lshl_add_u32 v17, v17, 4, v19
    v_lshl_add_u32 v19, v18, 2, v17
    buffer_load_dword v20, v19, s[4:7], 0 offen
    buffer_load_dword v21, v17, s[4:7], 0 offen offset:12
    v_add_u32 v15, 1, v15
    v_mad_u32_u24 v18, v18, 10, 2
    s_waitcnt vmcnt(0)
    v_and_b32 v19, 0x3fff, v20
    v_lshlrev_b32 v19, 3, v19
    buffer_load_dwordx2 v[22:23], v19, s[8:11], s22 offen
    v_mad_u32_u16 v20, v20, 16, s50 op_sel:[1,0,0,0]
    v_bfe_i32 v21, v21, v18, 10
    v_cmp_eq_i32 vcc, -512, v21
    v_cvt_f32_i32 v21, v21
    v_mul_f32 v21, 989872160, v21
    v_cndmask_b32 v21, v21, v29, vcc
    s_waitcnt vmcnt(0)
    v_lshlrev_b32 v24, 16, v22
    v_and_b32 v25, 0xffff0000, v22
    v_lshlrev_b32 v26, 16, v23
    v_and_b32 v27, 0xffff0000, v23
    v_mul_f32 v24, v21, v24
    v_mul_f32 v25, v21, v25
    v_mul_f32 v26, v21, v26
    v_mul_f32 v27, v21, v27
    ds_add_f32 v20, v24
    ds_add_f32 v20, v25 offset:4
    ds_add_f32 v20, v26 offset:8
    ds_add_f32 v20, v27 offset:12
    s_branch L_p2_srec
L_p2_sdone:
    s_mov_b64 exec, -1
    s_add_u32 s25, s25, 2
    s_add_u32 s22, s22, 80000
    s_add_u32 s24, s24, 1
    s_cmp_lt_u32 s24, 16
    s_cbranch_scc1 L_p2_sstep
    s_waitcnt lgkmcnt(0)
    s_barrier
    s_mul_i32 s14, s12, 10240000
    s_mul_i32 s15, s3, 160000
    s_add_u32 s26, s14, s15
    s_add_u32 s26, s26, 249069568
    v_mov_b32 v12, v1
    s_mov_b32 s24, 0
L_p2_sout:
    v_cmp_gt_u32 vcc, 160000, v12
    ds_read_b128 v[8:11], v12
    s_nop 0
    s_and_b64 exec, exec, vcc
    s_cbranch_execz L_p2_sfin
    s_waitcnt lgkmcnt(0)
    buffer_store_dwordx4 v[8:11], v12, s[4:7], s26 offen sc1
    s_waitcnt vmcnt(0)
    v_add_u32 v12, 16384, v12
    s_branch L_p2_sout
L_p2_sfin:
    s_mov_b64 exec, -1
    s_waitcnt vmcnt(0) lgkmcnt(0)
    s_barrier
    s_branch L_p2_signal
L_p2_end:
    s_endpgm
.section .rodata,"a"
.p2align 6
.amdhsa_kernel p1_kernel
  .amdhsa_next_free_vgpr 128
  .amdhsa_next_free_sgpr 96
  .amdhsa_accum_offset 128
  .amdhsa_group_segment_fixed_size 0
  .amdhsa_kernarg_size 112
  .amdhsa_user_sgpr_count 2
  .amdhsa_user_sgpr_kernarg_segment_ptr 1
  .amdhsa_system_sgpr_workgroup_id_x 1
  .amdhsa_float_denorm_mode_32 0
.end_amdhsa_kernel
.p2align 6
.amdhsa_kernel p2_kernel
  .amdhsa_next_free_vgpr 128
  .amdhsa_next_free_sgpr 102
  .amdhsa_accum_offset 128
  .amdhsa_group_segment_fixed_size 0
  .amdhsa_kernarg_size 112
  .amdhsa_user_sgpr_count 2
  .amdhsa_user_sgpr_kernarg_segment_ptr 1
  .amdhsa_system_sgpr_workgroup_id_x 1
  .amdhsa_float_denorm_mode_32 0
.end_amdhsa_kernel
```

```asm
; @launch kernel=p1_kernel grid=(256,1,1) block=(1024,1,1) lds=163840
; @launch kernel=p2_kernel grid=(256,1,1) block=(1024,1,1) lds=163840
.amdgcn_target "amdgcn-amd-amdhsa--gfx950"
.text
.globl p1_kernel
.p2align 8
.type p1_kernel,@function
p1_kernel:
    s_cmp_ge_u32 s2, 256
    s_cbranch_scc1 L_p1_end
    s_load_dwordx2 s[4:5], s[0:1], 104
    s_load_dwordx2 s[8:9], s[0:1], 8
    s_load_dwordx2 s[12:13], s[0:1], 16
    s_load_dwordx2 s[16:17], s[0:1], 32
    s_load_dwordx2 s[28:29], s[0:1], 0
    s_load_dwordx2 s[6:7], s[0:1], 48
    v_cmp_gt_u32 vcc, 256, v0
    s_nop 1
    s_cbranch_vccz L_p1_nopf
    s_getpc_b64 s[72:73]
L_p1_kernel_pc_1:
    s_add_u32 s72, s72, L_p1_nopf-L_p1_kernel_pc_1
    s_addc_u32 s73, s73, 0
    v_lshlrev_b32 v14, 7, v0
    v_min_u32 v14, L_p2_end-L_p1_nopf, v14
    global_load_dword v15, v14, s[72:73]
L_p1_nopf:
    v_lshlrev_b32 v1, 4, v0
    v_lshlrev_b32 v2, 3, v0
    v_lshrrev_b32 v6, 6, v0
    v_mul_u32_u24 v3, 851904, v6
    v_add_lshl_u32 v3, v3, v0, 4
    v_mov_b32 v4, 1
    v_mov_b32 v5, 0
    v_readfirstlane_b32 s39, v6
    v_cmp_gt_u32 vcc, 784, v0
    s_and_b32 s51, s2, 7
    s_lshl_b32 s51, s51, 0
    s_bfe_u32 s35, s2, 3
    s_add_u32 s51, s51, s35
    s_and_b32 s35, s2, 248
    s_add_u32 s51, s51, s35
    s_and_b32 s32, s2, 7
    s_lshl_b32 s32, s32, 2
    s_bfe_u32 s35, s2, 131075
    s_add_u32 s32, s32, s35
    s_and_b32 s35, s2, 224
    s_add_u32 s32, s32, s35
    s_lshr_b32 s35, s39, 4
    s_mul_i32 s36, s35, 4177920
    s_lshl_b32 s33, s51, 14
    s_add_u32 s33, s33, s36
    s_lshr_b32 s34, s33, 1
    s_mul_i32 s48, s51, 3840
    s_cmp_ge_u32 s35, 0
    s_cselect_b32 s48, s48, 0
    s_lshr_b32 s49, s48, 1
    s_mov_b64 s[44:45], vcc
    s_waitcnt lgkmcnt(0)
    s_load_dword s3, s[6:7], 0
    s_mov_b32 s10, 163840000
    s_mov_b32 s11, 0x00020000
    s_mov_b32 s14, 163840000
    s_mov_b32 s15, 0x00020000
    s_mov_b32 s18, 81920000
    s_mov_b32 s19, 0x00020000
    s_mul_i32 s36, s2, 20000
    s_add_u32 s30, s36, 20000
    s_mov_b32 s31, 0x00020000
    s_add_u32 s35, s36, 16384
    buffer_load_dwordx4 v[48:51], v1, s[28:31], s36 offen
    buffer_load_dwordx4 v[52:55], v1, s[28:31], s35 offen
    s_add_u32 s35, s33, 0
    buffer_load_dwordx4 v[16:19], v1, s[8:11], s35 offen nt
    s_add_u32 s35, s33, 0
    buffer_load_dwordx4 v[20:23], v1, s[12:15], s35 offen nt
    s_add_u32 s35, s33, 4194304
    buffer_load_dwordx4 v[24:27], v1, s[8:11], s35 offen nt
    s_add_u32 s35, s33, 4194304
    buffer_load_dwordx4 v[28:31], v1, s[12:15], s35 offen nt
    s_add_u32 s35, s33, 8388608
    buffer_load_dwordx4 v[32:35], v1, s[8:11], s35 offen nt
    s_add_u32 s35, s33, 8388608
    buffer_load_dwordx4 v[36:39], v1, s[12:15], s35 offen nt
    s_add_u32 s35, s33, 12582912
    buffer_load_dwordx4 v[40:43], v1, s[8:11], s35 offen nt
    s_add_u32 s35, s33, 12582912
    buffer_load_dwordx4 v[44:47], v1, s[12:15], s35 offen nt
    s_add_u32 s35, s33, 16777216
    buffer_load_dwordx4 v[72:75], v1, s[8:11], s35 offen nt
    s_add_u32 s35, s33, 16777216
    buffer_load_dwordx4 v[76:79], v1, s[12:15], s35 offen nt
    s_mov_b32 s20, s4
    s_mov_b32 s21, s5
    s_mov_b32 s22, 0
    s_mov_b32 s23, 0x00020000
    s_add_u32 s24, s4, 0
    s_addc_u32 s25, s5, 0
    s_mov_b32 s26, 8540160
    s_mov_b32 s27, 0x00020000
    s_mov_b32 s37, 1492179184
    s_mov_b32 s55, 0
    s_mov_b64 s[72:73], s[4:5]
    s_mov_b32 s74, 0
    s_mov_b32 s75, 0x00020000
    s_mov_b32 s50, 21845
    s_mov_b32 s52, 0x8000
    s_mov_b32 s38, 262400
    s_mov_b32 s43, 0x05040100
    s_mov_b32 s40, 0
    v_mov_b32 v8, 0
    v_mov_b32 v9, 0
    v_mov_b32 v10, 0
    v_mov_b32 v11, 0
    ds_write_b128 v1, v[8:11] offset:0
    v_min_u32 v7, 16, v0
    v_lshlrev_b32 v7, 2, v7
    v_add_u32 v7, 160768, v7
    ds_write_b32 v7, v8
    s_waitcnt lgkmcnt(0)
    s_lshl_b32 s3, s3, 16
    v_mov_b32 v12, s3
    v_mul_f32 v12, 0.15915494, v12
    s_nop 0
    v_readfirstlane_b32 s41, v12
    s_waitcnt vmcnt(10)
    v_mov_b32 v12, 0x3f803f80
    v_and_b32 v48, 0x7fff7fff, v48
    v_and_b32 v49, 0x7fff7fff, v49
    v_and_b32 v50, 0x7fff7fff, v50
    v_and_b32 v51, 0x7fff7fff, v51
    v_and_b32 v52, 0x7fff7fff, v52
    v_and_b32 v53, 0x7fff7fff, v53
    v_and_b32 v54, 0x7fff7fff, v54
    v_and_b32 v55, 0x7fff7fff, v55
    v_pk_max_u16 v8, v8, v48
    v_dot2c_f32_bf16 v9, v48, v12
    v_pk_max_u16 v8, v8, v49
    v_dot2c_f32_bf16 v9, v49, v12
    v_pk_max_u16 v8, v8, v50
    v_dot2c_f32_bf16 v9, v50, v12
    v_pk_max_u16 v8, v8, v51
    v_dot2c_f32_bf16 v9, v51, v12
    v_pk_max_u16 v8, v8, v52
    v_dot2c_f32_bf16 v9, v52, v12
    v_pk_max_u16 v8, v8, v53
    v_dot2c_f32_bf16 v9, v53, v12
    v_pk_max_u16 v8, v8, v54
    v_dot2c_f32_bf16 v9, v54, v12
    v_pk_max_u16 v8, v8, v55
    v_dot2c_f32_bf16 v9, v55, v12
    v_lshrrev_b32 v10, 16, v8
    v_and_b32 v8, 0xffff, v8
    v_max_u32 v8, v8, v10
    s_nop 0
    s_nop 1
    v_max_u32_dpp v8, v8, v8 row_shr:1 row_mask:0xf bank_mask:0xf bound_ctrl:0
    s_nop 1
    v_max_u32_dpp v8, v8, v8 row_shr:2 row_mask:0xf bank_mask:0xf bound_ctrl:0
    s_nop 1
    v_max_u32_dpp v8, v8, v8 row_shr:4 row_mask:0xf bank_mask:0xf bound_ctrl:0
    s_nop 1
    v_max_u32_dpp v8, v8, v8 row_shr:8 row_mask:0xf bank_mask:0xf bound_ctrl:0
    s_nop 1
    v_max_u32_dpp v8, v8, v8 row_bcast:15 row_mask:0xa bank_mask:0xf
    s_nop 1
    v_max_u32_dpp v8, v8, v8 row_bcast:31 row_mask:0xc bank_mask:0xf
    s_nop 1
    v_add_f32_dpp v9, v9, v9 row_shr:1 row_mask:0xf bank_mask:0xf bound_ctrl:0
    s_nop 1
    v_add_f32_dpp v9, v9, v9 row_shr:2 row_mask:0xf bank_mask:0xf bound_ctrl:0
    s_nop 1
    v_add_f32_dpp v9, v9, v9 row_shr:4 row_mask:0xf bank_mask:0xf bound_ctrl:0
    s_nop 1
    v_add_f32_dpp v9, v9, v9 row_shr:8 row_mask:0xf bank_mask:0xf bound_ctrl:0
    s_nop 1
    v_add_f32_dpp v9, v9, v9 row_bcast:15 row_mask:0xa bank_mask:0xf
    s_nop 1
    v_add_f32_dpp v9, v9, v9 row_bcast:31 row_mask:0xc bank_mask:0xf
    s_lshl_b32 s35, s39, 4
    s_add_u32 s35, s35, 160320
    v_mov_b32 v10, s35
    s_mov_b32 exec_lo, 0
    s_brev_b32 exec_hi, 1
    ds_write_b64 v10, v[8:9]
    s_mov_b64 exec, -1
    s_waitcnt lgkmcnt(0)
    s_barrier
    s_branch L_p1_first
L_p1_loop:
    s_mov_b64 s[72:73], s[20:21]
    s_mov_b32 s74, s22
    s_getreg_b32 s51, hwreg(HW_REG_XCC_ID, 0, 1)
    s_cmp_eq_u32 s51, 0
    s_cselect_b64 vcc, -1, 0
    s_cmp_lg_u32 s39, 15
    s_cbranch_scc1 L_p1_kernel_nox_2
    s_waitcnt lgkmcnt(13)
    v_lshlrev_b32 v15, 16, v120
    v_and_b32 v120, 0xffff0000, v120
    v_lshlrev_b32 v121, 16, v121
    v_mul_f32 v15, s41, v15
    v_mul_f32 v120, s41, v120
    v_mul_f32 v121, s41, v121
    v_fract_f32 v15, v15
    v_fract_f32 v120, v120
    v_fract_f32 v121, v121
    v_cos_f32 v15, v15
    v_cos_f32 v120, v120
    v_cos_f32 v121, v121
    v_fmaak_f32 v15, v10, v15, 1262486016
    v_fmaak_f32 v120, v10, v120, 1262486016
    v_fmaak_f32 v121, v10, v121, 1262486016
    v_lshlrev_b32 v15, 22, v15
    v_alignbit_b32 v15, v120, v15, 10
    v_alignbit_b32 v15, v121, v15, 10
    v_xor_b32 v15, 0x80200800, v15
    s_mov_b32 s36, 13631488
    buffer_store_dwordx4 v[12:15], v3, s[20:23], s36 offen sc1
L_p1_kernel_nox_2:
    s_waitcnt lgkmcnt(12)
    v_lshlrev_b32 v75, 16, v122
    v_and_b32 v122, 0xffff0000, v122
    v_lshlrev_b32 v123, 16, v123
    v_mul_f32 v75, s41, v75
    v_mul_f32 v122, s41, v122
    v_mul_f32 v123, s41, v123
    v_fract_f32 v75, v75
    v_fract_f32 v122, v122
    v_fract_f32 v123, v123
    v_cos_f32 v75, v75
    v_cos_f32 v122, v122
    v_cos_f32 v123, v123
    v_fmaak_f32 v75, v10, v75, 1262486016
    v_fmaak_f32 v122, v10, v122, 1262486016
    v_fmaak_f32 v123, v10, v123, 1262486016
    v_lshlrev_b32 v75, 22, v75
    v_alignbit_b32 v75, v122, v75, 10
    v_alignbit_b32 v75, v123, v75, 10
    v_xor_b32 v75, 0x80200800, v75
    s_mov_b32 s36, 0
    buffer_store_dwordx4 v[72:75], v3, s[20:23], s36 offen sc1
    s_waitcnt lgkmcnt(11)
    v_lshlrev_b32 v79, 16, v124
    v_and_b32 v124, 0xffff0000, v124
    v_lshlrev_b32 v125, 16, v125
    v_mul_f32 v79, s41, v79
    v_mul_f32 v124, s41, v124
    v_mul_f32 v125, s41, v125
    v_fract_f32 v79, v79
    v_fract_f32 v124, v124
    v_fract_f32 v125, v125
    v_cos_f32 v79, v79
    v_cos_f32 v124, v124
    v_cos_f32 v125, v125
    v_fmaak_f32 v79, v10, v79, 1262486016
    v_fmaak_f32 v124, v10, v124, 1262486016
    v_fmaak_f32 v125, v10, v125, 1262486016
    v_lshlrev_b32 v79, 22, v79
    v_alignbit_b32 v79, v124, v79, 10
    v_alignbit_b32 v79, v125, v79, 10
    v_xor_b32 v79, 0x80200800, v79
    s_mov_b32 s36, 1048576
    buffer_store_dwordx4 v[76:79], v3, s[20:23], s36 offen sc1
    s_waitcnt lgkmcnt(0)
    v_lshlrev_b32 v51, 16, v126
    v_and_b32 v126, 0xffff0000, v126
    v_lshlrev_b32 v127, 16, v127
    v_mul_f32 v51, s41, v51
    v_mul_f32 v126, s41, v126
    v_mul_f32 v127, s41, v127
    v_fract_f32 v51, v51
    v_fract_f32 v126, v126
    v_fract_f32 v127, v127
    v_cos_f32 v51, v51
    v_cos_f32 v126, v126
    v_cos_f32 v127, v127
    v_fmaak_f32 v51, v10, v51, 1262486016
    v_fmaak_f32 v126, v10, v126, 1262486016
    v_fmaak_f32 v127, v10, v127, 1262486016
    v_lshlrev_b32 v51, 22, v51
    v_alignbit_b32 v51, v126, v51, 10
    v_alignbit_b32 v51, v127, v51, 10
    v_xor_b32 v51, 0x80200800, v51
    s_mov_b32 s36, 2097152
    buffer_store_dwordx4 v[48:51], v3, s[20:23], s36 offen sc1
    s_add_u32 s35, s33, 16777216
    buffer_load_dwordx4 v[72:75], v1, s[8:11], s35 offen nt
    s_add_u32 s35, s33, 16777216
    buffer_load_dwordx4 v[76:79], v1, s[12:15], s35 offen nt
    s_cbranch_vccz L_p1_kernel_thr_3
    s_waitcnt vmcnt(2)
L_p1_kernel_thr_3:
    s_waitcnt vmcnt(11)
    v_perm_b32 v6, v20, v16, s43
    v_perm_b32 v7, v21, v17, s43
    v_perm_b32 v8, v22, v18, s43
    v_perm_b32 v9, v23, v19, s43
    v_mul_hi_u32_u24 v16, 429497, v16
    v_mul_hi_u32_u24 v20, 429497, v20
    v_mul_hi_u32_u24 v17, 429497, v17
    v_mul_hi_u32_u24 v21, 429497, v21
    v_mul_hi_u32_u24 v18, 429497, v18
    v_mul_hi_u32_u24 v22, 429497, v22
    v_mul_hi_u32_u24 v19, 429497, v19
    v_mul_hi_u32_u24 v23, 429497, v23
    v_lshl_or_b32 v16, v20, 16, v16
    v_lshl_or_b32 v17, v21, 16, v17
    v_lshl_or_b32 v18, v22, 16, v18
    v_lshl_or_b32 v19, v23, 16, v19
    v_dot2_u32_u16 v20, v16, s38, 0
    v_dot2_u32_u16 v21, v17, s38, 0
    v_dot2_u32_u16 v22, v18, s38, 0
    v_dot2_u32_u16 v23, v19, s38, 0
    v_pk_mad_u16 v6, v16, s37, v6
    v_pk_mad_u16 v7, v17, s37, v7
    v_pk_mad_u16 v8, v18, s37, v8
    v_pk_mad_u16 v9, v19, s37, v9
    ds_add_u32 v20, v4 offset:0
    ds_add_u32 v21, v4 offset:0
    ds_add_u32 v22, v4 offset:0
    ds_add_u32 v23, v4 offset:0
    v_pk_mad_u16 v6, v16, s52, v6 op_sel:[1,0,0] op_sel_hi:[1,1,1]
    v_pk_mad_u16 v7, v17, s52, v7 op_sel:[1,0,0] op_sel_hi:[1,1,1]
    v_pk_mad_u16 v8, v18, s52, v8 op_sel:[1,0,0] op_sel_hi:[1,1,1]
    v_pk_mad_u16 v9, v19, s52, v9 op_sel:[1,0,0] op_sel_hi:[1,1,1]
    v_perm_b32 v121, v23, v22, s43
    v_perm_b32 v120, v21, v20, s43
    v_or_b32 v127, 0x40000000, v6
    v_or_b32 v48, 0x40000000, v7
    v_or_b32 v49, 0x40000000, v8
    v_or_b32 v50, 0x40000000, v9
    v_lshlrev_b32 v83, 16, v100
    v_and_b32 v100, 0xffff0000, v100
    v_lshlrev_b32 v101, 16, v101
    v_mul_f32 v83, s41, v83
    v_mul_f32 v100, s41, v100
    v_mul_f32 v101, s41, v101
    v_fract_f32 v83, v83
    v_fract_f32 v100, v100
    v_fract_f32 v101, v101
    v_cos_f32 v83, v83
    v_cos_f32 v100, v100
    v_cos_f32 v101, v101
    v_fmaak_f32 v83, v10, v83, 1262486016
    v_fmaak_f32 v100, v10, v100, 1262486016
    v_fmaak_f32 v101, v10, v101, 1262486016
    v_lshlrev_b32 v83, 22, v83
    v_alignbit_b32 v83, v100, v83, 10
    v_alignbit_b32 v83, v101, v83, 10
    v_xor_b32 v83, 0x80200800, v83
    s_mov_b32 s36, 3145728
    buffer_store_dwordx4 v[80:83], v3, s[20:23], s36 offen sc1
    v_lshlrev_b32 v55, 16, v102
    v_and_b32 v102, 0xffff0000, v102
    v_lshlrev_b32 v103, 16, v103
    v_mul_f32 v55, s41, v55
    v_mul_f32 v102, s41, v102
    v_mul_f32 v103, s41, v103
    v_fract_f32 v55, v55
    v_fract_f32 v102, v102
    v_fract_f32 v103, v103
    v_cos_f32 v55, v55
    v_cos_f32 v102, v102
    v_cos_f32 v103, v103
    v_fmaak_f32 v55, v10, v55, 1262486016
    v_fmaak_f32 v102, v10, v102, 1262486016
    v_fmaak_f32 v103, v10, v103, 1262486016
    v_lshlrev_b32 v55, 22, v55
    v_alignbit_b32 v55, v102, v55, 10
    v_alignbit_b32 v55, v103, v55, 10
    v_xor_b32 v55, 0x80200800, v55
    s_cmp_lg_u32 s40, 3
    s_cbranch_scc1 L_p1_kernel_now_4
    v_mov_b64 v[16:17], v[52:53]
    v_mov_b64 v[18:19], v[54:55]
    s_branch L_p1_kernel_held_5
L_p1_kernel_now_4:
    s_mov_b32 s36, 4194304
    buffer_store_dwordx4 v[52:55], v3, s[20:23], s36 offen sc1
L_p1_kernel_held_5:
    s_add_u32 s35, s33, 20971520
    buffer_load_dwordx4 v[80:83], v1, s[8:11], s35 offen nt
    s_add_u32 s35, s33, 20971520
    buffer_load_dwordx4 v[100:103], v1, s[12:15], s35 offen nt
    s_cbranch_vccz L_p1_kernel_thr_6
    s_waitcnt vmcnt(2)
L_p1_kernel_thr_6:
    v_lshlrev_b32 v87, 16, v104
    v_and_b32 v104, 0xffff0000, v104
    v_lshlrev_b32 v105, 16, v105
    v_mul_f32 v87, s41, v87
    v_mul_f32 v104, s41, v104
    v_mul_f32 v105, s41, v105
    v_fract_f32 v87, v87
    v_fract_f32 v104, v104
    v_fract_f32 v105, v105
    v_cos_f32 v87, v87
    v_cos_f32 v104, v104
    v_cos_f32 v105, v105
    v_fmaak_f32 v87, v10, v87, 1262486016
    v_fmaak_f32 v104, v10, v104, 1262486016
    v_fmaak_f32 v105, v10, v105, 1262486016
    v_lshlrev_b32 v87, 22, v87
    v_alignbit_b32 v87, v104, v87, 10
    v_alignbit_b32 v87, v105, v87, 10
    v_xor_b32 v87, 0x80200800, v87
    s_mov_b32 s36, 5242880
    buffer_store_dwordx4 v[84:87], v3, s[20:23], s36 offen sc1
    v_lshlrev_b32 v59, 16, v106
    v_and_b32 v106, 0xffff0000, v106
    v_lshlrev_b32 v107, 16, v107
    v_mul_f32 v59, s41, v59
    v_mul_f32 v106, s41, v106
    v_mul_f32 v107, s41, v107
    v_fract_f32 v59, v59
    v_fract_f32 v106, v106
    v_fract_f32 v107, v107
    v_cos_f32 v59, v59
    v_cos_f32 v106, v106
    v_cos_f32 v107, v107
    v_fmaak_f32 v59, v10, v59, 1262486016
    v_fmaak_f32 v106, v10, v106, 1262486016
    v_fmaak_f32 v107, v10, v107, 1262486016
    v_lshlrev_b32 v59, 22, v59
    v_alignbit_b32 v59, v106, v59, 10
    v_alignbit_b32 v59, v107, v59, 10
    v_xor_b32 v59, 0x80200800, v59
    s_cmp_lg_u32 s40, 3
    s_cbranch_scc1 L_p1_kernel_now_7
    v_mov_b64 v[20:21], v[56:57]
    v_mov_b64 v[22:23], v[58:59]
    s_branch L_p1_kernel_held_8
L_p1_kernel_now_7:
    s_mov_b32 s36, 6291456
    buffer_store_dwordx4 v[56:59], v3, s[20:23], s36 offen sc1
L_p1_kernel_held_8:
    s_add_u32 s35, s33, 25165824
    buffer_load_dwordx4 v[84:87], v1, s[8:11], s35 offen nt
    s_add_u32 s35, s33, 25165824
    buffer_load_dwordx4 v[104:107], v1, s[12:15], s35 offen nt
    s_cbranch_vccz L_p1_kernel_thr_9
    s_waitcnt vmcnt(2)
L_p1_kernel_thr_9:
    s_waitcnt vmcnt(15)
    v_perm_b32 v6, v28, v24, s43
    v_perm_b32 v7, v29, v25, s43
    v_perm_b32 v8, v30, v26, s43
    v_perm_b32 v9, v31, v27, s43
    v_mul_hi_u32_u24 v24, 429497, v24
    v_mul_hi_u32_u24 v28, 429497, v28
    v_mul_hi_u32_u24 v25, 429497, v25
    v_mul_hi_u32_u24 v29, 429497, v29
    v_mul_hi_u32_u24 v26, 429497, v26
    v_mul_hi_u32_u24 v30, 429497, v30
    v_mul_hi_u32_u24 v27, 429497, v27
    v_mul_hi_u32_u24 v31, 429497, v31
    v_lshl_or_b32 v24, v28, 16, v24
    v_lshl_or_b32 v25, v29, 16, v25
    v_lshl_or_b32 v26, v30, 16, v26
    v_lshl_or_b32 v27, v31, 16, v27
    v_dot2_u32_u16 v28, v24, s38, 0
    v_dot2_u32_u16 v29, v25, s38, 0
    v_dot2_u32_u16 v30, v26, s38, 0
    v_dot2_u32_u16 v31, v27, s38, 0
    v_pk_mad_u16 v6, v24, s37, v6
    v_pk_mad_u16 v7, v25, s37, v7
    v_pk_mad_u16 v8, v26, s37, v8
    v_pk_mad_u16 v9, v27, s37, v9
    ds_add_u32 v28, v4 offset:0
    ds_add_u32 v29, v4 offset:0
    ds_add_u32 v30, v4 offset:0
    ds_add_u32 v31, v4 offset:0
    v_pk_mad_u16 v6, v24, s52, v6 op_sel:[1,0,0] op_sel_hi:[1,1,1]
    v_pk_mad_u16 v7, v25, s52, v7 op_sel:[1,0,0] op_sel_hi:[1,1,1]
    v_pk_mad_u16 v8, v26, s52, v8 op_sel:[1,0,0] op_sel_hi:[1,1,1]
    v_pk_mad_u16 v9, v27, s52, v9 op_sel:[1,0,0] op_sel_hi:[1,1,1]
    v_perm_b32 v123, v31, v30, s43
    v_perm_b32 v122, v29, v28, s43
    v_or_b32 v52, 0x40000000, v6
    v_or_b32 v53, 0x40000000, v7
    v_or_b32 v54, 0x40000000, v8
    v_or_b32 v56, 0x40000000, v9
    v_lshlrev_b32 v91, 16, v108
    v_and_b32 v108, 0xffff0000, v108
    v_lshlrev_b32 v109, 16, v109
    v_mul_f32 v91, s41, v91
    v_mul_f32 v108, s41, v108
    v_mul_f32 v109, s41, v109
    v_fract_f32 v91, v91
    v_fract_f32 v108, v108
    v_fract_f32 v109, v109
    v_cos_f32 v91, v91
    v_cos_f32 v108, v108
    v_cos_f32 v109, v109
    v_fmaak_f32 v91, v10, v91, 1262486016
    v_fmaak_f32 v108, v10, v108, 1262486016
    v_fmaak_f32 v109, v10, v109, 1262486016
    v_lshlrev_b32 v91, 22, v91
    v_alignbit_b32 v91, v108, v91, 10
    v_alignbit_b32 v91, v109, v91, 10
    v_xor_b32 v91, 0x80200800, v91
    s_cmp_lg_u32 s40, 3
    s_cbranch_scc1 L_p1_kernel_now_10
    v_mov_b64 v[24:25], v[88:89]
    v_mov_b64 v[26:27], v[90:91]
    s_branch L_p1_kernel_held_11
L_p1_kernel_now_10:
    s_mov_b32 s36, 7340032
    buffer_store_dwordx4 v[88:91], v3, s[20:23], s36 offen sc1
L_p1_kernel_held_11:
    v_lshlrev_b32 v63, 16, v110
    v_and_b32 v110, 0xffff0000, v110
    v_lshlrev_b32 v111, 16, v111
    v_mul_f32 v63, s41, v63
    v_mul_f32 v110, s41, v110
    v_mul_f32 v111, s41, v111
    v_fract_f32 v63, v63
    v_fract_f32 v110, v110
    v_fract_f32 v111, v111
    v_cos_f32 v63, v63
    v_cos_f32 v110, v110
    v_cos_f32 v111, v111
    v_fmaak_f32 v63, v10, v63, 1262486016
    v_fmaak_f32 v110, v10, v110, 1262486016
    v_fmaak_f32 v111, v10, v111, 1262486016
    v_lshlrev_b32 v63, 22, v63
    v_alignbit_b32 v63, v110, v63, 10
    v_alignbit_b32 v63, v111, v63, 10
    v_xor_b32 v63, 0x80200800, v63
    s_cmp_lg_u32 s40, 3
    s_cbranch_scc1 L_p1_kernel_now_12
    v_mov_b64 v[28:29], v[60:61]
    v_mov_b64 v[30:31], v[62:63]
    s_branch L_p1_kernel_held_13
L_p1_kernel_now_12:
    s_mov_b32 s36, 8388608
    buffer_store_dwordx4 v[60:63], v3, s[20:23], s36 offen sc1
L_p1_kernel_held_13:
    s_add_u32 s35, s33, 29360128
    buffer_load_dwordx4 v[88:91], v1, s[8:11], s35 offen nt
    s_add_u32 s35, s33, 29360128
    buffer_load_dwordx4 v[108:111], v1, s[12:15], s35 offen nt
    s_cbranch_vccz L_p1_kernel_thr_14
    s_waitcnt vmcnt(2)
L_p1_kernel_thr_14:
    s_waitcnt vmcnt(15)
    v_perm_b32 v6, v36, v32, s43
    v_perm_b32 v7, v37, v33, s43
    v_perm_b32 v8, v38, v34, s43
    v_perm_b32 v9, v39, v35, s43
    v_mul_hi_u32_u24 v32, 429497, v32
    v_mul_hi_u32_u24 v36, 429497, v36
    v_mul_hi_u32_u24 v33, 429497, v33
    v_mul_hi_u32_u24 v37, 429497, v37
    v_mul_hi_u32_u24 v34, 429497, v34
    v_mul_hi_u32_u24 v38, 429497, v38
    v_mul_hi_u32_u24 v35, 429497, v35
    v_mul_hi_u32_u24 v39, 429497, v39
    v_lshl_or_b32 v32, v36, 16, v32
    v_lshl_or_b32 v33, v37, 16, v33
    v_lshl_or_b32 v34, v38, 16, v34
    v_lshl_or_b32 v35, v39, 16, v35
    v_dot2_u32_u16 v36, v32, s38, 0
    v_dot2_u32_u16 v37, v33, s38, 0
    v_dot2_u32_u16 v38, v34, s38, 0
    v_dot2_u32_u16 v39, v35, s38, 0
    v_pk_mad_u16 v6, v32, s37, v6
    v_pk_mad_u16 v7, v33, s37, v7
    v_pk_mad_u16 v8, v34, s37, v8
    v_pk_mad_u16 v9, v35, s37, v9
    ds_add_u32 v36, v4 offset:0
    ds_add_u32 v37, v4 offset:0
    ds_add_u32 v38, v4 offset:0
    ds_add_u32 v39, v4 offset:0
    v_pk_mad_u16 v6, v32, s52, v6 op_sel:[1,0,0] op_sel_hi:[1,1,1]
    v_pk_mad_u16 v7, v33, s52, v7 op_sel:[1,0,0] op_sel_hi:[1,1,1]
    v_pk_mad_u16 v8, v34, s52, v8 op_sel:[1,0,0] op_sel_hi:[1,1,1]
    v_pk_mad_u16 v9, v35, s52, v9 op_sel:[1,0,0] op_sel_hi:[1,1,1]
    v_perm_b32 v125, v39, v38, s43
    v_perm_b32 v124, v37, v36, s43
    v_or_b32 v57, 0x40000000, v6
    v_or_b32 v58, 0x40000000, v7
    v_or_b32 v60, 0x40000000, v8
    v_or_b32 v61, 0x40000000, v9
    v_lshlrev_b32 v95, 16, v112
    v_and_b32 v112, 0xffff0000, v112
    v_lshlrev_b32 v113, 16, v113
    v_mul_f32 v95, s41, v95
    v_mul_f32 v112, s41, v112
    v_mul_f32 v113, s41, v113
    v_fract_f32 v95, v95
    v_fract_f32 v112, v112
    v_fract_f32 v113, v113
    v_cos_f32 v95, v95
    v_cos_f32 v112, v112
    v_cos_f32 v113, v113
    v_fmaak_f32 v95, v10, v95, 1262486016
    v_fmaak_f32 v112, v10, v112, 1262486016
    v_fmaak_f32 v113, v10, v113, 1262486016
    v_lshlrev_b32 v95, 22, v95
    v_alignbit_b32 v95, v112, v95, 10
    v_alignbit_b32 v95, v113, v95, 10
    v_xor_b32 v95, 0x80200800, v95
    s_cmp_lg_u32 s40, 3
    s_cbranch_scc1 L_p1_kernel_now_15
    v_mov_b64 v[32:33], v[92:93]
    v_mov_b64 v[34:35], v[94:95]
    s_branch L_p1_kernel_held_16
L_p1_kernel_now_15:
    s_mov_b32 s36, 9437184
    buffer_store_dwordx4 v[92:95], v3, s[20:23], s36 offen sc1
L_p1_kernel_held_16:
    v_lshlrev_b32 v67, 16, v114
    v_and_b32 v114, 0xffff0000, v114
    v_lshlrev_b32 v115, 16, v115
    v_mul_f32 v67, s41, v67
    v_mul_f32 v114, s41, v114
    v_mul_f32 v115, s41, v115
    v_fract_f32 v67, v67
    v_fract_f32 v114, v114
    v_fract_f32 v115, v115
    v_cos_f32 v67, v67
    v_cos_f32 v114, v114
    v_cos_f32 v115, v115
    v_fmaak_f32 v67, v10, v67, 1262486016
    v_fmaak_f32 v114, v10, v114, 1262486016
    v_fmaak_f32 v115, v10, v115, 1262486016
    v_lshlrev_b32 v67, 22, v67
    v_alignbit_b32 v67, v114, v67, 10
    v_alignbit_b32 v67, v115, v67, 10
    v_xor_b32 v67, 0x80200800, v67
    s_cmp_lg_u32 s40, 3
    s_cbranch_scc1 L_p1_kernel_now_17
    v_mov_b64 v[36:37], v[64:65]
    v_mov_b64 v[38:39], v[66:67]
    s_branch L_p1_kernel_held_18
L_p1_kernel_now_17:
    s_mov_b32 s36, 10485760
    buffer_store_dwordx4 v[64:67], v3, s[20:23], s36 offen sc1
L_p1_kernel_held_18:
    s_add_u32 s35, s33, 33554432
    buffer_load_dwordx4 v[92:95], v1, s[8:11], s35 offen nt
    s_add_u32 s35, s33, 33554432
    buffer_load_dwordx4 v[112:115], v1, s[12:15], s35 offen nt
    s_cbranch_vccz L_p1_kernel_thr_19
    s_waitcnt vmcnt(2)
L_p1_kernel_thr_19:
    s_waitcnt vmcnt(15)
    v_perm_b32 v6, v44, v40, s43
    v_perm_b32 v7, v45, v41, s43
    v_perm_b32 v8, v46, v42, s43
    v_perm_b32 v9, v47, v43, s43
    v_mul_hi_u32_u24 v40, 429497, v40
    v_mul_hi_u32_u24 v44, 429497, v44
    v_mul_hi_u32_u24 v41, 429497, v41
    v_mul_hi_u32_u24 v45, 429497, v45
    v_mul_hi_u32_u24 v42, 429497, v42
    v_mul_hi_u32_u24 v46, 429497, v46
    v_mul_hi_u32_u24 v43, 429497, v43
    v_mul_hi_u32_u24 v47, 429497, v47
    v_lshl_or_b32 v40, v44, 16, v40
    v_lshl_or_b32 v41, v45, 16, v41
    v_lshl_or_b32 v42, v46, 16, v42
    v_lshl_or_b32 v43, v47, 16, v43
    v_dot2_u32_u16 v44, v40, s38, 0
    v_dot2_u32_u16 v45, v41, s38, 0
    v_dot2_u32_u16 v46, v42, s38, 0
    v_dot2_u32_u16 v47, v43, s38, 0
    v_pk_mad_u16 v6, v40, s37, v6
    v_pk_mad_u16 v7, v41, s37, v7
    v_pk_mad_u16 v8, v42, s37, v8
    v_pk_mad_u16 v9, v43, s37, v9
    ds_add_u32 v44, v4 offset:0
    ds_add_u32 v45, v4 offset:0
    ds_add_u32 v46, v4 offset:0
    ds_add_u32 v47, v4 offset:0
    v_pk_mad_u16 v6, v40, s52, v6 op_sel:[1,0,0] op_sel_hi:[1,1,1]
    v_pk_mad_u16 v7, v41, s52, v7 op_sel:[1,0,0] op_sel_hi:[1,1,1]
    v_pk_mad_u16 v8, v42, s52, v8 op_sel:[1,0,0] op_sel_hi:[1,1,1]
    v_pk_mad_u16 v9, v43, s52, v9 op_sel:[1,0,0] op_sel_hi:[1,1,1]
    v_perm_b32 v51, v47, v46, s43
    v_perm_b32 v126, v45, v44, s43
    v_or_b32 v62, 0x40000000, v6
    v_or_b32 v64, 0x40000000, v7
    v_or_b32 v65, 0x40000000, v8
    v_or_b32 v66, 0x40000000, v9
    v_lshlrev_b32 v99, 16, v116
    v_and_b32 v116, 0xffff0000, v116
    v_lshlrev_b32 v117, 16, v117
    v_mul_f32 v99, s41, v99
    v_mul_f32 v116, s41, v116
    v_mul_f32 v117, s41, v117
    v_fract_f32 v99, v99
    v_fract_f32 v116, v116
    v_fract_f32 v117, v117
    v_cos_f32 v99, v99
    v_cos_f32 v116, v116
    v_cos_f32 v117, v117
    v_fmaak_f32 v99, v10, v99, 1262486016
    v_fmaak_f32 v116, v10, v116, 1262486016
    v_fmaak_f32 v117, v10, v117, 1262486016
    v_lshlrev_b32 v99, 22, v99
    v_alignbit_b32 v99, v116, v99, 10
    v_alignbit_b32 v99, v117, v99, 10
    v_xor_b32 v99, 0x80200800, v99
    s_cmp_lg_u32 s40, 3
    s_cbranch_scc1 L_p1_kernel_now_20
    v_mov_b64 v[40:41], v[96:97]
    v_mov_b64 v[42:43], v[98:99]
    s_branch L_p1_kernel_held_21
L_p1_kernel_now_20:
    s_mov_b32 s36, 11534336
    buffer_store_dwordx4 v[96:99], v3, s[20:23], s36 offen sc1
L_p1_kernel_held_21:
    v_lshlrev_b32 v71, 16, v118
    v_and_b32 v118, 0xffff0000, v118
    v_lshlrev_b32 v119, 16, v119
    v_mul_f32 v71, s41, v71
    v_mul_f32 v118, s41, v118
    v_mul_f32 v119, s41, v119
    v_fract_f32 v71, v71
    v_fract_f32 v118, v118
    v_fract_f32 v119, v119
    v_cos_f32 v71, v71
    v_cos_f32 v118, v118
    v_cos_f32 v119, v119
    v_fmaak_f32 v71, v10, v71, 1262486016
    v_fmaak_f32 v118, v10, v118, 1262486016
    v_fmaak_f32 v119, v10, v119, 1262486016
    v_lshlrev_b32 v71, 22, v71
    v_alignbit_b32 v71, v118, v71, 10
    v_alignbit_b32 v71, v119, v71, 10
    v_xor_b32 v71, 0x80200800, v71
    s_cmp_lg_u32 s40, 3
    s_cbranch_scc1 L_p1_kernel_now_22
    v_mov_b64 v[44:45], v[68:69]
    v_mov_b64 v[46:47], v[70:71]
    s_branch L_p1_kernel_held_23
L_p1_kernel_now_22:
    s_mov_b32 s36, 12582912
    buffer_store_dwordx4 v[68:71], v3, s[20:23], s36 offen sc1
L_p1_kernel_held_23:
    s_add_u32 s35, s33, 37748736
    s_sub_u32 s35, s35, s48
    v_cndmask_b32 v96, 2.0, v1, s[44:45]
    buffer_load_dwordx4 v[96:99], v96, s[8:11], s35 offen nt
    s_add_u32 s35, s33, 37748736
    s_sub_u32 s35, s35, s48
    v_cndmask_b32 v116, 2.0, v1, s[44:45]
    buffer_load_dwordx4 v[116:119], v116, s[12:15], s35 offen nt
    s_cbranch_vccz L_p1_kernel_thr_24
    s_waitcnt vmcnt(2)
L_p1_kernel_thr_24:
    s_branch L_p1_join
L_p1_first:
    s_add_u32 s35, s33, 20971520
    buffer_load_dwordx4 v[80:83], v1, s[8:11], s35 offen nt
    s_add_u32 s35, s33, 20971520
    buffer_load_dwordx4 v[100:103], v1, s[12:15], s35 offen nt
    s_add_u32 s35, s33, 25165824
    buffer_load_dwordx4 v[84:87], v1, s[8:11], s35 offen nt
    s_add_u32 s35, s33, 25165824
    buffer_load_dwordx4 v[104:107], v1, s[12:15], s35 offen nt
    s_add_u32 s35, s33, 29360128
    buffer_load_dwordx4 v[88:91], v1, s[8:11], s35 offen nt
    s_add_u32 s35, s33, 29360128
    buffer_load_dwordx4 v[108:111], v1, s[12:15], s35 offen nt
    s_add_u32 s35, s33, 33554432
    buffer_load_dwordx4 v[92:95], v1, s[8:11], s35 offen nt
    s_add_u32 s35, s33, 33554432
    buffer_load_dwordx4 v[112:115], v1, s[12:15], s35 offen nt
    s_add_u32 s35, s33, 37748736
    s_sub_u32 s35, s35, s48
    v_cndmask_b32 v96, 2.0, v1, s[44:45]
    buffer_load_dwordx4 v[96:99], v96, s[8:11], s35 offen nt
    s_add_u32 s35, s33, 37748736
    s_sub_u32 s35, s35, s48
    v_cndmask_b32 v116, 2.0, v1, s[44:45]
    buffer_load_dwordx4 v[116:119], v116, s[12:15], s35 offen nt
    s_waitcnt vmcnt(18)
    v_perm_b32 v6, v20, v16, s43
    v_perm_b32 v7, v21, v17, s43
    v_perm_b32 v8, v22, v18, s43
    v_perm_b32 v9, v23, v19, s43
    v_mul_hi_u32_u24 v16, 429497, v16
    v_mul_hi_u32_u24 v20, 429497, v20
    v_mul_hi_u32_u24 v17, 429497, v17
    v_mul_hi_u32_u24 v21, 429497, v21
    v_mul_hi_u32_u24 v18, 429497, v18
    v_mul_hi_u32_u24 v22, 429497, v22
    v_mul_hi_u32_u24 v19, 429497, v19
    v_mul_hi_u32_u24 v23, 429497, v23
    v_lshl_or_b32 v16, v20, 16, v16
    v_lshl_or_b32 v17, v21, 16, v17
    v_lshl_or_b32 v18, v22, 16, v18
    v_lshl_or_b32 v19, v23, 16, v19
    v_dot2_u32_u16 v20, v16, s38, 0
    v_dot2_u32_u16 v21, v17, s38, 0
    v_dot2_u32_u16 v22, v18, s38, 0
    v_dot2_u32_u16 v23, v19, s38, 0
    v_pk_mad_u16 v6, v16, s37, v6
    v_pk_mad_u16 v7, v17, s37, v7
    v_pk_mad_u16 v8, v18, s37, v8
    v_pk_mad_u16 v9, v19, s37, v9
    ds_add_u32 v20, v4 offset:0
    ds_add_u32 v21, v4 offset:0
    ds_add_u32 v22, v4 offset:0
    ds_add_u32 v23, v4 offset:0
    v_pk_mad_u16 v6, v16, s52, v6 op_sel:[1,0,0] op_sel_hi:[1,1,1]
    v_pk_mad_u16 v7, v17, s52, v7 op_sel:[1,0,0] op_sel_hi:[1,1,1]
    v_pk_mad_u16 v8, v18, s52, v8 op_sel:[1,0,0] op_sel_hi:[1,1,1]
    v_pk_mad_u16 v9, v19, s52, v9 op_sel:[1,0,0] op_sel_hi:[1,1,1]
    v_perm_b32 v121, v23, v22, s43
    v_perm_b32 v120, v21, v20, s43
    v_or_b32 v127, 0x40000000, v6
    v_or_b32 v48, 0x40000000, v7
    v_or_b32 v49, 0x40000000, v8
    v_or_b32 v50, 0x40000000, v9
    s_waitcnt vmcnt(16)
    v_perm_b32 v6, v28, v24, s43
    v_perm_b32 v7, v29, v25, s43
    v_perm_b32 v8, v30, v26, s43
    v_perm_b32 v9, v31, v27, s43
    v_mul_hi_u32_u24 v24, 429497, v24
    v_mul_hi_u32_u24 v28, 429497, v28
    v_mul_hi_u32_u24 v25, 429497, v25
    v_mul_hi_u32_u24 v29, 429497, v29
    v_mul_hi_u32_u24 v26, 429497, v26
    v_mul_hi_u32_u24 v30, 429497, v30
    v_mul_hi_u32_u24 v27, 429497, v27
    v_mul_hi_u32_u24 v31, 429497, v31
    v_lshl_or_b32 v24, v28, 16, v24
    v_lshl_or_b32 v25, v29, 16, v25
    v_lshl_or_b32 v26, v30, 16, v26
    v_lshl_or_b32 v27, v31, 16, v27
    v_dot2_u32_u16 v28, v24, s38, 0
    v_dot2_u32_u16 v29, v25, s38, 0
    v_dot2_u32_u16 v30, v26, s38, 0
    v_dot2_u32_u16 v31, v27, s38, 0
    v_pk_mad_u16 v6, v24, s37, v6
    v_pk_mad_u16 v7, v25, s37, v7
    v_pk_mad_u16 v8, v26, s37, v8
    v_pk_mad_u16 v9, v27, s37, v9
    ds_add_u32 v28, v4 offset:0
    ds_add_u32 v29, v4 offset:0
    ds_add_u32 v30, v4 offset:0
    ds_add_u32 v31, v4 offset:0
    v_pk_mad_u16 v6, v24, s52, v6 op_sel:[1,0,0] op_sel_hi:[1,1,1]
    v_pk_mad_u16 v7, v25, s52, v7 op_sel:[1,0,0] op_sel_hi:[1,1,1]
    v_pk_mad_u16 v8, v26, s52, v8 op_sel:[1,0,0] op_sel_hi:[1,1,1]
    v_pk_mad_u16 v9, v27, s52, v9 op_sel:[1,0,0] op_sel_hi:[1,1,1]
    v_perm_b32 v123, v31, v30, s43
    v_perm_b32 v122, v29, v28, s43
    v_or_b32 v52, 0x40000000, v6
    v_or_b32 v53, 0x40000000, v7
    v_or_b32 v54, 0x40000000, v8
    v_or_b32 v56, 0x40000000, v9
    s_waitcnt vmcnt(14)
    v_perm_b32 v6, v36, v32, s43
    v_perm_b32 v7, v37, v33, s43
    v_perm_b32 v8, v38, v34, s43
    v_perm_b32 v9, v39, v35, s43
    v_mul_hi_u32_u24 v32, 429497, v32
    v_mul_hi_u32_u24 v36, 429497, v36
    v_mul_hi_u32_u24 v33, 429497, v33
    v_mul_hi_u32_u24 v37, 429497, v37
    v_mul_hi_u32_u24 v34, 429497, v34
    v_mul_hi_u32_u24 v38, 429497, v38
    v_mul_hi_u32_u24 v35, 429497, v35
    v_mul_hi_u32_u24 v39, 429497, v39
    v_lshl_or_b32 v32, v36, 16, v32
    v_lshl_or_b32 v33, v37, 16, v33
    v_lshl_or_b32 v34, v38, 16, v34
    v_lshl_or_b32 v35, v39, 16, v35
    v_dot2_u32_u16 v36, v32, s38, 0
    v_dot2_u32_u16 v37, v33, s38, 0
    v_dot2_u32_u16 v38, v34, s38, 0
    v_dot2_u32_u16 v39, v35, s38, 0
    v_pk_mad_u16 v6, v32, s37, v6
    v_pk_mad_u16 v7, v33, s37, v7
    v_pk_mad_u16 v8, v34, s37, v8
    v_pk_mad_u16 v9, v35, s37, v9
    ds_add_u32 v36, v4 offset:0
    ds_add_u32 v37, v4 offset:0
    ds_add_u32 v38, v4 offset:0
    ds_add_u32 v39, v4 offset:0
    v_pk_mad_u16 v6, v32, s52, v6 op_sel:[1,0,0] op_sel_hi:[1,1,1]
    v_pk_mad_u16 v7, v33, s52, v7 op_sel:[1,0,0] op_sel_hi:[1,1,1]
    v_pk_mad_u16 v8, v34, s52, v8 op_sel:[1,0,0] op_sel_hi:[1,1,1]
    v_pk_mad_u16 v9, v35, s52, v9 op_sel:[1,0,0] op_sel_hi:[1,1,1]
    v_perm_b32 v125, v39, v38, s43
    v_perm_b32 v124, v37, v36, s43
    v_or_b32 v57, 0x40000000, v6
    v_or_b32 v58, 0x40000000, v7
    v_or_b32 v60, 0x40000000, v8
    v_or_b32 v61, 0x40000000, v9
    s_waitcnt vmcnt(12)
    v_perm_b32 v6, v44, v40, s43
    v_perm_b32 v7, v45, v41, s43
    v_perm_b32 v8, v46, v42, s43
    v_perm_b32 v9, v47, v43, s43
    v_mul_hi_u32_u24 v40, 429497, v40
    v_mul_hi_u32_u24 v44, 429497, v44
    v_mul_hi_u32_u24 v41, 429497, v41
    v_mul_hi_u32_u24 v45, 429497, v45
    v_mul_hi_u32_u24 v42, 429497, v42
    v_mul_hi_u32_u24 v46, 429497, v46
    v_mul_hi_u32_u24 v43, 429497, v43
    v_mul_hi_u32_u24 v47, 429497, v47
    v_lshl_or_b32 v40, v44, 16, v40
    v_lshl_or_b32 v41, v45, 16, v41
    v_lshl_or_b32 v42, v46, 16, v42
    v_lshl_or_b32 v43, v47, 16, v43
    v_dot2_u32_u16 v44, v40, s38, 0
    v_dot2_u32_u16 v45, v41, s38, 0
    v_dot2_u32_u16 v46, v42, s38, 0
    v_dot2_u32_u16 v47, v43, s38, 0
    v_pk_mad_u16 v6, v40, s37, v6
    v_pk_mad_u16 v7, v41, s37, v7
    v_pk_mad_u16 v8, v42, s37, v8
    v_pk_mad_u16 v9, v43, s37, v9
    ds_add_u32 v44, v4 offset:0
    ds_add_u32 v45, v4 offset:0
    ds_add_u32 v46, v4 offset:0
    ds_add_u32 v47, v4 offset:0
    v_pk_mad_u16 v6, v40, s52, v6 op_sel:[1,0,0] op_sel_hi:[1,1,1]
    v_pk_mad_u16 v7, v41, s52, v7 op_sel:[1,0,0] op_sel_hi:[1,1,1]
    v_pk_mad_u16 v8, v42, s52, v8 op_sel:[1,0,0] op_sel_hi:[1,1,1]
    v_pk_mad_u16 v9, v43, s52, v9 op_sel:[1,0,0] op_sel_hi:[1,1,1]
    v_perm_b32 v51, v47, v46, s43
    v_perm_b32 v126, v45, v44, s43
    v_or_b32 v62, 0x40000000, v6
    v_or_b32 v64, 0x40000000, v7
    v_or_b32 v65, 0x40000000, v8
    v_or_b32 v66, 0x40000000, v9
L_p1_join:
    s_waitcnt vmcnt(10)
    v_perm_b32 v6, v76, v72, s43
    v_perm_b32 v7, v77, v73, s43
    v_perm_b32 v8, v78, v74, s43
    v_perm_b32 v9, v79, v75, s43
    v_mul_hi_u32_u24 v72, 429497, v72
    v_mul_hi_u32_u24 v76, 429497, v76
    v_mul_hi_u32_u24 v73, 429497, v73
    v_mul_hi_u32_u24 v77, 429497, v77
    v_mul_hi_u32_u24 v74, 429497, v74
    v_mul_hi_u32_u24 v78, 429497, v78
    v_mul_hi_u32_u24 v75, 429497, v75
    v_mul_hi_u32_u24 v79, 429497, v79
    v_lshl_or_b32 v72, v76, 16, v72
    v_lshl_or_b32 v73, v77, 16, v73
    v_lshl_or_b32 v74, v78, 16, v74
    v_lshl_or_b32 v75, v79, 16, v75
    v_dot2_u32_u16 v76, v72, s38, 0
    v_dot2_u32_u16 v77, v73, s38, 0
    v_dot2_u32_u16 v78, v74, s38, 0
    v_dot2_u32_u16 v79, v75, s38, 0
    v_pk_mad_u16 v6, v72, s37, v6
    v_pk_mad_u16 v7, v73, s37, v7
    v_pk_mad_u16 v8, v74, s37, v8
    v_pk_mad_u16 v9, v75, s37, v9
    ds_add_u32 v76, v4 offset:0
    ds_add_u32 v77, v4 offset:0
    ds_add_u32 v78, v4 offset:0
    ds_add_u32 v79, v4 offset:0
    v_pk_mad_u16 v6, v72, s52, v6 op_sel:[1,0,0] op_sel_hi:[1,1,1]
    v_pk_mad_u16 v7, v73, s52, v7 op_sel:[1,0,0] op_sel_hi:[1,1,1]
    v_pk_mad_u16 v8, v74, s52, v8 op_sel:[1,0,0] op_sel_hi:[1,1,1]
    v_pk_mad_u16 v9, v75, s52, v9 op_sel:[1,0,0] op_sel_hi:[1,1,1]
    v_perm_b32 v59, v79, v78, s43
    v_perm_b32 v55, v77, v76, s43
    v_or_b32 v68, 0x40000000, v6
    v_or_b32 v69, 0x40000000, v7
    v_or_b32 v70, 0x40000000, v8
    v_or_b32 v72, 0x40000000, v9
    s_waitcnt vmcnt(8)
    v_perm_b32 v6, v100, v80, s43
    v_perm_b32 v7, v101, v81, s43
    v_perm_b32 v8, v102, v82, s43
    v_perm_b32 v9, v103, v83, s43
    v_mul_hi_u32_u24 v80, 429497, v80
    v_mul_hi_u32_u24 v100, 429497, v100
    v_mul_hi_u32_u24 v81, 429497, v81
    v_mul_hi_u32_u24 v101, 429497, v101
    v_mul_hi_u32_u24 v82, 429497, v82
    v_mul_hi_u32_u24 v102, 429497, v102
    v_mul_hi_u32_u24 v83, 429497, v83
    v_mul_hi_u32_u24 v103, 429497, v103
    v_lshl_or_b32 v80, v100, 16, v80
    v_lshl_or_b32 v81, v101, 16, v81
    v_lshl_or_b32 v82, v102, 16, v82
    v_lshl_or_b32 v83, v103, 16, v83
    v_dot2_u32_u16 v100, v80, s38, 0
    v_dot2_u32_u16 v101, v81, s38, 0
    v_dot2_u32_u16 v102, v82, s38, 0
    v_dot2_u32_u16 v103, v83, s38, 0
    v_pk_mad_u16 v6, v80, s37, v6
    v_pk_mad_u16 v7, v81, s37, v7
    v_pk_mad_u16 v8, v82, s37, v8
    v_pk_mad_u16 v9, v83, s37, v9
    ds_add_u32 v100, v4 offset:0
    ds_add_u32 v101, v4 offset:0
    ds_add_u32 v102, v4 offset:0
    ds_add_u32 v103, v4 offset:0
    v_pk_mad_u16 v6, v80, s52, v6 op_sel:[1,0,0] op_sel_hi:[1,1,1]
    v_pk_mad_u16 v7, v81, s52, v7 op_sel:[1,0,0] op_sel_hi:[1,1,1]
    v_pk_mad_u16 v8, v82, s52, v8 op_sel:[1,0,0] op_sel_hi:[1,1,1]
    v_pk_mad_u16 v9, v83, s52, v9 op_sel:[1,0,0] op_sel_hi:[1,1,1]
    v_perm_b32 v67, v103, v102, s43
    v_perm_b32 v63, v101, v100, s43
    v_or_b32 v73, 0x40000000, v6
    v_or_b32 v74, 0x40000000, v7
    v_or_b32 v76, 0x40000000, v8
    v_or_b32 v77, 0x40000000, v9
    s_waitcnt vmcnt(6)
    v_perm_b32 v6, v104, v84, s43
    v_perm_b32 v7, v105, v85, s43
    v_perm_b32 v8, v106, v86, s43
    v_perm_b32 v9, v107, v87, s43
    v_mul_hi_u32_u24 v84, 429497, v84
    v_mul_hi_u32_u24 v104, 429497, v104
    v_mul_hi_u32_u24 v85, 429497, v85
    v_mul_hi_u32_u24 v105, 429497, v105
    v_mul_hi_u32_u24 v86, 429497, v86
    v_mul_hi_u32_u24 v106, 429497, v106
    v_mul_hi_u32_u24 v87, 429497, v87
    v_mul_hi_u32_u24 v107, 429497, v107
    v_lshl_or_b32 v84, v104, 16, v84
    v_lshl_or_b32 v85, v105, 16, v85
    v_lshl_or_b32 v86, v106, 16, v86
    v_lshl_or_b32 v87, v107, 16, v87
    v_dot2_u32_u16 v104, v84, s38, 0
    v_dot2_u32_u16 v105, v85, s38, 0
    v_dot2_u32_u16 v106, v86, s38, 0
    v_dot2_u32_u16 v107, v87, s38, 0
    v_pk_mad_u16 v6, v84, s37, v6
    v_pk_mad_u16 v7, v85, s37, v7
    v_pk_mad_u16 v8, v86, s37, v8
    v_pk_mad_u16 v9, v87, s37, v9
    ds_add_u32 v104, v4 offset:0
    ds_add_u32 v105, v4 offset:0
    ds_add_u32 v106, v4 offset:0
    ds_add_u32 v107, v4 offset:0
    v_pk_mad_u16 v6, v84, s52, v6 op_sel:[1,0,0] op_sel_hi:[1,1,1]
    v_pk_mad_u16 v7, v85, s52, v7 op_sel:[1,0,0] op_sel_hi:[1,1,1]
    v_pk_mad_u16 v8, v86, s52, v8 op_sel:[1,0,0] op_sel_hi:[1,1,1]
    v_pk_mad_u16 v9, v87, s52, v9 op_sel:[1,0,0] op_sel_hi:[1,1,1]
    v_perm_b32 v75, v107, v106, s43
    v_perm_b32 v71, v105, v104, s43
    v_or_b32 v78, 0x40000000, v6
    v_or_b32 v80, 0x40000000, v7
    v_or_b32 v81, 0x40000000, v8
    v_or_b32 v82, 0x40000000, v9
    s_waitcnt vmcnt(4)
    v_perm_b32 v6, v108, v88, s43
    v_perm_b32 v7, v109, v89, s43
    v_perm_b32 v8, v110, v90, s43
    v_perm_b32 v9, v111, v91, s43
    v_mul_hi_u32_u24 v88, 429497, v88
    v_mul_hi_u32_u24 v108, 429497, v108
    v_mul_hi_u32_u24 v89, 429497, v89
    v_mul_hi_u32_u24 v109, 429497, v109
    v_mul_hi_u32_u24 v90, 429497, v90
    v_mul_hi_u32_u24 v110, 429497, v110
    v_mul_hi_u32_u24 v91, 429497, v91
    v_mul_hi_u32_u24 v111, 429497, v111
    v_lshl_or_b32 v88, v108, 16, v88
    v_lshl_or_b32 v89, v109, 16, v89
    v_lshl_or_b32 v90, v110, 16, v90
    v_lshl_or_b32 v91, v111, 16, v91
    v_dot2_u32_u16 v108, v88, s38, 0
    v_dot2_u32_u16 v109, v89, s38, 0
    v_dot2_u32_u16 v110, v90, s38, 0
    v_dot2_u32_u16 v111, v91, s38, 0
    v_pk_mad_u16 v6, v88, s37, v6
    v_pk_mad_u16 v7, v89, s37, v7
    v_pk_mad_u16 v8, v90, s37, v8
    v_pk_mad_u16 v9, v91, s37, v9
    ds_add_u32 v108, v4 offset:0
    ds_add_u32 v109, v4 offset:0
    ds_add_u32 v110, v4 offset:0
    ds_add_u32 v111, v4 offset:0
    v_pk_mad_u16 v6, v88, s52, v6 op_sel:[1,0,0] op_sel_hi:[1,1,1]
    v_pk_mad_u16 v7, v89, s52, v7 op_sel:[1,0,0] op_sel_hi:[1,1,1]
    v_pk_mad_u16 v8, v90, s52, v8 op_sel:[1,0,0] op_sel_hi:[1,1,1]
    v_pk_mad_u16 v9, v91, s52, v9 op_sel:[1,0,0] op_sel_hi:[1,1,1]
    v_perm_b32 v83, v111, v110, s43
    v_perm_b32 v79, v109, v108, s43
    v_or_b32 v84, 0x40000000, v6
    v_or_b32 v85, 0x40000000, v7
    v_or_b32 v86, 0x40000000, v8
    v_or_b32 v88, 0x40000000, v9
    s_waitcnt vmcnt(2)
    v_perm_b32 v6, v112, v92, s43
    v_perm_b32 v7, v113, v93, s43
    v_perm_b32 v8, v114, v94, s43
    v_perm_b32 v9, v115, v95, s43
    v_mul_hi_u32_u24 v92, 429497, v92
    v_mul_hi_u32_u24 v112, 429497, v112
    v_mul_hi_u32_u24 v93, 429497, v93
    v_mul_hi_u32_u24 v113, 429497, v113
    v_mul_hi_u32_u24 v94, 429497, v94
    v_mul_hi_u32_u24 v114, 429497, v114
    v_mul_hi_u32_u24 v95, 429497, v95
    v_mul_hi_u32_u24 v115, 429497, v115
    v_lshl_or_b32 v92, v112, 16, v92
    v_lshl_or_b32 v93, v113, 16, v93
    v_lshl_or_b32 v94, v114, 16, v94
    v_lshl_or_b32 v95, v115, 16, v95
    v_dot2_u32_u16 v112, v92, s38, 0
    v_dot2_u32_u16 v113, v93, s38, 0
    v_dot2_u32_u16 v114, v94, s38, 0
    v_dot2_u32_u16 v115, v95, s38, 0
    v_pk_mad_u16 v6, v92, s37, v6
    v_pk_mad_u16 v7, v93, s37, v7
    v_pk_mad_u16 v8, v94, s37, v8
    v_pk_mad_u16 v9, v95, s37, v9
    ds_add_u32 v112, v4 offset:0
    ds_add_u32 v113, v4 offset:0
    ds_add_u32 v114, v4 offset:0
    ds_add_u32 v115, v4 offset:0
    v_pk_mad_u16 v6, v92, s52, v6 op_sel:[1,0,0] op_sel_hi:[1,1,1]
    v_pk_mad_u16 v7, v93, s52, v7 op_sel:[1,0,0] op_sel_hi:[1,1,1]
    v_pk_mad_u16 v8, v94, s52, v8 op_sel:[1,0,0] op_sel_hi:[1,1,1]
    v_pk_mad_u16 v9, v95, s52, v9 op_sel:[1,0,0] op_sel_hi:[1,1,1]
    v_perm_b32 v91, v115, v114, s43
    v_perm_b32 v87, v113, v112, s43
    v_or_b32 v89, 0x40000000, v6
    v_or_b32 v90, 0x40000000, v7
    v_or_b32 v92, 0x40000000, v8
    v_or_b32 v93, 0x40000000, v9
    s_waitcnt vmcnt(0)
    s_mov_b64 exec, s[44:45]
    v_perm_b32 v6, v116, v96, s43
    v_perm_b32 v7, v117, v97, s43
    v_perm_b32 v8, v118, v98, s43
    v_perm_b32 v9, v119, v99, s43
    v_mul_hi_u32_u24 v96, 429497, v96
    v_mul_hi_u32_u24 v116, 429497, v116
    v_mul_hi_u32_u24 v97, 429497, v97
    v_mul_hi_u32_u24 v117, 429497, v117
    v_mul_hi_u32_u24 v98, 429497, v98
    v_mul_hi_u32_u24 v118, 429497, v118
    v_mul_hi_u32_u24 v99, 429497, v99
    v_mul_hi_u32_u24 v119, 429497, v119
    v_lshl_or_b32 v96, v116, 16, v96
    v_lshl_or_b32 v97, v117, 16, v97
    v_lshl_or_b32 v98, v118, 16, v98
    v_lshl_or_b32 v99, v119, 16, v99
    v_dot2_u32_u16 v116, v96, s38, 0
    v_dot2_u32_u16 v117, v97, s38, 0
    v_dot2_u32_u16 v118, v98, s38, 0
    v_dot2_u32_u16 v119, v99, s38, 0
    v_pk_mad_u16 v6, v96, s37, v6
    v_pk_mad_u16 v7, v97, s37, v7
    v_pk_mad_u16 v8, v98, s37, v8
    v_pk_mad_u16 v9, v99, s37, v9
    ds_add_u32 v116, v4 offset:0
    ds_add_u32 v117, v4 offset:0
    ds_add_u32 v118, v4 offset:0
    ds_add_u32 v119, v4 offset:0
    v_pk_mad_u16 v6, v96, s52, v6 op_sel:[1,0,0] op_sel_hi:[1,1,1]
    v_pk_mad_u16 v7, v97, s52, v7 op_sel:[1,0,0] op_sel_hi:[1,1,1]
    v_pk_mad_u16 v8, v98, s52, v8 op_sel:[1,0,0] op_sel_hi:[1,1,1]
    v_pk_mad_u16 v9, v99, s52, v9 op_sel:[1,0,0] op_sel_hi:[1,1,1]
    v_perm_b32 v99, v119, v118, s43
    v_perm_b32 v95, v117, v116, s43
    v_or_b32 v94, 0x40000000, v6
    v_or_b32 v96, 0x40000000, v7
    v_or_b32 v97, 0x40000000, v8
    v_or_b32 v98, 0x40000000, v9
    s_mov_b64 exec, -1
    s_add_u32 s35, s34, 0
    buffer_load_dwordx2 v[100:101], v2, s[16:19], s35 offen nt
    s_lshl_b32 s35, s32, 10
    s_add_u32 s35, s35, 9437184
    s_add_u32 s20, s4, s35
    s_addc_u32 s21, s5, 0
    s_lshl2_add_u32 s35, s39, 160768
    v_mov_b32 v13, s35
    v_mov_b32 v7, 2.0
    v_and_b32 v6, 63, v0
    s_mov_b32 s36, 160768
    s_lshl_b32 s35, 0x1fffe, s39
    s_and_b32 s35, s35, 0x1ffff
    s_mov_b32 exec_hi, 0
    s_mov_b32 exec_lo, s35
    v_lshl_add_u32 v7, v6, 2, s36
    s_mov_b64 exec, -1
    v_mov_b32 v14, 160832
    s_mov_b32 s53, 2
    s_waitcnt lgkmcnt(0)
    s_barrier
    ds_read_b128 v[8:11], v1 offset:0
    s_add_u32 s35, s34, 2097152
    buffer_load_dwordx2 v[102:103], v2, s[16:19], s35 offen nt
L_p1_redo:
    s_waitcnt lgkmcnt(0)
    v_min3_u32 v12, v8, v9, v10
    v_min_u32 v12, v12, v11
    v_cmp_gt_u32 vcc, s53, v12
    s_nop 0
    s_mov_b64 s[46:47], vcc
    s_cbranch_vccz L_p1_kernel_nomask_25
    v_cmp_eq_u32 s[56:57], 0, v8
    v_cmp_ge_u32 s[64:65], 1, v8
    v_max_u32 v8, 2, v8
    v_cmp_eq_u32 s[58:59], 0, v9
    v_cmp_ge_u32 s[66:67], 1, v9
    v_max_u32 v9, 2, v9
    v_cmp_eq_u32 s[60:61], 0, v10
    v_cmp_ge_u32 s[68:69], 1, v10
    v_max_u32 v10, 2, v10
    v_cmp_eq_u32 s[62:63], 0, v11
    v_cmp_ge_u32 s[70:71], 1, v11
    v_max_u32 v11, 2, v11
L_p1_kernel_nomask_25:
    v_add_u32 v9, v8, v9
    v_add_u32 v10, v9, v10
    v_add_u32 v11, v10, v11
    s_nop 1
    v_add_u32_dpp v6, v11, v11 row_shr:1 row_mask:0xf bank_mask:0xf bound_ctrl:0
    s_nop 1
    v_add_u32_dpp v6, v6, v6 row_shr:2 row_mask:0xf bank_mask:0xf bound_ctrl:0
    s_nop 1
    v_add_u32_dpp v6, v6, v6 row_shr:4 row_mask:0xf bank_mask:0xf bound_ctrl:0
    s_nop 1
    v_add_u32_dpp v6, v6, v6 row_shr:8 row_mask:0xf bank_mask:0xf bound_ctrl:0
    s_nop 1
    v_add_u32_dpp v6, v6, v6 row_bcast:15 row_mask:0xa bank_mask:0xf
    s_nop 1
    v_add_u32_dpp v6, v6, v6 row_bcast:31 row_mask:0xc bank_mask:0xf
    s_nop 0
    v_readlane_b32 s35, v6, 63
    v_sub_u32 v6, v6, v11
    v_add_u32 v8, v8, v6
    v_mov_b32 v12, s35
    ds_add_u32 v7, v12
    v_add_u32 v9, v9, v6
    v_add_u32 v10, v10, v6
    s_waitcnt lgkmcnt(0)
    s_barrier
    ds_read_b32 v12, v14
    ds_read_b32 v11, v13
    s_add_u32 s35, s34, 4194304
    buffer_load_dwordx2 v[104:105], v2, s[16:19], s35 offen nt
    s_waitcnt lgkmcnt(1)
    v_readfirstlane_b32 s54, v12
    s_waitcnt lgkmcnt(0)
    s_cmp_ge_u32 s54, 40063
    s_cbranch_scc0 L_p1_fits
    s_barrier
    v_mov_b32 v12, 0
    ds_write_b32 v7, v12
    s_mov_b32 s53, 0
    s_mov_b32 s55, 1
    s_waitcnt lgkmcnt(0)
    s_barrier
    ds_read_b128 v[8:11], v1 offset:0
    s_branch L_p1_redo
L_p1_fits:
    s_mov_b64 exec, 1
    v_mov_b32 v7, 24576
    ds_write_b16 v7, v12
    s_mov_b64 exec, -1
    v_add_u32 v12, v11, v6
    v_add_u32 v13, v11, v8
    v_add_u32 v14, v11, v9
    v_add_u32 v15, v11, v10
    ds_write_b128 v1, v[12:15] offset:0
    s_add_u32 s35, s54, 2
    s_mul_hi_u32 s35, s35, 1431655766
    v_perm_b32 v15, v15, v14, s43
    v_perm_b32 v14, v13, v12, s43
    ds_write_b64 v2, v[14:15] offset:16384
    s_lshl_b32 s35, s35, 4
    s_add_u32 s35, s35, 217890816
    s_min_u32 s22, s35, 218104832
    s_waitcnt lgkmcnt(0)
    s_barrier
    s_nop 0
    v_and_b32 v6, 0xffff, v120
    v_lshrrev_b32 v7, 16, v120
    v_and_b32 v8, 0xffff, v121
    v_lshrrev_b32 v9, 16, v121
    ds_add_rtn_u32 v6, v6, v4 offset:0
    ds_add_rtn_u32 v7, v7, v4 offset:0
    ds_add_rtn_u32 v8, v8, v4 offset:0
    ds_add_rtn_u32 v9, v9, v4 offset:0
    v_and_b32 v10, 0xffff, v122
    v_lshrrev_b32 v11, 16, v122
    v_and_b32 v12, 0xffff, v123
    v_lshrrev_b32 v13, 16, v123
    ds_add_rtn_u32 v10, v10, v4 offset:0
    ds_add_rtn_u32 v11, v11, v4 offset:0
    ds_add_rtn_u32 v12, v12, v4 offset:0
    ds_add_rtn_u32 v13, v13, v4 offset:0
    s_waitcnt lgkmcnt(4)
    v_perm_b32 v120, v7, v6, s43
    v_perm_b32 v121, v9, v8, s43
    v_and_b32 v6, 0xffff, v124
    v_lshrrev_b32 v7, 16, v124
    v_and_b32 v8, 0xffff, v125
    v_lshrrev_b32 v9, 16, v125
    ds_add_rtn_u32 v6, v6, v4 offset:0
    ds_add_rtn_u32 v7, v7, v4 offset:0
    ds_add_rtn_u32 v8, v8, v4 offset:0
    ds_add_rtn_u32 v9, v9, v4 offset:0
    s_waitcnt lgkmcnt(4)
    v_perm_b32 v122, v11, v10, s43
    v_perm_b32 v123, v13, v12, s43
    s_add_u32 s35, s34, 6291456
    buffer_load_dwordx2 v[106:107], v2, s[16:19], s35 offen nt
    v_and_b32 v10, 0xffff, v126
    v_lshrrev_b32 v11, 16, v126
    v_and_b32 v12, 0xffff, v51
    v_lshrrev_b32 v13, 16, v51
    ds_add_rtn_u32 v10, v10, v4 offset:0
    ds_add_rtn_u32 v11, v11, v4 offset:0
    ds_add_rtn_u32 v12, v12, v4 offset:0
    ds_add_rtn_u32 v13, v13, v4 offset:0
    s_waitcnt lgkmcnt(4)
    v_perm_b32 v124, v7, v6, s43
    v_perm_b32 v125, v9, v8, s43
    s_add_u32 s35, s34, 8388608
    buffer_load_dwordx2 v[108:109], v2, s[16:19], s35 offen nt
    v_and_b32 v6, 0xffff, v55
    v_lshrrev_b32 v7, 16, v55
    v_and_b32 v8, 0xffff, v59
    v_lshrrev_b32 v9, 16, v59
    ds_add_rtn_u32 v6, v6, v4 offset:0
    ds_add_rtn_u32 v7, v7, v4 offset:0
    ds_add_rtn_u32 v8, v8, v4 offset:0
    ds_add_rtn_u32 v9, v9, v4 offset:0
    s_waitcnt lgkmcnt(4)
    v_perm_b32 v126, v11, v10, s43
    v_perm_b32 v51, v13, v12, s43
    s_add_u32 s35, s34, 10485760
    buffer_load_dwordx2 v[110:111], v2, s[16:19], s35 offen nt
    v_and_b32 v10, 0xffff, v63
    v_lshrrev_b32 v11, 16, v63
    v_and_b32 v12, 0xffff, v67
    v_lshrrev_b32 v13, 16, v67
    ds_add_rtn_u32 v10, v10, v4 offset:0
    ds_add_rtn_u32 v11, v11, v4 offset:0
    ds_add_rtn_u32 v12, v12, v4 offset:0
    ds_add_rtn_u32 v13, v13, v4 offset:0
    s_waitcnt lgkmcnt(4)
    v_perm_b32 v55, v7, v6, s43
    v_perm_b32 v59, v9, v8, s43
    v_and_b32 v6, 0xffff, v71
    v_lshrrev_b32 v7, 16, v71
    v_and_b32 v8, 0xffff, v75
    v_lshrrev_b32 v9, 16, v75
    ds_add_rtn_u32 v6, v6, v4 offset:0
    ds_add_rtn_u32 v7, v7, v4 offset:0
    ds_add_rtn_u32 v8, v8, v4 offset:0
    ds_add_rtn_u32 v9, v9, v4 offset:0
    s_waitcnt lgkmcnt(4)
    v_perm_b32 v63, v11, v10, s43
    v_perm_b32 v67, v13, v12, s43
    s_add_u32 s35, s34, 12582912
    buffer_load_dwordx2 v[112:113], v2, s[16:19], s35 offen nt
    v_and_b32 v10, 0xffff, v79
    v_lshrrev_b32 v11, 16, v79
    v_and_b32 v12, 0xffff, v83
    v_lshrrev_b32 v13, 16, v83
    ds_add_rtn_u32 v10, v10, v4 offset:0
    ds_add_rtn_u32 v11, v11, v4 offset:0
    ds_add_rtn_u32 v12, v12, v4 offset:0
    ds_add_rtn_u32 v13, v13, v4 offset:0
    s_waitcnt lgkmcnt(4)
    v_perm_b32 v71, v7, v6, s43
    v_perm_b32 v75, v9, v8, s43
    s_add_u32 s35, s34, 14680064
    buffer_load_dwordx2 v[114:115], v2, s[16:19], s35 offen nt
    v_and_b32 v6, 0xffff, v87
    v_lshrrev_b32 v7, 16, v87
    v_and_b32 v8, 0xffff, v91
    v_lshrrev_b32 v9, 16, v91
    ds_add_rtn_u32 v6, v6, v4 offset:0
    ds_add_rtn_u32 v7, v7, v4 offset:0
    ds_add_rtn_u32 v8, v8, v4 offset:0
    ds_add_rtn_u32 v9, v9, v4 offset:0
    s_waitcnt lgkmcnt(4)
    v_perm_b32 v79, v11, v10, s43
    v_perm_b32 v83, v13, v12, s43
    s_add_u32 s35, s34, 16777216
    buffer_load_dwordx2 v[116:117], v2, s[16:19], s35 offen nt
    s_mov_b64 exec, s[44:45]
    v_and_b32 v10, 0xffff, v95
    v_lshrrev_b32 v11, 16, v95
    v_and_b32 v12, 0xffff, v99
    v_lshrrev_b32 v13, 16, v99
    ds_add_rtn_u32 v10, v10, v4 offset:0
    ds_add_rtn_u32 v11, v11, v4 offset:0
    ds_add_rtn_u32 v12, v12, v4 offset:0
    ds_add_rtn_u32 v13, v13, v4 offset:0
    s_mov_b64 exec, -1
    s_waitcnt lgkmcnt(4)
    v_perm_b32 v87, v7, v6, s43
    v_perm_b32 v91, v9, v8, s43
    s_add_u32 s35, s34, 18874368
    s_sub_u32 s35, s35, s49
    v_cndmask_b32 v118, 2.0, v2, s[44:45]
    buffer_load_dwordx2 v[118:119], v118, s[16:19], s35 offen nt
    s_waitcnt lgkmcnt(0)
    v_perm_b32 v95, v11, v10, s43
    v_perm_b32 v99, v13, v12, s43
    s_cmp_gt_u32 s39, 8
    s_cbranch_scc1 L_p1_kernel_notab_26
    v_lshrrev_b32 v6, 1, v0
    v_mul_u32_u24 v7, 1009, v6
    v_lshrrev_b32 v7, 16, v7
    v_mul_u32_u24 v7, 959, v7
    v_and_b32 v8, 1, v0
    v_lshl_add_u32 v7, v8, 9, v7
    v_add_lshl_u32 v13, v7, v6, 1
    ds_read_u16 v6, v13 offset:16384
    ds_read_u16 v7, v13 offset:16512
    ds_read_u16 v8, v13 offset:16640
    ds_read_u16 v9, v13 offset:16768
    ds_read_u16 v10, v13 offset:16896
    ds_read_u16 v11, v13 offset:17024
    ds_read_u16 v12, v13 offset:17152
    ds_read_u16 v13, v13 offset:17280
    s_mul_i32 s35, s32, 8320
    s_add_u32 s26, s35, 8320
    s_waitcnt lgkmcnt(6)
    v_perm_b32 v6, v7, v6, s43
    s_waitcnt lgkmcnt(4)
    v_perm_b32 v7, v9, v8, s43
    s_waitcnt lgkmcnt(2)
    v_perm_b32 v8, v11, v10, s43
    s_waitcnt lgkmcnt(0)
    v_perm_b32 v9, v13, v12, s43
    buffer_store_dwordx4 v[6:9], v1, s[24:27], s35 offen sc1
    s_nop 1
L_p1_kernel_notab_26:
    s_barrier
    s_lshl_b32 s35, s54, 2
    v_mov_b32 v6, s35
    v_mov_b32 v7, 0
    v_mov_b32 v12, 1140817920
    s_mov_b64 exec, 1
    ds_write2_b32 v6, v7, v7 offset0:0 offset1:1
    s_cmp_eq_u64 s[46:47], 0
    s_cbranch_scc1 L_p1_kernel_nonull_27
    s_mov_b64 exec, s[64:65]
    v_lshlrev_b32_sdwa v6, 2, v14 dst_sel:DWORD dst_unused:UNUSED_PAD src0_sel:DWORD src1_sel:WORD_0
    ds_write_b32 v6, v7 offset:4
    s_mov_b64 exec, s[56:57]
    ds_write_b32 v6, v7
    s_mov_b64 exec, s[66:67]
    v_lshlrev_b32_sdwa v6, 2, v14 dst_sel:DWORD dst_unused:UNUSED_PAD src0_sel:DWORD src1_sel:WORD_1
    ds_write_b32 v6, v7 offset:4
    s_mov_b64 exec, s[58:59]
    ds_write_b32 v6, v7
    s_mov_b64 exec, s[68:69]
    v_lshlrev_b32_sdwa v6, 2, v15 dst_sel:DWORD dst_unused:UNUSED_PAD src0_sel:DWORD src1_sel:WORD_0
    ds_write_b32 v6, v7 offset:4
    s_mov_b64 exec, s[60:61]
    ds_write_b32 v6, v7
    s_mov_b64 exec, s[70:71]
    v_lshlrev_b32_sdwa v6, 2, v15 dst_sel:DWORD dst_unused:UNUSED_PAD src0_sel:DWORD src1_sel:WORD_1
    ds_write_b32 v6, v7 offset:4
    s_mov_b64 exec, s[62:63]
    ds_write_b32 v6, v7
L_p1_kernel_nonull_27:
    s_mov_b64 exec, -1
    v_lshlrev_b32_sdwa v6, 2, v120 dst_sel:DWORD dst_unused:UNUSED_PAD src0_sel:DWORD src1_sel:WORD_0
    v_lshlrev_b32_sdwa v7, 2, v120 dst_sel:DWORD dst_unused:UNUSED_PAD src0_sel:DWORD src1_sel:WORD_1
    v_lshlrev_b32_sdwa v8, 2, v121 dst_sel:DWORD dst_unused:UNUSED_PAD src0_sel:DWORD src1_sel:WORD_0
    v_lshlrev_b32_sdwa v9, 2, v121 dst_sel:DWORD dst_unused:UNUSED_PAD src0_sel:DWORD src1_sel:WORD_1
    ds_write_b32 v6, v127
    ds_write_b32 v7, v48
    ds_write_b32 v8, v49
    ds_write_b32 v9, v50
    s_cmp_lg_u32 s40, 3
    s_cbranch_scc1 L_p1_kernel_ld_28
    s_mov_b32 s36, 4194304
    buffer_store_dwordx4 v[16:19], v3, s[72:75], s36 offen sc1
    s_branch L_p1_kernel_st_29
L_p1_kernel_ld_28:
    s_add_u32 s35, s33, 40960000
    buffer_load_dwordx4 v[16:19], v1, s[8:11], s35 offen nt
L_p1_kernel_st_29:
    v_lshlrev_b32_sdwa v6, 2, v122 dst_sel:DWORD dst_unused:UNUSED_PAD src0_sel:DWORD src1_sel:WORD_0
    v_lshlrev_b32_sdwa v7, 2, v122 dst_sel:DWORD dst_unused:UNUSED_PAD src0_sel:DWORD src1_sel:WORD_1
    v_lshlrev_b32_sdwa v8, 2, v123 dst_sel:DWORD dst_unused:UNUSED_PAD src0_sel:DWORD src1_sel:WORD_0
    v_lshlrev_b32_sdwa v9, 2, v123 dst_sel:DWORD dst_unused:UNUSED_PAD src0_sel:DWORD src1_sel:WORD_1
    ds_write_b32 v6, v52
    ds_write_b32 v7, v53
    ds_write_b32 v8, v54
    ds_write_b32 v9, v56
    v_lshlrev_b32_sdwa v6, 2, v124 dst_sel:DWORD dst_unused:UNUSED_PAD src0_sel:DWORD src1_sel:WORD_0
    v_lshlrev_b32_sdwa v7, 2, v124 dst_sel:DWORD dst_unused:UNUSED_PAD src0_sel:DWORD src1_sel:WORD_1
    v_lshlrev_b32_sdwa v8, 2, v125 dst_sel:DWORD dst_unused:UNUSED_PAD src0_sel:DWORD src1_sel:WORD_0
    v_lshlrev_b32_sdwa v9, 2, v125 dst_sel:DWORD dst_unused:UNUSED_PAD src0_sel:DWORD src1_sel:WORD_1
    ds_write_b32 v6, v57
    ds_write_b32 v7, v58
    ds_write_b32 v8, v60
    ds_write_b32 v9, v61
    v_lshlrev_b32_sdwa v6, 2, v126 dst_sel:DWORD dst_unused:UNUSED_PAD src0_sel:DWORD src1_sel:WORD_0
    v_lshlrev_b32_sdwa v7, 2, v126 dst_sel:DWORD dst_unused:UNUSED_PAD src0_sel:DWORD src1_sel:WORD_1
    v_lshlrev_b32_sdwa v8, 2, v51 dst_sel:DWORD dst_unused:UNUSED_PAD src0_sel:DWORD src1_sel:WORD_0
    v_lshlrev_b32_sdwa v9, 2, v51 dst_sel:DWORD dst_unused:UNUSED_PAD src0_sel:DWORD src1_sel:WORD_1
    ds_write_b32 v6, v62
    ds_write_b32 v7, v64
    ds_write_b32 v8, v65
    ds_write_b32 v9, v66
    s_cmp_lg_u32 s40, 3
    s_cbranch_scc1 L_p1_kernel_ld_30
    s_mov_b32 s36, 6291456
    buffer_store_dwordx4 v[20:23], v3, s[72:75], s36 offen sc1
    s_branch L_p1_kernel_st_31
L_p1_kernel_ld_30:
    s_add_u32 s35, s33, 40960000
    buffer_load_dwordx4 v[20:23], v1, s[12:15], s35 offen nt
L_p1_kernel_st_31:
    v_lshlrev_b32_sdwa v6, 2, v55 dst_sel:DWORD dst_unused:UNUSED_PAD src0_sel:DWORD src1_sel:WORD_0
    v_lshlrev_b32_sdwa v7, 2, v55 dst_sel:DWORD dst_unused:UNUSED_PAD src0_sel:DWORD src1_sel:WORD_1
    v_lshlrev_b32_sdwa v8, 2, v59 dst_sel:DWORD dst_unused:UNUSED_PAD src0_sel:DWORD src1_sel:WORD_0
    v_lshlrev_b32_sdwa v9, 2, v59 dst_sel:DWORD dst_unused:UNUSED_PAD src0_sel:DWORD src1_sel:WORD_1
    ds_write_b32 v6, v68
    ds_write_b32 v7, v69
    ds_write_b32 v8, v70
    ds_write_b32 v9, v72
    v_lshlrev_b32_sdwa v6, 2, v63 dst_sel:DWORD dst_unused:UNUSED_PAD src0_sel:DWORD src1_sel:WORD_0
    v_lshlrev_b32_sdwa v7, 2, v63 dst_sel:DWORD dst_unused:UNUSED_PAD src0_sel:DWORD src1_sel:WORD_1
    v_lshlrev_b32_sdwa v8, 2, v67 dst_sel:DWORD dst_unused:UNUSED_PAD src0_sel:DWORD src1_sel:WORD_0
    v_lshlrev_b32_sdwa v9, 2, v67 dst_sel:DWORD dst_unused:UNUSED_PAD src0_sel:DWORD src1_sel:WORD_1
    ds_write_b32 v6, v73
    ds_write_b32 v7, v74
    ds_write_b32 v8, v76
    ds_write_b32 v9, v77
    v_lshlrev_b32_sdwa v6, 2, v71 dst_sel:DWORD dst_unused:UNUSED_PAD src0_sel:DWORD src1_sel:WORD_0
    v_lshlrev_b32_sdwa v7, 2, v71 dst_sel:DWORD dst_unused:UNUSED_PAD src0_sel:DWORD src1_sel:WORD_1
    v_lshlrev_b32_sdwa v8, 2, v75 dst_sel:DWORD dst_unused:UNUSED_PAD src0_sel:DWORD src1_sel:WORD_0
    v_lshlrev_b32_sdwa v9, 2, v75 dst_sel:DWORD dst_unused:UNUSED_PAD src0_sel:DWORD src1_sel:WORD_1
    ds_write_b32 v6, v78
    ds_write_b32 v7, v80
    ds_write_b32 v8, v81
    ds_write_b32 v9, v82
    s_cmp_lg_u32 s40, 3
    s_cbranch_scc1 L_p1_kernel_ld_32
    s_mov_b32 s36, 7340032
    buffer_store_dwordx4 v[24:27], v3, s[72:75], s36 offen sc1
    s_branch L_p1_kernel_st_33
L_p1_kernel_ld_32:
    s_add_u32 s35, s33, 45154304
    buffer_load_dwordx4 v[24:27], v1, s[8:11], s35 offen nt
L_p1_kernel_st_33:
    v_lshlrev_b32_sdwa v6, 2, v79 dst_sel:DWORD dst_unused:UNUSED_PAD src0_sel:DWORD src1_sel:WORD_0
    v_lshlrev_b32_sdwa v7, 2, v79 dst_sel:DWORD dst_unused:UNUSED_PAD src0_sel:DWORD src1_sel:WORD_1
    v_lshlrev_b32_sdwa v8, 2, v83 dst_sel:DWORD dst_unused:UNUSED_PAD src0_sel:DWORD src1_sel:WORD_0
    v_lshlrev_b32_sdwa v9, 2, v83 dst_sel:DWORD dst_unused:UNUSED_PAD src0_sel:DWORD src1_sel:WORD_1
    ds_write_b32 v6, v84
    ds_write_b32 v7, v85
    ds_write_b32 v8, v86
    ds_write_b32 v9, v88
    v_lshlrev_b32_sdwa v6, 2, v87 dst_sel:DWORD dst_unused:UNUSED_PAD src0_sel:DWORD src1_sel:WORD_0
    v_lshlrev_b32_sdwa v7, 2, v87 dst_sel:DWORD dst_unused:UNUSED_PAD src0_sel:DWORD src1_sel:WORD_1
    v_lshlrev_b32_sdwa v8, 2, v91 dst_sel:DWORD dst_unused:UNUSED_PAD src0_sel:DWORD src1_sel:WORD_0
    v_lshlrev_b32_sdwa v9, 2, v91 dst_sel:DWORD dst_unused:UNUSED_PAD src0_sel:DWORD src1_sel:WORD_1
    ds_write_b32 v6, v89
    ds_write_b32 v7, v90
    ds_write_b32 v8, v92
    ds_write_b32 v9, v93
    s_mov_b64 exec, s[44:45]
    v_lshlrev_b32_sdwa v6, 2, v95 dst_sel:DWORD dst_unused:UNUSED_PAD src0_sel:DWORD src1_sel:WORD_0
    v_lshlrev_b32_sdwa v7, 2, v95 dst_sel:DWORD dst_unused:UNUSED_PAD src0_sel:DWORD src1_sel:WORD_1
    v_lshlrev_b32_sdwa v8, 2, v99 dst_sel:DWORD dst_unused:UNUSED_PAD src0_sel:DWORD src1_sel:WORD_0
    v_lshlrev_b32_sdwa v9, 2, v99 dst_sel:DWORD dst_unused:UNUSED_PAD src0_sel:DWORD src1_sel:WORD_1
    ds_write_b32 v6, v94
    ds_write_b32 v7, v96
    ds_write_b32 v8, v97
    ds_write_b32 v9, v98
    s_mov_b64 exec, -1
    s_cmp_lg_u32 s40, 3
    s_cbranch_scc1 L_p1_kernel_ld_34
    s_mov_b32 s36, 8388608
    buffer_store_dwordx4 v[28:31], v3, s[72:75], s36 offen sc1
    s_branch L_p1_kernel_st_35
L_p1_kernel_ld_34:
    s_add_u32 s35, s33, 45154304
    buffer_load_dwordx4 v[28:31], v1, s[12:15], s35 offen nt
L_p1_kernel_st_35:
    s_mul_i32 s35, s39, 9216
    v_mad_u32_u24 v6, v0, 12, s35
    s_waitcnt lgkmcnt(0)
    s_barrier
    s_cmp_lg_u32 s39, 15
    s_cbranch_scc1 L_p1_kernel_nox_36
    ds_read_b32 v12, v6 offset:9984
    ds_read_b32 v13, v6 offset:9988
    ds_read_b32 v14, v6 offset:9992
L_p1_kernel_nox_36:
    ds_read_b32 v48, v6 offset:1536
    ds_read_b32 v49, v6 offset:1540
    ds_read_b32 v50, v6 offset:1544
    ds_read_b32 v52, v6 offset:3072
    ds_read_b32 v53, v6 offset:3076
    ds_read_b32 v54, v6 offset:3080
    ds_read_b32 v56, v6 offset:4608
    ds_read_b32 v57, v6 offset:4612
    ds_read_b32 v58, v6 offset:4616
    ds_read_b32 v60, v6 offset:6144
    ds_read_b32 v61, v6 offset:6148
    ds_read_b32 v62, v6 offset:6152
    ds_read_b32 v64, v6 offset:7680
    ds_read_b32 v65, v6 offset:7684
    ds_read_b32 v66, v6 offset:7688
    ds_read_b32 v68, v6 offset:9216
    ds_read_b32 v69, v6 offset:9220
    ds_read_b32 v70, v6 offset:9224
    ds_read_b32 v72, v6 offset:0
    ds_read_b32 v73, v6 offset:4
    ds_read_b32 v74, v6 offset:8
    ds_read_b32 v76, v6 offset:768
    ds_read_b32 v77, v6 offset:772
    ds_read_b32 v78, v6 offset:776
    ds_read_b32 v80, v6 offset:2304
    ds_read_b32 v81, v6 offset:2308
    ds_read_b32 v82, v6 offset:2312
    ds_read_b32 v84, v6 offset:3840
    ds_read_b32 v85, v6 offset:3844
    ds_read_b32 v86, v6 offset:3848
    ds_read_b32 v88, v6 offset:5376
    ds_read_b32 v89, v6 offset:5380
    ds_read_b32 v90, v6 offset:5384
    ds_read_b32 v92, v6 offset:6912
    ds_read_b32 v93, v6 offset:6916
    ds_read_b32 v94, v6 offset:6920
    ds_read_b32 v96, v6 offset:8448
    ds_read_b32 v97, v6 offset:8452
    ds_read_b32 v98, v6 offset:8456
    s_cmp_lg_u32 s40, 3
    s_cbranch_scc1 L_p1_kernel_ld_37
    s_mov_b32 s36, 9437184
    buffer_store_dwordx4 v[32:35], v3, s[72:75], s36 offen sc1
    s_branch L_p1_kernel_st_38
L_p1_kernel_ld_37:
    s_add_u32 s35, s33, 49348608
    buffer_load_dwordx4 v[32:35], v1, s[8:11], s35 offen nt
L_p1_kernel_st_38:
    v_mov_b32 v8, 0
    v_mov_b32 v9, 0
    v_mov_b32 v10, 0
    v_mov_b32 v11, 0
    v_mov_b32 v15, 16384
    v_min_u32 v7, 16, v0
    v_lshlrev_b32 v7, 2, v7
    v_add_u32 v7, 160768, v7
    s_waitcnt lgkmcnt(0)
    s_barrier
    ds_write_b128 v1, v[8:11] offset:0
    ds_write_b32 v7, v8
    s_nop 1
    v_mov_b32 v6, 1140817920
    s_waitcnt vmcnt(14)
    v_pk_maximum3_f16 v5, v100, v101, v5
    v_mad_u32_u16 v6, v120, s50, v15 op_sel:[0,0,0,0]
    v_mad_u32_u16 v7, v120, s50, v15 op_sel:[1,0,0,0]
    v_mad_u32_u16 v8, v121, s50, v15 op_sel:[0,0,0,0]
    v_mad_u32_u16 v9, v121, s50, v15 op_sel:[1,0,0,0]
    v_add_u32_sdwa v6, v6, v120 dst_sel:DWORD dst_unused:UNUSED_PAD src0_sel:WORD_1 src1_sel:WORD_0
    v_add_u32_sdwa v7, v7, v120 dst_sel:DWORD dst_unused:UNUSED_PAD src0_sel:WORD_1 src1_sel:WORD_1
    v_add_u32_sdwa v8, v8, v121 dst_sel:DWORD dst_unused:UNUSED_PAD src0_sel:WORD_1 src1_sel:WORD_0
    v_add_u32_sdwa v9, v9, v121 dst_sel:DWORD dst_unused:UNUSED_PAD src0_sel:WORD_1 src1_sel:WORD_1
    v_add_u32 v6, v6, v6
    v_add_u32 v7, v7, v7
    v_add_u32 v8, v8, v8
    v_add_u32 v9, v9, v9
    ds_write_b16 v6, v100 offset:16384
    ds_write_b16_d16_hi v7, v100 offset:16384
    ds_write_b16 v8, v101 offset:16384
    ds_write_b16_d16_hi v9, v101 offset:16384
    v_mov_b32 v6, 1140817920
    s_waitcnt vmcnt(13)
    v_pk_maximum3_f16 v5, v102, v103, v5
    v_mad_u32_u16 v6, v122, s50, v15 op_sel:[0,0,0,0]
    v_mad_u32_u16 v7, v122, s50, v15 op_sel:[1,0,0,0]
    v_mad_u32_u16 v8, v123, s50, v15 op_sel:[0,0,0,0]
    v_mad_u32_u16 v9, v123, s50, v15 op_sel:[1,0,0,0]
    v_add_u32_sdwa v6, v6, v122 dst_sel:DWORD dst_unused:UNUSED_PAD src0_sel:WORD_1 src1_sel:WORD_0
    v_add_u32_sdwa v7, v7, v122 dst_sel:DWORD dst_unused:UNUSED_PAD src0_sel:WORD_1 src1_sel:WORD_1
    v_add_u32_sdwa v8, v8, v123 dst_sel:DWORD dst_unused:UNUSED_PAD src0_sel:WORD_1 src1_sel:WORD_0
    v_add_u32_sdwa v9, v9, v123 dst_sel:DWORD dst_unused:UNUSED_PAD src0_sel:WORD_1 src1_sel:WORD_1
    v_add_u32 v6, v6, v6
    v_add_u32 v7, v7, v7
    v_add_u32 v8, v8, v8
    v_add_u32 v9, v9, v9
    ds_write_b16 v6, v102 offset:16384
    ds_write_b16_d16_hi v7, v102 offset:16384
    ds_write_b16 v8, v103 offset:16384
    ds_write_b16_d16_hi v9, v103 offset:16384
    v_mov_b32 v6, 1140817920
    s_waitcnt vmcnt(12)
    v_pk_maximum3_f16 v5, v104, v105, v5
    v_mad_u32_u16 v6, v124, s50, v15 op_sel:[0,0,0,0]
    v_mad_u32_u16 v7, v124, s50, v15 op_sel:[1,0,0,0]
    v_mad_u32_u16 v8, v125, s50, v15 op_sel:[0,0,0,0]
    v_mad_u32_u16 v9, v125, s50, v15 op_sel:[1,0,0,0]
    v_add_u32_sdwa v6, v6, v124 dst_sel:DWORD dst_unused:UNUSED_PAD src0_sel:WORD_1 src1_sel:WORD_0
    v_add_u32_sdwa v7, v7, v124 dst_sel:DWORD dst_unused:UNUSED_PAD src0_sel:WORD_1 src1_sel:WORD_1
    v_add_u32_sdwa v8, v8, v125 dst_sel:DWORD dst_unused:UNUSED_PAD src0_sel:WORD_1 src1_sel:WORD_0
    v_add_u32_sdwa v9, v9, v125 dst_sel:DWORD dst_unused:UNUSED_PAD src0_sel:WORD_1 src1_sel:WORD_1
    v_add_u32 v6, v6, v6
    v_add_u32 v7, v7, v7
    v_add_u32 v8, v8, v8
    v_add_u32 v9, v9, v9
    ds_write_b16 v6, v104 offset:16384
    ds_write_b16_d16_hi v7, v104 offset:16384
    ds_write_b16 v8, v105 offset:16384
    ds_write_b16_d16_hi v9, v105 offset:16384
    s_cmp_lg_u32 s40, 3
    s_cbranch_scc1 L_p1_kernel_ld_39
    s_mov_b32 s36, 10485760
    buffer_store_dwordx4 v[36:39], v3, s[72:75], s36 offen sc1
    s_branch L_p1_kernel_st_40
L_p1_kernel_ld_39:
    s_add_u32 s35, s33, 49348608
    buffer_load_dwordx4 v[36:39], v1, s[12:15], s35 offen nt
L_p1_kernel_st_40:
    v_mov_b32 v6, 1140817920
    s_waitcnt vmcnt(12)
    v_pk_maximum3_f16 v5, v106, v107, v5
    v_mad_u32_u16 v6, v126, s50, v15 op_sel:[0,0,0,0]
    v_mad_u32_u16 v7, v126, s50, v15 op_sel:[1,0,0,0]
    v_mad_u32_u16 v8, v51, s50, v15 op_sel:[0,0,0,0]
    v_mad_u32_u16 v9, v51, s50, v15 op_sel:[1,0,0,0]
    v_add_u32_sdwa v6, v6, v126 dst_sel:DWORD dst_unused:UNUSED_PAD src0_sel:WORD_1 src1_sel:WORD_0
    v_add_u32_sdwa v7, v7, v126 dst_sel:DWORD dst_unused:UNUSED_PAD src0_sel:WORD_1 src1_sel:WORD_1
    v_add_u32_sdwa v8, v8, v51 dst_sel:DWORD dst_unused:UNUSED_PAD src0_sel:WORD_1 src1_sel:WORD_0
    v_add_u32_sdwa v9, v9, v51 dst_sel:DWORD dst_unused:UNUSED_PAD src0_sel:WORD_1 src1_sel:WORD_1
    v_add_u32 v6, v6, v6
    v_add_u32 v7, v7, v7
    v_add_u32 v8, v8, v8
    v_add_u32 v9, v9, v9
    ds_write_b16 v6, v106 offset:16384
    ds_write_b16_d16_hi v7, v106 offset:16384
    ds_write_b16 v8, v107 offset:16384
    ds_write_b16_d16_hi v9, v107 offset:16384
    v_mov_b32 v6, 1140817920
    s_waitcnt vmcnt(11)
    v_pk_maximum3_f16 v5, v108, v109, v5
    v_mad_u32_u16 v6, v55, s50, v15 op_sel:[0,0,0,0]
    v_mad_u32_u16 v7, v55, s50, v15 op_sel:[1,0,0,0]
    v_mad_u32_u16 v8, v59, s50, v15 op_sel:[0,0,0,0]
    v_mad_u32_u16 v9, v59, s50, v15 op_sel:[1,0,0,0]
    v_add_u32_sdwa v6, v6, v55 dst_sel:DWORD dst_unused:UNUSED_PAD src0_sel:WORD_1 src1_sel:WORD_0
    v_add_u32_sdwa v7, v7, v55 dst_sel:DWORD dst_unused:UNUSED_PAD src0_sel:WORD_1 src1_sel:WORD_1
    v_add_u32_sdwa v8, v8, v59 dst_sel:DWORD dst_unused:UNUSED_PAD src0_sel:WORD_1 src1_sel:WORD_0
    v_add_u32_sdwa v9, v9, v59 dst_sel:DWORD dst_unused:UNUSED_PAD src0_sel:WORD_1 src1_sel:WORD_1
    v_add_u32 v6, v6, v6
    v_add_u32 v7, v7, v7
    v_add_u32 v8, v8, v8
    v_add_u32 v9, v9, v9
    ds_write_b16 v6, v108 offset:16384
    ds_write_b16_d16_hi v7, v108 offset:16384
    ds_write_b16 v8, v109 offset:16384
    ds_write_b16_d16_hi v9, v109 offset:16384
    v_mov_b32 v6, 1140817920
    s_waitcnt vmcnt(10)
    v_pk_maximum3_f16 v5, v110, v111, v5
    v_mad_u32_u16 v6, v63, s50, v15 op_sel:[0,0,0,0]
    v_mad_u32_u16 v7, v63, s50, v15 op_sel:[1,0,0,0]
    v_mad_u32_u16 v8, v67, s50, v15 op_sel:[0,0,0,0]
    v_mad_u32_u16 v9, v67, s50, v15 op_sel:[1,0,0,0]
    v_add_u32_sdwa v6, v6, v63 dst_sel:DWORD dst_unused:UNUSED_PAD src0_sel:WORD_1 src1_sel:WORD_0
    v_add_u32_sdwa v7, v7, v63 dst_sel:DWORD dst_unused:UNUSED_PAD src0_sel:WORD_1 src1_sel:WORD_1
    v_add_u32_sdwa v8, v8, v67 dst_sel:DWORD dst_unused:UNUSED_PAD src0_sel:WORD_1 src1_sel:WORD_0
    v_add_u32_sdwa v9, v9, v67 dst_sel:DWORD dst_unused:UNUSED_PAD src0_sel:WORD_1 src1_sel:WORD_1
    v_add_u32 v6, v6, v6
    v_add_u32 v7, v7, v7
    v_add_u32 v8, v8, v8
    v_add_u32 v9, v9, v9
    ds_write_b16 v6, v110 offset:16384
    ds_write_b16_d16_hi v7, v110 offset:16384
    ds_write_b16 v8, v111 offset:16384
    ds_write_b16_d16_hi v9, v111 offset:16384
    s_cmp_lg_u32 s40, 3
    s_cbranch_scc1 L_p1_kernel_ld_41
    s_mov_b32 s36, 11534336
    buffer_store_dwordx4 v[40:43], v3, s[72:75], s36 offen sc1
    s_branch L_p1_kernel_st_42
L_p1_kernel_ld_41:
    s_add_u32 s35, s33, 53542912
    buffer_load_dwordx4 v[40:43], v1, s[8:11], s35 offen nt
L_p1_kernel_st_42:
    v_mov_b32 v6, 1140817920
    s_waitcnt vmcnt(10)
    v_pk_maximum3_f16 v5, v112, v113, v5
    v_mad_u32_u16 v6, v71, s50, v15 op_sel:[0,0,0,0]
    v_mad_u32_u16 v7, v71, s50, v15 op_sel:[1,0,0,0]
    v_mad_u32_u16 v8, v75, s50, v15 op_sel:[0,0,0,0]
    v_mad_u32_u16 v9, v75, s50, v15 op_sel:[1,0,0,0]
    v_add_u32_sdwa v6, v6, v71 dst_sel:DWORD dst_unused:UNUSED_PAD src0_sel:WORD_1 src1_sel:WORD_0
    v_add_u32_sdwa v7, v7, v71 dst_sel:DWORD dst_unused:UNUSED_PAD src0_sel:WORD_1 src1_sel:WORD_1
    v_add_u32_sdwa v8, v8, v75 dst_sel:DWORD dst_unused:UNUSED_PAD src0_sel:WORD_1 src1_sel:WORD_0
    v_add_u32_sdwa v9, v9, v75 dst_sel:DWORD dst_unused:UNUSED_PAD src0_sel:WORD_1 src1_sel:WORD_1
    v_add_u32 v6, v6, v6
    v_add_u32 v7, v7, v7
    v_add_u32 v8, v8, v8
    v_add_u32 v9, v9, v9
    ds_write_b16 v6, v112 offset:16384
    ds_write_b16_d16_hi v7, v112 offset:16384
    ds_write_b16 v8, v113 offset:16384
    ds_write_b16_d16_hi v9, v113 offset:16384
    v_mov_b32 v6, 1140817920
    s_waitcnt vmcnt(9)
    v_pk_maximum3_f16 v5, v114, v115, v5
    v_mad_u32_u16 v6, v79, s50, v15 op_sel:[0,0,0,0]
    v_mad_u32_u16 v7, v79, s50, v15 op_sel:[1,0,0,0]
    v_mad_u32_u16 v8, v83, s50, v15 op_sel:[0,0,0,0]
    v_mad_u32_u16 v9, v83, s50, v15 op_sel:[1,0,0,0]
    v_add_u32_sdwa v6, v6, v79 dst_sel:DWORD dst_unused:UNUSED_PAD src0_sel:WORD_1 src1_sel:WORD_0
    v_add_u32_sdwa v7, v7, v79 dst_sel:DWORD dst_unused:UNUSED_PAD src0_sel:WORD_1 src1_sel:WORD_1
    v_add_u32_sdwa v8, v8, v83 dst_sel:DWORD dst_unused:UNUSED_PAD src0_sel:WORD_1 src1_sel:WORD_0
    v_add_u32_sdwa v9, v9, v83 dst_sel:DWORD dst_unused:UNUSED_PAD src0_sel:WORD_1 src1_sel:WORD_1
    v_add_u32 v6, v6, v6
    v_add_u32 v7, v7, v7
    v_add_u32 v8, v8, v8
    v_add_u32 v9, v9, v9
    ds_write_b16 v6, v114 offset:16384
    ds_write_b16_d16_hi v7, v114 offset:16384
    ds_write_b16 v8, v115 offset:16384
    ds_write_b16_d16_hi v9, v115 offset:16384
    v_mov_b32 v6, 1140817920
    s_waitcnt vmcnt(8)
    v_pk_maximum3_f16 v5, v116, v117, v5
    v_mad_u32_u16 v6, v87, s50, v15 op_sel:[0,0,0,0]
    v_mad_u32_u16 v7, v87, s50, v15 op_sel:[1,0,0,0]
    v_mad_u32_u16 v8, v91, s50, v15 op_sel:[0,0,0,0]
    v_mad_u32_u16 v9, v91, s50, v15 op_sel:[1,0,0,0]
    v_add_u32_sdwa v6, v6, v87 dst_sel:DWORD dst_unused:UNUSED_PAD src0_sel:WORD_1 src1_sel:WORD_0
    v_add_u32_sdwa v7, v7, v87 dst_sel:DWORD dst_unused:UNUSED_PAD src0_sel:WORD_1 src1_sel:WORD_1
    v_add_u32_sdwa v8, v8, v91 dst_sel:DWORD dst_unused:UNUSED_PAD src0_sel:WORD_1 src1_sel:WORD_0
    v_add_u32_sdwa v9, v9, v91 dst_sel:DWORD dst_unused:UNUSED_PAD src0_sel:WORD_1 src1_sel:WORD_1
    v_add_u32 v6, v6, v6
    v_add_u32 v7, v7, v7
    v_add_u32 v8, v8, v8
    v_add_u32 v9, v9, v9
    ds_write_b16 v6, v116 offset:16384
    ds_write_b16_d16_hi v7, v116 offset:16384
    ds_write_b16 v8, v117 offset:16384
    ds_write_b16_d16_hi v9, v117 offset:16384
    s_cmp_lg_u32 s40, 3
    s_cbranch_scc1 L_p1_kernel_ld_43
    s_mov_b32 s36, 12582912
    buffer_store_dwordx4 v[44:47], v3, s[72:75], s36 offen sc1
    s_branch L_p1_kernel_st_44
L_p1_kernel_ld_43:
    s_add_u32 s35, s33, 53542912
    buffer_load_dwordx4 v[44:47], v1, s[12:15], s35 offen nt
L_p1_kernel_st_44:
    v_mov_b32 v6, 1140817920
    s_mov_b64 exec, s[44:45]
    s_waitcnt vmcnt(8)
    v_pk_maximum3_f16 v5, v118, v119, v5
    s_mov_b64 exec, -1
    s_mov_b64 exec, s[44:45]
    v_mad_u32_u16 v6, v95, s50, v15 op_sel:[0,0,0,0]
    v_mad_u32_u16 v7, v95, s50, v15 op_sel:[1,0,0,0]
    v_mad_u32_u16 v8, v99, s50, v15 op_sel:[0,0,0,0]
    v_mad_u32_u16 v9, v99, s50, v15 op_sel:[1,0,0,0]
    v_add_u32_sdwa v6, v6, v95 dst_sel:DWORD dst_unused:UNUSED_PAD src0_sel:WORD_1 src1_sel:WORD_0
    v_add_u32_sdwa v7, v7, v95 dst_sel:DWORD dst_unused:UNUSED_PAD src0_sel:WORD_1 src1_sel:WORD_1
    v_add_u32_sdwa v8, v8, v99 dst_sel:DWORD dst_unused:UNUSED_PAD src0_sel:WORD_1 src1_sel:WORD_0
    v_add_u32_sdwa v9, v9, v99 dst_sel:DWORD dst_unused:UNUSED_PAD src0_sel:WORD_1 src1_sel:WORD_1
    v_add_u32 v6, v6, v6
    v_add_u32 v7, v7, v7
    v_add_u32 v8, v8, v8
    v_add_u32 v9, v9, v9
    ds_write_b16 v6, v118 offset:16384
    ds_write_b16_d16_hi v7, v118 offset:16384
    ds_write_b16 v8, v119 offset:16384
    ds_write_b16_d16_hi v9, v119 offset:16384
    s_mov_b64 exec, -1
    s_mul_i32 s35, s39, 6144
    v_add_u32 v6, s35, v2
    v_mov_b32 v10, 1140817920
    s_waitcnt lgkmcnt(0)
    s_barrier
    ds_read_b64 v[120:121], v6 offset:23040
    ds_read_b64 v[122:123], v6 offset:16384
    ds_read_b64 v[124:125], v6 offset:16896
    ds_read_b64 v[126:127], v6 offset:17408
    ds_read_b64 v[100:101], v6 offset:17920
    ds_read_b64 v[102:103], v6 offset:18432
    ds_read_b64 v[104:105], v6 offset:18944
    ds_read_b64 v[106:107], v6 offset:19456
    ds_read_b64 v[108:109], v6 offset:19968
    ds_read_b64 v[110:111], v6 offset:20480
    ds_read_b64 v[112:113], v6 offset:20992
    ds_read_b64 v[114:115], v6 offset:21504
    ds_read_b64 v[116:117], v6 offset:22016
    ds_read_b64 v[118:119], v6 offset:22528
    s_add_u32 s32, s32, 256
    s_add_u32 s33, s33, 40960000
    s_add_u32 s34, s34, 20480000
    s_add_u32 s40, s40, 1
    s_cmp_lt_u32 s40, 4
    s_cbranch_scc1 L_p1_loop
    s_cmp_lg_u32 s39, 15
    s_cbranch_scc1 L_p1_kernel_nox_45
    s_waitcnt lgkmcnt(13)
    v_lshlrev_b32 v15, 16, v120
    v_and_b32 v120, 0xffff0000, v120
    v_lshlrev_b32 v121, 16, v121
    v_mul_f32 v15, s41, v15
    v_mul_f32 v120, s41, v120
    v_mul_f32 v121, s41, v121
    v_fract_f32 v15, v15
    v_fract_f32 v120, v120
    v_fract_f32 v121, v121
    v_cos_f32 v15, v15
    v_cos_f32 v120, v120
    v_cos_f32 v121, v121
    v_fmaak_f32 v15, v10, v15, 1262486016
    v_fmaak_f32 v120, v10, v120, 1262486016
    v_fmaak_f32 v121, v10, v121, 1262486016
    v_lshlrev_b32 v15, 22, v15
    v_alignbit_b32 v15, v120, v15, 10
    v_alignbit_b32 v15, v121, v15, 10
    v_xor_b32 v15, 0x80200800, v15
    s_mov_b32 s36, 13631488
    buffer_store_dwordx4 v[12:15], v3, s[20:23], s36 offen sc1
L_p1_kernel_nox_45:
    s_waitcnt lgkmcnt(12)
    v_lshlrev_b32 v75, 16, v122
    v_and_b32 v122, 0xffff0000, v122
    v_lshlrev_b32 v123, 16, v123
    v_mul_f32 v75, s41, v75
    v_mul_f32 v122, s41, v122
    v_mul_f32 v123, s41, v123
    v_fract_f32 v75, v75
    v_fract_f32 v122, v122
    v_fract_f32 v123, v123
    v_cos_f32 v75, v75
    v_cos_f32 v122, v122
    v_cos_f32 v123, v123
    v_fmaak_f32 v75, v10, v75, 1262486016
    v_fmaak_f32 v122, v10, v122, 1262486016
    v_fmaak_f32 v123, v10, v123, 1262486016
    v_lshlrev_b32 v75, 22, v75
    v_alignbit_b32 v75, v122, v75, 10
    v_alignbit_b32 v75, v123, v75, 10
    v_xor_b32 v75, 0x80200800, v75
    s_mov_b32 s36, 0
    buffer_store_dwordx4 v[72:75], v3, s[20:23], s36 offen sc1
    s_waitcnt lgkmcnt(11)
    v_lshlrev_b32 v79, 16, v124
    v_and_b32 v124, 0xffff0000, v124
    v_lshlrev_b32 v125, 16, v125
    v_mul_f32 v79, s41, v79
    v_mul_f32 v124, s41, v124
    v_mul_f32 v125, s41, v125
    v_fract_f32 v79, v79
    v_fract_f32 v124, v124
    v_fract_f32 v125, v125
    v_cos_f32 v79, v79
    v_cos_f32 v124, v124
    v_cos_f32 v125, v125
    v_fmaak_f32 v79, v10, v79, 1262486016
    v_fmaak_f32 v124, v10, v124, 1262486016
    v_fmaak_f32 v125, v10, v125, 1262486016
    v_lshlrev_b32 v79, 22, v79
    v_alignbit_b32 v79, v124, v79, 10
    v_alignbit_b32 v79, v125, v79, 10
    v_xor_b32 v79, 0x80200800, v79
    s_mov_b32 s36, 1048576
    buffer_store_dwordx4 v[76:79], v3, s[20:23], s36 offen sc1
    s_waitcnt lgkmcnt(0)
    v_lshlrev_b32 v51, 16, v126
    v_and_b32 v126, 0xffff0000, v126
    v_lshlrev_b32 v127, 16, v127
    v_mul_f32 v51, s41, v51
    v_mul_f32 v126, s41, v126
    v_mul_f32 v127, s41, v127
    v_fract_f32 v51, v51
    v_fract_f32 v126, v126
    v_fract_f32 v127, v127
    v_cos_f32 v51, v51
    v_cos_f32 v126, v126
    v_cos_f32 v127, v127
    v_fmaak_f32 v51, v10, v51, 1262486016
    v_fmaak_f32 v126, v10, v126, 1262486016
    v_fmaak_f32 v127, v10, v127, 1262486016
    v_lshlrev_b32 v51, 22, v51
    v_alignbit_b32 v51, v126, v51, 10
    v_alignbit_b32 v51, v127, v51, 10
    v_xor_b32 v51, 0x80200800, v51
    s_mov_b32 s36, 2097152
    buffer_store_dwordx4 v[48:51], v3, s[20:23], s36 offen sc1
    v_lshlrev_b32 v83, 16, v100
    v_and_b32 v100, 0xffff0000, v100
    v_lshlrev_b32 v101, 16, v101
    v_mul_f32 v83, s41, v83
    v_mul_f32 v100, s41, v100
    v_mul_f32 v101, s41, v101
    v_fract_f32 v83, v83
    v_fract_f32 v100, v100
    v_fract_f32 v101, v101
    v_cos_f32 v83, v83
    v_cos_f32 v100, v100
    v_cos_f32 v101, v101
    v_fmaak_f32 v83, v10, v83, 1262486016
    v_fmaak_f32 v100, v10, v100, 1262486016
    v_fmaak_f32 v101, v10, v101, 1262486016
    v_lshlrev_b32 v83, 22, v83
    v_alignbit_b32 v83, v100, v83, 10
    v_alignbit_b32 v83, v101, v83, 10
    v_xor_b32 v83, 0x80200800, v83
    s_mov_b32 s36, 3145728
    buffer_store_dwordx4 v[80:83], v3, s[20:23], s36 offen sc1
    v_lshlrev_b32 v55, 16, v102
    v_and_b32 v102, 0xffff0000, v102
    v_lshlrev_b32 v103, 16, v103
    v_mul_f32 v55, s41, v55
    v_mul_f32 v102, s41, v102
    v_mul_f32 v103, s41, v103
    v_fract_f32 v55, v55
    v_fract_f32 v102, v102
    v_fract_f32 v103, v103
    v_cos_f32 v55, v55
    v_cos_f32 v102, v102
    v_cos_f32 v103, v103
    v_fmaak_f32 v55, v10, v55, 1262486016
    v_fmaak_f32 v102, v10, v102, 1262486016
    v_fmaak_f32 v103, v10, v103, 1262486016
    v_lshlrev_b32 v55, 22, v55
    v_alignbit_b32 v55, v102, v55, 10
    v_alignbit_b32 v55, v103, v55, 10
    v_xor_b32 v55, 0x80200800, v55
    s_mov_b32 s36, 4194304
    buffer_store_dwordx4 v[52:55], v3, s[20:23], s36 offen sc1
    v_lshlrev_b32 v87, 16, v104
    v_and_b32 v104, 0xffff0000, v104
    v_lshlrev_b32 v105, 16, v105
    v_mul_f32 v87, s41, v87
    v_mul_f32 v104, s41, v104
    v_mul_f32 v105, s41, v105
    v_fract_f32 v87, v87
    v_fract_f32 v104, v104
    v_fract_f32 v105, v105
    v_cos_f32 v87, v87
    v_cos_f32 v104, v104
    v_cos_f32 v105, v105
    v_fmaak_f32 v87, v10, v87, 1262486016
    v_fmaak_f32 v104, v10, v104, 1262486016
    v_fmaak_f32 v105, v10, v105, 1262486016
    v_lshlrev_b32 v87, 22, v87
    v_alignbit_b32 v87, v104, v87, 10
    v_alignbit_b32 v87, v105, v87, 10
    v_xor_b32 v87, 0x80200800, v87
    s_mov_b32 s36, 5242880
    buffer_store_dwordx4 v[84:87], v3, s[20:23], s36 offen sc1
    v_lshlrev_b32 v59, 16, v106
    v_and_b32 v106, 0xffff0000, v106
    v_lshlrev_b32 v107, 16, v107
    v_mul_f32 v59, s41, v59
    v_mul_f32 v106, s41, v106
    v_mul_f32 v107, s41, v107
    v_fract_f32 v59, v59
    v_fract_f32 v106, v106
    v_fract_f32 v107, v107
    v_cos_f32 v59, v59
    v_cos_f32 v106, v106
    v_cos_f32 v107, v107
    v_fmaak_f32 v59, v10, v59, 1262486016
    v_fmaak_f32 v106, v10, v106, 1262486016
    v_fmaak_f32 v107, v10, v107, 1262486016
    v_lshlrev_b32 v59, 22, v59
    v_alignbit_b32 v59, v106, v59, 10
    v_alignbit_b32 v59, v107, v59, 10
    v_xor_b32 v59, 0x80200800, v59
    s_mov_b32 s36, 6291456
    buffer_store_dwordx4 v[56:59], v3, s[20:23], s36 offen sc1
    v_lshlrev_b32 v91, 16, v108
    v_and_b32 v108, 0xffff0000, v108
    v_lshlrev_b32 v109, 16, v109
    v_mul_f32 v91, s41, v91
    v_mul_f32 v108, s41, v108
    v_mul_f32 v109, s41, v109
    v_fract_f32 v91, v91
    v_fract_f32 v108, v108
    v_fract_f32 v109, v109
    v_cos_f32 v91, v91
    v_cos_f32 v108, v108
    v_cos_f32 v109, v109
    v_fmaak_f32 v91, v10, v91, 1262486016
    v_fmaak_f32 v108, v10, v108, 1262486016
    v_fmaak_f32 v109, v10, v109, 1262486016
    v_lshlrev_b32 v91, 22, v91
    v_alignbit_b32 v91, v108, v91, 10
    v_alignbit_b32 v91, v109, v91, 10
    v_xor_b32 v91, 0x80200800, v91
    s_mov_b32 s36, 7340032
    buffer_store_dwordx4 v[88:91], v3, s[20:23], s36 offen sc1
    v_lshlrev_b32 v63, 16, v110
    v_and_b32 v110, 0xffff0000, v110
    v_lshlrev_b32 v111, 16, v111
    v_mul_f32 v63, s41, v63
    v_mul_f32 v110, s41, v110
    v_mul_f32 v111, s41, v111
    v_fract_f32 v63, v63
    v_fract_f32 v110, v110
    v_fract_f32 v111, v111
    v_cos_f32 v63, v63
    v_cos_f32 v110, v110
    v_cos_f32 v111, v111
    v_fmaak_f32 v63, v10, v63, 1262486016
    v_fmaak_f32 v110, v10, v110, 1262486016
    v_fmaak_f32 v111, v10, v111, 1262486016
    v_lshlrev_b32 v63, 22, v63
    v_alignbit_b32 v63, v110, v63, 10
    v_alignbit_b32 v63, v111, v63, 10
    v_xor_b32 v63, 0x80200800, v63
    s_mov_b32 s36, 8388608
    buffer_store_dwordx4 v[60:63], v3, s[20:23], s36 offen sc1
    v_lshlrev_b32 v95, 16, v112
    v_and_b32 v112, 0xffff0000, v112
    v_lshlrev_b32 v113, 16, v113
    v_mul_f32 v95, s41, v95
    v_mul_f32 v112, s41, v112
    v_mul_f32 v113, s41, v113
    v_fract_f32 v95, v95
    v_fract_f32 v112, v112
    v_fract_f32 v113, v113
    v_cos_f32 v95, v95
    v_cos_f32 v112, v112
    v_cos_f32 v113, v113
    v_fmaak_f32 v95, v10, v95, 1262486016
    v_fmaak_f32 v112, v10, v112, 1262486016
    v_fmaak_f32 v113, v10, v113, 1262486016
    v_lshlrev_b32 v95, 22, v95
    v_alignbit_b32 v95, v112, v95, 10
    v_alignbit_b32 v95, v113, v95, 10
    v_xor_b32 v95, 0x80200800, v95
    s_mov_b32 s36, 9437184
    buffer_store_dwordx4 v[92:95], v3, s[20:23], s36 offen sc1
    v_lshlrev_b32 v67, 16, v114
    v_and_b32 v114, 0xffff0000, v114
    v_lshlrev_b32 v115, 16, v115
    v_mul_f32 v67, s41, v67
    v_mul_f32 v114, s41, v114
    v_mul_f32 v115, s41, v115
    v_fract_f32 v67, v67
    v_fract_f32 v114, v114
    v_fract_f32 v115, v115
    v_cos_f32 v67, v67
    v_cos_f32 v114, v114
    v_cos_f32 v115, v115
    v_fmaak_f32 v67, v10, v67, 1262486016
    v_fmaak_f32 v114, v10, v114, 1262486016
    v_fmaak_f32 v115, v10, v115, 1262486016
    v_lshlrev_b32 v67, 22, v67
    v_alignbit_b32 v67, v114, v67, 10
    v_alignbit_b32 v67, v115, v67, 10
    v_xor_b32 v67, 0x80200800, v67
    s_mov_b32 s36, 10485760
    buffer_store_dwordx4 v[64:67], v3, s[20:23], s36 offen sc1
    v_lshlrev_b32 v99, 16, v116
    v_and_b32 v116, 0xffff0000, v116
    v_lshlrev_b32 v117, 16, v117
    v_mul_f32 v99, s41, v99
    v_mul_f32 v116, s41, v116
    v_mul_f32 v117, s41, v117
    v_fract_f32 v99, v99
    v_fract_f32 v116, v116
    v_fract_f32 v117, v117
    v_cos_f32 v99, v99
    v_cos_f32 v116, v116
    v_cos_f32 v117, v117
    v_fmaak_f32 v99, v10, v99, 1262486016
    v_fmaak_f32 v116, v10, v116, 1262486016
    v_fmaak_f32 v117, v10, v117, 1262486016
    v_lshlrev_b32 v99, 22, v99
    v_alignbit_b32 v99, v116, v99, 10
    v_alignbit_b32 v99, v117, v99, 10
    v_xor_b32 v99, 0x80200800, v99
    s_mov_b32 s36, 11534336
    buffer_store_dwordx4 v[96:99], v3, s[20:23], s36 offen sc1
    v_lshlrev_b32 v71, 16, v118
    v_and_b32 v118, 0xffff0000, v118
    v_lshlrev_b32 v119, 16, v119
    v_mul_f32 v71, s41, v71
    v_mul_f32 v118, s41, v118
    v_mul_f32 v119, s41, v119
    v_fract_f32 v71, v71
    v_fract_f32 v118, v118
    v_fract_f32 v119, v119
    v_cos_f32 v71, v71
    v_cos_f32 v118, v118
    v_cos_f32 v119, v119
    v_fmaak_f32 v71, v10, v71, 1262486016
    v_fmaak_f32 v118, v10, v118, 1262486016
    v_fmaak_f32 v119, v10, v119, 1262486016
    v_lshlrev_b32 v71, 22, v71
    v_alignbit_b32 v71, v118, v71, 10
    v_alignbit_b32 v71, v119, v71, 10
    v_xor_b32 v71, 0x80200800, v71
    s_mov_b32 s36, 12582912
    buffer_store_dwordx4 v[68:71], v3, s[20:23], s36 offen sc1
    v_and_b32 v6, 0x7c007c00, v5
    v_add_u32 v6, 0x04000400, v6
    v_and_b32 v6, 0x80008000, v6
    v_cmp_ne_u32 vcc, 0, v6
    s_lshl_b32 s35, s39, 4
    s_add_u32 s35, s35, 160328
    v_mov_b32 v10, s35
    s_cmp_lg_u64 vcc, 0
    s_cselect_b32 s36, 1, s55
    v_mov_b32 v11, s36
    ds_write_b32 v10, v11
    s_waitcnt lgkmcnt(0)
    s_barrier
    s_cmp_lg_u32 s39, 0
    s_cbranch_scc1 L_p1_end
    v_and_b32 v6, 15, v0
    v_lshlrev_b32 v6, 4, v6
    v_add_u32 v6, 160320, v6
    ds_read_b128 v[8:11], v6
    s_waitcnt lgkmcnt(0)
    s_nop 1
    v_max_u32_dpp v8, v8, v8 row_shr:1 row_mask:0xf bank_mask:0xf bound_ctrl:0
    s_nop 1
    v_max_u32_dpp v8, v8, v8 row_shr:2 row_mask:0xf bank_mask:0xf bound_ctrl:0
    s_nop 1
    v_max_u32_dpp v8, v8, v8 row_shr:4 row_mask:0xf bank_mask:0xf bound_ctrl:0
    s_nop 1
    v_max_u32_dpp v8, v8, v8 row_shr:8 row_mask:0xf bank_mask:0xf bound_ctrl:0
    s_nop 1
    v_add_f32_dpp v9, v9, v9 row_shr:1 row_mask:0xf bank_mask:0xf bound_ctrl:0
    s_nop 1
    v_add_f32_dpp v9, v9, v9 row_shr:2 row_mask:0xf bank_mask:0xf bound_ctrl:0
    s_nop 1
    v_add_f32_dpp v9, v9, v9 row_shr:4 row_mask:0xf bank_mask:0xf bound_ctrl:0
    s_nop 1
    v_add_f32_dpp v9, v9, v9 row_shr:8 row_mask:0xf bank_mask:0xf bound_ctrl:0
    s_nop 1
    v_or_b32_dpp v10, v10, v10 row_shr:1 row_mask:0xf bank_mask:0xf bound_ctrl:0
    s_nop 1
    v_or_b32_dpp v10, v10, v10 row_shr:2 row_mask:0xf bank_mask:0xf bound_ctrl:0
    s_nop 1
    v_or_b32_dpp v10, v10, v10 row_shr:4 row_mask:0xf bank_mask:0xf bound_ctrl:0
    s_nop 1
    v_or_b32_dpp v10, v10, v10 row_shr:8 row_mask:0xf bank_mask:0xf bound_ctrl:0
    s_lshl_b32 s35, s2, 3
    s_mov_b32 s26, 8540160
    s_add_u32 s35, s35, 8519680
    v_mov_b32 v6, 0
    v_lshl_or_b32 v8, v10, 16, v8
    s_mov_b64 exec, 0x8000
    buffer_store_dwordx2 v[8:9], v6, s[24:27], s35 offen
    s_lshl_b32 s35, s2, 8
    s_add_u32 s35, s35, 8523776
    buffer_store_dword v6, v6, s[24:27], s35 offen
L_p1_end:
    s_endpgm
.globl p2_kernel
.p2align 8
.type p2_kernel,@function
p2_kernel:
    s_cmp_ge_u32 s2, 256
    s_cbranch_scc1 L_p2_end
    s_load_dwordx2 s[4:5], s[0:1], 104
    s_load_dwordx2 s[100:101], s[0:1], 24
    s_load_dwordx2 s[8:9], s[0:1], 0
    s_load_dwordx2 s[30:31], s[0:1], 40
    s_load_dwordx4 s[32:35], s[0:1], 56
    s_load_dwordx4 s[36:39], s[0:1], 72
    s_and_b32 s14, s2, 7
    s_lshr_b32 s49, s2, 3
    s_and_b32 s3, s14, 1
    s_lshl_b32 s3, s3, 5
    s_add_u32 s3, s3, s49
    s_lshr_b32 s12, s14, 1
    v_lshrrev_b32 v108, 6, v0
    v_lshlrev_b32 v1, 4, v0
    v_and_b32 v109, 63, v0
    v_readfirstlane_b32 s13, v108
    v_lshlrev_b32 v111, 4, v109
    v_lshrrev_b32 v110, 2, v109
    v_mul_u32_u24 v110, 8256, v110
    v_add_u32 v110, v110, v111
    s_mul_i32 s14, s12, 65
    s_add_u32 s14, s14, s3
    s_lshl_b32 s14, s14, 5
    s_mul_i32 s15, s13, 532480
    s_add_u32 s14, s14, s15
    s_add_u32 s25, s14, 0
    s_mul_i32 s22, s12, 1280000
    s_mov_b32 s2, 0
    s_waitcnt lgkmcnt(0)
    s_mov_b32 s6, 655360000
    s_mov_b32 s7, 0x00020000
    s_add_u32 s10, s22, 1280000
    s_mov_b32 s11, 0x00020000
    s_add_u32 s15, s25, 0
    buffer_load_dwordx4 v[28:31], v110, s[4:7], s15 offen
    s_add_u32 s15, s25, 133120
    buffer_load_dwordx4 v[32:35], v110, s[4:7], s15 offen
    s_add_u32 s15, s25, 266240
    buffer_load_dwordx4 v[36:39], v110, s[4:7], s15 offen
    s_add_u32 s15, s25, 399360
    buffer_load_dwordx4 v[40:43], v110, s[4:7], s15 offen
    s_load_dwordx4 s[40:43], s[30:31], 0
    s_load_dwordx16 s[52:67], s[32:33], 0
    s_load_dwordx16 s[68:83], s[34:35], 0
    s_load_dwordx8 s[84:91], s[36:37], 0
    s_load_dwordx8 s[92:99], s[38:39], 0
    v_mov_b32 v52, 0x100
    s_cmp_lg_u32 s13, 0
    s_cbranch_scc1 L_p2_noann
    s_lshl_b32 s14, s3, 8
    s_add_u32 s14, s14, 8523776
    s_mov_b64 exec, 1
    buffer_atomic_add v52, off, s[4:7], s14
    s_mov_b64 exec, -1
L_p2_noann:
    s_add_u32 s14, s22, 0
    buffer_load_dwordx4 v[88:91], v1, s[8:11], s14 offen
    s_add_u32 s14, s22, 16384
    buffer_load_dwordx4 v[92:95], v1, s[8:11], s14 offen
    s_add_u32 s14, s22, 32768
    buffer_load_dwordx4 v[96:99], v1, s[8:11], s14 offen
    s_add_u32 s14, s22, 49152
    buffer_load_dwordx4 v[100:103], v1, s[8:11], s14 offen
    s_add_u32 s14, s22, 65536
    buffer_load_dwordx4 v[104:107], v1, s[8:11], s14 offen
    s_mov_b32 s15, 8519680
    buffer_load_dwordx4 v[80:83], v111, s[4:7], s15 offen offset:0
    buffer_load_dwordx4 v[84:87], v111, s[4:7], s15 offen offset:1024
    v_lshlrev_b32 v2, 10, v109
    v_mov_b32 v50, 21845
    v_add_u32 v3, 80000, v1
    v_add_u32 v124, 145536, v1
    v_add_u32 v113, 65536, v1
    v_mov_b32 v112, 0x7f000000
    v_cmp_gt_u32 vcc, 904, v0
    s_mul_i32 s19, s13, 240
    s_add_u32 s19, s19, 160000
    v_cndmask_b32 v124, v112, v124, vcc
    v_cndmask_b32 v113, v112, v113, vcc
    v_lshl_add_u32 v6, v109, 2, s19
    v_lshl_add_u32 v126, v109, 1, s19
    v_cmp_gt_u32 vcc, 10, v109
    s_lshl_b32 s27, s13, 16
    s_mov_b32 s23, 1024
    v_cndmask_b32 v6, v112, v6, vcc
    s_add_u32 s44, s4, 4194304
    s_addc_u32 s45, s5, 1048576
    s_mov_b32 s46, 14024704
    s_mov_b32 s47, 0x00020000
    s_mov_b32 s18, 80000
    s_and_b32 s50, s3, 1
    s_lshl_b32 s50, s50, 18
    s_sub_u32 s18, s18, s50
    s_sub_u32 s50, 4294836224, s50
    v_lshlrev_b32 v116, 3, v0
    v_and_b32 v116, 16, v116
    v_and_b32 v117, 1, v0
    v_lshl_or_b32 v116, v117, 5, v116
    v_mov_b32 v58, 0x3f80
    v_mov_b32 v59, 0
    v_lshlrev_b64 v[58:59], v116, v[58:59]
    v_mov_b32 v4, 0
    v_mov_b32 v5, 0
    v_mov_b32 v114, 0xff00
    v_bfe_u32 v127, v0, 0, 1
    v_mul_u32_u24 v127, 40, v127
    v_add_u32 v127, s19, v127
    ds_write2_b32 v6, v5, v5 offset0:34 offset1:44
    ds_write_b16 v126, v114 offset:2
    v_mov_b32 v44, 1073758208
    v_mov_b32 v45, 1073758208
    v_mov_b32 v46, 1073758208
    v_mov_b32 v47, 1073758208
    v_mov_b32 v48, 1073758208
    v_mov_b32 v49, 1073758208
    ds_write_b128 v113, v[44:47]
    v_lshrrev_b32 v115, 4, v109
    v_mul_u32_u24 v115, 15360, v115
    v_lshl_add_u32 v115, v109, 6, v115
    v_lshl_add_u32 v115, v108, 10, v115
    s_waitcnt lgkmcnt(0)
    v_mov_b32 v53, s40
    v_mov_b32 v54, s41
    v_mov_b32 v56, s42
    v_mov_b32 v57, s43
    s_mov_b32 s40, 20987904
    s_mov_b32 s41, 21031594
    s_pack_ll_b32_b16 s14, s52, s54
    s_pack_hh_b32_b16 s15, s52, s54
    s_pack_ll_b32_b16 s54, s53, s55
    s_pack_hh_b32_b16 s55, s53, s55
    s_mov_b32 s52, s14
    s_mov_b32 s53, s15
    s_pack_ll_b32_b16 s14, s56, s58
    s_pack_hh_b32_b16 s15, s56, s58
    s_pack_ll_b32_b16 s58, s57, s59
    s_pack_hh_b32_b16 s59, s57, s59
    s_mov_b32 s56, s14
    s_mov_b32 s57, s15
    s_pack_ll_b32_b16 s14, s60, s62
    s_pack_hh_b32_b16 s15, s60, s62
    s_pack_ll_b32_b16 s62, s61, s63
    s_pack_hh_b32_b16 s63, s61, s63
    s_mov_b32 s60, s14
    s_mov_b32 s61, s15
    s_pack_ll_b32_b16 s14, s64, s66
    s_pack_hh_b32_b16 s15, s64, s66
    s_pack_ll_b32_b16 s66, s65, s67
    s_pack_hh_b32_b16 s67, s65, s67
    s_mov_b32 s64, s14
    s_mov_b32 s65, s15
    s_pack_ll_b32_b16 s14, s68, s70
    s_pack_hh_b32_b16 s15, s68, s70
    s_pack_ll_b32_b16 s70, s69, s71
    s_pack_hh_b32_b16 s71, s69, s71
    s_mov_b32 s68, s14
    s_mov_b32 s69, s15
    s_pack_ll_b32_b16 s14, s72, s74
    s_pack_hh_b32_b16 s15, s72, s74
    s_pack_ll_b32_b16 s74, s73, s75
    s_pack_hh_b32_b16 s75, s73, s75
    s_mov_b32 s72, s14
    s_mov_b32 s73, s15
    s_pack_ll_b32_b16 s14, s76, s78
    s_pack_hh_b32_b16 s15, s76, s78
    s_pack_ll_b32_b16 s78, s77, s79
    s_pack_hh_b32_b16 s79, s77, s79
    s_mov_b32 s76, s14
    s_mov_b32 s77, s15
    s_pack_ll_b32_b16 s14, s80, s82
    s_pack_hh_b32_b16 s15, s80, s82
    s_pack_ll_b32_b16 s82, s81, s83
    s_pack_hh_b32_b16 s83, s81, s83
    s_mov_b32 s80, s14
    s_mov_b32 s81, s15
    s_waitcnt vmcnt(10)
    ds_write_b128 v1, v[28:31] offset:0
    s_waitcnt vmcnt(9)
    ds_write_b128 v1, v[32:35] offset:16384
    s_waitcnt vmcnt(8)
    ds_write_b128 v1, v[36:39] offset:32768
    s_waitcnt vmcnt(7)
    ds_write_b128 v1, v[40:43] offset:49152
    ds_read_b128 v[28:31], v115 offset:0
    ds_read_b128 v[36:39], v115 offset:32
    ds_read_b128 v[32:35], v115 offset:16
    ds_read_b128 v[40:43], v115 offset:48
    ds_write_b128 v1, v[44:47] offset:0
    ds_write_b128 v1, v[44:47] offset:16384
    ds_write_b128 v1, v[44:47] offset:32768
    ds_write_b128 v1, v[44:47] offset:49152
    s_waitcnt lgkmcnt(6)
    v_mad_u32_u16 v108, v28, v50, s40 op_sel:[0,0,0,0]
    v_mad_u32_u16 v109, v36, v50, s41 op_sel:[0,0,0,0]
    v_sub_u32_sdwa v110, v109, v108 dst_sel:DWORD dst_unused:UNUSED_PAD src0_sel:WORD_1 src1_sel:WORD_1
    s_nop 1
    v_add_u32_dpp v110, v110, v110 row_shr:1 row_mask:0xf bank_mask:0xf bound_ctrl:0
    s_nop 1
    v_add_u32_dpp v110, v110, v110 row_shr:2 row_mask:0xf bank_mask:0xf bound_ctrl:0
    s_nop 1
    v_add_u32_dpp v110, v110, v110 row_shr:4 row_mask:0xf bank_mask:0xf bound_ctrl:0
    s_nop 1
    v_add_u32_dpp v110, v110, v110 row_shr:8 row_mask:0xf bank_mask:0xf bound_ctrl:0
    s_nop 1
    v_add_u32_dpp v110, v110, v110 row_bcast:15 row_mask:0xa bank_mask:0xf
    s_nop 1
    v_add_u32_dpp v110, v110, v110 row_bcast:31 row_mask:0xc bank_mask:0xf
    v_sub_u32_sdwa v109, v109, v110 dst_sel:DWORD dst_unused:UNUSED_PAD src0_sel:WORD_1 src1_sel:DWORD
    v_readlane_b32 s29, v110, 63
    v_add_u32 v110, -1, v110
    ds_write_b16 v126, v109
    v_lshlrev_b32_e64 v111, v110, 1
    v_lshrrev_b32 v110, 5, v110
    s_cmp_gt_u32 s29, 320
    s_cselect_b32 s2, 1, s2
    v_lshl_add_u32 v110, v110, 2, v127
    s_cselect_b64 exec, 0, -1
    ds_or_b32 v110, v111 offset:136
    s_mov_b64 exec, -1
    ds_wrxchg2_rtn_b32 v[108:109], v6, v5, v5 offset0:34 offset1:44
    s_waitcnt lgkmcnt(0)
    v_or_b32 v7, v108, v109
    s_nop 0
    v_readlane_b32 s30, v7, 0
    v_readlane_b32 s31, v7, 1
    v_readlane_b32 s32, v7, 2
    v_readlane_b32 s33, v7, 3
    v_readlane_b32 s34, v7, 4
    v_readlane_b32 s35, v7, 5
    v_readlane_b32 s36, v7, 6
    v_readlane_b32 s37, v7, 7
    s_mov_b32 s25, s19
    s_mov_b32 s26, s27
    s_mov_b32 s51, s28
    s_mov_b32 s28, s29
    v_mbcnt_lo_u32_b32 v8, s30, 0
    v_mbcnt_hi_u32_b32 v8, s31, v8
    s_bcnt1_i32_b64 s14, s[30:31]
    v_lshl_add_u32 v9, v8, 1, s25
    ds_read_u16 v9, v9
    s_add_u32 s30, s26, 0
    s_lshl1_add_u32 s25, s14, s25
    s_lshl_b32 s14, s14, 10
    s_add_u32 s26, s26, s14
    v_mbcnt_lo_u32_b32 v12, s32, 0
    v_mbcnt_hi_u32_b32 v12, s33, v12
    s_bcnt1_i32_b64 s14, s[32:33]
    v_lshl_add_u32 v13, v12, 1, s25
    ds_read_u16 v13, v13
    s_add_u32 s32, s26, 1048576
    s_lshl1_add_u32 s25, s14, s25
    s_lshl_b32 s14, s14, 10
    s_add_u32 s26, s26, s14
    v_mbcnt_lo_u32_b32 v16, s34, 0
    v_mbcnt_hi_u32_b32 v16, s35, v16
    s_bcnt1_i32_b64 s14, s[34:35]
    v_lshl_add_u32 v17, v16, 1, s25
    ds_read_u16 v17, v17
    s_add_u32 s34, s26, 2097152
    s_lshl1_add_u32 s25, s14, s25
    s_lshl_b32 s14, s14, 10
    s_add_u32 s26, s26, s14
    v_mbcnt_lo_u32_b32 v20, s36, 0
    v_mbcnt_hi_u32_b32 v20, s37, v20
    s_bcnt1_i32_b64 s14, s[36:37]
    v_lshl_add_u32 v21, v20, 1, s25
    ds_read_u16 v21, v21
    s_add_u32 s36, s26, 3145728
    s_lshl1_add_u32 s25, s14, s25
    s_lshl_b32 s14, s14, 10
    s_add_u32 s26, s26, s14
    s_waitcnt lgkmcnt(3)
    v_mad_u32_u16 v9, v9, s23, v2
    v_pk_lshrrev_b16 v9, 10, v9 op_sel_hi:[1,1]
    v_lshl_add_u32 v8, v8, 6, v9
    buffer_load_dwordx4 v[8:11], v8, s[44:47], s30 idxen
    s_waitcnt lgkmcnt(2)
    v_mad_u32_u16 v13, v13, s23, v2
    v_pk_lshrrev_b16 v13, 10, v13 op_sel_hi:[1,1]
    v_lshl_add_u32 v12, v12, 6, v13
    buffer_load_dwordx4 v[12:15], v12, s[44:47], s32 idxen
    s_waitcnt lgkmcnt(1)
    v_mad_u32_u16 v17, v17, s23, v2
    v_pk_lshrrev_b16 v17, 10, v17 op_sel_hi:[1,1]
    v_lshl_add_u32 v16, v16, 6, v17
    buffer_load_dwordx4 v[16:19], v16, s[44:47], s34 idxen
    s_waitcnt lgkmcnt(0)
    v_mad_u32_u16 v21, v21, s23, v2
    v_pk_lshrrev_b16 v21, 10, v21 op_sel_hi:[1,1]
    v_lshl_add_u32 v20, v20, 6, v21
    buffer_load_dwordx4 v[20:23], v20, s[44:47], s36 idxen
    s_cmp_le_u32 s28, 256
    s_cbranch_scc1 L_p2_kernel_noopt_1
    v_readlane_b32 s38, v7, 8
    v_readlane_b32 s39, v7, 9
    s_nop 1
    v_mbcnt_lo_u32_b32 v51, s38, 0
    v_mbcnt_hi_u32_b32 v51, s39, v51
    s_bcnt1_i32_b64 s14, s[38:39]
    v_lshl_add_u32 v55, v51, 1, s25
    ds_read_u16 v55, v55
    s_add_u32 s38, s26, 4194304
    s_lshl1_add_u32 s25, s14, s25
    s_lshl_b32 s14, s14, 10
    s_add_u32 s26, s26, s14
    s_waitcnt lgkmcnt(0)
    v_mad_u32_u16 v55, v55, s23, v2
    v_pk_lshrrev_b16 v55, 10, v55 op_sel_hi:[1,1]
    v_lshl_add_u32 v51, v51, 6, v55
    buffer_load_dwordx4 v[24:27], v51, s[44:47], s38 idxen
L_p2_kernel_noopt_1:
    s_waitcnt vmcnt(6)
    ds_write_b128 v3, v[88:91] offset:0
    ds_write_b128 v3, v[92:95] offset:16384
    ds_write_b128 v3, v[96:99] offset:32768
    ds_write_b128 v3, v[100:103] offset:49152
    ds_write_b128 v124, v[104:107] offset:0
    s_waitcnt vmcnt(4)
    v_max3_u32 v64, v80, v82, v84
    v_add_f32 v65, v81, v83
    v_add_f32 v66, v85, v87
    v_max_u32 v64, v64, v86
    v_add_f32 v65, v65, v66
    v_cmp_lt_u32 vcc, 0xffff, v64
    s_nop 1
    v_max_u32_dpp v64, v64, v64 row_shr:1 row_mask:0xf bank_mask:0xf bound_ctrl:0
    s_nop 1
    v_max_u32_dpp v64, v64, v64 row_shr:2 row_mask:0xf bank_mask:0xf bound_ctrl:0
    s_nop 1
    v_max_u32_dpp v64, v64, v64 row_shr:4 row_mask:0xf bank_mask:0xf bound_ctrl:0
    s_nop 1
    v_max_u32_dpp v64, v64, v64 row_shr:8 row_mask:0xf bank_mask:0xf bound_ctrl:0
    s_nop 1
    v_max_u32_dpp v64, v64, v64 row_bcast:15 row_mask:0xa bank_mask:0xf
    s_nop 1
    v_max_u32_dpp v64, v64, v64 row_bcast:31 row_mask:0xc bank_mask:0xf
    s_nop 1
    v_add_f32_dpp v65, v65, v65 row_shr:1 row_mask:0xf bank_mask:0xf bound_ctrl:0
    s_nop 1
    v_add_f32_dpp v65, v65, v65 row_shr:2 row_mask:0xf bank_mask:0xf bound_ctrl:0
    s_nop 1
    v_add_f32_dpp v65, v65, v65 row_shr:4 row_mask:0xf bank_mask:0xf bound_ctrl:0
    s_nop 1
    v_add_f32_dpp v65, v65, v65 row_shr:8 row_mask:0xf bank_mask:0xf bound_ctrl:0
    s_nop 1
    v_add_f32_dpp v65, v65, v65 row_bcast:15 row_mask:0xa bank_mask:0xf
    s_nop 1
    v_add_f32_dpp v65, v65, v65 row_bcast:31 row_mask:0xc bank_mask:0xf
    s_cmp_lg_u64 vcc, 0
    s_cselect_b32 s2, 1, s2
    v_lshlrev_b32 v64, 16, v64
    v_mul_f32 v66, 936490775, v65
    v_mul_f32 v65, 928531664, v65
    v_cmp_nle_f32 vcc, v64, v66
    v_max_u32 v64, v64, v65
    s_nop 0
    v_readlane_b32 s14, v64, 63
    s_bitcmp1_b32 vcc_hi, 31
    s_cselect_b32 s2, 1, s2
    s_lshr_b32 s14, s14, 23
    s_add_u32 s14, s14, 1
    s_cmp_lt_u32 s14, 40
    s_cselect_b32 s2, 1, s2
    s_cmp_gt_u32 s14, 230
    s_cselect_b32 s2, 1, s2
    s_sub_u32 s48, s14, 14
    s_lshl_b32 s48, s48, 23
    s_add_u32 s16, s48, 272629760
    s_lshr_b32 s15, s16, 16
    s_sub_u32 s15, 0x10000, s15
    s_add_u32 s20, s16, s15
    s_sub_u32 s17, s20, 1
    s_mov_b32 s21, s17
    s_or_b32 s48, s48, 16416
    s_sub_u32 s14, s14, 40
    s_cmp_gt_u32 s14, 190
    s_cselect_b32 s48, 0, s48
    s_waitcnt lgkmcnt(0)
    s_barrier
    s_add_u32 s14, s22, 80000
    buffer_load_dwordx4 v[88:91], v1, s[8:11], s14 offen
    s_add_u32 s14, s22, 96384
    buffer_load_dwordx4 v[92:95], v1, s[8:11], s14 offen
    v_mad_u32_u16 v108, v28, v50, s40 op_sel:[1,0,0,0]
    v_mad_u32_u16 v109, v36, v50, s41 op_sel:[1,0,0,0]
    v_sub_u32_sdwa v110, v109, v108 dst_sel:DWORD dst_unused:UNUSED_PAD src0_sel:WORD_1 src1_sel:WORD_1
    s_nop 1
    v_add_u32_dpp v110, v110, v110 row_shr:1 row_mask:0xf bank_mask:0xf bound_ctrl:0
    s_nop 1
    v_add_u32_dpp v110, v110, v110 row_shr:2 row_mask:0xf bank_mask:0xf bound_ctrl:0
    s_nop 1
    v_add_u32_dpp v110, v110, v110 row_shr:4 row_mask:0xf bank_mask:0xf bound_ctrl:0
    s_nop 1
    v_add_u32_dpp v110, v110, v110 row_shr:8 row_mask:0xf bank_mask:0xf bound_ctrl:0
    s_nop 1
    v_add_u32_dpp v110, v110, v110 row_bcast:15 row_mask:0xa bank_mask:0xf
    s_nop 1
    v_add_u32_dpp v110, v110, v110 row_bcast:31 row_mask:0xc bank_mask:0xf
    v_sub_u32_sdwa v109, v109, v110 dst_sel:DWORD dst_unused:UNUSED_PAD src0_sel:WORD_1 src1_sel:DWORD
    v_readlane_b32 s29, v110, 63
    v_add_u32 v110, -1, v110
    ds_write_b16 v126, v109
    v_lshlrev_b32_e64 v111, v110, 1
    v_lshrrev_b32 v110, 5, v110
    s_cmp_gt_u32 s29, 320
    s_cselect_b32 s2, 1, s2
    v_lshl_add_u32 v110, v110, 2, v127
    s_cselect_b64 exec, 0, -1
    ds_or_b32 v110, v111 offset:136
    s_mov_b64 exec, -1
    ds_wrxchg2_rtn_b32 v[108:109], v6, v5, v5 offset0:34 offset1:44
    s_mov_b32 s24, 0
L_p2_loop:
    s_add_u32 s22, s22, 80000
    s_lshl_b32 s14, s13, 4
    s_or_b32 s14, s14, s24
    s_cmp_lg_u32 s14, 5
    s_cbranch_scc1 L_p2_nost
    v_mov_b32 v52, 0
    s_lshl_b32 s14, s3, 8
    s_add_u32 s14, s14, 8523776
    s_mov_b64 exec, 1
    buffer_atomic_add v52, off, s[4:7], s14 sc0
    s_mov_b64 exec, -1
L_p2_nost:
    s_waitcnt vmcnt(5)
    v_mad_u32_u16 v64, v8, 8, s18
    v_mad_u32_u16 v66, v9, 8, s18
    v_mad_u32_u16 v68, v10, 8, s18
    ds_read_b64 v[64:65], v64
    ds_read_b64 v[66:67], v66
    ds_read_b64 v[68:69], v68
    s_add_u32 s14, s22, 32768
    buffer_load_dwordx4 v[96:99], v1, s[8:11], s14 offen
    s_waitcnt vmcnt(5)
    v_mad_u32_u16 v70, v12, 8, s18
    v_mad_u32_u16 v72, v13, 8, s18
    v_mad_u32_u16 v74, v14, 8, s18
    ds_read_b64 v[70:71], v70
    ds_read_b64 v[72:73], v72
    ds_read_b64 v[74:75], v74
    s_add_u32 s14, s22, 49152
    buffer_load_dwordx4 v[100:103], v1, s[8:11], s14 offen
    s_waitcnt lgkmcnt(6)
    v_or_b32 v7, v108, v109
    s_nop 0
    v_readlane_b32 s30, v7, 0
    v_readlane_b32 s31, v7, 1
    v_readlane_b32 s32, v7, 2
    v_readlane_b32 s33, v7, 3
    v_readlane_b32 s34, v7, 4
    v_readlane_b32 s35, v7, 5
    v_readlane_b32 s36, v7, 6
    v_readlane_b32 s37, v7, 7
    s_mov_b32 s25, s19
    s_mov_b32 s26, s27
    s_mov_b32 s51, s28
    s_mov_b32 s28, s29
    v_mbcnt_lo_u32_b32 v51, s30, 0
    v_mbcnt_hi_u32_b32 v51, s31, v51
    s_bcnt1_i32_b64 s14, s[30:31]
    v_lshl_add_u32 v55, v51, 1, s25
    ds_read_u16 v55, v55
    s_add_u32 s30, s26, 0
    s_lshl1_add_u32 s25, s14, s25
    s_lshl_b32 s14, s14, 10
    s_add_u32 s26, s26, s14
    v_bfe_i32 v108, v11, 2, 10
    v_bfe_i32 v109, v11, 12, 10
    v_ashrrev_i32 v110, 22, v11
    v_cvt_f32_i32 v108, v108
    v_cvt_f32_i32 v109, v109
    v_cvt_f32_i32 v110, v110
    s_waitcnt lgkmcnt(4)
    v_mfma_f32_4x4x4_16b_bf16 v[112:115], v[58:59], v[64:65], 0
    v_mfma_f32_4x4x4_16b_bf16 v[116:119], v[58:59], v[66:67], 0
    v_mfma_f32_4x4x4_16b_bf16 v[120:123], v[58:59], v[68:69], 0
    v_mad_u32_u16 v8, v8, 8, s50 op_sel:[1,0,0,0]
    v_mad_u32_u16 v9, v9, 8, s50 op_sel:[1,0,0,0]
    v_mad_u32_u16 v10, v10, 8, s50 op_sel:[1,0,0,0]
    v_pk_fma_f32 v[114:115], v[114:115], v[108:109], s[20:21] op_sel:[0,0,0] op_sel_hi:[1,0,1]
    v_pk_fma_f32 v[112:113], v[112:113], v[108:109], s[16:17] op_sel:[0,0,0] op_sel_hi:[1,0,1]
    v_pk_fma_f32 v[118:119], v[118:119], v[108:109], s[20:21] op_sel:[0,1,0] op_sel_hi:[1,1,1]
    v_pk_fma_f32 v[116:117], v[116:117], v[108:109], s[16:17] op_sel:[0,1,0] op_sel_hi:[1,1,1]
    v_pk_fma_f32 v[122:123], v[122:123], v[110:111], s[20:21] op_sel:[0,0,0] op_sel_hi:[1,0,1]
    v_pk_fma_f32 v[120:121], v[120:121], v[110:111], s[16:17] op_sel:[0,0,0] op_sel_hi:[1,0,1]
    v_lshlrev_b64 v[114:115], 16, v[114:115]
    v_lshlrev_b64 v[118:119], 16, v[118:119]
    v_lshlrev_b64 v[122:123], 16, v[122:123]
    v_lshl_add_u64 v[64:65], v[112:113], 0, v[114:115]
    v_lshl_add_u64 v[66:67], v[116:117], 0, v[118:119]
    v_lshl_add_u64 v[68:69], v[120:121], 0, v[122:123]
    v_or3_b32 v4, v44, v45, v4
    v_or3_b32 v4, v46, v47, v4
    v_or3_b32 v4, v48, v49, v4
    ds_add_rtn_u64 v[44:45], v8, v[64:65]
    ds_add_rtn_u64 v[46:47], v9, v[66:67]
    ds_add_rtn_u64 v[48:49], v10, v[68:69]
    s_waitcnt lgkmcnt(3)
    v_mad_u32_u16 v55, v55, s23, v2
    v_pk_lshrrev_b16 v55, 10, v55 op_sel_hi:[1,1]
    v_lshl_add_u32 v51, v51, 6, v55
    buffer_load_dwordx4 v[8:11], v51, s[44:47], s30 idxen
    s_sub_u32 s14, s22, 80000
    buffer_load_dwordx4 v[104:107], v124, s[8:11], s14 offen
    s_waitcnt vmcnt(7)
    v_mad_u32_u16 v76, v16, 8, s18
    v_mad_u32_u16 v78, v17, 8, s18
    v_mad_u32_u16 v80, v18, 8, s18
    ds_read_b64 v[76:77], v76
    ds_read_b64 v[78:79], v78
    ds_read_b64 v[80:81], v80
    s_waitcnt vmcnt(6)
    v_mad_u32_u16 v82, v20, 8, s18
    v_mad_u32_u16 v84, v21, 8, s18
    v_mad_u32_u16 v86, v22, 8, s18
    ds_read_b64 v[82:83], v82
    ds_read_b64 v[84:85], v84
    ds_read_b64 v[86:87], v86
    s_cmp_le_u32 s51, 256
    s_cbranch_scc1 L_p2_kernel_noopt3_2
    v_mad_u32_u16 v64, v24, 8, s18
    v_mad_u32_u16 v66, v25, 8, s18
    v_mad_u32_u16 v68, v26, 8, s18
    ds_read_b64 v[64:65], v64
    ds_read_b64 v[66:67], v66
    ds_read_b64 v[68:69], v68
L_p2_kernel_noopt3_2:
    v_mbcnt_lo_u32_b32 v51, s32, 0
    v_mbcnt_hi_u32_b32 v51, s33, v51
    s_bcnt1_i32_b64 s14, s[32:33]
    v_lshl_add_u32 v55, v51, 1, s25
    ds_read_u16 v55, v55
    s_add_u32 s32, s26, 1048576
    s_lshl1_add_u32 s25, s14, s25
    s_lshl_b32 s14, s14, 10
    s_add_u32 s26, s26, s14
    v_bfe_i32 v108, v15, 2, 10
    v_bfe_i32 v109, v15, 12, 10
    v_ashrrev_i32 v110, 22, v15
    v_cvt_f32_i32 v108, v108
    v_cvt_f32_i32 v109, v109
    v_cvt_f32_i32 v110, v110
    v_mfma_f32_4x4x4_16b_bf16 v[112:115], v[58:59], v[70:71], 0
    v_mfma_f32_4x4x4_16b_bf16 v[116:119], v[58:59], v[72:73], 0
    v_mfma_f32_4x4x4_16b_bf16 v[120:123], v[58:59], v[74:75], 0
    v_mad_u32_u16 v12, v12, 8, s50 op_sel:[1,0,0,0]
    v_mad_u32_u16 v13, v13, 8, s50 op_sel:[1,0,0,0]
    v_mad_u32_u16 v14, v14, 8, s50 op_sel:[1,0,0,0]
    v_pk_fma_f32 v[114:115], v[114:115], v[108:109], s[20:21] op_sel:[0,0,0] op_sel_hi:[1,0,1]
    v_pk_fma_f32 v[112:113], v[112:113], v[108:109], s[16:17] op_sel:[0,0,0] op_sel_hi:[1,0,1]
    v_pk_fma_f32 v[118:119], v[118:119], v[108:109], s[20:21] op_sel:[0,1,0] op_sel_hi:[1,1,1]
    v_pk_fma_f32 v[116:117], v[116:117], v[108:109], s[16:17] op_sel:[0,1,0] op_sel_hi:[1,1,1]
    v_pk_fma_f32 v[122:123], v[122:123], v[110:111], s[20:21] op_sel:[0,0,0] op_sel_hi:[1,0,1]
    v_pk_fma_f32 v[120:121], v[120:121], v[110:111], s[16:17] op_sel:[0,0,0] op_sel_hi:[1,0,1]
    v_lshlrev_b64 v[114:115], 16, v[114:115]
    v_lshlrev_b64 v[118:119], 16, v[118:119]
    v_lshlrev_b64 v[122:123], 16, v[122:123]
    v_lshl_add_u64 v[70:71], v[112:113], 0, v[114:115]
    v_lshl_add_u64 v[72:73], v[116:117], 0, v[118:119]
    v_lshl_add_u64 v[74:75], v[120:121], 0, v[122:123]
    s_waitcnt lgkmcnt(7)
    v_or3_b32 v4, v44, v45, v4
    v_or3_b32 v4, v46, v47, v4
    v_or3_b32 v4, v48, v49, v4
    ds_add_rtn_u64 v[44:45], v12, v[70:71]
    ds_add_rtn_u64 v[46:47], v13, v[72:73]
    ds_add_rtn_u64 v[48:49], v14, v[74:75]
    s_waitcnt lgkmcnt(3)
    v_mad_u32_u16 v55, v55, s23, v2
    v_pk_lshrrev_b16 v55, 10, v55 op_sel_hi:[1,1]
    v_lshl_add_u32 v51, v51, 6, v55
    buffer_load_dwordx4 v[12:15], v51, s[44:47], s32 idxen
    s_barrier
    s_waitcnt vmcnt(1)
    ds_write_b128 v3, v[88:91] offset:0
    ds_write_b128 v3, v[92:95] offset:16384
    ds_write_b128 v3, v[96:99] offset:32768
    ds_write_b128 v3, v[100:103] offset:49152
    ds_write_b128 v124, v[104:107] offset:0
    s_cmp_lg_u32 s24, 7
    s_cbranch_scc1 L_p2_nofin
    s_lshl2_add_u32 s14, s3, s12
    s_mul_i32 s14, s14, 5000
    s_add_u32 s15, s14, 4096
    v_min_u32 v61, 225, v0
    v_lshl_add_u32 v60, v0, 2, s14
    v_lshl_add_u32 v61, v61, 2, s15
    global_load_dword v60, v60, s[100:101] nt
    global_load_dword v61, v61, s[100:101] nt
    s_lshl_b32 s14, s14, 2
    s_lshl_b32 s15, s15, 2
    v_min_u32 v36, 225, v0
    v_add_u32 v28, s14, v1
    v_lshl_add_u32 v36, v36, 4, s15
    global_load_dwordx4 v[28:31], v28, s[8:9]
    global_load_dwordx4 v[36:39], v36, s[8:9]
L_p2_nofin:
    v_mbcnt_lo_u32_b32 v51, s34, 0
    v_mbcnt_hi_u32_b32 v51, s35, v51
    s_bcnt1_i32_b64 s14, s[34:35]
    v_lshl_add_u32 v55, v51, 1, s25
    ds_read_u16 v55, v55
    s_add_u32 s34, s26, 2097152
    s_lshl1_add_u32 s25, s14, s25
    s_lshl_b32 s14, s14, 10
    s_add_u32 s26, s26, s14
    v_bfe_i32 v108, v19, 2, 10
    v_bfe_i32 v109, v19, 12, 10
    v_ashrrev_i32 v110, 22, v19
    v_cvt_f32_i32 v108, v108
    v_cvt_f32_i32 v109, v109
    v_cvt_f32_i32 v110, v110
    v_mfma_f32_4x4x4_16b_bf16 v[112:115], v[58:59], v[76:77], 0
    v_mfma_f32_4x4x4_16b_bf16 v[116:119], v[58:59], v[78:79], 0
    v_mfma_f32_4x4x4_16b_bf16 v[120:123], v[58:59], v[80:81], 0
    v_mad_u32_u16 v16, v16, 8, s50 op_sel:[1,0,0,0]
    v_mad_u32_u16 v17, v17, 8, s50 op_sel:[1,0,0,0]
    v_mad_u32_u16 v18, v18, 8, s50 op_sel:[1,0,0,0]
    v_pk_fma_f32 v[114:115], v[114:115], v[108:109], s[20:21] op_sel:[0,0,0] op_sel_hi:[1,0,1]
    v_pk_fma_f32 v[112:113], v[112:113], v[108:109], s[16:17] op_sel:[0,0,0] op_sel_hi:[1,0,1]
    v_pk_fma_f32 v[118:119], v[118:119], v[108:109], s[20:21] op_sel:[0,1,0] op_sel_hi:[1,1,1]
    v_pk_fma_f32 v[116:117], v[116:117], v[108:109], s[16:17] op_sel:[0,1,0] op_sel_hi:[1,1,1]
    v_pk_fma_f32 v[122:123], v[122:123], v[110:111], s[20:21] op_sel:[0,0,0] op_sel_hi:[1,0,1]
    v_pk_fma_f32 v[120:121], v[120:121], v[110:111], s[16:17] op_sel:[0,0,0] op_sel_hi:[1,0,1]
    v_lshlrev_b64 v[114:115], 16, v[114:115]
    v_lshlrev_b64 v[118:119], 16, v[118:119]
    v_lshlrev_b64 v[122:123], 16, v[122:123]
    v_lshl_add_u64 v[76:77], v[112:113], 0, v[114:115]
    v_lshl_add_u64 v[78:79], v[116:117], 0, v[118:119]
    v_lshl_add_u64 v[80:81], v[120:121], 0, v[122:123]
    s_waitcnt lgkmcnt(6)
    v_or3_b32 v4, v44, v45, v4
    v_or3_b32 v4, v46, v47, v4
    v_or3_b32 v4, v48, v49, v4
    ds_add_rtn_u64 v[44:45], v16, v[76:77]
    ds_add_rtn_u64 v[46:47], v17, v[78:79]
    ds_add_rtn_u64 v[48:49], v18, v[80:81]
    s_waitcnt lgkmcnt(3)
    v_mad_u32_u16 v55, v55, s23, v2
    v_pk_lshrrev_b16 v55, 10, v55 op_sel_hi:[1,1]
    v_lshl_add_u32 v51, v51, 6, v55
    buffer_load_dwordx4 v[16:19], v51, s[44:47], s34 idxen
    s_cmp_le_u32 s51, 256
    s_cbranch_scc1 L_p2_kernel_noopt3_3
    v_bfe_i32 v108, v27, 2, 10
    v_bfe_i32 v109, v27, 12, 10
    v_ashrrev_i32 v110, 22, v27
    v_cvt_f32_i32 v108, v108
    v_cvt_f32_i32 v109, v109
    v_cvt_f32_i32 v110, v110
    v_mfma_f32_4x4x4_16b_bf16 v[112:115], v[58:59], v[64:65], 0
    v_mfma_f32_4x4x4_16b_bf16 v[116:119], v[58:59], v[66:67], 0
    v_mfma_f32_4x4x4_16b_bf16 v[120:123], v[58:59], v[68:69], 0
    v_mad_u32_u16 v24, v24, 8, s50 op_sel:[1,0,0,0]
    v_mad_u32_u16 v25, v25, 8, s50 op_sel:[1,0,0,0]
    v_mad_u32_u16 v26, v26, 8, s50 op_sel:[1,0,0,0]
    v_pk_fma_f32 v[114:115], v[114:115], v[108:109], s[20:21] op_sel:[0,0,0] op_sel_hi:[1,0,1]
    v_pk_fma_f32 v[112:113], v[112:113], v[108:109], s[16:17] op_sel:[0,0,0] op_sel_hi:[1,0,1]
    v_pk_fma_f32 v[118:119], v[118:119], v[108:109], s[20:21] op_sel:[0,1,0] op_sel_hi:[1,1,1]
    v_pk_fma_f32 v[116:117], v[116:117], v[108:109], s[16:17] op_sel:[0,1,0] op_sel_hi:[1,1,1]
    v_pk_fma_f32 v[122:123], v[122:123], v[110:111], s[20:21] op_sel:[0,0,0] op_sel_hi:[1,0,1]
    v_pk_fma_f32 v[120:121], v[120:121], v[110:111], s[16:17] op_sel:[0,0,0] op_sel_hi:[1,0,1]
    v_lshlrev_b64 v[114:115], 16, v[114:115]
    v_lshlrev_b64 v[118:119], 16, v[118:119]
    v_lshlrev_b64 v[122:123], 16, v[122:123]
    v_lshl_add_u64 v[64:65], v[112:113], 0, v[114:115]
    v_lshl_add_u64 v[66:67], v[116:117], 0, v[118:119]
    v_lshl_add_u64 v[68:69], v[120:121], 0, v[122:123]
    s_waitcnt lgkmcnt(0)
    v_or3_b32 v4, v44, v45, v4
    v_or3_b32 v4, v46, v47, v4
    v_or3_b32 v4, v48, v49, v4
    ds_add_rtn_u64 v[44:45], v24, v[64:65]
    ds_add_rtn_u64 v[46:47], v25, v[66:67]
    ds_add_rtn_u64 v[48:49], v26, v[68:69]
L_p2_kernel_noopt3_3:
    v_mbcnt_lo_u32_b32 v51, s36, 0
    v_mbcnt_hi_u32_b32 v51, s37, v51
    s_bcnt1_i32_b64 s14, s[36:37]
    v_lshl_add_u32 v55, v51, 1, s25
    ds_read_u16 v55, v55
    s_add_u32 s36, s26, 3145728
    s_lshl1_add_u32 s25, s14, s25
    s_lshl_b32 s14, s14, 10
    s_add_u32 s26, s26, s14
    s_cmp_le_u32 s28, 256
    s_cbranch_scc1 L_p2_kernel_noopt3_4
    v_readlane_b32 s38, v7, 8
    v_readlane_b32 s39, v7, 9
    s_nop 1
    v_mbcnt_lo_u32_b32 v62, s38, 0
    v_mbcnt_hi_u32_b32 v62, s39, v62
    s_bcnt1_i32_b64 s14, s[38:39]
    v_lshl_add_u32 v63, v62, 1, s25
    ds_read_u16 v63, v63
    s_add_u32 s38, s26, 4194304
    s_lshl1_add_u32 s25, s14, s25
    s_lshl_b32 s14, s14, 10
    s_add_u32 s26, s26, s14
L_p2_kernel_noopt3_4:
    v_bfe_i32 v108, v23, 2, 10
    v_bfe_i32 v109, v23, 12, 10
    v_ashrrev_i32 v110, 22, v23
    v_cvt_f32_i32 v108, v108
    v_cvt_f32_i32 v109, v109
    v_cvt_f32_i32 v110, v110
    v_mfma_f32_4x4x4_16b_bf16 v[112:115], v[58:59], v[82:83], 0
    v_mfma_f32_4x4x4_16b_bf16 v[116:119], v[58:59], v[84:85], 0
    v_mfma_f32_4x4x4_16b_bf16 v[120:123], v[58:59], v[86:87], 0
    v_mad_u32_u16 v20, v20, 8, s50 op_sel:[1,0,0,0]
    v_mad_u32_u16 v21, v21, 8, s50 op_sel:[1,0,0,0]
    v_mad_u32_u16 v22, v22, 8, s50 op_sel:[1,0,0,0]
    v_pk_fma_f32 v[114:115], v[114:115], v[108:109], s[20:21] op_sel:[0,0,0] op_sel_hi:[1,0,1]
    v_pk_fma_f32 v[112:113], v[112:113], v[108:109], s[16:17] op_sel:[0,0,0] op_sel_hi:[1,0,1]
    v_pk_fma_f32 v[118:119], v[118:119], v[108:109], s[20:21] op_sel:[0,1,0] op_sel_hi:[1,1,1]
    v_pk_fma_f32 v[116:117], v[116:117], v[108:109], s[16:17] op_sel:[0,1,0] op_sel_hi:[1,1,1]
    v_pk_fma_f32 v[122:123], v[122:123], v[110:111], s[20:21] op_sel:[0,0,0] op_sel_hi:[1,0,1]
    v_pk_fma_f32 v[120:121], v[120:121], v[110:111], s[16:17] op_sel:[0,0,0] op_sel_hi:[1,0,1]
    v_lshlrev_b64 v[114:115], 16, v[114:115]
    v_lshlrev_b64 v[118:119], 16, v[118:119]
    v_lshlrev_b64 v[122:123], 16, v[122:123]
    v_lshl_add_u64 v[82:83], v[112:113], 0, v[114:115]
    v_lshl_add_u64 v[84:85], v[116:117], 0, v[118:119]
    v_lshl_add_u64 v[86:87], v[120:121], 0, v[122:123]
    s_waitcnt lgkmcnt(1)
    v_or3_b32 v4, v44, v45, v4
    v_or3_b32 v4, v46, v47, v4
    v_or3_b32 v4, v48, v49, v4
    ds_add_rtn_u64 v[44:45], v20, v[82:83]
    ds_add_rtn_u64 v[46:47], v21, v[84:85]
    ds_add_rtn_u64 v[48:49], v22, v[86:87]
    s_waitcnt lgkmcnt(3)
    v_mad_u32_u16 v55, v55, s23, v2
    v_pk_lshrrev_b16 v55, 10, v55 op_sel_hi:[1,1]
    v_lshl_add_u32 v51, v51, 6, v55
    buffer_load_dwordx4 v[20:23], v51, s[44:47], s36 idxen
    s_cmp_le_u32 s28, 256
    s_cbranch_scc1 L_p2_kernel_noopt3_5
    v_mad_u32_u16 v63, v63, s23, v2
    v_pk_lshrrev_b16 v63, 10, v63 op_sel_hi:[1,1]
    v_lshl_add_u32 v62, v62, 6, v63
    buffer_load_dwordx4 v[24:27], v62, s[44:47], s38 idxen
L_p2_kernel_noopt3_5:
    s_add_u32 s14, s22, 80000
    buffer_load_dwordx4 v[88:91], v1, s[8:11], s14 offen
    s_add_u32 s14, s24, 1
    s_min_u32 s14, s14, 7
    s_set_gpr_idx_on s14, gpr_idx(SRC0)
    v_mad_u32_u16 v108, v28, v50, s40 op_sel:[0,0,0,0]
    v_mad_u32_u16 v109, v36, v50, s41 op_sel:[0,0,0,0]
    s_set_gpr_idx_off
    v_sub_u32_sdwa v110, v109, v108 dst_sel:DWORD dst_unused:UNUSED_PAD src0_sel:WORD_1 src1_sel:WORD_1
    s_nop 1
    v_add_u32_dpp v110, v110, v110 row_shr:1 row_mask:0xf bank_mask:0xf bound_ctrl:0
    s_nop 1
    v_add_u32_dpp v110, v110, v110 row_shr:2 row_mask:0xf bank_mask:0xf bound_ctrl:0
    s_nop 1
    v_add_u32_dpp v110, v110, v110 row_shr:4 row_mask:0xf bank_mask:0xf bound_ctrl:0
    s_nop 1
    v_add_u32_dpp v110, v110, v110 row_shr:8 row_mask:0xf bank_mask:0xf bound_ctrl:0
    s_nop 1
    v_add_u32_dpp v110, v110, v110 row_bcast:15 row_mask:0xa bank_mask:0xf
    s_nop 1
    v_add_u32_dpp v110, v110, v110 row_bcast:31 row_mask:0xc bank_mask:0xf
    v_sub_u32_sdwa v109, v109, v110 dst_sel:DWORD dst_unused:UNUSED_PAD src0_sel:WORD_1 src1_sel:DWORD
    v_readlane_b32 s29, v110, 63
    v_add_u32 v110, -1, v110
    ds_write_b16 v126, v109
    v_lshlrev_b32_e64 v111, v110, 1
    v_lshrrev_b32 v110, 5, v110
    s_cmp_gt_u32 s29, 320
    s_cselect_b32 s2, 1, s2
    v_lshl_add_u32 v110, v110, 2, v127
    s_cselect_b64 exec, 0, -1
    ds_or_b32 v110, v111 offset:136
    s_mov_b64 exec, -1
    ds_wrxchg2_rtn_b32 v[108:109], v6, v5, v5 offset0:34 offset1:44
    s_add_u32 s14, s22, 96384
    buffer_load_dwordx4 v[92:95], v1, s[8:11], s14 offen
    s_barrier
    s_add_u32 s22, s22, 80000
    s_cmp_eq_u32 s24, 7
    s_cselect_b32 s46, 0, s46
    v_mad_u32_u16 v64, v8, 8, s18
    v_mad_u32_u16 v66, v9, 8, s18
    v_mad_u32_u16 v68, v10, 8, s18
    ds_read_b64 v[64:65], v64
    ds_read_b64 v[66:67], v66
    ds_read_b64 v[68:69], v68
    s_add_u32 s14, s22, 32768
    buffer_load_dwordx4 v[96:99], v1, s[8:11], s14 offen
    s_waitcnt vmcnt(5)
    v_mad_u32_u16 v70, v12, 8, s18
    v_mad_u32_u16 v72, v13, 8, s18
    v_mad_u32_u16 v74, v14, 8, s18
    ds_read_b64 v[70:71], v70
    ds_read_b64 v[72:73], v72
    ds_read_b64 v[74:75], v74
    s_add_u32 s14, s22, 49152
    buffer_load_dwordx4 v[100:103], v1, s[8:11], s14 offen
    s_waitcnt lgkmcnt(6)
    v_or_b32 v7, v108, v109
    s_nop 0
    v_readlane_b32 s30, v7, 0
    v_readlane_b32 s31, v7, 1
    v_readlane_b32 s32, v7, 2
    v_readlane_b32 s33, v7, 3
    v_readlane_b32 s34, v7, 4
    v_readlane_b32 s35, v7, 5
    v_readlane_b32 s36, v7, 6
    v_readlane_b32 s37, v7, 7
    s_mov_b32 s25, s19
    s_mov_b32 s26, s27
    s_mov_b32 s51, s28
    s_mov_b32 s28, s29
    v_mbcnt_lo_u32_b32 v51, s30, 0
    v_mbcnt_hi_u32_b32 v51, s31, v51
    s_bcnt1_i32_b64 s14, s[30:31]
    v_lshl_add_u32 v55, v51, 1, s25
    ds_read_u16 v55, v55
    s_add_u32 s30, s26, 0
    s_lshl1_add_u32 s25, s14, s25
    s_lshl_b32 s14, s14, 10
    s_add_u32 s26, s26, s14
    v_bfe_i32 v108, v11, 2, 10
    v_bfe_i32 v109, v11, 12, 10
    v_ashrrev_i32 v110, 22, v11
    v_cvt_f32_i32 v108, v108
    v_cvt_f32_i32 v109, v109
    v_cvt_f32_i32 v110, v110
    s_waitcnt lgkmcnt(4)
    v_mfma_f32_4x4x4_16b_bf16 v[112:115], v[58:59], v[64:65], 0
    v_mfma_f32_4x4x4_16b_bf16 v[116:119], v[58:59], v[66:67], 0
    v_mfma_f32_4x4x4_16b_bf16 v[120:123], v[58:59], v[68:69], 0
    v_mad_u32_u16 v8, v8, 8, s50 op_sel:[1,0,0,0]
    v_mad_u32_u16 v9, v9, 8, s50 op_sel:[1,0,0,0]
    v_mad_u32_u16 v10, v10, 8, s50 op_sel:[1,0,0,0]
    v_pk_fma_f32 v[114:115], v[114:115], v[108:109], s[20:21] op_sel:[0,0,0] op_sel_hi:[1,0,1]
    v_pk_fma_f32 v[112:113], v[112:113], v[108:109], s[16:17] op_sel:[0,0,0] op_sel_hi:[1,0,1]
    v_pk_fma_f32 v[118:119], v[118:119], v[108:109], s[20:21] op_sel:[0,1,0] op_sel_hi:[1,1,1]
    v_pk_fma_f32 v[116:117], v[116:117], v[108:109], s[16:17] op_sel:[0,1,0] op_sel_hi:[1,1,1]
    v_pk_fma_f32 v[122:123], v[122:123], v[110:111], s[20:21] op_sel:[0,0,0] op_sel_hi:[1,0,1]
    v_pk_fma_f32 v[120:121], v[120:121], v[110:111], s[16:17] op_sel:[0,0,0] op_sel_hi:[1,0,1]
    v_lshlrev_b64 v[114:115], 16, v[114:115]
    v_lshlrev_b64 v[118:119], 16, v[118:119]
    v_lshlrev_b64 v[122:123], 16, v[122:123]
    v_lshl_add_u64 v[64:65], v[112:113], 0, v[114:115]
    v_lshl_add_u64 v[66:67], v[116:117], 0, v[118:119]
    v_lshl_add_u64 v[68:69], v[120:121], 0, v[122:123]
    v_or3_b32 v4, v44, v45, v4
    v_or3_b32 v4, v46, v47, v4
    v_or3_b32 v4, v48, v49, v4
    ds_add_rtn_u64 v[44:45], v8, v[64:65]
    ds_add_rtn_u64 v[46:47], v9, v[66:67]
    ds_add_rtn_u64 v[48:49], v10, v[68:69]
    s_waitcnt lgkmcnt(3)
    v_mad_u32_u16 v55, v55, s23, v2
    v_pk_lshrrev_b16 v55, 10, v55 op_sel_hi:[1,1]
    v_lshl_add_u32 v51, v51, 6, v55
    buffer_load_dwordx4 v[8:11], v51, s[44:47], s30 idxen
    s_sub_u32 s14, s22, 80000
    buffer_load_dwordx4 v[104:107], v124, s[8:11], s14 offen
    s_waitcnt vmcnt(7)
    v_mad_u32_u16 v76, v16, 8, s18
    v_mad_u32_u16 v78, v17, 8, s18
    v_mad_u32_u16 v80, v18, 8, s18
    ds_read_b64 v[76:77], v76
    ds_read_b64 v[78:79], v78
    ds_read_b64 v[80:81], v80
    s_waitcnt vmcnt(6)
    v_mad_u32_u16 v82, v20, 8, s18
    v_mad_u32_u16 v84, v21, 8, s18
    v_mad_u32_u16 v86, v22, 8, s18
    ds_read_b64 v[82:83], v82
    ds_read_b64 v[84:85], v84
    ds_read_b64 v[86:87], v86
    s_cmp_le_u32 s51, 256
    s_cbranch_scc1 L_p2_kernel_noopt3_6
    v_mad_u32_u16 v64, v24, 8, s18
    v_mad_u32_u16 v66, v25, 8, s18
    v_mad_u32_u16 v68, v26, 8, s18
    ds_read_b64 v[64:65], v64
    ds_read_b64 v[66:67], v66
    ds_read_b64 v[68:69], v68
L_p2_kernel_noopt3_6:
    v_mbcnt_lo_u32_b32 v51, s32, 0
    v_mbcnt_hi_u32_b32 v51, s33, v51
    s_bcnt1_i32_b64 s14, s[32:33]
    v_lshl_add_u32 v55, v51, 1, s25
    ds_read_u16 v55, v55
    s_add_u32 s32, s26, 1048576
    s_lshl1_add_u32 s25, s14, s25
    s_lshl_b32 s14, s14, 10
    s_add_u32 s26, s26, s14
    v_bfe_i32 v108, v15, 2, 10
    v_bfe_i32 v109, v15, 12, 10
    v_ashrrev_i32 v110, 22, v15
    v_cvt_f32_i32 v108, v108
    v_cvt_f32_i32 v109, v109
    v_cvt_f32_i32 v110, v110
    v_mfma_f32_4x4x4_16b_bf16 v[112:115], v[58:59], v[70:71], 0
    v_mfma_f32_4x4x4_16b_bf16 v[116:119], v[58:59], v[72:73], 0
    v_mfma_f32_4x4x4_16b_bf16 v[120:123], v[58:59], v[74:75], 0
    v_mad_u32_u16 v12, v12, 8, s50 op_sel:[1,0,0,0]
    v_mad_u32_u16 v13, v13, 8, s50 op_sel:[1,0,0,0]
    v_mad_u32_u16 v14, v14, 8, s50 op_sel:[1,0,0,0]
    v_pk_fma_f32 v[114:115], v[114:115], v[108:109], s[20:21] op_sel:[0,0,0] op_sel_hi:[1,0,1]
    v_pk_fma_f32 v[112:113], v[112:113], v[108:109], s[16:17] op_sel:[0,0,0] op_sel_hi:[1,0,1]
    v_pk_fma_f32 v[118:119], v[118:119], v[108:109], s[20:21] op_sel:[0,1,0] op_sel_hi:[1,1,1]
    v_pk_fma_f32 v[116:117], v[116:117], v[108:109], s[16:17] op_sel:[0,1,0] op_sel_hi:[1,1,1]
    v_pk_fma_f32 v[122:123], v[122:123], v[110:111], s[20:21] op_sel:[0,0,0] op_sel_hi:[1,0,1]
    v_pk_fma_f32 v[120:121], v[120:121], v[110:111], s[16:17] op_sel:[0,0,0] op_sel_hi:[1,0,1]
    v_lshlrev_b64 v[114:115], 16, v[114:115]
    v_lshlrev_b64 v[118:119], 16, v[118:119]
    v_lshlrev_b64 v[122:123], 16, v[122:123]
    v_lshl_add_u64 v[70:71], v[112:113], 0, v[114:115]
    v_lshl_add_u64 v[72:73], v[116:117], 0, v[118:119]
    v_lshl_add_u64 v[74:75], v[120:121], 0, v[122:123]
    s_waitcnt lgkmcnt(7)
    v_or3_b32 v4, v44, v45, v4
    v_or3_b32 v4, v46, v47, v4
    v_or3_b32 v4, v48, v49, v4
    ds_add_rtn_u64 v[44:45], v12, v[70:71]
    ds_add_rtn_u64 v[46:47], v13, v[72:73]
    ds_add_rtn_u64 v[48:49], v14, v[74:75]
    s_waitcnt lgkmcnt(3)
    v_mad_u32_u16 v55, v55, s23, v2
    v_pk_lshrrev_b16 v55, 10, v55 op_sel_hi:[1,1]
    v_lshl_add_u32 v51, v51, 6, v55
    buffer_load_dwordx4 v[12:15], v51, s[44:47], s32 idxen
    s_cmp_lg_u32 s24, 7
    s_cbranch_scc1 L_p2_stage
    s_waitcnt lgkmcnt(0)
    s_branch L_p2_staged
L_p2_stage:
    s_barrier
    s_waitcnt vmcnt(1)
    ds_write_b128 v3, v[88:91] offset:0
    ds_write_b128 v3, v[92:95] offset:16384
    ds_write_b128 v3, v[96:99] offset:32768
    ds_write_b128 v3, v[100:103] offset:49152
    ds_write_b128 v124, v[104:107] offset:0
L_p2_staged:
    v_mbcnt_lo_u32_b32 v51, s34, 0
    v_mbcnt_hi_u32_b32 v51, s35, v51
    s_bcnt1_i32_b64 s14, s[34:35]
    v_lshl_add_u32 v55, v51, 1, s25
    ds_read_u16 v55, v55
    s_add_u32 s34, s26, 2097152
    s_lshl1_add_u32 s25, s14, s25
    s_lshl_b32 s14, s14, 10
    s_add_u32 s26, s26, s14
    v_bfe_i32 v108, v19, 2, 10
    v_bfe_i32 v109, v19, 12, 10
    v_ashrrev_i32 v110, 22, v19
    v_cvt_f32_i32 v108, v108
    v_cvt_f32_i32 v109, v109
    v_cvt_f32_i32 v110, v110
    v_mfma_f32_4x4x4_16b_bf16 v[112:115], v[58:59], v[76:77], 0
    v_mfma_f32_4x4x4_16b_bf16 v[116:119], v[58:59], v[78:79], 0
    v_mfma_f32_4x4x4_16b_bf16 v[120:123], v[58:59], v[80:81], 0
    v_mad_u32_u16 v16, v16, 8, s50 op_sel:[1,0,0,0]
    v_mad_u32_u16 v17, v17, 8, s50 op_sel:[1,0,0,0]
    v_mad_u32_u16 v18, v18, 8, s50 op_sel:[1,0,0,0]
    v_pk_fma_f32 v[114:115], v[114:115], v[108:109], s[20:21] op_sel:[0,0,0] op_sel_hi:[1,0,1]
    v_pk_fma_f32 v[112:113], v[112:113], v[108:109], s[16:17] op_sel:[0,0,0] op_sel_hi:[1,0,1]
    v_pk_fma_f32 v[118:119], v[118:119], v[108:109], s[20:21] op_sel:[0,1,0] op_sel_hi:[1,1,1]
    v_pk_fma_f32 v[116:117], v[116:117], v[108:109], s[16:17] op_sel:[0,1,0] op_sel_hi:[1,1,1]
    v_pk_fma_f32 v[122:123], v[122:123], v[110:111], s[20:21] op_sel:[0,0,0] op_sel_hi:[1,0,1]
    v_pk_fma_f32 v[120:121], v[120:121], v[110:111], s[16:17] op_sel:[0,0,0] op_sel_hi:[1,0,1]
    v_lshlrev_b64 v[114:115], 16, v[114:115]
    v_lshlrev_b64 v[118:119], 16, v[118:119]
    v_lshlrev_b64 v[122:123], 16, v[122:123]
    v_lshl_add_u64 v[76:77], v[112:113], 0, v[114:115]
    v_lshl_add_u64 v[78:79], v[116:117], 0, v[118:119]
    v_lshl_add_u64 v[80:81], v[120:121], 0, v[122:123]
    s_waitcnt lgkmcnt(6)
    v_or3_b32 v4, v44, v45, v4
    v_or3_b32 v4, v46, v47, v4
    v_or3_b32 v4, v48, v49, v4
    ds_add_rtn_u64 v[44:45], v16, v[76:77]
    ds_add_rtn_u64 v[46:47], v17, v[78:79]
    ds_add_rtn_u64 v[48:49], v18, v[80:81]
    s_waitcnt lgkmcnt(3)
    v_mad_u32_u16 v55, v55, s23, v2
    v_pk_lshrrev_b16 v55, 10, v55 op_sel_hi:[1,1]
    v_lshl_add_u32 v51, v51, 6, v55
    buffer_load_dwordx4 v[16:19], v51, s[44:47], s34 idxen
    s_cmp_le_u32 s51, 256
    s_cbranch_scc1 L_p2_kernel_noopt3_7
    v_bfe_i32 v108, v27, 2, 10
    v_bfe_i32 v109, v27, 12, 10
    v_ashrrev_i32 v110, 22, v27
    v_cvt_f32_i32 v108, v108
    v_cvt_f32_i32 v109, v109
    v_cvt_f32_i32 v110, v110
    v_mfma_f32_4x4x4_16b_bf16 v[112:115], v[58:59], v[64:65], 0
    v_mfma_f32_4x4x4_16b_bf16 v[116:119], v[58:59], v[66:67], 0
    v_mfma_f32_4x4x4_16b_bf16 v[120:123], v[58:59], v[68:69], 0
    v_mad_u32_u16 v24, v24, 8, s50 op_sel:[1,0,0,0]
    v_mad_u32_u16 v25, v25, 8, s50 op_sel:[1,0,0,0]
    v_mad_u32_u16 v26, v26, 8, s50 op_sel:[1,0,0,0]
    v_pk_fma_f32 v[114:115], v[114:115], v[108:109], s[20:21] op_sel:[0,0,0] op_sel_hi:[1,0,1]
    v_pk_fma_f32 v[112:113], v[112:113], v[108:109], s[16:17] op_sel:[0,0,0] op_sel_hi:[1,0,1]
    v_pk_fma_f32 v[118:119], v[118:119], v[108:109], s[20:21] op_sel:[0,1,0] op_sel_hi:[1,1,1]
    v_pk_fma_f32 v[116:117], v[116:117], v[108:109], s[16:17] op_sel:[0,1,0] op_sel_hi:[1,1,1]
    v_pk_fma_f32 v[122:123], v[122:123], v[110:111], s[20:21] op_sel:[0,0,0] op_sel_hi:[1,0,1]
    v_pk_fma_f32 v[120:121], v[120:121], v[110:111], s[16:17] op_sel:[0,0,0] op_sel_hi:[1,0,1]
    v_lshlrev_b64 v[114:115], 16, v[114:115]
    v_lshlrev_b64 v[118:119], 16, v[118:119]
    v_lshlrev_b64 v[122:123], 16, v[122:123]
    v_lshl_add_u64 v[64:65], v[112:113], 0, v[114:115]
    v_lshl_add_u64 v[66:67], v[116:117], 0, v[118:119]
    v_lshl_add_u64 v[68:69], v[120:121], 0, v[122:123]
    s_waitcnt lgkmcnt(0)
    v_or3_b32 v4, v44, v45, v4
    v_or3_b32 v4, v46, v47, v4
    v_or3_b32 v4, v48, v49, v4
    ds_add_rtn_u64 v[44:45], v24, v[64:65]
    ds_add_rtn_u64 v[46:47], v25, v[66:67]
    ds_add_rtn_u64 v[48:49], v26, v[68:69]
L_p2_kernel_noopt3_7:
    v_mbcnt_lo_u32_b32 v51, s36, 0
    v_mbcnt_hi_u32_b32 v51, s37, v51
    s_bcnt1_i32_b64 s14, s[36:37]
    v_lshl_add_u32 v55, v51, 1, s25
    ds_read_u16 v55, v55
    s_add_u32 s36, s26, 3145728
    s_lshl1_add_u32 s25, s14, s25
    s_lshl_b32 s14, s14, 10
    s_add_u32 s26, s26, s14
    s_cmp_le_u32 s28, 256
    s_cbranch_scc1 L_p2_kernel_noopt3_8
    v_readlane_b32 s38, v7, 8
    v_readlane_b32 s39, v7, 9
    s_nop 1
    v_mbcnt_lo_u32_b32 v62, s38, 0
    v_mbcnt_hi_u32_b32 v62, s39, v62
    s_bcnt1_i32_b64 s14, s[38:39]
    v_lshl_add_u32 v63, v62, 1, s25
    ds_read_u16 v63, v63
    s_add_u32 s38, s26, 4194304
    s_lshl1_add_u32 s25, s14, s25
    s_lshl_b32 s14, s14, 10
    s_add_u32 s26, s26, s14
L_p2_kernel_noopt3_8:
    v_bfe_i32 v108, v23, 2, 10
    v_bfe_i32 v109, v23, 12, 10
    v_ashrrev_i32 v110, 22, v23
    v_cvt_f32_i32 v108, v108
    v_cvt_f32_i32 v109, v109
    v_cvt_f32_i32 v110, v110
    v_mfma_f32_4x4x4_16b_bf16 v[112:115], v[58:59], v[82:83], 0
    v_mfma_f32_4x4x4_16b_bf16 v[116:119], v[58:59], v[84:85], 0
    v_mfma_f32_4x4x4_16b_bf16 v[120:123], v[58:59], v[86:87], 0
    v_mad_u32_u16 v20, v20, 8, s50 op_sel:[1,0,0,0]
    v_mad_u32_u16 v21, v21, 8, s50 op_sel:[1,0,0,0]
    v_mad_u32_u16 v22, v22, 8, s50 op_sel:[1,0,0,0]
    v_pk_fma_f32 v[114:115], v[114:115], v[108:109], s[20:21] op_sel:[0,0,0] op_sel_hi:[1,0,1]
    v_pk_fma_f32 v[112:113], v[112:113], v[108:109], s[16:17] op_sel:[0,0,0] op_sel_hi:[1,0,1]
    v_pk_fma_f32 v[118:119], v[118:119], v[108:109], s[20:21] op_sel:[0,1,0] op_sel_hi:[1,1,1]
    v_pk_fma_f32 v[116:117], v[116:117], v[108:109], s[16:17] op_sel:[0,1,0] op_sel_hi:[1,1,1]
    v_pk_fma_f32 v[122:123], v[122:123], v[110:111], s[20:21] op_sel:[0,0,0] op_sel_hi:[1,0,1]
    v_pk_fma_f32 v[120:121], v[120:121], v[110:111], s[16:17] op_sel:[0,0,0] op_sel_hi:[1,0,1]
    v_lshlrev_b64 v[114:115], 16, v[114:115]
    v_lshlrev_b64 v[118:119], 16, v[118:119]
    v_lshlrev_b64 v[122:123], 16, v[122:123]
    v_lshl_add_u64 v[82:83], v[112:113], 0, v[114:115]
    v_lshl_add_u64 v[84:85], v[116:117], 0, v[118:119]
    v_lshl_add_u64 v[86:87], v[120:121], 0, v[122:123]
    s_waitcnt lgkmcnt(1)
    v_or3_b32 v4, v44, v45, v4
    v_or3_b32 v4, v46, v47, v4
    v_or3_b32 v4, v48, v49, v4
    ds_add_rtn_u64 v[44:45], v20, v[82:83]
    ds_add_rtn_u64 v[46:47], v21, v[84:85]
    ds_add_rtn_u64 v[48:49], v22, v[86:87]
    s_waitcnt lgkmcnt(3)
    v_mad_u32_u16 v55, v55, s23, v2
    v_pk_lshrrev_b16 v55, 10, v55 op_sel_hi:[1,1]
    v_lshl_add_u32 v51, v51, 6, v55
    buffer_load_dwordx4 v[20:23], v51, s[44:47], s36 idxen
    s_cmp_le_u32 s28, 256
    s_cbranch_scc1 L_p2_kernel_noopt3_9
    v_mad_u32_u16 v63, v63, s23, v2
    v_pk_lshrrev_b16 v63, 10, v63 op_sel_hi:[1,1]
    v_lshl_add_u32 v62, v62, 6, v63
    buffer_load_dwordx4 v[24:27], v62, s[44:47], s38 idxen
L_p2_kernel_noopt3_9:
    s_add_u32 s14, s22, 80000
    buffer_load_dwordx4 v[88:91], v1, s[8:11], s14 offen
    s_cmp_eq_u32 s24, 7
    s_cbranch_scc1 L_p2_exit
    s_add_u32 s14, s24, 1
    s_min_u32 s14, s14, 7
    s_set_gpr_idx_on s14, gpr_idx(SRC0)
    v_mad_u32_u16 v108, v28, v50, s40 op_sel:[1,0,0,0]
    v_mad_u32_u16 v109, v36, v50, s41 op_sel:[1,0,0,0]
    s_set_gpr_idx_off
    v_sub_u32_sdwa v110, v109, v108 dst_sel:DWORD dst_unused:UNUSED_PAD src0_sel:WORD_1 src1_sel:WORD_1
    s_nop 1
    v_add_u32_dpp v110, v110, v110 row_shr:1 row_mask:0xf bank_mask:0xf bound_ctrl:0
    s_nop 1
    v_add_u32_dpp v110, v110, v110 row_shr:2 row_mask:0xf bank_mask:0xf bound_ctrl:0
    s_nop 1
    v_add_u32_dpp v110, v110, v110 row_shr:4 row_mask:0xf bank_mask:0xf bound_ctrl:0
    s_nop 1
    v_add_u32_dpp v110, v110, v110 row_shr:8 row_mask:0xf bank_mask:0xf bound_ctrl:0
    s_nop 1
    v_add_u32_dpp v110, v110, v110 row_bcast:15 row_mask:0xa bank_mask:0xf
    s_nop 1
    v_add_u32_dpp v110, v110, v110 row_bcast:31 row_mask:0xc bank_mask:0xf
    v_sub_u32_sdwa v109, v109, v110 dst_sel:DWORD dst_unused:UNUSED_PAD src0_sel:WORD_1 src1_sel:DWORD
    v_readlane_b32 s29, v110, 63
    v_add_u32 v110, -1, v110
    ds_write_b16 v126, v109
    v_lshlrev_b32_e64 v111, v110, 1
    v_lshrrev_b32 v110, 5, v110
    s_cmp_gt_u32 s29, 320
    s_cselect_b32 s2, 1, s2
    v_lshl_add_u32 v110, v110, 2, v127
    s_cselect_b64 exec, 0, -1
    ds_or_b32 v110, v111 offset:136
    s_mov_b64 exec, -1
    ds_wrxchg2_rtn_b32 v[108:109], v6, v5, v5 offset0:34 offset1:44
    s_add_u32 s14, s22, 96384
    buffer_load_dwordx4 v[92:95], v1, s[8:11], s14 offen
    s_add_u32 s24, s24, 1
    s_cmp_lt_u32 s24, 8
    s_barrier
    s_cbranch_scc1 L_p2_loop
L_p2_exit:
    s_waitcnt lgkmcnt(0)
    v_or3_b32 v4, v44, v45, v4
    v_or3_b32 v4, v46, v47, v4
    v_or3_b32 v4, v48, v49, v4
    s_mov_b32 s27, s19
    s_waitcnt vmcnt(0)
    v_mov_b64 v[64:65], v[28:29]
    v_mov_b64 v[66:67], v[30:31]
    v_mov_b64 v[68:69], v[36:37]
    v_mov_b64 v[70:71], v[38:39]
    v_mov_b32 v8, 160232
    s_cmp_lg_u32 s13, 0
    s_cselect_b64 exec, 0, 1
    ds_write_b32 v8, v52
    s_mov_b64 exec, -1
    v_subrev_u32 v6, 80000, v124
    s_mul_i32 s24, s12, 20000
    v_subrev_u32 v10, s24, v1
    v_mov_b32 v11, 0x7f000000
    s_waitcnt vmcnt(0) lgkmcnt(0)
    s_barrier
    s_cmp_lt_u32 s13, 12
    s_cbranch_scc1 L_p2_ga
L_p2_ga:
    ds_read_b32 v9, v8
    ds_read_b128 v[88:91], v1 offset:0
    ds_read_b128 v[92:95], v1 offset:16384
    ds_read_b128 v[96:99], v1 offset:32768
    ds_read_b128 v[100:103], v1 offset:49152
    ds_read_b128 v[104:107], v6
    s_mul_i32 s14, s12, 5120000
    s_mul_i32 s15, s3, 80000
    s_add_u32 s25, s14, s15
    s_add_u32 s25, s25, 228589568
    s_waitcnt lgkmcnt(5)
    v_readfirstlane_b32 s21, v9
    s_nop 0
    s_bfe_u32 s21, s21, 524296
    s_cmp_lg_u32 s21, 4
    s_cselect_b32 s21, 1, 0
    s_cselect_b32 s24, 0, 20000
    v_cmp_le_u32 vcc, s24, v10
    v_add_u32 v10, 16384, v10
    s_add_u32 s14, s25, 0
    v_cndmask_b32 v12, v11, v1, vcc
    s_waitcnt lgkmcnt(4)
    buffer_store_dwordx4 v[88:91], v12, s[4:7], s14 offen sc1
    v_or3_b32 v4, v88, v89, v4
    v_or3_b32 v4, v90, v91, v4
    v_cmp_le_u32 vcc, s24, v10
    v_add_u32 v10, 16384, v10
    s_add_u32 s14, s25, 16384
    v_cndmask_b32 v12, v11, v1, vcc
    s_waitcnt lgkmcnt(3)
    buffer_store_dwordx4 v[92:95], v12, s[4:7], s14 offen sc1
    v_or3_b32 v4, v92, v93, v4
    v_or3_b32 v4, v94, v95, v4
    v_cmp_le_u32 vcc, s24, v10
    v_add_u32 v10, 16384, v10
    s_add_u32 s14, s25, 32768
    v_cndmask_b32 v12, v11, v1, vcc
    s_waitcnt lgkmcnt(2)
    buffer_store_dwordx4 v[96:99], v12, s[4:7], s14 offen sc1
    v_or3_b32 v4, v96, v97, v4
    v_or3_b32 v4, v98, v99, v4
    v_cmp_le_u32 vcc, s24, v10
    v_add_u32 v10, 16384, v10
    s_add_u32 s14, s25, 49152
    v_cndmask_b32 v12, v11, v1, vcc
    s_waitcnt lgkmcnt(1)
    buffer_store_dwordx4 v[100:103], v12, s[4:7], s14 offen sc1
    v_or3_b32 v4, v100, v101, v4
    v_or3_b32 v4, v102, v103, v4
    v_cmp_le_u32 vcc, s24, v10
    v_add_u32 v10, 16384, v10
    s_add_u32 s14, s25, 0
    v_cndmask_b32 v12, v11, v6, vcc
    s_waitcnt lgkmcnt(0)
    buffer_store_dwordx4 v[104:107], v12, s[4:7], s14 offen sc1
    v_or3_b32 v4, v104, v105, v4
    v_or3_b32 v4, v106, v107, v4
    s_load_dwordx2 s[16:17], s[0:1], 88
    s_cmp_ge_u32 s13, 12
    s_cbranch_scc1 L_p2_gb
    v_lshlrev_b32 v30, 16, v60
    v_and_b32 v31, 0xffff0000, v60
    v_lshlrev_b32 v36, 16, v53
    v_and_b32 v37, 0xffff0000, v53
    v_lshlrev_b32 v38, 16, v54
    v_and_b32 v39, 0xffff0000, v54
    v_lshlrev_b32 v40, 16, v56
    v_and_b32 v41, 0xffff0000, v56
    v_lshlrev_b32 v42, 16, v57
    v_and_b32 v43, 0xffff0000, v57
    v_pk_add_f32 v[14:15], v[30:31], v[36:37] op_sel:[0,0] op_sel_hi:[1,0] neg_lo:[0,1] neg_hi:[0,1]
    v_pk_add_f32 v[16:17], v[30:31], v[36:37] op_sel:[0,1] op_sel_hi:[1,1] neg_lo:[0,1] neg_hi:[0,1]
    v_pk_add_f32 v[18:19], v[30:31], v[38:39] op_sel:[0,0] op_sel_hi:[1,0] neg_lo:[0,1] neg_hi:[0,1]
    v_pk_add_f32 v[20:21], v[30:31], v[38:39] op_sel:[0,1] op_sel_hi:[1,1] neg_lo:[0,1] neg_hi:[0,1]
    v_pk_add_f32 v[22:23], v[30:31], v[40:41] op_sel:[0,0] op_sel_hi:[1,0] neg_lo:[0,1] neg_hi:[0,1]
    v_pk_add_f32 v[24:25], v[30:31], v[40:41] op_sel:[0,1] op_sel_hi:[1,1] neg_lo:[0,1] neg_hi:[0,1]
    v_pk_add_f32 v[26:27], v[30:31], v[42:43] op_sel:[0,0] op_sel_hi:[1,0] neg_lo:[0,1] neg_hi:[0,1]
    v_pk_add_f32 v[28:29], v[30:31], v[42:43] op_sel:[0,1] op_sel_hi:[1,1] neg_lo:[0,1] neg_hi:[0,1]
    v_cvt_pk_bf16_f32 v32, v14, v15
    v_lshlrev_b32 v14, 16, v32
    v_and_b32 v15, 0xffff0000, v32
    v_cvt_pk_bf16_f32 v32, v16, v17
    v_lshlrev_b32 v16, 16, v32
    v_and_b32 v17, 0xffff0000, v32
    v_cvt_pk_bf16_f32 v32, v18, v19
    v_lshlrev_b32 v18, 16, v32
    v_and_b32 v19, 0xffff0000, v32
    v_cvt_pk_bf16_f32 v32, v20, v21
    v_lshlrev_b32 v20, 16, v32
    v_and_b32 v21, 0xffff0000, v32
    v_cvt_pk_bf16_f32 v32, v22, v23
    v_lshlrev_b32 v22, 16, v32
    v_and_b32 v23, 0xffff0000, v32
    v_cvt_pk_bf16_f32 v32, v24, v25
    v_lshlrev_b32 v24, 16, v32
    v_and_b32 v25, 0xffff0000, v32
    v_cvt_pk_bf16_f32 v32, v26, v27
    v_lshlrev_b32 v26, 16, v32
    v_and_b32 v27, 0xffff0000, v32
    v_cvt_pk_bf16_f32 v32, v28, v29
    v_lshlrev_b32 v28, 16, v32
    v_and_b32 v29, 0xffff0000, v32
    v_pk_mul_f32 v[14:15], v[14:15], v[14:15]
    v_pk_mul_f32 v[16:17], v[16:17], v[16:17]
    v_pk_mul_f32 v[18:19], v[18:19], v[18:19]
    v_pk_mul_f32 v[20:21], v[20:21], v[20:21]
    v_pk_mul_f32 v[22:23], v[22:23], v[22:23]
    v_pk_mul_f32 v[24:25], v[24:25], v[24:25]
    v_pk_mul_f32 v[26:27], v[26:27], v[26:27]
    v_pk_mul_f32 v[28:29], v[28:29], v[28:29]
    v_cvt_pk_bf16_f32 v32, v14, v15
    v_lshlrev_b32 v14, 16, v32
    v_and_b32 v15, 0xffff0000, v32
    v_cvt_pk_bf16_f32 v32, v16, v17
    v_lshlrev_b32 v16, 16, v32
    v_and_b32 v17, 0xffff0000, v32
    v_cvt_pk_bf16_f32 v32, v18, v19
    v_lshlrev_b32 v18, 16, v32
    v_and_b32 v19, 0xffff0000, v32
    v_cvt_pk_bf16_f32 v32, v20, v21
    v_lshlrev_b32 v20, 16, v32
    v_and_b32 v21, 0xffff0000, v32
    v_cvt_pk_bf16_f32 v32, v22, v23
    v_lshlrev_b32 v22, 16, v32
    v_and_b32 v23, 0xffff0000, v32
    v_cvt_pk_bf16_f32 v32, v24, v25
    v_lshlrev_b32 v24, 16, v32
    v_and_b32 v25, 0xffff0000, v32
    v_cvt_pk_bf16_f32 v32, v26, v27
    v_lshlrev_b32 v26, 16, v32
    v_and_b32 v27, 0xffff0000, v32
    v_cvt_pk_bf16_f32 v32, v28, v29
    v_lshlrev_b32 v28, 16, v32
    v_and_b32 v29, 0xffff0000, v32
    v_mov_b32 v30, 1092616192
    v_mov_b32 v31, 0x3fb8aa3b
    v_pk_mul_f32 v[14:15], v[14:15], v[30:31] op_sel:[0,0] op_sel_hi:[1,0]
    v_pk_mul_f32 v[16:17], v[16:17], v[30:31] op_sel:[0,0] op_sel_hi:[1,0]
    v_pk_mul_f32 v[18:19], v[18:19], v[30:31] op_sel:[0,0] op_sel_hi:[1,0]
    v_pk_mul_f32 v[20:21], v[20:21], v[30:31] op_sel:[0,0] op_sel_hi:[1,0]
    v_pk_mul_f32 v[22:23], v[22:23], v[30:31] op_sel:[0,0] op_sel_hi:[1,0]
    v_pk_mul_f32 v[24:25], v[24:25], v[30:31] op_sel:[0,0] op_sel_hi:[1,0]
    v_pk_mul_f32 v[26:27], v[26:27], v[30:31] op_sel:[0,0] op_sel_hi:[1,0]
    v_pk_mul_f32 v[28:29], v[28:29], v[30:31] op_sel:[0,0] op_sel_hi:[1,0]
    v_cvt_pk_bf16_f32 v32, v14, v15
    v_lshlrev_b32 v14, 16, v32
    v_and_b32 v15, 0xffff0000, v32
    v_cvt_pk_bf16_f32 v32, v16, v17
    v_lshlrev_b32 v16, 16, v32
    v_and_b32 v17, 0xffff0000, v32
    v_cvt_pk_bf16_f32 v32, v18, v19
    v_lshlrev_b32 v18, 16, v32
    v_and_b32 v19, 0xffff0000, v32
    v_cvt_pk_bf16_f32 v32, v20, v21
    v_lshlrev_b32 v20, 16, v32
    v_and_b32 v21, 0xffff0000, v32
    v_cvt_pk_bf16_f32 v32, v22, v23
    v_lshlrev_b32 v22, 16, v32
    v_and_b32 v23, 0xffff0000, v32
    v_cvt_pk_bf16_f32 v32, v24, v25
    v_lshlrev_b32 v24, 16, v32
    v_and_b32 v25, 0xffff0000, v32
    v_cvt_pk_bf16_f32 v32, v26, v27
    v_lshlrev_b32 v26, 16, v32
    v_and_b32 v27, 0xffff0000, v32
    v_cvt_pk_bf16_f32 v32, v28, v29
    v_lshlrev_b32 v28, 16, v32
    v_and_b32 v29, 0xffff0000, v32
    v_pk_mul_f32 v[14:15], v[14:15], v[30:31] op_sel:[0,1] op_sel_hi:[1,1]
    v_pk_mul_f32 v[16:17], v[16:17], v[30:31] op_sel:[0,1] op_sel_hi:[1,1]
    v_pk_mul_f32 v[18:19], v[18:19], v[30:31] op_sel:[0,1] op_sel_hi:[1,1]
    v_pk_mul_f32 v[20:21], v[20:21], v[30:31] op_sel:[0,1] op_sel_hi:[1,1]
    v_pk_mul_f32 v[22:23], v[22:23], v[30:31] op_sel:[0,1] op_sel_hi:[1,1]
    v_pk_mul_f32 v[24:25], v[24:25], v[30:31] op_sel:[0,1] op_sel_hi:[1,1]
    v_pk_mul_f32 v[26:27], v[26:27], v[30:31] op_sel:[0,1] op_sel_hi:[1,1]
    v_pk_mul_f32 v[28:29], v[28:29], v[30:31] op_sel:[0,1] op_sel_hi:[1,1]
    v_exp_f32 v14, -v14
    v_exp_f32 v15, -v15
    v_exp_f32 v16, -v16
    v_exp_f32 v17, -v17
    v_exp_f32 v18, -v18
    v_exp_f32 v19, -v19
    v_exp_f32 v20, -v20
    v_exp_f32 v21, -v21
    v_exp_f32 v22, -v22
    v_exp_f32 v23, -v23
    v_exp_f32 v24, -v24
    v_exp_f32 v25, -v25
    v_exp_f32 v26, -v26
    v_exp_f32 v27, -v27
    v_exp_f32 v28, -v28
    v_exp_f32 v29, -v29
    v_cvt_pk_bf16_f32 v14, v14, v16
    v_cvt_pk_bf16_f32 v15, v15, v17
    v_cvt_pk_bf16_f32 v18, v18, v20
    v_cvt_pk_bf16_f32 v19, v19, v21
    v_cvt_pk_bf16_f32 v22, v22, v24
    v_cvt_pk_bf16_f32 v23, v23, v25
    v_cvt_pk_bf16_f32 v26, v26, v28
    v_cvt_pk_bf16_f32 v27, v27, v29
    v_dot2_f32_bf16 v72, v14, s68, 0
    v_dot2_f32_bf16 v73, v15, s68, 0
    v_dot2_f32_bf16 v74, v14, s69, 0
    v_dot2_f32_bf16 v75, v15, s69, 0
    v_dot2_f32_bf16 v76, v14, s70, 0
    v_dot2_f32_bf16 v77, v15, s70, 0
    v_dot2_f32_bf16 v78, v14, s71, 0
    v_dot2_f32_bf16 v79, v15, s71, 0
    v_dot2_f32_bf16 v80, v14, s52, 0
    v_dot2_f32_bf16 v81, v15, s52, 0
    v_dot2_f32_bf16 v82, v14, s53, 0
    v_dot2_f32_bf16 v83, v15, s53, 0
    v_dot2_f32_bf16 v84, v14, s54, 0
    v_dot2_f32_bf16 v85, v15, s54, 0
    v_dot2_f32_bf16 v86, v14, s55, 0
    v_dot2_f32_bf16 v87, v15, s55, 0
    v_dot2_f32_bf16 v72, v18, s72, v72
    v_dot2_f32_bf16 v73, v19, s72, v73
    v_dot2_f32_bf16 v74, v18, s73, v74
    v_dot2_f32_bf16 v75, v19, s73, v75
    v_dot2_f32_bf16 v76, v18, s74, v76
    v_dot2_f32_bf16 v77, v19, s74, v77
    v_dot2_f32_bf16 v78, v18, s75, v78
    v_dot2_f32_bf16 v79, v19, s75, v79
    v_dot2_f32_bf16 v80, v18, s56, v80
    v_dot2_f32_bf16 v81, v19, s56, v81
    v_dot2_f32_bf16 v82, v18, s57, v82
    v_dot2_f32_bf16 v83, v19, s57, v83
    v_dot2_f32_bf16 v84, v18, s58, v84
    v_dot2_f32_bf16 v85, v19, s58, v85
    v_dot2_f32_bf16 v86, v18, s59, v86
    v_dot2_f32_bf16 v87, v19, s59, v87
    v_dot2_f32_bf16 v72, v22, s76, v72
    v_dot2_f32_bf16 v73, v23, s76, v73
    v_dot2_f32_bf16 v74, v22, s77, v74
    v_dot2_f32_bf16 v75, v23, s77, v75
    v_dot2_f32_bf16 v76, v22, s78, v76
    v_dot2_f32_bf16 v77, v23, s78, v77
    v_dot2_f32_bf16 v78, v22, s79, v78
    v_dot2_f32_bf16 v79, v23, s79, v79
    v_dot2_f32_bf16 v80, v22, s60, v80
    v_dot2_f32_bf16 v81, v23, s60, v81
    v_dot2_f32_bf16 v82, v22, s61, v82
    v_dot2_f32_bf16 v83, v23, s61, v83
    v_dot2_f32_bf16 v84, v22, s62, v84
    v_dot2_f32_bf16 v85, v23, s62, v85
    v_dot2_f32_bf16 v86, v22, s63, v86
    v_dot2_f32_bf16 v87, v23, s63, v87
    v_dot2_f32_bf16 v72, v26, s80, v72
    v_dot2_f32_bf16 v73, v27, s80, v73
    v_dot2_f32_bf16 v74, v26, s81, v74
    v_dot2_f32_bf16 v75, v27, s81, v75
    v_dot2_f32_bf16 v76, v26, s82, v76
    v_dot2_f32_bf16 v77, v27, s82, v77
    v_dot2_f32_bf16 v78, v26, s83, v78
    v_dot2_f32_bf16 v79, v27, s83, v79
    v_dot2_f32_bf16 v80, v26, s64, v80
    v_dot2_f32_bf16 v81, v27, s64, v81
    v_dot2_f32_bf16 v82, v26, s65, v82
    v_dot2_f32_bf16 v83, v27, s65, v83
    v_dot2_f32_bf16 v84, v26, s66, v84
    v_dot2_f32_bf16 v85, v27, s66, v85
    v_dot2_f32_bf16 v86, v26, s67, v86
    v_dot2_f32_bf16 v87, v27, s67, v87
L_p2_gb:
    v_and_b32 v4, 0x80008000, v4
    v_cmp_ne_u32 vcc, 0, v4
    v_mov_b32 v8, s27
    v_and_b32 v10, 15, v0
    v_mul_u32_u24 v10, 240, v10
    v_add_u32 v10, 160000, v10
    s_cmp_lg_u64 vcc, 0
    s_cselect_b32 s2, 1, s2
    v_mov_b32 v9, s2
    s_mov_b64 exec, 1
    ds_write_b32 v8, v9
    s_mov_b64 exec, -1
    v_add_u32 v2, 16384, v1
    v_mov_b32 v9, 0x3f000000
    v_cmp_gt_u32 vcc, 226, v0
    s_mov_b32 s49, s12
    s_mov_b32 s51, 0
    v_cndmask_b32 v2, v9, v2, vcc
    s_waitcnt vmcnt(0) lgkmcnt(0)
    s_barrier
    ds_read_b32 v9, v10
    s_mov_b32 s18, 5120000
    s_mov_b32 s19, 0x00020000
    s_waitcnt lgkmcnt(0)
    v_cmp_ne_u32 vcc, 0, v9
    s_nop 1
    s_cmp_lg_u64 vcc, 0
    s_cselect_b32 s2, 1, 0
    s_cbranch_scc1 L_p2_slow
L_p2_signal:
    v_mov_b32 v8, 160228
    s_lshl_b32 s15, s2, 4
    s_or_b32 s15, s15, s21
    s_add_u32 s14, s12, 16
    s_lshl_b32 s20, s15, s14
    s_add_u32 s20, s20, 1
    v_mov_b32 v9, s20
    s_cmp_lg_u32 s13, 15
    s_cbranch_scc1 L_p2_nosig0
    s_lshl_b32 s14, s3, 8
    s_add_u32 s14, s14, 8523776
    s_mov_b64 exec, 1
    buffer_atomic_add v9, off, s[4:7], s14 sc0
    s_mov_b64 exec, -1
L_p2_nosig0:
    s_lshl2_add_u32 s14, s3, s49
    s_mul_i32 s26, s14, 20000
    s_mov_b32 s10, 5120000
    s_lshl_b32 s28, s92, 16
    s_and_b32 s29, s92, 0xffff0000
    s_lshl_b32 s30, s93, 16
    s_and_b32 s31, s93, 0xffff0000
    s_lshl_b32 s32, s94, 16
    s_and_b32 s33, s94, 0xffff0000
    s_lshl_b32 s34, s95, 16
    s_and_b32 s35, s95, 0xffff0000
    s_lshl_b32 s36, s96, 16
    s_and_b32 s37, s96, 0xffff0000
    s_lshl_b32 s38, s97, 16
    s_and_b32 s39, s97, 0xffff0000
    s_lshl_b32 s40, s98, 16
    s_and_b32 s41, s98, 0xffff0000
    s_lshl_b32 s42, s99, 16
    s_and_b32 s43, s99, 0xffff0000
    s_and_b32 s99, s91, 0xffff0000
    s_lshl_b32 s98, s91, 16
    s_and_b32 s97, s90, 0xffff0000
    s_lshl_b32 s96, s90, 16
    s_and_b32 s95, s89, 0xffff0000
    s_lshl_b32 s94, s89, 16
    s_and_b32 s93, s88, 0xffff0000
    s_lshl_b32 s92, s88, 16
    s_and_b32 s91, s87, 0xffff0000
    s_lshl_b32 s90, s87, 16
    s_and_b32 s89, s86, 0xffff0000
    s_lshl_b32 s88, s86, 16
    s_and_b32 s87, s85, 0xffff0000
    s_lshl_b32 s86, s85, 16
    s_and_b32 s85, s84, 0xffff0000
    s_lshl_b32 s84, s84, 16
    s_mov_b32 s44, s48
    s_add_u32 s45, s48, 2281701376
    s_cmp_eq_u32 s48, 0
    s_cselect_b32 s45, 0, s45
    s_cmp_lt_u32 s13, 12
    s_cbranch_scc1 L_p2_gc
    v_lshlrev_b32 v30, 16, v60
    v_and_b32 v31, 0xffff0000, v60
    v_lshlrev_b32 v36, 16, v53
    v_and_b32 v37, 0xffff0000, v53
    v_lshlrev_b32 v38, 16, v54
    v_and_b32 v39, 0xffff0000, v54
    v_lshlrev_b32 v40, 16, v56
    v_and_b32 v41, 0xffff0000, v56
    v_lshlrev_b32 v42, 16, v57
    v_and_b32 v43, 0xffff0000, v57
    v_pk_add_f32 v[14:15], v[30:31], v[36:37] op_sel:[0,0] op_sel_hi:[1,0] neg_lo:[0,1] neg_hi:[0,1]
    v_pk_add_f32 v[16:17], v[30:31], v[36:37] op_sel:[0,1] op_sel_hi:[1,1] neg_lo:[0,1] neg_hi:[0,1]
    v_pk_add_f32 v[18:19], v[30:31], v[38:39] op_sel:[0,0] op_sel_hi:[1,0] neg_lo:[0,1] neg_hi:[0,1]
    v_pk_add_f32 v[20:21], v[30:31], v[38:39] op_sel:[0,1] op_sel_hi:[1,1] neg_lo:[0,1] neg_hi:[0,1]
    v_pk_add_f32 v[22:23], v[30:31], v[40:41] op_sel:[0,0] op_sel_hi:[1,0] neg_lo:[0,1] neg_hi:[0,1]
    v_pk_add_f32 v[24:25], v[30:31], v[40:41] op_sel:[0,1] op_sel_hi:[1,1] neg_lo:[0,1] neg_hi:[0,1]
    v_pk_add_f32 v[26:27], v[30:31], v[42:43] op_sel:[0,0] op_sel_hi:[1,0] neg_lo:[0,1] neg_hi:[0,1]
    v_pk_add_f32 v[28:29], v[30:31], v[42:43] op_sel:[0,1] op_sel_hi:[1,1] neg_lo:[0,1] neg_hi:[0,1]
    v_cvt_pk_bf16_f32 v32, v14, v15
    v_lshlrev_b32 v14, 16, v32
    v_and_b32 v15, 0xffff0000, v32
    v_cvt_pk_bf16_f32 v32, v16, v17
    v_lshlrev_b32 v16, 16, v32
    v_and_b32 v17, 0xffff0000, v32
    v_cvt_pk_bf16_f32 v32, v18, v19
    v_lshlrev_b32 v18, 16, v32
    v_and_b32 v19, 0xffff0000, v32
    v_cvt_pk_bf16_f32 v32, v20, v21
    v_lshlrev_b32 v20, 16, v32
    v_and_b32 v21, 0xffff0000, v32
    v_cvt_pk_bf16_f32 v32, v22, v23
    v_lshlrev_b32 v22, 16, v32
    v_and_b32 v23, 0xffff0000, v32
    v_cvt_pk_bf16_f32 v32, v24, v25
    v_lshlrev_b32 v24, 16, v32
    v_and_b32 v25, 0xffff0000, v32
    v_cvt_pk_bf16_f32 v32, v26, v27
    v_lshlrev_b32 v26, 16, v32
    v_and_b32 v27, 0xffff0000, v32
    v_cvt_pk_bf16_f32 v32, v28, v29
    v_lshlrev_b32 v28, 16, v32
    v_and_b32 v29, 0xffff0000, v32
    v_pk_mul_f32 v[14:15], v[14:15], v[14:15]
    v_pk_mul_f32 v[16:17], v[16:17], v[16:17]
    v_pk_mul_f32 v[18:19], v[18:19], v[18:19]
    v_pk_mul_f32 v[20:21], v[20:21], v[20:21]
    v_pk_mul_f32 v[22:23], v[22:23], v[22:23]
    v_pk_mul_f32 v[24:25], v[24:25], v[24:25]
    v_pk_mul_f32 v[26:27], v[26:27], v[26:27]
    v_pk_mul_f32 v[28:29], v[28:29], v[28:29]
    v_cvt_pk_bf16_f32 v32, v14, v15
    v_lshlrev_b32 v14, 16, v32
    v_and_b32 v15, 0xffff0000, v32
    v_cvt_pk_bf16_f32 v32, v16, v17
    v_lshlrev_b32 v16, 16, v32
    v_and_b32 v17, 0xffff0000, v32
    v_cvt_pk_bf16_f32 v32, v18, v19
    v_lshlrev_b32 v18, 16, v32
    v_and_b32 v19, 0xffff0000, v32
    v_cvt_pk_bf16_f32 v32, v20, v21
    v_lshlrev_b32 v20, 16, v32
    v_and_b32 v21, 0xffff0000, v32
    v_cvt_pk_bf16_f32 v32, v22, v23
    v_lshlrev_b32 v22, 16, v32
    v_and_b32 v23, 0xffff0000, v32
    v_cvt_pk_bf16_f32 v32, v24, v25
    v_lshlrev_b32 v24, 16, v32
    v_and_b32 v25, 0xffff0000, v32
    v_cvt_pk_bf16_f32 v32, v26, v27
    v_lshlrev_b32 v26, 16, v32
    v_and_b32 v27, 0xffff0000, v32
    v_cvt_pk_bf16_f32 v32, v28, v29
    v_lshlrev_b32 v28, 16, v32
    v_and_b32 v29, 0xffff0000, v32
    v_mov_b32 v30, 1092616192
    v_mov_b32 v31, 0x3fb8aa3b
    v_pk_mul_f32 v[14:15], v[14:15], v[30:31] op_sel:[0,0] op_sel_hi:[1,0]
    v_pk_mul_f32 v[16:17], v[16:17], v[30:31] op_sel:[0,0] op_sel_hi:[1,0]
    v_pk_mul_f32 v[18:19], v[18:19], v[30:31] op_sel:[0,0] op_sel_hi:[1,0]
    v_pk_mul_f32 v[20:21], v[20:21], v[30:31] op_sel:[0,0] op_sel_hi:[1,0]
    v_pk_mul_f32 v[22:23], v[22:23], v[30:31] op_sel:[0,0] op_sel_hi:[1,0]
    v_pk_mul_f32 v[24:25], v[24:25], v[30:31] op_sel:[0,0] op_sel_hi:[1,0]
    v_pk_mul_f32 v[26:27], v[26:27], v[30:31] op_sel:[0,0] op_sel_hi:[1,0]
    v_pk_mul_f32 v[28:29], v[28:29], v[30:31] op_sel:[0,0] op_sel_hi:[1,0]
    v_cvt_pk_bf16_f32 v32, v14, v15
    v_lshlrev_b32 v14, 16, v32
    v_and_b32 v15, 0xffff0000, v32
    v_cvt_pk_bf16_f32 v32, v16, v17
    v_lshlrev_b32 v16, 16, v32
    v_and_b32 v17, 0xffff0000, v32
    v_cvt_pk_bf16_f32 v32, v18, v19
    v_lshlrev_b32 v18, 16, v32
    v_and_b32 v19, 0xffff0000, v32
    v_cvt_pk_bf16_f32 v32, v20, v21
    v_lshlrev_b32 v20, 16, v32
    v_and_b32 v21, 0xffff0000, v32
    v_cvt_pk_bf16_f32 v32, v22, v23
    v_lshlrev_b32 v22, 16, v32
    v_and_b32 v23, 0xffff0000, v32
    v_cvt_pk_bf16_f32 v32, v24, v25
    v_lshlrev_b32 v24, 16, v32
    v_and_b32 v25, 0xffff0000, v32
    v_cvt_pk_bf16_f32 v32, v26, v27
    v_lshlrev_b32 v26, 16, v32
    v_and_b32 v27, 0xffff0000, v32
    v_cvt_pk_bf16_f32 v32, v28, v29
    v_lshlrev_b32 v28, 16, v32
    v_and_b32 v29, 0xffff0000, v32
    v_pk_mul_f32 v[14:15], v[14:15], v[30:31] op_sel:[0,1] op_sel_hi:[1,1]
    v_pk_mul_f32 v[16:17], v[16:17], v[30:31] op_sel:[0,1] op_sel_hi:[1,1]
    v_pk_mul_f32 v[18:19], v[18:19], v[30:31] op_sel:[0,1] op_sel_hi:[1,1]
    v_pk_mul_f32 v[20:21], v[20:21], v[30:31] op_sel:[0,1] op_sel_hi:[1,1]
    v_pk_mul_f32 v[22:23], v[22:23], v[30:31] op_sel:[0,1] op_sel_hi:[1,1]
    v_pk_mul_f32 v[24:25], v[24:25], v[30:31] op_sel:[0,1] op_sel_hi:[1,1]
    v_pk_mul_f32 v[26:27], v[26:27], v[30:31] op_sel:[0,1] op_sel_hi:[1,1]
    v_pk_mul_f32 v[28:29], v[28:29], v[30:31] op_sel:[0,1] op_sel_hi:[1,1]
    v_exp_f32 v14, -v14
    v_exp_f32 v15, -v15
    v_exp_f32 v16, -v16
    v_exp_f32 v17, -v17
    v_exp_f32 v18, -v18
    v_exp_f32 v19, -v19
    v_exp_f32 v20, -v20
    v_exp_f32 v21, -v21
    v_exp_f32 v22, -v22
    v_exp_f32 v23, -v23
    v_exp_f32 v24, -v24
    v_exp_f32 v25, -v25
    v_exp_f32 v26, -v26
    v_exp_f32 v27, -v27
    v_exp_f32 v28, -v28
    v_exp_f32 v29, -v29
    v_cvt_pk_bf16_f32 v14, v14, v16
    v_cvt_pk_bf16_f32 v15, v15, v17
    v_cvt_pk_bf16_f32 v18, v18, v20
    v_cvt_pk_bf16_f32 v19, v19, v21
    v_cvt_pk_bf16_f32 v22, v22, v24
    v_cvt_pk_bf16_f32 v23, v23, v25
    v_cvt_pk_bf16_f32 v26, v26, v28
    v_cvt_pk_bf16_f32 v27, v27, v29
    v_dot2_f32_bf16 v72, v14, s68, 0
    v_dot2_f32_bf16 v73, v15, s68, 0
    v_dot2_f32_bf16 v74, v14, s69, 0
    v_dot2_f32_bf16 v75, v15, s69, 0
    v_dot2_f32_bf16 v76, v14, s70, 0
    v_dot2_f32_bf16 v77, v15, s70, 0
    v_dot2_f32_bf16 v78, v14, s71, 0
    v_dot2_f32_bf16 v79, v15, s71, 0
    v_dot2_f32_bf16 v80, v14, s52, 0
    v_dot2_f32_bf16 v81, v15, s52, 0
    v_dot2_f32_bf16 v82, v14, s53, 0
    v_dot2_f32_bf16 v83, v15, s53, 0
    v_dot2_f32_bf16 v84, v14, s54, 0
    v_dot2_f32_bf16 v85, v15, s54, 0
    v_dot2_f32_bf16 v86, v14, s55, 0
    v_dot2_f32_bf16 v87, v15, s55, 0
    v_dot2_f32_bf16 v72, v18, s72, v72
    v_dot2_f32_bf16 v73, v19, s72, v73
    v_dot2_f32_bf16 v74, v18, s73, v74
    v_dot2_f32_bf16 v75, v19, s73, v75
    v_dot2_f32_bf16 v76, v18, s74, v76
    v_dot2_f32_bf16 v77, v19, s74, v77
    v_dot2_f32_bf16 v78, v18, s75, v78
    v_dot2_f32_bf16 v79, v19, s75, v79
    v_dot2_f32_bf16 v80, v18, s56, v80
    v_dot2_f32_bf16 v81, v19, s56, v81
    v_dot2_f32_bf16 v82, v18, s57, v82
    v_dot2_f32_bf16 v83, v19, s57, v83
    v_dot2_f32_bf16 v84, v18, s58, v84
    v_dot2_f32_bf16 v85, v19, s58, v85
    v_dot2_f32_bf16 v86, v18, s59, v86
    v_dot2_f32_bf16 v87, v19, s59, v87
    v_dot2_f32_bf16 v72, v22, s76, v72
    v_dot2_f32_bf16 v73, v23, s76, v73
    v_dot2_f32_bf16 v74, v22, s77, v74
    v_dot2_f32_bf16 v75, v23, s77, v75
    v_dot2_f32_bf16 v76, v22, s78, v76
    v_dot2_f32_bf16 v77, v23, s78, v77
    v_dot2_f32_bf16 v78, v22, s79, v78
    v_dot2_f32_bf16 v79, v23, s79, v79
    v_dot2_f32_bf16 v80, v22, s60, v80
    v_dot2_f32_bf16 v81, v23, s60, v81
    v_dot2_f32_bf16 v82, v22, s61, v82
    v_dot2_f32_bf16 v83, v23, s61, v83
    v_dot2_f32_bf16 v84, v22, s62, v84
    v_dot2_f32_bf16 v85, v23, s62, v85
    v_dot2_f32_bf16 v86, v22, s63, v86
    v_dot2_f32_bf16 v87, v23, s63, v87
    v_dot2_f32_bf16 v72, v26, s80, v72
    v_dot2_f32_bf16 v73, v27, s80, v73
    v_dot2_f32_bf16 v74, v26, s81, v74
    v_dot2_f32_bf16 v75, v27, s81, v75
    v_dot2_f32_bf16 v76, v26, s82, v76
    v_dot2_f32_bf16 v77, v27, s82, v77
    v_dot2_f32_bf16 v78, v26, s83, v78
    v_dot2_f32_bf16 v79, v27, s83, v79
    v_dot2_f32_bf16 v80, v26, s64, v80
    v_dot2_f32_bf16 v81, v27, s64, v81
    v_dot2_f32_bf16 v82, v26, s65, v82
    v_dot2_f32_bf16 v83, v27, s65, v83
    v_dot2_f32_bf16 v84, v26, s66, v84
    v_dot2_f32_bf16 v85, v27, s66, v85
    v_dot2_f32_bf16 v86, v26, s67, v86
    v_dot2_f32_bf16 v87, v27, s67, v87
L_p2_gc:
    s_cmp_ge_u32 s13, 4
    s_cbranch_scc1 L_p2_gd
    v_lshlrev_b32 v30, 16, v61
    v_and_b32 v31, 0xffff0000, v61
    v_pk_add_f32 v[14:15], v[30:31], v[36:37] op_sel:[0,0] op_sel_hi:[1,0] neg_lo:[0,1] neg_hi:[0,1]
    v_pk_add_f32 v[16:17], v[30:31], v[36:37] op_sel:[0,1] op_sel_hi:[1,1] neg_lo:[0,1] neg_hi:[0,1]
    v_pk_add_f32 v[18:19], v[30:31], v[38:39] op_sel:[0,0] op_sel_hi:[1,0] neg_lo:[0,1] neg_hi:[0,1]
    v_pk_add_f32 v[20:21], v[30:31], v[38:39] op_sel:[0,1] op_sel_hi:[1,1] neg_lo:[0,1] neg_hi:[0,1]
    v_pk_add_f32 v[22:23], v[30:31], v[40:41] op_sel:[0,0] op_sel_hi:[1,0] neg_lo:[0,1] neg_hi:[0,1]
    v_pk_add_f32 v[24:25], v[30:31], v[40:41] op_sel:[0,1] op_sel_hi:[1,1] neg_lo:[0,1] neg_hi:[0,1]
    v_pk_add_f32 v[26:27], v[30:31], v[42:43] op_sel:[0,0] op_sel_hi:[1,0] neg_lo:[0,1] neg_hi:[0,1]
    v_pk_add_f32 v[28:29], v[30:31], v[42:43] op_sel:[0,1] op_sel_hi:[1,1] neg_lo:[0,1] neg_hi:[0,1]
    v_cvt_pk_bf16_f32 v32, v14, v15
    v_lshlrev_b32 v14, 16, v32
    v_and_b32 v15, 0xffff0000, v32
    v_cvt_pk_bf16_f32 v32, v16, v17
    v_lshlrev_b32 v16, 16, v32
    v_and_b32 v17, 0xffff0000, v32
    v_cvt_pk_bf16_f32 v32, v18, v19
    v_lshlrev_b32 v18, 16, v32
    v_and_b32 v19, 0xffff0000, v32
    v_cvt_pk_bf16_f32 v32, v20, v21
    v_lshlrev_b32 v20, 16, v32
    v_and_b32 v21, 0xffff0000, v32
    v_cvt_pk_bf16_f32 v32, v22, v23
    v_lshlrev_b32 v22, 16, v32
    v_and_b32 v23, 0xffff0000, v32
    v_cvt_pk_bf16_f32 v32, v24, v25
    v_lshlrev_b32 v24, 16, v32
    v_and_b32 v25, 0xffff0000, v32
    v_cvt_pk_bf16_f32 v32, v26, v27
    v_lshlrev_b32 v26, 16, v32
    v_and_b32 v27, 0xffff0000, v32
    v_cvt_pk_bf16_f32 v32, v28, v29
    v_lshlrev_b32 v28, 16, v32
    v_and_b32 v29, 0xffff0000, v32
    v_pk_mul_f32 v[14:15], v[14:15], v[14:15]
    v_pk_mul_f32 v[16:17], v[16:17], v[16:17]
    v_pk_mul_f32 v[18:19], v[18:19], v[18:19]
    v_pk_mul_f32 v[20:21], v[20:21], v[20:21]
    v_pk_mul_f32 v[22:23], v[22:23], v[22:23]
    v_pk_mul_f32 v[24:25], v[24:25], v[24:25]
    v_pk_mul_f32 v[26:27], v[26:27], v[26:27]
    v_pk_mul_f32 v[28:29], v[28:29], v[28:29]
    v_cvt_pk_bf16_f32 v32, v14, v15
    v_lshlrev_b32 v14, 16, v32
    v_and_b32 v15, 0xffff0000, v32
    v_cvt_pk_bf16_f32 v32, v16, v17
    v_lshlrev_b32 v16, 16, v32
    v_and_b32 v17, 0xffff0000, v32
    v_cvt_pk_bf16_f32 v32, v18, v19
    v_lshlrev_b32 v18, 16, v32
    v_and_b32 v19, 0xffff0000, v32
    v_cvt_pk_bf16_f32 v32, v20, v21
    v_lshlrev_b32 v20, 16, v32
    v_and_b32 v21, 0xffff0000, v32
    v_cvt_pk_bf16_f32 v32, v22, v23
    v_lshlrev_b32 v22, 16, v32
    v_and_b32 v23, 0xffff0000, v32
    v_cvt_pk_bf16_f32 v32, v24, v25
    v_lshlrev_b32 v24, 16, v32
    v_and_b32 v25, 0xffff0000, v32
    v_cvt_pk_bf16_f32 v32, v26, v27
    v_lshlrev_b32 v26, 16, v32
    v_and_b32 v27, 0xffff0000, v32
    v_cvt_pk_bf16_f32 v32, v28, v29
    v_lshlrev_b32 v28, 16, v32
    v_and_b32 v29, 0xffff0000, v32
    v_mov_b32 v30, 1092616192
    v_mov_b32 v31, 0x3fb8aa3b
    v_pk_mul_f32 v[14:15], v[14:15], v[30:31] op_sel:[0,0] op_sel_hi:[1,0]
    v_pk_mul_f32 v[16:17], v[16:17], v[30:31] op_sel:[0,0] op_sel_hi:[1,0]
    v_pk_mul_f32 v[18:19], v[18:19], v[30:31] op_sel:[0,0] op_sel_hi:[1,0]
    v_pk_mul_f32 v[20:21], v[20:21], v[30:31] op_sel:[0,0] op_sel_hi:[1,0]
    v_pk_mul_f32 v[22:23], v[22:23], v[30:31] op_sel:[0,0] op_sel_hi:[1,0]
    v_pk_mul_f32 v[24:25], v[24:25], v[30:31] op_sel:[0,0] op_sel_hi:[1,0]
    v_pk_mul_f32 v[26:27], v[26:27], v[30:31] op_sel:[0,0] op_sel_hi:[1,0]
    v_pk_mul_f32 v[28:29], v[28:29], v[30:31] op_sel:[0,0] op_sel_hi:[1,0]
    v_cvt_pk_bf16_f32 v32, v14, v15
    v_lshlrev_b32 v14, 16, v32
    v_and_b32 v15, 0xffff0000, v32
    v_cvt_pk_bf16_f32 v32, v16, v17
    v_lshlrev_b32 v16, 16, v32
    v_and_b32 v17, 0xffff0000, v32
    v_cvt_pk_bf16_f32 v32, v18, v19
    v_lshlrev_b32 v18, 16, v32
    v_and_b32 v19, 0xffff0000, v32
    v_cvt_pk_bf16_f32 v32, v20, v21
    v_lshlrev_b32 v20, 16, v32
    v_and_b32 v21, 0xffff0000, v32
    v_cvt_pk_bf16_f32 v32, v22, v23
    v_lshlrev_b32 v22, 16, v32
    v_and_b32 v23, 0xffff0000, v32
    v_cvt_pk_bf16_f32 v32, v24, v25
    v_lshlrev_b32 v24, 16, v32
    v_and_b32 v25, 0xffff0000, v32
    v_cvt_pk_bf16_f32 v32, v26, v27
    v_lshlrev_b32 v26, 16, v32
    v_and_b32 v27, 0xffff0000, v32
    v_cvt_pk_bf16_f32 v32, v28, v29
    v_lshlrev_b32 v28, 16, v32
    v_and_b32 v29, 0xffff0000, v32
    v_pk_mul_f32 v[14:15], v[14:15], v[30:31] op_sel:[0,1] op_sel_hi:[1,1]
    v_pk_mul_f32 v[16:17], v[16:17], v[30:31] op_sel:[0,1] op_sel_hi:[1,1]
    v_pk_mul_f32 v[18:19], v[18:19], v[30:31] op_sel:[0,1] op_sel_hi:[1,1]
    v_pk_mul_f32 v[20:21], v[20:21], v[30:31] op_sel:[0,1] op_sel_hi:[1,1]
    v_pk_mul_f32 v[22:23], v[22:23], v[30:31] op_sel:[0,1] op_sel_hi:[1,1]
    v_pk_mul_f32 v[24:25], v[24:25], v[30:31] op_sel:[0,1] op_sel_hi:[1,1]
    v_pk_mul_f32 v[26:27], v[26:27], v[30:31] op_sel:[0,1] op_sel_hi:[1,1]
    v_pk_mul_f32 v[28:29], v[28:29], v[30:31] op_sel:[0,1] op_sel_hi:[1,1]
    v_exp_f32 v14, -v14
    v_exp_f32 v15, -v15
    v_exp_f32 v16, -v16
    v_exp_f32 v17, -v17
    v_exp_f32 v18, -v18
    v_exp_f32 v19, -v19
    v_exp_f32 v20, -v20
    v_exp_f32 v21, -v21
    v_exp_f32 v22, -v22
    v_exp_f32 v23, -v23
    v_exp_f32 v24, -v24
    v_exp_f32 v25, -v25
    v_exp_f32 v26, -v26
    v_exp_f32 v27, -v27
    v_exp_f32 v28, -v28
    v_exp_f32 v29, -v29
    v_cvt_pk_bf16_f32 v14, v14, v16
    v_cvt_pk_bf16_f32 v15, v15, v17
    v_cvt_pk_bf16_f32 v18, v18, v20
    v_cvt_pk_bf16_f32 v19, v19, v21
    v_cvt_pk_bf16_f32 v22, v22, v24
    v_cvt_pk_bf16_f32 v23, v23, v25
    v_cvt_pk_bf16_f32 v26, v26, v28
    v_cvt_pk_bf16_f32 v27, v27, v29
    v_dot2_f32_bf16 v112, v14, s68, 0
    v_dot2_f32_bf16 v113, v15, s68, 0
    v_dot2_f32_bf16 v114, v14, s69, 0
    v_dot2_f32_bf16 v115, v15, s69, 0
    v_dot2_f32_bf16 v116, v14, s70, 0
    v_dot2_f32_bf16 v117, v15, s70, 0
    v_dot2_f32_bf16 v118, v14, s71, 0
    v_dot2_f32_bf16 v119, v15, s71, 0
    v_dot2_f32_bf16 v120, v14, s52, 0
    v_dot2_f32_bf16 v121, v15, s52, 0
    v_dot2_f32_bf16 v122, v14, s53, 0
    v_dot2_f32_bf16 v123, v15, s53, 0
    v_dot2_f32_bf16 v124, v14, s54, 0
    v_dot2_f32_bf16 v125, v15, s54, 0
    v_dot2_f32_bf16 v126, v14, s55, 0
    v_dot2_f32_bf16 v127, v15, s55, 0
    v_dot2_f32_bf16 v112, v18, s72, v112
    v_dot2_f32_bf16 v113, v19, s72, v113
    v_dot2_f32_bf16 v114, v18, s73, v114
    v_dot2_f32_bf16 v115, v19, s73, v115
    v_dot2_f32_bf16 v116, v18, s74, v116
    v_dot2_f32_bf16 v117, v19, s74, v117
    v_dot2_f32_bf16 v118, v18, s75, v118
    v_dot2_f32_bf16 v119, v19, s75, v119
    v_dot2_f32_bf16 v120, v18, s56, v120
    v_dot2_f32_bf16 v121, v19, s56, v121
    v_dot2_f32_bf16 v122, v18, s57, v122
    v_dot2_f32_bf16 v123, v19, s57, v123
    v_dot2_f32_bf16 v124, v18, s58, v124
    v_dot2_f32_bf16 v125, v19, s58, v125
    v_dot2_f32_bf16 v126, v18, s59, v126
    v_dot2_f32_bf16 v127, v19, s59, v127
    v_dot2_f32_bf16 v112, v22, s76, v112
    v_dot2_f32_bf16 v113, v23, s76, v113
    v_dot2_f32_bf16 v114, v22, s77, v114
    v_dot2_f32_bf16 v115, v23, s77, v115
    v_dot2_f32_bf16 v116, v22, s78, v116
    v_dot2_f32_bf16 v117, v23, s78, v117
    v_dot2_f32_bf16 v118, v22, s79, v118
    v_dot2_f32_bf16 v119, v23, s79, v119
    v_dot2_f32_bf16 v120, v22, s60, v120
    v_dot2_f32_bf16 v121, v23, s60, v121
    v_dot2_f32_bf16 v122, v22, s61, v122
    v_dot2_f32_bf16 v123, v23, s61, v123
    v_dot2_f32_bf16 v124, v22, s62, v124
    v_dot2_f32_bf16 v125, v23, s62, v125
    v_dot2_f32_bf16 v126, v22, s63, v126
    v_dot2_f32_bf16 v127, v23, s63, v127
    v_dot2_f32_bf16 v112, v26, s80, v112
    v_dot2_f32_bf16 v113, v27, s80, v113
    v_dot2_f32_bf16 v114, v26, s81, v114
    v_dot2_f32_bf16 v115, v27, s81, v115
    v_dot2_f32_bf16 v116, v26, s82, v116
    v_dot2_f32_bf16 v117, v27, s82, v117
    v_dot2_f32_bf16 v118, v26, s83, v118
    v_dot2_f32_bf16 v119, v27, s83, v119
    v_dot2_f32_bf16 v120, v26, s64, v120
    v_dot2_f32_bf16 v121, v27, s64, v121
    v_dot2_f32_bf16 v122, v26, s65, v122
    v_dot2_f32_bf16 v123, v27, s65, v123
    v_dot2_f32_bf16 v124, v26, s66, v124
    v_dot2_f32_bf16 v125, v27, s66, v125
    v_dot2_f32_bf16 v126, v26, s67, v126
    v_dot2_f32_bf16 v127, v27, s67, v127
L_p2_gd:
    s_cmp_lg_u32 s13, 15
    s_cbranch_scc1 L_p2_nosig
    s_waitcnt vmcnt(0)
    v_readfirstlane_b32 s15, v9
    s_lshl_b32 s51, 1, s12
    s_add_u32 s20, s20, s15
    s_and_b32 s15, s20, 0xff
    s_cmp_eq_u32 s15, 4
    s_cbranch_scc0 L_p2_notlast
    s_bfe_u32 s15, s20, 262160
    s_or_b32 s51, s51, s15
    s_branch L_p2_pub
L_p2_notlast:
    s_cmp_lg_u32 s21, 0
    s_cselect_b32 s51, 0, s51
    s_cbranch_scc1 L_p2_pub
L_p2_poll:
    v_mov_b32 v9, 0
    s_lshl_b32 s14, s3, 8
    s_add_u32 s14, s14, 8523776
    s_mov_b64 exec, 1
    buffer_atomic_add v9, off, s[4:7], s14 sc0
    s_mov_b64 exec, -1
    s_waitcnt vmcnt(0)
    v_readfirstlane_b32 s20, v9
    s_nop 0
    s_and_b32 s15, s20, 0xff
    s_cmp_lt_u32 s15, 4
    s_cbranch_scc1 L_p2_poll
L_p2_pub:
    s_lshl_b32 s15, s51, 24
    s_or_b32 s15, s15, s20
    v_mov_b32 v9, s15
    s_mov_b64 exec, 1
    ds_write_b32 v8, v9
    s_mov_b64 exec, -1
    s_waitcnt lgkmcnt(0)
L_p2_nosig:
    s_barrier
    ds_read_b32 v9, v8
    s_waitcnt lgkmcnt(0)
    v_readfirstlane_b32 s20, v9
    s_nop 0
    s_lshr_b32 s51, s20, 24
    s_cbranch_scc0 L_p2_end
L_p2_fin:
    s_mul_i32 s24, s49, 20000
    s_add_u32 s14, s12, 1
    s_and_b32 s14, s14, 3
    s_mul_i32 s15, s14, 5120000
    s_add_u32 s15, s15, 228589568
    s_add_u32 s15, s15, s26
    buffer_load_dwordx4 v[12:15], v1, s[4:7], s15 offen sc1
    buffer_load_dwordx4 v[92:95], v2, s[4:7], s15 offen sc1
    s_add_u32 s14, s12, 2
    s_and_b32 s14, s14, 3
    s_mul_i32 s15, s14, 5120000
    s_add_u32 s15, s15, 228589568
    s_add_u32 s15, s15, s26
    buffer_load_dwordx4 v[16:19], v1, s[4:7], s15 offen sc1
    buffer_load_dwordx4 v[96:99], v2, s[4:7], s15 offen sc1
    s_add_u32 s14, s12, 3
    s_and_b32 s14, s14, 3
    s_mul_i32 s15, s14, 5120000
    s_add_u32 s15, s15, 228589568
    s_add_u32 s15, s15, s26
    buffer_load_dwordx4 v[20:23], v1, s[4:7], s15 offen sc1
    buffer_load_dwordx4 v[100:103], v2, s[4:7], s15 offen sc1
    v_add_u32 v24, s24, v1
    ds_read_b128 v[8:11], v24
    v_add_u32 v25, s24, v2
    ds_read_b128 v[88:91], v25
    s_waitcnt vmcnt(0) lgkmcnt(0)
    s_bfe_u32 s14, s20, 262164
    s_cbranch_scc0 L_p2_kernel_nof32a_10
    s_add_u32 s14, s12, 0
    s_and_b32 s14, s14, 3
    s_add_u32 s14, s14, 20
    s_bitcmp1_b32 s20, s14
    s_cbranch_scc0 L_p2_kernel_q_11
    v_mov_b32 v8, 1073758208
    v_mov_b32 v9, 1073758208
    v_mov_b32 v10, 1073758208
    v_mov_b32 v11, 1073758208
L_p2_kernel_q_11:
    s_add_u32 s14, s12, 1
    s_and_b32 s14, s14, 3
    s_add_u32 s14, s14, 20
    s_bitcmp1_b32 s20, s14
    s_cbranch_scc0 L_p2_kernel_q_12
    v_mov_b32 v12, 1073758208
    v_mov_b32 v13, 1073758208
    v_mov_b32 v14, 1073758208
    v_mov_b32 v15, 1073758208
L_p2_kernel_q_12:
    s_add_u32 s14, s12, 2
    s_and_b32 s14, s14, 3
    s_add_u32 s14, s14, 20
    s_bitcmp1_b32 s20, s14
    s_cbranch_scc0 L_p2_kernel_q_13
    v_mov_b32 v16, 1073758208
    v_mov_b32 v17, 1073758208
    v_mov_b32 v18, 1073758208
    v_mov_b32 v19, 1073758208
L_p2_kernel_q_13:
    s_add_u32 s14, s12, 3
    s_and_b32 s14, s14, 3
    s_add_u32 s14, s14, 20
    s_bitcmp1_b32 s20, s14
    s_cbranch_scc0 L_p2_kernel_q_14
    v_mov_b32 v20, 1073758208
    v_mov_b32 v21, 1073758208
    v_mov_b32 v22, 1073758208
    v_mov_b32 v23, 1073758208
L_p2_kernel_q_14:
L_p2_kernel_nof32a_10:
    v_pk_add_u16 v8, v8, v12
    v_pk_add_u16 v16, v16, v20
    v_pk_add_u16 v9, v9, v13
    v_pk_add_u16 v17, v17, v21
    v_pk_add_u16 v10, v10, v14
    v_pk_add_u16 v18, v18, v22
    v_pk_add_u16 v11, v11, v15
    v_pk_add_u16 v19, v19, v23
    v_add_u32_sdwa v24, v8, v16 dst_sel:DWORD dst_unused:UNUSED_PAD src0_sel:WORD_0 src1_sel:WORD_0
    v_add_u32_sdwa v25, v10, v18 dst_sel:DWORD dst_unused:UNUSED_PAD src0_sel:WORD_0 src1_sel:WORD_0
    v_add_u32_sdwa v26, v8, v16 dst_sel:DWORD dst_unused:UNUSED_PAD src0_sel:WORD_1 src1_sel:WORD_1
    v_add_u32_sdwa v27, v10, v18 dst_sel:DWORD dst_unused:UNUSED_PAD src0_sel:WORD_1 src1_sel:WORD_1
    v_add_u32_sdwa v28, v9, v17 dst_sel:DWORD dst_unused:UNUSED_PAD src0_sel:WORD_0 src1_sel:WORD_0
    v_add_u32_sdwa v29, v11, v19 dst_sel:DWORD dst_unused:UNUSED_PAD src0_sel:WORD_0 src1_sel:WORD_0
    v_add_u32_sdwa v30, v9, v17 dst_sel:DWORD dst_unused:UNUSED_PAD src0_sel:WORD_1 src1_sel:WORD_1
    v_add_u32_sdwa v31, v11, v19 dst_sel:DWORD dst_unused:UNUSED_PAD src0_sel:WORD_1 src1_sel:WORD_1
    v_cvt_f32_u32 v24, v24
    v_cvt_f32_u32 v25, v25
    v_cvt_f32_u32 v26, v26
    v_cvt_f32_u32 v27, v27
    v_cvt_f32_u32 v28, v28
    v_cvt_f32_u32 v29, v29
    v_cvt_f32_u32 v30, v30
    v_cvt_f32_u32 v31, v31
    v_pk_fma_f32 v[24:25], v[24:25], s[44:45], s[44:45] op_sel:[0,0,1] op_sel_hi:[1,0,1]
    v_pk_fma_f32 v[26:27], v[26:27], s[44:45], s[44:45] op_sel:[0,0,1] op_sel_hi:[1,0,1]
    v_pk_fma_f32 v[28:29], v[28:29], s[44:45], s[44:45] op_sel:[0,0,1] op_sel_hi:[1,0,1]
    v_pk_fma_f32 v[30:31], v[30:31], s[44:45], s[44:45] op_sel:[0,0,1] op_sel_hi:[1,0,1]
    s_bfe_u32 s14, s20, 262164
    s_cbranch_scc0 L_p2_kernel_nof32b_15
    v_lshlrev_b32 v32, 1, v1
    s_bitcmp1_b32 s20, 20
    s_cbranch_scc0 L_p2_kernel_q_16
    s_lshl_b32 s15, s26, 1
    s_add_u32 s15, s15, 249069568
    buffer_load_dwordx4 v[8:11], v32, s[4:7], s15 offen sc1
    buffer_load_dwordx4 v[12:15], v32, s[4:7], s15 offen offset:16 sc1
    s_waitcnt vmcnt(0)
    v_add_f32 v24, v24, v8
    v_add_f32 v25, v25, v12
    v_add_f32 v26, v26, v9
    v_add_f32 v27, v27, v13
    v_add_f32 v28, v28, v10
    v_add_f32 v29, v29, v14
    v_add_f32 v30, v30, v11
    v_add_f32 v31, v31, v15
L_p2_kernel_q_16:
    s_bitcmp1_b32 s20, 21
    s_cbranch_scc0 L_p2_kernel_q_17
    s_lshl_b32 s15, s26, 1
    s_add_u32 s15, s15, 259309568
    buffer_load_dwordx4 v[8:11], v32, s[4:7], s15 offen sc1
    buffer_load_dwordx4 v[12:15], v32, s[4:7], s15 offen offset:16 sc1
    s_waitcnt vmcnt(0)
    v_add_f32 v24, v24, v8
    v_add_f32 v25, v25, v12
    v_add_f32 v26, v26, v9
    v_add_f32 v27, v27, v13
    v_add_f32 v28, v28, v10
    v_add_f32 v29, v29, v14
    v_add_f32 v30, v30, v11
    v_add_f32 v31, v31, v15
L_p2_kernel_q_17:
    s_bitcmp1_b32 s20, 22
    s_cbranch_scc0 L_p2_kernel_q_18
    s_lshl_b32 s15, s26, 1
    s_add_u32 s15, s15, 269549568
    buffer_load_dwordx4 v[8:11], v32, s[4:7], s15 offen sc1
    buffer_load_dwordx4 v[12:15], v32, s[4:7], s15 offen offset:16 sc1
    s_waitcnt vmcnt(0)
    v_add_f32 v24, v24, v8
    v_add_f32 v25, v25, v12
    v_add_f32 v26, v26, v9
    v_add_f32 v27, v27, v13
    v_add_f32 v28, v28, v10
    v_add_f32 v29, v29, v14
    v_add_f32 v30, v30, v11
    v_add_f32 v31, v31, v15
L_p2_kernel_q_18:
    s_bitcmp1_b32 s20, 23
    s_cbranch_scc0 L_p2_kernel_q_19
    s_lshl_b32 s15, s26, 1
    s_add_u32 s15, s15, 279789568
    buffer_load_dwordx4 v[8:11], v32, s[4:7], s15 offen sc1
    buffer_load_dwordx4 v[12:15], v32, s[4:7], s15 offen offset:16 sc1
    s_waitcnt vmcnt(0)
    v_add_f32 v24, v24, v8
    v_add_f32 v25, v25, v12
    v_add_f32 v26, v26, v9
    v_add_f32 v27, v27, v13
    v_add_f32 v28, v28, v10
    v_add_f32 v29, v29, v14
    v_add_f32 v30, v30, v11
    v_add_f32 v31, v31, v15
L_p2_kernel_q_19:
L_p2_kernel_nof32b_15:
    v_pk_mul_f32 v[8:9], v[24:25], s[84:85] op_sel:[0,0] op_sel_hi:[1,0]
    v_pk_mul_f32 v[10:11], v[24:25], s[84:85] op_sel:[0,1] op_sel_hi:[1,1]
    v_pk_mul_f32 v[12:13], v[24:25], s[86:87] op_sel:[0,0] op_sel_hi:[1,0]
    v_pk_mul_f32 v[14:15], v[24:25], s[86:87] op_sel:[0,1] op_sel_hi:[1,1]
    v_pk_fma_f32 v[8:9], v[26:27], s[88:89], v[8:9] op_sel:[0,0,0] op_sel_hi:[1,0,1]
    v_pk_fma_f32 v[10:11], v[26:27], s[88:89], v[10:11] op_sel:[0,1,0] op_sel_hi:[1,1,1]
    v_pk_fma_f32 v[12:13], v[26:27], s[90:91], v[12:13] op_sel:[0,0,0] op_sel_hi:[1,0,1]
    v_pk_fma_f32 v[14:15], v[26:27], s[90:91], v[14:15] op_sel:[0,1,0] op_sel_hi:[1,1,1]
    v_pk_fma_f32 v[8:9], v[28:29], s[92:93], v[8:9] op_sel:[0,0,0] op_sel_hi:[1,0,1]
    v_pk_fma_f32 v[10:11], v[28:29], s[92:93], v[10:11] op_sel:[0,1,0] op_sel_hi:[1,1,1]
    v_pk_fma_f32 v[12:13], v[28:29], s[94:95], v[12:13] op_sel:[0,0,0] op_sel_hi:[1,0,1]
    v_pk_fma_f32 v[14:15], v[28:29], s[94:95], v[14:15] op_sel:[0,1,0] op_sel_hi:[1,1,1]
    v_pk_fma_f32 v[8:9], v[30:31], s[96:97], v[8:9] op_sel:[0,0,0] op_sel_hi:[1,0,1]
    v_pk_fma_f32 v[10:11], v[30:31], s[96:97], v[10:11] op_sel:[0,1,0] op_sel_hi:[1,1,1]
    v_pk_fma_f32 v[12:13], v[30:31], s[98:99], v[12:13] op_sel:[0,0,0] op_sel_hi:[1,0,1]
    v_pk_fma_f32 v[14:15], v[30:31], s[98:99], v[14:15] op_sel:[0,1,0] op_sel_hi:[1,1,1]
    v_pk_mul_f32 v[8:9], v[8:9], v[72:73]
    v_pk_mul_f32 v[10:11], v[10:11], v[74:75]
    v_pk_mul_f32 v[12:13], v[12:13], v[76:77]
    v_pk_mul_f32 v[14:15], v[14:15], v[78:79]
    v_pk_mul_f32 v[24:25], v[8:9], s[28:29] op_sel:[0,0] op_sel_hi:[1,0]
    v_pk_mul_f32 v[26:27], v[8:9], s[28:29] op_sel:[0,1] op_sel_hi:[1,1]
    v_pk_mul_f32 v[28:29], v[8:9], s[30:31] op_sel:[0,0] op_sel_hi:[1,0]
    v_pk_mul_f32 v[30:31], v[8:9], s[30:31] op_sel:[0,1] op_sel_hi:[1,1]
    v_pk_fma_f32 v[24:25], v[10:11], s[32:33], v[24:25] op_sel:[0,0,0] op_sel_hi:[1,0,1]
    v_pk_fma_f32 v[26:27], v[10:11], s[32:33], v[26:27] op_sel:[0,1,0] op_sel_hi:[1,1,1]
    v_pk_fma_f32 v[28:29], v[10:11], s[34:35], v[28:29] op_sel:[0,0,0] op_sel_hi:[1,0,1]
    v_pk_fma_f32 v[30:31], v[10:11], s[34:35], v[30:31] op_sel:[0,1,0] op_sel_hi:[1,1,1]
    v_pk_fma_f32 v[24:25], v[12:13], s[36:37], v[24:25] op_sel:[0,0,0] op_sel_hi:[1,0,1]
    v_pk_fma_f32 v[26:27], v[12:13], s[36:37], v[26:27] op_sel:[0,1,0] op_sel_hi:[1,1,1]
    v_pk_fma_f32 v[28:29], v[12:13], s[38:39], v[28:29] op_sel:[0,0,0] op_sel_hi:[1,0,1]
    v_pk_fma_f32 v[30:31], v[12:13], s[38:39], v[30:31] op_sel:[0,1,0] op_sel_hi:[1,1,1]
    v_pk_fma_f32 v[24:25], v[14:15], s[40:41], v[24:25] op_sel:[0,0,0] op_sel_hi:[1,0,1]
    v_pk_fma_f32 v[26:27], v[14:15], s[40:41], v[26:27] op_sel:[0,1,0] op_sel_hi:[1,1,1]
    v_pk_fma_f32 v[28:29], v[14:15], s[42:43], v[28:29] op_sel:[0,0,0] op_sel_hi:[1,0,1]
    v_pk_fma_f32 v[30:31], v[14:15], s[42:43], v[30:31] op_sel:[0,1,0] op_sel_hi:[1,1,1]
    v_lshlrev_b32 v8, 16, v64
    v_and_b32 v10, 0xffff0000, v64
    v_lshlrev_b32 v12, 16, v65
    v_and_b32 v14, 0xffff0000, v65
    v_lshlrev_b32 v9, 16, v66
    v_and_b32 v11, 0xffff0000, v66
    v_lshlrev_b32 v13, 16, v67
    v_and_b32 v15, 0xffff0000, v67
    v_pk_fma_f32 v[8:9], v[24:25], v[80:81], v[8:9]
    v_pk_fma_f32 v[10:11], v[26:27], v[82:83], v[10:11]
    v_pk_fma_f32 v[12:13], v[28:29], v[84:85], v[12:13]
    v_pk_fma_f32 v[14:15], v[30:31], v[86:87], v[14:15]
    v_cvt_pk_bf16_f32 v16, v8, v10
    v_cvt_pk_bf16_f32 v17, v12, v14
    v_cvt_pk_bf16_f32 v18, v9, v11
    v_cvt_pk_bf16_f32 v19, v13, v15
    buffer_store_dwordx4 v[16:19], v1, s[16:19], s26 offen
    s_cmp_ge_u32 s13, 4
    s_cbranch_scc1 L_p2_f1
    s_bfe_u32 s14, s20, 262164
    s_cbranch_scc0 L_p2_kernel_nof32a_20
    s_add_u32 s14, s12, 0
    s_and_b32 s14, s14, 3
    s_add_u32 s14, s14, 20
    s_bitcmp1_b32 s20, s14
    s_cbranch_scc0 L_p2_kernel_q_21
    v_mov_b32 v88, 1073758208
    v_mov_b32 v89, 1073758208
    v_mov_b32 v90, 1073758208
    v_mov_b32 v91, 1073758208
L_p2_kernel_q_21:
    s_add_u32 s14, s12, 1
    s_and_b32 s14, s14, 3
    s_add_u32 s14, s14, 20
    s_bitcmp1_b32 s20, s14
    s_cbranch_scc0 L_p2_kernel_q_22
    v_mov_b32 v92, 1073758208
    v_mov_b32 v93, 1073758208
    v_mov_b32 v94, 1073758208
    v_mov_b32 v95, 1073758208
L_p2_kernel_q_22:
    s_add_u32 s14, s12, 2
    s_and_b32 s14, s14, 3
    s_add_u32 s14, s14, 20
    s_bitcmp1_b32 s20, s14
    s_cbranch_scc0 L_p2_kernel_q_23
    v_mov_b32 v96, 1073758208
    v_mov_b32 v97, 1073758208
    v_mov_b32 v98, 1073758208
    v_mov_b32 v99, 1073758208
L_p2_kernel_q_23:
    s_add_u32 s14, s12, 3
    s_and_b32 s14, s14, 3
    s_add_u32 s14, s14, 20
    s_bitcmp1_b32 s20, s14
    s_cbranch_scc0 L_p2_kernel_q_24
    v_mov_b32 v100, 1073758208
    v_mov_b32 v101, 1073758208
    v_mov_b32 v102, 1073758208
    v_mov_b32 v103, 1073758208
L_p2_kernel_q_24:
L_p2_kernel_nof32a_20:
    v_pk_add_u16 v88, v88, v92
    v_pk_add_u16 v96, v96, v100
    v_pk_add_u16 v89, v89, v93
    v_pk_add_u16 v97, v97, v101
    v_pk_add_u16 v90, v90, v94
    v_pk_add_u16 v98, v98, v102
    v_pk_add_u16 v91, v91, v95
    v_pk_add_u16 v99, v99, v103
    v_add_u32_sdwa v24, v88, v96 dst_sel:DWORD dst_unused:UNUSED_PAD src0_sel:WORD_0 src1_sel:WORD_0
    v_add_u32_sdwa v25, v90, v98 dst_sel:DWORD dst_unused:UNUSED_PAD src0_sel:WORD_0 src1_sel:WORD_0
    v_add_u32_sdwa v26, v88, v96 dst_sel:DWORD dst_unused:UNUSED_PAD src0_sel:WORD_1 src1_sel:WORD_1
    v_add_u32_sdwa v27, v90, v98 dst_sel:DWORD dst_unused:UNUSED_PAD src0_sel:WORD_1 src1_sel:WORD_1
    v_add_u32_sdwa v28, v89, v97 dst_sel:DWORD dst_unused:UNUSED_PAD src0_sel:WORD_0 src1_sel:WORD_0
    v_add_u32_sdwa v29, v91, v99 dst_sel:DWORD dst_unused:UNUSED_PAD src0_sel:WORD_0 src1_sel:WORD_0
    v_add_u32_sdwa v30, v89, v97 dst_sel:DWORD dst_unused:UNUSED_PAD src0_sel:WORD_1 src1_sel:WORD_1
    v_add_u32_sdwa v31, v91, v99 dst_sel:DWORD dst_unused:UNUSED_PAD src0_sel:WORD_1 src1_sel:WORD_1
    v_cvt_f32_u32 v24, v24
    v_cvt_f32_u32 v25, v25
    v_cvt_f32_u32 v26, v26
    v_cvt_f32_u32 v27, v27
    v_cvt_f32_u32 v28, v28
    v_cvt_f32_u32 v29, v29
    v_cvt_f32_u32 v30, v30
    v_cvt_f32_u32 v31, v31
    v_pk_fma_f32 v[24:25], v[24:25], s[44:45], s[44:45] op_sel:[0,0,1] op_sel_hi:[1,0,1]
    v_pk_fma_f32 v[26:27], v[26:27], s[44:45], s[44:45] op_sel:[0,0,1] op_sel_hi:[1,0,1]
    v_pk_fma_f32 v[28:29], v[28:29], s[44:45], s[44:45] op_sel:[0,0,1] op_sel_hi:[1,0,1]
    v_pk_fma_f32 v[30:31], v[30:31], s[44:45], s[44:45] op_sel:[0,0,1] op_sel_hi:[1,0,1]
    s_bfe_u32 s14, s20, 262164
    s_cbranch_scc0 L_p2_kernel_nof32b_25
    v_lshlrev_b32 v32, 1, v2
    s_bitcmp1_b32 s20, 20
    s_cbranch_scc0 L_p2_kernel_q_26
    s_lshl_b32 s15, s26, 1
    s_add_u32 s15, s15, 249069568
    buffer_load_dwordx4 v[88:91], v32, s[4:7], s15 offen sc1
    buffer_load_dwordx4 v[92:95], v32, s[4:7], s15 offen offset:16 sc1
    s_waitcnt vmcnt(0)
    v_add_f32 v24, v24, v88
    v_add_f32 v25, v25, v92
    v_add_f32 v26, v26, v89
    v_add_f32 v27, v27, v93
    v_add_f32 v28, v28, v90
    v_add_f32 v29, v29, v94
    v_add_f32 v30, v30, v91
    v_add_f32 v31, v31, v95
L_p2_kernel_q_26:
    s_bitcmp1_b32 s20, 21
    s_cbranch_scc0 L_p2_kernel_q_27
    s_lshl_b32 s15, s26, 1
    s_add_u32 s15, s15, 259309568
    buffer_load_dwordx4 v[88:91], v32, s[4:7], s15 offen sc1
    buffer_load_dwordx4 v[92:95], v32, s[4:7], s15 offen offset:16 sc1
    s_waitcnt vmcnt(0)
    v_add_f32 v24, v24, v88
    v_add_f32 v25, v25, v92
    v_add_f32 v26, v26, v89
    v_add_f32 v27, v27, v93
    v_add_f32 v28, v28, v90
    v_add_f32 v29, v29, v94
    v_add_f32 v30, v30, v91
    v_add_f32 v31, v31, v95
L_p2_kernel_q_27:
    s_bitcmp1_b32 s20, 22
    s_cbranch_scc0 L_p2_kernel_q_28
    s_lshl_b32 s15, s26, 1
    s_add_u32 s15, s15, 269549568
    buffer_load_dwordx4 v[88:91], v32, s[4:7], s15 offen sc1
    buffer_load_dwordx4 v[92:95], v32, s[4:7], s15 offen offset:16 sc1
    s_waitcnt vmcnt(0)
    v_add_f32 v24, v24, v88
    v_add_f32 v25, v25, v92
    v_add_f32 v26, v26, v89
    v_add_f32 v27, v27, v93
    v_add_f32 v28, v28, v90
    v_add_f32 v29, v29, v94
    v_add_f32 v30, v30, v91
    v_add_f32 v31, v31, v95
L_p2_kernel_q_28:
    s_bitcmp1_b32 s20, 23
    s_cbranch_scc0 L_p2_kernel_q_29
    s_lshl_b32 s15, s26, 1
    s_add_u32 s15, s15, 279789568
    buffer_load_dwordx4 v[88:91], v32, s[4:7], s15 offen sc1
    buffer_load_dwordx4 v[92:95], v32, s[4:7], s15 offen offset:16 sc1
    s_waitcnt vmcnt(0)
    v_add_f32 v24, v24, v88
    v_add_f32 v25, v25, v92
    v_add_f32 v26, v26, v89
    v_add_f32 v27, v27, v93
    v_add_f32 v28, v28, v90
    v_add_f32 v29, v29, v94
    v_add_f32 v30, v30, v91
    v_add_f32 v31, v31, v95
L_p2_kernel_q_29:
L_p2_kernel_nof32b_25:
    v_pk_mul_f32 v[88:89], v[24:25], s[84:85] op_sel:[0,0] op_sel_hi:[1,0]
    v_pk_mul_f32 v[90:91], v[24:25], s[84:85] op_sel:[0,1] op_sel_hi:[1,1]
    v_pk_mul_f32 v[92:93], v[24:25], s[86:87] op_sel:[0,0] op_sel_hi:[1,0]
    v_pk_mul_f32 v[94:95], v[24:25], s[86:87] op_sel:[0,1] op_sel_hi:[1,1]
    v_pk_fma_f32 v[88:89], v[26:27], s[88:89], v[88:89] op_sel:[0,0,0] op_sel_hi:[1,0,1]
    v_pk_fma_f32 v[90:91], v[26:27], s[88:89], v[90:91] op_sel:[0,1,0] op_sel_hi:[1,1,1]
    v_pk_fma_f32 v[92:93], v[26:27], s[90:91], v[92:93] op_sel:[0,0,0] op_sel_hi:[1,0,1]
    v_pk_fma_f32 v[94:95], v[26:27], s[90:91], v[94:95] op_sel:[0,1,0] op_sel_hi:[1,1,1]
    v_pk_fma_f32 v[88:89], v[28:29], s[92:93], v[88:89] op_sel:[0,0,0] op_sel_hi:[1,0,1]
    v_pk_fma_f32 v[90:91], v[28:29], s[92:93], v[90:91] op_sel:[0,1,0] op_sel_hi:[1,1,1]
    v_pk_fma_f32 v[92:93], v[28:29], s[94:95], v[92:93] op_sel:[0,0,0] op_sel_hi:[1,0,1]
    v_pk_fma_f32 v[94:95], v[28:29], s[94:95], v[94:95] op_sel:[0,1,0] op_sel_hi:[1,1,1]
    v_pk_fma_f32 v[88:89], v[30:31], s[96:97], v[88:89] op_sel:[0,0,0] op_sel_hi:[1,0,1]
    v_pk_fma_f32 v[90:91], v[30:31], s[96:97], v[90:91] op_sel:[0,1,0] op_sel_hi:[1,1,1]
    v_pk_fma_f32 v[92:93], v[30:31], s[98:99], v[92:93] op_sel:[0,0,0] op_sel_hi:[1,0,1]
    v_pk_fma_f32 v[94:95], v[30:31], s[98:99], v[94:95] op_sel:[0,1,0] op_sel_hi:[1,1,1]
    v_pk_mul_f32 v[88:89], v[88:89], v[112:113]
    v_pk_mul_f32 v[90:91], v[90:91], v[114:115]
    v_pk_mul_f32 v[92:93], v[92:93], v[116:117]
    v_pk_mul_f32 v[94:95], v[94:95], v[118:119]
    v_pk_mul_f32 v[24:25], v[88:89], s[28:29] op_sel:[0,0] op_sel_hi:[1,0]
    v_pk_mul_f32 v[26:27], v[88:89], s[28:29] op_sel:[0,1] op_sel_hi:[1,1]
    v_pk_mul_f32 v[28:29], v[88:89], s[30:31] op_sel:[0,0] op_sel_hi:[1,0]
    v_pk_mul_f32 v[30:31], v[88:89], s[30:31] op_sel:[0,1] op_sel_hi:[1,1]
    v_pk_fma_f32 v[24:25], v[90:91], s[32:33], v[24:25] op_sel:[0,0,0] op_sel_hi:[1,0,1]
    v_pk_fma_f32 v[26:27], v[90:91], s[32:33], v[26:27] op_sel:[0,1,0] op_sel_hi:[1,1,1]
    v_pk_fma_f32 v[28:29], v[90:91], s[34:35], v[28:29] op_sel:[0,0,0] op_sel_hi:[1,0,1]
    v_pk_fma_f32 v[30:31], v[90:91], s[34:35], v[30:31] op_sel:[0,1,0] op_sel_hi:[1,1,1]
    v_pk_fma_f32 v[24:25], v[92:93], s[36:37], v[24:25] op_sel:[0,0,0] op_sel_hi:[1,0,1]
    v_pk_fma_f32 v[26:27], v[92:93], s[36:37], v[26:27] op_sel:[0,1,0] op_sel_hi:[1,1,1]
    v_pk_fma_f32 v[28:29], v[92:93], s[38:39], v[28:29] op_sel:[0,0,0] op_sel_hi:[1,0,1]
    v_pk_fma_f32 v[30:31], v[92:93], s[38:39], v[30:31] op_sel:[0,1,0] op_sel_hi:[1,1,1]
    v_pk_fma_f32 v[24:25], v[94:95], s[40:41], v[24:25] op_sel:[0,0,0] op_sel_hi:[1,0,1]
    v_pk_fma_f32 v[26:27], v[94:95], s[40:41], v[26:27] op_sel:[0,1,0] op_sel_hi:[1,1,1]
    v_pk_fma_f32 v[28:29], v[94:95], s[42:43], v[28:29] op_sel:[0,0,0] op_sel_hi:[1,0,1]
    v_pk_fma_f32 v[30:31], v[94:95], s[42:43], v[30:31] op_sel:[0,1,0] op_sel_hi:[1,1,1]
    v_lshlrev_b32 v88, 16, v68
    v_and_b32 v90, 0xffff0000, v68
    v_lshlrev_b32 v92, 16, v69
    v_and_b32 v94, 0xffff0000, v69
    v_lshlrev_b32 v89, 16, v70
    v_and_b32 v91, 0xffff0000, v70
    v_lshlrev_b32 v93, 16, v71
    v_and_b32 v95, 0xffff0000, v71
    v_pk_fma_f32 v[88:89], v[24:25], v[120:121], v[88:89]
    v_pk_fma_f32 v[90:91], v[26:27], v[122:123], v[90:91]
    v_pk_fma_f32 v[92:93], v[28:29], v[124:125], v[92:93]
    v_pk_fma_f32 v[94:95], v[30:31], v[126:127], v[94:95]
    v_cvt_pk_bf16_f32 v96, v88, v90
    v_cvt_pk_bf16_f32 v97, v92, v94
    v_cvt_pk_bf16_f32 v98, v89, v91
    v_cvt_pk_bf16_f32 v99, v93, v95
    buffer_store_dwordx4 v[96:99], v2, s[16:19], s26 offen
L_p2_f1:
    s_bitset0_b32 s51, s49
    s_cmp_eq_u32 s51, 0
    s_cbranch_scc1 L_p2_done
    s_ff1_i32_b32 s49, s51
    s_lshl2_add_u32 s14, s3, s49
    s_mul_i32 s14, s14, 5000
    s_add_u32 s15, s14, 4096
    v_min_u32 v61, 225, v0
    v_lshl_add_u32 v60, v0, 2, s14
    v_lshl_add_u32 v61, v61, 2, s15
    global_load_dword v60, v60, s[100:101] nt
    global_load_dword v61, v61, s[100:101] nt
    s_waitcnt vmcnt(0)
    v_lshlrev_b32 v30, 16, v60
    v_and_b32 v31, 0xffff0000, v60
    v_lshlrev_b32 v36, 16, v53
    v_and_b32 v37, 0xffff0000, v53
    v_lshlrev_b32 v38, 16, v54
    v_and_b32 v39, 0xffff0000, v54
    v_lshlrev_b32 v40, 16, v56
    v_and_b32 v41, 0xffff0000, v56
    v_lshlrev_b32 v42, 16, v57
    v_and_b32 v43, 0xffff0000, v57
    v_pk_add_f32 v[14:15], v[30:31], v[36:37] op_sel:[0,0] op_sel_hi:[1,0] neg_lo:[0,1] neg_hi:[0,1]
    v_pk_add_f32 v[16:17], v[30:31], v[36:37] op_sel:[0,1] op_sel_hi:[1,1] neg_lo:[0,1] neg_hi:[0,1]
    v_pk_add_f32 v[18:19], v[30:31], v[38:39] op_sel:[0,0] op_sel_hi:[1,0] neg_lo:[0,1] neg_hi:[0,1]
    v_pk_add_f32 v[20:21], v[30:31], v[38:39] op_sel:[0,1] op_sel_hi:[1,1] neg_lo:[0,1] neg_hi:[0,1]
    v_pk_add_f32 v[22:23], v[30:31], v[40:41] op_sel:[0,0] op_sel_hi:[1,0] neg_lo:[0,1] neg_hi:[0,1]
    v_pk_add_f32 v[24:25], v[30:31], v[40:41] op_sel:[0,1] op_sel_hi:[1,1] neg_lo:[0,1] neg_hi:[0,1]
    v_pk_add_f32 v[26:27], v[30:31], v[42:43] op_sel:[0,0] op_sel_hi:[1,0] neg_lo:[0,1] neg_hi:[0,1]
    v_pk_add_f32 v[28:29], v[30:31], v[42:43] op_sel:[0,1] op_sel_hi:[1,1] neg_lo:[0,1] neg_hi:[0,1]
    v_cvt_pk_bf16_f32 v32, v14, v15
    v_lshlrev_b32 v14, 16, v32
    v_and_b32 v15, 0xffff0000, v32
    v_cvt_pk_bf16_f32 v32, v16, v17
    v_lshlrev_b32 v16, 16, v32
    v_and_b32 v17, 0xffff0000, v32
    v_cvt_pk_bf16_f32 v32, v18, v19
    v_lshlrev_b32 v18, 16, v32
    v_and_b32 v19, 0xffff0000, v32
    v_cvt_pk_bf16_f32 v32, v20, v21
    v_lshlrev_b32 v20, 16, v32
    v_and_b32 v21, 0xffff0000, v32
    v_cvt_pk_bf16_f32 v32, v22, v23
    v_lshlrev_b32 v22, 16, v32
    v_and_b32 v23, 0xffff0000, v32
    v_cvt_pk_bf16_f32 v32, v24, v25
    v_lshlrev_b32 v24, 16, v32
    v_and_b32 v25, 0xffff0000, v32
    v_cvt_pk_bf16_f32 v32, v26, v27
    v_lshlrev_b32 v26, 16, v32
    v_and_b32 v27, 0xffff0000, v32
    v_cvt_pk_bf16_f32 v32, v28, v29
    v_lshlrev_b32 v28, 16, v32
    v_and_b32 v29, 0xffff0000, v32
    v_pk_mul_f32 v[14:15], v[14:15], v[14:15]
    v_pk_mul_f32 v[16:17], v[16:17], v[16:17]
    v_pk_mul_f32 v[18:19], v[18:19], v[18:19]
    v_pk_mul_f32 v[20:21], v[20:21], v[20:21]
    v_pk_mul_f32 v[22:23], v[22:23], v[22:23]
    v_pk_mul_f32 v[24:25], v[24:25], v[24:25]
    v_pk_mul_f32 v[26:27], v[26:27], v[26:27]
    v_pk_mul_f32 v[28:29], v[28:29], v[28:29]
    v_cvt_pk_bf16_f32 v32, v14, v15
    v_lshlrev_b32 v14, 16, v32
    v_and_b32 v15, 0xffff0000, v32
    v_cvt_pk_bf16_f32 v32, v16, v17
    v_lshlrev_b32 v16, 16, v32
    v_and_b32 v17, 0xffff0000, v32
    v_cvt_pk_bf16_f32 v32, v18, v19
    v_lshlrev_b32 v18, 16, v32
    v_and_b32 v19, 0xffff0000, v32
    v_cvt_pk_bf16_f32 v32, v20, v21
    v_lshlrev_b32 v20, 16, v32
    v_and_b32 v21, 0xffff0000, v32
    v_cvt_pk_bf16_f32 v32, v22, v23
    v_lshlrev_b32 v22, 16, v32
    v_and_b32 v23, 0xffff0000, v32
    v_cvt_pk_bf16_f32 v32, v24, v25
    v_lshlrev_b32 v24, 16, v32
    v_and_b32 v25, 0xffff0000, v32
    v_cvt_pk_bf16_f32 v32, v26, v27
    v_lshlrev_b32 v26, 16, v32
    v_and_b32 v27, 0xffff0000, v32
    v_cvt_pk_bf16_f32 v32, v28, v29
    v_lshlrev_b32 v28, 16, v32
    v_and_b32 v29, 0xffff0000, v32
    v_mov_b32 v30, 1092616192
    v_mov_b32 v31, 0x3fb8aa3b
    v_pk_mul_f32 v[14:15], v[14:15], v[30:31] op_sel:[0,0] op_sel_hi:[1,0]
    v_pk_mul_f32 v[16:17], v[16:17], v[30:31] op_sel:[0,0] op_sel_hi:[1,0]
    v_pk_mul_f32 v[18:19], v[18:19], v[30:31] op_sel:[0,0] op_sel_hi:[1,0]
    v_pk_mul_f32 v[20:21], v[20:21], v[30:31] op_sel:[0,0] op_sel_hi:[1,0]
    v_pk_mul_f32 v[22:23], v[22:23], v[30:31] op_sel:[0,0] op_sel_hi:[1,0]
    v_pk_mul_f32 v[24:25], v[24:25], v[30:31] op_sel:[0,0] op_sel_hi:[1,0]
    v_pk_mul_f32 v[26:27], v[26:27], v[30:31] op_sel:[0,0] op_sel_hi:[1,0]
    v_pk_mul_f32 v[28:29], v[28:29], v[30:31] op_sel:[0,0] op_sel_hi:[1,0]
    v_cvt_pk_bf16_f32 v32, v14, v15
    v_lshlrev_b32 v14, 16, v32
    v_and_b32 v15, 0xffff0000, v32
    v_cvt_pk_bf16_f32 v32, v16, v17
    v_lshlrev_b32 v16, 16, v32
    v_and_b32 v17, 0xffff0000, v32
    v_cvt_pk_bf16_f32 v32, v18, v19
    v_lshlrev_b32 v18, 16, v32
    v_and_b32 v19, 0xffff0000, v32
    v_cvt_pk_bf16_f32 v32, v20, v21
    v_lshlrev_b32 v20, 16, v32
    v_and_b32 v21, 0xffff0000, v32
    v_cvt_pk_bf16_f32 v32, v22, v23
    v_lshlrev_b32 v22, 16, v32
    v_and_b32 v23, 0xffff0000, v32
    v_cvt_pk_bf16_f32 v32, v24, v25
    v_lshlrev_b32 v24, 16, v32
    v_and_b32 v25, 0xffff0000, v32
    v_cvt_pk_bf16_f32 v32, v26, v27
    v_lshlrev_b32 v26, 16, v32
    v_and_b32 v27, 0xffff0000, v32
    v_cvt_pk_bf16_f32 v32, v28, v29
    v_lshlrev_b32 v28, 16, v32
    v_and_b32 v29, 0xffff0000, v32
    v_pk_mul_f32 v[14:15], v[14:15], v[30:31] op_sel:[0,1] op_sel_hi:[1,1]
    v_pk_mul_f32 v[16:17], v[16:17], v[30:31] op_sel:[0,1] op_sel_hi:[1,1]
    v_pk_mul_f32 v[18:19], v[18:19], v[30:31] op_sel:[0,1] op_sel_hi:[1,1]
    v_pk_mul_f32 v[20:21], v[20:21], v[30:31] op_sel:[0,1] op_sel_hi:[1,1]
    v_pk_mul_f32 v[22:23], v[22:23], v[30:31] op_sel:[0,1] op_sel_hi:[1,1]
    v_pk_mul_f32 v[24:25], v[24:25], v[30:31] op_sel:[0,1] op_sel_hi:[1,1]
    v_pk_mul_f32 v[26:27], v[26:27], v[30:31] op_sel:[0,1] op_sel_hi:[1,1]
    v_pk_mul_f32 v[28:29], v[28:29], v[30:31] op_sel:[0,1] op_sel_hi:[1,1]
    v_exp_f32 v14, -v14
    v_exp_f32 v15, -v15
    v_exp_f32 v16, -v16
    v_exp_f32 v17, -v17
    v_exp_f32 v18, -v18
    v_exp_f32 v19, -v19
    v_exp_f32 v20, -v20
    v_exp_f32 v21, -v21
    v_exp_f32 v22, -v22
    v_exp_f32 v23, -v23
    v_exp_f32 v24, -v24
    v_exp_f32 v25, -v25
    v_exp_f32 v26, -v26
    v_exp_f32 v27, -v27
    v_exp_f32 v28, -v28
    v_exp_f32 v29, -v29
    v_cvt_pk_bf16_f32 v14, v14, v16
    v_cvt_pk_bf16_f32 v15, v15, v17
    v_cvt_pk_bf16_f32 v18, v18, v20
    v_cvt_pk_bf16_f32 v19, v19, v21
    v_cvt_pk_bf16_f32 v22, v22, v24
    v_cvt_pk_bf16_f32 v23, v23, v25
    v_cvt_pk_bf16_f32 v26, v26, v28
    v_cvt_pk_bf16_f32 v27, v27, v29
    v_dot2_f32_bf16 v72, v14, s68, 0
    v_dot2_f32_bf16 v73, v15, s68, 0
    v_dot2_f32_bf16 v74, v14, s69, 0
    v_dot2_f32_bf16 v75, v15, s69, 0
    v_dot2_f32_bf16 v76, v14, s70, 0
    v_dot2_f32_bf16 v77, v15, s70, 0
    v_dot2_f32_bf16 v78, v14, s71, 0
    v_dot2_f32_bf16 v79, v15, s71, 0
    v_dot2_f32_bf16 v80, v14, s52, 0
    v_dot2_f32_bf16 v81, v15, s52, 0
    v_dot2_f32_bf16 v82, v14, s53, 0
    v_dot2_f32_bf16 v83, v15, s53, 0
    v_dot2_f32_bf16 v84, v14, s54, 0
    v_dot2_f32_bf16 v85, v15, s54, 0
    v_dot2_f32_bf16 v86, v14, s55, 0
    v_dot2_f32_bf16 v87, v15, s55, 0
    v_dot2_f32_bf16 v72, v18, s72, v72
    v_dot2_f32_bf16 v73, v19, s72, v73
    v_dot2_f32_bf16 v74, v18, s73, v74
    v_dot2_f32_bf16 v75, v19, s73, v75
    v_dot2_f32_bf16 v76, v18, s74, v76
    v_dot2_f32_bf16 v77, v19, s74, v77
    v_dot2_f32_bf16 v78, v18, s75, v78
    v_dot2_f32_bf16 v79, v19, s75, v79
    v_dot2_f32_bf16 v80, v18, s56, v80
    v_dot2_f32_bf16 v81, v19, s56, v81
    v_dot2_f32_bf16 v82, v18, s57, v82
    v_dot2_f32_bf16 v83, v19, s57, v83
    v_dot2_f32_bf16 v84, v18, s58, v84
    v_dot2_f32_bf16 v85, v19, s58, v85
    v_dot2_f32_bf16 v86, v18, s59, v86
    v_dot2_f32_bf16 v87, v19, s59, v87
    v_dot2_f32_bf16 v72, v22, s76, v72
    v_dot2_f32_bf16 v73, v23, s76, v73
    v_dot2_f32_bf16 v74, v22, s77, v74
    v_dot2_f32_bf16 v75, v23, s77, v75
    v_dot2_f32_bf16 v76, v22, s78, v76
    v_dot2_f32_bf16 v77, v23, s78, v77
    v_dot2_f32_bf16 v78, v22, s79, v78
    v_dot2_f32_bf16 v79, v23, s79, v79
    v_dot2_f32_bf16 v80, v22, s60, v80
    v_dot2_f32_bf16 v81, v23, s60, v81
    v_dot2_f32_bf16 v82, v22, s61, v82
    v_dot2_f32_bf16 v83, v23, s61, v83
    v_dot2_f32_bf16 v84, v22, s62, v84
    v_dot2_f32_bf16 v85, v23, s62, v85
    v_dot2_f32_bf16 v86, v22, s63, v86
    v_dot2_f32_bf16 v87, v23, s63, v87
    v_dot2_f32_bf16 v72, v26, s80, v72
    v_dot2_f32_bf16 v73, v27, s80, v73
    v_dot2_f32_bf16 v74, v26, s81, v74
    v_dot2_f32_bf16 v75, v27, s81, v75
    v_dot2_f32_bf16 v76, v26, s82, v76
    v_dot2_f32_bf16 v77, v27, s82, v77
    v_dot2_f32_bf16 v78, v26, s83, v78
    v_dot2_f32_bf16 v79, v27, s83, v79
    v_dot2_f32_bf16 v80, v26, s64, v80
    v_dot2_f32_bf16 v81, v27, s64, v81
    v_dot2_f32_bf16 v82, v26, s65, v82
    v_dot2_f32_bf16 v83, v27, s65, v83
    v_dot2_f32_bf16 v84, v26, s66, v84
    v_dot2_f32_bf16 v85, v27, s66, v85
    v_dot2_f32_bf16 v86, v26, s67, v86
    v_dot2_f32_bf16 v87, v27, s67, v87
    s_cmp_ge_u32 s13, 4
    s_cbranch_scc1 L_p2_kernel_g1_30
    v_lshlrev_b32 v30, 16, v61
    v_and_b32 v31, 0xffff0000, v61
    v_pk_add_f32 v[14:15], v[30:31], v[36:37] op_sel:[0,0] op_sel_hi:[1,0] neg_lo:[0,1] neg_hi:[0,1]
    v_pk_add_f32 v[16:17], v[30:31], v[36:37] op_sel:[0,1] op_sel_hi:[1,1] neg_lo:[0,1] neg_hi:[0,1]
    v_pk_add_f32 v[18:19], v[30:31], v[38:39] op_sel:[0,0] op_sel_hi:[1,0] neg_lo:[0,1] neg_hi:[0,1]
    v_pk_add_f32 v[20:21], v[30:31], v[38:39] op_sel:[0,1] op_sel_hi:[1,1] neg_lo:[0,1] neg_hi:[0,1]
    v_pk_add_f32 v[22:23], v[30:31], v[40:41] op_sel:[0,0] op_sel_hi:[1,0] neg_lo:[0,1] neg_hi:[0,1]
    v_pk_add_f32 v[24:25], v[30:31], v[40:41] op_sel:[0,1] op_sel_hi:[1,1] neg_lo:[0,1] neg_hi:[0,1]
    v_pk_add_f32 v[26:27], v[30:31], v[42:43] op_sel:[0,0] op_sel_hi:[1,0] neg_lo:[0,1] neg_hi:[0,1]
    v_pk_add_f32 v[28:29], v[30:31], v[42:43] op_sel:[0,1] op_sel_hi:[1,1] neg_lo:[0,1] neg_hi:[0,1]
    v_cvt_pk_bf16_f32 v32, v14, v15
    v_lshlrev_b32 v14, 16, v32
    v_and_b32 v15, 0xffff0000, v32
    v_cvt_pk_bf16_f32 v32, v16, v17
    v_lshlrev_b32 v16, 16, v32
    v_and_b32 v17, 0xffff0000, v32
    v_cvt_pk_bf16_f32 v32, v18, v19
    v_lshlrev_b32 v18, 16, v32
    v_and_b32 v19, 0xffff0000, v32
    v_cvt_pk_bf16_f32 v32, v20, v21
    v_lshlrev_b32 v20, 16, v32
    v_and_b32 v21, 0xffff0000, v32
    v_cvt_pk_bf16_f32 v32, v22, v23
    v_lshlrev_b32 v22, 16, v32
    v_and_b32 v23, 0xffff0000, v32
    v_cvt_pk_bf16_f32 v32, v24, v25
    v_lshlrev_b32 v24, 16, v32
    v_and_b32 v25, 0xffff0000, v32
    v_cvt_pk_bf16_f32 v32, v26, v27
    v_lshlrev_b32 v26, 16, v32
    v_and_b32 v27, 0xffff0000, v32
    v_cvt_pk_bf16_f32 v32, v28, v29
    v_lshlrev_b32 v28, 16, v32
    v_and_b32 v29, 0xffff0000, v32
    v_pk_mul_f32 v[14:15], v[14:15], v[14:15]
    v_pk_mul_f32 v[16:17], v[16:17], v[16:17]
    v_pk_mul_f32 v[18:19], v[18:19], v[18:19]
    v_pk_mul_f32 v[20:21], v[20:21], v[20:21]
    v_pk_mul_f32 v[22:23], v[22:23], v[22:23]
    v_pk_mul_f32 v[24:25], v[24:25], v[24:25]
    v_pk_mul_f32 v[26:27], v[26:27], v[26:27]
    v_pk_mul_f32 v[28:29], v[28:29], v[28:29]
    v_cvt_pk_bf16_f32 v32, v14, v15
    v_lshlrev_b32 v14, 16, v32
    v_and_b32 v15, 0xffff0000, v32
    v_cvt_pk_bf16_f32 v32, v16, v17
    v_lshlrev_b32 v16, 16, v32
    v_and_b32 v17, 0xffff0000, v32
    v_cvt_pk_bf16_f32 v32, v18, v19
    v_lshlrev_b32 v18, 16, v32
    v_and_b32 v19, 0xffff0000, v32
    v_cvt_pk_bf16_f32 v32, v20, v21
    v_lshlrev_b32 v20, 16, v32
    v_and_b32 v21, 0xffff0000, v32
    v_cvt_pk_bf16_f32 v32, v22, v23
    v_lshlrev_b32 v22, 16, v32
    v_and_b32 v23, 0xffff0000, v32
    v_cvt_pk_bf16_f32 v32, v24, v25
    v_lshlrev_b32 v24, 16, v32
    v_and_b32 v25, 0xffff0000, v32
    v_cvt_pk_bf16_f32 v32, v26, v27
    v_lshlrev_b32 v26, 16, v32
    v_and_b32 v27, 0xffff0000, v32
    v_cvt_pk_bf16_f32 v32, v28, v29
    v_lshlrev_b32 v28, 16, v32
    v_and_b32 v29, 0xffff0000, v32
    v_mov_b32 v30, 1092616192
    v_mov_b32 v31, 0x3fb8aa3b
    v_pk_mul_f32 v[14:15], v[14:15], v[30:31] op_sel:[0,0] op_sel_hi:[1,0]
    v_pk_mul_f32 v[16:17], v[16:17], v[30:31] op_sel:[0,0] op_sel_hi:[1,0]
    v_pk_mul_f32 v[18:19], v[18:19], v[30:31] op_sel:[0,0] op_sel_hi:[1,0]
    v_pk_mul_f32 v[20:21], v[20:21], v[30:31] op_sel:[0,0] op_sel_hi:[1,0]
    v_pk_mul_f32 v[22:23], v[22:23], v[30:31] op_sel:[0,0] op_sel_hi:[1,0]
    v_pk_mul_f32 v[24:25], v[24:25], v[30:31] op_sel:[0,0] op_sel_hi:[1,0]
    v_pk_mul_f32 v[26:27], v[26:27], v[30:31] op_sel:[0,0] op_sel_hi:[1,0]
    v_pk_mul_f32 v[28:29], v[28:29], v[30:31] op_sel:[0,0] op_sel_hi:[1,0]
    v_cvt_pk_bf16_f32 v32, v14, v15
    v_lshlrev_b32 v14, 16, v32
    v_and_b32 v15, 0xffff0000, v32
    v_cvt_pk_bf16_f32 v32, v16, v17
    v_lshlrev_b32 v16, 16, v32
    v_and_b32 v17, 0xffff0000, v32
    v_cvt_pk_bf16_f32 v32, v18, v19
    v_lshlrev_b32 v18, 16, v32
    v_and_b32 v19, 0xffff0000, v32
    v_cvt_pk_bf16_f32 v32, v20, v21
    v_lshlrev_b32 v20, 16, v32
    v_and_b32 v21, 0xffff0000, v32
    v_cvt_pk_bf16_f32 v32, v22, v23
    v_lshlrev_b32 v22, 16, v32
    v_and_b32 v23, 0xffff0000, v32
    v_cvt_pk_bf16_f32 v32, v24, v25
    v_lshlrev_b32 v24, 16, v32
    v_and_b32 v25, 0xffff0000, v32
    v_cvt_pk_bf16_f32 v32, v26, v27
    v_lshlrev_b32 v26, 16, v32
    v_and_b32 v27, 0xffff0000, v32
    v_cvt_pk_bf16_f32 v32, v28, v29
    v_lshlrev_b32 v28, 16, v32
    v_and_b32 v29, 0xffff0000, v32
    v_pk_mul_f32 v[14:15], v[14:15], v[30:31] op_sel:[0,1] op_sel_hi:[1,1]
    v_pk_mul_f32 v[16:17], v[16:17], v[30:31] op_sel:[0,1] op_sel_hi:[1,1]
    v_pk_mul_f32 v[18:19], v[18:19], v[30:31] op_sel:[0,1] op_sel_hi:[1,1]
    v_pk_mul_f32 v[20:21], v[20:21], v[30:31] op_sel:[0,1] op_sel_hi:[1,1]
    v_pk_mul_f32 v[22:23], v[22:23], v[30:31] op_sel:[0,1] op_sel_hi:[1,1]
    v_pk_mul_f32 v[24:25], v[24:25], v[30:31] op_sel:[0,1] op_sel_hi:[1,1]
    v_pk_mul_f32 v[26:27], v[26:27], v[30:31] op_sel:[0,1] op_sel_hi:[1,1]
    v_pk_mul_f32 v[28:29], v[28:29], v[30:31] op_sel:[0,1] op_sel_hi:[1,1]
    v_exp_f32 v14, -v14
    v_exp_f32 v15, -v15
    v_exp_f32 v16, -v16
    v_exp_f32 v17, -v17
    v_exp_f32 v18, -v18
    v_exp_f32 v19, -v19
    v_exp_f32 v20, -v20
    v_exp_f32 v21, -v21
    v_exp_f32 v22, -v22
    v_exp_f32 v23, -v23
    v_exp_f32 v24, -v24
    v_exp_f32 v25, -v25
    v_exp_f32 v26, -v26
    v_exp_f32 v27, -v27
    v_exp_f32 v28, -v28
    v_exp_f32 v29, -v29
    v_cvt_pk_bf16_f32 v14, v14, v16
    v_cvt_pk_bf16_f32 v15, v15, v17
    v_cvt_pk_bf16_f32 v18, v18, v20
    v_cvt_pk_bf16_f32 v19, v19, v21
    v_cvt_pk_bf16_f32 v22, v22, v24
    v_cvt_pk_bf16_f32 v23, v23, v25
    v_cvt_pk_bf16_f32 v26, v26, v28
    v_cvt_pk_bf16_f32 v27, v27, v29
    v_dot2_f32_bf16 v112, v14, s68, 0
    v_dot2_f32_bf16 v113, v15, s68, 0
    v_dot2_f32_bf16 v114, v14, s69, 0
    v_dot2_f32_bf16 v115, v15, s69, 0
    v_dot2_f32_bf16 v116, v14, s70, 0
    v_dot2_f32_bf16 v117, v15, s70, 0
    v_dot2_f32_bf16 v118, v14, s71, 0
    v_dot2_f32_bf16 v119, v15, s71, 0
    v_dot2_f32_bf16 v120, v14, s52, 0
    v_dot2_f32_bf16 v121, v15, s52, 0
    v_dot2_f32_bf16 v122, v14, s53, 0
    v_dot2_f32_bf16 v123, v15, s53, 0
    v_dot2_f32_bf16 v124, v14, s54, 0
    v_dot2_f32_bf16 v125, v15, s54, 0
    v_dot2_f32_bf16 v126, v14, s55, 0
    v_dot2_f32_bf16 v127, v15, s55, 0
    v_dot2_f32_bf16 v112, v18, s72, v112
    v_dot2_f32_bf16 v113, v19, s72, v113
    v_dot2_f32_bf16 v114, v18, s73, v114
    v_dot2_f32_bf16 v115, v19, s73, v115
    v_dot2_f32_bf16 v116, v18, s74, v116
    v_dot2_f32_bf16 v117, v19, s74, v117
    v_dot2_f32_bf16 v118, v18, s75, v118
    v_dot2_f32_bf16 v119, v19, s75, v119
    v_dot2_f32_bf16 v120, v18, s56, v120
    v_dot2_f32_bf16 v121, v19, s56, v121
    v_dot2_f32_bf16 v122, v18, s57, v122
    v_dot2_f32_bf16 v123, v19, s57, v123
    v_dot2_f32_bf16 v124, v18, s58, v124
    v_dot2_f32_bf16 v125, v19, s58, v125
    v_dot2_f32_bf16 v126, v18, s59, v126
    v_dot2_f32_bf16 v127, v19, s59, v127
    v_dot2_f32_bf16 v112, v22, s76, v112
    v_dot2_f32_bf16 v113, v23, s76, v113
    v_dot2_f32_bf16 v114, v22, s77, v114
    v_dot2_f32_bf16 v115, v23, s77, v115
    v_dot2_f32_bf16 v116, v22, s78, v116
    v_dot2_f32_bf16 v117, v23, s78, v117
    v_dot2_f32_bf16 v118, v22, s79, v118
    v_dot2_f32_bf16 v119, v23, s79, v119
    v_dot2_f32_bf16 v120, v22, s60, v120
    v_dot2_f32_bf16 v121, v23, s60, v121
    v_dot2_f32_bf16 v122, v22, s61, v122
    v_dot2_f32_bf16 v123, v23, s61, v123
    v_dot2_f32_bf16 v124, v22, s62, v124
    v_dot2_f32_bf16 v125, v23, s62, v125
    v_dot2_f32_bf16 v126, v22, s63, v126
    v_dot2_f32_bf16 v127, v23, s63, v127
    v_dot2_f32_bf16 v112, v26, s80, v112
    v_dot2_f32_bf16 v113, v27, s80, v113
    v_dot2_f32_bf16 v114, v26, s81, v114
    v_dot2_f32_bf16 v115, v27, s81, v115
    v_dot2_f32_bf16 v116, v26, s82, v116
    v_dot2_f32_bf16 v117, v27, s82, v117
    v_dot2_f32_bf16 v118, v26, s83, v118
    v_dot2_f32_bf16 v119, v27, s83, v119
    v_dot2_f32_bf16 v120, v26, s64, v120
    v_dot2_f32_bf16 v121, v27, s64, v121
    v_dot2_f32_bf16 v122, v26, s65, v122
    v_dot2_f32_bf16 v123, v27, s65, v123
    v_dot2_f32_bf16 v124, v26, s66, v124
    v_dot2_f32_bf16 v125, v27, s66, v125
    v_dot2_f32_bf16 v126, v26, s67, v126
    v_dot2_f32_bf16 v127, v27, s67, v127
L_p2_kernel_g1_30:
    s_lshl2_add_u32 s14, s3, s49
    s_mul_i32 s26, s14, 20000
    s_mov_b32 s10, 5120000
    buffer_load_dwordx4 v[64:67], v1, s[8:11], s26 offen
    buffer_load_dwordx4 v[68:71], v2, s[8:11], s26 offen
    s_branch L_p2_fin
L_p2_done:
    s_branch L_p2_end
L_p2_slow:
    s_barrier
    v_mov_b32 v8, 0
    v_mov_b32 v9, 0
    v_mov_b32 v10, 0
    v_mov_b32 v11, 0
    v_mov_b32 v12, v1
    ds_write_b128 v12, v[8:11]
    v_add_u32 v12, 16384, v12
    ds_write_b128 v12, v[8:11]
    v_add_u32 v12, 16384, v12
    ds_write_b128 v12, v[8:11]
    v_add_u32 v12, 16384, v12
    ds_write_b128 v12, v[8:11]
    v_add_u32 v12, 16384, v12
    ds_write_b128 v12, v[8:11]
    v_add_u32 v12, 16384, v12
    ds_write_b128 v12, v[8:11]
    v_add_u32 v12, 16384, v12
    ds_write_b128 v12, v[8:11]
    v_add_u32 v12, 16384, v12
    ds_write_b128 v12, v[8:11]
    v_add_u32 v12, 16384, v12
    ds_write_b128 v12, v[8:11]
    v_add_u32 v12, 16384, v12
    ds_write_b128 v12, v[8:11]
    v_add_u32 v12, 16384, v12
    v_mul_u32_u24 v13, 8320, v0
    v_mov_b32 v29, 0x7fc00000
    v_add_u32 v28, 32, v13
    v_lshlrev_b32 v14, 10, v0
    v_add_u32 v14, 9437184, v14
    s_mul_i32 s25, s12, 65
    s_add_u32 s25, s25, s3
    s_lshl_b32 s25, s25, 5
    s_add_u32 s25, s25, 0
    s_lshl_b32 s50, s50, 1
    s_mul_i32 s22, s12, 1280000
    s_mov_b32 s24, 0
    s_waitcnt lgkmcnt(0)
    s_barrier
L_p2_sstep:
    buffer_load_ushort v15, v13, s[4:7], s25 offen
    buffer_load_ushort v16, v28, s[4:7], s25 offen
    s_waitcnt vmcnt(0)
L_p2_srec:
    v_cmp_lt_u32 vcc, v15, v16
    s_nop 1
    s_and_b64 exec, exec, vcc
    s_cbranch_execz L_p2_sdone
    v_mul_u32_u24 v17, 43691, v15
    v_lshrrev_b32 v17, 17, v17
    v_mad_i32_i24 v18, v17, -3, v15
    v_lshrrev_b32 v19, 6, v17
    v_lshl_add_u32 v19, v19, 20, v14
    v_and_b32 v17, 63, v17
    v_lshl_add_u32 v17, v17, 4, v19
    v_lshl_add_u32 v19, v18, 2, v17
    buffer_load_dword v20, v19, s[4:7], 0 offen
    buffer_load_dword v21, v17, s[4:7], 0 offen offset:12
    v_add_u32 v15, 1, v15
    v_mad_u32_u24 v18, v18, 10, 2
    s_waitcnt vmcnt(0)
    v_and_b32 v19, 0x3fff, v20
    v_lshlrev_b32 v19, 3, v19
    buffer_load_dwordx2 v[22:23], v19, s[8:11], s22 offen
    v_mad_u32_u16 v20, v20, 16, s50 op_sel:[1,0,0,0]
    v_bfe_i32 v21, v21, v18, 10
    v_cmp_eq_i32 vcc, -512, v21
    v_cvt_f32_i32 v21, v21
    v_mul_f32 v21, 989872160, v21
    v_cndmask_b32 v21, v21, v29, vcc
    s_waitcnt vmcnt(0)
    v_lshlrev_b32 v24, 16, v22
    v_and_b32 v25, 0xffff0000, v22
    v_lshlrev_b32 v26, 16, v23
    v_and_b32 v27, 0xffff0000, v23
    v_mul_f32 v24, v21, v24
    v_mul_f32 v25, v21, v25
    v_mul_f32 v26, v21, v26
    v_mul_f32 v27, v21, v27
    ds_add_f32 v20, v24
    ds_add_f32 v20, v25 offset:4
    ds_add_f32 v20, v26 offset:8
    ds_add_f32 v20, v27 offset:12
    s_branch L_p2_srec
L_p2_sdone:
    s_mov_b64 exec, -1
    s_add_u32 s25, s25, 2
    s_add_u32 s22, s22, 80000
    s_add_u32 s24, s24, 1
    s_cmp_lt_u32 s24, 16
    s_cbranch_scc1 L_p2_sstep
    s_waitcnt lgkmcnt(0)
    s_barrier
    s_mul_i32 s14, s12, 10240000
    s_mul_i32 s15, s3, 160000
    s_add_u32 s26, s14, s15
    s_add_u32 s26, s26, 249069568
    v_mov_b32 v12, v1
    s_mov_b32 s24, 0
L_p2_sout:
    v_cmp_gt_u32 vcc, 160000, v12
    ds_read_b128 v[8:11], v12
    s_nop 0
    s_and_b64 exec, exec, vcc
    s_cbranch_execz L_p2_sfin
    s_waitcnt lgkmcnt(0)
    buffer_store_dwordx4 v[8:11], v12, s[4:7], s26 offen sc1
    s_waitcnt vmcnt(0)
    v_add_u32 v12, 16384, v12
    s_branch L_p2_sout
L_p2_sfin:
    s_mov_b64 exec, -1
    s_waitcnt vmcnt(0) lgkmcnt(0)
    s_barrier
    s_branch L_p2_signal
L_p2_end:
    s_endpgm
.section .rodata,"a"
.p2align 6
.amdhsa_kernel p1_kernel
  .amdhsa_next_free_vgpr 128
  .amdhsa_next_free_sgpr 96
  .amdhsa_accum_offset 128
  .amdhsa_group_segment_fixed_size 0
  .amdhsa_kernarg_size 112
  .amdhsa_user_sgpr_count 2
  .amdhsa_user_sgpr_kernarg_segment_ptr 1
  .amdhsa_system_sgpr_workgroup_id_x 1
  .amdhsa_float_denorm_mode_32 0
.end_amdhsa_kernel
.p2align 6
.amdhsa_kernel p2_kernel
  .amdhsa_next_free_vgpr 128
  .amdhsa_next_free_sgpr 102
  .amdhsa_accum_offset 128
  .amdhsa_group_segment_fixed_size 0
  .amdhsa_kernarg_size 112
  .amdhsa_user_sgpr_count 2
  .amdhsa_user_sgpr_kernarg_segment_ptr 1
  .amdhsa_system_sgpr_workgroup_id_x 1
  .amdhsa_float_denorm_mode_32 0
.end_amdhsa_kernel
```

```asm
; @launch kernel=p1_kernel grid=(256,1,1) block=(1024,1,1) lds=163840
; @launch kernel=p2_kernel grid=(256,1,1) block=(1024,1,1) lds=163840
.amdgcn_target "amdgcn-amd-amdhsa--gfx950"
.text
.globl p1_kernel
.p2align 8
.type p1_kernel,@function
p1_kernel:
    s_cmp_ge_u32 s2, 256
    s_cbranch_scc1 L_p1_end
    s_load_dwordx2 s[4:5], s[0:1], 104
    s_load_dwordx2 s[8:9], s[0:1], 8
    s_load_dwordx2 s[12:13], s[0:1], 16
    s_load_dwordx2 s[16:17], s[0:1], 32
    s_load_dwordx2 s[28:29], s[0:1], 0
    s_load_dwordx2 s[6:7], s[0:1], 48
    v_cmp_gt_u32 vcc, 256, v0
    s_nop 1
    s_cbranch_vccz L_p1_nopf
    s_getpc_b64 s[72:73]
L_p1_kernel_pc_1:
    s_add_u32 s72, s72, L_p1_nopf-L_p1_kernel_pc_1
    s_addc_u32 s73, s73, 0
    v_lshlrev_b32 v14, 7, v0
    v_min_u32 v14, L_p2_end-L_p1_nopf, v14
    global_load_dword v15, v14, s[72:73]
L_p1_nopf:
    v_lshlrev_b32 v1, 4, v0
    v_lshlrev_b32 v2, 3, v0
    v_lshrrev_b32 v6, 6, v0
    v_mul_u32_u24 v3, 851904, v6
    v_add_lshl_u32 v3, v3, v0, 4
    v_mov_b32 v4, 1
    v_mov_b32 v5, 0
    v_readfirstlane_b32 s39, v6
    v_cmp_gt_u32 vcc, 784, v0
    s_and_b32 s51, s2, 7
    s_lshl_b32 s51, s51, 0
    s_bfe_u32 s35, s2, 3
    s_add_u32 s51, s51, s35
    s_and_b32 s35, s2, 248
    s_add_u32 s51, s51, s35
    s_and_b32 s32, s2, 7
    s_lshl_b32 s32, s32, 2
    s_bfe_u32 s35, s2, 131075
    s_add_u32 s32, s32, s35
    s_and_b32 s35, s2, 224
    s_add_u32 s32, s32, s35
    s_lshr_b32 s35, s39, 4
    s_mul_i32 s36, s35, 4177920
    s_lshl_b32 s33, s51, 14
    s_add_u32 s33, s33, s36
    s_lshr_b32 s34, s33, 1
    s_mul_i32 s48, s51, 3840
    s_cmp_ge_u32 s35, 0
    s_cselect_b32 s48, s48, 0
    s_lshr_b32 s49, s48, 1
    s_mov_b64 s[44:45], vcc
    s_waitcnt lgkmcnt(0)
    s_load_dword s3, s[6:7], 0
    s_mov_b32 s10, 163840000
    s_mov_b32 s11, 0x00020000
    s_mov_b32 s14, 163840000
    s_mov_b32 s15, 0x00020000
    s_mov_b32 s18, 81920000
    s_mov_b32 s19, 0x00020000
    s_mul_i32 s36, s2, 20000
    s_add_u32 s30, s36, 20000
    s_mov_b32 s31, 0x00020000
    s_add_u32 s35, s36, 16384
    buffer_load_dwordx4 v[48:51], v1, s[28:31], s36 offen
    buffer_load_dwordx4 v[52:55], v1, s[28:31], s35 offen
    s_add_u32 s35, s33, 0
    buffer_load_dwordx4 v[16:19], v1, s[8:11], s35 offen nt
    s_add_u32 s35, s33, 0
    buffer_load_dwordx4 v[20:23], v1, s[12:15], s35 offen nt
    s_add_u32 s35, s33, 4194304
    buffer_load_dwordx4 v[24:27], v1, s[8:11], s35 offen nt
    s_add_u32 s35, s33, 4194304
    buffer_load_dwordx4 v[28:31], v1, s[12:15], s35 offen nt
    s_add_u32 s35, s33, 8388608
    buffer_load_dwordx4 v[32:35], v1, s[8:11], s35 offen nt
    s_add_u32 s35, s33, 8388608
    buffer_load_dwordx4 v[36:39], v1, s[12:15], s35 offen nt
    s_add_u32 s35, s33, 12582912
    buffer_load_dwordx4 v[40:43], v1, s[8:11], s35 offen nt
    s_add_u32 s35, s33, 12582912
    buffer_load_dwordx4 v[44:47], v1, s[12:15], s35 offen nt
    s_add_u32 s35, s33, 16777216
    buffer_load_dwordx4 v[72:75], v1, s[8:11], s35 offen nt
    s_add_u32 s35, s33, 16777216
    buffer_load_dwordx4 v[76:79], v1, s[12:15], s35 offen nt
    s_mov_b32 s20, s4
    s_mov_b32 s21, s5
    s_mov_b32 s22, 0
    s_mov_b32 s23, 0x00020000
    s_add_u32 s24, s4, 0
    s_addc_u32 s25, s5, 0
    s_mov_b32 s26, 8540160
    s_mov_b32 s27, 0x00020000
    s_mov_b32 s37, 1492179184
    s_mov_b32 s55, 0
    s_mov_b64 s[72:73], s[4:5]
    s_mov_b32 s74, 0
    s_mov_b32 s75, 0x00020000
    s_mov_b32 s50, 21845
    s_mov_b32 s52, 0x8000
    s_mov_b32 s38, 262400
    s_mov_b32 s43, 0x05040100
    s_mov_b32 s40, 0
    v_mov_b32 v8, 0
    v_mov_b32 v9, 0
    v_mov_b32 v10, 0
    v_mov_b32 v11, 0
    ds_write_b128 v1, v[8:11] offset:0
    v_min_u32 v7, 16, v0
    v_lshlrev_b32 v7, 2, v7
    v_add_u32 v7, 160768, v7
    ds_write_b32 v7, v8
    s_waitcnt lgkmcnt(0)
    s_lshl_b32 s3, s3, 16
    v_mov_b32 v12, s3
    v_mul_f32 v12, 0.15915494, v12
    s_nop 0
    v_readfirstlane_b32 s41, v12
    s_waitcnt vmcnt(10)
    v_mov_b32 v12, 0x3f803f80
    v_and_b32 v48, 0x7fff7fff, v48
    v_and_b32 v49, 0x7fff7fff, v49
    v_and_b32 v50, 0x7fff7fff, v50
    v_and_b32 v51, 0x7fff7fff, v51
    v_and_b32 v52, 0x7fff7fff, v52
    v_and_b32 v53, 0x7fff7fff, v53
    v_and_b32 v54, 0x7fff7fff, v54
    v_and_b32 v55, 0x7fff7fff, v55
    v_pk_max_u16 v8, v8, v48
    v_dot2c_f32_bf16 v9, v48, v12
    v_pk_max_u16 v8, v8, v49
    v_dot2c_f32_bf16 v9, v49, v12
    v_pk_max_u16 v8, v8, v50
    v_dot2c_f32_bf16 v9, v50, v12
    v_pk_max_u16 v8, v8, v51
    v_dot2c_f32_bf16 v9, v51, v12
    v_pk_max_u16 v8, v8, v52
    v_dot2c_f32_bf16 v9, v52, v12
    v_pk_max_u16 v8, v8, v53
    v_dot2c_f32_bf16 v9, v53, v12
    v_pk_max_u16 v8, v8, v54
    v_dot2c_f32_bf16 v9, v54, v12
    v_pk_max_u16 v8, v8, v55
    v_dot2c_f32_bf16 v9, v55, v12
    v_lshrrev_b32 v10, 16, v8
    v_and_b32 v8, 0xffff, v8
    v_max_u32 v8, v8, v10
    s_nop 0
    s_nop 1
    v_max_u32_dpp v8, v8, v8 row_shr:1 row_mask:0xf bank_mask:0xf bound_ctrl:0
    s_nop 1
    v_max_u32_dpp v8, v8, v8 row_shr:2 row_mask:0xf bank_mask:0xf bound_ctrl:0
    s_nop 1
    v_max_u32_dpp v8, v8, v8 row_shr:4 row_mask:0xf bank_mask:0xf bound_ctrl:0
    s_nop 1
    v_max_u32_dpp v8, v8, v8 row_shr:8 row_mask:0xf bank_mask:0xf bound_ctrl:0
    s_nop 1
    v_max_u32_dpp v8, v8, v8 row_bcast:15 row_mask:0xa bank_mask:0xf
    s_nop 1
    v_max_u32_dpp v8, v8, v8 row_bcast:31 row_mask:0xc bank_mask:0xf
    s_nop 1
    v_add_f32_dpp v9, v9, v9 row_shr:1 row_mask:0xf bank_mask:0xf bound_ctrl:0
    s_nop 1
    v_add_f32_dpp v9, v9, v9 row_shr:2 row_mask:0xf bank_mask:0xf bound_ctrl:0
    s_nop 1
    v_add_f32_dpp v9, v9, v9 row_shr:4 row_mask:0xf bank_mask:0xf bound_ctrl:0
    s_nop 1
    v_add_f32_dpp v9, v9, v9 row_shr:8 row_mask:0xf bank_mask:0xf bound_ctrl:0
    s_nop 1
    v_add_f32_dpp v9, v9, v9 row_bcast:15 row_mask:0xa bank_mask:0xf
    s_nop 1
    v_add_f32_dpp v9, v9, v9 row_bcast:31 row_mask:0xc bank_mask:0xf
    s_lshl_b32 s35, s39, 4
    s_add_u32 s35, s35, 160320
    v_mov_b32 v10, s35
    s_mov_b32 exec_lo, 0
    s_brev_b32 exec_hi, 1
    ds_write_b64 v10, v[8:9]
    s_mov_b64 exec, -1
    s_waitcnt lgkmcnt(0)
    s_barrier
    s_branch L_p1_first
L_p1_loop:
    s_mov_b64 s[72:73], s[20:21]
    s_mov_b32 s74, s22
    s_getreg_b32 s51, hwreg(HW_REG_XCC_ID, 0, 1)
    s_cmp_eq_u32 s51, 0
    s_cselect_b64 vcc, -1, 0
    s_cmp_lg_u32 s39, 15
    s_cbranch_scc1 L_p1_kernel_nox_2
    s_waitcnt lgkmcnt(13)
    v_lshlrev_b32 v15, 16, v120
    v_and_b32 v120, 0xffff0000, v120
    v_lshlrev_b32 v121, 16, v121
    v_mul_f32 v15, s41, v15
    v_mul_f32 v120, s41, v120
    v_mul_f32 v121, s41, v121
    v_fract_f32 v15, v15
    v_fract_f32 v120, v120
    v_fract_f32 v121, v121
    v_cos_f32 v15, v15
    v_cos_f32 v120, v120
    v_cos_f32 v121, v121
    v_fmaak_f32 v15, v10, v15, 1262486016
    v_fmaak_f32 v120, v10, v120, 1262486016
    v_fmaak_f32 v121, v10, v121, 1262486016
    v_lshlrev_b32 v15, 22, v15
    v_alignbit_b32 v15, v120, v15, 10
    v_alignbit_b32 v15, v121, v15, 10
    v_xor_b32 v15, 0x80200800, v15
    s_mov_b32 s36, 13631488
    buffer_store_dwordx4 v[12:15], v3, s[20:23], s36 offen sc1
L_p1_kernel_nox_2:
    s_waitcnt lgkmcnt(12)
    v_lshlrev_b32 v75, 16, v122
    v_and_b32 v122, 0xffff0000, v122
    v_lshlrev_b32 v123, 16, v123
    v_mul_f32 v75, s41, v75
    v_mul_f32 v122, s41, v122
    v_mul_f32 v123, s41, v123
    v_fract_f32 v75, v75
    v_fract_f32 v122, v122
    v_fract_f32 v123, v123
    v_cos_f32 v75, v75
    v_cos_f32 v122, v122
    v_cos_f32 v123, v123
    v_fmaak_f32 v75, v10, v75, 1262486016
    v_fmaak_f32 v122, v10, v122, 1262486016
    v_fmaak_f32 v123, v10, v123, 1262486016
    v_lshlrev_b32 v75, 22, v75
    v_alignbit_b32 v75, v122, v75, 10
    v_alignbit_b32 v75, v123, v75, 10
    v_xor_b32 v75, 0x80200800, v75
    s_mov_b32 s36, 0
    buffer_store_dwordx4 v[72:75], v3, s[20:23], s36 offen sc1
    s_waitcnt lgkmcnt(11)
    v_lshlrev_b32 v79, 16, v124
    v_and_b32 v124, 0xffff0000, v124
    v_lshlrev_b32 v125, 16, v125
    v_mul_f32 v79, s41, v79
    v_mul_f32 v124, s41, v124
    v_mul_f32 v125, s41, v125
    v_fract_f32 v79, v79
    v_fract_f32 v124, v124
    v_fract_f32 v125, v125
    v_cos_f32 v79, v79
    v_cos_f32 v124, v124
    v_cos_f32 v125, v125
    v_fmaak_f32 v79, v10, v79, 1262486016
    v_fmaak_f32 v124, v10, v124, 1262486016
    v_fmaak_f32 v125, v10, v125, 1262486016
    v_lshlrev_b32 v79, 22, v79
    v_alignbit_b32 v79, v124, v79, 10
    v_alignbit_b32 v79, v125, v79, 10
    v_xor_b32 v79, 0x80200800, v79
    s_mov_b32 s36, 1048576
    buffer_store_dwordx4 v[76:79], v3, s[20:23], s36 offen sc1
    s_waitcnt lgkmcnt(0)
    v_lshlrev_b32 v51, 16, v126
    v_and_b32 v126, 0xffff0000, v126
    v_lshlrev_b32 v127, 16, v127
    v_mul_f32 v51, s41, v51
    v_mul_f32 v126, s41, v126
    v_mul_f32 v127, s41, v127
    v_fract_f32 v51, v51
    v_fract_f32 v126, v126
    v_fract_f32 v127, v127
    v_cos_f32 v51, v51
    v_cos_f32 v126, v126
    v_cos_f32 v127, v127
    v_fmaak_f32 v51, v10, v51, 1262486016
    v_fmaak_f32 v126, v10, v126, 1262486016
    v_fmaak_f32 v127, v10, v127, 1262486016
    v_lshlrev_b32 v51, 22, v51
    v_alignbit_b32 v51, v126, v51, 10
    v_alignbit_b32 v51, v127, v51, 10
    v_xor_b32 v51, 0x80200800, v51
    s_mov_b32 s36, 2097152
    buffer_store_dwordx4 v[48:51], v3, s[20:23], s36 offen sc1
    s_add_u32 s35, s33, 16777216
    buffer_load_dwordx4 v[72:75], v1, s[8:11], s35 offen nt
    s_add_u32 s35, s33, 16777216
    buffer_load_dwordx4 v[76:79], v1, s[12:15], s35 offen nt
    s_cbranch_vccz L_p1_kernel_thr_3
    s_waitcnt vmcnt(2)
L_p1_kernel_thr_3:
    s_waitcnt vmcnt(11)
    v_perm_b32 v6, v20, v16, s43
    v_perm_b32 v7, v21, v17, s43
    v_perm_b32 v8, v22, v18, s43
    v_perm_b32 v9, v23, v19, s43
    v_mul_hi_u32_u24 v16, 429497, v16
    v_mul_hi_u32_u24 v20, 429497, v20
    v_mul_hi_u32_u24 v17, 429497, v17
    v_mul_hi_u32_u24 v21, 429497, v21
    v_mul_hi_u32_u24 v18, 429497, v18
    v_mul_hi_u32_u24 v22, 429497, v22
    v_mul_hi_u32_u24 v19, 429497, v19
    v_mul_hi_u32_u24 v23, 429497, v23
    v_lshl_or_b32 v16, v20, 16, v16
    v_lshl_or_b32 v17, v21, 16, v17
    v_lshl_or_b32 v18, v22, 16, v18
    v_lshl_or_b32 v19, v23, 16, v19
    v_dot2_u32_u16 v20, v16, s38, 0
    v_dot2_u32_u16 v21, v17, s38, 0
    v_dot2_u32_u16 v22, v18, s38, 0
    v_dot2_u32_u16 v23, v19, s38, 0
    v_pk_mad_u16 v6, v16, s37, v6
    v_pk_mad_u16 v7, v17, s37, v7
    v_pk_mad_u16 v8, v18, s37, v8
    v_pk_mad_u16 v9, v19, s37, v9
    ds_add_u32 v20, v4 offset:0
    ds_add_u32 v21, v4 offset:0
    ds_add_u32 v22, v4 offset:0
    ds_add_u32 v23, v4 offset:0
    v_pk_mad_u16 v6, v16, s52, v6 op_sel:[1,0,0] op_sel_hi:[1,1,1]
    v_pk_mad_u16 v7, v17, s52, v7 op_sel:[1,0,0] op_sel_hi:[1,1,1]
    v_pk_mad_u16 v8, v18, s52, v8 op_sel:[1,0,0] op_sel_hi:[1,1,1]
    v_pk_mad_u16 v9, v19, s52, v9 op_sel:[1,0,0] op_sel_hi:[1,1,1]
    v_perm_b32 v121, v23, v22, s43
    v_perm_b32 v120, v21, v20, s43
    v_or_b32 v127, 0x40000000, v6
    v_or_b32 v48, 0x40000000, v7
    v_or_b32 v49, 0x40000000, v8
    v_or_b32 v50, 0x40000000, v9
    v_lshlrev_b32 v83, 16, v100
    v_and_b32 v100, 0xffff0000, v100
    v_lshlrev_b32 v101, 16, v101
    v_mul_f32 v83, s41, v83
    v_mul_f32 v100, s41, v100
    v_mul_f32 v101, s41, v101
    v_fract_f32 v83, v83
    v_fract_f32 v100, v100
    v_fract_f32 v101, v101
    v_cos_f32 v83, v83
    v_cos_f32 v100, v100
    v_cos_f32 v101, v101
    v_fmaak_f32 v83, v10, v83, 1262486016
    v_fmaak_f32 v100, v10, v100, 1262486016
    v_fmaak_f32 v101, v10, v101, 1262486016
    v_lshlrev_b32 v83, 22, v83
    v_alignbit_b32 v83, v100, v83, 10
    v_alignbit_b32 v83, v101, v83, 10
    v_xor_b32 v83, 0x80200800, v83
    s_mov_b32 s36, 3145728
    buffer_store_dwordx4 v[80:83], v3, s[20:23], s36 offen sc1
    v_lshlrev_b32 v55, 16, v102
    v_and_b32 v102, 0xffff0000, v102
    v_lshlrev_b32 v103, 16, v103
    v_mul_f32 v55, s41, v55
    v_mul_f32 v102, s41, v102
    v_mul_f32 v103, s41, v103
    v_fract_f32 v55, v55
    v_fract_f32 v102, v102
    v_fract_f32 v103, v103
    v_cos_f32 v55, v55
    v_cos_f32 v102, v102
    v_cos_f32 v103, v103
    v_fmaak_f32 v55, v10, v55, 1262486016
    v_fmaak_f32 v102, v10, v102, 1262486016
    v_fmaak_f32 v103, v10, v103, 1262486016
    v_lshlrev_b32 v55, 22, v55
    v_alignbit_b32 v55, v102, v55, 10
    v_alignbit_b32 v55, v103, v55, 10
    v_xor_b32 v55, 0x80200800, v55
    s_cmp_lg_u32 s40, 3
    s_cbranch_scc1 L_p1_kernel_now_4
    v_mov_b64 v[16:17], v[52:53]
    v_mov_b64 v[18:19], v[54:55]
    s_branch L_p1_kernel_held_5
L_p1_kernel_now_4:
    s_mov_b32 s36, 4194304
    buffer_store_dwordx4 v[52:55], v3, s[20:23], s36 offen sc1
L_p1_kernel_held_5:
    s_add_u32 s35, s33, 20971520
    buffer_load_dwordx4 v[80:83], v1, s[8:11], s35 offen nt
    s_add_u32 s35, s33, 20971520
    buffer_load_dwordx4 v[100:103], v1, s[12:15], s35 offen nt
    s_cbranch_vccz L_p1_kernel_thr_6
    s_waitcnt vmcnt(2)
L_p1_kernel_thr_6:
    v_lshlrev_b32 v87, 16, v104
    v_and_b32 v104, 0xffff0000, v104
    v_lshlrev_b32 v105, 16, v105
    v_mul_f32 v87, s41, v87
    v_mul_f32 v104, s41, v104
    v_mul_f32 v105, s41, v105
    v_fract_f32 v87, v87
    v_fract_f32 v104, v104
    v_fract_f32 v105, v105
    v_cos_f32 v87, v87
    v_cos_f32 v104, v104
    v_cos_f32 v105, v105
    v_fmaak_f32 v87, v10, v87, 1262486016
    v_fmaak_f32 v104, v10, v104, 1262486016
    v_fmaak_f32 v105, v10, v105, 1262486016
    v_lshlrev_b32 v87, 22, v87
    v_alignbit_b32 v87, v104, v87, 10
    v_alignbit_b32 v87, v105, v87, 10
    v_xor_b32 v87, 0x80200800, v87
    s_mov_b32 s36, 5242880
    buffer_store_dwordx4 v[84:87], v3, s[20:23], s36 offen sc1
    v_lshlrev_b32 v59, 16, v106
    v_and_b32 v106, 0xffff0000, v106
    v_lshlrev_b32 v107, 16, v107
    v_mul_f32 v59, s41, v59
    v_mul_f32 v106, s41, v106
    v_mul_f32 v107, s41, v107
    v_fract_f32 v59, v59
    v_fract_f32 v106, v106
    v_fract_f32 v107, v107
    v_cos_f32 v59, v59
    v_cos_f32 v106, v106
    v_cos_f32 v107, v107
    v_fmaak_f32 v59, v10, v59, 1262486016
    v_fmaak_f32 v106, v10, v106, 1262486016
    v_fmaak_f32 v107, v10, v107, 1262486016
    v_lshlrev_b32 v59, 22, v59
    v_alignbit_b32 v59, v106, v59, 10
    v_alignbit_b32 v59, v107, v59, 10
    v_xor_b32 v59, 0x80200800, v59
    s_cmp_lg_u32 s40, 3
    s_cbranch_scc1 L_p1_kernel_now_7
    v_mov_b64 v[20:21], v[56:57]
    v_mov_b64 v[22:23], v[58:59]
    s_branch L_p1_kernel_held_8
L_p1_kernel_now_7:
    s_mov_b32 s36, 6291456
    buffer_store_dwordx4 v[56:59], v3, s[20:23], s36 offen sc1
L_p1_kernel_held_8:
    s_add_u32 s35, s33, 25165824
    buffer_load_dwordx4 v[84:87], v1, s[8:11], s35 offen nt
    s_add_u32 s35, s33, 25165824
    buffer_load_dwordx4 v[104:107], v1, s[12:15], s35 offen nt
    s_cbranch_vccz L_p1_kernel_thr_9
    s_waitcnt vmcnt(2)
L_p1_kernel_thr_9:
    s_waitcnt vmcnt(15)
    v_perm_b32 v6, v28, v24, s43
    v_perm_b32 v7, v29, v25, s43
    v_perm_b32 v8, v30, v26, s43
    v_perm_b32 v9, v31, v27, s43
    v_mul_hi_u32_u24 v24, 429497, v24
    v_mul_hi_u32_u24 v28, 429497, v28
    v_mul_hi_u32_u24 v25, 429497, v25
    v_mul_hi_u32_u24 v29, 429497, v29
    v_mul_hi_u32_u24 v26, 429497, v26
    v_mul_hi_u32_u24 v30, 429497, v30
    v_mul_hi_u32_u24 v27, 429497, v27
    v_mul_hi_u32_u24 v31, 429497, v31
    v_lshl_or_b32 v24, v28, 16, v24
    v_lshl_or_b32 v25, v29, 16, v25
    v_lshl_or_b32 v26, v30, 16, v26
    v_lshl_or_b32 v27, v31, 16, v27
    v_dot2_u32_u16 v28, v24, s38, 0
    v_dot2_u32_u16 v29, v25, s38, 0
    v_dot2_u32_u16 v30, v26, s38, 0
    v_dot2_u32_u16 v31, v27, s38, 0
    v_pk_mad_u16 v6, v24, s37, v6
    v_pk_mad_u16 v7, v25, s37, v7
    v_pk_mad_u16 v8, v26, s37, v8
    v_pk_mad_u16 v9, v27, s37, v9
    ds_add_u32 v28, v4 offset:0
    ds_add_u32 v29, v4 offset:0
    ds_add_u32 v30, v4 offset:0
    ds_add_u32 v31, v4 offset:0
    v_pk_mad_u16 v6, v24, s52, v6 op_sel:[1,0,0] op_sel_hi:[1,1,1]
    v_pk_mad_u16 v7, v25, s52, v7 op_sel:[1,0,0] op_sel_hi:[1,1,1]
    v_pk_mad_u16 v8, v26, s52, v8 op_sel:[1,0,0] op_sel_hi:[1,1,1]
    v_pk_mad_u16 v9, v27, s52, v9 op_sel:[1,0,0] op_sel_hi:[1,1,1]
    v_perm_b32 v123, v31, v30, s43
    v_perm_b32 v122, v29, v28, s43
    v_or_b32 v52, 0x40000000, v6
    v_or_b32 v53, 0x40000000, v7
    v_or_b32 v54, 0x40000000, v8
    v_or_b32 v56, 0x40000000, v9
    v_lshlrev_b32 v91, 16, v108
    v_and_b32 v108, 0xffff0000, v108
    v_lshlrev_b32 v109, 16, v109
    v_mul_f32 v91, s41, v91
    v_mul_f32 v108, s41, v108
    v_mul_f32 v109, s41, v109
    v_fract_f32 v91, v91
    v_fract_f32 v108, v108
    v_fract_f32 v109, v109
    v_cos_f32 v91, v91
    v_cos_f32 v108, v108
    v_cos_f32 v109, v109
    v_fmaak_f32 v91, v10, v91, 1262486016
    v_fmaak_f32 v108, v10, v108, 1262486016
    v_fmaak_f32 v109, v10, v109, 1262486016
    v_lshlrev_b32 v91, 22, v91
    v_alignbit_b32 v91, v108, v91, 10
    v_alignbit_b32 v91, v109, v91, 10
    v_xor_b32 v91, 0x80200800, v91
    s_cmp_lg_u32 s40, 3
    s_cbranch_scc1 L_p1_kernel_now_10
    v_mov_b64 v[24:25], v[88:89]
    v_mov_b64 v[26:27], v[90:91]
    s_branch L_p1_kernel_held_11
L_p1_kernel_now_10:
    s_mov_b32 s36, 7340032
    buffer_store_dwordx4 v[88:91], v3, s[20:23], s36 offen sc1
L_p1_kernel_held_11:
    v_lshlrev_b32 v63, 16, v110
    v_and_b32 v110, 0xffff0000, v110
    v_lshlrev_b32 v111, 16, v111
    v_mul_f32 v63, s41, v63
    v_mul_f32 v110, s41, v110
    v_mul_f32 v111, s41, v111
    v_fract_f32 v63, v63
    v_fract_f32 v110, v110
    v_fract_f32 v111, v111
    v_cos_f32 v63, v63
    v_cos_f32 v110, v110
    v_cos_f32 v111, v111
    v_fmaak_f32 v63, v10, v63, 1262486016
    v_fmaak_f32 v110, v10, v110, 1262486016
    v_fmaak_f32 v111, v10, v111, 1262486016
    v_lshlrev_b32 v63, 22, v63
    v_alignbit_b32 v63, v110, v63, 10
    v_alignbit_b32 v63, v111, v63, 10
    v_xor_b32 v63, 0x80200800, v63
    s_cmp_lg_u32 s40, 3
    s_cbranch_scc1 L_p1_kernel_now_12
    v_mov_b64 v[28:29], v[60:61]
    v_mov_b64 v[30:31], v[62:63]
    s_branch L_p1_kernel_held_13
L_p1_kernel_now_12:
    s_mov_b32 s36, 8388608
    buffer_store_dwordx4 v[60:63], v3, s[20:23], s36 offen sc1
L_p1_kernel_held_13:
    s_add_u32 s35, s33, 29360128
    buffer_load_dwordx4 v[88:91], v1, s[8:11], s35 offen nt
    s_add_u32 s35, s33, 29360128
    buffer_load_dwordx4 v[108:111], v1, s[12:15], s35 offen nt
    s_cbranch_vccz L_p1_kernel_thr_14
    s_waitcnt vmcnt(2)
L_p1_kernel_thr_14:
    s_waitcnt vmcnt(15)
    v_perm_b32 v6, v36, v32, s43
    v_perm_b32 v7, v37, v33, s43
    v_perm_b32 v8, v38, v34, s43
    v_perm_b32 v9, v39, v35, s43
    v_mul_hi_u32_u24 v32, 429497, v32
    v_mul_hi_u32_u24 v36, 429497, v36
    v_mul_hi_u32_u24 v33, 429497, v33
    v_mul_hi_u32_u24 v37, 429497, v37
    v_mul_hi_u32_u24 v34, 429497, v34
    v_mul_hi_u32_u24 v38, 429497, v38
    v_mul_hi_u32_u24 v35, 429497, v35
    v_mul_hi_u32_u24 v39, 429497, v39
    v_lshl_or_b32 v32, v36, 16, v32
    v_lshl_or_b32 v33, v37, 16, v33
    v_lshl_or_b32 v34, v38, 16, v34
    v_lshl_or_b32 v35, v39, 16, v35
    v_dot2_u32_u16 v36, v32, s38, 0
    v_dot2_u32_u16 v37, v33, s38, 0
    v_dot2_u32_u16 v38, v34, s38, 0
    v_dot2_u32_u16 v39, v35, s38, 0
    v_pk_mad_u16 v6, v32, s37, v6
    v_pk_mad_u16 v7, v33, s37, v7
    v_pk_mad_u16 v8, v34, s37, v8
    v_pk_mad_u16 v9, v35, s37, v9
    ds_add_u32 v36, v4 offset:0
    ds_add_u32 v37, v4 offset:0
    ds_add_u32 v38, v4 offset:0
    ds_add_u32 v39, v4 offset:0
    v_pk_mad_u16 v6, v32, s52, v6 op_sel:[1,0,0] op_sel_hi:[1,1,1]
    v_pk_mad_u16 v7, v33, s52, v7 op_sel:[1,0,0] op_sel_hi:[1,1,1]
    v_pk_mad_u16 v8, v34, s52, v8 op_sel:[1,0,0] op_sel_hi:[1,1,1]
    v_pk_mad_u16 v9, v35, s52, v9 op_sel:[1,0,0] op_sel_hi:[1,1,1]
    v_perm_b32 v125, v39, v38, s43
    v_perm_b32 v124, v37, v36, s43
    v_or_b32 v57, 0x40000000, v6
    v_or_b32 v58, 0x40000000, v7
    v_or_b32 v60, 0x40000000, v8
    v_or_b32 v61, 0x40000000, v9
    v_lshlrev_b32 v95, 16, v112
    v_and_b32 v112, 0xffff0000, v112
    v_lshlrev_b32 v113, 16, v113
    v_mul_f32 v95, s41, v95
    v_mul_f32 v112, s41, v112
    v_mul_f32 v113, s41, v113
    v_fract_f32 v95, v95
    v_fract_f32 v112, v112
    v_fract_f32 v113, v113
    v_cos_f32 v95, v95
    v_cos_f32 v112, v112
    v_cos_f32 v113, v113
    v_fmaak_f32 v95, v10, v95, 1262486016
    v_fmaak_f32 v112, v10, v112, 1262486016
    v_fmaak_f32 v113, v10, v113, 1262486016
    v_lshlrev_b32 v95, 22, v95
    v_alignbit_b32 v95, v112, v95, 10
    v_alignbit_b32 v95, v113, v95, 10
    v_xor_b32 v95, 0x80200800, v95
    s_cmp_lg_u32 s40, 3
    s_cbranch_scc1 L_p1_kernel_now_15
    v_mov_b64 v[32:33], v[92:93]
    v_mov_b64 v[34:35], v[94:95]
    s_branch L_p1_kernel_held_16
L_p1_kernel_now_15:
    s_mov_b32 s36, 9437184
    buffer_store_dwordx4 v[92:95], v3, s[20:23], s36 offen sc1
L_p1_kernel_held_16:
    v_lshlrev_b32 v67, 16, v114
    v_and_b32 v114, 0xffff0000, v114
    v_lshlrev_b32 v115, 16, v115
    v_mul_f32 v67, s41, v67
    v_mul_f32 v114, s41, v114
    v_mul_f32 v115, s41, v115
    v_fract_f32 v67, v67
    v_fract_f32 v114, v114
    v_fract_f32 v115, v115
    v_cos_f32 v67, v67
    v_cos_f32 v114, v114
    v_cos_f32 v115, v115
    v_fmaak_f32 v67, v10, v67, 1262486016
    v_fmaak_f32 v114, v10, v114, 1262486016
    v_fmaak_f32 v115, v10, v115, 1262486016
    v_lshlrev_b32 v67, 22, v67
    v_alignbit_b32 v67, v114, v67, 10
    v_alignbit_b32 v67, v115, v67, 10
    v_xor_b32 v67, 0x80200800, v67
    s_cmp_lg_u32 s40, 3
    s_cbranch_scc1 L_p1_kernel_now_17
    v_mov_b64 v[36:37], v[64:65]
    v_mov_b64 v[38:39], v[66:67]
    s_branch L_p1_kernel_held_18
L_p1_kernel_now_17:
    s_mov_b32 s36, 10485760
    buffer_store_dwordx4 v[64:67], v3, s[20:23], s36 offen sc1
L_p1_kernel_held_18:
    s_add_u32 s35, s33, 33554432
    buffer_load_dwordx4 v[92:95], v1, s[8:11], s35 offen nt
    s_add_u32 s35, s33, 33554432
    buffer_load_dwordx4 v[112:115], v1, s[12:15], s35 offen nt
    s_cbranch_vccz L_p1_kernel_thr_19
    s_waitcnt vmcnt(2)
L_p1_kernel_thr_19:
    s_waitcnt vmcnt(15)
    v_perm_b32 v6, v44, v40, s43
    v_perm_b32 v7, v45, v41, s43
    v_perm_b32 v8, v46, v42, s43
    v_perm_b32 v9, v47, v43, s43
    v_mul_hi_u32_u24 v40, 429497, v40
    v_mul_hi_u32_u24 v44, 429497, v44
    v_mul_hi_u32_u24 v41, 429497, v41
    v_mul_hi_u32_u24 v45, 429497, v45
    v_mul_hi_u32_u24 v42, 429497, v42
    v_mul_hi_u32_u24 v46, 429497, v46
    v_mul_hi_u32_u24 v43, 429497, v43
    v_mul_hi_u32_u24 v47, 429497, v47
    v_lshl_or_b32 v40, v44, 16, v40
    v_lshl_or_b32 v41, v45, 16, v41
    v_lshl_or_b32 v42, v46, 16, v42
    v_lshl_or_b32 v43, v47, 16, v43
    v_dot2_u32_u16 v44, v40, s38, 0
    v_dot2_u32_u16 v45, v41, s38, 0
    v_dot2_u32_u16 v46, v42, s38, 0
    v_dot2_u32_u16 v47, v43, s38, 0
    v_pk_mad_u16 v6, v40, s37, v6
    v_pk_mad_u16 v7, v41, s37, v7
    v_pk_mad_u16 v8, v42, s37, v8
    v_pk_mad_u16 v9, v43, s37, v9
    ds_add_u32 v44, v4 offset:0
    ds_add_u32 v45, v4 offset:0
    ds_add_u32 v46, v4 offset:0
    ds_add_u32 v47, v4 offset:0
    v_pk_mad_u16 v6, v40, s52, v6 op_sel:[1,0,0] op_sel_hi:[1,1,1]
    v_pk_mad_u16 v7, v41, s52, v7 op_sel:[1,0,0] op_sel_hi:[1,1,1]
    v_pk_mad_u16 v8, v42, s52, v8 op_sel:[1,0,0] op_sel_hi:[1,1,1]
    v_pk_mad_u16 v9, v43, s52, v9 op_sel:[1,0,0] op_sel_hi:[1,1,1]
    v_perm_b32 v51, v47, v46, s43
    v_perm_b32 v126, v45, v44, s43
    v_or_b32 v62, 0x40000000, v6
    v_or_b32 v64, 0x40000000, v7
    v_or_b32 v65, 0x40000000, v8
    v_or_b32 v66, 0x40000000, v9
    v_lshlrev_b32 v99, 16, v116
    v_and_b32 v116, 0xffff0000, v116
    v_lshlrev_b32 v117, 16, v117
    v_mul_f32 v99, s41, v99
    v_mul_f32 v116, s41, v116
    v_mul_f32 v117, s41, v117
    v_fract_f32 v99, v99
    v_fract_f32 v116, v116
    v_fract_f32 v117, v117
    v_cos_f32 v99, v99
    v_cos_f32 v116, v116
    v_cos_f32 v117, v117
    v_fmaak_f32 v99, v10, v99, 1262486016
    v_fmaak_f32 v116, v10, v116, 1262486016
    v_fmaak_f32 v117, v10, v117, 1262486016
    v_lshlrev_b32 v99, 22, v99
    v_alignbit_b32 v99, v116, v99, 10
    v_alignbit_b32 v99, v117, v99, 10
    v_xor_b32 v99, 0x80200800, v99
    s_cmp_lg_u32 s40, 3
    s_cbranch_scc1 L_p1_kernel_now_20
    v_mov_b64 v[40:41], v[96:97]
    v_mov_b64 v[42:43], v[98:99]
    s_branch L_p1_kernel_held_21
L_p1_kernel_now_20:
    s_mov_b32 s36, 11534336
    buffer_store_dwordx4 v[96:99], v3, s[20:23], s36 offen sc1
L_p1_kernel_held_21:
    v_lshlrev_b32 v71, 16, v118
    v_and_b32 v118, 0xffff0000, v118
    v_lshlrev_b32 v119, 16, v119
    v_mul_f32 v71, s41, v71
    v_mul_f32 v118, s41, v118
    v_mul_f32 v119, s41, v119
    v_fract_f32 v71, v71
    v_fract_f32 v118, v118
    v_fract_f32 v119, v119
    v_cos_f32 v71, v71
    v_cos_f32 v118, v118
    v_cos_f32 v119, v119
    v_fmaak_f32 v71, v10, v71, 1262486016
    v_fmaak_f32 v118, v10, v118, 1262486016
    v_fmaak_f32 v119, v10, v119, 1262486016
    v_lshlrev_b32 v71, 22, v71
    v_alignbit_b32 v71, v118, v71, 10
    v_alignbit_b32 v71, v119, v71, 10
    v_xor_b32 v71, 0x80200800, v71
    s_cmp_lg_u32 s40, 3
    s_cbranch_scc1 L_p1_kernel_now_22
    v_mov_b64 v[44:45], v[68:69]
    v_mov_b64 v[46:47], v[70:71]
    s_branch L_p1_kernel_held_23
L_p1_kernel_now_22:
    s_mov_b32 s36, 12582912
    buffer_store_dwordx4 v[68:71], v3, s[20:23], s36 offen sc1
L_p1_kernel_held_23:
    s_add_u32 s35, s33, 37748736
    s_sub_u32 s35, s35, s48
    v_cndmask_b32 v96, 2.0, v1, s[44:45]
    buffer_load_dwordx4 v[96:99], v96, s[8:11], s35 offen nt
    s_add_u32 s35, s33, 37748736
    s_sub_u32 s35, s35, s48
    v_cndmask_b32 v116, 2.0, v1, s[44:45]
    buffer_load_dwordx4 v[116:119], v116, s[12:15], s35 offen nt
    s_cbranch_vccz L_p1_kernel_thr_24
    s_waitcnt vmcnt(2)
L_p1_kernel_thr_24:
    s_branch L_p1_join
L_p1_first:
    s_add_u32 s35, s33, 20971520
    buffer_load_dwordx4 v[80:83], v1, s[8:11], s35 offen nt
    s_add_u32 s35, s33, 20971520
    buffer_load_dwordx4 v[100:103], v1, s[12:15], s35 offen nt
    s_add_u32 s35, s33, 25165824
    buffer_load_dwordx4 v[84:87], v1, s[8:11], s35 offen nt
    s_add_u32 s35, s33, 25165824
    buffer_load_dwordx4 v[104:107], v1, s[12:15], s35 offen nt
    s_add_u32 s35, s33, 29360128
    buffer_load_dwordx4 v[88:91], v1, s[8:11], s35 offen nt
    s_add_u32 s35, s33, 29360128
    buffer_load_dwordx4 v[108:111], v1, s[12:15], s35 offen nt
    s_add_u32 s35, s33, 33554432
    buffer_load_dwordx4 v[92:95], v1, s[8:11], s35 offen nt
    s_add_u32 s35, s33, 33554432
    buffer_load_dwordx4 v[112:115], v1, s[12:15], s35 offen nt
    s_add_u32 s35, s33, 37748736
    s_sub_u32 s35, s35, s48
    v_cndmask_b32 v96, 2.0, v1, s[44:45]
    buffer_load_dwordx4 v[96:99], v96, s[8:11], s35 offen nt
    s_add_u32 s35, s33, 37748736
    s_sub_u32 s35, s35, s48
    v_cndmask_b32 v116, 2.0, v1, s[44:45]
    buffer_load_dwordx4 v[116:119], v116, s[12:15], s35 offen nt
    s_waitcnt vmcnt(18)
    v_perm_b32 v6, v20, v16, s43
    v_perm_b32 v7, v21, v17, s43
    v_perm_b32 v8, v22, v18, s43
    v_perm_b32 v9, v23, v19, s43
    v_mul_hi_u32_u24 v16, 429497, v16
    v_mul_hi_u32_u24 v20, 429497, v20
    v_mul_hi_u32_u24 v17, 429497, v17
    v_mul_hi_u32_u24 v21, 429497, v21
    v_mul_hi_u32_u24 v18, 429497, v18
    v_mul_hi_u32_u24 v22, 429497, v22
    v_mul_hi_u32_u24 v19, 429497, v19
    v_mul_hi_u32_u24 v23, 429497, v23
    v_lshl_or_b32 v16, v20, 16, v16
    v_lshl_or_b32 v17, v21, 16, v17
    v_lshl_or_b32 v18, v22, 16, v18
    v_lshl_or_b32 v19, v23, 16, v19
    v_dot2_u32_u16 v20, v16, s38, 0
    v_dot2_u32_u16 v21, v17, s38, 0
    v_dot2_u32_u16 v22, v18, s38, 0
    v_dot2_u32_u16 v23, v19, s38, 0
    v_pk_mad_u16 v6, v16, s37, v6
    v_pk_mad_u16 v7, v17, s37, v7
    v_pk_mad_u16 v8, v18, s37, v8
    v_pk_mad_u16 v9, v19, s37, v9
    ds_add_u32 v20, v4 offset:0
    ds_add_u32 v21, v4 offset:0
    ds_add_u32 v22, v4 offset:0
    ds_add_u32 v23, v4 offset:0
    v_pk_mad_u16 v6, v16, s52, v6 op_sel:[1,0,0] op_sel_hi:[1,1,1]
    v_pk_mad_u16 v7, v17, s52, v7 op_sel:[1,0,0] op_sel_hi:[1,1,1]
    v_pk_mad_u16 v8, v18, s52, v8 op_sel:[1,0,0] op_sel_hi:[1,1,1]
    v_pk_mad_u16 v9, v19, s52, v9 op_sel:[1,0,0] op_sel_hi:[1,1,1]
    v_perm_b32 v121, v23, v22, s43
    v_perm_b32 v120, v21, v20, s43
    v_or_b32 v127, 0x40000000, v6
    v_or_b32 v48, 0x40000000, v7
    v_or_b32 v49, 0x40000000, v8
    v_or_b32 v50, 0x40000000, v9
    s_waitcnt vmcnt(16)
    v_perm_b32 v6, v28, v24, s43
    v_perm_b32 v7, v29, v25, s43
    v_perm_b32 v8, v30, v26, s43
    v_perm_b32 v9, v31, v27, s43
    v_mul_hi_u32_u24 v24, 429497, v24
    v_mul_hi_u32_u24 v28, 429497, v28
    v_mul_hi_u32_u24 v25, 429497, v25
    v_mul_hi_u32_u24 v29, 429497, v29
    v_mul_hi_u32_u24 v26, 429497, v26
    v_mul_hi_u32_u24 v30, 429497, v30
    v_mul_hi_u32_u24 v27, 429497, v27
    v_mul_hi_u32_u24 v31, 429497, v31
    v_lshl_or_b32 v24, v28, 16, v24
    v_lshl_or_b32 v25, v29, 16, v25
    v_lshl_or_b32 v26, v30, 16, v26
    v_lshl_or_b32 v27, v31, 16, v27
    v_dot2_u32_u16 v28, v24, s38, 0
    v_dot2_u32_u16 v29, v25, s38, 0
    v_dot2_u32_u16 v30, v26, s38, 0
    v_dot2_u32_u16 v31, v27, s38, 0
    v_pk_mad_u16 v6, v24, s37, v6
    v_pk_mad_u16 v7, v25, s37, v7
    v_pk_mad_u16 v8, v26, s37, v8
    v_pk_mad_u16 v9, v27, s37, v9
    ds_add_u32 v28, v4 offset:0
    ds_add_u32 v29, v4 offset:0
    ds_add_u32 v30, v4 offset:0
    ds_add_u32 v31, v4 offset:0
    v_pk_mad_u16 v6, v24, s52, v6 op_sel:[1,0,0] op_sel_hi:[1,1,1]
    v_pk_mad_u16 v7, v25, s52, v7 op_sel:[1,0,0] op_sel_hi:[1,1,1]
    v_pk_mad_u16 v8, v26, s52, v8 op_sel:[1,0,0] op_sel_hi:[1,1,1]
    v_pk_mad_u16 v9, v27, s52, v9 op_sel:[1,0,0] op_sel_hi:[1,1,1]
    v_perm_b32 v123, v31, v30, s43
    v_perm_b32 v122, v29, v28, s43
    v_or_b32 v52, 0x40000000, v6
    v_or_b32 v53, 0x40000000, v7
    v_or_b32 v54, 0x40000000, v8
    v_or_b32 v56, 0x40000000, v9
    s_waitcnt vmcnt(14)
    v_perm_b32 v6, v36, v32, s43
    v_perm_b32 v7, v37, v33, s43
    v_perm_b32 v8, v38, v34, s43
    v_perm_b32 v9, v39, v35, s43
    v_mul_hi_u32_u24 v32, 429497, v32
    v_mul_hi_u32_u24 v36, 429497, v36
    v_mul_hi_u32_u24 v33, 429497, v33
    v_mul_hi_u32_u24 v37, 429497, v37
    v_mul_hi_u32_u24 v34, 429497, v34
    v_mul_hi_u32_u24 v38, 429497, v38
    v_mul_hi_u32_u24 v35, 429497, v35
    v_mul_hi_u32_u24 v39, 429497, v39
    v_lshl_or_b32 v32, v36, 16, v32
    v_lshl_or_b32 v33, v37, 16, v33
    v_lshl_or_b32 v34, v38, 16, v34
    v_lshl_or_b32 v35, v39, 16, v35
    v_dot2_u32_u16 v36, v32, s38, 0
    v_dot2_u32_u16 v37, v33, s38, 0
    v_dot2_u32_u16 v38, v34, s38, 0
    v_dot2_u32_u16 v39, v35, s38, 0
    v_pk_mad_u16 v6, v32, s37, v6
    v_pk_mad_u16 v7, v33, s37, v7
    v_pk_mad_u16 v8, v34, s37, v8
    v_pk_mad_u16 v9, v35, s37, v9
    ds_add_u32 v36, v4 offset:0
    ds_add_u32 v37, v4 offset:0
    ds_add_u32 v38, v4 offset:0
    ds_add_u32 v39, v4 offset:0
    v_pk_mad_u16 v6, v32, s52, v6 op_sel:[1,0,0] op_sel_hi:[1,1,1]
    v_pk_mad_u16 v7, v33, s52, v7 op_sel:[1,0,0] op_sel_hi:[1,1,1]
    v_pk_mad_u16 v8, v34, s52, v8 op_sel:[1,0,0] op_sel_hi:[1,1,1]
    v_pk_mad_u16 v9, v35, s52, v9 op_sel:[1,0,0] op_sel_hi:[1,1,1]
    v_perm_b32 v125, v39, v38, s43
    v_perm_b32 v124, v37, v36, s43
    v_or_b32 v57, 0x40000000, v6
    v_or_b32 v58, 0x40000000, v7
    v_or_b32 v60, 0x40000000, v8
    v_or_b32 v61, 0x40000000, v9
    s_waitcnt vmcnt(12)
    v_perm_b32 v6, v44, v40, s43
    v_perm_b32 v7, v45, v41, s43
    v_perm_b32 v8, v46, v42, s43
    v_perm_b32 v9, v47, v43, s43
    v_mul_hi_u32_u24 v40, 429497, v40
    v_mul_hi_u32_u24 v44, 429497, v44
    v_mul_hi_u32_u24 v41, 429497, v41
    v_mul_hi_u32_u24 v45, 429497, v45
    v_mul_hi_u32_u24 v42, 429497, v42
    v_mul_hi_u32_u24 v46, 429497, v46
    v_mul_hi_u32_u24 v43, 429497, v43
    v_mul_hi_u32_u24 v47, 429497, v47
    v_lshl_or_b32 v40, v44, 16, v40
    v_lshl_or_b32 v41, v45, 16, v41
    v_lshl_or_b32 v42, v46, 16, v42
    v_lshl_or_b32 v43, v47, 16, v43
    v_dot2_u32_u16 v44, v40, s38, 0
    v_dot2_u32_u16 v45, v41, s38, 0
    v_dot2_u32_u16 v46, v42, s38, 0
    v_dot2_u32_u16 v47, v43, s38, 0
    v_pk_mad_u16 v6, v40, s37, v6
    v_pk_mad_u16 v7, v41, s37, v7
    v_pk_mad_u16 v8, v42, s37, v8
    v_pk_mad_u16 v9, v43, s37, v9
    ds_add_u32 v44, v4 offset:0
    ds_add_u32 v45, v4 offset:0
    ds_add_u32 v46, v4 offset:0
    ds_add_u32 v47, v4 offset:0
    v_pk_mad_u16 v6, v40, s52, v6 op_sel:[1,0,0] op_sel_hi:[1,1,1]
    v_pk_mad_u16 v7, v41, s52, v7 op_sel:[1,0,0] op_sel_hi:[1,1,1]
    v_pk_mad_u16 v8, v42, s52, v8 op_sel:[1,0,0] op_sel_hi:[1,1,1]
    v_pk_mad_u16 v9, v43, s52, v9 op_sel:[1,0,0] op_sel_hi:[1,1,1]
    v_perm_b32 v51, v47, v46, s43
    v_perm_b32 v126, v45, v44, s43
    v_or_b32 v62, 0x40000000, v6
    v_or_b32 v64, 0x40000000, v7
    v_or_b32 v65, 0x40000000, v8
    v_or_b32 v66, 0x40000000, v9
L_p1_join:
    s_waitcnt vmcnt(10)
    v_perm_b32 v6, v76, v72, s43
    v_perm_b32 v7, v77, v73, s43
    v_perm_b32 v8, v78, v74, s43
    v_perm_b32 v9, v79, v75, s43
    v_mul_hi_u32_u24 v72, 429497, v72
    v_mul_hi_u32_u24 v76, 429497, v76
    v_mul_hi_u32_u24 v73, 429497, v73
    v_mul_hi_u32_u24 v77, 429497, v77
    v_mul_hi_u32_u24 v74, 429497, v74
    v_mul_hi_u32_u24 v78, 429497, v78
    v_mul_hi_u32_u24 v75, 429497, v75
    v_mul_hi_u32_u24 v79, 429497, v79
    v_lshl_or_b32 v72, v76, 16, v72
    v_lshl_or_b32 v73, v77, 16, v73
    v_lshl_or_b32 v74, v78, 16, v74
    v_lshl_or_b32 v75, v79, 16, v75
    v_dot2_u32_u16 v76, v72, s38, 0
    v_dot2_u32_u16 v77, v73, s38, 0
    v_dot2_u32_u16 v78, v74, s38, 0
    v_dot2_u32_u16 v79, v75, s38, 0
    v_pk_mad_u16 v6, v72, s37, v6
    v_pk_mad_u16 v7, v73, s37, v7
    v_pk_mad_u16 v8, v74, s37, v8
    v_pk_mad_u16 v9, v75, s37, v9
    ds_add_u32 v76, v4 offset:0
    ds_add_u32 v77, v4 offset:0
    ds_add_u32 v78, v4 offset:0
    ds_add_u32 v79, v4 offset:0
    v_pk_mad_u16 v6, v72, s52, v6 op_sel:[1,0,0] op_sel_hi:[1,1,1]
    v_pk_mad_u16 v7, v73, s52, v7 op_sel:[1,0,0] op_sel_hi:[1,1,1]
    v_pk_mad_u16 v8, v74, s52, v8 op_sel:[1,0,0] op_sel_hi:[1,1,1]
    v_pk_mad_u16 v9, v75, s52, v9 op_sel:[1,0,0] op_sel_hi:[1,1,1]
    v_perm_b32 v59, v79, v78, s43
    v_perm_b32 v55, v77, v76, s43
    v_or_b32 v68, 0x40000000, v6
    v_or_b32 v69, 0x40000000, v7
    v_or_b32 v70, 0x40000000, v8
    v_or_b32 v72, 0x40000000, v9
    s_waitcnt vmcnt(8)
    v_perm_b32 v6, v100, v80, s43
    v_perm_b32 v7, v101, v81, s43
    v_perm_b32 v8, v102, v82, s43
    v_perm_b32 v9, v103, v83, s43
    v_mul_hi_u32_u24 v80, 429497, v80
    v_mul_hi_u32_u24 v100, 429497, v100
    v_mul_hi_u32_u24 v81, 429497, v81
    v_mul_hi_u32_u24 v101, 429497, v101
    v_mul_hi_u32_u24 v82, 429497, v82
    v_mul_hi_u32_u24 v102, 429497, v102
    v_mul_hi_u32_u24 v83, 429497, v83
    v_mul_hi_u32_u24 v103, 429497, v103
    v_lshl_or_b32 v80, v100, 16, v80
    v_lshl_or_b32 v81, v101, 16, v81
    v_lshl_or_b32 v82, v102, 16, v82
    v_lshl_or_b32 v83, v103, 16, v83
    v_dot2_u32_u16 v100, v80, s38, 0
    v_dot2_u32_u16 v101, v81, s38, 0
    v_dot2_u32_u16 v102, v82, s38, 0
    v_dot2_u32_u16 v103, v83, s38, 0
    v_pk_mad_u16 v6, v80, s37, v6
    v_pk_mad_u16 v7, v81, s37, v7
    v_pk_mad_u16 v8, v82, s37, v8
    v_pk_mad_u16 v9, v83, s37, v9
    ds_add_u32 v100, v4 offset:0
    ds_add_u32 v101, v4 offset:0
    ds_add_u32 v102, v4 offset:0
    ds_add_u32 v103, v4 offset:0
    v_pk_mad_u16 v6, v80, s52, v6 op_sel:[1,0,0] op_sel_hi:[1,1,1]
    v_pk_mad_u16 v7, v81, s52, v7 op_sel:[1,0,0] op_sel_hi:[1,1,1]
    v_pk_mad_u16 v8, v82, s52, v8 op_sel:[1,0,0] op_sel_hi:[1,1,1]
    v_pk_mad_u16 v9, v83, s52, v9 op_sel:[1,0,0] op_sel_hi:[1,1,1]
    v_perm_b32 v67, v103, v102, s43
    v_perm_b32 v63, v101, v100, s43
    v_or_b32 v73, 0x40000000, v6
    v_or_b32 v74, 0x40000000, v7
    v_or_b32 v76, 0x40000000, v8
    v_or_b32 v77, 0x40000000, v9
    s_waitcnt vmcnt(6)
    v_perm_b32 v6, v104, v84, s43
    v_perm_b32 v7, v105, v85, s43
    v_perm_b32 v8, v106, v86, s43
    v_perm_b32 v9, v107, v87, s43
    v_mul_hi_u32_u24 v84, 429497, v84
    v_mul_hi_u32_u24 v104, 429497, v104
    v_mul_hi_u32_u24 v85, 429497, v85
    v_mul_hi_u32_u24 v105, 429497, v105
    v_mul_hi_u32_u24 v86, 429497, v86
    v_mul_hi_u32_u24 v106, 429497, v106
    v_mul_hi_u32_u24 v87, 429497, v87
    v_mul_hi_u32_u24 v107, 429497, v107
    v_lshl_or_b32 v84, v104, 16, v84
    v_lshl_or_b32 v85, v105, 16, v85
    v_lshl_or_b32 v86, v106, 16, v86
    v_lshl_or_b32 v87, v107, 16, v87
    v_dot2_u32_u16 v104, v84, s38, 0
    v_dot2_u32_u16 v105, v85, s38, 0
    v_dot2_u32_u16 v106, v86, s38, 0
    v_dot2_u32_u16 v107, v87, s38, 0
    v_pk_mad_u16 v6, v84, s37, v6
    v_pk_mad_u16 v7, v85, s37, v7
    v_pk_mad_u16 v8, v86, s37, v8
    v_pk_mad_u16 v9, v87, s37, v9
    ds_add_u32 v104, v4 offset:0
    ds_add_u32 v105, v4 offset:0
    ds_add_u32 v106, v4 offset:0
    ds_add_u32 v107, v4 offset:0
    v_pk_mad_u16 v6, v84, s52, v6 op_sel:[1,0,0] op_sel_hi:[1,1,1]
    v_pk_mad_u16 v7, v85, s52, v7 op_sel:[1,0,0] op_sel_hi:[1,1,1]
    v_pk_mad_u16 v8, v86, s52, v8 op_sel:[1,0,0] op_sel_hi:[1,1,1]
    v_pk_mad_u16 v9, v87, s52, v9 op_sel:[1,0,0] op_sel_hi:[1,1,1]
    v_perm_b32 v75, v107, v106, s43
    v_perm_b32 v71, v105, v104, s43
    v_or_b32 v78, 0x40000000, v6
    v_or_b32 v80, 0x40000000, v7
    v_or_b32 v81, 0x40000000, v8
    v_or_b32 v82, 0x40000000, v9
    s_waitcnt vmcnt(4)
    v_perm_b32 v6, v108, v88, s43
    v_perm_b32 v7, v109, v89, s43
    v_perm_b32 v8, v110, v90, s43
    v_perm_b32 v9, v111, v91, s43
    v_mul_hi_u32_u24 v88, 429497, v88
    v_mul_hi_u32_u24 v108, 429497, v108
    v_mul_hi_u32_u24 v89, 429497, v89
    v_mul_hi_u32_u24 v109, 429497, v109
    v_mul_hi_u32_u24 v90, 429497, v90
    v_mul_hi_u32_u24 v110, 429497, v110
    v_mul_hi_u32_u24 v91, 429497, v91
    v_mul_hi_u32_u24 v111, 429497, v111
    v_lshl_or_b32 v88, v108, 16, v88
    v_lshl_or_b32 v89, v109, 16, v89
    v_lshl_or_b32 v90, v110, 16, v90
    v_lshl_or_b32 v91, v111, 16, v91
    v_dot2_u32_u16 v108, v88, s38, 0
    v_dot2_u32_u16 v109, v89, s38, 0
    v_dot2_u32_u16 v110, v90, s38, 0
    v_dot2_u32_u16 v111, v91, s38, 0
    v_pk_mad_u16 v6, v88, s37, v6
    v_pk_mad_u16 v7, v89, s37, v7
    v_pk_mad_u16 v8, v90, s37, v8
    v_pk_mad_u16 v9, v91, s37, v9
    ds_add_u32 v108, v4 offset:0
    ds_add_u32 v109, v4 offset:0
    ds_add_u32 v110, v4 offset:0
    ds_add_u32 v111, v4 offset:0
    v_pk_mad_u16 v6, v88, s52, v6 op_sel:[1,0,0] op_sel_hi:[1,1,1]
    v_pk_mad_u16 v7, v89, s52, v7 op_sel:[1,0,0] op_sel_hi:[1,1,1]
    v_pk_mad_u16 v8, v90, s52, v8 op_sel:[1,0,0] op_sel_hi:[1,1,1]
    v_pk_mad_u16 v9, v91, s52, v9 op_sel:[1,0,0] op_sel_hi:[1,1,1]
    v_perm_b32 v83, v111, v110, s43
    v_perm_b32 v79, v109, v108, s43
    v_or_b32 v84, 0x40000000, v6
    v_or_b32 v85, 0x40000000, v7
    v_or_b32 v86, 0x40000000, v8
    v_or_b32 v88, 0x40000000, v9
    s_waitcnt vmcnt(2)
    v_perm_b32 v6, v112, v92, s43
    v_perm_b32 v7, v113, v93, s43
    v_perm_b32 v8, v114, v94, s43
    v_perm_b32 v9, v115, v95, s43
    v_mul_hi_u32_u24 v92, 429497, v92
    v_mul_hi_u32_u24 v112, 429497, v112
    v_mul_hi_u32_u24 v93, 429497, v93
    v_mul_hi_u32_u24 v113, 429497, v113
    v_mul_hi_u32_u24 v94, 429497, v94
    v_mul_hi_u32_u24 v114, 429497, v114
    v_mul_hi_u32_u24 v95, 429497, v95
    v_mul_hi_u32_u24 v115, 429497, v115
    v_lshl_or_b32 v92, v112, 16, v92
    v_lshl_or_b32 v93, v113, 16, v93
    v_lshl_or_b32 v94, v114, 16, v94
    v_lshl_or_b32 v95, v115, 16, v95
    v_dot2_u32_u16 v112, v92, s38, 0
    v_dot2_u32_u16 v113, v93, s38, 0
    v_dot2_u32_u16 v114, v94, s38, 0
    v_dot2_u32_u16 v115, v95, s38, 0
    v_pk_mad_u16 v6, v92, s37, v6
    v_pk_mad_u16 v7, v93, s37, v7
    v_pk_mad_u16 v8, v94, s37, v8
    v_pk_mad_u16 v9, v95, s37, v9
    ds_add_u32 v112, v4 offset:0
    ds_add_u32 v113, v4 offset:0
    ds_add_u32 v114, v4 offset:0
    ds_add_u32 v115, v4 offset:0
    v_pk_mad_u16 v6, v92, s52, v6 op_sel:[1,0,0] op_sel_hi:[1,1,1]
    v_pk_mad_u16 v7, v93, s52, v7 op_sel:[1,0,0] op_sel_hi:[1,1,1]
    v_pk_mad_u16 v8, v94, s52, v8 op_sel:[1,0,0] op_sel_hi:[1,1,1]
    v_pk_mad_u16 v9, v95, s52, v9 op_sel:[1,0,0] op_sel_hi:[1,1,1]
    v_perm_b32 v91, v115, v114, s43
    v_perm_b32 v87, v113, v112, s43
    v_or_b32 v89, 0x40000000, v6
    v_or_b32 v90, 0x40000000, v7
    v_or_b32 v92, 0x40000000, v8
    v_or_b32 v93, 0x40000000, v9
    s_waitcnt vmcnt(0)
    s_mov_b64 exec, s[44:45]
    v_perm_b32 v6, v116, v96, s43
    v_perm_b32 v7, v117, v97, s43
    v_perm_b32 v8, v118, v98, s43
    v_perm_b32 v9, v119, v99, s43
    v_mul_hi_u32_u24 v96, 429497, v96
    v_mul_hi_u32_u24 v116, 429497, v116
    v_mul_hi_u32_u24 v97, 429497, v97
    v_mul_hi_u32_u24 v117, 429497, v117
    v_mul_hi_u32_u24 v98, 429497, v98
    v_mul_hi_u32_u24 v118, 429497, v118
    v_mul_hi_u32_u24 v99, 429497, v99
    v_mul_hi_u32_u24 v119, 429497, v119
    v_lshl_or_b32 v96, v116, 16, v96
    v_lshl_or_b32 v97, v117, 16, v97
    v_lshl_or_b32 v98, v118, 16, v98
    v_lshl_or_b32 v99, v119, 16, v99
    v_dot2_u32_u16 v116, v96, s38, 0
    v_dot2_u32_u16 v117, v97, s38, 0
    v_dot2_u32_u16 v118, v98, s38, 0
    v_dot2_u32_u16 v119, v99, s38, 0
    v_pk_mad_u16 v6, v96, s37, v6
    v_pk_mad_u16 v7, v97, s37, v7
    v_pk_mad_u16 v8, v98, s37, v8
    v_pk_mad_u16 v9, v99, s37, v9
    ds_add_u32 v116, v4 offset:0
    ds_add_u32 v117, v4 offset:0
    ds_add_u32 v118, v4 offset:0
    ds_add_u32 v119, v4 offset:0
    v_pk_mad_u16 v6, v96, s52, v6 op_sel:[1,0,0] op_sel_hi:[1,1,1]
    v_pk_mad_u16 v7, v97, s52, v7 op_sel:[1,0,0] op_sel_hi:[1,1,1]
    v_pk_mad_u16 v8, v98, s52, v8 op_sel:[1,0,0] op_sel_hi:[1,1,1]
    v_pk_mad_u16 v9, v99, s52, v9 op_sel:[1,0,0] op_sel_hi:[1,1,1]
    v_perm_b32 v99, v119, v118, s43
    v_perm_b32 v95, v117, v116, s43
    v_or_b32 v94, 0x40000000, v6
    v_or_b32 v96, 0x40000000, v7
    v_or_b32 v97, 0x40000000, v8
    v_or_b32 v98, 0x40000000, v9
    s_mov_b64 exec, -1
    s_add_u32 s35, s34, 0
    buffer_load_dwordx2 v[100:101], v2, s[16:19], s35 offen nt
    s_lshl_b32 s35, s32, 10
    s_add_u32 s35, s35, 9437184
    s_add_u32 s20, s4, s35
    s_addc_u32 s21, s5, 0
    s_lshl2_add_u32 s35, s39, 160768
    v_mov_b32 v13, s35
    v_mov_b32 v7, 2.0
    v_and_b32 v6, 63, v0
    s_mov_b32 s36, 160768
    s_lshl_b32 s35, 0x1fffe, s39
    s_and_b32 s35, s35, 0x1ffff
    s_mov_b32 exec_hi, 0
    s_mov_b32 exec_lo, s35
    v_lshl_add_u32 v7, v6, 2, s36
    s_mov_b64 exec, -1
    v_mov_b32 v14, 160832
    s_mov_b32 s53, 2
    s_waitcnt lgkmcnt(0)
    s_barrier
    ds_read_b128 v[8:11], v1 offset:0
    s_add_u32 s35, s34, 2097152
    buffer_load_dwordx2 v[102:103], v2, s[16:19], s35 offen nt
L_p1_redo:
    s_waitcnt lgkmcnt(0)
    v_min3_u32 v12, v8, v9, v10
    v_min_u32 v12, v12, v11
    v_cmp_gt_u32 vcc, s53, v12
    s_nop 0
    s_mov_b64 s[46:47], vcc
    s_cbranch_vccz L_p1_kernel_nomask_25
    v_cmp_eq_u32 s[56:57], 0, v8
    v_cmp_ge_u32 s[64:65], 1, v8
    v_max_u32 v8, 2, v8
    v_cmp_eq_u32 s[58:59], 0, v9
    v_cmp_ge_u32 s[66:67], 1, v9
    v_max_u32 v9, 2, v9
    v_cmp_eq_u32 s[60:61], 0, v10
    v_cmp_ge_u32 s[68:69], 1, v10
    v_max_u32 v10, 2, v10
    v_cmp_eq_u32 s[62:63], 0, v11
    v_cmp_ge_u32 s[70:71], 1, v11
    v_max_u32 v11, 2, v11
L_p1_kernel_nomask_25:
    v_add_u32 v9, v8, v9
    v_add_u32 v10, v9, v10
    v_add_u32 v11, v10, v11
    s_nop 1
    v_add_u32_dpp v6, v11, v11 row_shr:1 row_mask:0xf bank_mask:0xf bound_ctrl:0
    s_nop 1
    v_add_u32_dpp v6, v6, v6 row_shr:2 row_mask:0xf bank_mask:0xf bound_ctrl:0
    s_nop 1
    v_add_u32_dpp v6, v6, v6 row_shr:4 row_mask:0xf bank_mask:0xf bound_ctrl:0
    s_nop 1
    v_add_u32_dpp v6, v6, v6 row_shr:8 row_mask:0xf bank_mask:0xf bound_ctrl:0
    s_nop 1
    v_add_u32_dpp v6, v6, v6 row_bcast:15 row_mask:0xa bank_mask:0xf
    s_nop 1
    v_add_u32_dpp v6, v6, v6 row_bcast:31 row_mask:0xc bank_mask:0xf
    s_nop 0
    v_readlane_b32 s35, v6, 63
    v_sub_u32 v6, v6, v11
    v_add_u32 v8, v8, v6
    v_mov_b32 v12, s35
    ds_add_u32 v7, v12
    v_add_u32 v9, v9, v6
    v_add_u32 v10, v10, v6
    s_waitcnt lgkmcnt(0)
    s_barrier
    ds_read_b32 v12, v14
    ds_read_b32 v11, v13
    s_add_u32 s35, s34, 4194304
    buffer_load_dwordx2 v[104:105], v2, s[16:19], s35 offen nt
    s_waitcnt lgkmcnt(1)
    v_readfirstlane_b32 s54, v12
    s_waitcnt lgkmcnt(0)
    s_cmp_ge_u32 s54, 40063
    s_cbranch_scc0 L_p1_fits
    s_barrier
    v_mov_b32 v12, 0
    ds_write_b32 v7, v12
    s_mov_b32 s53, 0
    s_mov_b32 s55, 1
    s_waitcnt lgkmcnt(0)
    s_barrier
    ds_read_b128 v[8:11], v1 offset:0
    s_branch L_p1_redo
L_p1_fits:
    s_mov_b64 exec, 1
    v_mov_b32 v7, 24576
    ds_write_b16 v7, v12
    s_mov_b64 exec, -1
    v_add_u32 v12, v11, v6
    v_add_u32 v13, v11, v8
    v_add_u32 v14, v11, v9
    v_add_u32 v15, v11, v10
    ds_write_b128 v1, v[12:15] offset:0
    s_add_u32 s35, s54, 2
    s_mul_hi_u32 s35, s35, 1431655766
    v_perm_b32 v15, v15, v14, s43
    v_perm_b32 v14, v13, v12, s43
    ds_write_b64 v2, v[14:15] offset:16384
    s_lshl_b32 s35, s35, 4
    s_add_u32 s35, s35, 217890816
    s_min_u32 s22, s35, 218104832
    s_waitcnt lgkmcnt(0)
    s_barrier
    s_nop 0
    v_and_b32 v6, 0xffff, v120
    v_lshrrev_b32 v7, 16, v120
    v_and_b32 v8, 0xffff, v121
    v_lshrrev_b32 v9, 16, v121
    ds_add_rtn_u32 v6, v6, v4 offset:0
    ds_add_rtn_u32 v7, v7, v4 offset:0
    ds_add_rtn_u32 v8, v8, v4 offset:0
    ds_add_rtn_u32 v9, v9, v4 offset:0
    v_and_b32 v10, 0xffff, v122
    v_lshrrev_b32 v11, 16, v122
    v_and_b32 v12, 0xffff, v123
    v_lshrrev_b32 v13, 16, v123
    ds_add_rtn_u32 v10, v10, v4 offset:0
    ds_add_rtn_u32 v11, v11, v4 offset:0
    ds_add_rtn_u32 v12, v12, v4 offset:0
    ds_add_rtn_u32 v13, v13, v4 offset:0
    s_waitcnt lgkmcnt(4)
    v_perm_b32 v120, v7, v6, s43
    v_perm_b32 v121, v9, v8, s43
    v_and_b32 v6, 0xffff, v124
    v_lshrrev_b32 v7, 16, v124
    v_and_b32 v8, 0xffff, v125
    v_lshrrev_b32 v9, 16, v125
    ds_add_rtn_u32 v6, v6, v4 offset:0
    ds_add_rtn_u32 v7, v7, v4 offset:0
    ds_add_rtn_u32 v8, v8, v4 offset:0
    ds_add_rtn_u32 v9, v9, v4 offset:0
    s_waitcnt lgkmcnt(4)
    v_perm_b32 v122, v11, v10, s43
    v_perm_b32 v123, v13, v12, s43
    s_add_u32 s35, s34, 6291456
    buffer_load_dwordx2 v[106:107], v2, s[16:19], s35 offen nt
    v_and_b32 v10, 0xffff, v126
    v_lshrrev_b32 v11, 16, v126
    v_and_b32 v12, 0xffff, v51
    v_lshrrev_b32 v13, 16, v51
    ds_add_rtn_u32 v10, v10, v4 offset:0
    ds_add_rtn_u32 v11, v11, v4 offset:0
    ds_add_rtn_u32 v12, v12, v4 offset:0
    ds_add_rtn_u32 v13, v13, v4 offset:0
    s_waitcnt lgkmcnt(4)
    v_perm_b32 v124, v7, v6, s43
    v_perm_b32 v125, v9, v8, s43
    s_add_u32 s35, s34, 8388608
    buffer_load_dwordx2 v[108:109], v2, s[16:19], s35 offen nt
    v_and_b32 v6, 0xffff, v55
    v_lshrrev_b32 v7, 16, v55
    v_and_b32 v8, 0xffff, v59
    v_lshrrev_b32 v9, 16, v59
    ds_add_rtn_u32 v6, v6, v4 offset:0
    ds_add_rtn_u32 v7, v7, v4 offset:0
    ds_add_rtn_u32 v8, v8, v4 offset:0
    ds_add_rtn_u32 v9, v9, v4 offset:0
    s_waitcnt lgkmcnt(4)
    v_perm_b32 v126, v11, v10, s43
    v_perm_b32 v51, v13, v12, s43
    s_add_u32 s35, s34, 10485760
    buffer_load_dwordx2 v[110:111], v2, s[16:19], s35 offen nt
    v_and_b32 v10, 0xffff, v63
    v_lshrrev_b32 v11, 16, v63
    v_and_b32 v12, 0xffff, v67
    v_lshrrev_b32 v13, 16, v67
    ds_add_rtn_u32 v10, v10, v4 offset:0
    ds_add_rtn_u32 v11, v11, v4 offset:0
    ds_add_rtn_u32 v12, v12, v4 offset:0
    ds_add_rtn_u32 v13, v13, v4 offset:0
    s_waitcnt lgkmcnt(4)
    v_perm_b32 v55, v7, v6, s43
    v_perm_b32 v59, v9, v8, s43
    v_and_b32 v6, 0xffff, v71
    v_lshrrev_b32 v7, 16, v71
    v_and_b32 v8, 0xffff, v75
    v_lshrrev_b32 v9, 16, v75
    ds_add_rtn_u32 v6, v6, v4 offset:0
    ds_add_rtn_u32 v7, v7, v4 offset:0
    ds_add_rtn_u32 v8, v8, v4 offset:0
    ds_add_rtn_u32 v9, v9, v4 offset:0
    s_waitcnt lgkmcnt(4)
    v_perm_b32 v63, v11, v10, s43
    v_perm_b32 v67, v13, v12, s43
    s_add_u32 s35, s34, 12582912
    buffer_load_dwordx2 v[112:113], v2, s[16:19], s35 offen nt
    v_and_b32 v10, 0xffff, v79
    v_lshrrev_b32 v11, 16, v79
    v_and_b32 v12, 0xffff, v83
    v_lshrrev_b32 v13, 16, v83
    ds_add_rtn_u32 v10, v10, v4 offset:0
    ds_add_rtn_u32 v11, v11, v4 offset:0
    ds_add_rtn_u32 v12, v12, v4 offset:0
    ds_add_rtn_u32 v13, v13, v4 offset:0
    s_waitcnt lgkmcnt(4)
    v_perm_b32 v71, v7, v6, s43
    v_perm_b32 v75, v9, v8, s43
    s_add_u32 s35, s34, 14680064
    buffer_load_dwordx2 v[114:115], v2, s[16:19], s35 offen nt
    v_and_b32 v6, 0xffff, v87
    v_lshrrev_b32 v7, 16, v87
    v_and_b32 v8, 0xffff, v91
    v_lshrrev_b32 v9, 16, v91
    ds_add_rtn_u32 v6, v6, v4 offset:0
    ds_add_rtn_u32 v7, v7, v4 offset:0
    ds_add_rtn_u32 v8, v8, v4 offset:0
    ds_add_rtn_u32 v9, v9, v4 offset:0
    s_waitcnt lgkmcnt(4)
    v_perm_b32 v79, v11, v10, s43
    v_perm_b32 v83, v13, v12, s43
    s_add_u32 s35, s34, 16777216
    buffer_load_dwordx2 v[116:117], v2, s[16:19], s35 offen nt
    s_mov_b64 exec, s[44:45]
    v_and_b32 v10, 0xffff, v95
    v_lshrrev_b32 v11, 16, v95
    v_and_b32 v12, 0xffff, v99
    v_lshrrev_b32 v13, 16, v99
    ds_add_rtn_u32 v10, v10, v4 offset:0
    ds_add_rtn_u32 v11, v11, v4 offset:0
    ds_add_rtn_u32 v12, v12, v4 offset:0
    ds_add_rtn_u32 v13, v13, v4 offset:0
    s_mov_b64 exec, -1
    s_waitcnt lgkmcnt(4)
    v_perm_b32 v87, v7, v6, s43
    v_perm_b32 v91, v9, v8, s43
    s_add_u32 s35, s34, 18874368
    s_sub_u32 s35, s35, s49
    v_cndmask_b32 v118, 2.0, v2, s[44:45]
    buffer_load_dwordx2 v[118:119], v118, s[16:19], s35 offen nt
    s_waitcnt lgkmcnt(0)
    v_perm_b32 v95, v11, v10, s43
    v_perm_b32 v99, v13, v12, s43
    s_cmp_gt_u32 s39, 8
    s_cbranch_scc1 L_p1_kernel_notab_26
    v_lshrrev_b32 v6, 1, v0
    v_mul_u32_u24 v7, 1009, v6
    v_lshrrev_b32 v7, 16, v7
    v_mul_u32_u24 v7, 959, v7
    v_and_b32 v8, 1, v0
    v_lshl_add_u32 v7, v8, 9, v7
    v_add_lshl_u32 v13, v7, v6, 1
    ds_read_u16 v6, v13 offset:16384
    ds_read_u16 v7, v13 offset:16512
    ds_read_u16 v8, v13 offset:16640
    ds_read_u16 v9, v13 offset:16768
    ds_read_u16 v10, v13 offset:16896
    ds_read_u16 v11, v13 offset:17024
    ds_read_u16 v12, v13 offset:17152
    ds_read_u16 v13, v13 offset:17280
    s_mul_i32 s35, s32, 8320
    s_add_u32 s26, s35, 8320
    s_waitcnt lgkmcnt(6)
    v_perm_b32 v6, v7, v6, s43
    s_waitcnt lgkmcnt(4)
    v_perm_b32 v7, v9, v8, s43
    s_waitcnt lgkmcnt(2)
    v_perm_b32 v8, v11, v10, s43
    s_waitcnt lgkmcnt(0)
    v_perm_b32 v9, v13, v12, s43
    buffer_store_dwordx4 v[6:9], v1, s[24:27], s35 offen sc1
    s_nop 1
L_p1_kernel_notab_26:
    s_barrier
    s_lshl_b32 s35, s54, 2
    v_mov_b32 v6, s35
    v_mov_b32 v7, 0
    v_mov_b32 v12, 1140817920
    s_mov_b64 exec, 1
    ds_write2_b32 v6, v7, v7 offset0:0 offset1:1
    s_cmp_eq_u64 s[46:47], 0
    s_cbranch_scc1 L_p1_kernel_nonull_27
    s_mov_b64 exec, s[64:65]
    v_lshlrev_b32_sdwa v6, 2, v14 dst_sel:DWORD dst_unused:UNUSED_PAD src0_sel:DWORD src1_sel:WORD_0
    ds_write_b32 v6, v7 offset:4
    s_mov_b64 exec, s[56:57]
    ds_write_b32 v6, v7
    s_mov_b64 exec, s[66:67]
    v_lshlrev_b32_sdwa v6, 2, v14 dst_sel:DWORD dst_unused:UNUSED_PAD src0_sel:DWORD src1_sel:WORD_1
    ds_write_b32 v6, v7 offset:4
    s_mov_b64 exec, s[58:59]
    ds_write_b32 v6, v7
    s_mov_b64 exec, s[68:69]
    v_lshlrev_b32_sdwa v6, 2, v15 dst_sel:DWORD dst_unused:UNUSED_PAD src0_sel:DWORD src1_sel:WORD_0
    ds_write_b32 v6, v7 offset:4
    s_mov_b64 exec, s[60:61]
    ds_write_b32 v6, v7
    s_mov_b64 exec, s[70:71]
    v_lshlrev_b32_sdwa v6, 2, v15 dst_sel:DWORD dst_unused:UNUSED_PAD src0_sel:DWORD src1_sel:WORD_1
    ds_write_b32 v6, v7 offset:4
    s_mov_b64 exec, s[62:63]
    ds_write_b32 v6, v7
L_p1_kernel_nonull_27:
    s_mov_b64 exec, -1
    v_lshlrev_b32_sdwa v6, 2, v120 dst_sel:DWORD dst_unused:UNUSED_PAD src0_sel:DWORD src1_sel:WORD_0
    v_lshlrev_b32_sdwa v7, 2, v120 dst_sel:DWORD dst_unused:UNUSED_PAD src0_sel:DWORD src1_sel:WORD_1
    v_lshlrev_b32_sdwa v8, 2, v121 dst_sel:DWORD dst_unused:UNUSED_PAD src0_sel:DWORD src1_sel:WORD_0
    v_lshlrev_b32_sdwa v9, 2, v121 dst_sel:DWORD dst_unused:UNUSED_PAD src0_sel:DWORD src1_sel:WORD_1
    ds_write_b32 v6, v127
    ds_write_b32 v7, v48
    ds_write_b32 v8, v49
    ds_write_b32 v9, v50
    s_cmp_lg_u32 s40, 3
    s_cbranch_scc1 L_p1_kernel_ld_28
    s_mov_b32 s36, 4194304
    buffer_store_dwordx4 v[16:19], v3, s[72:75], s36 offen sc1
    s_branch L_p1_kernel_st_29
L_p1_kernel_ld_28:
    s_add_u32 s35, s33, 40960000
    buffer_load_dwordx4 v[16:19], v1, s[8:11], s35 offen nt
L_p1_kernel_st_29:
    v_lshlrev_b32_sdwa v6, 2, v122 dst_sel:DWORD dst_unused:UNUSED_PAD src0_sel:DWORD src1_sel:WORD_0
    v_lshlrev_b32_sdwa v7, 2, v122 dst_sel:DWORD dst_unused:UNUSED_PAD src0_sel:DWORD src1_sel:WORD_1
    v_lshlrev_b32_sdwa v8, 2, v123 dst_sel:DWORD dst_unused:UNUSED_PAD src0_sel:DWORD src1_sel:WORD_0
    v_lshlrev_b32_sdwa v9, 2, v123 dst_sel:DWORD dst_unused:UNUSED_PAD src0_sel:DWORD src1_sel:WORD_1
    ds_write_b32 v6, v52
    ds_write_b32 v7, v53
    ds_write_b32 v8, v54
    ds_write_b32 v9, v56
    v_lshlrev_b32_sdwa v6, 2, v124 dst_sel:DWORD dst_unused:UNUSED_PAD src0_sel:DWORD src1_sel:WORD_0
    v_lshlrev_b32_sdwa v7, 2, v124 dst_sel:DWORD dst_unused:UNUSED_PAD src0_sel:DWORD src1_sel:WORD_1
    v_lshlrev_b32_sdwa v8, 2, v125 dst_sel:DWORD dst_unused:UNUSED_PAD src0_sel:DWORD src1_sel:WORD_0
    v_lshlrev_b32_sdwa v9, 2, v125 dst_sel:DWORD dst_unused:UNUSED_PAD src0_sel:DWORD src1_sel:WORD_1
    ds_write_b32 v6, v57
    ds_write_b32 v7, v58
    ds_write_b32 v8, v60
    ds_write_b32 v9, v61
    v_lshlrev_b32_sdwa v6, 2, v126 dst_sel:DWORD dst_unused:UNUSED_PAD src0_sel:DWORD src1_sel:WORD_0
    v_lshlrev_b32_sdwa v7, 2, v126 dst_sel:DWORD dst_unused:UNUSED_PAD src0_sel:DWORD src1_sel:WORD_1
    v_lshlrev_b32_sdwa v8, 2, v51 dst_sel:DWORD dst_unused:UNUSED_PAD src0_sel:DWORD src1_sel:WORD_0
    v_lshlrev_b32_sdwa v9, 2, v51 dst_sel:DWORD dst_unused:UNUSED_PAD src0_sel:DWORD src1_sel:WORD_1
    ds_write_b32 v6, v62
    ds_write_b32 v7, v64
    ds_write_b32 v8, v65
    ds_write_b32 v9, v66
    s_cmp_lg_u32 s40, 3
    s_cbranch_scc1 L_p1_kernel_ld_30
    s_mov_b32 s36, 6291456
    buffer_store_dwordx4 v[20:23], v3, s[72:75], s36 offen sc1
    s_branch L_p1_kernel_st_31
L_p1_kernel_ld_30:
    s_add_u32 s35, s33, 40960000
    buffer_load_dwordx4 v[20:23], v1, s[12:15], s35 offen nt
L_p1_kernel_st_31:
    v_lshlrev_b32_sdwa v6, 2, v55 dst_sel:DWORD dst_unused:UNUSED_PAD src0_sel:DWORD src1_sel:WORD_0
    v_lshlrev_b32_sdwa v7, 2, v55 dst_sel:DWORD dst_unused:UNUSED_PAD src0_sel:DWORD src1_sel:WORD_1
    v_lshlrev_b32_sdwa v8, 2, v59 dst_sel:DWORD dst_unused:UNUSED_PAD src0_sel:DWORD src1_sel:WORD_0
    v_lshlrev_b32_sdwa v9, 2, v59 dst_sel:DWORD dst_unused:UNUSED_PAD src0_sel:DWORD src1_sel:WORD_1
    ds_write_b32 v6, v68
    ds_write_b32 v7, v69
    ds_write_b32 v8, v70
    ds_write_b32 v9, v72
    v_lshlrev_b32_sdwa v6, 2, v63 dst_sel:DWORD dst_unused:UNUSED_PAD src0_sel:DWORD src1_sel:WORD_0
    v_lshlrev_b32_sdwa v7, 2, v63 dst_sel:DWORD dst_unused:UNUSED_PAD src0_sel:DWORD src1_sel:WORD_1
    v_lshlrev_b32_sdwa v8, 2, v67 dst_sel:DWORD dst_unused:UNUSED_PAD src0_sel:DWORD src1_sel:WORD_0
    v_lshlrev_b32_sdwa v9, 2, v67 dst_sel:DWORD dst_unused:UNUSED_PAD src0_sel:DWORD src1_sel:WORD_1
    ds_write_b32 v6, v73
    ds_write_b32 v7, v74
    ds_write_b32 v8, v76
    ds_write_b32 v9, v77
    v_lshlrev_b32_sdwa v6, 2, v71 dst_sel:DWORD dst_unused:UNUSED_PAD src0_sel:DWORD src1_sel:WORD_0
    v_lshlrev_b32_sdwa v7, 2, v71 dst_sel:DWORD dst_unused:UNUSED_PAD src0_sel:DWORD src1_sel:WORD_1
    v_lshlrev_b32_sdwa v8, 2, v75 dst_sel:DWORD dst_unused:UNUSED_PAD src0_sel:DWORD src1_sel:WORD_0
    v_lshlrev_b32_sdwa v9, 2, v75 dst_sel:DWORD dst_unused:UNUSED_PAD src0_sel:DWORD src1_sel:WORD_1
    ds_write_b32 v6, v78
    ds_write_b32 v7, v80
    ds_write_b32 v8, v81
    ds_write_b32 v9, v82
    s_cmp_lg_u32 s40, 3
    s_cbranch_scc1 L_p1_kernel_ld_32
    s_mov_b32 s36, 7340032
    buffer_store_dwordx4 v[24:27], v3, s[72:75], s36 offen sc1
    s_branch L_p1_kernel_st_33
L_p1_kernel_ld_32:
    s_add_u32 s35, s33, 45154304
    buffer_load_dwordx4 v[24:27], v1, s[8:11], s35 offen nt
L_p1_kernel_st_33:
    v_lshlrev_b32_sdwa v6, 2, v79 dst_sel:DWORD dst_unused:UNUSED_PAD src0_sel:DWORD src1_sel:WORD_0
    v_lshlrev_b32_sdwa v7, 2, v79 dst_sel:DWORD dst_unused:UNUSED_PAD src0_sel:DWORD src1_sel:WORD_1
    v_lshlrev_b32_sdwa v8, 2, v83 dst_sel:DWORD dst_unused:UNUSED_PAD src0_sel:DWORD src1_sel:WORD_0
    v_lshlrev_b32_sdwa v9, 2, v83 dst_sel:DWORD dst_unused:UNUSED_PAD src0_sel:DWORD src1_sel:WORD_1
    ds_write_b32 v6, v84
    ds_write_b32 v7, v85
    ds_write_b32 v8, v86
    ds_write_b32 v9, v88
    v_lshlrev_b32_sdwa v6, 2, v87 dst_sel:DWORD dst_unused:UNUSED_PAD src0_sel:DWORD src1_sel:WORD_0
    v_lshlrev_b32_sdwa v7, 2, v87 dst_sel:DWORD dst_unused:UNUSED_PAD src0_sel:DWORD src1_sel:WORD_1
    v_lshlrev_b32_sdwa v8, 2, v91 dst_sel:DWORD dst_unused:UNUSED_PAD src0_sel:DWORD src1_sel:WORD_0
    v_lshlrev_b32_sdwa v9, 2, v91 dst_sel:DWORD dst_unused:UNUSED_PAD src0_sel:DWORD src1_sel:WORD_1
    ds_write_b32 v6, v89
    ds_write_b32 v7, v90
    ds_write_b32 v8, v92
    ds_write_b32 v9, v93
    s_mov_b64 exec, s[44:45]
    v_lshlrev_b32_sdwa v6, 2, v95 dst_sel:DWORD dst_unused:UNUSED_PAD src0_sel:DWORD src1_sel:WORD_0
    v_lshlrev_b32_sdwa v7, 2, v95 dst_sel:DWORD dst_unused:UNUSED_PAD src0_sel:DWORD src1_sel:WORD_1
    v_lshlrev_b32_sdwa v8, 2, v99 dst_sel:DWORD dst_unused:UNUSED_PAD src0_sel:DWORD src1_sel:WORD_0
    v_lshlrev_b32_sdwa v9, 2, v99 dst_sel:DWORD dst_unused:UNUSED_PAD src0_sel:DWORD src1_sel:WORD_1
    ds_write_b32 v6, v94
    ds_write_b32 v7, v96
    ds_write_b32 v8, v97
    ds_write_b32 v9, v98
    s_mov_b64 exec, -1
    s_cmp_lg_u32 s40, 3
    s_cbranch_scc1 L_p1_kernel_ld_34
    s_mov_b32 s36, 8388608
    buffer_store_dwordx4 v[28:31], v3, s[72:75], s36 offen sc1
    s_branch L_p1_kernel_st_35
L_p1_kernel_ld_34:
    s_add_u32 s35, s33, 45154304
    buffer_load_dwordx4 v[28:31], v1, s[12:15], s35 offen nt
L_p1_kernel_st_35:
    s_mul_i32 s35, s39, 9216
    v_mad_u32_u24 v6, v0, 12, s35
    s_waitcnt lgkmcnt(0)
    s_barrier
    s_cmp_lg_u32 s39, 15
    s_cbranch_scc1 L_p1_kernel_nox_36
    ds_read_b32 v12, v6 offset:9984
    ds_read_b32 v13, v6 offset:9988
    ds_read_b32 v14, v6 offset:9992
L_p1_kernel_nox_36:
    ds_read_b32 v48, v6 offset:1536
    ds_read_b32 v49, v6 offset:1540
    ds_read_b32 v50, v6 offset:1544
    ds_read_b32 v52, v6 offset:3072
    ds_read_b32 v53, v6 offset:3076
    ds_read_b32 v54, v6 offset:3080
    ds_read_b32 v56, v6 offset:4608
    ds_read_b32 v57, v6 offset:4612
    ds_read_b32 v58, v6 offset:4616
    ds_read_b32 v60, v6 offset:6144
    ds_read_b32 v61, v6 offset:6148
    ds_read_b32 v62, v6 offset:6152
    ds_read_b32 v64, v6 offset:7680
    ds_read_b32 v65, v6 offset:7684
    ds_read_b32 v66, v6 offset:7688
    ds_read_b32 v68, v6 offset:9216
    ds_read_b32 v69, v6 offset:9220
    ds_read_b32 v70, v6 offset:9224
    ds_read_b32 v72, v6 offset:0
    ds_read_b32 v73, v6 offset:4
    ds_read_b32 v74, v6 offset:8
    ds_read_b32 v76, v6 offset:768
    ds_read_b32 v77, v6 offset:772
    ds_read_b32 v78, v6 offset:776
    ds_read_b32 v80, v6 offset:2304
    ds_read_b32 v81, v6 offset:2308
    ds_read_b32 v82, v6 offset:2312
    ds_read_b32 v84, v6 offset:3840
    ds_read_b32 v85, v6 offset:3844
    ds_read_b32 v86, v6 offset:3848
    ds_read_b32 v88, v6 offset:5376
    ds_read_b32 v89, v6 offset:5380
    ds_read_b32 v90, v6 offset:5384
    ds_read_b32 v92, v6 offset:6912
    ds_read_b32 v93, v6 offset:6916
    ds_read_b32 v94, v6 offset:6920
    ds_read_b32 v96, v6 offset:8448
    ds_read_b32 v97, v6 offset:8452
    ds_read_b32 v98, v6 offset:8456
    s_cmp_lg_u32 s40, 3
    s_cbranch_scc1 L_p1_kernel_ld_37
    s_mov_b32 s36, 9437184
    buffer_store_dwordx4 v[32:35], v3, s[72:75], s36 offen sc1
    s_branch L_p1_kernel_st_38
L_p1_kernel_ld_37:
    s_add_u32 s35, s33, 49348608
    buffer_load_dwordx4 v[32:35], v1, s[8:11], s35 offen nt
L_p1_kernel_st_38:
    v_mov_b32 v8, 0
    v_mov_b32 v9, 0
    v_mov_b32 v10, 0
    v_mov_b32 v11, 0
    v_mov_b32 v15, 16384
    v_min_u32 v7, 16, v0
    v_lshlrev_b32 v7, 2, v7
    v_add_u32 v7, 160768, v7
    s_waitcnt lgkmcnt(0)
    s_barrier
    ds_write_b128 v1, v[8:11] offset:0
    ds_write_b32 v7, v8
    s_nop 1
    v_mov_b32 v6, 1140817920
    s_waitcnt vmcnt(14)
    v_pk_maximum3_f16 v5, v100, v101, v5
    v_mad_u32_u16 v6, v120, s50, v15 op_sel:[0,0,0,0]
    v_mad_u32_u16 v7, v120, s50, v15 op_sel:[1,0,0,0]
    v_mad_u32_u16 v8, v121, s50, v15 op_sel:[0,0,0,0]
    v_mad_u32_u16 v9, v121, s50, v15 op_sel:[1,0,0,0]
    v_add_u32_sdwa v6, v6, v120 dst_sel:DWORD dst_unused:UNUSED_PAD src0_sel:WORD_1 src1_sel:WORD_0
    v_add_u32_sdwa v7, v7, v120 dst_sel:DWORD dst_unused:UNUSED_PAD src0_sel:WORD_1 src1_sel:WORD_1
    v_add_u32_sdwa v8, v8, v121 dst_sel:DWORD dst_unused:UNUSED_PAD src0_sel:WORD_1 src1_sel:WORD_0
    v_add_u32_sdwa v9, v9, v121 dst_sel:DWORD dst_unused:UNUSED_PAD src0_sel:WORD_1 src1_sel:WORD_1
    v_add_u32 v6, v6, v6
    v_add_u32 v7, v7, v7
    v_add_u32 v8, v8, v8
    v_add_u32 v9, v9, v9
    ds_write_b16 v6, v100 offset:16384
    ds_write_b16_d16_hi v7, v100 offset:16384
    ds_write_b16 v8, v101 offset:16384
    ds_write_b16_d16_hi v9, v101 offset:16384
    v_mov_b32 v6, 1140817920
    s_waitcnt vmcnt(13)
    v_pk_maximum3_f16 v5, v102, v103, v5
    v_mad_u32_u16 v6, v122, s50, v15 op_sel:[0,0,0,0]
    v_mad_u32_u16 v7, v122, s50, v15 op_sel:[1,0,0,0]
    v_mad_u32_u16 v8, v123, s50, v15 op_sel:[0,0,0,0]
    v_mad_u32_u16 v9, v123, s50, v15 op_sel:[1,0,0,0]
    v_add_u32_sdwa v6, v6, v122 dst_sel:DWORD dst_unused:UNUSED_PAD src0_sel:WORD_1 src1_sel:WORD_0
    v_add_u32_sdwa v7, v7, v122 dst_sel:DWORD dst_unused:UNUSED_PAD src0_sel:WORD_1 src1_sel:WORD_1
    v_add_u32_sdwa v8, v8, v123 dst_sel:DWORD dst_unused:UNUSED_PAD src0_sel:WORD_1 src1_sel:WORD_0
    v_add_u32_sdwa v9, v9, v123 dst_sel:DWORD dst_unused:UNUSED_PAD src0_sel:WORD_1 src1_sel:WORD_1
    v_add_u32 v6, v6, v6
    v_add_u32 v7, v7, v7
    v_add_u32 v8, v8, v8
    v_add_u32 v9, v9, v9
    ds_write_b16 v6, v102 offset:16384
    ds_write_b16_d16_hi v7, v102 offset:16384
    ds_write_b16 v8, v103 offset:16384
    ds_write_b16_d16_hi v9, v103 offset:16384
    v_mov_b32 v6, 1140817920
    s_waitcnt vmcnt(12)
    v_pk_maximum3_f16 v5, v104, v105, v5
    v_mad_u32_u16 v6, v124, s50, v15 op_sel:[0,0,0,0]
    v_mad_u32_u16 v7, v124, s50, v15 op_sel:[1,0,0,0]
    v_mad_u32_u16 v8, v125, s50, v15 op_sel:[0,0,0,0]
    v_mad_u32_u16 v9, v125, s50, v15 op_sel:[1,0,0,0]
    v_add_u32_sdwa v6, v6, v124 dst_sel:DWORD dst_unused:UNUSED_PAD src0_sel:WORD_1 src1_sel:WORD_0
    v_add_u32_sdwa v7, v7, v124 dst_sel:DWORD dst_unused:UNUSED_PAD src0_sel:WORD_1 src1_sel:WORD_1
    v_add_u32_sdwa v8, v8, v125 dst_sel:DWORD dst_unused:UNUSED_PAD src0_sel:WORD_1 src1_sel:WORD_0
    v_add_u32_sdwa v9, v9, v125 dst_sel:DWORD dst_unused:UNUSED_PAD src0_sel:WORD_1 src1_sel:WORD_1
    v_add_u32 v6, v6, v6
    v_add_u32 v7, v7, v7
    v_add_u32 v8, v8, v8
    v_add_u32 v9, v9, v9
    ds_write_b16 v6, v104 offset:16384
    ds_write_b16_d16_hi v7, v104 offset:16384
    ds_write_b16 v8, v105 offset:16384
    ds_write_b16_d16_hi v9, v105 offset:16384
    s_cmp_lg_u32 s40, 3
    s_cbranch_scc1 L_p1_kernel_ld_39
    s_mov_b32 s36, 10485760
    buffer_store_dwordx4 v[36:39], v3, s[72:75], s36 offen sc1
    s_branch L_p1_kernel_st_40
L_p1_kernel_ld_39:
    s_add_u32 s35, s33, 49348608
    buffer_load_dwordx4 v[36:39], v1, s[12:15], s35 offen nt
L_p1_kernel_st_40:
    v_mov_b32 v6, 1140817920
    s_waitcnt vmcnt(12)
    v_pk_maximum3_f16 v5, v106, v107, v5
    v_mad_u32_u16 v6, v126, s50, v15 op_sel:[0,0,0,0]
    v_mad_u32_u16 v7, v126, s50, v15 op_sel:[1,0,0,0]
    v_mad_u32_u16 v8, v51, s50, v15 op_sel:[0,0,0,0]
    v_mad_u32_u16 v9, v51, s50, v15 op_sel:[1,0,0,0]
    v_add_u32_sdwa v6, v6, v126 dst_sel:DWORD dst_unused:UNUSED_PAD src0_sel:WORD_1 src1_sel:WORD_0
    v_add_u32_sdwa v7, v7, v126 dst_sel:DWORD dst_unused:UNUSED_PAD src0_sel:WORD_1 src1_sel:WORD_1
    v_add_u32_sdwa v8, v8, v51 dst_sel:DWORD dst_unused:UNUSED_PAD src0_sel:WORD_1 src1_sel:WORD_0
    v_add_u32_sdwa v9, v9, v51 dst_sel:DWORD dst_unused:UNUSED_PAD src0_sel:WORD_1 src1_sel:WORD_1
    v_add_u32 v6, v6, v6
    v_add_u32 v7, v7, v7
    v_add_u32 v8, v8, v8
    v_add_u32 v9, v9, v9
    ds_write_b16 v6, v106 offset:16384
    ds_write_b16_d16_hi v7, v106 offset:16384
    ds_write_b16 v8, v107 offset:16384
    ds_write_b16_d16_hi v9, v107 offset:16384
    v_mov_b32 v6, 1140817920
    s_waitcnt vmcnt(11)
    v_pk_maximum3_f16 v5, v108, v109, v5
    v_mad_u32_u16 v6, v55, s50, v15 op_sel:[0,0,0,0]
    v_mad_u32_u16 v7, v55, s50, v15 op_sel:[1,0,0,0]
    v_mad_u32_u16 v8, v59, s50, v15 op_sel:[0,0,0,0]
    v_mad_u32_u16 v9, v59, s50, v15 op_sel:[1,0,0,0]
    v_add_u32_sdwa v6, v6, v55 dst_sel:DWORD dst_unused:UNUSED_PAD src0_sel:WORD_1 src1_sel:WORD_0
    v_add_u32_sdwa v7, v7, v55 dst_sel:DWORD dst_unused:UNUSED_PAD src0_sel:WORD_1 src1_sel:WORD_1
    v_add_u32_sdwa v8, v8, v59 dst_sel:DWORD dst_unused:UNUSED_PAD src0_sel:WORD_1 src1_sel:WORD_0
    v_add_u32_sdwa v9, v9, v59 dst_sel:DWORD dst_unused:UNUSED_PAD src0_sel:WORD_1 src1_sel:WORD_1
    v_add_u32 v6, v6, v6
    v_add_u32 v7, v7, v7
    v_add_u32 v8, v8, v8
    v_add_u32 v9, v9, v9
    ds_write_b16 v6, v108 offset:16384
    ds_write_b16_d16_hi v7, v108 offset:16384
    ds_write_b16 v8, v109 offset:16384
    ds_write_b16_d16_hi v9, v109 offset:16384
    v_mov_b32 v6, 1140817920
    s_waitcnt vmcnt(10)
    v_pk_maximum3_f16 v5, v110, v111, v5
    v_mad_u32_u16 v6, v63, s50, v15 op_sel:[0,0,0,0]
    v_mad_u32_u16 v7, v63, s50, v15 op_sel:[1,0,0,0]
    v_mad_u32_u16 v8, v67, s50, v15 op_sel:[0,0,0,0]
    v_mad_u32_u16 v9, v67, s50, v15 op_sel:[1,0,0,0]
    v_add_u32_sdwa v6, v6, v63 dst_sel:DWORD dst_unused:UNUSED_PAD src0_sel:WORD_1 src1_sel:WORD_0
    v_add_u32_sdwa v7, v7, v63 dst_sel:DWORD dst_unused:UNUSED_PAD src0_sel:WORD_1 src1_sel:WORD_1
    v_add_u32_sdwa v8, v8, v67 dst_sel:DWORD dst_unused:UNUSED_PAD src0_sel:WORD_1 src1_sel:WORD_0
    v_add_u32_sdwa v9, v9, v67 dst_sel:DWORD dst_unused:UNUSED_PAD src0_sel:WORD_1 src1_sel:WORD_1
    v_add_u32 v6, v6, v6
    v_add_u32 v7, v7, v7
    v_add_u32 v8, v8, v8
    v_add_u32 v9, v9, v9
    ds_write_b16 v6, v110 offset:16384
    ds_write_b16_d16_hi v7, v110 offset:16384
    ds_write_b16 v8, v111 offset:16384
    ds_write_b16_d16_hi v9, v111 offset:16384
    s_cmp_lg_u32 s40, 3
    s_cbranch_scc1 L_p1_kernel_ld_41
    s_mov_b32 s36, 11534336
    buffer_store_dwordx4 v[40:43], v3, s[72:75], s36 offen sc1
    s_branch L_p1_kernel_st_42
L_p1_kernel_ld_41:
    s_add_u32 s35, s33, 53542912
    buffer_load_dwordx4 v[40:43], v1, s[8:11], s35 offen nt
L_p1_kernel_st_42:
    v_mov_b32 v6, 1140817920
    s_waitcnt vmcnt(10)
    v_pk_maximum3_f16 v5, v112, v113, v5
    v_mad_u32_u16 v6, v71, s50, v15 op_sel:[0,0,0,0]
    v_mad_u32_u16 v7, v71, s50, v15 op_sel:[1,0,0,0]
    v_mad_u32_u16 v8, v75, s50, v15 op_sel:[0,0,0,0]
    v_mad_u32_u16 v9, v75, s50, v15 op_sel:[1,0,0,0]
    v_add_u32_sdwa v6, v6, v71 dst_sel:DWORD dst_unused:UNUSED_PAD src0_sel:WORD_1 src1_sel:WORD_0
    v_add_u32_sdwa v7, v7, v71 dst_sel:DWORD dst_unused:UNUSED_PAD src0_sel:WORD_1 src1_sel:WORD_1
    v_add_u32_sdwa v8, v8, v75 dst_sel:DWORD dst_unused:UNUSED_PAD src0_sel:WORD_1 src1_sel:WORD_0
    v_add_u32_sdwa v9, v9, v75 dst_sel:DWORD dst_unused:UNUSED_PAD src0_sel:WORD_1 src1_sel:WORD_1
    v_add_u32 v6, v6, v6
    v_add_u32 v7, v7, v7
    v_add_u32 v8, v8, v8
    v_add_u32 v9, v9, v9
    ds_write_b16 v6, v112 offset:16384
    ds_write_b16_d16_hi v7, v112 offset:16384
    ds_write_b16 v8, v113 offset:16384
    ds_write_b16_d16_hi v9, v113 offset:16384
    v_mov_b32 v6, 1140817920
    s_waitcnt vmcnt(9)
    v_pk_maximum3_f16 v5, v114, v115, v5
    v_mad_u32_u16 v6, v79, s50, v15 op_sel:[0,0,0,0]
    v_mad_u32_u16 v7, v79, s50, v15 op_sel:[1,0,0,0]
    v_mad_u32_u16 v8, v83, s50, v15 op_sel:[0,0,0,0]
    v_mad_u32_u16 v9, v83, s50, v15 op_sel:[1,0,0,0]
    v_add_u32_sdwa v6, v6, v79 dst_sel:DWORD dst_unused:UNUSED_PAD src0_sel:WORD_1 src1_sel:WORD_0
    v_add_u32_sdwa v7, v7, v79 dst_sel:DWORD dst_unused:UNUSED_PAD src0_sel:WORD_1 src1_sel:WORD_1
    v_add_u32_sdwa v8, v8, v83 dst_sel:DWORD dst_unused:UNUSED_PAD src0_sel:WORD_1 src1_sel:WORD_0
    v_add_u32_sdwa v9, v9, v83 dst_sel:DWORD dst_unused:UNUSED_PAD src0_sel:WORD_1 src1_sel:WORD_1
    v_add_u32 v6, v6, v6
    v_add_u32 v7, v7, v7
    v_add_u32 v8, v8, v8
    v_add_u32 v9, v9, v9
    ds_write_b16 v6, v114 offset:16384
    ds_write_b16_d16_hi v7, v114 offset:16384
    ds_write_b16 v8, v115 offset:16384
    ds_write_b16_d16_hi v9, v115 offset:16384
    v_mov_b32 v6, 1140817920
    s_waitcnt vmcnt(8)
    v_pk_maximum3_f16 v5, v116, v117, v5
    v_mad_u32_u16 v6, v87, s50, v15 op_sel:[0,0,0,0]
    v_mad_u32_u16 v7, v87, s50, v15 op_sel:[1,0,0,0]
    v_mad_u32_u16 v8, v91, s50, v15 op_sel:[0,0,0,0]
    v_mad_u32_u16 v9, v91, s50, v15 op_sel:[1,0,0,0]
    v_add_u32_sdwa v6, v6, v87 dst_sel:DWORD dst_unused:UNUSED_PAD src0_sel:WORD_1 src1_sel:WORD_0
    v_add_u32_sdwa v7, v7, v87 dst_sel:DWORD dst_unused:UNUSED_PAD src0_sel:WORD_1 src1_sel:WORD_1
    v_add_u32_sdwa v8, v8, v91 dst_sel:DWORD dst_unused:UNUSED_PAD src0_sel:WORD_1 src1_sel:WORD_0
    v_add_u32_sdwa v9, v9, v91 dst_sel:DWORD dst_unused:UNUSED_PAD src0_sel:WORD_1 src1_sel:WORD_1
    v_add_u32 v6, v6, v6
    v_add_u32 v7, v7, v7
    v_add_u32 v8, v8, v8
    v_add_u32 v9, v9, v9
    ds_write_b16 v6, v116 offset:16384
    ds_write_b16_d16_hi v7, v116 offset:16384
    ds_write_b16 v8, v117 offset:16384
    ds_write_b16_d16_hi v9, v117 offset:16384
    s_cmp_lg_u32 s40, 3
    s_cbranch_scc1 L_p1_kernel_ld_43
    s_mov_b32 s36, 12582912
    buffer_store_dwordx4 v[44:47], v3, s[72:75], s36 offen sc1
    s_branch L_p1_kernel_st_44
L_p1_kernel_ld_43:
    s_add_u32 s35, s33, 53542912
    buffer_load_dwordx4 v[44:47], v1, s[12:15], s35 offen nt
L_p1_kernel_st_44:
    v_mov_b32 v6, 1140817920
    s_mov_b64 exec, s[44:45]
    s_waitcnt vmcnt(8)
    v_pk_maximum3_f16 v5, v118, v119, v5
    s_mov_b64 exec, -1
    s_mov_b64 exec, s[44:45]
    v_mad_u32_u16 v6, v95, s50, v15 op_sel:[0,0,0,0]
    v_mad_u32_u16 v7, v95, s50, v15 op_sel:[1,0,0,0]
    v_mad_u32_u16 v8, v99, s50, v15 op_sel:[0,0,0,0]
    v_mad_u32_u16 v9, v99, s50, v15 op_sel:[1,0,0,0]
    v_add_u32_sdwa v6, v6, v95 dst_sel:DWORD dst_unused:UNUSED_PAD src0_sel:WORD_1 src1_sel:WORD_0
    v_add_u32_sdwa v7, v7, v95 dst_sel:DWORD dst_unused:UNUSED_PAD src0_sel:WORD_1 src1_sel:WORD_1
    v_add_u32_sdwa v8, v8, v99 dst_sel:DWORD dst_unused:UNUSED_PAD src0_sel:WORD_1 src1_sel:WORD_0
    v_add_u32_sdwa v9, v9, v99 dst_sel:DWORD dst_unused:UNUSED_PAD src0_sel:WORD_1 src1_sel:WORD_1
    v_add_u32 v6, v6, v6
    v_add_u32 v7, v7, v7
    v_add_u32 v8, v8, v8
    v_add_u32 v9, v9, v9
    ds_write_b16 v6, v118 offset:16384
    ds_write_b16_d16_hi v7, v118 offset:16384
    ds_write_b16 v8, v119 offset:16384
    ds_write_b16_d16_hi v9, v119 offset:16384
    s_mov_b64 exec, -1
    s_mul_i32 s35, s39, 6144
    v_add_u32 v6, s35, v2
    v_mov_b32 v10, 1140817920
    s_waitcnt lgkmcnt(0)
    s_barrier
    ds_read_b64 v[120:121], v6 offset:23040
    ds_read_b64 v[122:123], v6 offset:16384
    ds_read_b64 v[124:125], v6 offset:16896
    ds_read_b64 v[126:127], v6 offset:17408
    ds_read_b64 v[100:101], v6 offset:17920
    ds_read_b64 v[102:103], v6 offset:18432
    ds_read_b64 v[104:105], v6 offset:18944
    ds_read_b64 v[106:107], v6 offset:19456
    ds_read_b64 v[108:109], v6 offset:19968
    ds_read_b64 v[110:111], v6 offset:20480
    ds_read_b64 v[112:113], v6 offset:20992
    ds_read_b64 v[114:115], v6 offset:21504
    ds_read_b64 v[116:117], v6 offset:22016
    ds_read_b64 v[118:119], v6 offset:22528
    s_add_u32 s32, s32, 256
    s_add_u32 s33, s33, 40960000
    s_add_u32 s34, s34, 20480000
    s_add_u32 s40, s40, 1
    s_cmp_lt_u32 s40, 4
    s_cbranch_scc1 L_p1_loop
    s_cmp_lg_u32 s39, 15
    s_cbranch_scc1 L_p1_kernel_nox_45
    s_waitcnt lgkmcnt(13)
    v_lshlrev_b32 v15, 16, v120
    v_and_b32 v120, 0xffff0000, v120
    v_lshlrev_b32 v121, 16, v121
    v_mul_f32 v15, s41, v15
    v_mul_f32 v120, s41, v120
    v_mul_f32 v121, s41, v121
    v_fract_f32 v15, v15
    v_fract_f32 v120, v120
    v_fract_f32 v121, v121
    v_cos_f32 v15, v15
    v_cos_f32 v120, v120
    v_cos_f32 v121, v121
    v_fmaak_f32 v15, v10, v15, 1262486016
    v_fmaak_f32 v120, v10, v120, 1262486016
    v_fmaak_f32 v121, v10, v121, 1262486016
    v_lshlrev_b32 v15, 22, v15
    v_alignbit_b32 v15, v120, v15, 10
    v_alignbit_b32 v15, v121, v15, 10
    v_xor_b32 v15, 0x80200800, v15
    s_mov_b32 s36, 13631488
    buffer_store_dwordx4 v[12:15], v3, s[20:23], s36 offen sc1
L_p1_kernel_nox_45:
    s_waitcnt lgkmcnt(12)
    v_lshlrev_b32 v75, 16, v122
    v_and_b32 v122, 0xffff0000, v122
    v_lshlrev_b32 v123, 16, v123
    v_mul_f32 v75, s41, v75
    v_mul_f32 v122, s41, v122
    v_mul_f32 v123, s41, v123
    v_fract_f32 v75, v75
    v_fract_f32 v122, v122
    v_fract_f32 v123, v123
    v_cos_f32 v75, v75
    v_cos_f32 v122, v122
    v_cos_f32 v123, v123
    v_fmaak_f32 v75, v10, v75, 1262486016
    v_fmaak_f32 v122, v10, v122, 1262486016
    v_fmaak_f32 v123, v10, v123, 1262486016
    v_lshlrev_b32 v75, 22, v75
    v_alignbit_b32 v75, v122, v75, 10
    v_alignbit_b32 v75, v123, v75, 10
    v_xor_b32 v75, 0x80200800, v75
    s_mov_b32 s36, 0
    buffer_store_dwordx4 v[72:75], v3, s[20:23], s36 offen sc1
    s_waitcnt lgkmcnt(11)
    v_lshlrev_b32 v79, 16, v124
    v_and_b32 v124, 0xffff0000, v124
    v_lshlrev_b32 v125, 16, v125
    v_mul_f32 v79, s41, v79
    v_mul_f32 v124, s41, v124
    v_mul_f32 v125, s41, v125
    v_fract_f32 v79, v79
    v_fract_f32 v124, v124
    v_fract_f32 v125, v125
    v_cos_f32 v79, v79
    v_cos_f32 v124, v124
    v_cos_f32 v125, v125
    v_fmaak_f32 v79, v10, v79, 1262486016
    v_fmaak_f32 v124, v10, v124, 1262486016
    v_fmaak_f32 v125, v10, v125, 1262486016
    v_lshlrev_b32 v79, 22, v79
    v_alignbit_b32 v79, v124, v79, 10
    v_alignbit_b32 v79, v125, v79, 10
    v_xor_b32 v79, 0x80200800, v79
    s_mov_b32 s36, 1048576
    buffer_store_dwordx4 v[76:79], v3, s[20:23], s36 offen sc1
    s_waitcnt lgkmcnt(0)
    v_lshlrev_b32 v51, 16, v126
    v_and_b32 v126, 0xffff0000, v126
    v_lshlrev_b32 v127, 16, v127
    v_mul_f32 v51, s41, v51
    v_mul_f32 v126, s41, v126
    v_mul_f32 v127, s41, v127
    v_fract_f32 v51, v51
    v_fract_f32 v126, v126
    v_fract_f32 v127, v127
    v_cos_f32 v51, v51
    v_cos_f32 v126, v126
    v_cos_f32 v127, v127
    v_fmaak_f32 v51, v10, v51, 1262486016
    v_fmaak_f32 v126, v10, v126, 1262486016
    v_fmaak_f32 v127, v10, v127, 1262486016
    v_lshlrev_b32 v51, 22, v51
    v_alignbit_b32 v51, v126, v51, 10
    v_alignbit_b32 v51, v127, v51, 10
    v_xor_b32 v51, 0x80200800, v51
    s_mov_b32 s36, 2097152
    buffer_store_dwordx4 v[48:51], v3, s[20:23], s36 offen sc1
    v_lshlrev_b32 v83, 16, v100
    v_and_b32 v100, 0xffff0000, v100
    v_lshlrev_b32 v101, 16, v101
    v_mul_f32 v83, s41, v83
    v_mul_f32 v100, s41, v100
    v_mul_f32 v101, s41, v101
    v_fract_f32 v83, v83
    v_fract_f32 v100, v100
    v_fract_f32 v101, v101
    v_cos_f32 v83, v83
    v_cos_f32 v100, v100
    v_cos_f32 v101, v101
    v_fmaak_f32 v83, v10, v83, 1262486016
    v_fmaak_f32 v100, v10, v100, 1262486016
    v_fmaak_f32 v101, v10, v101, 1262486016
    v_lshlrev_b32 v83, 22, v83
    v_alignbit_b32 v83, v100, v83, 10
    v_alignbit_b32 v83, v101, v83, 10
    v_xor_b32 v83, 0x80200800, v83
    s_mov_b32 s36, 3145728
    buffer_store_dwordx4 v[80:83], v3, s[20:23], s36 offen sc1
    v_lshlrev_b32 v55, 16, v102
    v_and_b32 v102, 0xffff0000, v102
    v_lshlrev_b32 v103, 16, v103
    v_mul_f32 v55, s41, v55
    v_mul_f32 v102, s41, v102
    v_mul_f32 v103, s41, v103
    v_fract_f32 v55, v55
    v_fract_f32 v102, v102
    v_fract_f32 v103, v103
    v_cos_f32 v55, v55
    v_cos_f32 v102, v102
    v_cos_f32 v103, v103
    v_fmaak_f32 v55, v10, v55, 1262486016
    v_fmaak_f32 v102, v10, v102, 1262486016
    v_fmaak_f32 v103, v10, v103, 1262486016
    v_lshlrev_b32 v55, 22, v55
    v_alignbit_b32 v55, v102, v55, 10
    v_alignbit_b32 v55, v103, v55, 10
    v_xor_b32 v55, 0x80200800, v55
    s_mov_b32 s36, 4194304
    buffer_store_dwordx4 v[52:55], v3, s[20:23], s36 offen sc1
    v_lshlrev_b32 v87, 16, v104
    v_and_b32 v104, 0xffff0000, v104
    v_lshlrev_b32 v105, 16, v105
    v_mul_f32 v87, s41, v87
    v_mul_f32 v104, s41, v104
    v_mul_f32 v105, s41, v105
    v_fract_f32 v87, v87
    v_fract_f32 v104, v104
    v_fract_f32 v105, v105
    v_cos_f32 v87, v87
    v_cos_f32 v104, v104
    v_cos_f32 v105, v105
    v_fmaak_f32 v87, v10, v87, 1262486016
    v_fmaak_f32 v104, v10, v104, 1262486016
    v_fmaak_f32 v105, v10, v105, 1262486016
    v_lshlrev_b32 v87, 22, v87
    v_alignbit_b32 v87, v104, v87, 10
    v_alignbit_b32 v87, v105, v87, 10
    v_xor_b32 v87, 0x80200800, v87
    s_mov_b32 s36, 5242880
    buffer_store_dwordx4 v[84:87], v3, s[20:23], s36 offen sc1
    v_lshlrev_b32 v59, 16, v106
    v_and_b32 v106, 0xffff0000, v106
    v_lshlrev_b32 v107, 16, v107
    v_mul_f32 v59, s41, v59
    v_mul_f32 v106, s41, v106
    v_mul_f32 v107, s41, v107
    v_fract_f32 v59, v59
    v_fract_f32 v106, v106
    v_fract_f32 v107, v107
    v_cos_f32 v59, v59
    v_cos_f32 v106, v106
    v_cos_f32 v107, v107
    v_fmaak_f32 v59, v10, v59, 1262486016
    v_fmaak_f32 v106, v10, v106, 1262486016
    v_fmaak_f32 v107, v10, v107, 1262486016
    v_lshlrev_b32 v59, 22, v59
    v_alignbit_b32 v59, v106, v59, 10
    v_alignbit_b32 v59, v107, v59, 10
    v_xor_b32 v59, 0x80200800, v59
    s_mov_b32 s36, 6291456
    buffer_store_dwordx4 v[56:59], v3, s[20:23], s36 offen sc1
    v_lshlrev_b32 v91, 16, v108
    v_and_b32 v108, 0xffff0000, v108
    v_lshlrev_b32 v109, 16, v109
    v_mul_f32 v91, s41, v91
    v_mul_f32 v108, s41, v108
    v_mul_f32 v109, s41, v109
    v_fract_f32 v91, v91
    v_fract_f32 v108, v108
    v_fract_f32 v109, v109
    v_cos_f32 v91, v91
    v_cos_f32 v108, v108
    v_cos_f32 v109, v109
    v_fmaak_f32 v91, v10, v91, 1262486016
    v_fmaak_f32 v108, v10, v108, 1262486016
    v_fmaak_f32 v109, v10, v109, 1262486016
    v_lshlrev_b32 v91, 22, v91
    v_alignbit_b32 v91, v108, v91, 10
    v_alignbit_b32 v91, v109, v91, 10
    v_xor_b32 v91, 0x80200800, v91
    s_mov_b32 s36, 7340032
    buffer_store_dwordx4 v[88:91], v3, s[20:23], s36 offen sc1
    v_lshlrev_b32 v63, 16, v110
    v_and_b32 v110, 0xffff0000, v110
    v_lshlrev_b32 v111, 16, v111
    v_mul_f32 v63, s41, v63
    v_mul_f32 v110, s41, v110
    v_mul_f32 v111, s41, v111
    v_fract_f32 v63, v63
    v_fract_f32 v110, v110
    v_fract_f32 v111, v111
    v_cos_f32 v63, v63
    v_cos_f32 v110, v110
    v_cos_f32 v111, v111
    v_fmaak_f32 v63, v10, v63, 1262486016
    v_fmaak_f32 v110, v10, v110, 1262486016
    v_fmaak_f32 v111, v10, v111, 1262486016
    v_lshlrev_b32 v63, 22, v63
    v_alignbit_b32 v63, v110, v63, 10
    v_alignbit_b32 v63, v111, v63, 10
    v_xor_b32 v63, 0x80200800, v63
    s_mov_b32 s36, 8388608
    buffer_store_dwordx4 v[60:63], v3, s[20:23], s36 offen sc1
    v_lshlrev_b32 v95, 16, v112
    v_and_b32 v112, 0xffff0000, v112
    v_lshlrev_b32 v113, 16, v113
    v_mul_f32 v95, s41, v95
    v_mul_f32 v112, s41, v112
    v_mul_f32 v113, s41, v113
    v_fract_f32 v95, v95
    v_fract_f32 v112, v112
    v_fract_f32 v113, v113
    v_cos_f32 v95, v95
    v_cos_f32 v112, v112
    v_cos_f32 v113, v113
    v_fmaak_f32 v95, v10, v95, 1262486016
    v_fmaak_f32 v112, v10, v112, 1262486016
    v_fmaak_f32 v113, v10, v113, 1262486016
    v_lshlrev_b32 v95, 22, v95
    v_alignbit_b32 v95, v112, v95, 10
    v_alignbit_b32 v95, v113, v95, 10
    v_xor_b32 v95, 0x80200800, v95
    s_mov_b32 s36, 9437184
    buffer_store_dwordx4 v[92:95], v3, s[20:23], s36 offen sc1
    v_lshlrev_b32 v67, 16, v114
    v_and_b32 v114, 0xffff0000, v114
    v_lshlrev_b32 v115, 16, v115
    v_mul_f32 v67, s41, v67
    v_mul_f32 v114, s41, v114
    v_mul_f32 v115, s41, v115
    v_fract_f32 v67, v67
    v_fract_f32 v114, v114
    v_fract_f32 v115, v115
    v_cos_f32 v67, v67
    v_cos_f32 v114, v114
    v_cos_f32 v115, v115
    v_fmaak_f32 v67, v10, v67, 1262486016
    v_fmaak_f32 v114, v10, v114, 1262486016
    v_fmaak_f32 v115, v10, v115, 1262486016
    v_lshlrev_b32 v67, 22, v67
    v_alignbit_b32 v67, v114, v67, 10
    v_alignbit_b32 v67, v115, v67, 10
    v_xor_b32 v67, 0x80200800, v67
    s_mov_b32 s36, 10485760
    buffer_store_dwordx4 v[64:67], v3, s[20:23], s36 offen sc1
    v_lshlrev_b32 v99, 16, v116
    v_and_b32 v116, 0xffff0000, v116
    v_lshlrev_b32 v117, 16, v117
    v_mul_f32 v99, s41, v99
    v_mul_f32 v116, s41, v116
    v_mul_f32 v117, s41, v117
    v_fract_f32 v99, v99
    v_fract_f32 v116, v116
    v_fract_f32 v117, v117
    v_cos_f32 v99, v99
    v_cos_f32 v116, v116
    v_cos_f32 v117, v117
    v_fmaak_f32 v99, v10, v99, 1262486016
    v_fmaak_f32 v116, v10, v116, 1262486016
    v_fmaak_f32 v117, v10, v117, 1262486016
    v_lshlrev_b32 v99, 22, v99
    v_alignbit_b32 v99, v116, v99, 10
    v_alignbit_b32 v99, v117, v99, 10
    v_xor_b32 v99, 0x80200800, v99
    s_mov_b32 s36, 11534336
    buffer_store_dwordx4 v[96:99], v3, s[20:23], s36 offen sc1
    v_lshlrev_b32 v71, 16, v118
    v_and_b32 v118, 0xffff0000, v118
    v_lshlrev_b32 v119, 16, v119
    v_mul_f32 v71, s41, v71
    v_mul_f32 v118, s41, v118
    v_mul_f32 v119, s41, v119
    v_fract_f32 v71, v71
    v_fract_f32 v118, v118
    v_fract_f32 v119, v119
    v_cos_f32 v71, v71
    v_cos_f32 v118, v118
    v_cos_f32 v119, v119
    v_fmaak_f32 v71, v10, v71, 1262486016
    v_fmaak_f32 v118, v10, v118, 1262486016
    v_fmaak_f32 v119, v10, v119, 1262486016
    v_lshlrev_b32 v71, 22, v71
    v_alignbit_b32 v71, v118, v71, 10
    v_alignbit_b32 v71, v119, v71, 10
    v_xor_b32 v71, 0x80200800, v71
    s_mov_b32 s36, 12582912
    buffer_store_dwordx4 v[68:71], v3, s[20:23], s36 offen sc1
    v_and_b32 v6, 0x7c007c00, v5
    v_add_u32 v6, 0x04000400, v6
    v_and_b32 v6, 0x80008000, v6
    v_cmp_ne_u32 vcc, 0, v6
    s_lshl_b32 s35, s39, 4
    s_add_u32 s35, s35, 160328
    v_mov_b32 v10, s35
    s_cmp_lg_u64 vcc, 0
    s_cselect_b32 s36, 1, s55
    v_mov_b32 v11, s36
    ds_write_b32 v10, v11
    s_waitcnt lgkmcnt(0)
    s_barrier
    s_cmp_lg_u32 s39, 0
    s_cbranch_scc1 L_p1_end
    v_and_b32 v6, 15, v0
    v_lshlrev_b32 v6, 4, v6
    v_add_u32 v6, 160320, v6
    ds_read_b128 v[8:11], v6
    s_waitcnt lgkmcnt(0)
    s_nop 1
    v_max_u32_dpp v8, v8, v8 row_shr:1 row_mask:0xf bank_mask:0xf bound_ctrl:0
    s_nop 1
    v_max_u32_dpp v8, v8, v8 row_shr:2 row_mask:0xf bank_mask:0xf bound_ctrl:0
    s_nop 1
    v_max_u32_dpp v8, v8, v8 row_shr:4 row_mask:0xf bank_mask:0xf bound_ctrl:0
    s_nop 1
    v_max_u32_dpp v8, v8, v8 row_shr:8 row_mask:0xf bank_mask:0xf bound_ctrl:0
    s_nop 1
    v_add_f32_dpp v9, v9, v9 row_shr:1 row_mask:0xf bank_mask:0xf bound_ctrl:0
    s_nop 1
    v_add_f32_dpp v9, v9, v9 row_shr:2 row_mask:0xf bank_mask:0xf bound_ctrl:0
    s_nop 1
    v_add_f32_dpp v9, v9, v9 row_shr:4 row_mask:0xf bank_mask:0xf bound_ctrl:0
    s_nop 1
    v_add_f32_dpp v9, v9, v9 row_shr:8 row_mask:0xf bank_mask:0xf bound_ctrl:0
    s_nop 1
    v_or_b32_dpp v10, v10, v10 row_shr:1 row_mask:0xf bank_mask:0xf bound_ctrl:0
    s_nop 1
    v_or_b32_dpp v10, v10, v10 row_shr:2 row_mask:0xf bank_mask:0xf bound_ctrl:0
    s_nop 1
    v_or_b32_dpp v10, v10, v10 row_shr:4 row_mask:0xf bank_mask:0xf bound_ctrl:0
    s_nop 1
    v_or_b32_dpp v10, v10, v10 row_shr:8 row_mask:0xf bank_mask:0xf bound_ctrl:0
    s_lshl_b32 s35, s2, 3
    s_mov_b32 s26, 8540160
    s_add_u32 s35, s35, 8519680
    v_mov_b32 v6, 0
    v_lshl_or_b32 v8, v10, 16, v8
    s_mov_b64 exec, 0x8000
    buffer_store_dwordx2 v[8:9], v6, s[24:27], s35 offen
    s_lshl_b32 s35, s2, 8
    s_add_u32 s35, s35, 8523776
    buffer_store_dword v6, v6, s[24:27], s35 offen
L_p1_end:
    s_endpgm
.globl p2_kernel
.p2align 8
.type p2_kernel,@function
p2_kernel:
    s_cmp_ge_u32 s2, 256
    s_cbranch_scc1 L_p2_end
    s_load_dwordx2 s[4:5], s[0:1], 104
    s_load_dwordx2 s[100:101], s[0:1], 24
    s_load_dwordx2 s[8:9], s[0:1], 0
    s_load_dwordx2 s[30:31], s[0:1], 40
    s_load_dwordx4 s[32:35], s[0:1], 56
    s_load_dwordx4 s[36:39], s[0:1], 72
    s_and_b32 s14, s2, 7
    s_lshr_b32 s49, s2, 3
    s_and_b32 s3, s14, 1
    s_lshl_b32 s3, s3, 5
    s_add_u32 s3, s3, s49
    s_lshr_b32 s12, s14, 1
    v_lshrrev_b32 v108, 6, v0
    v_lshlrev_b32 v1, 4, v0
    v_and_b32 v109, 63, v0
    v_readfirstlane_b32 s13, v108
    v_lshlrev_b32 v111, 4, v109
    v_lshrrev_b32 v110, 2, v109
    v_mul_u32_u24 v110, 8256, v110
    v_add_u32 v110, v110, v111
    s_mul_i32 s14, s12, 65
    s_add_u32 s14, s14, s3
    s_lshl_b32 s14, s14, 5
    s_mul_i32 s15, s13, 532480
    s_add_u32 s14, s14, s15
    s_add_u32 s25, s14, 0
    s_mul_i32 s22, s12, 1280000
    s_mov_b32 s2, 0
    s_waitcnt lgkmcnt(0)
    s_mov_b32 s6, 655360000
    s_mov_b32 s7, 0x00020000
    s_add_u32 s10, s22, 1280000
    s_mov_b32 s11, 0x00020000
    s_add_u32 s15, s25, 0
    buffer_load_dwordx4 v[28:31], v110, s[4:7], s15 offen
    s_add_u32 s15, s25, 133120
    buffer_load_dwordx4 v[32:35], v110, s[4:7], s15 offen
    s_add_u32 s15, s25, 266240
    buffer_load_dwordx4 v[36:39], v110, s[4:7], s15 offen
    s_add_u32 s15, s25, 399360
    buffer_load_dwordx4 v[40:43], v110, s[4:7], s15 offen
    s_load_dwordx4 s[40:43], s[30:31], 0
    s_load_dwordx16 s[52:67], s[32:33], 0
    s_load_dwordx16 s[68:83], s[34:35], 0
    s_load_dwordx8 s[84:91], s[36:37], 0
    s_load_dwordx8 s[92:99], s[38:39], 0
    v_mov_b32 v52, 0x100
    s_cmp_lg_u32 s13, 0
    s_cbranch_scc1 L_p2_noann
    s_lshl_b32 s14, s3, 8
    s_add_u32 s14, s14, 8523776
    s_mov_b64 exec, 1
    buffer_atomic_add v52, off, s[4:7], s14
    s_mov_b64 exec, -1
L_p2_noann:
    s_add_u32 s14, s22, 0
    buffer_load_dwordx4 v[88:91], v1, s[8:11], s14 offen
    s_add_u32 s14, s22, 16384
    buffer_load_dwordx4 v[92:95], v1, s[8:11], s14 offen
    s_add_u32 s14, s22, 32768
    buffer_load_dwordx4 v[96:99], v1, s[8:11], s14 offen
    s_add_u32 s14, s22, 49152
    buffer_load_dwordx4 v[100:103], v1, s[8:11], s14 offen
    s_add_u32 s14, s22, 65536
    buffer_load_dwordx4 v[104:107], v1, s[8:11], s14 offen
    s_mov_b32 s15, 8519680
    buffer_load_dwordx4 v[80:83], v111, s[4:7], s15 offen offset:0
    buffer_load_dwordx4 v[84:87], v111, s[4:7], s15 offen offset:1024
    v_lshlrev_b32 v2, 10, v109
    v_mov_b32 v50, 21845
    v_add_u32 v3, 80000, v1
    v_add_u32 v124, 145536, v1
    v_add_u32 v113, 65536, v1
    v_mov_b32 v112, 0x7f000000
    v_cmp_gt_u32 vcc, 904, v0
    s_mul_i32 s19, s13, 240
    s_add_u32 s19, s19, 160000
    v_cndmask_b32 v124, v112, v124, vcc
    v_cndmask_b32 v113, v112, v113, vcc
    v_lshl_add_u32 v6, v109, 2, s19
    v_lshl_add_u32 v126, v109, 1, s19
    v_cmp_gt_u32 vcc, 10, v109
    s_lshl_b32 s27, s13, 16
    s_mov_b32 s23, 1024
    v_cndmask_b32 v6, v112, v6, vcc
    s_add_u32 s44, s4, 4194304
    s_addc_u32 s45, s5, 1048576
    s_mov_b32 s46, 14024704
    s_mov_b32 s47, 0x00020000
    s_mov_b32 s18, 80000
    s_and_b32 s50, s3, 1
    s_lshl_b32 s50, s50, 18
    s_sub_u32 s18, s18, s50
    s_sub_u32 s50, 4294836224, s50
    v_lshlrev_b32 v116, 3, v0
    v_and_b32 v116, 16, v116
    v_and_b32 v117, 1, v0
    v_lshl_or_b32 v116, v117, 5, v116
    v_mov_b32 v58, 0x3f80
    v_mov_b32 v59, 0
    v_lshlrev_b64 v[58:59], v116, v[58:59]
    v_mov_b32 v4, 0
    v_mov_b32 v5, 0
    v_mov_b32 v114, 0xff00
    v_bfe_u32 v127, v0, 0, 1
    v_mul_u32_u24 v127, 40, v127
    v_add_u32 v127, s19, v127
    ds_write2_b32 v6, v5, v5 offset0:34 offset1:44
    ds_write_b16 v126, v114 offset:2
    v_mov_b32 v44, 1073758208
    v_mov_b32 v45, 1073758208
    v_mov_b32 v46, 1073758208
    v_mov_b32 v47, 1073758208
    v_mov_b32 v48, 1073758208
    v_mov_b32 v49, 1073758208
    ds_write_b128 v113, v[44:47]
    v_lshrrev_b32 v115, 4, v109
    v_mul_u32_u24 v115, 15360, v115
    v_lshl_add_u32 v115, v109, 6, v115
    v_lshl_add_u32 v115, v108, 10, v115
    s_waitcnt lgkmcnt(0)
    v_mov_b32 v53, s40
    v_mov_b32 v54, s41
    v_mov_b32 v56, s42
    v_mov_b32 v57, s43
    s_mov_b32 s40, 20987904
    s_mov_b32 s41, 21031594
    s_pack_ll_b32_b16 s14, s52, s54
    s_pack_hh_b32_b16 s15, s52, s54
    s_pack_ll_b32_b16 s54, s53, s55
    s_pack_hh_b32_b16 s55, s53, s55
    s_mov_b32 s52, s14
    s_mov_b32 s53, s15
    s_pack_ll_b32_b16 s14, s56, s58
    s_pack_hh_b32_b16 s15, s56, s58
    s_pack_ll_b32_b16 s58, s57, s59
    s_pack_hh_b32_b16 s59, s57, s59
    s_mov_b32 s56, s14
    s_mov_b32 s57, s15
    s_pack_ll_b32_b16 s14, s60, s62
    s_pack_hh_b32_b16 s15, s60, s62
    s_pack_ll_b32_b16 s62, s61, s63
    s_pack_hh_b32_b16 s63, s61, s63
    s_mov_b32 s60, s14
    s_mov_b32 s61, s15
    s_pack_ll_b32_b16 s14, s64, s66
    s_pack_hh_b32_b16 s15, s64, s66
    s_pack_ll_b32_b16 s66, s65, s67
    s_pack_hh_b32_b16 s67, s65, s67
    s_mov_b32 s64, s14
    s_mov_b32 s65, s15
    s_pack_ll_b32_b16 s14, s68, s70
    s_pack_hh_b32_b16 s15, s68, s70
    s_pack_ll_b32_b16 s70, s69, s71
    s_pack_hh_b32_b16 s71, s69, s71
    s_mov_b32 s68, s14
    s_mov_b32 s69, s15
    s_pack_ll_b32_b16 s14, s72, s74
    s_pack_hh_b32_b16 s15, s72, s74
    s_pack_ll_b32_b16 s74, s73, s75
    s_pack_hh_b32_b16 s75, s73, s75
    s_mov_b32 s72, s14
    s_mov_b32 s73, s15
    s_pack_ll_b32_b16 s14, s76, s78
    s_pack_hh_b32_b16 s15, s76, s78
    s_pack_ll_b32_b16 s78, s77, s79
    s_pack_hh_b32_b16 s79, s77, s79
    s_mov_b32 s76, s14
    s_mov_b32 s77, s15
    s_pack_ll_b32_b16 s14, s80, s82
    s_pack_hh_b32_b16 s15, s80, s82
    s_pack_ll_b32_b16 s82, s81, s83
    s_pack_hh_b32_b16 s83, s81, s83
    s_mov_b32 s80, s14
    s_mov_b32 s81, s15
    s_waitcnt vmcnt(10)
    ds_write_b128 v1, v[28:31] offset:0
    s_waitcnt vmcnt(9)
    ds_write_b128 v1, v[32:35] offset:16384
    s_waitcnt vmcnt(8)
    ds_write_b128 v1, v[36:39] offset:32768
    s_waitcnt vmcnt(7)
    ds_write_b128 v1, v[40:43] offset:49152
    ds_read_b128 v[28:31], v115 offset:0
    ds_read_b128 v[36:39], v115 offset:32
    ds_read_b128 v[32:35], v115 offset:16
    ds_read_b128 v[40:43], v115 offset:48
    ds_write_b128 v1, v[44:47] offset:0
    ds_write_b128 v1, v[44:47] offset:16384
    ds_write_b128 v1, v[44:47] offset:32768
    ds_write_b128 v1, v[44:47] offset:49152
    s_waitcnt lgkmcnt(6)
    v_mad_u32_u16 v108, v28, v50, s40 op_sel:[0,0,0,0]
    v_mad_u32_u16 v109, v36, v50, s41 op_sel:[0,0,0,0]
    v_sub_u32_sdwa v110, v109, v108 dst_sel:DWORD dst_unused:UNUSED_PAD src0_sel:WORD_1 src1_sel:WORD_1
    s_nop 1
    v_add_u32_dpp v110, v110, v110 row_shr:1 row_mask:0xf bank_mask:0xf bound_ctrl:0
    s_nop 1
    v_add_u32_dpp v110, v110, v110 row_shr:2 row_mask:0xf bank_mask:0xf bound_ctrl:0
    s_nop 1
    v_add_u32_dpp v110, v110, v110 row_shr:4 row_mask:0xf bank_mask:0xf bound_ctrl:0
    s_nop 1
    v_add_u32_dpp v110, v110, v110 row_shr:8 row_mask:0xf bank_mask:0xf bound_ctrl:0
    s_nop 1
    v_add_u32_dpp v110, v110, v110 row_bcast:15 row_mask:0xa bank_mask:0xf
    s_nop 1
    v_add_u32_dpp v110, v110, v110 row_bcast:31 row_mask:0xc bank_mask:0xf
    v_sub_u32_sdwa v109, v109, v110 dst_sel:DWORD dst_unused:UNUSED_PAD src0_sel:WORD_1 src1_sel:DWORD
    v_readlane_b32 s29, v110, 63
    v_add_u32 v110, -1, v110
    ds_write_b16 v126, v109
    v_lshlrev_b32_e64 v111, v110, 1
    v_lshrrev_b32 v110, 5, v110
    s_cmp_gt_u32 s29, 320
    s_cselect_b32 s2, 1, s2
    v_lshl_add_u32 v110, v110, 2, v127
    s_cselect_b64 exec, 0, -1
    ds_or_b32 v110, v111 offset:136
    s_mov_b64 exec, -1
    ds_wrxchg2_rtn_b32 v[108:109], v6, v5, v5 offset0:34 offset1:44
    s_waitcnt lgkmcnt(0)
    v_or_b32 v7, v108, v109
    s_nop 0
    v_readlane_b32 s30, v7, 0
    v_readlane_b32 s31, v7, 1
    v_readlane_b32 s32, v7, 2
    v_readlane_b32 s33, v7, 3
    v_readlane_b32 s34, v7, 4
    v_readlane_b32 s35, v7, 5
    v_readlane_b32 s36, v7, 6
    v_readlane_b32 s37, v7, 7
    s_mov_b32 s25, s19
    s_mov_b32 s26, s27
    s_mov_b32 s51, s28
    s_mov_b32 s28, s29
    v_mbcnt_lo_u32_b32 v8, s30, 0
    v_mbcnt_hi_u32_b32 v8, s31, v8
    s_bcnt1_i32_b64 s14, s[30:31]
    v_lshl_add_u32 v9, v8, 1, s25
    ds_read_u16 v9, v9
    s_add_u32 s30, s26, 0
    s_lshl1_add_u32 s25, s14, s25
    s_lshl_b32 s14, s14, 10
    s_add_u32 s26, s26, s14
    v_mbcnt_lo_u32_b32 v12, s32, 0
    v_mbcnt_hi_u32_b32 v12, s33, v12
    s_bcnt1_i32_b64 s14, s[32:33]
    v_lshl_add_u32 v13, v12, 1, s25
    ds_read_u16 v13, v13
    s_add_u32 s32, s26, 1048576
    s_lshl1_add_u32 s25, s14, s25
    s_lshl_b32 s14, s14, 10
    s_add_u32 s26, s26, s14
    v_mbcnt_lo_u32_b32 v16, s34, 0
    v_mbcnt_hi_u32_b32 v16, s35, v16
    s_bcnt1_i32_b64 s14, s[34:35]
    v_lshl_add_u32 v17, v16, 1, s25
    ds_read_u16 v17, v17
    s_add_u32 s34, s26, 2097152
    s_lshl1_add_u32 s25, s14, s25
    s_lshl_b32 s14, s14, 10
    s_add_u32 s26, s26, s14
    v_mbcnt_lo_u32_b32 v20, s36, 0
    v_mbcnt_hi_u32_b32 v20, s37, v20
    s_bcnt1_i32_b64 s14, s[36:37]
    v_lshl_add_u32 v21, v20, 1, s25
    ds_read_u16 v21, v21
    s_add_u32 s36, s26, 3145728
    s_lshl1_add_u32 s25, s14, s25
    s_lshl_b32 s14, s14, 10
    s_add_u32 s26, s26, s14
    s_waitcnt lgkmcnt(3)
    v_mad_u32_u16 v9, v9, s23, v2
    v_pk_lshrrev_b16 v9, 10, v9 op_sel_hi:[1,1]
    v_lshl_add_u32 v8, v8, 6, v9
    buffer_load_dwordx4 v[8:11], v8, s[44:47], s30 idxen
    s_waitcnt lgkmcnt(2)
    v_mad_u32_u16 v13, v13, s23, v2
    v_pk_lshrrev_b16 v13, 10, v13 op_sel_hi:[1,1]
    v_lshl_add_u32 v12, v12, 6, v13
    buffer_load_dwordx4 v[12:15], v12, s[44:47], s32 idxen
    s_waitcnt lgkmcnt(1)
    v_mad_u32_u16 v17, v17, s23, v2
    v_pk_lshrrev_b16 v17, 10, v17 op_sel_hi:[1,1]
    v_lshl_add_u32 v16, v16, 6, v17
    buffer_load_dwordx4 v[16:19], v16, s[44:47], s34 idxen
    s_waitcnt lgkmcnt(0)
    v_mad_u32_u16 v21, v21, s23, v2
    v_pk_lshrrev_b16 v21, 10, v21 op_sel_hi:[1,1]
    v_lshl_add_u32 v20, v20, 6, v21
    buffer_load_dwordx4 v[20:23], v20, s[44:47], s36 idxen
    s_cmp_le_u32 s28, 256
    s_cbranch_scc1 L_p2_kernel_noopt_1
    v_readlane_b32 s38, v7, 8
    v_readlane_b32 s39, v7, 9
    s_nop 1
    v_mbcnt_lo_u32_b32 v51, s38, 0
    v_mbcnt_hi_u32_b32 v51, s39, v51
    s_bcnt1_i32_b64 s14, s[38:39]
    v_lshl_add_u32 v55, v51, 1, s25
    ds_read_u16 v55, v55
    s_add_u32 s38, s26, 4194304
    s_lshl1_add_u32 s25, s14, s25
    s_lshl_b32 s14, s14, 10
    s_add_u32 s26, s26, s14
    s_waitcnt lgkmcnt(0)
    v_mad_u32_u16 v55, v55, s23, v2
    v_pk_lshrrev_b16 v55, 10, v55 op_sel_hi:[1,1]
    v_lshl_add_u32 v51, v51, 6, v55
    buffer_load_dwordx4 v[24:27], v51, s[44:47], s38 idxen
L_p2_kernel_noopt_1:
    s_waitcnt vmcnt(6)
    ds_write_b128 v3, v[88:91] offset:0
    ds_write_b128 v3, v[92:95] offset:16384
    ds_write_b128 v3, v[96:99] offset:32768
    ds_write_b128 v3, v[100:103] offset:49152
    ds_write_b128 v124, v[104:107] offset:0
    s_waitcnt vmcnt(4)
    v_max3_u32 v64, v80, v82, v84
    v_add_f32 v65, v81, v83
    v_add_f32 v66, v85, v87
    v_max_u32 v64, v64, v86
    v_add_f32 v65, v65, v66
    v_cmp_lt_u32 vcc, 0xffff, v64
    s_nop 1
    v_max_u32_dpp v64, v64, v64 row_shr:1 row_mask:0xf bank_mask:0xf bound_ctrl:0
    s_nop 1
    v_max_u32_dpp v64, v64, v64 row_shr:2 row_mask:0xf bank_mask:0xf bound_ctrl:0
    s_nop 1
    v_max_u32_dpp v64, v64, v64 row_shr:4 row_mask:0xf bank_mask:0xf bound_ctrl:0
    s_nop 1
    v_max_u32_dpp v64, v64, v64 row_shr:8 row_mask:0xf bank_mask:0xf bound_ctrl:0
    s_nop 1
    v_max_u32_dpp v64, v64, v64 row_bcast:15 row_mask:0xa bank_mask:0xf
    s_nop 1
    v_max_u32_dpp v64, v64, v64 row_bcast:31 row_mask:0xc bank_mask:0xf
    s_nop 1
    v_add_f32_dpp v65, v65, v65 row_shr:1 row_mask:0xf bank_mask:0xf bound_ctrl:0
    s_nop 1
    v_add_f32_dpp v65, v65, v65 row_shr:2 row_mask:0xf bank_mask:0xf bound_ctrl:0
    s_nop 1
    v_add_f32_dpp v65, v65, v65 row_shr:4 row_mask:0xf bank_mask:0xf bound_ctrl:0
    s_nop 1
    v_add_f32_dpp v65, v65, v65 row_shr:8 row_mask:0xf bank_mask:0xf bound_ctrl:0
    s_nop 1
    v_add_f32_dpp v65, v65, v65 row_bcast:15 row_mask:0xa bank_mask:0xf
    s_nop 1
    v_add_f32_dpp v65, v65, v65 row_bcast:31 row_mask:0xc bank_mask:0xf
    s_cmp_lg_u64 vcc, 0
    s_cselect_b32 s2, 1, s2
    v_lshlrev_b32 v64, 16, v64
    v_mul_f32 v66, 936490775, v65
    v_mul_f32 v65, 928531664, v65
    v_cmp_nle_f32 vcc, v64, v66
    v_max_u32 v64, v64, v65
    s_nop 0
    v_readlane_b32 s14, v64, 63
    s_bitcmp1_b32 vcc_hi, 31
    s_cselect_b32 s2, 1, s2
    s_lshr_b32 s14, s14, 23
    s_add_u32 s14, s14, 1
    s_cmp_lt_u32 s14, 40
    s_cselect_b32 s2, 1, s2
    s_cmp_gt_u32 s14, 230
    s_cselect_b32 s2, 1, s2
    s_sub_u32 s48, s14, 14
    s_lshl_b32 s48, s48, 23
    s_add_u32 s16, s48, 272629760
    s_lshr_b32 s15, s16, 16
    s_sub_u32 s15, 0x10000, s15
    s_add_u32 s20, s16, s15
    s_sub_u32 s17, s20, 1
    s_mov_b32 s21, s17
    s_or_b32 s48, s48, 16416
    s_sub_u32 s14, s14, 40
    s_cmp_gt_u32 s14, 190
    s_cselect_b32 s48, 0, s48
    s_waitcnt lgkmcnt(0)
    s_barrier
    s_add_u32 s14, s22, 80000
    buffer_load_dwordx4 v[88:91], v1, s[8:11], s14 offen
    s_add_u32 s14, s22, 96384
    buffer_load_dwordx4 v[92:95], v1, s[8:11], s14 offen
    v_mad_u32_u16 v108, v28, v50, s40 op_sel:[1,0,0,0]
    v_mad_u32_u16 v109, v36, v50, s41 op_sel:[1,0,0,0]
    v_sub_u32_sdwa v110, v109, v108 dst_sel:DWORD dst_unused:UNUSED_PAD src0_sel:WORD_1 src1_sel:WORD_1
    s_nop 1
    v_add_u32_dpp v110, v110, v110 row_shr:1 row_mask:0xf bank_mask:0xf bound_ctrl:0
    s_nop 1
    v_add_u32_dpp v110, v110, v110 row_shr:2 row_mask:0xf bank_mask:0xf bound_ctrl:0
    s_nop 1
    v_add_u32_dpp v110, v110, v110 row_shr:4 row_mask:0xf bank_mask:0xf bound_ctrl:0
    s_nop 1
    v_add_u32_dpp v110, v110, v110 row_shr:8 row_mask:0xf bank_mask:0xf bound_ctrl:0
    s_nop 1
    v_add_u32_dpp v110, v110, v110 row_bcast:15 row_mask:0xa bank_mask:0xf
    s_nop 1
    v_add_u32_dpp v110, v110, v110 row_bcast:31 row_mask:0xc bank_mask:0xf
    v_sub_u32_sdwa v109, v109, v110 dst_sel:DWORD dst_unused:UNUSED_PAD src0_sel:WORD_1 src1_sel:DWORD
    v_readlane_b32 s29, v110, 63
    v_add_u32 v110, -1, v110
    ds_write_b16 v126, v109
    v_lshlrev_b32_e64 v111, v110, 1
    v_lshrrev_b32 v110, 5, v110
    s_cmp_gt_u32 s29, 320
    s_cselect_b32 s2, 1, s2
    v_lshl_add_u32 v110, v110, 2, v127
    s_cselect_b64 exec, 0, -1
    ds_or_b32 v110, v111 offset:136
    s_mov_b64 exec, -1
    ds_wrxchg2_rtn_b32 v[108:109], v6, v5, v5 offset0:34 offset1:44
    s_mov_b32 s24, 0
L_p2_loop:
    s_add_u32 s22, s22, 80000
    s_lshl_b32 s14, s13, 4
    s_or_b32 s14, s14, s24
    s_cmp_lg_u32 s14, 5
    s_cbranch_scc1 L_p2_nost
    v_mov_b32 v52, 0
    s_lshl_b32 s14, s3, 8
    s_add_u32 s14, s14, 8523776
    s_mov_b64 exec, 1
    buffer_atomic_add v52, off, s[4:7], s14 sc0
    s_mov_b64 exec, -1
L_p2_nost:
    s_waitcnt vmcnt(5)
    v_mad_u32_u16 v64, v8, 8, s18
    v_mad_u32_u16 v66, v9, 8, s18
    v_mad_u32_u16 v68, v10, 8, s18
    ds_read_b64 v[64:65], v64
    ds_read_b64 v[66:67], v66
    ds_read_b64 v[68:69], v68
    s_add_u32 s14, s22, 32768
    buffer_load_dwordx4 v[96:99], v1, s[8:11], s14 offen
    s_waitcnt vmcnt(5)
    v_mad_u32_u16 v70, v12, 8, s18
    v_mad_u32_u16 v72, v13, 8, s18
    v_mad_u32_u16 v74, v14, 8, s18
    ds_read_b64 v[70:71], v70
    ds_read_b64 v[72:73], v72
    ds_read_b64 v[74:75], v74
    s_add_u32 s14, s22, 49152
    buffer_load_dwordx4 v[100:103], v1, s[8:11], s14 offen
    s_waitcnt lgkmcnt(6)
    v_or_b32 v7, v108, v109
    s_nop 0
    v_readlane_b32 s30, v7, 0
    v_readlane_b32 s31, v7, 1
    v_readlane_b32 s32, v7, 2
    v_readlane_b32 s33, v7, 3
    v_readlane_b32 s34, v7, 4
    v_readlane_b32 s35, v7, 5
    v_readlane_b32 s36, v7, 6
    v_readlane_b32 s37, v7, 7
    s_mov_b32 s25, s19
    s_mov_b32 s26, s27
    s_mov_b32 s51, s28
    s_mov_b32 s28, s29
    v_mbcnt_lo_u32_b32 v51, s30, 0
    v_mbcnt_hi_u32_b32 v51, s31, v51
    s_bcnt1_i32_b64 s14, s[30:31]
    v_lshl_add_u32 v55, v51, 1, s25
    ds_read_u16 v55, v55
    s_add_u32 s30, s26, 0
    s_lshl1_add_u32 s25, s14, s25
    s_lshl_b32 s14, s14, 10
    s_add_u32 s26, s26, s14
    v_bfe_i32 v108, v11, 2, 10
    v_bfe_i32 v109, v11, 12, 10
    v_ashrrev_i32 v110, 22, v11
    v_cvt_f32_i32 v108, v108
    v_cvt_f32_i32 v109, v109
    v_cvt_f32_i32 v110, v110
    s_waitcnt lgkmcnt(4)
    v_mfma_f32_4x4x4_16b_bf16 v[112:115], v[58:59], v[64:65], 0
    v_mfma_f32_4x4x4_16b_bf16 v[116:119], v[58:59], v[66:67], 0
    v_mfma_f32_4x4x4_16b_bf16 v[120:123], v[58:59], v[68:69], 0
    v_mad_u32_u16 v8, v8, 8, s50 op_sel:[1,0,0,0]
    v_mad_u32_u16 v9, v9, 8, s50 op_sel:[1,0,0,0]
    v_mad_u32_u16 v10, v10, 8, s50 op_sel:[1,0,0,0]
    v_pk_fma_f32 v[114:115], v[114:115], v[108:109], s[20:21] op_sel:[0,0,0] op_sel_hi:[1,0,1]
    v_pk_fma_f32 v[112:113], v[112:113], v[108:109], s[16:17] op_sel:[0,0,0] op_sel_hi:[1,0,1]
    v_pk_fma_f32 v[118:119], v[118:119], v[108:109], s[20:21] op_sel:[0,1,0] op_sel_hi:[1,1,1]
    v_pk_fma_f32 v[116:117], v[116:117], v[108:109], s[16:17] op_sel:[0,1,0] op_sel_hi:[1,1,1]
    v_pk_fma_f32 v[122:123], v[122:123], v[110:111], s[20:21] op_sel:[0,0,0] op_sel_hi:[1,0,1]
    v_pk_fma_f32 v[120:121], v[120:121], v[110:111], s[16:17] op_sel:[0,0,0] op_sel_hi:[1,0,1]
    v_lshlrev_b64 v[114:115], 16, v[114:115]
    v_lshlrev_b64 v[118:119], 16, v[118:119]
    v_lshlrev_b64 v[122:123], 16, v[122:123]
    v_lshl_add_u64 v[64:65], v[112:113], 0, v[114:115]
    v_lshl_add_u64 v[66:67], v[116:117], 0, v[118:119]
    v_lshl_add_u64 v[68:69], v[120:121], 0, v[122:123]
    v_or3_b32 v4, v44, v45, v4
    v_or3_b32 v4, v46, v47, v4
    v_or3_b32 v4, v48, v49, v4
    ds_add_rtn_u64 v[44:45], v8, v[64:65]
    ds_add_rtn_u64 v[46:47], v9, v[66:67]
    ds_add_rtn_u64 v[48:49], v10, v[68:69]
    s_waitcnt lgkmcnt(3)
    v_mad_u32_u16 v55, v55, s23, v2
    v_pk_lshrrev_b16 v55, 10, v55 op_sel_hi:[1,1]
    v_lshl_add_u32 v51, v51, 6, v55
    buffer_load_dwordx4 v[8:11], v51, s[44:47], s30 idxen
    s_sub_u32 s14, s22, 80000
    buffer_load_dwordx4 v[104:107], v124, s[8:11], s14 offen
    s_waitcnt vmcnt(7)
    v_mad_u32_u16 v76, v16, 8, s18
    v_mad_u32_u16 v78, v17, 8, s18
    v_mad_u32_u16 v80, v18, 8, s18
    ds_read_b64 v[76:77], v76
    ds_read_b64 v[78:79], v78
    ds_read_b64 v[80:81], v80
    s_waitcnt vmcnt(6)
    v_mad_u32_u16 v82, v20, 8, s18
    v_mad_u32_u16 v84, v21, 8, s18
    v_mad_u32_u16 v86, v22, 8, s18
    ds_read_b64 v[82:83], v82
    ds_read_b64 v[84:85], v84
    ds_read_b64 v[86:87], v86
    s_cmp_le_u32 s51, 256
    s_cbranch_scc1 L_p2_kernel_noopt3_2
    v_mad_u32_u16 v64, v24, 8, s18
    v_mad_u32_u16 v66, v25, 8, s18
    v_mad_u32_u16 v68, v26, 8, s18
    ds_read_b64 v[64:65], v64
    ds_read_b64 v[66:67], v66
    ds_read_b64 v[68:69], v68
L_p2_kernel_noopt3_2:
    v_mbcnt_lo_u32_b32 v51, s32, 0
    v_mbcnt_hi_u32_b32 v51, s33, v51
    s_bcnt1_i32_b64 s14, s[32:33]
    v_lshl_add_u32 v55, v51, 1, s25
    ds_read_u16 v55, v55
    s_add_u32 s32, s26, 1048576
    s_lshl1_add_u32 s25, s14, s25
    s_lshl_b32 s14, s14, 10
    s_add_u32 s26, s26, s14
    v_bfe_i32 v108, v15, 2, 10
    v_bfe_i32 v109, v15, 12, 10
    v_ashrrev_i32 v110, 22, v15
    v_cvt_f32_i32 v108, v108
    v_cvt_f32_i32 v109, v109
    v_cvt_f32_i32 v110, v110
    v_mfma_f32_4x4x4_16b_bf16 v[112:115], v[58:59], v[70:71], 0
    v_mfma_f32_4x4x4_16b_bf16 v[116:119], v[58:59], v[72:73], 0
    v_mfma_f32_4x4x4_16b_bf16 v[120:123], v[58:59], v[74:75], 0
    v_mad_u32_u16 v12, v12, 8, s50 op_sel:[1,0,0,0]
    v_mad_u32_u16 v13, v13, 8, s50 op_sel:[1,0,0,0]
    v_mad_u32_u16 v14, v14, 8, s50 op_sel:[1,0,0,0]
    v_pk_fma_f32 v[114:115], v[114:115], v[108:109], s[20:21] op_sel:[0,0,0] op_sel_hi:[1,0,1]
    v_pk_fma_f32 v[112:113], v[112:113], v[108:109], s[16:17] op_sel:[0,0,0] op_sel_hi:[1,0,1]
    v_pk_fma_f32 v[118:119], v[118:119], v[108:109], s[20:21] op_sel:[0,1,0] op_sel_hi:[1,1,1]
    v_pk_fma_f32 v[116:117], v[116:117], v[108:109], s[16:17] op_sel:[0,1,0] op_sel_hi:[1,1,1]
    v_pk_fma_f32 v[122:123], v[122:123], v[110:111], s[20:21] op_sel:[0,0,0] op_sel_hi:[1,0,1]
    v_pk_fma_f32 v[120:121], v[120:121], v[110:111], s[16:17] op_sel:[0,0,0] op_sel_hi:[1,0,1]
    v_lshlrev_b64 v[114:115], 16, v[114:115]
    v_lshlrev_b64 v[118:119], 16, v[118:119]
    v_lshlrev_b64 v[122:123], 16, v[122:123]
    v_lshl_add_u64 v[70:71], v[112:113], 0, v[114:115]
    v_lshl_add_u64 v[72:73], v[116:117], 0, v[118:119]
    v_lshl_add_u64 v[74:75], v[120:121], 0, v[122:123]
    s_waitcnt lgkmcnt(7)
    v_or3_b32 v4, v44, v45, v4
    v_or3_b32 v4, v46, v47, v4
    v_or3_b32 v4, v48, v49, v4
    ds_add_rtn_u64 v[44:45], v12, v[70:71]
    ds_add_rtn_u64 v[46:47], v13, v[72:73]
    ds_add_rtn_u64 v[48:49], v14, v[74:75]
    s_waitcnt lgkmcnt(3)
    v_mad_u32_u16 v55, v55, s23, v2
    v_pk_lshrrev_b16 v55, 10, v55 op_sel_hi:[1,1]
    v_lshl_add_u32 v51, v51, 6, v55
    buffer_load_dwordx4 v[12:15], v51, s[44:47], s32 idxen
    s_barrier
    s_waitcnt vmcnt(1)
    ds_write_b128 v3, v[88:91] offset:0
    ds_write_b128 v3, v[92:95] offset:16384
    ds_write_b128 v3, v[96:99] offset:32768
    ds_write_b128 v3, v[100:103] offset:49152
    ds_write_b128 v124, v[104:107] offset:0
    s_cmp_lg_u32 s24, 7
    s_cbranch_scc1 L_p2_nofin
    s_mul_i32 s14, s3, 20000
    s_mul_i32 s15, s12, 4992
    s_add_u32 s14, s14, s15
    s_add_u32 s15, s14, 4096
    v_min_u32 v61, 231, v0
    v_lshl_add_u32 v60, v0, 2, s14
    v_lshl_add_u32 v61, v61, 2, s15
    global_load_dword v60, v60, s[100:101] nt
    global_load_dword v61, v61, s[100:101] nt
    s_lshl_b32 s14, s14, 2
    s_lshl_b32 s15, s15, 2
    v_min_u32 v36, 231, v0
    v_add_u32 v28, s14, v1
    v_lshl_add_u32 v36, v36, 4, s15
    global_load_dwordx4 v[28:31], v28, s[8:9]
    global_load_dwordx4 v[36:39], v36, s[8:9]
L_p2_nofin:
    v_mbcnt_lo_u32_b32 v51, s34, 0
    v_mbcnt_hi_u32_b32 v51, s35, v51
    s_bcnt1_i32_b64 s14, s[34:35]
    v_lshl_add_u32 v55, v51, 1, s25
    ds_read_u16 v55, v55
    s_add_u32 s34, s26, 2097152
    s_lshl1_add_u32 s25, s14, s25
    s_lshl_b32 s14, s14, 10
    s_add_u32 s26, s26, s14
    v_bfe_i32 v108, v19, 2, 10
    v_bfe_i32 v109, v19, 12, 10
    v_ashrrev_i32 v110, 22, v19
    v_cvt_f32_i32 v108, v108
    v_cvt_f32_i32 v109, v109
    v_cvt_f32_i32 v110, v110
    v_mfma_f32_4x4x4_16b_bf16 v[112:115], v[58:59], v[76:77], 0
    v_mfma_f32_4x4x4_16b_bf16 v[116:119], v[58:59], v[78:79], 0
    v_mfma_f32_4x4x4_16b_bf16 v[120:123], v[58:59], v[80:81], 0
    v_mad_u32_u16 v16, v16, 8, s50 op_sel:[1,0,0,0]
    v_mad_u32_u16 v17, v17, 8, s50 op_sel:[1,0,0,0]
    v_mad_u32_u16 v18, v18, 8, s50 op_sel:[1,0,0,0]
    v_pk_fma_f32 v[114:115], v[114:115], v[108:109], s[20:21] op_sel:[0,0,0] op_sel_hi:[1,0,1]
    v_pk_fma_f32 v[112:113], v[112:113], v[108:109], s[16:17] op_sel:[0,0,0] op_sel_hi:[1,0,1]
    v_pk_fma_f32 v[118:119], v[118:119], v[108:109], s[20:21] op_sel:[0,1,0] op_sel_hi:[1,1,1]
    v_pk_fma_f32 v[116:117], v[116:117], v[108:109], s[16:17] op_sel:[0,1,0] op_sel_hi:[1,1,1]
    v_pk_fma_f32 v[122:123], v[122:123], v[110:111], s[20:21] op_sel:[0,0,0] op_sel_hi:[1,0,1]
    v_pk_fma_f32 v[120:121], v[120:121], v[110:111], s[16:17] op_sel:[0,0,0] op_sel_hi:[1,0,1]
    v_lshlrev_b64 v[114:115], 16, v[114:115]
    v_lshlrev_b64 v[118:119], 16, v[118:119]
    v_lshlrev_b64 v[122:123], 16, v[122:123]
    v_lshl_add_u64 v[76:77], v[112:113], 0, v[114:115]
    v_lshl_add_u64 v[78:79], v[116:117], 0, v[118:119]
    v_lshl_add_u64 v[80:81], v[120:121], 0, v[122:123]
    s_waitcnt lgkmcnt(6)
    v_or3_b32 v4, v44, v45, v4
    v_or3_b32 v4, v46, v47, v4
    v_or3_b32 v4, v48, v49, v4
    ds_add_rtn_u64 v[44:45], v16, v[76:77]
    ds_add_rtn_u64 v[46:47], v17, v[78:79]
    ds_add_rtn_u64 v[48:49], v18, v[80:81]
    s_waitcnt lgkmcnt(3)
    v_mad_u32_u16 v55, v55, s23, v2
    v_pk_lshrrev_b16 v55, 10, v55 op_sel_hi:[1,1]
    v_lshl_add_u32 v51, v51, 6, v55
    buffer_load_dwordx4 v[16:19], v51, s[44:47], s34 idxen
    s_cmp_le_u32 s51, 256
    s_cbranch_scc1 L_p2_kernel_noopt3_3
    v_bfe_i32 v108, v27, 2, 10
    v_bfe_i32 v109, v27, 12, 10
    v_ashrrev_i32 v110, 22, v27
    v_cvt_f32_i32 v108, v108
    v_cvt_f32_i32 v109, v109
    v_cvt_f32_i32 v110, v110
    v_mfma_f32_4x4x4_16b_bf16 v[112:115], v[58:59], v[64:65], 0
    v_mfma_f32_4x4x4_16b_bf16 v[116:119], v[58:59], v[66:67], 0
    v_mfma_f32_4x4x4_16b_bf16 v[120:123], v[58:59], v[68:69], 0
    v_mad_u32_u16 v24, v24, 8, s50 op_sel:[1,0,0,0]
    v_mad_u32_u16 v25, v25, 8, s50 op_sel:[1,0,0,0]
    v_mad_u32_u16 v26, v26, 8, s50 op_sel:[1,0,0,0]
    v_pk_fma_f32 v[114:115], v[114:115], v[108:109], s[20:21] op_sel:[0,0,0] op_sel_hi:[1,0,1]
    v_pk_fma_f32 v[112:113], v[112:113], v[108:109], s[16:17] op_sel:[0,0,0] op_sel_hi:[1,0,1]
    v_pk_fma_f32 v[118:119], v[118:119], v[108:109], s[20:21] op_sel:[0,1,0] op_sel_hi:[1,1,1]
    v_pk_fma_f32 v[116:117], v[116:117], v[108:109], s[16:17] op_sel:[0,1,0] op_sel_hi:[1,1,1]
    v_pk_fma_f32 v[122:123], v[122:123], v[110:111], s[20:21] op_sel:[0,0,0] op_sel_hi:[1,0,1]
    v_pk_fma_f32 v[120:121], v[120:121], v[110:111], s[16:17] op_sel:[0,0,0] op_sel_hi:[1,0,1]
    v_lshlrev_b64 v[114:115], 16, v[114:115]
    v_lshlrev_b64 v[118:119], 16, v[118:119]
    v_lshlrev_b64 v[122:123], 16, v[122:123]
    v_lshl_add_u64 v[64:65], v[112:113], 0, v[114:115]
    v_lshl_add_u64 v[66:67], v[116:117], 0, v[118:119]
    v_lshl_add_u64 v[68:69], v[120:121], 0, v[122:123]
    s_waitcnt lgkmcnt(0)
    v_or3_b32 v4, v44, v45, v4
    v_or3_b32 v4, v46, v47, v4
    v_or3_b32 v4, v48, v49, v4
    ds_add_rtn_u64 v[44:45], v24, v[64:65]
    ds_add_rtn_u64 v[46:47], v25, v[66:67]
    ds_add_rtn_u64 v[48:49], v26, v[68:69]
L_p2_kernel_noopt3_3:
    v_mbcnt_lo_u32_b32 v51, s36, 0
    v_mbcnt_hi_u32_b32 v51, s37, v51
    s_bcnt1_i32_b64 s14, s[36:37]
    v_lshl_add_u32 v55, v51, 1, s25
    ds_read_u16 v55, v55
    s_add_u32 s36, s26, 3145728
    s_lshl1_add_u32 s25, s14, s25
    s_lshl_b32 s14, s14, 10
    s_add_u32 s26, s26, s14
    s_cmp_le_u32 s28, 256
    s_cbranch_scc1 L_p2_kernel_noopt3_4
    v_readlane_b32 s38, v7, 8
    v_readlane_b32 s39, v7, 9
    s_nop 1
    v_mbcnt_lo_u32_b32 v62, s38, 0
    v_mbcnt_hi_u32_b32 v62, s39, v62
    s_bcnt1_i32_b64 s14, s[38:39]
    v_lshl_add_u32 v63, v62, 1, s25
    ds_read_u16 v63, v63
    s_add_u32 s38, s26, 4194304
    s_lshl1_add_u32 s25, s14, s25
    s_lshl_b32 s14, s14, 10
    s_add_u32 s26, s26, s14
L_p2_kernel_noopt3_4:
    v_bfe_i32 v108, v23, 2, 10
    v_bfe_i32 v109, v23, 12, 10
    v_ashrrev_i32 v110, 22, v23
    v_cvt_f32_i32 v108, v108
    v_cvt_f32_i32 v109, v109
    v_cvt_f32_i32 v110, v110
    v_mfma_f32_4x4x4_16b_bf16 v[112:115], v[58:59], v[82:83], 0
    v_mfma_f32_4x4x4_16b_bf16 v[116:119], v[58:59], v[84:85], 0
    v_mfma_f32_4x4x4_16b_bf16 v[120:123], v[58:59], v[86:87], 0
    v_mad_u32_u16 v20, v20, 8, s50 op_sel:[1,0,0,0]
    v_mad_u32_u16 v21, v21, 8, s50 op_sel:[1,0,0,0]
    v_mad_u32_u16 v22, v22, 8, s50 op_sel:[1,0,0,0]
    v_pk_fma_f32 v[114:115], v[114:115], v[108:109], s[20:21] op_sel:[0,0,0] op_sel_hi:[1,0,1]
    v_pk_fma_f32 v[112:113], v[112:113], v[108:109], s[16:17] op_sel:[0,0,0] op_sel_hi:[1,0,1]
    v_pk_fma_f32 v[118:119], v[118:119], v[108:109], s[20:21] op_sel:[0,1,0] op_sel_hi:[1,1,1]
    v_pk_fma_f32 v[116:117], v[116:117], v[108:109], s[16:17] op_sel:[0,1,0] op_sel_hi:[1,1,1]
    v_pk_fma_f32 v[122:123], v[122:123], v[110:111], s[20:21] op_sel:[0,0,0] op_sel_hi:[1,0,1]
    v_pk_fma_f32 v[120:121], v[120:121], v[110:111], s[16:17] op_sel:[0,0,0] op_sel_hi:[1,0,1]
    v_lshlrev_b64 v[114:115], 16, v[114:115]
    v_lshlrev_b64 v[118:119], 16, v[118:119]
    v_lshlrev_b64 v[122:123], 16, v[122:123]
    v_lshl_add_u64 v[82:83], v[112:113], 0, v[114:115]
    v_lshl_add_u64 v[84:85], v[116:117], 0, v[118:119]
    v_lshl_add_u64 v[86:87], v[120:121], 0, v[122:123]
    s_waitcnt lgkmcnt(1)
    v_or3_b32 v4, v44, v45, v4
    v_or3_b32 v4, v46, v47, v4
    v_or3_b32 v4, v48, v49, v4
    ds_add_rtn_u64 v[44:45], v20, v[82:83]
    ds_add_rtn_u64 v[46:47], v21, v[84:85]
    ds_add_rtn_u64 v[48:49], v22, v[86:87]
    s_waitcnt lgkmcnt(3)
    v_mad_u32_u16 v55, v55, s23, v2
    v_pk_lshrrev_b16 v55, 10, v55 op_sel_hi:[1,1]
    v_lshl_add_u32 v51, v51, 6, v55
    buffer_load_dwordx4 v[20:23], v51, s[44:47], s36 idxen
    s_cmp_le_u32 s28, 256
    s_cbranch_scc1 L_p2_kernel_noopt3_5
    v_mad_u32_u16 v63, v63, s23, v2
    v_pk_lshrrev_b16 v63, 10, v63 op_sel_hi:[1,1]
    v_lshl_add_u32 v62, v62, 6, v63
    buffer_load_dwordx4 v[24:27], v62, s[44:47], s38 idxen
L_p2_kernel_noopt3_5:
    s_add_u32 s14, s22, 80000
    buffer_load_dwordx4 v[88:91], v1, s[8:11], s14 offen
    s_add_u32 s14, s24, 1
    s_min_u32 s14, s14, 7
    s_set_gpr_idx_on s14, gpr_idx(SRC0)
    v_mad_u32_u16 v108, v28, v50, s40 op_sel:[0,0,0,0]
    v_mad_u32_u16 v109, v36, v50, s41 op_sel:[0,0,0,0]
    s_set_gpr_idx_off
    v_sub_u32_sdwa v110, v109, v108 dst_sel:DWORD dst_unused:UNUSED_PAD src0_sel:WORD_1 src1_sel:WORD_1
    s_nop 1
    v_add_u32_dpp v110, v110, v110 row_shr:1 row_mask:0xf bank_mask:0xf bound_ctrl:0
    s_nop 1
    v_add_u32_dpp v110, v110, v110 row_shr:2 row_mask:0xf bank_mask:0xf bound_ctrl:0
    s_nop 1
    v_add_u32_dpp v110, v110, v110 row_shr:4 row_mask:0xf bank_mask:0xf bound_ctrl:0
    s_nop 1
    v_add_u32_dpp v110, v110, v110 row_shr:8 row_mask:0xf bank_mask:0xf bound_ctrl:0
    s_nop 1
    v_add_u32_dpp v110, v110, v110 row_bcast:15 row_mask:0xa bank_mask:0xf
    s_nop 1
    v_add_u32_dpp v110, v110, v110 row_bcast:31 row_mask:0xc bank_mask:0xf
    v_sub_u32_sdwa v109, v109, v110 dst_sel:DWORD dst_unused:UNUSED_PAD src0_sel:WORD_1 src1_sel:DWORD
    v_readlane_b32 s29, v110, 63
    v_add_u32 v110, -1, v110
    ds_write_b16 v126, v109
    v_lshlrev_b32_e64 v111, v110, 1
    v_lshrrev_b32 v110, 5, v110
    s_cmp_gt_u32 s29, 320
    s_cselect_b32 s2, 1, s2
    v_lshl_add_u32 v110, v110, 2, v127
    s_cselect_b64 exec, 0, -1
    ds_or_b32 v110, v111 offset:136
    s_mov_b64 exec, -1
    ds_wrxchg2_rtn_b32 v[108:109], v6, v5, v5 offset0:34 offset1:44
    s_add_u32 s14, s22, 96384
    buffer_load_dwordx4 v[92:95], v1, s[8:11], s14 offen
    s_barrier
    s_add_u32 s22, s22, 80000
    s_cmp_eq_u32 s24, 7
    s_cselect_b32 s46, 0, s46
    v_mad_u32_u16 v64, v8, 8, s18
    v_mad_u32_u16 v66, v9, 8, s18
    v_mad_u32_u16 v68, v10, 8, s18
    ds_read_b64 v[64:65], v64
    ds_read_b64 v[66:67], v66
    ds_read_b64 v[68:69], v68
    s_add_u32 s14, s22, 32768
    buffer_load_dwordx4 v[96:99], v1, s[8:11], s14 offen
    s_waitcnt vmcnt(5)
    v_mad_u32_u16 v70, v12, 8, s18
    v_mad_u32_u16 v72, v13, 8, s18
    v_mad_u32_u16 v74, v14, 8, s18
    ds_read_b64 v[70:71], v70
    ds_read_b64 v[72:73], v72
    ds_read_b64 v[74:75], v74
    s_add_u32 s14, s22, 49152
    buffer_load_dwordx4 v[100:103], v1, s[8:11], s14 offen
    s_waitcnt lgkmcnt(6)
    v_or_b32 v7, v108, v109
    s_nop 0
    v_readlane_b32 s30, v7, 0
    v_readlane_b32 s31, v7, 1
    v_readlane_b32 s32, v7, 2
    v_readlane_b32 s33, v7, 3
    v_readlane_b32 s34, v7, 4
    v_readlane_b32 s35, v7, 5
    v_readlane_b32 s36, v7, 6
    v_readlane_b32 s37, v7, 7
    s_mov_b32 s25, s19
    s_mov_b32 s26, s27
    s_mov_b32 s51, s28
    s_mov_b32 s28, s29
    v_mbcnt_lo_u32_b32 v51, s30, 0
    v_mbcnt_hi_u32_b32 v51, s31, v51
    s_bcnt1_i32_b64 s14, s[30:31]
    v_lshl_add_u32 v55, v51, 1, s25
    ds_read_u16 v55, v55
    s_add_u32 s30, s26, 0
    s_lshl1_add_u32 s25, s14, s25
    s_lshl_b32 s14, s14, 10
    s_add_u32 s26, s26, s14
    v_bfe_i32 v108, v11, 2, 10
    v_bfe_i32 v109, v11, 12, 10
    v_ashrrev_i32 v110, 22, v11
    v_cvt_f32_i32 v108, v108
    v_cvt_f32_i32 v109, v109
    v_cvt_f32_i32 v110, v110
    s_waitcnt lgkmcnt(4)
    v_mfma_f32_4x4x4_16b_bf16 v[112:115], v[58:59], v[64:65], 0
    v_mfma_f32_4x4x4_16b_bf16 v[116:119], v[58:59], v[66:67], 0
    v_mfma_f32_4x4x4_16b_bf16 v[120:123], v[58:59], v[68:69], 0
    v_mad_u32_u16 v8, v8, 8, s50 op_sel:[1,0,0,0]
    v_mad_u32_u16 v9, v9, 8, s50 op_sel:[1,0,0,0]
    v_mad_u32_u16 v10, v10, 8, s50 op_sel:[1,0,0,0]
    v_pk_fma_f32 v[114:115], v[114:115], v[108:109], s[20:21] op_sel:[0,0,0] op_sel_hi:[1,0,1]
    v_pk_fma_f32 v[112:113], v[112:113], v[108:109], s[16:17] op_sel:[0,0,0] op_sel_hi:[1,0,1]
    v_pk_fma_f32 v[118:119], v[118:119], v[108:109], s[20:21] op_sel:[0,1,0] op_sel_hi:[1,1,1]
    v_pk_fma_f32 v[116:117], v[116:117], v[108:109], s[16:17] op_sel:[0,1,0] op_sel_hi:[1,1,1]
    v_pk_fma_f32 v[122:123], v[122:123], v[110:111], s[20:21] op_sel:[0,0,0] op_sel_hi:[1,0,1]
    v_pk_fma_f32 v[120:121], v[120:121], v[110:111], s[16:17] op_sel:[0,0,0] op_sel_hi:[1,0,1]
    v_lshlrev_b64 v[114:115], 16, v[114:115]
    v_lshlrev_b64 v[118:119], 16, v[118:119]
    v_lshlrev_b64 v[122:123], 16, v[122:123]
    v_lshl_add_u64 v[64:65], v[112:113], 0, v[114:115]
    v_lshl_add_u64 v[66:67], v[116:117], 0, v[118:119]
    v_lshl_add_u64 v[68:69], v[120:121], 0, v[122:123]
    v_or3_b32 v4, v44, v45, v4
    v_or3_b32 v4, v46, v47, v4
    v_or3_b32 v4, v48, v49, v4
    ds_add_rtn_u64 v[44:45], v8, v[64:65]
    ds_add_rtn_u64 v[46:47], v9, v[66:67]
    ds_add_rtn_u64 v[48:49], v10, v[68:69]
    s_waitcnt lgkmcnt(3)
    v_mad_u32_u16 v55, v55, s23, v2
    v_pk_lshrrev_b16 v55, 10, v55 op_sel_hi:[1,1]
    v_lshl_add_u32 v51, v51, 6, v55
    buffer_load_dwordx4 v[8:11], v51, s[44:47], s30 idxen
    s_sub_u32 s14, s22, 80000
    buffer_load_dwordx4 v[104:107], v124, s[8:11], s14 offen
    s_waitcnt vmcnt(7)
    v_mad_u32_u16 v76, v16, 8, s18
    v_mad_u32_u16 v78, v17, 8, s18
    v_mad_u32_u16 v80, v18, 8, s18
    ds_read_b64 v[76:77], v76
    ds_read_b64 v[78:79], v78
    ds_read_b64 v[80:81], v80
    s_waitcnt vmcnt(6)
    v_mad_u32_u16 v82, v20, 8, s18
    v_mad_u32_u16 v84, v21, 8, s18
    v_mad_u32_u16 v86, v22, 8, s18
    ds_read_b64 v[82:83], v82
    ds_read_b64 v[84:85], v84
    ds_read_b64 v[86:87], v86
    s_cmp_le_u32 s51, 256
    s_cbranch_scc1 L_p2_kernel_noopt3_6
    v_mad_u32_u16 v64, v24, 8, s18
    v_mad_u32_u16 v66, v25, 8, s18
    v_mad_u32_u16 v68, v26, 8, s18
    ds_read_b64 v[64:65], v64
    ds_read_b64 v[66:67], v66
    ds_read_b64 v[68:69], v68
L_p2_kernel_noopt3_6:
    v_mbcnt_lo_u32_b32 v51, s32, 0
    v_mbcnt_hi_u32_b32 v51, s33, v51
    s_bcnt1_i32_b64 s14, s[32:33]
    v_lshl_add_u32 v55, v51, 1, s25
    ds_read_u16 v55, v55
    s_add_u32 s32, s26, 1048576
    s_lshl1_add_u32 s25, s14, s25
    s_lshl_b32 s14, s14, 10
    s_add_u32 s26, s26, s14
    v_bfe_i32 v108, v15, 2, 10
    v_bfe_i32 v109, v15, 12, 10
    v_ashrrev_i32 v110, 22, v15
    v_cvt_f32_i32 v108, v108
    v_cvt_f32_i32 v109, v109
    v_cvt_f32_i32 v110, v110
    v_mfma_f32_4x4x4_16b_bf16 v[112:115], v[58:59], v[70:71], 0
    v_mfma_f32_4x4x4_16b_bf16 v[116:119], v[58:59], v[72:73], 0
    v_mfma_f32_4x4x4_16b_bf16 v[120:123], v[58:59], v[74:75], 0
    v_mad_u32_u16 v12, v12, 8, s50 op_sel:[1,0,0,0]
    v_mad_u32_u16 v13, v13, 8, s50 op_sel:[1,0,0,0]
    v_mad_u32_u16 v14, v14, 8, s50 op_sel:[1,0,0,0]
    v_pk_fma_f32 v[114:115], v[114:115], v[108:109], s[20:21] op_sel:[0,0,0] op_sel_hi:[1,0,1]
    v_pk_fma_f32 v[112:113], v[112:113], v[108:109], s[16:17] op_sel:[0,0,0] op_sel_hi:[1,0,1]
    v_pk_fma_f32 v[118:119], v[118:119], v[108:109], s[20:21] op_sel:[0,1,0] op_sel_hi:[1,1,1]
    v_pk_fma_f32 v[116:117], v[116:117], v[108:109], s[16:17] op_sel:[0,1,0] op_sel_hi:[1,1,1]
    v_pk_fma_f32 v[122:123], v[122:123], v[110:111], s[20:21] op_sel:[0,0,0] op_sel_hi:[1,0,1]
    v_pk_fma_f32 v[120:121], v[120:121], v[110:111], s[16:17] op_sel:[0,0,0] op_sel_hi:[1,0,1]
    v_lshlrev_b64 v[114:115], 16, v[114:115]
    v_lshlrev_b64 v[118:119], 16, v[118:119]
    v_lshlrev_b64 v[122:123], 16, v[122:123]
    v_lshl_add_u64 v[70:71], v[112:113], 0, v[114:115]
    v_lshl_add_u64 v[72:73], v[116:117], 0, v[118:119]
    v_lshl_add_u64 v[74:75], v[120:121], 0, v[122:123]
    s_waitcnt lgkmcnt(7)
    v_or3_b32 v4, v44, v45, v4
    v_or3_b32 v4, v46, v47, v4
    v_or3_b32 v4, v48, v49, v4
    ds_add_rtn_u64 v[44:45], v12, v[70:71]
    ds_add_rtn_u64 v[46:47], v13, v[72:73]
    ds_add_rtn_u64 v[48:49], v14, v[74:75]
    s_waitcnt lgkmcnt(3)
    v_mad_u32_u16 v55, v55, s23, v2
    v_pk_lshrrev_b16 v55, 10, v55 op_sel_hi:[1,1]
    v_lshl_add_u32 v51, v51, 6, v55
    buffer_load_dwordx4 v[12:15], v51, s[44:47], s32 idxen
    s_cmp_lg_u32 s24, 7
    s_cbranch_scc1 L_p2_stage
    s_waitcnt lgkmcnt(0)
    s_branch L_p2_staged
L_p2_stage:
    s_barrier
    s_waitcnt vmcnt(1)
    ds_write_b128 v3, v[88:91] offset:0
    ds_write_b128 v3, v[92:95] offset:16384
    ds_write_b128 v3, v[96:99] offset:32768
    ds_write_b128 v3, v[100:103] offset:49152
    ds_write_b128 v124, v[104:107] offset:0
L_p2_staged:
    v_mbcnt_lo_u32_b32 v51, s34, 0
    v_mbcnt_hi_u32_b32 v51, s35, v51
    s_bcnt1_i32_b64 s14, s[34:35]
    v_lshl_add_u32 v55, v51, 1, s25
    ds_read_u16 v55, v55
    s_add_u32 s34, s26, 2097152
    s_lshl1_add_u32 s25, s14, s25
    s_lshl_b32 s14, s14, 10
    s_add_u32 s26, s26, s14
    v_bfe_i32 v108, v19, 2, 10
    v_bfe_i32 v109, v19, 12, 10
    v_ashrrev_i32 v110, 22, v19
    v_cvt_f32_i32 v108, v108
    v_cvt_f32_i32 v109, v109
    v_cvt_f32_i32 v110, v110
    v_mfma_f32_4x4x4_16b_bf16 v[112:115], v[58:59], v[76:77], 0
    v_mfma_f32_4x4x4_16b_bf16 v[116:119], v[58:59], v[78:79], 0
    v_mfma_f32_4x4x4_16b_bf16 v[120:123], v[58:59], v[80:81], 0
    v_mad_u32_u16 v16, v16, 8, s50 op_sel:[1,0,0,0]
    v_mad_u32_u16 v17, v17, 8, s50 op_sel:[1,0,0,0]
    v_mad_u32_u16 v18, v18, 8, s50 op_sel:[1,0,0,0]
    v_pk_fma_f32 v[114:115], v[114:115], v[108:109], s[20:21] op_sel:[0,0,0] op_sel_hi:[1,0,1]
    v_pk_fma_f32 v[112:113], v[112:113], v[108:109], s[16:17] op_sel:[0,0,0] op_sel_hi:[1,0,1]
    v_pk_fma_f32 v[118:119], v[118:119], v[108:109], s[20:21] op_sel:[0,1,0] op_sel_hi:[1,1,1]
    v_pk_fma_f32 v[116:117], v[116:117], v[108:109], s[16:17] op_sel:[0,1,0] op_sel_hi:[1,1,1]
    v_pk_fma_f32 v[122:123], v[122:123], v[110:111], s[20:21] op_sel:[0,0,0] op_sel_hi:[1,0,1]
    v_pk_fma_f32 v[120:121], v[120:121], v[110:111], s[16:17] op_sel:[0,0,0] op_sel_hi:[1,0,1]
    v_lshlrev_b64 v[114:115], 16, v[114:115]
    v_lshlrev_b64 v[118:119], 16, v[118:119]
    v_lshlrev_b64 v[122:123], 16, v[122:123]
    v_lshl_add_u64 v[76:77], v[112:113], 0, v[114:115]
    v_lshl_add_u64 v[78:79], v[116:117], 0, v[118:119]
    v_lshl_add_u64 v[80:81], v[120:121], 0, v[122:123]
    s_waitcnt lgkmcnt(6)
    v_or3_b32 v4, v44, v45, v4
    v_or3_b32 v4, v46, v47, v4
    v_or3_b32 v4, v48, v49, v4
    ds_add_rtn_u64 v[44:45], v16, v[76:77]
    ds_add_rtn_u64 v[46:47], v17, v[78:79]
    ds_add_rtn_u64 v[48:49], v18, v[80:81]
    s_waitcnt lgkmcnt(3)
    v_mad_u32_u16 v55, v55, s23, v2
    v_pk_lshrrev_b16 v55, 10, v55 op_sel_hi:[1,1]
    v_lshl_add_u32 v51, v51, 6, v55
    buffer_load_dwordx4 v[16:19], v51, s[44:47], s34 idxen
    s_cmp_le_u32 s51, 256
    s_cbranch_scc1 L_p2_kernel_noopt3_7
    v_bfe_i32 v108, v27, 2, 10
    v_bfe_i32 v109, v27, 12, 10
    v_ashrrev_i32 v110, 22, v27
    v_cvt_f32_i32 v108, v108
    v_cvt_f32_i32 v109, v109
    v_cvt_f32_i32 v110, v110
    v_mfma_f32_4x4x4_16b_bf16 v[112:115], v[58:59], v[64:65], 0
    v_mfma_f32_4x4x4_16b_bf16 v[116:119], v[58:59], v[66:67], 0
    v_mfma_f32_4x4x4_16b_bf16 v[120:123], v[58:59], v[68:69], 0
    v_mad_u32_u16 v24, v24, 8, s50 op_sel:[1,0,0,0]
    v_mad_u32_u16 v25, v25, 8, s50 op_sel:[1,0,0,0]
    v_mad_u32_u16 v26, v26, 8, s50 op_sel:[1,0,0,0]
    v_pk_fma_f32 v[114:115], v[114:115], v[108:109], s[20:21] op_sel:[0,0,0] op_sel_hi:[1,0,1]
    v_pk_fma_f32 v[112:113], v[112:113], v[108:109], s[16:17] op_sel:[0,0,0] op_sel_hi:[1,0,1]
    v_pk_fma_f32 v[118:119], v[118:119], v[108:109], s[20:21] op_sel:[0,1,0] op_sel_hi:[1,1,1]
    v_pk_fma_f32 v[116:117], v[116:117], v[108:109], s[16:17] op_sel:[0,1,0] op_sel_hi:[1,1,1]
    v_pk_fma_f32 v[122:123], v[122:123], v[110:111], s[20:21] op_sel:[0,0,0] op_sel_hi:[1,0,1]
    v_pk_fma_f32 v[120:121], v[120:121], v[110:111], s[16:17] op_sel:[0,0,0] op_sel_hi:[1,0,1]
    v_lshlrev_b64 v[114:115], 16, v[114:115]
    v_lshlrev_b64 v[118:119], 16, v[118:119]
    v_lshlrev_b64 v[122:123], 16, v[122:123]
    v_lshl_add_u64 v[64:65], v[112:113], 0, v[114:115]
    v_lshl_add_u64 v[66:67], v[116:117], 0, v[118:119]
    v_lshl_add_u64 v[68:69], v[120:121], 0, v[122:123]
    s_waitcnt lgkmcnt(0)
    v_or3_b32 v4, v44, v45, v4
    v_or3_b32 v4, v46, v47, v4
    v_or3_b32 v4, v48, v49, v4
    ds_add_rtn_u64 v[44:45], v24, v[64:65]
    ds_add_rtn_u64 v[46:47], v25, v[66:67]
    ds_add_rtn_u64 v[48:49], v26, v[68:69]
L_p2_kernel_noopt3_7:
    v_mbcnt_lo_u32_b32 v51, s36, 0
    v_mbcnt_hi_u32_b32 v51, s37, v51
    s_bcnt1_i32_b64 s14, s[36:37]
    v_lshl_add_u32 v55, v51, 1, s25
    ds_read_u16 v55, v55
    s_add_u32 s36, s26, 3145728
    s_lshl1_add_u32 s25, s14, s25
    s_lshl_b32 s14, s14, 10
    s_add_u32 s26, s26, s14
    s_cmp_le_u32 s28, 256
    s_cbranch_scc1 L_p2_kernel_noopt3_8
    v_readlane_b32 s38, v7, 8
    v_readlane_b32 s39, v7, 9
    s_nop 1
    v_mbcnt_lo_u32_b32 v62, s38, 0
    v_mbcnt_hi_u32_b32 v62, s39, v62
    s_bcnt1_i32_b64 s14, s[38:39]
    v_lshl_add_u32 v63, v62, 1, s25
    ds_read_u16 v63, v63
    s_add_u32 s38, s26, 4194304
    s_lshl1_add_u32 s25, s14, s25
    s_lshl_b32 s14, s14, 10
    s_add_u32 s26, s26, s14
L_p2_kernel_noopt3_8:
    v_bfe_i32 v108, v23, 2, 10
    v_bfe_i32 v109, v23, 12, 10
    v_ashrrev_i32 v110, 22, v23
    v_cvt_f32_i32 v108, v108
    v_cvt_f32_i32 v109, v109
    v_cvt_f32_i32 v110, v110
    v_mfma_f32_4x4x4_16b_bf16 v[112:115], v[58:59], v[82:83], 0
    v_mfma_f32_4x4x4_16b_bf16 v[116:119], v[58:59], v[84:85], 0
    v_mfma_f32_4x4x4_16b_bf16 v[120:123], v[58:59], v[86:87], 0
    v_mad_u32_u16 v20, v20, 8, s50 op_sel:[1,0,0,0]
    v_mad_u32_u16 v21, v21, 8, s50 op_sel:[1,0,0,0]
    v_mad_u32_u16 v22, v22, 8, s50 op_sel:[1,0,0,0]
    v_pk_fma_f32 v[114:115], v[114:115], v[108:109], s[20:21] op_sel:[0,0,0] op_sel_hi:[1,0,1]
    v_pk_fma_f32 v[112:113], v[112:113], v[108:109], s[16:17] op_sel:[0,0,0] op_sel_hi:[1,0,1]
    v_pk_fma_f32 v[118:119], v[118:119], v[108:109], s[20:21] op_sel:[0,1,0] op_sel_hi:[1,1,1]
    v_pk_fma_f32 v[116:117], v[116:117], v[108:109], s[16:17] op_sel:[0,1,0] op_sel_hi:[1,1,1]
    v_pk_fma_f32 v[122:123], v[122:123], v[110:111], s[20:21] op_sel:[0,0,0] op_sel_hi:[1,0,1]
    v_pk_fma_f32 v[120:121], v[120:121], v[110:111], s[16:17] op_sel:[0,0,0] op_sel_hi:[1,0,1]
    v_lshlrev_b64 v[114:115], 16, v[114:115]
    v_lshlrev_b64 v[118:119], 16, v[118:119]
    v_lshlrev_b64 v[122:123], 16, v[122:123]
    v_lshl_add_u64 v[82:83], v[112:113], 0, v[114:115]
    v_lshl_add_u64 v[84:85], v[116:117], 0, v[118:119]
    v_lshl_add_u64 v[86:87], v[120:121], 0, v[122:123]
    s_waitcnt lgkmcnt(1)
    v_or3_b32 v4, v44, v45, v4
    v_or3_b32 v4, v46, v47, v4
    v_or3_b32 v4, v48, v49, v4
    ds_add_rtn_u64 v[44:45], v20, v[82:83]
    ds_add_rtn_u64 v[46:47], v21, v[84:85]
    ds_add_rtn_u64 v[48:49], v22, v[86:87]
    s_waitcnt lgkmcnt(3)
    v_mad_u32_u16 v55, v55, s23, v2
    v_pk_lshrrev_b16 v55, 10, v55 op_sel_hi:[1,1]
    v_lshl_add_u32 v51, v51, 6, v55
    buffer_load_dwordx4 v[20:23], v51, s[44:47], s36 idxen
    s_cmp_le_u32 s28, 256
    s_cbranch_scc1 L_p2_kernel_noopt3_9
    v_mad_u32_u16 v63, v63, s23, v2
    v_pk_lshrrev_b16 v63, 10, v63 op_sel_hi:[1,1]
    v_lshl_add_u32 v62, v62, 6, v63
    buffer_load_dwordx4 v[24:27], v62, s[44:47], s38 idxen
L_p2_kernel_noopt3_9:
    s_add_u32 s14, s22, 80000
    buffer_load_dwordx4 v[88:91], v1, s[8:11], s14 offen
    s_cmp_eq_u32 s24, 7
    s_cbranch_scc1 L_p2_exit
    s_add_u32 s14, s24, 1
    s_min_u32 s14, s14, 7
    s_set_gpr_idx_on s14, gpr_idx(SRC0)
    v_mad_u32_u16 v108, v28, v50, s40 op_sel:[1,0,0,0]
    v_mad_u32_u16 v109, v36, v50, s41 op_sel:[1,0,0,0]
    s_set_gpr_idx_off
    v_sub_u32_sdwa v110, v109, v108 dst_sel:DWORD dst_unused:UNUSED_PAD src0_sel:WORD_1 src1_sel:WORD_1
    s_nop 1
    v_add_u32_dpp v110, v110, v110 row_shr:1 row_mask:0xf bank_mask:0xf bound_ctrl:0
    s_nop 1
    v_add_u32_dpp v110, v110, v110 row_shr:2 row_mask:0xf bank_mask:0xf bound_ctrl:0
    s_nop 1
    v_add_u32_dpp v110, v110, v110 row_shr:4 row_mask:0xf bank_mask:0xf bound_ctrl:0
    s_nop 1
    v_add_u32_dpp v110, v110, v110 row_shr:8 row_mask:0xf bank_mask:0xf bound_ctrl:0
    s_nop 1
    v_add_u32_dpp v110, v110, v110 row_bcast:15 row_mask:0xa bank_mask:0xf
    s_nop 1
    v_add_u32_dpp v110, v110, v110 row_bcast:31 row_mask:0xc bank_mask:0xf
    v_sub_u32_sdwa v109, v109, v110 dst_sel:DWORD dst_unused:UNUSED_PAD src0_sel:WORD_1 src1_sel:DWORD
    v_readlane_b32 s29, v110, 63
    v_add_u32 v110, -1, v110
    ds_write_b16 v126, v109
    v_lshlrev_b32_e64 v111, v110, 1
    v_lshrrev_b32 v110, 5, v110
    s_cmp_gt_u32 s29, 320
    s_cselect_b32 s2, 1, s2
    v_lshl_add_u32 v110, v110, 2, v127
    s_cselect_b64 exec, 0, -1
    ds_or_b32 v110, v111 offset:136
    s_mov_b64 exec, -1
    ds_wrxchg2_rtn_b32 v[108:109], v6, v5, v5 offset0:34 offset1:44
    s_add_u32 s14, s22, 96384
    buffer_load_dwordx4 v[92:95], v1, s[8:11], s14 offen
    s_add_u32 s24, s24, 1
    s_cmp_lt_u32 s24, 8
    s_barrier
    s_cbranch_scc1 L_p2_loop
L_p2_exit:
    s_waitcnt lgkmcnt(0)
    v_or3_b32 v4, v44, v45, v4
    v_or3_b32 v4, v46, v47, v4
    v_or3_b32 v4, v48, v49, v4
    s_mov_b32 s27, s19
    s_waitcnt vmcnt(0)
    v_mov_b64 v[64:65], v[28:29]
    v_mov_b64 v[66:67], v[30:31]
    v_mov_b64 v[68:69], v[36:37]
    v_mov_b64 v[70:71], v[38:39]
    v_mov_b32 v8, 160232
    s_cmp_lg_u32 s13, 0
    s_cselect_b64 exec, 0, 1
    ds_write_b32 v8, v52
    s_mov_b64 exec, -1
    v_subrev_u32 v6, 80000, v124
    s_mul_i32 s24, s12, 19968
    v_subrev_u32 v10, s24, v1
    v_mov_b32 v11, 0x7f000000
    s_waitcnt vmcnt(0) lgkmcnt(0)
    s_barrier
    s_cmp_lt_u32 s13, 12
    s_cbranch_scc1 L_p2_ga
L_p2_ga:
    ds_read_b32 v9, v8
    ds_read_b128 v[88:91], v1 offset:0
    ds_read_b128 v[92:95], v1 offset:16384
    ds_read_b128 v[96:99], v1 offset:32768
    ds_read_b128 v[100:103], v1 offset:49152
    ds_read_b128 v[104:107], v6
    s_mul_i32 s14, s12, 5120000
    s_mul_i32 s15, s3, 80000
    s_add_u32 s25, s14, s15
    s_add_u32 s25, s25, 228589568
    s_cmp_eq_u32 s12, 3
    s_cselect_b32 s15, 128, 0
    s_add_u32 s15, s15, 19968
    s_waitcnt lgkmcnt(5)
    v_readfirstlane_b32 s21, v9
    s_nop 0
    s_bfe_u32 s21, s21, 524296
    s_cmp_lg_u32 s21, 4
    s_cselect_b32 s21, 1, 0
    s_cselect_b32 s24, 0, s15
    v_cmp_le_u32 vcc, s24, v10
    v_add_u32 v10, 16384, v10
    s_add_u32 s14, s25, 0
    v_cndmask_b32 v12, v11, v1, vcc
    s_waitcnt lgkmcnt(4)
    buffer_store_dwordx4 v[88:91], v12, s[4:7], s14 offen sc1
    v_or3_b32 v4, v88, v89, v4
    v_or3_b32 v4, v90, v91, v4
    v_cmp_le_u32 vcc, s24, v10
    v_add_u32 v10, 16384, v10
    s_add_u32 s14, s25, 16384
    v_cndmask_b32 v12, v11, v1, vcc
    s_waitcnt lgkmcnt(3)
    buffer_store_dwordx4 v[92:95], v12, s[4:7], s14 offen sc1
    v_or3_b32 v4, v92, v93, v4
    v_or3_b32 v4, v94, v95, v4
    v_cmp_le_u32 vcc, s24, v10
    v_add_u32 v10, 16384, v10
    s_add_u32 s14, s25, 32768
    v_cndmask_b32 v12, v11, v1, vcc
    s_waitcnt lgkmcnt(2)
    buffer_store_dwordx4 v[96:99], v12, s[4:7], s14 offen sc1
    v_or3_b32 v4, v96, v97, v4
    v_or3_b32 v4, v98, v99, v4
    v_cmp_le_u32 vcc, s24, v10
    v_add_u32 v10, 16384, v10
    s_add_u32 s14, s25, 49152
    v_cndmask_b32 v12, v11, v1, vcc
    s_waitcnt lgkmcnt(1)
    buffer_store_dwordx4 v[100:103], v12, s[4:7], s14 offen sc1
    v_or3_b32 v4, v100, v101, v4
    v_or3_b32 v4, v102, v103, v4
    v_cmp_le_u32 vcc, s24, v10
    v_add_u32 v10, 16384, v10
    s_add_u32 s14, s25, 0
    v_cndmask_b32 v12, v11, v6, vcc
    s_waitcnt lgkmcnt(0)
    buffer_store_dwordx4 v[104:107], v12, s[4:7], s14 offen sc1
    v_or3_b32 v4, v104, v105, v4
    v_or3_b32 v4, v106, v107, v4
    s_load_dwordx2 s[16:17], s[0:1], 88
    s_cmp_ge_u32 s13, 12
    s_cbranch_scc1 L_p2_gb
    v_lshlrev_b32 v30, 16, v60
    v_and_b32 v31, 0xffff0000, v60
    v_lshlrev_b32 v36, 16, v53
    v_and_b32 v37, 0xffff0000, v53
    v_lshlrev_b32 v38, 16, v54
    v_and_b32 v39, 0xffff0000, v54
    v_lshlrev_b32 v40, 16, v56
    v_and_b32 v41, 0xffff0000, v56
    v_lshlrev_b32 v42, 16, v57
    v_and_b32 v43, 0xffff0000, v57
    v_pk_add_f32 v[14:15], v[30:31], v[36:37] op_sel:[0,0] op_sel_hi:[1,0] neg_lo:[0,1] neg_hi:[0,1]
    v_pk_add_f32 v[16:17], v[30:31], v[36:37] op_sel:[0,1] op_sel_hi:[1,1] neg_lo:[0,1] neg_hi:[0,1]
    v_pk_add_f32 v[18:19], v[30:31], v[38:39] op_sel:[0,0] op_sel_hi:[1,0] neg_lo:[0,1] neg_hi:[0,1]
    v_pk_add_f32 v[20:21], v[30:31], v[38:39] op_sel:[0,1] op_sel_hi:[1,1] neg_lo:[0,1] neg_hi:[0,1]
    v_pk_add_f32 v[22:23], v[30:31], v[40:41] op_sel:[0,0] op_sel_hi:[1,0] neg_lo:[0,1] neg_hi:[0,1]
    v_pk_add_f32 v[24:25], v[30:31], v[40:41] op_sel:[0,1] op_sel_hi:[1,1] neg_lo:[0,1] neg_hi:[0,1]
    v_pk_add_f32 v[26:27], v[30:31], v[42:43] op_sel:[0,0] op_sel_hi:[1,0] neg_lo:[0,1] neg_hi:[0,1]
    v_pk_add_f32 v[28:29], v[30:31], v[42:43] op_sel:[0,1] op_sel_hi:[1,1] neg_lo:[0,1] neg_hi:[0,1]
    v_cvt_pk_bf16_f32 v32, v14, v15
    v_lshlrev_b32 v14, 16, v32
    v_and_b32 v15, 0xffff0000, v32
    v_cvt_pk_bf16_f32 v32, v16, v17
    v_lshlrev_b32 v16, 16, v32
    v_and_b32 v17, 0xffff0000, v32
    v_cvt_pk_bf16_f32 v32, v18, v19
    v_lshlrev_b32 v18, 16, v32
    v_and_b32 v19, 0xffff0000, v32
    v_cvt_pk_bf16_f32 v32, v20, v21
    v_lshlrev_b32 v20, 16, v32
    v_and_b32 v21, 0xffff0000, v32
    v_cvt_pk_bf16_f32 v32, v22, v23
    v_lshlrev_b32 v22, 16, v32
    v_and_b32 v23, 0xffff0000, v32
    v_cvt_pk_bf16_f32 v32, v24, v25
    v_lshlrev_b32 v24, 16, v32
    v_and_b32 v25, 0xffff0000, v32
    v_cvt_pk_bf16_f32 v32, v26, v27
    v_lshlrev_b32 v26, 16, v32
    v_and_b32 v27, 0xffff0000, v32
    v_cvt_pk_bf16_f32 v32, v28, v29
    v_lshlrev_b32 v28, 16, v32
    v_and_b32 v29, 0xffff0000, v32
    v_pk_mul_f32 v[14:15], v[14:15], v[14:15]
    v_pk_mul_f32 v[16:17], v[16:17], v[16:17]
    v_pk_mul_f32 v[18:19], v[18:19], v[18:19]
    v_pk_mul_f32 v[20:21], v[20:21], v[20:21]
    v_pk_mul_f32 v[22:23], v[22:23], v[22:23]
    v_pk_mul_f32 v[24:25], v[24:25], v[24:25]
    v_pk_mul_f32 v[26:27], v[26:27], v[26:27]
    v_pk_mul_f32 v[28:29], v[28:29], v[28:29]
    v_cvt_pk_bf16_f32 v32, v14, v15
    v_lshlrev_b32 v14, 16, v32
    v_and_b32 v15, 0xffff0000, v32
    v_cvt_pk_bf16_f32 v32, v16, v17
    v_lshlrev_b32 v16, 16, v32
    v_and_b32 v17, 0xffff0000, v32
    v_cvt_pk_bf16_f32 v32, v18, v19
    v_lshlrev_b32 v18, 16, v32
    v_and_b32 v19, 0xffff0000, v32
    v_cvt_pk_bf16_f32 v32, v20, v21
    v_lshlrev_b32 v20, 16, v32
    v_and_b32 v21, 0xffff0000, v32
    v_cvt_pk_bf16_f32 v32, v22, v23
    v_lshlrev_b32 v22, 16, v32
    v_and_b32 v23, 0xffff0000, v32
    v_cvt_pk_bf16_f32 v32, v24, v25
    v_lshlrev_b32 v24, 16, v32
    v_and_b32 v25, 0xffff0000, v32
    v_cvt_pk_bf16_f32 v32, v26, v27
    v_lshlrev_b32 v26, 16, v32
    v_and_b32 v27, 0xffff0000, v32
    v_cvt_pk_bf16_f32 v32, v28, v29
    v_lshlrev_b32 v28, 16, v32
    v_and_b32 v29, 0xffff0000, v32
    v_mov_b32 v30, 1092616192
    v_mov_b32 v31, 0x3fb8aa3b
    v_pk_mul_f32 v[14:15], v[14:15], v[30:31] op_sel:[0,0] op_sel_hi:[1,0]
    v_pk_mul_f32 v[16:17], v[16:17], v[30:31] op_sel:[0,0] op_sel_hi:[1,0]
    v_pk_mul_f32 v[18:19], v[18:19], v[30:31] op_sel:[0,0] op_sel_hi:[1,0]
    v_pk_mul_f32 v[20:21], v[20:21], v[30:31] op_sel:[0,0] op_sel_hi:[1,0]
    v_pk_mul_f32 v[22:23], v[22:23], v[30:31] op_sel:[0,0] op_sel_hi:[1,0]
    v_pk_mul_f32 v[24:25], v[24:25], v[30:31] op_sel:[0,0] op_sel_hi:[1,0]
    v_pk_mul_f32 v[26:27], v[26:27], v[30:31] op_sel:[0,0] op_sel_hi:[1,0]
    v_pk_mul_f32 v[28:29], v[28:29], v[30:31] op_sel:[0,0] op_sel_hi:[1,0]
    v_cvt_pk_bf16_f32 v32, v14, v15
    v_lshlrev_b32 v14, 16, v32
    v_and_b32 v15, 0xffff0000, v32
    v_cvt_pk_bf16_f32 v32, v16, v17
    v_lshlrev_b32 v16, 16, v32
    v_and_b32 v17, 0xffff0000, v32
    v_cvt_pk_bf16_f32 v32, v18, v19
    v_lshlrev_b32 v18, 16, v32
    v_and_b32 v19, 0xffff0000, v32
    v_cvt_pk_bf16_f32 v32, v20, v21
    v_lshlrev_b32 v20, 16, v32
    v_and_b32 v21, 0xffff0000, v32
    v_cvt_pk_bf16_f32 v32, v22, v23
    v_lshlrev_b32 v22, 16, v32
    v_and_b32 v23, 0xffff0000, v32
    v_cvt_pk_bf16_f32 v32, v24, v25
    v_lshlrev_b32 v24, 16, v32
    v_and_b32 v25, 0xffff0000, v32
    v_cvt_pk_bf16_f32 v32, v26, v27
    v_lshlrev_b32 v26, 16, v32
    v_and_b32 v27, 0xffff0000, v32
    v_cvt_pk_bf16_f32 v32, v28, v29
    v_lshlrev_b32 v28, 16, v32
    v_and_b32 v29, 0xffff0000, v32
    v_pk_mul_f32 v[14:15], v[14:15], v[30:31] op_sel:[0,1] op_sel_hi:[1,1]
    v_pk_mul_f32 v[16:17], v[16:17], v[30:31] op_sel:[0,1] op_sel_hi:[1,1]
    v_pk_mul_f32 v[18:19], v[18:19], v[30:31] op_sel:[0,1] op_sel_hi:[1,1]
    v_pk_mul_f32 v[20:21], v[20:21], v[30:31] op_sel:[0,1] op_sel_hi:[1,1]
    v_pk_mul_f32 v[22:23], v[22:23], v[30:31] op_sel:[0,1] op_sel_hi:[1,1]
    v_pk_mul_f32 v[24:25], v[24:25], v[30:31] op_sel:[0,1] op_sel_hi:[1,1]
    v_pk_mul_f32 v[26:27], v[26:27], v[30:31] op_sel:[0,1] op_sel_hi:[1,1]
    v_pk_mul_f32 v[28:29], v[28:29], v[30:31] op_sel:[0,1] op_sel_hi:[1,1]
    v_exp_f32 v14, -v14
    v_exp_f32 v15, -v15
    v_exp_f32 v16, -v16
    v_exp_f32 v17, -v17
    v_exp_f32 v18, -v18
    v_exp_f32 v19, -v19
    v_exp_f32 v20, -v20
    v_exp_f32 v21, -v21
    v_exp_f32 v22, -v22
    v_exp_f32 v23, -v23
    v_exp_f32 v24, -v24
    v_exp_f32 v25, -v25
    v_exp_f32 v26, -v26
    v_exp_f32 v27, -v27
    v_exp_f32 v28, -v28
    v_exp_f32 v29, -v29
    v_cvt_pk_bf16_f32 v14, v14, v16
    v_cvt_pk_bf16_f32 v15, v15, v17
    v_cvt_pk_bf16_f32 v18, v18, v20
    v_cvt_pk_bf16_f32 v19, v19, v21
    v_cvt_pk_bf16_f32 v22, v22, v24
    v_cvt_pk_bf16_f32 v23, v23, v25
    v_cvt_pk_bf16_f32 v26, v26, v28
    v_cvt_pk_bf16_f32 v27, v27, v29
    v_dot2_f32_bf16 v72, v14, s68, 0
    v_dot2_f32_bf16 v73, v15, s68, 0
    v_dot2_f32_bf16 v74, v14, s69, 0
    v_dot2_f32_bf16 v75, v15, s69, 0
    v_dot2_f32_bf16 v76, v14, s70, 0
    v_dot2_f32_bf16 v77, v15, s70, 0
    v_dot2_f32_bf16 v78, v14, s71, 0
    v_dot2_f32_bf16 v79, v15, s71, 0
    v_dot2_f32_bf16 v80, v14, s52, 0
    v_dot2_f32_bf16 v81, v15, s52, 0
    v_dot2_f32_bf16 v82, v14, s53, 0
    v_dot2_f32_bf16 v83, v15, s53, 0
    v_dot2_f32_bf16 v84, v14, s54, 0
    v_dot2_f32_bf16 v85, v15, s54, 0
    v_dot2_f32_bf16 v86, v14, s55, 0
    v_dot2_f32_bf16 v87, v15, s55, 0
    v_dot2_f32_bf16 v72, v18, s72, v72
    v_dot2_f32_bf16 v73, v19, s72, v73
    v_dot2_f32_bf16 v74, v18, s73, v74
    v_dot2_f32_bf16 v75, v19, s73, v75
    v_dot2_f32_bf16 v76, v18, s74, v76
    v_dot2_f32_bf16 v77, v19, s74, v77
    v_dot2_f32_bf16 v78, v18, s75, v78
    v_dot2_f32_bf16 v79, v19, s75, v79
    v_dot2_f32_bf16 v80, v18, s56, v80
    v_dot2_f32_bf16 v81, v19, s56, v81
    v_dot2_f32_bf16 v82, v18, s57, v82
    v_dot2_f32_bf16 v83, v19, s57, v83
    v_dot2_f32_bf16 v84, v18, s58, v84
    v_dot2_f32_bf16 v85, v19, s58, v85
    v_dot2_f32_bf16 v86, v18, s59, v86
    v_dot2_f32_bf16 v87, v19, s59, v87
    v_dot2_f32_bf16 v72, v22, s76, v72
    v_dot2_f32_bf16 v73, v23, s76, v73
    v_dot2_f32_bf16 v74, v22, s77, v74
    v_dot2_f32_bf16 v75, v23, s77, v75
    v_dot2_f32_bf16 v76, v22, s78, v76
    v_dot2_f32_bf16 v77, v23, s78, v77
    v_dot2_f32_bf16 v78, v22, s79, v78
    v_dot2_f32_bf16 v79, v23, s79, v79
    v_dot2_f32_bf16 v80, v22, s60, v80
    v_dot2_f32_bf16 v81, v23, s60, v81
    v_dot2_f32_bf16 v82, v22, s61, v82
    v_dot2_f32_bf16 v83, v23, s61, v83
    v_dot2_f32_bf16 v84, v22, s62, v84
    v_dot2_f32_bf16 v85, v23, s62, v85
    v_dot2_f32_bf16 v86, v22, s63, v86
    v_dot2_f32_bf16 v87, v23, s63, v87
    v_dot2_f32_bf16 v72, v26, s80, v72
    v_dot2_f32_bf16 v73, v27, s80, v73
    v_dot2_f32_bf16 v74, v26, s81, v74
    v_dot2_f32_bf16 v75, v27, s81, v75
    v_dot2_f32_bf16 v76, v26, s82, v76
    v_dot2_f32_bf16 v77, v27, s82, v77
    v_dot2_f32_bf16 v78, v26, s83, v78
    v_dot2_f32_bf16 v79, v27, s83, v79
    v_dot2_f32_bf16 v80, v26, s64, v80
    v_dot2_f32_bf16 v81, v27, s64, v81
    v_dot2_f32_bf16 v82, v26, s65, v82
    v_dot2_f32_bf16 v83, v27, s65, v83
    v_dot2_f32_bf16 v84, v26, s66, v84
    v_dot2_f32_bf16 v85, v27, s66, v85
    v_dot2_f32_bf16 v86, v26, s67, v86
    v_dot2_f32_bf16 v87, v27, s67, v87
L_p2_gb:
    v_and_b32 v4, 0x80008000, v4
    v_cmp_ne_u32 vcc, 0, v4
    v_mov_b32 v8, s27
    v_and_b32 v10, 15, v0
    v_mul_u32_u24 v10, 240, v10
    v_add_u32 v10, 160000, v10
    s_cmp_lg_u64 vcc, 0
    s_cselect_b32 s2, 1, s2
    v_mov_b32 v9, s2
    s_mov_b64 exec, 1
    ds_write_b32 v8, v9
    s_mov_b64 exec, -1
    s_mov_b32 s49, s12
    s_mov_b32 s51, 0
    s_waitcnt vmcnt(0) lgkmcnt(0)
    s_barrier
    ds_read_b32 v9, v10
    s_mov_b32 s18, 5120000
    s_mov_b32 s19, 0x00020000
    s_waitcnt lgkmcnt(0)
    v_cmp_ne_u32 vcc, 0, v9
    s_nop 1
    s_cmp_lg_u64 vcc, 0
    s_cselect_b32 s2, 1, 0
    s_cbranch_scc1 L_p2_slow
L_p2_signal:
    v_mov_b32 v8, 160228
    s_lshl_b32 s15, s2, 4
    s_or_b32 s15, s15, s21
    s_add_u32 s14, s12, 16
    s_lshl_b32 s20, s15, s14
    s_add_u32 s20, s20, 1
    v_mov_b32 v9, s20
    s_cmp_lg_u32 s13, 15
    s_cbranch_scc1 L_p2_nosig0
    s_lshl_b32 s14, s3, 8
    s_add_u32 s14, s14, 8523776
    s_mov_b64 exec, 1
    buffer_atomic_add v9, off, s[4:7], s14 sc0
    s_mov_b64 exec, -1
L_p2_nosig0:
    s_cmp_eq_u32 s49, 3
    s_cselect_b32 s15, 8, 0
    s_add_u32 s15, s15, 224
    v_add_u32 v2, 16384, v1
    v_cmp_gt_u32 vcc, s15, v0
    s_mul_i32 s14, s3, 80000
    s_mul_i32 s26, s49, 19968
    s_add_u32 s26, s26, s14
    v_cndmask_b32 v2, 0.5, v2, vcc
    s_mov_b32 s10, 5120000
    s_lshl_b32 s28, s92, 16
    s_and_b32 s29, s92, 0xffff0000
    s_lshl_b32 s30, s93, 16
    s_and_b32 s31, s93, 0xffff0000
    s_lshl_b32 s32, s94, 16
    s_and_b32 s33, s94, 0xffff0000
    s_lshl_b32 s34, s95, 16
    s_and_b32 s35, s95, 0xffff0000
    s_lshl_b32 s36, s96, 16
    s_and_b32 s37, s96, 0xffff0000
    s_lshl_b32 s38, s97, 16
    s_and_b32 s39, s97, 0xffff0000
    s_lshl_b32 s40, s98, 16
    s_and_b32 s41, s98, 0xffff0000
    s_lshl_b32 s42, s99, 16
    s_and_b32 s43, s99, 0xffff0000
    s_and_b32 s99, s91, 0xffff0000
    s_lshl_b32 s98, s91, 16
    s_and_b32 s97, s90, 0xffff0000
    s_lshl_b32 s96, s90, 16
    s_and_b32 s95, s89, 0xffff0000
    s_lshl_b32 s94, s89, 16
    s_and_b32 s93, s88, 0xffff0000
    s_lshl_b32 s92, s88, 16
    s_and_b32 s91, s87, 0xffff0000
    s_lshl_b32 s90, s87, 16
    s_and_b32 s89, s86, 0xffff0000
    s_lshl_b32 s88, s86, 16
    s_and_b32 s87, s85, 0xffff0000
    s_lshl_b32 s86, s85, 16
    s_and_b32 s85, s84, 0xffff0000
    s_lshl_b32 s84, s84, 16
    s_mov_b32 s44, s48
    s_add_u32 s45, s48, 2281701376
    s_cmp_eq_u32 s48, 0
    s_cselect_b32 s45, 0, s45
    s_cmp_lt_u32 s13, 12
    s_cbranch_scc1 L_p2_gc
    v_lshlrev_b32 v30, 16, v60
    v_and_b32 v31, 0xffff0000, v60
    v_lshlrev_b32 v36, 16, v53
    v_and_b32 v37, 0xffff0000, v53
    v_lshlrev_b32 v38, 16, v54
    v_and_b32 v39, 0xffff0000, v54
    v_lshlrev_b32 v40, 16, v56
    v_and_b32 v41, 0xffff0000, v56
    v_lshlrev_b32 v42, 16, v57
    v_and_b32 v43, 0xffff0000, v57
    v_pk_add_f32 v[14:15], v[30:31], v[36:37] op_sel:[0,0] op_sel_hi:[1,0] neg_lo:[0,1] neg_hi:[0,1]
    v_pk_add_f32 v[16:17], v[30:31], v[36:37] op_sel:[0,1] op_sel_hi:[1,1] neg_lo:[0,1] neg_hi:[0,1]
    v_pk_add_f32 v[18:19], v[30:31], v[38:39] op_sel:[0,0] op_sel_hi:[1,0] neg_lo:[0,1] neg_hi:[0,1]
    v_pk_add_f32 v[20:21], v[30:31], v[38:39] op_sel:[0,1] op_sel_hi:[1,1] neg_lo:[0,1] neg_hi:[0,1]
    v_pk_add_f32 v[22:23], v[30:31], v[40:41] op_sel:[0,0] op_sel_hi:[1,0] neg_lo:[0,1] neg_hi:[0,1]
    v_pk_add_f32 v[24:25], v[30:31], v[40:41] op_sel:[0,1] op_sel_hi:[1,1] neg_lo:[0,1] neg_hi:[0,1]
    v_pk_add_f32 v[26:27], v[30:31], v[42:43] op_sel:[0,0] op_sel_hi:[1,0] neg_lo:[0,1] neg_hi:[0,1]
    v_pk_add_f32 v[28:29], v[30:31], v[42:43] op_sel:[0,1] op_sel_hi:[1,1] neg_lo:[0,1] neg_hi:[0,1]
    v_cvt_pk_bf16_f32 v32, v14, v15
    v_lshlrev_b32 v14, 16, v32
    v_and_b32 v15, 0xffff0000, v32
    v_cvt_pk_bf16_f32 v32, v16, v17
    v_lshlrev_b32 v16, 16, v32
    v_and_b32 v17, 0xffff0000, v32
    v_cvt_pk_bf16_f32 v32, v18, v19
    v_lshlrev_b32 v18, 16, v32
    v_and_b32 v19, 0xffff0000, v32
    v_cvt_pk_bf16_f32 v32, v20, v21
    v_lshlrev_b32 v20, 16, v32
    v_and_b32 v21, 0xffff0000, v32
    v_cvt_pk_bf16_f32 v32, v22, v23
    v_lshlrev_b32 v22, 16, v32
    v_and_b32 v23, 0xffff0000, v32
    v_cvt_pk_bf16_f32 v32, v24, v25
    v_lshlrev_b32 v24, 16, v32
    v_and_b32 v25, 0xffff0000, v32
    v_cvt_pk_bf16_f32 v32, v26, v27
    v_lshlrev_b32 v26, 16, v32
    v_and_b32 v27, 0xffff0000, v32
    v_cvt_pk_bf16_f32 v32, v28, v29
    v_lshlrev_b32 v28, 16, v32
    v_and_b32 v29, 0xffff0000, v32
    v_pk_mul_f32 v[14:15], v[14:15], v[14:15]
    v_pk_mul_f32 v[16:17], v[16:17], v[16:17]
    v_pk_mul_f32 v[18:19], v[18:19], v[18:19]
    v_pk_mul_f32 v[20:21], v[20:21], v[20:21]
    v_pk_mul_f32 v[22:23], v[22:23], v[22:23]
    v_pk_mul_f32 v[24:25], v[24:25], v[24:25]
    v_pk_mul_f32 v[26:27], v[26:27], v[26:27]
    v_pk_mul_f32 v[28:29], v[28:29], v[28:29]
    v_cvt_pk_bf16_f32 v32, v14, v15
    v_lshlrev_b32 v14, 16, v32
    v_and_b32 v15, 0xffff0000, v32
    v_cvt_pk_bf16_f32 v32, v16, v17
    v_lshlrev_b32 v16, 16, v32
    v_and_b32 v17, 0xffff0000, v32
    v_cvt_pk_bf16_f32 v32, v18, v19
    v_lshlrev_b32 v18, 16, v32
    v_and_b32 v19, 0xffff0000, v32
    v_cvt_pk_bf16_f32 v32, v20, v21
    v_lshlrev_b32 v20, 16, v32
    v_and_b32 v21, 0xffff0000, v32
    v_cvt_pk_bf16_f32 v32, v22, v23
    v_lshlrev_b32 v22, 16, v32
    v_and_b32 v23, 0xffff0000, v32
    v_cvt_pk_bf16_f32 v32, v24, v25
    v_lshlrev_b32 v24, 16, v32
    v_and_b32 v25, 0xffff0000, v32
    v_cvt_pk_bf16_f32 v32, v26, v27
    v_lshlrev_b32 v26, 16, v32
    v_and_b32 v27, 0xffff0000, v32
    v_cvt_pk_bf16_f32 v32, v28, v29
    v_lshlrev_b32 v28, 16, v32
    v_and_b32 v29, 0xffff0000, v32
    v_mov_b32 v30, 1092616192
    v_mov_b32 v31, 0x3fb8aa3b
    v_pk_mul_f32 v[14:15], v[14:15], v[30:31] op_sel:[0,0] op_sel_hi:[1,0]
    v_pk_mul_f32 v[16:17], v[16:17], v[30:31] op_sel:[0,0] op_sel_hi:[1,0]
    v_pk_mul_f32 v[18:19], v[18:19], v[30:31] op_sel:[0,0] op_sel_hi:[1,0]
    v_pk_mul_f32 v[20:21], v[20:21], v[30:31] op_sel:[0,0] op_sel_hi:[1,0]
    v_pk_mul_f32 v[22:23], v[22:23], v[30:31] op_sel:[0,0] op_sel_hi:[1,0]
    v_pk_mul_f32 v[24:25], v[24:25], v[30:31] op_sel:[0,0] op_sel_hi:[1,0]
    v_pk_mul_f32 v[26:27], v[26:27], v[30:31] op_sel:[0,0] op_sel_hi:[1,0]
    v_pk_mul_f32 v[28:29], v[28:29], v[30:31] op_sel:[0,0] op_sel_hi:[1,0]
    v_cvt_pk_bf16_f32 v32, v14, v15
    v_lshlrev_b32 v14, 16, v32
    v_and_b32 v15, 0xffff0000, v32
    v_cvt_pk_bf16_f32 v32, v16, v17
    v_lshlrev_b32 v16, 16, v32
    v_and_b32 v17, 0xffff0000, v32
    v_cvt_pk_bf16_f32 v32, v18, v19
    v_lshlrev_b32 v18, 16, v32
    v_and_b32 v19, 0xffff0000, v32
    v_cvt_pk_bf16_f32 v32, v20, v21
    v_lshlrev_b32 v20, 16, v32
    v_and_b32 v21, 0xffff0000, v32
    v_cvt_pk_bf16_f32 v32, v22, v23
    v_lshlrev_b32 v22, 16, v32
    v_and_b32 v23, 0xffff0000, v32
    v_cvt_pk_bf16_f32 v32, v24, v25
    v_lshlrev_b32 v24, 16, v32
    v_and_b32 v25, 0xffff0000, v32
    v_cvt_pk_bf16_f32 v32, v26, v27
    v_lshlrev_b32 v26, 16, v32
    v_and_b32 v27, 0xffff0000, v32
    v_cvt_pk_bf16_f32 v32, v28, v29
    v_lshlrev_b32 v28, 16, v32
    v_and_b32 v29, 0xffff0000, v32
    v_pk_mul_f32 v[14:15], v[14:15], v[30:31] op_sel:[0,1] op_sel_hi:[1,1]
    v_pk_mul_f32 v[16:17], v[16:17], v[30:31] op_sel:[0,1] op_sel_hi:[1,1]
    v_pk_mul_f32 v[18:19], v[18:19], v[30:31] op_sel:[0,1] op_sel_hi:[1,1]
    v_pk_mul_f32 v[20:21], v[20:21], v[30:31] op_sel:[0,1] op_sel_hi:[1,1]
    v_pk_mul_f32 v[22:23], v[22:23], v[30:31] op_sel:[0,1] op_sel_hi:[1,1]
    v_pk_mul_f32 v[24:25], v[24:25], v[30:31] op_sel:[0,1] op_sel_hi:[1,1]
    v_pk_mul_f32 v[26:27], v[26:27], v[30:31] op_sel:[0,1] op_sel_hi:[1,1]
    v_pk_mul_f32 v[28:29], v[28:29], v[30:31] op_sel:[0,1] op_sel_hi:[1,1]
    v_exp_f32 v14, -v14
    v_exp_f32 v15, -v15
    v_exp_f32 v16, -v16
    v_exp_f32 v17, -v17
    v_exp_f32 v18, -v18
    v_exp_f32 v19, -v19
    v_exp_f32 v20, -v20
    v_exp_f32 v21, -v21
    v_exp_f32 v22, -v22
    v_exp_f32 v23, -v23
    v_exp_f32 v24, -v24
    v_exp_f32 v25, -v25
    v_exp_f32 v26, -v26
    v_exp_f32 v27, -v27
    v_exp_f32 v28, -v28
    v_exp_f32 v29, -v29
    v_cvt_pk_bf16_f32 v14, v14, v16
    v_cvt_pk_bf16_f32 v15, v15, v17
    v_cvt_pk_bf16_f32 v18, v18, v20
    v_cvt_pk_bf16_f32 v19, v19, v21
    v_cvt_pk_bf16_f32 v22, v22, v24
    v_cvt_pk_bf16_f32 v23, v23, v25
    v_cvt_pk_bf16_f32 v26, v26, v28
    v_cvt_pk_bf16_f32 v27, v27, v29
    v_dot2_f32_bf16 v72, v14, s68, 0
    v_dot2_f32_bf16 v73, v15, s68, 0
    v_dot2_f32_bf16 v74, v14, s69, 0
    v_dot2_f32_bf16 v75, v15, s69, 0
    v_dot2_f32_bf16 v76, v14, s70, 0
    v_dot2_f32_bf16 v77, v15, s70, 0
    v_dot2_f32_bf16 v78, v14, s71, 0
    v_dot2_f32_bf16 v79, v15, s71, 0
    v_dot2_f32_bf16 v80, v14, s52, 0
    v_dot2_f32_bf16 v81, v15, s52, 0
    v_dot2_f32_bf16 v82, v14, s53, 0
    v_dot2_f32_bf16 v83, v15, s53, 0
    v_dot2_f32_bf16 v84, v14, s54, 0
    v_dot2_f32_bf16 v85, v15, s54, 0
    v_dot2_f32_bf16 v86, v14, s55, 0
    v_dot2_f32_bf16 v87, v15, s55, 0
    v_dot2_f32_bf16 v72, v18, s72, v72
    v_dot2_f32_bf16 v73, v19, s72, v73
    v_dot2_f32_bf16 v74, v18, s73, v74
    v_dot2_f32_bf16 v75, v19, s73, v75
    v_dot2_f32_bf16 v76, v18, s74, v76
    v_dot2_f32_bf16 v77, v19, s74, v77
    v_dot2_f32_bf16 v78, v18, s75, v78
    v_dot2_f32_bf16 v79, v19, s75, v79
    v_dot2_f32_bf16 v80, v18, s56, v80
    v_dot2_f32_bf16 v81, v19, s56, v81
    v_dot2_f32_bf16 v82, v18, s57, v82
    v_dot2_f32_bf16 v83, v19, s57, v83
    v_dot2_f32_bf16 v84, v18, s58, v84
    v_dot2_f32_bf16 v85, v19, s58, v85
    v_dot2_f32_bf16 v86, v18, s59, v86
    v_dot2_f32_bf16 v87, v19, s59, v87
    v_dot2_f32_bf16 v72, v22, s76, v72
    v_dot2_f32_bf16 v73, v23, s76, v73
    v_dot2_f32_bf16 v74, v22, s77, v74
    v_dot2_f32_bf16 v75, v23, s77, v75
    v_dot2_f32_bf16 v76, v22, s78, v76
    v_dot2_f32_bf16 v77, v23, s78, v77
    v_dot2_f32_bf16 v78, v22, s79, v78
    v_dot2_f32_bf16 v79, v23, s79, v79
    v_dot2_f32_bf16 v80, v22, s60, v80
    v_dot2_f32_bf16 v81, v23, s60, v81
    v_dot2_f32_bf16 v82, v22, s61, v82
    v_dot2_f32_bf16 v83, v23, s61, v83
    v_dot2_f32_bf16 v84, v22, s62, v84
    v_dot2_f32_bf16 v85, v23, s62, v85
    v_dot2_f32_bf16 v86, v22, s63, v86
    v_dot2_f32_bf16 v87, v23, s63, v87
    v_dot2_f32_bf16 v72, v26, s80, v72
    v_dot2_f32_bf16 v73, v27, s80, v73
    v_dot2_f32_bf16 v74, v26, s81, v74
    v_dot2_f32_bf16 v75, v27, s81, v75
    v_dot2_f32_bf16 v76, v26, s82, v76
    v_dot2_f32_bf16 v77, v27, s82, v77
    v_dot2_f32_bf16 v78, v26, s83, v78
    v_dot2_f32_bf16 v79, v27, s83, v79
    v_dot2_f32_bf16 v80, v26, s64, v80
    v_dot2_f32_bf16 v81, v27, s64, v81
    v_dot2_f32_bf16 v82, v26, s65, v82
    v_dot2_f32_bf16 v83, v27, s65, v83
    v_dot2_f32_bf16 v84, v26, s66, v84
    v_dot2_f32_bf16 v85, v27, s66, v85
    v_dot2_f32_bf16 v86, v26, s67, v86
    v_dot2_f32_bf16 v87, v27, s67, v87
L_p2_gc:
    s_cmp_ge_u32 s13, 4
    s_cbranch_scc1 L_p2_gd
    v_lshlrev_b32 v30, 16, v61
    v_and_b32 v31, 0xffff0000, v61
    v_pk_add_f32 v[14:15], v[30:31], v[36:37] op_sel:[0,0] op_sel_hi:[1,0] neg_lo:[0,1] neg_hi:[0,1]
    v_pk_add_f32 v[16:17], v[30:31], v[36:37] op_sel:[0,1] op_sel_hi:[1,1] neg_lo:[0,1] neg_hi:[0,1]
    v_pk_add_f32 v[18:19], v[30:31], v[38:39] op_sel:[0,0] op_sel_hi:[1,0] neg_lo:[0,1] neg_hi:[0,1]
    v_pk_add_f32 v[20:21], v[30:31], v[38:39] op_sel:[0,1] op_sel_hi:[1,1] neg_lo:[0,1] neg_hi:[0,1]
    v_pk_add_f32 v[22:23], v[30:31], v[40:41] op_sel:[0,0] op_sel_hi:[1,0] neg_lo:[0,1] neg_hi:[0,1]
    v_pk_add_f32 v[24:25], v[30:31], v[40:41] op_sel:[0,1] op_sel_hi:[1,1] neg_lo:[0,1] neg_hi:[0,1]
    v_pk_add_f32 v[26:27], v[30:31], v[42:43] op_sel:[0,0] op_sel_hi:[1,0] neg_lo:[0,1] neg_hi:[0,1]
    v_pk_add_f32 v[28:29], v[30:31], v[42:43] op_sel:[0,1] op_sel_hi:[1,1] neg_lo:[0,1] neg_hi:[0,1]
    v_cvt_pk_bf16_f32 v32, v14, v15
    v_lshlrev_b32 v14, 16, v32
    v_and_b32 v15, 0xffff0000, v32
    v_cvt_pk_bf16_f32 v32, v16, v17
    v_lshlrev_b32 v16, 16, v32
    v_and_b32 v17, 0xffff0000, v32
    v_cvt_pk_bf16_f32 v32, v18, v19
    v_lshlrev_b32 v18, 16, v32
    v_and_b32 v19, 0xffff0000, v32
    v_cvt_pk_bf16_f32 v32, v20, v21
    v_lshlrev_b32 v20, 16, v32
    v_and_b32 v21, 0xffff0000, v32
    v_cvt_pk_bf16_f32 v32, v22, v23
    v_lshlrev_b32 v22, 16, v32
    v_and_b32 v23, 0xffff0000, v32
    v_cvt_pk_bf16_f32 v32, v24, v25
    v_lshlrev_b32 v24, 16, v32
    v_and_b32 v25, 0xffff0000, v32
    v_cvt_pk_bf16_f32 v32, v26, v27
    v_lshlrev_b32 v26, 16, v32
    v_and_b32 v27, 0xffff0000, v32
    v_cvt_pk_bf16_f32 v32, v28, v29
    v_lshlrev_b32 v28, 16, v32
    v_and_b32 v29, 0xffff0000, v32
    v_pk_mul_f32 v[14:15], v[14:15], v[14:15]
    v_pk_mul_f32 v[16:17], v[16:17], v[16:17]
    v_pk_mul_f32 v[18:19], v[18:19], v[18:19]
    v_pk_mul_f32 v[20:21], v[20:21], v[20:21]
    v_pk_mul_f32 v[22:23], v[22:23], v[22:23]
    v_pk_mul_f32 v[24:25], v[24:25], v[24:25]
    v_pk_mul_f32 v[26:27], v[26:27], v[26:27]
    v_pk_mul_f32 v[28:29], v[28:29], v[28:29]
    v_cvt_pk_bf16_f32 v32, v14, v15
    v_lshlrev_b32 v14, 16, v32
    v_and_b32 v15, 0xffff0000, v32
    v_cvt_pk_bf16_f32 v32, v16, v17
    v_lshlrev_b32 v16, 16, v32
    v_and_b32 v17, 0xffff0000, v32
    v_cvt_pk_bf16_f32 v32, v18, v19
    v_lshlrev_b32 v18, 16, v32
    v_and_b32 v19, 0xffff0000, v32
    v_cvt_pk_bf16_f32 v32, v20, v21
    v_lshlrev_b32 v20, 16, v32
    v_and_b32 v21, 0xffff0000, v32
    v_cvt_pk_bf16_f32 v32, v22, v23
    v_lshlrev_b32 v22, 16, v32
    v_and_b32 v23, 0xffff0000, v32
    v_cvt_pk_bf16_f32 v32, v24, v25
    v_lshlrev_b32 v24, 16, v32
    v_and_b32 v25, 0xffff0000, v32
    v_cvt_pk_bf16_f32 v32, v26, v27
    v_lshlrev_b32 v26, 16, v32
    v_and_b32 v27, 0xffff0000, v32
    v_cvt_pk_bf16_f32 v32, v28, v29
    v_lshlrev_b32 v28, 16, v32
    v_and_b32 v29, 0xffff0000, v32
    v_mov_b32 v30, 1092616192
    v_mov_b32 v31, 0x3fb8aa3b
    v_pk_mul_f32 v[14:15], v[14:15], v[30:31] op_sel:[0,0] op_sel_hi:[1,0]
    v_pk_mul_f32 v[16:17], v[16:17], v[30:31] op_sel:[0,0] op_sel_hi:[1,0]
    v_pk_mul_f32 v[18:19], v[18:19], v[30:31] op_sel:[0,0] op_sel_hi:[1,0]
    v_pk_mul_f32 v[20:21], v[20:21], v[30:31] op_sel:[0,0] op_sel_hi:[1,0]
    v_pk_mul_f32 v[22:23], v[22:23], v[30:31] op_sel:[0,0] op_sel_hi:[1,0]
    v_pk_mul_f32 v[24:25], v[24:25], v[30:31] op_sel:[0,0] op_sel_hi:[1,0]
    v_pk_mul_f32 v[26:27], v[26:27], v[30:31] op_sel:[0,0] op_sel_hi:[1,0]
    v_pk_mul_f32 v[28:29], v[28:29], v[30:31] op_sel:[0,0] op_sel_hi:[1,0]
    v_cvt_pk_bf16_f32 v32, v14, v15
    v_lshlrev_b32 v14, 16, v32
    v_and_b32 v15, 0xffff0000, v32
    v_cvt_pk_bf16_f32 v32, v16, v17
    v_lshlrev_b32 v16, 16, v32
    v_and_b32 v17, 0xffff0000, v32
    v_cvt_pk_bf16_f32 v32, v18, v19
    v_lshlrev_b32 v18, 16, v32
    v_and_b32 v19, 0xffff0000, v32
    v_cvt_pk_bf16_f32 v32, v20, v21
    v_lshlrev_b32 v20, 16, v32
    v_and_b32 v21, 0xffff0000, v32
    v_cvt_pk_bf16_f32 v32, v22, v23
    v_lshlrev_b32 v22, 16, v32
    v_and_b32 v23, 0xffff0000, v32
    v_cvt_pk_bf16_f32 v32, v24, v25
    v_lshlrev_b32 v24, 16, v32
    v_and_b32 v25, 0xffff0000, v32
    v_cvt_pk_bf16_f32 v32, v26, v27
    v_lshlrev_b32 v26, 16, v32
    v_and_b32 v27, 0xffff0000, v32
    v_cvt_pk_bf16_f32 v32, v28, v29
    v_lshlrev_b32 v28, 16, v32
    v_and_b32 v29, 0xffff0000, v32
    v_pk_mul_f32 v[14:15], v[14:15], v[30:31] op_sel:[0,1] op_sel_hi:[1,1]
    v_pk_mul_f32 v[16:17], v[16:17], v[30:31] op_sel:[0,1] op_sel_hi:[1,1]
    v_pk_mul_f32 v[18:19], v[18:19], v[30:31] op_sel:[0,1] op_sel_hi:[1,1]
    v_pk_mul_f32 v[20:21], v[20:21], v[30:31] op_sel:[0,1] op_sel_hi:[1,1]
    v_pk_mul_f32 v[22:23], v[22:23], v[30:31] op_sel:[0,1] op_sel_hi:[1,1]
    v_pk_mul_f32 v[24:25], v[24:25], v[30:31] op_sel:[0,1] op_sel_hi:[1,1]
    v_pk_mul_f32 v[26:27], v[26:27], v[30:31] op_sel:[0,1] op_sel_hi:[1,1]
    v_pk_mul_f32 v[28:29], v[28:29], v[30:31] op_sel:[0,1] op_sel_hi:[1,1]
    v_exp_f32 v14, -v14
    v_exp_f32 v15, -v15
    v_exp_f32 v16, -v16
    v_exp_f32 v17, -v17
    v_exp_f32 v18, -v18
    v_exp_f32 v19, -v19
    v_exp_f32 v20, -v20
    v_exp_f32 v21, -v21
    v_exp_f32 v22, -v22
    v_exp_f32 v23, -v23
    v_exp_f32 v24, -v24
    v_exp_f32 v25, -v25
    v_exp_f32 v26, -v26
    v_exp_f32 v27, -v27
    v_exp_f32 v28, -v28
    v_exp_f32 v29, -v29
    v_cvt_pk_bf16_f32 v14, v14, v16
    v_cvt_pk_bf16_f32 v15, v15, v17
    v_cvt_pk_bf16_f32 v18, v18, v20
    v_cvt_pk_bf16_f32 v19, v19, v21
    v_cvt_pk_bf16_f32 v22, v22, v24
    v_cvt_pk_bf16_f32 v23, v23, v25
    v_cvt_pk_bf16_f32 v26, v26, v28
    v_cvt_pk_bf16_f32 v27, v27, v29
    v_dot2_f32_bf16 v112, v14, s68, 0
    v_dot2_f32_bf16 v113, v15, s68, 0
    v_dot2_f32_bf16 v114, v14, s69, 0
    v_dot2_f32_bf16 v115, v15, s69, 0
    v_dot2_f32_bf16 v116, v14, s70, 0
    v_dot2_f32_bf16 v117, v15, s70, 0
    v_dot2_f32_bf16 v118, v14, s71, 0
    v_dot2_f32_bf16 v119, v15, s71, 0
    v_dot2_f32_bf16 v120, v14, s52, 0
    v_dot2_f32_bf16 v121, v15, s52, 0
    v_dot2_f32_bf16 v122, v14, s53, 0
    v_dot2_f32_bf16 v123, v15, s53, 0
    v_dot2_f32_bf16 v124, v14, s54, 0
    v_dot2_f32_bf16 v125, v15, s54, 0
    v_dot2_f32_bf16 v126, v14, s55, 0
    v_dot2_f32_bf16 v127, v15, s55, 0
    v_dot2_f32_bf16 v112, v18, s72, v112
    v_dot2_f32_bf16 v113, v19, s72, v113
    v_dot2_f32_bf16 v114, v18, s73, v114
    v_dot2_f32_bf16 v115, v19, s73, v115
    v_dot2_f32_bf16 v116, v18, s74, v116
    v_dot2_f32_bf16 v117, v19, s74, v117
    v_dot2_f32_bf16 v118, v18, s75, v118
    v_dot2_f32_bf16 v119, v19, s75, v119
    v_dot2_f32_bf16 v120, v18, s56, v120
    v_dot2_f32_bf16 v121, v19, s56, v121
    v_dot2_f32_bf16 v122, v18, s57, v122
    v_dot2_f32_bf16 v123, v19, s57, v123
    v_dot2_f32_bf16 v124, v18, s58, v124
    v_dot2_f32_bf16 v125, v19, s58, v125
    v_dot2_f32_bf16 v126, v18, s59, v126
    v_dot2_f32_bf16 v127, v19, s59, v127
    v_dot2_f32_bf16 v112, v22, s76, v112
    v_dot2_f32_bf16 v113, v23, s76, v113
    v_dot2_f32_bf16 v114, v22, s77, v114
    v_dot2_f32_bf16 v115, v23, s77, v115
    v_dot2_f32_bf16 v116, v22, s78, v116
    v_dot2_f32_bf16 v117, v23, s78, v117
    v_dot2_f32_bf16 v118, v22, s79, v118
    v_dot2_f32_bf16 v119, v23, s79, v119
    v_dot2_f32_bf16 v120, v22, s60, v120
    v_dot2_f32_bf16 v121, v23, s60, v121
    v_dot2_f32_bf16 v122, v22, s61, v122
    v_dot2_f32_bf16 v123, v23, s61, v123
    v_dot2_f32_bf16 v124, v22, s62, v124
    v_dot2_f32_bf16 v125, v23, s62, v125
    v_dot2_f32_bf16 v126, v22, s63, v126
    v_dot2_f32_bf16 v127, v23, s63, v127
    v_dot2_f32_bf16 v112, v26, s80, v112
    v_dot2_f32_bf16 v113, v27, s80, v113
    v_dot2_f32_bf16 v114, v26, s81, v114
    v_dot2_f32_bf16 v115, v27, s81, v115
    v_dot2_f32_bf16 v116, v26, s82, v116
    v_dot2_f32_bf16 v117, v27, s82, v117
    v_dot2_f32_bf16 v118, v26, s83, v118
    v_dot2_f32_bf16 v119, v27, s83, v119
    v_dot2_f32_bf16 v120, v26, s64, v120
    v_dot2_f32_bf16 v121, v27, s64, v121
    v_dot2_f32_bf16 v122, v26, s65, v122
    v_dot2_f32_bf16 v123, v27, s65, v123
    v_dot2_f32_bf16 v124, v26, s66, v124
    v_dot2_f32_bf16 v125, v27, s66, v125
    v_dot2_f32_bf16 v126, v26, s67, v126
    v_dot2_f32_bf16 v127, v27, s67, v127
L_p2_gd:
    s_cmp_lg_u32 s13, 15
    s_cbranch_scc1 L_p2_nosig
    s_waitcnt vmcnt(0)
    v_readfirstlane_b32 s15, v9
    s_lshl_b32 s51, 1, s12
    s_add_u32 s20, s20, s15
    s_and_b32 s15, s20, 0xff
    s_cmp_eq_u32 s15, 4
    s_cbranch_scc0 L_p2_notlast
    s_bfe_u32 s15, s20, 262160
    s_or_b32 s51, s51, s15
    s_branch L_p2_pub
L_p2_notlast:
    s_cmp_lg_u32 s21, 0
    s_cselect_b32 s51, 0, s51
    s_cbranch_scc1 L_p2_pub
L_p2_poll:
    v_mov_b32 v9, 0
    s_lshl_b32 s14, s3, 8
    s_add_u32 s14, s14, 8523776
    s_mov_b64 exec, 1
    buffer_atomic_add v9, off, s[4:7], s14 sc0
    s_mov_b64 exec, -1
    s_waitcnt vmcnt(0)
    v_readfirstlane_b32 s20, v9
    s_nop 0
    s_and_b32 s15, s20, 0xff
    s_cmp_lt_u32 s15, 4
    s_cbranch_scc1 L_p2_poll
L_p2_pub:
    s_lshl_b32 s15, s51, 24
    s_or_b32 s15, s15, s20
    v_mov_b32 v9, s15
    s_mov_b64 exec, 1
    ds_write_b32 v8, v9
    s_mov_b64 exec, -1
    s_waitcnt lgkmcnt(0)
L_p2_nosig:
    s_barrier
    ds_read_b32 v9, v8
    s_waitcnt lgkmcnt(0)
    v_readfirstlane_b32 s20, v9
    s_nop 0
    s_lshr_b32 s51, s20, 24
    s_cbranch_scc0 L_p2_end
L_p2_fin:
    s_mul_i32 s24, s49, 19968
    s_add_u32 s14, s12, 1
    s_and_b32 s14, s14, 3
    s_mul_i32 s15, s14, 5120000
    s_add_u32 s15, s15, 228589568
    s_add_u32 s15, s15, s26
    buffer_load_dwordx4 v[12:15], v1, s[4:7], s15 offen sc1
    buffer_load_dwordx4 v[92:95], v2, s[4:7], s15 offen sc1
    s_add_u32 s14, s12, 2
    s_and_b32 s14, s14, 3
    s_mul_i32 s15, s14, 5120000
    s_add_u32 s15, s15, 228589568
    s_add_u32 s15, s15, s26
    buffer_load_dwordx4 v[16:19], v1, s[4:7], s15 offen sc1
    buffer_load_dwordx4 v[96:99], v2, s[4:7], s15 offen sc1
    s_add_u32 s14, s12, 3
    s_and_b32 s14, s14, 3
    s_mul_i32 s15, s14, 5120000
    s_add_u32 s15, s15, 228589568
    s_add_u32 s15, s15, s26
    buffer_load_dwordx4 v[20:23], v1, s[4:7], s15 offen sc1
    buffer_load_dwordx4 v[100:103], v2, s[4:7], s15 offen sc1
    v_add_u32 v24, s24, v1
    ds_read_b128 v[8:11], v24
    v_add_u32 v25, s24, v2
    ds_read_b128 v[88:91], v25
    s_waitcnt vmcnt(0) lgkmcnt(0)
    s_bfe_u32 s14, s20, 262164
    s_cbranch_scc0 L_p2_kernel_nof32a_10
    s_add_u32 s14, s12, 0
    s_and_b32 s14, s14, 3
    s_add_u32 s14, s14, 20
    s_bitcmp1_b32 s20, s14
    s_cbranch_scc0 L_p2_kernel_q_11
    v_mov_b32 v8, 1073758208
    v_mov_b32 v9, 1073758208
    v_mov_b32 v10, 1073758208
    v_mov_b32 v11, 1073758208
L_p2_kernel_q_11:
    s_add_u32 s14, s12, 1
    s_and_b32 s14, s14, 3
    s_add_u32 s14, s14, 20
    s_bitcmp1_b32 s20, s14
    s_cbranch_scc0 L_p2_kernel_q_12
    v_mov_b32 v12, 1073758208
    v_mov_b32 v13, 1073758208
    v_mov_b32 v14, 1073758208
    v_mov_b32 v15, 1073758208
L_p2_kernel_q_12:
    s_add_u32 s14, s12, 2
    s_and_b32 s14, s14, 3
    s_add_u32 s14, s14, 20
    s_bitcmp1_b32 s20, s14
    s_cbranch_scc0 L_p2_kernel_q_13
    v_mov_b32 v16, 1073758208
    v_mov_b32 v17, 1073758208
    v_mov_b32 v18, 1073758208
    v_mov_b32 v19, 1073758208
L_p2_kernel_q_13:
    s_add_u32 s14, s12, 3
    s_and_b32 s14, s14, 3
    s_add_u32 s14, s14, 20
    s_bitcmp1_b32 s20, s14
    s_cbranch_scc0 L_p2_kernel_q_14
    v_mov_b32 v20, 1073758208
    v_mov_b32 v21, 1073758208
    v_mov_b32 v22, 1073758208
    v_mov_b32 v23, 1073758208
L_p2_kernel_q_14:
L_p2_kernel_nof32a_10:
    v_pk_add_u16 v8, v8, v12
    v_pk_add_u16 v16, v16, v20
    v_pk_add_u16 v9, v9, v13
    v_pk_add_u16 v17, v17, v21
    v_pk_add_u16 v10, v10, v14
    v_pk_add_u16 v18, v18, v22
    v_pk_add_u16 v11, v11, v15
    v_pk_add_u16 v19, v19, v23
    v_add_u32_sdwa v24, v8, v16 dst_sel:DWORD dst_unused:UNUSED_PAD src0_sel:WORD_0 src1_sel:WORD_0
    v_add_u32_sdwa v25, v10, v18 dst_sel:DWORD dst_unused:UNUSED_PAD src0_sel:WORD_0 src1_sel:WORD_0
    v_add_u32_sdwa v26, v8, v16 dst_sel:DWORD dst_unused:UNUSED_PAD src0_sel:WORD_1 src1_sel:WORD_1
    v_add_u32_sdwa v27, v10, v18 dst_sel:DWORD dst_unused:UNUSED_PAD src0_sel:WORD_1 src1_sel:WORD_1
    v_add_u32_sdwa v28, v9, v17 dst_sel:DWORD dst_unused:UNUSED_PAD src0_sel:WORD_0 src1_sel:WORD_0
    v_add_u32_sdwa v29, v11, v19 dst_sel:DWORD dst_unused:UNUSED_PAD src0_sel:WORD_0 src1_sel:WORD_0
    v_add_u32_sdwa v30, v9, v17 dst_sel:DWORD dst_unused:UNUSED_PAD src0_sel:WORD_1 src1_sel:WORD_1
    v_add_u32_sdwa v31, v11, v19 dst_sel:DWORD dst_unused:UNUSED_PAD src0_sel:WORD_1 src1_sel:WORD_1
    v_cvt_f32_u32 v24, v24
    v_cvt_f32_u32 v25, v25
    v_cvt_f32_u32 v26, v26
    v_cvt_f32_u32 v27, v27
    v_cvt_f32_u32 v28, v28
    v_cvt_f32_u32 v29, v29
    v_cvt_f32_u32 v30, v30
    v_cvt_f32_u32 v31, v31
    v_pk_fma_f32 v[24:25], v[24:25], s[44:45], s[44:45] op_sel:[0,0,1] op_sel_hi:[1,0,1]
    v_pk_fma_f32 v[26:27], v[26:27], s[44:45], s[44:45] op_sel:[0,0,1] op_sel_hi:[1,0,1]
    v_pk_fma_f32 v[28:29], v[28:29], s[44:45], s[44:45] op_sel:[0,0,1] op_sel_hi:[1,0,1]
    v_pk_fma_f32 v[30:31], v[30:31], s[44:45], s[44:45] op_sel:[0,0,1] op_sel_hi:[1,0,1]
    s_bfe_u32 s14, s20, 262164
    s_cbranch_scc0 L_p2_kernel_nof32b_15
    v_lshlrev_b32 v32, 1, v1
    s_bitcmp1_b32 s20, 20
    s_cbranch_scc0 L_p2_kernel_q_16
    s_lshl_b32 s15, s26, 1
    s_add_u32 s15, s15, 249069568
    buffer_load_dwordx4 v[8:11], v32, s[4:7], s15 offen sc1
    buffer_load_dwordx4 v[12:15], v32, s[4:7], s15 offen offset:16 sc1
    s_waitcnt vmcnt(0)
    v_add_f32 v24, v24, v8
    v_add_f32 v25, v25, v12
    v_add_f32 v26, v26, v9
    v_add_f32 v27, v27, v13
    v_add_f32 v28, v28, v10
    v_add_f32 v29, v29, v14
    v_add_f32 v30, v30, v11
    v_add_f32 v31, v31, v15
L_p2_kernel_q_16:
    s_bitcmp1_b32 s20, 21
    s_cbranch_scc0 L_p2_kernel_q_17
    s_lshl_b32 s15, s26, 1
    s_add_u32 s15, s15, 259309568
    buffer_load_dwordx4 v[8:11], v32, s[4:7], s15 offen sc1
    buffer_load_dwordx4 v[12:15], v32, s[4:7], s15 offen offset:16 sc1
    s_waitcnt vmcnt(0)
    v_add_f32 v24, v24, v8
    v_add_f32 v25, v25, v12
    v_add_f32 v26, v26, v9
    v_add_f32 v27, v27, v13
    v_add_f32 v28, v28, v10
    v_add_f32 v29, v29, v14
    v_add_f32 v30, v30, v11
    v_add_f32 v31, v31, v15
L_p2_kernel_q_17:
    s_bitcmp1_b32 s20, 22
    s_cbranch_scc0 L_p2_kernel_q_18
    s_lshl_b32 s15, s26, 1
    s_add_u32 s15, s15, 269549568
    buffer_load_dwordx4 v[8:11], v32, s[4:7], s15 offen sc1
    buffer_load_dwordx4 v[12:15], v32, s[4:7], s15 offen offset:16 sc1
    s_waitcnt vmcnt(0)
    v_add_f32 v24, v24, v8
    v_add_f32 v25, v25, v12
    v_add_f32 v26, v26, v9
    v_add_f32 v27, v27, v13
    v_add_f32 v28, v28, v10
    v_add_f32 v29, v29, v14
    v_add_f32 v30, v30, v11
    v_add_f32 v31, v31, v15
L_p2_kernel_q_18:
    s_bitcmp1_b32 s20, 23
    s_cbranch_scc0 L_p2_kernel_q_19
    s_lshl_b32 s15, s26, 1
    s_add_u32 s15, s15, 279789568
    buffer_load_dwordx4 v[8:11], v32, s[4:7], s15 offen sc1
    buffer_load_dwordx4 v[12:15], v32, s[4:7], s15 offen offset:16 sc1
    s_waitcnt vmcnt(0)
    v_add_f32 v24, v24, v8
    v_add_f32 v25, v25, v12
    v_add_f32 v26, v26, v9
    v_add_f32 v27, v27, v13
    v_add_f32 v28, v28, v10
    v_add_f32 v29, v29, v14
    v_add_f32 v30, v30, v11
    v_add_f32 v31, v31, v15
L_p2_kernel_q_19:
L_p2_kernel_nof32b_15:
    v_pk_mul_f32 v[8:9], v[24:25], s[84:85] op_sel:[0,0] op_sel_hi:[1,0]
    v_pk_mul_f32 v[10:11], v[24:25], s[84:85] op_sel:[0,1] op_sel_hi:[1,1]
    v_pk_mul_f32 v[12:13], v[24:25], s[86:87] op_sel:[0,0] op_sel_hi:[1,0]
    v_pk_mul_f32 v[14:15], v[24:25], s[86:87] op_sel:[0,1] op_sel_hi:[1,1]
    v_pk_fma_f32 v[8:9], v[26:27], s[88:89], v[8:9] op_sel:[0,0,0] op_sel_hi:[1,0,1]
    v_pk_fma_f32 v[10:11], v[26:27], s[88:89], v[10:11] op_sel:[0,1,0] op_sel_hi:[1,1,1]
    v_pk_fma_f32 v[12:13], v[26:27], s[90:91], v[12:13] op_sel:[0,0,0] op_sel_hi:[1,0,1]
    v_pk_fma_f32 v[14:15], v[26:27], s[90:91], v[14:15] op_sel:[0,1,0] op_sel_hi:[1,1,1]
    v_pk_fma_f32 v[8:9], v[28:29], s[92:93], v[8:9] op_sel:[0,0,0] op_sel_hi:[1,0,1]
    v_pk_fma_f32 v[10:11], v[28:29], s[92:93], v[10:11] op_sel:[0,1,0] op_sel_hi:[1,1,1]
    v_pk_fma_f32 v[12:13], v[28:29], s[94:95], v[12:13] op_sel:[0,0,0] op_sel_hi:[1,0,1]
    v_pk_fma_f32 v[14:15], v[28:29], s[94:95], v[14:15] op_sel:[0,1,0] op_sel_hi:[1,1,1]
    v_pk_fma_f32 v[8:9], v[30:31], s[96:97], v[8:9] op_sel:[0,0,0] op_sel_hi:[1,0,1]
    v_pk_fma_f32 v[10:11], v[30:31], s[96:97], v[10:11] op_sel:[0,1,0] op_sel_hi:[1,1,1]
    v_pk_fma_f32 v[12:13], v[30:31], s[98:99], v[12:13] op_sel:[0,0,0] op_sel_hi:[1,0,1]
    v_pk_fma_f32 v[14:15], v[30:31], s[98:99], v[14:15] op_sel:[0,1,0] op_sel_hi:[1,1,1]
    v_pk_mul_f32 v[8:9], v[8:9], v[72:73]
    v_pk_mul_f32 v[10:11], v[10:11], v[74:75]
    v_pk_mul_f32 v[12:13], v[12:13], v[76:77]
    v_pk_mul_f32 v[14:15], v[14:15], v[78:79]
    v_pk_mul_f32 v[24:25], v[8:9], s[28:29] op_sel:[0,0] op_sel_hi:[1,0]
    v_pk_mul_f32 v[26:27], v[8:9], s[28:29] op_sel:[0,1] op_sel_hi:[1,1]
    v_pk_mul_f32 v[28:29], v[8:9], s[30:31] op_sel:[0,0] op_sel_hi:[1,0]
    v_pk_mul_f32 v[30:31], v[8:9], s[30:31] op_sel:[0,1] op_sel_hi:[1,1]
    v_pk_fma_f32 v[24:25], v[10:11], s[32:33], v[24:25] op_sel:[0,0,0] op_sel_hi:[1,0,1]
    v_pk_fma_f32 v[26:27], v[10:11], s[32:33], v[26:27] op_sel:[0,1,0] op_sel_hi:[1,1,1]
    v_pk_fma_f32 v[28:29], v[10:11], s[34:35], v[28:29] op_sel:[0,0,0] op_sel_hi:[1,0,1]
    v_pk_fma_f32 v[30:31], v[10:11], s[34:35], v[30:31] op_sel:[0,1,0] op_sel_hi:[1,1,1]
    v_pk_fma_f32 v[24:25], v[12:13], s[36:37], v[24:25] op_sel:[0,0,0] op_sel_hi:[1,0,1]
    v_pk_fma_f32 v[26:27], v[12:13], s[36:37], v[26:27] op_sel:[0,1,0] op_sel_hi:[1,1,1]
    v_pk_fma_f32 v[28:29], v[12:13], s[38:39], v[28:29] op_sel:[0,0,0] op_sel_hi:[1,0,1]
    v_pk_fma_f32 v[30:31], v[12:13], s[38:39], v[30:31] op_sel:[0,1,0] op_sel_hi:[1,1,1]
    v_pk_fma_f32 v[24:25], v[14:15], s[40:41], v[24:25] op_sel:[0,0,0] op_sel_hi:[1,0,1]
    v_pk_fma_f32 v[26:27], v[14:15], s[40:41], v[26:27] op_sel:[0,1,0] op_sel_hi:[1,1,1]
    v_pk_fma_f32 v[28:29], v[14:15], s[42:43], v[28:29] op_sel:[0,0,0] op_sel_hi:[1,0,1]
    v_pk_fma_f32 v[30:31], v[14:15], s[42:43], v[30:31] op_sel:[0,1,0] op_sel_hi:[1,1,1]
    v_lshlrev_b32 v8, 16, v64
    v_and_b32 v10, 0xffff0000, v64
    v_lshlrev_b32 v12, 16, v65
    v_and_b32 v14, 0xffff0000, v65
    v_lshlrev_b32 v9, 16, v66
    v_and_b32 v11, 0xffff0000, v66
    v_lshlrev_b32 v13, 16, v67
    v_and_b32 v15, 0xffff0000, v67
    v_pk_fma_f32 v[8:9], v[24:25], v[80:81], v[8:9]
    v_pk_fma_f32 v[10:11], v[26:27], v[82:83], v[10:11]
    v_pk_fma_f32 v[12:13], v[28:29], v[84:85], v[12:13]
    v_pk_fma_f32 v[14:15], v[30:31], v[86:87], v[14:15]
    v_cvt_pk_bf16_f32 v16, v8, v10
    v_cvt_pk_bf16_f32 v17, v12, v14
    v_cvt_pk_bf16_f32 v18, v9, v11
    v_cvt_pk_bf16_f32 v19, v13, v15
    buffer_store_dwordx4 v[16:19], v1, s[16:19], s26 offen
    s_cmp_ge_u32 s13, 4
    s_cbranch_scc1 L_p2_f1
    s_bfe_u32 s14, s20, 262164
    s_cbranch_scc0 L_p2_kernel_nof32a_20
    s_add_u32 s14, s12, 0
    s_and_b32 s14, s14, 3
    s_add_u32 s14, s14, 20
    s_bitcmp1_b32 s20, s14
    s_cbranch_scc0 L_p2_kernel_q_21
    v_mov_b32 v88, 1073758208
    v_mov_b32 v89, 1073758208
    v_mov_b32 v90, 1073758208
    v_mov_b32 v91, 1073758208
L_p2_kernel_q_21:
    s_add_u32 s14, s12, 1
    s_and_b32 s14, s14, 3
    s_add_u32 s14, s14, 20
    s_bitcmp1_b32 s20, s14
    s_cbranch_scc0 L_p2_kernel_q_22
    v_mov_b32 v92, 1073758208
    v_mov_b32 v93, 1073758208
    v_mov_b32 v94, 1073758208
    v_mov_b32 v95, 1073758208
L_p2_kernel_q_22:
    s_add_u32 s14, s12, 2
    s_and_b32 s14, s14, 3
    s_add_u32 s14, s14, 20
    s_bitcmp1_b32 s20, s14
    s_cbranch_scc0 L_p2_kernel_q_23
    v_mov_b32 v96, 1073758208
    v_mov_b32 v97, 1073758208
    v_mov_b32 v98, 1073758208
    v_mov_b32 v99, 1073758208
L_p2_kernel_q_23:
    s_add_u32 s14, s12, 3
    s_and_b32 s14, s14, 3
    s_add_u32 s14, s14, 20
    s_bitcmp1_b32 s20, s14
    s_cbranch_scc0 L_p2_kernel_q_24
    v_mov_b32 v100, 1073758208
    v_mov_b32 v101, 1073758208
    v_mov_b32 v102, 1073758208
    v_mov_b32 v103, 1073758208
L_p2_kernel_q_24:
L_p2_kernel_nof32a_20:
    v_pk_add_u16 v88, v88, v92
    v_pk_add_u16 v96, v96, v100
    v_pk_add_u16 v89, v89, v93
    v_pk_add_u16 v97, v97, v101
    v_pk_add_u16 v90, v90, v94
    v_pk_add_u16 v98, v98, v102
    v_pk_add_u16 v91, v91, v95
    v_pk_add_u16 v99, v99, v103
    v_add_u32_sdwa v24, v88, v96 dst_sel:DWORD dst_unused:UNUSED_PAD src0_sel:WORD_0 src1_sel:WORD_0
    v_add_u32_sdwa v25, v90, v98 dst_sel:DWORD dst_unused:UNUSED_PAD src0_sel:WORD_0 src1_sel:WORD_0
    v_add_u32_sdwa v26, v88, v96 dst_sel:DWORD dst_unused:UNUSED_PAD src0_sel:WORD_1 src1_sel:WORD_1
    v_add_u32_sdwa v27, v90, v98 dst_sel:DWORD dst_unused:UNUSED_PAD src0_sel:WORD_1 src1_sel:WORD_1
    v_add_u32_sdwa v28, v89, v97 dst_sel:DWORD dst_unused:UNUSED_PAD src0_sel:WORD_0 src1_sel:WORD_0
    v_add_u32_sdwa v29, v91, v99 dst_sel:DWORD dst_unused:UNUSED_PAD src0_sel:WORD_0 src1_sel:WORD_0
    v_add_u32_sdwa v30, v89, v97 dst_sel:DWORD dst_unused:UNUSED_PAD src0_sel:WORD_1 src1_sel:WORD_1
    v_add_u32_sdwa v31, v91, v99 dst_sel:DWORD dst_unused:UNUSED_PAD src0_sel:WORD_1 src1_sel:WORD_1
    v_cvt_f32_u32 v24, v24
    v_cvt_f32_u32 v25, v25
    v_cvt_f32_u32 v26, v26
    v_cvt_f32_u32 v27, v27
    v_cvt_f32_u32 v28, v28
    v_cvt_f32_u32 v29, v29
    v_cvt_f32_u32 v30, v30
    v_cvt_f32_u32 v31, v31
    v_pk_fma_f32 v[24:25], v[24:25], s[44:45], s[44:45] op_sel:[0,0,1] op_sel_hi:[1,0,1]
    v_pk_fma_f32 v[26:27], v[26:27], s[44:45], s[44:45] op_sel:[0,0,1] op_sel_hi:[1,0,1]
    v_pk_fma_f32 v[28:29], v[28:29], s[44:45], s[44:45] op_sel:[0,0,1] op_sel_hi:[1,0,1]
    v_pk_fma_f32 v[30:31], v[30:31], s[44:45], s[44:45] op_sel:[0,0,1] op_sel_hi:[1,0,1]
    s_bfe_u32 s14, s20, 262164
    s_cbranch_scc0 L_p2_kernel_nof32b_25
    v_lshlrev_b32 v32, 1, v2
    s_bitcmp1_b32 s20, 20
    s_cbranch_scc0 L_p2_kernel_q_26
    s_lshl_b32 s15, s26, 1
    s_add_u32 s15, s15, 249069568
    buffer_load_dwordx4 v[88:91], v32, s[4:7], s15 offen sc1
    buffer_load_dwordx4 v[92:95], v32, s[4:7], s15 offen offset:16 sc1
    s_waitcnt vmcnt(0)
    v_add_f32 v24, v24, v88
    v_add_f32 v25, v25, v92
    v_add_f32 v26, v26, v89
    v_add_f32 v27, v27, v93
    v_add_f32 v28, v28, v90
    v_add_f32 v29, v29, v94
    v_add_f32 v30, v30, v91
    v_add_f32 v31, v31, v95
L_p2_kernel_q_26:
    s_bitcmp1_b32 s20, 21
    s_cbranch_scc0 L_p2_kernel_q_27
    s_lshl_b32 s15, s26, 1
    s_add_u32 s15, s15, 259309568
    buffer_load_dwordx4 v[88:91], v32, s[4:7], s15 offen sc1
    buffer_load_dwordx4 v[92:95], v32, s[4:7], s15 offen offset:16 sc1
    s_waitcnt vmcnt(0)
    v_add_f32 v24, v24, v88
    v_add_f32 v25, v25, v92
    v_add_f32 v26, v26, v89
    v_add_f32 v27, v27, v93
    v_add_f32 v28, v28, v90
    v_add_f32 v29, v29, v94
    v_add_f32 v30, v30, v91
    v_add_f32 v31, v31, v95
L_p2_kernel_q_27:
    s_bitcmp1_b32 s20, 22
    s_cbranch_scc0 L_p2_kernel_q_28
    s_lshl_b32 s15, s26, 1
    s_add_u32 s15, s15, 269549568
    buffer_load_dwordx4 v[88:91], v32, s[4:7], s15 offen sc1
    buffer_load_dwordx4 v[92:95], v32, s[4:7], s15 offen offset:16 sc1
    s_waitcnt vmcnt(0)
    v_add_f32 v24, v24, v88
    v_add_f32 v25, v25, v92
    v_add_f32 v26, v26, v89
    v_add_f32 v27, v27, v93
    v_add_f32 v28, v28, v90
    v_add_f32 v29, v29, v94
    v_add_f32 v30, v30, v91
    v_add_f32 v31, v31, v95
L_p2_kernel_q_28:
    s_bitcmp1_b32 s20, 23
    s_cbranch_scc0 L_p2_kernel_q_29
    s_lshl_b32 s15, s26, 1
    s_add_u32 s15, s15, 279789568
    buffer_load_dwordx4 v[88:91], v32, s[4:7], s15 offen sc1
    buffer_load_dwordx4 v[92:95], v32, s[4:7], s15 offen offset:16 sc1
    s_waitcnt vmcnt(0)
    v_add_f32 v24, v24, v88
    v_add_f32 v25, v25, v92
    v_add_f32 v26, v26, v89
    v_add_f32 v27, v27, v93
    v_add_f32 v28, v28, v90
    v_add_f32 v29, v29, v94
    v_add_f32 v30, v30, v91
    v_add_f32 v31, v31, v95
L_p2_kernel_q_29:
L_p2_kernel_nof32b_25:
    v_pk_mul_f32 v[88:89], v[24:25], s[84:85] op_sel:[0,0] op_sel_hi:[1,0]
    v_pk_mul_f32 v[90:91], v[24:25], s[84:85] op_sel:[0,1] op_sel_hi:[1,1]
    v_pk_mul_f32 v[92:93], v[24:25], s[86:87] op_sel:[0,0] op_sel_hi:[1,0]
    v_pk_mul_f32 v[94:95], v[24:25], s[86:87] op_sel:[0,1] op_sel_hi:[1,1]
    v_pk_fma_f32 v[88:89], v[26:27], s[88:89], v[88:89] op_sel:[0,0,0] op_sel_hi:[1,0,1]
    v_pk_fma_f32 v[90:91], v[26:27], s[88:89], v[90:91] op_sel:[0,1,0] op_sel_hi:[1,1,1]
    v_pk_fma_f32 v[92:93], v[26:27], s[90:91], v[92:93] op_sel:[0,0,0] op_sel_hi:[1,0,1]
    v_pk_fma_f32 v[94:95], v[26:27], s[90:91], v[94:95] op_sel:[0,1,0] op_sel_hi:[1,1,1]
    v_pk_fma_f32 v[88:89], v[28:29], s[92:93], v[88:89] op_sel:[0,0,0] op_sel_hi:[1,0,1]
    v_pk_fma_f32 v[90:91], v[28:29], s[92:93], v[90:91] op_sel:[0,1,0] op_sel_hi:[1,1,1]
    v_pk_fma_f32 v[92:93], v[28:29], s[94:95], v[92:93] op_sel:[0,0,0] op_sel_hi:[1,0,1]
    v_pk_fma_f32 v[94:95], v[28:29], s[94:95], v[94:95] op_sel:[0,1,0] op_sel_hi:[1,1,1]
    v_pk_fma_f32 v[88:89], v[30:31], s[96:97], v[88:89] op_sel:[0,0,0] op_sel_hi:[1,0,1]
    v_pk_fma_f32 v[90:91], v[30:31], s[96:97], v[90:91] op_sel:[0,1,0] op_sel_hi:[1,1,1]
    v_pk_fma_f32 v[92:93], v[30:31], s[98:99], v[92:93] op_sel:[0,0,0] op_sel_hi:[1,0,1]
    v_pk_fma_f32 v[94:95], v[30:31], s[98:99], v[94:95] op_sel:[0,1,0] op_sel_hi:[1,1,1]
    v_pk_mul_f32 v[88:89], v[88:89], v[112:113]
    v_pk_mul_f32 v[90:91], v[90:91], v[114:115]
    v_pk_mul_f32 v[92:93], v[92:93], v[116:117]
    v_pk_mul_f32 v[94:95], v[94:95], v[118:119]
    v_pk_mul_f32 v[24:25], v[88:89], s[28:29] op_sel:[0,0] op_sel_hi:[1,0]
    v_pk_mul_f32 v[26:27], v[88:89], s[28:29] op_sel:[0,1] op_sel_hi:[1,1]
    v_pk_mul_f32 v[28:29], v[88:89], s[30:31] op_sel:[0,0] op_sel_hi:[1,0]
    v_pk_mul_f32 v[30:31], v[88:89], s[30:31] op_sel:[0,1] op_sel_hi:[1,1]
    v_pk_fma_f32 v[24:25], v[90:91], s[32:33], v[24:25] op_sel:[0,0,0] op_sel_hi:[1,0,1]
    v_pk_fma_f32 v[26:27], v[90:91], s[32:33], v[26:27] op_sel:[0,1,0] op_sel_hi:[1,1,1]
    v_pk_fma_f32 v[28:29], v[90:91], s[34:35], v[28:29] op_sel:[0,0,0] op_sel_hi:[1,0,1]
    v_pk_fma_f32 v[30:31], v[90:91], s[34:35], v[30:31] op_sel:[0,1,0] op_sel_hi:[1,1,1]
    v_pk_fma_f32 v[24:25], v[92:93], s[36:37], v[24:25] op_sel:[0,0,0] op_sel_hi:[1,0,1]
    v_pk_fma_f32 v[26:27], v[92:93], s[36:37], v[26:27] op_sel:[0,1,0] op_sel_hi:[1,1,1]
    v_pk_fma_f32 v[28:29], v[92:93], s[38:39], v[28:29] op_sel:[0,0,0] op_sel_hi:[1,0,1]
    v_pk_fma_f32 v[30:31], v[92:93], s[38:39], v[30:31] op_sel:[0,1,0] op_sel_hi:[1,1,1]
    v_pk_fma_f32 v[24:25], v[94:95], s[40:41], v[24:25] op_sel:[0,0,0] op_sel_hi:[1,0,1]
    v_pk_fma_f32 v[26:27], v[94:95], s[40:41], v[26:27] op_sel:[0,1,0] op_sel_hi:[1,1,1]
    v_pk_fma_f32 v[28:29], v[94:95], s[42:43], v[28:29] op_sel:[0,0,0] op_sel_hi:[1,0,1]
    v_pk_fma_f32 v[30:31], v[94:95], s[42:43], v[30:31] op_sel:[0,1,0] op_sel_hi:[1,1,1]
    v_lshlrev_b32 v88, 16, v68
    v_and_b32 v90, 0xffff0000, v68
    v_lshlrev_b32 v92, 16, v69
    v_and_b32 v94, 0xffff0000, v69
    v_lshlrev_b32 v89, 16, v70
    v_and_b32 v91, 0xffff0000, v70
    v_lshlrev_b32 v93, 16, v71
    v_and_b32 v95, 0xffff0000, v71
    v_pk_fma_f32 v[88:89], v[24:25], v[120:121], v[88:89]
    v_pk_fma_f32 v[90:91], v[26:27], v[122:123], v[90:91]
    v_pk_fma_f32 v[92:93], v[28:29], v[124:125], v[92:93]
    v_pk_fma_f32 v[94:95], v[30:31], v[126:127], v[94:95]
    v_cvt_pk_bf16_f32 v96, v88, v90
    v_cvt_pk_bf16_f32 v97, v92, v94
    v_cvt_pk_bf16_f32 v98, v89, v91
    v_cvt_pk_bf16_f32 v99, v93, v95
    buffer_store_dwordx4 v[96:99], v2, s[16:19], s26 offen
L_p2_f1:
    s_bitset0_b32 s51, s49
    s_cmp_eq_u32 s51, 0
    s_cbranch_scc1 L_p2_done
    s_ff1_i32_b32 s49, s51
    s_mul_i32 s14, s3, 20000
    s_mul_i32 s15, s49, 4992
    s_add_u32 s14, s14, s15
    s_add_u32 s15, s14, 4096
    v_min_u32 v61, 231, v0
    v_lshl_add_u32 v60, v0, 2, s14
    v_lshl_add_u32 v61, v61, 2, s15
    global_load_dword v60, v60, s[100:101] nt
    global_load_dword v61, v61, s[100:101] nt
    s_waitcnt vmcnt(0)
    v_lshlrev_b32 v30, 16, v60
    v_and_b32 v31, 0xffff0000, v60
    v_lshlrev_b32 v36, 16, v53
    v_and_b32 v37, 0xffff0000, v53
    v_lshlrev_b32 v38, 16, v54
    v_and_b32 v39, 0xffff0000, v54
    v_lshlrev_b32 v40, 16, v56
    v_and_b32 v41, 0xffff0000, v56
    v_lshlrev_b32 v42, 16, v57
    v_and_b32 v43, 0xffff0000, v57
    v_pk_add_f32 v[14:15], v[30:31], v[36:37] op_sel:[0,0] op_sel_hi:[1,0] neg_lo:[0,1] neg_hi:[0,1]
    v_pk_add_f32 v[16:17], v[30:31], v[36:37] op_sel:[0,1] op_sel_hi:[1,1] neg_lo:[0,1] neg_hi:[0,1]
    v_pk_add_f32 v[18:19], v[30:31], v[38:39] op_sel:[0,0] op_sel_hi:[1,0] neg_lo:[0,1] neg_hi:[0,1]
    v_pk_add_f32 v[20:21], v[30:31], v[38:39] op_sel:[0,1] op_sel_hi:[1,1] neg_lo:[0,1] neg_hi:[0,1]
    v_pk_add_f32 v[22:23], v[30:31], v[40:41] op_sel:[0,0] op_sel_hi:[1,0] neg_lo:[0,1] neg_hi:[0,1]
    v_pk_add_f32 v[24:25], v[30:31], v[40:41] op_sel:[0,1] op_sel_hi:[1,1] neg_lo:[0,1] neg_hi:[0,1]
    v_pk_add_f32 v[26:27], v[30:31], v[42:43] op_sel:[0,0] op_sel_hi:[1,0] neg_lo:[0,1] neg_hi:[0,1]
    v_pk_add_f32 v[28:29], v[30:31], v[42:43] op_sel:[0,1] op_sel_hi:[1,1] neg_lo:[0,1] neg_hi:[0,1]
    v_cvt_pk_bf16_f32 v32, v14, v15
    v_lshlrev_b32 v14, 16, v32
    v_and_b32 v15, 0xffff0000, v32
    v_cvt_pk_bf16_f32 v32, v16, v17
    v_lshlrev_b32 v16, 16, v32
    v_and_b32 v17, 0xffff0000, v32
    v_cvt_pk_bf16_f32 v32, v18, v19
    v_lshlrev_b32 v18, 16, v32
    v_and_b32 v19, 0xffff0000, v32
    v_cvt_pk_bf16_f32 v32, v20, v21
    v_lshlrev_b32 v20, 16, v32
    v_and_b32 v21, 0xffff0000, v32
    v_cvt_pk_bf16_f32 v32, v22, v23
    v_lshlrev_b32 v22, 16, v32
    v_and_b32 v23, 0xffff0000, v32
    v_cvt_pk_bf16_f32 v32, v24, v25
    v_lshlrev_b32 v24, 16, v32
    v_and_b32 v25, 0xffff0000, v32
    v_cvt_pk_bf16_f32 v32, v26, v27
    v_lshlrev_b32 v26, 16, v32
    v_and_b32 v27, 0xffff0000, v32
    v_cvt_pk_bf16_f32 v32, v28, v29
    v_lshlrev_b32 v28, 16, v32
    v_and_b32 v29, 0xffff0000, v32
    v_pk_mul_f32 v[14:15], v[14:15], v[14:15]
    v_pk_mul_f32 v[16:17], v[16:17], v[16:17]
    v_pk_mul_f32 v[18:19], v[18:19], v[18:19]
    v_pk_mul_f32 v[20:21], v[20:21], v[20:21]
    v_pk_mul_f32 v[22:23], v[22:23], v[22:23]
    v_pk_mul_f32 v[24:25], v[24:25], v[24:25]
    v_pk_mul_f32 v[26:27], v[26:27], v[26:27]
    v_pk_mul_f32 v[28:29], v[28:29], v[28:29]
    v_cvt_pk_bf16_f32 v32, v14, v15
    v_lshlrev_b32 v14, 16, v32
    v_and_b32 v15, 0xffff0000, v32
    v_cvt_pk_bf16_f32 v32, v16, v17
    v_lshlrev_b32 v16, 16, v32
    v_and_b32 v17, 0xffff0000, v32
    v_cvt_pk_bf16_f32 v32, v18, v19
    v_lshlrev_b32 v18, 16, v32
    v_and_b32 v19, 0xffff0000, v32
    v_cvt_pk_bf16_f32 v32, v20, v21
    v_lshlrev_b32 v20, 16, v32
    v_and_b32 v21, 0xffff0000, v32
    v_cvt_pk_bf16_f32 v32, v22, v23
    v_lshlrev_b32 v22, 16, v32
    v_and_b32 v23, 0xffff0000, v32
    v_cvt_pk_bf16_f32 v32, v24, v25
    v_lshlrev_b32 v24, 16, v32
    v_and_b32 v25, 0xffff0000, v32
    v_cvt_pk_bf16_f32 v32, v26, v27
    v_lshlrev_b32 v26, 16, v32
    v_and_b32 v27, 0xffff0000, v32
    v_cvt_pk_bf16_f32 v32, v28, v29
    v_lshlrev_b32 v28, 16, v32
    v_and_b32 v29, 0xffff0000, v32
    v_mov_b32 v30, 1092616192
    v_mov_b32 v31, 0x3fb8aa3b
    v_pk_mul_f32 v[14:15], v[14:15], v[30:31] op_sel:[0,0] op_sel_hi:[1,0]
    v_pk_mul_f32 v[16:17], v[16:17], v[30:31] op_sel:[0,0] op_sel_hi:[1,0]
    v_pk_mul_f32 v[18:19], v[18:19], v[30:31] op_sel:[0,0] op_sel_hi:[1,0]
    v_pk_mul_f32 v[20:21], v[20:21], v[30:31] op_sel:[0,0] op_sel_hi:[1,0]
    v_pk_mul_f32 v[22:23], v[22:23], v[30:31] op_sel:[0,0] op_sel_hi:[1,0]
    v_pk_mul_f32 v[24:25], v[24:25], v[30:31] op_sel:[0,0] op_sel_hi:[1,0]
    v_pk_mul_f32 v[26:27], v[26:27], v[30:31] op_sel:[0,0] op_sel_hi:[1,0]
    v_pk_mul_f32 v[28:29], v[28:29], v[30:31] op_sel:[0,0] op_sel_hi:[1,0]
    v_cvt_pk_bf16_f32 v32, v14, v15
    v_lshlrev_b32 v14, 16, v32
    v_and_b32 v15, 0xffff0000, v32
    v_cvt_pk_bf16_f32 v32, v16, v17
    v_lshlrev_b32 v16, 16, v32
    v_and_b32 v17, 0xffff0000, v32
    v_cvt_pk_bf16_f32 v32, v18, v19
    v_lshlrev_b32 v18, 16, v32
    v_and_b32 v19, 0xffff0000, v32
    v_cvt_pk_bf16_f32 v32, v20, v21
    v_lshlrev_b32 v20, 16, v32
    v_and_b32 v21, 0xffff0000, v32
    v_cvt_pk_bf16_f32 v32, v22, v23
    v_lshlrev_b32 v22, 16, v32
    v_and_b32 v23, 0xffff0000, v32
    v_cvt_pk_bf16_f32 v32, v24, v25
    v_lshlrev_b32 v24, 16, v32
    v_and_b32 v25, 0xffff0000, v32
    v_cvt_pk_bf16_f32 v32, v26, v27
    v_lshlrev_b32 v26, 16, v32
    v_and_b32 v27, 0xffff0000, v32
    v_cvt_pk_bf16_f32 v32, v28, v29
    v_lshlrev_b32 v28, 16, v32
    v_and_b32 v29, 0xffff0000, v32
    v_pk_mul_f32 v[14:15], v[14:15], v[30:31] op_sel:[0,1] op_sel_hi:[1,1]
    v_pk_mul_f32 v[16:17], v[16:17], v[30:31] op_sel:[0,1] op_sel_hi:[1,1]
    v_pk_mul_f32 v[18:19], v[18:19], v[30:31] op_sel:[0,1] op_sel_hi:[1,1]
    v_pk_mul_f32 v[20:21], v[20:21], v[30:31] op_sel:[0,1] op_sel_hi:[1,1]
    v_pk_mul_f32 v[22:23], v[22:23], v[30:31] op_sel:[0,1] op_sel_hi:[1,1]
    v_pk_mul_f32 v[24:25], v[24:25], v[30:31] op_sel:[0,1] op_sel_hi:[1,1]
    v_pk_mul_f32 v[26:27], v[26:27], v[30:31] op_sel:[0,1] op_sel_hi:[1,1]
    v_pk_mul_f32 v[28:29], v[28:29], v[30:31] op_sel:[0,1] op_sel_hi:[1,1]
    v_exp_f32 v14, -v14
    v_exp_f32 v15, -v15
    v_exp_f32 v16, -v16
    v_exp_f32 v17, -v17
    v_exp_f32 v18, -v18
    v_exp_f32 v19, -v19
    v_exp_f32 v20, -v20
    v_exp_f32 v21, -v21
    v_exp_f32 v22, -v22
    v_exp_f32 v23, -v23
    v_exp_f32 v24, -v24
    v_exp_f32 v25, -v25
    v_exp_f32 v26, -v26
    v_exp_f32 v27, -v27
    v_exp_f32 v28, -v28
    v_exp_f32 v29, -v29
    v_cvt_pk_bf16_f32 v14, v14, v16
    v_cvt_pk_bf16_f32 v15, v15, v17
    v_cvt_pk_bf16_f32 v18, v18, v20
    v_cvt_pk_bf16_f32 v19, v19, v21
    v_cvt_pk_bf16_f32 v22, v22, v24
    v_cvt_pk_bf16_f32 v23, v23, v25
    v_cvt_pk_bf16_f32 v26, v26, v28
    v_cvt_pk_bf16_f32 v27, v27, v29
    v_dot2_f32_bf16 v72, v14, s68, 0
    v_dot2_f32_bf16 v73, v15, s68, 0
    v_dot2_f32_bf16 v74, v14, s69, 0
    v_dot2_f32_bf16 v75, v15, s69, 0
    v_dot2_f32_bf16 v76, v14, s70, 0
    v_dot2_f32_bf16 v77, v15, s70, 0
    v_dot2_f32_bf16 v78, v14, s71, 0
    v_dot2_f32_bf16 v79, v15, s71, 0
    v_dot2_f32_bf16 v80, v14, s52, 0
    v_dot2_f32_bf16 v81, v15, s52, 0
    v_dot2_f32_bf16 v82, v14, s53, 0
    v_dot2_f32_bf16 v83, v15, s53, 0
    v_dot2_f32_bf16 v84, v14, s54, 0
    v_dot2_f32_bf16 v85, v15, s54, 0
    v_dot2_f32_bf16 v86, v14, s55, 0
    v_dot2_f32_bf16 v87, v15, s55, 0
    v_dot2_f32_bf16 v72, v18, s72, v72
    v_dot2_f32_bf16 v73, v19, s72, v73
    v_dot2_f32_bf16 v74, v18, s73, v74
    v_dot2_f32_bf16 v75, v19, s73, v75
    v_dot2_f32_bf16 v76, v18, s74, v76
    v_dot2_f32_bf16 v77, v19, s74, v77
    v_dot2_f32_bf16 v78, v18, s75, v78
    v_dot2_f32_bf16 v79, v19, s75, v79
    v_dot2_f32_bf16 v80, v18, s56, v80
    v_dot2_f32_bf16 v81, v19, s56, v81
    v_dot2_f32_bf16 v82, v18, s57, v82
    v_dot2_f32_bf16 v83, v19, s57, v83
    v_dot2_f32_bf16 v84, v18, s58, v84
    v_dot2_f32_bf16 v85, v19, s58, v85
    v_dot2_f32_bf16 v86, v18, s59, v86
    v_dot2_f32_bf16 v87, v19, s59, v87
    v_dot2_f32_bf16 v72, v22, s76, v72
    v_dot2_f32_bf16 v73, v23, s76, v73
    v_dot2_f32_bf16 v74, v22, s77, v74
    v_dot2_f32_bf16 v75, v23, s77, v75
    v_dot2_f32_bf16 v76, v22, s78, v76
    v_dot2_f32_bf16 v77, v23, s78, v77
    v_dot2_f32_bf16 v78, v22, s79, v78
    v_dot2_f32_bf16 v79, v23, s79, v79
    v_dot2_f32_bf16 v80, v22, s60, v80
    v_dot2_f32_bf16 v81, v23, s60, v81
    v_dot2_f32_bf16 v82, v22, s61, v82
    v_dot2_f32_bf16 v83, v23, s61, v83
    v_dot2_f32_bf16 v84, v22, s62, v84
    v_dot2_f32_bf16 v85, v23, s62, v85
    v_dot2_f32_bf16 v86, v22, s63, v86
    v_dot2_f32_bf16 v87, v23, s63, v87
    v_dot2_f32_bf16 v72, v26, s80, v72
    v_dot2_f32_bf16 v73, v27, s80, v73
    v_dot2_f32_bf16 v74, v26, s81, v74
    v_dot2_f32_bf16 v75, v27, s81, v75
    v_dot2_f32_bf16 v76, v26, s82, v76
    v_dot2_f32_bf16 v77, v27, s82, v77
    v_dot2_f32_bf16 v78, v26, s83, v78
    v_dot2_f32_bf16 v79, v27, s83, v79
    v_dot2_f32_bf16 v80, v26, s64, v80
    v_dot2_f32_bf16 v81, v27, s64, v81
    v_dot2_f32_bf16 v82, v26, s65, v82
    v_dot2_f32_bf16 v83, v27, s65, v83
    v_dot2_f32_bf16 v84, v26, s66, v84
    v_dot2_f32_bf16 v85, v27, s66, v85
    v_dot2_f32_bf16 v86, v26, s67, v86
    v_dot2_f32_bf16 v87, v27, s67, v87
    s_cmp_ge_u32 s13, 4
    s_cbranch_scc1 L_p2_kernel_g1_30
    v_lshlrev_b32 v30, 16, v61
    v_and_b32 v31, 0xffff0000, v61
    v_pk_add_f32 v[14:15], v[30:31], v[36:37] op_sel:[0,0] op_sel_hi:[1,0] neg_lo:[0,1] neg_hi:[0,1]
    v_pk_add_f32 v[16:17], v[30:31], v[36:37] op_sel:[0,1] op_sel_hi:[1,1] neg_lo:[0,1] neg_hi:[0,1]
    v_pk_add_f32 v[18:19], v[30:31], v[38:39] op_sel:[0,0] op_sel_hi:[1,0] neg_lo:[0,1] neg_hi:[0,1]
    v_pk_add_f32 v[20:21], v[30:31], v[38:39] op_sel:[0,1] op_sel_hi:[1,1] neg_lo:[0,1] neg_hi:[0,1]
    v_pk_add_f32 v[22:23], v[30:31], v[40:41] op_sel:[0,0] op_sel_hi:[1,0] neg_lo:[0,1] neg_hi:[0,1]
    v_pk_add_f32 v[24:25], v[30:31], v[40:41] op_sel:[0,1] op_sel_hi:[1,1] neg_lo:[0,1] neg_hi:[0,1]
    v_pk_add_f32 v[26:27], v[30:31], v[42:43] op_sel:[0,0] op_sel_hi:[1,0] neg_lo:[0,1] neg_hi:[0,1]
    v_pk_add_f32 v[28:29], v[30:31], v[42:43] op_sel:[0,1] op_sel_hi:[1,1] neg_lo:[0,1] neg_hi:[0,1]
    v_cvt_pk_bf16_f32 v32, v14, v15
    v_lshlrev_b32 v14, 16, v32
    v_and_b32 v15, 0xffff0000, v32
    v_cvt_pk_bf16_f32 v32, v16, v17
    v_lshlrev_b32 v16, 16, v32
    v_and_b32 v17, 0xffff0000, v32
    v_cvt_pk_bf16_f32 v32, v18, v19
    v_lshlrev_b32 v18, 16, v32
    v_and_b32 v19, 0xffff0000, v32
    v_cvt_pk_bf16_f32 v32, v20, v21
    v_lshlrev_b32 v20, 16, v32
    v_and_b32 v21, 0xffff0000, v32
    v_cvt_pk_bf16_f32 v32, v22, v23
    v_lshlrev_b32 v22, 16, v32
    v_and_b32 v23, 0xffff0000, v32
    v_cvt_pk_bf16_f32 v32, v24, v25
    v_lshlrev_b32 v24, 16, v32
    v_and_b32 v25, 0xffff0000, v32
    v_cvt_pk_bf16_f32 v32, v26, v27
    v_lshlrev_b32 v26, 16, v32
    v_and_b32 v27, 0xffff0000, v32
    v_cvt_pk_bf16_f32 v32, v28, v29
    v_lshlrev_b32 v28, 16, v32
    v_and_b32 v29, 0xffff0000, v32
    v_pk_mul_f32 v[14:15], v[14:15], v[14:15]
    v_pk_mul_f32 v[16:17], v[16:17], v[16:17]
    v_pk_mul_f32 v[18:19], v[18:19], v[18:19]
    v_pk_mul_f32 v[20:21], v[20:21], v[20:21]
    v_pk_mul_f32 v[22:23], v[22:23], v[22:23]
    v_pk_mul_f32 v[24:25], v[24:25], v[24:25]
    v_pk_mul_f32 v[26:27], v[26:27], v[26:27]
    v_pk_mul_f32 v[28:29], v[28:29], v[28:29]
    v_cvt_pk_bf16_f32 v32, v14, v15
    v_lshlrev_b32 v14, 16, v32
    v_and_b32 v15, 0xffff0000, v32
    v_cvt_pk_bf16_f32 v32, v16, v17
    v_lshlrev_b32 v16, 16, v32
    v_and_b32 v17, 0xffff0000, v32
    v_cvt_pk_bf16_f32 v32, v18, v19
    v_lshlrev_b32 v18, 16, v32
    v_and_b32 v19, 0xffff0000, v32
    v_cvt_pk_bf16_f32 v32, v20, v21
    v_lshlrev_b32 v20, 16, v32
    v_and_b32 v21, 0xffff0000, v32
    v_cvt_pk_bf16_f32 v32, v22, v23
    v_lshlrev_b32 v22, 16, v32
    v_and_b32 v23, 0xffff0000, v32
    v_cvt_pk_bf16_f32 v32, v24, v25
    v_lshlrev_b32 v24, 16, v32
    v_and_b32 v25, 0xffff0000, v32
    v_cvt_pk_bf16_f32 v32, v26, v27
    v_lshlrev_b32 v26, 16, v32
    v_and_b32 v27, 0xffff0000, v32
    v_cvt_pk_bf16_f32 v32, v28, v29
    v_lshlrev_b32 v28, 16, v32
    v_and_b32 v29, 0xffff0000, v32
    v_mov_b32 v30, 1092616192
    v_mov_b32 v31, 0x3fb8aa3b
    v_pk_mul_f32 v[14:15], v[14:15], v[30:31] op_sel:[0,0] op_sel_hi:[1,0]
    v_pk_mul_f32 v[16:17], v[16:17], v[30:31] op_sel:[0,0] op_sel_hi:[1,0]
    v_pk_mul_f32 v[18:19], v[18:19], v[30:31] op_sel:[0,0] op_sel_hi:[1,0]
    v_pk_mul_f32 v[20:21], v[20:21], v[30:31] op_sel:[0,0] op_sel_hi:[1,0]
    v_pk_mul_f32 v[22:23], v[22:23], v[30:31] op_sel:[0,0] op_sel_hi:[1,0]
    v_pk_mul_f32 v[24:25], v[24:25], v[30:31] op_sel:[0,0] op_sel_hi:[1,0]
    v_pk_mul_f32 v[26:27], v[26:27], v[30:31] op_sel:[0,0] op_sel_hi:[1,0]
    v_pk_mul_f32 v[28:29], v[28:29], v[30:31] op_sel:[0,0] op_sel_hi:[1,0]
    v_cvt_pk_bf16_f32 v32, v14, v15
    v_lshlrev_b32 v14, 16, v32
    v_and_b32 v15, 0xffff0000, v32
    v_cvt_pk_bf16_f32 v32, v16, v17
    v_lshlrev_b32 v16, 16, v32
    v_and_b32 v17, 0xffff0000, v32
    v_cvt_pk_bf16_f32 v32, v18, v19
    v_lshlrev_b32 v18, 16, v32
    v_and_b32 v19, 0xffff0000, v32
    v_cvt_pk_bf16_f32 v32, v20, v21
    v_lshlrev_b32 v20, 16, v32
    v_and_b32 v21, 0xffff0000, v32
    v_cvt_pk_bf16_f32 v32, v22, v23
    v_lshlrev_b32 v22, 16, v32
    v_and_b32 v23, 0xffff0000, v32
    v_cvt_pk_bf16_f32 v32, v24, v25
    v_lshlrev_b32 v24, 16, v32
    v_and_b32 v25, 0xffff0000, v32
    v_cvt_pk_bf16_f32 v32, v26, v27
    v_lshlrev_b32 v26, 16, v32
    v_and_b32 v27, 0xffff0000, v32
    v_cvt_pk_bf16_f32 v32, v28, v29
    v_lshlrev_b32 v28, 16, v32
    v_and_b32 v29, 0xffff0000, v32
    v_pk_mul_f32 v[14:15], v[14:15], v[30:31] op_sel:[0,1] op_sel_hi:[1,1]
    v_pk_mul_f32 v[16:17], v[16:17], v[30:31] op_sel:[0,1] op_sel_hi:[1,1]
    v_pk_mul_f32 v[18:19], v[18:19], v[30:31] op_sel:[0,1] op_sel_hi:[1,1]
    v_pk_mul_f32 v[20:21], v[20:21], v[30:31] op_sel:[0,1] op_sel_hi:[1,1]
    v_pk_mul_f32 v[22:23], v[22:23], v[30:31] op_sel:[0,1] op_sel_hi:[1,1]
    v_pk_mul_f32 v[24:25], v[24:25], v[30:31] op_sel:[0,1] op_sel_hi:[1,1]
    v_pk_mul_f32 v[26:27], v[26:27], v[30:31] op_sel:[0,1] op_sel_hi:[1,1]
    v_pk_mul_f32 v[28:29], v[28:29], v[30:31] op_sel:[0,1] op_sel_hi:[1,1]
    v_exp_f32 v14, -v14
    v_exp_f32 v15, -v15
    v_exp_f32 v16, -v16
    v_exp_f32 v17, -v17
    v_exp_f32 v18, -v18
    v_exp_f32 v19, -v19
    v_exp_f32 v20, -v20
    v_exp_f32 v21, -v21
    v_exp_f32 v22, -v22
    v_exp_f32 v23, -v23
    v_exp_f32 v24, -v24
    v_exp_f32 v25, -v25
    v_exp_f32 v26, -v26
    v_exp_f32 v27, -v27
    v_exp_f32 v28, -v28
    v_exp_f32 v29, -v29
    v_cvt_pk_bf16_f32 v14, v14, v16
    v_cvt_pk_bf16_f32 v15, v15, v17
    v_cvt_pk_bf16_f32 v18, v18, v20
    v_cvt_pk_bf16_f32 v19, v19, v21
    v_cvt_pk_bf16_f32 v22, v22, v24
    v_cvt_pk_bf16_f32 v23, v23, v25
    v_cvt_pk_bf16_f32 v26, v26, v28
    v_cvt_pk_bf16_f32 v27, v27, v29
    v_dot2_f32_bf16 v112, v14, s68, 0
    v_dot2_f32_bf16 v113, v15, s68, 0
    v_dot2_f32_bf16 v114, v14, s69, 0
    v_dot2_f32_bf16 v115, v15, s69, 0
    v_dot2_f32_bf16 v116, v14, s70, 0
    v_dot2_f32_bf16 v117, v15, s70, 0
    v_dot2_f32_bf16 v118, v14, s71, 0
    v_dot2_f32_bf16 v119, v15, s71, 0
    v_dot2_f32_bf16 v120, v14, s52, 0
    v_dot2_f32_bf16 v121, v15, s52, 0
    v_dot2_f32_bf16 v122, v14, s53, 0
    v_dot2_f32_bf16 v123, v15, s53, 0
    v_dot2_f32_bf16 v124, v14, s54, 0
    v_dot2_f32_bf16 v125, v15, s54, 0
    v_dot2_f32_bf16 v126, v14, s55, 0
    v_dot2_f32_bf16 v127, v15, s55, 0
    v_dot2_f32_bf16 v112, v18, s72, v112
    v_dot2_f32_bf16 v113, v19, s72, v113
    v_dot2_f32_bf16 v114, v18, s73, v114
    v_dot2_f32_bf16 v115, v19, s73, v115
    v_dot2_f32_bf16 v116, v18, s74, v116
    v_dot2_f32_bf16 v117, v19, s74, v117
    v_dot2_f32_bf16 v118, v18, s75, v118
    v_dot2_f32_bf16 v119, v19, s75, v119
    v_dot2_f32_bf16 v120, v18, s56, v120
    v_dot2_f32_bf16 v121, v19, s56, v121
    v_dot2_f32_bf16 v122, v18, s57, v122
    v_dot2_f32_bf16 v123, v19, s57, v123
    v_dot2_f32_bf16 v124, v18, s58, v124
    v_dot2_f32_bf16 v125, v19, s58, v125
    v_dot2_f32_bf16 v126, v18, s59, v126
    v_dot2_f32_bf16 v127, v19, s59, v127
    v_dot2_f32_bf16 v112, v22, s76, v112
    v_dot2_f32_bf16 v113, v23, s76, v113
    v_dot2_f32_bf16 v114, v22, s77, v114
    v_dot2_f32_bf16 v115, v23, s77, v115
    v_dot2_f32_bf16 v116, v22, s78, v116
    v_dot2_f32_bf16 v117, v23, s78, v117
    v_dot2_f32_bf16 v118, v22, s79, v118
    v_dot2_f32_bf16 v119, v23, s79, v119
    v_dot2_f32_bf16 v120, v22, s60, v120
    v_dot2_f32_bf16 v121, v23, s60, v121
    v_dot2_f32_bf16 v122, v22, s61, v122
    v_dot2_f32_bf16 v123, v23, s61, v123
    v_dot2_f32_bf16 v124, v22, s62, v124
    v_dot2_f32_bf16 v125, v23, s62, v125
    v_dot2_f32_bf16 v126, v22, s63, v126
    v_dot2_f32_bf16 v127, v23, s63, v127
    v_dot2_f32_bf16 v112, v26, s80, v112
    v_dot2_f32_bf16 v113, v27, s80, v113
    v_dot2_f32_bf16 v114, v26, s81, v114
    v_dot2_f32_bf16 v115, v27, s81, v115
    v_dot2_f32_bf16 v116, v26, s82, v116
    v_dot2_f32_bf16 v117, v27, s82, v117
    v_dot2_f32_bf16 v118, v26, s83, v118
    v_dot2_f32_bf16 v119, v27, s83, v119
    v_dot2_f32_bf16 v120, v26, s64, v120
    v_dot2_f32_bf16 v121, v27, s64, v121
    v_dot2_f32_bf16 v122, v26, s65, v122
    v_dot2_f32_bf16 v123, v27, s65, v123
    v_dot2_f32_bf16 v124, v26, s66, v124
    v_dot2_f32_bf16 v125, v27, s66, v125
    v_dot2_f32_bf16 v126, v26, s67, v126
    v_dot2_f32_bf16 v127, v27, s67, v127
L_p2_kernel_g1_30:
    s_cmp_eq_u32 s49, 3
    s_cselect_b32 s15, 8, 0
    s_add_u32 s15, s15, 224
    v_add_u32 v2, 16384, v1
    v_cmp_gt_u32 vcc, s15, v0
    s_mul_i32 s14, s3, 80000
    s_mul_i32 s26, s49, 19968
    s_add_u32 s26, s26, s14
    v_cndmask_b32 v2, 0.5, v2, vcc
    s_mov_b32 s10, 5120000
    buffer_load_dwordx4 v[64:67], v1, s[8:11], s26 offen
    buffer_load_dwordx4 v[68:71], v2, s[8:11], s26 offen
    s_branch L_p2_fin
L_p2_done:
    s_branch L_p2_end
L_p2_slow:
    s_barrier
    v_mov_b32 v8, 0
    v_mov_b32 v9, 0
    v_mov_b32 v10, 0
    v_mov_b32 v11, 0
    v_mov_b32 v12, v1
    ds_write_b128 v12, v[8:11]
    v_add_u32 v12, 16384, v12
    ds_write_b128 v12, v[8:11]
    v_add_u32 v12, 16384, v12
    ds_write_b128 v12, v[8:11]
    v_add_u32 v12, 16384, v12
    ds_write_b128 v12, v[8:11]
    v_add_u32 v12, 16384, v12
    ds_write_b128 v12, v[8:11]
    v_add_u32 v12, 16384, v12
    ds_write_b128 v12, v[8:11]
    v_add_u32 v12, 16384, v12
    ds_write_b128 v12, v[8:11]
    v_add_u32 v12, 16384, v12
    ds_write_b128 v12, v[8:11]
    v_add_u32 v12, 16384, v12
    ds_write_b128 v12, v[8:11]
    v_add_u32 v12, 16384, v12
    ds_write_b128 v12, v[8:11]
    v_add_u32 v12, 16384, v12
    v_mul_u32_u24 v13, 8320, v0
    v_mov_b32 v29, 0x7fc00000
    v_add_u32 v28, 32, v13
    v_lshlrev_b32 v14, 10, v0
    v_add_u32 v14, 9437184, v14
    s_mul_i32 s25, s12, 65
    s_add_u32 s25, s25, s3
    s_lshl_b32 s25, s25, 5
    s_add_u32 s25, s25, 0
    s_lshl_b32 s50, s50, 1
    s_mul_i32 s22, s12, 1280000
    s_mov_b32 s24, 0
    s_waitcnt lgkmcnt(0)
    s_barrier
L_p2_sstep:
    buffer_load_ushort v15, v13, s[4:7], s25 offen
    buffer_load_ushort v16, v28, s[4:7], s25 offen
    s_waitcnt vmcnt(0)
L_p2_srec:
    v_cmp_lt_u32 vcc, v15, v16
    s_nop 1
    s_and_b64 exec, exec, vcc
    s_cbranch_execz L_p2_sdone
    v_mul_u32_u24 v17, 43691, v15
    v_lshrrev_b32 v17, 17, v17
    v_mad_i32_i24 v18, v17, -3, v15
    v_lshrrev_b32 v19, 6, v17
    v_lshl_add_u32 v19, v19, 20, v14
    v_and_b32 v17, 63, v17
    v_lshl_add_u32 v17, v17, 4, v19
    v_lshl_add_u32 v19, v18, 2, v17
    buffer_load_dword v20, v19, s[4:7], 0 offen
    buffer_load_dword v21, v17, s[4:7], 0 offen offset:12
    v_add_u32 v15, 1, v15
    v_mad_u32_u24 v18, v18, 10, 2
    s_waitcnt vmcnt(0)
    v_and_b32 v19, 0x3fff, v20
    v_lshlrev_b32 v19, 3, v19
    buffer_load_dwordx2 v[22:23], v19, s[8:11], s22 offen
    v_mad_u32_u16 v20, v20, 16, s50 op_sel:[1,0,0,0]
    v_bfe_i32 v21, v21, v18, 10
    v_cmp_eq_i32 vcc, -512, v21
    v_cvt_f32_i32 v21, v21
    v_mul_f32 v21, 989872160, v21
    v_cndmask_b32 v21, v21, v29, vcc
    s_waitcnt vmcnt(0)
    v_lshlrev_b32 v24, 16, v22
    v_and_b32 v25, 0xffff0000, v22
    v_lshlrev_b32 v26, 16, v23
    v_and_b32 v27, 0xffff0000, v23
    v_mul_f32 v24, v21, v24
    v_mul_f32 v25, v21, v25
    v_mul_f32 v26, v21, v26
    v_mul_f32 v27, v21, v27
    ds_add_f32 v20, v24
    ds_add_f32 v20, v25 offset:4
    ds_add_f32 v20, v26 offset:8
    ds_add_f32 v20, v27 offset:12
    s_branch L_p2_srec
L_p2_sdone:
    s_mov_b64 exec, -1
    s_add_u32 s25, s25, 2
    s_add_u32 s22, s22, 80000
    s_add_u32 s24, s24, 1
    s_cmp_lt_u32 s24, 16
    s_cbranch_scc1 L_p2_sstep
    s_waitcnt lgkmcnt(0)
    s_barrier
    s_mul_i32 s14, s12, 10240000
    s_mul_i32 s15, s3, 160000
    s_add_u32 s26, s14, s15
    s_add_u32 s26, s26, 249069568
    v_mov_b32 v12, v1
    s_mov_b32 s24, 0
L_p2_sout:
    v_cmp_gt_u32 vcc, 160000, v12
    ds_read_b128 v[8:11], v12
    s_nop 0
    s_and_b64 exec, exec, vcc
    s_cbranch_execz L_p2_sfin
    s_waitcnt lgkmcnt(0)
    buffer_store_dwordx4 v[8:11], v12, s[4:7], s26 offen sc1
    s_waitcnt vmcnt(0)
    v_add_u32 v12, 16384, v12
    s_branch L_p2_sout
L_p2_sfin:
    s_mov_b64 exec, -1
    s_waitcnt vmcnt(0) lgkmcnt(0)
    s_barrier
    s_branch L_p2_signal
L_p2_end:
    s_endpgm
.section .rodata,"a"
.p2align 6
.amdhsa_kernel p1_kernel
  .amdhsa_next_free_vgpr 128
  .amdhsa_next_free_sgpr 96
  .amdhsa_accum_offset 128
  .amdhsa_group_segment_fixed_size 0
  .amdhsa_kernarg_size 112
  .amdhsa_user_sgpr_count 2
  .amdhsa_user_sgpr_kernarg_segment_ptr 1
  .amdhsa_system_sgpr_workgroup_id_x 1
  .amdhsa_float_denorm_mode_32 0
.end_amdhsa_kernel
.p2align 6
.amdhsa_kernel p2_kernel
  .amdhsa_next_free_vgpr 128
  .amdhsa_next_free_sgpr 102
  .amdhsa_accum_offset 128
  .amdhsa_group_segment_fixed_size 0
  .amdhsa_kernarg_size 112
  .amdhsa_user_sgpr_count 2
  .amdhsa_user_sgpr_kernarg_segment_ptr 1
  .amdhsa_system_sgpr_workgroup_id_x 1
  .amdhsa_float_denorm_mode_32 0
.end_amdhsa_kernel
```

```asm
; @launch kernel=p1_kernel grid=(256,1,1) block=(1024,1,1) lds=163840
; @launch kernel=p2_kernel grid=(256,1,1) block=(1024,1,1) lds=163840
.amdgcn_target "amdgcn-amd-amdhsa--gfx950"
.text
.globl p1_kernel
.p2align 8
.type p1_kernel,@function
p1_kernel:
    s_cmp_ge_u32 s2, 256
    s_cbranch_scc1 L_p1_end
    s_load_dwordx2 s[4:5], s[0:1], 104
    s_load_dwordx2 s[8:9], s[0:1], 8
    s_load_dwordx2 s[12:13], s[0:1], 16
    s_load_dwordx2 s[16:17], s[0:1], 32
    s_load_dwordx2 s[28:29], s[0:1], 0
    s_load_dwordx2 s[6:7], s[0:1], 48
    v_cmp_gt_u32 vcc, 256, v0
    s_nop 1
    s_cbranch_vccz L_p1_nopf
    s_getpc_b64 s[72:73]
L_p1_kernel_pc_1:
    s_add_u32 s72, s72, L_p1_nopf-L_p1_kernel_pc_1
    s_addc_u32 s73, s73, 0
    v_lshlrev_b32 v14, 7, v0
    v_min_u32 v14, L_p2_end-L_p1_nopf, v14
    global_load_dword v15, v14, s[72:73]
L_p1_nopf:
    v_lshlrev_b32 v1, 4, v0
    v_lshlrev_b32 v2, 3, v0
    v_lshrrev_b32 v6, 6, v0
    v_mul_u32_u24 v3, 851904, v6
    v_add_lshl_u32 v3, v3, v0, 4
    v_mov_b32 v4, 1
    v_mov_b32 v5, 0
    v_readfirstlane_b32 s39, v6
    v_cmp_gt_u32 vcc, 784, v0
    s_and_b32 s51, s2, 7
    s_lshl_b32 s51, s51, 0
    s_bfe_u32 s35, s2, 3
    s_add_u32 s51, s51, s35
    s_and_b32 s35, s2, 248
    s_add_u32 s51, s51, s35
    s_and_b32 s32, s2, 7
    s_lshl_b32 s32, s32, 2
    s_bfe_u32 s35, s2, 131075
    s_add_u32 s32, s32, s35
    s_and_b32 s35, s2, 224
    s_add_u32 s32, s32, s35
    s_lshr_b32 s35, s39, 4
    s_mul_i32 s36, s35, 4177920
    s_lshl_b32 s33, s51, 14
    s_add_u32 s33, s33, s36
    s_lshr_b32 s34, s33, 1
    s_mul_i32 s48, s51, 3840
    s_cmp_ge_u32 s35, 0
    s_cselect_b32 s48, s48, 0
    s_lshr_b32 s49, s48, 1
    s_mov_b64 s[44:45], vcc
    s_waitcnt lgkmcnt(0)
    s_load_dword s3, s[6:7], 0
    s_mov_b32 s10, 163840000
    s_mov_b32 s11, 0x00020000
    s_mov_b32 s14, 163840000
    s_mov_b32 s15, 0x00020000
    s_mov_b32 s18, 81920000
    s_mov_b32 s19, 0x00020000
    s_mul_i32 s36, s2, 20000
    s_add_u32 s30, s36, 20000
    s_mov_b32 s31, 0x00020000
    s_add_u32 s35, s36, 16384
    buffer_load_dwordx4 v[48:51], v1, s[28:31], s36 offen
    buffer_load_dwordx4 v[52:55], v1, s[28:31], s35 offen
    s_add_u32 s35, s33, 0
    buffer_load_dwordx4 v[16:19], v1, s[8:11], s35 offen nt
    s_add_u32 s35, s33, 0
    buffer_load_dwordx4 v[20:23], v1, s[12:15], s35 offen nt
    s_add_u32 s35, s33, 4194304
    buffer_load_dwordx4 v[24:27], v1, s[8:11], s35 offen nt
    s_add_u32 s35, s33, 4194304
    buffer_load_dwordx4 v[28:31], v1, s[12:15], s35 offen nt
    s_add_u32 s35, s33, 8388608
    buffer_load_dwordx4 v[32:35], v1, s[8:11], s35 offen nt
    s_add_u32 s35, s33, 8388608
    buffer_load_dwordx4 v[36:39], v1, s[12:15], s35 offen nt
    s_add_u32 s35, s33, 12582912
    buffer_load_dwordx4 v[40:43], v1, s[8:11], s35 offen nt
    s_add_u32 s35, s33, 12582912
    buffer_load_dwordx4 v[44:47], v1, s[12:15], s35 offen nt
    s_add_u32 s35, s33, 16777216
    buffer_load_dwordx4 v[72:75], v1, s[8:11], s35 offen nt
    s_add_u32 s35, s33, 16777216
    buffer_load_dwordx4 v[76:79], v1, s[12:15], s35 offen nt
    s_mov_b32 s20, s4
    s_mov_b32 s21, s5
    s_mov_b32 s22, 0
    s_mov_b32 s23, 0x00020000
    s_add_u32 s24, s4, 0
    s_addc_u32 s25, s5, 0
    s_mov_b32 s26, 8540160
    s_mov_b32 s27, 0x00020000
    s_mov_b32 s37, 1492179184
    s_mov_b32 s55, 0
    s_mov_b64 s[72:73], s[4:5]
    s_mov_b32 s74, 0
    s_mov_b32 s75, 0x00020000
    s_mov_b32 s50, 21845
    s_mov_b32 s52, 0x8000
    s_mov_b32 s38, 262400
    s_mov_b32 s43, 0x05040100
    s_mov_b32 s40, 0
    v_mov_b32 v8, 0
    v_mov_b32 v9, 0
    v_mov_b32 v10, 0
    v_mov_b32 v11, 0
    ds_write_b128 v1, v[8:11] offset:0
    v_min_u32 v7, 16, v0
    v_lshlrev_b32 v7, 2, v7
    v_add_u32 v7, 160768, v7
    ds_write_b32 v7, v8
    s_waitcnt lgkmcnt(0)
    s_lshl_b32 s3, s3, 16
    v_mov_b32 v12, s3
    v_mul_f32 v12, 0.15915494, v12
    s_nop 0
    v_readfirstlane_b32 s41, v12
    s_waitcnt vmcnt(10)
    v_mov_b32 v12, 0x3f803f80
    v_and_b32 v48, 0x7fff7fff, v48
    v_and_b32 v49, 0x7fff7fff, v49
    v_and_b32 v50, 0x7fff7fff, v50
    v_and_b32 v51, 0x7fff7fff, v51
    v_and_b32 v52, 0x7fff7fff, v52
    v_and_b32 v53, 0x7fff7fff, v53
    v_and_b32 v54, 0x7fff7fff, v54
    v_and_b32 v55, 0x7fff7fff, v55
    v_pk_max_u16 v8, v8, v48
    v_dot2c_f32_bf16 v9, v48, v12
    v_pk_max_u16 v8, v8, v49
    v_dot2c_f32_bf16 v9, v49, v12
    v_pk_max_u16 v8, v8, v50
    v_dot2c_f32_bf16 v9, v50, v12
    v_pk_max_u16 v8, v8, v51
    v_dot2c_f32_bf16 v9, v51, v12
    v_pk_max_u16 v8, v8, v52
    v_dot2c_f32_bf16 v9, v52, v12
    v_pk_max_u16 v8, v8, v53
    v_dot2c_f32_bf16 v9, v53, v12
    v_pk_max_u16 v8, v8, v54
    v_dot2c_f32_bf16 v9, v54, v12
    v_pk_max_u16 v8, v8, v55
    v_dot2c_f32_bf16 v9, v55, v12
    v_lshrrev_b32 v10, 16, v8
    v_and_b32 v8, 0xffff, v8
    v_max_u32 v8, v8, v10
    s_nop 0
    s_nop 1
    v_max_u32_dpp v8, v8, v8 row_shr:1 row_mask:0xf bank_mask:0xf bound_ctrl:0
    s_nop 1
    v_max_u32_dpp v8, v8, v8 row_shr:2 row_mask:0xf bank_mask:0xf bound_ctrl:0
    s_nop 1
    v_max_u32_dpp v8, v8, v8 row_shr:4 row_mask:0xf bank_mask:0xf bound_ctrl:0
    s_nop 1
    v_max_u32_dpp v8, v8, v8 row_shr:8 row_mask:0xf bank_mask:0xf bound_ctrl:0
    s_nop 1
    v_max_u32_dpp v8, v8, v8 row_bcast:15 row_mask:0xa bank_mask:0xf
    s_nop 1
    v_max_u32_dpp v8, v8, v8 row_bcast:31 row_mask:0xc bank_mask:0xf
    s_nop 1
    v_add_f32_dpp v9, v9, v9 row_shr:1 row_mask:0xf bank_mask:0xf bound_ctrl:0
    s_nop 1
    v_add_f32_dpp v9, v9, v9 row_shr:2 row_mask:0xf bank_mask:0xf bound_ctrl:0
    s_nop 1
    v_add_f32_dpp v9, v9, v9 row_shr:4 row_mask:0xf bank_mask:0xf bound_ctrl:0
    s_nop 1
    v_add_f32_dpp v9, v9, v9 row_shr:8 row_mask:0xf bank_mask:0xf bound_ctrl:0
    s_nop 1
    v_add_f32_dpp v9, v9, v9 row_bcast:15 row_mask:0xa bank_mask:0xf
    s_nop 1
    v_add_f32_dpp v9, v9, v9 row_bcast:31 row_mask:0xc bank_mask:0xf
    s_lshl_b32 s35, s39, 4
    s_add_u32 s35, s35, 160320
    v_mov_b32 v10, s35
    s_mov_b32 exec_lo, 0
    s_brev_b32 exec_hi, 1
    ds_write_b64 v10, v[8:9]
    s_mov_b64 exec, -1
    s_waitcnt lgkmcnt(0)
    s_barrier
    s_cmp_lg_u32 s39, 0
    s_cbranch_scc1 L_p1_first
    v_and_b32 v6, 15, v0
    v_lshlrev_b32 v6, 4, v6
    v_add_u32 v6, 160320, v6
    ds_read_b64 v[8:9], v6
    s_waitcnt lgkmcnt(0)
    s_nop 1
    v_max_u32_dpp v8, v8, v8 row_shr:1 row_mask:0xf bank_mask:0xf bound_ctrl:0
    s_nop 1
    v_max_u32_dpp v8, v8, v8 row_shr:2 row_mask:0xf bank_mask:0xf bound_ctrl:0
    s_nop 1
    v_max_u32_dpp v8, v8, v8 row_shr:4 row_mask:0xf bank_mask:0xf bound_ctrl:0
    s_nop 1
    v_max_u32_dpp v8, v8, v8 row_shr:8 row_mask:0xf bank_mask:0xf bound_ctrl:0
    s_nop 1
    v_add_f32_dpp v9, v9, v9 row_shr:1 row_mask:0xf bank_mask:0xf bound_ctrl:0
    s_nop 1
    v_add_f32_dpp v9, v9, v9 row_shr:2 row_mask:0xf bank_mask:0xf bound_ctrl:0
    s_nop 1
    v_add_f32_dpp v9, v9, v9 row_shr:4 row_mask:0xf bank_mask:0xf bound_ctrl:0
    s_nop 1
    v_add_f32_dpp v9, v9, v9 row_shr:8 row_mask:0xf bank_mask:0xf bound_ctrl:0
    s_lshl_b32 s35, s2, 3
    s_add_u32 s35, s35, 8519680
    v_mov_b32 v6, 0
    s_mov_b64 exec, 0x8000
    buffer_store_dwordx2 v[8:9], v6, s[24:27], s35 offen sc1
    s_lshl_b32 s35, s2, 8
    s_add_u32 s35, s35, 8523776
    buffer_store_dword v6, v6, s[24:27], s35 offen sc1
    s_mov_b64 exec, -1
    s_branch L_p1_first
L_p1_loop:
    s_mov_b64 s[72:73], s[20:21]
    s_mov_b32 s74, s22
    s_getreg_b32 s51, hwreg(HW_REG_XCC_ID, 0, 1)
    s_cmp_eq_u32 s51, 0
    s_cselect_b64 vcc, -1, 0
    s_cmp_lg_u32 s39, 15
    s_cbranch_scc1 L_p1_kernel_nox_2
    s_waitcnt lgkmcnt(13)
    v_lshlrev_b32 v15, 16, v120
    v_and_b32 v120, 0xffff0000, v120
    v_lshlrev_b32 v121, 16, v121
    v_mul_f32 v15, s41, v15
    v_mul_f32 v120, s41, v120
    v_mul_f32 v121, s41, v121
    v_fract_f32 v15, v15
    v_fract_f32 v120, v120
    v_fract_f32 v121, v121
    v_cos_f32 v15, v15
    v_cos_f32 v120, v120
    v_cos_f32 v121, v121
    v_fmaak_f32 v15, v10, v15, 1262486016
    v_fmaak_f32 v120, v10, v120, 1262486016
    v_fmaak_f32 v121, v10, v121, 1262486016
    v_lshlrev_b32 v15, 22, v15
    v_alignbit_b32 v15, v120, v15, 10
    v_alignbit_b32 v15, v121, v15, 10
    v_xor_b32 v15, 0x80200800, v15
    s_mov_b32 s36, 13631488
    buffer_store_dwordx4 v[12:15], v3, s[20:23], s36 offen sc1
L_p1_kernel_nox_2:
    s_waitcnt lgkmcnt(12)
    v_lshlrev_b32 v75, 16, v122
    v_and_b32 v122, 0xffff0000, v122
    v_lshlrev_b32 v123, 16, v123
    v_mul_f32 v75, s41, v75
    v_mul_f32 v122, s41, v122
    v_mul_f32 v123, s41, v123
    v_fract_f32 v75, v75
    v_fract_f32 v122, v122
    v_fract_f32 v123, v123
    v_cos_f32 v75, v75
    v_cos_f32 v122, v122
    v_cos_f32 v123, v123
    v_fmaak_f32 v75, v10, v75, 1262486016
    v_fmaak_f32 v122, v10, v122, 1262486016
    v_fmaak_f32 v123, v10, v123, 1262486016
    v_lshlrev_b32 v75, 22, v75
    v_alignbit_b32 v75, v122, v75, 10
    v_alignbit_b32 v75, v123, v75, 10
    v_xor_b32 v75, 0x80200800, v75
    s_mov_b32 s36, 0
    buffer_store_dwordx4 v[72:75], v3, s[20:23], s36 offen sc1
    s_waitcnt lgkmcnt(11)
    v_lshlrev_b32 v79, 16, v124
    v_and_b32 v124, 0xffff0000, v124
    v_lshlrev_b32 v125, 16, v125
    v_mul_f32 v79, s41, v79
    v_mul_f32 v124, s41, v124
    v_mul_f32 v125, s41, v125
    v_fract_f32 v79, v79
    v_fract_f32 v124, v124
    v_fract_f32 v125, v125
    v_cos_f32 v79, v79
    v_cos_f32 v124, v124
    v_cos_f32 v125, v125
    v_fmaak_f32 v79, v10, v79, 1262486016
    v_fmaak_f32 v124, v10, v124, 1262486016
    v_fmaak_f32 v125, v10, v125, 1262486016
    v_lshlrev_b32 v79, 22, v79
    v_alignbit_b32 v79, v124, v79, 10
    v_alignbit_b32 v79, v125, v79, 10
    v_xor_b32 v79, 0x80200800, v79
    s_mov_b32 s36, 1048576
    buffer_store_dwordx4 v[76:79], v3, s[20:23], s36 offen sc1
    s_waitcnt lgkmcnt(0)
    v_lshlrev_b32 v51, 16, v126
    v_and_b32 v126, 0xffff0000, v126
    v_lshlrev_b32 v127, 16, v127
    v_mul_f32 v51, s41, v51
    v_mul_f32 v126, s41, v126
    v_mul_f32 v127, s41, v127
    v_fract_f32 v51, v51
    v_fract_f32 v126, v126
    v_fract_f32 v127, v127
    v_cos_f32 v51, v51
    v_cos_f32 v126, v126
    v_cos_f32 v127, v127
    v_fmaak_f32 v51, v10, v51, 1262486016
    v_fmaak_f32 v126, v10, v126, 1262486016
    v_fmaak_f32 v127, v10, v127, 1262486016
    v_lshlrev_b32 v51, 22, v51
    v_alignbit_b32 v51, v126, v51, 10
    v_alignbit_b32 v51, v127, v51, 10
    v_xor_b32 v51, 0x80200800, v51
    s_mov_b32 s36, 2097152
    buffer_store_dwordx4 v[48:51], v3, s[20:23], s36 offen sc1
    s_add_u32 s35, s33, 16777216
    buffer_load_dwordx4 v[72:75], v1, s[8:11], s35 offen nt
    s_add_u32 s35, s33, 16777216
    buffer_load_dwordx4 v[76:79], v1, s[12:15], s35 offen nt
    s_cbranch_vccz L_p1_kernel_thr_3
    s_waitcnt vmcnt(2)
L_p1_kernel_thr_3:
    s_waitcnt vmcnt(11)
    v_perm_b32 v6, v20, v16, s43
    v_perm_b32 v7, v21, v17, s43
    v_perm_b32 v8, v22, v18, s43
    v_perm_b32 v9, v23, v19, s43
    v_mul_hi_u32_u24 v16, 429497, v16
    v_mul_hi_u32_u24 v20, 429497, v20
    v_mul_hi_u32_u24 v17, 429497, v17
    v_mul_hi_u32_u24 v21, 429497, v21
    v_mul_hi_u32_u24 v18, 429497, v18
    v_mul_hi_u32_u24 v22, 429497, v22
    v_mul_hi_u32_u24 v19, 429497, v19
    v_mul_hi_u32_u24 v23, 429497, v23
    v_lshl_or_b32 v16, v20, 16, v16
    v_lshl_or_b32 v17, v21, 16, v17
    v_lshl_or_b32 v18, v22, 16, v18
    v_lshl_or_b32 v19, v23, 16, v19
    v_dot2_u32_u16 v20, v16, s38, 0
    v_dot2_u32_u16 v21, v17, s38, 0
    v_dot2_u32_u16 v22, v18, s38, 0
    v_dot2_u32_u16 v23, v19, s38, 0
    v_pk_mad_u16 v6, v16, s37, v6
    v_pk_mad_u16 v7, v17, s37, v7
    v_pk_mad_u16 v8, v18, s37, v8
    v_pk_mad_u16 v9, v19, s37, v9
    ds_add_u32 v20, v4 offset:0
    ds_add_u32 v21, v4 offset:0
    ds_add_u32 v22, v4 offset:0
    ds_add_u32 v23, v4 offset:0
    v_pk_mad_u16 v6, v16, s52, v6 op_sel:[1,0,0] op_sel_hi:[1,1,1]
    v_pk_mad_u16 v7, v17, s52, v7 op_sel:[1,0,0] op_sel_hi:[1,1,1]
    v_pk_mad_u16 v8, v18, s52, v8 op_sel:[1,0,0] op_sel_hi:[1,1,1]
    v_pk_mad_u16 v9, v19, s52, v9 op_sel:[1,0,0] op_sel_hi:[1,1,1]
    v_perm_b32 v121, v23, v22, s43
    v_perm_b32 v120, v21, v20, s43
    v_or_b32 v127, 0x40000000, v6
    v_or_b32 v48, 0x40000000, v7
    v_or_b32 v49, 0x40000000, v8
    v_or_b32 v50, 0x40000000, v9
    v_lshlrev_b32 v83, 16, v100
    v_and_b32 v100, 0xffff0000, v100
    v_lshlrev_b32 v101, 16, v101
    v_mul_f32 v83, s41, v83
    v_mul_f32 v100, s41, v100
    v_mul_f32 v101, s41, v101
    v_fract_f32 v83, v83
    v_fract_f32 v100, v100
    v_fract_f32 v101, v101
    v_cos_f32 v83, v83
    v_cos_f32 v100, v100
    v_cos_f32 v101, v101
    v_fmaak_f32 v83, v10, v83, 1262486016
    v_fmaak_f32 v100, v10, v100, 1262486016
    v_fmaak_f32 v101, v10, v101, 1262486016
    v_lshlrev_b32 v83, 22, v83
    v_alignbit_b32 v83, v100, v83, 10
    v_alignbit_b32 v83, v101, v83, 10
    v_xor_b32 v83, 0x80200800, v83
    s_mov_b32 s36, 3145728
    buffer_store_dwordx4 v[80:83], v3, s[20:23], s36 offen sc1
    v_lshlrev_b32 v55, 16, v102
    v_and_b32 v102, 0xffff0000, v102
    v_lshlrev_b32 v103, 16, v103
    v_mul_f32 v55, s41, v55
    v_mul_f32 v102, s41, v102
    v_mul_f32 v103, s41, v103
    v_fract_f32 v55, v55
    v_fract_f32 v102, v102
    v_fract_f32 v103, v103
    v_cos_f32 v55, v55
    v_cos_f32 v102, v102
    v_cos_f32 v103, v103
    v_fmaak_f32 v55, v10, v55, 1262486016
    v_fmaak_f32 v102, v10, v102, 1262486016
    v_fmaak_f32 v103, v10, v103, 1262486016
    v_lshlrev_b32 v55, 22, v55
    v_alignbit_b32 v55, v102, v55, 10
    v_alignbit_b32 v55, v103, v55, 10
    v_xor_b32 v55, 0x80200800, v55
    s_cmp_lg_u32 s40, 3
    s_cbranch_scc1 L_p1_kernel_now_4
    v_mov_b64 v[16:17], v[52:53]
    v_mov_b64 v[18:19], v[54:55]
    s_branch L_p1_kernel_held_5
L_p1_kernel_now_4:
    s_mov_b32 s36, 4194304
    buffer_store_dwordx4 v[52:55], v3, s[20:23], s36 offen sc1
L_p1_kernel_held_5:
    s_add_u32 s35, s33, 20971520
    buffer_load_dwordx4 v[80:83], v1, s[8:11], s35 offen nt
    s_add_u32 s35, s33, 20971520
    buffer_load_dwordx4 v[100:103], v1, s[12:15], s35 offen nt
    s_cbranch_vccz L_p1_kernel_thr_6
    s_waitcnt vmcnt(2)
L_p1_kernel_thr_6:
    v_lshlrev_b32 v87, 16, v104
    v_and_b32 v104, 0xffff0000, v104
    v_lshlrev_b32 v105, 16, v105
    v_mul_f32 v87, s41, v87
    v_mul_f32 v104, s41, v104
    v_mul_f32 v105, s41, v105
    v_fract_f32 v87, v87
    v_fract_f32 v104, v104
    v_fract_f32 v105, v105
    v_cos_f32 v87, v87
    v_cos_f32 v104, v104
    v_cos_f32 v105, v105
    v_fmaak_f32 v87, v10, v87, 1262486016
    v_fmaak_f32 v104, v10, v104, 1262486016
    v_fmaak_f32 v105, v10, v105, 1262486016
    v_lshlrev_b32 v87, 22, v87
    v_alignbit_b32 v87, v104, v87, 10
    v_alignbit_b32 v87, v105, v87, 10
    v_xor_b32 v87, 0x80200800, v87
    s_mov_b32 s36, 5242880
    buffer_store_dwordx4 v[84:87], v3, s[20:23], s36 offen sc1
    v_lshlrev_b32 v59, 16, v106
    v_and_b32 v106, 0xffff0000, v106
    v_lshlrev_b32 v107, 16, v107
    v_mul_f32 v59, s41, v59
    v_mul_f32 v106, s41, v106
    v_mul_f32 v107, s41, v107
    v_fract_f32 v59, v59
    v_fract_f32 v106, v106
    v_fract_f32 v107, v107
    v_cos_f32 v59, v59
    v_cos_f32 v106, v106
    v_cos_f32 v107, v107
    v_fmaak_f32 v59, v10, v59, 1262486016
    v_fmaak_f32 v106, v10, v106, 1262486016
    v_fmaak_f32 v107, v10, v107, 1262486016
    v_lshlrev_b32 v59, 22, v59
    v_alignbit_b32 v59, v106, v59, 10
    v_alignbit_b32 v59, v107, v59, 10
    v_xor_b32 v59, 0x80200800, v59
    s_cmp_lg_u32 s40, 3
    s_cbranch_scc1 L_p1_kernel_now_7
    v_mov_b64 v[20:21], v[56:57]
    v_mov_b64 v[22:23], v[58:59]
    s_branch L_p1_kernel_held_8
L_p1_kernel_now_7:
    s_mov_b32 s36, 6291456
    buffer_store_dwordx4 v[56:59], v3, s[20:23], s36 offen sc1
L_p1_kernel_held_8:
    s_add_u32 s35, s33, 25165824
    buffer_load_dwordx4 v[84:87], v1, s[8:11], s35 offen nt
    s_add_u32 s35, s33, 25165824
    buffer_load_dwordx4 v[104:107], v1, s[12:15], s35 offen nt
    s_cbranch_vccz L_p1_kernel_thr_9
    s_waitcnt vmcnt(2)
L_p1_kernel_thr_9:
    s_waitcnt vmcnt(15)
    v_perm_b32 v6, v28, v24, s43
    v_perm_b32 v7, v29, v25, s43
    v_perm_b32 v8, v30, v26, s43
    v_perm_b32 v9, v31, v27, s43
    v_mul_hi_u32_u24 v24, 429497, v24
    v_mul_hi_u32_u24 v28, 429497, v28
    v_mul_hi_u32_u24 v25, 429497, v25
    v_mul_hi_u32_u24 v29, 429497, v29
    v_mul_hi_u32_u24 v26, 429497, v26
    v_mul_hi_u32_u24 v30, 429497, v30
    v_mul_hi_u32_u24 v27, 429497, v27
    v_mul_hi_u32_u24 v31, 429497, v31
    v_lshl_or_b32 v24, v28, 16, v24
    v_lshl_or_b32 v25, v29, 16, v25
    v_lshl_or_b32 v26, v30, 16, v26
    v_lshl_or_b32 v27, v31, 16, v27
    v_dot2_u32_u16 v28, v24, s38, 0
    v_dot2_u32_u16 v29, v25, s38, 0
    v_dot2_u32_u16 v30, v26, s38, 0
    v_dot2_u32_u16 v31, v27, s38, 0
    v_pk_mad_u16 v6, v24, s37, v6
    v_pk_mad_u16 v7, v25, s37, v7
    v_pk_mad_u16 v8, v26, s37, v8
    v_pk_mad_u16 v9, v27, s37, v9
    ds_add_u32 v28, v4 offset:0
    ds_add_u32 v29, v4 offset:0
    ds_add_u32 v30, v4 offset:0
    ds_add_u32 v31, v4 offset:0
    v_pk_mad_u16 v6, v24, s52, v6 op_sel:[1,0,0] op_sel_hi:[1,1,1]
    v_pk_mad_u16 v7, v25, s52, v7 op_sel:[1,0,0] op_sel_hi:[1,1,1]
    v_pk_mad_u16 v8, v26, s52, v8 op_sel:[1,0,0] op_sel_hi:[1,1,1]
    v_pk_mad_u16 v9, v27, s52, v9 op_sel:[1,0,0] op_sel_hi:[1,1,1]
    v_perm_b32 v123, v31, v30, s43
    v_perm_b32 v122, v29, v28, s43
    v_or_b32 v52, 0x40000000, v6
    v_or_b32 v53, 0x40000000, v7
    v_or_b32 v54, 0x40000000, v8
    v_or_b32 v56, 0x40000000, v9
    v_lshlrev_b32 v91, 16, v108
    v_and_b32 v108, 0xffff0000, v108
    v_lshlrev_b32 v109, 16, v109
    v_mul_f32 v91, s41, v91
    v_mul_f32 v108, s41, v108
    v_mul_f32 v109, s41, v109
    v_fract_f32 v91, v91
    v_fract_f32 v108, v108
    v_fract_f32 v109, v109
    v_cos_f32 v91, v91
    v_cos_f32 v108, v108
    v_cos_f32 v109, v109
    v_fmaak_f32 v91, v10, v91, 1262486016
    v_fmaak_f32 v108, v10, v108, 1262486016
    v_fmaak_f32 v109, v10, v109, 1262486016
    v_lshlrev_b32 v91, 22, v91
    v_alignbit_b32 v91, v108, v91, 10
    v_alignbit_b32 v91, v109, v91, 10
    v_xor_b32 v91, 0x80200800, v91
    s_cmp_lg_u32 s40, 3
    s_cbranch_scc1 L_p1_kernel_now_10
    v_mov_b64 v[24:25], v[88:89]
    v_mov_b64 v[26:27], v[90:91]
    s_branch L_p1_kernel_held_11
L_p1_kernel_now_10:
    s_mov_b32 s36, 7340032
    buffer_store_dwordx4 v[88:91], v3, s[20:23], s36 offen sc1
L_p1_kernel_held_11:
    v_lshlrev_b32 v63, 16, v110
    v_and_b32 v110, 0xffff0000, v110
    v_lshlrev_b32 v111, 16, v111
    v_mul_f32 v63, s41, v63
    v_mul_f32 v110, s41, v110
    v_mul_f32 v111, s41, v111
    v_fract_f32 v63, v63
    v_fract_f32 v110, v110
    v_fract_f32 v111, v111
    v_cos_f32 v63, v63
    v_cos_f32 v110, v110
    v_cos_f32 v111, v111
    v_fmaak_f32 v63, v10, v63, 1262486016
    v_fmaak_f32 v110, v10, v110, 1262486016
    v_fmaak_f32 v111, v10, v111, 1262486016
    v_lshlrev_b32 v63, 22, v63
    v_alignbit_b32 v63, v110, v63, 10
    v_alignbit_b32 v63, v111, v63, 10
    v_xor_b32 v63, 0x80200800, v63
    s_cmp_lg_u32 s40, 3
    s_cbranch_scc1 L_p1_kernel_now_12
    v_mov_b64 v[28:29], v[60:61]
    v_mov_b64 v[30:31], v[62:63]
    s_branch L_p1_kernel_held_13
L_p1_kernel_now_12:
    s_mov_b32 s36, 8388608
    buffer_store_dwordx4 v[60:63], v3, s[20:23], s36 offen sc1
L_p1_kernel_held_13:
    s_add_u32 s35, s33, 29360128
    buffer_load_dwordx4 v[88:91], v1, s[8:11], s35 offen nt
    s_add_u32 s35, s33, 29360128
    buffer_load_dwordx4 v[108:111], v1, s[12:15], s35 offen nt
    s_cbranch_vccz L_p1_kernel_thr_14
    s_waitcnt vmcnt(2)
L_p1_kernel_thr_14:
    s_waitcnt vmcnt(15)
    v_perm_b32 v6, v36, v32, s43
    v_perm_b32 v7, v37, v33, s43
    v_perm_b32 v8, v38, v34, s43
    v_perm_b32 v9, v39, v35, s43
    v_mul_hi_u32_u24 v32, 429497, v32
    v_mul_hi_u32_u24 v36, 429497, v36
    v_mul_hi_u32_u24 v33, 429497, v33
    v_mul_hi_u32_u24 v37, 429497, v37
    v_mul_hi_u32_u24 v34, 429497, v34
    v_mul_hi_u32_u24 v38, 429497, v38
    v_mul_hi_u32_u24 v35, 429497, v35
    v_mul_hi_u32_u24 v39, 429497, v39
    v_lshl_or_b32 v32, v36, 16, v32
    v_lshl_or_b32 v33, v37, 16, v33
    v_lshl_or_b32 v34, v38, 16, v34
    v_lshl_or_b32 v35, v39, 16, v35
    v_dot2_u32_u16 v36, v32, s38, 0
    v_dot2_u32_u16 v37, v33, s38, 0
    v_dot2_u32_u16 v38, v34, s38, 0
    v_dot2_u32_u16 v39, v35, s38, 0
    v_pk_mad_u16 v6, v32, s37, v6
    v_pk_mad_u16 v7, v33, s37, v7
    v_pk_mad_u16 v8, v34, s37, v8
    v_pk_mad_u16 v9, v35, s37, v9
    ds_add_u32 v36, v4 offset:0
    ds_add_u32 v37, v4 offset:0
    ds_add_u32 v38, v4 offset:0
    ds_add_u32 v39, v4 offset:0
    v_pk_mad_u16 v6, v32, s52, v6 op_sel:[1,0,0] op_sel_hi:[1,1,1]
    v_pk_mad_u16 v7, v33, s52, v7 op_sel:[1,0,0] op_sel_hi:[1,1,1]
    v_pk_mad_u16 v8, v34, s52, v8 op_sel:[1,0,0] op_sel_hi:[1,1,1]
    v_pk_mad_u16 v9, v35, s52, v9 op_sel:[1,0,0] op_sel_hi:[1,1,1]
    v_perm_b32 v125, v39, v38, s43
    v_perm_b32 v124, v37, v36, s43
    v_or_b32 v57, 0x40000000, v6
    v_or_b32 v58, 0x40000000, v7
    v_or_b32 v60, 0x40000000, v8
    v_or_b32 v61, 0x40000000, v9
    v_lshlrev_b32 v95, 16, v112
    v_and_b32 v112, 0xffff0000, v112
    v_lshlrev_b32 v113, 16, v113
    v_mul_f32 v95, s41, v95
    v_mul_f32 v112, s41, v112
    v_mul_f32 v113, s41, v113
    v_fract_f32 v95, v95
    v_fract_f32 v112, v112
    v_fract_f32 v113, v113
    v_cos_f32 v95, v95
    v_cos_f32 v112, v112
    v_cos_f32 v113, v113
    v_fmaak_f32 v95, v10, v95, 1262486016
    v_fmaak_f32 v112, v10, v112, 1262486016
    v_fmaak_f32 v113, v10, v113, 1262486016
    v_lshlrev_b32 v95, 22, v95
    v_alignbit_b32 v95, v112, v95, 10
    v_alignbit_b32 v95, v113, v95, 10
    v_xor_b32 v95, 0x80200800, v95
    s_cmp_lg_u32 s40, 3
    s_cbranch_scc1 L_p1_kernel_now_15
    v_mov_b64 v[32:33], v[92:93]
    v_mov_b64 v[34:35], v[94:95]
    s_branch L_p1_kernel_held_16
L_p1_kernel_now_15:
    s_mov_b32 s36, 9437184
    buffer_store_dwordx4 v[92:95], v3, s[20:23], s36 offen sc1
L_p1_kernel_held_16:
    v_lshlrev_b32 v67, 16, v114
    v_and_b32 v114, 0xffff0000, v114
    v_lshlrev_b32 v115, 16, v115
    v_mul_f32 v67, s41, v67
    v_mul_f32 v114, s41, v114
    v_mul_f32 v115, s41, v115
    v_fract_f32 v67, v67
    v_fract_f32 v114, v114
    v_fract_f32 v115, v115
    v_cos_f32 v67, v67
    v_cos_f32 v114, v114
    v_cos_f32 v115, v115
    v_fmaak_f32 v67, v10, v67, 1262486016
    v_fmaak_f32 v114, v10, v114, 1262486016
    v_fmaak_f32 v115, v10, v115, 1262486016
    v_lshlrev_b32 v67, 22, v67
    v_alignbit_b32 v67, v114, v67, 10
    v_alignbit_b32 v67, v115, v67, 10
    v_xor_b32 v67, 0x80200800, v67
    s_cmp_lg_u32 s40, 3
    s_cbranch_scc1 L_p1_kernel_now_17
    v_mov_b64 v[36:37], v[64:65]
    v_mov_b64 v[38:39], v[66:67]
    s_branch L_p1_kernel_held_18
L_p1_kernel_now_17:
    s_mov_b32 s36, 10485760
    buffer_store_dwordx4 v[64:67], v3, s[20:23], s36 offen sc1
L_p1_kernel_held_18:
    s_add_u32 s35, s33, 33554432
    buffer_load_dwordx4 v[92:95], v1, s[8:11], s35 offen nt
    s_add_u32 s35, s33, 33554432
    buffer_load_dwordx4 v[112:115], v1, s[12:15], s35 offen nt
    s_cbranch_vccz L_p1_kernel_thr_19
    s_waitcnt vmcnt(2)
L_p1_kernel_thr_19:
    s_waitcnt vmcnt(15)
    v_perm_b32 v6, v44, v40, s43
    v_perm_b32 v7, v45, v41, s43
    v_perm_b32 v8, v46, v42, s43
    v_perm_b32 v9, v47, v43, s43
    v_mul_hi_u32_u24 v40, 429497, v40
    v_mul_hi_u32_u24 v44, 429497, v44
    v_mul_hi_u32_u24 v41, 429497, v41
    v_mul_hi_u32_u24 v45, 429497, v45
    v_mul_hi_u32_u24 v42, 429497, v42
    v_mul_hi_u32_u24 v46, 429497, v46
    v_mul_hi_u32_u24 v43, 429497, v43
    v_mul_hi_u32_u24 v47, 429497, v47
    v_lshl_or_b32 v40, v44, 16, v40
    v_lshl_or_b32 v41, v45, 16, v41
    v_lshl_or_b32 v42, v46, 16, v42
    v_lshl_or_b32 v43, v47, 16, v43
    v_dot2_u32_u16 v44, v40, s38, 0
    v_dot2_u32_u16 v45, v41, s38, 0
    v_dot2_u32_u16 v46, v42, s38, 0
    v_dot2_u32_u16 v47, v43, s38, 0
    v_pk_mad_u16 v6, v40, s37, v6
    v_pk_mad_u16 v7, v41, s37, v7
    v_pk_mad_u16 v8, v42, s37, v8
    v_pk_mad_u16 v9, v43, s37, v9
    ds_add_u32 v44, v4 offset:0
    ds_add_u32 v45, v4 offset:0
    ds_add_u32 v46, v4 offset:0
    ds_add_u32 v47, v4 offset:0
    v_pk_mad_u16 v6, v40, s52, v6 op_sel:[1,0,0] op_sel_hi:[1,1,1]
    v_pk_mad_u16 v7, v41, s52, v7 op_sel:[1,0,0] op_sel_hi:[1,1,1]
    v_pk_mad_u16 v8, v42, s52, v8 op_sel:[1,0,0] op_sel_hi:[1,1,1]
    v_pk_mad_u16 v9, v43, s52, v9 op_sel:[1,0,0] op_sel_hi:[1,1,1]
    v_perm_b32 v51, v47, v46, s43
    v_perm_b32 v126, v45, v44, s43
    v_or_b32 v62, 0x40000000, v6
    v_or_b32 v64, 0x40000000, v7
    v_or_b32 v65, 0x40000000, v8
    v_or_b32 v66, 0x40000000, v9
    v_lshlrev_b32 v99, 16, v116
    v_and_b32 v116, 0xffff0000, v116
    v_lshlrev_b32 v117, 16, v117
    v_mul_f32 v99, s41, v99
    v_mul_f32 v116, s41, v116
    v_mul_f32 v117, s41, v117
    v_fract_f32 v99, v99
    v_fract_f32 v116, v116
    v_fract_f32 v117, v117
    v_cos_f32 v99, v99
    v_cos_f32 v116, v116
    v_cos_f32 v117, v117
    v_fmaak_f32 v99, v10, v99, 1262486016
    v_fmaak_f32 v116, v10, v116, 1262486016
    v_fmaak_f32 v117, v10, v117, 1262486016
    v_lshlrev_b32 v99, 22, v99
    v_alignbit_b32 v99, v116, v99, 10
    v_alignbit_b32 v99, v117, v99, 10
    v_xor_b32 v99, 0x80200800, v99
    s_cmp_lg_u32 s40, 3
    s_cbranch_scc1 L_p1_kernel_now_20
    v_mov_b64 v[40:41], v[96:97]
    v_mov_b64 v[42:43], v[98:99]
    s_branch L_p1_kernel_held_21
L_p1_kernel_now_20:
    s_mov_b32 s36, 11534336
    buffer_store_dwordx4 v[96:99], v3, s[20:23], s36 offen sc1
L_p1_kernel_held_21:
    v_lshlrev_b32 v71, 16, v118
    v_and_b32 v118, 0xffff0000, v118
    v_lshlrev_b32 v119, 16, v119
    v_mul_f32 v71, s41, v71
    v_mul_f32 v118, s41, v118
    v_mul_f32 v119, s41, v119
    v_fract_f32 v71, v71
    v_fract_f32 v118, v118
    v_fract_f32 v119, v119
    v_cos_f32 v71, v71
    v_cos_f32 v118, v118
    v_cos_f32 v119, v119
    v_fmaak_f32 v71, v10, v71, 1262486016
    v_fmaak_f32 v118, v10, v118, 1262486016
    v_fmaak_f32 v119, v10, v119, 1262486016
    v_lshlrev_b32 v71, 22, v71
    v_alignbit_b32 v71, v118, v71, 10
    v_alignbit_b32 v71, v119, v71, 10
    v_xor_b32 v71, 0x80200800, v71
    s_cmp_lg_u32 s40, 3
    s_cbranch_scc1 L_p1_kernel_now_22
    v_mov_b64 v[44:45], v[68:69]
    v_mov_b64 v[46:47], v[70:71]
    s_branch L_p1_kernel_held_23
L_p1_kernel_now_22:
    s_mov_b32 s36, 12582912
    buffer_store_dwordx4 v[68:71], v3, s[20:23], s36 offen sc1
L_p1_kernel_held_23:
    s_add_u32 s35, s33, 37748736
    s_sub_u32 s35, s35, s48
    v_cndmask_b32 v96, 2.0, v1, s[44:45]
    buffer_load_dwordx4 v[96:99], v96, s[8:11], s35 offen nt
    s_add_u32 s35, s33, 37748736
    s_sub_u32 s35, s35, s48
    v_cndmask_b32 v116, 2.0, v1, s[44:45]
    buffer_load_dwordx4 v[116:119], v116, s[12:15], s35 offen nt
    s_cbranch_vccz L_p1_kernel_thr_24
    s_waitcnt vmcnt(2)
L_p1_kernel_thr_24:
    s_branch L_p1_join
L_p1_first:
    s_add_u32 s35, s33, 20971520
    buffer_load_dwordx4 v[80:83], v1, s[8:11], s35 offen nt
    s_add_u32 s35, s33, 20971520
    buffer_load_dwordx4 v[100:103], v1, s[12:15], s35 offen nt
    s_add_u32 s35, s33, 25165824
    buffer_load_dwordx4 v[84:87], v1, s[8:11], s35 offen nt
    s_add_u32 s35, s33, 25165824
    buffer_load_dwordx4 v[104:107], v1, s[12:15], s35 offen nt
    s_add_u32 s35, s33, 29360128
    buffer_load_dwordx4 v[88:91], v1, s[8:11], s35 offen nt
    s_add_u32 s35, s33, 29360128
    buffer_load_dwordx4 v[108:111], v1, s[12:15], s35 offen nt
    s_add_u32 s35, s33, 33554432
    buffer_load_dwordx4 v[92:95], v1, s[8:11], s35 offen nt
    s_add_u32 s35, s33, 33554432
    buffer_load_dwordx4 v[112:115], v1, s[12:15], s35 offen nt
    s_add_u32 s35, s33, 37748736
    s_sub_u32 s35, s35, s48
    v_cndmask_b32 v96, 2.0, v1, s[44:45]
    buffer_load_dwordx4 v[96:99], v96, s[8:11], s35 offen nt
    s_add_u32 s35, s33, 37748736
    s_sub_u32 s35, s35, s48
    v_cndmask_b32 v116, 2.0, v1, s[44:45]
    buffer_load_dwordx4 v[116:119], v116, s[12:15], s35 offen nt
    s_waitcnt vmcnt(18)
    v_perm_b32 v6, v20, v16, s43
    v_perm_b32 v7, v21, v17, s43
    v_perm_b32 v8, v22, v18, s43
    v_perm_b32 v9, v23, v19, s43
    v_mul_hi_u32_u24 v16, 429497, v16
    v_mul_hi_u32_u24 v20, 429497, v20
    v_mul_hi_u32_u24 v17, 429497, v17
    v_mul_hi_u32_u24 v21, 429497, v21
    v_mul_hi_u32_u24 v18, 429497, v18
    v_mul_hi_u32_u24 v22, 429497, v22
    v_mul_hi_u32_u24 v19, 429497, v19
    v_mul_hi_u32_u24 v23, 429497, v23
    v_lshl_or_b32 v16, v20, 16, v16
    v_lshl_or_b32 v17, v21, 16, v17
    v_lshl_or_b32 v18, v22, 16, v18
    v_lshl_or_b32 v19, v23, 16, v19
    v_dot2_u32_u16 v20, v16, s38, 0
    v_dot2_u32_u16 v21, v17, s38, 0
    v_dot2_u32_u16 v22, v18, s38, 0
    v_dot2_u32_u16 v23, v19, s38, 0
    v_pk_mad_u16 v6, v16, s37, v6
    v_pk_mad_u16 v7, v17, s37, v7
    v_pk_mad_u16 v8, v18, s37, v8
    v_pk_mad_u16 v9, v19, s37, v9
    ds_add_u32 v20, v4 offset:0
    ds_add_u32 v21, v4 offset:0
    ds_add_u32 v22, v4 offset:0
    ds_add_u32 v23, v4 offset:0
    v_pk_mad_u16 v6, v16, s52, v6 op_sel:[1,0,0] op_sel_hi:[1,1,1]
    v_pk_mad_u16 v7, v17, s52, v7 op_sel:[1,0,0] op_sel_hi:[1,1,1]
    v_pk_mad_u16 v8, v18, s52, v8 op_sel:[1,0,0] op_sel_hi:[1,1,1]
    v_pk_mad_u16 v9, v19, s52, v9 op_sel:[1,0,0] op_sel_hi:[1,1,1]
    v_perm_b32 v121, v23, v22, s43
    v_perm_b32 v120, v21, v20, s43
    v_or_b32 v127, 0x40000000, v6
    v_or_b32 v48, 0x40000000, v7
    v_or_b32 v49, 0x40000000, v8
    v_or_b32 v50, 0x40000000, v9
    s_waitcnt vmcnt(16)
    v_perm_b32 v6, v28, v24, s43
    v_perm_b32 v7, v29, v25, s43
    v_perm_b32 v8, v30, v26, s43
    v_perm_b32 v9, v31, v27, s43
    v_mul_hi_u32_u24 v24, 429497, v24
    v_mul_hi_u32_u24 v28, 429497, v28
    v_mul_hi_u32_u24 v25, 429497, v25
    v_mul_hi_u32_u24 v29, 429497, v29
    v_mul_hi_u32_u24 v26, 429497, v26
    v_mul_hi_u32_u24 v30, 429497, v30
    v_mul_hi_u32_u24 v27, 429497, v27
    v_mul_hi_u32_u24 v31, 429497, v31
    v_lshl_or_b32 v24, v28, 16, v24
    v_lshl_or_b32 v25, v29, 16, v25
    v_lshl_or_b32 v26, v30, 16, v26
    v_lshl_or_b32 v27, v31, 16, v27
    v_dot2_u32_u16 v28, v24, s38, 0
    v_dot2_u32_u16 v29, v25, s38, 0
    v_dot2_u32_u16 v30, v26, s38, 0
    v_dot2_u32_u16 v31, v27, s38, 0
    v_pk_mad_u16 v6, v24, s37, v6
    v_pk_mad_u16 v7, v25, s37, v7
    v_pk_mad_u16 v8, v26, s37, v8
    v_pk_mad_u16 v9, v27, s37, v9
    ds_add_u32 v28, v4 offset:0
    ds_add_u32 v29, v4 offset:0
    ds_add_u32 v30, v4 offset:0
    ds_add_u32 v31, v4 offset:0
    v_pk_mad_u16 v6, v24, s52, v6 op_sel:[1,0,0] op_sel_hi:[1,1,1]
    v_pk_mad_u16 v7, v25, s52, v7 op_sel:[1,0,0] op_sel_hi:[1,1,1]
    v_pk_mad_u16 v8, v26, s52, v8 op_sel:[1,0,0] op_sel_hi:[1,1,1]
    v_pk_mad_u16 v9, v27, s52, v9 op_sel:[1,0,0] op_sel_hi:[1,1,1]
    v_perm_b32 v123, v31, v30, s43
    v_perm_b32 v122, v29, v28, s43
    v_or_b32 v52, 0x40000000, v6
    v_or_b32 v53, 0x40000000, v7
    v_or_b32 v54, 0x40000000, v8
    v_or_b32 v56, 0x40000000, v9
    s_waitcnt vmcnt(14)
    v_perm_b32 v6, v36, v32, s43
    v_perm_b32 v7, v37, v33, s43
    v_perm_b32 v8, v38, v34, s43
    v_perm_b32 v9, v39, v35, s43
    v_mul_hi_u32_u24 v32, 429497, v32
    v_mul_hi_u32_u24 v36, 429497, v36
    v_mul_hi_u32_u24 v33, 429497, v33
    v_mul_hi_u32_u24 v37, 429497, v37
    v_mul_hi_u32_u24 v34, 429497, v34
    v_mul_hi_u32_u24 v38, 429497, v38
    v_mul_hi_u32_u24 v35, 429497, v35
    v_mul_hi_u32_u24 v39, 429497, v39
    v_lshl_or_b32 v32, v36, 16, v32
    v_lshl_or_b32 v33, v37, 16, v33
    v_lshl_or_b32 v34, v38, 16, v34
    v_lshl_or_b32 v35, v39, 16, v35
    v_dot2_u32_u16 v36, v32, s38, 0
    v_dot2_u32_u16 v37, v33, s38, 0
    v_dot2_u32_u16 v38, v34, s38, 0
    v_dot2_u32_u16 v39, v35, s38, 0
    v_pk_mad_u16 v6, v32, s37, v6
    v_pk_mad_u16 v7, v33, s37, v7
    v_pk_mad_u16 v8, v34, s37, v8
    v_pk_mad_u16 v9, v35, s37, v9
    ds_add_u32 v36, v4 offset:0
    ds_add_u32 v37, v4 offset:0
    ds_add_u32 v38, v4 offset:0
    ds_add_u32 v39, v4 offset:0
    v_pk_mad_u16 v6, v32, s52, v6 op_sel:[1,0,0] op_sel_hi:[1,1,1]
    v_pk_mad_u16 v7, v33, s52, v7 op_sel:[1,0,0] op_sel_hi:[1,1,1]
    v_pk_mad_u16 v8, v34, s52, v8 op_sel:[1,0,0] op_sel_hi:[1,1,1]
    v_pk_mad_u16 v9, v35, s52, v9 op_sel:[1,0,0] op_sel_hi:[1,1,1]
    v_perm_b32 v125, v39, v38, s43
    v_perm_b32 v124, v37, v36, s43
    v_or_b32 v57, 0x40000000, v6
    v_or_b32 v58, 0x40000000, v7
    v_or_b32 v60, 0x40000000, v8
    v_or_b32 v61, 0x40000000, v9
    s_waitcnt vmcnt(12)
    v_perm_b32 v6, v44, v40, s43
    v_perm_b32 v7, v45, v41, s43
    v_perm_b32 v8, v46, v42, s43
    v_perm_b32 v9, v47, v43, s43
    v_mul_hi_u32_u24 v40, 429497, v40
    v_mul_hi_u32_u24 v44, 429497, v44
    v_mul_hi_u32_u24 v41, 429497, v41
    v_mul_hi_u32_u24 v45, 429497, v45
    v_mul_hi_u32_u24 v42, 429497, v42
    v_mul_hi_u32_u24 v46, 429497, v46
    v_mul_hi_u32_u24 v43, 429497, v43
    v_mul_hi_u32_u24 v47, 429497, v47
    v_lshl_or_b32 v40, v44, 16, v40
    v_lshl_or_b32 v41, v45, 16, v41
    v_lshl_or_b32 v42, v46, 16, v42
    v_lshl_or_b32 v43, v47, 16, v43
    v_dot2_u32_u16 v44, v40, s38, 0
    v_dot2_u32_u16 v45, v41, s38, 0
    v_dot2_u32_u16 v46, v42, s38, 0
    v_dot2_u32_u16 v47, v43, s38, 0
    v_pk_mad_u16 v6, v40, s37, v6
    v_pk_mad_u16 v7, v41, s37, v7
    v_pk_mad_u16 v8, v42, s37, v8
    v_pk_mad_u16 v9, v43, s37, v9
    ds_add_u32 v44, v4 offset:0
    ds_add_u32 v45, v4 offset:0
    ds_add_u32 v46, v4 offset:0
    ds_add_u32 v47, v4 offset:0
    v_pk_mad_u16 v6, v40, s52, v6 op_sel:[1,0,0] op_sel_hi:[1,1,1]
    v_pk_mad_u16 v7, v41, s52, v7 op_sel:[1,0,0] op_sel_hi:[1,1,1]
    v_pk_mad_u16 v8, v42, s52, v8 op_sel:[1,0,0] op_sel_hi:[1,1,1]
    v_pk_mad_u16 v9, v43, s52, v9 op_sel:[1,0,0] op_sel_hi:[1,1,1]
    v_perm_b32 v51, v47, v46, s43
    v_perm_b32 v126, v45, v44, s43
    v_or_b32 v62, 0x40000000, v6
    v_or_b32 v64, 0x40000000, v7
    v_or_b32 v65, 0x40000000, v8
    v_or_b32 v66, 0x40000000, v9
L_p1_join:
    s_waitcnt vmcnt(10)
    v_perm_b32 v6, v76, v72, s43
    v_perm_b32 v7, v77, v73, s43
    v_perm_b32 v8, v78, v74, s43
    v_perm_b32 v9, v79, v75, s43
    v_mul_hi_u32_u24 v72, 429497, v72
    v_mul_hi_u32_u24 v76, 429497, v76
    v_mul_hi_u32_u24 v73, 429497, v73
    v_mul_hi_u32_u24 v77, 429497, v77
    v_mul_hi_u32_u24 v74, 429497, v74
    v_mul_hi_u32_u24 v78, 429497, v78
    v_mul_hi_u32_u24 v75, 429497, v75
    v_mul_hi_u32_u24 v79, 429497, v79
    v_lshl_or_b32 v72, v76, 16, v72
    v_lshl_or_b32 v73, v77, 16, v73
    v_lshl_or_b32 v74, v78, 16, v74
    v_lshl_or_b32 v75, v79, 16, v75
    v_dot2_u32_u16 v76, v72, s38, 0
    v_dot2_u32_u16 v77, v73, s38, 0
    v_dot2_u32_u16 v78, v74, s38, 0
    v_dot2_u32_u16 v79, v75, s38, 0
    v_pk_mad_u16 v6, v72, s37, v6
    v_pk_mad_u16 v7, v73, s37, v7
    v_pk_mad_u16 v8, v74, s37, v8
    v_pk_mad_u16 v9, v75, s37, v9
    ds_add_u32 v76, v4 offset:0
    ds_add_u32 v77, v4 offset:0
    ds_add_u32 v78, v4 offset:0
    ds_add_u32 v79, v4 offset:0
    v_pk_mad_u16 v6, v72, s52, v6 op_sel:[1,0,0] op_sel_hi:[1,1,1]
    v_pk_mad_u16 v7, v73, s52, v7 op_sel:[1,0,0] op_sel_hi:[1,1,1]
    v_pk_mad_u16 v8, v74, s52, v8 op_sel:[1,0,0] op_sel_hi:[1,1,1]
    v_pk_mad_u16 v9, v75, s52, v9 op_sel:[1,0,0] op_sel_hi:[1,1,1]
    v_perm_b32 v59, v79, v78, s43
    v_perm_b32 v55, v77, v76, s43
    v_or_b32 v68, 0x40000000, v6
    v_or_b32 v69, 0x40000000, v7
    v_or_b32 v70, 0x40000000, v8
    v_or_b32 v72, 0x40000000, v9
    s_waitcnt vmcnt(8)
    v_perm_b32 v6, v100, v80, s43
    v_perm_b32 v7, v101, v81, s43
    v_perm_b32 v8, v102, v82, s43
    v_perm_b32 v9, v103, v83, s43
    v_mul_hi_u32_u24 v80, 429497, v80
    v_mul_hi_u32_u24 v100, 429497, v100
    v_mul_hi_u32_u24 v81, 429497, v81
    v_mul_hi_u32_u24 v101, 429497, v101
    v_mul_hi_u32_u24 v82, 429497, v82
    v_mul_hi_u32_u24 v102, 429497, v102
    v_mul_hi_u32_u24 v83, 429497, v83
    v_mul_hi_u32_u24 v103, 429497, v103
    v_lshl_or_b32 v80, v100, 16, v80
    v_lshl_or_b32 v81, v101, 16, v81
    v_lshl_or_b32 v82, v102, 16, v82
    v_lshl_or_b32 v83, v103, 16, v83
    v_dot2_u32_u16 v100, v80, s38, 0
    v_dot2_u32_u16 v101, v81, s38, 0
    v_dot2_u32_u16 v102, v82, s38, 0
    v_dot2_u32_u16 v103, v83, s38, 0
    v_pk_mad_u16 v6, v80, s37, v6
    v_pk_mad_u16 v7, v81, s37, v7
    v_pk_mad_u16 v8, v82, s37, v8
    v_pk_mad_u16 v9, v83, s37, v9
    ds_add_u32 v100, v4 offset:0
    ds_add_u32 v101, v4 offset:0
    ds_add_u32 v102, v4 offset:0
    ds_add_u32 v103, v4 offset:0
    v_pk_mad_u16 v6, v80, s52, v6 op_sel:[1,0,0] op_sel_hi:[1,1,1]
    v_pk_mad_u16 v7, v81, s52, v7 op_sel:[1,0,0] op_sel_hi:[1,1,1]
    v_pk_mad_u16 v8, v82, s52, v8 op_sel:[1,0,0] op_sel_hi:[1,1,1]
    v_pk_mad_u16 v9, v83, s52, v9 op_sel:[1,0,0] op_sel_hi:[1,1,1]
    v_perm_b32 v67, v103, v102, s43
    v_perm_b32 v63, v101, v100, s43
    v_or_b32 v73, 0x40000000, v6
    v_or_b32 v74, 0x40000000, v7
    v_or_b32 v76, 0x40000000, v8
    v_or_b32 v77, 0x40000000, v9
    s_waitcnt vmcnt(6)
    v_perm_b32 v6, v104, v84, s43
    v_perm_b32 v7, v105, v85, s43
    v_perm_b32 v8, v106, v86, s43
    v_perm_b32 v9, v107, v87, s43
    v_mul_hi_u32_u24 v84, 429497, v84
    v_mul_hi_u32_u24 v104, 429497, v104
    v_mul_hi_u32_u24 v85, 429497, v85
    v_mul_hi_u32_u24 v105, 429497, v105
    v_mul_hi_u32_u24 v86, 429497, v86
    v_mul_hi_u32_u24 v106, 429497, v106
    v_mul_hi_u32_u24 v87, 429497, v87
    v_mul_hi_u32_u24 v107, 429497, v107
    v_lshl_or_b32 v84, v104, 16, v84
    v_lshl_or_b32 v85, v105, 16, v85
    v_lshl_or_b32 v86, v106, 16, v86
    v_lshl_or_b32 v87, v107, 16, v87
    v_dot2_u32_u16 v104, v84, s38, 0
    v_dot2_u32_u16 v105, v85, s38, 0
    v_dot2_u32_u16 v106, v86, s38, 0
    v_dot2_u32_u16 v107, v87, s38, 0
    v_pk_mad_u16 v6, v84, s37, v6
    v_pk_mad_u16 v7, v85, s37, v7
    v_pk_mad_u16 v8, v86, s37, v8
    v_pk_mad_u16 v9, v87, s37, v9
    ds_add_u32 v104, v4 offset:0
    ds_add_u32 v105, v4 offset:0
    ds_add_u32 v106, v4 offset:0
    ds_add_u32 v107, v4 offset:0
    v_pk_mad_u16 v6, v84, s52, v6 op_sel:[1,0,0] op_sel_hi:[1,1,1]
    v_pk_mad_u16 v7, v85, s52, v7 op_sel:[1,0,0] op_sel_hi:[1,1,1]
    v_pk_mad_u16 v8, v86, s52, v8 op_sel:[1,0,0] op_sel_hi:[1,1,1]
    v_pk_mad_u16 v9, v87, s52, v9 op_sel:[1,0,0] op_sel_hi:[1,1,1]
    v_perm_b32 v75, v107, v106, s43
    v_perm_b32 v71, v105, v104, s43
    v_or_b32 v78, 0x40000000, v6
    v_or_b32 v80, 0x40000000, v7
    v_or_b32 v81, 0x40000000, v8
    v_or_b32 v82, 0x40000000, v9
    s_waitcnt vmcnt(4)
    v_perm_b32 v6, v108, v88, s43
    v_perm_b32 v7, v109, v89, s43
    v_perm_b32 v8, v110, v90, s43
    v_perm_b32 v9, v111, v91, s43
    v_mul_hi_u32_u24 v88, 429497, v88
    v_mul_hi_u32_u24 v108, 429497, v108
    v_mul_hi_u32_u24 v89, 429497, v89
    v_mul_hi_u32_u24 v109, 429497, v109
    v_mul_hi_u32_u24 v90, 429497, v90
    v_mul_hi_u32_u24 v110, 429497, v110
    v_mul_hi_u32_u24 v91, 429497, v91
    v_mul_hi_u32_u24 v111, 429497, v111
    v_lshl_or_b32 v88, v108, 16, v88
    v_lshl_or_b32 v89, v109, 16, v89
    v_lshl_or_b32 v90, v110, 16, v90
    v_lshl_or_b32 v91, v111, 16, v91
    v_dot2_u32_u16 v108, v88, s38, 0
    v_dot2_u32_u16 v109, v89, s38, 0
    v_dot2_u32_u16 v110, v90, s38, 0
    v_dot2_u32_u16 v111, v91, s38, 0
    v_pk_mad_u16 v6, v88, s37, v6
    v_pk_mad_u16 v7, v89, s37, v7
    v_pk_mad_u16 v8, v90, s37, v8
    v_pk_mad_u16 v9, v91, s37, v9
    ds_add_u32 v108, v4 offset:0
    ds_add_u32 v109, v4 offset:0
    ds_add_u32 v110, v4 offset:0
    ds_add_u32 v111, v4 offset:0
    v_pk_mad_u16 v6, v88, s52, v6 op_sel:[1,0,0] op_sel_hi:[1,1,1]
    v_pk_mad_u16 v7, v89, s52, v7 op_sel:[1,0,0] op_sel_hi:[1,1,1]
    v_pk_mad_u16 v8, v90, s52, v8 op_sel:[1,0,0] op_sel_hi:[1,1,1]
    v_pk_mad_u16 v9, v91, s52, v9 op_sel:[1,0,0] op_sel_hi:[1,1,1]
    v_perm_b32 v83, v111, v110, s43
    v_perm_b32 v79, v109, v108, s43
    v_or_b32 v84, 0x40000000, v6
    v_or_b32 v85, 0x40000000, v7
    v_or_b32 v86, 0x40000000, v8
    v_or_b32 v88, 0x40000000, v9
    s_waitcnt vmcnt(2)
    v_perm_b32 v6, v112, v92, s43
    v_perm_b32 v7, v113, v93, s43
    v_perm_b32 v8, v114, v94, s43
    v_perm_b32 v9, v115, v95, s43
    v_mul_hi_u32_u24 v92, 429497, v92
    v_mul_hi_u32_u24 v112, 429497, v112
    v_mul_hi_u32_u24 v93, 429497, v93
    v_mul_hi_u32_u24 v113, 429497, v113
    v_mul_hi_u32_u24 v94, 429497, v94
    v_mul_hi_u32_u24 v114, 429497, v114
    v_mul_hi_u32_u24 v95, 429497, v95
    v_mul_hi_u32_u24 v115, 429497, v115
    v_lshl_or_b32 v92, v112, 16, v92
    v_lshl_or_b32 v93, v113, 16, v93
    v_lshl_or_b32 v94, v114, 16, v94
    v_lshl_or_b32 v95, v115, 16, v95
    v_dot2_u32_u16 v112, v92, s38, 0
    v_dot2_u32_u16 v113, v93, s38, 0
    v_dot2_u32_u16 v114, v94, s38, 0
    v_dot2_u32_u16 v115, v95, s38, 0
    v_pk_mad_u16 v6, v92, s37, v6
    v_pk_mad_u16 v7, v93, s37, v7
    v_pk_mad_u16 v8, v94, s37, v8
    v_pk_mad_u16 v9, v95, s37, v9
    ds_add_u32 v112, v4 offset:0
    ds_add_u32 v113, v4 offset:0
    ds_add_u32 v114, v4 offset:0
    ds_add_u32 v115, v4 offset:0
    v_pk_mad_u16 v6, v92, s52, v6 op_sel:[1,0,0] op_sel_hi:[1,1,1]
    v_pk_mad_u16 v7, v93, s52, v7 op_sel:[1,0,0] op_sel_hi:[1,1,1]
    v_pk_mad_u16 v8, v94, s52, v8 op_sel:[1,0,0] op_sel_hi:[1,1,1]
    v_pk_mad_u16 v9, v95, s52, v9 op_sel:[1,0,0] op_sel_hi:[1,1,1]
    v_perm_b32 v91, v115, v114, s43
    v_perm_b32 v87, v113, v112, s43
    v_or_b32 v89, 0x40000000, v6
    v_or_b32 v90, 0x40000000, v7
    v_or_b32 v92, 0x40000000, v8
    v_or_b32 v93, 0x40000000, v9
    s_waitcnt vmcnt(0)
    s_mov_b64 exec, s[44:45]
    v_perm_b32 v6, v116, v96, s43
    v_perm_b32 v7, v117, v97, s43
    v_perm_b32 v8, v118, v98, s43
    v_perm_b32 v9, v119, v99, s43
    v_mul_hi_u32_u24 v96, 429497, v96
    v_mul_hi_u32_u24 v116, 429497, v116
    v_mul_hi_u32_u24 v97, 429497, v97
    v_mul_hi_u32_u24 v117, 429497, v117
    v_mul_hi_u32_u24 v98, 429497, v98
    v_mul_hi_u32_u24 v118, 429497, v118
    v_mul_hi_u32_u24 v99, 429497, v99
    v_mul_hi_u32_u24 v119, 429497, v119
    v_lshl_or_b32 v96, v116, 16, v96
    v_lshl_or_b32 v97, v117, 16, v97
    v_lshl_or_b32 v98, v118, 16, v98
    v_lshl_or_b32 v99, v119, 16, v99
    v_dot2_u32_u16 v116, v96, s38, 0
    v_dot2_u32_u16 v117, v97, s38, 0
    v_dot2_u32_u16 v118, v98, s38, 0
    v_dot2_u32_u16 v119, v99, s38, 0
    v_pk_mad_u16 v6, v96, s37, v6
    v_pk_mad_u16 v7, v97, s37, v7
    v_pk_mad_u16 v8, v98, s37, v8
    v_pk_mad_u16 v9, v99, s37, v9
    ds_add_u32 v116, v4 offset:0
    ds_add_u32 v117, v4 offset:0
    ds_add_u32 v118, v4 offset:0
    ds_add_u32 v119, v4 offset:0
    v_pk_mad_u16 v6, v96, s52, v6 op_sel:[1,0,0] op_sel_hi:[1,1,1]
    v_pk_mad_u16 v7, v97, s52, v7 op_sel:[1,0,0] op_sel_hi:[1,1,1]
    v_pk_mad_u16 v8, v98, s52, v8 op_sel:[1,0,0] op_sel_hi:[1,1,1]
    v_pk_mad_u16 v9, v99, s52, v9 op_sel:[1,0,0] op_sel_hi:[1,1,1]
    v_perm_b32 v99, v119, v118, s43
    v_perm_b32 v95, v117, v116, s43
    v_or_b32 v94, 0x40000000, v6
    v_or_b32 v96, 0x40000000, v7
    v_or_b32 v97, 0x40000000, v8
    v_or_b32 v98, 0x40000000, v9
    s_mov_b64 exec, -1
    s_add_u32 s35, s34, 0
    buffer_load_dwordx2 v[100:101], v2, s[16:19], s35 offen nt
    s_lshl_b32 s35, s32, 10
    s_add_u32 s35, s35, 9437184
    s_add_u32 s20, s4, s35
    s_addc_u32 s21, s5, 0
    s_lshl2_add_u32 s35, s39, 160768
    v_mov_b32 v13, s35
    v_mov_b32 v7, 2.0
    v_and_b32 v6, 63, v0
    s_mov_b32 s36, 160768
    s_lshl_b32 s35, 0x1fffe, s39
    s_and_b32 s35, s35, 0x1ffff
    s_mov_b32 exec_hi, 0
    s_mov_b32 exec_lo, s35
    v_lshl_add_u32 v7, v6, 2, s36
    s_mov_b64 exec, -1
    v_mov_b32 v14, 160832
    s_mov_b32 s53, 2
    s_waitcnt lgkmcnt(0)
    s_barrier
    ds_read_b128 v[8:11], v1 offset:0
    s_add_u32 s35, s34, 2097152
    buffer_load_dwordx2 v[102:103], v2, s[16:19], s35 offen nt
L_p1_redo:
    s_waitcnt lgkmcnt(0)
    v_min3_u32 v12, v8, v9, v10
    v_min_u32 v12, v12, v11
    v_cmp_gt_u32 vcc, s53, v12
    s_nop 0
    s_mov_b64 s[46:47], vcc
    s_cbranch_vccz L_p1_kernel_nomask_25
    v_cmp_eq_u32 s[56:57], 0, v8
    v_cmp_ge_u32 s[64:65], 1, v8
    v_max_u32 v8, 2, v8
    v_cmp_eq_u32 s[58:59], 0, v9
    v_cmp_ge_u32 s[66:67], 1, v9
    v_max_u32 v9, 2, v9
    v_cmp_eq_u32 s[60:61], 0, v10
    v_cmp_ge_u32 s[68:69], 1, v10
    v_max_u32 v10, 2, v10
    v_cmp_eq_u32 s[62:63], 0, v11
    v_cmp_ge_u32 s[70:71], 1, v11
    v_max_u32 v11, 2, v11
L_p1_kernel_nomask_25:
    v_add_u32 v9, v8, v9
    v_add_u32 v10, v9, v10
    v_add_u32 v11, v10, v11
    s_nop 1
    v_add_u32_dpp v6, v11, v11 row_shr:1 row_mask:0xf bank_mask:0xf bound_ctrl:0
    s_nop 1
    v_add_u32_dpp v6, v6, v6 row_shr:2 row_mask:0xf bank_mask:0xf bound_ctrl:0
    s_nop 1
    v_add_u32_dpp v6, v6, v6 row_shr:4 row_mask:0xf bank_mask:0xf bound_ctrl:0
    s_nop 1
    v_add_u32_dpp v6, v6, v6 row_shr:8 row_mask:0xf bank_mask:0xf bound_ctrl:0
    s_nop 1
    v_add_u32_dpp v6, v6, v6 row_bcast:15 row_mask:0xa bank_mask:0xf
    s_nop 1
    v_add_u32_dpp v6, v6, v6 row_bcast:31 row_mask:0xc bank_mask:0xf
    s_nop 0
    v_readlane_b32 s35, v6, 63
    v_sub_u32 v6, v6, v11
    v_add_u32 v8, v8, v6
    v_mov_b32 v12, s35
    ds_add_u32 v7, v12
    v_add_u32 v9, v9, v6
    v_add_u32 v10, v10, v6
    s_waitcnt lgkmcnt(0)
    s_barrier
    ds_read_b32 v12, v14
    ds_read_b32 v11, v13
    s_add_u32 s35, s34, 4194304
    buffer_load_dwordx2 v[104:105], v2, s[16:19], s35 offen nt
    s_waitcnt lgkmcnt(1)
    v_readfirstlane_b32 s54, v12
    s_waitcnt lgkmcnt(0)
    s_cmp_ge_u32 s54, 40063
    s_cbranch_scc0 L_p1_fits
    s_barrier
    v_mov_b32 v12, 0
    ds_write_b32 v7, v12
    s_mov_b32 s53, 0
    s_mov_b32 s55, 1
    s_waitcnt lgkmcnt(0)
    s_barrier
    ds_read_b128 v[8:11], v1 offset:0
    s_branch L_p1_redo
L_p1_fits:
    s_mov_b64 exec, 1
    v_mov_b32 v7, 24576
    ds_write_b16 v7, v12
    s_mov_b64 exec, -1
    v_add_u32 v12, v11, v6
    v_add_u32 v13, v11, v8
    v_add_u32 v14, v11, v9
    v_add_u32 v15, v11, v10
    ds_write_b128 v1, v[12:15] offset:0
    s_add_u32 s35, s54, 2
    s_mul_hi_u32 s35, s35, 1431655766
    v_perm_b32 v15, v15, v14, s43
    v_perm_b32 v14, v13, v12, s43
    ds_write_b64 v2, v[14:15] offset:16384
    s_lshl_b32 s35, s35, 4
    s_add_u32 s35, s35, 217890943
    s_andn2_b32 s35, s35, 127
    s_min_u32 s22, s35, 218104832
    s_waitcnt lgkmcnt(0)
    s_barrier
    s_nop 0
    v_and_b32 v6, 0xffff, v120
    v_lshrrev_b32 v7, 16, v120
    v_and_b32 v8, 0xffff, v121
    v_lshrrev_b32 v9, 16, v121
    ds_add_rtn_u32 v6, v6, v4 offset:0
    ds_add_rtn_u32 v7, v7, v4 offset:0
    ds_add_rtn_u32 v8, v8, v4 offset:0
    ds_add_rtn_u32 v9, v9, v4 offset:0
    v_and_b32 v10, 0xffff, v122
    v_lshrrev_b32 v11, 16, v122
    v_and_b32 v12, 0xffff, v123
    v_lshrrev_b32 v13, 16, v123
    ds_add_rtn_u32 v10, v10, v4 offset:0
    ds_add_rtn_u32 v11, v11, v4 offset:0
    ds_add_rtn_u32 v12, v12, v4 offset:0
    ds_add_rtn_u32 v13, v13, v4 offset:0
    s_waitcnt lgkmcnt(4)
    v_perm_b32 v120, v7, v6, s43
    v_perm_b32 v121, v9, v8, s43
    v_and_b32 v6, 0xffff, v124
    v_lshrrev_b32 v7, 16, v124
    v_and_b32 v8, 0xffff, v125
    v_lshrrev_b32 v9, 16, v125
    ds_add_rtn_u32 v6, v6, v4 offset:0
    ds_add_rtn_u32 v7, v7, v4 offset:0
    ds_add_rtn_u32 v8, v8, v4 offset:0
    ds_add_rtn_u32 v9, v9, v4 offset:0
    s_waitcnt lgkmcnt(4)
    v_perm_b32 v122, v11, v10, s43
    v_perm_b32 v123, v13, v12, s43
    s_add_u32 s35, s34, 6291456
    buffer_load_dwordx2 v[106:107], v2, s[16:19], s35 offen nt
    v_and_b32 v10, 0xffff, v126
    v_lshrrev_b32 v11, 16, v126
    v_and_b32 v12, 0xffff, v51
    v_lshrrev_b32 v13, 16, v51
    ds_add_rtn_u32 v10, v10, v4 offset:0
    ds_add_rtn_u32 v11, v11, v4 offset:0
    ds_add_rtn_u32 v12, v12, v4 offset:0
    ds_add_rtn_u32 v13, v13, v4 offset:0
    s_waitcnt lgkmcnt(4)
    v_perm_b32 v124, v7, v6, s43
    v_perm_b32 v125, v9, v8, s43
    s_add_u32 s35, s34, 8388608
    buffer_load_dwordx2 v[108:109], v2, s[16:19], s35 offen nt
    v_and_b32 v6, 0xffff, v55
    v_lshrrev_b32 v7, 16, v55
    v_and_b32 v8, 0xffff, v59
    v_lshrrev_b32 v9, 16, v59
    ds_add_rtn_u32 v6, v6, v4 offset:0
    ds_add_rtn_u32 v7, v7, v4 offset:0
    ds_add_rtn_u32 v8, v8, v4 offset:0
    ds_add_rtn_u32 v9, v9, v4 offset:0
    s_waitcnt lgkmcnt(4)
    v_perm_b32 v126, v11, v10, s43
    v_perm_b32 v51, v13, v12, s43
    s_add_u32 s35, s34, 10485760
    buffer_load_dwordx2 v[110:111], v2, s[16:19], s35 offen nt
    v_and_b32 v10, 0xffff, v63
    v_lshrrev_b32 v11, 16, v63
    v_and_b32 v12, 0xffff, v67
    v_lshrrev_b32 v13, 16, v67
    ds_add_rtn_u32 v10, v10, v4 offset:0
    ds_add_rtn_u32 v11, v11, v4 offset:0
    ds_add_rtn_u32 v12, v12, v4 offset:0
    ds_add_rtn_u32 v13, v13, v4 offset:0
    s_waitcnt lgkmcnt(4)
    v_perm_b32 v55, v7, v6, s43
    v_perm_b32 v59, v9, v8, s43
    v_and_b32 v6, 0xffff, v71
    v_lshrrev_b32 v7, 16, v71
    v_and_b32 v8, 0xffff, v75
    v_lshrrev_b32 v9, 16, v75
    ds_add_rtn_u32 v6, v6, v4 offset:0
    ds_add_rtn_u32 v7, v7, v4 offset:0
    ds_add_rtn_u32 v8, v8, v4 offset:0
    ds_add_rtn_u32 v9, v9, v4 offset:0
    s_waitcnt lgkmcnt(4)
    v_perm_b32 v63, v11, v10, s43
    v_perm_b32 v67, v13, v12, s43
    s_add_u32 s35, s34, 12582912
    buffer_load_dwordx2 v[112:113], v2, s[16:19], s35 offen nt
    v_and_b32 v10, 0xffff, v79
    v_lshrrev_b32 v11, 16, v79
    v_and_b32 v12, 0xffff, v83
    v_lshrrev_b32 v13, 16, v83
    ds_add_rtn_u32 v10, v10, v4 offset:0
    ds_add_rtn_u32 v11, v11, v4 offset:0
    ds_add_rtn_u32 v12, v12, v4 offset:0
    ds_add_rtn_u32 v13, v13, v4 offset:0
    s_waitcnt lgkmcnt(4)
    v_perm_b32 v71, v7, v6, s43
    v_perm_b32 v75, v9, v8, s43
    s_add_u32 s35, s34, 14680064
    buffer_load_dwordx2 v[114:115], v2, s[16:19], s35 offen nt
    v_and_b32 v6, 0xffff, v87
    v_lshrrev_b32 v7, 16, v87
    v_and_b32 v8, 0xffff, v91
    v_lshrrev_b32 v9, 16, v91
    ds_add_rtn_u32 v6, v6, v4 offset:0
    ds_add_rtn_u32 v7, v7, v4 offset:0
    ds_add_rtn_u32 v8, v8, v4 offset:0
    ds_add_rtn_u32 v9, v9, v4 offset:0
    s_waitcnt lgkmcnt(4)
    v_perm_b32 v79, v11, v10, s43
    v_perm_b32 v83, v13, v12, s43
    s_add_u32 s35, s34, 16777216
    buffer_load_dwordx2 v[116:117], v2, s[16:19], s35 offen nt
    s_mov_b64 exec, s[44:45]
    v_and_b32 v10, 0xffff, v95
    v_lshrrev_b32 v11, 16, v95
    v_and_b32 v12, 0xffff, v99
    v_lshrrev_b32 v13, 16, v99
    ds_add_rtn_u32 v10, v10, v4 offset:0
    ds_add_rtn_u32 v11, v11, v4 offset:0
    ds_add_rtn_u32 v12, v12, v4 offset:0
    ds_add_rtn_u32 v13, v13, v4 offset:0
    s_mov_b64 exec, -1
    s_waitcnt lgkmcnt(4)
    v_perm_b32 v87, v7, v6, s43
    v_perm_b32 v91, v9, v8, s43
    s_add_u32 s35, s34, 18874368
    s_sub_u32 s35, s35, s49
    v_cndmask_b32 v118, 2.0, v2, s[44:45]
    buffer_load_dwordx2 v[118:119], v118, s[16:19], s35 offen nt
    s_waitcnt lgkmcnt(0)
    v_perm_b32 v95, v11, v10, s43
    v_perm_b32 v99, v13, v12, s43
    s_cmp_gt_u32 s39, 8
    s_cbranch_scc1 L_p1_kernel_notab_26
    v_lshrrev_b32 v6, 1, v0
    v_mul_u32_u24 v7, 1009, v6
    v_lshrrev_b32 v7, 16, v7
    v_mul_u32_u24 v7, 959, v7
    v_and_b32 v8, 1, v0
    v_lshl_add_u32 v7, v8, 9, v7
    v_add_lshl_u32 v13, v7, v6, 1
    ds_read_u16 v6, v13 offset:16384
    ds_read_u16 v7, v13 offset:16512
    ds_read_u16 v8, v13 offset:16640
    ds_read_u16 v9, v13 offset:16768
    ds_read_u16 v10, v13 offset:16896
    ds_read_u16 v11, v13 offset:17024
    ds_read_u16 v12, v13 offset:17152
    ds_read_u16 v13, v13 offset:17280
    s_mul_i32 s35, s32, 8320
    s_add_u32 s26, s35, 8320
    s_waitcnt lgkmcnt(6)
    v_perm_b32 v6, v7, v6, s43
    s_waitcnt lgkmcnt(4)
    v_perm_b32 v7, v9, v8, s43
    s_waitcnt lgkmcnt(2)
    v_perm_b32 v8, v11, v10, s43
    s_waitcnt lgkmcnt(0)
    v_perm_b32 v9, v13, v12, s43
    buffer_store_dwordx4 v[6:9], v1, s[24:27], s35 offen sc1
    s_nop 1
L_p1_kernel_notab_26:
    s_barrier
    s_lshl_b32 s35, s54, 2
    v_mov_b32 v6, s35
    v_mov_b32 v7, 0
    v_mov_b32 v12, 1140817920
    s_mov_b64 exec, 1
    ds_write2_b32 v6, v7, v7 offset0:0 offset1:1
    s_cmp_eq_u64 s[46:47], 0
    s_cbranch_scc1 L_p1_kernel_nonull_27
    s_mov_b64 exec, s[64:65]
    v_lshlrev_b32_sdwa v6, 2, v14 dst_sel:DWORD dst_unused:UNUSED_PAD src0_sel:DWORD src1_sel:WORD_0
    ds_write_b32 v6, v7 offset:4
    s_mov_b64 exec, s[56:57]
    ds_write_b32 v6, v7
    s_mov_b64 exec, s[66:67]
    v_lshlrev_b32_sdwa v6, 2, v14 dst_sel:DWORD dst_unused:UNUSED_PAD src0_sel:DWORD src1_sel:WORD_1
    ds_write_b32 v6, v7 offset:4
    s_mov_b64 exec, s[58:59]
    ds_write_b32 v6, v7
    s_mov_b64 exec, s[68:69]
    v_lshlrev_b32_sdwa v6, 2, v15 dst_sel:DWORD dst_unused:UNUSED_PAD src0_sel:DWORD src1_sel:WORD_0
    ds_write_b32 v6, v7 offset:4
    s_mov_b64 exec, s[60:61]
    ds_write_b32 v6, v7
    s_mov_b64 exec, s[70:71]
    v_lshlrev_b32_sdwa v6, 2, v15 dst_sel:DWORD dst_unused:UNUSED_PAD src0_sel:DWORD src1_sel:WORD_1
    ds_write_b32 v6, v7 offset:4
    s_mov_b64 exec, s[62:63]
    ds_write_b32 v6, v7
L_p1_kernel_nonull_27:
    s_mov_b64 exec, -1
    v_lshlrev_b32_sdwa v6, 2, v120 dst_sel:DWORD dst_unused:UNUSED_PAD src0_sel:DWORD src1_sel:WORD_0
    v_lshlrev_b32_sdwa v7, 2, v120 dst_sel:DWORD dst_unused:UNUSED_PAD src0_sel:DWORD src1_sel:WORD_1
    v_lshlrev_b32_sdwa v8, 2, v121 dst_sel:DWORD dst_unused:UNUSED_PAD src0_sel:DWORD src1_sel:WORD_0
    v_lshlrev_b32_sdwa v9, 2, v121 dst_sel:DWORD dst_unused:UNUSED_PAD src0_sel:DWORD src1_sel:WORD_1
    ds_write_b32 v6, v127
    ds_write_b32 v7, v48
    ds_write_b32 v8, v49
    ds_write_b32 v9, v50
    s_cmp_lg_u32 s40, 3
    s_cbranch_scc1 L_p1_kernel_ld_28
    s_mov_b32 s36, 4194304
    buffer_store_dwordx4 v[16:19], v3, s[72:75], s36 offen sc1
    s_branch L_p1_kernel_st_29
L_p1_kernel_ld_28:
    s_add_u32 s35, s33, 40960000
    buffer_load_dwordx4 v[16:19], v1, s[8:11], s35 offen nt
L_p1_kernel_st_29:
    v_lshlrev_b32_sdwa v6, 2, v122 dst_sel:DWORD dst_unused:UNUSED_PAD src0_sel:DWORD src1_sel:WORD_0
    v_lshlrev_b32_sdwa v7, 2, v122 dst_sel:DWORD dst_unused:UNUSED_PAD src0_sel:DWORD src1_sel:WORD_1
    v_lshlrev_b32_sdwa v8, 2, v123 dst_sel:DWORD dst_unused:UNUSED_PAD src0_sel:DWORD src1_sel:WORD_0
    v_lshlrev_b32_sdwa v9, 2, v123 dst_sel:DWORD dst_unused:UNUSED_PAD src0_sel:DWORD src1_sel:WORD_1
    ds_write_b32 v6, v52
    ds_write_b32 v7, v53
    ds_write_b32 v8, v54
    ds_write_b32 v9, v56
    v_lshlrev_b32_sdwa v6, 2, v124 dst_sel:DWORD dst_unused:UNUSED_PAD src0_sel:DWORD src1_sel:WORD_0
    v_lshlrev_b32_sdwa v7, 2, v124 dst_sel:DWORD dst_unused:UNUSED_PAD src0_sel:DWORD src1_sel:WORD_1
    v_lshlrev_b32_sdwa v8, 2, v125 dst_sel:DWORD dst_unused:UNUSED_PAD src0_sel:DWORD src1_sel:WORD_0
    v_lshlrev_b32_sdwa v9, 2, v125 dst_sel:DWORD dst_unused:UNUSED_PAD src0_sel:DWORD src1_sel:WORD_1
    ds_write_b32 v6, v57
    ds_write_b32 v7, v58
    ds_write_b32 v8, v60
    ds_write_b32 v9, v61
    v_lshlrev_b32_sdwa v6, 2, v126 dst_sel:DWORD dst_unused:UNUSED_PAD src0_sel:DWORD src1_sel:WORD_0
    v_lshlrev_b32_sdwa v7, 2, v126 dst_sel:DWORD dst_unused:UNUSED_PAD src0_sel:DWORD src1_sel:WORD_1
    v_lshlrev_b32_sdwa v8, 2, v51 dst_sel:DWORD dst_unused:UNUSED_PAD src0_sel:DWORD src1_sel:WORD_0
    v_lshlrev_b32_sdwa v9, 2, v51 dst_sel:DWORD dst_unused:UNUSED_PAD src0_sel:DWORD src1_sel:WORD_1
    ds_write_b32 v6, v62
    ds_write_b32 v7, v64
    ds_write_b32 v8, v65
    ds_write_b32 v9, v66
    s_cmp_lg_u32 s40, 3
    s_cbranch_scc1 L_p1_kernel_ld_30
    s_mov_b32 s36, 6291456
    buffer_store_dwordx4 v[20:23], v3, s[72:75], s36 offen sc1
    s_branch L_p1_kernel_st_31
L_p1_kernel_ld_30:
    s_add_u32 s35, s33, 40960000
    buffer_load_dwordx4 v[20:23], v1, s[12:15], s35 offen nt
L_p1_kernel_st_31:
    v_lshlrev_b32_sdwa v6, 2, v55 dst_sel:DWORD dst_unused:UNUSED_PAD src0_sel:DWORD src1_sel:WORD_0
    v_lshlrev_b32_sdwa v7, 2, v55 dst_sel:DWORD dst_unused:UNUSED_PAD src0_sel:DWORD src1_sel:WORD_1
    v_lshlrev_b32_sdwa v8, 2, v59 dst_sel:DWORD dst_unused:UNUSED_PAD src0_sel:DWORD src1_sel:WORD_0
    v_lshlrev_b32_sdwa v9, 2, v59 dst_sel:DWORD dst_unused:UNUSED_PAD src0_sel:DWORD src1_sel:WORD_1
    ds_write_b32 v6, v68
    ds_write_b32 v7, v69
    ds_write_b32 v8, v70
    ds_write_b32 v9, v72
    v_lshlrev_b32_sdwa v6, 2, v63 dst_sel:DWORD dst_unused:UNUSED_PAD src0_sel:DWORD src1_sel:WORD_0
    v_lshlrev_b32_sdwa v7, 2, v63 dst_sel:DWORD dst_unused:UNUSED_PAD src0_sel:DWORD src1_sel:WORD_1
    v_lshlrev_b32_sdwa v8, 2, v67 dst_sel:DWORD dst_unused:UNUSED_PAD src0_sel:DWORD src1_sel:WORD_0
    v_lshlrev_b32_sdwa v9, 2, v67 dst_sel:DWORD dst_unused:UNUSED_PAD src0_sel:DWORD src1_sel:WORD_1
    ds_write_b32 v6, v73
    ds_write_b32 v7, v74
    ds_write_b32 v8, v76
    ds_write_b32 v9, v77
    v_lshlrev_b32_sdwa v6, 2, v71 dst_sel:DWORD dst_unused:UNUSED_PAD src0_sel:DWORD src1_sel:WORD_0
    v_lshlrev_b32_sdwa v7, 2, v71 dst_sel:DWORD dst_unused:UNUSED_PAD src0_sel:DWORD src1_sel:WORD_1
    v_lshlrev_b32_sdwa v8, 2, v75 dst_sel:DWORD dst_unused:UNUSED_PAD src0_sel:DWORD src1_sel:WORD_0
    v_lshlrev_b32_sdwa v9, 2, v75 dst_sel:DWORD dst_unused:UNUSED_PAD src0_sel:DWORD src1_sel:WORD_1
    ds_write_b32 v6, v78
    ds_write_b32 v7, v80
    ds_write_b32 v8, v81
    ds_write_b32 v9, v82
    s_cmp_lg_u32 s40, 3
    s_cbranch_scc1 L_p1_kernel_ld_32
    s_mov_b32 s36, 7340032
    buffer_store_dwordx4 v[24:27], v3, s[72:75], s36 offen sc1
    s_branch L_p1_kernel_st_33
L_p1_kernel_ld_32:
    s_add_u32 s35, s33, 45154304
    buffer_load_dwordx4 v[24:27], v1, s[8:11], s35 offen nt
L_p1_kernel_st_33:
    v_lshlrev_b32_sdwa v6, 2, v79 dst_sel:DWORD dst_unused:UNUSED_PAD src0_sel:DWORD src1_sel:WORD_0
    v_lshlrev_b32_sdwa v7, 2, v79 dst_sel:DWORD dst_unused:UNUSED_PAD src0_sel:DWORD src1_sel:WORD_1
    v_lshlrev_b32_sdwa v8, 2, v83 dst_sel:DWORD dst_unused:UNUSED_PAD src0_sel:DWORD src1_sel:WORD_0
    v_lshlrev_b32_sdwa v9, 2, v83 dst_sel:DWORD dst_unused:UNUSED_PAD src0_sel:DWORD src1_sel:WORD_1
    ds_write_b32 v6, v84
    ds_write_b32 v7, v85
    ds_write_b32 v8, v86
    ds_write_b32 v9, v88
    v_lshlrev_b32_sdwa v6, 2, v87 dst_sel:DWORD dst_unused:UNUSED_PAD src0_sel:DWORD src1_sel:WORD_0
    v_lshlrev_b32_sdwa v7, 2, v87 dst_sel:DWORD dst_unused:UNUSED_PAD src0_sel:DWORD src1_sel:WORD_1
    v_lshlrev_b32_sdwa v8, 2, v91 dst_sel:DWORD dst_unused:UNUSED_PAD src0_sel:DWORD src1_sel:WORD_0
    v_lshlrev_b32_sdwa v9, 2, v91 dst_sel:DWORD dst_unused:UNUSED_PAD src0_sel:DWORD src1_sel:WORD_1
    ds_write_b32 v6, v89
    ds_write_b32 v7, v90
    ds_write_b32 v8, v92
    ds_write_b32 v9, v93
    s_mov_b64 exec, s[44:45]
    v_lshlrev_b32_sdwa v6, 2, v95 dst_sel:DWORD dst_unused:UNUSED_PAD src0_sel:DWORD src1_sel:WORD_0
    v_lshlrev_b32_sdwa v7, 2, v95 dst_sel:DWORD dst_unused:UNUSED_PAD src0_sel:DWORD src1_sel:WORD_1
    v_lshlrev_b32_sdwa v8, 2, v99 dst_sel:DWORD dst_unused:UNUSED_PAD src0_sel:DWORD src1_sel:WORD_0
    v_lshlrev_b32_sdwa v9, 2, v99 dst_sel:DWORD dst_unused:UNUSED_PAD src0_sel:DWORD src1_sel:WORD_1
    ds_write_b32 v6, v94
    ds_write_b32 v7, v96
    ds_write_b32 v8, v97
    ds_write_b32 v9, v98
    s_mov_b64 exec, -1
    s_cmp_lg_u32 s40, 3
    s_cbranch_scc1 L_p1_kernel_ld_34
    s_mov_b32 s36, 8388608
    buffer_store_dwordx4 v[28:31], v3, s[72:75], s36 offen sc1
    s_branch L_p1_kernel_st_35
L_p1_kernel_ld_34:
    s_add_u32 s35, s33, 45154304
    buffer_load_dwordx4 v[28:31], v1, s[12:15], s35 offen nt
L_p1_kernel_st_35:
    s_mul_i32 s35, s39, 9216
    v_mad_u32_u24 v6, v0, 12, s35
    s_waitcnt lgkmcnt(0)
    s_barrier
    s_cmp_lg_u32 s39, 15
    s_cbranch_scc1 L_p1_kernel_nox_36
    ds_read_b32 v12, v6 offset:9984
    ds_read_b32 v13, v6 offset:9988
    ds_read_b32 v14, v6 offset:9992
L_p1_kernel_nox_36:
    ds_read_b32 v48, v6 offset:1536
    ds_read_b32 v49, v6 offset:1540
    ds_read_b32 v50, v6 offset:1544
    ds_read_b32 v52, v6 offset:3072
    ds_read_b32 v53, v6 offset:3076
    ds_read_b32 v54, v6 offset:3080
    ds_read_b32 v56, v6 offset:4608
    ds_read_b32 v57, v6 offset:4612
    ds_read_b32 v58, v6 offset:4616
    ds_read_b32 v60, v6 offset:6144
    ds_read_b32 v61, v6 offset:6148
    ds_read_b32 v62, v6 offset:6152
    ds_read_b32 v64, v6 offset:7680
    ds_read_b32 v65, v6 offset:7684
    ds_read_b32 v66, v6 offset:7688
    ds_read_b32 v68, v6 offset:9216
    ds_read_b32 v69, v6 offset:9220
    ds_read_b32 v70, v6 offset:9224
    ds_read_b32 v72, v6 offset:0
    ds_read_b32 v73, v6 offset:4
    ds_read_b32 v74, v6 offset:8
    ds_read_b32 v76, v6 offset:768
    ds_read_b32 v77, v6 offset:772
    ds_read_b32 v78, v6 offset:776
    ds_read_b32 v80, v6 offset:2304
    ds_read_b32 v81, v6 offset:2308
    ds_read_b32 v82, v6 offset:2312
    ds_read_b32 v84, v6 offset:3840
    ds_read_b32 v85, v6 offset:3844
    ds_read_b32 v86, v6 offset:3848
    ds_read_b32 v88, v6 offset:5376
    ds_read_b32 v89, v6 offset:5380
    ds_read_b32 v90, v6 offset:5384
    ds_read_b32 v92, v6 offset:6912
    ds_read_b32 v93, v6 offset:6916
    ds_read_b32 v94, v6 offset:6920
    ds_read_b32 v96, v6 offset:8448
    ds_read_b32 v97, v6 offset:8452
    ds_read_b32 v98, v6 offset:8456
    s_cmp_lg_u32 s40, 3
    s_cbranch_scc1 L_p1_kernel_ld_37
    s_mov_b32 s36, 9437184
    buffer_store_dwordx4 v[32:35], v3, s[72:75], s36 offen sc1
    s_branch L_p1_kernel_st_38
L_p1_kernel_ld_37:
    s_add_u32 s35, s33, 49348608
    buffer_load_dwordx4 v[32:35], v1, s[8:11], s35 offen nt
L_p1_kernel_st_38:
    v_mov_b32 v8, 0
    v_mov_b32 v9, 0
    v_mov_b32 v10, 0
    v_mov_b32 v11, 0
    v_mov_b32 v15, 16384
    v_min_u32 v7, 16, v0
    v_lshlrev_b32 v7, 2, v7
    v_add_u32 v7, 160768, v7
    s_waitcnt lgkmcnt(0)
    s_barrier
    ds_write_b128 v1, v[8:11] offset:0
    ds_write_b32 v7, v8
    s_nop 1
    v_mov_b32 v6, 1140817920
    s_waitcnt vmcnt(14)
    v_pk_maximum3_f16 v5, v100, v101, v5
    v_mad_u32_u16 v6, v120, s50, v15 op_sel:[0,0,0,0]
    v_mad_u32_u16 v7, v120, s50, v15 op_sel:[1,0,0,0]
    v_mad_u32_u16 v8, v121, s50, v15 op_sel:[0,0,0,0]
    v_mad_u32_u16 v9, v121, s50, v15 op_sel:[1,0,0,0]
    v_add_u32_sdwa v6, v6, v120 dst_sel:DWORD dst_unused:UNUSED_PAD src0_sel:WORD_1 src1_sel:WORD_0
    v_add_u32_sdwa v7, v7, v120 dst_sel:DWORD dst_unused:UNUSED_PAD src0_sel:WORD_1 src1_sel:WORD_1
    v_add_u32_sdwa v8, v8, v121 dst_sel:DWORD dst_unused:UNUSED_PAD src0_sel:WORD_1 src1_sel:WORD_0
    v_add_u32_sdwa v9, v9, v121 dst_sel:DWORD dst_unused:UNUSED_PAD src0_sel:WORD_1 src1_sel:WORD_1
    v_add_u32 v6, v6, v6
    v_add_u32 v7, v7, v7
    v_add_u32 v8, v8, v8
    v_add_u32 v9, v9, v9
    ds_write_b16 v6, v100 offset:16384
    ds_write_b16_d16_hi v7, v100 offset:16384
    ds_write_b16 v8, v101 offset:16384
    ds_write_b16_d16_hi v9, v101 offset:16384
    v_mov_b32 v6, 1140817920
    s_waitcnt vmcnt(13)
    v_pk_maximum3_f16 v5, v102, v103, v5
    v_mad_u32_u16 v6, v122, s50, v15 op_sel:[0,0,0,0]
    v_mad_u32_u16 v7, v122, s50, v15 op_sel:[1,0,0,0]
    v_mad_u32_u16 v8, v123, s50, v15 op_sel:[0,0,0,0]
    v_mad_u32_u16 v9, v123, s50, v15 op_sel:[1,0,0,0]
    v_add_u32_sdwa v6, v6, v122 dst_sel:DWORD dst_unused:UNUSED_PAD src0_sel:WORD_1 src1_sel:WORD_0
    v_add_u32_sdwa v7, v7, v122 dst_sel:DWORD dst_unused:UNUSED_PAD src0_sel:WORD_1 src1_sel:WORD_1
    v_add_u32_sdwa v8, v8, v123 dst_sel:DWORD dst_unused:UNUSED_PAD src0_sel:WORD_1 src1_sel:WORD_0
    v_add_u32_sdwa v9, v9, v123 dst_sel:DWORD dst_unused:UNUSED_PAD src0_sel:WORD_1 src1_sel:WORD_1
    v_add_u32 v6, v6, v6
    v_add_u32 v7, v7, v7
    v_add_u32 v8, v8, v8
    v_add_u32 v9, v9, v9
    ds_write_b16 v6, v102 offset:16384
    ds_write_b16_d16_hi v7, v102 offset:16384
    ds_write_b16 v8, v103 offset:16384
    ds_write_b16_d16_hi v9, v103 offset:16384
    v_mov_b32 v6, 1140817920
    s_waitcnt vmcnt(12)
    v_pk_maximum3_f16 v5, v104, v105, v5
    v_mad_u32_u16 v6, v124, s50, v15 op_sel:[0,0,0,0]
    v_mad_u32_u16 v7, v124, s50, v15 op_sel:[1,0,0,0]
    v_mad_u32_u16 v8, v125, s50, v15 op_sel:[0,0,0,0]
    v_mad_u32_u16 v9, v125, s50, v15 op_sel:[1,0,0,0]
    v_add_u32_sdwa v6, v6, v124 dst_sel:DWORD dst_unused:UNUSED_PAD src0_sel:WORD_1 src1_sel:WORD_0
    v_add_u32_sdwa v7, v7, v124 dst_sel:DWORD dst_unused:UNUSED_PAD src0_sel:WORD_1 src1_sel:WORD_1
    v_add_u32_sdwa v8, v8, v125 dst_sel:DWORD dst_unused:UNUSED_PAD src0_sel:WORD_1 src1_sel:WORD_0
    v_add_u32_sdwa v9, v9, v125 dst_sel:DWORD dst_unused:UNUSED_PAD src0_sel:WORD_1 src1_sel:WORD_1
    v_add_u32 v6, v6, v6
    v_add_u32 v7, v7, v7
    v_add_u32 v8, v8, v8
    v_add_u32 v9, v9, v9
    ds_write_b16 v6, v104 offset:16384
    ds_write_b16_d16_hi v7, v104 offset:16384
    ds_write_b16 v8, v105 offset:16384
    ds_write_b16_d16_hi v9, v105 offset:16384
    s_cmp_lg_u32 s40, 3
    s_cbranch_scc1 L_p1_kernel_ld_39
    s_mov_b32 s36, 10485760
    buffer_store_dwordx4 v[36:39], v3, s[72:75], s36 offen sc1
    s_branch L_p1_kernel_st_40
L_p1_kernel_ld_39:
    s_add_u32 s35, s33, 49348608
    buffer_load_dwordx4 v[36:39], v1, s[12:15], s35 offen nt
L_p1_kernel_st_40:
    v_mov_b32 v6, 1140817920
    s_waitcnt vmcnt(12)
    v_pk_maximum3_f16 v5, v106, v107, v5
    v_mad_u32_u16 v6, v126, s50, v15 op_sel:[0,0,0,0]
    v_mad_u32_u16 v7, v126, s50, v15 op_sel:[1,0,0,0]
    v_mad_u32_u16 v8, v51, s50, v15 op_sel:[0,0,0,0]
    v_mad_u32_u16 v9, v51, s50, v15 op_sel:[1,0,0,0]
    v_add_u32_sdwa v6, v6, v126 dst_sel:DWORD dst_unused:UNUSED_PAD src0_sel:WORD_1 src1_sel:WORD_0
    v_add_u32_sdwa v7, v7, v126 dst_sel:DWORD dst_unused:UNUSED_PAD src0_sel:WORD_1 src1_sel:WORD_1
    v_add_u32_sdwa v8, v8, v51 dst_sel:DWORD dst_unused:UNUSED_PAD src0_sel:WORD_1 src1_sel:WORD_0
    v_add_u32_sdwa v9, v9, v51 dst_sel:DWORD dst_unused:UNUSED_PAD src0_sel:WORD_1 src1_sel:WORD_1
    v_add_u32 v6, v6, v6
    v_add_u32 v7, v7, v7
    v_add_u32 v8, v8, v8
    v_add_u32 v9, v9, v9
    ds_write_b16 v6, v106 offset:16384
    ds_write_b16_d16_hi v7, v106 offset:16384
    ds_write_b16 v8, v107 offset:16384
    ds_write_b16_d16_hi v9, v107 offset:16384
    v_mov_b32 v6, 1140817920
    s_waitcnt vmcnt(11)
    v_pk_maximum3_f16 v5, v108, v109, v5
    v_mad_u32_u16 v6, v55, s50, v15 op_sel:[0,0,0,0]
    v_mad_u32_u16 v7, v55, s50, v15 op_sel:[1,0,0,0]
    v_mad_u32_u16 v8, v59, s50, v15 op_sel:[0,0,0,0]
    v_mad_u32_u16 v9, v59, s50, v15 op_sel:[1,0,0,0]
    v_add_u32_sdwa v6, v6, v55 dst_sel:DWORD dst_unused:UNUSED_PAD src0_sel:WORD_1 src1_sel:WORD_0
    v_add_u32_sdwa v7, v7, v55 dst_sel:DWORD dst_unused:UNUSED_PAD src0_sel:WORD_1 src1_sel:WORD_1
    v_add_u32_sdwa v8, v8, v59 dst_sel:DWORD dst_unused:UNUSED_PAD src0_sel:WORD_1 src1_sel:WORD_0
    v_add_u32_sdwa v9, v9, v59 dst_sel:DWORD dst_unused:UNUSED_PAD src0_sel:WORD_1 src1_sel:WORD_1
    v_add_u32 v6, v6, v6
    v_add_u32 v7, v7, v7
    v_add_u32 v8, v8, v8
    v_add_u32 v9, v9, v9
    ds_write_b16 v6, v108 offset:16384
    ds_write_b16_d16_hi v7, v108 offset:16384
    ds_write_b16 v8, v109 offset:16384
    ds_write_b16_d16_hi v9, v109 offset:16384
    v_mov_b32 v6, 1140817920
    s_waitcnt vmcnt(10)
    v_pk_maximum3_f16 v5, v110, v111, v5
    v_mad_u32_u16 v6, v63, s50, v15 op_sel:[0,0,0,0]
    v_mad_u32_u16 v7, v63, s50, v15 op_sel:[1,0,0,0]
    v_mad_u32_u16 v8, v67, s50, v15 op_sel:[0,0,0,0]
    v_mad_u32_u16 v9, v67, s50, v15 op_sel:[1,0,0,0]
    v_add_u32_sdwa v6, v6, v63 dst_sel:DWORD dst_unused:UNUSED_PAD src0_sel:WORD_1 src1_sel:WORD_0
    v_add_u32_sdwa v7, v7, v63 dst_sel:DWORD dst_unused:UNUSED_PAD src0_sel:WORD_1 src1_sel:WORD_1
    v_add_u32_sdwa v8, v8, v67 dst_sel:DWORD dst_unused:UNUSED_PAD src0_sel:WORD_1 src1_sel:WORD_0
    v_add_u32_sdwa v9, v9, v67 dst_sel:DWORD dst_unused:UNUSED_PAD src0_sel:WORD_1 src1_sel:WORD_1
    v_add_u32 v6, v6, v6
    v_add_u32 v7, v7, v7
    v_add_u32 v8, v8, v8
    v_add_u32 v9, v9, v9
    ds_write_b16 v6, v110 offset:16384
    ds_write_b16_d16_hi v7, v110 offset:16384
    ds_write_b16 v8, v111 offset:16384
    ds_write_b16_d16_hi v9, v111 offset:16384
    s_cmp_lg_u32 s40, 3
    s_cbranch_scc1 L_p1_kernel_ld_41
    s_mov_b32 s36, 11534336
    buffer_store_dwordx4 v[40:43], v3, s[72:75], s36 offen sc1
    s_branch L_p1_kernel_st_42
L_p1_kernel_ld_41:
    s_add_u32 s35, s33, 53542912
    buffer_load_dwordx4 v[40:43], v1, s[8:11], s35 offen nt
L_p1_kernel_st_42:
    v_mov_b32 v6, 1140817920
    s_waitcnt vmcnt(10)
    v_pk_maximum3_f16 v5, v112, v113, v5
    v_mad_u32_u16 v6, v71, s50, v15 op_sel:[0,0,0,0]
    v_mad_u32_u16 v7, v71, s50, v15 op_sel:[1,0,0,0]
    v_mad_u32_u16 v8, v75, s50, v15 op_sel:[0,0,0,0]
    v_mad_u32_u16 v9, v75, s50, v15 op_sel:[1,0,0,0]
    v_add_u32_sdwa v6, v6, v71 dst_sel:DWORD dst_unused:UNUSED_PAD src0_sel:WORD_1 src1_sel:WORD_0
    v_add_u32_sdwa v7, v7, v71 dst_sel:DWORD dst_unused:UNUSED_PAD src0_sel:WORD_1 src1_sel:WORD_1
    v_add_u32_sdwa v8, v8, v75 dst_sel:DWORD dst_unused:UNUSED_PAD src0_sel:WORD_1 src1_sel:WORD_0
    v_add_u32_sdwa v9, v9, v75 dst_sel:DWORD dst_unused:UNUSED_PAD src0_sel:WORD_1 src1_sel:WORD_1
    v_add_u32 v6, v6, v6
    v_add_u32 v7, v7, v7
    v_add_u32 v8, v8, v8
    v_add_u32 v9, v9, v9
    ds_write_b16 v6, v112 offset:16384
    ds_write_b16_d16_hi v7, v112 offset:16384
    ds_write_b16 v8, v113 offset:16384
    ds_write_b16_d16_hi v9, v113 offset:16384
    v_mov_b32 v6, 1140817920
    s_waitcnt vmcnt(9)
    v_pk_maximum3_f16 v5, v114, v115, v5
    v_mad_u32_u16 v6, v79, s50, v15 op_sel:[0,0,0,0]
    v_mad_u32_u16 v7, v79, s50, v15 op_sel:[1,0,0,0]
    v_mad_u32_u16 v8, v83, s50, v15 op_sel:[0,0,0,0]
    v_mad_u32_u16 v9, v83, s50, v15 op_sel:[1,0,0,0]
    v_add_u32_sdwa v6, v6, v79 dst_sel:DWORD dst_unused:UNUSED_PAD src0_sel:WORD_1 src1_sel:WORD_0
    v_add_u32_sdwa v7, v7, v79 dst_sel:DWORD dst_unused:UNUSED_PAD src0_sel:WORD_1 src1_sel:WORD_1
    v_add_u32_sdwa v8, v8, v83 dst_sel:DWORD dst_unused:UNUSED_PAD src0_sel:WORD_1 src1_sel:WORD_0
    v_add_u32_sdwa v9, v9, v83 dst_sel:DWORD dst_unused:UNUSED_PAD src0_sel:WORD_1 src1_sel:WORD_1
    v_add_u32 v6, v6, v6
    v_add_u32 v7, v7, v7
    v_add_u32 v8, v8, v8
    v_add_u32 v9, v9, v9
    ds_write_b16 v6, v114 offset:16384
    ds_write_b16_d16_hi v7, v114 offset:16384
    ds_write_b16 v8, v115 offset:16384
    ds_write_b16_d16_hi v9, v115 offset:16384
    v_mov_b32 v6, 1140817920
    s_waitcnt vmcnt(8)
    v_pk_maximum3_f16 v5, v116, v117, v5
    v_mad_u32_u16 v6, v87, s50, v15 op_sel:[0,0,0,0]
    v_mad_u32_u16 v7, v87, s50, v15 op_sel:[1,0,0,0]
    v_mad_u32_u16 v8, v91, s50, v15 op_sel:[0,0,0,0]
    v_mad_u32_u16 v9, v91, s50, v15 op_sel:[1,0,0,0]
    v_add_u32_sdwa v6, v6, v87 dst_sel:DWORD dst_unused:UNUSED_PAD src0_sel:WORD_1 src1_sel:WORD_0
    v_add_u32_sdwa v7, v7, v87 dst_sel:DWORD dst_unused:UNUSED_PAD src0_sel:WORD_1 src1_sel:WORD_1
    v_add_u32_sdwa v8, v8, v91 dst_sel:DWORD dst_unused:UNUSED_PAD src0_sel:WORD_1 src1_sel:WORD_0
    v_add_u32_sdwa v9, v9, v91 dst_sel:DWORD dst_unused:UNUSED_PAD src0_sel:WORD_1 src1_sel:WORD_1
    v_add_u32 v6, v6, v6
    v_add_u32 v7, v7, v7
    v_add_u32 v8, v8, v8
    v_add_u32 v9, v9, v9
    ds_write_b16 v6, v116 offset:16384
    ds_write_b16_d16_hi v7, v116 offset:16384
    ds_write_b16 v8, v117 offset:16384
    ds_write_b16_d16_hi v9, v117 offset:16384
    s_cmp_lg_u32 s40, 3
    s_cbranch_scc1 L_p1_kernel_ld_43
    s_mov_b32 s36, 12582912
    buffer_store_dwordx4 v[44:47], v3, s[72:75], s36 offen sc1
    s_branch L_p1_kernel_st_44
L_p1_kernel_ld_43:
    s_add_u32 s35, s33, 53542912
    buffer_load_dwordx4 v[44:47], v1, s[12:15], s35 offen nt
L_p1_kernel_st_44:
    v_mov_b32 v6, 1140817920
    s_mov_b64 exec, s[44:45]
    s_waitcnt vmcnt(8)
    v_pk_maximum3_f16 v5, v118, v119, v5
    s_mov_b64 exec, -1
    s_mov_b64 exec, s[44:45]
    v_mad_u32_u16 v6, v95, s50, v15 op_sel:[0,0,0,0]
    v_mad_u32_u16 v7, v95, s50, v15 op_sel:[1,0,0,0]
    v_mad_u32_u16 v8, v99, s50, v15 op_sel:[0,0,0,0]
    v_mad_u32_u16 v9, v99, s50, v15 op_sel:[1,0,0,0]
    v_add_u32_sdwa v6, v6, v95 dst_sel:DWORD dst_unused:UNUSED_PAD src0_sel:WORD_1 src1_sel:WORD_0
    v_add_u32_sdwa v7, v7, v95 dst_sel:DWORD dst_unused:UNUSED_PAD src0_sel:WORD_1 src1_sel:WORD_1
    v_add_u32_sdwa v8, v8, v99 dst_sel:DWORD dst_unused:UNUSED_PAD src0_sel:WORD_1 src1_sel:WORD_0
    v_add_u32_sdwa v9, v9, v99 dst_sel:DWORD dst_unused:UNUSED_PAD src0_sel:WORD_1 src1_sel:WORD_1
    v_add_u32 v6, v6, v6
    v_add_u32 v7, v7, v7
    v_add_u32 v8, v8, v8
    v_add_u32 v9, v9, v9
    ds_write_b16 v6, v118 offset:16384
    ds_write_b16_d16_hi v7, v118 offset:16384
    ds_write_b16 v8, v119 offset:16384
    ds_write_b16_d16_hi v9, v119 offset:16384
    s_mov_b64 exec, -1
    s_mul_i32 s35, s39, 6144
    v_add_u32 v6, s35, v2
    v_mov_b32 v10, 1140817920
    s_waitcnt lgkmcnt(0)
    s_barrier
    ds_read_b64 v[120:121], v6 offset:23040
    ds_read_b64 v[122:123], v6 offset:16384
    ds_read_b64 v[124:125], v6 offset:16896
    ds_read_b64 v[126:127], v6 offset:17408
    ds_read_b64 v[100:101], v6 offset:17920
    ds_read_b64 v[102:103], v6 offset:18432
    ds_read_b64 v[104:105], v6 offset:18944
    ds_read_b64 v[106:107], v6 offset:19456
    ds_read_b64 v[108:109], v6 offset:19968
    ds_read_b64 v[110:111], v6 offset:20480
    ds_read_b64 v[112:113], v6 offset:20992
    ds_read_b64 v[114:115], v6 offset:21504
    ds_read_b64 v[116:117], v6 offset:22016
    ds_read_b64 v[118:119], v6 offset:22528
    s_add_u32 s32, s32, 256
    s_add_u32 s33, s33, 40960000
    s_add_u32 s34, s34, 20480000
    s_add_u32 s40, s40, 1
    s_cmp_lt_u32 s40, 4
    s_cbranch_scc1 L_p1_loop
    s_cmp_lg_u32 s39, 15
    s_cbranch_scc1 L_p1_kernel_nox_45
    s_waitcnt lgkmcnt(13)
    v_lshlrev_b32 v15, 16, v120
    v_and_b32 v120, 0xffff0000, v120
    v_lshlrev_b32 v121, 16, v121
    v_mul_f32 v15, s41, v15
    v_mul_f32 v120, s41, v120
    v_mul_f32 v121, s41, v121
    v_fract_f32 v15, v15
    v_fract_f32 v120, v120
    v_fract_f32 v121, v121
    v_cos_f32 v15, v15
    v_cos_f32 v120, v120
    v_cos_f32 v121, v121
    v_fmaak_f32 v15, v10, v15, 1262486016
    v_fmaak_f32 v120, v10, v120, 1262486016
    v_fmaak_f32 v121, v10, v121, 1262486016
    v_lshlrev_b32 v15, 22, v15
    v_alignbit_b32 v15, v120, v15, 10
    v_alignbit_b32 v15, v121, v15, 10
    v_xor_b32 v15, 0x80200800, v15
    s_mov_b32 s36, 13631488
    buffer_store_dwordx4 v[12:15], v3, s[20:23], s36 offen sc1
L_p1_kernel_nox_45:
    s_waitcnt lgkmcnt(12)
    v_lshlrev_b32 v75, 16, v122
    v_and_b32 v122, 0xffff0000, v122
    v_lshlrev_b32 v123, 16, v123
    v_mul_f32 v75, s41, v75
    v_mul_f32 v122, s41, v122
    v_mul_f32 v123, s41, v123
    v_fract_f32 v75, v75
    v_fract_f32 v122, v122
    v_fract_f32 v123, v123
    v_cos_f32 v75, v75
    v_cos_f32 v122, v122
    v_cos_f32 v123, v123
    v_fmaak_f32 v75, v10, v75, 1262486016
    v_fmaak_f32 v122, v10, v122, 1262486016
    v_fmaak_f32 v123, v10, v123, 1262486016
    v_lshlrev_b32 v75, 22, v75
    v_alignbit_b32 v75, v122, v75, 10
    v_alignbit_b32 v75, v123, v75, 10
    v_xor_b32 v75, 0x80200800, v75
    s_mov_b32 s36, 0
    buffer_store_dwordx4 v[72:75], v3, s[20:23], s36 offen sc1
    s_waitcnt lgkmcnt(11)
    v_lshlrev_b32 v79, 16, v124
    v_and_b32 v124, 0xffff0000, v124
    v_lshlrev_b32 v125, 16, v125
    v_mul_f32 v79, s41, v79
    v_mul_f32 v124, s41, v124
    v_mul_f32 v125, s41, v125
    v_fract_f32 v79, v79
    v_fract_f32 v124, v124
    v_fract_f32 v125, v125
    v_cos_f32 v79, v79
    v_cos_f32 v124, v124
    v_cos_f32 v125, v125
    v_fmaak_f32 v79, v10, v79, 1262486016
    v_fmaak_f32 v124, v10, v124, 1262486016
    v_fmaak_f32 v125, v10, v125, 1262486016
    v_lshlrev_b32 v79, 22, v79
    v_alignbit_b32 v79, v124, v79, 10
    v_alignbit_b32 v79, v125, v79, 10
    v_xor_b32 v79, 0x80200800, v79
    s_mov_b32 s36, 1048576
    buffer_store_dwordx4 v[76:79], v3, s[20:23], s36 offen sc1
    s_waitcnt lgkmcnt(0)
    v_lshlrev_b32 v51, 16, v126
    v_and_b32 v126, 0xffff0000, v126
    v_lshlrev_b32 v127, 16, v127
    v_mul_f32 v51, s41, v51
    v_mul_f32 v126, s41, v126
    v_mul_f32 v127, s41, v127
    v_fract_f32 v51, v51
    v_fract_f32 v126, v126
    v_fract_f32 v127, v127
    v_cos_f32 v51, v51
    v_cos_f32 v126, v126
    v_cos_f32 v127, v127
    v_fmaak_f32 v51, v10, v51, 1262486016
    v_fmaak_f32 v126, v10, v126, 1262486016
    v_fmaak_f32 v127, v10, v127, 1262486016
    v_lshlrev_b32 v51, 22, v51
    v_alignbit_b32 v51, v126, v51, 10
    v_alignbit_b32 v51, v127, v51, 10
    v_xor_b32 v51, 0x80200800, v51
    s_mov_b32 s36, 2097152
    buffer_store_dwordx4 v[48:51], v3, s[20:23], s36 offen sc1
    v_lshlrev_b32 v83, 16, v100
    v_and_b32 v100, 0xffff0000, v100
    v_lshlrev_b32 v101, 16, v101
    v_mul_f32 v83, s41, v83
    v_mul_f32 v100, s41, v100
    v_mul_f32 v101, s41, v101
    v_fract_f32 v83, v83
    v_fract_f32 v100, v100
    v_fract_f32 v101, v101
    v_cos_f32 v83, v83
    v_cos_f32 v100, v100
    v_cos_f32 v101, v101
    v_fmaak_f32 v83, v10, v83, 1262486016
    v_fmaak_f32 v100, v10, v100, 1262486016
    v_fmaak_f32 v101, v10, v101, 1262486016
    v_lshlrev_b32 v83, 22, v83
    v_alignbit_b32 v83, v100, v83, 10
    v_alignbit_b32 v83, v101, v83, 10
    v_xor_b32 v83, 0x80200800, v83
    s_mov_b32 s36, 3145728
    buffer_store_dwordx4 v[80:83], v3, s[20:23], s36 offen sc1
    v_lshlrev_b32 v55, 16, v102
    v_and_b32 v102, 0xffff0000, v102
    v_lshlrev_b32 v103, 16, v103
    v_mul_f32 v55, s41, v55
    v_mul_f32 v102, s41, v102
    v_mul_f32 v103, s41, v103
    v_fract_f32 v55, v55
    v_fract_f32 v102, v102
    v_fract_f32 v103, v103
    v_cos_f32 v55, v55
    v_cos_f32 v102, v102
    v_cos_f32 v103, v103
    v_fmaak_f32 v55, v10, v55, 1262486016
    v_fmaak_f32 v102, v10, v102, 1262486016
    v_fmaak_f32 v103, v10, v103, 1262486016
    v_lshlrev_b32 v55, 22, v55
    v_alignbit_b32 v55, v102, v55, 10
    v_alignbit_b32 v55, v103, v55, 10
    v_xor_b32 v55, 0x80200800, v55
    s_mov_b32 s36, 4194304
    buffer_store_dwordx4 v[52:55], v3, s[20:23], s36 offen sc1
    v_lshlrev_b32 v87, 16, v104
    v_and_b32 v104, 0xffff0000, v104
    v_lshlrev_b32 v105, 16, v105
    v_mul_f32 v87, s41, v87
    v_mul_f32 v104, s41, v104
    v_mul_f32 v105, s41, v105
    v_fract_f32 v87, v87
    v_fract_f32 v104, v104
    v_fract_f32 v105, v105
    v_cos_f32 v87, v87
    v_cos_f32 v104, v104
    v_cos_f32 v105, v105
    v_fmaak_f32 v87, v10, v87, 1262486016
    v_fmaak_f32 v104, v10, v104, 1262486016
    v_fmaak_f32 v105, v10, v105, 1262486016
    v_lshlrev_b32 v87, 22, v87
    v_alignbit_b32 v87, v104, v87, 10
    v_alignbit_b32 v87, v105, v87, 10
    v_xor_b32 v87, 0x80200800, v87
    s_mov_b32 s36, 5242880
    buffer_store_dwordx4 v[84:87], v3, s[20:23], s36 offen sc1
    v_lshlrev_b32 v59, 16, v106
    v_and_b32 v106, 0xffff0000, v106
    v_lshlrev_b32 v107, 16, v107
    v_mul_f32 v59, s41, v59
    v_mul_f32 v106, s41, v106
    v_mul_f32 v107, s41, v107
    v_fract_f32 v59, v59
    v_fract_f32 v106, v106
    v_fract_f32 v107, v107
    v_cos_f32 v59, v59
    v_cos_f32 v106, v106
    v_cos_f32 v107, v107
    v_fmaak_f32 v59, v10, v59, 1262486016
    v_fmaak_f32 v106, v10, v106, 1262486016
    v_fmaak_f32 v107, v10, v107, 1262486016
    v_lshlrev_b32 v59, 22, v59
    v_alignbit_b32 v59, v106, v59, 10
    v_alignbit_b32 v59, v107, v59, 10
    v_xor_b32 v59, 0x80200800, v59
    s_mov_b32 s36, 6291456
    buffer_store_dwordx4 v[56:59], v3, s[20:23], s36 offen sc1
    v_lshlrev_b32 v91, 16, v108
    v_and_b32 v108, 0xffff0000, v108
    v_lshlrev_b32 v109, 16, v109
    v_mul_f32 v91, s41, v91
    v_mul_f32 v108, s41, v108
    v_mul_f32 v109, s41, v109
    v_fract_f32 v91, v91
    v_fract_f32 v108, v108
    v_fract_f32 v109, v109
    v_cos_f32 v91, v91
    v_cos_f32 v108, v108
    v_cos_f32 v109, v109
    v_fmaak_f32 v91, v10, v91, 1262486016
    v_fmaak_f32 v108, v10, v108, 1262486016
    v_fmaak_f32 v109, v10, v109, 1262486016
    v_lshlrev_b32 v91, 22, v91
    v_alignbit_b32 v91, v108, v91, 10
    v_alignbit_b32 v91, v109, v91, 10
    v_xor_b32 v91, 0x80200800, v91
    s_mov_b32 s36, 7340032
    buffer_store_dwordx4 v[88:91], v3, s[20:23], s36 offen sc1
    v_lshlrev_b32 v63, 16, v110
    v_and_b32 v110, 0xffff0000, v110
    v_lshlrev_b32 v111, 16, v111
    v_mul_f32 v63, s41, v63
    v_mul_f32 v110, s41, v110
    v_mul_f32 v111, s41, v111
    v_fract_f32 v63, v63
    v_fract_f32 v110, v110
    v_fract_f32 v111, v111
    v_cos_f32 v63, v63
    v_cos_f32 v110, v110
    v_cos_f32 v111, v111
    v_fmaak_f32 v63, v10, v63, 1262486016
    v_fmaak_f32 v110, v10, v110, 1262486016
    v_fmaak_f32 v111, v10, v111, 1262486016
    v_lshlrev_b32 v63, 22, v63
    v_alignbit_b32 v63, v110, v63, 10
    v_alignbit_b32 v63, v111, v63, 10
    v_xor_b32 v63, 0x80200800, v63
    s_mov_b32 s36, 8388608
    buffer_store_dwordx4 v[60:63], v3, s[20:23], s36 offen sc1
    v_lshlrev_b32 v95, 16, v112
    v_and_b32 v112, 0xffff0000, v112
    v_lshlrev_b32 v113, 16, v113
    v_mul_f32 v95, s41, v95
    v_mul_f32 v112, s41, v112
    v_mul_f32 v113, s41, v113
    v_fract_f32 v95, v95
    v_fract_f32 v112, v112
    v_fract_f32 v113, v113
    v_cos_f32 v95, v95
    v_cos_f32 v112, v112
    v_cos_f32 v113, v113
    v_fmaak_f32 v95, v10, v95, 1262486016
    v_fmaak_f32 v112, v10, v112, 1262486016
    v_fmaak_f32 v113, v10, v113, 1262486016
    v_lshlrev_b32 v95, 22, v95
    v_alignbit_b32 v95, v112, v95, 10
    v_alignbit_b32 v95, v113, v95, 10
    v_xor_b32 v95, 0x80200800, v95
    s_mov_b32 s36, 9437184
    buffer_store_dwordx4 v[92:95], v3, s[20:23], s36 offen sc1
    v_lshlrev_b32 v67, 16, v114
    v_and_b32 v114, 0xffff0000, v114
    v_lshlrev_b32 v115, 16, v115
    v_mul_f32 v67, s41, v67
    v_mul_f32 v114, s41, v114
    v_mul_f32 v115, s41, v115
    v_fract_f32 v67, v67
    v_fract_f32 v114, v114
    v_fract_f32 v115, v115
    v_cos_f32 v67, v67
    v_cos_f32 v114, v114
    v_cos_f32 v115, v115
    v_fmaak_f32 v67, v10, v67, 1262486016
    v_fmaak_f32 v114, v10, v114, 1262486016
    v_fmaak_f32 v115, v10, v115, 1262486016
    v_lshlrev_b32 v67, 22, v67
    v_alignbit_b32 v67, v114, v67, 10
    v_alignbit_b32 v67, v115, v67, 10
    v_xor_b32 v67, 0x80200800, v67
    s_mov_b32 s36, 10485760
    buffer_store_dwordx4 v[64:67], v3, s[20:23], s36 offen sc1
    v_lshlrev_b32 v99, 16, v116
    v_and_b32 v116, 0xffff0000, v116
    v_lshlrev_b32 v117, 16, v117
    v_mul_f32 v99, s41, v99
    v_mul_f32 v116, s41, v116
    v_mul_f32 v117, s41, v117
    v_fract_f32 v99, v99
    v_fract_f32 v116, v116
    v_fract_f32 v117, v117
    v_cos_f32 v99, v99
    v_cos_f32 v116, v116
    v_cos_f32 v117, v117
    v_fmaak_f32 v99, v10, v99, 1262486016
    v_fmaak_f32 v116, v10, v116, 1262486016
    v_fmaak_f32 v117, v10, v117, 1262486016
    v_lshlrev_b32 v99, 22, v99
    v_alignbit_b32 v99, v116, v99, 10
    v_alignbit_b32 v99, v117, v99, 10
    v_xor_b32 v99, 0x80200800, v99
    s_mov_b32 s36, 11534336
    buffer_store_dwordx4 v[96:99], v3, s[20:23], s36 offen sc1
    v_lshlrev_b32 v71, 16, v118
    v_and_b32 v118, 0xffff0000, v118
    v_lshlrev_b32 v119, 16, v119
    v_mul_f32 v71, s41, v71
    v_mul_f32 v118, s41, v118
    v_mul_f32 v119, s41, v119
    v_fract_f32 v71, v71
    v_fract_f32 v118, v118
    v_fract_f32 v119, v119
    v_cos_f32 v71, v71
    v_cos_f32 v118, v118
    v_cos_f32 v119, v119
    v_fmaak_f32 v71, v10, v71, 1262486016
    v_fmaak_f32 v118, v10, v118, 1262486016
    v_fmaak_f32 v119, v10, v119, 1262486016
    v_lshlrev_b32 v71, 22, v71
    v_alignbit_b32 v71, v118, v71, 10
    v_alignbit_b32 v71, v119, v71, 10
    v_xor_b32 v71, 0x80200800, v71
    s_mov_b32 s36, 12582912
    buffer_store_dwordx4 v[68:71], v3, s[20:23], s36 offen sc1
    v_and_b32 v6, 0x7c007c00, v5
    v_add_u32 v6, 0x04000400, v6
    v_and_b32 v6, 0x80008000, v6
    v_cmp_ne_u32 vcc, 0, v6
    s_lshl_b32 s35, s2, 3
    s_add_u32 s35, s35, 8519682
    s_mov_b32 s26, 8540160
    s_cmp_lg_u64 vcc, 0
    s_cselect_b32 s55, 1, s55
    s_cmp_eq_u32 s55, 0
    s_cbranch_scc1 L_p1_end
    s_mov_b64 exec, 1
    buffer_store_short v4, off, s[24:27], s35 sc1
L_p1_end:
    s_endpgm
.globl p2_kernel
.p2align 8
.type p2_kernel,@function
p2_kernel:
    s_cmp_ge_u32 s2, 256
    s_cbranch_scc1 L_p2_end
    s_load_dwordx2 s[4:5], s[0:1], 104
    s_load_dwordx2 s[100:101], s[0:1], 24
    s_load_dwordx2 s[8:9], s[0:1], 0
    s_load_dwordx2 s[30:31], s[0:1], 40
    s_load_dwordx4 s[32:35], s[0:1], 56
    s_load_dwordx4 s[36:39], s[0:1], 72
    s_and_b32 s14, s2, 7
    s_lshr_b32 s49, s2, 3
    s_and_b32 s3, s14, 1
    s_lshl_b32 s3, s3, 5
    s_add_u32 s3, s3, s49
    s_lshr_b32 s12, s14, 1
    v_lshrrev_b32 v108, 6, v0
    v_lshlrev_b32 v1, 4, v0
    v_and_b32 v109, 63, v0
    v_readfirstlane_b32 s13, v108
    v_lshlrev_b32 v111, 4, v109
    v_lshrrev_b32 v110, 2, v109
    v_mul_u32_u24 v110, 8256, v110
    v_add_u32 v110, v110, v111
    s_mul_i32 s14, s12, 65
    s_add_u32 s14, s14, s3
    s_lshl_b32 s14, s14, 5
    s_mul_i32 s15, s13, 532480
    s_add_u32 s14, s14, s15
    s_add_u32 s25, s14, 0
    s_mul_i32 s22, s12, 1280000
    s_mov_b32 s2, 0
    s_waitcnt lgkmcnt(0)
    s_mov_b32 s6, 655360000
    s_mov_b32 s7, 0x00020000
    s_add_u32 s10, s22, 1280000
    s_mov_b32 s11, 0x00020000
    s_add_u32 s15, s25, 0
    buffer_load_dwordx4 v[28:31], v110, s[4:7], s15 offen
    s_add_u32 s15, s25, 133120
    buffer_load_dwordx4 v[32:35], v110, s[4:7], s15 offen
    s_add_u32 s15, s25, 266240
    buffer_load_dwordx4 v[36:39], v110, s[4:7], s15 offen
    s_add_u32 s15, s25, 399360
    buffer_load_dwordx4 v[40:43], v110, s[4:7], s15 offen
    s_load_dwordx4 s[40:43], s[30:31], 0
    s_load_dwordx16 s[52:67], s[32:33], 0
    s_load_dwordx16 s[68:83], s[34:35], 0
    s_load_dwordx8 s[84:91], s[36:37], 0
    s_load_dwordx8 s[92:99], s[38:39], 0
    v_mov_b32 v52, 0x100
    s_cmp_lg_u32 s13, 0
    s_cbranch_scc1 L_p2_noann
    s_lshl_b32 s14, s3, 8
    s_add_u32 s14, s14, 8523776
    s_mov_b64 exec, 1
    buffer_atomic_add v52, off, s[4:7], s14
    s_mov_b64 exec, -1
L_p2_noann:
    s_add_u32 s14, s22, 0
    buffer_load_dwordx4 v[88:91], v1, s[8:11], s14 offen
    s_add_u32 s14, s22, 16384
    buffer_load_dwordx4 v[92:95], v1, s[8:11], s14 offen
    s_add_u32 s14, s22, 32768
    buffer_load_dwordx4 v[96:99], v1, s[8:11], s14 offen
    s_add_u32 s14, s22, 49152
    buffer_load_dwordx4 v[100:103], v1, s[8:11], s14 offen
    s_add_u32 s14, s22, 65536
    buffer_load_dwordx4 v[104:107], v1, s[8:11], s14 offen
    s_mov_b32 s15, 8519680
    buffer_load_dwordx4 v[80:83], v111, s[4:7], s15 offen offset:0
    buffer_load_dwordx4 v[84:87], v111, s[4:7], s15 offen offset:1024
    v_lshlrev_b32 v2, 10, v109
    v_mov_b32 v50, 21845
    v_add_u32 v3, 80000, v1
    v_add_u32 v124, 145536, v1
    v_add_u32 v113, 65536, v1
    v_mov_b32 v112, 0x7f000000
    v_cmp_gt_u32 vcc, 904, v0
    s_mul_i32 s19, s13, 240
    s_add_u32 s19, s19, 160000
    v_cndmask_b32 v124, v112, v124, vcc
    v_cndmask_b32 v113, v112, v113, vcc
    v_lshl_add_u32 v6, v109, 2, s19
    v_lshl_add_u32 v126, v109, 1, s19
    v_cmp_gt_u32 vcc, 10, v109
    s_lshl_b32 s27, s13, 16
    s_mov_b32 s23, 1024
    v_cndmask_b32 v6, v112, v6, vcc
    s_add_u32 s44, s4, 4194304
    s_addc_u32 s45, s5, 1048576
    s_mov_b32 s46, 14024704
    s_mov_b32 s47, 0x00020000
    s_mov_b32 s18, 80000
    s_and_b32 s50, s3, 1
    s_lshl_b32 s50, s50, 18
    s_sub_u32 s18, s18, s50
    s_sub_u32 s50, 4294836224, s50
    v_lshlrev_b32 v116, 3, v0
    v_and_b32 v116, 16, v116
    v_and_b32 v117, 1, v0
    v_lshl_or_b32 v116, v117, 5, v116
    v_mov_b32 v58, 0x3f80
    v_mov_b32 v59, 0
    v_lshlrev_b64 v[58:59], v116, v[58:59]
    v_mov_b32 v4, 0
    v_mov_b32 v5, 0
    v_mov_b32 v114, 0xff00
    v_bfe_u32 v127, v0, 0, 1
    v_mul_u32_u24 v127, 40, v127
    v_add_u32 v127, s19, v127
    ds_write2_b32 v6, v5, v5 offset0:34 offset1:44
    ds_write_b16 v126, v114 offset:2
    v_mov_b32 v44, 1073758208
    v_mov_b32 v45, 1073758208
    v_mov_b32 v46, 1073758208
    v_mov_b32 v47, 1073758208
    v_mov_b32 v48, 1073758208
    v_mov_b32 v49, 1073758208
    ds_write_b128 v113, v[44:47]
    v_lshrrev_b32 v115, 4, v109
    v_mul_u32_u24 v115, 15360, v115
    v_lshl_add_u32 v115, v109, 6, v115
    v_lshl_add_u32 v115, v108, 10, v115
    s_waitcnt lgkmcnt(0)
    v_mov_b32 v53, s40
    v_mov_b32 v54, s41
    v_mov_b32 v56, s42
    v_mov_b32 v57, s43
    s_mov_b32 s40, 20987904
    s_mov_b32 s41, 21031594
    s_pack_ll_b32_b16 s14, s52, s54
    s_pack_hh_b32_b16 s15, s52, s54
    s_pack_ll_b32_b16 s54, s53, s55
    s_pack_hh_b32_b16 s55, s53, s55
    s_mov_b32 s52, s14
    s_mov_b32 s53, s15
    s_pack_ll_b32_b16 s14, s56, s58
    s_pack_hh_b32_b16 s15, s56, s58
    s_pack_ll_b32_b16 s58, s57, s59
    s_pack_hh_b32_b16 s59, s57, s59
    s_mov_b32 s56, s14
    s_mov_b32 s57, s15
    s_pack_ll_b32_b16 s14, s60, s62
    s_pack_hh_b32_b16 s15, s60, s62
    s_pack_ll_b32_b16 s62, s61, s63
    s_pack_hh_b32_b16 s63, s61, s63
    s_mov_b32 s60, s14
    s_mov_b32 s61, s15
    s_pack_ll_b32_b16 s14, s64, s66
    s_pack_hh_b32_b16 s15, s64, s66
    s_pack_ll_b32_b16 s66, s65, s67
    s_pack_hh_b32_b16 s67, s65, s67
    s_mov_b32 s64, s14
    s_mov_b32 s65, s15
    s_pack_ll_b32_b16 s14, s68, s70
    s_pack_hh_b32_b16 s15, s68, s70
    s_pack_ll_b32_b16 s70, s69, s71
    s_pack_hh_b32_b16 s71, s69, s71
    s_mov_b32 s68, s14
    s_mov_b32 s69, s15
    s_pack_ll_b32_b16 s14, s72, s74
    s_pack_hh_b32_b16 s15, s72, s74
    s_pack_ll_b32_b16 s74, s73, s75
    s_pack_hh_b32_b16 s75, s73, s75
    s_mov_b32 s72, s14
    s_mov_b32 s73, s15
    s_pack_ll_b32_b16 s14, s76, s78
    s_pack_hh_b32_b16 s15, s76, s78
    s_pack_ll_b32_b16 s78, s77, s79
    s_pack_hh_b32_b16 s79, s77, s79
    s_mov_b32 s76, s14
    s_mov_b32 s77, s15
    s_pack_ll_b32_b16 s14, s80, s82
    s_pack_hh_b32_b16 s15, s80, s82
    s_pack_ll_b32_b16 s82, s81, s83
    s_pack_hh_b32_b16 s83, s81, s83
    s_mov_b32 s80, s14
    s_mov_b32 s81, s15
    s_waitcnt vmcnt(10)
    ds_write_b128 v1, v[28:31] offset:0
    s_waitcnt vmcnt(9)
    ds_write_b128 v1, v[32:35] offset:16384
    s_waitcnt vmcnt(8)
    ds_write_b128 v1, v[36:39] offset:32768
    s_waitcnt vmcnt(7)
    ds_write_b128 v1, v[40:43] offset:49152
    ds_read_b128 v[28:31], v115 offset:0
    ds_read_b128 v[36:39], v115 offset:32
    ds_read_b128 v[32:35], v115 offset:16
    ds_read_b128 v[40:43], v115 offset:48
    ds_write_b128 v1, v[44:47] offset:0
    ds_write_b128 v1, v[44:47] offset:16384
    ds_write_b128 v1, v[44:47] offset:32768
    ds_write_b128 v1, v[44:47] offset:49152
    s_waitcnt lgkmcnt(6)
    v_mad_u32_u16 v108, v28, v50, s40 op_sel:[0,0,0,0]
    v_mad_u32_u16 v109, v36, v50, s41 op_sel:[0,0,0,0]
    v_sub_u32_sdwa v110, v109, v108 dst_sel:DWORD dst_unused:UNUSED_PAD src0_sel:WORD_1 src1_sel:WORD_1
    s_nop 1
    v_add_u32_dpp v110, v110, v110 row_shr:1 row_mask:0xf bank_mask:0xf bound_ctrl:0
    s_nop 1
    v_add_u32_dpp v110, v110, v110 row_shr:2 row_mask:0xf bank_mask:0xf bound_ctrl:0
    s_nop 1
    v_add_u32_dpp v110, v110, v110 row_shr:4 row_mask:0xf bank_mask:0xf bound_ctrl:0
    s_nop 1
    v_add_u32_dpp v110, v110, v110 row_shr:8 row_mask:0xf bank_mask:0xf bound_ctrl:0
    s_nop 1
    v_add_u32_dpp v110, v110, v110 row_bcast:15 row_mask:0xa bank_mask:0xf
    s_nop 1
    v_add_u32_dpp v110, v110, v110 row_bcast:31 row_mask:0xc bank_mask:0xf
    v_sub_u32_sdwa v109, v109, v110 dst_sel:DWORD dst_unused:UNUSED_PAD src0_sel:WORD_1 src1_sel:DWORD
    v_readlane_b32 s29, v110, 63
    v_add_u32 v110, -1, v110
    ds_write_b16 v126, v109
    v_lshlrev_b32_e64 v111, v110, 1
    v_lshrrev_b32 v110, 5, v110
    s_cmp_gt_u32 s29, 320
    s_cselect_b32 s2, 1, s2
    v_lshl_add_u32 v110, v110, 2, v127
    s_cselect_b64 exec, 0, -1
    ds_or_b32 v110, v111 offset:136
    s_mov_b64 exec, -1
    ds_wrxchg2_rtn_b32 v[108:109], v6, v5, v5 offset0:34 offset1:44
    s_waitcnt lgkmcnt(0)
    v_or_b32 v7, v108, v109
    s_nop 0
    v_readlane_b32 s30, v7, 0
    v_readlane_b32 s31, v7, 1
    v_readlane_b32 s32, v7, 2
    v_readlane_b32 s33, v7, 3
    v_readlane_b32 s34, v7, 4
    v_readlane_b32 s35, v7, 5
    v_readlane_b32 s36, v7, 6
    v_readlane_b32 s37, v7, 7
    s_mov_b32 s25, s19
    s_mov_b32 s26, s27
    s_mov_b32 s51, s28
    s_mov_b32 s28, s29
    v_mbcnt_lo_u32_b32 v8, s30, 0
    v_mbcnt_hi_u32_b32 v8, s31, v8
    s_bcnt1_i32_b64 s14, s[30:31]
    v_lshl_add_u32 v9, v8, 1, s25
    ds_read_u16 v9, v9
    s_add_u32 s30, s26, 0
    s_lshl1_add_u32 s25, s14, s25
    s_lshl_b32 s14, s14, 10
    s_add_u32 s26, s26, s14
    v_mbcnt_lo_u32_b32 v12, s32, 0
    v_mbcnt_hi_u32_b32 v12, s33, v12
    s_bcnt1_i32_b64 s14, s[32:33]
    v_lshl_add_u32 v13, v12, 1, s25
    ds_read_u16 v13, v13
    s_add_u32 s32, s26, 1048576
    s_lshl1_add_u32 s25, s14, s25
    s_lshl_b32 s14, s14, 10
    s_add_u32 s26, s26, s14
    v_mbcnt_lo_u32_b32 v16, s34, 0
    v_mbcnt_hi_u32_b32 v16, s35, v16
    s_bcnt1_i32_b64 s14, s[34:35]
    v_lshl_add_u32 v17, v16, 1, s25
    ds_read_u16 v17, v17
    s_add_u32 s34, s26, 2097152
    s_lshl1_add_u32 s25, s14, s25
    s_lshl_b32 s14, s14, 10
    s_add_u32 s26, s26, s14
    v_mbcnt_lo_u32_b32 v20, s36, 0
    v_mbcnt_hi_u32_b32 v20, s37, v20
    s_bcnt1_i32_b64 s14, s[36:37]
    v_lshl_add_u32 v21, v20, 1, s25
    ds_read_u16 v21, v21
    s_add_u32 s36, s26, 3145728
    s_lshl1_add_u32 s25, s14, s25
    s_lshl_b32 s14, s14, 10
    s_add_u32 s26, s26, s14
    s_waitcnt lgkmcnt(3)
    v_mad_u32_u16 v9, v9, s23, v2
    v_pk_lshrrev_b16 v9, 10, v9 op_sel_hi:[1,1]
    v_lshl_add_u32 v8, v8, 6, v9
    buffer_load_dwordx4 v[8:11], v8, s[44:47], s30 idxen
    s_waitcnt lgkmcnt(2)
    v_mad_u32_u16 v13, v13, s23, v2
    v_pk_lshrrev_b16 v13, 10, v13 op_sel_hi:[1,1]
    v_lshl_add_u32 v12, v12, 6, v13
    buffer_load_dwordx4 v[12:15], v12, s[44:47], s32 idxen
    s_waitcnt lgkmcnt(1)
    v_mad_u32_u16 v17, v17, s23, v2
    v_pk_lshrrev_b16 v17, 10, v17 op_sel_hi:[1,1]
    v_lshl_add_u32 v16, v16, 6, v17
    buffer_load_dwordx4 v[16:19], v16, s[44:47], s34 idxen
    s_waitcnt lgkmcnt(0)
    v_mad_u32_u16 v21, v21, s23, v2
    v_pk_lshrrev_b16 v21, 10, v21 op_sel_hi:[1,1]
    v_lshl_add_u32 v20, v20, 6, v21
    buffer_load_dwordx4 v[20:23], v20, s[44:47], s36 idxen
    s_cmp_le_u32 s28, 256
    s_cbranch_scc1 L_p2_kernel_noopt_1
    v_readlane_b32 s38, v7, 8
    v_readlane_b32 s39, v7, 9
    s_nop 1
    v_mbcnt_lo_u32_b32 v51, s38, 0
    v_mbcnt_hi_u32_b32 v51, s39, v51
    s_bcnt1_i32_b64 s14, s[38:39]
    v_lshl_add_u32 v55, v51, 1, s25
    ds_read_u16 v55, v55
    s_add_u32 s38, s26, 4194304
    s_lshl1_add_u32 s25, s14, s25
    s_lshl_b32 s14, s14, 10
    s_add_u32 s26, s26, s14
    s_waitcnt lgkmcnt(0)
    v_mad_u32_u16 v55, v55, s23, v2
    v_pk_lshrrev_b16 v55, 10, v55 op_sel_hi:[1,1]
    v_lshl_add_u32 v51, v51, 6, v55
    buffer_load_dwordx4 v[24:27], v51, s[44:47], s38 idxen
L_p2_kernel_noopt_1:
    s_waitcnt vmcnt(6)
    ds_write_b128 v3, v[88:91] offset:0
    ds_write_b128 v3, v[92:95] offset:16384
    ds_write_b128 v3, v[96:99] offset:32768
    ds_write_b128 v3, v[100:103] offset:49152
    ds_write_b128 v124, v[104:107] offset:0
    s_waitcnt vmcnt(4)
    v_max3_u32 v64, v80, v82, v84
    v_add_f32 v65, v81, v83
    v_add_f32 v66, v85, v87
    v_max_u32 v64, v64, v86
    v_add_f32 v65, v65, v66
    v_cmp_lt_u32 vcc, 0xffff, v64
    s_nop 1
    v_max_u32_dpp v64, v64, v64 row_shr:1 row_mask:0xf bank_mask:0xf bound_ctrl:0
    s_nop 1
    v_max_u32_dpp v64, v64, v64 row_shr:2 row_mask:0xf bank_mask:0xf bound_ctrl:0
    s_nop 1
    v_max_u32_dpp v64, v64, v64 row_shr:4 row_mask:0xf bank_mask:0xf bound_ctrl:0
    s_nop 1
    v_max_u32_dpp v64, v64, v64 row_shr:8 row_mask:0xf bank_mask:0xf bound_ctrl:0
    s_nop 1
    v_max_u32_dpp v64, v64, v64 row_bcast:15 row_mask:0xa bank_mask:0xf
    s_nop 1
    v_max_u32_dpp v64, v64, v64 row_bcast:31 row_mask:0xc bank_mask:0xf
    s_nop 1
    v_add_f32_dpp v65, v65, v65 row_shr:1 row_mask:0xf bank_mask:0xf bound_ctrl:0
    s_nop 1
    v_add_f32_dpp v65, v65, v65 row_shr:2 row_mask:0xf bank_mask:0xf bound_ctrl:0
    s_nop 1
    v_add_f32_dpp v65, v65, v65 row_shr:4 row_mask:0xf bank_mask:0xf bound_ctrl:0
    s_nop 1
    v_add_f32_dpp v65, v65, v65 row_shr:8 row_mask:0xf bank_mask:0xf bound_ctrl:0
    s_nop 1
    v_add_f32_dpp v65, v65, v65 row_bcast:15 row_mask:0xa bank_mask:0xf
    s_nop 1
    v_add_f32_dpp v65, v65, v65 row_bcast:31 row_mask:0xc bank_mask:0xf
    s_cmp_lg_u64 vcc, 0
    s_cselect_b32 s2, 1, s2
    v_lshlrev_b32 v64, 16, v64
    v_mul_f32 v66, 936490775, v65
    v_mul_f32 v65, 928531664, v65
    v_cmp_nle_f32 vcc, v64, v66
    v_max_u32 v64, v64, v65
    s_nop 0
    v_readlane_b32 s14, v64, 63
    s_bitcmp1_b32 vcc_hi, 31
    s_cselect_b32 s2, 1, s2
    s_lshr_b32 s14, s14, 23
    s_add_u32 s14, s14, 1
    s_cmp_lt_u32 s14, 40
    s_cselect_b32 s2, 1, s2
    s_cmp_gt_u32 s14, 230
    s_cselect_b32 s2, 1, s2
    s_sub_u32 s48, s14, 14
    s_lshl_b32 s48, s48, 23
    s_add_u32 s16, s48, 272629760
    s_lshr_b32 s15, s16, 16
    s_sub_u32 s15, 0x10000, s15
    s_add_u32 s20, s16, s15
    s_sub_u32 s17, s20, 1
    s_mov_b32 s21, s17
    s_or_b32 s48, s48, 16416
    s_sub_u32 s14, s14, 40
    s_cmp_gt_u32 s14, 190
    s_cselect_b32 s48, 0, s48
    s_waitcnt lgkmcnt(0)
    s_barrier
    s_add_u32 s14, s22, 80000
    buffer_load_dwordx4 v[88:91], v1, s[8:11], s14 offen
    s_add_u32 s14, s22, 96384
    buffer_load_dwordx4 v[92:95], v1, s[8:11], s14 offen
    v_mad_u32_u16 v108, v28, v50, s40 op_sel:[1,0,0,0]
    v_mad_u32_u16 v109, v36, v50, s41 op_sel:[1,0,0,0]
    v_sub_u32_sdwa v110, v109, v108 dst_sel:DWORD dst_unused:UNUSED_PAD src0_sel:WORD_1 src1_sel:WORD_1
    s_nop 1
    v_add_u32_dpp v110, v110, v110 row_shr:1 row_mask:0xf bank_mask:0xf bound_ctrl:0
    s_nop 1
    v_add_u32_dpp v110, v110, v110 row_shr:2 row_mask:0xf bank_mask:0xf bound_ctrl:0
    s_nop 1
    v_add_u32_dpp v110, v110, v110 row_shr:4 row_mask:0xf bank_mask:0xf bound_ctrl:0
    s_nop 1
    v_add_u32_dpp v110, v110, v110 row_shr:8 row_mask:0xf bank_mask:0xf bound_ctrl:0
    s_nop 1
    v_add_u32_dpp v110, v110, v110 row_bcast:15 row_mask:0xa bank_mask:0xf
    s_nop 1
    v_add_u32_dpp v110, v110, v110 row_bcast:31 row_mask:0xc bank_mask:0xf
    v_sub_u32_sdwa v109, v109, v110 dst_sel:DWORD dst_unused:UNUSED_PAD src0_sel:WORD_1 src1_sel:DWORD
    v_readlane_b32 s29, v110, 63
    v_add_u32 v110, -1, v110
    ds_write_b16 v126, v109
    v_lshlrev_b32_e64 v111, v110, 1
    v_lshrrev_b32 v110, 5, v110
    s_cmp_gt_u32 s29, 320
    s_cselect_b32 s2, 1, s2
    v_lshl_add_u32 v110, v110, 2, v127
    s_cselect_b64 exec, 0, -1
    ds_or_b32 v110, v111 offset:136
    s_mov_b64 exec, -1
    ds_wrxchg2_rtn_b32 v[108:109], v6, v5, v5 offset0:34 offset1:44
    s_mov_b32 s24, 0
L_p2_loop:
    s_add_u32 s22, s22, 80000
    s_lshl_b32 s14, s13, 4
    s_or_b32 s14, s14, s24
    s_cmp_lg_u32 s14, 5
    s_cbranch_scc1 L_p2_nost
    v_mov_b32 v52, 0
    s_lshl_b32 s14, s3, 8
    s_add_u32 s14, s14, 8523776
    s_mov_b64 exec, 1
    buffer_atomic_add v52, off, s[4:7], s14 sc0
    s_mov_b64 exec, -1
L_p2_nost:
    s_waitcnt vmcnt(5)
    v_mad_u32_u16 v64, v8, 8, s18
    v_mad_u32_u16 v66, v9, 8, s18
    v_mad_u32_u16 v68, v10, 8, s18
    ds_read_b64 v[64:65], v64
    ds_read_b64 v[66:67], v66
    ds_read_b64 v[68:69], v68
    s_add_u32 s14, s22, 32768
    buffer_load_dwordx4 v[96:99], v1, s[8:11], s14 offen
    s_waitcnt vmcnt(5)
    v_mad_u32_u16 v70, v12, 8, s18
    v_mad_u32_u16 v72, v13, 8, s18
    v_mad_u32_u16 v74, v14, 8, s18
    ds_read_b64 v[70:71], v70
    ds_read_b64 v[72:73], v72
    ds_read_b64 v[74:75], v74
    s_add_u32 s14, s22, 49152
    buffer_load_dwordx4 v[100:103], v1, s[8:11], s14 offen
    s_waitcnt lgkmcnt(6)
    v_or_b32 v7, v108, v109
    s_nop 0
    v_readlane_b32 s30, v7, 0
    v_readlane_b32 s31, v7, 1
    v_readlane_b32 s32, v7, 2
    v_readlane_b32 s33, v7, 3
    v_readlane_b32 s34, v7, 4
    v_readlane_b32 s35, v7, 5
    v_readlane_b32 s36, v7, 6
    v_readlane_b32 s37, v7, 7
    s_mov_b32 s25, s19
    s_mov_b32 s26, s27
    s_mov_b32 s51, s28
    s_mov_b32 s28, s29
    v_mbcnt_lo_u32_b32 v51, s30, 0
    v_mbcnt_hi_u32_b32 v51, s31, v51
    s_bcnt1_i32_b64 s14, s[30:31]
    v_lshl_add_u32 v55, v51, 1, s25
    ds_read_u16 v55, v55
    s_add_u32 s30, s26, 0
    s_lshl1_add_u32 s25, s14, s25
    s_lshl_b32 s14, s14, 10
    s_add_u32 s26, s26, s14
    v_bfe_i32 v108, v11, 2, 10
    v_bfe_i32 v109, v11, 12, 10
    v_ashrrev_i32 v110, 22, v11
    v_cvt_f32_i32 v108, v108
    v_cvt_f32_i32 v109, v109
    v_cvt_f32_i32 v110, v110
    s_waitcnt lgkmcnt(4)
    v_mfma_f32_4x4x4_16b_bf16 v[112:115], v[58:59], v[64:65], 0
    v_mfma_f32_4x4x4_16b_bf16 v[116:119], v[58:59], v[66:67], 0
    v_mfma_f32_4x4x4_16b_bf16 v[120:123], v[58:59], v[68:69], 0
    v_mad_u32_u16 v8, v8, 8, s50 op_sel:[1,0,0,0]
    v_mad_u32_u16 v9, v9, 8, s50 op_sel:[1,0,0,0]
    v_mad_u32_u16 v10, v10, 8, s50 op_sel:[1,0,0,0]
    v_pk_fma_f32 v[114:115], v[114:115], v[108:109], s[20:21] op_sel:[0,0,0] op_sel_hi:[1,0,1]
    v_pk_fma_f32 v[112:113], v[112:113], v[108:109], s[16:17] op_sel:[0,0,0] op_sel_hi:[1,0,1]
    v_pk_fma_f32 v[118:119], v[118:119], v[108:109], s[20:21] op_sel:[0,1,0] op_sel_hi:[1,1,1]
    v_pk_fma_f32 v[116:117], v[116:117], v[108:109], s[16:17] op_sel:[0,1,0] op_sel_hi:[1,1,1]
    v_pk_fma_f32 v[122:123], v[122:123], v[110:111], s[20:21] op_sel:[0,0,0] op_sel_hi:[1,0,1]
    v_pk_fma_f32 v[120:121], v[120:121], v[110:111], s[16:17] op_sel:[0,0,0] op_sel_hi:[1,0,1]
    v_lshlrev_b64 v[114:115], 16, v[114:115]
    v_lshlrev_b64 v[118:119], 16, v[118:119]
    v_lshlrev_b64 v[122:123], 16, v[122:123]
    v_lshl_add_u64 v[64:65], v[112:113], 0, v[114:115]
    v_lshl_add_u64 v[66:67], v[116:117], 0, v[118:119]
    v_lshl_add_u64 v[68:69], v[120:121], 0, v[122:123]
    v_or3_b32 v4, v44, v45, v4
    v_or3_b32 v4, v46, v47, v4
    v_or3_b32 v4, v48, v49, v4
    ds_add_rtn_u64 v[44:45], v8, v[64:65]
    ds_add_rtn_u64 v[46:47], v9, v[66:67]
    ds_add_rtn_u64 v[48:49], v10, v[68:69]
    s_waitcnt lgkmcnt(3)
    v_mad_u32_u16 v55, v55, s23, v2
    v_pk_lshrrev_b16 v55, 10, v55 op_sel_hi:[1,1]
    v_lshl_add_u32 v51, v51, 6, v55
    buffer_load_dwordx4 v[8:11], v51, s[44:47], s30 idxen
    s_sub_u32 s14, s22, 80000
    buffer_load_dwordx4 v[104:107], v124, s[8:11], s14 offen
    s_waitcnt vmcnt(7)
    v_mad_u32_u16 v76, v16, 8, s18
    v_mad_u32_u16 v78, v17, 8, s18
    v_mad_u32_u16 v80, v18, 8, s18
    ds_read_b64 v[76:77], v76
    ds_read_b64 v[78:79], v78
    ds_read_b64 v[80:81], v80
    s_waitcnt vmcnt(6)
    v_mad_u32_u16 v82, v20, 8, s18
    v_mad_u32_u16 v84, v21, 8, s18
    v_mad_u32_u16 v86, v22, 8, s18
    ds_read_b64 v[82:83], v82
    ds_read_b64 v[84:85], v84
    ds_read_b64 v[86:87], v86
    s_cmp_le_u32 s51, 256
    s_cbranch_scc1 L_p2_kernel_noopt3_2
    v_mad_u32_u16 v64, v24, 8, s18
    v_mad_u32_u16 v66, v25, 8, s18
    v_mad_u32_u16 v68, v26, 8, s18
    ds_read_b64 v[64:65], v64
    ds_read_b64 v[66:67], v66
    ds_read_b64 v[68:69], v68
L_p2_kernel_noopt3_2:
    v_mbcnt_lo_u32_b32 v51, s32, 0
    v_mbcnt_hi_u32_b32 v51, s33, v51
    s_bcnt1_i32_b64 s14, s[32:33]
    v_lshl_add_u32 v55, v51, 1, s25
    ds_read_u16 v55, v55
    s_add_u32 s32, s26, 1048576
    s_lshl1_add_u32 s25, s14, s25
    s_lshl_b32 s14, s14, 10
    s_add_u32 s26, s26, s14
    v_bfe_i32 v108, v15, 2, 10
    v_bfe_i32 v109, v15, 12, 10
    v_ashrrev_i32 v110, 22, v15
    v_cvt_f32_i32 v108, v108
    v_cvt_f32_i32 v109, v109
    v_cvt_f32_i32 v110, v110
    v_mfma_f32_4x4x4_16b_bf16 v[112:115], v[58:59], v[70:71], 0
    v_mfma_f32_4x4x4_16b_bf16 v[116:119], v[58:59], v[72:73], 0
    v_mfma_f32_4x4x4_16b_bf16 v[120:123], v[58:59], v[74:75], 0
    v_mad_u32_u16 v12, v12, 8, s50 op_sel:[1,0,0,0]
    v_mad_u32_u16 v13, v13, 8, s50 op_sel:[1,0,0,0]
    v_mad_u32_u16 v14, v14, 8, s50 op_sel:[1,0,0,0]
    v_pk_fma_f32 v[114:115], v[114:115], v[108:109], s[20:21] op_sel:[0,0,0] op_sel_hi:[1,0,1]
    v_pk_fma_f32 v[112:113], v[112:113], v[108:109], s[16:17] op_sel:[0,0,0] op_sel_hi:[1,0,1]
    v_pk_fma_f32 v[118:119], v[118:119], v[108:109], s[20:21] op_sel:[0,1,0] op_sel_hi:[1,1,1]
    v_pk_fma_f32 v[116:117], v[116:117], v[108:109], s[16:17] op_sel:[0,1,0] op_sel_hi:[1,1,1]
    v_pk_fma_f32 v[122:123], v[122:123], v[110:111], s[20:21] op_sel:[0,0,0] op_sel_hi:[1,0,1]
    v_pk_fma_f32 v[120:121], v[120:121], v[110:111], s[16:17] op_sel:[0,0,0] op_sel_hi:[1,0,1]
    v_lshlrev_b64 v[114:115], 16, v[114:115]
    v_lshlrev_b64 v[118:119], 16, v[118:119]
    v_lshlrev_b64 v[122:123], 16, v[122:123]
    v_lshl_add_u64 v[70:71], v[112:113], 0, v[114:115]
    v_lshl_add_u64 v[72:73], v[116:117], 0, v[118:119]
    v_lshl_add_u64 v[74:75], v[120:121], 0, v[122:123]
    s_waitcnt lgkmcnt(7)
    v_or3_b32 v4, v44, v45, v4
    v_or3_b32 v4, v46, v47, v4
    v_or3_b32 v4, v48, v49, v4
    ds_add_rtn_u64 v[44:45], v12, v[70:71]
    ds_add_rtn_u64 v[46:47], v13, v[72:73]
    ds_add_rtn_u64 v[48:49], v14, v[74:75]
    s_waitcnt lgkmcnt(3)
    v_mad_u32_u16 v55, v55, s23, v2
    v_pk_lshrrev_b16 v55, 10, v55 op_sel_hi:[1,1]
    v_lshl_add_u32 v51, v51, 6, v55
    buffer_load_dwordx4 v[12:15], v51, s[44:47], s32 idxen
    s_barrier
    s_waitcnt vmcnt(1)
    ds_write_b128 v3, v[88:91] offset:0
    ds_write_b128 v3, v[92:95] offset:16384
    ds_write_b128 v3, v[96:99] offset:32768
    ds_write_b128 v3, v[100:103] offset:49152
    ds_write_b128 v124, v[104:107] offset:0
    s_cmp_lg_u32 s24, 7
    s_cbranch_scc1 L_p2_nofin
    s_mul_i32 s14, s3, 20000
    s_mul_i32 s15, s12, 4992
    s_add_u32 s14, s14, s15
    s_add_u32 s15, s14, 4096
    v_min_u32 v61, 231, v0
    v_lshl_add_u32 v60, v0, 2, s14
    v_lshl_add_u32 v61, v61, 2, s15
    global_load_dword v60, v60, s[100:101] nt
    global_load_dword v61, v61, s[100:101] nt
    s_lshl_b32 s14, s14, 2
    s_lshl_b32 s15, s15, 2
    v_min_u32 v36, 231, v0
    v_add_u32 v28, s14, v1
    v_lshl_add_u32 v36, v36, 4, s15
    global_load_dwordx4 v[28:31], v28, s[8:9]
    global_load_dwordx4 v[36:39], v36, s[8:9]
L_p2_nofin:
    v_mbcnt_lo_u32_b32 v51, s34, 0
    v_mbcnt_hi_u32_b32 v51, s35, v51
    s_bcnt1_i32_b64 s14, s[34:35]
    v_lshl_add_u32 v55, v51, 1, s25
    ds_read_u16 v55, v55
    s_add_u32 s34, s26, 2097152
    s_lshl1_add_u32 s25, s14, s25
    s_lshl_b32 s14, s14, 10
    s_add_u32 s26, s26, s14
    v_bfe_i32 v108, v19, 2, 10
    v_bfe_i32 v109, v19, 12, 10
    v_ashrrev_i32 v110, 22, v19
    v_cvt_f32_i32 v108, v108
    v_cvt_f32_i32 v109, v109
    v_cvt_f32_i32 v110, v110
    v_mfma_f32_4x4x4_16b_bf16 v[112:115], v[58:59], v[76:77], 0
    v_mfma_f32_4x4x4_16b_bf16 v[116:119], v[58:59], v[78:79], 0
    v_mfma_f32_4x4x4_16b_bf16 v[120:123], v[58:59], v[80:81], 0
    v_mad_u32_u16 v16, v16, 8, s50 op_sel:[1,0,0,0]
    v_mad_u32_u16 v17, v17, 8, s50 op_sel:[1,0,0,0]
    v_mad_u32_u16 v18, v18, 8, s50 op_sel:[1,0,0,0]
    v_pk_fma_f32 v[114:115], v[114:115], v[108:109], s[20:21] op_sel:[0,0,0] op_sel_hi:[1,0,1]
    v_pk_fma_f32 v[112:113], v[112:113], v[108:109], s[16:17] op_sel:[0,0,0] op_sel_hi:[1,0,1]
    v_pk_fma_f32 v[118:119], v[118:119], v[108:109], s[20:21] op_sel:[0,1,0] op_sel_hi:[1,1,1]
    v_pk_fma_f32 v[116:117], v[116:117], v[108:109], s[16:17] op_sel:[0,1,0] op_sel_hi:[1,1,1]
    v_pk_fma_f32 v[122:123], v[122:123], v[110:111], s[20:21] op_sel:[0,0,0] op_sel_hi:[1,0,1]
    v_pk_fma_f32 v[120:121], v[120:121], v[110:111], s[16:17] op_sel:[0,0,0] op_sel_hi:[1,0,1]
    v_lshlrev_b64 v[114:115], 16, v[114:115]
    v_lshlrev_b64 v[118:119], 16, v[118:119]
    v_lshlrev_b64 v[122:123], 16, v[122:123]
    v_lshl_add_u64 v[76:77], v[112:113], 0, v[114:115]
    v_lshl_add_u64 v[78:79], v[116:117], 0, v[118:119]
    v_lshl_add_u64 v[80:81], v[120:121], 0, v[122:123]
    s_waitcnt lgkmcnt(6)
    v_or3_b32 v4, v44, v45, v4
    v_or3_b32 v4, v46, v47, v4
    v_or3_b32 v4, v48, v49, v4
    ds_add_rtn_u64 v[44:45], v16, v[76:77]
    ds_add_rtn_u64 v[46:47], v17, v[78:79]
    ds_add_rtn_u64 v[48:49], v18, v[80:81]
    s_waitcnt lgkmcnt(3)
    v_mad_u32_u16 v55, v55, s23, v2
    v_pk_lshrrev_b16 v55, 10, v55 op_sel_hi:[1,1]
    v_lshl_add_u32 v51, v51, 6, v55
    buffer_load_dwordx4 v[16:19], v51, s[44:47], s34 idxen
    s_cmp_le_u32 s51, 256
    s_cbranch_scc1 L_p2_kernel_noopt3_3
    v_bfe_i32 v108, v27, 2, 10
    v_bfe_i32 v109, v27, 12, 10
    v_ashrrev_i32 v110, 22, v27
    v_cvt_f32_i32 v108, v108
    v_cvt_f32_i32 v109, v109
    v_cvt_f32_i32 v110, v110
    v_mfma_f32_4x4x4_16b_bf16 v[112:115], v[58:59], v[64:65], 0
    v_mfma_f32_4x4x4_16b_bf16 v[116:119], v[58:59], v[66:67], 0
    v_mfma_f32_4x4x4_16b_bf16 v[120:123], v[58:59], v[68:69], 0
    v_mad_u32_u16 v24, v24, 8, s50 op_sel:[1,0,0,0]
    v_mad_u32_u16 v25, v25, 8, s50 op_sel:[1,0,0,0]
    v_mad_u32_u16 v26, v26, 8, s50 op_sel:[1,0,0,0]
    v_pk_fma_f32 v[114:115], v[114:115], v[108:109], s[20:21] op_sel:[0,0,0] op_sel_hi:[1,0,1]
    v_pk_fma_f32 v[112:113], v[112:113], v[108:109], s[16:17] op_sel:[0,0,0] op_sel_hi:[1,0,1]
    v_pk_fma_f32 v[118:119], v[118:119], v[108:109], s[20:21] op_sel:[0,1,0] op_sel_hi:[1,1,1]
    v_pk_fma_f32 v[116:117], v[116:117], v[108:109], s[16:17] op_sel:[0,1,0] op_sel_hi:[1,1,1]
    v_pk_fma_f32 v[122:123], v[122:123], v[110:111], s[20:21] op_sel:[0,0,0] op_sel_hi:[1,0,1]
    v_pk_fma_f32 v[120:121], v[120:121], v[110:111], s[16:17] op_sel:[0,0,0] op_sel_hi:[1,0,1]
    v_lshlrev_b64 v[114:115], 16, v[114:115]
    v_lshlrev_b64 v[118:119], 16, v[118:119]
    v_lshlrev_b64 v[122:123], 16, v[122:123]
    v_lshl_add_u64 v[64:65], v[112:113], 0, v[114:115]
    v_lshl_add_u64 v[66:67], v[116:117], 0, v[118:119]
    v_lshl_add_u64 v[68:69], v[120:121], 0, v[122:123]
    s_waitcnt lgkmcnt(0)
    v_or3_b32 v4, v44, v45, v4
    v_or3_b32 v4, v46, v47, v4
    v_or3_b32 v4, v48, v49, v4
    ds_add_rtn_u64 v[44:45], v24, v[64:65]
    ds_add_rtn_u64 v[46:47], v25, v[66:67]
    ds_add_rtn_u64 v[48:49], v26, v[68:69]
L_p2_kernel_noopt3_3:
    v_mbcnt_lo_u32_b32 v51, s36, 0
    v_mbcnt_hi_u32_b32 v51, s37, v51
    s_bcnt1_i32_b64 s14, s[36:37]
    v_lshl_add_u32 v55, v51, 1, s25
    ds_read_u16 v55, v55
    s_add_u32 s36, s26, 3145728
    s_lshl1_add_u32 s25, s14, s25
    s_lshl_b32 s14, s14, 10
    s_add_u32 s26, s26, s14
    s_cmp_le_u32 s28, 256
    s_cbranch_scc1 L_p2_kernel_noopt3_4
    v_readlane_b32 s38, v7, 8
    v_readlane_b32 s39, v7, 9
    s_nop 1
    v_mbcnt_lo_u32_b32 v62, s38, 0
    v_mbcnt_hi_u32_b32 v62, s39, v62
    s_bcnt1_i32_b64 s14, s[38:39]
    v_lshl_add_u32 v63, v62, 1, s25
    ds_read_u16 v63, v63
    s_add_u32 s38, s26, 4194304
    s_lshl1_add_u32 s25, s14, s25
    s_lshl_b32 s14, s14, 10
    s_add_u32 s26, s26, s14
L_p2_kernel_noopt3_4:
    v_bfe_i32 v108, v23, 2, 10
    v_bfe_i32 v109, v23, 12, 10
    v_ashrrev_i32 v110, 22, v23
    v_cvt_f32_i32 v108, v108
    v_cvt_f32_i32 v109, v109
    v_cvt_f32_i32 v110, v110
    v_mfma_f32_4x4x4_16b_bf16 v[112:115], v[58:59], v[82:83], 0
    v_mfma_f32_4x4x4_16b_bf16 v[116:119], v[58:59], v[84:85], 0
    v_mfma_f32_4x4x4_16b_bf16 v[120:123], v[58:59], v[86:87], 0
    v_mad_u32_u16 v20, v20, 8, s50 op_sel:[1,0,0,0]
    v_mad_u32_u16 v21, v21, 8, s50 op_sel:[1,0,0,0]
    v_mad_u32_u16 v22, v22, 8, s50 op_sel:[1,0,0,0]
    v_pk_fma_f32 v[114:115], v[114:115], v[108:109], s[20:21] op_sel:[0,0,0] op_sel_hi:[1,0,1]
    v_pk_fma_f32 v[112:113], v[112:113], v[108:109], s[16:17] op_sel:[0,0,0] op_sel_hi:[1,0,1]
    v_pk_fma_f32 v[118:119], v[118:119], v[108:109], s[20:21] op_sel:[0,1,0] op_sel_hi:[1,1,1]
    v_pk_fma_f32 v[116:117], v[116:117], v[108:109], s[16:17] op_sel:[0,1,0] op_sel_hi:[1,1,1]
    v_pk_fma_f32 v[122:123], v[122:123], v[110:111], s[20:21] op_sel:[0,0,0] op_sel_hi:[1,0,1]
    v_pk_fma_f32 v[120:121], v[120:121], v[110:111], s[16:17] op_sel:[0,0,0] op_sel_hi:[1,0,1]
    v_lshlrev_b64 v[114:115], 16, v[114:115]
    v_lshlrev_b64 v[118:119], 16, v[118:119]
    v_lshlrev_b64 v[122:123], 16, v[122:123]
    v_lshl_add_u64 v[82:83], v[112:113], 0, v[114:115]
    v_lshl_add_u64 v[84:85], v[116:117], 0, v[118:119]
    v_lshl_add_u64 v[86:87], v[120:121], 0, v[122:123]
    s_waitcnt lgkmcnt(1)
    v_or3_b32 v4, v44, v45, v4
    v_or3_b32 v4, v46, v47, v4
    v_or3_b32 v4, v48, v49, v4
    ds_add_rtn_u64 v[44:45], v20, v[82:83]
    ds_add_rtn_u64 v[46:47], v21, v[84:85]
    ds_add_rtn_u64 v[48:49], v22, v[86:87]
    s_waitcnt lgkmcnt(3)
    v_mad_u32_u16 v55, v55, s23, v2
    v_pk_lshrrev_b16 v55, 10, v55 op_sel_hi:[1,1]
    v_lshl_add_u32 v51, v51, 6, v55
    buffer_load_dwordx4 v[20:23], v51, s[44:47], s36 idxen
    s_cmp_le_u32 s28, 256
    s_cbranch_scc1 L_p2_kernel_noopt3_5
    v_mad_u32_u16 v63, v63, s23, v2
    v_pk_lshrrev_b16 v63, 10, v63 op_sel_hi:[1,1]
    v_lshl_add_u32 v62, v62, 6, v63
    buffer_load_dwordx4 v[24:27], v62, s[44:47], s38 idxen
L_p2_kernel_noopt3_5:
    s_add_u32 s14, s22, 80000
    buffer_load_dwordx4 v[88:91], v1, s[8:11], s14 offen
    s_add_u32 s14, s24, 1
    s_min_u32 s14, s14, 7
    s_set_gpr_idx_on s14, gpr_idx(SRC0)
    v_mad_u32_u16 v108, v28, v50, s40 op_sel:[0,0,0,0]
    v_mad_u32_u16 v109, v36, v50, s41 op_sel:[0,0,0,0]
    s_set_gpr_idx_off
    v_sub_u32_sdwa v110, v109, v108 dst_sel:DWORD dst_unused:UNUSED_PAD src0_sel:WORD_1 src1_sel:WORD_1
    s_nop 1
    v_add_u32_dpp v110, v110, v110 row_shr:1 row_mask:0xf bank_mask:0xf bound_ctrl:0
    s_nop 1
    v_add_u32_dpp v110, v110, v110 row_shr:2 row_mask:0xf bank_mask:0xf bound_ctrl:0
    s_nop 1
    v_add_u32_dpp v110, v110, v110 row_shr:4 row_mask:0xf bank_mask:0xf bound_ctrl:0
    s_nop 1
    v_add_u32_dpp v110, v110, v110 row_shr:8 row_mask:0xf bank_mask:0xf bound_ctrl:0
    s_nop 1
    v_add_u32_dpp v110, v110, v110 row_bcast:15 row_mask:0xa bank_mask:0xf
    s_nop 1
    v_add_u32_dpp v110, v110, v110 row_bcast:31 row_mask:0xc bank_mask:0xf
    v_sub_u32_sdwa v109, v109, v110 dst_sel:DWORD dst_unused:UNUSED_PAD src0_sel:WORD_1 src1_sel:DWORD
    v_readlane_b32 s29, v110, 63
    v_add_u32 v110, -1, v110
    ds_write_b16 v126, v109
    v_lshlrev_b32_e64 v111, v110, 1
    v_lshrrev_b32 v110, 5, v110
    s_cmp_gt_u32 s29, 320
    s_cselect_b32 s2, 1, s2
    v_lshl_add_u32 v110, v110, 2, v127
    s_cselect_b64 exec, 0, -1
    ds_or_b32 v110, v111 offset:136
    s_mov_b64 exec, -1
    ds_wrxchg2_rtn_b32 v[108:109], v6, v5, v5 offset0:34 offset1:44
    s_add_u32 s14, s22, 96384
    buffer_load_dwordx4 v[92:95], v1, s[8:11], s14 offen
    s_barrier
    s_add_u32 s22, s22, 80000
    s_cmp_eq_u32 s24, 7
    s_cselect_b32 s46, 0, s46
    v_mad_u32_u16 v64, v8, 8, s18
    v_mad_u32_u16 v66, v9, 8, s18
    v_mad_u32_u16 v68, v10, 8, s18
    ds_read_b64 v[64:65], v64
    ds_read_b64 v[66:67], v66
    ds_read_b64 v[68:69], v68
    s_add_u32 s14, s22, 32768
    buffer_load_dwordx4 v[96:99], v1, s[8:11], s14 offen
    s_waitcnt vmcnt(5)
    v_mad_u32_u16 v70, v12, 8, s18
    v_mad_u32_u16 v72, v13, 8, s18
    v_mad_u32_u16 v74, v14, 8, s18
    ds_read_b64 v[70:71], v70
    ds_read_b64 v[72:73], v72
    ds_read_b64 v[74:75], v74
    s_add_u32 s14, s22, 49152
    buffer_load_dwordx4 v[100:103], v1, s[8:11], s14 offen
    s_waitcnt lgkmcnt(6)
    v_or_b32 v7, v108, v109
    s_nop 0
    v_readlane_b32 s30, v7, 0
    v_readlane_b32 s31, v7, 1
    v_readlane_b32 s32, v7, 2
    v_readlane_b32 s33, v7, 3
    v_readlane_b32 s34, v7, 4
    v_readlane_b32 s35, v7, 5
    v_readlane_b32 s36, v7, 6
    v_readlane_b32 s37, v7, 7
    s_mov_b32 s25, s19
    s_mov_b32 s26, s27
    s_mov_b32 s51, s28
    s_mov_b32 s28, s29
    v_mbcnt_lo_u32_b32 v51, s30, 0
    v_mbcnt_hi_u32_b32 v51, s31, v51
    s_bcnt1_i32_b64 s14, s[30:31]
    v_lshl_add_u32 v55, v51, 1, s25
    ds_read_u16 v55, v55
    s_add_u32 s30, s26, 0
    s_lshl1_add_u32 s25, s14, s25
    s_lshl_b32 s14, s14, 10
    s_add_u32 s26, s26, s14
    v_bfe_i32 v108, v11, 2, 10
    v_bfe_i32 v109, v11, 12, 10
    v_ashrrev_i32 v110, 22, v11
    v_cvt_f32_i32 v108, v108
    v_cvt_f32_i32 v109, v109
    v_cvt_f32_i32 v110, v110
    s_waitcnt lgkmcnt(4)
    v_mfma_f32_4x4x4_16b_bf16 v[112:115], v[58:59], v[64:65], 0
    v_mfma_f32_4x4x4_16b_bf16 v[116:119], v[58:59], v[66:67], 0
    v_mfma_f32_4x4x4_16b_bf16 v[120:123], v[58:59], v[68:69], 0
    v_mad_u32_u16 v8, v8, 8, s50 op_sel:[1,0,0,0]
    v_mad_u32_u16 v9, v9, 8, s50 op_sel:[1,0,0,0]
    v_mad_u32_u16 v10, v10, 8, s50 op_sel:[1,0,0,0]
    v_pk_fma_f32 v[114:115], v[114:115], v[108:109], s[20:21] op_sel:[0,0,0] op_sel_hi:[1,0,1]
    v_pk_fma_f32 v[112:113], v[112:113], v[108:109], s[16:17] op_sel:[0,0,0] op_sel_hi:[1,0,1]
    v_pk_fma_f32 v[118:119], v[118:119], v[108:109], s[20:21] op_sel:[0,1,0] op_sel_hi:[1,1,1]
    v_pk_fma_f32 v[116:117], v[116:117], v[108:109], s[16:17] op_sel:[0,1,0] op_sel_hi:[1,1,1]
    v_pk_fma_f32 v[122:123], v[122:123], v[110:111], s[20:21] op_sel:[0,0,0] op_sel_hi:[1,0,1]
    v_pk_fma_f32 v[120:121], v[120:121], v[110:111], s[16:17] op_sel:[0,0,0] op_sel_hi:[1,0,1]
    v_lshlrev_b64 v[114:115], 16, v[114:115]
    v_lshlrev_b64 v[118:119], 16, v[118:119]
    v_lshlrev_b64 v[122:123], 16, v[122:123]
    v_lshl_add_u64 v[64:65], v[112:113], 0, v[114:115]
    v_lshl_add_u64 v[66:67], v[116:117], 0, v[118:119]
    v_lshl_add_u64 v[68:69], v[120:121], 0, v[122:123]
    v_or3_b32 v4, v44, v45, v4
    v_or3_b32 v4, v46, v47, v4
    v_or3_b32 v4, v48, v49, v4
    ds_add_rtn_u64 v[44:45], v8, v[64:65]
    ds_add_rtn_u64 v[46:47], v9, v[66:67]
    ds_add_rtn_u64 v[48:49], v10, v[68:69]
    s_waitcnt lgkmcnt(3)
    v_mad_u32_u16 v55, v55, s23, v2
    v_pk_lshrrev_b16 v55, 10, v55 op_sel_hi:[1,1]
    v_lshl_add_u32 v51, v51, 6, v55
    buffer_load_dwordx4 v[8:11], v51, s[44:47], s30 idxen
    s_sub_u32 s14, s22, 80000
    buffer_load_dwordx4 v[104:107], v124, s[8:11], s14 offen
    s_waitcnt vmcnt(7)
    v_mad_u32_u16 v76, v16, 8, s18
    v_mad_u32_u16 v78, v17, 8, s18
    v_mad_u32_u16 v80, v18, 8, s18
    ds_read_b64 v[76:77], v76
    ds_read_b64 v[78:79], v78
    ds_read_b64 v[80:81], v80
    s_waitcnt vmcnt(6)
    v_mad_u32_u16 v82, v20, 8, s18
    v_mad_u32_u16 v84, v21, 8, s18
    v_mad_u32_u16 v86, v22, 8, s18
    ds_read_b64 v[82:83], v82
    ds_read_b64 v[84:85], v84
    ds_read_b64 v[86:87], v86
    s_cmp_le_u32 s51, 256
    s_cbranch_scc1 L_p2_kernel_noopt3_6
    v_mad_u32_u16 v64, v24, 8, s18
    v_mad_u32_u16 v66, v25, 8, s18
    v_mad_u32_u16 v68, v26, 8, s18
    ds_read_b64 v[64:65], v64
    ds_read_b64 v[66:67], v66
    ds_read_b64 v[68:69], v68
L_p2_kernel_noopt3_6:
    v_mbcnt_lo_u32_b32 v51, s32, 0
    v_mbcnt_hi_u32_b32 v51, s33, v51
    s_bcnt1_i32_b64 s14, s[32:33]
    v_lshl_add_u32 v55, v51, 1, s25
    ds_read_u16 v55, v55
    s_add_u32 s32, s26, 1048576
    s_lshl1_add_u32 s25, s14, s25
    s_lshl_b32 s14, s14, 10
    s_add_u32 s26, s26, s14
    v_bfe_i32 v108, v15, 2, 10
    v_bfe_i32 v109, v15, 12, 10
    v_ashrrev_i32 v110, 22, v15
    v_cvt_f32_i32 v108, v108
    v_cvt_f32_i32 v109, v109
    v_cvt_f32_i32 v110, v110
    v_mfma_f32_4x4x4_16b_bf16 v[112:115], v[58:59], v[70:71], 0
    v_mfma_f32_4x4x4_16b_bf16 v[116:119], v[58:59], v[72:73], 0
    v_mfma_f32_4x4x4_16b_bf16 v[120:123], v[58:59], v[74:75], 0
    v_mad_u32_u16 v12, v12, 8, s50 op_sel:[1,0,0,0]
    v_mad_u32_u16 v13, v13, 8, s50 op_sel:[1,0,0,0]
    v_mad_u32_u16 v14, v14, 8, s50 op_sel:[1,0,0,0]
    v_pk_fma_f32 v[114:115], v[114:115], v[108:109], s[20:21] op_sel:[0,0,0] op_sel_hi:[1,0,1]
    v_pk_fma_f32 v[112:113], v[112:113], v[108:109], s[16:17] op_sel:[0,0,0] op_sel_hi:[1,0,1]
    v_pk_fma_f32 v[118:119], v[118:119], v[108:109], s[20:21] op_sel:[0,1,0] op_sel_hi:[1,1,1]
    v_pk_fma_f32 v[116:117], v[116:117], v[108:109], s[16:17] op_sel:[0,1,0] op_sel_hi:[1,1,1]
    v_pk_fma_f32 v[122:123], v[122:123], v[110:111], s[20:21] op_sel:[0,0,0] op_sel_hi:[1,0,1]
    v_pk_fma_f32 v[120:121], v[120:121], v[110:111], s[16:17] op_sel:[0,0,0] op_sel_hi:[1,0,1]
    v_lshlrev_b64 v[114:115], 16, v[114:115]
    v_lshlrev_b64 v[118:119], 16, v[118:119]
    v_lshlrev_b64 v[122:123], 16, v[122:123]
    v_lshl_add_u64 v[70:71], v[112:113], 0, v[114:115]
    v_lshl_add_u64 v[72:73], v[116:117], 0, v[118:119]
    v_lshl_add_u64 v[74:75], v[120:121], 0, v[122:123]
    s_waitcnt lgkmcnt(7)
    v_or3_b32 v4, v44, v45, v4
    v_or3_b32 v4, v46, v47, v4
    v_or3_b32 v4, v48, v49, v4
    ds_add_rtn_u64 v[44:45], v12, v[70:71]
    ds_add_rtn_u64 v[46:47], v13, v[72:73]
    ds_add_rtn_u64 v[48:49], v14, v[74:75]
    s_waitcnt lgkmcnt(3)
    v_mad_u32_u16 v55, v55, s23, v2
    v_pk_lshrrev_b16 v55, 10, v55 op_sel_hi:[1,1]
    v_lshl_add_u32 v51, v51, 6, v55
    buffer_load_dwordx4 v[12:15], v51, s[44:47], s32 idxen
    s_cmp_lg_u32 s24, 7
    s_cbranch_scc1 L_p2_stage
    s_waitcnt lgkmcnt(0)
    s_branch L_p2_staged
L_p2_stage:
    s_barrier
    s_waitcnt vmcnt(1)
    ds_write_b128 v3, v[88:91] offset:0
    ds_write_b128 v3, v[92:95] offset:16384
    ds_write_b128 v3, v[96:99] offset:32768
    ds_write_b128 v3, v[100:103] offset:49152
    ds_write_b128 v124, v[104:107] offset:0
L_p2_staged:
    v_mbcnt_lo_u32_b32 v51, s34, 0
    v_mbcnt_hi_u32_b32 v51, s35, v51
    s_bcnt1_i32_b64 s14, s[34:35]
    v_lshl_add_u32 v55, v51, 1, s25
    ds_read_u16 v55, v55
    s_add_u32 s34, s26, 2097152
    s_lshl1_add_u32 s25, s14, s25
    s_lshl_b32 s14, s14, 10
    s_add_u32 s26, s26, s14
    v_bfe_i32 v108, v19, 2, 10
    v_bfe_i32 v109, v19, 12, 10
    v_ashrrev_i32 v110, 22, v19
    v_cvt_f32_i32 v108, v108
    v_cvt_f32_i32 v109, v109
    v_cvt_f32_i32 v110, v110
    v_mfma_f32_4x4x4_16b_bf16 v[112:115], v[58:59], v[76:77], 0
    v_mfma_f32_4x4x4_16b_bf16 v[116:119], v[58:59], v[78:79], 0
    v_mfma_f32_4x4x4_16b_bf16 v[120:123], v[58:59], v[80:81], 0
    v_mad_u32_u16 v16, v16, 8, s50 op_sel:[1,0,0,0]
    v_mad_u32_u16 v17, v17, 8, s50 op_sel:[1,0,0,0]
    v_mad_u32_u16 v18, v18, 8, s50 op_sel:[1,0,0,0]
    v_pk_fma_f32 v[114:115], v[114:115], v[108:109], s[20:21] op_sel:[0,0,0] op_sel_hi:[1,0,1]
    v_pk_fma_f32 v[112:113], v[112:113], v[108:109], s[16:17] op_sel:[0,0,0] op_sel_hi:[1,0,1]
    v_pk_fma_f32 v[118:119], v[118:119], v[108:109], s[20:21] op_sel:[0,1,0] op_sel_hi:[1,1,1]
    v_pk_fma_f32 v[116:117], v[116:117], v[108:109], s[16:17] op_sel:[0,1,0] op_sel_hi:[1,1,1]
    v_pk_fma_f32 v[122:123], v[122:123], v[110:111], s[20:21] op_sel:[0,0,0] op_sel_hi:[1,0,1]
    v_pk_fma_f32 v[120:121], v[120:121], v[110:111], s[16:17] op_sel:[0,0,0] op_sel_hi:[1,0,1]
    v_lshlrev_b64 v[114:115], 16, v[114:115]
    v_lshlrev_b64 v[118:119], 16, v[118:119]
    v_lshlrev_b64 v[122:123], 16, v[122:123]
    v_lshl_add_u64 v[76:77], v[112:113], 0, v[114:115]
    v_lshl_add_u64 v[78:79], v[116:117], 0, v[118:119]
    v_lshl_add_u64 v[80:81], v[120:121], 0, v[122:123]
    s_waitcnt lgkmcnt(6)
    v_or3_b32 v4, v44, v45, v4
    v_or3_b32 v4, v46, v47, v4
    v_or3_b32 v4, v48, v49, v4
    ds_add_rtn_u64 v[44:45], v16, v[76:77]
    ds_add_rtn_u64 v[46:47], v17, v[78:79]
    ds_add_rtn_u64 v[48:49], v18, v[80:81]
    s_waitcnt lgkmcnt(3)
    v_mad_u32_u16 v55, v55, s23, v2
    v_pk_lshrrev_b16 v55, 10, v55 op_sel_hi:[1,1]
    v_lshl_add_u32 v51, v51, 6, v55
    buffer_load_dwordx4 v[16:19], v51, s[44:47], s34 idxen
    s_cmp_le_u32 s51, 256
    s_cbranch_scc1 L_p2_kernel_noopt3_7
    v_bfe_i32 v108, v27, 2, 10
    v_bfe_i32 v109, v27, 12, 10
    v_ashrrev_i32 v110, 22, v27
    v_cvt_f32_i32 v108, v108
    v_cvt_f32_i32 v109, v109
    v_cvt_f32_i32 v110, v110
    v_mfma_f32_4x4x4_16b_bf16 v[112:115], v[58:59], v[64:65], 0
    v_mfma_f32_4x4x4_16b_bf16 v[116:119], v[58:59], v[66:67], 0
    v_mfma_f32_4x4x4_16b_bf16 v[120:123], v[58:59], v[68:69], 0
    v_mad_u32_u16 v24, v24, 8, s50 op_sel:[1,0,0,0]
    v_mad_u32_u16 v25, v25, 8, s50 op_sel:[1,0,0,0]
    v_mad_u32_u16 v26, v26, 8, s50 op_sel:[1,0,0,0]
    v_pk_fma_f32 v[114:115], v[114:115], v[108:109], s[20:21] op_sel:[0,0,0] op_sel_hi:[1,0,1]
    v_pk_fma_f32 v[112:113], v[112:113], v[108:109], s[16:17] op_sel:[0,0,0] op_sel_hi:[1,0,1]
    v_pk_fma_f32 v[118:119], v[118:119], v[108:109], s[20:21] op_sel:[0,1,0] op_sel_hi:[1,1,1]
    v_pk_fma_f32 v[116:117], v[116:117], v[108:109], s[16:17] op_sel:[0,1,0] op_sel_hi:[1,1,1]
    v_pk_fma_f32 v[122:123], v[122:123], v[110:111], s[20:21] op_sel:[0,0,0] op_sel_hi:[1,0,1]
    v_pk_fma_f32 v[120:121], v[120:121], v[110:111], s[16:17] op_sel:[0,0,0] op_sel_hi:[1,0,1]
    v_lshlrev_b64 v[114:115], 16, v[114:115]
    v_lshlrev_b64 v[118:119], 16, v[118:119]
    v_lshlrev_b64 v[122:123], 16, v[122:123]
    v_lshl_add_u64 v[64:65], v[112:113], 0, v[114:115]
    v_lshl_add_u64 v[66:67], v[116:117], 0, v[118:119]
    v_lshl_add_u64 v[68:69], v[120:121], 0, v[122:123]
    s_waitcnt lgkmcnt(0)
    v_or3_b32 v4, v44, v45, v4
    v_or3_b32 v4, v46, v47, v4
    v_or3_b32 v4, v48, v49, v4
    ds_add_rtn_u64 v[44:45], v24, v[64:65]
    ds_add_rtn_u64 v[46:47], v25, v[66:67]
    ds_add_rtn_u64 v[48:49], v26, v[68:69]
L_p2_kernel_noopt3_7:
    v_mbcnt_lo_u32_b32 v51, s36, 0
    v_mbcnt_hi_u32_b32 v51, s37, v51
    s_bcnt1_i32_b64 s14, s[36:37]
    v_lshl_add_u32 v55, v51, 1, s25
    ds_read_u16 v55, v55
    s_add_u32 s36, s26, 3145728
    s_lshl1_add_u32 s25, s14, s25
    s_lshl_b32 s14, s14, 10
    s_add_u32 s26, s26, s14
    s_cmp_le_u32 s28, 256
    s_cbranch_scc1 L_p2_kernel_noopt3_8
    v_readlane_b32 s38, v7, 8
    v_readlane_b32 s39, v7, 9
    s_nop 1
    v_mbcnt_lo_u32_b32 v62, s38, 0
    v_mbcnt_hi_u32_b32 v62, s39, v62
    s_bcnt1_i32_b64 s14, s[38:39]
    v_lshl_add_u32 v63, v62, 1, s25
    ds_read_u16 v63, v63
    s_add_u32 s38, s26, 4194304
    s_lshl1_add_u32 s25, s14, s25
    s_lshl_b32 s14, s14, 10
    s_add_u32 s26, s26, s14
L_p2_kernel_noopt3_8:
    v_bfe_i32 v108, v23, 2, 10
    v_bfe_i32 v109, v23, 12, 10
    v_ashrrev_i32 v110, 22, v23
    v_cvt_f32_i32 v108, v108
    v_cvt_f32_i32 v109, v109
    v_cvt_f32_i32 v110, v110
    v_mfma_f32_4x4x4_16b_bf16 v[112:115], v[58:59], v[82:83], 0
    v_mfma_f32_4x4x4_16b_bf16 v[116:119], v[58:59], v[84:85], 0
    v_mfma_f32_4x4x4_16b_bf16 v[120:123], v[58:59], v[86:87], 0
    v_mad_u32_u16 v20, v20, 8, s50 op_sel:[1,0,0,0]
    v_mad_u32_u16 v21, v21, 8, s50 op_sel:[1,0,0,0]
    v_mad_u32_u16 v22, v22, 8, s50 op_sel:[1,0,0,0]
    v_pk_fma_f32 v[114:115], v[114:115], v[108:109], s[20:21] op_sel:[0,0,0] op_sel_hi:[1,0,1]
    v_pk_fma_f32 v[112:113], v[112:113], v[108:109], s[16:17] op_sel:[0,0,0] op_sel_hi:[1,0,1]
    v_pk_fma_f32 v[118:119], v[118:119], v[108:109], s[20:21] op_sel:[0,1,0] op_sel_hi:[1,1,1]
    v_pk_fma_f32 v[116:117], v[116:117], v[108:109], s[16:17] op_sel:[0,1,0] op_sel_hi:[1,1,1]
    v_pk_fma_f32 v[122:123], v[122:123], v[110:111], s[20:21] op_sel:[0,0,0] op_sel_hi:[1,0,1]
    v_pk_fma_f32 v[120:121], v[120:121], v[110:111], s[16:17] op_sel:[0,0,0] op_sel_hi:[1,0,1]
    v_lshlrev_b64 v[114:115], 16, v[114:115]
    v_lshlrev_b64 v[118:119], 16, v[118:119]
    v_lshlrev_b64 v[122:123], 16, v[122:123]
    v_lshl_add_u64 v[82:83], v[112:113], 0, v[114:115]
    v_lshl_add_u64 v[84:85], v[116:117], 0, v[118:119]
    v_lshl_add_u64 v[86:87], v[120:121], 0, v[122:123]
    s_waitcnt lgkmcnt(1)
    v_or3_b32 v4, v44, v45, v4
    v_or3_b32 v4, v46, v47, v4
    v_or3_b32 v4, v48, v49, v4
    ds_add_rtn_u64 v[44:45], v20, v[82:83]
    ds_add_rtn_u64 v[46:47], v21, v[84:85]
    ds_add_rtn_u64 v[48:49], v22, v[86:87]
    s_waitcnt lgkmcnt(3)
    v_mad_u32_u16 v55, v55, s23, v2
    v_pk_lshrrev_b16 v55, 10, v55 op_sel_hi:[1,1]
    v_lshl_add_u32 v51, v51, 6, v55
    buffer_load_dwordx4 v[20:23], v51, s[44:47], s36 idxen
    s_cmp_le_u32 s28, 256
    s_cbranch_scc1 L_p2_kernel_noopt3_9
    v_mad_u32_u16 v63, v63, s23, v2
    v_pk_lshrrev_b16 v63, 10, v63 op_sel_hi:[1,1]
    v_lshl_add_u32 v62, v62, 6, v63
    buffer_load_dwordx4 v[24:27], v62, s[44:47], s38 idxen
L_p2_kernel_noopt3_9:
    s_add_u32 s14, s22, 80000
    buffer_load_dwordx4 v[88:91], v1, s[8:11], s14 offen
    s_cmp_eq_u32 s24, 7
    s_cbranch_scc1 L_p2_exit
    s_add_u32 s14, s24, 1
    s_min_u32 s14, s14, 7
    s_set_gpr_idx_on s14, gpr_idx(SRC0)
    v_mad_u32_u16 v108, v28, v50, s40 op_sel:[1,0,0,0]
    v_mad_u32_u16 v109, v36, v50, s41 op_sel:[1,0,0,0]
    s_set_gpr_idx_off
    v_sub_u32_sdwa v110, v109, v108 dst_sel:DWORD dst_unused:UNUSED_PAD src0_sel:WORD_1 src1_sel:WORD_1
    s_nop 1
    v_add_u32_dpp v110, v110, v110 row_shr:1 row_mask:0xf bank_mask:0xf bound_ctrl:0
    s_nop 1
    v_add_u32_dpp v110, v110, v110 row_shr:2 row_mask:0xf bank_mask:0xf bound_ctrl:0
    s_nop 1
    v_add_u32_dpp v110, v110, v110 row_shr:4 row_mask:0xf bank_mask:0xf bound_ctrl:0
    s_nop 1
    v_add_u32_dpp v110, v110, v110 row_shr:8 row_mask:0xf bank_mask:0xf bound_ctrl:0
    s_nop 1
    v_add_u32_dpp v110, v110, v110 row_bcast:15 row_mask:0xa bank_mask:0xf
    s_nop 1
    v_add_u32_dpp v110, v110, v110 row_bcast:31 row_mask:0xc bank_mask:0xf
    v_sub_u32_sdwa v109, v109, v110 dst_sel:DWORD dst_unused:UNUSED_PAD src0_sel:WORD_1 src1_sel:DWORD
    v_readlane_b32 s29, v110, 63
    v_add_u32 v110, -1, v110
    ds_write_b16 v126, v109
    v_lshlrev_b32_e64 v111, v110, 1
    v_lshrrev_b32 v110, 5, v110
    s_cmp_gt_u32 s29, 320
    s_cselect_b32 s2, 1, s2
    v_lshl_add_u32 v110, v110, 2, v127
    s_cselect_b64 exec, 0, -1
    ds_or_b32 v110, v111 offset:136
    s_mov_b64 exec, -1
    ds_wrxchg2_rtn_b32 v[108:109], v6, v5, v5 offset0:34 offset1:44
    s_add_u32 s14, s22, 96384
    buffer_load_dwordx4 v[92:95], v1, s[8:11], s14 offen
    s_add_u32 s24, s24, 1
    s_cmp_lt_u32 s24, 8
    s_barrier
    s_cbranch_scc1 L_p2_loop
L_p2_exit:
    s_waitcnt lgkmcnt(0)
    v_or3_b32 v4, v44, v45, v4
    v_or3_b32 v4, v46, v47, v4
    v_or3_b32 v4, v48, v49, v4
    s_mov_b32 s27, s19
    s_waitcnt vmcnt(0)
    v_mov_b64 v[64:65], v[28:29]
    v_mov_b64 v[66:67], v[30:31]
    v_mov_b64 v[68:69], v[36:37]
    v_mov_b64 v[70:71], v[38:39]
    v_mov_b32 v8, 160232
    s_cmp_lg_u32 s13, 0
    s_cselect_b64 exec, 0, 1
    ds_write_b32 v8, v52
    s_mov_b64 exec, -1
    v_subrev_u32 v6, 80000, v124
    s_mul_i32 s24, s12, 19968
    v_subrev_u32 v10, s24, v1
    v_mov_b32 v11, 0x7f000000
    s_waitcnt vmcnt(0) lgkmcnt(0)
    s_barrier
    s_cmp_lt_u32 s13, 12
    s_cbranch_scc1 L_p2_ga
L_p2_ga:
    ds_read_b32 v9, v8
    ds_read_b128 v[88:91], v1 offset:0
    ds_read_b128 v[92:95], v1 offset:16384
    ds_read_b128 v[96:99], v1 offset:32768
    ds_read_b128 v[100:103], v1 offset:49152
    ds_read_b128 v[104:107], v6
    s_mul_i32 s14, s12, 5120000
    s_mul_i32 s15, s3, 80000
    s_add_u32 s25, s14, s15
    s_add_u32 s25, s25, 228589568
    s_cmp_eq_u32 s12, 3
    s_cselect_b32 s15, 128, 0
    s_add_u32 s15, s15, 19968
    s_waitcnt lgkmcnt(5)
    v_readfirstlane_b32 s21, v9
    s_nop 0
    s_bfe_u32 s21, s21, 524296
    s_cmp_lg_u32 s21, 4
    s_cselect_b32 s21, 1, 0
    s_cselect_b32 s24, 0, s15
    v_cmp_le_u32 vcc, s24, v10
    v_add_u32 v10, 16384, v10
    s_add_u32 s14, s25, 0
    v_cndmask_b32 v12, v11, v1, vcc
    s_waitcnt lgkmcnt(4)
    buffer_store_dwordx4 v[88:91], v12, s[4:7], s14 offen sc1
    v_or3_b32 v4, v88, v89, v4
    v_or3_b32 v4, v90, v91, v4
    v_cmp_le_u32 vcc, s24, v10
    v_add_u32 v10, 16384, v10
    s_add_u32 s14, s25, 16384
    v_cndmask_b32 v12, v11, v1, vcc
    s_waitcnt lgkmcnt(3)
    buffer_store_dwordx4 v[92:95], v12, s[4:7], s14 offen sc1
    v_or3_b32 v4, v92, v93, v4
    v_or3_b32 v4, v94, v95, v4
    v_cmp_le_u32 vcc, s24, v10
    v_add_u32 v10, 16384, v10
    s_add_u32 s14, s25, 32768
    v_cndmask_b32 v12, v11, v1, vcc
    s_waitcnt lgkmcnt(2)
    buffer_store_dwordx4 v[96:99], v12, s[4:7], s14 offen sc1
    v_or3_b32 v4, v96, v97, v4
    v_or3_b32 v4, v98, v99, v4
    v_cmp_le_u32 vcc, s24, v10
    v_add_u32 v10, 16384, v10
    s_add_u32 s14, s25, 49152
    v_cndmask_b32 v12, v11, v1, vcc
    s_waitcnt lgkmcnt(1)
    buffer_store_dwordx4 v[100:103], v12, s[4:7], s14 offen sc1
    v_or3_b32 v4, v100, v101, v4
    v_or3_b32 v4, v102, v103, v4
    v_cmp_le_u32 vcc, s24, v10
    v_add_u32 v10, 16384, v10
    s_add_u32 s14, s25, 0
    v_cndmask_b32 v12, v11, v6, vcc
    s_waitcnt lgkmcnt(0)
    buffer_store_dwordx4 v[104:107], v12, s[4:7], s14 offen sc1
    v_or3_b32 v4, v104, v105, v4
    v_or3_b32 v4, v106, v107, v4
    s_load_dwordx2 s[16:17], s[0:1], 88
    s_cmp_ge_u32 s13, 12
    s_cbranch_scc1 L_p2_gb
    v_lshlrev_b32 v30, 16, v60
    v_and_b32 v31, 0xffff0000, v60
    v_lshlrev_b32 v36, 16, v53
    v_and_b32 v37, 0xffff0000, v53
    v_lshlrev_b32 v38, 16, v54
    v_and_b32 v39, 0xffff0000, v54
    v_lshlrev_b32 v40, 16, v56
    v_and_b32 v41, 0xffff0000, v56
    v_lshlrev_b32 v42, 16, v57
    v_and_b32 v43, 0xffff0000, v57
    v_pk_add_f32 v[14:15], v[30:31], v[36:37] op_sel:[0,0] op_sel_hi:[1,0] neg_lo:[0,1] neg_hi:[0,1]
    v_pk_add_f32 v[16:17], v[30:31], v[36:37] op_sel:[0,1] op_sel_hi:[1,1] neg_lo:[0,1] neg_hi:[0,1]
    v_pk_add_f32 v[18:19], v[30:31], v[38:39] op_sel:[0,0] op_sel_hi:[1,0] neg_lo:[0,1] neg_hi:[0,1]
    v_pk_add_f32 v[20:21], v[30:31], v[38:39] op_sel:[0,1] op_sel_hi:[1,1] neg_lo:[0,1] neg_hi:[0,1]
    v_pk_add_f32 v[22:23], v[30:31], v[40:41] op_sel:[0,0] op_sel_hi:[1,0] neg_lo:[0,1] neg_hi:[0,1]
    v_pk_add_f32 v[24:25], v[30:31], v[40:41] op_sel:[0,1] op_sel_hi:[1,1] neg_lo:[0,1] neg_hi:[0,1]
    v_pk_add_f32 v[26:27], v[30:31], v[42:43] op_sel:[0,0] op_sel_hi:[1,0] neg_lo:[0,1] neg_hi:[0,1]
    v_pk_add_f32 v[28:29], v[30:31], v[42:43] op_sel:[0,1] op_sel_hi:[1,1] neg_lo:[0,1] neg_hi:[0,1]
    v_cvt_pk_bf16_f32 v32, v14, v15
    v_lshlrev_b32 v14, 16, v32
    v_and_b32 v15, 0xffff0000, v32
    v_cvt_pk_bf16_f32 v32, v16, v17
    v_lshlrev_b32 v16, 16, v32
    v_and_b32 v17, 0xffff0000, v32
    v_cvt_pk_bf16_f32 v32, v18, v19
    v_lshlrev_b32 v18, 16, v32
    v_and_b32 v19, 0xffff0000, v32
    v_cvt_pk_bf16_f32 v32, v20, v21
    v_lshlrev_b32 v20, 16, v32
    v_and_b32 v21, 0xffff0000, v32
    v_cvt_pk_bf16_f32 v32, v22, v23
    v_lshlrev_b32 v22, 16, v32
    v_and_b32 v23, 0xffff0000, v32
    v_cvt_pk_bf16_f32 v32, v24, v25
    v_lshlrev_b32 v24, 16, v32
    v_and_b32 v25, 0xffff0000, v32
    v_cvt_pk_bf16_f32 v32, v26, v27
    v_lshlrev_b32 v26, 16, v32
    v_and_b32 v27, 0xffff0000, v32
    v_cvt_pk_bf16_f32 v32, v28, v29
    v_lshlrev_b32 v28, 16, v32
    v_and_b32 v29, 0xffff0000, v32
    v_pk_mul_f32 v[14:15], v[14:15], v[14:15]
    v_pk_mul_f32 v[16:17], v[16:17], v[16:17]
    v_pk_mul_f32 v[18:19], v[18:19], v[18:19]
    v_pk_mul_f32 v[20:21], v[20:21], v[20:21]
    v_pk_mul_f32 v[22:23], v[22:23], v[22:23]
    v_pk_mul_f32 v[24:25], v[24:25], v[24:25]
    v_pk_mul_f32 v[26:27], v[26:27], v[26:27]
    v_pk_mul_f32 v[28:29], v[28:29], v[28:29]
    v_cvt_pk_bf16_f32 v32, v14, v15
    v_lshlrev_b32 v14, 16, v32
    v_and_b32 v15, 0xffff0000, v32
    v_cvt_pk_bf16_f32 v32, v16, v17
    v_lshlrev_b32 v16, 16, v32
    v_and_b32 v17, 0xffff0000, v32
    v_cvt_pk_bf16_f32 v32, v18, v19
    v_lshlrev_b32 v18, 16, v32
    v_and_b32 v19, 0xffff0000, v32
    v_cvt_pk_bf16_f32 v32, v20, v21
    v_lshlrev_b32 v20, 16, v32
    v_and_b32 v21, 0xffff0000, v32
    v_cvt_pk_bf16_f32 v32, v22, v23
    v_lshlrev_b32 v22, 16, v32
    v_and_b32 v23, 0xffff0000, v32
    v_cvt_pk_bf16_f32 v32, v24, v25
    v_lshlrev_b32 v24, 16, v32
    v_and_b32 v25, 0xffff0000, v32
    v_cvt_pk_bf16_f32 v32, v26, v27
    v_lshlrev_b32 v26, 16, v32
    v_and_b32 v27, 0xffff0000, v32
    v_cvt_pk_bf16_f32 v32, v28, v29
    v_lshlrev_b32 v28, 16, v32
    v_and_b32 v29, 0xffff0000, v32
    v_mov_b32 v30, 1092616192
    v_mov_b32 v31, 0x3fb8aa3b
    v_pk_mul_f32 v[14:15], v[14:15], v[30:31] op_sel:[0,0] op_sel_hi:[1,0]
    v_pk_mul_f32 v[16:17], v[16:17], v[30:31] op_sel:[0,0] op_sel_hi:[1,0]
    v_pk_mul_f32 v[18:19], v[18:19], v[30:31] op_sel:[0,0] op_sel_hi:[1,0]
    v_pk_mul_f32 v[20:21], v[20:21], v[30:31] op_sel:[0,0] op_sel_hi:[1,0]
    v_pk_mul_f32 v[22:23], v[22:23], v[30:31] op_sel:[0,0] op_sel_hi:[1,0]
    v_pk_mul_f32 v[24:25], v[24:25], v[30:31] op_sel:[0,0] op_sel_hi:[1,0]
    v_pk_mul_f32 v[26:27], v[26:27], v[30:31] op_sel:[0,0] op_sel_hi:[1,0]
    v_pk_mul_f32 v[28:29], v[28:29], v[30:31] op_sel:[0,0] op_sel_hi:[1,0]
    v_cvt_pk_bf16_f32 v32, v14, v15
    v_lshlrev_b32 v14, 16, v32
    v_and_b32 v15, 0xffff0000, v32
    v_cvt_pk_bf16_f32 v32, v16, v17
    v_lshlrev_b32 v16, 16, v32
    v_and_b32 v17, 0xffff0000, v32
    v_cvt_pk_bf16_f32 v32, v18, v19
    v_lshlrev_b32 v18, 16, v32
    v_and_b32 v19, 0xffff0000, v32
    v_cvt_pk_bf16_f32 v32, v20, v21
    v_lshlrev_b32 v20, 16, v32
    v_and_b32 v21, 0xffff0000, v32
    v_cvt_pk_bf16_f32 v32, v22, v23
    v_lshlrev_b32 v22, 16, v32
    v_and_b32 v23, 0xffff0000, v32
    v_cvt_pk_bf16_f32 v32, v24, v25
    v_lshlrev_b32 v24, 16, v32
    v_and_b32 v25, 0xffff0000, v32
    v_cvt_pk_bf16_f32 v32, v26, v27
    v_lshlrev_b32 v26, 16, v32
    v_and_b32 v27, 0xffff0000, v32
    v_cvt_pk_bf16_f32 v32, v28, v29
    v_lshlrev_b32 v28, 16, v32
    v_and_b32 v29, 0xffff0000, v32
    v_pk_mul_f32 v[14:15], v[14:15], v[30:31] op_sel:[0,1] op_sel_hi:[1,1]
    v_pk_mul_f32 v[16:17], v[16:17], v[30:31] op_sel:[0,1] op_sel_hi:[1,1]
    v_pk_mul_f32 v[18:19], v[18:19], v[30:31] op_sel:[0,1] op_sel_hi:[1,1]
    v_pk_mul_f32 v[20:21], v[20:21], v[30:31] op_sel:[0,1] op_sel_hi:[1,1]
    v_pk_mul_f32 v[22:23], v[22:23], v[30:31] op_sel:[0,1] op_sel_hi:[1,1]
    v_pk_mul_f32 v[24:25], v[24:25], v[30:31] op_sel:[0,1] op_sel_hi:[1,1]
    v_pk_mul_f32 v[26:27], v[26:27], v[30:31] op_sel:[0,1] op_sel_hi:[1,1]
    v_pk_mul_f32 v[28:29], v[28:29], v[30:31] op_sel:[0,1] op_sel_hi:[1,1]
    v_exp_f32 v14, -v14
    v_exp_f32 v15, -v15
    v_exp_f32 v16, -v16
    v_exp_f32 v17, -v17
    v_exp_f32 v18, -v18
    v_exp_f32 v19, -v19
    v_exp_f32 v20, -v20
    v_exp_f32 v21, -v21
    v_exp_f32 v22, -v22
    v_exp_f32 v23, -v23
    v_exp_f32 v24, -v24
    v_exp_f32 v25, -v25
    v_exp_f32 v26, -v26
    v_exp_f32 v27, -v27
    v_exp_f32 v28, -v28
    v_exp_f32 v29, -v29
    v_cvt_pk_bf16_f32 v14, v14, v16
    v_cvt_pk_bf16_f32 v15, v15, v17
    v_cvt_pk_bf16_f32 v18, v18, v20
    v_cvt_pk_bf16_f32 v19, v19, v21
    v_cvt_pk_bf16_f32 v22, v22, v24
    v_cvt_pk_bf16_f32 v23, v23, v25
    v_cvt_pk_bf16_f32 v26, v26, v28
    v_cvt_pk_bf16_f32 v27, v27, v29
    v_dot2_f32_bf16 v72, v14, s68, 0
    v_dot2_f32_bf16 v73, v15, s68, 0
    v_dot2_f32_bf16 v74, v14, s69, 0
    v_dot2_f32_bf16 v75, v15, s69, 0
    v_dot2_f32_bf16 v76, v14, s70, 0
    v_dot2_f32_bf16 v77, v15, s70, 0
    v_dot2_f32_bf16 v78, v14, s71, 0
    v_dot2_f32_bf16 v79, v15, s71, 0
    v_dot2_f32_bf16 v80, v14, s52, 0
    v_dot2_f32_bf16 v81, v15, s52, 0
    v_dot2_f32_bf16 v82, v14, s53, 0
    v_dot2_f32_bf16 v83, v15, s53, 0
    v_dot2_f32_bf16 v84, v14, s54, 0
    v_dot2_f32_bf16 v85, v15, s54, 0
    v_dot2_f32_bf16 v86, v14, s55, 0
    v_dot2_f32_bf16 v87, v15, s55, 0
    v_dot2_f32_bf16 v72, v18, s72, v72
    v_dot2_f32_bf16 v73, v19, s72, v73
    v_dot2_f32_bf16 v74, v18, s73, v74
    v_dot2_f32_bf16 v75, v19, s73, v75
    v_dot2_f32_bf16 v76, v18, s74, v76
    v_dot2_f32_bf16 v77, v19, s74, v77
    v_dot2_f32_bf16 v78, v18, s75, v78
    v_dot2_f32_bf16 v79, v19, s75, v79
    v_dot2_f32_bf16 v80, v18, s56, v80
    v_dot2_f32_bf16 v81, v19, s56, v81
    v_dot2_f32_bf16 v82, v18, s57, v82
    v_dot2_f32_bf16 v83, v19, s57, v83
    v_dot2_f32_bf16 v84, v18, s58, v84
    v_dot2_f32_bf16 v85, v19, s58, v85
    v_dot2_f32_bf16 v86, v18, s59, v86
    v_dot2_f32_bf16 v87, v19, s59, v87
    v_dot2_f32_bf16 v72, v22, s76, v72
    v_dot2_f32_bf16 v73, v23, s76, v73
    v_dot2_f32_bf16 v74, v22, s77, v74
    v_dot2_f32_bf16 v75, v23, s77, v75
    v_dot2_f32_bf16 v76, v22, s78, v76
    v_dot2_f32_bf16 v77, v23, s78, v77
    v_dot2_f32_bf16 v78, v22, s79, v78
    v_dot2_f32_bf16 v79, v23, s79, v79
    v_dot2_f32_bf16 v80, v22, s60, v80
    v_dot2_f32_bf16 v81, v23, s60, v81
    v_dot2_f32_bf16 v82, v22, s61, v82
    v_dot2_f32_bf16 v83, v23, s61, v83
    v_dot2_f32_bf16 v84, v22, s62, v84
    v_dot2_f32_bf16 v85, v23, s62, v85
    v_dot2_f32_bf16 v86, v22, s63, v86
    v_dot2_f32_bf16 v87, v23, s63, v87
    v_dot2_f32_bf16 v72, v26, s80, v72
    v_dot2_f32_bf16 v73, v27, s80, v73
    v_dot2_f32_bf16 v74, v26, s81, v74
    v_dot2_f32_bf16 v75, v27, s81, v75
    v_dot2_f32_bf16 v76, v26, s82, v76
    v_dot2_f32_bf16 v77, v27, s82, v77
    v_dot2_f32_bf16 v78, v26, s83, v78
    v_dot2_f32_bf16 v79, v27, s83, v79
    v_dot2_f32_bf16 v80, v26, s64, v80
    v_dot2_f32_bf16 v81, v27, s64, v81
    v_dot2_f32_bf16 v82, v26, s65, v82
    v_dot2_f32_bf16 v83, v27, s65, v83
    v_dot2_f32_bf16 v84, v26, s66, v84
    v_dot2_f32_bf16 v85, v27, s66, v85
    v_dot2_f32_bf16 v86, v26, s67, v86
    v_dot2_f32_bf16 v87, v27, s67, v87
L_p2_gb:
    v_and_b32 v4, 0x80008000, v4
    v_cmp_ne_u32 vcc, 0, v4
    v_mov_b32 v8, s27
    v_and_b32 v10, 15, v0
    v_mul_u32_u24 v10, 240, v10
    v_add_u32 v10, 160000, v10
    s_cmp_lg_u64 vcc, 0
    s_cselect_b32 s2, 1, s2
    v_mov_b32 v9, s2
    s_mov_b64 exec, 1
    ds_write_b32 v8, v9
    s_mov_b64 exec, -1
    s_mov_b32 s49, s12
    s_mov_b32 s51, 0
    s_waitcnt vmcnt(0) lgkmcnt(0)
    s_barrier
    ds_read_b32 v9, v10
    s_mov_b32 s18, 5120000
    s_mov_b32 s19, 0x00020000
    s_waitcnt lgkmcnt(0)
    v_cmp_ne_u32 vcc, 0, v9
    s_nop 1
    s_cmp_lg_u64 vcc, 0
    s_cselect_b32 s2, 1, 0
    s_cbranch_scc1 L_p2_slow
L_p2_signal:
    v_mov_b32 v8, 160228
    s_lshl_b32 s15, s2, 4
    s_or_b32 s15, s15, s21
    s_add_u32 s14, s12, 16
    s_lshl_b32 s20, s15, s14
    s_add_u32 s20, s20, 1
    v_mov_b32 v9, s20
    s_cmp_lg_u32 s13, 15
    s_cbranch_scc1 L_p2_nosig0
    s_lshl_b32 s14, s3, 8
    s_add_u32 s14, s14, 8523776
    s_mov_b64 exec, 1
    buffer_atomic_add v9, off, s[4:7], s14 sc0
    s_mov_b64 exec, -1
L_p2_nosig0:
    s_cmp_eq_u32 s49, 3
    s_cselect_b32 s15, 8, 0
    s_add_u32 s15, s15, 224
    v_add_u32 v2, 16384, v1
    v_cmp_gt_u32 vcc, s15, v0
    s_mul_i32 s14, s3, 80000
    s_mul_i32 s26, s49, 19968
    s_add_u32 s26, s26, s14
    v_cndmask_b32 v2, 0.5, v2, vcc
    s_mov_b32 s10, 5120000
    s_lshl_b32 s28, s92, 16
    s_and_b32 s29, s92, 0xffff0000
    s_lshl_b32 s30, s93, 16
    s_and_b32 s31, s93, 0xffff0000
    s_lshl_b32 s32, s94, 16
    s_and_b32 s33, s94, 0xffff0000
    s_lshl_b32 s34, s95, 16
    s_and_b32 s35, s95, 0xffff0000
    s_lshl_b32 s36, s96, 16
    s_and_b32 s37, s96, 0xffff0000
    s_lshl_b32 s38, s97, 16
    s_and_b32 s39, s97, 0xffff0000
    s_lshl_b32 s40, s98, 16
    s_and_b32 s41, s98, 0xffff0000
    s_lshl_b32 s42, s99, 16
    s_and_b32 s43, s99, 0xffff0000
    s_and_b32 s99, s91, 0xffff0000
    s_lshl_b32 s98, s91, 16
    s_and_b32 s97, s90, 0xffff0000
    s_lshl_b32 s96, s90, 16
    s_and_b32 s95, s89, 0xffff0000
    s_lshl_b32 s94, s89, 16
    s_and_b32 s93, s88, 0xffff0000
    s_lshl_b32 s92, s88, 16
    s_and_b32 s91, s87, 0xffff0000
    s_lshl_b32 s90, s87, 16
    s_and_b32 s89, s86, 0xffff0000
    s_lshl_b32 s88, s86, 16
    s_and_b32 s87, s85, 0xffff0000
    s_lshl_b32 s86, s85, 16
    s_and_b32 s85, s84, 0xffff0000
    s_lshl_b32 s84, s84, 16
    s_mov_b32 s44, s48
    s_add_u32 s45, s48, 2281701376
    s_cmp_eq_u32 s48, 0
    s_cselect_b32 s45, 0, s45
    s_cmp_lt_u32 s13, 12
    s_cbranch_scc1 L_p2_gc
    v_lshlrev_b32 v30, 16, v60
    v_and_b32 v31, 0xffff0000, v60
    v_lshlrev_b32 v36, 16, v53
    v_and_b32 v37, 0xffff0000, v53
    v_lshlrev_b32 v38, 16, v54
    v_and_b32 v39, 0xffff0000, v54
    v_lshlrev_b32 v40, 16, v56
    v_and_b32 v41, 0xffff0000, v56
    v_lshlrev_b32 v42, 16, v57
    v_and_b32 v43, 0xffff0000, v57
    v_pk_add_f32 v[14:15], v[30:31], v[36:37] op_sel:[0,0] op_sel_hi:[1,0] neg_lo:[0,1] neg_hi:[0,1]
    v_pk_add_f32 v[16:17], v[30:31], v[36:37] op_sel:[0,1] op_sel_hi:[1,1] neg_lo:[0,1] neg_hi:[0,1]
    v_pk_add_f32 v[18:19], v[30:31], v[38:39] op_sel:[0,0] op_sel_hi:[1,0] neg_lo:[0,1] neg_hi:[0,1]
    v_pk_add_f32 v[20:21], v[30:31], v[38:39] op_sel:[0,1] op_sel_hi:[1,1] neg_lo:[0,1] neg_hi:[0,1]
    v_pk_add_f32 v[22:23], v[30:31], v[40:41] op_sel:[0,0] op_sel_hi:[1,0] neg_lo:[0,1] neg_hi:[0,1]
    v_pk_add_f32 v[24:25], v[30:31], v[40:41] op_sel:[0,1] op_sel_hi:[1,1] neg_lo:[0,1] neg_hi:[0,1]
    v_pk_add_f32 v[26:27], v[30:31], v[42:43] op_sel:[0,0] op_sel_hi:[1,0] neg_lo:[0,1] neg_hi:[0,1]
    v_pk_add_f32 v[28:29], v[30:31], v[42:43] op_sel:[0,1] op_sel_hi:[1,1] neg_lo:[0,1] neg_hi:[0,1]
    v_cvt_pk_bf16_f32 v32, v14, v15
    v_lshlrev_b32 v14, 16, v32
    v_and_b32 v15, 0xffff0000, v32
    v_cvt_pk_bf16_f32 v32, v16, v17
    v_lshlrev_b32 v16, 16, v32
    v_and_b32 v17, 0xffff0000, v32
    v_cvt_pk_bf16_f32 v32, v18, v19
    v_lshlrev_b32 v18, 16, v32
    v_and_b32 v19, 0xffff0000, v32
    v_cvt_pk_bf16_f32 v32, v20, v21
    v_lshlrev_b32 v20, 16, v32
    v_and_b32 v21, 0xffff0000, v32
    v_cvt_pk_bf16_f32 v32, v22, v23
    v_lshlrev_b32 v22, 16, v32
    v_and_b32 v23, 0xffff0000, v32
    v_cvt_pk_bf16_f32 v32, v24, v25
    v_lshlrev_b32 v24, 16, v32
    v_and_b32 v25, 0xffff0000, v32
    v_cvt_pk_bf16_f32 v32, v26, v27
    v_lshlrev_b32 v26, 16, v32
    v_and_b32 v27, 0xffff0000, v32
    v_cvt_pk_bf16_f32 v32, v28, v29
    v_lshlrev_b32 v28, 16, v32
    v_and_b32 v29, 0xffff0000, v32
    v_pk_mul_f32 v[14:15], v[14:15], v[14:15]
    v_pk_mul_f32 v[16:17], v[16:17], v[16:17]
    v_pk_mul_f32 v[18:19], v[18:19], v[18:19]
    v_pk_mul_f32 v[20:21], v[20:21], v[20:21]
    v_pk_mul_f32 v[22:23], v[22:23], v[22:23]
    v_pk_mul_f32 v[24:25], v[24:25], v[24:25]
    v_pk_mul_f32 v[26:27], v[26:27], v[26:27]
    v_pk_mul_f32 v[28:29], v[28:29], v[28:29]
    v_cvt_pk_bf16_f32 v32, v14, v15
    v_lshlrev_b32 v14, 16, v32
    v_and_b32 v15, 0xffff0000, v32
    v_cvt_pk_bf16_f32 v32, v16, v17
    v_lshlrev_b32 v16, 16, v32
    v_and_b32 v17, 0xffff0000, v32
    v_cvt_pk_bf16_f32 v32, v18, v19
    v_lshlrev_b32 v18, 16, v32
    v_and_b32 v19, 0xffff0000, v32
    v_cvt_pk_bf16_f32 v32, v20, v21
    v_lshlrev_b32 v20, 16, v32
    v_and_b32 v21, 0xffff0000, v32
    v_cvt_pk_bf16_f32 v32, v22, v23
    v_lshlrev_b32 v22, 16, v32
    v_and_b32 v23, 0xffff0000, v32
    v_cvt_pk_bf16_f32 v32, v24, v25
    v_lshlrev_b32 v24, 16, v32
    v_and_b32 v25, 0xffff0000, v32
    v_cvt_pk_bf16_f32 v32, v26, v27
    v_lshlrev_b32 v26, 16, v32
    v_and_b32 v27, 0xffff0000, v32
    v_cvt_pk_bf16_f32 v32, v28, v29
    v_lshlrev_b32 v28, 16, v32
    v_and_b32 v29, 0xffff0000, v32
    v_mov_b32 v30, 1092616192
    v_mov_b32 v31, 0x3fb8aa3b
    v_pk_mul_f32 v[14:15], v[14:15], v[30:31] op_sel:[0,0] op_sel_hi:[1,0]
    v_pk_mul_f32 v[16:17], v[16:17], v[30:31] op_sel:[0,0] op_sel_hi:[1,0]
    v_pk_mul_f32 v[18:19], v[18:19], v[30:31] op_sel:[0,0] op_sel_hi:[1,0]
    v_pk_mul_f32 v[20:21], v[20:21], v[30:31] op_sel:[0,0] op_sel_hi:[1,0]
    v_pk_mul_f32 v[22:23], v[22:23], v[30:31] op_sel:[0,0] op_sel_hi:[1,0]
    v_pk_mul_f32 v[24:25], v[24:25], v[30:31] op_sel:[0,0] op_sel_hi:[1,0]
    v_pk_mul_f32 v[26:27], v[26:27], v[30:31] op_sel:[0,0] op_sel_hi:[1,0]
    v_pk_mul_f32 v[28:29], v[28:29], v[30:31] op_sel:[0,0] op_sel_hi:[1,0]
    v_cvt_pk_bf16_f32 v32, v14, v15
    v_lshlrev_b32 v14, 16, v32
    v_and_b32 v15, 0xffff0000, v32
    v_cvt_pk_bf16_f32 v32, v16, v17
    v_lshlrev_b32 v16, 16, v32
    v_and_b32 v17, 0xffff0000, v32
    v_cvt_pk_bf16_f32 v32, v18, v19
    v_lshlrev_b32 v18, 16, v32
    v_and_b32 v19, 0xffff0000, v32
    v_cvt_pk_bf16_f32 v32, v20, v21
    v_lshlrev_b32 v20, 16, v32
    v_and_b32 v21, 0xffff0000, v32
    v_cvt_pk_bf16_f32 v32, v22, v23
    v_lshlrev_b32 v22, 16, v32
    v_and_b32 v23, 0xffff0000, v32
    v_cvt_pk_bf16_f32 v32, v24, v25
    v_lshlrev_b32 v24, 16, v32
    v_and_b32 v25, 0xffff0000, v32
    v_cvt_pk_bf16_f32 v32, v26, v27
    v_lshlrev_b32 v26, 16, v32
    v_and_b32 v27, 0xffff0000, v32
    v_cvt_pk_bf16_f32 v32, v28, v29
    v_lshlrev_b32 v28, 16, v32
    v_and_b32 v29, 0xffff0000, v32
    v_pk_mul_f32 v[14:15], v[14:15], v[30:31] op_sel:[0,1] op_sel_hi:[1,1]
    v_pk_mul_f32 v[16:17], v[16:17], v[30:31] op_sel:[0,1] op_sel_hi:[1,1]
    v_pk_mul_f32 v[18:19], v[18:19], v[30:31] op_sel:[0,1] op_sel_hi:[1,1]
    v_pk_mul_f32 v[20:21], v[20:21], v[30:31] op_sel:[0,1] op_sel_hi:[1,1]
    v_pk_mul_f32 v[22:23], v[22:23], v[30:31] op_sel:[0,1] op_sel_hi:[1,1]
    v_pk_mul_f32 v[24:25], v[24:25], v[30:31] op_sel:[0,1] op_sel_hi:[1,1]
    v_pk_mul_f32 v[26:27], v[26:27], v[30:31] op_sel:[0,1] op_sel_hi:[1,1]
    v_pk_mul_f32 v[28:29], v[28:29], v[30:31] op_sel:[0,1] op_sel_hi:[1,1]
    v_exp_f32 v14, -v14
    v_exp_f32 v15, -v15
    v_exp_f32 v16, -v16
    v_exp_f32 v17, -v17
    v_exp_f32 v18, -v18
    v_exp_f32 v19, -v19
    v_exp_f32 v20, -v20
    v_exp_f32 v21, -v21
    v_exp_f32 v22, -v22
    v_exp_f32 v23, -v23
    v_exp_f32 v24, -v24
    v_exp_f32 v25, -v25
    v_exp_f32 v26, -v26
    v_exp_f32 v27, -v27
    v_exp_f32 v28, -v28
    v_exp_f32 v29, -v29
    v_cvt_pk_bf16_f32 v14, v14, v16
    v_cvt_pk_bf16_f32 v15, v15, v17
    v_cvt_pk_bf16_f32 v18, v18, v20
    v_cvt_pk_bf16_f32 v19, v19, v21
    v_cvt_pk_bf16_f32 v22, v22, v24
    v_cvt_pk_bf16_f32 v23, v23, v25
    v_cvt_pk_bf16_f32 v26, v26, v28
    v_cvt_pk_bf16_f32 v27, v27, v29
    v_dot2_f32_bf16 v72, v14, s68, 0
    v_dot2_f32_bf16 v73, v15, s68, 0
    v_dot2_f32_bf16 v74, v14, s69, 0
    v_dot2_f32_bf16 v75, v15, s69, 0
    v_dot2_f32_bf16 v76, v14, s70, 0
    v_dot2_f32_bf16 v77, v15, s70, 0
    v_dot2_f32_bf16 v78, v14, s71, 0
    v_dot2_f32_bf16 v79, v15, s71, 0
    v_dot2_f32_bf16 v80, v14, s52, 0
    v_dot2_f32_bf16 v81, v15, s52, 0
    v_dot2_f32_bf16 v82, v14, s53, 0
    v_dot2_f32_bf16 v83, v15, s53, 0
    v_dot2_f32_bf16 v84, v14, s54, 0
    v_dot2_f32_bf16 v85, v15, s54, 0
    v_dot2_f32_bf16 v86, v14, s55, 0
    v_dot2_f32_bf16 v87, v15, s55, 0
    v_dot2_f32_bf16 v72, v18, s72, v72
    v_dot2_f32_bf16 v73, v19, s72, v73
    v_dot2_f32_bf16 v74, v18, s73, v74
    v_dot2_f32_bf16 v75, v19, s73, v75
    v_dot2_f32_bf16 v76, v18, s74, v76
    v_dot2_f32_bf16 v77, v19, s74, v77
    v_dot2_f32_bf16 v78, v18, s75, v78
    v_dot2_f32_bf16 v79, v19, s75, v79
    v_dot2_f32_bf16 v80, v18, s56, v80
    v_dot2_f32_bf16 v81, v19, s56, v81
    v_dot2_f32_bf16 v82, v18, s57, v82
    v_dot2_f32_bf16 v83, v19, s57, v83
    v_dot2_f32_bf16 v84, v18, s58, v84
    v_dot2_f32_bf16 v85, v19, s58, v85
    v_dot2_f32_bf16 v86, v18, s59, v86
    v_dot2_f32_bf16 v87, v19, s59, v87
    v_dot2_f32_bf16 v72, v22, s76, v72
    v_dot2_f32_bf16 v73, v23, s76, v73
    v_dot2_f32_bf16 v74, v22, s77, v74
    v_dot2_f32_bf16 v75, v23, s77, v75
    v_dot2_f32_bf16 v76, v22, s78, v76
    v_dot2_f32_bf16 v77, v23, s78, v77
    v_dot2_f32_bf16 v78, v22, s79, v78
    v_dot2_f32_bf16 v79, v23, s79, v79
    v_dot2_f32_bf16 v80, v22, s60, v80
    v_dot2_f32_bf16 v81, v23, s60, v81
    v_dot2_f32_bf16 v82, v22, s61, v82
    v_dot2_f32_bf16 v83, v23, s61, v83
    v_dot2_f32_bf16 v84, v22, s62, v84
    v_dot2_f32_bf16 v85, v23, s62, v85
    v_dot2_f32_bf16 v86, v22, s63, v86
    v_dot2_f32_bf16 v87, v23, s63, v87
    v_dot2_f32_bf16 v72, v26, s80, v72
    v_dot2_f32_bf16 v73, v27, s80, v73
    v_dot2_f32_bf16 v74, v26, s81, v74
    v_dot2_f32_bf16 v75, v27, s81, v75
    v_dot2_f32_bf16 v76, v26, s82, v76
    v_dot2_f32_bf16 v77, v27, s82, v77
    v_dot2_f32_bf16 v78, v26, s83, v78
    v_dot2_f32_bf16 v79, v27, s83, v79
    v_dot2_f32_bf16 v80, v26, s64, v80
    v_dot2_f32_bf16 v81, v27, s64, v81
    v_dot2_f32_bf16 v82, v26, s65, v82
    v_dot2_f32_bf16 v83, v27, s65, v83
    v_dot2_f32_bf16 v84, v26, s66, v84
    v_dot2_f32_bf16 v85, v27, s66, v85
    v_dot2_f32_bf16 v86, v26, s67, v86
    v_dot2_f32_bf16 v87, v27, s67, v87
L_p2_gc:
    s_cmp_ge_u32 s13, 4
    s_cbranch_scc1 L_p2_gd
    v_lshlrev_b32 v30, 16, v61
    v_and_b32 v31, 0xffff0000, v61
    v_pk_add_f32 v[14:15], v[30:31], v[36:37] op_sel:[0,0] op_sel_hi:[1,0] neg_lo:[0,1] neg_hi:[0,1]
    v_pk_add_f32 v[16:17], v[30:31], v[36:37] op_sel:[0,1] op_sel_hi:[1,1] neg_lo:[0,1] neg_hi:[0,1]
    v_pk_add_f32 v[18:19], v[30:31], v[38:39] op_sel:[0,0] op_sel_hi:[1,0] neg_lo:[0,1] neg_hi:[0,1]
    v_pk_add_f32 v[20:21], v[30:31], v[38:39] op_sel:[0,1] op_sel_hi:[1,1] neg_lo:[0,1] neg_hi:[0,1]
    v_pk_add_f32 v[22:23], v[30:31], v[40:41] op_sel:[0,0] op_sel_hi:[1,0] neg_lo:[0,1] neg_hi:[0,1]
    v_pk_add_f32 v[24:25], v[30:31], v[40:41] op_sel:[0,1] op_sel_hi:[1,1] neg_lo:[0,1] neg_hi:[0,1]
    v_pk_add_f32 v[26:27], v[30:31], v[42:43] op_sel:[0,0] op_sel_hi:[1,0] neg_lo:[0,1] neg_hi:[0,1]
    v_pk_add_f32 v[28:29], v[30:31], v[42:43] op_sel:[0,1] op_sel_hi:[1,1] neg_lo:[0,1] neg_hi:[0,1]
    v_cvt_pk_bf16_f32 v32, v14, v15
    v_lshlrev_b32 v14, 16, v32
    v_and_b32 v15, 0xffff0000, v32
    v_cvt_pk_bf16_f32 v32, v16, v17
    v_lshlrev_b32 v16, 16, v32
    v_and_b32 v17, 0xffff0000, v32
    v_cvt_pk_bf16_f32 v32, v18, v19
    v_lshlrev_b32 v18, 16, v32
    v_and_b32 v19, 0xffff0000, v32
    v_cvt_pk_bf16_f32 v32, v20, v21
    v_lshlrev_b32 v20, 16, v32
    v_and_b32 v21, 0xffff0000, v32
    v_cvt_pk_bf16_f32 v32, v22, v23
    v_lshlrev_b32 v22, 16, v32
    v_and_b32 v23, 0xffff0000, v32
    v_cvt_pk_bf16_f32 v32, v24, v25
    v_lshlrev_b32 v24, 16, v32
    v_and_b32 v25, 0xffff0000, v32
    v_cvt_pk_bf16_f32 v32, v26, v27
    v_lshlrev_b32 v26, 16, v32
    v_and_b32 v27, 0xffff0000, v32
    v_cvt_pk_bf16_f32 v32, v28, v29
    v_lshlrev_b32 v28, 16, v32
    v_and_b32 v29, 0xffff0000, v32
    v_pk_mul_f32 v[14:15], v[14:15], v[14:15]
    v_pk_mul_f32 v[16:17], v[16:17], v[16:17]
    v_pk_mul_f32 v[18:19], v[18:19], v[18:19]
    v_pk_mul_f32 v[20:21], v[20:21], v[20:21]
    v_pk_mul_f32 v[22:23], v[22:23], v[22:23]
    v_pk_mul_f32 v[24:25], v[24:25], v[24:25]
    v_pk_mul_f32 v[26:27], v[26:27], v[26:27]
    v_pk_mul_f32 v[28:29], v[28:29], v[28:29]
    v_cvt_pk_bf16_f32 v32, v14, v15
    v_lshlrev_b32 v14, 16, v32
    v_and_b32 v15, 0xffff0000, v32
    v_cvt_pk_bf16_f32 v32, v16, v17
    v_lshlrev_b32 v16, 16, v32
    v_and_b32 v17, 0xffff0000, v32
    v_cvt_pk_bf16_f32 v32, v18, v19
    v_lshlrev_b32 v18, 16, v32
    v_and_b32 v19, 0xffff0000, v32
    v_cvt_pk_bf16_f32 v32, v20, v21
    v_lshlrev_b32 v20, 16, v32
    v_and_b32 v21, 0xffff0000, v32
    v_cvt_pk_bf16_f32 v32, v22, v23
    v_lshlrev_b32 v22, 16, v32
    v_and_b32 v23, 0xffff0000, v32
    v_cvt_pk_bf16_f32 v32, v24, v25
    v_lshlrev_b32 v24, 16, v32
    v_and_b32 v25, 0xffff0000, v32
    v_cvt_pk_bf16_f32 v32, v26, v27
    v_lshlrev_b32 v26, 16, v32
    v_and_b32 v27, 0xffff0000, v32
    v_cvt_pk_bf16_f32 v32, v28, v29
    v_lshlrev_b32 v28, 16, v32
    v_and_b32 v29, 0xffff0000, v32
    v_mov_b32 v30, 1092616192
    v_mov_b32 v31, 0x3fb8aa3b
    v_pk_mul_f32 v[14:15], v[14:15], v[30:31] op_sel:[0,0] op_sel_hi:[1,0]
    v_pk_mul_f32 v[16:17], v[16:17], v[30:31] op_sel:[0,0] op_sel_hi:[1,0]
    v_pk_mul_f32 v[18:19], v[18:19], v[30:31] op_sel:[0,0] op_sel_hi:[1,0]
    v_pk_mul_f32 v[20:21], v[20:21], v[30:31] op_sel:[0,0] op_sel_hi:[1,0]
    v_pk_mul_f32 v[22:23], v[22:23], v[30:31] op_sel:[0,0] op_sel_hi:[1,0]
    v_pk_mul_f32 v[24:25], v[24:25], v[30:31] op_sel:[0,0] op_sel_hi:[1,0]
    v_pk_mul_f32 v[26:27], v[26:27], v[30:31] op_sel:[0,0] op_sel_hi:[1,0]
    v_pk_mul_f32 v[28:29], v[28:29], v[30:31] op_sel:[0,0] op_sel_hi:[1,0]
    v_cvt_pk_bf16_f32 v32, v14, v15
    v_lshlrev_b32 v14, 16, v32
    v_and_b32 v15, 0xffff0000, v32
    v_cvt_pk_bf16_f32 v32, v16, v17
    v_lshlrev_b32 v16, 16, v32
    v_and_b32 v17, 0xffff0000, v32
    v_cvt_pk_bf16_f32 v32, v18, v19
    v_lshlrev_b32 v18, 16, v32
    v_and_b32 v19, 0xffff0000, v32
    v_cvt_pk_bf16_f32 v32, v20, v21
    v_lshlrev_b32 v20, 16, v32
    v_and_b32 v21, 0xffff0000, v32
    v_cvt_pk_bf16_f32 v32, v22, v23
    v_lshlrev_b32 v22, 16, v32
    v_and_b32 v23, 0xffff0000, v32
    v_cvt_pk_bf16_f32 v32, v24, v25
    v_lshlrev_b32 v24, 16, v32
    v_and_b32 v25, 0xffff0000, v32
    v_cvt_pk_bf16_f32 v32, v26, v27
    v_lshlrev_b32 v26, 16, v32
    v_and_b32 v27, 0xffff0000, v32
    v_cvt_pk_bf16_f32 v32, v28, v29
    v_lshlrev_b32 v28, 16, v32
    v_and_b32 v29, 0xffff0000, v32
    v_pk_mul_f32 v[14:15], v[14:15], v[30:31] op_sel:[0,1] op_sel_hi:[1,1]
    v_pk_mul_f32 v[16:17], v[16:17], v[30:31] op_sel:[0,1] op_sel_hi:[1,1]
    v_pk_mul_f32 v[18:19], v[18:19], v[30:31] op_sel:[0,1] op_sel_hi:[1,1]
    v_pk_mul_f32 v[20:21], v[20:21], v[30:31] op_sel:[0,1] op_sel_hi:[1,1]
    v_pk_mul_f32 v[22:23], v[22:23], v[30:31] op_sel:[0,1] op_sel_hi:[1,1]
    v_pk_mul_f32 v[24:25], v[24:25], v[30:31] op_sel:[0,1] op_sel_hi:[1,1]
    v_pk_mul_f32 v[26:27], v[26:27], v[30:31] op_sel:[0,1] op_sel_hi:[1,1]
    v_pk_mul_f32 v[28:29], v[28:29], v[30:31] op_sel:[0,1] op_sel_hi:[1,1]
    v_exp_f32 v14, -v14
    v_exp_f32 v15, -v15
    v_exp_f32 v16, -v16
    v_exp_f32 v17, -v17
    v_exp_f32 v18, -v18
    v_exp_f32 v19, -v19
    v_exp_f32 v20, -v20
    v_exp_f32 v21, -v21
    v_exp_f32 v22, -v22
    v_exp_f32 v23, -v23
    v_exp_f32 v24, -v24
    v_exp_f32 v25, -v25
    v_exp_f32 v26, -v26
    v_exp_f32 v27, -v27
    v_exp_f32 v28, -v28
    v_exp_f32 v29, -v29
    v_cvt_pk_bf16_f32 v14, v14, v16
    v_cvt_pk_bf16_f32 v15, v15, v17
    v_cvt_pk_bf16_f32 v18, v18, v20
    v_cvt_pk_bf16_f32 v19, v19, v21
    v_cvt_pk_bf16_f32 v22, v22, v24
    v_cvt_pk_bf16_f32 v23, v23, v25
    v_cvt_pk_bf16_f32 v26, v26, v28
    v_cvt_pk_bf16_f32 v27, v27, v29
    v_dot2_f32_bf16 v112, v14, s68, 0
    v_dot2_f32_bf16 v113, v15, s68, 0
    v_dot2_f32_bf16 v114, v14, s69, 0
    v_dot2_f32_bf16 v115, v15, s69, 0
    v_dot2_f32_bf16 v116, v14, s70, 0
    v_dot2_f32_bf16 v117, v15, s70, 0
    v_dot2_f32_bf16 v118, v14, s71, 0
    v_dot2_f32_bf16 v119, v15, s71, 0
    v_dot2_f32_bf16 v120, v14, s52, 0
    v_dot2_f32_bf16 v121, v15, s52, 0
    v_dot2_f32_bf16 v122, v14, s53, 0
    v_dot2_f32_bf16 v123, v15, s53, 0
    v_dot2_f32_bf16 v124, v14, s54, 0
    v_dot2_f32_bf16 v125, v15, s54, 0
    v_dot2_f32_bf16 v126, v14, s55, 0
    v_dot2_f32_bf16 v127, v15, s55, 0
    v_dot2_f32_bf16 v112, v18, s72, v112
    v_dot2_f32_bf16 v113, v19, s72, v113
    v_dot2_f32_bf16 v114, v18, s73, v114
    v_dot2_f32_bf16 v115, v19, s73, v115
    v_dot2_f32_bf16 v116, v18, s74, v116
    v_dot2_f32_bf16 v117, v19, s74, v117
    v_dot2_f32_bf16 v118, v18, s75, v118
    v_dot2_f32_bf16 v119, v19, s75, v119
    v_dot2_f32_bf16 v120, v18, s56, v120
    v_dot2_f32_bf16 v121, v19, s56, v121
    v_dot2_f32_bf16 v122, v18, s57, v122
    v_dot2_f32_bf16 v123, v19, s57, v123
    v_dot2_f32_bf16 v124, v18, s58, v124
    v_dot2_f32_bf16 v125, v19, s58, v125
    v_dot2_f32_bf16 v126, v18, s59, v126
    v_dot2_f32_bf16 v127, v19, s59, v127
    v_dot2_f32_bf16 v112, v22, s76, v112
    v_dot2_f32_bf16 v113, v23, s76, v113
    v_dot2_f32_bf16 v114, v22, s77, v114
    v_dot2_f32_bf16 v115, v23, s77, v115
    v_dot2_f32_bf16 v116, v22, s78, v116
    v_dot2_f32_bf16 v117, v23, s78, v117
    v_dot2_f32_bf16 v118, v22, s79, v118
    v_dot2_f32_bf16 v119, v23, s79, v119
    v_dot2_f32_bf16 v120, v22, s60, v120
    v_dot2_f32_bf16 v121, v23, s60, v121
    v_dot2_f32_bf16 v122, v22, s61, v122
    v_dot2_f32_bf16 v123, v23, s61, v123
    v_dot2_f32_bf16 v124, v22, s62, v124
    v_dot2_f32_bf16 v125, v23, s62, v125
    v_dot2_f32_bf16 v126, v22, s63, v126
    v_dot2_f32_bf16 v127, v23, s63, v127
    v_dot2_f32_bf16 v112, v26, s80, v112
    v_dot2_f32_bf16 v113, v27, s80, v113
    v_dot2_f32_bf16 v114, v26, s81, v114
    v_dot2_f32_bf16 v115, v27, s81, v115
    v_dot2_f32_bf16 v116, v26, s82, v116
    v_dot2_f32_bf16 v117, v27, s82, v117
    v_dot2_f32_bf16 v118, v26, s83, v118
    v_dot2_f32_bf16 v119, v27, s83, v119
    v_dot2_f32_bf16 v120, v26, s64, v120
    v_dot2_f32_bf16 v121, v27, s64, v121
    v_dot2_f32_bf16 v122, v26, s65, v122
    v_dot2_f32_bf16 v123, v27, s65, v123
    v_dot2_f32_bf16 v124, v26, s66, v124
    v_dot2_f32_bf16 v125, v27, s66, v125
    v_dot2_f32_bf16 v126, v26, s67, v126
    v_dot2_f32_bf16 v127, v27, s67, v127
L_p2_gd:
    s_cmp_lg_u32 s13, 15
    s_cbranch_scc1 L_p2_nosig
    s_waitcnt vmcnt(0)
    v_readfirstlane_b32 s15, v9
    s_lshl_b32 s51, 1, s12
    s_add_u32 s20, s20, s15
    s_and_b32 s15, s20, 0xff
    s_cmp_eq_u32 s15, 4
    s_cbranch_scc0 L_p2_notlast
    s_bfe_u32 s15, s20, 262160
    s_or_b32 s51, s51, s15
    s_branch L_p2_pub
L_p2_notlast:
    s_cmp_lg_u32 s21, 0
    s_cselect_b32 s51, 0, s51
    s_cbranch_scc1 L_p2_pub
L_p2_poll:
    v_mov_b32 v9, 0
    s_lshl_b32 s14, s3, 8
    s_add_u32 s14, s14, 8523776
    s_mov_b64 exec, 1
    buffer_atomic_add v9, off, s[4:7], s14 sc0
    s_mov_b64 exec, -1
    s_waitcnt vmcnt(0)
    v_readfirstlane_b32 s20, v9
    s_nop 0
    s_and_b32 s15, s20, 0xff
    s_cmp_lt_u32 s15, 4
    s_cbranch_scc1 L_p2_poll
L_p2_pub:
    s_lshl_b32 s15, s51, 24
    s_or_b32 s15, s15, s20
    v_mov_b32 v9, s15
    s_mov_b64 exec, 1
    ds_write_b32 v8, v9
    s_mov_b64 exec, -1
    s_waitcnt lgkmcnt(0)
L_p2_nosig:
    s_barrier
    ds_read_b32 v9, v8
    s_waitcnt lgkmcnt(0)
    v_readfirstlane_b32 s20, v9
    s_nop 0
    s_lshr_b32 s51, s20, 24
    s_cbranch_scc0 L_p2_end
L_p2_fin:
    s_mul_i32 s24, s49, 19968
    s_add_u32 s14, s12, 1
    s_and_b32 s14, s14, 3
    s_mul_i32 s15, s14, 5120000
    s_add_u32 s15, s15, 228589568
    s_add_u32 s15, s15, s26
    buffer_load_dwordx4 v[12:15], v1, s[4:7], s15 offen sc1
    buffer_load_dwordx4 v[92:95], v2, s[4:7], s15 offen sc1
    s_add_u32 s14, s12, 2
    s_and_b32 s14, s14, 3
    s_mul_i32 s15, s14, 5120000
    s_add_u32 s15, s15, 228589568
    s_add_u32 s15, s15, s26
    buffer_load_dwordx4 v[16:19], v1, s[4:7], s15 offen sc1
    buffer_load_dwordx4 v[96:99], v2, s[4:7], s15 offen sc1
    s_add_u32 s14, s12, 3
    s_and_b32 s14, s14, 3
    s_mul_i32 s15, s14, 5120000
    s_add_u32 s15, s15, 228589568
    s_add_u32 s15, s15, s26
    buffer_load_dwordx4 v[20:23], v1, s[4:7], s15 offen sc1
    buffer_load_dwordx4 v[100:103], v2, s[4:7], s15 offen sc1
    v_add_u32 v24, s24, v1
    ds_read_b128 v[8:11], v24
    v_add_u32 v25, s24, v2
    ds_read_b128 v[88:91], v25
    s_waitcnt vmcnt(0) lgkmcnt(0)
    s_bfe_u32 s14, s20, 262164
    s_cbranch_scc0 L_p2_kernel_nof32a_10
    s_add_u32 s14, s12, 0
    s_and_b32 s14, s14, 3
    s_add_u32 s14, s14, 20
    s_bitcmp1_b32 s20, s14
    s_cbranch_scc0 L_p2_kernel_q_11
    v_mov_b32 v8, 1073758208
    v_mov_b32 v9, 1073758208
    v_mov_b32 v10, 1073758208
    v_mov_b32 v11, 1073758208
L_p2_kernel_q_11:
    s_add_u32 s14, s12, 1
    s_and_b32 s14, s14, 3
    s_add_u32 s14, s14, 20
    s_bitcmp1_b32 s20, s14
    s_cbranch_scc0 L_p2_kernel_q_12
    v_mov_b32 v12, 1073758208
    v_mov_b32 v13, 1073758208
    v_mov_b32 v14, 1073758208
    v_mov_b32 v15, 1073758208
L_p2_kernel_q_12:
    s_add_u32 s14, s12, 2
    s_and_b32 s14, s14, 3
    s_add_u32 s14, s14, 20
    s_bitcmp1_b32 s20, s14
    s_cbranch_scc0 L_p2_kernel_q_13
    v_mov_b32 v16, 1073758208
    v_mov_b32 v17, 1073758208
    v_mov_b32 v18, 1073758208
    v_mov_b32 v19, 1073758208
L_p2_kernel_q_13:
    s_add_u32 s14, s12, 3
    s_and_b32 s14, s14, 3
    s_add_u32 s14, s14, 20
    s_bitcmp1_b32 s20, s14
    s_cbranch_scc0 L_p2_kernel_q_14
    v_mov_b32 v20, 1073758208
    v_mov_b32 v21, 1073758208
    v_mov_b32 v22, 1073758208
    v_mov_b32 v23, 1073758208
L_p2_kernel_q_14:
L_p2_kernel_nof32a_10:
    v_pk_add_u16 v8, v8, v12
    v_pk_add_u16 v16, v16, v20
    v_pk_add_u16 v9, v9, v13
    v_pk_add_u16 v17, v17, v21
    v_pk_add_u16 v10, v10, v14
    v_pk_add_u16 v18, v18, v22
    v_pk_add_u16 v11, v11, v15
    v_pk_add_u16 v19, v19, v23
    v_add_u32_sdwa v24, v8, v16 dst_sel:DWORD dst_unused:UNUSED_PAD src0_sel:WORD_0 src1_sel:WORD_0
    v_add_u32_sdwa v25, v10, v18 dst_sel:DWORD dst_unused:UNUSED_PAD src0_sel:WORD_0 src1_sel:WORD_0
    v_add_u32_sdwa v26, v8, v16 dst_sel:DWORD dst_unused:UNUSED_PAD src0_sel:WORD_1 src1_sel:WORD_1
    v_add_u32_sdwa v27, v10, v18 dst_sel:DWORD dst_unused:UNUSED_PAD src0_sel:WORD_1 src1_sel:WORD_1
    v_add_u32_sdwa v28, v9, v17 dst_sel:DWORD dst_unused:UNUSED_PAD src0_sel:WORD_0 src1_sel:WORD_0
    v_add_u32_sdwa v29, v11, v19 dst_sel:DWORD dst_unused:UNUSED_PAD src0_sel:WORD_0 src1_sel:WORD_0
    v_add_u32_sdwa v30, v9, v17 dst_sel:DWORD dst_unused:UNUSED_PAD src0_sel:WORD_1 src1_sel:WORD_1
    v_add_u32_sdwa v31, v11, v19 dst_sel:DWORD dst_unused:UNUSED_PAD src0_sel:WORD_1 src1_sel:WORD_1
    v_cvt_f32_u32 v24, v24
    v_cvt_f32_u32 v25, v25
    v_cvt_f32_u32 v26, v26
    v_cvt_f32_u32 v27, v27
    v_cvt_f32_u32 v28, v28
    v_cvt_f32_u32 v29, v29
    v_cvt_f32_u32 v30, v30
    v_cvt_f32_u32 v31, v31
    v_pk_fma_f32 v[24:25], v[24:25], s[44:45], s[44:45] op_sel:[0,0,1] op_sel_hi:[1,0,1]
    v_pk_fma_f32 v[26:27], v[26:27], s[44:45], s[44:45] op_sel:[0,0,1] op_sel_hi:[1,0,1]
    v_pk_fma_f32 v[28:29], v[28:29], s[44:45], s[44:45] op_sel:[0,0,1] op_sel_hi:[1,0,1]
    v_pk_fma_f32 v[30:31], v[30:31], s[44:45], s[44:45] op_sel:[0,0,1] op_sel_hi:[1,0,1]
    s_bfe_u32 s14, s20, 262164
    s_cbranch_scc0 L_p2_kernel_nof32b_15
    v_lshlrev_b32 v32, 1, v1
    s_bitcmp1_b32 s20, 20
    s_cbranch_scc0 L_p2_kernel_q_16
    s_lshl_b32 s15, s26, 1
    s_add_u32 s15, s15, 249069568
    buffer_load_dwordx4 v[8:11], v32, s[4:7], s15 offen sc1
    buffer_load_dwordx4 v[12:15], v32, s[4:7], s15 offen offset:16 sc1
    s_waitcnt vmcnt(0)
    v_add_f32 v24, v24, v8
    v_add_f32 v25, v25, v12
    v_add_f32 v26, v26, v9
    v_add_f32 v27, v27, v13
    v_add_f32 v28, v28, v10
    v_add_f32 v29, v29, v14
    v_add_f32 v30, v30, v11
    v_add_f32 v31, v31, v15
L_p2_kernel_q_16:
    s_bitcmp1_b32 s20, 21
    s_cbranch_scc0 L_p2_kernel_q_17
    s_lshl_b32 s15, s26, 1
    s_add_u32 s15, s15, 259309568
    buffer_load_dwordx4 v[8:11], v32, s[4:7], s15 offen sc1
    buffer_load_dwordx4 v[12:15], v32, s[4:7], s15 offen offset:16 sc1
    s_waitcnt vmcnt(0)
    v_add_f32 v24, v24, v8
    v_add_f32 v25, v25, v12
    v_add_f32 v26, v26, v9
    v_add_f32 v27, v27, v13
    v_add_f32 v28, v28, v10
    v_add_f32 v29, v29, v14
    v_add_f32 v30, v30, v11
    v_add_f32 v31, v31, v15
L_p2_kernel_q_17:
    s_bitcmp1_b32 s20, 22
    s_cbranch_scc0 L_p2_kernel_q_18
    s_lshl_b32 s15, s26, 1
    s_add_u32 s15, s15, 269549568
    buffer_load_dwordx4 v[8:11], v32, s[4:7], s15 offen sc1
    buffer_load_dwordx4 v[12:15], v32, s[4:7], s15 offen offset:16 sc1
    s_waitcnt vmcnt(0)
    v_add_f32 v24, v24, v8
    v_add_f32 v25, v25, v12
    v_add_f32 v26, v26, v9
    v_add_f32 v27, v27, v13
    v_add_f32 v28, v28, v10
    v_add_f32 v29, v29, v14
    v_add_f32 v30, v30, v11
    v_add_f32 v31, v31, v15
L_p2_kernel_q_18:
    s_bitcmp1_b32 s20, 23
    s_cbranch_scc0 L_p2_kernel_q_19
    s_lshl_b32 s15, s26, 1
    s_add_u32 s15, s15, 279789568
    buffer_load_dwordx4 v[8:11], v32, s[4:7], s15 offen sc1
    buffer_load_dwordx4 v[12:15], v32, s[4:7], s15 offen offset:16 sc1
    s_waitcnt vmcnt(0)
    v_add_f32 v24, v24, v8
    v_add_f32 v25, v25, v12
    v_add_f32 v26, v26, v9
    v_add_f32 v27, v27, v13
    v_add_f32 v28, v28, v10
    v_add_f32 v29, v29, v14
    v_add_f32 v30, v30, v11
    v_add_f32 v31, v31, v15
L_p2_kernel_q_19:
L_p2_kernel_nof32b_15:
    v_pk_mul_f32 v[8:9], v[24:25], s[84:85] op_sel:[0,0] op_sel_hi:[1,0]
    v_pk_mul_f32 v[10:11], v[24:25], s[84:85] op_sel:[0,1] op_sel_hi:[1,1]
    v_pk_mul_f32 v[12:13], v[24:25], s[86:87] op_sel:[0,0] op_sel_hi:[1,0]
    v_pk_mul_f32 v[14:15], v[24:25], s[86:87] op_sel:[0,1] op_sel_hi:[1,1]
    v_pk_fma_f32 v[8:9], v[26:27], s[88:89], v[8:9] op_sel:[0,0,0] op_sel_hi:[1,0,1]
    v_pk_fma_f32 v[10:11], v[26:27], s[88:89], v[10:11] op_sel:[0,1,0] op_sel_hi:[1,1,1]
    v_pk_fma_f32 v[12:13], v[26:27], s[90:91], v[12:13] op_sel:[0,0,0] op_sel_hi:[1,0,1]
    v_pk_fma_f32 v[14:15], v[26:27], s[90:91], v[14:15] op_sel:[0,1,0] op_sel_hi:[1,1,1]
    v_pk_fma_f32 v[8:9], v[28:29], s[92:93], v[8:9] op_sel:[0,0,0] op_sel_hi:[1,0,1]
    v_pk_fma_f32 v[10:11], v[28:29], s[92:93], v[10:11] op_sel:[0,1,0] op_sel_hi:[1,1,1]
    v_pk_fma_f32 v[12:13], v[28:29], s[94:95], v[12:13] op_sel:[0,0,0] op_sel_hi:[1,0,1]
    v_pk_fma_f32 v[14:15], v[28:29], s[94:95], v[14:15] op_sel:[0,1,0] op_sel_hi:[1,1,1]
    v_pk_fma_f32 v[8:9], v[30:31], s[96:97], v[8:9] op_sel:[0,0,0] op_sel_hi:[1,0,1]
    v_pk_fma_f32 v[10:11], v[30:31], s[96:97], v[10:11] op_sel:[0,1,0] op_sel_hi:[1,1,1]
    v_pk_fma_f32 v[12:13], v[30:31], s[98:99], v[12:13] op_sel:[0,0,0] op_sel_hi:[1,0,1]
    v_pk_fma_f32 v[14:15], v[30:31], s[98:99], v[14:15] op_sel:[0,1,0] op_sel_hi:[1,1,1]
    v_pk_mul_f32 v[8:9], v[8:9], v[72:73]
    v_pk_mul_f32 v[10:11], v[10:11], v[74:75]
    v_pk_mul_f32 v[12:13], v[12:13], v[76:77]
    v_pk_mul_f32 v[14:15], v[14:15], v[78:79]
    v_pk_mul_f32 v[24:25], v[8:9], s[28:29] op_sel:[0,0] op_sel_hi:[1,0]
    v_pk_mul_f32 v[26:27], v[8:9], s[28:29] op_sel:[0,1] op_sel_hi:[1,1]
    v_pk_mul_f32 v[28:29], v[8:9], s[30:31] op_sel:[0,0] op_sel_hi:[1,0]
    v_pk_mul_f32 v[30:31], v[8:9], s[30:31] op_sel:[0,1] op_sel_hi:[1,1]
    v_pk_fma_f32 v[24:25], v[10:11], s[32:33], v[24:25] op_sel:[0,0,0] op_sel_hi:[1,0,1]
    v_pk_fma_f32 v[26:27], v[10:11], s[32:33], v[26:27] op_sel:[0,1,0] op_sel_hi:[1,1,1]
    v_pk_fma_f32 v[28:29], v[10:11], s[34:35], v[28:29] op_sel:[0,0,0] op_sel_hi:[1,0,1]
    v_pk_fma_f32 v[30:31], v[10:11], s[34:35], v[30:31] op_sel:[0,1,0] op_sel_hi:[1,1,1]
    v_pk_fma_f32 v[24:25], v[12:13], s[36:37], v[24:25] op_sel:[0,0,0] op_sel_hi:[1,0,1]
    v_pk_fma_f32 v[26:27], v[12:13], s[36:37], v[26:27] op_sel:[0,1,0] op_sel_hi:[1,1,1]
    v_pk_fma_f32 v[28:29], v[12:13], s[38:39], v[28:29] op_sel:[0,0,0] op_sel_hi:[1,0,1]
    v_pk_fma_f32 v[30:31], v[12:13], s[38:39], v[30:31] op_sel:[0,1,0] op_sel_hi:[1,1,1]
    v_pk_fma_f32 v[24:25], v[14:15], s[40:41], v[24:25] op_sel:[0,0,0] op_sel_hi:[1,0,1]
    v_pk_fma_f32 v[26:27], v[14:15], s[40:41], v[26:27] op_sel:[0,1,0] op_sel_hi:[1,1,1]
    v_pk_fma_f32 v[28:29], v[14:15], s[42:43], v[28:29] op_sel:[0,0,0] op_sel_hi:[1,0,1]
    v_pk_fma_f32 v[30:31], v[14:15], s[42:43], v[30:31] op_sel:[0,1,0] op_sel_hi:[1,1,1]
    v_lshlrev_b32 v8, 16, v64
    v_and_b32 v10, 0xffff0000, v64
    v_lshlrev_b32 v12, 16, v65
    v_and_b32 v14, 0xffff0000, v65
    v_lshlrev_b32 v9, 16, v66
    v_and_b32 v11, 0xffff0000, v66
    v_lshlrev_b32 v13, 16, v67
    v_and_b32 v15, 0xffff0000, v67
    v_pk_fma_f32 v[8:9], v[24:25], v[80:81], v[8:9]
    v_pk_fma_f32 v[10:11], v[26:27], v[82:83], v[10:11]
    v_pk_fma_f32 v[12:13], v[28:29], v[84:85], v[12:13]
    v_pk_fma_f32 v[14:15], v[30:31], v[86:87], v[14:15]
    v_cvt_pk_bf16_f32 v16, v8, v10
    v_cvt_pk_bf16_f32 v17, v12, v14
    v_cvt_pk_bf16_f32 v18, v9, v11
    v_cvt_pk_bf16_f32 v19, v13, v15
    buffer_store_dwordx4 v[16:19], v1, s[16:19], s26 offen
    s_cmp_ge_u32 s13, 4
    s_cbranch_scc1 L_p2_f1
    s_bfe_u32 s14, s20, 262164
    s_cbranch_scc0 L_p2_kernel_nof32a_20
    s_add_u32 s14, s12, 0
    s_and_b32 s14, s14, 3
    s_add_u32 s14, s14, 20
    s_bitcmp1_b32 s20, s14
    s_cbranch_scc0 L_p2_kernel_q_21
    v_mov_b32 v88, 1073758208
    v_mov_b32 v89, 1073758208
    v_mov_b32 v90, 1073758208
    v_mov_b32 v91, 1073758208
L_p2_kernel_q_21:
    s_add_u32 s14, s12, 1
    s_and_b32 s14, s14, 3
    s_add_u32 s14, s14, 20
    s_bitcmp1_b32 s20, s14
    s_cbranch_scc0 L_p2_kernel_q_22
    v_mov_b32 v92, 1073758208
    v_mov_b32 v93, 1073758208
    v_mov_b32 v94, 1073758208
    v_mov_b32 v95, 1073758208
L_p2_kernel_q_22:
    s_add_u32 s14, s12, 2
    s_and_b32 s14, s14, 3
    s_add_u32 s14, s14, 20
    s_bitcmp1_b32 s20, s14
    s_cbranch_scc0 L_p2_kernel_q_23
    v_mov_b32 v96, 1073758208
    v_mov_b32 v97, 1073758208
    v_mov_b32 v98, 1073758208
    v_mov_b32 v99, 1073758208
L_p2_kernel_q_23:
    s_add_u32 s14, s12, 3
    s_and_b32 s14, s14, 3
    s_add_u32 s14, s14, 20
    s_bitcmp1_b32 s20, s14
    s_cbranch_scc0 L_p2_kernel_q_24
    v_mov_b32 v100, 1073758208
    v_mov_b32 v101, 1073758208
    v_mov_b32 v102, 1073758208
    v_mov_b32 v103, 1073758208
L_p2_kernel_q_24:
L_p2_kernel_nof32a_20:
    v_pk_add_u16 v88, v88, v92
    v_pk_add_u16 v96, v96, v100
    v_pk_add_u16 v89, v89, v93
    v_pk_add_u16 v97, v97, v101
    v_pk_add_u16 v90, v90, v94
    v_pk_add_u16 v98, v98, v102
    v_pk_add_u16 v91, v91, v95
    v_pk_add_u16 v99, v99, v103
    v_add_u32_sdwa v24, v88, v96 dst_sel:DWORD dst_unused:UNUSED_PAD src0_sel:WORD_0 src1_sel:WORD_0
    v_add_u32_sdwa v25, v90, v98 dst_sel:DWORD dst_unused:UNUSED_PAD src0_sel:WORD_0 src1_sel:WORD_0
    v_add_u32_sdwa v26, v88, v96 dst_sel:DWORD dst_unused:UNUSED_PAD src0_sel:WORD_1 src1_sel:WORD_1
    v_add_u32_sdwa v27, v90, v98 dst_sel:DWORD dst_unused:UNUSED_PAD src0_sel:WORD_1 src1_sel:WORD_1
    v_add_u32_sdwa v28, v89, v97 dst_sel:DWORD dst_unused:UNUSED_PAD src0_sel:WORD_0 src1_sel:WORD_0
    v_add_u32_sdwa v29, v91, v99 dst_sel:DWORD dst_unused:UNUSED_PAD src0_sel:WORD_0 src1_sel:WORD_0
    v_add_u32_sdwa v30, v89, v97 dst_sel:DWORD dst_unused:UNUSED_PAD src0_sel:WORD_1 src1_sel:WORD_1
    v_add_u32_sdwa v31, v91, v99 dst_sel:DWORD dst_unused:UNUSED_PAD src0_sel:WORD_1 src1_sel:WORD_1
    v_cvt_f32_u32 v24, v24
    v_cvt_f32_u32 v25, v25
    v_cvt_f32_u32 v26, v26
    v_cvt_f32_u32 v27, v27
    v_cvt_f32_u32 v28, v28
    v_cvt_f32_u32 v29, v29
    v_cvt_f32_u32 v30, v30
    v_cvt_f32_u32 v31, v31
    v_pk_fma_f32 v[24:25], v[24:25], s[44:45], s[44:45] op_sel:[0,0,1] op_sel_hi:[1,0,1]
    v_pk_fma_f32 v[26:27], v[26:27], s[44:45], s[44:45] op_sel:[0,0,1] op_sel_hi:[1,0,1]
    v_pk_fma_f32 v[28:29], v[28:29], s[44:45], s[44:45] op_sel:[0,0,1] op_sel_hi:[1,0,1]
    v_pk_fma_f32 v[30:31], v[30:31], s[44:45], s[44:45] op_sel:[0,0,1] op_sel_hi:[1,0,1]
    s_bfe_u32 s14, s20, 262164
    s_cbranch_scc0 L_p2_kernel_nof32b_25
    v_lshlrev_b32 v32, 1, v2
    s_bitcmp1_b32 s20, 20
    s_cbranch_scc0 L_p2_kernel_q_26
    s_lshl_b32 s15, s26, 1
    s_add_u32 s15, s15, 249069568
    buffer_load_dwordx4 v[88:91], v32, s[4:7], s15 offen sc1
    buffer_load_dwordx4 v[92:95], v32, s[4:7], s15 offen offset:16 sc1
    s_waitcnt vmcnt(0)
    v_add_f32 v24, v24, v88
    v_add_f32 v25, v25, v92
    v_add_f32 v26, v26, v89
    v_add_f32 v27, v27, v93
    v_add_f32 v28, v28, v90
    v_add_f32 v29, v29, v94
    v_add_f32 v30, v30, v91
    v_add_f32 v31, v31, v95
L_p2_kernel_q_26:
    s_bitcmp1_b32 s20, 21
    s_cbranch_scc0 L_p2_kernel_q_27
    s_lshl_b32 s15, s26, 1
    s_add_u32 s15, s15, 259309568
    buffer_load_dwordx4 v[88:91], v32, s[4:7], s15 offen sc1
    buffer_load_dwordx4 v[92:95], v32, s[4:7], s15 offen offset:16 sc1
    s_waitcnt vmcnt(0)
    v_add_f32 v24, v24, v88
    v_add_f32 v25, v25, v92
    v_add_f32 v26, v26, v89
    v_add_f32 v27, v27, v93
    v_add_f32 v28, v28, v90
    v_add_f32 v29, v29, v94
    v_add_f32 v30, v30, v91
    v_add_f32 v31, v31, v95
L_p2_kernel_q_27:
    s_bitcmp1_b32 s20, 22
    s_cbranch_scc0 L_p2_kernel_q_28
    s_lshl_b32 s15, s26, 1
    s_add_u32 s15, s15, 269549568
    buffer_load_dwordx4 v[88:91], v32, s[4:7], s15 offen sc1
    buffer_load_dwordx4 v[92:95], v32, s[4:7], s15 offen offset:16 sc1
    s_waitcnt vmcnt(0)
    v_add_f32 v24, v24, v88
    v_add_f32 v25, v25, v92
    v_add_f32 v26, v26, v89
    v_add_f32 v27, v27, v93
    v_add_f32 v28, v28, v90
    v_add_f32 v29, v29, v94
    v_add_f32 v30, v30, v91
    v_add_f32 v31, v31, v95
L_p2_kernel_q_28:
    s_bitcmp1_b32 s20, 23
    s_cbranch_scc0 L_p2_kernel_q_29
    s_lshl_b32 s15, s26, 1
    s_add_u32 s15, s15, 279789568
    buffer_load_dwordx4 v[88:91], v32, s[4:7], s15 offen sc1
    buffer_load_dwordx4 v[92:95], v32, s[4:7], s15 offen offset:16 sc1
    s_waitcnt vmcnt(0)
    v_add_f32 v24, v24, v88
    v_add_f32 v25, v25, v92
    v_add_f32 v26, v26, v89
    v_add_f32 v27, v27, v93
    v_add_f32 v28, v28, v90
    v_add_f32 v29, v29, v94
    v_add_f32 v30, v30, v91
    v_add_f32 v31, v31, v95
L_p2_kernel_q_29:
L_p2_kernel_nof32b_25:
    v_pk_mul_f32 v[88:89], v[24:25], s[84:85] op_sel:[0,0] op_sel_hi:[1,0]
    v_pk_mul_f32 v[90:91], v[24:25], s[84:85] op_sel:[0,1] op_sel_hi:[1,1]
    v_pk_mul_f32 v[92:93], v[24:25], s[86:87] op_sel:[0,0] op_sel_hi:[1,0]
    v_pk_mul_f32 v[94:95], v[24:25], s[86:87] op_sel:[0,1] op_sel_hi:[1,1]
    v_pk_fma_f32 v[88:89], v[26:27], s[88:89], v[88:89] op_sel:[0,0,0] op_sel_hi:[1,0,1]
    v_pk_fma_f32 v[90:91], v[26:27], s[88:89], v[90:91] op_sel:[0,1,0] op_sel_hi:[1,1,1]
    v_pk_fma_f32 v[92:93], v[26:27], s[90:91], v[92:93] op_sel:[0,0,0] op_sel_hi:[1,0,1]
    v_pk_fma_f32 v[94:95], v[26:27], s[90:91], v[94:95] op_sel:[0,1,0] op_sel_hi:[1,1,1]
    v_pk_fma_f32 v[88:89], v[28:29], s[92:93], v[88:89] op_sel:[0,0,0] op_sel_hi:[1,0,1]
    v_pk_fma_f32 v[90:91], v[28:29], s[92:93], v[90:91] op_sel:[0,1,0] op_sel_hi:[1,1,1]
    v_pk_fma_f32 v[92:93], v[28:29], s[94:95], v[92:93] op_sel:[0,0,0] op_sel_hi:[1,0,1]
    v_pk_fma_f32 v[94:95], v[28:29], s[94:95], v[94:95] op_sel:[0,1,0] op_sel_hi:[1,1,1]
    v_pk_fma_f32 v[88:89], v[30:31], s[96:97], v[88:89] op_sel:[0,0,0] op_sel_hi:[1,0,1]
    v_pk_fma_f32 v[90:91], v[30:31], s[96:97], v[90:91] op_sel:[0,1,0] op_sel_hi:[1,1,1]
    v_pk_fma_f32 v[92:93], v[30:31], s[98:99], v[92:93] op_sel:[0,0,0] op_sel_hi:[1,0,1]
    v_pk_fma_f32 v[94:95], v[30:31], s[98:99], v[94:95] op_sel:[0,1,0] op_sel_hi:[1,1,1]
    v_pk_mul_f32 v[88:89], v[88:89], v[112:113]
    v_pk_mul_f32 v[90:91], v[90:91], v[114:115]
    v_pk_mul_f32 v[92:93], v[92:93], v[116:117]
    v_pk_mul_f32 v[94:95], v[94:95], v[118:119]
    v_pk_mul_f32 v[24:25], v[88:89], s[28:29] op_sel:[0,0] op_sel_hi:[1,0]
    v_pk_mul_f32 v[26:27], v[88:89], s[28:29] op_sel:[0,1] op_sel_hi:[1,1]
    v_pk_mul_f32 v[28:29], v[88:89], s[30:31] op_sel:[0,0] op_sel_hi:[1,0]
    v_pk_mul_f32 v[30:31], v[88:89], s[30:31] op_sel:[0,1] op_sel_hi:[1,1]
    v_pk_fma_f32 v[24:25], v[90:91], s[32:33], v[24:25] op_sel:[0,0,0] op_sel_hi:[1,0,1]
    v_pk_fma_f32 v[26:27], v[90:91], s[32:33], v[26:27] op_sel:[0,1,0] op_sel_hi:[1,1,1]
    v_pk_fma_f32 v[28:29], v[90:91], s[34:35], v[28:29] op_sel:[0,0,0] op_sel_hi:[1,0,1]
    v_pk_fma_f32 v[30:31], v[90:91], s[34:35], v[30:31] op_sel:[0,1,0] op_sel_hi:[1,1,1]
    v_pk_fma_f32 v[24:25], v[92:93], s[36:37], v[24:25] op_sel:[0,0,0] op_sel_hi:[1,0,1]
    v_pk_fma_f32 v[26:27], v[92:93], s[36:37], v[26:27] op_sel:[0,1,0] op_sel_hi:[1,1,1]
    v_pk_fma_f32 v[28:29], v[92:93], s[38:39], v[28:29] op_sel:[0,0,0] op_sel_hi:[1,0,1]
    v_pk_fma_f32 v[30:31], v[92:93], s[38:39], v[30:31] op_sel:[0,1,0] op_sel_hi:[1,1,1]
    v_pk_fma_f32 v[24:25], v[94:95], s[40:41], v[24:25] op_sel:[0,0,0] op_sel_hi:[1,0,1]
    v_pk_fma_f32 v[26:27], v[94:95], s[40:41], v[26:27] op_sel:[0,1,0] op_sel_hi:[1,1,1]
    v_pk_fma_f32 v[28:29], v[94:95], s[42:43], v[28:29] op_sel:[0,0,0] op_sel_hi:[1,0,1]
    v_pk_fma_f32 v[30:31], v[94:95], s[42:43], v[30:31] op_sel:[0,1,0] op_sel_hi:[1,1,1]
    v_lshlrev_b32 v88, 16, v68
    v_and_b32 v90, 0xffff0000, v68
    v_lshlrev_b32 v92, 16, v69
    v_and_b32 v94, 0xffff0000, v69
    v_lshlrev_b32 v89, 16, v70
    v_and_b32 v91, 0xffff0000, v70
    v_lshlrev_b32 v93, 16, v71
    v_and_b32 v95, 0xffff0000, v71
    v_pk_fma_f32 v[88:89], v[24:25], v[120:121], v[88:89]
    v_pk_fma_f32 v[90:91], v[26:27], v[122:123], v[90:91]
    v_pk_fma_f32 v[92:93], v[28:29], v[124:125], v[92:93]
    v_pk_fma_f32 v[94:95], v[30:31], v[126:127], v[94:95]
    v_cvt_pk_bf16_f32 v96, v88, v90
    v_cvt_pk_bf16_f32 v97, v92, v94
    v_cvt_pk_bf16_f32 v98, v89, v91
    v_cvt_pk_bf16_f32 v99, v93, v95
    buffer_store_dwordx4 v[96:99], v2, s[16:19], s26 offen
L_p2_f1:
    s_bitset0_b32 s51, s49
    s_cmp_eq_u32 s51, 0
    s_cbranch_scc1 L_p2_done
    s_ff1_i32_b32 s49, s51
    s_mul_i32 s14, s3, 20000
    s_mul_i32 s15, s49, 4992
    s_add_u32 s14, s14, s15
    s_add_u32 s15, s14, 4096
    v_min_u32 v61, 231, v0
    v_lshl_add_u32 v60, v0, 2, s14
    v_lshl_add_u32 v61, v61, 2, s15
    global_load_dword v60, v60, s[100:101] nt
    global_load_dword v61, v61, s[100:101] nt
    s_waitcnt vmcnt(0)
    v_lshlrev_b32 v30, 16, v60
    v_and_b32 v31, 0xffff0000, v60
    v_lshlrev_b32 v36, 16, v53
    v_and_b32 v37, 0xffff0000, v53
    v_lshlrev_b32 v38, 16, v54
    v_and_b32 v39, 0xffff0000, v54
    v_lshlrev_b32 v40, 16, v56
    v_and_b32 v41, 0xffff0000, v56
    v_lshlrev_b32 v42, 16, v57
    v_and_b32 v43, 0xffff0000, v57
    v_pk_add_f32 v[14:15], v[30:31], v[36:37] op_sel:[0,0] op_sel_hi:[1,0] neg_lo:[0,1] neg_hi:[0,1]
    v_pk_add_f32 v[16:17], v[30:31], v[36:37] op_sel:[0,1] op_sel_hi:[1,1] neg_lo:[0,1] neg_hi:[0,1]
    v_pk_add_f32 v[18:19], v[30:31], v[38:39] op_sel:[0,0] op_sel_hi:[1,0] neg_lo:[0,1] neg_hi:[0,1]
    v_pk_add_f32 v[20:21], v[30:31], v[38:39] op_sel:[0,1] op_sel_hi:[1,1] neg_lo:[0,1] neg_hi:[0,1]
    v_pk_add_f32 v[22:23], v[30:31], v[40:41] op_sel:[0,0] op_sel_hi:[1,0] neg_lo:[0,1] neg_hi:[0,1]
    v_pk_add_f32 v[24:25], v[30:31], v[40:41] op_sel:[0,1] op_sel_hi:[1,1] neg_lo:[0,1] neg_hi:[0,1]
    v_pk_add_f32 v[26:27], v[30:31], v[42:43] op_sel:[0,0] op_sel_hi:[1,0] neg_lo:[0,1] neg_hi:[0,1]
    v_pk_add_f32 v[28:29], v[30:31], v[42:43] op_sel:[0,1] op_sel_hi:[1,1] neg_lo:[0,1] neg_hi:[0,1]
    v_cvt_pk_bf16_f32 v32, v14, v15
    v_lshlrev_b32 v14, 16, v32
    v_and_b32 v15, 0xffff0000, v32
    v_cvt_pk_bf16_f32 v32, v16, v17
    v_lshlrev_b32 v16, 16, v32
    v_and_b32 v17, 0xffff0000, v32
    v_cvt_pk_bf16_f32 v32, v18, v19
    v_lshlrev_b32 v18, 16, v32
    v_and_b32 v19, 0xffff0000, v32
    v_cvt_pk_bf16_f32 v32, v20, v21
    v_lshlrev_b32 v20, 16, v32
    v_and_b32 v21, 0xffff0000, v32
    v_cvt_pk_bf16_f32 v32, v22, v23
    v_lshlrev_b32 v22, 16, v32
    v_and_b32 v23, 0xffff0000, v32
    v_cvt_pk_bf16_f32 v32, v24, v25
    v_lshlrev_b32 v24, 16, v32
    v_and_b32 v25, 0xffff0000, v32
    v_cvt_pk_bf16_f32 v32, v26, v27
    v_lshlrev_b32 v26, 16, v32
    v_and_b32 v27, 0xffff0000, v32
    v_cvt_pk_bf16_f32 v32, v28, v29
    v_lshlrev_b32 v28, 16, v32
    v_and_b32 v29, 0xffff0000, v32
    v_pk_mul_f32 v[14:15], v[14:15], v[14:15]
    v_pk_mul_f32 v[16:17], v[16:17], v[16:17]
    v_pk_mul_f32 v[18:19], v[18:19], v[18:19]
    v_pk_mul_f32 v[20:21], v[20:21], v[20:21]
    v_pk_mul_f32 v[22:23], v[22:23], v[22:23]
    v_pk_mul_f32 v[24:25], v[24:25], v[24:25]
    v_pk_mul_f32 v[26:27], v[26:27], v[26:27]
    v_pk_mul_f32 v[28:29], v[28:29], v[28:29]
    v_cvt_pk_bf16_f32 v32, v14, v15
    v_lshlrev_b32 v14, 16, v32
    v_and_b32 v15, 0xffff0000, v32
    v_cvt_pk_bf16_f32 v32, v16, v17
    v_lshlrev_b32 v16, 16, v32
    v_and_b32 v17, 0xffff0000, v32
    v_cvt_pk_bf16_f32 v32, v18, v19
    v_lshlrev_b32 v18, 16, v32
    v_and_b32 v19, 0xffff0000, v32
    v_cvt_pk_bf16_f32 v32, v20, v21
    v_lshlrev_b32 v20, 16, v32
    v_and_b32 v21, 0xffff0000, v32
    v_cvt_pk_bf16_f32 v32, v22, v23
    v_lshlrev_b32 v22, 16, v32
    v_and_b32 v23, 0xffff0000, v32
    v_cvt_pk_bf16_f32 v32, v24, v25
    v_lshlrev_b32 v24, 16, v32
    v_and_b32 v25, 0xffff0000, v32
    v_cvt_pk_bf16_f32 v32, v26, v27
    v_lshlrev_b32 v26, 16, v32
    v_and_b32 v27, 0xffff0000, v32
    v_cvt_pk_bf16_f32 v32, v28, v29
    v_lshlrev_b32 v28, 16, v32
    v_and_b32 v29, 0xffff0000, v32
    v_mov_b32 v30, 1092616192
    v_mov_b32 v31, 0x3fb8aa3b
    v_pk_mul_f32 v[14:15], v[14:15], v[30:31] op_sel:[0,0] op_sel_hi:[1,0]
    v_pk_mul_f32 v[16:17], v[16:17], v[30:31] op_sel:[0,0] op_sel_hi:[1,0]
    v_pk_mul_f32 v[18:19], v[18:19], v[30:31] op_sel:[0,0] op_sel_hi:[1,0]
    v_pk_mul_f32 v[20:21], v[20:21], v[30:31] op_sel:[0,0] op_sel_hi:[1,0]
    v_pk_mul_f32 v[22:23], v[22:23], v[30:31] op_sel:[0,0] op_sel_hi:[1,0]
    v_pk_mul_f32 v[24:25], v[24:25], v[30:31] op_sel:[0,0] op_sel_hi:[1,0]
    v_pk_mul_f32 v[26:27], v[26:27], v[30:31] op_sel:[0,0] op_sel_hi:[1,0]
    v_pk_mul_f32 v[28:29], v[28:29], v[30:31] op_sel:[0,0] op_sel_hi:[1,0]
    v_cvt_pk_bf16_f32 v32, v14, v15
    v_lshlrev_b32 v14, 16, v32
    v_and_b32 v15, 0xffff0000, v32
    v_cvt_pk_bf16_f32 v32, v16, v17
    v_lshlrev_b32 v16, 16, v32
    v_and_b32 v17, 0xffff0000, v32
    v_cvt_pk_bf16_f32 v32, v18, v19
    v_lshlrev_b32 v18, 16, v32
    v_and_b32 v19, 0xffff0000, v32
    v_cvt_pk_bf16_f32 v32, v20, v21
    v_lshlrev_b32 v20, 16, v32
    v_and_b32 v21, 0xffff0000, v32
    v_cvt_pk_bf16_f32 v32, v22, v23
    v_lshlrev_b32 v22, 16, v32
    v_and_b32 v23, 0xffff0000, v32
    v_cvt_pk_bf16_f32 v32, v24, v25
    v_lshlrev_b32 v24, 16, v32
    v_and_b32 v25, 0xffff0000, v32
    v_cvt_pk_bf16_f32 v32, v26, v27
    v_lshlrev_b32 v26, 16, v32
    v_and_b32 v27, 0xffff0000, v32
    v_cvt_pk_bf16_f32 v32, v28, v29
    v_lshlrev_b32 v28, 16, v32
    v_and_b32 v29, 0xffff0000, v32
    v_pk_mul_f32 v[14:15], v[14:15], v[30:31] op_sel:[0,1] op_sel_hi:[1,1]
    v_pk_mul_f32 v[16:17], v[16:17], v[30:31] op_sel:[0,1] op_sel_hi:[1,1]
    v_pk_mul_f32 v[18:19], v[18:19], v[30:31] op_sel:[0,1] op_sel_hi:[1,1]
    v_pk_mul_f32 v[20:21], v[20:21], v[30:31] op_sel:[0,1] op_sel_hi:[1,1]
    v_pk_mul_f32 v[22:23], v[22:23], v[30:31] op_sel:[0,1] op_sel_hi:[1,1]
    v_pk_mul_f32 v[24:25], v[24:25], v[30:31] op_sel:[0,1] op_sel_hi:[1,1]
    v_pk_mul_f32 v[26:27], v[26:27], v[30:31] op_sel:[0,1] op_sel_hi:[1,1]
    v_pk_mul_f32 v[28:29], v[28:29], v[30:31] op_sel:[0,1] op_sel_hi:[1,1]
    v_exp_f32 v14, -v14
    v_exp_f32 v15, -v15
    v_exp_f32 v16, -v16
    v_exp_f32 v17, -v17
    v_exp_f32 v18, -v18
    v_exp_f32 v19, -v19
    v_exp_f32 v20, -v20
    v_exp_f32 v21, -v21
    v_exp_f32 v22, -v22
    v_exp_f32 v23, -v23
    v_exp_f32 v24, -v24
    v_exp_f32 v25, -v25
    v_exp_f32 v26, -v26
    v_exp_f32 v27, -v27
    v_exp_f32 v28, -v28
    v_exp_f32 v29, -v29
    v_cvt_pk_bf16_f32 v14, v14, v16
    v_cvt_pk_bf16_f32 v15, v15, v17
    v_cvt_pk_bf16_f32 v18, v18, v20
    v_cvt_pk_bf16_f32 v19, v19, v21
    v_cvt_pk_bf16_f32 v22, v22, v24
    v_cvt_pk_bf16_f32 v23, v23, v25
    v_cvt_pk_bf16_f32 v26, v26, v28
    v_cvt_pk_bf16_f32 v27, v27, v29
    v_dot2_f32_bf16 v72, v14, s68, 0
    v_dot2_f32_bf16 v73, v15, s68, 0
    v_dot2_f32_bf16 v74, v14, s69, 0
    v_dot2_f32_bf16 v75, v15, s69, 0
    v_dot2_f32_bf16 v76, v14, s70, 0
    v_dot2_f32_bf16 v77, v15, s70, 0
    v_dot2_f32_bf16 v78, v14, s71, 0
    v_dot2_f32_bf16 v79, v15, s71, 0
    v_dot2_f32_bf16 v80, v14, s52, 0
    v_dot2_f32_bf16 v81, v15, s52, 0
    v_dot2_f32_bf16 v82, v14, s53, 0
    v_dot2_f32_bf16 v83, v15, s53, 0
    v_dot2_f32_bf16 v84, v14, s54, 0
    v_dot2_f32_bf16 v85, v15, s54, 0
    v_dot2_f32_bf16 v86, v14, s55, 0
    v_dot2_f32_bf16 v87, v15, s55, 0
    v_dot2_f32_bf16 v72, v18, s72, v72
    v_dot2_f32_bf16 v73, v19, s72, v73
    v_dot2_f32_bf16 v74, v18, s73, v74
    v_dot2_f32_bf16 v75, v19, s73, v75
    v_dot2_f32_bf16 v76, v18, s74, v76
    v_dot2_f32_bf16 v77, v19, s74, v77
    v_dot2_f32_bf16 v78, v18, s75, v78
    v_dot2_f32_bf16 v79, v19, s75, v79
    v_dot2_f32_bf16 v80, v18, s56, v80
    v_dot2_f32_bf16 v81, v19, s56, v81
    v_dot2_f32_bf16 v82, v18, s57, v82
    v_dot2_f32_bf16 v83, v19, s57, v83
    v_dot2_f32_bf16 v84, v18, s58, v84
    v_dot2_f32_bf16 v85, v19, s58, v85
    v_dot2_f32_bf16 v86, v18, s59, v86
    v_dot2_f32_bf16 v87, v19, s59, v87
    v_dot2_f32_bf16 v72, v22, s76, v72
    v_dot2_f32_bf16 v73, v23, s76, v73
    v_dot2_f32_bf16 v74, v22, s77, v74
    v_dot2_f32_bf16 v75, v23, s77, v75
    v_dot2_f32_bf16 v76, v22, s78, v76
    v_dot2_f32_bf16 v77, v23, s78, v77
    v_dot2_f32_bf16 v78, v22, s79, v78
    v_dot2_f32_bf16 v79, v23, s79, v79
    v_dot2_f32_bf16 v80, v22, s60, v80
    v_dot2_f32_bf16 v81, v23, s60, v81
    v_dot2_f32_bf16 v82, v22, s61, v82
    v_dot2_f32_bf16 v83, v23, s61, v83
    v_dot2_f32_bf16 v84, v22, s62, v84
    v_dot2_f32_bf16 v85, v23, s62, v85
    v_dot2_f32_bf16 v86, v22, s63, v86
    v_dot2_f32_bf16 v87, v23, s63, v87
    v_dot2_f32_bf16 v72, v26, s80, v72
    v_dot2_f32_bf16 v73, v27, s80, v73
    v_dot2_f32_bf16 v74, v26, s81, v74
    v_dot2_f32_bf16 v75, v27, s81, v75
    v_dot2_f32_bf16 v76, v26, s82, v76
    v_dot2_f32_bf16 v77, v27, s82, v77
    v_dot2_f32_bf16 v78, v26, s83, v78
    v_dot2_f32_bf16 v79, v27, s83, v79
    v_dot2_f32_bf16 v80, v26, s64, v80
    v_dot2_f32_bf16 v81, v27, s64, v81
    v_dot2_f32_bf16 v82, v26, s65, v82
    v_dot2_f32_bf16 v83, v27, s65, v83
    v_dot2_f32_bf16 v84, v26, s66, v84
    v_dot2_f32_bf16 v85, v27, s66, v85
    v_dot2_f32_bf16 v86, v26, s67, v86
    v_dot2_f32_bf16 v87, v27, s67, v87
    s_cmp_ge_u32 s13, 4
    s_cbranch_scc1 L_p2_kernel_g1_30
    v_lshlrev_b32 v30, 16, v61
    v_and_b32 v31, 0xffff0000, v61
    v_pk_add_f32 v[14:15], v[30:31], v[36:37] op_sel:[0,0] op_sel_hi:[1,0] neg_lo:[0,1] neg_hi:[0,1]
    v_pk_add_f32 v[16:17], v[30:31], v[36:37] op_sel:[0,1] op_sel_hi:[1,1] neg_lo:[0,1] neg_hi:[0,1]
    v_pk_add_f32 v[18:19], v[30:31], v[38:39] op_sel:[0,0] op_sel_hi:[1,0] neg_lo:[0,1] neg_hi:[0,1]
    v_pk_add_f32 v[20:21], v[30:31], v[38:39] op_sel:[0,1] op_sel_hi:[1,1] neg_lo:[0,1] neg_hi:[0,1]
    v_pk_add_f32 v[22:23], v[30:31], v[40:41] op_sel:[0,0] op_sel_hi:[1,0] neg_lo:[0,1] neg_hi:[0,1]
    v_pk_add_f32 v[24:25], v[30:31], v[40:41] op_sel:[0,1] op_sel_hi:[1,1] neg_lo:[0,1] neg_hi:[0,1]
    v_pk_add_f32 v[26:27], v[30:31], v[42:43] op_sel:[0,0] op_sel_hi:[1,0] neg_lo:[0,1] neg_hi:[0,1]
    v_pk_add_f32 v[28:29], v[30:31], v[42:43] op_sel:[0,1] op_sel_hi:[1,1] neg_lo:[0,1] neg_hi:[0,1]
    v_cvt_pk_bf16_f32 v32, v14, v15
    v_lshlrev_b32 v14, 16, v32
    v_and_b32 v15, 0xffff0000, v32
    v_cvt_pk_bf16_f32 v32, v16, v17
    v_lshlrev_b32 v16, 16, v32
    v_and_b32 v17, 0xffff0000, v32
    v_cvt_pk_bf16_f32 v32, v18, v19
    v_lshlrev_b32 v18, 16, v32
    v_and_b32 v19, 0xffff0000, v32
    v_cvt_pk_bf16_f32 v32, v20, v21
    v_lshlrev_b32 v20, 16, v32
    v_and_b32 v21, 0xffff0000, v32
    v_cvt_pk_bf16_f32 v32, v22, v23
    v_lshlrev_b32 v22, 16, v32
    v_and_b32 v23, 0xffff0000, v32
    v_cvt_pk_bf16_f32 v32, v24, v25
    v_lshlrev_b32 v24, 16, v32
    v_and_b32 v25, 0xffff0000, v32
    v_cvt_pk_bf16_f32 v32, v26, v27
    v_lshlrev_b32 v26, 16, v32
    v_and_b32 v27, 0xffff0000, v32
    v_cvt_pk_bf16_f32 v32, v28, v29
    v_lshlrev_b32 v28, 16, v32
    v_and_b32 v29, 0xffff0000, v32
    v_pk_mul_f32 v[14:15], v[14:15], v[14:15]
    v_pk_mul_f32 v[16:17], v[16:17], v[16:17]
    v_pk_mul_f32 v[18:19], v[18:19], v[18:19]
    v_pk_mul_f32 v[20:21], v[20:21], v[20:21]
    v_pk_mul_f32 v[22:23], v[22:23], v[22:23]
    v_pk_mul_f32 v[24:25], v[24:25], v[24:25]
    v_pk_mul_f32 v[26:27], v[26:27], v[26:27]
    v_pk_mul_f32 v[28:29], v[28:29], v[28:29]
    v_cvt_pk_bf16_f32 v32, v14, v15
    v_lshlrev_b32 v14, 16, v32
    v_and_b32 v15, 0xffff0000, v32
    v_cvt_pk_bf16_f32 v32, v16, v17
    v_lshlrev_b32 v16, 16, v32
    v_and_b32 v17, 0xffff0000, v32
    v_cvt_pk_bf16_f32 v32, v18, v19
    v_lshlrev_b32 v18, 16, v32
    v_and_b32 v19, 0xffff0000, v32
    v_cvt_pk_bf16_f32 v32, v20, v21
    v_lshlrev_b32 v20, 16, v32
    v_and_b32 v21, 0xffff0000, v32
    v_cvt_pk_bf16_f32 v32, v22, v23
    v_lshlrev_b32 v22, 16, v32
    v_and_b32 v23, 0xffff0000, v32
    v_cvt_pk_bf16_f32 v32, v24, v25
    v_lshlrev_b32 v24, 16, v32
    v_and_b32 v25, 0xffff0000, v32
    v_cvt_pk_bf16_f32 v32, v26, v27
    v_lshlrev_b32 v26, 16, v32
    v_and_b32 v27, 0xffff0000, v32
    v_cvt_pk_bf16_f32 v32, v28, v29
    v_lshlrev_b32 v28, 16, v32
    v_and_b32 v29, 0xffff0000, v32
    v_mov_b32 v30, 1092616192
    v_mov_b32 v31, 0x3fb8aa3b
    v_pk_mul_f32 v[14:15], v[14:15], v[30:31] op_sel:[0,0] op_sel_hi:[1,0]
    v_pk_mul_f32 v[16:17], v[16:17], v[30:31] op_sel:[0,0] op_sel_hi:[1,0]
    v_pk_mul_f32 v[18:19], v[18:19], v[30:31] op_sel:[0,0] op_sel_hi:[1,0]
    v_pk_mul_f32 v[20:21], v[20:21], v[30:31] op_sel:[0,0] op_sel_hi:[1,0]
    v_pk_mul_f32 v[22:23], v[22:23], v[30:31] op_sel:[0,0] op_sel_hi:[1,0]
    v_pk_mul_f32 v[24:25], v[24:25], v[30:31] op_sel:[0,0] op_sel_hi:[1,0]
    v_pk_mul_f32 v[26:27], v[26:27], v[30:31] op_sel:[0,0] op_sel_hi:[1,0]
    v_pk_mul_f32 v[28:29], v[28:29], v[30:31] op_sel:[0,0] op_sel_hi:[1,0]
    v_cvt_pk_bf16_f32 v32, v14, v15
    v_lshlrev_b32 v14, 16, v32
    v_and_b32 v15, 0xffff0000, v32
    v_cvt_pk_bf16_f32 v32, v16, v17
    v_lshlrev_b32 v16, 16, v32
    v_and_b32 v17, 0xffff0000, v32
    v_cvt_pk_bf16_f32 v32, v18, v19
    v_lshlrev_b32 v18, 16, v32
    v_and_b32 v19, 0xffff0000, v32
    v_cvt_pk_bf16_f32 v32, v20, v21
    v_lshlrev_b32 v20, 16, v32
    v_and_b32 v21, 0xffff0000, v32
    v_cvt_pk_bf16_f32 v32, v22, v23
    v_lshlrev_b32 v22, 16, v32
    v_and_b32 v23, 0xffff0000, v32
    v_cvt_pk_bf16_f32 v32, v24, v25
    v_lshlrev_b32 v24, 16, v32
    v_and_b32 v25, 0xffff0000, v32
    v_cvt_pk_bf16_f32 v32, v26, v27
    v_lshlrev_b32 v26, 16, v32
    v_and_b32 v27, 0xffff0000, v32
    v_cvt_pk_bf16_f32 v32, v28, v29
    v_lshlrev_b32 v28, 16, v32
    v_and_b32 v29, 0xffff0000, v32
    v_pk_mul_f32 v[14:15], v[14:15], v[30:31] op_sel:[0,1] op_sel_hi:[1,1]
    v_pk_mul_f32 v[16:17], v[16:17], v[30:31] op_sel:[0,1] op_sel_hi:[1,1]
    v_pk_mul_f32 v[18:19], v[18:19], v[30:31] op_sel:[0,1] op_sel_hi:[1,1]
    v_pk_mul_f32 v[20:21], v[20:21], v[30:31] op_sel:[0,1] op_sel_hi:[1,1]
    v_pk_mul_f32 v[22:23], v[22:23], v[30:31] op_sel:[0,1] op_sel_hi:[1,1]
    v_pk_mul_f32 v[24:25], v[24:25], v[30:31] op_sel:[0,1] op_sel_hi:[1,1]
    v_pk_mul_f32 v[26:27], v[26:27], v[30:31] op_sel:[0,1] op_sel_hi:[1,1]
    v_pk_mul_f32 v[28:29], v[28:29], v[30:31] op_sel:[0,1] op_sel_hi:[1,1]
    v_exp_f32 v14, -v14
    v_exp_f32 v15, -v15
    v_exp_f32 v16, -v16
    v_exp_f32 v17, -v17
    v_exp_f32 v18, -v18
    v_exp_f32 v19, -v19
    v_exp_f32 v20, -v20
    v_exp_f32 v21, -v21
    v_exp_f32 v22, -v22
    v_exp_f32 v23, -v23
    v_exp_f32 v24, -v24
    v_exp_f32 v25, -v25
    v_exp_f32 v26, -v26
    v_exp_f32 v27, -v27
    v_exp_f32 v28, -v28
    v_exp_f32 v29, -v29
    v_cvt_pk_bf16_f32 v14, v14, v16
    v_cvt_pk_bf16_f32 v15, v15, v17
    v_cvt_pk_bf16_f32 v18, v18, v20
    v_cvt_pk_bf16_f32 v19, v19, v21
    v_cvt_pk_bf16_f32 v22, v22, v24
    v_cvt_pk_bf16_f32 v23, v23, v25
    v_cvt_pk_bf16_f32 v26, v26, v28
    v_cvt_pk_bf16_f32 v27, v27, v29
    v_dot2_f32_bf16 v112, v14, s68, 0
    v_dot2_f32_bf16 v113, v15, s68, 0
    v_dot2_f32_bf16 v114, v14, s69, 0
    v_dot2_f32_bf16 v115, v15, s69, 0
    v_dot2_f32_bf16 v116, v14, s70, 0
    v_dot2_f32_bf16 v117, v15, s70, 0
    v_dot2_f32_bf16 v118, v14, s71, 0
    v_dot2_f32_bf16 v119, v15, s71, 0
    v_dot2_f32_bf16 v120, v14, s52, 0
    v_dot2_f32_bf16 v121, v15, s52, 0
    v_dot2_f32_bf16 v122, v14, s53, 0
    v_dot2_f32_bf16 v123, v15, s53, 0
    v_dot2_f32_bf16 v124, v14, s54, 0
    v_dot2_f32_bf16 v125, v15, s54, 0
    v_dot2_f32_bf16 v126, v14, s55, 0
    v_dot2_f32_bf16 v127, v15, s55, 0
    v_dot2_f32_bf16 v112, v18, s72, v112
    v_dot2_f32_bf16 v113, v19, s72, v113
    v_dot2_f32_bf16 v114, v18, s73, v114
    v_dot2_f32_bf16 v115, v19, s73, v115
    v_dot2_f32_bf16 v116, v18, s74, v116
    v_dot2_f32_bf16 v117, v19, s74, v117
    v_dot2_f32_bf16 v118, v18, s75, v118
    v_dot2_f32_bf16 v119, v19, s75, v119
    v_dot2_f32_bf16 v120, v18, s56, v120
    v_dot2_f32_bf16 v121, v19, s56, v121
    v_dot2_f32_bf16 v122, v18, s57, v122
    v_dot2_f32_bf16 v123, v19, s57, v123
    v_dot2_f32_bf16 v124, v18, s58, v124
    v_dot2_f32_bf16 v125, v19, s58, v125
    v_dot2_f32_bf16 v126, v18, s59, v126
    v_dot2_f32_bf16 v127, v19, s59, v127
    v_dot2_f32_bf16 v112, v22, s76, v112
    v_dot2_f32_bf16 v113, v23, s76, v113
    v_dot2_f32_bf16 v114, v22, s77, v114
    v_dot2_f32_bf16 v115, v23, s77, v115
    v_dot2_f32_bf16 v116, v22, s78, v116
    v_dot2_f32_bf16 v117, v23, s78, v117
    v_dot2_f32_bf16 v118, v22, s79, v118
    v_dot2_f32_bf16 v119, v23, s79, v119
    v_dot2_f32_bf16 v120, v22, s60, v120
    v_dot2_f32_bf16 v121, v23, s60, v121
    v_dot2_f32_bf16 v122, v22, s61, v122
    v_dot2_f32_bf16 v123, v23, s61, v123
    v_dot2_f32_bf16 v124, v22, s62, v124
    v_dot2_f32_bf16 v125, v23, s62, v125
    v_dot2_f32_bf16 v126, v22, s63, v126
    v_dot2_f32_bf16 v127, v23, s63, v127
    v_dot2_f32_bf16 v112, v26, s80, v112
    v_dot2_f32_bf16 v113, v27, s80, v113
    v_dot2_f32_bf16 v114, v26, s81, v114
    v_dot2_f32_bf16 v115, v27, s81, v115
    v_dot2_f32_bf16 v116, v26, s82, v116
    v_dot2_f32_bf16 v117, v27, s82, v117
    v_dot2_f32_bf16 v118, v26, s83, v118
    v_dot2_f32_bf16 v119, v27, s83, v119
    v_dot2_f32_bf16 v120, v26, s64, v120
    v_dot2_f32_bf16 v121, v27, s64, v121
    v_dot2_f32_bf16 v122, v26, s65, v122
    v_dot2_f32_bf16 v123, v27, s65, v123
    v_dot2_f32_bf16 v124, v26, s66, v124
    v_dot2_f32_bf16 v125, v27, s66, v125
    v_dot2_f32_bf16 v126, v26, s67, v126
    v_dot2_f32_bf16 v127, v27, s67, v127
L_p2_kernel_g1_30:
    s_cmp_eq_u32 s49, 3
    s_cselect_b32 s15, 8, 0
    s_add_u32 s15, s15, 224
    v_add_u32 v2, 16384, v1
    v_cmp_gt_u32 vcc, s15, v0
    s_mul_i32 s14, s3, 80000
    s_mul_i32 s26, s49, 19968
    s_add_u32 s26, s26, s14
    v_cndmask_b32 v2, 0.5, v2, vcc
    s_mov_b32 s10, 5120000
    buffer_load_dwordx4 v[64:67], v1, s[8:11], s26 offen
    buffer_load_dwordx4 v[68:71], v2, s[8:11], s26 offen
    s_branch L_p2_fin
L_p2_done:
    s_branch L_p2_end
L_p2_slow:
    s_barrier
    v_mov_b32 v8, 0
    v_mov_b32 v9, 0
    v_mov_b32 v10, 0
    v_mov_b32 v11, 0
    v_mov_b32 v12, v1
    ds_write_b128 v12, v[8:11]
    v_add_u32 v12, 16384, v12
    ds_write_b128 v12, v[8:11]
    v_add_u32 v12, 16384, v12
    ds_write_b128 v12, v[8:11]
    v_add_u32 v12, 16384, v12
    ds_write_b128 v12, v[8:11]
    v_add_u32 v12, 16384, v12
    ds_write_b128 v12, v[8:11]
    v_add_u32 v12, 16384, v12
    ds_write_b128 v12, v[8:11]
    v_add_u32 v12, 16384, v12
    ds_write_b128 v12, v[8:11]
    v_add_u32 v12, 16384, v12
    ds_write_b128 v12, v[8:11]
    v_add_u32 v12, 16384, v12
    ds_write_b128 v12, v[8:11]
    v_add_u32 v12, 16384, v12
    ds_write_b128 v12, v[8:11]
    v_add_u32 v12, 16384, v12
    v_mul_u32_u24 v13, 8320, v0
    v_mov_b32 v29, 0x7fc00000
    v_add_u32 v28, 32, v13
    v_lshlrev_b32 v14, 10, v0
    v_add_u32 v14, 9437184, v14
    s_mul_i32 s25, s12, 65
    s_add_u32 s25, s25, s3
    s_lshl_b32 s25, s25, 5
    s_add_u32 s25, s25, 0
    s_lshl_b32 s50, s50, 1
    s_mul_i32 s22, s12, 1280000
    s_mov_b32 s24, 0
    s_waitcnt lgkmcnt(0)
    s_barrier
L_p2_sstep:
    buffer_load_ushort v15, v13, s[4:7], s25 offen
    buffer_load_ushort v16, v28, s[4:7], s25 offen
    s_waitcnt vmcnt(0)
L_p2_srec:
    v_cmp_lt_u32 vcc, v15, v16
    s_nop 1
    s_and_b64 exec, exec, vcc
    s_cbranch_execz L_p2_sdone
    v_mul_u32_u24 v17, 43691, v15
    v_lshrrev_b32 v17, 17, v17
    v_mad_i32_i24 v18, v17, -3, v15
    v_lshrrev_b32 v19, 6, v17
    v_lshl_add_u32 v19, v19, 20, v14
    v_and_b32 v17, 63, v17
    v_lshl_add_u32 v17, v17, 4, v19
    v_lshl_add_u32 v19, v18, 2, v17
    buffer_load_dword v20, v19, s[4:7], 0 offen
    buffer_load_dword v21, v17, s[4:7], 0 offen offset:12
    v_add_u32 v15, 1, v15
    v_mad_u32_u24 v18, v18, 10, 2
    s_waitcnt vmcnt(0)
    v_and_b32 v19, 0x3fff, v20
    v_lshlrev_b32 v19, 3, v19
    buffer_load_dwordx2 v[22:23], v19, s[8:11], s22 offen
    v_mad_u32_u16 v20, v20, 16, s50 op_sel:[1,0,0,0]
    v_bfe_i32 v21, v21, v18, 10
    v_cmp_eq_i32 vcc, -512, v21
    v_cvt_f32_i32 v21, v21
    v_mul_f32 v21, 989872160, v21
    v_cndmask_b32 v21, v21, v29, vcc
    s_waitcnt vmcnt(0)
    v_lshlrev_b32 v24, 16, v22
    v_and_b32 v25, 0xffff0000, v22
    v_lshlrev_b32 v26, 16, v23
    v_and_b32 v27, 0xffff0000, v23
    v_mul_f32 v24, v21, v24
    v_mul_f32 v25, v21, v25
    v_mul_f32 v26, v21, v26
    v_mul_f32 v27, v21, v27
    ds_add_f32 v20, v24
    ds_add_f32 v20, v25 offset:4
    ds_add_f32 v20, v26 offset:8
    ds_add_f32 v20, v27 offset:12
    s_branch L_p2_srec
L_p2_sdone:
    s_mov_b64 exec, -1
    s_add_u32 s25, s25, 2
    s_add_u32 s22, s22, 80000
    s_add_u32 s24, s24, 1
    s_cmp_lt_u32 s24, 16
    s_cbranch_scc1 L_p2_sstep
    s_waitcnt lgkmcnt(0)
    s_barrier
    s_mul_i32 s14, s12, 10240000
    s_mul_i32 s15, s3, 160000
    s_add_u32 s26, s14, s15
    s_add_u32 s26, s26, 249069568
    v_mov_b32 v12, v1
    s_mov_b32 s24, 0
L_p2_sout:
    v_cmp_gt_u32 vcc, 160000, v12
    ds_read_b128 v[8:11], v12
    s_nop 0
    s_and_b64 exec, exec, vcc
    s_cbranch_execz L_p2_sfin
    s_waitcnt lgkmcnt(0)
    buffer_store_dwordx4 v[8:11], v12, s[4:7], s26 offen sc1
    s_waitcnt vmcnt(0)
    v_add_u32 v12, 16384, v12
    s_branch L_p2_sout
L_p2_sfin:
    s_mov_b64 exec, -1
    s_waitcnt vmcnt(0) lgkmcnt(0)
    s_barrier
    s_branch L_p2_signal
L_p2_end:
    s_endpgm
.section .rodata,"a"
.p2align 6
.amdhsa_kernel p1_kernel
  .amdhsa_next_free_vgpr 128
  .amdhsa_next_free_sgpr 96
  .amdhsa_accum_offset 128
  .amdhsa_group_segment_fixed_size 0
  .amdhsa_kernarg_size 112
  .amdhsa_user_sgpr_count 2
  .amdhsa_user_sgpr_kernarg_segment_ptr 1
  .amdhsa_system_sgpr_workgroup_id_x 1
  .amdhsa_float_denorm_mode_32 0
.end_amdhsa_kernel
.p2align 6
.amdhsa_kernel p2_kernel
  .amdhsa_next_free_vgpr 128
  .amdhsa_next_free_sgpr 102
  .amdhsa_accum_offset 128
  .amdhsa_group_segment_fixed_size 0
  .amdhsa_kernarg_size 112
  .amdhsa_user_sgpr_count 2
  .amdhsa_user_sgpr_kernarg_segment_ptr 1
  .amdhsa_system_sgpr_workgroup_id_x 1
  .amdhsa_float_denorm_mode_32 0
.end_amdhsa_kernel
```

```asm
; @launch kernel=p1_kernel grid=(256,1,1) block=(1024,1,1) lds=163840
; @launch kernel=p2_kernel grid=(256,1,1) block=(1024,1,1) lds=163840
.amdgcn_target "amdgcn-amd-amdhsa--gfx950"
.text
.globl p1_kernel
.p2align 8
.type p1_kernel,@function
p1_kernel:
    s_cmp_ge_u32 s2, 256
    s_cbranch_scc1 L_p1_end
    s_load_dwordx2 s[4:5], s[0:1], 104
    s_load_dwordx2 s[8:9], s[0:1], 8
    s_load_dwordx2 s[12:13], s[0:1], 16
    s_load_dwordx2 s[16:17], s[0:1], 32
    s_load_dwordx2 s[28:29], s[0:1], 0
    s_load_dwordx2 s[6:7], s[0:1], 48
    v_cmp_gt_u32 vcc, 256, v0
    s_nop 1
    s_cbranch_vccz L_p1_nopf
    s_getpc_b64 s[72:73]
L_p1_kernel_pc_1:
    s_add_u32 s72, s72, L_p1_nopf-L_p1_kernel_pc_1
    s_addc_u32 s73, s73, 0
    v_lshlrev_b32 v14, 7, v0
    v_min_u32 v14, L_p2_end-L_p1_nopf, v14
    global_load_dword v15, v14, s[72:73]
L_p1_nopf:
    v_lshlrev_b32 v1, 4, v0
    v_lshlrev_b32 v2, 3, v0
    v_lshrrev_b32 v6, 6, v0
    v_mul_u32_u24 v3, 851904, v6
    v_add_lshl_u32 v3, v3, v0, 4
    v_mov_b32 v4, 1
    v_mov_b32 v5, 0
    v_readfirstlane_b32 s39, v6
    v_cmp_gt_u32 vcc, 784, v0
    s_and_b32 s51, s2, 7
    s_lshl_b32 s51, s51, 0
    s_bfe_u32 s35, s2, 3
    s_add_u32 s51, s51, s35
    s_and_b32 s35, s2, 248
    s_add_u32 s51, s51, s35
    s_and_b32 s32, s2, 7
    s_lshl_b32 s32, s32, 2
    s_bfe_u32 s35, s2, 131075
    s_add_u32 s32, s32, s35
    s_and_b32 s35, s2, 224
    s_add_u32 s32, s32, s35
    s_lshr_b32 s35, s39, 4
    s_mul_i32 s36, s35, 4177920
    s_lshl_b32 s33, s51, 14
    s_add_u32 s33, s33, s36
    s_lshr_b32 s34, s33, 1
    s_mul_i32 s48, s51, 3840
    s_cmp_ge_u32 s35, 0
    s_cselect_b32 s48, s48, 0
    s_lshr_b32 s49, s48, 1
    s_mov_b64 s[44:45], vcc
    s_waitcnt lgkmcnt(0)
    s_load_dword s3, s[6:7], 0
    s_mov_b32 s10, 163840000
    s_mov_b32 s11, 0x00020000
    s_mov_b32 s14, 163840000
    s_mov_b32 s15, 0x00020000
    s_mov_b32 s18, 81920000
    s_mov_b32 s19, 0x00020000
    s_mul_i32 s36, s2, 20000
    s_add_u32 s30, s36, 20000
    s_mov_b32 s31, 0x00020000
    s_add_u32 s35, s36, 16384
    buffer_load_dwordx4 v[48:51], v1, s[28:31], s36 offen
    buffer_load_dwordx4 v[52:55], v1, s[28:31], s35 offen
    s_add_u32 s35, s33, 0
    buffer_load_dwordx4 v[16:19], v1, s[8:11], s35 offen nt
    s_add_u32 s35, s33, 0
    buffer_load_dwordx4 v[20:23], v1, s[12:15], s35 offen nt
    s_add_u32 s35, s33, 4194304
    buffer_load_dwordx4 v[24:27], v1, s[8:11], s35 offen nt
    s_add_u32 s35, s33, 4194304
    buffer_load_dwordx4 v[28:31], v1, s[12:15], s35 offen nt
    s_add_u32 s35, s33, 8388608
    buffer_load_dwordx4 v[32:35], v1, s[8:11], s35 offen nt
    s_add_u32 s35, s33, 8388608
    buffer_load_dwordx4 v[36:39], v1, s[12:15], s35 offen nt
    s_add_u32 s35, s33, 12582912
    buffer_load_dwordx4 v[40:43], v1, s[8:11], s35 offen nt
    s_add_u32 s35, s33, 12582912
    buffer_load_dwordx4 v[44:47], v1, s[12:15], s35 offen nt
    s_add_u32 s35, s33, 16777216
    buffer_load_dwordx4 v[72:75], v1, s[8:11], s35 offen nt
    s_add_u32 s35, s33, 16777216
    buffer_load_dwordx4 v[76:79], v1, s[12:15], s35 offen nt
    s_mov_b32 s20, s4
    s_mov_b32 s21, s5
    s_mov_b32 s22, 0
    s_mov_b32 s23, 0x00020000
    s_add_u32 s24, s4, 0
    s_addc_u32 s25, s5, 0
    s_mov_b32 s26, 8540160
    s_mov_b32 s27, 0x00020000
    s_mov_b32 s37, 1492179184
    s_mov_b32 s55, 0
    s_mov_b64 s[72:73], s[4:5]
    s_mov_b32 s74, 0
    s_mov_b32 s75, 0x00020000
    s_mov_b32 s50, 21845
    s_mov_b32 s52, 0x8000
    s_mov_b32 s38, 262400
    s_mov_b32 s43, 0x05040100
    s_mov_b32 s40, 0
    v_mov_b32 v8, 0
    v_mov_b32 v9, 0
    v_mov_b32 v10, 0
    v_mov_b32 v11, 0
    ds_write_b128 v1, v[8:11] offset:0
    v_min_u32 v7, 16, v0
    v_lshlrev_b32 v7, 2, v7
    v_add_u32 v7, 160768, v7
    ds_write_b32 v7, v8
    s_waitcnt lgkmcnt(0)
    s_lshl_b32 s3, s3, 16
    v_mov_b32 v12, s3
    v_mul_f32 v12, 0.15915494, v12
    s_nop 0
    v_readfirstlane_b32 s41, v12
    s_waitcnt vmcnt(10)
    v_mov_b32 v12, 0x3f803f80
    v_and_b32 v48, 0x7fff7fff, v48
    v_and_b32 v49, 0x7fff7fff, v49
    v_and_b32 v50, 0x7fff7fff, v50
    v_and_b32 v51, 0x7fff7fff, v51
    v_and_b32 v52, 0x7fff7fff, v52
    v_and_b32 v53, 0x7fff7fff, v53
    v_and_b32 v54, 0x7fff7fff, v54
    v_and_b32 v55, 0x7fff7fff, v55
    v_pk_max_u16 v8, v8, v48
    v_dot2c_f32_bf16 v9, v48, v12
    v_pk_max_u16 v8, v8, v49
    v_dot2c_f32_bf16 v9, v49, v12
    v_pk_max_u16 v8, v8, v50
    v_dot2c_f32_bf16 v9, v50, v12
    v_pk_max_u16 v8, v8, v51
    v_dot2c_f32_bf16 v9, v51, v12
    v_pk_max_u16 v8, v8, v52
    v_dot2c_f32_bf16 v9, v52, v12
    v_pk_max_u16 v8, v8, v53
    v_dot2c_f32_bf16 v9, v53, v12
    v_pk_max_u16 v8, v8, v54
    v_dot2c_f32_bf16 v9, v54, v12
    v_pk_max_u16 v8, v8, v55
    v_dot2c_f32_bf16 v9, v55, v12
    v_lshrrev_b32 v10, 16, v8
    v_and_b32 v8, 0xffff, v8
    v_max_u32 v8, v8, v10
    s_nop 0
    s_nop 1
    v_max_u32_dpp v8, v8, v8 row_shr:1 row_mask:0xf bank_mask:0xf bound_ctrl:0
    s_nop 1
    v_max_u32_dpp v8, v8, v8 row_shr:2 row_mask:0xf bank_mask:0xf bound_ctrl:0
    s_nop 1
    v_max_u32_dpp v8, v8, v8 row_shr:4 row_mask:0xf bank_mask:0xf bound_ctrl:0
    s_nop 1
    v_max_u32_dpp v8, v8, v8 row_shr:8 row_mask:0xf bank_mask:0xf bound_ctrl:0
    s_nop 1
    v_max_u32_dpp v8, v8, v8 row_bcast:15 row_mask:0xa bank_mask:0xf
    s_nop 1
    v_max_u32_dpp v8, v8, v8 row_bcast:31 row_mask:0xc bank_mask:0xf
    s_nop 1
    v_add_f32_dpp v9, v9, v9 row_shr:1 row_mask:0xf bank_mask:0xf bound_ctrl:0
    s_nop 1
    v_add_f32_dpp v9, v9, v9 row_shr:2 row_mask:0xf bank_mask:0xf bound_ctrl:0
    s_nop 1
    v_add_f32_dpp v9, v9, v9 row_shr:4 row_mask:0xf bank_mask:0xf bound_ctrl:0
    s_nop 1
    v_add_f32_dpp v9, v9, v9 row_shr:8 row_mask:0xf bank_mask:0xf bound_ctrl:0
    s_nop 1
    v_add_f32_dpp v9, v9, v9 row_bcast:15 row_mask:0xa bank_mask:0xf
    s_nop 1
    v_add_f32_dpp v9, v9, v9 row_bcast:31 row_mask:0xc bank_mask:0xf
    s_lshl_b32 s35, s39, 4
    s_add_u32 s35, s35, 160320
    v_mov_b32 v10, s35
    s_mov_b32 exec_lo, 0
    s_brev_b32 exec_hi, 1
    ds_write_b64 v10, v[8:9]
    s_mov_b64 exec, -1
    s_waitcnt lgkmcnt(0)
    s_barrier
    s_cmp_lg_u32 s39, 0
    s_cbranch_scc1 L_p1_first
    v_and_b32 v6, 15, v0
    v_lshlrev_b32 v6, 4, v6
    v_add_u32 v6, 160320, v6
    ds_read_b64 v[8:9], v6
    s_waitcnt lgkmcnt(0)
    s_nop 1
    v_max_u32_dpp v8, v8, v8 row_shr:1 row_mask:0xf bank_mask:0xf bound_ctrl:0
    s_nop 1
    v_max_u32_dpp v8, v8, v8 row_shr:2 row_mask:0xf bank_mask:0xf bound_ctrl:0
    s_nop 1
    v_max_u32_dpp v8, v8, v8 row_shr:4 row_mask:0xf bank_mask:0xf bound_ctrl:0
    s_nop 1
    v_max_u32_dpp v8, v8, v8 row_shr:8 row_mask:0xf bank_mask:0xf bound_ctrl:0
    s_nop 1
    v_add_f32_dpp v9, v9, v9 row_shr:1 row_mask:0xf bank_mask:0xf bound_ctrl:0
    s_nop 1
    v_add_f32_dpp v9, v9, v9 row_shr:2 row_mask:0xf bank_mask:0xf bound_ctrl:0
    s_nop 1
    v_add_f32_dpp v9, v9, v9 row_shr:4 row_mask:0xf bank_mask:0xf bound_ctrl:0
    s_nop 1
    v_add_f32_dpp v9, v9, v9 row_shr:8 row_mask:0xf bank_mask:0xf bound_ctrl:0
    s_lshl_b32 s35, s2, 3
    s_add_u32 s35, s35, 8519680
    v_mov_b32 v6, 0
    s_mov_b64 exec, 0x8000
    buffer_store_dwordx2 v[8:9], v6, s[24:27], s35 offen sc1
    s_lshl_b32 s35, s2, 8
    s_add_u32 s35, s35, 8523776
    buffer_store_dword v6, v6, s[24:27], s35 offen sc1
    s_mov_b64 exec, -1
    s_branch L_p1_first
L_p1_loop:
    s_mov_b64 s[72:73], s[20:21]
    s_mov_b32 s74, s22
    s_getreg_b32 s51, hwreg(HW_REG_XCC_ID, 0, 1)
    s_cmp_eq_u32 s51, 0
    s_cselect_b64 vcc, -1, 0
    s_cmp_lg_u32 s39, 15
    s_cbranch_scc1 L_p1_kernel_nox_2
    s_waitcnt lgkmcnt(13)
    v_lshlrev_b32 v15, 16, v120
    v_and_b32 v120, 0xffff0000, v120
    v_lshlrev_b32 v121, 16, v121
    v_mul_f32 v15, s41, v15
    v_mul_f32 v120, s41, v120
    v_mul_f32 v121, s41, v121
    v_fract_f32 v15, v15
    v_fract_f32 v120, v120
    v_fract_f32 v121, v121
    v_cos_f32 v15, v15
    v_cos_f32 v120, v120
    v_cos_f32 v121, v121
    v_fmaak_f32 v15, v10, v15, 1262486016
    v_fmaak_f32 v120, v10, v120, 1262486016
    v_fmaak_f32 v121, v10, v121, 1262486016
    v_lshlrev_b32 v15, 22, v15
    v_alignbit_b32 v15, v120, v15, 10
    v_alignbit_b32 v15, v121, v15, 10
    v_xor_b32 v15, 0x80200800, v15
    s_mov_b32 s36, 13631488
    buffer_store_dwordx4 v[12:15], v3, s[20:23], s36 offen sc1
L_p1_kernel_nox_2:
    s_waitcnt lgkmcnt(12)
    v_lshlrev_b32 v75, 16, v122
    v_and_b32 v122, 0xffff0000, v122
    v_lshlrev_b32 v123, 16, v123
    v_mul_f32 v75, s41, v75
    v_mul_f32 v122, s41, v122
    v_mul_f32 v123, s41, v123
    v_fract_f32 v75, v75
    v_fract_f32 v122, v122
    v_fract_f32 v123, v123
    v_cos_f32 v75, v75
    v_cos_f32 v122, v122
    v_cos_f32 v123, v123
    v_fmaak_f32 v75, v10, v75, 1262486016
    v_fmaak_f32 v122, v10, v122, 1262486016
    v_fmaak_f32 v123, v10, v123, 1262486016
    v_lshlrev_b32 v75, 22, v75
    v_alignbit_b32 v75, v122, v75, 10
    v_alignbit_b32 v75, v123, v75, 10
    v_xor_b32 v75, 0x80200800, v75
    s_mov_b32 s36, 0
    buffer_store_dwordx4 v[72:75], v3, s[20:23], s36 offen sc1
    s_waitcnt lgkmcnt(11)
    v_lshlrev_b32 v79, 16, v124
    v_and_b32 v124, 0xffff0000, v124
    v_lshlrev_b32 v125, 16, v125
    v_mul_f32 v79, s41, v79
    v_mul_f32 v124, s41, v124
    v_mul_f32 v125, s41, v125
    v_fract_f32 v79, v79
    v_fract_f32 v124, v124
    v_fract_f32 v125, v125
    v_cos_f32 v79, v79
    v_cos_f32 v124, v124
    v_cos_f32 v125, v125
    v_fmaak_f32 v79, v10, v79, 1262486016
    v_fmaak_f32 v124, v10, v124, 1262486016
    v_fmaak_f32 v125, v10, v125, 1262486016
    v_lshlrev_b32 v79, 22, v79
    v_alignbit_b32 v79, v124, v79, 10
    v_alignbit_b32 v79, v125, v79, 10
    v_xor_b32 v79, 0x80200800, v79
    s_mov_b32 s36, 1048576
    buffer_store_dwordx4 v[76:79], v3, s[20:23], s36 offen sc1
    s_waitcnt lgkmcnt(0)
    v_lshlrev_b32 v51, 16, v126
    v_and_b32 v126, 0xffff0000, v126
    v_lshlrev_b32 v127, 16, v127
    v_mul_f32 v51, s41, v51
    v_mul_f32 v126, s41, v126
    v_mul_f32 v127, s41, v127
    v_fract_f32 v51, v51
    v_fract_f32 v126, v126
    v_fract_f32 v127, v127
    v_cos_f32 v51, v51
    v_cos_f32 v126, v126
    v_cos_f32 v127, v127
    v_fmaak_f32 v51, v10, v51, 1262486016
    v_fmaak_f32 v126, v10, v126, 1262486016
    v_fmaak_f32 v127, v10, v127, 1262486016
    v_lshlrev_b32 v51, 22, v51
    v_alignbit_b32 v51, v126, v51, 10
    v_alignbit_b32 v51, v127, v51, 10
    v_xor_b32 v51, 0x80200800, v51
    s_mov_b32 s36, 2097152
    buffer_store_dwordx4 v[48:51], v3, s[20:23], s36 offen sc1
    s_add_u32 s35, s33, 16777216
    buffer_load_dwordx4 v[72:75], v1, s[8:11], s35 offen nt
    s_add_u32 s35, s33, 16777216
    buffer_load_dwordx4 v[76:79], v1, s[12:15], s35 offen nt
    s_cbranch_vccz L_p1_kernel_thr_3
    s_waitcnt vmcnt(0)
L_p1_kernel_thr_3:
    s_waitcnt vmcnt(11)
    v_perm_b32 v6, v20, v16, s43
    v_perm_b32 v7, v21, v17, s43
    v_perm_b32 v8, v22, v18, s43
    v_perm_b32 v9, v23, v19, s43
    v_mul_hi_u32_u24 v16, 429497, v16
    v_mul_hi_u32_u24 v20, 429497, v20
    v_mul_hi_u32_u24 v17, 429497, v17
    v_mul_hi_u32_u24 v21, 429497, v21
    v_mul_hi_u32_u24 v18, 429497, v18
    v_mul_hi_u32_u24 v22, 429497, v22
    v_mul_hi_u32_u24 v19, 429497, v19
    v_mul_hi_u32_u24 v23, 429497, v23
    v_lshl_or_b32 v16, v20, 16, v16
    v_lshl_or_b32 v17, v21, 16, v17
    v_lshl_or_b32 v18, v22, 16, v18
    v_lshl_or_b32 v19, v23, 16, v19
    v_dot2_u32_u16 v20, v16, s38, 0
    v_dot2_u32_u16 v21, v17, s38, 0
    v_dot2_u32_u16 v22, v18, s38, 0
    v_dot2_u32_u16 v23, v19, s38, 0
    v_pk_mad_u16 v6, v16, s37, v6
    v_pk_mad_u16 v7, v17, s37, v7
    v_pk_mad_u16 v8, v18, s37, v8
    v_pk_mad_u16 v9, v19, s37, v9
    ds_add_u32 v20, v4 offset:0
    ds_add_u32 v21, v4 offset:0
    ds_add_u32 v22, v4 offset:0
    ds_add_u32 v23, v4 offset:0
    v_pk_mad_u16 v6, v16, s52, v6 op_sel:[1,0,0] op_sel_hi:[1,1,1]
    v_pk_mad_u16 v7, v17, s52, v7 op_sel:[1,0,0] op_sel_hi:[1,1,1]
    v_pk_mad_u16 v8, v18, s52, v8 op_sel:[1,0,0] op_sel_hi:[1,1,1]
    v_pk_mad_u16 v9, v19, s52, v9 op_sel:[1,0,0] op_sel_hi:[1,1,1]
    v_perm_b32 v121, v23, v22, s43
    v_perm_b32 v120, v21, v20, s43
    v_or_b32 v127, 0x40000000, v6
    v_or_b32 v48, 0x40000000, v7
    v_or_b32 v49, 0x40000000, v8
    v_or_b32 v50, 0x40000000, v9
    v_lshlrev_b32 v83, 16, v100
    v_and_b32 v100, 0xffff0000, v100
    v_lshlrev_b32 v101, 16, v101
    v_mul_f32 v83, s41, v83
    v_mul_f32 v100, s41, v100
    v_mul_f32 v101, s41, v101
    v_fract_f32 v83, v83
    v_fract_f32 v100, v100
    v_fract_f32 v101, v101
    v_cos_f32 v83, v83
    v_cos_f32 v100, v100
    v_cos_f32 v101, v101
    v_fmaak_f32 v83, v10, v83, 1262486016
    v_fmaak_f32 v100, v10, v100, 1262486016
    v_fmaak_f32 v101, v10, v101, 1262486016
    v_lshlrev_b32 v83, 22, v83
    v_alignbit_b32 v83, v100, v83, 10
    v_alignbit_b32 v83, v101, v83, 10
    v_xor_b32 v83, 0x80200800, v83
    s_mov_b32 s36, 3145728
    buffer_store_dwordx4 v[80:83], v3, s[20:23], s36 offen sc1
    v_lshlrev_b32 v55, 16, v102
    v_and_b32 v102, 0xffff0000, v102
    v_lshlrev_b32 v103, 16, v103
    v_mul_f32 v55, s41, v55
    v_mul_f32 v102, s41, v102
    v_mul_f32 v103, s41, v103
    v_fract_f32 v55, v55
    v_fract_f32 v102, v102
    v_fract_f32 v103, v103
    v_cos_f32 v55, v55
    v_cos_f32 v102, v102
    v_cos_f32 v103, v103
    v_fmaak_f32 v55, v10, v55, 1262486016
    v_fmaak_f32 v102, v10, v102, 1262486016
    v_fmaak_f32 v103, v10, v103, 1262486016
    v_lshlrev_b32 v55, 22, v55
    v_alignbit_b32 v55, v102, v55, 10
    v_alignbit_b32 v55, v103, v55, 10
    v_xor_b32 v55, 0x80200800, v55
    s_cmp_lg_u32 s40, 3
    s_cbranch_scc1 L_p1_kernel_now_4
    v_mov_b64 v[16:17], v[52:53]
    v_mov_b64 v[18:19], v[54:55]
    s_branch L_p1_kernel_held_5
L_p1_kernel_now_4:
    s_mov_b32 s36, 4194304
    buffer_store_dwordx4 v[52:55], v3, s[20:23], s36 offen sc1
L_p1_kernel_held_5:
    s_add_u32 s35, s33, 20971520
    buffer_load_dwordx4 v[80:83], v1, s[8:11], s35 offen nt
    s_add_u32 s35, s33, 20971520
    buffer_load_dwordx4 v[100:103], v1, s[12:15], s35 offen nt
    s_cbranch_vccz L_p1_kernel_thr_6
    s_waitcnt vmcnt(0)
L_p1_kernel_thr_6:
    v_lshlrev_b32 v87, 16, v104
    v_and_b32 v104, 0xffff0000, v104
    v_lshlrev_b32 v105, 16, v105
    v_mul_f32 v87, s41, v87
    v_mul_f32 v104, s41, v104
    v_mul_f32 v105, s41, v105
    v_fract_f32 v87, v87
    v_fract_f32 v104, v104
    v_fract_f32 v105, v105
    v_cos_f32 v87, v87
    v_cos_f32 v104, v104
    v_cos_f32 v105, v105
    v_fmaak_f32 v87, v10, v87, 1262486016
    v_fmaak_f32 v104, v10, v104, 1262486016
    v_fmaak_f32 v105, v10, v105, 1262486016
    v_lshlrev_b32 v87, 22, v87
    v_alignbit_b32 v87, v104, v87, 10
    v_alignbit_b32 v87, v105, v87, 10
    v_xor_b32 v87, 0x80200800, v87
    s_mov_b32 s36, 5242880
    buffer_store_dwordx4 v[84:87], v3, s[20:23], s36 offen sc1
    v_lshlrev_b32 v59, 16, v106
    v_and_b32 v106, 0xffff0000, v106
    v_lshlrev_b32 v107, 16, v107
    v_mul_f32 v59, s41, v59
    v_mul_f32 v106, s41, v106
    v_mul_f32 v107, s41, v107
    v_fract_f32 v59, v59
    v_fract_f32 v106, v106
    v_fract_f32 v107, v107
    v_cos_f32 v59, v59
    v_cos_f32 v106, v106
    v_cos_f32 v107, v107
    v_fmaak_f32 v59, v10, v59, 1262486016
    v_fmaak_f32 v106, v10, v106, 1262486016
    v_fmaak_f32 v107, v10, v107, 1262486016
    v_lshlrev_b32 v59, 22, v59
    v_alignbit_b32 v59, v106, v59, 10
    v_alignbit_b32 v59, v107, v59, 10
    v_xor_b32 v59, 0x80200800, v59
    s_cmp_lg_u32 s40, 3
    s_cbranch_scc1 L_p1_kernel_now_7
    v_mov_b64 v[20:21], v[56:57]
    v_mov_b64 v[22:23], v[58:59]
    s_branch L_p1_kernel_held_8
L_p1_kernel_now_7:
    s_mov_b32 s36, 6291456
    buffer_store_dwordx4 v[56:59], v3, s[20:23], s36 offen sc1
L_p1_kernel_held_8:
    s_add_u32 s35, s33, 25165824
    buffer_load_dwordx4 v[84:87], v1, s[8:11], s35 offen nt
    s_add_u32 s35, s33, 25165824
    buffer_load_dwordx4 v[104:107], v1, s[12:15], s35 offen nt
    s_cbranch_vccz L_p1_kernel_thr_9
    s_waitcnt vmcnt(0)
L_p1_kernel_thr_9:
    s_waitcnt vmcnt(15)
    v_perm_b32 v6, v28, v24, s43
    v_perm_b32 v7, v29, v25, s43
    v_perm_b32 v8, v30, v26, s43
    v_perm_b32 v9, v31, v27, s43
    v_mul_hi_u32_u24 v24, 429497, v24
    v_mul_hi_u32_u24 v28, 429497, v28
    v_mul_hi_u32_u24 v25, 429497, v25
    v_mul_hi_u32_u24 v29, 429497, v29
    v_mul_hi_u32_u24 v26, 429497, v26
    v_mul_hi_u32_u24 v30, 429497, v30
    v_mul_hi_u32_u24 v27, 429497, v27
    v_mul_hi_u32_u24 v31, 429497, v31
    v_lshl_or_b32 v24, v28, 16, v24
    v_lshl_or_b32 v25, v29, 16, v25
    v_lshl_or_b32 v26, v30, 16, v26
    v_lshl_or_b32 v27, v31, 16, v27
    v_dot2_u32_u16 v28, v24, s38, 0
    v_dot2_u32_u16 v29, v25, s38, 0
    v_dot2_u32_u16 v30, v26, s38, 0
    v_dot2_u32_u16 v31, v27, s38, 0
    v_pk_mad_u16 v6, v24, s37, v6
    v_pk_mad_u16 v7, v25, s37, v7
    v_pk_mad_u16 v8, v26, s37, v8
    v_pk_mad_u16 v9, v27, s37, v9
    ds_add_u32 v28, v4 offset:0
    ds_add_u32 v29, v4 offset:0
    ds_add_u32 v30, v4 offset:0
    ds_add_u32 v31, v4 offset:0
    v_pk_mad_u16 v6, v24, s52, v6 op_sel:[1,0,0] op_sel_hi:[1,1,1]
    v_pk_mad_u16 v7, v25, s52, v7 op_sel:[1,0,0] op_sel_hi:[1,1,1]
    v_pk_mad_u16 v8, v26, s52, v8 op_sel:[1,0,0] op_sel_hi:[1,1,1]
    v_pk_mad_u16 v9, v27, s52, v9 op_sel:[1,0,0] op_sel_hi:[1,1,1]
    v_perm_b32 v123, v31, v30, s43
    v_perm_b32 v122, v29, v28, s43
    v_or_b32 v52, 0x40000000, v6
    v_or_b32 v53, 0x40000000, v7
    v_or_b32 v54, 0x40000000, v8
    v_or_b32 v56, 0x40000000, v9
    v_lshlrev_b32 v91, 16, v108
    v_and_b32 v108, 0xffff0000, v108
    v_lshlrev_b32 v109, 16, v109
    v_mul_f32 v91, s41, v91
    v_mul_f32 v108, s41, v108
    v_mul_f32 v109, s41, v109
    v_fract_f32 v91, v91
    v_fract_f32 v108, v108
    v_fract_f32 v109, v109
    v_cos_f32 v91, v91
    v_cos_f32 v108, v108
    v_cos_f32 v109, v109
    v_fmaak_f32 v91, v10, v91, 1262486016
    v_fmaak_f32 v108, v10, v108, 1262486016
    v_fmaak_f32 v109, v10, v109, 1262486016
    v_lshlrev_b32 v91, 22, v91
    v_alignbit_b32 v91, v108, v91, 10
    v_alignbit_b32 v91, v109, v91, 10
    v_xor_b32 v91, 0x80200800, v91
    s_cmp_lg_u32 s40, 3
    s_cbranch_scc1 L_p1_kernel_now_10
    v_mov_b64 v[24:25], v[88:89]
    v_mov_b64 v[26:27], v[90:91]
    s_branch L_p1_kernel_held_11
L_p1_kernel_now_10:
    s_mov_b32 s36, 7340032
    buffer_store_dwordx4 v[88:91], v3, s[20:23], s36 offen sc1
L_p1_kernel_held_11:
    v_lshlrev_b32 v63, 16, v110
    v_and_b32 v110, 0xffff0000, v110
    v_lshlrev_b32 v111, 16, v111
    v_mul_f32 v63, s41, v63
    v_mul_f32 v110, s41, v110
    v_mul_f32 v111, s41, v111
    v_fract_f32 v63, v63
    v_fract_f32 v110, v110
    v_fract_f32 v111, v111
    v_cos_f32 v63, v63
    v_cos_f32 v110, v110
    v_cos_f32 v111, v111
    v_fmaak_f32 v63, v10, v63, 1262486016
    v_fmaak_f32 v110, v10, v110, 1262486016
    v_fmaak_f32 v111, v10, v111, 1262486016
    v_lshlrev_b32 v63, 22, v63
    v_alignbit_b32 v63, v110, v63, 10
    v_alignbit_b32 v63, v111, v63, 10
    v_xor_b32 v63, 0x80200800, v63
    s_cmp_lg_u32 s40, 3
    s_cbranch_scc1 L_p1_kernel_now_12
    v_mov_b64 v[28:29], v[60:61]
    v_mov_b64 v[30:31], v[62:63]
    s_branch L_p1_kernel_held_13
L_p1_kernel_now_12:
    s_mov_b32 s36, 8388608
    buffer_store_dwordx4 v[60:63], v3, s[20:23], s36 offen sc1
L_p1_kernel_held_13:
    s_add_u32 s35, s33, 29360128
    buffer_load_dwordx4 v[88:91], v1, s[8:11], s35 offen nt
    s_add_u32 s35, s33, 29360128
    buffer_load_dwordx4 v[108:111], v1, s[12:15], s35 offen nt
    s_cbranch_vccz L_p1_kernel_thr_14
    s_waitcnt vmcnt(0)
L_p1_kernel_thr_14:
    s_waitcnt vmcnt(15)
    v_perm_b32 v6, v36, v32, s43
    v_perm_b32 v7, v37, v33, s43
    v_perm_b32 v8, v38, v34, s43
    v_perm_b32 v9, v39, v35, s43
    v_mul_hi_u32_u24 v32, 429497, v32
    v_mul_hi_u32_u24 v36, 429497, v36
    v_mul_hi_u32_u24 v33, 429497, v33
    v_mul_hi_u32_u24 v37, 429497, v37
    v_mul_hi_u32_u24 v34, 429497, v34
    v_mul_hi_u32_u24 v38, 429497, v38
    v_mul_hi_u32_u24 v35, 429497, v35
    v_mul_hi_u32_u24 v39, 429497, v39
    v_lshl_or_b32 v32, v36, 16, v32
    v_lshl_or_b32 v33, v37, 16, v33
    v_lshl_or_b32 v34, v38, 16, v34
    v_lshl_or_b32 v35, v39, 16, v35
    v_dot2_u32_u16 v36, v32, s38, 0
    v_dot2_u32_u16 v37, v33, s38, 0
    v_dot2_u32_u16 v38, v34, s38, 0
    v_dot2_u32_u16 v39, v35, s38, 0
    v_pk_mad_u16 v6, v32, s37, v6
    v_pk_mad_u16 v7, v33, s37, v7
    v_pk_mad_u16 v8, v34, s37, v8
    v_pk_mad_u16 v9, v35, s37, v9
    ds_add_u32 v36, v4 offset:0
    ds_add_u32 v37, v4 offset:0
    ds_add_u32 v38, v4 offset:0
    ds_add_u32 v39, v4 offset:0
    v_pk_mad_u16 v6, v32, s52, v6 op_sel:[1,0,0] op_sel_hi:[1,1,1]
    v_pk_mad_u16 v7, v33, s52, v7 op_sel:[1,0,0] op_sel_hi:[1,1,1]
    v_pk_mad_u16 v8, v34, s52, v8 op_sel:[1,0,0] op_sel_hi:[1,1,1]
    v_pk_mad_u16 v9, v35, s52, v9 op_sel:[1,0,0] op_sel_hi:[1,1,1]
    v_perm_b32 v125, v39, v38, s43
    v_perm_b32 v124, v37, v36, s43
    v_or_b32 v57, 0x40000000, v6
    v_or_b32 v58, 0x40000000, v7
    v_or_b32 v60, 0x40000000, v8
    v_or_b32 v61, 0x40000000, v9
    v_lshlrev_b32 v95, 16, v112
    v_and_b32 v112, 0xffff0000, v112
    v_lshlrev_b32 v113, 16, v113
    v_mul_f32 v95, s41, v95
    v_mul_f32 v112, s41, v112
    v_mul_f32 v113, s41, v113
    v_fract_f32 v95, v95
    v_fract_f32 v112, v112
    v_fract_f32 v113, v113
    v_cos_f32 v95, v95
    v_cos_f32 v112, v112
    v_cos_f32 v113, v113
    v_fmaak_f32 v95, v10, v95, 1262486016
    v_fmaak_f32 v112, v10, v112, 1262486016
    v_fmaak_f32 v113, v10, v113, 1262486016
    v_lshlrev_b32 v95, 22, v95
    v_alignbit_b32 v95, v112, v95, 10
    v_alignbit_b32 v95, v113, v95, 10
    v_xor_b32 v95, 0x80200800, v95
    s_cmp_lg_u32 s40, 3
    s_cbranch_scc1 L_p1_kernel_now_15
    v_mov_b64 v[32:33], v[92:93]
    v_mov_b64 v[34:35], v[94:95]
    s_branch L_p1_kernel_held_16
L_p1_kernel_now_15:
    s_mov_b32 s36, 9437184
    buffer_store_dwordx4 v[92:95], v3, s[20:23], s36 offen sc1
L_p1_kernel_held_16:
    v_lshlrev_b32 v67, 16, v114
    v_and_b32 v114, 0xffff0000, v114
    v_lshlrev_b32 v115, 16, v115
    v_mul_f32 v67, s41, v67
    v_mul_f32 v114, s41, v114
    v_mul_f32 v115, s41, v115
    v_fract_f32 v67, v67
    v_fract_f32 v114, v114
    v_fract_f32 v115, v115
    v_cos_f32 v67, v67
    v_cos_f32 v114, v114
    v_cos_f32 v115, v115
    v_fmaak_f32 v67, v10, v67, 1262486016
    v_fmaak_f32 v114, v10, v114, 1262486016
    v_fmaak_f32 v115, v10, v115, 1262486016
    v_lshlrev_b32 v67, 22, v67
    v_alignbit_b32 v67, v114, v67, 10
    v_alignbit_b32 v67, v115, v67, 10
    v_xor_b32 v67, 0x80200800, v67
    s_cmp_lg_u32 s40, 3
    s_cbranch_scc1 L_p1_kernel_now_17
    v_mov_b64 v[36:37], v[64:65]
    v_mov_b64 v[38:39], v[66:67]
    s_branch L_p1_kernel_held_18
L_p1_kernel_now_17:
    s_mov_b32 s36, 10485760
    buffer_store_dwordx4 v[64:67], v3, s[20:23], s36 offen sc1
L_p1_kernel_held_18:
    s_add_u32 s35, s33, 33554432
    buffer_load_dwordx4 v[92:95], v1, s[8:11], s35 offen nt
    s_add_u32 s35, s33, 33554432
    buffer_load_dwordx4 v[112:115], v1, s[12:15], s35 offen nt
    s_cbranch_vccz L_p1_kernel_thr_19
    s_waitcnt vmcnt(0)
L_p1_kernel_thr_19:
    s_waitcnt vmcnt(15)
    v_perm_b32 v6, v44, v40, s43
    v_perm_b32 v7, v45, v41, s43
    v_perm_b32 v8, v46, v42, s43
    v_perm_b32 v9, v47, v43, s43
    v_mul_hi_u32_u24 v40, 429497, v40
    v_mul_hi_u32_u24 v44, 429497, v44
    v_mul_hi_u32_u24 v41, 429497, v41
    v_mul_hi_u32_u24 v45, 429497, v45
    v_mul_hi_u32_u24 v42, 429497, v42
    v_mul_hi_u32_u24 v46, 429497, v46
    v_mul_hi_u32_u24 v43, 429497, v43
    v_mul_hi_u32_u24 v47, 429497, v47
    v_lshl_or_b32 v40, v44, 16, v40
    v_lshl_or_b32 v41, v45, 16, v41
    v_lshl_or_b32 v42, v46, 16, v42
    v_lshl_or_b32 v43, v47, 16, v43
    v_dot2_u32_u16 v44, v40, s38, 0
    v_dot2_u32_u16 v45, v41, s38, 0
    v_dot2_u32_u16 v46, v42, s38, 0
    v_dot2_u32_u16 v47, v43, s38, 0
    v_pk_mad_u16 v6, v40, s37, v6
    v_pk_mad_u16 v7, v41, s37, v7
    v_pk_mad_u16 v8, v42, s37, v8
    v_pk_mad_u16 v9, v43, s37, v9
    ds_add_u32 v44, v4 offset:0
    ds_add_u32 v45, v4 offset:0
    ds_add_u32 v46, v4 offset:0
    ds_add_u32 v47, v4 offset:0
    v_pk_mad_u16 v6, v40, s52, v6 op_sel:[1,0,0] op_sel_hi:[1,1,1]
    v_pk_mad_u16 v7, v41, s52, v7 op_sel:[1,0,0] op_sel_hi:[1,1,1]
    v_pk_mad_u16 v8, v42, s52, v8 op_sel:[1,0,0] op_sel_hi:[1,1,1]
    v_pk_mad_u16 v9, v43, s52, v9 op_sel:[1,0,0] op_sel_hi:[1,1,1]
    v_perm_b32 v51, v47, v46, s43
    v_perm_b32 v126, v45, v44, s43
    v_or_b32 v62, 0x40000000, v6
    v_or_b32 v64, 0x40000000, v7
    v_or_b32 v65, 0x40000000, v8
    v_or_b32 v66, 0x40000000, v9
    v_lshlrev_b32 v99, 16, v116
    v_and_b32 v116, 0xffff0000, v116
    v_lshlrev_b32 v117, 16, v117
    v_mul_f32 v99, s41, v99
    v_mul_f32 v116, s41, v116
    v_mul_f32 v117, s41, v117
    v_fract_f32 v99, v99
    v_fract_f32 v116, v116
    v_fract_f32 v117, v117
    v_cos_f32 v99, v99
    v_cos_f32 v116, v116
    v_cos_f32 v117, v117
    v_fmaak_f32 v99, v10, v99, 1262486016
    v_fmaak_f32 v116, v10, v116, 1262486016
    v_fmaak_f32 v117, v10, v117, 1262486016
    v_lshlrev_b32 v99, 22, v99
    v_alignbit_b32 v99, v116, v99, 10
    v_alignbit_b32 v99, v117, v99, 10
    v_xor_b32 v99, 0x80200800, v99
    s_cmp_lg_u32 s40, 3
    s_cbranch_scc1 L_p1_kernel_now_20
    v_mov_b64 v[40:41], v[96:97]
    v_mov_b64 v[42:43], v[98:99]
    s_branch L_p1_kernel_held_21
L_p1_kernel_now_20:
    s_mov_b32 s36, 11534336
    buffer_store_dwordx4 v[96:99], v3, s[20:23], s36 offen sc1
L_p1_kernel_held_21:
    v_lshlrev_b32 v71, 16, v118
    v_and_b32 v118, 0xffff0000, v118
    v_lshlrev_b32 v119, 16, v119
    v_mul_f32 v71, s41, v71
    v_mul_f32 v118, s41, v118
    v_mul_f32 v119, s41, v119
    v_fract_f32 v71, v71
    v_fract_f32 v118, v118
    v_fract_f32 v119, v119
    v_cos_f32 v71, v71
    v_cos_f32 v118, v118
    v_cos_f32 v119, v119
    v_fmaak_f32 v71, v10, v71, 1262486016
    v_fmaak_f32 v118, v10, v118, 1262486016
    v_fmaak_f32 v119, v10, v119, 1262486016
    v_lshlrev_b32 v71, 22, v71
    v_alignbit_b32 v71, v118, v71, 10
    v_alignbit_b32 v71, v119, v71, 10
    v_xor_b32 v71, 0x80200800, v71
    s_cmp_lg_u32 s40, 3
    s_cbranch_scc1 L_p1_kernel_now_22
    v_mov_b64 v[44:45], v[68:69]
    v_mov_b64 v[46:47], v[70:71]
    s_branch L_p1_kernel_held_23
L_p1_kernel_now_22:
    s_mov_b32 s36, 12582912
    buffer_store_dwordx4 v[68:71], v3, s[20:23], s36 offen sc1
L_p1_kernel_held_23:
    s_add_u32 s35, s33, 37748736
    s_sub_u32 s35, s35, s48
    v_cndmask_b32 v96, 2.0, v1, s[44:45]
    buffer_load_dwordx4 v[96:99], v96, s[8:11], s35 offen nt
    s_add_u32 s35, s33, 37748736
    s_sub_u32 s35, s35, s48
    v_cndmask_b32 v116, 2.0, v1, s[44:45]
    buffer_load_dwordx4 v[116:119], v116, s[12:15], s35 offen nt
    s_cbranch_vccz L_p1_kernel_thr_24
    s_waitcnt vmcnt(0)
L_p1_kernel_thr_24:
    s_branch L_p1_join
L_p1_first:
    s_add_u32 s35, s33, 20971520
    buffer_load_dwordx4 v[80:83], v1, s[8:11], s35 offen nt
    s_add_u32 s35, s33, 20971520
    buffer_load_dwordx4 v[100:103], v1, s[12:15], s35 offen nt
    s_add_u32 s35, s33, 25165824
    buffer_load_dwordx4 v[84:87], v1, s[8:11], s35 offen nt
    s_add_u32 s35, s33, 25165824
    buffer_load_dwordx4 v[104:107], v1, s[12:15], s35 offen nt
    s_add_u32 s35, s33, 29360128
    buffer_load_dwordx4 v[88:91], v1, s[8:11], s35 offen nt
    s_add_u32 s35, s33, 29360128
    buffer_load_dwordx4 v[108:111], v1, s[12:15], s35 offen nt
    s_add_u32 s35, s33, 33554432
    buffer_load_dwordx4 v[92:95], v1, s[8:11], s35 offen nt
    s_add_u32 s35, s33, 33554432
    buffer_load_dwordx4 v[112:115], v1, s[12:15], s35 offen nt
    s_add_u32 s35, s33, 37748736
    s_sub_u32 s35, s35, s48
    v_cndmask_b32 v96, 2.0, v1, s[44:45]
    buffer_load_dwordx4 v[96:99], v96, s[8:11], s35 offen nt
    s_add_u32 s35, s33, 37748736
    s_sub_u32 s35, s35, s48
    v_cndmask_b32 v116, 2.0, v1, s[44:45]
    buffer_load_dwordx4 v[116:119], v116, s[12:15], s35 offen nt
    s_waitcnt vmcnt(18)
    v_perm_b32 v6, v20, v16, s43
    v_perm_b32 v7, v21, v17, s43
    v_perm_b32 v8, v22, v18, s43
    v_perm_b32 v9, v23, v19, s43
    v_mul_hi_u32_u24 v16, 429497, v16
    v_mul_hi_u32_u24 v20, 429497, v20
    v_mul_hi_u32_u24 v17, 429497, v17
    v_mul_hi_u32_u24 v21, 429497, v21
    v_mul_hi_u32_u24 v18, 429497, v18
    v_mul_hi_u32_u24 v22, 429497, v22
    v_mul_hi_u32_u24 v19, 429497, v19
    v_mul_hi_u32_u24 v23, 429497, v23
    v_lshl_or_b32 v16, v20, 16, v16
    v_lshl_or_b32 v17, v21, 16, v17
    v_lshl_or_b32 v18, v22, 16, v18
    v_lshl_or_b32 v19, v23, 16, v19
    v_dot2_u32_u16 v20, v16, s38, 0
    v_dot2_u32_u16 v21, v17, s38, 0
    v_dot2_u32_u16 v22, v18, s38, 0
    v_dot2_u32_u16 v23, v19, s38, 0
    v_pk_mad_u16 v6, v16, s37, v6
    v_pk_mad_u16 v7, v17, s37, v7
    v_pk_mad_u16 v8, v18, s37, v8
    v_pk_mad_u16 v9, v19, s37, v9
    ds_add_u32 v20, v4 offset:0
    ds_add_u32 v21, v4 offset:0
    ds_add_u32 v22, v4 offset:0
    ds_add_u32 v23, v4 offset:0
    v_pk_mad_u16 v6, v16, s52, v6 op_sel:[1,0,0] op_sel_hi:[1,1,1]
    v_pk_mad_u16 v7, v17, s52, v7 op_sel:[1,0,0] op_sel_hi:[1,1,1]
    v_pk_mad_u16 v8, v18, s52, v8 op_sel:[1,0,0] op_sel_hi:[1,1,1]
    v_pk_mad_u16 v9, v19, s52, v9 op_sel:[1,0,0] op_sel_hi:[1,1,1]
    v_perm_b32 v121, v23, v22, s43
    v_perm_b32 v120, v21, v20, s43
    v_or_b32 v127, 0x40000000, v6
    v_or_b32 v48, 0x40000000, v7
    v_or_b32 v49, 0x40000000, v8
    v_or_b32 v50, 0x40000000, v9
    s_waitcnt vmcnt(16)
    v_perm_b32 v6, v28, v24, s43
    v_perm_b32 v7, v29, v25, s43
    v_perm_b32 v8, v30, v26, s43
    v_perm_b32 v9, v31, v27, s43
    v_mul_hi_u32_u24 v24, 429497, v24
    v_mul_hi_u32_u24 v28, 429497, v28
    v_mul_hi_u32_u24 v25, 429497, v25
    v_mul_hi_u32_u24 v29, 429497, v29
    v_mul_hi_u32_u24 v26, 429497, v26
    v_mul_hi_u32_u24 v30, 429497, v30
    v_mul_hi_u32_u24 v27, 429497, v27
    v_mul_hi_u32_u24 v31, 429497, v31
    v_lshl_or_b32 v24, v28, 16, v24
    v_lshl_or_b32 v25, v29, 16, v25
    v_lshl_or_b32 v26, v30, 16, v26
    v_lshl_or_b32 v27, v31, 16, v27
    v_dot2_u32_u16 v28, v24, s38, 0
    v_dot2_u32_u16 v29, v25, s38, 0
    v_dot2_u32_u16 v30, v26, s38, 0
    v_dot2_u32_u16 v31, v27, s38, 0
    v_pk_mad_u16 v6, v24, s37, v6
    v_pk_mad_u16 v7, v25, s37, v7
    v_pk_mad_u16 v8, v26, s37, v8
    v_pk_mad_u16 v9, v27, s37, v9
    ds_add_u32 v28, v4 offset:0
    ds_add_u32 v29, v4 offset:0
    ds_add_u32 v30, v4 offset:0
    ds_add_u32 v31, v4 offset:0
    v_pk_mad_u16 v6, v24, s52, v6 op_sel:[1,0,0] op_sel_hi:[1,1,1]
    v_pk_mad_u16 v7, v25, s52, v7 op_sel:[1,0,0] op_sel_hi:[1,1,1]
    v_pk_mad_u16 v8, v26, s52, v8 op_sel:[1,0,0] op_sel_hi:[1,1,1]
    v_pk_mad_u16 v9, v27, s52, v9 op_sel:[1,0,0] op_sel_hi:[1,1,1]
    v_perm_b32 v123, v31, v30, s43
    v_perm_b32 v122, v29, v28, s43
    v_or_b32 v52, 0x40000000, v6
    v_or_b32 v53, 0x40000000, v7
    v_or_b32 v54, 0x40000000, v8
    v_or_b32 v56, 0x40000000, v9
    s_waitcnt vmcnt(14)
    v_perm_b32 v6, v36, v32, s43
    v_perm_b32 v7, v37, v33, s43
    v_perm_b32 v8, v38, v34, s43
    v_perm_b32 v9, v39, v35, s43
    v_mul_hi_u32_u24 v32, 429497, v32
    v_mul_hi_u32_u24 v36, 429497, v36
    v_mul_hi_u32_u24 v33, 429497, v33
    v_mul_hi_u32_u24 v37, 429497, v37
    v_mul_hi_u32_u24 v34, 429497, v34
    v_mul_hi_u32_u24 v38, 429497, v38
    v_mul_hi_u32_u24 v35, 429497, v35
    v_mul_hi_u32_u24 v39, 429497, v39
    v_lshl_or_b32 v32, v36, 16, v32
    v_lshl_or_b32 v33, v37, 16, v33
    v_lshl_or_b32 v34, v38, 16, v34
    v_lshl_or_b32 v35, v39, 16, v35
    v_dot2_u32_u16 v36, v32, s38, 0
    v_dot2_u32_u16 v37, v33, s38, 0
    v_dot2_u32_u16 v38, v34, s38, 0
    v_dot2_u32_u16 v39, v35, s38, 0
    v_pk_mad_u16 v6, v32, s37, v6
    v_pk_mad_u16 v7, v33, s37, v7
    v_pk_mad_u16 v8, v34, s37, v8
    v_pk_mad_u16 v9, v35, s37, v9
    ds_add_u32 v36, v4 offset:0
    ds_add_u32 v37, v4 offset:0
    ds_add_u32 v38, v4 offset:0
    ds_add_u32 v39, v4 offset:0
    v_pk_mad_u16 v6, v32, s52, v6 op_sel:[1,0,0] op_sel_hi:[1,1,1]
    v_pk_mad_u16 v7, v33, s52, v7 op_sel:[1,0,0] op_sel_hi:[1,1,1]
    v_pk_mad_u16 v8, v34, s52, v8 op_sel:[1,0,0] op_sel_hi:[1,1,1]
    v_pk_mad_u16 v9, v35, s52, v9 op_sel:[1,0,0] op_sel_hi:[1,1,1]
    v_perm_b32 v125, v39, v38, s43
    v_perm_b32 v124, v37, v36, s43
    v_or_b32 v57, 0x40000000, v6
    v_or_b32 v58, 0x40000000, v7
    v_or_b32 v60, 0x40000000, v8
    v_or_b32 v61, 0x40000000, v9
    s_waitcnt vmcnt(12)
    v_perm_b32 v6, v44, v40, s43
    v_perm_b32 v7, v45, v41, s43
    v_perm_b32 v8, v46, v42, s43
    v_perm_b32 v9, v47, v43, s43
    v_mul_hi_u32_u24 v40, 429497, v40
    v_mul_hi_u32_u24 v44, 429497, v44
    v_mul_hi_u32_u24 v41, 429497, v41
    v_mul_hi_u32_u24 v45, 429497, v45
    v_mul_hi_u32_u24 v42, 429497, v42
    v_mul_hi_u32_u24 v46, 429497, v46
    v_mul_hi_u32_u24 v43, 429497, v43
    v_mul_hi_u32_u24 v47, 429497, v47
    v_lshl_or_b32 v40, v44, 16, v40
    v_lshl_or_b32 v41, v45, 16, v41
    v_lshl_or_b32 v42, v46, 16, v42
    v_lshl_or_b32 v43, v47, 16, v43
    v_dot2_u32_u16 v44, v40, s38, 0
    v_dot2_u32_u16 v45, v41, s38, 0
    v_dot2_u32_u16 v46, v42, s38, 0
    v_dot2_u32_u16 v47, v43, s38, 0
    v_pk_mad_u16 v6, v40, s37, v6
    v_pk_mad_u16 v7, v41, s37, v7
    v_pk_mad_u16 v8, v42, s37, v8
    v_pk_mad_u16 v9, v43, s37, v9
    ds_add_u32 v44, v4 offset:0
    ds_add_u32 v45, v4 offset:0
    ds_add_u32 v46, v4 offset:0
    ds_add_u32 v47, v4 offset:0
    v_pk_mad_u16 v6, v40, s52, v6 op_sel:[1,0,0] op_sel_hi:[1,1,1]
    v_pk_mad_u16 v7, v41, s52, v7 op_sel:[1,0,0] op_sel_hi:[1,1,1]
    v_pk_mad_u16 v8, v42, s52, v8 op_sel:[1,0,0] op_sel_hi:[1,1,1]
    v_pk_mad_u16 v9, v43, s52, v9 op_sel:[1,0,0] op_sel_hi:[1,1,1]
    v_perm_b32 v51, v47, v46, s43
    v_perm_b32 v126, v45, v44, s43
    v_or_b32 v62, 0x40000000, v6
    v_or_b32 v64, 0x40000000, v7
    v_or_b32 v65, 0x40000000, v8
    v_or_b32 v66, 0x40000000, v9
L_p1_join:
    s_waitcnt vmcnt(10)
    v_perm_b32 v6, v76, v72, s43
    v_perm_b32 v7, v77, v73, s43
    v_perm_b32 v8, v78, v74, s43
    v_perm_b32 v9, v79, v75, s43
    v_mul_hi_u32_u24 v72, 429497, v72
    v_mul_hi_u32_u24 v76, 429497, v76
    v_mul_hi_u32_u24 v73, 429497, v73
    v_mul_hi_u32_u24 v77, 429497, v77
    v_mul_hi_u32_u24 v74, 429497, v74
    v_mul_hi_u32_u24 v78, 429497, v78
    v_mul_hi_u32_u24 v75, 429497, v75
    v_mul_hi_u32_u24 v79, 429497, v79
    v_lshl_or_b32 v72, v76, 16, v72
    v_lshl_or_b32 v73, v77, 16, v73
    v_lshl_or_b32 v74, v78, 16, v74
    v_lshl_or_b32 v75, v79, 16, v75
    v_dot2_u32_u16 v76, v72, s38, 0
    v_dot2_u32_u16 v77, v73, s38, 0
    v_dot2_u32_u16 v78, v74, s38, 0
    v_dot2_u32_u16 v79, v75, s38, 0
    v_pk_mad_u16 v6, v72, s37, v6
    v_pk_mad_u16 v7, v73, s37, v7
    v_pk_mad_u16 v8, v74, s37, v8
    v_pk_mad_u16 v9, v75, s37, v9
    ds_add_u32 v76, v4 offset:0
    ds_add_u32 v77, v4 offset:0
    ds_add_u32 v78, v4 offset:0
    ds_add_u32 v79, v4 offset:0
    v_pk_mad_u16 v6, v72, s52, v6 op_sel:[1,0,0] op_sel_hi:[1,1,1]
    v_pk_mad_u16 v7, v73, s52, v7 op_sel:[1,0,0] op_sel_hi:[1,1,1]
    v_pk_mad_u16 v8, v74, s52, v8 op_sel:[1,0,0] op_sel_hi:[1,1,1]
    v_pk_mad_u16 v9, v75, s52, v9 op_sel:[1,0,0] op_sel_hi:[1,1,1]
    v_perm_b32 v59, v79, v78, s43
    v_perm_b32 v55, v77, v76, s43
    v_or_b32 v68, 0x40000000, v6
    v_or_b32 v69, 0x40000000, v7
    v_or_b32 v70, 0x40000000, v8
    v_or_b32 v72, 0x40000000, v9
    s_waitcnt vmcnt(8)
    v_perm_b32 v6, v100, v80, s43
    v_perm_b32 v7, v101, v81, s43
    v_perm_b32 v8, v102, v82, s43
    v_perm_b32 v9, v103, v83, s43
    v_mul_hi_u32_u24 v80, 429497, v80
    v_mul_hi_u32_u24 v100, 429497, v100
    v_mul_hi_u32_u24 v81, 429497, v81
    v_mul_hi_u32_u24 v101, 429497, v101
    v_mul_hi_u32_u24 v82, 429497, v82
    v_mul_hi_u32_u24 v102, 429497, v102
    v_mul_hi_u32_u24 v83, 429497, v83
    v_mul_hi_u32_u24 v103, 429497, v103
    v_lshl_or_b32 v80, v100, 16, v80
    v_lshl_or_b32 v81, v101, 16, v81
    v_lshl_or_b32 v82, v102, 16, v82
    v_lshl_or_b32 v83, v103, 16, v83
    v_dot2_u32_u16 v100, v80, s38, 0
    v_dot2_u32_u16 v101, v81, s38, 0
    v_dot2_u32_u16 v102, v82, s38, 0
    v_dot2_u32_u16 v103, v83, s38, 0
    v_pk_mad_u16 v6, v80, s37, v6
    v_pk_mad_u16 v7, v81, s37, v7
    v_pk_mad_u16 v8, v82, s37, v8
    v_pk_mad_u16 v9, v83, s37, v9
    ds_add_u32 v100, v4 offset:0
    ds_add_u32 v101, v4 offset:0
    ds_add_u32 v102, v4 offset:0
    ds_add_u32 v103, v4 offset:0
    v_pk_mad_u16 v6, v80, s52, v6 op_sel:[1,0,0] op_sel_hi:[1,1,1]
    v_pk_mad_u16 v7, v81, s52, v7 op_sel:[1,0,0] op_sel_hi:[1,1,1]
    v_pk_mad_u16 v8, v82, s52, v8 op_sel:[1,0,0] op_sel_hi:[1,1,1]
    v_pk_mad_u16 v9, v83, s52, v9 op_sel:[1,0,0] op_sel_hi:[1,1,1]
    v_perm_b32 v67, v103, v102, s43
    v_perm_b32 v63, v101, v100, s43
    v_or_b32 v73, 0x40000000, v6
    v_or_b32 v74, 0x40000000, v7
    v_or_b32 v76, 0x40000000, v8
    v_or_b32 v77, 0x40000000, v9
    s_waitcnt vmcnt(6)
    v_perm_b32 v6, v104, v84, s43
    v_perm_b32 v7, v105, v85, s43
    v_perm_b32 v8, v106, v86, s43
    v_perm_b32 v9, v107, v87, s43
    v_mul_hi_u32_u24 v84, 429497, v84
    v_mul_hi_u32_u24 v104, 429497, v104
    v_mul_hi_u32_u24 v85, 429497, v85
    v_mul_hi_u32_u24 v105, 429497, v105
    v_mul_hi_u32_u24 v86, 429497, v86
    v_mul_hi_u32_u24 v106, 429497, v106
    v_mul_hi_u32_u24 v87, 429497, v87
    v_mul_hi_u32_u24 v107, 429497, v107
    v_lshl_or_b32 v84, v104, 16, v84
    v_lshl_or_b32 v85, v105, 16, v85
    v_lshl_or_b32 v86, v106, 16, v86
    v_lshl_or_b32 v87, v107, 16, v87
    v_dot2_u32_u16 v104, v84, s38, 0
    v_dot2_u32_u16 v105, v85, s38, 0
    v_dot2_u32_u16 v106, v86, s38, 0
    v_dot2_u32_u16 v107, v87, s38, 0
    v_pk_mad_u16 v6, v84, s37, v6
    v_pk_mad_u16 v7, v85, s37, v7
    v_pk_mad_u16 v8, v86, s37, v8
    v_pk_mad_u16 v9, v87, s37, v9
    ds_add_u32 v104, v4 offset:0
    ds_add_u32 v105, v4 offset:0
    ds_add_u32 v106, v4 offset:0
    ds_add_u32 v107, v4 offset:0
    v_pk_mad_u16 v6, v84, s52, v6 op_sel:[1,0,0] op_sel_hi:[1,1,1]
    v_pk_mad_u16 v7, v85, s52, v7 op_sel:[1,0,0] op_sel_hi:[1,1,1]
    v_pk_mad_u16 v8, v86, s52, v8 op_sel:[1,0,0] op_sel_hi:[1,1,1]
    v_pk_mad_u16 v9, v87, s52, v9 op_sel:[1,0,0] op_sel_hi:[1,1,1]
    v_perm_b32 v75, v107, v106, s43
    v_perm_b32 v71, v105, v104, s43
    v_or_b32 v78, 0x40000000, v6
    v_or_b32 v80, 0x40000000, v7
    v_or_b32 v81, 0x40000000, v8
    v_or_b32 v82, 0x40000000, v9
    s_waitcnt vmcnt(4)
    v_perm_b32 v6, v108, v88, s43
    v_perm_b32 v7, v109, v89, s43
    v_perm_b32 v8, v110, v90, s43
    v_perm_b32 v9, v111, v91, s43
    v_mul_hi_u32_u24 v88, 429497, v88
    v_mul_hi_u32_u24 v108, 429497, v108
    v_mul_hi_u32_u24 v89, 429497, v89
    v_mul_hi_u32_u24 v109, 429497, v109
    v_mul_hi_u32_u24 v90, 429497, v90
    v_mul_hi_u32_u24 v110, 429497, v110
    v_mul_hi_u32_u24 v91, 429497, v91
    v_mul_hi_u32_u24 v111, 429497, v111
    v_lshl_or_b32 v88, v108, 16, v88
    v_lshl_or_b32 v89, v109, 16, v89
    v_lshl_or_b32 v90, v110, 16, v90
    v_lshl_or_b32 v91, v111, 16, v91
    v_dot2_u32_u16 v108, v88, s38, 0
    v_dot2_u32_u16 v109, v89, s38, 0
    v_dot2_u32_u16 v110, v90, s38, 0
    v_dot2_u32_u16 v111, v91, s38, 0
    v_pk_mad_u16 v6, v88, s37, v6
    v_pk_mad_u16 v7, v89, s37, v7
    v_pk_mad_u16 v8, v90, s37, v8
    v_pk_mad_u16 v9, v91, s37, v9
    ds_add_u32 v108, v4 offset:0
    ds_add_u32 v109, v4 offset:0
    ds_add_u32 v110, v4 offset:0
    ds_add_u32 v111, v4 offset:0
    v_pk_mad_u16 v6, v88, s52, v6 op_sel:[1,0,0] op_sel_hi:[1,1,1]
    v_pk_mad_u16 v7, v89, s52, v7 op_sel:[1,0,0] op_sel_hi:[1,1,1]
    v_pk_mad_u16 v8, v90, s52, v8 op_sel:[1,0,0] op_sel_hi:[1,1,1]
    v_pk_mad_u16 v9, v91, s52, v9 op_sel:[1,0,0] op_sel_hi:[1,1,1]
    v_perm_b32 v83, v111, v110, s43
    v_perm_b32 v79, v109, v108, s43
    v_or_b32 v84, 0x40000000, v6
    v_or_b32 v85, 0x40000000, v7
    v_or_b32 v86, 0x40000000, v8
    v_or_b32 v88, 0x40000000, v9
    s_waitcnt vmcnt(2)
    v_perm_b32 v6, v112, v92, s43
    v_perm_b32 v7, v113, v93, s43
    v_perm_b32 v8, v114, v94, s43
    v_perm_b32 v9, v115, v95, s43
    v_mul_hi_u32_u24 v92, 429497, v92
    v_mul_hi_u32_u24 v112, 429497, v112
    v_mul_hi_u32_u24 v93, 429497, v93
    v_mul_hi_u32_u24 v113, 429497, v113
    v_mul_hi_u32_u24 v94, 429497, v94
    v_mul_hi_u32_u24 v114, 429497, v114
    v_mul_hi_u32_u24 v95, 429497, v95
    v_mul_hi_u32_u24 v115, 429497, v115
    v_lshl_or_b32 v92, v112, 16, v92
    v_lshl_or_b32 v93, v113, 16, v93
    v_lshl_or_b32 v94, v114, 16, v94
    v_lshl_or_b32 v95, v115, 16, v95
    v_dot2_u32_u16 v112, v92, s38, 0
    v_dot2_u32_u16 v113, v93, s38, 0
    v_dot2_u32_u16 v114, v94, s38, 0
    v_dot2_u32_u16 v115, v95, s38, 0
    v_pk_mad_u16 v6, v92, s37, v6
    v_pk_mad_u16 v7, v93, s37, v7
    v_pk_mad_u16 v8, v94, s37, v8
    v_pk_mad_u16 v9, v95, s37, v9
    ds_add_u32 v112, v4 offset:0
    ds_add_u32 v113, v4 offset:0
    ds_add_u32 v114, v4 offset:0
    ds_add_u32 v115, v4 offset:0
    v_pk_mad_u16 v6, v92, s52, v6 op_sel:[1,0,0] op_sel_hi:[1,1,1]
    v_pk_mad_u16 v7, v93, s52, v7 op_sel:[1,0,0] op_sel_hi:[1,1,1]
    v_pk_mad_u16 v8, v94, s52, v8 op_sel:[1,0,0] op_sel_hi:[1,1,1]
    v_pk_mad_u16 v9, v95, s52, v9 op_sel:[1,0,0] op_sel_hi:[1,1,1]
    v_perm_b32 v91, v115, v114, s43
    v_perm_b32 v87, v113, v112, s43
    v_or_b32 v89, 0x40000000, v6
    v_or_b32 v90, 0x40000000, v7
    v_or_b32 v92, 0x40000000, v8
    v_or_b32 v93, 0x40000000, v9
    s_waitcnt vmcnt(0)
    s_mov_b64 exec, s[44:45]
    v_perm_b32 v6, v116, v96, s43
    v_perm_b32 v7, v117, v97, s43
    v_perm_b32 v8, v118, v98, s43
    v_perm_b32 v9, v119, v99, s43
    v_mul_hi_u32_u24 v96, 429497, v96
    v_mul_hi_u32_u24 v116, 429497, v116
    v_mul_hi_u32_u24 v97, 429497, v97
    v_mul_hi_u32_u24 v117, 429497, v117
    v_mul_hi_u32_u24 v98, 429497, v98
    v_mul_hi_u32_u24 v118, 429497, v118
    v_mul_hi_u32_u24 v99, 429497, v99
    v_mul_hi_u32_u24 v119, 429497, v119
    v_lshl_or_b32 v96, v116, 16, v96
    v_lshl_or_b32 v97, v117, 16, v97
    v_lshl_or_b32 v98, v118, 16, v98
    v_lshl_or_b32 v99, v119, 16, v99
    v_dot2_u32_u16 v116, v96, s38, 0
    v_dot2_u32_u16 v117, v97, s38, 0
    v_dot2_u32_u16 v118, v98, s38, 0
    v_dot2_u32_u16 v119, v99, s38, 0
    v_pk_mad_u16 v6, v96, s37, v6
    v_pk_mad_u16 v7, v97, s37, v7
    v_pk_mad_u16 v8, v98, s37, v8
    v_pk_mad_u16 v9, v99, s37, v9
    ds_add_u32 v116, v4 offset:0
    ds_add_u32 v117, v4 offset:0
    ds_add_u32 v118, v4 offset:0
    ds_add_u32 v119, v4 offset:0
    v_pk_mad_u16 v6, v96, s52, v6 op_sel:[1,0,0] op_sel_hi:[1,1,1]
    v_pk_mad_u16 v7, v97, s52, v7 op_sel:[1,0,0] op_sel_hi:[1,1,1]
    v_pk_mad_u16 v8, v98, s52, v8 op_sel:[1,0,0] op_sel_hi:[1,1,1]
    v_pk_mad_u16 v9, v99, s52, v9 op_sel:[1,0,0] op_sel_hi:[1,1,1]
    v_perm_b32 v99, v119, v118, s43
    v_perm_b32 v95, v117, v116, s43
    v_or_b32 v94, 0x40000000, v6
    v_or_b32 v96, 0x40000000, v7
    v_or_b32 v97, 0x40000000, v8
    v_or_b32 v98, 0x40000000, v9
    s_mov_b64 exec, -1
    s_add_u32 s35, s34, 0
    buffer_load_dwordx2 v[100:101], v2, s[16:19], s35 offen nt
    s_lshl_b32 s35, s32, 10
    s_add_u32 s35, s35, 9437184
    s_add_u32 s20, s4, s35
    s_addc_u32 s21, s5, 0
    s_lshl2_add_u32 s35, s39, 160768
    v_mov_b32 v13, s35
    v_mov_b32 v7, 2.0
    v_and_b32 v6, 63, v0
    s_mov_b32 s36, 160768
    s_lshl_b32 s35, 0x1fffe, s39
    s_and_b32 s35, s35, 0x1ffff
    s_mov_b32 exec_hi, 0
    s_mov_b32 exec_lo, s35
    v_lshl_add_u32 v7, v6, 2, s36
    s_mov_b64 exec, -1
    v_mov_b32 v14, 160832
    s_mov_b32 s53, 2
    s_waitcnt lgkmcnt(0)
    s_barrier
    ds_read_b128 v[8:11], v1 offset:0
    s_add_u32 s35, s34, 2097152
    buffer_load_dwordx2 v[102:103], v2, s[16:19], s35 offen nt
L_p1_redo:
    s_waitcnt lgkmcnt(0)
    v_min3_u32 v12, v8, v9, v10
    v_min_u32 v12, v12, v11
    v_cmp_gt_u32 vcc, s53, v12
    s_nop 0
    s_mov_b64 s[46:47], vcc
    s_cbranch_vccz L_p1_kernel_nomask_25
    v_cmp_eq_u32 s[56:57], 0, v8
    v_cmp_ge_u32 s[64:65], 1, v8
    v_max_u32 v8, 2, v8
    v_cmp_eq_u32 s[58:59], 0, v9
    v_cmp_ge_u32 s[66:67], 1, v9
    v_max_u32 v9, 2, v9
    v_cmp_eq_u32 s[60:61], 0, v10
    v_cmp_ge_u32 s[68:69], 1, v10
    v_max_u32 v10, 2, v10
    v_cmp_eq_u32 s[62:63], 0, v11
    v_cmp_ge_u32 s[70:71], 1, v11
    v_max_u32 v11, 2, v11
L_p1_kernel_nomask_25:
    v_add_u32 v9, v8, v9
    v_add_u32 v10, v9, v10
    v_add_u32 v11, v10, v11
    s_nop 1
    v_add_u32_dpp v6, v11, v11 row_shr:1 row_mask:0xf bank_mask:0xf bound_ctrl:0
    s_nop 1
    v_add_u32_dpp v6, v6, v6 row_shr:2 row_mask:0xf bank_mask:0xf bound_ctrl:0
    s_nop 1
    v_add_u32_dpp v6, v6, v6 row_shr:4 row_mask:0xf bank_mask:0xf bound_ctrl:0
    s_nop 1
    v_add_u32_dpp v6, v6, v6 row_shr:8 row_mask:0xf bank_mask:0xf bound_ctrl:0
    s_nop 1
    v_add_u32_dpp v6, v6, v6 row_bcast:15 row_mask:0xa bank_mask:0xf
    s_nop 1
    v_add_u32_dpp v6, v6, v6 row_bcast:31 row_mask:0xc bank_mask:0xf
    s_nop 0
    v_readlane_b32 s35, v6, 63
    v_sub_u32 v6, v6, v11
    v_add_u32 v8, v8, v6
    v_mov_b32 v12, s35
    ds_add_u32 v7, v12
    v_add_u32 v9, v9, v6
    v_add_u32 v10, v10, v6
    s_waitcnt lgkmcnt(0)
    s_barrier
    ds_read_b32 v12, v14
    ds_read_b32 v11, v13
    s_add_u32 s35, s34, 4194304
    buffer_load_dwordx2 v[104:105], v2, s[16:19], s35 offen nt
    s_waitcnt lgkmcnt(1)
    v_readfirstlane_b32 s54, v12
    s_waitcnt lgkmcnt(0)
    s_cmp_ge_u32 s54, 40063
    s_cbranch_scc0 L_p1_fits
    s_barrier
    v_mov_b32 v12, 0
    ds_write_b32 v7, v12
    s_mov_b32 s53, 0
    s_mov_b32 s55, 1
    s_waitcnt lgkmcnt(0)
    s_barrier
    ds_read_b128 v[8:11], v1 offset:0
    s_branch L_p1_redo
L_p1_fits:
    s_mov_b64 exec, 1
    v_mov_b32 v7, 24576
    ds_write_b16 v7, v12
    s_mov_b64 exec, -1
    v_add_u32 v12, v11, v6
    v_add_u32 v13, v11, v8
    v_add_u32 v14, v11, v9
    v_add_u32 v15, v11, v10
    ds_write_b128 v1, v[12:15] offset:0
    s_add_u32 s35, s54, 2
    s_mul_hi_u32 s35, s35, 1431655766
    v_perm_b32 v15, v15, v14, s43
    v_perm_b32 v14, v13, v12, s43
    ds_write_b64 v2, v[14:15] offset:16384
    s_lshl_b32 s35, s35, 4
    s_add_u32 s35, s35, 217890943
    s_andn2_b32 s35, s35, 127
    s_min_u32 s22, s35, 218104832
    s_waitcnt lgkmcnt(0)
    s_barrier
    s_nop 0
    v_and_b32 v6, 0xffff, v120
    v_lshrrev_b32 v7, 16, v120
    v_and_b32 v8, 0xffff, v121
    v_lshrrev_b32 v9, 16, v121
    ds_add_rtn_u32 v6, v6, v4 offset:0
    ds_add_rtn_u32 v7, v7, v4 offset:0
    ds_add_rtn_u32 v8, v8, v4 offset:0
    ds_add_rtn_u32 v9, v9, v4 offset:0
    v_and_b32 v10, 0xffff, v122
    v_lshrrev_b32 v11, 16, v122
    v_and_b32 v12, 0xffff, v123
    v_lshrrev_b32 v13, 16, v123
    ds_add_rtn_u32 v10, v10, v4 offset:0
    ds_add_rtn_u32 v11, v11, v4 offset:0
    ds_add_rtn_u32 v12, v12, v4 offset:0
    ds_add_rtn_u32 v13, v13, v4 offset:0
    s_waitcnt lgkmcnt(4)
    v_perm_b32 v120, v7, v6, s43
    v_perm_b32 v121, v9, v8, s43
    v_and_b32 v6, 0xffff, v124
    v_lshrrev_b32 v7, 16, v124
    v_and_b32 v8, 0xffff, v125
    v_lshrrev_b32 v9, 16, v125
    ds_add_rtn_u32 v6, v6, v4 offset:0
    ds_add_rtn_u32 v7, v7, v4 offset:0
    ds_add_rtn_u32 v8, v8, v4 offset:0
    ds_add_rtn_u32 v9, v9, v4 offset:0
    s_waitcnt lgkmcnt(4)
    v_perm_b32 v122, v11, v10, s43
    v_perm_b32 v123, v13, v12, s43
    s_add_u32 s35, s34, 6291456
    buffer_load_dwordx2 v[106:107], v2, s[16:19], s35 offen nt
    v_and_b32 v10, 0xffff, v126
    v_lshrrev_b32 v11, 16, v126
    v_and_b32 v12, 0xffff, v51
    v_lshrrev_b32 v13, 16, v51
    ds_add_rtn_u32 v10, v10, v4 offset:0
    ds_add_rtn_u32 v11, v11, v4 offset:0
    ds_add_rtn_u32 v12, v12, v4 offset:0
    ds_add_rtn_u32 v13, v13, v4 offset:0
    s_waitcnt lgkmcnt(4)
    v_perm_b32 v124, v7, v6, s43
    v_perm_b32 v125, v9, v8, s43
    s_add_u32 s35, s34, 8388608
    buffer_load_dwordx2 v[108:109], v2, s[16:19], s35 offen nt
    v_and_b32 v6, 0xffff, v55
    v_lshrrev_b32 v7, 16, v55
    v_and_b32 v8, 0xffff, v59
    v_lshrrev_b32 v9, 16, v59
    ds_add_rtn_u32 v6, v6, v4 offset:0
    ds_add_rtn_u32 v7, v7, v4 offset:0
    ds_add_rtn_u32 v8, v8, v4 offset:0
    ds_add_rtn_u32 v9, v9, v4 offset:0
    s_waitcnt lgkmcnt(4)
    v_perm_b32 v126, v11, v10, s43
    v_perm_b32 v51, v13, v12, s43
    s_add_u32 s35, s34, 10485760
    buffer_load_dwordx2 v[110:111], v2, s[16:19], s35 offen nt
    v_and_b32 v10, 0xffff, v63
    v_lshrrev_b32 v11, 16, v63
    v_and_b32 v12, 0xffff, v67
    v_lshrrev_b32 v13, 16, v67
    ds_add_rtn_u32 v10, v10, v4 offset:0
    ds_add_rtn_u32 v11, v11, v4 offset:0
    ds_add_rtn_u32 v12, v12, v4 offset:0
    ds_add_rtn_u32 v13, v13, v4 offset:0
    s_waitcnt lgkmcnt(4)
    v_perm_b32 v55, v7, v6, s43
    v_perm_b32 v59, v9, v8, s43
    v_and_b32 v6, 0xffff, v71
    v_lshrrev_b32 v7, 16, v71
    v_and_b32 v8, 0xffff, v75
    v_lshrrev_b32 v9, 16, v75
    ds_add_rtn_u32 v6, v6, v4 offset:0
    ds_add_rtn_u32 v7, v7, v4 offset:0
    ds_add_rtn_u32 v8, v8, v4 offset:0
    ds_add_rtn_u32 v9, v9, v4 offset:0
    s_waitcnt lgkmcnt(4)
    v_perm_b32 v63, v11, v10, s43
    v_perm_b32 v67, v13, v12, s43
    s_add_u32 s35, s34, 12582912
    buffer_load_dwordx2 v[112:113], v2, s[16:19], s35 offen nt
    v_and_b32 v10, 0xffff, v79
    v_lshrrev_b32 v11, 16, v79
    v_and_b32 v12, 0xffff, v83
    v_lshrrev_b32 v13, 16, v83
    ds_add_rtn_u32 v10, v10, v4 offset:0
    ds_add_rtn_u32 v11, v11, v4 offset:0
    ds_add_rtn_u32 v12, v12, v4 offset:0
    ds_add_rtn_u32 v13, v13, v4 offset:0
    s_waitcnt lgkmcnt(4)
    v_perm_b32 v71, v7, v6, s43
    v_perm_b32 v75, v9, v8, s43
    s_add_u32 s35, s34, 14680064
    buffer_load_dwordx2 v[114:115], v2, s[16:19], s35 offen nt
    v_and_b32 v6, 0xffff, v87
    v_lshrrev_b32 v7, 16, v87
    v_and_b32 v8, 0xffff, v91
    v_lshrrev_b32 v9, 16, v91
    ds_add_rtn_u32 v6, v6, v4 offset:0
    ds_add_rtn_u32 v7, v7, v4 offset:0
    ds_add_rtn_u32 v8, v8, v4 offset:0
    ds_add_rtn_u32 v9, v9, v4 offset:0
    s_waitcnt lgkmcnt(4)
    v_perm_b32 v79, v11, v10, s43
    v_perm_b32 v83, v13, v12, s43
    s_add_u32 s35, s34, 16777216
    buffer_load_dwordx2 v[116:117], v2, s[16:19], s35 offen nt
    s_mov_b64 exec, s[44:45]
    v_and_b32 v10, 0xffff, v95
    v_lshrrev_b32 v11, 16, v95
    v_and_b32 v12, 0xffff, v99
    v_lshrrev_b32 v13, 16, v99
    ds_add_rtn_u32 v10, v10, v4 offset:0
    ds_add_rtn_u32 v11, v11, v4 offset:0
    ds_add_rtn_u32 v12, v12, v4 offset:0
    ds_add_rtn_u32 v13, v13, v4 offset:0
    s_mov_b64 exec, -1
    s_waitcnt lgkmcnt(4)
    v_perm_b32 v87, v7, v6, s43
    v_perm_b32 v91, v9, v8, s43
    s_add_u32 s35, s34, 18874368
    s_sub_u32 s35, s35, s49
    v_cndmask_b32 v118, 2.0, v2, s[44:45]
    buffer_load_dwordx2 v[118:119], v118, s[16:19], s35 offen nt
    s_waitcnt lgkmcnt(0)
    v_perm_b32 v95, v11, v10, s43
    v_perm_b32 v99, v13, v12, s43
    s_cmp_gt_u32 s39, 8
    s_cbranch_scc1 L_p1_kernel_notab_26
    v_lshrrev_b32 v6, 1, v0
    v_mul_u32_u24 v7, 1009, v6
    v_lshrrev_b32 v7, 16, v7
    v_mul_u32_u24 v7, 959, v7
    v_and_b32 v8, 1, v0
    v_lshl_add_u32 v7, v8, 9, v7
    v_add_lshl_u32 v13, v7, v6, 1
    ds_read_u16 v6, v13 offset:16384
    ds_read_u16 v7, v13 offset:16512
    ds_read_u16 v8, v13 offset:16640
    ds_read_u16 v9, v13 offset:16768
    ds_read_u16 v10, v13 offset:16896
    ds_read_u16 v11, v13 offset:17024
    ds_read_u16 v12, v13 offset:17152
    ds_read_u16 v13, v13 offset:17280
    s_mul_i32 s35, s32, 8320
    s_add_u32 s26, s35, 8320
    s_waitcnt lgkmcnt(6)
    v_perm_b32 v6, v7, v6, s43
    s_waitcnt lgkmcnt(4)
    v_perm_b32 v7, v9, v8, s43
    s_waitcnt lgkmcnt(2)
    v_perm_b32 v8, v11, v10, s43
    s_waitcnt lgkmcnt(0)
    v_perm_b32 v9, v13, v12, s43
    buffer_store_dwordx4 v[6:9], v1, s[24:27], s35 offen sc1
    s_nop 1
L_p1_kernel_notab_26:
    s_barrier
    s_lshl_b32 s35, s54, 2
    v_mov_b32 v6, s35
    v_mov_b32 v7, 0
    v_mov_b32 v12, 1140817920
    s_mov_b64 exec, 1
    ds_write2_b32 v6, v7, v7 offset0:0 offset1:1
    s_cmp_eq_u64 s[46:47], 0
    s_cbranch_scc1 L_p1_kernel_nonull_27
    s_mov_b64 exec, s[64:65]
    v_lshlrev_b32_sdwa v6, 2, v14 dst_sel:DWORD dst_unused:UNUSED_PAD src0_sel:DWORD src1_sel:WORD_0
    ds_write_b32 v6, v7 offset:4
    s_mov_b64 exec, s[56:57]
    ds_write_b32 v6, v7
    s_mov_b64 exec, s[66:67]
    v_lshlrev_b32_sdwa v6, 2, v14 dst_sel:DWORD dst_unused:UNUSED_PAD src0_sel:DWORD src1_sel:WORD_1
    ds_write_b32 v6, v7 offset:4
    s_mov_b64 exec, s[58:59]
    ds_write_b32 v6, v7
    s_mov_b64 exec, s[68:69]
    v_lshlrev_b32_sdwa v6, 2, v15 dst_sel:DWORD dst_unused:UNUSED_PAD src0_sel:DWORD src1_sel:WORD_0
    ds_write_b32 v6, v7 offset:4
    s_mov_b64 exec, s[60:61]
    ds_write_b32 v6, v7
    s_mov_b64 exec, s[70:71]
    v_lshlrev_b32_sdwa v6, 2, v15 dst_sel:DWORD dst_unused:UNUSED_PAD src0_sel:DWORD src1_sel:WORD_1
    ds_write_b32 v6, v7 offset:4
    s_mov_b64 exec, s[62:63]
    ds_write_b32 v6, v7
L_p1_kernel_nonull_27:
    s_mov_b64 exec, -1
    v_lshlrev_b32_sdwa v6, 2, v120 dst_sel:DWORD dst_unused:UNUSED_PAD src0_sel:DWORD src1_sel:WORD_0
    v_lshlrev_b32_sdwa v7, 2, v120 dst_sel:DWORD dst_unused:UNUSED_PAD src0_sel:DWORD src1_sel:WORD_1
    v_lshlrev_b32_sdwa v8, 2, v121 dst_sel:DWORD dst_unused:UNUSED_PAD src0_sel:DWORD src1_sel:WORD_0
    v_lshlrev_b32_sdwa v9, 2, v121 dst_sel:DWORD dst_unused:UNUSED_PAD src0_sel:DWORD src1_sel:WORD_1
    ds_write_b32 v6, v127
    ds_write_b32 v7, v48
    ds_write_b32 v8, v49
    ds_write_b32 v9, v50
    s_cmp_lg_u32 s40, 3
    s_cbranch_scc1 L_p1_kernel_ld_28
    s_mov_b32 s36, 4194304
    buffer_store_dwordx4 v[16:19], v3, s[72:75], s36 offen sc1
    s_branch L_p1_kernel_st_29
L_p1_kernel_ld_28:
    s_add_u32 s35, s33, 40960000
    buffer_load_dwordx4 v[16:19], v1, s[8:11], s35 offen nt
L_p1_kernel_st_29:
    v_lshlrev_b32_sdwa v6, 2, v122 dst_sel:DWORD dst_unused:UNUSED_PAD src0_sel:DWORD src1_sel:WORD_0
    v_lshlrev_b32_sdwa v7, 2, v122 dst_sel:DWORD dst_unused:UNUSED_PAD src0_sel:DWORD src1_sel:WORD_1
    v_lshlrev_b32_sdwa v8, 2, v123 dst_sel:DWORD dst_unused:UNUSED_PAD src0_sel:DWORD src1_sel:WORD_0
    v_lshlrev_b32_sdwa v9, 2, v123 dst_sel:DWORD dst_unused:UNUSED_PAD src0_sel:DWORD src1_sel:WORD_1
    ds_write_b32 v6, v52
    ds_write_b32 v7, v53
    ds_write_b32 v8, v54
    ds_write_b32 v9, v56
    v_lshlrev_b32_sdwa v6, 2, v124 dst_sel:DWORD dst_unused:UNUSED_PAD src0_sel:DWORD src1_sel:WORD_0
    v_lshlrev_b32_sdwa v7, 2, v124 dst_sel:DWORD dst_unused:UNUSED_PAD src0_sel:DWORD src1_sel:WORD_1
    v_lshlrev_b32_sdwa v8, 2, v125 dst_sel:DWORD dst_unused:UNUSED_PAD src0_sel:DWORD src1_sel:WORD_0
    v_lshlrev_b32_sdwa v9, 2, v125 dst_sel:DWORD dst_unused:UNUSED_PAD src0_sel:DWORD src1_sel:WORD_1
    ds_write_b32 v6, v57
    ds_write_b32 v7, v58
    ds_write_b32 v8, v60
    ds_write_b32 v9, v61
    v_lshlrev_b32_sdwa v6, 2, v126 dst_sel:DWORD dst_unused:UNUSED_PAD src0_sel:DWORD src1_sel:WORD_0
    v_lshlrev_b32_sdwa v7, 2, v126 dst_sel:DWORD dst_unused:UNUSED_PAD src0_sel:DWORD src1_sel:WORD_1
    v_lshlrev_b32_sdwa v8, 2, v51 dst_sel:DWORD dst_unused:UNUSED_PAD src0_sel:DWORD src1_sel:WORD_0
    v_lshlrev_b32_sdwa v9, 2, v51 dst_sel:DWORD dst_unused:UNUSED_PAD src0_sel:DWORD src1_sel:WORD_1
    ds_write_b32 v6, v62
    ds_write_b32 v7, v64
    ds_write_b32 v8, v65
    ds_write_b32 v9, v66
    s_cmp_lg_u32 s40, 3
    s_cbranch_scc1 L_p1_kernel_ld_30
    s_mov_b32 s36, 6291456
    buffer_store_dwordx4 v[20:23], v3, s[72:75], s36 offen sc1
    s_branch L_p1_kernel_st_31
L_p1_kernel_ld_30:
    s_add_u32 s35, s33, 40960000
    buffer_load_dwordx4 v[20:23], v1, s[12:15], s35 offen nt
L_p1_kernel_st_31:
    v_lshlrev_b32_sdwa v6, 2, v55 dst_sel:DWORD dst_unused:UNUSED_PAD src0_sel:DWORD src1_sel:WORD_0
    v_lshlrev_b32_sdwa v7, 2, v55 dst_sel:DWORD dst_unused:UNUSED_PAD src0_sel:DWORD src1_sel:WORD_1
    v_lshlrev_b32_sdwa v8, 2, v59 dst_sel:DWORD dst_unused:UNUSED_PAD src0_sel:DWORD src1_sel:WORD_0
    v_lshlrev_b32_sdwa v9, 2, v59 dst_sel:DWORD dst_unused:UNUSED_PAD src0_sel:DWORD src1_sel:WORD_1
    ds_write_b32 v6, v68
    ds_write_b32 v7, v69
    ds_write_b32 v8, v70
    ds_write_b32 v9, v72
    v_lshlrev_b32_sdwa v6, 2, v63 dst_sel:DWORD dst_unused:UNUSED_PAD src0_sel:DWORD src1_sel:WORD_0
    v_lshlrev_b32_sdwa v7, 2, v63 dst_sel:DWORD dst_unused:UNUSED_PAD src0_sel:DWORD src1_sel:WORD_1
    v_lshlrev_b32_sdwa v8, 2, v67 dst_sel:DWORD dst_unused:UNUSED_PAD src0_sel:DWORD src1_sel:WORD_0
    v_lshlrev_b32_sdwa v9, 2, v67 dst_sel:DWORD dst_unused:UNUSED_PAD src0_sel:DWORD src1_sel:WORD_1
    ds_write_b32 v6, v73
    ds_write_b32 v7, v74
    ds_write_b32 v8, v76
    ds_write_b32 v9, v77
    v_lshlrev_b32_sdwa v6, 2, v71 dst_sel:DWORD dst_unused:UNUSED_PAD src0_sel:DWORD src1_sel:WORD_0
    v_lshlrev_b32_sdwa v7, 2, v71 dst_sel:DWORD dst_unused:UNUSED_PAD src0_sel:DWORD src1_sel:WORD_1
    v_lshlrev_b32_sdwa v8, 2, v75 dst_sel:DWORD dst_unused:UNUSED_PAD src0_sel:DWORD src1_sel:WORD_0
    v_lshlrev_b32_sdwa v9, 2, v75 dst_sel:DWORD dst_unused:UNUSED_PAD src0_sel:DWORD src1_sel:WORD_1
    ds_write_b32 v6, v78
    ds_write_b32 v7, v80
    ds_write_b32 v8, v81
    ds_write_b32 v9, v82
    s_cmp_lg_u32 s40, 3
    s_cbranch_scc1 L_p1_kernel_ld_32
    s_mov_b32 s36, 7340032
    buffer_store_dwordx4 v[24:27], v3, s[72:75], s36 offen sc1
    s_branch L_p1_kernel_st_33
L_p1_kernel_ld_32:
    s_add_u32 s35, s33, 45154304
    buffer_load_dwordx4 v[24:27], v1, s[8:11], s35 offen nt
L_p1_kernel_st_33:
    v_lshlrev_b32_sdwa v6, 2, v79 dst_sel:DWORD dst_unused:UNUSED_PAD src0_sel:DWORD src1_sel:WORD_0
    v_lshlrev_b32_sdwa v7, 2, v79 dst_sel:DWORD dst_unused:UNUSED_PAD src0_sel:DWORD src1_sel:WORD_1
    v_lshlrev_b32_sdwa v8, 2, v83 dst_sel:DWORD dst_unused:UNUSED_PAD src0_sel:DWORD src1_sel:WORD_0
    v_lshlrev_b32_sdwa v9, 2, v83 dst_sel:DWORD dst_unused:UNUSED_PAD src0_sel:DWORD src1_sel:WORD_1
    ds_write_b32 v6, v84
    ds_write_b32 v7, v85
    ds_write_b32 v8, v86
    ds_write_b32 v9, v88
    v_lshlrev_b32_sdwa v6, 2, v87 dst_sel:DWORD dst_unused:UNUSED_PAD src0_sel:DWORD src1_sel:WORD_0
    v_lshlrev_b32_sdwa v7, 2, v87 dst_sel:DWORD dst_unused:UNUSED_PAD src0_sel:DWORD src1_sel:WORD_1
    v_lshlrev_b32_sdwa v8, 2, v91 dst_sel:DWORD dst_unused:UNUSED_PAD src0_sel:DWORD src1_sel:WORD_0
    v_lshlrev_b32_sdwa v9, 2, v91 dst_sel:DWORD dst_unused:UNUSED_PAD src0_sel:DWORD src1_sel:WORD_1
    ds_write_b32 v6, v89
    ds_write_b32 v7, v90
    ds_write_b32 v8, v92
    ds_write_b32 v9, v93
    s_mov_b64 exec, s[44:45]
    v_lshlrev_b32_sdwa v6, 2, v95 dst_sel:DWORD dst_unused:UNUSED_PAD src0_sel:DWORD src1_sel:WORD_0
    v_lshlrev_b32_sdwa v7, 2, v95 dst_sel:DWORD dst_unused:UNUSED_PAD src0_sel:DWORD src1_sel:WORD_1
    v_lshlrev_b32_sdwa v8, 2, v99 dst_sel:DWORD dst_unused:UNUSED_PAD src0_sel:DWORD src1_sel:WORD_0
    v_lshlrev_b32_sdwa v9, 2, v99 dst_sel:DWORD dst_unused:UNUSED_PAD src0_sel:DWORD src1_sel:WORD_1
    ds_write_b32 v6, v94
    ds_write_b32 v7, v96
    ds_write_b32 v8, v97
    ds_write_b32 v9, v98
    s_mov_b64 exec, -1
    s_cmp_lg_u32 s40, 3
    s_cbranch_scc1 L_p1_kernel_ld_34
    s_mov_b32 s36, 8388608
    buffer_store_dwordx4 v[28:31], v3, s[72:75], s36 offen sc1
    s_branch L_p1_kernel_st_35
L_p1_kernel_ld_34:
    s_add_u32 s35, s33, 45154304
    buffer_load_dwordx4 v[28:31], v1, s[12:15], s35 offen nt
L_p1_kernel_st_35:
    s_mul_i32 s35, s39, 9216
    v_mad_u32_u24 v6, v0, 12, s35
    s_waitcnt lgkmcnt(0)
    s_barrier
    s_cmp_lg_u32 s39, 15
    s_cbranch_scc1 L_p1_kernel_nox_36
    ds_read_b32 v12, v6 offset:9984
    ds_read_b32 v13, v6 offset:9988
    ds_read_b32 v14, v6 offset:9992
L_p1_kernel_nox_36:
    ds_read_b32 v48, v6 offset:1536
    ds_read_b32 v49, v6 offset:1540
    ds_read_b32 v50, v6 offset:1544
    ds_read_b32 v52, v6 offset:3072
    ds_read_b32 v53, v6 offset:3076
    ds_read_b32 v54, v6 offset:3080
    ds_read_b32 v56, v6 offset:4608
    ds_read_b32 v57, v6 offset:4612
    ds_read_b32 v58, v6 offset:4616
    ds_read_b32 v60, v6 offset:6144
    ds_read_b32 v61, v6 offset:6148
    ds_read_b32 v62, v6 offset:6152
    ds_read_b32 v64, v6 offset:7680
    ds_read_b32 v65, v6 offset:7684
    ds_read_b32 v66, v6 offset:7688
    ds_read_b32 v68, v6 offset:9216
    ds_read_b32 v69, v6 offset:9220
    ds_read_b32 v70, v6 offset:9224
    ds_read_b32 v72, v6 offset:0
    ds_read_b32 v73, v6 offset:4
    ds_read_b32 v74, v6 offset:8
    ds_read_b32 v76, v6 offset:768
    ds_read_b32 v77, v6 offset:772
    ds_read_b32 v78, v6 offset:776
    ds_read_b32 v80, v6 offset:2304
    ds_read_b32 v81, v6 offset:2308
    ds_read_b32 v82, v6 offset:2312
    ds_read_b32 v84, v6 offset:3840
    ds_read_b32 v85, v6 offset:3844
    ds_read_b32 v86, v6 offset:3848
    ds_read_b32 v88, v6 offset:5376
    ds_read_b32 v89, v6 offset:5380
    ds_read_b32 v90, v6 offset:5384
    ds_read_b32 v92, v6 offset:6912
    ds_read_b32 v93, v6 offset:6916
    ds_read_b32 v94, v6 offset:6920
    ds_read_b32 v96, v6 offset:8448
    ds_read_b32 v97, v6 offset:8452
    ds_read_b32 v98, v6 offset:8456
    s_cmp_lg_u32 s40, 3
    s_cbranch_scc1 L_p1_kernel_ld_37
    s_mov_b32 s36, 9437184
    buffer_store_dwordx4 v[32:35], v3, s[72:75], s36 offen sc1
    s_branch L_p1_kernel_st_38
L_p1_kernel_ld_37:
    s_add_u32 s35, s33, 49348608
    buffer_load_dwordx4 v[32:35], v1, s[8:11], s35 offen nt
L_p1_kernel_st_38:
    v_mov_b32 v8, 0
    v_mov_b32 v9, 0
    v_mov_b32 v10, 0
    v_mov_b32 v11, 0
    v_mov_b32 v15, 16384
    v_min_u32 v7, 16, v0
    v_lshlrev_b32 v7, 2, v7
    v_add_u32 v7, 160768, v7
    s_waitcnt lgkmcnt(0)
    s_barrier
    ds_write_b128 v1, v[8:11] offset:0
    ds_write_b32 v7, v8
    s_nop 1
    v_mov_b32 v6, 1140817920
    s_waitcnt vmcnt(14)
    v_pk_maximum3_f16 v5, v100, v101, v5
    v_mad_u32_u16 v6, v120, s50, v15 op_sel:[0,0,0,0]
    v_mad_u32_u16 v7, v120, s50, v15 op_sel:[1,0,0,0]
    v_mad_u32_u16 v8, v121, s50, v15 op_sel:[0,0,0,0]
    v_mad_u32_u16 v9, v121, s50, v15 op_sel:[1,0,0,0]
    v_add_u32_sdwa v6, v6, v120 dst_sel:DWORD dst_unused:UNUSED_PAD src0_sel:WORD_1 src1_sel:WORD_0
    v_add_u32_sdwa v7, v7, v120 dst_sel:DWORD dst_unused:UNUSED_PAD src0_sel:WORD_1 src1_sel:WORD_1
    v_add_u32_sdwa v8, v8, v121 dst_sel:DWORD dst_unused:UNUSED_PAD src0_sel:WORD_1 src1_sel:WORD_0
    v_add_u32_sdwa v9, v9, v121 dst_sel:DWORD dst_unused:UNUSED_PAD src0_sel:WORD_1 src1_sel:WORD_1
    v_add_u32 v6, v6, v6
    v_add_u32 v7, v7, v7
    v_add_u32 v8, v8, v8
    v_add_u32 v9, v9, v9
    ds_write_b16 v6, v100 offset:16384
    ds_write_b16_d16_hi v7, v100 offset:16384
    ds_write_b16 v8, v101 offset:16384
    ds_write_b16_d16_hi v9, v101 offset:16384
    v_mov_b32 v6, 1140817920
    s_waitcnt vmcnt(13)
    v_pk_maximum3_f16 v5, v102, v103, v5
    v_mad_u32_u16 v6, v122, s50, v15 op_sel:[0,0,0,0]
    v_mad_u32_u16 v7, v122, s50, v15 op_sel:[1,0,0,0]
    v_mad_u32_u16 v8, v123, s50, v15 op_sel:[0,0,0,0]
    v_mad_u32_u16 v9, v123, s50, v15 op_sel:[1,0,0,0]
    v_add_u32_sdwa v6, v6, v122 dst_sel:DWORD dst_unused:UNUSED_PAD src0_sel:WORD_1 src1_sel:WORD_0
    v_add_u32_sdwa v7, v7, v122 dst_sel:DWORD dst_unused:UNUSED_PAD src0_sel:WORD_1 src1_sel:WORD_1
    v_add_u32_sdwa v8, v8, v123 dst_sel:DWORD dst_unused:UNUSED_PAD src0_sel:WORD_1 src1_sel:WORD_0
    v_add_u32_sdwa v9, v9, v123 dst_sel:DWORD dst_unused:UNUSED_PAD src0_sel:WORD_1 src1_sel:WORD_1
    v_add_u32 v6, v6, v6
    v_add_u32 v7, v7, v7
    v_add_u32 v8, v8, v8
    v_add_u32 v9, v9, v9
    ds_write_b16 v6, v102 offset:16384
    ds_write_b16_d16_hi v7, v102 offset:16384
    ds_write_b16 v8, v103 offset:16384
    ds_write_b16_d16_hi v9, v103 offset:16384
    v_mov_b32 v6, 1140817920
    s_waitcnt vmcnt(12)
    v_pk_maximum3_f16 v5, v104, v105, v5
    v_mad_u32_u16 v6, v124, s50, v15 op_sel:[0,0,0,0]
    v_mad_u32_u16 v7, v124, s50, v15 op_sel:[1,0,0,0]
    v_mad_u32_u16 v8, v125, s50, v15 op_sel:[0,0,0,0]
    v_mad_u32_u16 v9, v125, s50, v15 op_sel:[1,0,0,0]
    v_add_u32_sdwa v6, v6, v124 dst_sel:DWORD dst_unused:UNUSED_PAD src0_sel:WORD_1 src1_sel:WORD_0
    v_add_u32_sdwa v7, v7, v124 dst_sel:DWORD dst_unused:UNUSED_PAD src0_sel:WORD_1 src1_sel:WORD_1
    v_add_u32_sdwa v8, v8, v125 dst_sel:DWORD dst_unused:UNUSED_PAD src0_sel:WORD_1 src1_sel:WORD_0
    v_add_u32_sdwa v9, v9, v125 dst_sel:DWORD dst_unused:UNUSED_PAD src0_sel:WORD_1 src1_sel:WORD_1
    v_add_u32 v6, v6, v6
    v_add_u32 v7, v7, v7
    v_add_u32 v8, v8, v8
    v_add_u32 v9, v9, v9
    ds_write_b16 v6, v104 offset:16384
    ds_write_b16_d16_hi v7, v104 offset:16384
    ds_write_b16 v8, v105 offset:16384
    ds_write_b16_d16_hi v9, v105 offset:16384
    s_cmp_lg_u32 s40, 3
    s_cbranch_scc1 L_p1_kernel_ld_39
    s_mov_b32 s36, 10485760
    buffer_store_dwordx4 v[36:39], v3, s[72:75], s36 offen sc1
    s_branch L_p1_kernel_st_40
L_p1_kernel_ld_39:
    s_add_u32 s35, s33, 49348608
    buffer_load_dwordx4 v[36:39], v1, s[12:15], s35 offen nt
L_p1_kernel_st_40:
    v_mov_b32 v6, 1140817920
    s_waitcnt vmcnt(12)
    v_pk_maximum3_f16 v5, v106, v107, v5
    v_mad_u32_u16 v6, v126, s50, v15 op_sel:[0,0,0,0]
    v_mad_u32_u16 v7, v126, s50, v15 op_sel:[1,0,0,0]
    v_mad_u32_u16 v8, v51, s50, v15 op_sel:[0,0,0,0]
    v_mad_u32_u16 v9, v51, s50, v15 op_sel:[1,0,0,0]
    v_add_u32_sdwa v6, v6, v126 dst_sel:DWORD dst_unused:UNUSED_PAD src0_sel:WORD_1 src1_sel:WORD_0
    v_add_u32_sdwa v7, v7, v126 dst_sel:DWORD dst_unused:UNUSED_PAD src0_sel:WORD_1 src1_sel:WORD_1
    v_add_u32_sdwa v8, v8, v51 dst_sel:DWORD dst_unused:UNUSED_PAD src0_sel:WORD_1 src1_sel:WORD_0
    v_add_u32_sdwa v9, v9, v51 dst_sel:DWORD dst_unused:UNUSED_PAD src0_sel:WORD_1 src1_sel:WORD_1
    v_add_u32 v6, v6, v6
    v_add_u32 v7, v7, v7
    v_add_u32 v8, v8, v8
    v_add_u32 v9, v9, v9
    ds_write_b16 v6, v106 offset:16384
    ds_write_b16_d16_hi v7, v106 offset:16384
    ds_write_b16 v8, v107 offset:16384
    ds_write_b16_d16_hi v9, v107 offset:16384
    v_mov_b32 v6, 1140817920
    s_waitcnt vmcnt(11)
    v_pk_maximum3_f16 v5, v108, v109, v5
    v_mad_u32_u16 v6, v55, s50, v15 op_sel:[0,0,0,0]
    v_mad_u32_u16 v7, v55, s50, v15 op_sel:[1,0,0,0]
    v_mad_u32_u16 v8, v59, s50, v15 op_sel:[0,0,0,0]
    v_mad_u32_u16 v9, v59, s50, v15 op_sel:[1,0,0,0]
    v_add_u32_sdwa v6, v6, v55 dst_sel:DWORD dst_unused:UNUSED_PAD src0_sel:WORD_1 src1_sel:WORD_0
    v_add_u32_sdwa v7, v7, v55 dst_sel:DWORD dst_unused:UNUSED_PAD src0_sel:WORD_1 src1_sel:WORD_1
    v_add_u32_sdwa v8, v8, v59 dst_sel:DWORD dst_unused:UNUSED_PAD src0_sel:WORD_1 src1_sel:WORD_0
    v_add_u32_sdwa v9, v9, v59 dst_sel:DWORD dst_unused:UNUSED_PAD src0_sel:WORD_1 src1_sel:WORD_1
    v_add_u32 v6, v6, v6
    v_add_u32 v7, v7, v7
    v_add_u32 v8, v8, v8
    v_add_u32 v9, v9, v9
    ds_write_b16 v6, v108 offset:16384
    ds_write_b16_d16_hi v7, v108 offset:16384
    ds_write_b16 v8, v109 offset:16384
    ds_write_b16_d16_hi v9, v109 offset:16384
    v_mov_b32 v6, 1140817920
    s_waitcnt vmcnt(10)
    v_pk_maximum3_f16 v5, v110, v111, v5
    v_mad_u32_u16 v6, v63, s50, v15 op_sel:[0,0,0,0]
    v_mad_u32_u16 v7, v63, s50, v15 op_sel:[1,0,0,0]
    v_mad_u32_u16 v8, v67, s50, v15 op_sel:[0,0,0,0]
    v_mad_u32_u16 v9, v67, s50, v15 op_sel:[1,0,0,0]
    v_add_u32_sdwa v6, v6, v63 dst_sel:DWORD dst_unused:UNUSED_PAD src0_sel:WORD_1 src1_sel:WORD_0
    v_add_u32_sdwa v7, v7, v63 dst_sel:DWORD dst_unused:UNUSED_PAD src0_sel:WORD_1 src1_sel:WORD_1
    v_add_u32_sdwa v8, v8, v67 dst_sel:DWORD dst_unused:UNUSED_PAD src0_sel:WORD_1 src1_sel:WORD_0
    v_add_u32_sdwa v9, v9, v67 dst_sel:DWORD dst_unused:UNUSED_PAD src0_sel:WORD_1 src1_sel:WORD_1
    v_add_u32 v6, v6, v6
    v_add_u32 v7, v7, v7
    v_add_u32 v8, v8, v8
    v_add_u32 v9, v9, v9
    ds_write_b16 v6, v110 offset:16384
    ds_write_b16_d16_hi v7, v110 offset:16384
    ds_write_b16 v8, v111 offset:16384
    ds_write_b16_d16_hi v9, v111 offset:16384
    s_cmp_lg_u32 s40, 3
    s_cbranch_scc1 L_p1_kernel_ld_41
    s_mov_b32 s36, 11534336
    buffer_store_dwordx4 v[40:43], v3, s[72:75], s36 offen sc1
    s_branch L_p1_kernel_st_42
L_p1_kernel_ld_41:
    s_add_u32 s35, s33, 53542912
    buffer_load_dwordx4 v[40:43], v1, s[8:11], s35 offen nt
L_p1_kernel_st_42:
    v_mov_b32 v6, 1140817920
    s_waitcnt vmcnt(10)
    v_pk_maximum3_f16 v5, v112, v113, v5
    v_mad_u32_u16 v6, v71, s50, v15 op_sel:[0,0,0,0]
    v_mad_u32_u16 v7, v71, s50, v15 op_sel:[1,0,0,0]
    v_mad_u32_u16 v8, v75, s50, v15 op_sel:[0,0,0,0]
    v_mad_u32_u16 v9, v75, s50, v15 op_sel:[1,0,0,0]
    v_add_u32_sdwa v6, v6, v71 dst_sel:DWORD dst_unused:UNUSED_PAD src0_sel:WORD_1 src1_sel:WORD_0
    v_add_u32_sdwa v7, v7, v71 dst_sel:DWORD dst_unused:UNUSED_PAD src0_sel:WORD_1 src1_sel:WORD_1
    v_add_u32_sdwa v8, v8, v75 dst_sel:DWORD dst_unused:UNUSED_PAD src0_sel:WORD_1 src1_sel:WORD_0
    v_add_u32_sdwa v9, v9, v75 dst_sel:DWORD dst_unused:UNUSED_PAD src0_sel:WORD_1 src1_sel:WORD_1
    v_add_u32 v6, v6, v6
    v_add_u32 v7, v7, v7
    v_add_u32 v8, v8, v8
    v_add_u32 v9, v9, v9
    ds_write_b16 v6, v112 offset:16384
    ds_write_b16_d16_hi v7, v112 offset:16384
    ds_write_b16 v8, v113 offset:16384
    ds_write_b16_d16_hi v9, v113 offset:16384
    v_mov_b32 v6, 1140817920
    s_waitcnt vmcnt(9)
    v_pk_maximum3_f16 v5, v114, v115, v5
    v_mad_u32_u16 v6, v79, s50, v15 op_sel:[0,0,0,0]
    v_mad_u32_u16 v7, v79, s50, v15 op_sel:[1,0,0,0]
    v_mad_u32_u16 v8, v83, s50, v15 op_sel:[0,0,0,0]
    v_mad_u32_u16 v9, v83, s50, v15 op_sel:[1,0,0,0]
    v_add_u32_sdwa v6, v6, v79 dst_sel:DWORD dst_unused:UNUSED_PAD src0_sel:WORD_1 src1_sel:WORD_0
    v_add_u32_sdwa v7, v7, v79 dst_sel:DWORD dst_unused:UNUSED_PAD src0_sel:WORD_1 src1_sel:WORD_1
    v_add_u32_sdwa v8, v8, v83 dst_sel:DWORD dst_unused:UNUSED_PAD src0_sel:WORD_1 src1_sel:WORD_0
    v_add_u32_sdwa v9, v9, v83 dst_sel:DWORD dst_unused:UNUSED_PAD src0_sel:WORD_1 src1_sel:WORD_1
    v_add_u32 v6, v6, v6
    v_add_u32 v7, v7, v7
    v_add_u32 v8, v8, v8
    v_add_u32 v9, v9, v9
    ds_write_b16 v6, v114 offset:16384
    ds_write_b16_d16_hi v7, v114 offset:16384
    ds_write_b16 v8, v115 offset:16384
    ds_write_b16_d16_hi v9, v115 offset:16384
    v_mov_b32 v6, 1140817920
    s_waitcnt vmcnt(8)
    v_pk_maximum3_f16 v5, v116, v117, v5
    v_mad_u32_u16 v6, v87, s50, v15 op_sel:[0,0,0,0]
    v_mad_u32_u16 v7, v87, s50, v15 op_sel:[1,0,0,0]
    v_mad_u32_u16 v8, v91, s50, v15 op_sel:[0,0,0,0]
    v_mad_u32_u16 v9, v91, s50, v15 op_sel:[1,0,0,0]
    v_add_u32_sdwa v6, v6, v87 dst_sel:DWORD dst_unused:UNUSED_PAD src0_sel:WORD_1 src1_sel:WORD_0
    v_add_u32_sdwa v7, v7, v87 dst_sel:DWORD dst_unused:UNUSED_PAD src0_sel:WORD_1 src1_sel:WORD_1
    v_add_u32_sdwa v8, v8, v91 dst_sel:DWORD dst_unused:UNUSED_PAD src0_sel:WORD_1 src1_sel:WORD_0
    v_add_u32_sdwa v9, v9, v91 dst_sel:DWORD dst_unused:UNUSED_PAD src0_sel:WORD_1 src1_sel:WORD_1
    v_add_u32 v6, v6, v6
    v_add_u32 v7, v7, v7
    v_add_u32 v8, v8, v8
    v_add_u32 v9, v9, v9
    ds_write_b16 v6, v116 offset:16384
    ds_write_b16_d16_hi v7, v116 offset:16384
    ds_write_b16 v8, v117 offset:16384
    ds_write_b16_d16_hi v9, v117 offset:16384
    s_cmp_lg_u32 s40, 3
    s_cbranch_scc1 L_p1_kernel_ld_43
    s_mov_b32 s36, 12582912
    buffer_store_dwordx4 v[44:47], v3, s[72:75], s36 offen sc1
    s_branch L_p1_kernel_st_44
L_p1_kernel_ld_43:
    s_add_u32 s35, s33, 53542912
    buffer_load_dwordx4 v[44:47], v1, s[12:15], s35 offen nt
L_p1_kernel_st_44:
    v_mov_b32 v6, 1140817920
    s_mov_b64 exec, s[44:45]
    s_waitcnt vmcnt(8)
    v_pk_maximum3_f16 v5, v118, v119, v5
    s_mov_b64 exec, -1
    s_mov_b64 exec, s[44:45]
    v_mad_u32_u16 v6, v95, s50, v15 op_sel:[0,0,0,0]
    v_mad_u32_u16 v7, v95, s50, v15 op_sel:[1,0,0,0]
    v_mad_u32_u16 v8, v99, s50, v15 op_sel:[0,0,0,0]
    v_mad_u32_u16 v9, v99, s50, v15 op_sel:[1,0,0,0]
    v_add_u32_sdwa v6, v6, v95 dst_sel:DWORD dst_unused:UNUSED_PAD src0_sel:WORD_1 src1_sel:WORD_0
    v_add_u32_sdwa v7, v7, v95 dst_sel:DWORD dst_unused:UNUSED_PAD src0_sel:WORD_1 src1_sel:WORD_1
    v_add_u32_sdwa v8, v8, v99 dst_sel:DWORD dst_unused:UNUSED_PAD src0_sel:WORD_1 src1_sel:WORD_0
    v_add_u32_sdwa v9, v9, v99 dst_sel:DWORD dst_unused:UNUSED_PAD src0_sel:WORD_1 src1_sel:WORD_1
    v_add_u32 v6, v6, v6
    v_add_u32 v7, v7, v7
    v_add_u32 v8, v8, v8
    v_add_u32 v9, v9, v9
    ds_write_b16 v6, v118 offset:16384
    ds_write_b16_d16_hi v7, v118 offset:16384
    ds_write_b16 v8, v119 offset:16384
    ds_write_b16_d16_hi v9, v119 offset:16384
    s_mov_b64 exec, -1
    s_mul_i32 s35, s39, 6144
    v_add_u32 v6, s35, v2
    v_mov_b32 v10, 1140817920
    s_waitcnt lgkmcnt(0)
    s_barrier
    ds_read_b64 v[120:121], v6 offset:23040
    ds_read_b64 v[122:123], v6 offset:16384
    ds_read_b64 v[124:125], v6 offset:16896
    ds_read_b64 v[126:127], v6 offset:17408
    ds_read_b64 v[100:101], v6 offset:17920
    ds_read_b64 v[102:103], v6 offset:18432
    ds_read_b64 v[104:105], v6 offset:18944
    ds_read_b64 v[106:107], v6 offset:19456
    ds_read_b64 v[108:109], v6 offset:19968
    ds_read_b64 v[110:111], v6 offset:20480
    ds_read_b64 v[112:113], v6 offset:20992
    ds_read_b64 v[114:115], v6 offset:21504
    ds_read_b64 v[116:117], v6 offset:22016
    ds_read_b64 v[118:119], v6 offset:22528
    s_add_u32 s32, s32, 256
    s_add_u32 s33, s33, 40960000
    s_add_u32 s34, s34, 20480000
    s_add_u32 s40, s40, 1
    s_cmp_lt_u32 s40, 4
    s_cbranch_scc1 L_p1_loop
    s_cmp_lg_u32 s39, 15
    s_cbranch_scc1 L_p1_kernel_nox_45
    s_waitcnt lgkmcnt(13)
    v_lshlrev_b32 v15, 16, v120
    v_and_b32 v120, 0xffff0000, v120
    v_lshlrev_b32 v121, 16, v121
    v_mul_f32 v15, s41, v15
    v_mul_f32 v120, s41, v120
    v_mul_f32 v121, s41, v121
    v_fract_f32 v15, v15
    v_fract_f32 v120, v120
    v_fract_f32 v121, v121
    v_cos_f32 v15, v15
    v_cos_f32 v120, v120
    v_cos_f32 v121, v121
    v_fmaak_f32 v15, v10, v15, 1262486016
    v_fmaak_f32 v120, v10, v120, 1262486016
    v_fmaak_f32 v121, v10, v121, 1262486016
    v_lshlrev_b32 v15, 22, v15
    v_alignbit_b32 v15, v120, v15, 10
    v_alignbit_b32 v15, v121, v15, 10
    v_xor_b32 v15, 0x80200800, v15
    s_mov_b32 s36, 13631488
    buffer_store_dwordx4 v[12:15], v3, s[20:23], s36 offen sc1
L_p1_kernel_nox_45:
    s_waitcnt lgkmcnt(12)
    v_lshlrev_b32 v75, 16, v122
    v_and_b32 v122, 0xffff0000, v122
    v_lshlrev_b32 v123, 16, v123
    v_mul_f32 v75, s41, v75
    v_mul_f32 v122, s41, v122
    v_mul_f32 v123, s41, v123
    v_fract_f32 v75, v75
    v_fract_f32 v122, v122
    v_fract_f32 v123, v123
    v_cos_f32 v75, v75
    v_cos_f32 v122, v122
    v_cos_f32 v123, v123
    v_fmaak_f32 v75, v10, v75, 1262486016
    v_fmaak_f32 v122, v10, v122, 1262486016
    v_fmaak_f32 v123, v10, v123, 1262486016
    v_lshlrev_b32 v75, 22, v75
    v_alignbit_b32 v75, v122, v75, 10
    v_alignbit_b32 v75, v123, v75, 10
    v_xor_b32 v75, 0x80200800, v75
    s_mov_b32 s36, 0
    buffer_store_dwordx4 v[72:75], v3, s[20:23], s36 offen sc1
    s_waitcnt lgkmcnt(11)
    v_lshlrev_b32 v79, 16, v124
    v_and_b32 v124, 0xffff0000, v124
    v_lshlrev_b32 v125, 16, v125
    v_mul_f32 v79, s41, v79
    v_mul_f32 v124, s41, v124
    v_mul_f32 v125, s41, v125
    v_fract_f32 v79, v79
    v_fract_f32 v124, v124
    v_fract_f32 v125, v125
    v_cos_f32 v79, v79
    v_cos_f32 v124, v124
    v_cos_f32 v125, v125
    v_fmaak_f32 v79, v10, v79, 1262486016
    v_fmaak_f32 v124, v10, v124, 1262486016
    v_fmaak_f32 v125, v10, v125, 1262486016
    v_lshlrev_b32 v79, 22, v79
    v_alignbit_b32 v79, v124, v79, 10
    v_alignbit_b32 v79, v125, v79, 10
    v_xor_b32 v79, 0x80200800, v79
    s_mov_b32 s36, 1048576
    buffer_store_dwordx4 v[76:79], v3, s[20:23], s36 offen sc1
    s_waitcnt lgkmcnt(0)
    v_lshlrev_b32 v51, 16, v126
    v_and_b32 v126, 0xffff0000, v126
    v_lshlrev_b32 v127, 16, v127
    v_mul_f32 v51, s41, v51
    v_mul_f32 v126, s41, v126
    v_mul_f32 v127, s41, v127
    v_fract_f32 v51, v51
    v_fract_f32 v126, v126
    v_fract_f32 v127, v127
    v_cos_f32 v51, v51
    v_cos_f32 v126, v126
    v_cos_f32 v127, v127
    v_fmaak_f32 v51, v10, v51, 1262486016
    v_fmaak_f32 v126, v10, v126, 1262486016
    v_fmaak_f32 v127, v10, v127, 1262486016
    v_lshlrev_b32 v51, 22, v51
    v_alignbit_b32 v51, v126, v51, 10
    v_alignbit_b32 v51, v127, v51, 10
    v_xor_b32 v51, 0x80200800, v51
    s_mov_b32 s36, 2097152
    buffer_store_dwordx4 v[48:51], v3, s[20:23], s36 offen sc1
    v_lshlrev_b32 v83, 16, v100
    v_and_b32 v100, 0xffff0000, v100
    v_lshlrev_b32 v101, 16, v101
    v_mul_f32 v83, s41, v83
    v_mul_f32 v100, s41, v100
    v_mul_f32 v101, s41, v101
    v_fract_f32 v83, v83
    v_fract_f32 v100, v100
    v_fract_f32 v101, v101
    v_cos_f32 v83, v83
    v_cos_f32 v100, v100
    v_cos_f32 v101, v101
    v_fmaak_f32 v83, v10, v83, 1262486016
    v_fmaak_f32 v100, v10, v100, 1262486016
    v_fmaak_f32 v101, v10, v101, 1262486016
    v_lshlrev_b32 v83, 22, v83
    v_alignbit_b32 v83, v100, v83, 10
    v_alignbit_b32 v83, v101, v83, 10
    v_xor_b32 v83, 0x80200800, v83
    s_mov_b32 s36, 3145728
    buffer_store_dwordx4 v[80:83], v3, s[20:23], s36 offen sc1
    v_lshlrev_b32 v55, 16, v102
    v_and_b32 v102, 0xffff0000, v102
    v_lshlrev_b32 v103, 16, v103
    v_mul_f32 v55, s41, v55
    v_mul_f32 v102, s41, v102
    v_mul_f32 v103, s41, v103
    v_fract_f32 v55, v55
    v_fract_f32 v102, v102
    v_fract_f32 v103, v103
    v_cos_f32 v55, v55
    v_cos_f32 v102, v102
    v_cos_f32 v103, v103
    v_fmaak_f32 v55, v10, v55, 1262486016
    v_fmaak_f32 v102, v10, v102, 1262486016
    v_fmaak_f32 v103, v10, v103, 1262486016
    v_lshlrev_b32 v55, 22, v55
    v_alignbit_b32 v55, v102, v55, 10
    v_alignbit_b32 v55, v103, v55, 10
    v_xor_b32 v55, 0x80200800, v55
    s_mov_b32 s36, 4194304
    buffer_store_dwordx4 v[52:55], v3, s[20:23], s36 offen sc1
    v_lshlrev_b32 v87, 16, v104
    v_and_b32 v104, 0xffff0000, v104
    v_lshlrev_b32 v105, 16, v105
    v_mul_f32 v87, s41, v87
    v_mul_f32 v104, s41, v104
    v_mul_f32 v105, s41, v105
    v_fract_f32 v87, v87
    v_fract_f32 v104, v104
    v_fract_f32 v105, v105
    v_cos_f32 v87, v87
    v_cos_f32 v104, v104
    v_cos_f32 v105, v105
    v_fmaak_f32 v87, v10, v87, 1262486016
    v_fmaak_f32 v104, v10, v104, 1262486016
    v_fmaak_f32 v105, v10, v105, 1262486016
    v_lshlrev_b32 v87, 22, v87
    v_alignbit_b32 v87, v104, v87, 10
    v_alignbit_b32 v87, v105, v87, 10
    v_xor_b32 v87, 0x80200800, v87
    s_mov_b32 s36, 5242880
    buffer_store_dwordx4 v[84:87], v3, s[20:23], s36 offen sc1
    v_lshlrev_b32 v59, 16, v106
    v_and_b32 v106, 0xffff0000, v106
    v_lshlrev_b32 v107, 16, v107
    v_mul_f32 v59, s41, v59
    v_mul_f32 v106, s41, v106
    v_mul_f32 v107, s41, v107
    v_fract_f32 v59, v59
    v_fract_f32 v106, v106
    v_fract_f32 v107, v107
    v_cos_f32 v59, v59
    v_cos_f32 v106, v106
    v_cos_f32 v107, v107
    v_fmaak_f32 v59, v10, v59, 1262486016
    v_fmaak_f32 v106, v10, v106, 1262486016
    v_fmaak_f32 v107, v10, v107, 1262486016
    v_lshlrev_b32 v59, 22, v59
    v_alignbit_b32 v59, v106, v59, 10
    v_alignbit_b32 v59, v107, v59, 10
    v_xor_b32 v59, 0x80200800, v59
    s_mov_b32 s36, 6291456
    buffer_store_dwordx4 v[56:59], v3, s[20:23], s36 offen sc1
    v_lshlrev_b32 v91, 16, v108
    v_and_b32 v108, 0xffff0000, v108
    v_lshlrev_b32 v109, 16, v109
    v_mul_f32 v91, s41, v91
    v_mul_f32 v108, s41, v108
    v_mul_f32 v109, s41, v109
    v_fract_f32 v91, v91
    v_fract_f32 v108, v108
    v_fract_f32 v109, v109
    v_cos_f32 v91, v91
    v_cos_f32 v108, v108
    v_cos_f32 v109, v109
    v_fmaak_f32 v91, v10, v91, 1262486016
    v_fmaak_f32 v108, v10, v108, 1262486016
    v_fmaak_f32 v109, v10, v109, 1262486016
    v_lshlrev_b32 v91, 22, v91
    v_alignbit_b32 v91, v108, v91, 10
    v_alignbit_b32 v91, v109, v91, 10
    v_xor_b32 v91, 0x80200800, v91
    s_mov_b32 s36, 7340032
    buffer_store_dwordx4 v[88:91], v3, s[20:23], s36 offen sc1
    v_lshlrev_b32 v63, 16, v110
    v_and_b32 v110, 0xffff0000, v110
    v_lshlrev_b32 v111, 16, v111
    v_mul_f32 v63, s41, v63
    v_mul_f32 v110, s41, v110
    v_mul_f32 v111, s41, v111
    v_fract_f32 v63, v63
    v_fract_f32 v110, v110
    v_fract_f32 v111, v111
    v_cos_f32 v63, v63
    v_cos_f32 v110, v110
    v_cos_f32 v111, v111
    v_fmaak_f32 v63, v10, v63, 1262486016
    v_fmaak_f32 v110, v10, v110, 1262486016
    v_fmaak_f32 v111, v10, v111, 1262486016
    v_lshlrev_b32 v63, 22, v63
    v_alignbit_b32 v63, v110, v63, 10
    v_alignbit_b32 v63, v111, v63, 10
    v_xor_b32 v63, 0x80200800, v63
    s_mov_b32 s36, 8388608
    buffer_store_dwordx4 v[60:63], v3, s[20:23], s36 offen sc1
    v_lshlrev_b32 v95, 16, v112
    v_and_b32 v112, 0xffff0000, v112
    v_lshlrev_b32 v113, 16, v113
    v_mul_f32 v95, s41, v95
    v_mul_f32 v112, s41, v112
    v_mul_f32 v113, s41, v113
    v_fract_f32 v95, v95
    v_fract_f32 v112, v112
    v_fract_f32 v113, v113
    v_cos_f32 v95, v95
    v_cos_f32 v112, v112
    v_cos_f32 v113, v113
    v_fmaak_f32 v95, v10, v95, 1262486016
    v_fmaak_f32 v112, v10, v112, 1262486016
    v_fmaak_f32 v113, v10, v113, 1262486016
    v_lshlrev_b32 v95, 22, v95
    v_alignbit_b32 v95, v112, v95, 10
    v_alignbit_b32 v95, v113, v95, 10
    v_xor_b32 v95, 0x80200800, v95
    s_mov_b32 s36, 9437184
    buffer_store_dwordx4 v[92:95], v3, s[20:23], s36 offen sc1
    v_lshlrev_b32 v67, 16, v114
    v_and_b32 v114, 0xffff0000, v114
    v_lshlrev_b32 v115, 16, v115
    v_mul_f32 v67, s41, v67
    v_mul_f32 v114, s41, v114
    v_mul_f32 v115, s41, v115
    v_fract_f32 v67, v67
    v_fract_f32 v114, v114
    v_fract_f32 v115, v115
    v_cos_f32 v67, v67
    v_cos_f32 v114, v114
    v_cos_f32 v115, v115
    v_fmaak_f32 v67, v10, v67, 1262486016
    v_fmaak_f32 v114, v10, v114, 1262486016
    v_fmaak_f32 v115, v10, v115, 1262486016
    v_lshlrev_b32 v67, 22, v67
    v_alignbit_b32 v67, v114, v67, 10
    v_alignbit_b32 v67, v115, v67, 10
    v_xor_b32 v67, 0x80200800, v67
    s_mov_b32 s36, 10485760
    buffer_store_dwordx4 v[64:67], v3, s[20:23], s36 offen sc1
    v_lshlrev_b32 v99, 16, v116
    v_and_b32 v116, 0xffff0000, v116
    v_lshlrev_b32 v117, 16, v117
    v_mul_f32 v99, s41, v99
    v_mul_f32 v116, s41, v116
    v_mul_f32 v117, s41, v117
    v_fract_f32 v99, v99
    v_fract_f32 v116, v116
    v_fract_f32 v117, v117
    v_cos_f32 v99, v99
    v_cos_f32 v116, v116
    v_cos_f32 v117, v117
    v_fmaak_f32 v99, v10, v99, 1262486016
    v_fmaak_f32 v116, v10, v116, 1262486016
    v_fmaak_f32 v117, v10, v117, 1262486016
    v_lshlrev_b32 v99, 22, v99
    v_alignbit_b32 v99, v116, v99, 10
    v_alignbit_b32 v99, v117, v99, 10
    v_xor_b32 v99, 0x80200800, v99
    s_mov_b32 s36, 11534336
    buffer_store_dwordx4 v[96:99], v3, s[20:23], s36 offen sc1
    v_lshlrev_b32 v71, 16, v118
    v_and_b32 v118, 0xffff0000, v118
    v_lshlrev_b32 v119, 16, v119
    v_mul_f32 v71, s41, v71
    v_mul_f32 v118, s41, v118
    v_mul_f32 v119, s41, v119
    v_fract_f32 v71, v71
    v_fract_f32 v118, v118
    v_fract_f32 v119, v119
    v_cos_f32 v71, v71
    v_cos_f32 v118, v118
    v_cos_f32 v119, v119
    v_fmaak_f32 v71, v10, v71, 1262486016
    v_fmaak_f32 v118, v10, v118, 1262486016
    v_fmaak_f32 v119, v10, v119, 1262486016
    v_lshlrev_b32 v71, 22, v71
    v_alignbit_b32 v71, v118, v71, 10
    v_alignbit_b32 v71, v119, v71, 10
    v_xor_b32 v71, 0x80200800, v71
    s_mov_b32 s36, 12582912
    buffer_store_dwordx4 v[68:71], v3, s[20:23], s36 offen sc1
    v_and_b32 v6, 0x7c007c00, v5
    v_add_u32 v6, 0x04000400, v6
    v_and_b32 v6, 0x80008000, v6
    v_cmp_ne_u32 vcc, 0, v6
    s_lshl_b32 s35, s2, 3
    s_add_u32 s35, s35, 8519682
    s_mov_b32 s26, 8540160
    s_cmp_lg_u64 vcc, 0
    s_cselect_b32 s55, 1, s55
    s_cmp_eq_u32 s55, 0
    s_cbranch_scc1 L_p1_end
    s_mov_b64 exec, 1
    buffer_store_short v4, off, s[24:27], s35 sc1
L_p1_end:
    s_endpgm
.globl p2_kernel
.p2align 8
.type p2_kernel,@function
p2_kernel:
    s_cmp_ge_u32 s2, 256
    s_cbranch_scc1 L_p2_end
    s_load_dwordx2 s[4:5], s[0:1], 104
    s_load_dwordx2 s[100:101], s[0:1], 24
    s_load_dwordx2 s[8:9], s[0:1], 0
    s_load_dwordx2 s[30:31], s[0:1], 40
    s_load_dwordx4 s[32:35], s[0:1], 56
    s_load_dwordx4 s[36:39], s[0:1], 72
    s_and_b32 s14, s2, 7
    s_lshr_b32 s49, s2, 3
    s_and_b32 s3, s14, 1
    s_lshl_b32 s3, s3, 5
    s_add_u32 s3, s3, s49
    s_lshr_b32 s12, s14, 1
    v_lshrrev_b32 v108, 6, v0
    v_lshlrev_b32 v1, 4, v0
    v_and_b32 v109, 63, v0
    v_readfirstlane_b32 s13, v108
    v_lshlrev_b32 v111, 4, v109
    v_lshrrev_b32 v110, 2, v109
    v_mul_u32_u24 v110, 8256, v110
    v_add_u32 v110, v110, v111
    s_mul_i32 s14, s12, 65
    s_add_u32 s14, s14, s3
    s_lshl_b32 s14, s14, 5
    s_mul_i32 s15, s13, 532480
    s_add_u32 s14, s14, s15
    s_add_u32 s25, s14, 0
    s_mul_i32 s22, s12, 1280000
    s_mov_b32 s2, 0
    s_waitcnt lgkmcnt(0)
    s_mov_b32 s6, 655360000
    s_mov_b32 s7, 0x00020000
    s_add_u32 s10, s22, 1280000
    s_mov_b32 s11, 0x00020000
    s_add_u32 s15, s25, 0
    buffer_load_dwordx4 v[28:31], v110, s[4:7], s15 offen
    s_add_u32 s15, s25, 133120
    buffer_load_dwordx4 v[32:35], v110, s[4:7], s15 offen
    s_add_u32 s15, s25, 266240
    buffer_load_dwordx4 v[36:39], v110, s[4:7], s15 offen
    s_add_u32 s15, s25, 399360
    buffer_load_dwordx4 v[40:43], v110, s[4:7], s15 offen
    s_load_dwordx4 s[40:43], s[30:31], 0
    s_load_dwordx16 s[52:67], s[32:33], 0
    s_load_dwordx16 s[68:83], s[34:35], 0
    s_load_dwordx8 s[84:91], s[36:37], 0
    s_load_dwordx8 s[92:99], s[38:39], 0
    v_mov_b32 v52, 0x100
    s_cmp_lg_u32 s13, 0
    s_cbranch_scc1 L_p2_noann
    s_lshl_b32 s14, s3, 8
    s_add_u32 s14, s14, 8523776
    s_mov_b64 exec, 1
    buffer_atomic_add v52, off, s[4:7], s14
    s_mov_b64 exec, -1
L_p2_noann:
    s_add_u32 s14, s22, 0
    buffer_load_dwordx4 v[88:91], v1, s[8:11], s14 offen
    s_add_u32 s14, s22, 16384
    buffer_load_dwordx4 v[92:95], v1, s[8:11], s14 offen
    s_add_u32 s14, s22, 32768
    buffer_load_dwordx4 v[96:99], v1, s[8:11], s14 offen
    s_add_u32 s14, s22, 49152
    buffer_load_dwordx4 v[100:103], v1, s[8:11], s14 offen
    s_add_u32 s14, s22, 65536
    buffer_load_dwordx4 v[104:107], v1, s[8:11], s14 offen
    s_mov_b32 s15, 8519680
    buffer_load_dwordx4 v[80:83], v111, s[4:7], s15 offen offset:0
    buffer_load_dwordx4 v[84:87], v111, s[4:7], s15 offen offset:1024
    v_lshlrev_b32 v2, 10, v109
    v_mov_b32 v50, 21845
    v_add_u32 v3, 80000, v1
    v_add_u32 v124, 145536, v1
    v_add_u32 v113, 65536, v1
    v_mov_b32 v112, 0x7f000000
    v_cmp_gt_u32 vcc, 904, v0
    s_mul_i32 s19, s13, 240
    s_add_u32 s19, s19, 160000
    v_cndmask_b32 v124, v112, v124, vcc
    v_cndmask_b32 v113, v112, v113, vcc
    v_lshl_add_u32 v6, v109, 2, s19
    v_lshl_add_u32 v126, v109, 1, s19
    v_cmp_gt_u32 vcc, 10, v109
    s_lshl_b32 s27, s13, 16
    s_mov_b32 s23, 1024
    v_cndmask_b32 v6, v112, v6, vcc
    s_add_u32 s44, s4, 4194304
    s_addc_u32 s45, s5, 1048576
    s_mov_b32 s46, 14024704
    s_mov_b32 s47, 0x00020000
    s_mov_b32 s18, 80000
    s_and_b32 s50, s3, 1
    s_lshl_b32 s50, s50, 18
    s_sub_u32 s18, s18, s50
    s_sub_u32 s50, 4294836224, s50
    v_lshlrev_b32 v116, 3, v0
    v_and_b32 v116, 16, v116
    v_and_b32 v117, 1, v0
    v_lshl_or_b32 v116, v117, 5, v116
    v_mov_b32 v58, 0x3f80
    v_mov_b32 v59, 0
    v_lshlrev_b64 v[58:59], v116, v[58:59]
    v_mov_b32 v4, 0
    v_mov_b32 v5, 0
    v_mov_b32 v114, 0xff00
    v_bfe_u32 v127, v0, 0, 1
    v_mul_u32_u24 v127, 40, v127
    v_add_u32 v127, s19, v127
    ds_write2_b32 v6, v5, v5 offset0:34 offset1:44
    ds_write_b16 v126, v114 offset:2
    v_mov_b32 v44, 1073758208
    v_mov_b32 v45, 1073758208
    v_mov_b32 v46, 1073758208
    v_mov_b32 v47, 1073758208
    v_mov_b32 v48, 1073758208
    v_mov_b32 v49, 1073758208
    ds_write_b128 v113, v[44:47]
    v_lshrrev_b32 v115, 4, v109
    v_mul_u32_u24 v115, 15360, v115
    v_lshl_add_u32 v115, v109, 6, v115
    v_lshl_add_u32 v115, v108, 10, v115
    s_waitcnt lgkmcnt(0)
    v_mov_b32 v53, s40
    v_mov_b32 v54, s41
    v_mov_b32 v56, s42
    v_mov_b32 v57, s43
    s_mov_b32 s40, 20987904
    s_mov_b32 s41, 21031594
    s_pack_ll_b32_b16 s14, s52, s54
    s_pack_hh_b32_b16 s15, s52, s54
    s_pack_ll_b32_b16 s54, s53, s55
    s_pack_hh_b32_b16 s55, s53, s55
    s_mov_b32 s52, s14
    s_mov_b32 s53, s15
    s_pack_ll_b32_b16 s14, s56, s58
    s_pack_hh_b32_b16 s15, s56, s58
    s_pack_ll_b32_b16 s58, s57, s59
    s_pack_hh_b32_b16 s59, s57, s59
    s_mov_b32 s56, s14
    s_mov_b32 s57, s15
    s_pack_ll_b32_b16 s14, s60, s62
    s_pack_hh_b32_b16 s15, s60, s62
    s_pack_ll_b32_b16 s62, s61, s63
    s_pack_hh_b32_b16 s63, s61, s63
    s_mov_b32 s60, s14
    s_mov_b32 s61, s15
    s_pack_ll_b32_b16 s14, s64, s66
    s_pack_hh_b32_b16 s15, s64, s66
    s_pack_ll_b32_b16 s66, s65, s67
    s_pack_hh_b32_b16 s67, s65, s67
    s_mov_b32 s64, s14
    s_mov_b32 s65, s15
    s_pack_ll_b32_b16 s14, s68, s70
    s_pack_hh_b32_b16 s15, s68, s70
    s_pack_ll_b32_b16 s70, s69, s71
    s_pack_hh_b32_b16 s71, s69, s71
    s_mov_b32 s68, s14
    s_mov_b32 s69, s15
    s_pack_ll_b32_b16 s14, s72, s74
    s_pack_hh_b32_b16 s15, s72, s74
    s_pack_ll_b32_b16 s74, s73, s75
    s_pack_hh_b32_b16 s75, s73, s75
    s_mov_b32 s72, s14
    s_mov_b32 s73, s15
    s_pack_ll_b32_b16 s14, s76, s78
    s_pack_hh_b32_b16 s15, s76, s78
    s_pack_ll_b32_b16 s78, s77, s79
    s_pack_hh_b32_b16 s79, s77, s79
    s_mov_b32 s76, s14
    s_mov_b32 s77, s15
    s_pack_ll_b32_b16 s14, s80, s82
    s_pack_hh_b32_b16 s15, s80, s82
    s_pack_ll_b32_b16 s82, s81, s83
    s_pack_hh_b32_b16 s83, s81, s83
    s_mov_b32 s80, s14
    s_mov_b32 s81, s15
    s_waitcnt vmcnt(10)
    ds_write_b128 v1, v[28:31] offset:0
    s_waitcnt vmcnt(9)
    ds_write_b128 v1, v[32:35] offset:16384
    s_waitcnt vmcnt(8)
    ds_write_b128 v1, v[36:39] offset:32768
    s_waitcnt vmcnt(7)
    ds_write_b128 v1, v[40:43] offset:49152
    ds_read_b128 v[28:31], v115 offset:0
    ds_read_b128 v[36:39], v115 offset:32
    ds_read_b128 v[32:35], v115 offset:16
    ds_read_b128 v[40:43], v115 offset:48
    ds_write_b128 v1, v[44:47] offset:0
    ds_write_b128 v1, v[44:47] offset:16384
    ds_write_b128 v1, v[44:47] offset:32768
    ds_write_b128 v1, v[44:47] offset:49152
    s_waitcnt lgkmcnt(6)
    v_mad_u32_u16 v108, v28, v50, s40 op_sel:[0,0,0,0]
    v_mad_u32_u16 v109, v36, v50, s41 op_sel:[0,0,0,0]
    v_sub_u32_sdwa v110, v109, v108 dst_sel:DWORD dst_unused:UNUSED_PAD src0_sel:WORD_1 src1_sel:WORD_1
    s_nop 1
    v_add_u32_dpp v110, v110, v110 row_shr:1 row_mask:0xf bank_mask:0xf bound_ctrl:0
    s_nop 1
    v_add_u32_dpp v110, v110, v110 row_shr:2 row_mask:0xf bank_mask:0xf bound_ctrl:0
    s_nop 1
    v_add_u32_dpp v110, v110, v110 row_shr:4 row_mask:0xf bank_mask:0xf bound_ctrl:0
    s_nop 1
    v_add_u32_dpp v110, v110, v110 row_shr:8 row_mask:0xf bank_mask:0xf bound_ctrl:0
    s_nop 1
    v_add_u32_dpp v110, v110, v110 row_bcast:15 row_mask:0xa bank_mask:0xf
    s_nop 1
    v_add_u32_dpp v110, v110, v110 row_bcast:31 row_mask:0xc bank_mask:0xf
    v_sub_u32_sdwa v109, v109, v110 dst_sel:DWORD dst_unused:UNUSED_PAD src0_sel:WORD_1 src1_sel:DWORD
    v_readlane_b32 s29, v110, 63
    v_add_u32 v110, -1, v110
    ds_write_b16 v126, v109
    v_lshlrev_b32_e64 v111, v110, 1
    v_lshrrev_b32 v110, 5, v110
    s_cmp_gt_u32 s29, 320
    s_cselect_b32 s2, 1, s2
    v_lshl_add_u32 v110, v110, 2, v127
    s_cselect_b64 exec, 0, -1
    ds_or_b32 v110, v111 offset:136
    s_mov_b64 exec, -1
    ds_wrxchg2_rtn_b32 v[108:109], v6, v5, v5 offset0:34 offset1:44
    s_waitcnt lgkmcnt(0)
    v_or_b32 v7, v108, v109
    s_nop 0
    v_readlane_b32 s30, v7, 0
    v_readlane_b32 s31, v7, 1
    v_readlane_b32 s32, v7, 2
    v_readlane_b32 s33, v7, 3
    v_readlane_b32 s34, v7, 4
    v_readlane_b32 s35, v7, 5
    v_readlane_b32 s36, v7, 6
    v_readlane_b32 s37, v7, 7
    s_mov_b32 s25, s19
    s_mov_b32 s26, s27
    s_mov_b32 s51, s28
    s_mov_b32 s28, s29
    v_mbcnt_lo_u32_b32 v8, s30, 0
    v_mbcnt_hi_u32_b32 v8, s31, v8
    s_bcnt1_i32_b64 s14, s[30:31]
    v_lshl_add_u32 v9, v8, 1, s25
    ds_read_u16 v9, v9
    s_add_u32 s30, s26, 0
    s_lshl1_add_u32 s25, s14, s25
    s_lshl_b32 s14, s14, 10
    s_add_u32 s26, s26, s14
    v_mbcnt_lo_u32_b32 v12, s32, 0
    v_mbcnt_hi_u32_b32 v12, s33, v12
    s_bcnt1_i32_b64 s14, s[32:33]
    v_lshl_add_u32 v13, v12, 1, s25
    ds_read_u16 v13, v13
    s_add_u32 s32, s26, 1048576
    s_lshl1_add_u32 s25, s14, s25
    s_lshl_b32 s14, s14, 10
    s_add_u32 s26, s26, s14
    v_mbcnt_lo_u32_b32 v16, s34, 0
    v_mbcnt_hi_u32_b32 v16, s35, v16
    s_bcnt1_i32_b64 s14, s[34:35]
    v_lshl_add_u32 v17, v16, 1, s25
    ds_read_u16 v17, v17
    s_add_u32 s34, s26, 2097152
    s_lshl1_add_u32 s25, s14, s25
    s_lshl_b32 s14, s14, 10
    s_add_u32 s26, s26, s14
    v_mbcnt_lo_u32_b32 v20, s36, 0
    v_mbcnt_hi_u32_b32 v20, s37, v20
    s_bcnt1_i32_b64 s14, s[36:37]
    v_lshl_add_u32 v21, v20, 1, s25
    ds_read_u16 v21, v21
    s_add_u32 s36, s26, 3145728
    s_lshl1_add_u32 s25, s14, s25
    s_lshl_b32 s14, s14, 10
    s_add_u32 s26, s26, s14
    s_waitcnt lgkmcnt(3)
    v_mad_u32_u16 v9, v9, s23, v2
    v_pk_lshrrev_b16 v9, 10, v9 op_sel_hi:[1,1]
    v_lshl_add_u32 v8, v8, 6, v9
    buffer_load_dwordx4 v[8:11], v8, s[44:47], s30 idxen
    s_waitcnt lgkmcnt(2)
    v_mad_u32_u16 v13, v13, s23, v2
    v_pk_lshrrev_b16 v13, 10, v13 op_sel_hi:[1,1]
    v_lshl_add_u32 v12, v12, 6, v13
    buffer_load_dwordx4 v[12:15], v12, s[44:47], s32 idxen
    s_waitcnt lgkmcnt(1)
    v_mad_u32_u16 v17, v17, s23, v2
    v_pk_lshrrev_b16 v17, 10, v17 op_sel_hi:[1,1]
    v_lshl_add_u32 v16, v16, 6, v17
    buffer_load_dwordx4 v[16:19], v16, s[44:47], s34 idxen
    s_waitcnt lgkmcnt(0)
    v_mad_u32_u16 v21, v21, s23, v2
    v_pk_lshrrev_b16 v21, 10, v21 op_sel_hi:[1,1]
    v_lshl_add_u32 v20, v20, 6, v21
    buffer_load_dwordx4 v[20:23], v20, s[44:47], s36 idxen
    s_cmp_le_u32 s28, 256
    s_cbranch_scc1 L_p2_kernel_noopt_1
    v_readlane_b32 s38, v7, 8
    v_readlane_b32 s39, v7, 9
    s_nop 1
    v_mbcnt_lo_u32_b32 v51, s38, 0
    v_mbcnt_hi_u32_b32 v51, s39, v51
    s_bcnt1_i32_b64 s14, s[38:39]
    v_lshl_add_u32 v55, v51, 1, s25
    ds_read_u16 v55, v55
    s_add_u32 s38, s26, 4194304
    s_lshl1_add_u32 s25, s14, s25
    s_lshl_b32 s14, s14, 10
    s_add_u32 s26, s26, s14
    s_waitcnt lgkmcnt(0)
    v_mad_u32_u16 v55, v55, s23, v2
    v_pk_lshrrev_b16 v55, 10, v55 op_sel_hi:[1,1]
    v_lshl_add_u32 v51, v51, 6, v55
    buffer_load_dwordx4 v[24:27], v51, s[44:47], s38 idxen
L_p2_kernel_noopt_1:
    s_waitcnt vmcnt(6)
    ds_write_b128 v3, v[88:91] offset:0
    ds_write_b128 v3, v[92:95] offset:16384
    ds_write_b128 v3, v[96:99] offset:32768
    ds_write_b128 v3, v[100:103] offset:49152
    ds_write_b128 v124, v[104:107] offset:0
    s_waitcnt vmcnt(4)
    v_max3_u32 v64, v80, v82, v84
    v_add_f32 v65, v81, v83
    v_add_f32 v66, v85, v87
    v_max_u32 v64, v64, v86
    v_add_f32 v65, v65, v66
    v_cmp_lt_u32 vcc, 0xffff, v64
    s_nop 1
    v_max_u32_dpp v64, v64, v64 row_shr:1 row_mask:0xf bank_mask:0xf bound_ctrl:0
    s_nop 1
    v_max_u32_dpp v64, v64, v64 row_shr:2 row_mask:0xf bank_mask:0xf bound_ctrl:0
    s_nop 1
    v_max_u32_dpp v64, v64, v64 row_shr:4 row_mask:0xf bank_mask:0xf bound_ctrl:0
    s_nop 1
    v_max_u32_dpp v64, v64, v64 row_shr:8 row_mask:0xf bank_mask:0xf bound_ctrl:0
    s_nop 1
    v_max_u32_dpp v64, v64, v64 row_bcast:15 row_mask:0xa bank_mask:0xf
    s_nop 1
    v_max_u32_dpp v64, v64, v64 row_bcast:31 row_mask:0xc bank_mask:0xf
    s_nop 1
    v_add_f32_dpp v65, v65, v65 row_shr:1 row_mask:0xf bank_mask:0xf bound_ctrl:0
    s_nop 1
    v_add_f32_dpp v65, v65, v65 row_shr:2 row_mask:0xf bank_mask:0xf bound_ctrl:0
    s_nop 1
    v_add_f32_dpp v65, v65, v65 row_shr:4 row_mask:0xf bank_mask:0xf bound_ctrl:0
    s_nop 1
    v_add_f32_dpp v65, v65, v65 row_shr:8 row_mask:0xf bank_mask:0xf bound_ctrl:0
    s_nop 1
    v_add_f32_dpp v65, v65, v65 row_bcast:15 row_mask:0xa bank_mask:0xf
    s_nop 1
    v_add_f32_dpp v65, v65, v65 row_bcast:31 row_mask:0xc bank_mask:0xf
    s_cmp_lg_u64 vcc, 0
    s_cselect_b32 s2, 1, s2
    v_lshlrev_b32 v64, 16, v64
    v_mul_f32 v66, 936490775, v65
    v_mul_f32 v65, 928531664, v65
    v_cmp_nle_f32 vcc, v64, v66
    v_max_u32 v64, v64, v65
    s_nop 0
    v_readlane_b32 s14, v64, 63
    s_bitcmp1_b32 vcc_hi, 31
    s_cselect_b32 s2, 1, s2
    s_lshr_b32 s14, s14, 23
    s_add_u32 s14, s14, 1
    s_cmp_lt_u32 s14, 40
    s_cselect_b32 s2, 1, s2
    s_cmp_gt_u32 s14, 230
    s_cselect_b32 s2, 1, s2
    s_sub_u32 s48, s14, 14
    s_lshl_b32 s48, s48, 23
    s_add_u32 s16, s48, 272629760
    s_lshr_b32 s15, s16, 16
    s_sub_u32 s15, 0x10000, s15
    s_add_u32 s20, s16, s15
    s_sub_u32 s17, s20, 1
    s_mov_b32 s21, s17
    s_or_b32 s48, s48, 16416
    s_sub_u32 s14, s14, 40
    s_cmp_gt_u32 s14, 190
    s_cselect_b32 s48, 0, s48
    s_waitcnt lgkmcnt(0)
    s_barrier
    s_add_u32 s14, s22, 80000
    buffer_load_dwordx4 v[88:91], v1, s[8:11], s14 offen
    s_add_u32 s14, s22, 96384
    buffer_load_dwordx4 v[92:95], v1, s[8:11], s14 offen
    v_mad_u32_u16 v108, v28, v50, s40 op_sel:[1,0,0,0]
    v_mad_u32_u16 v109, v36, v50, s41 op_sel:[1,0,0,0]
    v_sub_u32_sdwa v110, v109, v108 dst_sel:DWORD dst_unused:UNUSED_PAD src0_sel:WORD_1 src1_sel:WORD_1
    s_nop 1
    v_add_u32_dpp v110, v110, v110 row_shr:1 row_mask:0xf bank_mask:0xf bound_ctrl:0
    s_nop 1
    v_add_u32_dpp v110, v110, v110 row_shr:2 row_mask:0xf bank_mask:0xf bound_ctrl:0
    s_nop 1
    v_add_u32_dpp v110, v110, v110 row_shr:4 row_mask:0xf bank_mask:0xf bound_ctrl:0
    s_nop 1
    v_add_u32_dpp v110, v110, v110 row_shr:8 row_mask:0xf bank_mask:0xf bound_ctrl:0
    s_nop 1
    v_add_u32_dpp v110, v110, v110 row_bcast:15 row_mask:0xa bank_mask:0xf
    s_nop 1
    v_add_u32_dpp v110, v110, v110 row_bcast:31 row_mask:0xc bank_mask:0xf
    v_sub_u32_sdwa v109, v109, v110 dst_sel:DWORD dst_unused:UNUSED_PAD src0_sel:WORD_1 src1_sel:DWORD
    v_readlane_b32 s29, v110, 63
    v_add_u32 v110, -1, v110
    ds_write_b16 v126, v109
    v_lshlrev_b32_e64 v111, v110, 1
    v_lshrrev_b32 v110, 5, v110
    s_cmp_gt_u32 s29, 320
    s_cselect_b32 s2, 1, s2
    v_lshl_add_u32 v110, v110, 2, v127
    s_cselect_b64 exec, 0, -1
    ds_or_b32 v110, v111 offset:136
    s_mov_b64 exec, -1
    ds_wrxchg2_rtn_b32 v[108:109], v6, v5, v5 offset0:34 offset1:44
    s_mov_b32 s24, 0
L_p2_loop:
    s_add_u32 s22, s22, 80000
    s_lshl_b32 s14, s13, 4
    s_or_b32 s14, s14, s24
    s_cmp_lg_u32 s14, 5
    s_cbranch_scc1 L_p2_nost
    v_mov_b32 v52, 0
    s_lshl_b32 s14, s3, 8
    s_add_u32 s14, s14, 8523776
    s_mov_b64 exec, 1
    buffer_atomic_add v52, off, s[4:7], s14 sc0
    s_mov_b64 exec, -1
L_p2_nost:
    s_waitcnt vmcnt(5)
    v_mad_u32_u16 v64, v8, 8, s18
    v_mad_u32_u16 v66, v9, 8, s18
    v_mad_u32_u16 v68, v10, 8, s18
    ds_read_b64 v[64:65], v64
    ds_read_b64 v[66:67], v66
    ds_read_b64 v[68:69], v68
    s_add_u32 s14, s22, 32768
    buffer_load_dwordx4 v[96:99], v1, s[8:11], s14 offen
    s_waitcnt vmcnt(5)
    v_mad_u32_u16 v70, v12, 8, s18
    v_mad_u32_u16 v72, v13, 8, s18
    v_mad_u32_u16 v74, v14, 8, s18
    ds_read_b64 v[70:71], v70
    ds_read_b64 v[72:73], v72
    ds_read_b64 v[74:75], v74
    s_add_u32 s14, s22, 49152
    buffer_load_dwordx4 v[100:103], v1, s[8:11], s14 offen
    s_waitcnt lgkmcnt(6)
    v_or_b32 v7, v108, v109
    s_nop 0
    v_readlane_b32 s30, v7, 0
    v_readlane_b32 s31, v7, 1
    v_readlane_b32 s32, v7, 2
    v_readlane_b32 s33, v7, 3
    v_readlane_b32 s34, v7, 4
    v_readlane_b32 s35, v7, 5
    v_readlane_b32 s36, v7, 6
    v_readlane_b32 s37, v7, 7
    s_mov_b32 s25, s19
    s_mov_b32 s26, s27
    s_mov_b32 s51, s28
    s_mov_b32 s28, s29
    v_mbcnt_lo_u32_b32 v51, s30, 0
    v_mbcnt_hi_u32_b32 v51, s31, v51
    s_bcnt1_i32_b64 s14, s[30:31]
    v_lshl_add_u32 v55, v51, 1, s25
    ds_read_u16 v55, v55
    s_add_u32 s30, s26, 0
    s_lshl1_add_u32 s25, s14, s25
    s_lshl_b32 s14, s14, 10
    s_add_u32 s26, s26, s14
    v_bfe_i32 v108, v11, 2, 10
    v_bfe_i32 v109, v11, 12, 10
    v_ashrrev_i32 v110, 22, v11
    v_cvt_f32_i32 v108, v108
    v_cvt_f32_i32 v109, v109
    v_cvt_f32_i32 v110, v110
    s_waitcnt lgkmcnt(4)
    v_mfma_f32_4x4x4_16b_bf16 v[112:115], v[58:59], v[64:65], 0
    v_mfma_f32_4x4x4_16b_bf16 v[116:119], v[58:59], v[66:67], 0
    v_mfma_f32_4x4x4_16b_bf16 v[120:123], v[58:59], v[68:69], 0
    v_mad_u32_u16 v8, v8, 8, s50 op_sel:[1,0,0,0]
    v_mad_u32_u16 v9, v9, 8, s50 op_sel:[1,0,0,0]
    v_mad_u32_u16 v10, v10, 8, s50 op_sel:[1,0,0,0]
    v_pk_fma_f32 v[114:115], v[114:115], v[108:109], s[20:21] op_sel:[0,0,0] op_sel_hi:[1,0,1]
    v_pk_fma_f32 v[112:113], v[112:113], v[108:109], s[16:17] op_sel:[0,0,0] op_sel_hi:[1,0,1]
    v_pk_fma_f32 v[118:119], v[118:119], v[108:109], s[20:21] op_sel:[0,1,0] op_sel_hi:[1,1,1]
    v_pk_fma_f32 v[116:117], v[116:117], v[108:109], s[16:17] op_sel:[0,1,0] op_sel_hi:[1,1,1]
    v_pk_fma_f32 v[122:123], v[122:123], v[110:111], s[20:21] op_sel:[0,0,0] op_sel_hi:[1,0,1]
    v_pk_fma_f32 v[120:121], v[120:121], v[110:111], s[16:17] op_sel:[0,0,0] op_sel_hi:[1,0,1]
    v_lshlrev_b64 v[114:115], 16, v[114:115]
    v_lshlrev_b64 v[118:119], 16, v[118:119]
    v_lshlrev_b64 v[122:123], 16, v[122:123]
    v_lshl_add_u64 v[64:65], v[112:113], 0, v[114:115]
    v_lshl_add_u64 v[66:67], v[116:117], 0, v[118:119]
    v_lshl_add_u64 v[68:69], v[120:121], 0, v[122:123]
    v_or3_b32 v4, v44, v45, v4
    v_or3_b32 v4, v46, v47, v4
    v_or3_b32 v4, v48, v49, v4
    ds_add_rtn_u64 v[44:45], v8, v[64:65]
    ds_add_rtn_u64 v[46:47], v9, v[66:67]
    ds_add_rtn_u64 v[48:49], v10, v[68:69]
    s_waitcnt lgkmcnt(3)
    v_mad_u32_u16 v55, v55, s23, v2
    v_pk_lshrrev_b16 v55, 10, v55 op_sel_hi:[1,1]
    v_lshl_add_u32 v51, v51, 6, v55
    buffer_load_dwordx4 v[8:11], v51, s[44:47], s30 idxen
    s_sub_u32 s14, s22, 80000
    buffer_load_dwordx4 v[104:107], v124, s[8:11], s14 offen
    s_waitcnt vmcnt(7)
    v_mad_u32_u16 v76, v16, 8, s18
    v_mad_u32_u16 v78, v17, 8, s18
    v_mad_u32_u16 v80, v18, 8, s18
    ds_read_b64 v[76:77], v76
    ds_read_b64 v[78:79], v78
    ds_read_b64 v[80:81], v80
    s_waitcnt vmcnt(6)
    v_mad_u32_u16 v82, v20, 8, s18
    v_mad_u32_u16 v84, v21, 8, s18
    v_mad_u32_u16 v86, v22, 8, s18
    ds_read_b64 v[82:83], v82
    ds_read_b64 v[84:85], v84
    ds_read_b64 v[86:87], v86
    s_cmp_le_u32 s51, 256
    s_cbranch_scc1 L_p2_kernel_noopt3_2
    v_mad_u32_u16 v64, v24, 8, s18
    v_mad_u32_u16 v66, v25, 8, s18
    v_mad_u32_u16 v68, v26, 8, s18
    ds_read_b64 v[64:65], v64
    ds_read_b64 v[66:67], v66
    ds_read_b64 v[68:69], v68
L_p2_kernel_noopt3_2:
    v_mbcnt_lo_u32_b32 v51, s32, 0
    v_mbcnt_hi_u32_b32 v51, s33, v51
    s_bcnt1_i32_b64 s14, s[32:33]
    v_lshl_add_u32 v55, v51, 1, s25
    ds_read_u16 v55, v55
    s_add_u32 s32, s26, 1048576
    s_lshl1_add_u32 s25, s14, s25
    s_lshl_b32 s14, s14, 10
    s_add_u32 s26, s26, s14
    v_bfe_i32 v108, v15, 2, 10
    v_bfe_i32 v109, v15, 12, 10
    v_ashrrev_i32 v110, 22, v15
    v_cvt_f32_i32 v108, v108
    v_cvt_f32_i32 v109, v109
    v_cvt_f32_i32 v110, v110
    v_mfma_f32_4x4x4_16b_bf16 v[112:115], v[58:59], v[70:71], 0
    v_mfma_f32_4x4x4_16b_bf16 v[116:119], v[58:59], v[72:73], 0
    v_mfma_f32_4x4x4_16b_bf16 v[120:123], v[58:59], v[74:75], 0
    v_mad_u32_u16 v12, v12, 8, s50 op_sel:[1,0,0,0]
    v_mad_u32_u16 v13, v13, 8, s50 op_sel:[1,0,0,0]
    v_mad_u32_u16 v14, v14, 8, s50 op_sel:[1,0,0,0]
    v_pk_fma_f32 v[114:115], v[114:115], v[108:109], s[20:21] op_sel:[0,0,0] op_sel_hi:[1,0,1]
    v_pk_fma_f32 v[112:113], v[112:113], v[108:109], s[16:17] op_sel:[0,0,0] op_sel_hi:[1,0,1]
    v_pk_fma_f32 v[118:119], v[118:119], v[108:109], s[20:21] op_sel:[0,1,0] op_sel_hi:[1,1,1]
    v_pk_fma_f32 v[116:117], v[116:117], v[108:109], s[16:17] op_sel:[0,1,0] op_sel_hi:[1,1,1]
    v_pk_fma_f32 v[122:123], v[122:123], v[110:111], s[20:21] op_sel:[0,0,0] op_sel_hi:[1,0,1]
    v_pk_fma_f32 v[120:121], v[120:121], v[110:111], s[16:17] op_sel:[0,0,0] op_sel_hi:[1,0,1]
    v_lshlrev_b64 v[114:115], 16, v[114:115]
    v_lshlrev_b64 v[118:119], 16, v[118:119]
    v_lshlrev_b64 v[122:123], 16, v[122:123]
    v_lshl_add_u64 v[70:71], v[112:113], 0, v[114:115]
    v_lshl_add_u64 v[72:73], v[116:117], 0, v[118:119]
    v_lshl_add_u64 v[74:75], v[120:121], 0, v[122:123]
    s_waitcnt lgkmcnt(7)
    v_or3_b32 v4, v44, v45, v4
    v_or3_b32 v4, v46, v47, v4
    v_or3_b32 v4, v48, v49, v4
    ds_add_rtn_u64 v[44:45], v12, v[70:71]
    ds_add_rtn_u64 v[46:47], v13, v[72:73]
    ds_add_rtn_u64 v[48:49], v14, v[74:75]
    s_waitcnt lgkmcnt(3)
    v_mad_u32_u16 v55, v55, s23, v2
    v_pk_lshrrev_b16 v55, 10, v55 op_sel_hi:[1,1]
    v_lshl_add_u32 v51, v51, 6, v55
    buffer_load_dwordx4 v[12:15], v51, s[44:47], s32 idxen
    s_barrier
    s_waitcnt vmcnt(1)
    ds_write_b128 v3, v[88:91] offset:0
    ds_write_b128 v3, v[92:95] offset:16384
    ds_write_b128 v3, v[96:99] offset:32768
    ds_write_b128 v3, v[100:103] offset:49152
    ds_write_b128 v124, v[104:107] offset:0
    s_cmp_lg_u32 s24, 7
    s_cbranch_scc1 L_p2_nofin
    s_mul_i32 s14, s3, 20000
    s_mul_i32 s15, s12, 4992
    s_add_u32 s14, s14, s15
    s_add_u32 s15, s14, 4096
    v_min_u32 v61, 231, v0
    v_lshl_add_u32 v60, v0, 2, s14
    v_lshl_add_u32 v61, v61, 2, s15
    global_load_dword v60, v60, s[100:101] nt
    global_load_dword v61, v61, s[100:101] nt
    s_lshl_b32 s14, s14, 2
    s_lshl_b32 s15, s15, 2
    v_min_u32 v36, 231, v0
    v_add_u32 v28, s14, v1
    v_lshl_add_u32 v36, v36, 4, s15
    global_load_dwordx4 v[28:31], v28, s[8:9]
    global_load_dwordx4 v[36:39], v36, s[8:9]
L_p2_nofin:
    v_mbcnt_lo_u32_b32 v51, s34, 0
    v_mbcnt_hi_u32_b32 v51, s35, v51
    s_bcnt1_i32_b64 s14, s[34:35]
    v_lshl_add_u32 v55, v51, 1, s25
    ds_read_u16 v55, v55
    s_add_u32 s34, s26, 2097152
    s_lshl1_add_u32 s25, s14, s25
    s_lshl_b32 s14, s14, 10
    s_add_u32 s26, s26, s14
    v_bfe_i32 v108, v19, 2, 10
    v_bfe_i32 v109, v19, 12, 10
    v_ashrrev_i32 v110, 22, v19
    v_cvt_f32_i32 v108, v108
    v_cvt_f32_i32 v109, v109
    v_cvt_f32_i32 v110, v110
    v_mfma_f32_4x4x4_16b_bf16 v[112:115], v[58:59], v[76:77], 0
    v_mfma_f32_4x4x4_16b_bf16 v[116:119], v[58:59], v[78:79], 0
    v_mfma_f32_4x4x4_16b_bf16 v[120:123], v[58:59], v[80:81], 0
    v_mad_u32_u16 v16, v16, 8, s50 op_sel:[1,0,0,0]
    v_mad_u32_u16 v17, v17, 8, s50 op_sel:[1,0,0,0]
    v_mad_u32_u16 v18, v18, 8, s50 op_sel:[1,0,0,0]
    v_pk_fma_f32 v[114:115], v[114:115], v[108:109], s[20:21] op_sel:[0,0,0] op_sel_hi:[1,0,1]
    v_pk_fma_f32 v[112:113], v[112:113], v[108:109], s[16:17] op_sel:[0,0,0] op_sel_hi:[1,0,1]
    v_pk_fma_f32 v[118:119], v[118:119], v[108:109], s[20:21] op_sel:[0,1,0] op_sel_hi:[1,1,1]
    v_pk_fma_f32 v[116:117], v[116:117], v[108:109], s[16:17] op_sel:[0,1,0] op_sel_hi:[1,1,1]
    v_pk_fma_f32 v[122:123], v[122:123], v[110:111], s[20:21] op_sel:[0,0,0] op_sel_hi:[1,0,1]
    v_pk_fma_f32 v[120:121], v[120:121], v[110:111], s[16:17] op_sel:[0,0,0] op_sel_hi:[1,0,1]
    v_lshlrev_b64 v[114:115], 16, v[114:115]
    v_lshlrev_b64 v[118:119], 16, v[118:119]
    v_lshlrev_b64 v[122:123], 16, v[122:123]
    v_lshl_add_u64 v[76:77], v[112:113], 0, v[114:115]
    v_lshl_add_u64 v[78:79], v[116:117], 0, v[118:119]
    v_lshl_add_u64 v[80:81], v[120:121], 0, v[122:123]
    s_waitcnt lgkmcnt(6)
    v_or3_b32 v4, v44, v45, v4
    v_or3_b32 v4, v46, v47, v4
    v_or3_b32 v4, v48, v49, v4
    ds_add_rtn_u64 v[44:45], v16, v[76:77]
    ds_add_rtn_u64 v[46:47], v17, v[78:79]
    ds_add_rtn_u64 v[48:49], v18, v[80:81]
    s_waitcnt lgkmcnt(3)
    v_mad_u32_u16 v55, v55, s23, v2
    v_pk_lshrrev_b16 v55, 10, v55 op_sel_hi:[1,1]
    v_lshl_add_u32 v51, v51, 6, v55
    buffer_load_dwordx4 v[16:19], v51, s[44:47], s34 idxen
    s_cmp_le_u32 s51, 256
    s_cbranch_scc1 L_p2_kernel_noopt3_3
    v_bfe_i32 v108, v27, 2, 10
    v_bfe_i32 v109, v27, 12, 10
    v_ashrrev_i32 v110, 22, v27
    v_cvt_f32_i32 v108, v108
    v_cvt_f32_i32 v109, v109
    v_cvt_f32_i32 v110, v110
    v_mfma_f32_4x4x4_16b_bf16 v[112:115], v[58:59], v[64:65], 0
    v_mfma_f32_4x4x4_16b_bf16 v[116:119], v[58:59], v[66:67], 0
    v_mfma_f32_4x4x4_16b_bf16 v[120:123], v[58:59], v[68:69], 0
    v_mad_u32_u16 v24, v24, 8, s50 op_sel:[1,0,0,0]
    v_mad_u32_u16 v25, v25, 8, s50 op_sel:[1,0,0,0]
    v_mad_u32_u16 v26, v26, 8, s50 op_sel:[1,0,0,0]
    v_pk_fma_f32 v[114:115], v[114:115], v[108:109], s[20:21] op_sel:[0,0,0] op_sel_hi:[1,0,1]
    v_pk_fma_f32 v[112:113], v[112:113], v[108:109], s[16:17] op_sel:[0,0,0] op_sel_hi:[1,0,1]
    v_pk_fma_f32 v[118:119], v[118:119], v[108:109], s[20:21] op_sel:[0,1,0] op_sel_hi:[1,1,1]
    v_pk_fma_f32 v[116:117], v[116:117], v[108:109], s[16:17] op_sel:[0,1,0] op_sel_hi:[1,1,1]
    v_pk_fma_f32 v[122:123], v[122:123], v[110:111], s[20:21] op_sel:[0,0,0] op_sel_hi:[1,0,1]
    v_pk_fma_f32 v[120:121], v[120:121], v[110:111], s[16:17] op_sel:[0,0,0] op_sel_hi:[1,0,1]
    v_lshlrev_b64 v[114:115], 16, v[114:115]
    v_lshlrev_b64 v[118:119], 16, v[118:119]
    v_lshlrev_b64 v[122:123], 16, v[122:123]
    v_lshl_add_u64 v[64:65], v[112:113], 0, v[114:115]
    v_lshl_add_u64 v[66:67], v[116:117], 0, v[118:119]
    v_lshl_add_u64 v[68:69], v[120:121], 0, v[122:123]
    s_waitcnt lgkmcnt(0)
    v_or3_b32 v4, v44, v45, v4
    v_or3_b32 v4, v46, v47, v4
    v_or3_b32 v4, v48, v49, v4
    ds_add_rtn_u64 v[44:45], v24, v[64:65]
    ds_add_rtn_u64 v[46:47], v25, v[66:67]
    ds_add_rtn_u64 v[48:49], v26, v[68:69]
L_p2_kernel_noopt3_3:
    v_mbcnt_lo_u32_b32 v51, s36, 0
    v_mbcnt_hi_u32_b32 v51, s37, v51
    s_bcnt1_i32_b64 s14, s[36:37]
    v_lshl_add_u32 v55, v51, 1, s25
    ds_read_u16 v55, v55
    s_add_u32 s36, s26, 3145728
    s_lshl1_add_u32 s25, s14, s25
    s_lshl_b32 s14, s14, 10
    s_add_u32 s26, s26, s14
    s_cmp_le_u32 s28, 256
    s_cbranch_scc1 L_p2_kernel_noopt3_4
    v_readlane_b32 s38, v7, 8
    v_readlane_b32 s39, v7, 9
    s_nop 1
    v_mbcnt_lo_u32_b32 v62, s38, 0
    v_mbcnt_hi_u32_b32 v62, s39, v62
    s_bcnt1_i32_b64 s14, s[38:39]
    v_lshl_add_u32 v63, v62, 1, s25
    ds_read_u16 v63, v63
    s_add_u32 s38, s26, 4194304
    s_lshl1_add_u32 s25, s14, s25
    s_lshl_b32 s14, s14, 10
    s_add_u32 s26, s26, s14
L_p2_kernel_noopt3_4:
    v_bfe_i32 v108, v23, 2, 10
    v_bfe_i32 v109, v23, 12, 10
    v_ashrrev_i32 v110, 22, v23
    v_cvt_f32_i32 v108, v108
    v_cvt_f32_i32 v109, v109
    v_cvt_f32_i32 v110, v110
    v_mfma_f32_4x4x4_16b_bf16 v[112:115], v[58:59], v[82:83], 0
    v_mfma_f32_4x4x4_16b_bf16 v[116:119], v[58:59], v[84:85], 0
    v_mfma_f32_4x4x4_16b_bf16 v[120:123], v[58:59], v[86:87], 0
    v_mad_u32_u16 v20, v20, 8, s50 op_sel:[1,0,0,0]
    v_mad_u32_u16 v21, v21, 8, s50 op_sel:[1,0,0,0]
    v_mad_u32_u16 v22, v22, 8, s50 op_sel:[1,0,0,0]
    v_pk_fma_f32 v[114:115], v[114:115], v[108:109], s[20:21] op_sel:[0,0,0] op_sel_hi:[1,0,1]
    v_pk_fma_f32 v[112:113], v[112:113], v[108:109], s[16:17] op_sel:[0,0,0] op_sel_hi:[1,0,1]
    v_pk_fma_f32 v[118:119], v[118:119], v[108:109], s[20:21] op_sel:[0,1,0] op_sel_hi:[1,1,1]
    v_pk_fma_f32 v[116:117], v[116:117], v[108:109], s[16:17] op_sel:[0,1,0] op_sel_hi:[1,1,1]
    v_pk_fma_f32 v[122:123], v[122:123], v[110:111], s[20:21] op_sel:[0,0,0] op_sel_hi:[1,0,1]
    v_pk_fma_f32 v[120:121], v[120:121], v[110:111], s[16:17] op_sel:[0,0,0] op_sel_hi:[1,0,1]
    v_lshlrev_b64 v[114:115], 16, v[114:115]
    v_lshlrev_b64 v[118:119], 16, v[118:119]
    v_lshlrev_b64 v[122:123], 16, v[122:123]
    v_lshl_add_u64 v[82:83], v[112:113], 0, v[114:115]
    v_lshl_add_u64 v[84:85], v[116:117], 0, v[118:119]
    v_lshl_add_u64 v[86:87], v[120:121], 0, v[122:123]
    s_waitcnt lgkmcnt(1)
    v_or3_b32 v4, v44, v45, v4
    v_or3_b32 v4, v46, v47, v4
    v_or3_b32 v4, v48, v49, v4
    ds_add_rtn_u64 v[44:45], v20, v[82:83]
    ds_add_rtn_u64 v[46:47], v21, v[84:85]
    ds_add_rtn_u64 v[48:49], v22, v[86:87]
    s_waitcnt lgkmcnt(3)
    v_mad_u32_u16 v55, v55, s23, v2
    v_pk_lshrrev_b16 v55, 10, v55 op_sel_hi:[1,1]
    v_lshl_add_u32 v51, v51, 6, v55
    buffer_load_dwordx4 v[20:23], v51, s[44:47], s36 idxen
    s_cmp_le_u32 s28, 256
    s_cbranch_scc1 L_p2_kernel_noopt3_5
    v_mad_u32_u16 v63, v63, s23, v2
    v_pk_lshrrev_b16 v63, 10, v63 op_sel_hi:[1,1]
    v_lshl_add_u32 v62, v62, 6, v63
    buffer_load_dwordx4 v[24:27], v62, s[44:47], s38 idxen
L_p2_kernel_noopt3_5:
    s_add_u32 s14, s22, 80000
    buffer_load_dwordx4 v[88:91], v1, s[8:11], s14 offen
    s_add_u32 s14, s24, 1
    s_min_u32 s14, s14, 7
    s_set_gpr_idx_on s14, gpr_idx(SRC0)
    v_mad_u32_u16 v108, v28, v50, s40 op_sel:[0,0,0,0]
    v_mad_u32_u16 v109, v36, v50, s41 op_sel:[0,0,0,0]
    s_set_gpr_idx_off
    v_sub_u32_sdwa v110, v109, v108 dst_sel:DWORD dst_unused:UNUSED_PAD src0_sel:WORD_1 src1_sel:WORD_1
    s_nop 1
    v_add_u32_dpp v110, v110, v110 row_shr:1 row_mask:0xf bank_mask:0xf bound_ctrl:0
    s_nop 1
    v_add_u32_dpp v110, v110, v110 row_shr:2 row_mask:0xf bank_mask:0xf bound_ctrl:0
    s_nop 1
    v_add_u32_dpp v110, v110, v110 row_shr:4 row_mask:0xf bank_mask:0xf bound_ctrl:0
    s_nop 1
    v_add_u32_dpp v110, v110, v110 row_shr:8 row_mask:0xf bank_mask:0xf bound_ctrl:0
    s_nop 1
    v_add_u32_dpp v110, v110, v110 row_bcast:15 row_mask:0xa bank_mask:0xf
    s_nop 1
    v_add_u32_dpp v110, v110, v110 row_bcast:31 row_mask:0xc bank_mask:0xf
    v_sub_u32_sdwa v109, v109, v110 dst_sel:DWORD dst_unused:UNUSED_PAD src0_sel:WORD_1 src1_sel:DWORD
    v_readlane_b32 s29, v110, 63
    v_add_u32 v110, -1, v110
    ds_write_b16 v126, v109
    v_lshlrev_b32_e64 v111, v110, 1
    v_lshrrev_b32 v110, 5, v110
    s_cmp_gt_u32 s29, 320
    s_cselect_b32 s2, 1, s2
    v_lshl_add_u32 v110, v110, 2, v127
    s_cselect_b64 exec, 0, -1
    ds_or_b32 v110, v111 offset:136
    s_mov_b64 exec, -1
    ds_wrxchg2_rtn_b32 v[108:109], v6, v5, v5 offset0:34 offset1:44
    s_add_u32 s14, s22, 96384
    buffer_load_dwordx4 v[92:95], v1, s[8:11], s14 offen
    s_barrier
    s_add_u32 s22, s22, 80000
    s_cmp_eq_u32 s24, 7
    s_cselect_b32 s46, 0, s46
    v_mad_u32_u16 v64, v8, 8, s18
    v_mad_u32_u16 v66, v9, 8, s18
    v_mad_u32_u16 v68, v10, 8, s18
    ds_read_b64 v[64:65], v64
    ds_read_b64 v[66:67], v66
    ds_read_b64 v[68:69], v68
    s_add_u32 s14, s22, 32768
    buffer_load_dwordx4 v[96:99], v1, s[8:11], s14 offen
    s_waitcnt vmcnt(5)
    v_mad_u32_u16 v70, v12, 8, s18
    v_mad_u32_u16 v72, v13, 8, s18
    v_mad_u32_u16 v74, v14, 8, s18
    ds_read_b64 v[70:71], v70
    ds_read_b64 v[72:73], v72
    ds_read_b64 v[74:75], v74
    s_add_u32 s14, s22, 49152
    buffer_load_dwordx4 v[100:103], v1, s[8:11], s14 offen
    s_waitcnt lgkmcnt(6)
    v_or_b32 v7, v108, v109
    s_nop 0
    v_readlane_b32 s30, v7, 0
    v_readlane_b32 s31, v7, 1
    v_readlane_b32 s32, v7, 2
    v_readlane_b32 s33, v7, 3
    v_readlane_b32 s34, v7, 4
    v_readlane_b32 s35, v7, 5
    v_readlane_b32 s36, v7, 6
    v_readlane_b32 s37, v7, 7
    s_mov_b32 s25, s19
    s_mov_b32 s26, s27
    s_mov_b32 s51, s28
    s_mov_b32 s28, s29
    v_mbcnt_lo_u32_b32 v51, s30, 0
    v_mbcnt_hi_u32_b32 v51, s31, v51
    s_bcnt1_i32_b64 s14, s[30:31]
    v_lshl_add_u32 v55, v51, 1, s25
    ds_read_u16 v55, v55
    s_add_u32 s30, s26, 0
    s_lshl1_add_u32 s25, s14, s25
    s_lshl_b32 s14, s14, 10
    s_add_u32 s26, s26, s14
    v_bfe_i32 v108, v11, 2, 10
    v_bfe_i32 v109, v11, 12, 10
    v_ashrrev_i32 v110, 22, v11
    v_cvt_f32_i32 v108, v108
    v_cvt_f32_i32 v109, v109
    v_cvt_f32_i32 v110, v110
    s_waitcnt lgkmcnt(4)
    v_mfma_f32_4x4x4_16b_bf16 v[112:115], v[58:59], v[64:65], 0
    v_mfma_f32_4x4x4_16b_bf16 v[116:119], v[58:59], v[66:67], 0
    v_mfma_f32_4x4x4_16b_bf16 v[120:123], v[58:59], v[68:69], 0
    v_mad_u32_u16 v8, v8, 8, s50 op_sel:[1,0,0,0]
    v_mad_u32_u16 v9, v9, 8, s50 op_sel:[1,0,0,0]
    v_mad_u32_u16 v10, v10, 8, s50 op_sel:[1,0,0,0]
    v_pk_fma_f32 v[114:115], v[114:115], v[108:109], s[20:21] op_sel:[0,0,0] op_sel_hi:[1,0,1]
    v_pk_fma_f32 v[112:113], v[112:113], v[108:109], s[16:17] op_sel:[0,0,0] op_sel_hi:[1,0,1]
    v_pk_fma_f32 v[118:119], v[118:119], v[108:109], s[20:21] op_sel:[0,1,0] op_sel_hi:[1,1,1]
    v_pk_fma_f32 v[116:117], v[116:117], v[108:109], s[16:17] op_sel:[0,1,0] op_sel_hi:[1,1,1]
    v_pk_fma_f32 v[122:123], v[122:123], v[110:111], s[20:21] op_sel:[0,0,0] op_sel_hi:[1,0,1]
    v_pk_fma_f32 v[120:121], v[120:121], v[110:111], s[16:17] op_sel:[0,0,0] op_sel_hi:[1,0,1]
    v_lshlrev_b64 v[114:115], 16, v[114:115]
    v_lshlrev_b64 v[118:119], 16, v[118:119]
    v_lshlrev_b64 v[122:123], 16, v[122:123]
    v_lshl_add_u64 v[64:65], v[112:113], 0, v[114:115]
    v_lshl_add_u64 v[66:67], v[116:117], 0, v[118:119]
    v_lshl_add_u64 v[68:69], v[120:121], 0, v[122:123]
    v_or3_b32 v4, v44, v45, v4
    v_or3_b32 v4, v46, v47, v4
    v_or3_b32 v4, v48, v49, v4
    ds_add_rtn_u64 v[44:45], v8, v[64:65]
    ds_add_rtn_u64 v[46:47], v9, v[66:67]
    ds_add_rtn_u64 v[48:49], v10, v[68:69]
    s_waitcnt lgkmcnt(3)
    v_mad_u32_u16 v55, v55, s23, v2
    v_pk_lshrrev_b16 v55, 10, v55 op_sel_hi:[1,1]
    v_lshl_add_u32 v51, v51, 6, v55
    buffer_load_dwordx4 v[8:11], v51, s[44:47], s30 idxen
    s_sub_u32 s14, s22, 80000
    buffer_load_dwordx4 v[104:107], v124, s[8:11], s14 offen
    s_waitcnt vmcnt(7)
    v_mad_u32_u16 v76, v16, 8, s18
    v_mad_u32_u16 v78, v17, 8, s18
    v_mad_u32_u16 v80, v18, 8, s18
    ds_read_b64 v[76:77], v76
    ds_read_b64 v[78:79], v78
    ds_read_b64 v[80:81], v80
    s_waitcnt vmcnt(6)
    v_mad_u32_u16 v82, v20, 8, s18
    v_mad_u32_u16 v84, v21, 8, s18
    v_mad_u32_u16 v86, v22, 8, s18
    ds_read_b64 v[82:83], v82
    ds_read_b64 v[84:85], v84
    ds_read_b64 v[86:87], v86
    s_cmp_le_u32 s51, 256
    s_cbranch_scc1 L_p2_kernel_noopt3_6
    v_mad_u32_u16 v64, v24, 8, s18
    v_mad_u32_u16 v66, v25, 8, s18
    v_mad_u32_u16 v68, v26, 8, s18
    ds_read_b64 v[64:65], v64
    ds_read_b64 v[66:67], v66
    ds_read_b64 v[68:69], v68
L_p2_kernel_noopt3_6:
    v_mbcnt_lo_u32_b32 v51, s32, 0
    v_mbcnt_hi_u32_b32 v51, s33, v51
    s_bcnt1_i32_b64 s14, s[32:33]
    v_lshl_add_u32 v55, v51, 1, s25
    ds_read_u16 v55, v55
    s_add_u32 s32, s26, 1048576
    s_lshl1_add_u32 s25, s14, s25
    s_lshl_b32 s14, s14, 10
    s_add_u32 s26, s26, s14
    v_bfe_i32 v108, v15, 2, 10
    v_bfe_i32 v109, v15, 12, 10
    v_ashrrev_i32 v110, 22, v15
    v_cvt_f32_i32 v108, v108
    v_cvt_f32_i32 v109, v109
    v_cvt_f32_i32 v110, v110
    v_mfma_f32_4x4x4_16b_bf16 v[112:115], v[58:59], v[70:71], 0
    v_mfma_f32_4x4x4_16b_bf16 v[116:119], v[58:59], v[72:73], 0
    v_mfma_f32_4x4x4_16b_bf16 v[120:123], v[58:59], v[74:75], 0
    v_mad_u32_u16 v12, v12, 8, s50 op_sel:[1,0,0,0]
    v_mad_u32_u16 v13, v13, 8, s50 op_sel:[1,0,0,0]
    v_mad_u32_u16 v14, v14, 8, s50 op_sel:[1,0,0,0]
    v_pk_fma_f32 v[114:115], v[114:115], v[108:109], s[20:21] op_sel:[0,0,0] op_sel_hi:[1,0,1]
    v_pk_fma_f32 v[112:113], v[112:113], v[108:109], s[16:17] op_sel:[0,0,0] op_sel_hi:[1,0,1]
    v_pk_fma_f32 v[118:119], v[118:119], v[108:109], s[20:21] op_sel:[0,1,0] op_sel_hi:[1,1,1]
    v_pk_fma_f32 v[116:117], v[116:117], v[108:109], s[16:17] op_sel:[0,1,0] op_sel_hi:[1,1,1]
    v_pk_fma_f32 v[122:123], v[122:123], v[110:111], s[20:21] op_sel:[0,0,0] op_sel_hi:[1,0,1]
    v_pk_fma_f32 v[120:121], v[120:121], v[110:111], s[16:17] op_sel:[0,0,0] op_sel_hi:[1,0,1]
    v_lshlrev_b64 v[114:115], 16, v[114:115]
    v_lshlrev_b64 v[118:119], 16, v[118:119]
    v_lshlrev_b64 v[122:123], 16, v[122:123]
    v_lshl_add_u64 v[70:71], v[112:113], 0, v[114:115]
    v_lshl_add_u64 v[72:73], v[116:117], 0, v[118:119]
    v_lshl_add_u64 v[74:75], v[120:121], 0, v[122:123]
    s_waitcnt lgkmcnt(7)
    v_or3_b32 v4, v44, v45, v4
    v_or3_b32 v4, v46, v47, v4
    v_or3_b32 v4, v48, v49, v4
    ds_add_rtn_u64 v[44:45], v12, v[70:71]
    ds_add_rtn_u64 v[46:47], v13, v[72:73]
    ds_add_rtn_u64 v[48:49], v14, v[74:75]
    s_waitcnt lgkmcnt(3)
    v_mad_u32_u16 v55, v55, s23, v2
    v_pk_lshrrev_b16 v55, 10, v55 op_sel_hi:[1,1]
    v_lshl_add_u32 v51, v51, 6, v55
    buffer_load_dwordx4 v[12:15], v51, s[44:47], s32 idxen
    s_cmp_lg_u32 s24, 7
    s_cbranch_scc1 L_p2_stage
    s_waitcnt lgkmcnt(0)
    s_branch L_p2_staged
L_p2_stage:
    s_barrier
    s_waitcnt vmcnt(1)
    ds_write_b128 v3, v[88:91] offset:0
    ds_write_b128 v3, v[92:95] offset:16384
    ds_write_b128 v3, v[96:99] offset:32768
    ds_write_b128 v3, v[100:103] offset:49152
    ds_write_b128 v124, v[104:107] offset:0
L_p2_staged:
    v_mbcnt_lo_u32_b32 v51, s34, 0
    v_mbcnt_hi_u32_b32 v51, s35, v51
    s_bcnt1_i32_b64 s14, s[34:35]
    v_lshl_add_u32 v55, v51, 1, s25
    ds_read_u16 v55, v55
    s_add_u32 s34, s26, 2097152
    s_lshl1_add_u32 s25, s14, s25
    s_lshl_b32 s14, s14, 10
    s_add_u32 s26, s26, s14
    v_bfe_i32 v108, v19, 2, 10
    v_bfe_i32 v109, v19, 12, 10
    v_ashrrev_i32 v110, 22, v19
    v_cvt_f32_i32 v108, v108
    v_cvt_f32_i32 v109, v109
    v_cvt_f32_i32 v110, v110
    v_mfma_f32_4x4x4_16b_bf16 v[112:115], v[58:59], v[76:77], 0
    v_mfma_f32_4x4x4_16b_bf16 v[116:119], v[58:59], v[78:79], 0
    v_mfma_f32_4x4x4_16b_bf16 v[120:123], v[58:59], v[80:81], 0
    v_mad_u32_u16 v16, v16, 8, s50 op_sel:[1,0,0,0]
    v_mad_u32_u16 v17, v17, 8, s50 op_sel:[1,0,0,0]
    v_mad_u32_u16 v18, v18, 8, s50 op_sel:[1,0,0,0]
    v_pk_fma_f32 v[114:115], v[114:115], v[108:109], s[20:21] op_sel:[0,0,0] op_sel_hi:[1,0,1]
    v_pk_fma_f32 v[112:113], v[112:113], v[108:109], s[16:17] op_sel:[0,0,0] op_sel_hi:[1,0,1]
    v_pk_fma_f32 v[118:119], v[118:119], v[108:109], s[20:21] op_sel:[0,1,0] op_sel_hi:[1,1,1]
    v_pk_fma_f32 v[116:117], v[116:117], v[108:109], s[16:17] op_sel:[0,1,0] op_sel_hi:[1,1,1]
    v_pk_fma_f32 v[122:123], v[122:123], v[110:111], s[20:21] op_sel:[0,0,0] op_sel_hi:[1,0,1]
    v_pk_fma_f32 v[120:121], v[120:121], v[110:111], s[16:17] op_sel:[0,0,0] op_sel_hi:[1,0,1]
    v_lshlrev_b64 v[114:115], 16, v[114:115]
    v_lshlrev_b64 v[118:119], 16, v[118:119]
    v_lshlrev_b64 v[122:123], 16, v[122:123]
    v_lshl_add_u64 v[76:77], v[112:113], 0, v[114:115]
    v_lshl_add_u64 v[78:79], v[116:117], 0, v[118:119]
    v_lshl_add_u64 v[80:81], v[120:121], 0, v[122:123]
    s_waitcnt lgkmcnt(6)
    v_or3_b32 v4, v44, v45, v4
    v_or3_b32 v4, v46, v47, v4
    v_or3_b32 v4, v48, v49, v4
    ds_add_rtn_u64 v[44:45], v16, v[76:77]
    ds_add_rtn_u64 v[46:47], v17, v[78:79]
    ds_add_rtn_u64 v[48:49], v18, v[80:81]
    s_waitcnt lgkmcnt(3)
    v_mad_u32_u16 v55, v55, s23, v2
    v_pk_lshrrev_b16 v55, 10, v55 op_sel_hi:[1,1]
    v_lshl_add_u32 v51, v51, 6, v55
    buffer_load_dwordx4 v[16:19], v51, s[44:47], s34 idxen
    s_cmp_le_u32 s51, 256
    s_cbranch_scc1 L_p2_kernel_noopt3_7
    v_bfe_i32 v108, v27, 2, 10
    v_bfe_i32 v109, v27, 12, 10
    v_ashrrev_i32 v110, 22, v27
    v_cvt_f32_i32 v108, v108
    v_cvt_f32_i32 v109, v109
    v_cvt_f32_i32 v110, v110
    v_mfma_f32_4x4x4_16b_bf16 v[112:115], v[58:59], v[64:65], 0
    v_mfma_f32_4x4x4_16b_bf16 v[116:119], v[58:59], v[66:67], 0
    v_mfma_f32_4x4x4_16b_bf16 v[120:123], v[58:59], v[68:69], 0
    v_mad_u32_u16 v24, v24, 8, s50 op_sel:[1,0,0,0]
    v_mad_u32_u16 v25, v25, 8, s50 op_sel:[1,0,0,0]
    v_mad_u32_u16 v26, v26, 8, s50 op_sel:[1,0,0,0]
    v_pk_fma_f32 v[114:115], v[114:115], v[108:109], s[20:21] op_sel:[0,0,0] op_sel_hi:[1,0,1]
    v_pk_fma_f32 v[112:113], v[112:113], v[108:109], s[16:17] op_sel:[0,0,0] op_sel_hi:[1,0,1]
    v_pk_fma_f32 v[118:119], v[118:119], v[108:109], s[20:21] op_sel:[0,1,0] op_sel_hi:[1,1,1]
    v_pk_fma_f32 v[116:117], v[116:117], v[108:109], s[16:17] op_sel:[0,1,0] op_sel_hi:[1,1,1]
    v_pk_fma_f32 v[122:123], v[122:123], v[110:111], s[20:21] op_sel:[0,0,0] op_sel_hi:[1,0,1]
    v_pk_fma_f32 v[120:121], v[120:121], v[110:111], s[16:17] op_sel:[0,0,0] op_sel_hi:[1,0,1]
    v_lshlrev_b64 v[114:115], 16, v[114:115]
    v_lshlrev_b64 v[118:119], 16, v[118:119]
    v_lshlrev_b64 v[122:123], 16, v[122:123]
    v_lshl_add_u64 v[64:65], v[112:113], 0, v[114:115]
    v_lshl_add_u64 v[66:67], v[116:117], 0, v[118:119]
    v_lshl_add_u64 v[68:69], v[120:121], 0, v[122:123]
    s_waitcnt lgkmcnt(0)
    v_or3_b32 v4, v44, v45, v4
    v_or3_b32 v4, v46, v47, v4
    v_or3_b32 v4, v48, v49, v4
    ds_add_rtn_u64 v[44:45], v24, v[64:65]
    ds_add_rtn_u64 v[46:47], v25, v[66:67]
    ds_add_rtn_u64 v[48:49], v26, v[68:69]
L_p2_kernel_noopt3_7:
    v_mbcnt_lo_u32_b32 v51, s36, 0
    v_mbcnt_hi_u32_b32 v51, s37, v51
    s_bcnt1_i32_b64 s14, s[36:37]
    v_lshl_add_u32 v55, v51, 1, s25
    ds_read_u16 v55, v55
    s_add_u32 s36, s26, 3145728
    s_lshl1_add_u32 s25, s14, s25
    s_lshl_b32 s14, s14, 10
    s_add_u32 s26, s26, s14
    s_cmp_le_u32 s28, 256
    s_cbranch_scc1 L_p2_kernel_noopt3_8
    v_readlane_b32 s38, v7, 8
    v_readlane_b32 s39, v7, 9
    s_nop 1
    v_mbcnt_lo_u32_b32 v62, s38, 0
    v_mbcnt_hi_u32_b32 v62, s39, v62
    s_bcnt1_i32_b64 s14, s[38:39]
    v_lshl_add_u32 v63, v62, 1, s25
    ds_read_u16 v63, v63
    s_add_u32 s38, s26, 4194304
    s_lshl1_add_u32 s25, s14, s25
    s_lshl_b32 s14, s14, 10
    s_add_u32 s26, s26, s14
L_p2_kernel_noopt3_8:
    v_bfe_i32 v108, v23, 2, 10
    v_bfe_i32 v109, v23, 12, 10
    v_ashrrev_i32 v110, 22, v23
    v_cvt_f32_i32 v108, v108
    v_cvt_f32_i32 v109, v109
    v_cvt_f32_i32 v110, v110
    v_mfma_f32_4x4x4_16b_bf16 v[112:115], v[58:59], v[82:83], 0
    v_mfma_f32_4x4x4_16b_bf16 v[116:119], v[58:59], v[84:85], 0
    v_mfma_f32_4x4x4_16b_bf16 v[120:123], v[58:59], v[86:87], 0
    v_mad_u32_u16 v20, v20, 8, s50 op_sel:[1,0,0,0]
    v_mad_u32_u16 v21, v21, 8, s50 op_sel:[1,0,0,0]
    v_mad_u32_u16 v22, v22, 8, s50 op_sel:[1,0,0,0]
    v_pk_fma_f32 v[114:115], v[114:115], v[108:109], s[20:21] op_sel:[0,0,0] op_sel_hi:[1,0,1]
    v_pk_fma_f32 v[112:113], v[112:113], v[108:109], s[16:17] op_sel:[0,0,0] op_sel_hi:[1,0,1]
    v_pk_fma_f32 v[118:119], v[118:119], v[108:109], s[20:21] op_sel:[0,1,0] op_sel_hi:[1,1,1]
    v_pk_fma_f32 v[116:117], v[116:117], v[108:109], s[16:17] op_sel:[0,1,0] op_sel_hi:[1,1,1]
    v_pk_fma_f32 v[122:123], v[122:123], v[110:111], s[20:21] op_sel:[0,0,0] op_sel_hi:[1,0,1]
    v_pk_fma_f32 v[120:121], v[120:121], v[110:111], s[16:17] op_sel:[0,0,0] op_sel_hi:[1,0,1]
    v_lshlrev_b64 v[114:115], 16, v[114:115]
    v_lshlrev_b64 v[118:119], 16, v[118:119]
    v_lshlrev_b64 v[122:123], 16, v[122:123]
    v_lshl_add_u64 v[82:83], v[112:113], 0, v[114:115]
    v_lshl_add_u64 v[84:85], v[116:117], 0, v[118:119]
    v_lshl_add_u64 v[86:87], v[120:121], 0, v[122:123]
    s_waitcnt lgkmcnt(1)
    v_or3_b32 v4, v44, v45, v4
    v_or3_b32 v4, v46, v47, v4
    v_or3_b32 v4, v48, v49, v4
    ds_add_rtn_u64 v[44:45], v20, v[82:83]
    ds_add_rtn_u64 v[46:47], v21, v[84:85]
    ds_add_rtn_u64 v[48:49], v22, v[86:87]
    s_waitcnt lgkmcnt(3)
    v_mad_u32_u16 v55, v55, s23, v2
    v_pk_lshrrev_b16 v55, 10, v55 op_sel_hi:[1,1]
    v_lshl_add_u32 v51, v51, 6, v55
    buffer_load_dwordx4 v[20:23], v51, s[44:47], s36 idxen
    s_cmp_le_u32 s28, 256
    s_cbranch_scc1 L_p2_kernel_noopt3_9
    v_mad_u32_u16 v63, v63, s23, v2
    v_pk_lshrrev_b16 v63, 10, v63 op_sel_hi:[1,1]
    v_lshl_add_u32 v62, v62, 6, v63
    buffer_load_dwordx4 v[24:27], v62, s[44:47], s38 idxen
L_p2_kernel_noopt3_9:
    s_add_u32 s14, s22, 80000
    buffer_load_dwordx4 v[88:91], v1, s[8:11], s14 offen
    s_cmp_eq_u32 s24, 7
    s_cbranch_scc1 L_p2_exit
    s_add_u32 s14, s24, 1
    s_min_u32 s14, s14, 7
    s_set_gpr_idx_on s14, gpr_idx(SRC0)
    v_mad_u32_u16 v108, v28, v50, s40 op_sel:[1,0,0,0]
    v_mad_u32_u16 v109, v36, v50, s41 op_sel:[1,0,0,0]
    s_set_gpr_idx_off
    v_sub_u32_sdwa v110, v109, v108 dst_sel:DWORD dst_unused:UNUSED_PAD src0_sel:WORD_1 src1_sel:WORD_1
    s_nop 1
    v_add_u32_dpp v110, v110, v110 row_shr:1 row_mask:0xf bank_mask:0xf bound_ctrl:0
    s_nop 1
    v_add_u32_dpp v110, v110, v110 row_shr:2 row_mask:0xf bank_mask:0xf bound_ctrl:0
    s_nop 1
    v_add_u32_dpp v110, v110, v110 row_shr:4 row_mask:0xf bank_mask:0xf bound_ctrl:0
    s_nop 1
    v_add_u32_dpp v110, v110, v110 row_shr:8 row_mask:0xf bank_mask:0xf bound_ctrl:0
    s_nop 1
    v_add_u32_dpp v110, v110, v110 row_bcast:15 row_mask:0xa bank_mask:0xf
    s_nop 1
    v_add_u32_dpp v110, v110, v110 row_bcast:31 row_mask:0xc bank_mask:0xf
    v_sub_u32_sdwa v109, v109, v110 dst_sel:DWORD dst_unused:UNUSED_PAD src0_sel:WORD_1 src1_sel:DWORD
    v_readlane_b32 s29, v110, 63
    v_add_u32 v110, -1, v110
    ds_write_b16 v126, v109
    v_lshlrev_b32_e64 v111, v110, 1
    v_lshrrev_b32 v110, 5, v110
    s_cmp_gt_u32 s29, 320
    s_cselect_b32 s2, 1, s2
    v_lshl_add_u32 v110, v110, 2, v127
    s_cselect_b64 exec, 0, -1
    ds_or_b32 v110, v111 offset:136
    s_mov_b64 exec, -1
    ds_wrxchg2_rtn_b32 v[108:109], v6, v5, v5 offset0:34 offset1:44
    s_add_u32 s14, s22, 96384
    buffer_load_dwordx4 v[92:95], v1, s[8:11], s14 offen
    s_add_u32 s24, s24, 1
    s_cmp_lt_u32 s24, 8
    s_barrier
    s_cbranch_scc1 L_p2_loop
L_p2_exit:
    s_waitcnt lgkmcnt(0)
    v_or3_b32 v4, v44, v45, v4
    v_or3_b32 v4, v46, v47, v4
    v_or3_b32 v4, v48, v49, v4
    s_mov_b32 s27, s19
    s_waitcnt vmcnt(0)
    v_mov_b64 v[64:65], v[28:29]
    v_mov_b64 v[66:67], v[30:31]
    v_mov_b64 v[68:69], v[36:37]
    v_mov_b64 v[70:71], v[38:39]
    v_mov_b32 v8, 160232
    s_cmp_lg_u32 s13, 0
    s_cselect_b64 exec, 0, 1
    ds_write_b32 v8, v52
    s_mov_b64 exec, -1
    v_subrev_u32 v6, 80000, v124
    s_mul_i32 s24, s12, 19968
    v_subrev_u32 v10, s24, v1
    v_mov_b32 v11, 0x7f000000
    s_waitcnt vmcnt(0) lgkmcnt(0)
    s_barrier
    s_cmp_lt_u32 s13, 12
    s_cbranch_scc1 L_p2_ga
L_p2_ga:
    ds_read_b32 v9, v8
    ds_read_b128 v[88:91], v1 offset:0
    ds_read_b128 v[92:95], v1 offset:16384
    ds_read_b128 v[96:99], v1 offset:32768
    ds_read_b128 v[100:103], v1 offset:49152
    ds_read_b128 v[104:107], v6
    s_mul_i32 s14, s12, 5120000
    s_mul_i32 s15, s3, 80000
    s_add_u32 s25, s14, s15
    s_add_u32 s25, s25, 228589568
    s_cmp_eq_u32 s12, 3
    s_cselect_b32 s15, 128, 0
    s_add_u32 s15, s15, 19968
    s_waitcnt lgkmcnt(5)
    v_readfirstlane_b32 s21, v9
    s_nop 0
    s_bfe_u32 s21, s21, 524296
    s_cmp_lg_u32 s21, 4
    s_cselect_b32 s21, 1, 0
    s_cselect_b32 s24, 0, s15
    v_cmp_le_u32 vcc, s24, v10
    v_add_u32 v10, 16384, v10
    s_add_u32 s14, s25, 0
    v_cndmask_b32 v12, v11, v1, vcc
    s_waitcnt lgkmcnt(4)
    buffer_store_dwordx4 v[88:91], v12, s[4:7], s14 offen sc1
    v_or3_b32 v4, v88, v89, v4
    v_or3_b32 v4, v90, v91, v4
    v_cmp_le_u32 vcc, s24, v10
    v_add_u32 v10, 16384, v10
    s_add_u32 s14, s25, 16384
    v_cndmask_b32 v12, v11, v1, vcc
    s_waitcnt lgkmcnt(3)
    buffer_store_dwordx4 v[92:95], v12, s[4:7], s14 offen sc1
    v_or3_b32 v4, v92, v93, v4
    v_or3_b32 v4, v94, v95, v4
    v_cmp_le_u32 vcc, s24, v10
    v_add_u32 v10, 16384, v10
    s_add_u32 s14, s25, 32768
    v_cndmask_b32 v12, v11, v1, vcc
    s_waitcnt lgkmcnt(2)
    buffer_store_dwordx4 v[96:99], v12, s[4:7], s14 offen sc1
    v_or3_b32 v4, v96, v97, v4
    v_or3_b32 v4, v98, v99, v4
    v_cmp_le_u32 vcc, s24, v10
    v_add_u32 v10, 16384, v10
    s_add_u32 s14, s25, 49152
    v_cndmask_b32 v12, v11, v1, vcc
    s_waitcnt lgkmcnt(1)
    buffer_store_dwordx4 v[100:103], v12, s[4:7], s14 offen sc1
    v_or3_b32 v4, v100, v101, v4
    v_or3_b32 v4, v102, v103, v4
    v_cmp_le_u32 vcc, s24, v10
    v_add_u32 v10, 16384, v10
    s_add_u32 s14, s25, 0
    v_cndmask_b32 v12, v11, v6, vcc
    s_waitcnt lgkmcnt(0)
    buffer_store_dwordx4 v[104:107], v12, s[4:7], s14 offen sc1
    v_or3_b32 v4, v104, v105, v4
    v_or3_b32 v4, v106, v107, v4
    s_load_dwordx2 s[16:17], s[0:1], 88
    s_cmp_ge_u32 s13, 12
    s_cbranch_scc1 L_p2_gb
    v_lshlrev_b32 v30, 16, v60
    v_and_b32 v31, 0xffff0000, v60
    v_lshlrev_b32 v36, 16, v53
    v_and_b32 v37, 0xffff0000, v53
    v_lshlrev_b32 v38, 16, v54
    v_and_b32 v39, 0xffff0000, v54
    v_lshlrev_b32 v40, 16, v56
    v_and_b32 v41, 0xffff0000, v56
    v_lshlrev_b32 v42, 16, v57
    v_and_b32 v43, 0xffff0000, v57
    v_pk_add_f32 v[14:15], v[30:31], v[36:37] op_sel:[0,0] op_sel_hi:[1,0] neg_lo:[0,1] neg_hi:[0,1]
    v_pk_add_f32 v[16:17], v[30:31], v[36:37] op_sel:[0,1] op_sel_hi:[1,1] neg_lo:[0,1] neg_hi:[0,1]
    v_pk_add_f32 v[18:19], v[30:31], v[38:39] op_sel:[0,0] op_sel_hi:[1,0] neg_lo:[0,1] neg_hi:[0,1]
    v_pk_add_f32 v[20:21], v[30:31], v[38:39] op_sel:[0,1] op_sel_hi:[1,1] neg_lo:[0,1] neg_hi:[0,1]
    v_pk_add_f32 v[22:23], v[30:31], v[40:41] op_sel:[0,0] op_sel_hi:[1,0] neg_lo:[0,1] neg_hi:[0,1]
    v_pk_add_f32 v[24:25], v[30:31], v[40:41] op_sel:[0,1] op_sel_hi:[1,1] neg_lo:[0,1] neg_hi:[0,1]
    v_pk_add_f32 v[26:27], v[30:31], v[42:43] op_sel:[0,0] op_sel_hi:[1,0] neg_lo:[0,1] neg_hi:[0,1]
    v_pk_add_f32 v[28:29], v[30:31], v[42:43] op_sel:[0,1] op_sel_hi:[1,1] neg_lo:[0,1] neg_hi:[0,1]
    v_cvt_pk_bf16_f32 v32, v14, v15
    v_lshlrev_b32 v14, 16, v32
    v_and_b32 v15, 0xffff0000, v32
    v_cvt_pk_bf16_f32 v32, v16, v17
    v_lshlrev_b32 v16, 16, v32
    v_and_b32 v17, 0xffff0000, v32
    v_cvt_pk_bf16_f32 v32, v18, v19
    v_lshlrev_b32 v18, 16, v32
    v_and_b32 v19, 0xffff0000, v32
    v_cvt_pk_bf16_f32 v32, v20, v21
    v_lshlrev_b32 v20, 16, v32
    v_and_b32 v21, 0xffff0000, v32
    v_cvt_pk_bf16_f32 v32, v22, v23
    v_lshlrev_b32 v22, 16, v32
    v_and_b32 v23, 0xffff0000, v32
    v_cvt_pk_bf16_f32 v32, v24, v25
    v_lshlrev_b32 v24, 16, v32
    v_and_b32 v25, 0xffff0000, v32
    v_cvt_pk_bf16_f32 v32, v26, v27
    v_lshlrev_b32 v26, 16, v32
    v_and_b32 v27, 0xffff0000, v32
    v_cvt_pk_bf16_f32 v32, v28, v29
    v_lshlrev_b32 v28, 16, v32
    v_and_b32 v29, 0xffff0000, v32
    v_pk_mul_f32 v[14:15], v[14:15], v[14:15]
    v_pk_mul_f32 v[16:17], v[16:17], v[16:17]
    v_pk_mul_f32 v[18:19], v[18:19], v[18:19]
    v_pk_mul_f32 v[20:21], v[20:21], v[20:21]
    v_pk_mul_f32 v[22:23], v[22:23], v[22:23]
    v_pk_mul_f32 v[24:25], v[24:25], v[24:25]
    v_pk_mul_f32 v[26:27], v[26:27], v[26:27]
    v_pk_mul_f32 v[28:29], v[28:29], v[28:29]
    v_cvt_pk_bf16_f32 v32, v14, v15
    v_lshlrev_b32 v14, 16, v32
    v_and_b32 v15, 0xffff0000, v32
    v_cvt_pk_bf16_f32 v32, v16, v17
    v_lshlrev_b32 v16, 16, v32
    v_and_b32 v17, 0xffff0000, v32
    v_cvt_pk_bf16_f32 v32, v18, v19
    v_lshlrev_b32 v18, 16, v32
    v_and_b32 v19, 0xffff0000, v32
    v_cvt_pk_bf16_f32 v32, v20, v21
    v_lshlrev_b32 v20, 16, v32
    v_and_b32 v21, 0xffff0000, v32
    v_cvt_pk_bf16_f32 v32, v22, v23
    v_lshlrev_b32 v22, 16, v32
    v_and_b32 v23, 0xffff0000, v32
    v_cvt_pk_bf16_f32 v32, v24, v25
    v_lshlrev_b32 v24, 16, v32
    v_and_b32 v25, 0xffff0000, v32
    v_cvt_pk_bf16_f32 v32, v26, v27
    v_lshlrev_b32 v26, 16, v32
    v_and_b32 v27, 0xffff0000, v32
    v_cvt_pk_bf16_f32 v32, v28, v29
    v_lshlrev_b32 v28, 16, v32
    v_and_b32 v29, 0xffff0000, v32
    v_mov_b32 v30, 1092616192
    v_mov_b32 v31, 0x3fb8aa3b
    v_pk_mul_f32 v[14:15], v[14:15], v[30:31] op_sel:[0,0] op_sel_hi:[1,0]
    v_pk_mul_f32 v[16:17], v[16:17], v[30:31] op_sel:[0,0] op_sel_hi:[1,0]
    v_pk_mul_f32 v[18:19], v[18:19], v[30:31] op_sel:[0,0] op_sel_hi:[1,0]
    v_pk_mul_f32 v[20:21], v[20:21], v[30:31] op_sel:[0,0] op_sel_hi:[1,0]
    v_pk_mul_f32 v[22:23], v[22:23], v[30:31] op_sel:[0,0] op_sel_hi:[1,0]
    v_pk_mul_f32 v[24:25], v[24:25], v[30:31] op_sel:[0,0] op_sel_hi:[1,0]
    v_pk_mul_f32 v[26:27], v[26:27], v[30:31] op_sel:[0,0] op_sel_hi:[1,0]
    v_pk_mul_f32 v[28:29], v[28:29], v[30:31] op_sel:[0,0] op_sel_hi:[1,0]
    v_cvt_pk_bf16_f32 v32, v14, v15
    v_lshlrev_b32 v14, 16, v32
    v_and_b32 v15, 0xffff0000, v32
    v_cvt_pk_bf16_f32 v32, v16, v17
    v_lshlrev_b32 v16, 16, v32
    v_and_b32 v17, 0xffff0000, v32
    v_cvt_pk_bf16_f32 v32, v18, v19
    v_lshlrev_b32 v18, 16, v32
    v_and_b32 v19, 0xffff0000, v32
    v_cvt_pk_bf16_f32 v32, v20, v21
    v_lshlrev_b32 v20, 16, v32
    v_and_b32 v21, 0xffff0000, v32
    v_cvt_pk_bf16_f32 v32, v22, v23
    v_lshlrev_b32 v22, 16, v32
    v_and_b32 v23, 0xffff0000, v32
    v_cvt_pk_bf16_f32 v32, v24, v25
    v_lshlrev_b32 v24, 16, v32
    v_and_b32 v25, 0xffff0000, v32
    v_cvt_pk_bf16_f32 v32, v26, v27
    v_lshlrev_b32 v26, 16, v32
    v_and_b32 v27, 0xffff0000, v32
    v_cvt_pk_bf16_f32 v32, v28, v29
    v_lshlrev_b32 v28, 16, v32
    v_and_b32 v29, 0xffff0000, v32
    v_pk_mul_f32 v[14:15], v[14:15], v[30:31] op_sel:[0,1] op_sel_hi:[1,1]
    v_pk_mul_f32 v[16:17], v[16:17], v[30:31] op_sel:[0,1] op_sel_hi:[1,1]
    v_pk_mul_f32 v[18:19], v[18:19], v[30:31] op_sel:[0,1] op_sel_hi:[1,1]
    v_pk_mul_f32 v[20:21], v[20:21], v[30:31] op_sel:[0,1] op_sel_hi:[1,1]
    v_pk_mul_f32 v[22:23], v[22:23], v[30:31] op_sel:[0,1] op_sel_hi:[1,1]
    v_pk_mul_f32 v[24:25], v[24:25], v[30:31] op_sel:[0,1] op_sel_hi:[1,1]
    v_pk_mul_f32 v[26:27], v[26:27], v[30:31] op_sel:[0,1] op_sel_hi:[1,1]
    v_pk_mul_f32 v[28:29], v[28:29], v[30:31] op_sel:[0,1] op_sel_hi:[1,1]
    v_exp_f32 v14, -v14
    v_exp_f32 v15, -v15
    v_exp_f32 v16, -v16
    v_exp_f32 v17, -v17
    v_exp_f32 v18, -v18
    v_exp_f32 v19, -v19
    v_exp_f32 v20, -v20
    v_exp_f32 v21, -v21
    v_exp_f32 v22, -v22
    v_exp_f32 v23, -v23
    v_exp_f32 v24, -v24
    v_exp_f32 v25, -v25
    v_exp_f32 v26, -v26
    v_exp_f32 v27, -v27
    v_exp_f32 v28, -v28
    v_exp_f32 v29, -v29
    v_cvt_pk_bf16_f32 v14, v14, v16
    v_cvt_pk_bf16_f32 v15, v15, v17
    v_cvt_pk_bf16_f32 v18, v18, v20
    v_cvt_pk_bf16_f32 v19, v19, v21
    v_cvt_pk_bf16_f32 v22, v22, v24
    v_cvt_pk_bf16_f32 v23, v23, v25
    v_cvt_pk_bf16_f32 v26, v26, v28
    v_cvt_pk_bf16_f32 v27, v27, v29
    v_dot2_f32_bf16 v72, v14, s68, 0
    v_dot2_f32_bf16 v73, v15, s68, 0
    v_dot2_f32_bf16 v74, v14, s69, 0
    v_dot2_f32_bf16 v75, v15, s69, 0
    v_dot2_f32_bf16 v76, v14, s70, 0
    v_dot2_f32_bf16 v77, v15, s70, 0
    v_dot2_f32_bf16 v78, v14, s71, 0
    v_dot2_f32_bf16 v79, v15, s71, 0
    v_dot2_f32_bf16 v80, v14, s52, 0
    v_dot2_f32_bf16 v81, v15, s52, 0
    v_dot2_f32_bf16 v82, v14, s53, 0
    v_dot2_f32_bf16 v83, v15, s53, 0
    v_dot2_f32_bf16 v84, v14, s54, 0
    v_dot2_f32_bf16 v85, v15, s54, 0
    v_dot2_f32_bf16 v86, v14, s55, 0
    v_dot2_f32_bf16 v87, v15, s55, 0
    v_dot2_f32_bf16 v72, v18, s72, v72
    v_dot2_f32_bf16 v73, v19, s72, v73
    v_dot2_f32_bf16 v74, v18, s73, v74
    v_dot2_f32_bf16 v75, v19, s73, v75
    v_dot2_f32_bf16 v76, v18, s74, v76
    v_dot2_f32_bf16 v77, v19, s74, v77
    v_dot2_f32_bf16 v78, v18, s75, v78
    v_dot2_f32_bf16 v79, v19, s75, v79
    v_dot2_f32_bf16 v80, v18, s56, v80
    v_dot2_f32_bf16 v81, v19, s56, v81
    v_dot2_f32_bf16 v82, v18, s57, v82
    v_dot2_f32_bf16 v83, v19, s57, v83
    v_dot2_f32_bf16 v84, v18, s58, v84
    v_dot2_f32_bf16 v85, v19, s58, v85
    v_dot2_f32_bf16 v86, v18, s59, v86
    v_dot2_f32_bf16 v87, v19, s59, v87
    v_dot2_f32_bf16 v72, v22, s76, v72
    v_dot2_f32_bf16 v73, v23, s76, v73
    v_dot2_f32_bf16 v74, v22, s77, v74
    v_dot2_f32_bf16 v75, v23, s77, v75
    v_dot2_f32_bf16 v76, v22, s78, v76
    v_dot2_f32_bf16 v77, v23, s78, v77
    v_dot2_f32_bf16 v78, v22, s79, v78
    v_dot2_f32_bf16 v79, v23, s79, v79
    v_dot2_f32_bf16 v80, v22, s60, v80
    v_dot2_f32_bf16 v81, v23, s60, v81
    v_dot2_f32_bf16 v82, v22, s61, v82
    v_dot2_f32_bf16 v83, v23, s61, v83
    v_dot2_f32_bf16 v84, v22, s62, v84
    v_dot2_f32_bf16 v85, v23, s62, v85
    v_dot2_f32_bf16 v86, v22, s63, v86
    v_dot2_f32_bf16 v87, v23, s63, v87
    v_dot2_f32_bf16 v72, v26, s80, v72
    v_dot2_f32_bf16 v73, v27, s80, v73
    v_dot2_f32_bf16 v74, v26, s81, v74
    v_dot2_f32_bf16 v75, v27, s81, v75
    v_dot2_f32_bf16 v76, v26, s82, v76
    v_dot2_f32_bf16 v77, v27, s82, v77
    v_dot2_f32_bf16 v78, v26, s83, v78
    v_dot2_f32_bf16 v79, v27, s83, v79
    v_dot2_f32_bf16 v80, v26, s64, v80
    v_dot2_f32_bf16 v81, v27, s64, v81
    v_dot2_f32_bf16 v82, v26, s65, v82
    v_dot2_f32_bf16 v83, v27, s65, v83
    v_dot2_f32_bf16 v84, v26, s66, v84
    v_dot2_f32_bf16 v85, v27, s66, v85
    v_dot2_f32_bf16 v86, v26, s67, v86
    v_dot2_f32_bf16 v87, v27, s67, v87
L_p2_gb:
    v_and_b32 v4, 0x80008000, v4
    v_cmp_ne_u32 vcc, 0, v4
    v_mov_b32 v8, s27
    v_and_b32 v10, 15, v0
    v_mul_u32_u24 v10, 240, v10
    v_add_u32 v10, 160000, v10
    s_cmp_lg_u64 vcc, 0
    s_cselect_b32 s2, 1, s2
    v_mov_b32 v9, s2
    s_mov_b64 exec, 1
    ds_write_b32 v8, v9
    s_mov_b64 exec, -1
    s_mov_b32 s49, s12
    s_mov_b32 s51, 0
    s_waitcnt vmcnt(0) lgkmcnt(0)
    s_barrier
    ds_read_b32 v9, v10
    s_mov_b32 s18, 5120000
    s_mov_b32 s19, 0x00020000
    s_waitcnt lgkmcnt(0)
    v_cmp_ne_u32 vcc, 0, v9
    s_nop 1
    s_cmp_lg_u64 vcc, 0
    s_cselect_b32 s2, 1, 0
    s_cbranch_scc1 L_p2_slow
L_p2_signal:
    v_mov_b32 v8, 160228
    s_lshl_b32 s15, s2, 4
    s_or_b32 s15, s15, s21
    s_add_u32 s14, s12, 16
    s_lshl_b32 s20, s15, s14
    s_add_u32 s20, s20, 1
    v_mov_b32 v9, s20
    s_cmp_lg_u32 s13, 15
    s_cbranch_scc1 L_p2_nosig0
    s_lshl_b32 s14, s3, 8
    s_add_u32 s14, s14, 8523776
    s_mov_b64 exec, 1
    buffer_atomic_add v9, off, s[4:7], s14 sc0
    s_mov_b64 exec, -1
L_p2_nosig0:
    s_cmp_eq_u32 s49, 3
    s_cselect_b32 s15, 8, 0
    s_add_u32 s15, s15, 224
    v_add_u32 v2, 16384, v1
    v_cmp_gt_u32 vcc, s15, v0
    s_mul_i32 s14, s3, 80000
    s_mul_i32 s26, s49, 19968
    s_add_u32 s26, s26, s14
    v_cndmask_b32 v2, 0.5, v2, vcc
    s_mov_b32 s10, 5120000
    s_lshl_b32 s28, s92, 16
    s_and_b32 s29, s92, 0xffff0000
    s_lshl_b32 s30, s93, 16
    s_and_b32 s31, s93, 0xffff0000
    s_lshl_b32 s32, s94, 16
    s_and_b32 s33, s94, 0xffff0000
    s_lshl_b32 s34, s95, 16
    s_and_b32 s35, s95, 0xffff0000
    s_lshl_b32 s36, s96, 16
    s_and_b32 s37, s96, 0xffff0000
    s_lshl_b32 s38, s97, 16
    s_and_b32 s39, s97, 0xffff0000
    s_lshl_b32 s40, s98, 16
    s_and_b32 s41, s98, 0xffff0000
    s_lshl_b32 s42, s99, 16
    s_and_b32 s43, s99, 0xffff0000
    s_and_b32 s99, s91, 0xffff0000
    s_lshl_b32 s98, s91, 16
    s_and_b32 s97, s90, 0xffff0000
    s_lshl_b32 s96, s90, 16
    s_and_b32 s95, s89, 0xffff0000
    s_lshl_b32 s94, s89, 16
    s_and_b32 s93, s88, 0xffff0000
    s_lshl_b32 s92, s88, 16
    s_and_b32 s91, s87, 0xffff0000
    s_lshl_b32 s90, s87, 16
    s_and_b32 s89, s86, 0xffff0000
    s_lshl_b32 s88, s86, 16
    s_and_b32 s87, s85, 0xffff0000
    s_lshl_b32 s86, s85, 16
    s_and_b32 s85, s84, 0xffff0000
    s_lshl_b32 s84, s84, 16
    s_mov_b32 s44, s48
    s_add_u32 s45, s48, 2281701376
    s_cmp_eq_u32 s48, 0
    s_cselect_b32 s45, 0, s45
    s_cmp_lt_u32 s13, 12
    s_cbranch_scc1 L_p2_gc
    v_lshlrev_b32 v30, 16, v60
    v_and_b32 v31, 0xffff0000, v60
    v_lshlrev_b32 v36, 16, v53
    v_and_b32 v37, 0xffff0000, v53
    v_lshlrev_b32 v38, 16, v54
    v_and_b32 v39, 0xffff0000, v54
    v_lshlrev_b32 v40, 16, v56
    v_and_b32 v41, 0xffff0000, v56
    v_lshlrev_b32 v42, 16, v57
    v_and_b32 v43, 0xffff0000, v57
    v_pk_add_f32 v[14:15], v[30:31], v[36:37] op_sel:[0,0] op_sel_hi:[1,0] neg_lo:[0,1] neg_hi:[0,1]
    v_pk_add_f32 v[16:17], v[30:31], v[36:37] op_sel:[0,1] op_sel_hi:[1,1] neg_lo:[0,1] neg_hi:[0,1]
    v_pk_add_f32 v[18:19], v[30:31], v[38:39] op_sel:[0,0] op_sel_hi:[1,0] neg_lo:[0,1] neg_hi:[0,1]
    v_pk_add_f32 v[20:21], v[30:31], v[38:39] op_sel:[0,1] op_sel_hi:[1,1] neg_lo:[0,1] neg_hi:[0,1]
    v_pk_add_f32 v[22:23], v[30:31], v[40:41] op_sel:[0,0] op_sel_hi:[1,0] neg_lo:[0,1] neg_hi:[0,1]
    v_pk_add_f32 v[24:25], v[30:31], v[40:41] op_sel:[0,1] op_sel_hi:[1,1] neg_lo:[0,1] neg_hi:[0,1]
    v_pk_add_f32 v[26:27], v[30:31], v[42:43] op_sel:[0,0] op_sel_hi:[1,0] neg_lo:[0,1] neg_hi:[0,1]
    v_pk_add_f32 v[28:29], v[30:31], v[42:43] op_sel:[0,1] op_sel_hi:[1,1] neg_lo:[0,1] neg_hi:[0,1]
    v_cvt_pk_bf16_f32 v32, v14, v15
    v_lshlrev_b32 v14, 16, v32
    v_and_b32 v15, 0xffff0000, v32
    v_cvt_pk_bf16_f32 v32, v16, v17
    v_lshlrev_b32 v16, 16, v32
    v_and_b32 v17, 0xffff0000, v32
    v_cvt_pk_bf16_f32 v32, v18, v19
    v_lshlrev_b32 v18, 16, v32
    v_and_b32 v19, 0xffff0000, v32
    v_cvt_pk_bf16_f32 v32, v20, v21
    v_lshlrev_b32 v20, 16, v32
    v_and_b32 v21, 0xffff0000, v32
    v_cvt_pk_bf16_f32 v32, v22, v23
    v_lshlrev_b32 v22, 16, v32
    v_and_b32 v23, 0xffff0000, v32
    v_cvt_pk_bf16_f32 v32, v24, v25
    v_lshlrev_b32 v24, 16, v32
    v_and_b32 v25, 0xffff0000, v32
    v_cvt_pk_bf16_f32 v32, v26, v27
    v_lshlrev_b32 v26, 16, v32
    v_and_b32 v27, 0xffff0000, v32
    v_cvt_pk_bf16_f32 v32, v28, v29
    v_lshlrev_b32 v28, 16, v32
    v_and_b32 v29, 0xffff0000, v32
    v_pk_mul_f32 v[14:15], v[14:15], v[14:15]
    v_pk_mul_f32 v[16:17], v[16:17], v[16:17]
    v_pk_mul_f32 v[18:19], v[18:19], v[18:19]
    v_pk_mul_f32 v[20:21], v[20:21], v[20:21]
    v_pk_mul_f32 v[22:23], v[22:23], v[22:23]
    v_pk_mul_f32 v[24:25], v[24:25], v[24:25]
    v_pk_mul_f32 v[26:27], v[26:27], v[26:27]
    v_pk_mul_f32 v[28:29], v[28:29], v[28:29]
    v_cvt_pk_bf16_f32 v32, v14, v15
    v_lshlrev_b32 v14, 16, v32
    v_and_b32 v15, 0xffff0000, v32
    v_cvt_pk_bf16_f32 v32, v16, v17
    v_lshlrev_b32 v16, 16, v32
    v_and_b32 v17, 0xffff0000, v32
    v_cvt_pk_bf16_f32 v32, v18, v19
    v_lshlrev_b32 v18, 16, v32
    v_and_b32 v19, 0xffff0000, v32
    v_cvt_pk_bf16_f32 v32, v20, v21
    v_lshlrev_b32 v20, 16, v32
    v_and_b32 v21, 0xffff0000, v32
    v_cvt_pk_bf16_f32 v32, v22, v23
    v_lshlrev_b32 v22, 16, v32
    v_and_b32 v23, 0xffff0000, v32
    v_cvt_pk_bf16_f32 v32, v24, v25
    v_lshlrev_b32 v24, 16, v32
    v_and_b32 v25, 0xffff0000, v32
    v_cvt_pk_bf16_f32 v32, v26, v27
    v_lshlrev_b32 v26, 16, v32
    v_and_b32 v27, 0xffff0000, v32
    v_cvt_pk_bf16_f32 v32, v28, v29
    v_lshlrev_b32 v28, 16, v32
    v_and_b32 v29, 0xffff0000, v32
    v_mov_b32 v30, 1092616192
    v_mov_b32 v31, 0x3fb8aa3b
    v_pk_mul_f32 v[14:15], v[14:15], v[30:31] op_sel:[0,0] op_sel_hi:[1,0]
    v_pk_mul_f32 v[16:17], v[16:17], v[30:31] op_sel:[0,0] op_sel_hi:[1,0]
    v_pk_mul_f32 v[18:19], v[18:19], v[30:31] op_sel:[0,0] op_sel_hi:[1,0]
    v_pk_mul_f32 v[20:21], v[20:21], v[30:31] op_sel:[0,0] op_sel_hi:[1,0]
    v_pk_mul_f32 v[22:23], v[22:23], v[30:31] op_sel:[0,0] op_sel_hi:[1,0]
    v_pk_mul_f32 v[24:25], v[24:25], v[30:31] op_sel:[0,0] op_sel_hi:[1,0]
    v_pk_mul_f32 v[26:27], v[26:27], v[30:31] op_sel:[0,0] op_sel_hi:[1,0]
    v_pk_mul_f32 v[28:29], v[28:29], v[30:31] op_sel:[0,0] op_sel_hi:[1,0]
    v_cvt_pk_bf16_f32 v32, v14, v15
    v_lshlrev_b32 v14, 16, v32
    v_and_b32 v15, 0xffff0000, v32
    v_cvt_pk_bf16_f32 v32, v16, v17
    v_lshlrev_b32 v16, 16, v32
    v_and_b32 v17, 0xffff0000, v32
    v_cvt_pk_bf16_f32 v32, v18, v19
    v_lshlrev_b32 v18, 16, v32
    v_and_b32 v19, 0xffff0000, v32
    v_cvt_pk_bf16_f32 v32, v20, v21
    v_lshlrev_b32 v20, 16, v32
    v_and_b32 v21, 0xffff0000, v32
    v_cvt_pk_bf16_f32 v32, v22, v23
    v_lshlrev_b32 v22, 16, v32
    v_and_b32 v23, 0xffff0000, v32
    v_cvt_pk_bf16_f32 v32, v24, v25
    v_lshlrev_b32 v24, 16, v32
    v_and_b32 v25, 0xffff0000, v32
    v_cvt_pk_bf16_f32 v32, v26, v27
    v_lshlrev_b32 v26, 16, v32
    v_and_b32 v27, 0xffff0000, v32
    v_cvt_pk_bf16_f32 v32, v28, v29
    v_lshlrev_b32 v28, 16, v32
    v_and_b32 v29, 0xffff0000, v32
    v_pk_mul_f32 v[14:15], v[14:15], v[30:31] op_sel:[0,1] op_sel_hi:[1,1]
    v_pk_mul_f32 v[16:17], v[16:17], v[30:31] op_sel:[0,1] op_sel_hi:[1,1]
    v_pk_mul_f32 v[18:19], v[18:19], v[30:31] op_sel:[0,1] op_sel_hi:[1,1]
    v_pk_mul_f32 v[20:21], v[20:21], v[30:31] op_sel:[0,1] op_sel_hi:[1,1]
    v_pk_mul_f32 v[22:23], v[22:23], v[30:31] op_sel:[0,1] op_sel_hi:[1,1]
    v_pk_mul_f32 v[24:25], v[24:25], v[30:31] op_sel:[0,1] op_sel_hi:[1,1]
    v_pk_mul_f32 v[26:27], v[26:27], v[30:31] op_sel:[0,1] op_sel_hi:[1,1]
    v_pk_mul_f32 v[28:29], v[28:29], v[30:31] op_sel:[0,1] op_sel_hi:[1,1]
    v_exp_f32 v14, -v14
    v_exp_f32 v15, -v15
    v_exp_f32 v16, -v16
    v_exp_f32 v17, -v17
    v_exp_f32 v18, -v18
    v_exp_f32 v19, -v19
    v_exp_f32 v20, -v20
    v_exp_f32 v21, -v21
    v_exp_f32 v22, -v22
    v_exp_f32 v23, -v23
    v_exp_f32 v24, -v24
    v_exp_f32 v25, -v25
    v_exp_f32 v26, -v26
    v_exp_f32 v27, -v27
    v_exp_f32 v28, -v28
    v_exp_f32 v29, -v29
    v_cvt_pk_bf16_f32 v14, v14, v16
    v_cvt_pk_bf16_f32 v15, v15, v17
    v_cvt_pk_bf16_f32 v18, v18, v20
    v_cvt_pk_bf16_f32 v19, v19, v21
    v_cvt_pk_bf16_f32 v22, v22, v24
    v_cvt_pk_bf16_f32 v23, v23, v25
    v_cvt_pk_bf16_f32 v26, v26, v28
    v_cvt_pk_bf16_f32 v27, v27, v29
    v_dot2_f32_bf16 v72, v14, s68, 0
    v_dot2_f32_bf16 v73, v15, s68, 0
    v_dot2_f32_bf16 v74, v14, s69, 0
    v_dot2_f32_bf16 v75, v15, s69, 0
    v_dot2_f32_bf16 v76, v14, s70, 0
    v_dot2_f32_bf16 v77, v15, s70, 0
    v_dot2_f32_bf16 v78, v14, s71, 0
    v_dot2_f32_bf16 v79, v15, s71, 0
    v_dot2_f32_bf16 v80, v14, s52, 0
    v_dot2_f32_bf16 v81, v15, s52, 0
    v_dot2_f32_bf16 v82, v14, s53, 0
    v_dot2_f32_bf16 v83, v15, s53, 0
    v_dot2_f32_bf16 v84, v14, s54, 0
    v_dot2_f32_bf16 v85, v15, s54, 0
    v_dot2_f32_bf16 v86, v14, s55, 0
    v_dot2_f32_bf16 v87, v15, s55, 0
    v_dot2_f32_bf16 v72, v18, s72, v72
    v_dot2_f32_bf16 v73, v19, s72, v73
    v_dot2_f32_bf16 v74, v18, s73, v74
    v_dot2_f32_bf16 v75, v19, s73, v75
    v_dot2_f32_bf16 v76, v18, s74, v76
    v_dot2_f32_bf16 v77, v19, s74, v77
    v_dot2_f32_bf16 v78, v18, s75, v78
    v_dot2_f32_bf16 v79, v19, s75, v79
    v_dot2_f32_bf16 v80, v18, s56, v80
    v_dot2_f32_bf16 v81, v19, s56, v81
    v_dot2_f32_bf16 v82, v18, s57, v82
    v_dot2_f32_bf16 v83, v19, s57, v83
    v_dot2_f32_bf16 v84, v18, s58, v84
    v_dot2_f32_bf16 v85, v19, s58, v85
    v_dot2_f32_bf16 v86, v18, s59, v86
    v_dot2_f32_bf16 v87, v19, s59, v87
    v_dot2_f32_bf16 v72, v22, s76, v72
    v_dot2_f32_bf16 v73, v23, s76, v73
    v_dot2_f32_bf16 v74, v22, s77, v74
    v_dot2_f32_bf16 v75, v23, s77, v75
    v_dot2_f32_bf16 v76, v22, s78, v76
    v_dot2_f32_bf16 v77, v23, s78, v77
    v_dot2_f32_bf16 v78, v22, s79, v78
    v_dot2_f32_bf16 v79, v23, s79, v79
    v_dot2_f32_bf16 v80, v22, s60, v80
    v_dot2_f32_bf16 v81, v23, s60, v81
    v_dot2_f32_bf16 v82, v22, s61, v82
    v_dot2_f32_bf16 v83, v23, s61, v83
    v_dot2_f32_bf16 v84, v22, s62, v84
    v_dot2_f32_bf16 v85, v23, s62, v85
    v_dot2_f32_bf16 v86, v22, s63, v86
    v_dot2_f32_bf16 v87, v23, s63, v87
    v_dot2_f32_bf16 v72, v26, s80, v72
    v_dot2_f32_bf16 v73, v27, s80, v73
    v_dot2_f32_bf16 v74, v26, s81, v74
    v_dot2_f32_bf16 v75, v27, s81, v75
    v_dot2_f32_bf16 v76, v26, s82, v76
    v_dot2_f32_bf16 v77, v27, s82, v77
    v_dot2_f32_bf16 v78, v26, s83, v78
    v_dot2_f32_bf16 v79, v27, s83, v79
    v_dot2_f32_bf16 v80, v26, s64, v80
    v_dot2_f32_bf16 v81, v27, s64, v81
    v_dot2_f32_bf16 v82, v26, s65, v82
    v_dot2_f32_bf16 v83, v27, s65, v83
    v_dot2_f32_bf16 v84, v26, s66, v84
    v_dot2_f32_bf16 v85, v27, s66, v85
    v_dot2_f32_bf16 v86, v26, s67, v86
    v_dot2_f32_bf16 v87, v27, s67, v87
L_p2_gc:
    s_cmp_ge_u32 s13, 4
    s_cbranch_scc1 L_p2_gd
    v_lshlrev_b32 v30, 16, v61
    v_and_b32 v31, 0xffff0000, v61
    v_pk_add_f32 v[14:15], v[30:31], v[36:37] op_sel:[0,0] op_sel_hi:[1,0] neg_lo:[0,1] neg_hi:[0,1]
    v_pk_add_f32 v[16:17], v[30:31], v[36:37] op_sel:[0,1] op_sel_hi:[1,1] neg_lo:[0,1] neg_hi:[0,1]
    v_pk_add_f32 v[18:19], v[30:31], v[38:39] op_sel:[0,0] op_sel_hi:[1,0] neg_lo:[0,1] neg_hi:[0,1]
    v_pk_add_f32 v[20:21], v[30:31], v[38:39] op_sel:[0,1] op_sel_hi:[1,1] neg_lo:[0,1] neg_hi:[0,1]
    v_pk_add_f32 v[22:23], v[30:31], v[40:41] op_sel:[0,0] op_sel_hi:[1,0] neg_lo:[0,1] neg_hi:[0,1]
    v_pk_add_f32 v[24:25], v[30:31], v[40:41] op_sel:[0,1] op_sel_hi:[1,1] neg_lo:[0,1] neg_hi:[0,1]
    v_pk_add_f32 v[26:27], v[30:31], v[42:43] op_sel:[0,0] op_sel_hi:[1,0] neg_lo:[0,1] neg_hi:[0,1]
    v_pk_add_f32 v[28:29], v[30:31], v[42:43] op_sel:[0,1] op_sel_hi:[1,1] neg_lo:[0,1] neg_hi:[0,1]
    v_cvt_pk_bf16_f32 v32, v14, v15
    v_lshlrev_b32 v14, 16, v32
    v_and_b32 v15, 0xffff0000, v32
    v_cvt_pk_bf16_f32 v32, v16, v17
    v_lshlrev_b32 v16, 16, v32
    v_and_b32 v17, 0xffff0000, v32
    v_cvt_pk_bf16_f32 v32, v18, v19
    v_lshlrev_b32 v18, 16, v32
    v_and_b32 v19, 0xffff0000, v32
    v_cvt_pk_bf16_f32 v32, v20, v21
    v_lshlrev_b32 v20, 16, v32
    v_and_b32 v21, 0xffff0000, v32
    v_cvt_pk_bf16_f32 v32, v22, v23
    v_lshlrev_b32 v22, 16, v32
    v_and_b32 v23, 0xffff0000, v32
    v_cvt_pk_bf16_f32 v32, v24, v25
    v_lshlrev_b32 v24, 16, v32
    v_and_b32 v25, 0xffff0000, v32
    v_cvt_pk_bf16_f32 v32, v26, v27
    v_lshlrev_b32 v26, 16, v32
    v_and_b32 v27, 0xffff0000, v32
    v_cvt_pk_bf16_f32 v32, v28, v29
    v_lshlrev_b32 v28, 16, v32
    v_and_b32 v29, 0xffff0000, v32
    v_pk_mul_f32 v[14:15], v[14:15], v[14:15]
    v_pk_mul_f32 v[16:17], v[16:17], v[16:17]
    v_pk_mul_f32 v[18:19], v[18:19], v[18:19]
    v_pk_mul_f32 v[20:21], v[20:21], v[20:21]
    v_pk_mul_f32 v[22:23], v[22:23], v[22:23]
    v_pk_mul_f32 v[24:25], v[24:25], v[24:25]
    v_pk_mul_f32 v[26:27], v[26:27], v[26:27]
    v_pk_mul_f32 v[28:29], v[28:29], v[28:29]
    v_cvt_pk_bf16_f32 v32, v14, v15
    v_lshlrev_b32 v14, 16, v32
    v_and_b32 v15, 0xffff0000, v32
    v_cvt_pk_bf16_f32 v32, v16, v17
    v_lshlrev_b32 v16, 16, v32
    v_and_b32 v17, 0xffff0000, v32
    v_cvt_pk_bf16_f32 v32, v18, v19
    v_lshlrev_b32 v18, 16, v32
    v_and_b32 v19, 0xffff0000, v32
    v_cvt_pk_bf16_f32 v32, v20, v21
    v_lshlrev_b32 v20, 16, v32
    v_and_b32 v21, 0xffff0000, v32
    v_cvt_pk_bf16_f32 v32, v22, v23
    v_lshlrev_b32 v22, 16, v32
    v_and_b32 v23, 0xffff0000, v32
    v_cvt_pk_bf16_f32 v32, v24, v25
    v_lshlrev_b32 v24, 16, v32
    v_and_b32 v25, 0xffff0000, v32
    v_cvt_pk_bf16_f32 v32, v26, v27
    v_lshlrev_b32 v26, 16, v32
    v_and_b32 v27, 0xffff0000, v32
    v_cvt_pk_bf16_f32 v32, v28, v29
    v_lshlrev_b32 v28, 16, v32
    v_and_b32 v29, 0xffff0000, v32
    v_mov_b32 v30, 1092616192
    v_mov_b32 v31, 0x3fb8aa3b
    v_pk_mul_f32 v[14:15], v[14:15], v[30:31] op_sel:[0,0] op_sel_hi:[1,0]
    v_pk_mul_f32 v[16:17], v[16:17], v[30:31] op_sel:[0,0] op_sel_hi:[1,0]
    v_pk_mul_f32 v[18:19], v[18:19], v[30:31] op_sel:[0,0] op_sel_hi:[1,0]
    v_pk_mul_f32 v[20:21], v[20:21], v[30:31] op_sel:[0,0] op_sel_hi:[1,0]
    v_pk_mul_f32 v[22:23], v[22:23], v[30:31] op_sel:[0,0] op_sel_hi:[1,0]
    v_pk_mul_f32 v[24:25], v[24:25], v[30:31] op_sel:[0,0] op_sel_hi:[1,0]
    v_pk_mul_f32 v[26:27], v[26:27], v[30:31] op_sel:[0,0] op_sel_hi:[1,0]
    v_pk_mul_f32 v[28:29], v[28:29], v[30:31] op_sel:[0,0] op_sel_hi:[1,0]
    v_cvt_pk_bf16_f32 v32, v14, v15
    v_lshlrev_b32 v14, 16, v32
    v_and_b32 v15, 0xffff0000, v32
    v_cvt_pk_bf16_f32 v32, v16, v17
    v_lshlrev_b32 v16, 16, v32
    v_and_b32 v17, 0xffff0000, v32
    v_cvt_pk_bf16_f32 v32, v18, v19
    v_lshlrev_b32 v18, 16, v32
    v_and_b32 v19, 0xffff0000, v32
    v_cvt_pk_bf16_f32 v32, v20, v21
    v_lshlrev_b32 v20, 16, v32
    v_and_b32 v21, 0xffff0000, v32
    v_cvt_pk_bf16_f32 v32, v22, v23
    v_lshlrev_b32 v22, 16, v32
    v_and_b32 v23, 0xffff0000, v32
    v_cvt_pk_bf16_f32 v32, v24, v25
    v_lshlrev_b32 v24, 16, v32
    v_and_b32 v25, 0xffff0000, v32
    v_cvt_pk_bf16_f32 v32, v26, v27
    v_lshlrev_b32 v26, 16, v32
    v_and_b32 v27, 0xffff0000, v32
    v_cvt_pk_bf16_f32 v32, v28, v29
    v_lshlrev_b32 v28, 16, v32
    v_and_b32 v29, 0xffff0000, v32
    v_pk_mul_f32 v[14:15], v[14:15], v[30:31] op_sel:[0,1] op_sel_hi:[1,1]
    v_pk_mul_f32 v[16:17], v[16:17], v[30:31] op_sel:[0,1] op_sel_hi:[1,1]
    v_pk_mul_f32 v[18:19], v[18:19], v[30:31] op_sel:[0,1] op_sel_hi:[1,1]
    v_pk_mul_f32 v[20:21], v[20:21], v[30:31] op_sel:[0,1] op_sel_hi:[1,1]
    v_pk_mul_f32 v[22:23], v[22:23], v[30:31] op_sel:[0,1] op_sel_hi:[1,1]
    v_pk_mul_f32 v[24:25], v[24:25], v[30:31] op_sel:[0,1] op_sel_hi:[1,1]
    v_pk_mul_f32 v[26:27], v[26:27], v[30:31] op_sel:[0,1] op_sel_hi:[1,1]
    v_pk_mul_f32 v[28:29], v[28:29], v[30:31] op_sel:[0,1] op_sel_hi:[1,1]
    v_exp_f32 v14, -v14
    v_exp_f32 v15, -v15
    v_exp_f32 v16, -v16
    v_exp_f32 v17, -v17
    v_exp_f32 v18, -v18
    v_exp_f32 v19, -v19
    v_exp_f32 v20, -v20
    v_exp_f32 v21, -v21
    v_exp_f32 v22, -v22
    v_exp_f32 v23, -v23
    v_exp_f32 v24, -v24
    v_exp_f32 v25, -v25
    v_exp_f32 v26, -v26
    v_exp_f32 v27, -v27
    v_exp_f32 v28, -v28
    v_exp_f32 v29, -v29
    v_cvt_pk_bf16_f32 v14, v14, v16
    v_cvt_pk_bf16_f32 v15, v15, v17
    v_cvt_pk_bf16_f32 v18, v18, v20
    v_cvt_pk_bf16_f32 v19, v19, v21
    v_cvt_pk_bf16_f32 v22, v22, v24
    v_cvt_pk_bf16_f32 v23, v23, v25
    v_cvt_pk_bf16_f32 v26, v26, v28
    v_cvt_pk_bf16_f32 v27, v27, v29
    v_dot2_f32_bf16 v112, v14, s68, 0
    v_dot2_f32_bf16 v113, v15, s68, 0
    v_dot2_f32_bf16 v114, v14, s69, 0
    v_dot2_f32_bf16 v115, v15, s69, 0
    v_dot2_f32_bf16 v116, v14, s70, 0
    v_dot2_f32_bf16 v117, v15, s70, 0
    v_dot2_f32_bf16 v118, v14, s71, 0
    v_dot2_f32_bf16 v119, v15, s71, 0
    v_dot2_f32_bf16 v120, v14, s52, 0
    v_dot2_f32_bf16 v121, v15, s52, 0
    v_dot2_f32_bf16 v122, v14, s53, 0
    v_dot2_f32_bf16 v123, v15, s53, 0
    v_dot2_f32_bf16 v124, v14, s54, 0
    v_dot2_f32_bf16 v125, v15, s54, 0
    v_dot2_f32_bf16 v126, v14, s55, 0
    v_dot2_f32_bf16 v127, v15, s55, 0
    v_dot2_f32_bf16 v112, v18, s72, v112
    v_dot2_f32_bf16 v113, v19, s72, v113
    v_dot2_f32_bf16 v114, v18, s73, v114
    v_dot2_f32_bf16 v115, v19, s73, v115
    v_dot2_f32_bf16 v116, v18, s74, v116
    v_dot2_f32_bf16 v117, v19, s74, v117
    v_dot2_f32_bf16 v118, v18, s75, v118
    v_dot2_f32_bf16 v119, v19, s75, v119
    v_dot2_f32_bf16 v120, v18, s56, v120
    v_dot2_f32_bf16 v121, v19, s56, v121
    v_dot2_f32_bf16 v122, v18, s57, v122
    v_dot2_f32_bf16 v123, v19, s57, v123
    v_dot2_f32_bf16 v124, v18, s58, v124
    v_dot2_f32_bf16 v125, v19, s58, v125
    v_dot2_f32_bf16 v126, v18, s59, v126
    v_dot2_f32_bf16 v127, v19, s59, v127
    v_dot2_f32_bf16 v112, v22, s76, v112
    v_dot2_f32_bf16 v113, v23, s76, v113
    v_dot2_f32_bf16 v114, v22, s77, v114
    v_dot2_f32_bf16 v115, v23, s77, v115
    v_dot2_f32_bf16 v116, v22, s78, v116
    v_dot2_f32_bf16 v117, v23, s78, v117
    v_dot2_f32_bf16 v118, v22, s79, v118
    v_dot2_f32_bf16 v119, v23, s79, v119
    v_dot2_f32_bf16 v120, v22, s60, v120
    v_dot2_f32_bf16 v121, v23, s60, v121
    v_dot2_f32_bf16 v122, v22, s61, v122
    v_dot2_f32_bf16 v123, v23, s61, v123
    v_dot2_f32_bf16 v124, v22, s62, v124
    v_dot2_f32_bf16 v125, v23, s62, v125
    v_dot2_f32_bf16 v126, v22, s63, v126
    v_dot2_f32_bf16 v127, v23, s63, v127
    v_dot2_f32_bf16 v112, v26, s80, v112
    v_dot2_f32_bf16 v113, v27, s80, v113
    v_dot2_f32_bf16 v114, v26, s81, v114
    v_dot2_f32_bf16 v115, v27, s81, v115
    v_dot2_f32_bf16 v116, v26, s82, v116
    v_dot2_f32_bf16 v117, v27, s82, v117
    v_dot2_f32_bf16 v118, v26, s83, v118
    v_dot2_f32_bf16 v119, v27, s83, v119
    v_dot2_f32_bf16 v120, v26, s64, v120
    v_dot2_f32_bf16 v121, v27, s64, v121
    v_dot2_f32_bf16 v122, v26, s65, v122
    v_dot2_f32_bf16 v123, v27, s65, v123
    v_dot2_f32_bf16 v124, v26, s66, v124
    v_dot2_f32_bf16 v125, v27, s66, v125
    v_dot2_f32_bf16 v126, v26, s67, v126
    v_dot2_f32_bf16 v127, v27, s67, v127
L_p2_gd:
    s_cmp_lg_u32 s13, 15
    s_cbranch_scc1 L_p2_nosig
    s_waitcnt vmcnt(0)
    v_readfirstlane_b32 s15, v9
    s_lshl_b32 s51, 1, s12
    s_add_u32 s20, s20, s15
    s_and_b32 s15, s20, 0xff
    s_cmp_eq_u32 s15, 4
    s_cbranch_scc0 L_p2_notlast
    s_bfe_u32 s15, s20, 262160
    s_or_b32 s51, s51, s15
    s_branch L_p2_pub
L_p2_notlast:
    s_cmp_lg_u32 s21, 0
    s_cselect_b32 s51, 0, s51
    s_cbranch_scc1 L_p2_pub
L_p2_poll:
    v_mov_b32 v9, 0
    s_lshl_b32 s14, s3, 8
    s_add_u32 s14, s14, 8523776
    s_mov_b64 exec, 1
    buffer_atomic_add v9, off, s[4:7], s14 sc0
    s_mov_b64 exec, -1
    s_waitcnt vmcnt(0)
    v_readfirstlane_b32 s20, v9
    s_nop 0
    s_and_b32 s15, s20, 0xff
    s_cmp_lt_u32 s15, 4
    s_cbranch_scc1 L_p2_poll
L_p2_pub:
    s_lshl_b32 s15, s51, 24
    s_or_b32 s15, s15, s20
    v_mov_b32 v9, s15
    s_mov_b64 exec, 1
    ds_write_b32 v8, v9
    s_mov_b64 exec, -1
    s_waitcnt lgkmcnt(0)
L_p2_nosig:
    s_barrier
    ds_read_b32 v9, v8
    s_waitcnt lgkmcnt(0)
    v_readfirstlane_b32 s20, v9
    s_nop 0
    s_lshr_b32 s51, s20, 24
    s_cbranch_scc0 L_p2_end
L_p2_fin:
    s_mul_i32 s24, s49, 19968
    s_add_u32 s14, s12, 1
    s_and_b32 s14, s14, 3
    s_mul_i32 s15, s14, 5120000
    s_add_u32 s15, s15, 228589568
    s_add_u32 s15, s15, s26
    buffer_load_dwordx4 v[12:15], v1, s[4:7], s15 offen sc1
    buffer_load_dwordx4 v[92:95], v2, s[4:7], s15 offen sc1
    s_add_u32 s14, s12, 2
    s_and_b32 s14, s14, 3
    s_mul_i32 s15, s14, 5120000
    s_add_u32 s15, s15, 228589568
    s_add_u32 s15, s15, s26
    buffer_load_dwordx4 v[16:19], v1, s[4:7], s15 offen sc1
    buffer_load_dwordx4 v[96:99], v2, s[4:7], s15 offen sc1
    s_add_u32 s14, s12, 3
    s_and_b32 s14, s14, 3
    s_mul_i32 s15, s14, 5120000
    s_add_u32 s15, s15, 228589568
    s_add_u32 s15, s15, s26
    buffer_load_dwordx4 v[20:23], v1, s[4:7], s15 offen sc1
    buffer_load_dwordx4 v[100:103], v2, s[4:7], s15 offen sc1
    v_add_u32 v24, s24, v1
    ds_read_b128 v[8:11], v24
    v_add_u32 v25, s24, v2
    ds_read_b128 v[88:91], v25
    s_waitcnt vmcnt(0) lgkmcnt(0)
    s_bfe_u32 s14, s20, 262164
    s_cbranch_scc0 L_p2_kernel_nof32a_10
    s_add_u32 s14, s12, 0
    s_and_b32 s14, s14, 3
    s_add_u32 s14, s14, 20
    s_bitcmp1_b32 s20, s14
    s_cbranch_scc0 L_p2_kernel_q_11
    v_mov_b32 v8, 1073758208
    v_mov_b32 v9, 1073758208
    v_mov_b32 v10, 1073758208
    v_mov_b32 v11, 1073758208
L_p2_kernel_q_11:
    s_add_u32 s14, s12, 1
    s_and_b32 s14, s14, 3
    s_add_u32 s14, s14, 20
    s_bitcmp1_b32 s20, s14
    s_cbranch_scc0 L_p2_kernel_q_12
    v_mov_b32 v12, 1073758208
    v_mov_b32 v13, 1073758208
    v_mov_b32 v14, 1073758208
    v_mov_b32 v15, 1073758208
L_p2_kernel_q_12:
    s_add_u32 s14, s12, 2
    s_and_b32 s14, s14, 3
    s_add_u32 s14, s14, 20
    s_bitcmp1_b32 s20, s14
    s_cbranch_scc0 L_p2_kernel_q_13
    v_mov_b32 v16, 1073758208
    v_mov_b32 v17, 1073758208
    v_mov_b32 v18, 1073758208
    v_mov_b32 v19, 1073758208
L_p2_kernel_q_13:
    s_add_u32 s14, s12, 3
    s_and_b32 s14, s14, 3
    s_add_u32 s14, s14, 20
    s_bitcmp1_b32 s20, s14
    s_cbranch_scc0 L_p2_kernel_q_14
    v_mov_b32 v20, 1073758208
    v_mov_b32 v21, 1073758208
    v_mov_b32 v22, 1073758208
    v_mov_b32 v23, 1073758208
L_p2_kernel_q_14:
L_p2_kernel_nof32a_10:
    v_pk_add_u16 v8, v8, v12
    v_pk_add_u16 v16, v16, v20
    v_pk_add_u16 v9, v9, v13
    v_pk_add_u16 v17, v17, v21
    v_pk_add_u16 v10, v10, v14
    v_pk_add_u16 v18, v18, v22
    v_pk_add_u16 v11, v11, v15
    v_pk_add_u16 v19, v19, v23
    v_add_u32_sdwa v24, v8, v16 dst_sel:DWORD dst_unused:UNUSED_PAD src0_sel:WORD_0 src1_sel:WORD_0
    v_add_u32_sdwa v25, v10, v18 dst_sel:DWORD dst_unused:UNUSED_PAD src0_sel:WORD_0 src1_sel:WORD_0
    v_add_u32_sdwa v26, v8, v16 dst_sel:DWORD dst_unused:UNUSED_PAD src0_sel:WORD_1 src1_sel:WORD_1
    v_add_u32_sdwa v27, v10, v18 dst_sel:DWORD dst_unused:UNUSED_PAD src0_sel:WORD_1 src1_sel:WORD_1
    v_add_u32_sdwa v28, v9, v17 dst_sel:DWORD dst_unused:UNUSED_PAD src0_sel:WORD_0 src1_sel:WORD_0
    v_add_u32_sdwa v29, v11, v19 dst_sel:DWORD dst_unused:UNUSED_PAD src0_sel:WORD_0 src1_sel:WORD_0
    v_add_u32_sdwa v30, v9, v17 dst_sel:DWORD dst_unused:UNUSED_PAD src0_sel:WORD_1 src1_sel:WORD_1
    v_add_u32_sdwa v31, v11, v19 dst_sel:DWORD dst_unused:UNUSED_PAD src0_sel:WORD_1 src1_sel:WORD_1
    v_cvt_f32_u32 v24, v24
    v_cvt_f32_u32 v25, v25
    v_cvt_f32_u32 v26, v26
    v_cvt_f32_u32 v27, v27
    v_cvt_f32_u32 v28, v28
    v_cvt_f32_u32 v29, v29
    v_cvt_f32_u32 v30, v30
    v_cvt_f32_u32 v31, v31
    v_pk_fma_f32 v[24:25], v[24:25], s[44:45], s[44:45] op_sel:[0,0,1] op_sel_hi:[1,0,1]
    v_pk_fma_f32 v[26:27], v[26:27], s[44:45], s[44:45] op_sel:[0,0,1] op_sel_hi:[1,0,1]
    v_pk_fma_f32 v[28:29], v[28:29], s[44:45], s[44:45] op_sel:[0,0,1] op_sel_hi:[1,0,1]
    v_pk_fma_f32 v[30:31], v[30:31], s[44:45], s[44:45] op_sel:[0,0,1] op_sel_hi:[1,0,1]
    s_bfe_u32 s14, s20, 262164
    s_cbranch_scc0 L_p2_kernel_nof32b_15
    v_lshlrev_b32 v32, 1, v1
    s_bitcmp1_b32 s20, 20
    s_cbranch_scc0 L_p2_kernel_q_16
    s_lshl_b32 s15, s26, 1
    s_add_u32 s15, s15, 249069568
    buffer_load_dwordx4 v[8:11], v32, s[4:7], s15 offen sc1
    buffer_load_dwordx4 v[12:15], v32, s[4:7], s15 offen offset:16 sc1
    s_waitcnt vmcnt(0)
    v_add_f32 v24, v24, v8
    v_add_f32 v25, v25, v12
    v_add_f32 v26, v26, v9
    v_add_f32 v27, v27, v13
    v_add_f32 v28, v28, v10
    v_add_f32 v29, v29, v14
    v_add_f32 v30, v30, v11
    v_add_f32 v31, v31, v15
L_p2_kernel_q_16:
    s_bitcmp1_b32 s20, 21
    s_cbranch_scc0 L_p2_kernel_q_17
    s_lshl_b32 s15, s26, 1
    s_add_u32 s15, s15, 259309568
    buffer_load_dwordx4 v[8:11], v32, s[4:7], s15 offen sc1
    buffer_load_dwordx4 v[12:15], v32, s[4:7], s15 offen offset:16 sc1
    s_waitcnt vmcnt(0)
    v_add_f32 v24, v24, v8
    v_add_f32 v25, v25, v12
    v_add_f32 v26, v26, v9
    v_add_f32 v27, v27, v13
    v_add_f32 v28, v28, v10
    v_add_f32 v29, v29, v14
    v_add_f32 v30, v30, v11
    v_add_f32 v31, v31, v15
L_p2_kernel_q_17:
    s_bitcmp1_b32 s20, 22
    s_cbranch_scc0 L_p2_kernel_q_18
    s_lshl_b32 s15, s26, 1
    s_add_u32 s15, s15, 269549568
    buffer_load_dwordx4 v[8:11], v32, s[4:7], s15 offen sc1
    buffer_load_dwordx4 v[12:15], v32, s[4:7], s15 offen offset:16 sc1
    s_waitcnt vmcnt(0)
    v_add_f32 v24, v24, v8
    v_add_f32 v25, v25, v12
    v_add_f32 v26, v26, v9
    v_add_f32 v27, v27, v13
    v_add_f32 v28, v28, v10
    v_add_f32 v29, v29, v14
    v_add_f32 v30, v30, v11
    v_add_f32 v31, v31, v15
L_p2_kernel_q_18:
    s_bitcmp1_b32 s20, 23
    s_cbranch_scc0 L_p2_kernel_q_19
    s_lshl_b32 s15, s26, 1
    s_add_u32 s15, s15, 279789568
    buffer_load_dwordx4 v[8:11], v32, s[4:7], s15 offen sc1
    buffer_load_dwordx4 v[12:15], v32, s[4:7], s15 offen offset:16 sc1
    s_waitcnt vmcnt(0)
    v_add_f32 v24, v24, v8
    v_add_f32 v25, v25, v12
    v_add_f32 v26, v26, v9
    v_add_f32 v27, v27, v13
    v_add_f32 v28, v28, v10
    v_add_f32 v29, v29, v14
    v_add_f32 v30, v30, v11
    v_add_f32 v31, v31, v15
L_p2_kernel_q_19:
L_p2_kernel_nof32b_15:
    v_pk_mul_f32 v[8:9], v[24:25], s[84:85] op_sel:[0,0] op_sel_hi:[1,0]
    v_pk_mul_f32 v[10:11], v[24:25], s[84:85] op_sel:[0,1] op_sel_hi:[1,1]
    v_pk_mul_f32 v[12:13], v[24:25], s[86:87] op_sel:[0,0] op_sel_hi:[1,0]
    v_pk_mul_f32 v[14:15], v[24:25], s[86:87] op_sel:[0,1] op_sel_hi:[1,1]
    v_pk_fma_f32 v[8:9], v[26:27], s[88:89], v[8:9] op_sel:[0,0,0] op_sel_hi:[1,0,1]
    v_pk_fma_f32 v[10:11], v[26:27], s[88:89], v[10:11] op_sel:[0,1,0] op_sel_hi:[1,1,1]
    v_pk_fma_f32 v[12:13], v[26:27], s[90:91], v[12:13] op_sel:[0,0,0] op_sel_hi:[1,0,1]
    v_pk_fma_f32 v[14:15], v[26:27], s[90:91], v[14:15] op_sel:[0,1,0] op_sel_hi:[1,1,1]
    v_pk_fma_f32 v[8:9], v[28:29], s[92:93], v[8:9] op_sel:[0,0,0] op_sel_hi:[1,0,1]
    v_pk_fma_f32 v[10:11], v[28:29], s[92:93], v[10:11] op_sel:[0,1,0] op_sel_hi:[1,1,1]
    v_pk_fma_f32 v[12:13], v[28:29], s[94:95], v[12:13] op_sel:[0,0,0] op_sel_hi:[1,0,1]
    v_pk_fma_f32 v[14:15], v[28:29], s[94:95], v[14:15] op_sel:[0,1,0] op_sel_hi:[1,1,1]
    v_pk_fma_f32 v[8:9], v[30:31], s[96:97], v[8:9] op_sel:[0,0,0] op_sel_hi:[1,0,1]
    v_pk_fma_f32 v[10:11], v[30:31], s[96:97], v[10:11] op_sel:[0,1,0] op_sel_hi:[1,1,1]
    v_pk_fma_f32 v[12:13], v[30:31], s[98:99], v[12:13] op_sel:[0,0,0] op_sel_hi:[1,0,1]
    v_pk_fma_f32 v[14:15], v[30:31], s[98:99], v[14:15] op_sel:[0,1,0] op_sel_hi:[1,1,1]
    v_pk_mul_f32 v[8:9], v[8:9], v[72:73]
    v_pk_mul_f32 v[10:11], v[10:11], v[74:75]
    v_pk_mul_f32 v[12:13], v[12:13], v[76:77]
    v_pk_mul_f32 v[14:15], v[14:15], v[78:79]
    v_pk_mul_f32 v[24:25], v[8:9], s[28:29] op_sel:[0,0] op_sel_hi:[1,0]
    v_pk_mul_f32 v[26:27], v[8:9], s[28:29] op_sel:[0,1] op_sel_hi:[1,1]
    v_pk_mul_f32 v[28:29], v[8:9], s[30:31] op_sel:[0,0] op_sel_hi:[1,0]
    v_pk_mul_f32 v[30:31], v[8:9], s[30:31] op_sel:[0,1] op_sel_hi:[1,1]
    v_pk_fma_f32 v[24:25], v[10:11], s[32:33], v[24:25] op_sel:[0,0,0] op_sel_hi:[1,0,1]
    v_pk_fma_f32 v[26:27], v[10:11], s[32:33], v[26:27] op_sel:[0,1,0] op_sel_hi:[1,1,1]
    v_pk_fma_f32 v[28:29], v[10:11], s[34:35], v[28:29] op_sel:[0,0,0] op_sel_hi:[1,0,1]
    v_pk_fma_f32 v[30:31], v[10:11], s[34:35], v[30:31] op_sel:[0,1,0] op_sel_hi:[1,1,1]
    v_pk_fma_f32 v[24:25], v[12:13], s[36:37], v[24:25] op_sel:[0,0,0] op_sel_hi:[1,0,1]
    v_pk_fma_f32 v[26:27], v[12:13], s[36:37], v[26:27] op_sel:[0,1,0] op_sel_hi:[1,1,1]
    v_pk_fma_f32 v[28:29], v[12:13], s[38:39], v[28:29] op_sel:[0,0,0] op_sel_hi:[1,0,1]
    v_pk_fma_f32 v[30:31], v[12:13], s[38:39], v[30:31] op_sel:[0,1,0] op_sel_hi:[1,1,1]
    v_pk_fma_f32 v[24:25], v[14:15], s[40:41], v[24:25] op_sel:[0,0,0] op_sel_hi:[1,0,1]
    v_pk_fma_f32 v[26:27], v[14:15], s[40:41], v[26:27] op_sel:[0,1,0] op_sel_hi:[1,1,1]
    v_pk_fma_f32 v[28:29], v[14:15], s[42:43], v[28:29] op_sel:[0,0,0] op_sel_hi:[1,0,1]
    v_pk_fma_f32 v[30:31], v[14:15], s[42:43], v[30:31] op_sel:[0,1,0] op_sel_hi:[1,1,1]
    v_lshlrev_b32 v8, 16, v64
    v_and_b32 v10, 0xffff0000, v64
    v_lshlrev_b32 v12, 16, v65
    v_and_b32 v14, 0xffff0000, v65
    v_lshlrev_b32 v9, 16, v66
    v_and_b32 v11, 0xffff0000, v66
    v_lshlrev_b32 v13, 16, v67
    v_and_b32 v15, 0xffff0000, v67
    v_pk_fma_f32 v[8:9], v[24:25], v[80:81], v[8:9]
    v_pk_fma_f32 v[10:11], v[26:27], v[82:83], v[10:11]
    v_pk_fma_f32 v[12:13], v[28:29], v[84:85], v[12:13]
    v_pk_fma_f32 v[14:15], v[30:31], v[86:87], v[14:15]
    v_cvt_pk_bf16_f32 v16, v8, v10
    v_cvt_pk_bf16_f32 v17, v12, v14
    v_cvt_pk_bf16_f32 v18, v9, v11
    v_cvt_pk_bf16_f32 v19, v13, v15
    buffer_store_dwordx4 v[16:19], v1, s[16:19], s26 offen
    s_cmp_ge_u32 s13, 4
    s_cbranch_scc1 L_p2_f1
    s_bfe_u32 s14, s20, 262164
    s_cbranch_scc0 L_p2_kernel_nof32a_20
    s_add_u32 s14, s12, 0
    s_and_b32 s14, s14, 3
    s_add_u32 s14, s14, 20
    s_bitcmp1_b32 s20, s14
    s_cbranch_scc0 L_p2_kernel_q_21
    v_mov_b32 v88, 1073758208
    v_mov_b32 v89, 1073758208
    v_mov_b32 v90, 1073758208
    v_mov_b32 v91, 1073758208
L_p2_kernel_q_21:
    s_add_u32 s14, s12, 1
    s_and_b32 s14, s14, 3
    s_add_u32 s14, s14, 20
    s_bitcmp1_b32 s20, s14
    s_cbranch_scc0 L_p2_kernel_q_22
    v_mov_b32 v92, 1073758208
    v_mov_b32 v93, 1073758208
    v_mov_b32 v94, 1073758208
    v_mov_b32 v95, 1073758208
L_p2_kernel_q_22:
    s_add_u32 s14, s12, 2
    s_and_b32 s14, s14, 3
    s_add_u32 s14, s14, 20
    s_bitcmp1_b32 s20, s14
    s_cbranch_scc0 L_p2_kernel_q_23
    v_mov_b32 v96, 1073758208
    v_mov_b32 v97, 1073758208
    v_mov_b32 v98, 1073758208
    v_mov_b32 v99, 1073758208
L_p2_kernel_q_23:
    s_add_u32 s14, s12, 3
    s_and_b32 s14, s14, 3
    s_add_u32 s14, s14, 20
    s_bitcmp1_b32 s20, s14
    s_cbranch_scc0 L_p2_kernel_q_24
    v_mov_b32 v100, 1073758208
    v_mov_b32 v101, 1073758208
    v_mov_b32 v102, 1073758208
    v_mov_b32 v103, 1073758208
L_p2_kernel_q_24:
L_p2_kernel_nof32a_20:
    v_pk_add_u16 v88, v88, v92
    v_pk_add_u16 v96, v96, v100
    v_pk_add_u16 v89, v89, v93
    v_pk_add_u16 v97, v97, v101
    v_pk_add_u16 v90, v90, v94
    v_pk_add_u16 v98, v98, v102
    v_pk_add_u16 v91, v91, v95
    v_pk_add_u16 v99, v99, v103
    v_add_u32_sdwa v24, v88, v96 dst_sel:DWORD dst_unused:UNUSED_PAD src0_sel:WORD_0 src1_sel:WORD_0
    v_add_u32_sdwa v25, v90, v98 dst_sel:DWORD dst_unused:UNUSED_PAD src0_sel:WORD_0 src1_sel:WORD_0
    v_add_u32_sdwa v26, v88, v96 dst_sel:DWORD dst_unused:UNUSED_PAD src0_sel:WORD_1 src1_sel:WORD_1
    v_add_u32_sdwa v27, v90, v98 dst_sel:DWORD dst_unused:UNUSED_PAD src0_sel:WORD_1 src1_sel:WORD_1
    v_add_u32_sdwa v28, v89, v97 dst_sel:DWORD dst_unused:UNUSED_PAD src0_sel:WORD_0 src1_sel:WORD_0
    v_add_u32_sdwa v29, v91, v99 dst_sel:DWORD dst_unused:UNUSED_PAD src0_sel:WORD_0 src1_sel:WORD_0
    v_add_u32_sdwa v30, v89, v97 dst_sel:DWORD dst_unused:UNUSED_PAD src0_sel:WORD_1 src1_sel:WORD_1
    v_add_u32_sdwa v31, v91, v99 dst_sel:DWORD dst_unused:UNUSED_PAD src0_sel:WORD_1 src1_sel:WORD_1
    v_cvt_f32_u32 v24, v24
    v_cvt_f32_u32 v25, v25
    v_cvt_f32_u32 v26, v26
    v_cvt_f32_u32 v27, v27
    v_cvt_f32_u32 v28, v28
    v_cvt_f32_u32 v29, v29
    v_cvt_f32_u32 v30, v30
    v_cvt_f32_u32 v31, v31
    v_pk_fma_f32 v[24:25], v[24:25], s[44:45], s[44:45] op_sel:[0,0,1] op_sel_hi:[1,0,1]
    v_pk_fma_f32 v[26:27], v[26:27], s[44:45], s[44:45] op_sel:[0,0,1] op_sel_hi:[1,0,1]
    v_pk_fma_f32 v[28:29], v[28:29], s[44:45], s[44:45] op_sel:[0,0,1] op_sel_hi:[1,0,1]
    v_pk_fma_f32 v[30:31], v[30:31], s[44:45], s[44:45] op_sel:[0,0,1] op_sel_hi:[1,0,1]
    s_bfe_u32 s14, s20, 262164
    s_cbranch_scc0 L_p2_kernel_nof32b_25
    v_lshlrev_b32 v32, 1, v2
    s_bitcmp1_b32 s20, 20
    s_cbranch_scc0 L_p2_kernel_q_26
    s_lshl_b32 s15, s26, 1
    s_add_u32 s15, s15, 249069568
    buffer_load_dwordx4 v[88:91], v32, s[4:7], s15 offen sc1
    buffer_load_dwordx4 v[92:95], v32, s[4:7], s15 offen offset:16 sc1
    s_waitcnt vmcnt(0)
    v_add_f32 v24, v24, v88
    v_add_f32 v25, v25, v92
    v_add_f32 v26, v26, v89
    v_add_f32 v27, v27, v93
    v_add_f32 v28, v28, v90
    v_add_f32 v29, v29, v94
    v_add_f32 v30, v30, v91
    v_add_f32 v31, v31, v95
L_p2_kernel_q_26:
    s_bitcmp1_b32 s20, 21
    s_cbranch_scc0 L_p2_kernel_q_27
    s_lshl_b32 s15, s26, 1
    s_add_u32 s15, s15, 259309568
    buffer_load_dwordx4 v[88:91], v32, s[4:7], s15 offen sc1
    buffer_load_dwordx4 v[92:95], v32, s[4:7], s15 offen offset:16 sc1
    s_waitcnt vmcnt(0)
    v_add_f32 v24, v24, v88
    v_add_f32 v25, v25, v92
    v_add_f32 v26, v26, v89
    v_add_f32 v27, v27, v93
    v_add_f32 v28, v28, v90
    v_add_f32 v29, v29, v94
    v_add_f32 v30, v30, v91
    v_add_f32 v31, v31, v95
L_p2_kernel_q_27:
    s_bitcmp1_b32 s20, 22
    s_cbranch_scc0 L_p2_kernel_q_28
    s_lshl_b32 s15, s26, 1
    s_add_u32 s15, s15, 269549568
    buffer_load_dwordx4 v[88:91], v32, s[4:7], s15 offen sc1
    buffer_load_dwordx4 v[92:95], v32, s[4:7], s15 offen offset:16 sc1
    s_waitcnt vmcnt(0)
    v_add_f32 v24, v24, v88
    v_add_f32 v25, v25, v92
    v_add_f32 v26, v26, v89
    v_add_f32 v27, v27, v93
    v_add_f32 v28, v28, v90
    v_add_f32 v29, v29, v94
    v_add_f32 v30, v30, v91
    v_add_f32 v31, v31, v95
L_p2_kernel_q_28:
    s_bitcmp1_b32 s20, 23
    s_cbranch_scc0 L_p2_kernel_q_29
    s_lshl_b32 s15, s26, 1
    s_add_u32 s15, s15, 279789568
    buffer_load_dwordx4 v[88:91], v32, s[4:7], s15 offen sc1
    buffer_load_dwordx4 v[92:95], v32, s[4:7], s15 offen offset:16 sc1
    s_waitcnt vmcnt(0)
    v_add_f32 v24, v24, v88
    v_add_f32 v25, v25, v92
    v_add_f32 v26, v26, v89
    v_add_f32 v27, v27, v93
    v_add_f32 v28, v28, v90
    v_add_f32 v29, v29, v94
    v_add_f32 v30, v30, v91
    v_add_f32 v31, v31, v95
L_p2_kernel_q_29:
L_p2_kernel_nof32b_25:
    v_pk_mul_f32 v[88:89], v[24:25], s[84:85] op_sel:[0,0] op_sel_hi:[1,0]
    v_pk_mul_f32 v[90:91], v[24:25], s[84:85] op_sel:[0,1] op_sel_hi:[1,1]
    v_pk_mul_f32 v[92:93], v[24:25], s[86:87] op_sel:[0,0] op_sel_hi:[1,0]
    v_pk_mul_f32 v[94:95], v[24:25], s[86:87] op_sel:[0,1] op_sel_hi:[1,1]
    v_pk_fma_f32 v[88:89], v[26:27], s[88:89], v[88:89] op_sel:[0,0,0] op_sel_hi:[1,0,1]
    v_pk_fma_f32 v[90:91], v[26:27], s[88:89], v[90:91] op_sel:[0,1,0] op_sel_hi:[1,1,1]
    v_pk_fma_f32 v[92:93], v[26:27], s[90:91], v[92:93] op_sel:[0,0,0] op_sel_hi:[1,0,1]
    v_pk_fma_f32 v[94:95], v[26:27], s[90:91], v[94:95] op_sel:[0,1,0] op_sel_hi:[1,1,1]
    v_pk_fma_f32 v[88:89], v[28:29], s[92:93], v[88:89] op_sel:[0,0,0] op_sel_hi:[1,0,1]
    v_pk_fma_f32 v[90:91], v[28:29], s[92:93], v[90:91] op_sel:[0,1,0] op_sel_hi:[1,1,1]
    v_pk_fma_f32 v[92:93], v[28:29], s[94:95], v[92:93] op_sel:[0,0,0] op_sel_hi:[1,0,1]
    v_pk_fma_f32 v[94:95], v[28:29], s[94:95], v[94:95] op_sel:[0,1,0] op_sel_hi:[1,1,1]
    v_pk_fma_f32 v[88:89], v[30:31], s[96:97], v[88:89] op_sel:[0,0,0] op_sel_hi:[1,0,1]
    v_pk_fma_f32 v[90:91], v[30:31], s[96:97], v[90:91] op_sel:[0,1,0] op_sel_hi:[1,1,1]
    v_pk_fma_f32 v[92:93], v[30:31], s[98:99], v[92:93] op_sel:[0,0,0] op_sel_hi:[1,0,1]
    v_pk_fma_f32 v[94:95], v[30:31], s[98:99], v[94:95] op_sel:[0,1,0] op_sel_hi:[1,1,1]
    v_pk_mul_f32 v[88:89], v[88:89], v[112:113]
    v_pk_mul_f32 v[90:91], v[90:91], v[114:115]
    v_pk_mul_f32 v[92:93], v[92:93], v[116:117]
    v_pk_mul_f32 v[94:95], v[94:95], v[118:119]
    v_pk_mul_f32 v[24:25], v[88:89], s[28:29] op_sel:[0,0] op_sel_hi:[1,0]
    v_pk_mul_f32 v[26:27], v[88:89], s[28:29] op_sel:[0,1] op_sel_hi:[1,1]
    v_pk_mul_f32 v[28:29], v[88:89], s[30:31] op_sel:[0,0] op_sel_hi:[1,0]
    v_pk_mul_f32 v[30:31], v[88:89], s[30:31] op_sel:[0,1] op_sel_hi:[1,1]
    v_pk_fma_f32 v[24:25], v[90:91], s[32:33], v[24:25] op_sel:[0,0,0] op_sel_hi:[1,0,1]
    v_pk_fma_f32 v[26:27], v[90:91], s[32:33], v[26:27] op_sel:[0,1,0] op_sel_hi:[1,1,1]
    v_pk_fma_f32 v[28:29], v[90:91], s[34:35], v[28:29] op_sel:[0,0,0] op_sel_hi:[1,0,1]
    v_pk_fma_f32 v[30:31], v[90:91], s[34:35], v[30:31] op_sel:[0,1,0] op_sel_hi:[1,1,1]
    v_pk_fma_f32 v[24:25], v[92:93], s[36:37], v[24:25] op_sel:[0,0,0] op_sel_hi:[1,0,1]
    v_pk_fma_f32 v[26:27], v[92:93], s[36:37], v[26:27] op_sel:[0,1,0] op_sel_hi:[1,1,1]
    v_pk_fma_f32 v[28:29], v[92:93], s[38:39], v[28:29] op_sel:[0,0,0] op_sel_hi:[1,0,1]
    v_pk_fma_f32 v[30:31], v[92:93], s[38:39], v[30:31] op_sel:[0,1,0] op_sel_hi:[1,1,1]
    v_pk_fma_f32 v[24:25], v[94:95], s[40:41], v[24:25] op_sel:[0,0,0] op_sel_hi:[1,0,1]
    v_pk_fma_f32 v[26:27], v[94:95], s[40:41], v[26:27] op_sel:[0,1,0] op_sel_hi:[1,1,1]
    v_pk_fma_f32 v[28:29], v[94:95], s[42:43], v[28:29] op_sel:[0,0,0] op_sel_hi:[1,0,1]
    v_pk_fma_f32 v[30:31], v[94:95], s[42:43], v[30:31] op_sel:[0,1,0] op_sel_hi:[1,1,1]
    v_lshlrev_b32 v88, 16, v68
    v_and_b32 v90, 0xffff0000, v68
    v_lshlrev_b32 v92, 16, v69
    v_and_b32 v94, 0xffff0000, v69
    v_lshlrev_b32 v89, 16, v70
    v_and_b32 v91, 0xffff0000, v70
    v_lshlrev_b32 v93, 16, v71
    v_and_b32 v95, 0xffff0000, v71
    v_pk_fma_f32 v[88:89], v[24:25], v[120:121], v[88:89]
    v_pk_fma_f32 v[90:91], v[26:27], v[122:123], v[90:91]
    v_pk_fma_f32 v[92:93], v[28:29], v[124:125], v[92:93]
    v_pk_fma_f32 v[94:95], v[30:31], v[126:127], v[94:95]
    v_cvt_pk_bf16_f32 v96, v88, v90
    v_cvt_pk_bf16_f32 v97, v92, v94
    v_cvt_pk_bf16_f32 v98, v89, v91
    v_cvt_pk_bf16_f32 v99, v93, v95
    buffer_store_dwordx4 v[96:99], v2, s[16:19], s26 offen
L_p2_f1:
    s_bitset0_b32 s51, s49
    s_cmp_eq_u32 s51, 0
    s_cbranch_scc1 L_p2_done
    s_ff1_i32_b32 s49, s51
    s_mul_i32 s14, s3, 20000
    s_mul_i32 s15, s49, 4992
    s_add_u32 s14, s14, s15
    s_add_u32 s15, s14, 4096
    v_min_u32 v61, 231, v0
    v_lshl_add_u32 v60, v0, 2, s14
    v_lshl_add_u32 v61, v61, 2, s15
    global_load_dword v60, v60, s[100:101] nt
    global_load_dword v61, v61, s[100:101] nt
    s_waitcnt vmcnt(0)
    v_lshlrev_b32 v30, 16, v60
    v_and_b32 v31, 0xffff0000, v60
    v_lshlrev_b32 v36, 16, v53
    v_and_b32 v37, 0xffff0000, v53
    v_lshlrev_b32 v38, 16, v54
    v_and_b32 v39, 0xffff0000, v54
    v_lshlrev_b32 v40, 16, v56
    v_and_b32 v41, 0xffff0000, v56
    v_lshlrev_b32 v42, 16, v57
    v_and_b32 v43, 0xffff0000, v57
    v_pk_add_f32 v[14:15], v[30:31], v[36:37] op_sel:[0,0] op_sel_hi:[1,0] neg_lo:[0,1] neg_hi:[0,1]
    v_pk_add_f32 v[16:17], v[30:31], v[36:37] op_sel:[0,1] op_sel_hi:[1,1] neg_lo:[0,1] neg_hi:[0,1]
    v_pk_add_f32 v[18:19], v[30:31], v[38:39] op_sel:[0,0] op_sel_hi:[1,0] neg_lo:[0,1] neg_hi:[0,1]
    v_pk_add_f32 v[20:21], v[30:31], v[38:39] op_sel:[0,1] op_sel_hi:[1,1] neg_lo:[0,1] neg_hi:[0,1]
    v_pk_add_f32 v[22:23], v[30:31], v[40:41] op_sel:[0,0] op_sel_hi:[1,0] neg_lo:[0,1] neg_hi:[0,1]
    v_pk_add_f32 v[24:25], v[30:31], v[40:41] op_sel:[0,1] op_sel_hi:[1,1] neg_lo:[0,1] neg_hi:[0,1]
    v_pk_add_f32 v[26:27], v[30:31], v[42:43] op_sel:[0,0] op_sel_hi:[1,0] neg_lo:[0,1] neg_hi:[0,1]
    v_pk_add_f32 v[28:29], v[30:31], v[42:43] op_sel:[0,1] op_sel_hi:[1,1] neg_lo:[0,1] neg_hi:[0,1]
    v_cvt_pk_bf16_f32 v32, v14, v15
    v_lshlrev_b32 v14, 16, v32
    v_and_b32 v15, 0xffff0000, v32
    v_cvt_pk_bf16_f32 v32, v16, v17
    v_lshlrev_b32 v16, 16, v32
    v_and_b32 v17, 0xffff0000, v32
    v_cvt_pk_bf16_f32 v32, v18, v19
    v_lshlrev_b32 v18, 16, v32
    v_and_b32 v19, 0xffff0000, v32
    v_cvt_pk_bf16_f32 v32, v20, v21
    v_lshlrev_b32 v20, 16, v32
    v_and_b32 v21, 0xffff0000, v32
    v_cvt_pk_bf16_f32 v32, v22, v23
    v_lshlrev_b32 v22, 16, v32
    v_and_b32 v23, 0xffff0000, v32
    v_cvt_pk_bf16_f32 v32, v24, v25
    v_lshlrev_b32 v24, 16, v32
    v_and_b32 v25, 0xffff0000, v32
    v_cvt_pk_bf16_f32 v32, v26, v27
    v_lshlrev_b32 v26, 16, v32
    v_and_b32 v27, 0xffff0000, v32
    v_cvt_pk_bf16_f32 v32, v28, v29
    v_lshlrev_b32 v28, 16, v32
    v_and_b32 v29, 0xffff0000, v32
    v_pk_mul_f32 v[14:15], v[14:15], v[14:15]
    v_pk_mul_f32 v[16:17], v[16:17], v[16:17]
    v_pk_mul_f32 v[18:19], v[18:19], v[18:19]
    v_pk_mul_f32 v[20:21], v[20:21], v[20:21]
    v_pk_mul_f32 v[22:23], v[22:23], v[22:23]
    v_pk_mul_f32 v[24:25], v[24:25], v[24:25]
    v_pk_mul_f32 v[26:27], v[26:27], v[26:27]
    v_pk_mul_f32 v[28:29], v[28:29], v[28:29]
    v_cvt_pk_bf16_f32 v32, v14, v15
    v_lshlrev_b32 v14, 16, v32
    v_and_b32 v15, 0xffff0000, v32
    v_cvt_pk_bf16_f32 v32, v16, v17
    v_lshlrev_b32 v16, 16, v32
    v_and_b32 v17, 0xffff0000, v32
    v_cvt_pk_bf16_f32 v32, v18, v19
    v_lshlrev_b32 v18, 16, v32
    v_and_b32 v19, 0xffff0000, v32
    v_cvt_pk_bf16_f32 v32, v20, v21
    v_lshlrev_b32 v20, 16, v32
    v_and_b32 v21, 0xffff0000, v32
    v_cvt_pk_bf16_f32 v32, v22, v23
    v_lshlrev_b32 v22, 16, v32
    v_and_b32 v23, 0xffff0000, v32
    v_cvt_pk_bf16_f32 v32, v24, v25
    v_lshlrev_b32 v24, 16, v32
    v_and_b32 v25, 0xffff0000, v32
    v_cvt_pk_bf16_f32 v32, v26, v27
    v_lshlrev_b32 v26, 16, v32
    v_and_b32 v27, 0xffff0000, v32
    v_cvt_pk_bf16_f32 v32, v28, v29
    v_lshlrev_b32 v28, 16, v32
    v_and_b32 v29, 0xffff0000, v32
    v_mov_b32 v30, 1092616192
    v_mov_b32 v31, 0x3fb8aa3b
    v_pk_mul_f32 v[14:15], v[14:15], v[30:31] op_sel:[0,0] op_sel_hi:[1,0]
    v_pk_mul_f32 v[16:17], v[16:17], v[30:31] op_sel:[0,0] op_sel_hi:[1,0]
    v_pk_mul_f32 v[18:19], v[18:19], v[30:31] op_sel:[0,0] op_sel_hi:[1,0]
    v_pk_mul_f32 v[20:21], v[20:21], v[30:31] op_sel:[0,0] op_sel_hi:[1,0]
    v_pk_mul_f32 v[22:23], v[22:23], v[30:31] op_sel:[0,0] op_sel_hi:[1,0]
    v_pk_mul_f32 v[24:25], v[24:25], v[30:31] op_sel:[0,0] op_sel_hi:[1,0]
    v_pk_mul_f32 v[26:27], v[26:27], v[30:31] op_sel:[0,0] op_sel_hi:[1,0]
    v_pk_mul_f32 v[28:29], v[28:29], v[30:31] op_sel:[0,0] op_sel_hi:[1,0]
    v_cvt_pk_bf16_f32 v32, v14, v15
    v_lshlrev_b32 v14, 16, v32
    v_and_b32 v15, 0xffff0000, v32
    v_cvt_pk_bf16_f32 v32, v16, v17
    v_lshlrev_b32 v16, 16, v32
    v_and_b32 v17, 0xffff0000, v32
    v_cvt_pk_bf16_f32 v32, v18, v19
    v_lshlrev_b32 v18, 16, v32
    v_and_b32 v19, 0xffff0000, v32
    v_cvt_pk_bf16_f32 v32, v20, v21
    v_lshlrev_b32 v20, 16, v32
    v_and_b32 v21, 0xffff0000, v32
    v_cvt_pk_bf16_f32 v32, v22, v23
    v_lshlrev_b32 v22, 16, v32
    v_and_b32 v23, 0xffff0000, v32
    v_cvt_pk_bf16_f32 v32, v24, v25
    v_lshlrev_b32 v24, 16, v32
    v_and_b32 v25, 0xffff0000, v32
    v_cvt_pk_bf16_f32 v32, v26, v27
    v_lshlrev_b32 v26, 16, v32
    v_and_b32 v27, 0xffff0000, v32
    v_cvt_pk_bf16_f32 v32, v28, v29
    v_lshlrev_b32 v28, 16, v32
    v_and_b32 v29, 0xffff0000, v32
    v_pk_mul_f32 v[14:15], v[14:15], v[30:31] op_sel:[0,1] op_sel_hi:[1,1]
    v_pk_mul_f32 v[16:17], v[16:17], v[30:31] op_sel:[0,1] op_sel_hi:[1,1]
    v_pk_mul_f32 v[18:19], v[18:19], v[30:31] op_sel:[0,1] op_sel_hi:[1,1]
    v_pk_mul_f32 v[20:21], v[20:21], v[30:31] op_sel:[0,1] op_sel_hi:[1,1]
    v_pk_mul_f32 v[22:23], v[22:23], v[30:31] op_sel:[0,1] op_sel_hi:[1,1]
    v_pk_mul_f32 v[24:25], v[24:25], v[30:31] op_sel:[0,1] op_sel_hi:[1,1]
    v_pk_mul_f32 v[26:27], v[26:27], v[30:31] op_sel:[0,1] op_sel_hi:[1,1]
    v_pk_mul_f32 v[28:29], v[28:29], v[30:31] op_sel:[0,1] op_sel_hi:[1,1]
    v_exp_f32 v14, -v14
    v_exp_f32 v15, -v15
    v_exp_f32 v16, -v16
    v_exp_f32 v17, -v17
    v_exp_f32 v18, -v18
    v_exp_f32 v19, -v19
    v_exp_f32 v20, -v20
    v_exp_f32 v21, -v21
    v_exp_f32 v22, -v22
    v_exp_f32 v23, -v23
    v_exp_f32 v24, -v24
    v_exp_f32 v25, -v25
    v_exp_f32 v26, -v26
    v_exp_f32 v27, -v27
    v_exp_f32 v28, -v28
    v_exp_f32 v29, -v29
    v_cvt_pk_bf16_f32 v14, v14, v16
    v_cvt_pk_bf16_f32 v15, v15, v17
    v_cvt_pk_bf16_f32 v18, v18, v20
    v_cvt_pk_bf16_f32 v19, v19, v21
    v_cvt_pk_bf16_f32 v22, v22, v24
    v_cvt_pk_bf16_f32 v23, v23, v25
    v_cvt_pk_bf16_f32 v26, v26, v28
    v_cvt_pk_bf16_f32 v27, v27, v29
    v_dot2_f32_bf16 v72, v14, s68, 0
    v_dot2_f32_bf16 v73, v15, s68, 0
    v_dot2_f32_bf16 v74, v14, s69, 0
    v_dot2_f32_bf16 v75, v15, s69, 0
    v_dot2_f32_bf16 v76, v14, s70, 0
    v_dot2_f32_bf16 v77, v15, s70, 0
    v_dot2_f32_bf16 v78, v14, s71, 0
    v_dot2_f32_bf16 v79, v15, s71, 0
    v_dot2_f32_bf16 v80, v14, s52, 0
    v_dot2_f32_bf16 v81, v15, s52, 0
    v_dot2_f32_bf16 v82, v14, s53, 0
    v_dot2_f32_bf16 v83, v15, s53, 0
    v_dot2_f32_bf16 v84, v14, s54, 0
    v_dot2_f32_bf16 v85, v15, s54, 0
    v_dot2_f32_bf16 v86, v14, s55, 0
    v_dot2_f32_bf16 v87, v15, s55, 0
    v_dot2_f32_bf16 v72, v18, s72, v72
    v_dot2_f32_bf16 v73, v19, s72, v73
    v_dot2_f32_bf16 v74, v18, s73, v74
    v_dot2_f32_bf16 v75, v19, s73, v75
    v_dot2_f32_bf16 v76, v18, s74, v76
    v_dot2_f32_bf16 v77, v19, s74, v77
    v_dot2_f32_bf16 v78, v18, s75, v78
    v_dot2_f32_bf16 v79, v19, s75, v79
    v_dot2_f32_bf16 v80, v18, s56, v80
    v_dot2_f32_bf16 v81, v19, s56, v81
    v_dot2_f32_bf16 v82, v18, s57, v82
    v_dot2_f32_bf16 v83, v19, s57, v83
    v_dot2_f32_bf16 v84, v18, s58, v84
    v_dot2_f32_bf16 v85, v19, s58, v85
    v_dot2_f32_bf16 v86, v18, s59, v86
    v_dot2_f32_bf16 v87, v19, s59, v87
    v_dot2_f32_bf16 v72, v22, s76, v72
    v_dot2_f32_bf16 v73, v23, s76, v73
    v_dot2_f32_bf16 v74, v22, s77, v74
    v_dot2_f32_bf16 v75, v23, s77, v75
    v_dot2_f32_bf16 v76, v22, s78, v76
    v_dot2_f32_bf16 v77, v23, s78, v77
    v_dot2_f32_bf16 v78, v22, s79, v78
    v_dot2_f32_bf16 v79, v23, s79, v79
    v_dot2_f32_bf16 v80, v22, s60, v80
    v_dot2_f32_bf16 v81, v23, s60, v81
    v_dot2_f32_bf16 v82, v22, s61, v82
    v_dot2_f32_bf16 v83, v23, s61, v83
    v_dot2_f32_bf16 v84, v22, s62, v84
    v_dot2_f32_bf16 v85, v23, s62, v85
    v_dot2_f32_bf16 v86, v22, s63, v86
    v_dot2_f32_bf16 v87, v23, s63, v87
    v_dot2_f32_bf16 v72, v26, s80, v72
    v_dot2_f32_bf16 v73, v27, s80, v73
    v_dot2_f32_bf16 v74, v26, s81, v74
    v_dot2_f32_bf16 v75, v27, s81, v75
    v_dot2_f32_bf16 v76, v26, s82, v76
    v_dot2_f32_bf16 v77, v27, s82, v77
    v_dot2_f32_bf16 v78, v26, s83, v78
    v_dot2_f32_bf16 v79, v27, s83, v79
    v_dot2_f32_bf16 v80, v26, s64, v80
    v_dot2_f32_bf16 v81, v27, s64, v81
    v_dot2_f32_bf16 v82, v26, s65, v82
    v_dot2_f32_bf16 v83, v27, s65, v83
    v_dot2_f32_bf16 v84, v26, s66, v84
    v_dot2_f32_bf16 v85, v27, s66, v85
    v_dot2_f32_bf16 v86, v26, s67, v86
    v_dot2_f32_bf16 v87, v27, s67, v87
    s_cmp_ge_u32 s13, 4
    s_cbranch_scc1 L_p2_kernel_g1_30
    v_lshlrev_b32 v30, 16, v61
    v_and_b32 v31, 0xffff0000, v61
    v_pk_add_f32 v[14:15], v[30:31], v[36:37] op_sel:[0,0] op_sel_hi:[1,0] neg_lo:[0,1] neg_hi:[0,1]
    v_pk_add_f32 v[16:17], v[30:31], v[36:37] op_sel:[0,1] op_sel_hi:[1,1] neg_lo:[0,1] neg_hi:[0,1]
    v_pk_add_f32 v[18:19], v[30:31], v[38:39] op_sel:[0,0] op_sel_hi:[1,0] neg_lo:[0,1] neg_hi:[0,1]
    v_pk_add_f32 v[20:21], v[30:31], v[38:39] op_sel:[0,1] op_sel_hi:[1,1] neg_lo:[0,1] neg_hi:[0,1]
    v_pk_add_f32 v[22:23], v[30:31], v[40:41] op_sel:[0,0] op_sel_hi:[1,0] neg_lo:[0,1] neg_hi:[0,1]
    v_pk_add_f32 v[24:25], v[30:31], v[40:41] op_sel:[0,1] op_sel_hi:[1,1] neg_lo:[0,1] neg_hi:[0,1]
    v_pk_add_f32 v[26:27], v[30:31], v[42:43] op_sel:[0,0] op_sel_hi:[1,0] neg_lo:[0,1] neg_hi:[0,1]
    v_pk_add_f32 v[28:29], v[30:31], v[42:43] op_sel:[0,1] op_sel_hi:[1,1] neg_lo:[0,1] neg_hi:[0,1]
    v_cvt_pk_bf16_f32 v32, v14, v15
    v_lshlrev_b32 v14, 16, v32
    v_and_b32 v15, 0xffff0000, v32
    v_cvt_pk_bf16_f32 v32, v16, v17
    v_lshlrev_b32 v16, 16, v32
    v_and_b32 v17, 0xffff0000, v32
    v_cvt_pk_bf16_f32 v32, v18, v19
    v_lshlrev_b32 v18, 16, v32
    v_and_b32 v19, 0xffff0000, v32
    v_cvt_pk_bf16_f32 v32, v20, v21
    v_lshlrev_b32 v20, 16, v32
    v_and_b32 v21, 0xffff0000, v32
    v_cvt_pk_bf16_f32 v32, v22, v23
    v_lshlrev_b32 v22, 16, v32
    v_and_b32 v23, 0xffff0000, v32
    v_cvt_pk_bf16_f32 v32, v24, v25
    v_lshlrev_b32 v24, 16, v32
    v_and_b32 v25, 0xffff0000, v32
    v_cvt_pk_bf16_f32 v32, v26, v27
    v_lshlrev_b32 v26, 16, v32
    v_and_b32 v27, 0xffff0000, v32
    v_cvt_pk_bf16_f32 v32, v28, v29
    v_lshlrev_b32 v28, 16, v32
    v_and_b32 v29, 0xffff0000, v32
    v_pk_mul_f32 v[14:15], v[14:15], v[14:15]
    v_pk_mul_f32 v[16:17], v[16:17], v[16:17]
    v_pk_mul_f32 v[18:19], v[18:19], v[18:19]
    v_pk_mul_f32 v[20:21], v[20:21], v[20:21]
    v_pk_mul_f32 v[22:23], v[22:23], v[22:23]
    v_pk_mul_f32 v[24:25], v[24:25], v[24:25]
    v_pk_mul_f32 v[26:27], v[26:27], v[26:27]
    v_pk_mul_f32 v[28:29], v[28:29], v[28:29]
    v_cvt_pk_bf16_f32 v32, v14, v15
    v_lshlrev_b32 v14, 16, v32
    v_and_b32 v15, 0xffff0000, v32
    v_cvt_pk_bf16_f32 v32, v16, v17
    v_lshlrev_b32 v16, 16, v32
    v_and_b32 v17, 0xffff0000, v32
    v_cvt_pk_bf16_f32 v32, v18, v19
    v_lshlrev_b32 v18, 16, v32
    v_and_b32 v19, 0xffff0000, v32
    v_cvt_pk_bf16_f32 v32, v20, v21
    v_lshlrev_b32 v20, 16, v32
    v_and_b32 v21, 0xffff0000, v32
    v_cvt_pk_bf16_f32 v32, v22, v23
    v_lshlrev_b32 v22, 16, v32
    v_and_b32 v23, 0xffff0000, v32
    v_cvt_pk_bf16_f32 v32, v24, v25
    v_lshlrev_b32 v24, 16, v32
    v_and_b32 v25, 0xffff0000, v32
    v_cvt_pk_bf16_f32 v32, v26, v27
    v_lshlrev_b32 v26, 16, v32
    v_and_b32 v27, 0xffff0000, v32
    v_cvt_pk_bf16_f32 v32, v28, v29
    v_lshlrev_b32 v28, 16, v32
    v_and_b32 v29, 0xffff0000, v32
    v_mov_b32 v30, 1092616192
    v_mov_b32 v31, 0x3fb8aa3b
    v_pk_mul_f32 v[14:15], v[14:15], v[30:31] op_sel:[0,0] op_sel_hi:[1,0]
    v_pk_mul_f32 v[16:17], v[16:17], v[30:31] op_sel:[0,0] op_sel_hi:[1,0]
    v_pk_mul_f32 v[18:19], v[18:19], v[30:31] op_sel:[0,0] op_sel_hi:[1,0]
    v_pk_mul_f32 v[20:21], v[20:21], v[30:31] op_sel:[0,0] op_sel_hi:[1,0]
    v_pk_mul_f32 v[22:23], v[22:23], v[30:31] op_sel:[0,0] op_sel_hi:[1,0]
    v_pk_mul_f32 v[24:25], v[24:25], v[30:31] op_sel:[0,0] op_sel_hi:[1,0]
    v_pk_mul_f32 v[26:27], v[26:27], v[30:31] op_sel:[0,0] op_sel_hi:[1,0]
    v_pk_mul_f32 v[28:29], v[28:29], v[30:31] op_sel:[0,0] op_sel_hi:[1,0]
    v_cvt_pk_bf16_f32 v32, v14, v15
    v_lshlrev_b32 v14, 16, v32
    v_and_b32 v15, 0xffff0000, v32
    v_cvt_pk_bf16_f32 v32, v16, v17
    v_lshlrev_b32 v16, 16, v32
    v_and_b32 v17, 0xffff0000, v32
    v_cvt_pk_bf16_f32 v32, v18, v19
    v_lshlrev_b32 v18, 16, v32
    v_and_b32 v19, 0xffff0000, v32
    v_cvt_pk_bf16_f32 v32, v20, v21
    v_lshlrev_b32 v20, 16, v32
    v_and_b32 v21, 0xffff0000, v32
    v_cvt_pk_bf16_f32 v32, v22, v23
    v_lshlrev_b32 v22, 16, v32
    v_and_b32 v23, 0xffff0000, v32
    v_cvt_pk_bf16_f32 v32, v24, v25
    v_lshlrev_b32 v24, 16, v32
    v_and_b32 v25, 0xffff0000, v32
    v_cvt_pk_bf16_f32 v32, v26, v27
    v_lshlrev_b32 v26, 16, v32
    v_and_b32 v27, 0xffff0000, v32
    v_cvt_pk_bf16_f32 v32, v28, v29
    v_lshlrev_b32 v28, 16, v32
    v_and_b32 v29, 0xffff0000, v32
    v_pk_mul_f32 v[14:15], v[14:15], v[30:31] op_sel:[0,1] op_sel_hi:[1,1]
    v_pk_mul_f32 v[16:17], v[16:17], v[30:31] op_sel:[0,1] op_sel_hi:[1,1]
    v_pk_mul_f32 v[18:19], v[18:19], v[30:31] op_sel:[0,1] op_sel_hi:[1,1]
    v_pk_mul_f32 v[20:21], v[20:21], v[30:31] op_sel:[0,1] op_sel_hi:[1,1]
    v_pk_mul_f32 v[22:23], v[22:23], v[30:31] op_sel:[0,1] op_sel_hi:[1,1]
    v_pk_mul_f32 v[24:25], v[24:25], v[30:31] op_sel:[0,1] op_sel_hi:[1,1]
    v_pk_mul_f32 v[26:27], v[26:27], v[30:31] op_sel:[0,1] op_sel_hi:[1,1]
    v_pk_mul_f32 v[28:29], v[28:29], v[30:31] op_sel:[0,1] op_sel_hi:[1,1]
    v_exp_f32 v14, -v14
    v_exp_f32 v15, -v15
    v_exp_f32 v16, -v16
    v_exp_f32 v17, -v17
    v_exp_f32 v18, -v18
    v_exp_f32 v19, -v19
    v_exp_f32 v20, -v20
    v_exp_f32 v21, -v21
    v_exp_f32 v22, -v22
    v_exp_f32 v23, -v23
    v_exp_f32 v24, -v24
    v_exp_f32 v25, -v25
    v_exp_f32 v26, -v26
    v_exp_f32 v27, -v27
    v_exp_f32 v28, -v28
    v_exp_f32 v29, -v29
    v_cvt_pk_bf16_f32 v14, v14, v16
    v_cvt_pk_bf16_f32 v15, v15, v17
    v_cvt_pk_bf16_f32 v18, v18, v20
    v_cvt_pk_bf16_f32 v19, v19, v21
    v_cvt_pk_bf16_f32 v22, v22, v24
    v_cvt_pk_bf16_f32 v23, v23, v25
    v_cvt_pk_bf16_f32 v26, v26, v28
    v_cvt_pk_bf16_f32 v27, v27, v29
    v_dot2_f32_bf16 v112, v14, s68, 0
    v_dot2_f32_bf16 v113, v15, s68, 0
    v_dot2_f32_bf16 v114, v14, s69, 0
    v_dot2_f32_bf16 v115, v15, s69, 0
    v_dot2_f32_bf16 v116, v14, s70, 0
    v_dot2_f32_bf16 v117, v15, s70, 0
    v_dot2_f32_bf16 v118, v14, s71, 0
    v_dot2_f32_bf16 v119, v15, s71, 0
    v_dot2_f32_bf16 v120, v14, s52, 0
    v_dot2_f32_bf16 v121, v15, s52, 0
    v_dot2_f32_bf16 v122, v14, s53, 0
    v_dot2_f32_bf16 v123, v15, s53, 0
    v_dot2_f32_bf16 v124, v14, s54, 0
    v_dot2_f32_bf16 v125, v15, s54, 0
    v_dot2_f32_bf16 v126, v14, s55, 0
    v_dot2_f32_bf16 v127, v15, s55, 0
    v_dot2_f32_bf16 v112, v18, s72, v112
    v_dot2_f32_bf16 v113, v19, s72, v113
    v_dot2_f32_bf16 v114, v18, s73, v114
    v_dot2_f32_bf16 v115, v19, s73, v115
    v_dot2_f32_bf16 v116, v18, s74, v116
    v_dot2_f32_bf16 v117, v19, s74, v117
    v_dot2_f32_bf16 v118, v18, s75, v118
    v_dot2_f32_bf16 v119, v19, s75, v119
    v_dot2_f32_bf16 v120, v18, s56, v120
    v_dot2_f32_bf16 v121, v19, s56, v121
    v_dot2_f32_bf16 v122, v18, s57, v122
    v_dot2_f32_bf16 v123, v19, s57, v123
    v_dot2_f32_bf16 v124, v18, s58, v124
    v_dot2_f32_bf16 v125, v19, s58, v125
    v_dot2_f32_bf16 v126, v18, s59, v126
    v_dot2_f32_bf16 v127, v19, s59, v127
    v_dot2_f32_bf16 v112, v22, s76, v112
    v_dot2_f32_bf16 v113, v23, s76, v113
    v_dot2_f32_bf16 v114, v22, s77, v114
    v_dot2_f32_bf16 v115, v23, s77, v115
    v_dot2_f32_bf16 v116, v22, s78, v116
    v_dot2_f32_bf16 v117, v23, s78, v117
    v_dot2_f32_bf16 v118, v22, s79, v118
    v_dot2_f32_bf16 v119, v23, s79, v119
    v_dot2_f32_bf16 v120, v22, s60, v120
    v_dot2_f32_bf16 v121, v23, s60, v121
    v_dot2_f32_bf16 v122, v22, s61, v122
    v_dot2_f32_bf16 v123, v23, s61, v123
    v_dot2_f32_bf16 v124, v22, s62, v124
    v_dot2_f32_bf16 v125, v23, s62, v125
    v_dot2_f32_bf16 v126, v22, s63, v126
    v_dot2_f32_bf16 v127, v23, s63, v127
    v_dot2_f32_bf16 v112, v26, s80, v112
    v_dot2_f32_bf16 v113, v27, s80, v113
    v_dot2_f32_bf16 v114, v26, s81, v114
    v_dot2_f32_bf16 v115, v27, s81, v115
    v_dot2_f32_bf16 v116, v26, s82, v116
    v_dot2_f32_bf16 v117, v27, s82, v117
    v_dot2_f32_bf16 v118, v26, s83, v118
    v_dot2_f32_bf16 v119, v27, s83, v119
    v_dot2_f32_bf16 v120, v26, s64, v120
    v_dot2_f32_bf16 v121, v27, s64, v121
    v_dot2_f32_bf16 v122, v26, s65, v122
    v_dot2_f32_bf16 v123, v27, s65, v123
    v_dot2_f32_bf16 v124, v26, s66, v124
    v_dot2_f32_bf16 v125, v27, s66, v125
    v_dot2_f32_bf16 v126, v26, s67, v126
    v_dot2_f32_bf16 v127, v27, s67, v127
L_p2_kernel_g1_30:
    s_cmp_eq_u32 s49, 3
    s_cselect_b32 s15, 8, 0
    s_add_u32 s15, s15, 224
    v_add_u32 v2, 16384, v1
    v_cmp_gt_u32 vcc, s15, v0
    s_mul_i32 s14, s3, 80000
    s_mul_i32 s26, s49, 19968
    s_add_u32 s26, s26, s14
    v_cndmask_b32 v2, 0.5, v2, vcc
    s_mov_b32 s10, 5120000
    buffer_load_dwordx4 v[64:67], v1, s[8:11], s26 offen
    buffer_load_dwordx4 v[68:71], v2, s[8:11], s26 offen
    s_branch L_p2_fin
L_p2_done:
    s_branch L_p2_end
L_p2_slow:
    s_barrier
    v_mov_b32 v8, 0
    v_mov_b32 v9, 0
    v_mov_b32 v10, 0
    v_mov_b32 v11, 0
    v_mov_b32 v12, v1
    ds_write_b128 v12, v[8:11]
    v_add_u32 v12, 16384, v12
    ds_write_b128 v12, v[8:11]
    v_add_u32 v12, 16384, v12
    ds_write_b128 v12, v[8:11]
    v_add_u32 v12, 16384, v12
    ds_write_b128 v12, v[8:11]
    v_add_u32 v12, 16384, v12
    ds_write_b128 v12, v[8:11]
    v_add_u32 v12, 16384, v12
    ds_write_b128 v12, v[8:11]
    v_add_u32 v12, 16384, v12
    ds_write_b128 v12, v[8:11]
    v_add_u32 v12, 16384, v12
    ds_write_b128 v12, v[8:11]
    v_add_u32 v12, 16384, v12
    ds_write_b128 v12, v[8:11]
    v_add_u32 v12, 16384, v12
    ds_write_b128 v12, v[8:11]
    v_add_u32 v12, 16384, v12
    v_mul_u32_u24 v13, 8320, v0
    v_mov_b32 v29, 0x7fc00000
    v_add_u32 v28, 32, v13
    v_lshlrev_b32 v14, 10, v0
    v_add_u32 v14, 9437184, v14
    s_mul_i32 s25, s12, 65
    s_add_u32 s25, s25, s3
    s_lshl_b32 s25, s25, 5
    s_add_u32 s25, s25, 0
    s_lshl_b32 s50, s50, 1
    s_mul_i32 s22, s12, 1280000
    s_mov_b32 s24, 0
    s_waitcnt lgkmcnt(0)
    s_barrier
L_p2_sstep:
    buffer_load_ushort v15, v13, s[4:7], s25 offen
    buffer_load_ushort v16, v28, s[4:7], s25 offen
    s_waitcnt vmcnt(0)
L_p2_srec:
    v_cmp_lt_u32 vcc, v15, v16
    s_nop 1
    s_and_b64 exec, exec, vcc
    s_cbranch_execz L_p2_sdone
    v_mul_u32_u24 v17, 43691, v15
    v_lshrrev_b32 v17, 17, v17
    v_mad_i32_i24 v18, v17, -3, v15
    v_lshrrev_b32 v19, 6, v17
    v_lshl_add_u32 v19, v19, 20, v14
    v_and_b32 v17, 63, v17
    v_lshl_add_u32 v17, v17, 4, v19
    v_lshl_add_u32 v19, v18, 2, v17
    buffer_load_dword v20, v19, s[4:7], 0 offen
    buffer_load_dword v21, v17, s[4:7], 0 offen offset:12
    v_add_u32 v15, 1, v15
    v_mad_u32_u24 v18, v18, 10, 2
    s_waitcnt vmcnt(0)
    v_and_b32 v19, 0x3fff, v20
    v_lshlrev_b32 v19, 3, v19
    buffer_load_dwordx2 v[22:23], v19, s[8:11], s22 offen
    v_mad_u32_u16 v20, v20, 16, s50 op_sel:[1,0,0,0]
    v_bfe_i32 v21, v21, v18, 10
    v_cmp_eq_i32 vcc, -512, v21
    v_cvt_f32_i32 v21, v21
    v_mul_f32 v21, 989872160, v21
    v_cndmask_b32 v21, v21, v29, vcc
    s_waitcnt vmcnt(0)
    v_lshlrev_b32 v24, 16, v22
    v_and_b32 v25, 0xffff0000, v22
    v_lshlrev_b32 v26, 16, v23
    v_and_b32 v27, 0xffff0000, v23
    v_mul_f32 v24, v21, v24
    v_mul_f32 v25, v21, v25
    v_mul_f32 v26, v21, v26
    v_mul_f32 v27, v21, v27
    ds_add_f32 v20, v24
    ds_add_f32 v20, v25 offset:4
    ds_add_f32 v20, v26 offset:8
    ds_add_f32 v20, v27 offset:12
    s_branch L_p2_srec
L_p2_sdone:
    s_mov_b64 exec, -1
    s_add_u32 s25, s25, 2
    s_add_u32 s22, s22, 80000
    s_add_u32 s24, s24, 1
    s_cmp_lt_u32 s24, 16
    s_cbranch_scc1 L_p2_sstep
    s_waitcnt lgkmcnt(0)
    s_barrier
    s_mul_i32 s14, s12, 10240000
    s_mul_i32 s15, s3, 160000
    s_add_u32 s26, s14, s15
    s_add_u32 s26, s26, 249069568
    v_mov_b32 v12, v1
    s_mov_b32 s24, 0
L_p2_sout:
    v_cmp_gt_u32 vcc, 160000, v12
    ds_read_b128 v[8:11], v12
    s_nop 0
    s_and_b64 exec, exec, vcc
    s_cbranch_execz L_p2_sfin
    s_waitcnt lgkmcnt(0)
    buffer_store_dwordx4 v[8:11], v12, s[4:7], s26 offen sc1
    s_waitcnt vmcnt(0)
    v_add_u32 v12, 16384, v12
    s_branch L_p2_sout
L_p2_sfin:
    s_mov_b64 exec, -1
    s_waitcnt vmcnt(0) lgkmcnt(0)
    s_barrier
    s_branch L_p2_signal
L_p2_end:
    s_endpgm
.section .rodata,"a"
.p2align 6
.amdhsa_kernel p1_kernel
  .amdhsa_next_free_vgpr 128
  .amdhsa_next_free_sgpr 96
  .amdhsa_accum_offset 128
  .amdhsa_group_segment_fixed_size 0
  .amdhsa_kernarg_size 112
  .amdhsa_user_sgpr_count 2
  .amdhsa_user_sgpr_kernarg_segment_ptr 1
  .amdhsa_system_sgpr_workgroup_id_x 1
  .amdhsa_float_denorm_mode_32 0
.end_amdhsa_kernel
.p2align 6
.amdhsa_kernel p2_kernel
  .amdhsa_next_free_vgpr 128
  .amdhsa_next_free_sgpr 102
  .amdhsa_accum_offset 128
  .amdhsa_group_segment_fixed_size 0
  .amdhsa_kernarg_size 112
  .amdhsa_user_sgpr_count 2
  .amdhsa_user_sgpr_kernarg_segment_ptr 1
  .amdhsa_system_sgpr_workgroup_id_x 1
  .amdhsa_float_denorm_mode_32 0
.end_amdhsa_kernel
```

```asm
; @launch kernel=p1_kernel grid=(256,1,1) block=(1024,1,1) lds=163840
; @launch kernel=p2_kernel grid=(256,1,1) block=(1024,1,1) lds=163840
.amdgcn_target "amdgcn-amd-amdhsa--gfx950"
.text
.globl p1_kernel
.p2align 8
.type p1_kernel,@function
p1_kernel:
    s_cmp_ge_u32 s2, 256
    s_cbranch_scc1 L_p1_end
    s_load_dwordx2 s[4:5], s[0:1], 104
    s_load_dwordx2 s[8:9], s[0:1], 8
    s_load_dwordx2 s[12:13], s[0:1], 16
    s_load_dwordx2 s[16:17], s[0:1], 32
    s_load_dwordx2 s[28:29], s[0:1], 0
    s_load_dwordx2 s[6:7], s[0:1], 48
    s_load_dwordx2 s[84:85], s[0:1], 96
    v_cmp_gt_u32 vcc, 256, v0
    s_nop 1
    s_cbranch_vccz L_p1_nopf
    s_getpc_b64 s[72:73]
L_p1_kernel_pc_1:
    s_add_u32 s72, s72, L_p1_nopf-L_p1_kernel_pc_1
    s_addc_u32 s73, s73, 0
    v_lshlrev_b32 v14, 7, v0
    v_min_u32 v14, L_p2_end-L_p1_nopf, v14
    global_load_dword v15, v14, s[72:73]
L_p1_nopf:
    v_lshlrev_b32 v1, 4, v0
    v_lshlrev_b32 v2, 3, v0
    v_lshrrev_b32 v6, 6, v0
    v_and_b32 v3, 1023, v1
    v_mov_b32 v4, 1
    v_mov_b32 v5, 0
    v_readfirstlane_b32 s39, v6
    v_cmp_gt_u32 vcc, 784, v0
    s_and_b32 s51, s2, 7
    s_lshl_b32 s51, s51, 0
    s_bfe_u32 s35, s2, 3
    s_add_u32 s51, s51, s35
    s_and_b32 s35, s2, 248
    s_add_u32 s51, s51, s35
    s_lshr_b32 s35, s39, 4
    s_mul_i32 s36, s35, 4177920
    s_lshl_b32 s33, s51, 14
    s_add_u32 s33, s33, s36
    s_lshr_b32 s34, s33, 1
    s_mul_i32 s48, s51, 3840
    s_cmp_ge_u32 s35, 0
    s_cselect_b32 s48, s48, 0
    s_lshr_b32 s49, s48, 1
    s_mov_b64 s[44:45], vcc
    s_waitcnt lgkmcnt(0)
    s_load_dword s3, s[6:7], 0
    s_mov_b32 s10, 163840000
    s_mov_b32 s11, 0x00020000
    s_mov_b32 s14, 163840000
    s_mov_b32 s15, 0x00020000
    s_mov_b32 s18, 81920000
    s_mov_b32 s19, 0x00020000
    s_mov_b32 s86, 256
    s_mov_b32 s87, 0x00020000
    s_mul_i32 s36, s2, 20000
    s_add_u32 s30, s36, 20000
    s_mov_b32 s31, 0x00020000
    s_add_u32 s35, s36, 16384
    buffer_load_dwordx4 v[48:51], v1, s[28:31], s36 offen
    buffer_load_dwordx4 v[52:55], v1, s[28:31], s35 offen
    s_add_u32 s35, s33, 0
    buffer_load_dwordx4 v[16:19], v1, s[8:11], s35 offen nt
    s_add_u32 s35, s33, 0
    buffer_load_dwordx4 v[20:23], v1, s[12:15], s35 offen nt
    s_add_u32 s35, s33, 4194304
    buffer_load_dwordx4 v[24:27], v1, s[8:11], s35 offen nt
    s_add_u32 s35, s33, 4194304
    buffer_load_dwordx4 v[28:31], v1, s[12:15], s35 offen nt
    s_add_u32 s35, s33, 8388608
    buffer_load_dwordx4 v[32:35], v1, s[8:11], s35 offen nt
    s_add_u32 s35, s33, 8388608
    buffer_load_dwordx4 v[36:39], v1, s[12:15], s35 offen nt
    s_add_u32 s35, s33, 12582912
    buffer_load_dwordx4 v[40:43], v1, s[8:11], s35 offen nt
    s_add_u32 s35, s33, 12582912
    buffer_load_dwordx4 v[44:47], v1, s[12:15], s35 offen nt
    s_add_u32 s35, s33, 16777216
    buffer_load_dwordx4 v[72:75], v1, s[8:11], s35 offen nt
    s_add_u32 s35, s33, 16777216
    buffer_load_dwordx4 v[76:79], v1, s[12:15], s35 offen nt
    s_cmp_lg_u32 s39, 0
    s_cbranch_scc1 L_p1_noprobe
    s_cmp_ge_u32 s2, 64
    s_cbranch_scc1 L_p1_noprobe
    s_mul_i32 s88, s2, 208
    s_lshr_b32 s88, s88, 8
    s_lshl_b32 s88, s88, 22
    s_and_b32 s90, s2, 63
    s_mul_i32 s90, s90, 16384
    s_add_u32 s88, s88, s90
    s_add_u32 s88, s4, s88
    s_addc_u32 s89, s5, 0
    s_load_dword s91, s[88:89], 0x1000
    s_lshl_b32 s90, s2, 10
    s_and_b32 s90, s90, 0x2000
    s_xor_b32 s94, s90, 0x2000
    s_waitcnt lgkmcnt(0)
    s_load_dword s91, s[88:89], s90
    s_load_dwordx2 s[92:93], s[88:89], s94
    s_waitcnt lgkmcnt(2)
    s_getreg_b32 s35, hwreg(HW_REG_IB_STS, 9, 1)
    s_waitcnt lgkmcnt(0)
    s_getreg_b32 s91, hwreg(HW_REG_XCC_ID, 0, 3)
    s_lshr_b32 s90, s2, 3
    s_lshr_b32 s92, s91, 2
    s_xor_b32 s90, s90, s92
    s_xor_b32 s90, s90, s35
    s_and_b32 s90, s90, 1
    s_or_b32 s90, s90, 0x10000
    v_mov_b32 v8, s90
    s_mov_b64 exec, 1
    buffer_atomic_add v8, off, s[84:87], 0 offset:128 sc0
    s_sub_u32 s91, s91, s2
    s_and_b32 s91, s91, 7
    s_or_b32 s92, s91, 8
    s_waitcnt vmcnt(0)
    v_readfirstlane_b32 s93, v8
    s_nop 0
    s_add_u32 s90, s90, s93
    s_cmp_le_u32 s90, 3145746
    s_cselect_b32 s92, s92, 16
    s_cmp_ge_u32 s90, 3145758
    s_cselect_b32 s92, s91, s92
    s_or_b32 s92, s92, 32
    v_mov_b32 v8, s92
    v_mov_b32 v9, 0
    s_lshr_b32 s90, s90, 16
    s_cmp_lg_u32 s90, 48
    s_cbranch_scc1 L_p1_voted
    buffer_atomic_cmpswap v[8:9], off, s[84:87], 0
L_p1_voted:
    s_mov_b64 exec, -1
L_p1_noprobe:
    s_mov_b32 s20, s4
    s_mov_b32 s21, s5
    s_mov_b32 s22, 0
    s_mov_b32 s23, 0x00020000
    s_add_u32 s24, s4, 222298112
    s_addc_u32 s25, s5, 0
    s_mov_b32 s26, 8540160
    s_mov_b32 s27, 0x00020000
    s_mov_b32 s37, 1492179184
    s_mov_b32 s55, 0
    s_mov_b64 s[76:77], 0
    s_mul_i32 s42, s39, 13
    s_mov_b64 s[72:73], s[4:5]
    s_mov_b32 s74, 0
    s_mov_b32 s75, 0x00020000
    s_mov_b32 s50, 21845
    s_mov_b32 s52, 0x8000
    s_mov_b32 s38, 262400
    s_mov_b32 s43, 0x05040100
    s_mov_b32 s40, 0
    v_mov_b32 v8, 0
    v_mov_b32 v9, 0
    v_mov_b32 v10, 0
    v_mov_b32 v11, 0
    ds_write_b128 v1, v[8:11] offset:0
    v_min_u32 v7, 16, v0
    v_lshlrev_b32 v7, 2, v7
    v_add_u32 v7, 160768, v7
    ds_write_b32 v7, v8
    s_waitcnt lgkmcnt(0)
    s_lshl_b32 s3, s3, 16
    v_mov_b32 v12, s3
    v_mul_f32 v12, 0.15915494, v12
    s_nop 0
    v_readfirstlane_b32 s41, v12
    s_waitcnt vmcnt(10)
    v_mov_b32 v12, 0x3f803f80
    v_and_b32 v48, 0x7fff7fff, v48
    v_and_b32 v49, 0x7fff7fff, v49
    v_and_b32 v50, 0x7fff7fff, v50
    v_and_b32 v51, 0x7fff7fff, v51
    v_and_b32 v52, 0x7fff7fff, v52
    v_and_b32 v53, 0x7fff7fff, v53
    v_and_b32 v54, 0x7fff7fff, v54
    v_and_b32 v55, 0x7fff7fff, v55
    v_pk_max_u16 v8, v8, v48
    v_dot2c_f32_bf16 v9, v48, v12
    v_pk_max_u16 v8, v8, v49
    v_dot2c_f32_bf16 v9, v49, v12
    v_pk_max_u16 v8, v8, v50
    v_dot2c_f32_bf16 v9, v50, v12
    v_pk_max_u16 v8, v8, v51
    v_dot2c_f32_bf16 v9, v51, v12
    v_pk_max_u16 v8, v8, v52
    v_dot2c_f32_bf16 v9, v52, v12
    v_pk_max_u16 v8, v8, v53
    v_dot2c_f32_bf16 v9, v53, v12
    v_pk_max_u16 v8, v8, v54
    v_dot2c_f32_bf16 v9, v54, v12
    v_pk_max_u16 v8, v8, v55
    v_dot2c_f32_bf16 v9, v55, v12
    v_lshrrev_b32 v10, 16, v8
    v_and_b32 v8, 0xffff, v8
    v_max_u32 v8, v8, v10
    s_nop 0
    s_nop 1
    v_max_u32_dpp v8, v8, v8 row_shr:1 row_mask:0xf bank_mask:0xf bound_ctrl:0
    s_nop 1
    v_max_u32_dpp v8, v8, v8 row_shr:2 row_mask:0xf bank_mask:0xf bound_ctrl:0
    s_nop 1
    v_max_u32_dpp v8, v8, v8 row_shr:4 row_mask:0xf bank_mask:0xf bound_ctrl:0
    s_nop 1
    v_max_u32_dpp v8, v8, v8 row_shr:8 row_mask:0xf bank_mask:0xf bound_ctrl:0
    s_nop 1
    v_max_u32_dpp v8, v8, v8 row_bcast:15 row_mask:0xa bank_mask:0xf
    s_nop 1
    v_max_u32_dpp v8, v8, v8 row_bcast:31 row_mask:0xc bank_mask:0xf
    s_nop 1
    v_add_f32_dpp v9, v9, v9 row_shr:1 row_mask:0xf bank_mask:0xf bound_ctrl:0
    s_nop 1
    v_add_f32_dpp v9, v9, v9 row_shr:2 row_mask:0xf bank_mask:0xf bound_ctrl:0
    s_nop 1
    v_add_f32_dpp v9, v9, v9 row_shr:4 row_mask:0xf bank_mask:0xf bound_ctrl:0
    s_nop 1
    v_add_f32_dpp v9, v9, v9 row_shr:8 row_mask:0xf bank_mask:0xf bound_ctrl:0
    s_nop 1
    v_add_f32_dpp v9, v9, v9 row_bcast:15 row_mask:0xa bank_mask:0xf
    s_nop 1
    v_add_f32_dpp v9, v9, v9 row_bcast:31 row_mask:0xc bank_mask:0xf
    s_lshl_b32 s35, s39, 4
    s_add_u32 s35, s35, 160320
    v_mov_b32 v10, s35
    s_mov_b32 exec_lo, 0
    s_brev_b32 exec_hi, 1
    ds_write_b64 v10, v[8:9]
    s_mov_b64 exec, -1
    s_waitcnt lgkmcnt(0)
    s_barrier
    s_cmp_lg_u32 s39, 0
    s_cbranch_scc1 L_p1_first
    v_and_b32 v6, 15, v0
    v_lshlrev_b32 v6, 4, v6
    v_add_u32 v6, 160320, v6
    ds_read_b64 v[8:9], v6
    s_waitcnt lgkmcnt(0)
    s_nop 1
    v_max_u32_dpp v8, v8, v8 row_shr:1 row_mask:0xf bank_mask:0xf bound_ctrl:0
    s_nop 1
    v_max_u32_dpp v8, v8, v8 row_shr:2 row_mask:0xf bank_mask:0xf bound_ctrl:0
    s_nop 1
    v_max_u32_dpp v8, v8, v8 row_shr:4 row_mask:0xf bank_mask:0xf bound_ctrl:0
    s_nop 1
    v_max_u32_dpp v8, v8, v8 row_shr:8 row_mask:0xf bank_mask:0xf bound_ctrl:0
    s_nop 1
    v_add_f32_dpp v9, v9, v9 row_shr:1 row_mask:0xf bank_mask:0xf bound_ctrl:0
    s_nop 1
    v_add_f32_dpp v9, v9, v9 row_shr:2 row_mask:0xf bank_mask:0xf bound_ctrl:0
    s_nop 1
    v_add_f32_dpp v9, v9, v9 row_shr:4 row_mask:0xf bank_mask:0xf bound_ctrl:0
    s_nop 1
    v_add_f32_dpp v9, v9, v9 row_shr:8 row_mask:0xf bank_mask:0xf bound_ctrl:0
    s_lshl_b32 s35, s2, 3
    s_add_u32 s35, s35, 8519680
    v_mov_b32 v6, 0
    s_mov_b64 exec, 0x8000
    buffer_store_dwordx2 v[8:9], v6, s[24:27], s35 offen sc1
    s_lshl_b32 s35, s2, 8
    s_add_u32 s35, s35, 8523776
    buffer_store_dword v6, v6, s[24:27], s35 offen sc1
    s_mov_b64 exec, -1
    s_branch L_p1_first
L_p1_loop:
    s_mov_b64 s[72:73], s[20:21]
    s_mov_b32 s74, s22
    s_cmp_lg_u32 s39, 15
    s_cbranch_scc1 L_p1_kernel_nox_2
    s_waitcnt lgkmcnt(13)
    v_lshlrev_b32 v15, 16, v120
    v_and_b32 v120, 0xffff0000, v120
    v_lshlrev_b32 v121, 16, v121
    v_mul_f32 v15, s41, v15
    v_mul_f32 v120, s41, v120
    v_mul_f32 v121, s41, v121
    v_fract_f32 v15, v15
    v_fract_f32 v120, v120
    v_fract_f32 v121, v121
    v_cos_f32 v15, v15
    v_cos_f32 v120, v120
    v_cos_f32 v121, v121
    v_fmaak_f32 v15, v10, v15, 1262486016
    v_fmaak_f32 v120, v10, v120, 1262486016
    v_fmaak_f32 v121, v10, v121, 1262486016
    v_lshlrev_b32 v15, 22, v15
    v_alignbit_b32 v15, v120, v15, 10
    v_alignbit_b32 v15, v121, v15, 10
    v_xor_b32 v15, 0x80200800, v15
    s_add_u32 s36, s42, 13
    s_and_b32 s35, s36, 3
    s_mul_i32 s35, s35, 1047552
    s_lshl_b32 s36, s36, 20
    s_sub_u32 s36, s36, s35
    buffer_store_dwordx4 v[12:15], v3, s[20:23], s36 offen sc1
L_p1_kernel_nox_2:
    s_waitcnt lgkmcnt(12)
    v_lshlrev_b32 v75, 16, v122
    v_and_b32 v122, 0xffff0000, v122
    v_lshlrev_b32 v123, 16, v123
    v_mul_f32 v75, s41, v75
    v_mul_f32 v122, s41, v122
    v_mul_f32 v123, s41, v123
    v_fract_f32 v75, v75
    v_fract_f32 v122, v122
    v_fract_f32 v123, v123
    v_cos_f32 v75, v75
    v_cos_f32 v122, v122
    v_cos_f32 v123, v123
    v_fmaak_f32 v75, v10, v75, 1262486016
    v_fmaak_f32 v122, v10, v122, 1262486016
    v_fmaak_f32 v123, v10, v123, 1262486016
    v_lshlrev_b32 v75, 22, v75
    v_alignbit_b32 v75, v122, v75, 10
    v_alignbit_b32 v75, v123, v75, 10
    v_xor_b32 v75, 0x80200800, v75
    s_add_u32 s36, s42, 0
    s_and_b32 s35, s36, 3
    s_mul_i32 s35, s35, 1047552
    s_lshl_b32 s36, s36, 20
    s_sub_u32 s36, s36, s35
    buffer_store_dwordx4 v[72:75], v3, s[20:23], s36 offen sc1
    s_waitcnt lgkmcnt(11)
    v_lshlrev_b32 v79, 16, v124
    v_and_b32 v124, 0xffff0000, v124
    v_lshlrev_b32 v125, 16, v125
    v_mul_f32 v79, s41, v79
    v_mul_f32 v124, s41, v124
    v_mul_f32 v125, s41, v125
    v_fract_f32 v79, v79
    v_fract_f32 v124, v124
    v_fract_f32 v125, v125
    v_cos_f32 v79, v79
    v_cos_f32 v124, v124
    v_cos_f32 v125, v125
    v_fmaak_f32 v79, v10, v79, 1262486016
    v_fmaak_f32 v124, v10, v124, 1262486016
    v_fmaak_f32 v125, v10, v125, 1262486016
    v_lshlrev_b32 v79, 22, v79
    v_alignbit_b32 v79, v124, v79, 10
    v_alignbit_b32 v79, v125, v79, 10
    v_xor_b32 v79, 0x80200800, v79
    s_add_u32 s36, s42, 1
    s_and_b32 s35, s36, 3
    s_mul_i32 s35, s35, 1047552
    s_lshl_b32 s36, s36, 20
    s_sub_u32 s36, s36, s35
    buffer_store_dwordx4 v[76:79], v3, s[20:23], s36 offen sc1
    s_waitcnt lgkmcnt(0)
    v_lshlrev_b32 v51, 16, v126
    v_and_b32 v126, 0xffff0000, v126
    v_lshlrev_b32 v127, 16, v127
    v_mul_f32 v51, s41, v51
    v_mul_f32 v126, s41, v126
    v_mul_f32 v127, s41, v127
    v_fract_f32 v51, v51
    v_fract_f32 v126, v126
    v_fract_f32 v127, v127
    v_cos_f32 v51, v51
    v_cos_f32 v126, v126
    v_cos_f32 v127, v127
    v_fmaak_f32 v51, v10, v51, 1262486016
    v_fmaak_f32 v126, v10, v126, 1262486016
    v_fmaak_f32 v127, v10, v127, 1262486016
    v_lshlrev_b32 v51, 22, v51
    v_alignbit_b32 v51, v126, v51, 10
    v_alignbit_b32 v51, v127, v51, 10
    v_xor_b32 v51, 0x80200800, v51
    s_add_u32 s36, s42, 2
    s_and_b32 s35, s36, 3
    s_mul_i32 s35, s35, 1047552
    s_lshl_b32 s36, s36, 20
    s_sub_u32 s36, s36, s35
    buffer_store_dwordx4 v[48:51], v3, s[20:23], s36 offen sc1
    s_add_u32 s35, s33, 16777216
    buffer_load_dwordx4 v[72:75], v1, s[8:11], s35 offen nt
    s_add_u32 s35, s33, 16777216
    buffer_load_dwordx4 v[76:79], v1, s[12:15], s35 offen nt
    s_waitcnt vmcnt(11)
    v_perm_b32 v6, v20, v16, s43
    v_perm_b32 v7, v21, v17, s43
    v_perm_b32 v8, v22, v18, s43
    v_perm_b32 v9, v23, v19, s43
    v_mul_hi_u32_u24 v16, 429497, v16
    v_mul_hi_u32_u24 v20, 429497, v20
    v_mul_hi_u32_u24 v17, 429497, v17
    v_mul_hi_u32_u24 v21, 429497, v21
    v_mul_hi_u32_u24 v18, 429497, v18
    v_mul_hi_u32_u24 v22, 429497, v22
    v_mul_hi_u32_u24 v19, 429497, v19
    v_mul_hi_u32_u24 v23, 429497, v23
    v_lshl_or_b32 v16, v20, 16, v16
    v_lshl_or_b32 v17, v21, 16, v17
    v_lshl_or_b32 v18, v22, 16, v18
    v_lshl_or_b32 v19, v23, 16, v19
    v_dot2_u32_u16 v20, v16, s38, 0
    v_dot2_u32_u16 v21, v17, s38, 0
    v_dot2_u32_u16 v22, v18, s38, 0
    v_dot2_u32_u16 v23, v19, s38, 0
    v_pk_mad_u16 v6, v16, s37, v6
    v_pk_mad_u16 v7, v17, s37, v7
    v_pk_mad_u16 v8, v18, s37, v8
    v_pk_mad_u16 v9, v19, s37, v9
    ds_add_u32 v20, v4 offset:0
    ds_add_u32 v21, v4 offset:0
    ds_add_u32 v22, v4 offset:0
    ds_add_u32 v23, v4 offset:0
    v_pk_mad_u16 v6, v16, s52, v6 op_sel:[1,0,0] op_sel_hi:[1,1,1]
    v_pk_mad_u16 v7, v17, s52, v7 op_sel:[1,0,0] op_sel_hi:[1,1,1]
    v_pk_mad_u16 v8, v18, s52, v8 op_sel:[1,0,0] op_sel_hi:[1,1,1]
    v_pk_mad_u16 v9, v19, s52, v9 op_sel:[1,0,0] op_sel_hi:[1,1,1]
    v_perm_b32 v121, v23, v22, s43
    v_perm_b32 v120, v21, v20, s43
    v_or_b32 v127, 0x40000000, v6
    v_or_b32 v48, 0x40000000, v7
    v_or_b32 v49, 0x40000000, v8
    v_or_b32 v50, 0x40000000, v9
    v_lshlrev_b32 v83, 16, v100
    v_and_b32 v100, 0xffff0000, v100
    v_lshlrev_b32 v101, 16, v101
    v_mul_f32 v83, s41, v83
    v_mul_f32 v100, s41, v100
    v_mul_f32 v101, s41, v101
    v_fract_f32 v83, v83
    v_fract_f32 v100, v100
    v_fract_f32 v101, v101
    v_cos_f32 v83, v83
    v_cos_f32 v100, v100
    v_cos_f32 v101, v101
    v_fmaak_f32 v83, v10, v83, 1262486016
    v_fmaak_f32 v100, v10, v100, 1262486016
    v_fmaak_f32 v101, v10, v101, 1262486016
    v_lshlrev_b32 v83, 22, v83
    v_alignbit_b32 v83, v100, v83, 10
    v_alignbit_b32 v83, v101, v83, 10
    v_xor_b32 v83, 0x80200800, v83
    s_add_u32 s36, s42, 3
    s_and_b32 s35, s36, 3
    s_mul_i32 s35, s35, 1047552
    s_lshl_b32 s36, s36, 20
    s_sub_u32 s36, s36, s35
    buffer_store_dwordx4 v[80:83], v3, s[20:23], s36 offen sc1
    v_lshlrev_b32 v55, 16, v102
    v_and_b32 v102, 0xffff0000, v102
    v_lshlrev_b32 v103, 16, v103
    v_mul_f32 v55, s41, v55
    v_mul_f32 v102, s41, v102
    v_mul_f32 v103, s41, v103
    v_fract_f32 v55, v55
    v_fract_f32 v102, v102
    v_fract_f32 v103, v103
    v_cos_f32 v55, v55
    v_cos_f32 v102, v102
    v_cos_f32 v103, v103
    v_fmaak_f32 v55, v10, v55, 1262486016
    v_fmaak_f32 v102, v10, v102, 1262486016
    v_fmaak_f32 v103, v10, v103, 1262486016
    v_lshlrev_b32 v55, 22, v55
    v_alignbit_b32 v55, v102, v55, 10
    v_alignbit_b32 v55, v103, v55, 10
    v_xor_b32 v55, 0x80200800, v55
    s_cmp_lg_u32 s40, 3
    s_cbranch_scc1 L_p1_kernel_now_3
    v_mov_b64 v[16:17], v[52:53]
    v_mov_b64 v[18:19], v[54:55]
    s_branch L_p1_kernel_held_4
L_p1_kernel_now_3:
    s_add_u32 s36, s42, 4
    s_and_b32 s35, s36, 3
    s_mul_i32 s35, s35, 1047552
    s_lshl_b32 s36, s36, 20
    s_sub_u32 s36, s36, s35
    buffer_store_dwordx4 v[52:55], v3, s[20:23], s36 offen sc1
L_p1_kernel_held_4:
    s_add_u32 s35, s33, 20971520
    buffer_load_dwordx4 v[80:83], v1, s[8:11], s35 offen nt
    s_add_u32 s35, s33, 20971520
    buffer_load_dwordx4 v[100:103], v1, s[12:15], s35 offen nt
    v_lshlrev_b32 v87, 16, v104
    v_and_b32 v104, 0xffff0000, v104
    v_lshlrev_b32 v105, 16, v105
    v_mul_f32 v87, s41, v87
    v_mul_f32 v104, s41, v104
    v_mul_f32 v105, s41, v105
    v_fract_f32 v87, v87
    v_fract_f32 v104, v104
    v_fract_f32 v105, v105
    v_cos_f32 v87, v87
    v_cos_f32 v104, v104
    v_cos_f32 v105, v105
    v_fmaak_f32 v87, v10, v87, 1262486016
    v_fmaak_f32 v104, v10, v104, 1262486016
    v_fmaak_f32 v105, v10, v105, 1262486016
    v_lshlrev_b32 v87, 22, v87
    v_alignbit_b32 v87, v104, v87, 10
    v_alignbit_b32 v87, v105, v87, 10
    v_xor_b32 v87, 0x80200800, v87
    s_add_u32 s36, s42, 5
    s_and_b32 s35, s36, 3
    s_mul_i32 s35, s35, 1047552
    s_lshl_b32 s36, s36, 20
    s_sub_u32 s36, s36, s35
    buffer_store_dwordx4 v[84:87], v3, s[20:23], s36 offen sc1
    v_lshlrev_b32 v59, 16, v106
    v_and_b32 v106, 0xffff0000, v106
    v_lshlrev_b32 v107, 16, v107
    v_mul_f32 v59, s41, v59
    v_mul_f32 v106, s41, v106
    v_mul_f32 v107, s41, v107
    v_fract_f32 v59, v59
    v_fract_f32 v106, v106
    v_fract_f32 v107, v107
    v_cos_f32 v59, v59
    v_cos_f32 v106, v106
    v_cos_f32 v107, v107
    v_fmaak_f32 v59, v10, v59, 1262486016
    v_fmaak_f32 v106, v10, v106, 1262486016
    v_fmaak_f32 v107, v10, v107, 1262486016
    v_lshlrev_b32 v59, 22, v59
    v_alignbit_b32 v59, v106, v59, 10
    v_alignbit_b32 v59, v107, v59, 10
    v_xor_b32 v59, 0x80200800, v59
    s_cmp_lg_u32 s40, 3
    s_cbranch_scc1 L_p1_kernel_now_5
    v_mov_b64 v[20:21], v[56:57]
    v_mov_b64 v[22:23], v[58:59]
    s_branch L_p1_kernel_held_6
L_p1_kernel_now_5:
    s_add_u32 s36, s42, 6
    s_and_b32 s35, s36, 3
    s_mul_i32 s35, s35, 1047552
    s_lshl_b32 s36, s36, 20
    s_sub_u32 s36, s36, s35
    buffer_store_dwordx4 v[56:59], v3, s[20:23], s36 offen sc1
L_p1_kernel_held_6:
    s_add_u32 s35, s33, 25165824
    buffer_load_dwordx4 v[84:87], v1, s[8:11], s35 offen nt
    s_add_u32 s35, s33, 25165824
    buffer_load_dwordx4 v[104:107], v1, s[12:15], s35 offen nt
    s_waitcnt vmcnt(15)
    v_perm_b32 v6, v28, v24, s43
    v_perm_b32 v7, v29, v25, s43
    v_perm_b32 v8, v30, v26, s43
    v_perm_b32 v9, v31, v27, s43
    v_mul_hi_u32_u24 v24, 429497, v24
    v_mul_hi_u32_u24 v28, 429497, v28
    v_mul_hi_u32_u24 v25, 429497, v25
    v_mul_hi_u32_u24 v29, 429497, v29
    v_mul_hi_u32_u24 v26, 429497, v26
    v_mul_hi_u32_u24 v30, 429497, v30
    v_mul_hi_u32_u24 v27, 429497, v27
    v_mul_hi_u32_u24 v31, 429497, v31
    v_lshl_or_b32 v24, v28, 16, v24
    v_lshl_or_b32 v25, v29, 16, v25
    v_lshl_or_b32 v26, v30, 16, v26
    v_lshl_or_b32 v27, v31, 16, v27
    v_dot2_u32_u16 v28, v24, s38, 0
    v_dot2_u32_u16 v29, v25, s38, 0
    v_dot2_u32_u16 v30, v26, s38, 0
    v_dot2_u32_u16 v31, v27, s38, 0
    v_pk_mad_u16 v6, v24, s37, v6
    v_pk_mad_u16 v7, v25, s37, v7
    v_pk_mad_u16 v8, v26, s37, v8
    v_pk_mad_u16 v9, v27, s37, v9
    ds_add_u32 v28, v4 offset:0
    ds_add_u32 v29, v4 offset:0
    ds_add_u32 v30, v4 offset:0
    ds_add_u32 v31, v4 offset:0
    v_pk_mad_u16 v6, v24, s52, v6 op_sel:[1,0,0] op_sel_hi:[1,1,1]
    v_pk_mad_u16 v7, v25, s52, v7 op_sel:[1,0,0] op_sel_hi:[1,1,1]
    v_pk_mad_u16 v8, v26, s52, v8 op_sel:[1,0,0] op_sel_hi:[1,1,1]
    v_pk_mad_u16 v9, v27, s52, v9 op_sel:[1,0,0] op_sel_hi:[1,1,1]
    v_perm_b32 v123, v31, v30, s43
    v_perm_b32 v122, v29, v28, s43
    v_or_b32 v52, 0x40000000, v6
    v_or_b32 v53, 0x40000000, v7
    v_or_b32 v54, 0x40000000, v8
    v_or_b32 v56, 0x40000000, v9
    v_lshlrev_b32 v91, 16, v108
    v_and_b32 v108, 0xffff0000, v108
    v_lshlrev_b32 v109, 16, v109
    v_mul_f32 v91, s41, v91
    v_mul_f32 v108, s41, v108
    v_mul_f32 v109, s41, v109
    v_fract_f32 v91, v91
    v_fract_f32 v108, v108
    v_fract_f32 v109, v109
    v_cos_f32 v91, v91
    v_cos_f32 v108, v108
    v_cos_f32 v109, v109
    v_fmaak_f32 v91, v10, v91, 1262486016
    v_fmaak_f32 v108, v10, v108, 1262486016
    v_fmaak_f32 v109, v10, v109, 1262486016
    v_lshlrev_b32 v91, 22, v91
    v_alignbit_b32 v91, v108, v91, 10
    v_alignbit_b32 v91, v109, v91, 10
    v_xor_b32 v91, 0x80200800, v91
    s_cmp_lg_u32 s40, 3
    s_cbranch_scc1 L_p1_kernel_now_7
    v_mov_b64 v[24:25], v[88:89]
    v_mov_b64 v[26:27], v[90:91]
    s_branch L_p1_kernel_held_8
L_p1_kernel_now_7:
    s_add_u32 s36, s42, 7
    s_and_b32 s35, s36, 3
    s_mul_i32 s35, s35, 1047552
    s_lshl_b32 s36, s36, 20
    s_sub_u32 s36, s36, s35
    buffer_store_dwordx4 v[88:91], v3, s[20:23], s36 offen sc1
L_p1_kernel_held_8:
    v_lshlrev_b32 v63, 16, v110
    v_and_b32 v110, 0xffff0000, v110
    v_lshlrev_b32 v111, 16, v111
    v_mul_f32 v63, s41, v63
    v_mul_f32 v110, s41, v110
    v_mul_f32 v111, s41, v111
    v_fract_f32 v63, v63
    v_fract_f32 v110, v110
    v_fract_f32 v111, v111
    v_cos_f32 v63, v63
    v_cos_f32 v110, v110
    v_cos_f32 v111, v111
    v_fmaak_f32 v63, v10, v63, 1262486016
    v_fmaak_f32 v110, v10, v110, 1262486016
    v_fmaak_f32 v111, v10, v111, 1262486016
    v_lshlrev_b32 v63, 22, v63
    v_alignbit_b32 v63, v110, v63, 10
    v_alignbit_b32 v63, v111, v63, 10
    v_xor_b32 v63, 0x80200800, v63
    s_cmp_lg_u32 s40, 3
    s_cbranch_scc1 L_p1_kernel_now_9
    v_mov_b64 v[28:29], v[60:61]
    v_mov_b64 v[30:31], v[62:63]
    s_branch L_p1_kernel_held_10
L_p1_kernel_now_9:
    s_add_u32 s36, s42, 8
    s_and_b32 s35, s36, 3
    s_mul_i32 s35, s35, 1047552
    s_lshl_b32 s36, s36, 20
    s_sub_u32 s36, s36, s35
    buffer_store_dwordx4 v[60:63], v3, s[20:23], s36 offen sc1
L_p1_kernel_held_10:
    s_add_u32 s35, s33, 29360128
    buffer_load_dwordx4 v[88:91], v1, s[8:11], s35 offen nt
    s_add_u32 s35, s33, 29360128
    buffer_load_dwordx4 v[108:111], v1, s[12:15], s35 offen nt
    s_waitcnt vmcnt(15)
    v_perm_b32 v6, v36, v32, s43
    v_perm_b32 v7, v37, v33, s43
    v_perm_b32 v8, v38, v34, s43
    v_perm_b32 v9, v39, v35, s43
    v_mul_hi_u32_u24 v32, 429497, v32
    v_mul_hi_u32_u24 v36, 429497, v36
    v_mul_hi_u32_u24 v33, 429497, v33
    v_mul_hi_u32_u24 v37, 429497, v37
    v_mul_hi_u32_u24 v34, 429497, v34
    v_mul_hi_u32_u24 v38, 429497, v38
    v_mul_hi_u32_u24 v35, 429497, v35
    v_mul_hi_u32_u24 v39, 429497, v39
    v_lshl_or_b32 v32, v36, 16, v32
    v_lshl_or_b32 v33, v37, 16, v33
    v_lshl_or_b32 v34, v38, 16, v34
    v_lshl_or_b32 v35, v39, 16, v35
    v_dot2_u32_u16 v36, v32, s38, 0
    v_dot2_u32_u16 v37, v33, s38, 0
    v_dot2_u32_u16 v38, v34, s38, 0
    v_dot2_u32_u16 v39, v35, s38, 0
    v_pk_mad_u16 v6, v32, s37, v6
    v_pk_mad_u16 v7, v33, s37, v7
    v_pk_mad_u16 v8, v34, s37, v8
    v_pk_mad_u16 v9, v35, s37, v9
    ds_add_u32 v36, v4 offset:0
    ds_add_u32 v37, v4 offset:0
    ds_add_u32 v38, v4 offset:0
    ds_add_u32 v39, v4 offset:0
    v_pk_mad_u16 v6, v32, s52, v6 op_sel:[1,0,0] op_sel_hi:[1,1,1]
    v_pk_mad_u16 v7, v33, s52, v7 op_sel:[1,0,0] op_sel_hi:[1,1,1]
    v_pk_mad_u16 v8, v34, s52, v8 op_sel:[1,0,0] op_sel_hi:[1,1,1]
    v_pk_mad_u16 v9, v35, s52, v9 op_sel:[1,0,0] op_sel_hi:[1,1,1]
    v_perm_b32 v125, v39, v38, s43
    v_perm_b32 v124, v37, v36, s43
    v_or_b32 v57, 0x40000000, v6
    v_or_b32 v58, 0x40000000, v7
    v_or_b32 v60, 0x40000000, v8
    v_or_b32 v61, 0x40000000, v9
    v_lshlrev_b32 v95, 16, v112
    v_and_b32 v112, 0xffff0000, v112
    v_lshlrev_b32 v113, 16, v113
    v_mul_f32 v95, s41, v95
    v_mul_f32 v112, s41, v112
    v_mul_f32 v113, s41, v113
    v_fract_f32 v95, v95
    v_fract_f32 v112, v112
    v_fract_f32 v113, v113
    v_cos_f32 v95, v95
    v_cos_f32 v112, v112
    v_cos_f32 v113, v113
    v_fmaak_f32 v95, v10, v95, 1262486016
    v_fmaak_f32 v112, v10, v112, 1262486016
    v_fmaak_f32 v113, v10, v113, 1262486016
    v_lshlrev_b32 v95, 22, v95
    v_alignbit_b32 v95, v112, v95, 10
    v_alignbit_b32 v95, v113, v95, 10
    v_xor_b32 v95, 0x80200800, v95
    s_cmp_lg_u32 s40, 3
    s_cbranch_scc1 L_p1_kernel_now_11
    v_mov_b64 v[32:33], v[92:93]
    v_mov_b64 v[34:35], v[94:95]
    s_branch L_p1_kernel_held_12
L_p1_kernel_now_11:
    s_add_u32 s36, s42, 9
    s_and_b32 s35, s36, 3
    s_mul_i32 s35, s35, 1047552
    s_lshl_b32 s36, s36, 20
    s_sub_u32 s36, s36, s35
    buffer_store_dwordx4 v[92:95], v3, s[20:23], s36 offen sc1
L_p1_kernel_held_12:
    v_lshlrev_b32 v67, 16, v114
    v_and_b32 v114, 0xffff0000, v114
    v_lshlrev_b32 v115, 16, v115
    v_mul_f32 v67, s41, v67
    v_mul_f32 v114, s41, v114
    v_mul_f32 v115, s41, v115
    v_fract_f32 v67, v67
    v_fract_f32 v114, v114
    v_fract_f32 v115, v115
    v_cos_f32 v67, v67
    v_cos_f32 v114, v114
    v_cos_f32 v115, v115
    v_fmaak_f32 v67, v10, v67, 1262486016
    v_fmaak_f32 v114, v10, v114, 1262486016
    v_fmaak_f32 v115, v10, v115, 1262486016
    v_lshlrev_b32 v67, 22, v67
    v_alignbit_b32 v67, v114, v67, 10
    v_alignbit_b32 v67, v115, v67, 10
    v_xor_b32 v67, 0x80200800, v67
    s_cmp_lg_u32 s40, 3
    s_cbranch_scc1 L_p1_kernel_now_13
    v_mov_b64 v[36:37], v[64:65]
    v_mov_b64 v[38:39], v[66:67]
    s_branch L_p1_kernel_held_14
L_p1_kernel_now_13:
    s_add_u32 s36, s42, 10
    s_and_b32 s35, s36, 3
    s_mul_i32 s35, s35, 1047552
    s_lshl_b32 s36, s36, 20
    s_sub_u32 s36, s36, s35
    buffer_store_dwordx4 v[64:67], v3, s[20:23], s36 offen sc1
L_p1_kernel_held_14:
    s_add_u32 s35, s33, 33554432
    buffer_load_dwordx4 v[92:95], v1, s[8:11], s35 offen nt
    s_add_u32 s35, s33, 33554432
    buffer_load_dwordx4 v[112:115], v1, s[12:15], s35 offen nt
    s_waitcnt vmcnt(15)
    v_perm_b32 v6, v44, v40, s43
    v_perm_b32 v7, v45, v41, s43
    v_perm_b32 v8, v46, v42, s43
    v_perm_b32 v9, v47, v43, s43
    v_mul_hi_u32_u24 v40, 429497, v40
    v_mul_hi_u32_u24 v44, 429497, v44
    v_mul_hi_u32_u24 v41, 429497, v41
    v_mul_hi_u32_u24 v45, 429497, v45
    v_mul_hi_u32_u24 v42, 429497, v42
    v_mul_hi_u32_u24 v46, 429497, v46
    v_mul_hi_u32_u24 v43, 429497, v43
    v_mul_hi_u32_u24 v47, 429497, v47
    v_lshl_or_b32 v40, v44, 16, v40
    v_lshl_or_b32 v41, v45, 16, v41
    v_lshl_or_b32 v42, v46, 16, v42
    v_lshl_or_b32 v43, v47, 16, v43
    v_dot2_u32_u16 v44, v40, s38, 0
    v_dot2_u32_u16 v45, v41, s38, 0
    v_dot2_u32_u16 v46, v42, s38, 0
    v_dot2_u32_u16 v47, v43, s38, 0
    v_pk_mad_u16 v6, v40, s37, v6
    v_pk_mad_u16 v7, v41, s37, v7
    v_pk_mad_u16 v8, v42, s37, v8
    v_pk_mad_u16 v9, v43, s37, v9
    ds_add_u32 v44, v4 offset:0
    ds_add_u32 v45, v4 offset:0
    ds_add_u32 v46, v4 offset:0
    ds_add_u32 v47, v4 offset:0
    v_pk_mad_u16 v6, v40, s52, v6 op_sel:[1,0,0] op_sel_hi:[1,1,1]
    v_pk_mad_u16 v7, v41, s52, v7 op_sel:[1,0,0] op_sel_hi:[1,1,1]
    v_pk_mad_u16 v8, v42, s52, v8 op_sel:[1,0,0] op_sel_hi:[1,1,1]
    v_pk_mad_u16 v9, v43, s52, v9 op_sel:[1,0,0] op_sel_hi:[1,1,1]
    v_perm_b32 v51, v47, v46, s43
    v_perm_b32 v126, v45, v44, s43
    v_or_b32 v62, 0x40000000, v6
    v_or_b32 v64, 0x40000000, v7
    v_or_b32 v65, 0x40000000, v8
    v_or_b32 v66, 0x40000000, v9
    v_lshlrev_b32 v99, 16, v116
    v_and_b32 v116, 0xffff0000, v116
    v_lshlrev_b32 v117, 16, v117
    v_mul_f32 v99, s41, v99
    v_mul_f32 v116, s41, v116
    v_mul_f32 v117, s41, v117
    v_fract_f32 v99, v99
    v_fract_f32 v116, v116
    v_fract_f32 v117, v117
    v_cos_f32 v99, v99
    v_cos_f32 v116, v116
    v_cos_f32 v117, v117
    v_fmaak_f32 v99, v10, v99, 1262486016
    v_fmaak_f32 v116, v10, v116, 1262486016
    v_fmaak_f32 v117, v10, v117, 1262486016
    v_lshlrev_b32 v99, 22, v99
    v_alignbit_b32 v99, v116, v99, 10
    v_alignbit_b32 v99, v117, v99, 10
    v_xor_b32 v99, 0x80200800, v99
    s_cmp_lg_u32 s40, 3
    s_cbranch_scc1 L_p1_kernel_now_15
    v_mov_b64 v[40:41], v[96:97]
    v_mov_b64 v[42:43], v[98:99]
    s_branch L_p1_kernel_held_16
L_p1_kernel_now_15:
    s_add_u32 s36, s42, 11
    s_and_b32 s35, s36, 3
    s_mul_i32 s35, s35, 1047552
    s_lshl_b32 s36, s36, 20
    s_sub_u32 s36, s36, s35
    buffer_store_dwordx4 v[96:99], v3, s[20:23], s36 offen sc1
L_p1_kernel_held_16:
    v_lshlrev_b32 v71, 16, v118
    v_and_b32 v118, 0xffff0000, v118
    v_lshlrev_b32 v119, 16, v119
    v_mul_f32 v71, s41, v71
    v_mul_f32 v118, s41, v118
    v_mul_f32 v119, s41, v119
    v_fract_f32 v71, v71
    v_fract_f32 v118, v118
    v_fract_f32 v119, v119
    v_cos_f32 v71, v71
    v_cos_f32 v118, v118
    v_cos_f32 v119, v119
    v_fmaak_f32 v71, v10, v71, 1262486016
    v_fmaak_f32 v118, v10, v118, 1262486016
    v_fmaak_f32 v119, v10, v119, 1262486016
    v_lshlrev_b32 v71, 22, v71
    v_alignbit_b32 v71, v118, v71, 10
    v_alignbit_b32 v71, v119, v71, 10
    v_xor_b32 v71, 0x80200800, v71
    s_cmp_lg_u32 s40, 3
    s_cbranch_scc1 L_p1_kernel_now_17
    v_mov_b64 v[44:45], v[68:69]
    v_mov_b64 v[46:47], v[70:71]
    s_branch L_p1_kernel_held_18
L_p1_kernel_now_17:
    s_add_u32 s36, s42, 12
    s_and_b32 s35, s36, 3
    s_mul_i32 s35, s35, 1047552
    s_lshl_b32 s36, s36, 20
    s_sub_u32 s36, s36, s35
    buffer_store_dwordx4 v[68:71], v3, s[20:23], s36 offen sc1
L_p1_kernel_held_18:
    s_add_u32 s35, s33, 37748736
    s_sub_u32 s35, s35, s48
    v_cndmask_b32 v96, 2.0, v1, s[44:45]
    buffer_load_dwordx4 v[96:99], v96, s[8:11], s35 offen nt
    s_add_u32 s35, s33, 37748736
    s_sub_u32 s35, s35, s48
    v_cndmask_b32 v116, 2.0, v1, s[44:45]
    buffer_load_dwordx4 v[116:119], v116, s[12:15], s35 offen nt
    s_branch L_p1_join
L_p1_first:
    s_add_u32 s35, s33, 20971520
    buffer_load_dwordx4 v[80:83], v1, s[8:11], s35 offen nt
    s_add_u32 s35, s33, 20971520
    buffer_load_dwordx4 v[100:103], v1, s[12:15], s35 offen nt
    s_add_u32 s35, s33, 25165824
    buffer_load_dwordx4 v[84:87], v1, s[8:11], s35 offen nt
    s_add_u32 s35, s33, 25165824
    buffer_load_dwordx4 v[104:107], v1, s[12:15], s35 offen nt
    s_add_u32 s35, s33, 29360128
    buffer_load_dwordx4 v[88:91], v1, s[8:11], s35 offen nt
    s_add_u32 s35, s33, 29360128
    buffer_load_dwordx4 v[108:111], v1, s[12:15], s35 offen nt
    s_add_u32 s35, s33, 33554432
    buffer_load_dwordx4 v[92:95], v1, s[8:11], s35 offen nt
    s_add_u32 s35, s33, 33554432
    buffer_load_dwordx4 v[112:115], v1, s[12:15], s35 offen nt
    s_add_u32 s35, s33, 37748736
    s_sub_u32 s35, s35, s48
    v_cndmask_b32 v96, 2.0, v1, s[44:45]
    buffer_load_dwordx4 v[96:99], v96, s[8:11], s35 offen nt
    s_add_u32 s35, s33, 37748736
    s_sub_u32 s35, s35, s48
    v_cndmask_b32 v116, 2.0, v1, s[44:45]
    buffer_load_dwordx4 v[116:119], v116, s[12:15], s35 offen nt
    s_cmp_lg_u32 s39, 15
    s_cbranch_scc1 L_p1_nofetch
    buffer_load_dword v12, off, s[84:87], 0 sc1
L_p1_nofetch:
    s_waitcnt vmcnt(18)
    v_perm_b32 v6, v20, v16, s43
    v_perm_b32 v7, v21, v17, s43
    v_perm_b32 v8, v22, v18, s43
    v_perm_b32 v9, v23, v19, s43
    v_mul_hi_u32_u24 v16, 429497, v16
    v_mul_hi_u32_u24 v20, 429497, v20
    v_mul_hi_u32_u24 v17, 429497, v17
    v_mul_hi_u32_u24 v21, 429497, v21
    v_mul_hi_u32_u24 v18, 429497, v18
    v_mul_hi_u32_u24 v22, 429497, v22
    v_mul_hi_u32_u24 v19, 429497, v19
    v_mul_hi_u32_u24 v23, 429497, v23
    v_lshl_or_b32 v16, v20, 16, v16
    v_lshl_or_b32 v17, v21, 16, v17
    v_lshl_or_b32 v18, v22, 16, v18
    v_lshl_or_b32 v19, v23, 16, v19
    v_dot2_u32_u16 v20, v16, s38, 0
    v_dot2_u32_u16 v21, v17, s38, 0
    v_dot2_u32_u16 v22, v18, s38, 0
    v_dot2_u32_u16 v23, v19, s38, 0
    v_pk_mad_u16 v6, v16, s37, v6
    v_pk_mad_u16 v7, v17, s37, v7
    v_pk_mad_u16 v8, v18, s37, v8
    v_pk_mad_u16 v9, v19, s37, v9
    ds_add_u32 v20, v4 offset:0
    ds_add_u32 v21, v4 offset:0
    ds_add_u32 v22, v4 offset:0
    ds_add_u32 v23, v4 offset:0
    v_pk_mad_u16 v6, v16, s52, v6 op_sel:[1,0,0] op_sel_hi:[1,1,1]
    v_pk_mad_u16 v7, v17, s52, v7 op_sel:[1,0,0] op_sel_hi:[1,1,1]
    v_pk_mad_u16 v8, v18, s52, v8 op_sel:[1,0,0] op_sel_hi:[1,1,1]
    v_pk_mad_u16 v9, v19, s52, v9 op_sel:[1,0,0] op_sel_hi:[1,1,1]
    v_perm_b32 v121, v23, v22, s43
    v_perm_b32 v120, v21, v20, s43
    v_or_b32 v127, 0x40000000, v6
    v_or_b32 v48, 0x40000000, v7
    v_or_b32 v49, 0x40000000, v8
    v_or_b32 v50, 0x40000000, v9
    s_waitcnt vmcnt(16)
    v_perm_b32 v6, v28, v24, s43
    v_perm_b32 v7, v29, v25, s43
    v_perm_b32 v8, v30, v26, s43
    v_perm_b32 v9, v31, v27, s43
    v_mul_hi_u32_u24 v24, 429497, v24
    v_mul_hi_u32_u24 v28, 429497, v28
    v_mul_hi_u32_u24 v25, 429497, v25
    v_mul_hi_u32_u24 v29, 429497, v29
    v_mul_hi_u32_u24 v26, 429497, v26
    v_mul_hi_u32_u24 v30, 429497, v30
    v_mul_hi_u32_u24 v27, 429497, v27
    v_mul_hi_u32_u24 v31, 429497, v31
    v_lshl_or_b32 v24, v28, 16, v24
    v_lshl_or_b32 v25, v29, 16, v25
    v_lshl_or_b32 v26, v30, 16, v26
    v_lshl_or_b32 v27, v31, 16, v27
    v_dot2_u32_u16 v28, v24, s38, 0
    v_dot2_u32_u16 v29, v25, s38, 0
    v_dot2_u32_u16 v30, v26, s38, 0
    v_dot2_u32_u16 v31, v27, s38, 0
    v_pk_mad_u16 v6, v24, s37, v6
    v_pk_mad_u16 v7, v25, s37, v7
    v_pk_mad_u16 v8, v26, s37, v8
    v_pk_mad_u16 v9, v27, s37, v9
    ds_add_u32 v28, v4 offset:0
    ds_add_u32 v29, v4 offset:0
    ds_add_u32 v30, v4 offset:0
    ds_add_u32 v31, v4 offset:0
    v_pk_mad_u16 v6, v24, s52, v6 op_sel:[1,0,0] op_sel_hi:[1,1,1]
    v_pk_mad_u16 v7, v25, s52, v7 op_sel:[1,0,0] op_sel_hi:[1,1,1]
    v_pk_mad_u16 v8, v26, s52, v8 op_sel:[1,0,0] op_sel_hi:[1,1,1]
    v_pk_mad_u16 v9, v27, s52, v9 op_sel:[1,0,0] op_sel_hi:[1,1,1]
    v_perm_b32 v123, v31, v30, s43
    v_perm_b32 v122, v29, v28, s43
    v_or_b32 v52, 0x40000000, v6
    v_or_b32 v53, 0x40000000, v7
    v_or_b32 v54, 0x40000000, v8
    v_or_b32 v56, 0x40000000, v9
    s_waitcnt vmcnt(14)
    v_perm_b32 v6, v36, v32, s43
    v_perm_b32 v7, v37, v33, s43
    v_perm_b32 v8, v38, v34, s43
    v_perm_b32 v9, v39, v35, s43
    v_mul_hi_u32_u24 v32, 429497, v32
    v_mul_hi_u32_u24 v36, 429497, v36
    v_mul_hi_u32_u24 v33, 429497, v33
    v_mul_hi_u32_u24 v37, 429497, v37
    v_mul_hi_u32_u24 v34, 429497, v34
    v_mul_hi_u32_u24 v38, 429497, v38
    v_mul_hi_u32_u24 v35, 429497, v35
    v_mul_hi_u32_u24 v39, 429497, v39
    v_lshl_or_b32 v32, v36, 16, v32
    v_lshl_or_b32 v33, v37, 16, v33
    v_lshl_or_b32 v34, v38, 16, v34
    v_lshl_or_b32 v35, v39, 16, v35
    v_dot2_u32_u16 v36, v32, s38, 0
    v_dot2_u32_u16 v37, v33, s38, 0
    v_dot2_u32_u16 v38, v34, s38, 0
    v_dot2_u32_u16 v39, v35, s38, 0
    v_pk_mad_u16 v6, v32, s37, v6
    v_pk_mad_u16 v7, v33, s37, v7
    v_pk_mad_u16 v8, v34, s37, v8
    v_pk_mad_u16 v9, v35, s37, v9
    ds_add_u32 v36, v4 offset:0
    ds_add_u32 v37, v4 offset:0
    ds_add_u32 v38, v4 offset:0
    ds_add_u32 v39, v4 offset:0
    v_pk_mad_u16 v6, v32, s52, v6 op_sel:[1,0,0] op_sel_hi:[1,1,1]
    v_pk_mad_u16 v7, v33, s52, v7 op_sel:[1,0,0] op_sel_hi:[1,1,1]
    v_pk_mad_u16 v8, v34, s52, v8 op_sel:[1,0,0] op_sel_hi:[1,1,1]
    v_pk_mad_u16 v9, v35, s52, v9 op_sel:[1,0,0] op_sel_hi:[1,1,1]
    v_perm_b32 v125, v39, v38, s43
    v_perm_b32 v124, v37, v36, s43
    v_or_b32 v57, 0x40000000, v6
    v_or_b32 v58, 0x40000000, v7
    v_or_b32 v60, 0x40000000, v8
    v_or_b32 v61, 0x40000000, v9
    s_waitcnt vmcnt(12)
    v_perm_b32 v6, v44, v40, s43
    v_perm_b32 v7, v45, v41, s43
    v_perm_b32 v8, v46, v42, s43
    v_perm_b32 v9, v47, v43, s43
    v_mul_hi_u32_u24 v40, 429497, v40
    v_mul_hi_u32_u24 v44, 429497, v44
    v_mul_hi_u32_u24 v41, 429497, v41
    v_mul_hi_u32_u24 v45, 429497, v45
    v_mul_hi_u32_u24 v42, 429497, v42
    v_mul_hi_u32_u24 v46, 429497, v46
    v_mul_hi_u32_u24 v43, 429497, v43
    v_mul_hi_u32_u24 v47, 429497, v47
    v_lshl_or_b32 v40, v44, 16, v40
    v_lshl_or_b32 v41, v45, 16, v41
    v_lshl_or_b32 v42, v46, 16, v42
    v_lshl_or_b32 v43, v47, 16, v43
    v_dot2_u32_u16 v44, v40, s38, 0
    v_dot2_u32_u16 v45, v41, s38, 0
    v_dot2_u32_u16 v46, v42, s38, 0
    v_dot2_u32_u16 v47, v43, s38, 0
    v_pk_mad_u16 v6, v40, s37, v6
    v_pk_mad_u16 v7, v41, s37, v7
    v_pk_mad_u16 v8, v42, s37, v8
    v_pk_mad_u16 v9, v43, s37, v9
    ds_add_u32 v44, v4 offset:0
    ds_add_u32 v45, v4 offset:0
    ds_add_u32 v46, v4 offset:0
    ds_add_u32 v47, v4 offset:0
    v_pk_mad_u16 v6, v40, s52, v6 op_sel:[1,0,0] op_sel_hi:[1,1,1]
    v_pk_mad_u16 v7, v41, s52, v7 op_sel:[1,0,0] op_sel_hi:[1,1,1]
    v_pk_mad_u16 v8, v42, s52, v8 op_sel:[1,0,0] op_sel_hi:[1,1,1]
    v_pk_mad_u16 v9, v43, s52, v9 op_sel:[1,0,0] op_sel_hi:[1,1,1]
    v_perm_b32 v51, v47, v46, s43
    v_perm_b32 v126, v45, v44, s43
    v_or_b32 v62, 0x40000000, v6
    v_or_b32 v64, 0x40000000, v7
    v_or_b32 v65, 0x40000000, v8
    v_or_b32 v66, 0x40000000, v9
L_p1_join:
    s_waitcnt vmcnt(10)
    v_perm_b32 v6, v76, v72, s43
    v_perm_b32 v7, v77, v73, s43
    v_perm_b32 v8, v78, v74, s43
    v_perm_b32 v9, v79, v75, s43
    v_mul_hi_u32_u24 v72, 429497, v72
    v_mul_hi_u32_u24 v76, 429497, v76
    v_mul_hi_u32_u24 v73, 429497, v73
    v_mul_hi_u32_u24 v77, 429497, v77
    v_mul_hi_u32_u24 v74, 429497, v74
    v_mul_hi_u32_u24 v78, 429497, v78
    v_mul_hi_u32_u24 v75, 429497, v75
    v_mul_hi_u32_u24 v79, 429497, v79
    v_lshl_or_b32 v72, v76, 16, v72
    v_lshl_or_b32 v73, v77, 16, v73
    v_lshl_or_b32 v74, v78, 16, v74
    v_lshl_or_b32 v75, v79, 16, v75
    v_dot2_u32_u16 v76, v72, s38, 0
    v_dot2_u32_u16 v77, v73, s38, 0
    v_dot2_u32_u16 v78, v74, s38, 0
    v_dot2_u32_u16 v79, v75, s38, 0
    v_pk_mad_u16 v6, v72, s37, v6
    v_pk_mad_u16 v7, v73, s37, v7
    v_pk_mad_u16 v8, v74, s37, v8
    v_pk_mad_u16 v9, v75, s37, v9
    ds_add_u32 v76, v4 offset:0
    ds_add_u32 v77, v4 offset:0
    ds_add_u32 v78, v4 offset:0
    ds_add_u32 v79, v4 offset:0
    v_pk_mad_u16 v6, v72, s52, v6 op_sel:[1,0,0] op_sel_hi:[1,1,1]
    v_pk_mad_u16 v7, v73, s52, v7 op_sel:[1,0,0] op_sel_hi:[1,1,1]
    v_pk_mad_u16 v8, v74, s52, v8 op_sel:[1,0,0] op_sel_hi:[1,1,1]
    v_pk_mad_u16 v9, v75, s52, v9 op_sel:[1,0,0] op_sel_hi:[1,1,1]
    v_perm_b32 v59, v79, v78, s43
    v_perm_b32 v55, v77, v76, s43
    v_or_b32 v68, 0x40000000, v6
    v_or_b32 v69, 0x40000000, v7
    v_or_b32 v70, 0x40000000, v8
    v_or_b32 v72, 0x40000000, v9
    s_waitcnt vmcnt(8)
    v_perm_b32 v6, v100, v80, s43
    v_perm_b32 v7, v101, v81, s43
    v_perm_b32 v8, v102, v82, s43
    v_perm_b32 v9, v103, v83, s43
    v_mul_hi_u32_u24 v80, 429497, v80
    v_mul_hi_u32_u24 v100, 429497, v100
    v_mul_hi_u32_u24 v81, 429497, v81
    v_mul_hi_u32_u24 v101, 429497, v101
    v_mul_hi_u32_u24 v82, 429497, v82
    v_mul_hi_u32_u24 v102, 429497, v102
    v_mul_hi_u32_u24 v83, 429497, v83
    v_mul_hi_u32_u24 v103, 429497, v103
    v_lshl_or_b32 v80, v100, 16, v80
    v_lshl_or_b32 v81, v101, 16, v81
    v_lshl_or_b32 v82, v102, 16, v82
    v_lshl_or_b32 v83, v103, 16, v83
    v_dot2_u32_u16 v100, v80, s38, 0
    v_dot2_u32_u16 v101, v81, s38, 0
    v_dot2_u32_u16 v102, v82, s38, 0
    v_dot2_u32_u16 v103, v83, s38, 0
    v_pk_mad_u16 v6, v80, s37, v6
    v_pk_mad_u16 v7, v81, s37, v7
    v_pk_mad_u16 v8, v82, s37, v8
    v_pk_mad_u16 v9, v83, s37, v9
    ds_add_u32 v100, v4 offset:0
    ds_add_u32 v101, v4 offset:0
    ds_add_u32 v102, v4 offset:0
    ds_add_u32 v103, v4 offset:0
    v_pk_mad_u16 v6, v80, s52, v6 op_sel:[1,0,0] op_sel_hi:[1,1,1]
    v_pk_mad_u16 v7, v81, s52, v7 op_sel:[1,0,0] op_sel_hi:[1,1,1]
    v_pk_mad_u16 v8, v82, s52, v8 op_sel:[1,0,0] op_sel_hi:[1,1,1]
    v_pk_mad_u16 v9, v83, s52, v9 op_sel:[1,0,0] op_sel_hi:[1,1,1]
    v_perm_b32 v67, v103, v102, s43
    v_perm_b32 v63, v101, v100, s43
    v_or_b32 v73, 0x40000000, v6
    v_or_b32 v74, 0x40000000, v7
    v_or_b32 v76, 0x40000000, v8
    v_or_b32 v77, 0x40000000, v9
    s_waitcnt vmcnt(6)
    v_perm_b32 v6, v104, v84, s43
    v_perm_b32 v7, v105, v85, s43
    v_perm_b32 v8, v106, v86, s43
    v_perm_b32 v9, v107, v87, s43
    v_mul_hi_u32_u24 v84, 429497, v84
    v_mul_hi_u32_u24 v104, 429497, v104
    v_mul_hi_u32_u24 v85, 429497, v85
    v_mul_hi_u32_u24 v105, 429497, v105
    v_mul_hi_u32_u24 v86, 429497, v86
    v_mul_hi_u32_u24 v106, 429497, v106
    v_mul_hi_u32_u24 v87, 429497, v87
    v_mul_hi_u32_u24 v107, 429497, v107
    v_lshl_or_b32 v84, v104, 16, v84
    v_lshl_or_b32 v85, v105, 16, v85
    v_lshl_or_b32 v86, v106, 16, v86
    v_lshl_or_b32 v87, v107, 16, v87
    v_dot2_u32_u16 v104, v84, s38, 0
    v_dot2_u32_u16 v105, v85, s38, 0
    v_dot2_u32_u16 v106, v86, s38, 0
    v_dot2_u32_u16 v107, v87, s38, 0
    v_pk_mad_u16 v6, v84, s37, v6
    v_pk_mad_u16 v7, v85, s37, v7
    v_pk_mad_u16 v8, v86, s37, v8
    v_pk_mad_u16 v9, v87, s37, v9
    ds_add_u32 v104, v4 offset:0
    ds_add_u32 v105, v4 offset:0
    ds_add_u32 v106, v4 offset:0
    ds_add_u32 v107, v4 offset:0
    v_pk_mad_u16 v6, v84, s52, v6 op_sel:[1,0,0] op_sel_hi:[1,1,1]
    v_pk_mad_u16 v7, v85, s52, v7 op_sel:[1,0,0] op_sel_hi:[1,1,1]
    v_pk_mad_u16 v8, v86, s52, v8 op_sel:[1,0,0] op_sel_hi:[1,1,1]
    v_pk_mad_u16 v9, v87, s52, v9 op_sel:[1,0,0] op_sel_hi:[1,1,1]
    v_perm_b32 v75, v107, v106, s43
    v_perm_b32 v71, v105, v104, s43
    v_or_b32 v78, 0x40000000, v6
    v_or_b32 v80, 0x40000000, v7
    v_or_b32 v81, 0x40000000, v8
    v_or_b32 v82, 0x40000000, v9
    s_waitcnt vmcnt(4)
    v_perm_b32 v6, v108, v88, s43
    v_perm_b32 v7, v109, v89, s43
    v_perm_b32 v8, v110, v90, s43
    v_perm_b32 v9, v111, v91, s43
    v_mul_hi_u32_u24 v88, 429497, v88
    v_mul_hi_u32_u24 v108, 429497, v108
    v_mul_hi_u32_u24 v89, 429497, v89
    v_mul_hi_u32_u24 v109, 429497, v109
    v_mul_hi_u32_u24 v90, 429497, v90
    v_mul_hi_u32_u24 v110, 429497, v110
    v_mul_hi_u32_u24 v91, 429497, v91
    v_mul_hi_u32_u24 v111, 429497, v111
    v_lshl_or_b32 v88, v108, 16, v88
    v_lshl_or_b32 v89, v109, 16, v89
    v_lshl_or_b32 v90, v110, 16, v90
    v_lshl_or_b32 v91, v111, 16, v91
    v_dot2_u32_u16 v108, v88, s38, 0
    v_dot2_u32_u16 v109, v89, s38, 0
    v_dot2_u32_u16 v110, v90, s38, 0
    v_dot2_u32_u16 v111, v91, s38, 0
    v_pk_mad_u16 v6, v88, s37, v6
    v_pk_mad_u16 v7, v89, s37, v7
    v_pk_mad_u16 v8, v90, s37, v8
    v_pk_mad_u16 v9, v91, s37, v9
    ds_add_u32 v108, v4 offset:0
    ds_add_u32 v109, v4 offset:0
    ds_add_u32 v110, v4 offset:0
    ds_add_u32 v111, v4 offset:0
    v_pk_mad_u16 v6, v88, s52, v6 op_sel:[1,0,0] op_sel_hi:[1,1,1]
    v_pk_mad_u16 v7, v89, s52, v7 op_sel:[1,0,0] op_sel_hi:[1,1,1]
    v_pk_mad_u16 v8, v90, s52, v8 op_sel:[1,0,0] op_sel_hi:[1,1,1]
    v_pk_mad_u16 v9, v91, s52, v9 op_sel:[1,0,0] op_sel_hi:[1,1,1]
    v_perm_b32 v83, v111, v110, s43
    v_perm_b32 v79, v109, v108, s43
    v_or_b32 v84, 0x40000000, v6
    v_or_b32 v85, 0x40000000, v7
    v_or_b32 v86, 0x40000000, v8
    v_or_b32 v88, 0x40000000, v9
    s_waitcnt vmcnt(2)
    v_perm_b32 v6, v112, v92, s43
    v_perm_b32 v7, v113, v93, s43
    v_perm_b32 v8, v114, v94, s43
    v_perm_b32 v9, v115, v95, s43
    v_mul_hi_u32_u24 v92, 429497, v92
    v_mul_hi_u32_u24 v112, 429497, v112
    v_mul_hi_u32_u24 v93, 429497, v93
    v_mul_hi_u32_u24 v113, 429497, v113
    v_mul_hi_u32_u24 v94, 429497, v94
    v_mul_hi_u32_u24 v114, 429497, v114
    v_mul_hi_u32_u24 v95, 429497, v95
    v_mul_hi_u32_u24 v115, 429497, v115
    v_lshl_or_b32 v92, v112, 16, v92
    v_lshl_or_b32 v93, v113, 16, v93
    v_lshl_or_b32 v94, v114, 16, v94
    v_lshl_or_b32 v95, v115, 16, v95
    v_dot2_u32_u16 v112, v92, s38, 0
    v_dot2_u32_u16 v113, v93, s38, 0
    v_dot2_u32_u16 v114, v94, s38, 0
    v_dot2_u32_u16 v115, v95, s38, 0
    v_pk_mad_u16 v6, v92, s37, v6
    v_pk_mad_u16 v7, v93, s37, v7
    v_pk_mad_u16 v8, v94, s37, v8
    v_pk_mad_u16 v9, v95, s37, v9
    ds_add_u32 v112, v4 offset:0
    ds_add_u32 v113, v4 offset:0
    ds_add_u32 v114, v4 offset:0
    ds_add_u32 v115, v4 offset:0
    v_pk_mad_u16 v6, v92, s52, v6 op_sel:[1,0,0] op_sel_hi:[1,1,1]
    v_pk_mad_u16 v7, v93, s52, v7 op_sel:[1,0,0] op_sel_hi:[1,1,1]
    v_pk_mad_u16 v8, v94, s52, v8 op_sel:[1,0,0] op_sel_hi:[1,1,1]
    v_pk_mad_u16 v9, v95, s52, v9 op_sel:[1,0,0] op_sel_hi:[1,1,1]
    v_perm_b32 v91, v115, v114, s43
    v_perm_b32 v87, v113, v112, s43
    v_or_b32 v89, 0x40000000, v6
    v_or_b32 v90, 0x40000000, v7
    v_or_b32 v92, 0x40000000, v8
    v_or_b32 v93, 0x40000000, v9
    s_waitcnt vmcnt(0)
    s_mov_b64 exec, s[44:45]
    v_perm_b32 v6, v116, v96, s43
    v_perm_b32 v7, v117, v97, s43
    v_perm_b32 v8, v118, v98, s43
    v_perm_b32 v9, v119, v99, s43
    v_mul_hi_u32_u24 v96, 429497, v96
    v_mul_hi_u32_u24 v116, 429497, v116
    v_mul_hi_u32_u24 v97, 429497, v97
    v_mul_hi_u32_u24 v117, 429497, v117
    v_mul_hi_u32_u24 v98, 429497, v98
    v_mul_hi_u32_u24 v118, 429497, v118
    v_mul_hi_u32_u24 v99, 429497, v99
    v_mul_hi_u32_u24 v119, 429497, v119
    v_lshl_or_b32 v96, v116, 16, v96
    v_lshl_or_b32 v97, v117, 16, v97
    v_lshl_or_b32 v98, v118, 16, v98
    v_lshl_or_b32 v99, v119, 16, v99
    v_dot2_u32_u16 v116, v96, s38, 0
    v_dot2_u32_u16 v117, v97, s38, 0
    v_dot2_u32_u16 v118, v98, s38, 0
    v_dot2_u32_u16 v119, v99, s38, 0
    v_pk_mad_u16 v6, v96, s37, v6
    v_pk_mad_u16 v7, v97, s37, v7
    v_pk_mad_u16 v8, v98, s37, v8
    v_pk_mad_u16 v9, v99, s37, v9
    ds_add_u32 v116, v4 offset:0
    ds_add_u32 v117, v4 offset:0
    ds_add_u32 v118, v4 offset:0
    ds_add_u32 v119, v4 offset:0
    v_pk_mad_u16 v6, v96, s52, v6 op_sel:[1,0,0] op_sel_hi:[1,1,1]
    v_pk_mad_u16 v7, v97, s52, v7 op_sel:[1,0,0] op_sel_hi:[1,1,1]
    v_pk_mad_u16 v8, v98, s52, v8 op_sel:[1,0,0] op_sel_hi:[1,1,1]
    v_pk_mad_u16 v9, v99, s52, v9 op_sel:[1,0,0] op_sel_hi:[1,1,1]
    v_perm_b32 v99, v119, v118, s43
    v_perm_b32 v95, v117, v116, s43
    v_or_b32 v94, 0x40000000, v6
    v_or_b32 v96, 0x40000000, v7
    v_or_b32 v97, 0x40000000, v8
    v_or_b32 v98, 0x40000000, v9
    s_mov_b64 exec, -1
    s_xor_b32 s35, s39, 15
    s_or_b32 s35, s35, s40
    s_cbranch_scc1 L_p1_nodec
    s_mov_b64 exec, 1
    v_cmp_eq_u32 vcc, 0, v12
    v_mov_b32 v6, 160896
    s_nop 0
    s_cbranch_vccz L_p1_dec
    v_mov_b32 v12, 48
    v_mov_b32 v13, 0
    buffer_atomic_cmpswap v[12:13], off, s[84:87], 0 sc0
    s_waitcnt vmcnt(0)
    v_cmp_eq_u32 vcc, 0, v12
    s_nop 1
    v_cndmask_b32 v12, v12, 48, vcc
L_p1_dec:
    ds_write_b32 v6, v12
    s_mov_b64 exec, -1
L_p1_nodec:
    s_add_u32 s35, s34, 0
    buffer_load_dwordx2 v[100:101], v2, s[16:19], s35 offen nt
    s_lshl2_add_u32 s35, s39, 160768
    v_mov_b32 v13, s35
    v_mov_b32 v7, 2.0
    v_and_b32 v6, 63, v0
    s_mov_b32 s36, 160768
    s_lshl_b32 s35, 0x1fffe, s39
    s_and_b32 s35, s35, 0x1ffff
    s_mov_b32 exec_hi, 0
    s_mov_b32 exec_lo, s35
    v_lshl_add_u32 v7, v6, 2, s36
    s_mov_b64 exec, -1
    v_mov_b32 v14, 160832
    s_mov_b32 s53, 2
    s_waitcnt lgkmcnt(0)
    s_barrier
    ds_read_b128 v[8:11], v1 offset:0
    s_add_u32 s35, s34, 2097152
    buffer_load_dwordx2 v[102:103], v2, s[16:19], s35 offen nt
L_p1_redo:
    s_waitcnt lgkmcnt(0)
    v_min3_u32 v12, v8, v9, v10
    v_min_u32 v12, v12, v11
    v_cmp_gt_u32 vcc, s53, v12
    s_nop 0
    s_mov_b64 s[46:47], vcc
    s_cbranch_vccz L_p1_kernel_nomask_19
    v_cmp_eq_u32 s[56:57], 0, v8
    v_cmp_ge_u32 s[64:65], 1, v8
    v_max_u32 v8, 2, v8
    v_cmp_eq_u32 s[58:59], 0, v9
    v_cmp_ge_u32 s[66:67], 1, v9
    v_max_u32 v9, 2, v9
    v_cmp_eq_u32 s[60:61], 0, v10
    v_cmp_ge_u32 s[68:69], 1, v10
    v_max_u32 v10, 2, v10
    v_cmp_eq_u32 s[62:63], 0, v11
    v_cmp_ge_u32 s[70:71], 1, v11
    v_max_u32 v11, 2, v11
L_p1_kernel_nomask_19:
    v_add_u32 v9, v8, v9
    v_add_u32 v10, v9, v10
    v_add_u32 v11, v10, v11
    s_nop 1
    v_add_u32_dpp v6, v11, v11 row_shr:1 row_mask:0xf bank_mask:0xf bound_ctrl:0
    s_nop 1
    v_add_u32_dpp v6, v6, v6 row_shr:2 row_mask:0xf bank_mask:0xf bound_ctrl:0
    s_nop 1
    v_add_u32_dpp v6, v6, v6 row_shr:4 row_mask:0xf bank_mask:0xf bound_ctrl:0
    s_nop 1
    v_add_u32_dpp v6, v6, v6 row_shr:8 row_mask:0xf bank_mask:0xf bound_ctrl:0
    s_nop 1
    v_add_u32_dpp v6, v6, v6 row_bcast:15 row_mask:0xa bank_mask:0xf
    s_nop 1
    v_add_u32_dpp v6, v6, v6 row_bcast:31 row_mask:0xc bank_mask:0xf
    s_nop 0
    v_readlane_b32 s35, v6, 63
    v_sub_u32 v6, v6, v11
    v_add_u32 v8, v8, v6
    v_mov_b32 v12, s35
    ds_add_u32 v7, v12
    v_add_u32 v9, v9, v6
    v_add_u32 v10, v10, v6
    s_waitcnt lgkmcnt(0)
    s_barrier
    ds_read_b32 v12, v14
    ds_read_b32 v11, v13
    s_add_u32 s35, s34, 4194304
    buffer_load_dwordx2 v[104:105], v2, s[16:19], s35 offen nt
    s_waitcnt lgkmcnt(1)
    v_readfirstlane_b32 s54, v12
    s_waitcnt lgkmcnt(0)
    s_cmp_ge_u32 s54, 40063
    s_cbranch_scc0 L_p1_fits
    s_barrier
    v_mov_b32 v12, 0
    ds_write_b32 v7, v12
    s_mov_b32 s53, 0
    s_mov_b32 s55, 1
    s_waitcnt lgkmcnt(0)
    s_barrier
    ds_read_b128 v[8:11], v1 offset:0
    s_branch L_p1_redo
L_p1_fits:
    s_mov_b64 exec, 1
    v_mov_b32 v7, 24576
    ds_write_b16 v7, v12
    s_mov_b64 exec, -1
    v_add_u32 v12, v11, v6
    v_add_u32 v13, v11, v8
    v_add_u32 v14, v11, v9
    v_add_u32 v15, v11, v10
    ds_write_b128 v1, v[12:15] offset:0
    s_add_u32 s35, s54, 2
    s_mul_hi_u32 s35, s35, 1431655766
    v_perm_b32 v15, v15, v14, s43
    v_perm_b32 v14, v13, v12, s43
    ds_write_b64 v2, v[14:15] offset:16384
    s_lshl_b32 s35, s35, 4
    s_add_u32 s35, s35, 217890943
    s_andn2_b32 s35, s35, 127
    s_min_u32 s22, s35, 218104832
    s_waitcnt lgkmcnt(0)
    s_barrier
    s_cmp_lg_u32 s40, 0
    s_cbranch_scc1 L_p1_slot
    v_mov_b32 v6, 160896
    ds_read_b32 v6, v6
    s_waitcnt lgkmcnt(0)
    v_readfirstlane_b32 s90, v6
    s_lshr_b32 s92, s2, 3
    s_add_u32 s91, s2, s90
    s_and_b32 s35, s91, 3
    s_lshl_b32 s35, s35, 5
    s_or_b32 s35, s35, s92
    s_andn2_b32 s36, s35, 1
    s_add_u32 s76, s35, s36
    s_lshr_b32 s91, s91, 2
    s_lshr_b32 s35, s90, 3
    s_xor_b32 s91, s91, s35
    s_lshr_b32 s35, s90, 4
    s_and_b32 s35, s35, s92
    s_xor_b32 s91, s91, s35
    s_and_b32 s91, s91, 1
    s_lshl1_add_u32 s76, s91, s76
    s_lshr_b32 s77, s90, 3
L_p1_slot:
    s_lshl_b32 s35, s40, 8
    s_lshl_b32 s36, s40, 1
    s_and_b32 s36, s36, s77
    s_xor_b32 s36, s36, s40
    s_and_b32 s36, s36, 2
    s_or_b32 s35, s35, s36
    s_xor_b32 s32, s76, s35
    s_and_b32 s32, s32, 1023
    s_lshl_b32 s35, s32, 12
    s_add_u32 s20, s4, s35
    s_addc_u32 s21, s5, 0
    s_nop 0
    v_and_b32 v6, 0xffff, v120
    v_lshrrev_b32 v7, 16, v120
    v_and_b32 v8, 0xffff, v121
    v_lshrrev_b32 v9, 16, v121
    ds_add_rtn_u32 v6, v6, v4 offset:0
    ds_add_rtn_u32 v7, v7, v4 offset:0
    ds_add_rtn_u32 v8, v8, v4 offset:0
    ds_add_rtn_u32 v9, v9, v4 offset:0
    v_and_b32 v10, 0xffff, v122
    v_lshrrev_b32 v11, 16, v122
    v_and_b32 v12, 0xffff, v123
    v_lshrrev_b32 v13, 16, v123
    ds_add_rtn_u32 v10, v10, v4 offset:0
    ds_add_rtn_u32 v11, v11, v4 offset:0
    ds_add_rtn_u32 v12, v12, v4 offset:0
    ds_add_rtn_u32 v13, v13, v4 offset:0
    s_waitcnt lgkmcnt(4)
    v_perm_b32 v120, v7, v6, s43
    v_perm_b32 v121, v9, v8, s43
    v_and_b32 v6, 0xffff, v124
    v_lshrrev_b32 v7, 16, v124
    v_and_b32 v8, 0xffff, v125
    v_lshrrev_b32 v9, 16, v125
    ds_add_rtn_u32 v6, v6, v4 offset:0
    ds_add_rtn_u32 v7, v7, v4 offset:0
    ds_add_rtn_u32 v8, v8, v4 offset:0
    ds_add_rtn_u32 v9, v9, v4 offset:0
    s_waitcnt lgkmcnt(4)
    v_perm_b32 v122, v11, v10, s43
    v_perm_b32 v123, v13, v12, s43
    s_add_u32 s35, s34, 6291456
    buffer_load_dwordx2 v[106:107], v2, s[16:19], s35 offen nt
    v_and_b32 v10, 0xffff, v126
    v_lshrrev_b32 v11, 16, v126
    v_and_b32 v12, 0xffff, v51
    v_lshrrev_b32 v13, 16, v51
    ds_add_rtn_u32 v10, v10, v4 offset:0
    ds_add_rtn_u32 v11, v11, v4 offset:0
    ds_add_rtn_u32 v12, v12, v4 offset:0
    ds_add_rtn_u32 v13, v13, v4 offset:0
    s_waitcnt lgkmcnt(4)
    v_perm_b32 v124, v7, v6, s43
    v_perm_b32 v125, v9, v8, s43
    s_add_u32 s35, s34, 8388608
    buffer_load_dwordx2 v[108:109], v2, s[16:19], s35 offen nt
    v_and_b32 v6, 0xffff, v55
    v_lshrrev_b32 v7, 16, v55
    v_and_b32 v8, 0xffff, v59
    v_lshrrev_b32 v9, 16, v59
    ds_add_rtn_u32 v6, v6, v4 offset:0
    ds_add_rtn_u32 v7, v7, v4 offset:0
    ds_add_rtn_u32 v8, v8, v4 offset:0
    ds_add_rtn_u32 v9, v9, v4 offset:0
    s_waitcnt lgkmcnt(4)
    v_perm_b32 v126, v11, v10, s43
    v_perm_b32 v51, v13, v12, s43
    s_add_u32 s35, s34, 10485760
    buffer_load_dwordx2 v[110:111], v2, s[16:19], s35 offen nt
    v_and_b32 v10, 0xffff, v63
    v_lshrrev_b32 v11, 16, v63
    v_and_b32 v12, 0xffff, v67
    v_lshrrev_b32 v13, 16, v67
    ds_add_rtn_u32 v10, v10, v4 offset:0
    ds_add_rtn_u32 v11, v11, v4 offset:0
    ds_add_rtn_u32 v12, v12, v4 offset:0
    ds_add_rtn_u32 v13, v13, v4 offset:0
    s_waitcnt lgkmcnt(4)
    v_perm_b32 v55, v7, v6, s43
    v_perm_b32 v59, v9, v8, s43
    v_and_b32 v6, 0xffff, v71
    v_lshrrev_b32 v7, 16, v71
    v_and_b32 v8, 0xffff, v75
    v_lshrrev_b32 v9, 16, v75
    ds_add_rtn_u32 v6, v6, v4 offset:0
    ds_add_rtn_u32 v7, v7, v4 offset:0
    ds_add_rtn_u32 v8, v8, v4 offset:0
    ds_add_rtn_u32 v9, v9, v4 offset:0
    s_waitcnt lgkmcnt(4)
    v_perm_b32 v63, v11, v10, s43
    v_perm_b32 v67, v13, v12, s43
    s_add_u32 s35, s34, 12582912
    buffer_load_dwordx2 v[112:113], v2, s[16:19], s35 offen nt
    v_and_b32 v10, 0xffff, v79
    v_lshrrev_b32 v11, 16, v79
    v_and_b32 v12, 0xffff, v83
    v_lshrrev_b32 v13, 16, v83
    ds_add_rtn_u32 v10, v10, v4 offset:0
    ds_add_rtn_u32 v11, v11, v4 offset:0
    ds_add_rtn_u32 v12, v12, v4 offset:0
    ds_add_rtn_u32 v13, v13, v4 offset:0
    s_waitcnt lgkmcnt(4)
    v_perm_b32 v71, v7, v6, s43
    v_perm_b32 v75, v9, v8, s43
    s_add_u32 s35, s34, 14680064
    buffer_load_dwordx2 v[114:115], v2, s[16:19], s35 offen nt
    v_and_b32 v6, 0xffff, v87
    v_lshrrev_b32 v7, 16, v87
    v_and_b32 v8, 0xffff, v91
    v_lshrrev_b32 v9, 16, v91
    ds_add_rtn_u32 v6, v6, v4 offset:0
    ds_add_rtn_u32 v7, v7, v4 offset:0
    ds_add_rtn_u32 v8, v8, v4 offset:0
    ds_add_rtn_u32 v9, v9, v4 offset:0
    s_waitcnt lgkmcnt(4)
    v_perm_b32 v79, v11, v10, s43
    v_perm_b32 v83, v13, v12, s43
    s_add_u32 s35, s34, 16777216
    buffer_load_dwordx2 v[116:117], v2, s[16:19], s35 offen nt
    s_mov_b64 exec, s[44:45]
    v_and_b32 v10, 0xffff, v95
    v_lshrrev_b32 v11, 16, v95
    v_and_b32 v12, 0xffff, v99
    v_lshrrev_b32 v13, 16, v99
    ds_add_rtn_u32 v10, v10, v4 offset:0
    ds_add_rtn_u32 v11, v11, v4 offset:0
    ds_add_rtn_u32 v12, v12, v4 offset:0
    ds_add_rtn_u32 v13, v13, v4 offset:0
    s_mov_b64 exec, -1
    s_waitcnt lgkmcnt(4)
    v_perm_b32 v87, v7, v6, s43
    v_perm_b32 v91, v9, v8, s43
    s_add_u32 s35, s34, 18874368
    s_sub_u32 s35, s35, s49
    v_cndmask_b32 v118, 2.0, v2, s[44:45]
    buffer_load_dwordx2 v[118:119], v118, s[16:19], s35 offen nt
    s_waitcnt lgkmcnt(0)
    v_perm_b32 v95, v11, v10, s43
    v_perm_b32 v99, v13, v12, s43
    s_cmp_gt_u32 s39, 8
    s_cbranch_scc1 L_p1_kernel_notab_20
    v_lshrrev_b32 v6, 1, v0
    v_mul_u32_u24 v7, 1009, v6
    v_lshrrev_b32 v7, 16, v7
    v_mul_u32_u24 v7, 959, v7
    v_and_b32 v8, 1, v0
    v_lshl_add_u32 v7, v8, 9, v7
    v_add_lshl_u32 v13, v7, v6, 1
    ds_read_u16 v6, v13 offset:16384
    ds_read_u16 v7, v13 offset:16512
    ds_read_u16 v8, v13 offset:16640
    ds_read_u16 v9, v13 offset:16768
    ds_read_u16 v10, v13 offset:16896
    ds_read_u16 v11, v13 offset:17024
    ds_read_u16 v12, v13 offset:17152
    ds_read_u16 v13, v13 offset:17280
    s_mul_i32 s35, s32, 8320
    s_add_u32 s26, s35, 8320
    s_waitcnt lgkmcnt(6)
    v_perm_b32 v6, v7, v6, s43
    s_waitcnt lgkmcnt(4)
    v_perm_b32 v7, v9, v8, s43
    s_waitcnt lgkmcnt(2)
    v_perm_b32 v8, v11, v10, s43
    s_waitcnt lgkmcnt(0)
    v_perm_b32 v9, v13, v12, s43
    buffer_store_dwordx4 v[6:9], v1, s[24:27], s35 offen sc1
    s_nop 1
L_p1_kernel_notab_20:
    s_barrier
    s_lshl_b32 s35, s54, 2
    v_mov_b32 v6, s35
    v_mov_b32 v7, 0
    v_mov_b32 v12, 1140817920
    s_mov_b64 exec, 1
    ds_write2_b32 v6, v7, v7 offset0:0 offset1:1
    s_cmp_eq_u64 s[46:47], 0
    s_cbranch_scc1 L_p1_kernel_nonull_21
    s_mov_b64 exec, s[64:65]
    v_lshlrev_b32_sdwa v6, 2, v14 dst_sel:DWORD dst_unused:UNUSED_PAD src0_sel:DWORD src1_sel:WORD_0
    ds_write_b32 v6, v7 offset:4
    s_mov_b64 exec, s[56:57]
    ds_write_b32 v6, v7
    s_mov_b64 exec, s[66:67]
    v_lshlrev_b32_sdwa v6, 2, v14 dst_sel:DWORD dst_unused:UNUSED_PAD src0_sel:DWORD src1_sel:WORD_1
    ds_write_b32 v6, v7 offset:4
    s_mov_b64 exec, s[58:59]
    ds_write_b32 v6, v7
    s_mov_b64 exec, s[68:69]
    v_lshlrev_b32_sdwa v6, 2, v15 dst_sel:DWORD dst_unused:UNUSED_PAD src0_sel:DWORD src1_sel:WORD_0
    ds_write_b32 v6, v7 offset:4
    s_mov_b64 exec, s[60:61]
    ds_write_b32 v6, v7
    s_mov_b64 exec, s[70:71]
    v_lshlrev_b32_sdwa v6, 2, v15 dst_sel:DWORD dst_unused:UNUSED_PAD src0_sel:DWORD src1_sel:WORD_1
    ds_write_b32 v6, v7 offset:4
    s_mov_b64 exec, s[62:63]
    ds_write_b32 v6, v7
L_p1_kernel_nonull_21:
    s_mov_b64 exec, -1
    v_lshlrev_b32_sdwa v6, 2, v120 dst_sel:DWORD dst_unused:UNUSED_PAD src0_sel:DWORD src1_sel:WORD_0
    v_lshlrev_b32_sdwa v7, 2, v120 dst_sel:DWORD dst_unused:UNUSED_PAD src0_sel:DWORD src1_sel:WORD_1
    v_lshlrev_b32_sdwa v8, 2, v121 dst_sel:DWORD dst_unused:UNUSED_PAD src0_sel:DWORD src1_sel:WORD_0
    v_lshlrev_b32_sdwa v9, 2, v121 dst_sel:DWORD dst_unused:UNUSED_PAD src0_sel:DWORD src1_sel:WORD_1
    ds_write_b32 v6, v127
    ds_write_b32 v7, v48
    ds_write_b32 v8, v49
    ds_write_b32 v9, v50
    s_cmp_lg_u32 s40, 3
    s_cbranch_scc1 L_p1_kernel_ld_22
    s_add_u32 s36, s42, 4
    s_and_b32 s35, s36, 3
    s_mul_i32 s35, s35, 1047552
    s_lshl_b32 s36, s36, 20
    s_sub_u32 s36, s36, s35
    buffer_store_dwordx4 v[16:19], v3, s[72:75], s36 offen sc1
    s_branch L_p1_kernel_st_23
L_p1_kernel_ld_22:
    s_add_u32 s35, s33, 40960000
    buffer_load_dwordx4 v[16:19], v1, s[8:11], s35 offen nt
L_p1_kernel_st_23:
    v_lshlrev_b32_sdwa v6, 2, v122 dst_sel:DWORD dst_unused:UNUSED_PAD src0_sel:DWORD src1_sel:WORD_0
    v_lshlrev_b32_sdwa v7, 2, v122 dst_sel:DWORD dst_unused:UNUSED_PAD src0_sel:DWORD src1_sel:WORD_1
    v_lshlrev_b32_sdwa v8, 2, v123 dst_sel:DWORD dst_unused:UNUSED_PAD src0_sel:DWORD src1_sel:WORD_0
    v_lshlrev_b32_sdwa v9, 2, v123 dst_sel:DWORD dst_unused:UNUSED_PAD src0_sel:DWORD src1_sel:WORD_1
    ds_write_b32 v6, v52
    ds_write_b32 v7, v53
    ds_write_b32 v8, v54
    ds_write_b32 v9, v56
    v_lshlrev_b32_sdwa v6, 2, v124 dst_sel:DWORD dst_unused:UNUSED_PAD src0_sel:DWORD src1_sel:WORD_0
    v_lshlrev_b32_sdwa v7, 2, v124 dst_sel:DWORD dst_unused:UNUSED_PAD src0_sel:DWORD src1_sel:WORD_1
    v_lshlrev_b32_sdwa v8, 2, v125 dst_sel:DWORD dst_unused:UNUSED_PAD src0_sel:DWORD src1_sel:WORD_0
    v_lshlrev_b32_sdwa v9, 2, v125 dst_sel:DWORD dst_unused:UNUSED_PAD src0_sel:DWORD src1_sel:WORD_1
    ds_write_b32 v6, v57
    ds_write_b32 v7, v58
    ds_write_b32 v8, v60
    ds_write_b32 v9, v61
    v_lshlrev_b32_sdwa v6, 2, v126 dst_sel:DWORD dst_unused:UNUSED_PAD src0_sel:DWORD src1_sel:WORD_0
    v_lshlrev_b32_sdwa v7, 2, v126 dst_sel:DWORD dst_unused:UNUSED_PAD src0_sel:DWORD src1_sel:WORD_1
    v_lshlrev_b32_sdwa v8, 2, v51 dst_sel:DWORD dst_unused:UNUSED_PAD src0_sel:DWORD src1_sel:WORD_0
    v_lshlrev_b32_sdwa v9, 2, v51 dst_sel:DWORD dst_unused:UNUSED_PAD src0_sel:DWORD src1_sel:WORD_1
    ds_write_b32 v6, v62
    ds_write_b32 v7, v64
    ds_write_b32 v8, v65
    ds_write_b32 v9, v66
    s_cmp_lg_u32 s40, 3
    s_cbranch_scc1 L_p1_kernel_ld_24
    s_add_u32 s36, s42, 6
    s_and_b32 s35, s36, 3
    s_mul_i32 s35, s35, 1047552
    s_lshl_b32 s36, s36, 20
    s_sub_u32 s36, s36, s35
    buffer_store_dwordx4 v[20:23], v3, s[72:75], s36 offen sc1
    s_branch L_p1_kernel_st_25
L_p1_kernel_ld_24:
    s_add_u32 s35, s33, 40960000
    buffer_load_dwordx4 v[20:23], v1, s[12:15], s35 offen nt
L_p1_kernel_st_25:
    v_lshlrev_b32_sdwa v6, 2, v55 dst_sel:DWORD dst_unused:UNUSED_PAD src0_sel:DWORD src1_sel:WORD_0
    v_lshlrev_b32_sdwa v7, 2, v55 dst_sel:DWORD dst_unused:UNUSED_PAD src0_sel:DWORD src1_sel:WORD_1
    v_lshlrev_b32_sdwa v8, 2, v59 dst_sel:DWORD dst_unused:UNUSED_PAD src0_sel:DWORD src1_sel:WORD_0
    v_lshlrev_b32_sdwa v9, 2, v59 dst_sel:DWORD dst_unused:UNUSED_PAD src0_sel:DWORD src1_sel:WORD_1
    ds_write_b32 v6, v68
    ds_write_b32 v7, v69
    ds_write_b32 v8, v70
    ds_write_b32 v9, v72
    v_lshlrev_b32_sdwa v6, 2, v63 dst_sel:DWORD dst_unused:UNUSED_PAD src0_sel:DWORD src1_sel:WORD_0
    v_lshlrev_b32_sdwa v7, 2, v63 dst_sel:DWORD dst_unused:UNUSED_PAD src0_sel:DWORD src1_sel:WORD_1
    v_lshlrev_b32_sdwa v8, 2, v67 dst_sel:DWORD dst_unused:UNUSED_PAD src0_sel:DWORD src1_sel:WORD_0
    v_lshlrev_b32_sdwa v9, 2, v67 dst_sel:DWORD dst_unused:UNUSED_PAD src0_sel:DWORD src1_sel:WORD_1
    ds_write_b32 v6, v73
    ds_write_b32 v7, v74
    ds_write_b32 v8, v76
    ds_write_b32 v9, v77
    v_lshlrev_b32_sdwa v6, 2, v71 dst_sel:DWORD dst_unused:UNUSED_PAD src0_sel:DWORD src1_sel:WORD_0
    v_lshlrev_b32_sdwa v7, 2, v71 dst_sel:DWORD dst_unused:UNUSED_PAD src0_sel:DWORD src1_sel:WORD_1
    v_lshlrev_b32_sdwa v8, 2, v75 dst_sel:DWORD dst_unused:UNUSED_PAD src0_sel:DWORD src1_sel:WORD_0
    v_lshlrev_b32_sdwa v9, 2, v75 dst_sel:DWORD dst_unused:UNUSED_PAD src0_sel:DWORD src1_sel:WORD_1
    ds_write_b32 v6, v78
    ds_write_b32 v7, v80
    ds_write_b32 v8, v81
    ds_write_b32 v9, v82
    s_cmp_lg_u32 s40, 3
    s_cbranch_scc1 L_p1_kernel_ld_26
    s_add_u32 s36, s42, 7
    s_and_b32 s35, s36, 3
    s_mul_i32 s35, s35, 1047552
    s_lshl_b32 s36, s36, 20
    s_sub_u32 s36, s36, s35
    buffer_store_dwordx4 v[24:27], v3, s[72:75], s36 offen sc1
    s_branch L_p1_kernel_st_27
L_p1_kernel_ld_26:
    s_add_u32 s35, s33, 45154304
    buffer_load_dwordx4 v[24:27], v1, s[8:11], s35 offen nt
L_p1_kernel_st_27:
    v_lshlrev_b32_sdwa v6, 2, v79 dst_sel:DWORD dst_unused:UNUSED_PAD src0_sel:DWORD src1_sel:WORD_0
    v_lshlrev_b32_sdwa v7, 2, v79 dst_sel:DWORD dst_unused:UNUSED_PAD src0_sel:DWORD src1_sel:WORD_1
    v_lshlrev_b32_sdwa v8, 2, v83 dst_sel:DWORD dst_unused:UNUSED_PAD src0_sel:DWORD src1_sel:WORD_0
    v_lshlrev_b32_sdwa v9, 2, v83 dst_sel:DWORD dst_unused:UNUSED_PAD src0_sel:DWORD src1_sel:WORD_1
    ds_write_b32 v6, v84
    ds_write_b32 v7, v85
    ds_write_b32 v8, v86
    ds_write_b32 v9, v88
    v_lshlrev_b32_sdwa v6, 2, v87 dst_sel:DWORD dst_unused:UNUSED_PAD src0_sel:DWORD src1_sel:WORD_0
    v_lshlrev_b32_sdwa v7, 2, v87 dst_sel:DWORD dst_unused:UNUSED_PAD src0_sel:DWORD src1_sel:WORD_1
    v_lshlrev_b32_sdwa v8, 2, v91 dst_sel:DWORD dst_unused:UNUSED_PAD src0_sel:DWORD src1_sel:WORD_0
    v_lshlrev_b32_sdwa v9, 2, v91 dst_sel:DWORD dst_unused:UNUSED_PAD src0_sel:DWORD src1_sel:WORD_1
    ds_write_b32 v6, v89
    ds_write_b32 v7, v90
    ds_write_b32 v8, v92
    ds_write_b32 v9, v93
    s_mov_b64 exec, s[44:45]
    v_lshlrev_b32_sdwa v6, 2, v95 dst_sel:DWORD dst_unused:UNUSED_PAD src0_sel:DWORD src1_sel:WORD_0
    v_lshlrev_b32_sdwa v7, 2, v95 dst_sel:DWORD dst_unused:UNUSED_PAD src0_sel:DWORD src1_sel:WORD_1
    v_lshlrev_b32_sdwa v8, 2, v99 dst_sel:DWORD dst_unused:UNUSED_PAD src0_sel:DWORD src1_sel:WORD_0
    v_lshlrev_b32_sdwa v9, 2, v99 dst_sel:DWORD dst_unused:UNUSED_PAD src0_sel:DWORD src1_sel:WORD_1
    ds_write_b32 v6, v94
    ds_write_b32 v7, v96
    ds_write_b32 v8, v97
    ds_write_b32 v9, v98
    s_mov_b64 exec, -1
    s_cmp_lg_u32 s40, 3
    s_cbranch_scc1 L_p1_kernel_ld_28
    s_add_u32 s36, s42, 8
    s_and_b32 s35, s36, 3
    s_mul_i32 s35, s35, 1047552
    s_lshl_b32 s36, s36, 20
    s_sub_u32 s36, s36, s35
    buffer_store_dwordx4 v[28:31], v3, s[72:75], s36 offen sc1
    s_branch L_p1_kernel_st_29
L_p1_kernel_ld_28:
    s_add_u32 s35, s33, 45154304
    buffer_load_dwordx4 v[28:31], v1, s[12:15], s35 offen nt
L_p1_kernel_st_29:
    s_mul_i32 s35, s39, 9216
    v_mad_u32_u24 v6, v0, 12, s35
    s_waitcnt lgkmcnt(0)
    s_barrier
    s_cmp_lg_u32 s39, 15
    s_cbranch_scc1 L_p1_kernel_nox_30
    ds_read_b32 v12, v6 offset:9984
    ds_read_b32 v13, v6 offset:9988
    ds_read_b32 v14, v6 offset:9992
L_p1_kernel_nox_30:
    ds_read_b32 v48, v6 offset:1536
    ds_read_b32 v49, v6 offset:1540
    ds_read_b32 v50, v6 offset:1544
    ds_read_b32 v52, v6 offset:3072
    ds_read_b32 v53, v6 offset:3076
    ds_read_b32 v54, v6 offset:3080
    ds_read_b32 v56, v6 offset:4608
    ds_read_b32 v57, v6 offset:4612
    ds_read_b32 v58, v6 offset:4616
    ds_read_b32 v60, v6 offset:6144
    ds_read_b32 v61, v6 offset:6148
    ds_read_b32 v62, v6 offset:6152
    ds_read_b32 v64, v6 offset:7680
    ds_read_b32 v65, v6 offset:7684
    ds_read_b32 v66, v6 offset:7688
    ds_read_b32 v68, v6 offset:9216
    ds_read_b32 v69, v6 offset:9220
    ds_read_b32 v70, v6 offset:9224
    ds_read_b32 v72, v6 offset:0
    ds_read_b32 v73, v6 offset:4
    ds_read_b32 v74, v6 offset:8
    ds_read_b32 v76, v6 offset:768
    ds_read_b32 v77, v6 offset:772
    ds_read_b32 v78, v6 offset:776
    ds_read_b32 v80, v6 offset:2304
    ds_read_b32 v81, v6 offset:2308
    ds_read_b32 v82, v6 offset:2312
    ds_read_b32 v84, v6 offset:3840
    ds_read_b32 v85, v6 offset:3844
    ds_read_b32 v86, v6 offset:3848
    ds_read_b32 v88, v6 offset:5376
    ds_read_b32 v89, v6 offset:5380
    ds_read_b32 v90, v6 offset:5384
    ds_read_b32 v92, v6 offset:6912
    ds_read_b32 v93, v6 offset:6916
    ds_read_b32 v94, v6 offset:6920
    ds_read_b32 v96, v6 offset:8448
    ds_read_b32 v97, v6 offset:8452
    ds_read_b32 v98, v6 offset:8456
    s_cmp_lg_u32 s40, 3
    s_cbranch_scc1 L_p1_kernel_ld_31
    s_add_u32 s36, s42, 9
    s_and_b32 s35, s36, 3
    s_mul_i32 s35, s35, 1047552
    s_lshl_b32 s36, s36, 20
    s_sub_u32 s36, s36, s35
    buffer_store_dwordx4 v[32:35], v3, s[72:75], s36 offen sc1
    s_branch L_p1_kernel_st_32
L_p1_kernel_ld_31:
    s_add_u32 s35, s33, 49348608
    buffer_load_dwordx4 v[32:35], v1, s[8:11], s35 offen nt
L_p1_kernel_st_32:
    v_mov_b32 v8, 0
    v_mov_b32 v9, 0
    v_mov_b32 v10, 0
    v_mov_b32 v11, 0
    v_mov_b32 v15, 16384
    v_min_u32 v7, 16, v0
    v_lshlrev_b32 v7, 2, v7
    v_add_u32 v7, 160768, v7
    s_waitcnt lgkmcnt(0)
    s_barrier
    ds_write_b128 v1, v[8:11] offset:0
    ds_write_b32 v7, v8
    s_nop 1
    v_mov_b32 v6, 1140817920
    s_waitcnt vmcnt(14)
    v_pk_maximum3_f16 v5, v100, v101, v5
    v_mad_u32_u16 v6, v120, s50, v15 op_sel:[0,0,0,0]
    v_mad_u32_u16 v7, v120, s50, v15 op_sel:[1,0,0,0]
    v_mad_u32_u16 v8, v121, s50, v15 op_sel:[0,0,0,0]
    v_mad_u32_u16 v9, v121, s50, v15 op_sel:[1,0,0,0]
    v_add_u32_sdwa v6, v6, v120 dst_sel:DWORD dst_unused:UNUSED_PAD src0_sel:WORD_1 src1_sel:WORD_0
    v_add_u32_sdwa v7, v7, v120 dst_sel:DWORD dst_unused:UNUSED_PAD src0_sel:WORD_1 src1_sel:WORD_1
    v_add_u32_sdwa v8, v8, v121 dst_sel:DWORD dst_unused:UNUSED_PAD src0_sel:WORD_1 src1_sel:WORD_0
    v_add_u32_sdwa v9, v9, v121 dst_sel:DWORD dst_unused:UNUSED_PAD src0_sel:WORD_1 src1_sel:WORD_1
    v_add_u32 v6, v6, v6
    v_add_u32 v7, v7, v7
    v_add_u32 v8, v8, v8
    v_add_u32 v9, v9, v9
    ds_write_b16 v6, v100 offset:16384
    ds_write_b16_d16_hi v7, v100 offset:16384
    ds_write_b16 v8, v101 offset:16384
    ds_write_b16_d16_hi v9, v101 offset:16384
    v_mov_b32 v6, 1140817920
    s_waitcnt vmcnt(13)
    v_pk_maximum3_f16 v5, v102, v103, v5
    v_mad_u32_u16 v6, v122, s50, v15 op_sel:[0,0,0,0]
    v_mad_u32_u16 v7, v122, s50, v15 op_sel:[1,0,0,0]
    v_mad_u32_u16 v8, v123, s50, v15 op_sel:[0,0,0,0]
    v_mad_u32_u16 v9, v123, s50, v15 op_sel:[1,0,0,0]
    v_add_u32_sdwa v6, v6, v122 dst_sel:DWORD dst_unused:UNUSED_PAD src0_sel:WORD_1 src1_sel:WORD_0
    v_add_u32_sdwa v7, v7, v122 dst_sel:DWORD dst_unused:UNUSED_PAD src0_sel:WORD_1 src1_sel:WORD_1
    v_add_u32_sdwa v8, v8, v123 dst_sel:DWORD dst_unused:UNUSED_PAD src0_sel:WORD_1 src1_sel:WORD_0
    v_add_u32_sdwa v9, v9, v123 dst_sel:DWORD dst_unused:UNUSED_PAD src0_sel:WORD_1 src1_sel:WORD_1
    v_add_u32 v6, v6, v6
    v_add_u32 v7, v7, v7
    v_add_u32 v8, v8, v8
    v_add_u32 v9, v9, v9
    ds_write_b16 v6, v102 offset:16384
    ds_write_b16_d16_hi v7, v102 offset:16384
    ds_write_b16 v8, v103 offset:16384
    ds_write_b16_d16_hi v9, v103 offset:16384
    v_mov_b32 v6, 1140817920
    s_waitcnt vmcnt(12)
    v_pk_maximum3_f16 v5, v104, v105, v5
    v_mad_u32_u16 v6, v124, s50, v15 op_sel:[0,0,0,0]
    v_mad_u32_u16 v7, v124, s50, v15 op_sel:[1,0,0,0]
    v_mad_u32_u16 v8, v125, s50, v15 op_sel:[0,0,0,0]
    v_mad_u32_u16 v9, v125, s50, v15 op_sel:[1,0,0,0]
    v_add_u32_sdwa v6, v6, v124 dst_sel:DWORD dst_unused:UNUSED_PAD src0_sel:WORD_1 src1_sel:WORD_0
    v_add_u32_sdwa v7, v7, v124 dst_sel:DWORD dst_unused:UNUSED_PAD src0_sel:WORD_1 src1_sel:WORD_1
    v_add_u32_sdwa v8, v8, v125 dst_sel:DWORD dst_unused:UNUSED_PAD src0_sel:WORD_1 src1_sel:WORD_0
    v_add_u32_sdwa v9, v9, v125 dst_sel:DWORD dst_unused:UNUSED_PAD src0_sel:WORD_1 src1_sel:WORD_1
    v_add_u32 v6, v6, v6
    v_add_u32 v7, v7, v7
    v_add_u32 v8, v8, v8
    v_add_u32 v9, v9, v9
    ds_write_b16 v6, v104 offset:16384
    ds_write_b16_d16_hi v7, v104 offset:16384
    ds_write_b16 v8, v105 offset:16384
    ds_write_b16_d16_hi v9, v105 offset:16384
    s_cmp_lg_u32 s40, 3
    s_cbranch_scc1 L_p1_kernel_ld_33
    s_add_u32 s36, s42, 10
    s_and_b32 s35, s36, 3
    s_mul_i32 s35, s35, 1047552
    s_lshl_b32 s36, s36, 20
    s_sub_u32 s36, s36, s35
    buffer_store_dwordx4 v[36:39], v3, s[72:75], s36 offen sc1
    s_branch L_p1_kernel_st_34
L_p1_kernel_ld_33:
    s_add_u32 s35, s33, 49348608
    buffer_load_dwordx4 v[36:39], v1, s[12:15], s35 offen nt
L_p1_kernel_st_34:
    v_mov_b32 v6, 1140817920
    s_waitcnt vmcnt(12)
    v_pk_maximum3_f16 v5, v106, v107, v5
    v_mad_u32_u16 v6, v126, s50, v15 op_sel:[0,0,0,0]
    v_mad_u32_u16 v7, v126, s50, v15 op_sel:[1,0,0,0]
    v_mad_u32_u16 v8, v51, s50, v15 op_sel:[0,0,0,0]
    v_mad_u32_u16 v9, v51, s50, v15 op_sel:[1,0,0,0]
    v_add_u32_sdwa v6, v6, v126 dst_sel:DWORD dst_unused:UNUSED_PAD src0_sel:WORD_1 src1_sel:WORD_0
    v_add_u32_sdwa v7, v7, v126 dst_sel:DWORD dst_unused:UNUSED_PAD src0_sel:WORD_1 src1_sel:WORD_1
    v_add_u32_sdwa v8, v8, v51 dst_sel:DWORD dst_unused:UNUSED_PAD src0_sel:WORD_1 src1_sel:WORD_0
    v_add_u32_sdwa v9, v9, v51 dst_sel:DWORD dst_unused:UNUSED_PAD src0_sel:WORD_1 src1_sel:WORD_1
    v_add_u32 v6, v6, v6
    v_add_u32 v7, v7, v7
    v_add_u32 v8, v8, v8
    v_add_u32 v9, v9, v9
    ds_write_b16 v6, v106 offset:16384
    ds_write_b16_d16_hi v7, v106 offset:16384
    ds_write_b16 v8, v107 offset:16384
    ds_write_b16_d16_hi v9, v107 offset:16384
    v_mov_b32 v6, 1140817920
    s_waitcnt vmcnt(11)
    v_pk_maximum3_f16 v5, v108, v109, v5
    v_mad_u32_u16 v6, v55, s50, v15 op_sel:[0,0,0,0]
    v_mad_u32_u16 v7, v55, s50, v15 op_sel:[1,0,0,0]
    v_mad_u32_u16 v8, v59, s50, v15 op_sel:[0,0,0,0]
    v_mad_u32_u16 v9, v59, s50, v15 op_sel:[1,0,0,0]
    v_add_u32_sdwa v6, v6, v55 dst_sel:DWORD dst_unused:UNUSED_PAD src0_sel:WORD_1 src1_sel:WORD_0
    v_add_u32_sdwa v7, v7, v55 dst_sel:DWORD dst_unused:UNUSED_PAD src0_sel:WORD_1 src1_sel:WORD_1
    v_add_u32_sdwa v8, v8, v59 dst_sel:DWORD dst_unused:UNUSED_PAD src0_sel:WORD_1 src1_sel:WORD_0
    v_add_u32_sdwa v9, v9, v59 dst_sel:DWORD dst_unused:UNUSED_PAD src0_sel:WORD_1 src1_sel:WORD_1
    v_add_u32 v6, v6, v6
    v_add_u32 v7, v7, v7
    v_add_u32 v8, v8, v8
    v_add_u32 v9, v9, v9
    ds_write_b16 v6, v108 offset:16384
    ds_write_b16_d16_hi v7, v108 offset:16384
    ds_write_b16 v8, v109 offset:16384
    ds_write_b16_d16_hi v9, v109 offset:16384
    v_mov_b32 v6, 1140817920
    s_waitcnt vmcnt(10)
    v_pk_maximum3_f16 v5, v110, v111, v5
    v_mad_u32_u16 v6, v63, s50, v15 op_sel:[0,0,0,0]
    v_mad_u32_u16 v7, v63, s50, v15 op_sel:[1,0,0,0]
    v_mad_u32_u16 v8, v67, s50, v15 op_sel:[0,0,0,0]
    v_mad_u32_u16 v9, v67, s50, v15 op_sel:[1,0,0,0]
    v_add_u32_sdwa v6, v6, v63 dst_sel:DWORD dst_unused:UNUSED_PAD src0_sel:WORD_1 src1_sel:WORD_0
    v_add_u32_sdwa v7, v7, v63 dst_sel:DWORD dst_unused:UNUSED_PAD src0_sel:WORD_1 src1_sel:WORD_1
    v_add_u32_sdwa v8, v8, v67 dst_sel:DWORD dst_unused:UNUSED_PAD src0_sel:WORD_1 src1_sel:WORD_0
    v_add_u32_sdwa v9, v9, v67 dst_sel:DWORD dst_unused:UNUSED_PAD src0_sel:WORD_1 src1_sel:WORD_1
    v_add_u32 v6, v6, v6
    v_add_u32 v7, v7, v7
    v_add_u32 v8, v8, v8
    v_add_u32 v9, v9, v9
    ds_write_b16 v6, v110 offset:16384
    ds_write_b16_d16_hi v7, v110 offset:16384
    ds_write_b16 v8, v111 offset:16384
    ds_write_b16_d16_hi v9, v111 offset:16384
    s_cmp_lg_u32 s40, 3
    s_cbranch_scc1 L_p1_kernel_ld_35
    s_add_u32 s36, s42, 11
    s_and_b32 s35, s36, 3
    s_mul_i32 s35, s35, 1047552
    s_lshl_b32 s36, s36, 20
    s_sub_u32 s36, s36, s35
    buffer_store_dwordx4 v[40:43], v3, s[72:75], s36 offen sc1
    s_branch L_p1_kernel_st_36
L_p1_kernel_ld_35:
    s_add_u32 s35, s33, 53542912
    buffer_load_dwordx4 v[40:43], v1, s[8:11], s35 offen nt
L_p1_kernel_st_36:
    v_mov_b32 v6, 1140817920
    s_waitcnt vmcnt(10)
    v_pk_maximum3_f16 v5, v112, v113, v5
    v_mad_u32_u16 v6, v71, s50, v15 op_sel:[0,0,0,0]
    v_mad_u32_u16 v7, v71, s50, v15 op_sel:[1,0,0,0]
    v_mad_u32_u16 v8, v75, s50, v15 op_sel:[0,0,0,0]
    v_mad_u32_u16 v9, v75, s50, v15 op_sel:[1,0,0,0]
    v_add_u32_sdwa v6, v6, v71 dst_sel:DWORD dst_unused:UNUSED_PAD src0_sel:WORD_1 src1_sel:WORD_0
    v_add_u32_sdwa v7, v7, v71 dst_sel:DWORD dst_unused:UNUSED_PAD src0_sel:WORD_1 src1_sel:WORD_1
    v_add_u32_sdwa v8, v8, v75 dst_sel:DWORD dst_unused:UNUSED_PAD src0_sel:WORD_1 src1_sel:WORD_0
    v_add_u32_sdwa v9, v9, v75 dst_sel:DWORD dst_unused:UNUSED_PAD src0_sel:WORD_1 src1_sel:WORD_1
    v_add_u32 v6, v6, v6
    v_add_u32 v7, v7, v7
    v_add_u32 v8, v8, v8
    v_add_u32 v9, v9, v9
    ds_write_b16 v6, v112 offset:16384
    ds_write_b16_d16_hi v7, v112 offset:16384
    ds_write_b16 v8, v113 offset:16384
    ds_write_b16_d16_hi v9, v113 offset:16384
    v_mov_b32 v6, 1140817920
    s_waitcnt vmcnt(9)
    v_pk_maximum3_f16 v5, v114, v115, v5
    v_mad_u32_u16 v6, v79, s50, v15 op_sel:[0,0,0,0]
    v_mad_u32_u16 v7, v79, s50, v15 op_sel:[1,0,0,0]
    v_mad_u32_u16 v8, v83, s50, v15 op_sel:[0,0,0,0]
    v_mad_u32_u16 v9, v83, s50, v15 op_sel:[1,0,0,0]
    v_add_u32_sdwa v6, v6, v79 dst_sel:DWORD dst_unused:UNUSED_PAD src0_sel:WORD_1 src1_sel:WORD_0
    v_add_u32_sdwa v7, v7, v79 dst_sel:DWORD dst_unused:UNUSED_PAD src0_sel:WORD_1 src1_sel:WORD_1
    v_add_u32_sdwa v8, v8, v83 dst_sel:DWORD dst_unused:UNUSED_PAD src0_sel:WORD_1 src1_sel:WORD_0
    v_add_u32_sdwa v9, v9, v83 dst_sel:DWORD dst_unused:UNUSED_PAD src0_sel:WORD_1 src1_sel:WORD_1
    v_add_u32 v6, v6, v6
    v_add_u32 v7, v7, v7
    v_add_u32 v8, v8, v8
    v_add_u32 v9, v9, v9
    ds_write_b16 v6, v114 offset:16384
    ds_write_b16_d16_hi v7, v114 offset:16384
    ds_write_b16 v8, v115 offset:16384
    ds_write_b16_d16_hi v9, v115 offset:16384
    v_mov_b32 v6, 1140817920
    s_waitcnt vmcnt(8)
    v_pk_maximum3_f16 v5, v116, v117, v5
    v_mad_u32_u16 v6, v87, s50, v15 op_sel:[0,0,0,0]
    v_mad_u32_u16 v7, v87, s50, v15 op_sel:[1,0,0,0]
    v_mad_u32_u16 v8, v91, s50, v15 op_sel:[0,0,0,0]
    v_mad_u32_u16 v9, v91, s50, v15 op_sel:[1,0,0,0]
    v_add_u32_sdwa v6, v6, v87 dst_sel:DWORD dst_unused:UNUSED_PAD src0_sel:WORD_1 src1_sel:WORD_0
    v_add_u32_sdwa v7, v7, v87 dst_sel:DWORD dst_unused:UNUSED_PAD src0_sel:WORD_1 src1_sel:WORD_1
    v_add_u32_sdwa v8, v8, v91 dst_sel:DWORD dst_unused:UNUSED_PAD src0_sel:WORD_1 src1_sel:WORD_0
    v_add_u32_sdwa v9, v9, v91 dst_sel:DWORD dst_unused:UNUSED_PAD src0_sel:WORD_1 src1_sel:WORD_1
    v_add_u32 v6, v6, v6
    v_add_u32 v7, v7, v7
    v_add_u32 v8, v8, v8
    v_add_u32 v9, v9, v9
    ds_write_b16 v6, v116 offset:16384
    ds_write_b16_d16_hi v7, v116 offset:16384
    ds_write_b16 v8, v117 offset:16384
    ds_write_b16_d16_hi v9, v117 offset:16384
    s_cmp_lg_u32 s40, 3
    s_cbranch_scc1 L_p1_kernel_ld_37
    s_add_u32 s36, s42, 12
    s_and_b32 s35, s36, 3
    s_mul_i32 s35, s35, 1047552
    s_lshl_b32 s36, s36, 20
    s_sub_u32 s36, s36, s35
    buffer_store_dwordx4 v[44:47], v3, s[72:75], s36 offen sc1
    s_branch L_p1_kernel_st_38
L_p1_kernel_ld_37:
    s_add_u32 s35, s33, 53542912
    buffer_load_dwordx4 v[44:47], v1, s[12:15], s35 offen nt
L_p1_kernel_st_38:
    v_mov_b32 v6, 1140817920
    s_mov_b64 exec, s[44:45]
    s_waitcnt vmcnt(8)
    v_pk_maximum3_f16 v5, v118, v119, v5
    s_mov_b64 exec, -1
    s_mov_b64 exec, s[44:45]
    v_mad_u32_u16 v6, v95, s50, v15 op_sel:[0,0,0,0]
    v_mad_u32_u16 v7, v95, s50, v15 op_sel:[1,0,0,0]
    v_mad_u32_u16 v8, v99, s50, v15 op_sel:[0,0,0,0]
    v_mad_u32_u16 v9, v99, s50, v15 op_sel:[1,0,0,0]
    v_add_u32_sdwa v6, v6, v95 dst_sel:DWORD dst_unused:UNUSED_PAD src0_sel:WORD_1 src1_sel:WORD_0
    v_add_u32_sdwa v7, v7, v95 dst_sel:DWORD dst_unused:UNUSED_PAD src0_sel:WORD_1 src1_sel:WORD_1
    v_add_u32_sdwa v8, v8, v99 dst_sel:DWORD dst_unused:UNUSED_PAD src0_sel:WORD_1 src1_sel:WORD_0
    v_add_u32_sdwa v9, v9, v99 dst_sel:DWORD dst_unused:UNUSED_PAD src0_sel:WORD_1 src1_sel:WORD_1
    v_add_u32 v6, v6, v6
    v_add_u32 v7, v7, v7
    v_add_u32 v8, v8, v8
    v_add_u32 v9, v9, v9
    ds_write_b16 v6, v118 offset:16384
    ds_write_b16_d16_hi v7, v118 offset:16384
    ds_write_b16 v8, v119 offset:16384
    ds_write_b16_d16_hi v9, v119 offset:16384
    s_mov_b64 exec, -1
    s_mul_i32 s35, s39, 6144
    v_add_u32 v6, s35, v2
    v_mov_b32 v10, 1140817920
    s_waitcnt lgkmcnt(0)
    s_barrier
    ds_read_b64 v[120:121], v6 offset:23040
    ds_read_b64 v[122:123], v6 offset:16384
    ds_read_b64 v[124:125], v6 offset:16896
    ds_read_b64 v[126:127], v6 offset:17408
    ds_read_b64 v[100:101], v6 offset:17920
    ds_read_b64 v[102:103], v6 offset:18432
    ds_read_b64 v[104:105], v6 offset:18944
    ds_read_b64 v[106:107], v6 offset:19456
    ds_read_b64 v[108:109], v6 offset:19968
    ds_read_b64 v[110:111], v6 offset:20480
    ds_read_b64 v[112:113], v6 offset:20992
    ds_read_b64 v[114:115], v6 offset:21504
    ds_read_b64 v[116:117], v6 offset:22016
    ds_read_b64 v[118:119], v6 offset:22528
    s_add_u32 s33, s33, 40960000
    s_add_u32 s34, s34, 20480000
    s_add_u32 s40, s40, 1
    s_cmp_lt_u32 s40, 4
    s_cbranch_scc1 L_p1_loop
    s_cmp_lg_u32 s39, 15
    s_cbranch_scc1 L_p1_kernel_nox_39
    s_waitcnt lgkmcnt(13)
    v_lshlrev_b32 v15, 16, v120
    v_and_b32 v120, 0xffff0000, v120
    v_lshlrev_b32 v121, 16, v121
    v_mul_f32 v15, s41, v15
    v_mul_f32 v120, s41, v120
    v_mul_f32 v121, s41, v121
    v_fract_f32 v15, v15
    v_fract_f32 v120, v120
    v_fract_f32 v121, v121
    v_cos_f32 v15, v15
    v_cos_f32 v120, v120
    v_cos_f32 v121, v121
    v_fmaak_f32 v15, v10, v15, 1262486016
    v_fmaak_f32 v120, v10, v120, 1262486016
    v_fmaak_f32 v121, v10, v121, 1262486016
    v_lshlrev_b32 v15, 22, v15
    v_alignbit_b32 v15, v120, v15, 10
    v_alignbit_b32 v15, v121, v15, 10
    v_xor_b32 v15, 0x80200800, v15
    s_add_u32 s36, s42, 13
    s_and_b32 s35, s36, 3
    s_mul_i32 s35, s35, 1047552
    s_lshl_b32 s36, s36, 20
    s_sub_u32 s36, s36, s35
    buffer_store_dwordx4 v[12:15], v3, s[20:23], s36 offen sc1
L_p1_kernel_nox_39:
    s_waitcnt lgkmcnt(12)
    v_lshlrev_b32 v75, 16, v122
    v_and_b32 v122, 0xffff0000, v122
    v_lshlrev_b32 v123, 16, v123
    v_mul_f32 v75, s41, v75
    v_mul_f32 v122, s41, v122
    v_mul_f32 v123, s41, v123
    v_fract_f32 v75, v75
    v_fract_f32 v122, v122
    v_fract_f32 v123, v123
    v_cos_f32 v75, v75
    v_cos_f32 v122, v122
    v_cos_f32 v123, v123
    v_fmaak_f32 v75, v10, v75, 1262486016
    v_fmaak_f32 v122, v10, v122, 1262486016
    v_fmaak_f32 v123, v10, v123, 1262486016
    v_lshlrev_b32 v75, 22, v75
    v_alignbit_b32 v75, v122, v75, 10
    v_alignbit_b32 v75, v123, v75, 10
    v_xor_b32 v75, 0x80200800, v75
    s_add_u32 s36, s42, 0
    s_and_b32 s35, s36, 3
    s_mul_i32 s35, s35, 1047552
    s_lshl_b32 s36, s36, 20
    s_sub_u32 s36, s36, s35
    buffer_store_dwordx4 v[72:75], v3, s[20:23], s36 offen sc1
    s_waitcnt lgkmcnt(11)
    v_lshlrev_b32 v79, 16, v124
    v_and_b32 v124, 0xffff0000, v124
    v_lshlrev_b32 v125, 16, v125
    v_mul_f32 v79, s41, v79
    v_mul_f32 v124, s41, v124
    v_mul_f32 v125, s41, v125
    v_fract_f32 v79, v79
    v_fract_f32 v124, v124
    v_fract_f32 v125, v125
    v_cos_f32 v79, v79
    v_cos_f32 v124, v124
    v_cos_f32 v125, v125
    v_fmaak_f32 v79, v10, v79, 1262486016
    v_fmaak_f32 v124, v10, v124, 1262486016
    v_fmaak_f32 v125, v10, v125, 1262486016
    v_lshlrev_b32 v79, 22, v79
    v_alignbit_b32 v79, v124, v79, 10
    v_alignbit_b32 v79, v125, v79, 10
    v_xor_b32 v79, 0x80200800, v79
    s_add_u32 s36, s42, 1
    s_and_b32 s35, s36, 3
    s_mul_i32 s35, s35, 1047552
    s_lshl_b32 s36, s36, 20
    s_sub_u32 s36, s36, s35
    buffer_store_dwordx4 v[76:79], v3, s[20:23], s36 offen sc1
    s_waitcnt lgkmcnt(0)
    v_lshlrev_b32 v51, 16, v126
    v_and_b32 v126, 0xffff0000, v126
    v_lshlrev_b32 v127, 16, v127
    v_mul_f32 v51, s41, v51
    v_mul_f32 v126, s41, v126
    v_mul_f32 v127, s41, v127
    v_fract_f32 v51, v51
    v_fract_f32 v126, v126
    v_fract_f32 v127, v127
    v_cos_f32 v51, v51
    v_cos_f32 v126, v126
    v_cos_f32 v127, v127
    v_fmaak_f32 v51, v10, v51, 1262486016
    v_fmaak_f32 v126, v10, v126, 1262486016
    v_fmaak_f32 v127, v10, v127, 1262486016
    v_lshlrev_b32 v51, 22, v51
    v_alignbit_b32 v51, v126, v51, 10
    v_alignbit_b32 v51, v127, v51, 10
    v_xor_b32 v51, 0x80200800, v51
    s_add_u32 s36, s42, 2
    s_and_b32 s35, s36, 3
    s_mul_i32 s35, s35, 1047552
    s_lshl_b32 s36, s36, 20
    s_sub_u32 s36, s36, s35
    buffer_store_dwordx4 v[48:51], v3, s[20:23], s36 offen sc1
    v_lshlrev_b32 v83, 16, v100
    v_and_b32 v100, 0xffff0000, v100
    v_lshlrev_b32 v101, 16, v101
    v_mul_f32 v83, s41, v83
    v_mul_f32 v100, s41, v100
    v_mul_f32 v101, s41, v101
    v_fract_f32 v83, v83
    v_fract_f32 v100, v100
    v_fract_f32 v101, v101
    v_cos_f32 v83, v83
    v_cos_f32 v100, v100
    v_cos_f32 v101, v101
    v_fmaak_f32 v83, v10, v83, 1262486016
    v_fmaak_f32 v100, v10, v100, 1262486016
    v_fmaak_f32 v101, v10, v101, 1262486016
    v_lshlrev_b32 v83, 22, v83
    v_alignbit_b32 v83, v100, v83, 10
    v_alignbit_b32 v83, v101, v83, 10
    v_xor_b32 v83, 0x80200800, v83
    s_add_u32 s36, s42, 3
    s_and_b32 s35, s36, 3
    s_mul_i32 s35, s35, 1047552
    s_lshl_b32 s36, s36, 20
    s_sub_u32 s36, s36, s35
    buffer_store_dwordx4 v[80:83], v3, s[20:23], s36 offen sc1
    v_lshlrev_b32 v55, 16, v102
    v_and_b32 v102, 0xffff0000, v102
    v_lshlrev_b32 v103, 16, v103
    v_mul_f32 v55, s41, v55
    v_mul_f32 v102, s41, v102
    v_mul_f32 v103, s41, v103
    v_fract_f32 v55, v55
    v_fract_f32 v102, v102
    v_fract_f32 v103, v103
    v_cos_f32 v55, v55
    v_cos_f32 v102, v102
    v_cos_f32 v103, v103
    v_fmaak_f32 v55, v10, v55, 1262486016
    v_fmaak_f32 v102, v10, v102, 1262486016
    v_fmaak_f32 v103, v10, v103, 1262486016
    v_lshlrev_b32 v55, 22, v55
    v_alignbit_b32 v55, v102, v55, 10
    v_alignbit_b32 v55, v103, v55, 10
    v_xor_b32 v55, 0x80200800, v55
    s_add_u32 s36, s42, 4
    s_and_b32 s35, s36, 3
    s_mul_i32 s35, s35, 1047552
    s_lshl_b32 s36, s36, 20
    s_sub_u32 s36, s36, s35
    buffer_store_dwordx4 v[52:55], v3, s[20:23], s36 offen sc1
    v_lshlrev_b32 v87, 16, v104
    v_and_b32 v104, 0xffff0000, v104
    v_lshlrev_b32 v105, 16, v105
    v_mul_f32 v87, s41, v87
    v_mul_f32 v104, s41, v104
    v_mul_f32 v105, s41, v105
    v_fract_f32 v87, v87
    v_fract_f32 v104, v104
    v_fract_f32 v105, v105
    v_cos_f32 v87, v87
    v_cos_f32 v104, v104
    v_cos_f32 v105, v105
    v_fmaak_f32 v87, v10, v87, 1262486016
    v_fmaak_f32 v104, v10, v104, 1262486016
    v_fmaak_f32 v105, v10, v105, 1262486016
    v_lshlrev_b32 v87, 22, v87
    v_alignbit_b32 v87, v104, v87, 10
    v_alignbit_b32 v87, v105, v87, 10
    v_xor_b32 v87, 0x80200800, v87
    s_add_u32 s36, s42, 5
    s_and_b32 s35, s36, 3
    s_mul_i32 s35, s35, 1047552
    s_lshl_b32 s36, s36, 20
    s_sub_u32 s36, s36, s35
    buffer_store_dwordx4 v[84:87], v3, s[20:23], s36 offen sc1
    v_lshlrev_b32 v59, 16, v106
    v_and_b32 v106, 0xffff0000, v106
    v_lshlrev_b32 v107, 16, v107
    v_mul_f32 v59, s41, v59
    v_mul_f32 v106, s41, v106
    v_mul_f32 v107, s41, v107
    v_fract_f32 v59, v59
    v_fract_f32 v106, v106
    v_fract_f32 v107, v107
    v_cos_f32 v59, v59
    v_cos_f32 v106, v106
    v_cos_f32 v107, v107
    v_fmaak_f32 v59, v10, v59, 1262486016
    v_fmaak_f32 v106, v10, v106, 1262486016
    v_fmaak_f32 v107, v10, v107, 1262486016
    v_lshlrev_b32 v59, 22, v59
    v_alignbit_b32 v59, v106, v59, 10
    v_alignbit_b32 v59, v107, v59, 10
    v_xor_b32 v59, 0x80200800, v59
    s_add_u32 s36, s42, 6
    s_and_b32 s35, s36, 3
    s_mul_i32 s35, s35, 1047552
    s_lshl_b32 s36, s36, 20
    s_sub_u32 s36, s36, s35
    buffer_store_dwordx4 v[56:59], v3, s[20:23], s36 offen sc1
    v_lshlrev_b32 v91, 16, v108
    v_and_b32 v108, 0xffff0000, v108
    v_lshlrev_b32 v109, 16, v109
    v_mul_f32 v91, s41, v91
    v_mul_f32 v108, s41, v108
    v_mul_f32 v109, s41, v109
    v_fract_f32 v91, v91
    v_fract_f32 v108, v108
    v_fract_f32 v109, v109
    v_cos_f32 v91, v91
    v_cos_f32 v108, v108
    v_cos_f32 v109, v109
    v_fmaak_f32 v91, v10, v91, 1262486016
    v_fmaak_f32 v108, v10, v108, 1262486016
    v_fmaak_f32 v109, v10, v109, 1262486016
    v_lshlrev_b32 v91, 22, v91
    v_alignbit_b32 v91, v108, v91, 10
    v_alignbit_b32 v91, v109, v91, 10
    v_xor_b32 v91, 0x80200800, v91
    s_add_u32 s36, s42, 7
    s_and_b32 s35, s36, 3
    s_mul_i32 s35, s35, 1047552
    s_lshl_b32 s36, s36, 20
    s_sub_u32 s36, s36, s35
    buffer_store_dwordx4 v[88:91], v3, s[20:23], s36 offen sc1
    v_lshlrev_b32 v63, 16, v110
    v_and_b32 v110, 0xffff0000, v110
    v_lshlrev_b32 v111, 16, v111
    v_mul_f32 v63, s41, v63
    v_mul_f32 v110, s41, v110
    v_mul_f32 v111, s41, v111
    v_fract_f32 v63, v63
    v_fract_f32 v110, v110
    v_fract_f32 v111, v111
    v_cos_f32 v63, v63
    v_cos_f32 v110, v110
    v_cos_f32 v111, v111
    v_fmaak_f32 v63, v10, v63, 1262486016
    v_fmaak_f32 v110, v10, v110, 1262486016
    v_fmaak_f32 v111, v10, v111, 1262486016
    v_lshlrev_b32 v63, 22, v63
    v_alignbit_b32 v63, v110, v63, 10
    v_alignbit_b32 v63, v111, v63, 10
    v_xor_b32 v63, 0x80200800, v63
    s_add_u32 s36, s42, 8
    s_and_b32 s35, s36, 3
    s_mul_i32 s35, s35, 1047552
    s_lshl_b32 s36, s36, 20
    s_sub_u32 s36, s36, s35
    buffer_store_dwordx4 v[60:63], v3, s[20:23], s36 offen sc1
    v_lshlrev_b32 v95, 16, v112
    v_and_b32 v112, 0xffff0000, v112
    v_lshlrev_b32 v113, 16, v113
    v_mul_f32 v95, s41, v95
    v_mul_f32 v112, s41, v112
    v_mul_f32 v113, s41, v113
    v_fract_f32 v95, v95
    v_fract_f32 v112, v112
    v_fract_f32 v113, v113
    v_cos_f32 v95, v95
    v_cos_f32 v112, v112
    v_cos_f32 v113, v113
    v_fmaak_f32 v95, v10, v95, 1262486016
    v_fmaak_f32 v112, v10, v112, 1262486016
    v_fmaak_f32 v113, v10, v113, 1262486016
    v_lshlrev_b32 v95, 22, v95
    v_alignbit_b32 v95, v112, v95, 10
    v_alignbit_b32 v95, v113, v95, 10
    v_xor_b32 v95, 0x80200800, v95
    s_add_u32 s36, s42, 9
    s_and_b32 s35, s36, 3
    s_mul_i32 s35, s35, 1047552
    s_lshl_b32 s36, s36, 20
    s_sub_u32 s36, s36, s35
    buffer_store_dwordx4 v[92:95], v3, s[20:23], s36 offen sc1
    v_lshlrev_b32 v67, 16, v114
    v_and_b32 v114, 0xffff0000, v114
    v_lshlrev_b32 v115, 16, v115
    v_mul_f32 v67, s41, v67
    v_mul_f32 v114, s41, v114
    v_mul_f32 v115, s41, v115
    v_fract_f32 v67, v67
    v_fract_f32 v114, v114
    v_fract_f32 v115, v115
    v_cos_f32 v67, v67
    v_cos_f32 v114, v114
    v_cos_f32 v115, v115
    v_fmaak_f32 v67, v10, v67, 1262486016
    v_fmaak_f32 v114, v10, v114, 1262486016
    v_fmaak_f32 v115, v10, v115, 1262486016
    v_lshlrev_b32 v67, 22, v67
    v_alignbit_b32 v67, v114, v67, 10
    v_alignbit_b32 v67, v115, v67, 10
    v_xor_b32 v67, 0x80200800, v67
    s_add_u32 s36, s42, 10
    s_and_b32 s35, s36, 3
    s_mul_i32 s35, s35, 1047552
    s_lshl_b32 s36, s36, 20
    s_sub_u32 s36, s36, s35
    buffer_store_dwordx4 v[64:67], v3, s[20:23], s36 offen sc1
    v_lshlrev_b32 v99, 16, v116
    v_and_b32 v116, 0xffff0000, v116
    v_lshlrev_b32 v117, 16, v117
    v_mul_f32 v99, s41, v99
    v_mul_f32 v116, s41, v116
    v_mul_f32 v117, s41, v117
    v_fract_f32 v99, v99
    v_fract_f32 v116, v116
    v_fract_f32 v117, v117
    v_cos_f32 v99, v99
    v_cos_f32 v116, v116
    v_cos_f32 v117, v117
    v_fmaak_f32 v99, v10, v99, 1262486016
    v_fmaak_f32 v116, v10, v116, 1262486016
    v_fmaak_f32 v117, v10, v117, 1262486016
    v_lshlrev_b32 v99, 22, v99
    v_alignbit_b32 v99, v116, v99, 10
    v_alignbit_b32 v99, v117, v99, 10
    v_xor_b32 v99, 0x80200800, v99
    s_add_u32 s36, s42, 11
    s_and_b32 s35, s36, 3
    s_mul_i32 s35, s35, 1047552
    s_lshl_b32 s36, s36, 20
    s_sub_u32 s36, s36, s35
    buffer_store_dwordx4 v[96:99], v3, s[20:23], s36 offen sc1
    v_lshlrev_b32 v71, 16, v118
    v_and_b32 v118, 0xffff0000, v118
    v_lshlrev_b32 v119, 16, v119
    v_mul_f32 v71, s41, v71
    v_mul_f32 v118, s41, v118
    v_mul_f32 v119, s41, v119
    v_fract_f32 v71, v71
    v_fract_f32 v118, v118
    v_fract_f32 v119, v119
    v_cos_f32 v71, v71
    v_cos_f32 v118, v118
    v_cos_f32 v119, v119
    v_fmaak_f32 v71, v10, v71, 1262486016
    v_fmaak_f32 v118, v10, v118, 1262486016
    v_fmaak_f32 v119, v10, v119, 1262486016
    v_lshlrev_b32 v71, 22, v71
    v_alignbit_b32 v71, v118, v71, 10
    v_alignbit_b32 v71, v119, v71, 10
    v_xor_b32 v71, 0x80200800, v71
    s_add_u32 s36, s42, 12
    s_and_b32 s35, s36, 3
    s_mul_i32 s35, s35, 1047552
    s_lshl_b32 s36, s36, 20
    s_sub_u32 s36, s36, s35
    buffer_store_dwordx4 v[68:71], v3, s[20:23], s36 offen sc1
    v_and_b32 v6, 0x7c007c00, v5
    v_add_u32 v6, 0x04000400, v6
    v_and_b32 v6, 0x80008000, v6
    v_cmp_ne_u32 vcc, 0, v6
    s_lshl_b32 s35, s2, 3
    s_add_u32 s35, s35, 8519682
    s_mov_b32 s26, 8540160
    s_cmp_lg_u64 vcc, 0
    s_cselect_b32 s55, 1, s55
    s_cmp_eq_u32 s55, 0
    s_cbranch_scc1 L_p1_end
    s_mov_b64 exec, 1
    buffer_store_short v4, off, s[24:27], s35 sc1
L_p1_end:
    s_endpgm
.globl p2_kernel
.p2align 8
.type p2_kernel,@function
p2_kernel:
    s_cmp_ge_u32 s2, 256
    s_cbranch_scc1 L_p2_end
    s_load_dwordx2 s[4:5], s[0:1], 104
    s_load_dwordx2 s[100:101], s[0:1], 24
    s_load_dwordx2 s[8:9], s[0:1], 0
    s_load_dwordx2 s[30:31], s[0:1], 40
    s_load_dwordx4 s[32:35], s[0:1], 56
    s_load_dwordx4 s[36:39], s[0:1], 72
    s_and_b32 s14, s2, 7
    s_lshr_b32 s49, s2, 3
    s_and_b32 s3, s14, 1
    s_lshl_b32 s3, s3, 5
    s_add_u32 s3, s3, s49
    s_lshr_b32 s12, s14, 1
    v_lshrrev_b32 v108, 6, v0
    v_lshlrev_b32 v1, 4, v0
    v_and_b32 v109, 63, v0
    v_readfirstlane_b32 s13, v108
    v_lshlrev_b32 v111, 4, v109
    v_lshrrev_b32 v110, 2, v109
    v_mul_u32_u24 v110, 8256, v110
    v_add_u32 v110, v110, v111
    s_mul_i32 s14, s12, 65
    s_add_u32 s14, s14, s3
    s_lshl_b32 s14, s14, 5
    s_mul_i32 s15, s13, 532480
    s_add_u32 s14, s14, s15
    s_add_u32 s25, s14, 222298112
    s_mul_i32 s22, s12, 1280000
    s_mov_b32 s2, 0
    s_waitcnt lgkmcnt(0)
    s_mov_b32 s6, 655360000
    s_mov_b32 s7, 0x00020000
    s_add_u32 s10, s22, 1280000
    s_mov_b32 s11, 0x00020000
    s_add_u32 s15, s25, 0
    buffer_load_dwordx4 v[28:31], v110, s[4:7], s15 offen
    s_add_u32 s15, s25, 133120
    buffer_load_dwordx4 v[32:35], v110, s[4:7], s15 offen
    s_add_u32 s15, s25, 266240
    buffer_load_dwordx4 v[36:39], v110, s[4:7], s15 offen
    s_add_u32 s15, s25, 399360
    buffer_load_dwordx4 v[40:43], v110, s[4:7], s15 offen
    s_load_dwordx4 s[40:43], s[30:31], 0
    s_load_dwordx16 s[52:67], s[32:33], 0
    s_load_dwordx16 s[68:83], s[34:35], 0
    s_load_dwordx8 s[84:91], s[36:37], 0
    s_load_dwordx8 s[92:99], s[38:39], 0
    v_mov_b32 v52, 0x100
    s_cmp_lg_u32 s13, 0
    s_cbranch_scc1 L_p2_noann
    s_lshl_b32 s14, s3, 8
    s_add_u32 s14, s14, 230821888
    s_mov_b64 exec, 1
    buffer_atomic_add v52, off, s[4:7], s14
    s_mov_b64 exec, -1
L_p2_noann:
    s_add_u32 s14, s22, 0
    buffer_load_dwordx4 v[88:91], v1, s[8:11], s14 offen
    s_add_u32 s14, s22, 16384
    buffer_load_dwordx4 v[92:95], v1, s[8:11], s14 offen
    s_add_u32 s14, s22, 32768
    buffer_load_dwordx4 v[96:99], v1, s[8:11], s14 offen
    s_add_u32 s14, s22, 49152
    buffer_load_dwordx4 v[100:103], v1, s[8:11], s14 offen
    s_add_u32 s14, s22, 65536
    buffer_load_dwordx4 v[104:107], v1, s[8:11], s14 offen
    s_mov_b32 s15, 230817792
    buffer_load_dwordx4 v[80:83], v111, s[4:7], s15 offen offset:0
    buffer_load_dwordx4 v[84:87], v111, s[4:7], s15 offen offset:1024
    v_mov_b32 v2, v109
    v_mov_b32 v50, 21845
    v_add_u32 v3, 80000, v1
    v_add_u32 v124, 145536, v1
    v_add_u32 v113, 65536, v1
    v_mov_b32 v112, 0x7f000000
    v_cmp_gt_u32 vcc, 904, v0
    s_mul_i32 s19, s13, 240
    s_add_u32 s19, s19, 160000
    v_cndmask_b32 v124, v112, v124, vcc
    v_cndmask_b32 v113, v112, v113, vcc
    v_lshl_add_u32 v6, v109, 2, s19
    v_lshl_add_u32 v126, v109, 1, s19
    v_cmp_gt_u32 vcc, 10, v109
    s_lshl_b32 s27, s13, 18
    s_mov_b32 s23, 261888
    v_cndmask_b32 v6, v112, v6, vcc
    s_mov_b32 s44, s4
    s_add_u32 s45, s5, 1048576
    s_mov_b32 s46, 13893632
    s_mov_b32 s47, 0x00020000
    s_mov_b32 s18, 80000
    s_and_b32 s50, s3, 1
    s_lshl_b32 s50, s50, 18
    s_sub_u32 s18, s18, s50
    s_sub_u32 s50, 4294836224, s50
    v_lshlrev_b32 v116, 3, v0
    v_and_b32 v116, 16, v116
    v_and_b32 v117, 1, v0
    v_lshl_or_b32 v116, v117, 5, v116
    v_mov_b32 v58, 0x3f80
    v_mov_b32 v59, 0
    v_lshlrev_b64 v[58:59], v116, v[58:59]
    v_mov_b32 v4, 0
    v_mov_b32 v5, 0
    v_mov_b32 v114, 0xff00
    v_bfe_u32 v127, v0, 0, 1
    v_mul_u32_u24 v127, 40, v127
    v_add_u32 v127, s19, v127
    ds_write2_b32 v6, v5, v5 offset0:34 offset1:44
    ds_write_b16 v126, v114 offset:2
    v_mov_b32 v44, 1073758208
    v_mov_b32 v45, 1073758208
    v_mov_b32 v46, 1073758208
    v_mov_b32 v47, 1073758208
    v_mov_b32 v48, 1073758208
    v_mov_b32 v49, 1073758208
    ds_write_b128 v113, v[44:47]
    v_lshrrev_b32 v115, 4, v109
    v_mul_u32_u24 v115, 15360, v115
    v_lshl_add_u32 v115, v109, 6, v115
    v_lshl_add_u32 v115, v108, 10, v115
    s_waitcnt lgkmcnt(0)
    v_mov_b32 v53, s40
    v_mov_b32 v54, s41
    v_mov_b32 v56, s42
    v_mov_b32 v57, s43
    s_mov_b32 s40, 20987904
    s_mov_b32 s41, 21031594
    s_pack_ll_b32_b16 s14, s52, s54
    s_pack_hh_b32_b16 s15, s52, s54
    s_pack_ll_b32_b16 s54, s53, s55
    s_pack_hh_b32_b16 s55, s53, s55
    s_mov_b32 s52, s14
    s_mov_b32 s53, s15
    s_pack_ll_b32_b16 s14, s56, s58
    s_pack_hh_b32_b16 s15, s56, s58
    s_pack_ll_b32_b16 s58, s57, s59
    s_pack_hh_b32_b16 s59, s57, s59
    s_mov_b32 s56, s14
    s_mov_b32 s57, s15
    s_pack_ll_b32_b16 s14, s60, s62
    s_pack_hh_b32_b16 s15, s60, s62
    s_pack_ll_b32_b16 s62, s61, s63
    s_pack_hh_b32_b16 s63, s61, s63
    s_mov_b32 s60, s14
    s_mov_b32 s61, s15
    s_pack_ll_b32_b16 s14, s64, s66
    s_pack_hh_b32_b16 s15, s64, s66
    s_pack_ll_b32_b16 s66, s65, s67
    s_pack_hh_b32_b16 s67, s65, s67
    s_mov_b32 s64, s14
    s_mov_b32 s65, s15
    s_pack_ll_b32_b16 s14, s68, s70
    s_pack_hh_b32_b16 s15, s68, s70
    s_pack_ll_b32_b16 s70, s69, s71
    s_pack_hh_b32_b16 s71, s69, s71
    s_mov_b32 s68, s14
    s_mov_b32 s69, s15
    s_pack_ll_b32_b16 s14, s72, s74
    s_pack_hh_b32_b16 s15, s72, s74
    s_pack_ll_b32_b16 s74, s73, s75
    s_pack_hh_b32_b16 s75, s73, s75
    s_mov_b32 s72, s14
    s_mov_b32 s73, s15
    s_pack_ll_b32_b16 s14, s76, s78
    s_pack_hh_b32_b16 s15, s76, s78
    s_pack_ll_b32_b16 s78, s77, s79
    s_pack_hh_b32_b16 s79, s77, s79
    s_mov_b32 s76, s14
    s_mov_b32 s77, s15
    s_pack_ll_b32_b16 s14, s80, s82
    s_pack_hh_b32_b16 s15, s80, s82
    s_pack_ll_b32_b16 s82, s81, s83
    s_pack_hh_b32_b16 s83, s81, s83
    s_mov_b32 s80, s14
    s_mov_b32 s81, s15
    s_waitcnt vmcnt(10)
    ds_write_b128 v1, v[28:31] offset:0
    s_waitcnt vmcnt(9)
    ds_write_b128 v1, v[32:35] offset:16384
    s_waitcnt vmcnt(8)
    ds_write_b128 v1, v[36:39] offset:32768
    s_waitcnt vmcnt(7)
    ds_write_b128 v1, v[40:43] offset:49152
    ds_read_b128 v[28:31], v115 offset:0
    ds_read_b128 v[36:39], v115 offset:32
    ds_read_b128 v[32:35], v115 offset:16
    ds_read_b128 v[40:43], v115 offset:48
    ds_write_b128 v1, v[44:47] offset:0
    ds_write_b128 v1, v[44:47] offset:16384
    ds_write_b128 v1, v[44:47] offset:32768
    ds_write_b128 v1, v[44:47] offset:49152
    s_waitcnt lgkmcnt(6)
    v_mad_u32_u16 v108, v28, v50, s40 op_sel:[0,0,0,0]
    v_mad_u32_u16 v109, v36, v50, s41 op_sel:[0,0,0,0]
    v_sub_u32_sdwa v110, v109, v108 dst_sel:DWORD dst_unused:UNUSED_PAD src0_sel:WORD_1 src1_sel:WORD_1
    s_nop 1
    v_add_u32_dpp v110, v110, v110 row_shr:1 row_mask:0xf bank_mask:0xf bound_ctrl:0
    s_nop 1
    v_add_u32_dpp v110, v110, v110 row_shr:2 row_mask:0xf bank_mask:0xf bound_ctrl:0
    s_nop 1
    v_add_u32_dpp v110, v110, v110 row_shr:4 row_mask:0xf bank_mask:0xf bound_ctrl:0
    s_nop 1
    v_add_u32_dpp v110, v110, v110 row_shr:8 row_mask:0xf bank_mask:0xf bound_ctrl:0
    s_nop 1
    v_add_u32_dpp v110, v110, v110 row_bcast:15 row_mask:0xa bank_mask:0xf
    s_nop 1
    v_add_u32_dpp v110, v110, v110 row_bcast:31 row_mask:0xc bank_mask:0xf
    v_sub_u32_sdwa v109, v109, v110 dst_sel:DWORD dst_unused:UNUSED_PAD src0_sel:WORD_1 src1_sel:DWORD
    v_readlane_b32 s29, v110, 63
    v_add_u32 v110, -1, v110
    ds_write_b16 v126, v109
    v_lshlrev_b32_e64 v111, v110, 1
    v_lshrrev_b32 v110, 5, v110
    s_cmp_gt_u32 s29, 320
    s_cselect_b32 s2, 1, s2
    v_lshl_add_u32 v110, v110, 2, v127
    s_cselect_b64 exec, 0, -1
    ds_or_b32 v110, v111 offset:136
    s_mov_b64 exec, -1
    ds_wrxchg2_rtn_b32 v[108:109], v6, v5, v5 offset0:34 offset1:44
    s_waitcnt lgkmcnt(0)
    v_or_b32 v7, v108, v109
    s_nop 0
    v_readlane_b32 s30, v7, 0
    v_readlane_b32 s31, v7, 1
    v_readlane_b32 s32, v7, 2
    v_readlane_b32 s33, v7, 3
    v_readlane_b32 s34, v7, 4
    v_readlane_b32 s35, v7, 5
    v_readlane_b32 s36, v7, 6
    v_readlane_b32 s37, v7, 7
    s_mov_b32 s25, s19
    s_mov_b32 s26, s27
    s_mov_b32 s51, s28
    s_mov_b32 s28, s29
    v_mbcnt_lo_u32_b32 v8, s30, 0
    v_mbcnt_hi_u32_b32 v8, s31, v8
    s_bcnt1_i32_b64 s14, s[30:31]
    v_lshl_add_u32 v9, v8, 1, s25
    ds_read_u16 v9, v9
    s_mov_b32 s30, s26
    s_movk_i32 s31, -320
    s_lshl1_add_u32 s25, s14, s25
    s_lshl_b32 s14, s14, 12
    s_add_u32 s26, s26, s14
    v_mbcnt_lo_u32_b32 v12, s32, 0
    v_mbcnt_hi_u32_b32 v12, s33, v12
    s_bcnt1_i32_b64 s14, s[32:33]
    v_lshl_add_u32 v13, v12, 1, s25
    ds_read_u16 v13, v13
    s_mov_b32 s32, s26
    s_movk_i32 s33, -256
    s_lshl1_add_u32 s25, s14, s25
    s_lshl_b32 s14, s14, 12
    s_add_u32 s26, s26, s14
    v_mbcnt_lo_u32_b32 v16, s34, 0
    v_mbcnt_hi_u32_b32 v16, s35, v16
    s_bcnt1_i32_b64 s14, s[34:35]
    v_lshl_add_u32 v17, v16, 1, s25
    ds_read_u16 v17, v17
    s_mov_b32 s34, s26
    s_movk_i32 s35, -192
    s_lshl1_add_u32 s25, s14, s25
    s_lshl_b32 s14, s14, 12
    s_add_u32 s26, s26, s14
    v_mbcnt_lo_u32_b32 v20, s36, 0
    v_mbcnt_hi_u32_b32 v20, s37, v20
    s_bcnt1_i32_b64 s14, s[36:37]
    v_lshl_add_u32 v21, v20, 1, s25
    ds_read_u16 v21, v21
    s_mov_b32 s36, s26
    s_movk_i32 s37, -128
    s_lshl1_add_u32 s25, s14, s25
    s_lshl_b32 s14, s14, 12
    s_add_u32 s26, s26, s14
    s_waitcnt lgkmcnt(3)
    v_add3_u32 v9, v9, v2, s31
    v_lshl_add_u32 v8, v8, 8, v9
    v_lshrrev_b32 v9, 8, v9
    v_mad_u32_u24 v8, v9, s23, v8
    buffer_load_dwordx4 v[8:11], v8, s[44:47], s30 idxen
    s_waitcnt lgkmcnt(2)
    v_add3_u32 v13, v13, v2, s33
    v_lshl_add_u32 v12, v12, 8, v13
    v_lshrrev_b32 v13, 8, v13
    v_mad_u32_u24 v12, v13, s23, v12
    buffer_load_dwordx4 v[12:15], v12, s[44:47], s32 idxen
    s_waitcnt lgkmcnt(1)
    v_add3_u32 v17, v17, v2, s35
    v_lshl_add_u32 v16, v16, 8, v17
    v_lshrrev_b32 v17, 8, v17
    v_mad_u32_u24 v16, v17, s23, v16
    buffer_load_dwordx4 v[16:19], v16, s[44:47], s34 idxen
    s_waitcnt lgkmcnt(0)
    v_add3_u32 v21, v21, v2, s37
    v_lshl_add_u32 v20, v20, 8, v21
    v_lshrrev_b32 v21, 8, v21
    v_mad_u32_u24 v20, v21, s23, v20
    buffer_load_dwordx4 v[20:23], v20, s[44:47], s36 idxen
    s_cmp_le_u32 s28, 256
    s_cbranch_scc1 L_p2_kernel_noopt_1
    v_readlane_b32 s38, v7, 8
    v_readlane_b32 s39, v7, 9
    s_nop 1
    v_mbcnt_lo_u32_b32 v51, s38, 0
    v_mbcnt_hi_u32_b32 v51, s39, v51
    s_bcnt1_i32_b64 s14, s[38:39]
    v_lshl_add_u32 v55, v51, 1, s25
    ds_read_u16 v55, v55
    s_mov_b32 s38, s26
    s_movk_i32 s39, -64
    s_lshl1_add_u32 s25, s14, s25
    s_lshl_b32 s14, s14, 12
    s_add_u32 s26, s26, s14
    s_waitcnt lgkmcnt(0)
    v_add3_u32 v55, v55, v2, s39
    v_lshl_add_u32 v51, v51, 8, v55
    v_lshrrev_b32 v55, 8, v55
    v_mad_u32_u24 v51, v55, s23, v51
    buffer_load_dwordx4 v[24:27], v51, s[44:47], s38 idxen
L_p2_kernel_noopt_1:
    s_waitcnt vmcnt(6)
    ds_write_b128 v3, v[88:91] offset:0
    ds_write_b128 v3, v[92:95] offset:16384
    ds_write_b128 v3, v[96:99] offset:32768
    ds_write_b128 v3, v[100:103] offset:49152
    ds_write_b128 v124, v[104:107] offset:0
    s_waitcnt vmcnt(4)
    v_max3_u32 v64, v80, v82, v84
    v_add_f32 v65, v81, v83
    v_add_f32 v66, v85, v87
    v_max_u32 v64, v64, v86
    v_add_f32 v65, v65, v66
    v_cmp_lt_u32 vcc, 0xffff, v64
    s_nop 1
    v_max_u32_dpp v64, v64, v64 row_shr:1 row_mask:0xf bank_mask:0xf bound_ctrl:0
    s_nop 1
    v_max_u32_dpp v64, v64, v64 row_shr:2 row_mask:0xf bank_mask:0xf bound_ctrl:0
    s_nop 1
    v_max_u32_dpp v64, v64, v64 row_shr:4 row_mask:0xf bank_mask:0xf bound_ctrl:0
    s_nop 1
    v_max_u32_dpp v64, v64, v64 row_shr:8 row_mask:0xf bank_mask:0xf bound_ctrl:0
    s_nop 1
    v_max_u32_dpp v64, v64, v64 row_bcast:15 row_mask:0xa bank_mask:0xf
    s_nop 1
    v_max_u32_dpp v64, v64, v64 row_bcast:31 row_mask:0xc bank_mask:0xf
    s_nop 1
    v_add_f32_dpp v65, v65, v65 row_shr:1 row_mask:0xf bank_mask:0xf bound_ctrl:0
    s_nop 1
    v_add_f32_dpp v65, v65, v65 row_shr:2 row_mask:0xf bank_mask:0xf bound_ctrl:0
    s_nop 1
    v_add_f32_dpp v65, v65, v65 row_shr:4 row_mask:0xf bank_mask:0xf bound_ctrl:0
    s_nop 1
    v_add_f32_dpp v65, v65, v65 row_shr:8 row_mask:0xf bank_mask:0xf bound_ctrl:0
    s_nop 1
    v_add_f32_dpp v65, v65, v65 row_bcast:15 row_mask:0xa bank_mask:0xf
    s_nop 1
    v_add_f32_dpp v65, v65, v65 row_bcast:31 row_mask:0xc bank_mask:0xf
    s_cmp_lg_u64 vcc, 0
    s_cselect_b32 s2, 1, s2
    v_lshlrev_b32 v64, 16, v64
    v_mul_f32 v66, 936490775, v65
    v_mul_f32 v65, 928531664, v65
    v_cmp_nle_f32 vcc, v64, v66
    v_max_u32 v64, v64, v65
    s_nop 0
    v_readlane_b32 s14, v64, 63
    s_bitcmp1_b32 vcc_hi, 31
    s_cselect_b32 s2, 1, s2
    s_lshr_b32 s14, s14, 23
    s_add_u32 s14, s14, 1
    s_cmp_lt_u32 s14, 40
    s_cselect_b32 s2, 1, s2
    s_cmp_gt_u32 s14, 230
    s_cselect_b32 s2, 1, s2
    s_sub_u32 s48, s14, 14
    s_lshl_b32 s48, s48, 23
    s_add_u32 s16, s48, 272629760
    s_lshr_b32 s15, s16, 16
    s_sub_u32 s15, 0x10000, s15
    s_add_u32 s20, s16, s15
    s_sub_u32 s17, s20, 1
    s_mov_b32 s21, s17
    s_or_b32 s48, s48, 16416
    s_sub_u32 s14, s14, 40
    s_cmp_gt_u32 s14, 190
    s_cselect_b32 s48, 0, s48
    s_waitcnt lgkmcnt(0)
    s_barrier
    s_add_u32 s14, s22, 80000
    buffer_load_dwordx4 v[88:91], v1, s[8:11], s14 offen
    s_add_u32 s14, s22, 96384
    buffer_load_dwordx4 v[92:95], v1, s[8:11], s14 offen
    v_mad_u32_u16 v108, v28, v50, s40 op_sel:[1,0,0,0]
    v_mad_u32_u16 v109, v36, v50, s41 op_sel:[1,0,0,0]
    v_sub_u32_sdwa v110, v109, v108 dst_sel:DWORD dst_unused:UNUSED_PAD src0_sel:WORD_1 src1_sel:WORD_1
    s_nop 1
    v_add_u32_dpp v110, v110, v110 row_shr:1 row_mask:0xf bank_mask:0xf bound_ctrl:0
    s_nop 1
    v_add_u32_dpp v110, v110, v110 row_shr:2 row_mask:0xf bank_mask:0xf bound_ctrl:0
    s_nop 1
    v_add_u32_dpp v110, v110, v110 row_shr:4 row_mask:0xf bank_mask:0xf bound_ctrl:0
    s_nop 1
    v_add_u32_dpp v110, v110, v110 row_shr:8 row_mask:0xf bank_mask:0xf bound_ctrl:0
    s_nop 1
    v_add_u32_dpp v110, v110, v110 row_bcast:15 row_mask:0xa bank_mask:0xf
    s_nop 1
    v_add_u32_dpp v110, v110, v110 row_bcast:31 row_mask:0xc bank_mask:0xf
    v_sub_u32_sdwa v109, v109, v110 dst_sel:DWORD dst_unused:UNUSED_PAD src0_sel:WORD_1 src1_sel:DWORD
    v_readlane_b32 s29, v110, 63
    v_add_u32 v110, -1, v110
    ds_write_b16 v126, v109
    v_lshlrev_b32_e64 v111, v110, 1
    v_lshrrev_b32 v110, 5, v110
    s_cmp_gt_u32 s29, 320
    s_cselect_b32 s2, 1, s2
    v_lshl_add_u32 v110, v110, 2, v127
    s_cselect_b64 exec, 0, -1
    ds_or_b32 v110, v111 offset:136
    s_mov_b64 exec, -1
    ds_wrxchg2_rtn_b32 v[108:109], v6, v5, v5 offset0:34 offset1:44
    s_mov_b32 s24, 0
L_p2_loop:
    s_add_u32 s22, s22, 80000
    s_lshl_b32 s14, s13, 4
    s_or_b32 s14, s14, s24
    s_cmp_lg_u32 s14, 5
    s_cbranch_scc1 L_p2_nost
    v_mov_b32 v52, 0
    s_lshl_b32 s14, s3, 8
    s_add_u32 s14, s14, 230821888
    s_mov_b64 exec, 1
    buffer_atomic_add v52, off, s[4:7], s14 sc0
    s_mov_b64 exec, -1
L_p2_nost:
    s_waitcnt vmcnt(5)
    v_mad_u32_u16 v64, v8, 8, s18
    v_mad_u32_u16 v66, v9, 8, s18
    v_mad_u32_u16 v68, v10, 8, s18
    ds_read_b64 v[64:65], v64
    ds_read_b64 v[66:67], v66
    ds_read_b64 v[68:69], v68
    s_add_u32 s14, s22, 32768
    buffer_load_dwordx4 v[96:99], v1, s[8:11], s14 offen
    s_waitcnt vmcnt(5)
    v_mad_u32_u16 v70, v12, 8, s18
    v_mad_u32_u16 v72, v13, 8, s18
    v_mad_u32_u16 v74, v14, 8, s18
    ds_read_b64 v[70:71], v70
    ds_read_b64 v[72:73], v72
    ds_read_b64 v[74:75], v74
    s_add_u32 s14, s22, 49152
    buffer_load_dwordx4 v[100:103], v1, s[8:11], s14 offen
    s_waitcnt lgkmcnt(6)
    v_or_b32 v7, v108, v109
    s_nop 0
    v_readlane_b32 s30, v7, 0
    v_readlane_b32 s31, v7, 1
    v_readlane_b32 s32, v7, 2
    v_readlane_b32 s33, v7, 3
    v_readlane_b32 s34, v7, 4
    v_readlane_b32 s35, v7, 5
    v_readlane_b32 s36, v7, 6
    v_readlane_b32 s37, v7, 7
    s_mov_b32 s25, s19
    s_mov_b32 s26, s27
    s_mov_b32 s51, s28
    s_mov_b32 s28, s29
    v_mbcnt_lo_u32_b32 v51, s30, 0
    v_mbcnt_hi_u32_b32 v51, s31, v51
    s_bcnt1_i32_b64 s14, s[30:31]
    v_lshl_add_u32 v55, v51, 1, s25
    ds_read_u16 v55, v55
    s_mov_b32 s30, s26
    s_movk_i32 s31, -320
    s_lshl1_add_u32 s25, s14, s25
    s_lshl_b32 s14, s14, 12
    s_add_u32 s26, s26, s14
    v_bfe_i32 v108, v11, 2, 10
    v_bfe_i32 v109, v11, 12, 10
    v_ashrrev_i32 v110, 22, v11
    v_cvt_f32_i32 v108, v108
    v_cvt_f32_i32 v109, v109
    v_cvt_f32_i32 v110, v110
    s_waitcnt lgkmcnt(4)
    v_mfma_f32_4x4x4_16b_bf16 v[112:115], v[58:59], v[64:65], 0
    v_mfma_f32_4x4x4_16b_bf16 v[116:119], v[58:59], v[66:67], 0
    v_mfma_f32_4x4x4_16b_bf16 v[120:123], v[58:59], v[68:69], 0
    v_mad_u32_u16 v8, v8, 8, s50 op_sel:[1,0,0,0]
    v_mad_u32_u16 v9, v9, 8, s50 op_sel:[1,0,0,0]
    v_mad_u32_u16 v10, v10, 8, s50 op_sel:[1,0,0,0]
    v_pk_fma_f32 v[114:115], v[114:115], v[108:109], s[20:21] op_sel:[0,0,0] op_sel_hi:[1,0,1]
    v_pk_fma_f32 v[112:113], v[112:113], v[108:109], s[16:17] op_sel:[0,0,0] op_sel_hi:[1,0,1]
    v_pk_fma_f32 v[118:119], v[118:119], v[108:109], s[20:21] op_sel:[0,1,0] op_sel_hi:[1,1,1]
    v_pk_fma_f32 v[116:117], v[116:117], v[108:109], s[16:17] op_sel:[0,1,0] op_sel_hi:[1,1,1]
    v_pk_fma_f32 v[122:123], v[122:123], v[110:111], s[20:21] op_sel:[0,0,0] op_sel_hi:[1,0,1]
    v_pk_fma_f32 v[120:121], v[120:121], v[110:111], s[16:17] op_sel:[0,0,0] op_sel_hi:[1,0,1]
    v_lshlrev_b64 v[114:115], 16, v[114:115]
    v_lshlrev_b64 v[118:119], 16, v[118:119]
    v_lshlrev_b64 v[122:123], 16, v[122:123]
    v_lshl_add_u64 v[64:65], v[112:113], 0, v[114:115]
    v_lshl_add_u64 v[66:67], v[116:117], 0, v[118:119]
    v_lshl_add_u64 v[68:69], v[120:121], 0, v[122:123]
    v_or3_b32 v4, v44, v45, v4
    v_or3_b32 v4, v46, v47, v4
    v_or3_b32 v4, v48, v49, v4
    ds_add_rtn_u64 v[44:45], v8, v[64:65]
    ds_add_rtn_u64 v[46:47], v9, v[66:67]
    ds_add_rtn_u64 v[48:49], v10, v[68:69]
    s_waitcnt lgkmcnt(3)
    v_add3_u32 v55, v55, v2, s31
    v_lshl_add_u32 v51, v51, 8, v55
    v_lshrrev_b32 v55, 8, v55
    v_mad_u32_u24 v51, v55, s23, v51
    buffer_load_dwordx4 v[8:11], v51, s[44:47], s30 idxen
    s_sub_u32 s14, s22, 80000
    buffer_load_dwordx4 v[104:107], v124, s[8:11], s14 offen
    s_waitcnt vmcnt(7)
    v_mad_u32_u16 v76, v16, 8, s18
    v_mad_u32_u16 v78, v17, 8, s18
    v_mad_u32_u16 v80, v18, 8, s18
    ds_read_b64 v[76:77], v76
    ds_read_b64 v[78:79], v78
    ds_read_b64 v[80:81], v80
    s_waitcnt vmcnt(6)
    v_mad_u32_u16 v82, v20, 8, s18
    v_mad_u32_u16 v84, v21, 8, s18
    v_mad_u32_u16 v86, v22, 8, s18
    ds_read_b64 v[82:83], v82
    ds_read_b64 v[84:85], v84
    ds_read_b64 v[86:87], v86
    s_cmp_le_u32 s51, 256
    s_cbranch_scc1 L_p2_kernel_noopt3_2
    v_mad_u32_u16 v64, v24, 8, s18
    v_mad_u32_u16 v66, v25, 8, s18
    v_mad_u32_u16 v68, v26, 8, s18
    ds_read_b64 v[64:65], v64
    ds_read_b64 v[66:67], v66
    ds_read_b64 v[68:69], v68
L_p2_kernel_noopt3_2:
    v_mbcnt_lo_u32_b32 v51, s32, 0
    v_mbcnt_hi_u32_b32 v51, s33, v51
    s_bcnt1_i32_b64 s14, s[32:33]
    v_lshl_add_u32 v55, v51, 1, s25
    ds_read_u16 v55, v55
    s_mov_b32 s32, s26
    s_movk_i32 s33, -256
    s_lshl1_add_u32 s25, s14, s25
    s_lshl_b32 s14, s14, 12
    s_add_u32 s26, s26, s14
    v_bfe_i32 v108, v15, 2, 10
    v_bfe_i32 v109, v15, 12, 10
    v_ashrrev_i32 v110, 22, v15
    v_cvt_f32_i32 v108, v108
    v_cvt_f32_i32 v109, v109
    v_cvt_f32_i32 v110, v110
    v_mfma_f32_4x4x4_16b_bf16 v[112:115], v[58:59], v[70:71], 0
    v_mfma_f32_4x4x4_16b_bf16 v[116:119], v[58:59], v[72:73], 0
    v_mfma_f32_4x4x4_16b_bf16 v[120:123], v[58:59], v[74:75], 0
    v_mad_u32_u16 v12, v12, 8, s50 op_sel:[1,0,0,0]
    v_mad_u32_u16 v13, v13, 8, s50 op_sel:[1,0,0,0]
    v_mad_u32_u16 v14, v14, 8, s50 op_sel:[1,0,0,0]
    v_pk_fma_f32 v[114:115], v[114:115], v[108:109], s[20:21] op_sel:[0,0,0] op_sel_hi:[1,0,1]
    v_pk_fma_f32 v[112:113], v[112:113], v[108:109], s[16:17] op_sel:[0,0,0] op_sel_hi:[1,0,1]
    v_pk_fma_f32 v[118:119], v[118:119], v[108:109], s[20:21] op_sel:[0,1,0] op_sel_hi:[1,1,1]
    v_pk_fma_f32 v[116:117], v[116:117], v[108:109], s[16:17] op_sel:[0,1,0] op_sel_hi:[1,1,1]
    v_pk_fma_f32 v[122:123], v[122:123], v[110:111], s[20:21] op_sel:[0,0,0] op_sel_hi:[1,0,1]
    v_pk_fma_f32 v[120:121], v[120:121], v[110:111], s[16:17] op_sel:[0,0,0] op_sel_hi:[1,0,1]
    v_lshlrev_b64 v[114:115], 16, v[114:115]
    v_lshlrev_b64 v[118:119], 16, v[118:119]
    v_lshlrev_b64 v[122:123], 16, v[122:123]
    v_lshl_add_u64 v[70:71], v[112:113], 0, v[114:115]
    v_lshl_add_u64 v[72:73], v[116:117], 0, v[118:119]
    v_lshl_add_u64 v[74:75], v[120:121], 0, v[122:123]
    s_waitcnt lgkmcnt(7)
    v_or3_b32 v4, v44, v45, v4
    v_or3_b32 v4, v46, v47, v4
    v_or3_b32 v4, v48, v49, v4
    ds_add_rtn_u64 v[44:45], v12, v[70:71]
    ds_add_rtn_u64 v[46:47], v13, v[72:73]
    ds_add_rtn_u64 v[48:49], v14, v[74:75]
    s_waitcnt lgkmcnt(3)
    v_add3_u32 v55, v55, v2, s33
    v_lshl_add_u32 v51, v51, 8, v55
    v_lshrrev_b32 v55, 8, v55
    v_mad_u32_u24 v51, v55, s23, v51
    buffer_load_dwordx4 v[12:15], v51, s[44:47], s32 idxen
    s_barrier
    s_waitcnt vmcnt(1)
    ds_write_b128 v3, v[88:91] offset:0
    ds_write_b128 v3, v[92:95] offset:16384
    ds_write_b128 v3, v[96:99] offset:32768
    ds_write_b128 v3, v[100:103] offset:49152
    ds_write_b128 v124, v[104:107] offset:0
    s_cmp_lg_u32 s24, 7
    s_cbranch_scc1 L_p2_nofin
    s_mul_i32 s14, s3, 20000
    s_mul_i32 s15, s12, 4992
    s_add_u32 s14, s14, s15
    s_add_u32 s15, s14, 4096
    v_min_u32 v61, 231, v0
    v_lshl_add_u32 v60, v0, 2, s14
    v_lshl_add_u32 v61, v61, 2, s15
    global_load_dword v60, v60, s[100:101] nt
    global_load_dword v61, v61, s[100:101] nt
    s_lshl_b32 s14, s14, 2
    s_lshl_b32 s15, s15, 2
    v_min_u32 v36, 231, v0
    v_add_u32 v28, s14, v1
    v_lshl_add_u32 v36, v36, 4, s15
    global_load_dwordx4 v[28:31], v28, s[8:9]
    global_load_dwordx4 v[36:39], v36, s[8:9]
L_p2_nofin:
    v_mbcnt_lo_u32_b32 v51, s34, 0
    v_mbcnt_hi_u32_b32 v51, s35, v51
    s_bcnt1_i32_b64 s14, s[34:35]
    v_lshl_add_u32 v55, v51, 1, s25
    ds_read_u16 v55, v55
    s_mov_b32 s34, s26
    s_movk_i32 s35, -192
    s_lshl1_add_u32 s25, s14, s25
    s_lshl_b32 s14, s14, 12
    s_add_u32 s26, s26, s14
    v_bfe_i32 v108, v19, 2, 10
    v_bfe_i32 v109, v19, 12, 10
    v_ashrrev_i32 v110, 22, v19
    v_cvt_f32_i32 v108, v108
    v_cvt_f32_i32 v109, v109
    v_cvt_f32_i32 v110, v110
    v_mfma_f32_4x4x4_16b_bf16 v[112:115], v[58:59], v[76:77], 0
    v_mfma_f32_4x4x4_16b_bf16 v[116:119], v[58:59], v[78:79], 0
    v_mfma_f32_4x4x4_16b_bf16 v[120:123], v[58:59], v[80:81], 0
    v_mad_u32_u16 v16, v16, 8, s50 op_sel:[1,0,0,0]
    v_mad_u32_u16 v17, v17, 8, s50 op_sel:[1,0,0,0]
    v_mad_u32_u16 v18, v18, 8, s50 op_sel:[1,0,0,0]
    v_pk_fma_f32 v[114:115], v[114:115], v[108:109], s[20:21] op_sel:[0,0,0] op_sel_hi:[1,0,1]
    v_pk_fma_f32 v[112:113], v[112:113], v[108:109], s[16:17] op_sel:[0,0,0] op_sel_hi:[1,0,1]
    v_pk_fma_f32 v[118:119], v[118:119], v[108:109], s[20:21] op_sel:[0,1,0] op_sel_hi:[1,1,1]
    v_pk_fma_f32 v[116:117], v[116:117], v[108:109], s[16:17] op_sel:[0,1,0] op_sel_hi:[1,1,1]
    v_pk_fma_f32 v[122:123], v[122:123], v[110:111], s[20:21] op_sel:[0,0,0] op_sel_hi:[1,0,1]
    v_pk_fma_f32 v[120:121], v[120:121], v[110:111], s[16:17] op_sel:[0,0,0] op_sel_hi:[1,0,1]
    v_lshlrev_b64 v[114:115], 16, v[114:115]
    v_lshlrev_b64 v[118:119], 16, v[118:119]
    v_lshlrev_b64 v[122:123], 16, v[122:123]
    v_lshl_add_u64 v[76:77], v[112:113], 0, v[114:115]
    v_lshl_add_u64 v[78:79], v[116:117], 0, v[118:119]
    v_lshl_add_u64 v[80:81], v[120:121], 0, v[122:123]
    s_waitcnt lgkmcnt(6)
    v_or3_b32 v4, v44, v45, v4
    v_or3_b32 v4, v46, v47, v4
    v_or3_b32 v4, v48, v49, v4
    ds_add_rtn_u64 v[44:45], v16, v[76:77]
    ds_add_rtn_u64 v[46:47], v17, v[78:79]
    ds_add_rtn_u64 v[48:49], v18, v[80:81]
    s_waitcnt lgkmcnt(3)
    v_add3_u32 v55, v55, v2, s35
    v_lshl_add_u32 v51, v51, 8, v55
    v_lshrrev_b32 v55, 8, v55
    v_mad_u32_u24 v51, v55, s23, v51
    buffer_load_dwordx4 v[16:19], v51, s[44:47], s34 idxen
    s_cmp_le_u32 s51, 256
    s_cbranch_scc1 L_p2_kernel_noopt3_3
    v_bfe_i32 v108, v27, 2, 10
    v_bfe_i32 v109, v27, 12, 10
    v_ashrrev_i32 v110, 22, v27
    v_cvt_f32_i32 v108, v108
    v_cvt_f32_i32 v109, v109
    v_cvt_f32_i32 v110, v110
    v_mfma_f32_4x4x4_16b_bf16 v[112:115], v[58:59], v[64:65], 0
    v_mfma_f32_4x4x4_16b_bf16 v[116:119], v[58:59], v[66:67], 0
    v_mfma_f32_4x4x4_16b_bf16 v[120:123], v[58:59], v[68:69], 0
    v_mad_u32_u16 v24, v24, 8, s50 op_sel:[1,0,0,0]
    v_mad_u32_u16 v25, v25, 8, s50 op_sel:[1,0,0,0]
    v_mad_u32_u16 v26, v26, 8, s50 op_sel:[1,0,0,0]
    v_pk_fma_f32 v[114:115], v[114:115], v[108:109], s[20:21] op_sel:[0,0,0] op_sel_hi:[1,0,1]
    v_pk_fma_f32 v[112:113], v[112:113], v[108:109], s[16:17] op_sel:[0,0,0] op_sel_hi:[1,0,1]
    v_pk_fma_f32 v[118:119], v[118:119], v[108:109], s[20:21] op_sel:[0,1,0] op_sel_hi:[1,1,1]
    v_pk_fma_f32 v[116:117], v[116:117], v[108:109], s[16:17] op_sel:[0,1,0] op_sel_hi:[1,1,1]
    v_pk_fma_f32 v[122:123], v[122:123], v[110:111], s[20:21] op_sel:[0,0,0] op_sel_hi:[1,0,1]
    v_pk_fma_f32 v[120:121], v[120:121], v[110:111], s[16:17] op_sel:[0,0,0] op_sel_hi:[1,0,1]
    v_lshlrev_b64 v[114:115], 16, v[114:115]
    v_lshlrev_b64 v[118:119], 16, v[118:119]
    v_lshlrev_b64 v[122:123], 16, v[122:123]
    v_lshl_add_u64 v[64:65], v[112:113], 0, v[114:115]
    v_lshl_add_u64 v[66:67], v[116:117], 0, v[118:119]
    v_lshl_add_u64 v[68:69], v[120:121], 0, v[122:123]
    s_waitcnt lgkmcnt(0)
    v_or3_b32 v4, v44, v45, v4
    v_or3_b32 v4, v46, v47, v4
    v_or3_b32 v4, v48, v49, v4
    ds_add_rtn_u64 v[44:45], v24, v[64:65]
    ds_add_rtn_u64 v[46:47], v25, v[66:67]
    ds_add_rtn_u64 v[48:49], v26, v[68:69]
L_p2_kernel_noopt3_3:
    v_mbcnt_lo_u32_b32 v51, s36, 0
    v_mbcnt_hi_u32_b32 v51, s37, v51
    s_bcnt1_i32_b64 s14, s[36:37]
    v_lshl_add_u32 v55, v51, 1, s25
    ds_read_u16 v55, v55
    s_mov_b32 s36, s26
    s_movk_i32 s37, -128
    s_lshl1_add_u32 s25, s14, s25
    s_lshl_b32 s14, s14, 12
    s_add_u32 s26, s26, s14
    s_cmp_le_u32 s28, 256
    s_cbranch_scc1 L_p2_kernel_noopt3_4
    v_readlane_b32 s38, v7, 8
    v_readlane_b32 s39, v7, 9
    s_nop 1
    v_mbcnt_lo_u32_b32 v62, s38, 0
    v_mbcnt_hi_u32_b32 v62, s39, v62
    s_bcnt1_i32_b64 s14, s[38:39]
    v_lshl_add_u32 v63, v62, 1, s25
    ds_read_u16 v63, v63
    s_mov_b32 s38, s26
    s_movk_i32 s39, -64
    s_lshl1_add_u32 s25, s14, s25
    s_lshl_b32 s14, s14, 12
    s_add_u32 s26, s26, s14
L_p2_kernel_noopt3_4:
    v_bfe_i32 v108, v23, 2, 10
    v_bfe_i32 v109, v23, 12, 10
    v_ashrrev_i32 v110, 22, v23
    v_cvt_f32_i32 v108, v108
    v_cvt_f32_i32 v109, v109
    v_cvt_f32_i32 v110, v110
    v_mfma_f32_4x4x4_16b_bf16 v[112:115], v[58:59], v[82:83], 0
    v_mfma_f32_4x4x4_16b_bf16 v[116:119], v[58:59], v[84:85], 0
    v_mfma_f32_4x4x4_16b_bf16 v[120:123], v[58:59], v[86:87], 0
    v_mad_u32_u16 v20, v20, 8, s50 op_sel:[1,0,0,0]
    v_mad_u32_u16 v21, v21, 8, s50 op_sel:[1,0,0,0]
    v_mad_u32_u16 v22, v22, 8, s50 op_sel:[1,0,0,0]
    v_pk_fma_f32 v[114:115], v[114:115], v[108:109], s[20:21] op_sel:[0,0,0] op_sel_hi:[1,0,1]
    v_pk_fma_f32 v[112:113], v[112:113], v[108:109], s[16:17] op_sel:[0,0,0] op_sel_hi:[1,0,1]
    v_pk_fma_f32 v[118:119], v[118:119], v[108:109], s[20:21] op_sel:[0,1,0] op_sel_hi:[1,1,1]
    v_pk_fma_f32 v[116:117], v[116:117], v[108:109], s[16:17] op_sel:[0,1,0] op_sel_hi:[1,1,1]
    v_pk_fma_f32 v[122:123], v[122:123], v[110:111], s[20:21] op_sel:[0,0,0] op_sel_hi:[1,0,1]
    v_pk_fma_f32 v[120:121], v[120:121], v[110:111], s[16:17] op_sel:[0,0,0] op_sel_hi:[1,0,1]
    v_lshlrev_b64 v[114:115], 16, v[114:115]
    v_lshlrev_b64 v[118:119], 16, v[118:119]
    v_lshlrev_b64 v[122:123], 16, v[122:123]
    v_lshl_add_u64 v[82:83], v[112:113], 0, v[114:115]
    v_lshl_add_u64 v[84:85], v[116:117], 0, v[118:119]
    v_lshl_add_u64 v[86:87], v[120:121], 0, v[122:123]
    s_waitcnt lgkmcnt(1)
    v_or3_b32 v4, v44, v45, v4
    v_or3_b32 v4, v46, v47, v4
    v_or3_b32 v4, v48, v49, v4
    ds_add_rtn_u64 v[44:45], v20, v[82:83]
    ds_add_rtn_u64 v[46:47], v21, v[84:85]
    ds_add_rtn_u64 v[48:49], v22, v[86:87]
    s_waitcnt lgkmcnt(3)
    v_add3_u32 v55, v55, v2, s37
    v_lshl_add_u32 v51, v51, 8, v55
    v_lshrrev_b32 v55, 8, v55
    v_mad_u32_u24 v51, v55, s23, v51
    buffer_load_dwordx4 v[20:23], v51, s[44:47], s36 idxen
    s_cmp_le_u32 s28, 256
    s_cbranch_scc1 L_p2_kernel_noopt3_5
    v_add3_u32 v63, v63, v2, s39
    v_lshl_add_u32 v62, v62, 8, v63
    v_lshrrev_b32 v63, 8, v63
    v_mad_u32_u24 v62, v63, s23, v62
    buffer_load_dwordx4 v[24:27], v62, s[44:47], s38 idxen
L_p2_kernel_noopt3_5:
    s_add_u32 s14, s22, 80000
    buffer_load_dwordx4 v[88:91], v1, s[8:11], s14 offen
    s_add_u32 s14, s24, 1
    s_min_u32 s14, s14, 7
    s_set_gpr_idx_on s14, gpr_idx(SRC0)
    v_mad_u32_u16 v108, v28, v50, s40 op_sel:[0,0,0,0]
    v_mad_u32_u16 v109, v36, v50, s41 op_sel:[0,0,0,0]
    s_set_gpr_idx_off
    v_sub_u32_sdwa v110, v109, v108 dst_sel:DWORD dst_unused:UNUSED_PAD src0_sel:WORD_1 src1_sel:WORD_1
    s_nop 1
    v_add_u32_dpp v110, v110, v110 row_shr:1 row_mask:0xf bank_mask:0xf bound_ctrl:0
    s_nop 1
    v_add_u32_dpp v110, v110, v110 row_shr:2 row_mask:0xf bank_mask:0xf bound_ctrl:0
    s_nop 1
    v_add_u32_dpp v110, v110, v110 row_shr:4 row_mask:0xf bank_mask:0xf bound_ctrl:0
    s_nop 1
    v_add_u32_dpp v110, v110, v110 row_shr:8 row_mask:0xf bank_mask:0xf bound_ctrl:0
    s_nop 1
    v_add_u32_dpp v110, v110, v110 row_bcast:15 row_mask:0xa bank_mask:0xf
    s_nop 1
    v_add_u32_dpp v110, v110, v110 row_bcast:31 row_mask:0xc bank_mask:0xf
    v_sub_u32_sdwa v109, v109, v110 dst_sel:DWORD dst_unused:UNUSED_PAD src0_sel:WORD_1 src1_sel:DWORD
    v_readlane_b32 s29, v110, 63
    v_add_u32 v110, -1, v110
    ds_write_b16 v126, v109
    v_lshlrev_b32_e64 v111, v110, 1
    v_lshrrev_b32 v110, 5, v110
    s_cmp_gt_u32 s29, 320
    s_cselect_b32 s2, 1, s2
    v_lshl_add_u32 v110, v110, 2, v127
    s_cselect_b64 exec, 0, -1
    ds_or_b32 v110, v111 offset:136
    s_mov_b64 exec, -1
    ds_wrxchg2_rtn_b32 v[108:109], v6, v5, v5 offset0:34 offset1:44
    s_add_u32 s14, s22, 96384
    buffer_load_dwordx4 v[92:95], v1, s[8:11], s14 offen
    s_barrier
    s_add_u32 s22, s22, 80000
    s_cmp_eq_u32 s24, 7
    s_cselect_b32 s46, 0, s46
    v_mad_u32_u16 v64, v8, 8, s18
    v_mad_u32_u16 v66, v9, 8, s18
    v_mad_u32_u16 v68, v10, 8, s18
    ds_read_b64 v[64:65], v64
    ds_read_b64 v[66:67], v66
    ds_read_b64 v[68:69], v68
    s_add_u32 s14, s22, 32768
    buffer_load_dwordx4 v[96:99], v1, s[8:11], s14 offen
    s_waitcnt vmcnt(5)
    v_mad_u32_u16 v70, v12, 8, s18
    v_mad_u32_u16 v72, v13, 8, s18
    v_mad_u32_u16 v74, v14, 8, s18
    ds_read_b64 v[70:71], v70
    ds_read_b64 v[72:73], v72
    ds_read_b64 v[74:75], v74
    s_add_u32 s14, s22, 49152
    buffer_load_dwordx4 v[100:103], v1, s[8:11], s14 offen
    s_waitcnt lgkmcnt(6)
    v_or_b32 v7, v108, v109
    s_nop 0
    v_readlane_b32 s30, v7, 0
    v_readlane_b32 s31, v7, 1
    v_readlane_b32 s32, v7, 2
    v_readlane_b32 s33, v7, 3
    v_readlane_b32 s34, v7, 4
    v_readlane_b32 s35, v7, 5
    v_readlane_b32 s36, v7, 6
    v_readlane_b32 s37, v7, 7
    s_mov_b32 s25, s19
    s_mov_b32 s26, s27
    s_mov_b32 s51, s28
    s_mov_b32 s28, s29
    v_mbcnt_lo_u32_b32 v51, s30, 0
    v_mbcnt_hi_u32_b32 v51, s31, v51
    s_bcnt1_i32_b64 s14, s[30:31]
    v_lshl_add_u32 v55, v51, 1, s25
    ds_read_u16 v55, v55
    s_mov_b32 s30, s26
    s_movk_i32 s31, -320
    s_lshl1_add_u32 s25, s14, s25
    s_lshl_b32 s14, s14, 12
    s_add_u32 s26, s26, s14
    v_bfe_i32 v108, v11, 2, 10
    v_bfe_i32 v109, v11, 12, 10
    v_ashrrev_i32 v110, 22, v11
    v_cvt_f32_i32 v108, v108
    v_cvt_f32_i32 v109, v109
    v_cvt_f32_i32 v110, v110
    s_waitcnt lgkmcnt(4)
    v_mfma_f32_4x4x4_16b_bf16 v[112:115], v[58:59], v[64:65], 0
    v_mfma_f32_4x4x4_16b_bf16 v[116:119], v[58:59], v[66:67], 0
    v_mfma_f32_4x4x4_16b_bf16 v[120:123], v[58:59], v[68:69], 0
    v_mad_u32_u16 v8, v8, 8, s50 op_sel:[1,0,0,0]
    v_mad_u32_u16 v9, v9, 8, s50 op_sel:[1,0,0,0]
    v_mad_u32_u16 v10, v10, 8, s50 op_sel:[1,0,0,0]
    v_pk_fma_f32 v[114:115], v[114:115], v[108:109], s[20:21] op_sel:[0,0,0] op_sel_hi:[1,0,1]
    v_pk_fma_f32 v[112:113], v[112:113], v[108:109], s[16:17] op_sel:[0,0,0] op_sel_hi:[1,0,1]
    v_pk_fma_f32 v[118:119], v[118:119], v[108:109], s[20:21] op_sel:[0,1,0] op_sel_hi:[1,1,1]
    v_pk_fma_f32 v[116:117], v[116:117], v[108:109], s[16:17] op_sel:[0,1,0] op_sel_hi:[1,1,1]
    v_pk_fma_f32 v[122:123], v[122:123], v[110:111], s[20:21] op_sel:[0,0,0] op_sel_hi:[1,0,1]
    v_pk_fma_f32 v[120:121], v[120:121], v[110:111], s[16:17] op_sel:[0,0,0] op_sel_hi:[1,0,1]
    v_lshlrev_b64 v[114:115], 16, v[114:115]
    v_lshlrev_b64 v[118:119], 16, v[118:119]
    v_lshlrev_b64 v[122:123], 16, v[122:123]
    v_lshl_add_u64 v[64:65], v[112:113], 0, v[114:115]
    v_lshl_add_u64 v[66:67], v[116:117], 0, v[118:119]
    v_lshl_add_u64 v[68:69], v[120:121], 0, v[122:123]
    v_or3_b32 v4, v44, v45, v4
    v_or3_b32 v4, v46, v47, v4
    v_or3_b32 v4, v48, v49, v4
    ds_add_rtn_u64 v[44:45], v8, v[64:65]
    ds_add_rtn_u64 v[46:47], v9, v[66:67]
    ds_add_rtn_u64 v[48:49], v10, v[68:69]
    s_waitcnt lgkmcnt(3)
    v_add3_u32 v55, v55, v2, s31
    v_lshl_add_u32 v51, v51, 8, v55
    v_lshrrev_b32 v55, 8, v55
    v_mad_u32_u24 v51, v55, s23, v51
    buffer_load_dwordx4 v[8:11], v51, s[44:47], s30 idxen
    s_sub_u32 s14, s22, 80000
    buffer_load_dwordx4 v[104:107], v124, s[8:11], s14 offen
    s_waitcnt vmcnt(7)
    v_mad_u32_u16 v76, v16, 8, s18
    v_mad_u32_u16 v78, v17, 8, s18
    v_mad_u32_u16 v80, v18, 8, s18
    ds_read_b64 v[76:77], v76
    ds_read_b64 v[78:79], v78
    ds_read_b64 v[80:81], v80
    s_waitcnt vmcnt(6)
    v_mad_u32_u16 v82, v20, 8, s18
    v_mad_u32_u16 v84, v21, 8, s18
    v_mad_u32_u16 v86, v22, 8, s18
    ds_read_b64 v[82:83], v82
    ds_read_b64 v[84:85], v84
    ds_read_b64 v[86:87], v86
    s_cmp_le_u32 s51, 256
    s_cbranch_scc1 L_p2_kernel_noopt3_6
    v_mad_u32_u16 v64, v24, 8, s18
    v_mad_u32_u16 v66, v25, 8, s18
    v_mad_u32_u16 v68, v26, 8, s18
    ds_read_b64 v[64:65], v64
    ds_read_b64 v[66:67], v66
    ds_read_b64 v[68:69], v68
L_p2_kernel_noopt3_6:
    v_mbcnt_lo_u32_b32 v51, s32, 0
    v_mbcnt_hi_u32_b32 v51, s33, v51
    s_bcnt1_i32_b64 s14, s[32:33]
    v_lshl_add_u32 v55, v51, 1, s25
    ds_read_u16 v55, v55
    s_mov_b32 s32, s26
    s_movk_i32 s33, -256
    s_lshl1_add_u32 s25, s14, s25
    s_lshl_b32 s14, s14, 12
    s_add_u32 s26, s26, s14
    v_bfe_i32 v108, v15, 2, 10
    v_bfe_i32 v109, v15, 12, 10
    v_ashrrev_i32 v110, 22, v15
    v_cvt_f32_i32 v108, v108
    v_cvt_f32_i32 v109, v109
    v_cvt_f32_i32 v110, v110
    v_mfma_f32_4x4x4_16b_bf16 v[112:115], v[58:59], v[70:71], 0
    v_mfma_f32_4x4x4_16b_bf16 v[116:119], v[58:59], v[72:73], 0
    v_mfma_f32_4x4x4_16b_bf16 v[120:123], v[58:59], v[74:75], 0
    v_mad_u32_u16 v12, v12, 8, s50 op_sel:[1,0,0,0]
    v_mad_u32_u16 v13, v13, 8, s50 op_sel:[1,0,0,0]
    v_mad_u32_u16 v14, v14, 8, s50 op_sel:[1,0,0,0]
    v_pk_fma_f32 v[114:115], v[114:115], v[108:109], s[20:21] op_sel:[0,0,0] op_sel_hi:[1,0,1]
    v_pk_fma_f32 v[112:113], v[112:113], v[108:109], s[16:17] op_sel:[0,0,0] op_sel_hi:[1,0,1]
    v_pk_fma_f32 v[118:119], v[118:119], v[108:109], s[20:21] op_sel:[0,1,0] op_sel_hi:[1,1,1]
    v_pk_fma_f32 v[116:117], v[116:117], v[108:109], s[16:17] op_sel:[0,1,0] op_sel_hi:[1,1,1]
    v_pk_fma_f32 v[122:123], v[122:123], v[110:111], s[20:21] op_sel:[0,0,0] op_sel_hi:[1,0,1]
    v_pk_fma_f32 v[120:121], v[120:121], v[110:111], s[16:17] op_sel:[0,0,0] op_sel_hi:[1,0,1]
    v_lshlrev_b64 v[114:115], 16, v[114:115]
    v_lshlrev_b64 v[118:119], 16, v[118:119]
    v_lshlrev_b64 v[122:123], 16, v[122:123]
    v_lshl_add_u64 v[70:71], v[112:113], 0, v[114:115]
    v_lshl_add_u64 v[72:73], v[116:117], 0, v[118:119]
    v_lshl_add_u64 v[74:75], v[120:121], 0, v[122:123]
    s_waitcnt lgkmcnt(7)
    v_or3_b32 v4, v44, v45, v4
    v_or3_b32 v4, v46, v47, v4
    v_or3_b32 v4, v48, v49, v4
    ds_add_rtn_u64 v[44:45], v12, v[70:71]
    ds_add_rtn_u64 v[46:47], v13, v[72:73]
    ds_add_rtn_u64 v[48:49], v14, v[74:75]
    s_waitcnt lgkmcnt(3)
    v_add3_u32 v55, v55, v2, s33
    v_lshl_add_u32 v51, v51, 8, v55
    v_lshrrev_b32 v55, 8, v55
    v_mad_u32_u24 v51, v55, s23, v51
    buffer_load_dwordx4 v[12:15], v51, s[44:47], s32 idxen
    s_cmp_lg_u32 s24, 7
    s_cbranch_scc1 L_p2_stage
    s_waitcnt lgkmcnt(0)
    s_branch L_p2_staged
L_p2_stage:
    s_barrier
    s_waitcnt vmcnt(1)
    ds_write_b128 v3, v[88:91] offset:0
    ds_write_b128 v3, v[92:95] offset:16384
    ds_write_b128 v3, v[96:99] offset:32768
    ds_write_b128 v3, v[100:103] offset:49152
    ds_write_b128 v124, v[104:107] offset:0
L_p2_staged:
    v_mbcnt_lo_u32_b32 v51, s34, 0
    v_mbcnt_hi_u32_b32 v51, s35, v51
    s_bcnt1_i32_b64 s14, s[34:35]
    v_lshl_add_u32 v55, v51, 1, s25
    ds_read_u16 v55, v55
    s_mov_b32 s34, s26
    s_movk_i32 s35, -192
    s_lshl1_add_u32 s25, s14, s25
    s_lshl_b32 s14, s14, 12
    s_add_u32 s26, s26, s14
    v_bfe_i32 v108, v19, 2, 10
    v_bfe_i32 v109, v19, 12, 10
    v_ashrrev_i32 v110, 22, v19
    v_cvt_f32_i32 v108, v108
    v_cvt_f32_i32 v109, v109
    v_cvt_f32_i32 v110, v110
    v_mfma_f32_4x4x4_16b_bf16 v[112:115], v[58:59], v[76:77], 0
    v_mfma_f32_4x4x4_16b_bf16 v[116:119], v[58:59], v[78:79], 0
    v_mfma_f32_4x4x4_16b_bf16 v[120:123], v[58:59], v[80:81], 0
    v_mad_u32_u16 v16, v16, 8, s50 op_sel:[1,0,0,0]
    v_mad_u32_u16 v17, v17, 8, s50 op_sel:[1,0,0,0]
    v_mad_u32_u16 v18, v18, 8, s50 op_sel:[1,0,0,0]
    v_pk_fma_f32 v[114:115], v[114:115], v[108:109], s[20:21] op_sel:[0,0,0] op_sel_hi:[1,0,1]
    v_pk_fma_f32 v[112:113], v[112:113], v[108:109], s[16:17] op_sel:[0,0,0] op_sel_hi:[1,0,1]
    v_pk_fma_f32 v[118:119], v[118:119], v[108:109], s[20:21] op_sel:[0,1,0] op_sel_hi:[1,1,1]
    v_pk_fma_f32 v[116:117], v[116:117], v[108:109], s[16:17] op_sel:[0,1,0] op_sel_hi:[1,1,1]
    v_pk_fma_f32 v[122:123], v[122:123], v[110:111], s[20:21] op_sel:[0,0,0] op_sel_hi:[1,0,1]
    v_pk_fma_f32 v[120:121], v[120:121], v[110:111], s[16:17] op_sel:[0,0,0] op_sel_hi:[1,0,1]
    v_lshlrev_b64 v[114:115], 16, v[114:115]
    v_lshlrev_b64 v[118:119], 16, v[118:119]
    v_lshlrev_b64 v[122:123], 16, v[122:123]
    v_lshl_add_u64 v[76:77], v[112:113], 0, v[114:115]
    v_lshl_add_u64 v[78:79], v[116:117], 0, v[118:119]
    v_lshl_add_u64 v[80:81], v[120:121], 0, v[122:123]
    s_waitcnt lgkmcnt(6)
    v_or3_b32 v4, v44, v45, v4
    v_or3_b32 v4, v46, v47, v4
    v_or3_b32 v4, v48, v49, v4
    ds_add_rtn_u64 v[44:45], v16, v[76:77]
    ds_add_rtn_u64 v[46:47], v17, v[78:79]
    ds_add_rtn_u64 v[48:49], v18, v[80:81]
    s_waitcnt lgkmcnt(3)
    v_add3_u32 v55, v55, v2, s35
    v_lshl_add_u32 v51, v51, 8, v55
    v_lshrrev_b32 v55, 8, v55
    v_mad_u32_u24 v51, v55, s23, v51
    buffer_load_dwordx4 v[16:19], v51, s[44:47], s34 idxen
    s_cmp_le_u32 s51, 256
    s_cbranch_scc1 L_p2_kernel_noopt3_7
    v_bfe_i32 v108, v27, 2, 10
    v_bfe_i32 v109, v27, 12, 10
    v_ashrrev_i32 v110, 22, v27
    v_cvt_f32_i32 v108, v108
    v_cvt_f32_i32 v109, v109
    v_cvt_f32_i32 v110, v110
    v_mfma_f32_4x4x4_16b_bf16 v[112:115], v[58:59], v[64:65], 0
    v_mfma_f32_4x4x4_16b_bf16 v[116:119], v[58:59], v[66:67], 0
    v_mfma_f32_4x4x4_16b_bf16 v[120:123], v[58:59], v[68:69], 0
    v_mad_u32_u16 v24, v24, 8, s50 op_sel:[1,0,0,0]
    v_mad_u32_u16 v25, v25, 8, s50 op_sel:[1,0,0,0]
    v_mad_u32_u16 v26, v26, 8, s50 op_sel:[1,0,0,0]
    v_pk_fma_f32 v[114:115], v[114:115], v[108:109], s[20:21] op_sel:[0,0,0] op_sel_hi:[1,0,1]
    v_pk_fma_f32 v[112:113], v[112:113], v[108:109], s[16:17] op_sel:[0,0,0] op_sel_hi:[1,0,1]
    v_pk_fma_f32 v[118:119], v[118:119], v[108:109], s[20:21] op_sel:[0,1,0] op_sel_hi:[1,1,1]
    v_pk_fma_f32 v[116:117], v[116:117], v[108:109], s[16:17] op_sel:[0,1,0] op_sel_hi:[1,1,1]
    v_pk_fma_f32 v[122:123], v[122:123], v[110:111], s[20:21] op_sel:[0,0,0] op_sel_hi:[1,0,1]
    v_pk_fma_f32 v[120:121], v[120:121], v[110:111], s[16:17] op_sel:[0,0,0] op_sel_hi:[1,0,1]
    v_lshlrev_b64 v[114:115], 16, v[114:115]
    v_lshlrev_b64 v[118:119], 16, v[118:119]
    v_lshlrev_b64 v[122:123], 16, v[122:123]
    v_lshl_add_u64 v[64:65], v[112:113], 0, v[114:115]
    v_lshl_add_u64 v[66:67], v[116:117], 0, v[118:119]
    v_lshl_add_u64 v[68:69], v[120:121], 0, v[122:123]
    s_waitcnt lgkmcnt(0)
    v_or3_b32 v4, v44, v45, v4
    v_or3_b32 v4, v46, v47, v4
    v_or3_b32 v4, v48, v49, v4
    ds_add_rtn_u64 v[44:45], v24, v[64:65]
    ds_add_rtn_u64 v[46:47], v25, v[66:67]
    ds_add_rtn_u64 v[48:49], v26, v[68:69]
L_p2_kernel_noopt3_7:
    v_mbcnt_lo_u32_b32 v51, s36, 0
    v_mbcnt_hi_u32_b32 v51, s37, v51
    s_bcnt1_i32_b64 s14, s[36:37]
    v_lshl_add_u32 v55, v51, 1, s25
    ds_read_u16 v55, v55
    s_mov_b32 s36, s26
    s_movk_i32 s37, -128
    s_lshl1_add_u32 s25, s14, s25
    s_lshl_b32 s14, s14, 12
    s_add_u32 s26, s26, s14
    s_cmp_le_u32 s28, 256
    s_cbranch_scc1 L_p2_kernel_noopt3_8
    v_readlane_b32 s38, v7, 8
    v_readlane_b32 s39, v7, 9
    s_nop 1
    v_mbcnt_lo_u32_b32 v62, s38, 0
    v_mbcnt_hi_u32_b32 v62, s39, v62
    s_bcnt1_i32_b64 s14, s[38:39]
    v_lshl_add_u32 v63, v62, 1, s25
    ds_read_u16 v63, v63
    s_mov_b32 s38, s26
    s_movk_i32 s39, -64
    s_lshl1_add_u32 s25, s14, s25
    s_lshl_b32 s14, s14, 12
    s_add_u32 s26, s26, s14
L_p2_kernel_noopt3_8:
    v_bfe_i32 v108, v23, 2, 10
    v_bfe_i32 v109, v23, 12, 10
    v_ashrrev_i32 v110, 22, v23
    v_cvt_f32_i32 v108, v108
    v_cvt_f32_i32 v109, v109
    v_cvt_f32_i32 v110, v110
    v_mfma_f32_4x4x4_16b_bf16 v[112:115], v[58:59], v[82:83], 0
    v_mfma_f32_4x4x4_16b_bf16 v[116:119], v[58:59], v[84:85], 0
    v_mfma_f32_4x4x4_16b_bf16 v[120:123], v[58:59], v[86:87], 0
    v_mad_u32_u16 v20, v20, 8, s50 op_sel:[1,0,0,0]
    v_mad_u32_u16 v21, v21, 8, s50 op_sel:[1,0,0,0]
    v_mad_u32_u16 v22, v22, 8, s50 op_sel:[1,0,0,0]
    v_pk_fma_f32 v[114:115], v[114:115], v[108:109], s[20:21] op_sel:[0,0,0] op_sel_hi:[1,0,1]
    v_pk_fma_f32 v[112:113], v[112:113], v[108:109], s[16:17] op_sel:[0,0,0] op_sel_hi:[1,0,1]
    v_pk_fma_f32 v[118:119], v[118:119], v[108:109], s[20:21] op_sel:[0,1,0] op_sel_hi:[1,1,1]
    v_pk_fma_f32 v[116:117], v[116:117], v[108:109], s[16:17] op_sel:[0,1,0] op_sel_hi:[1,1,1]
    v_pk_fma_f32 v[122:123], v[122:123], v[110:111], s[20:21] op_sel:[0,0,0] op_sel_hi:[1,0,1]
    v_pk_fma_f32 v[120:121], v[120:121], v[110:111], s[16:17] op_sel:[0,0,0] op_sel_hi:[1,0,1]
    v_lshlrev_b64 v[114:115], 16, v[114:115]
    v_lshlrev_b64 v[118:119], 16, v[118:119]
    v_lshlrev_b64 v[122:123], 16, v[122:123]
    v_lshl_add_u64 v[82:83], v[112:113], 0, v[114:115]
    v_lshl_add_u64 v[84:85], v[116:117], 0, v[118:119]
    v_lshl_add_u64 v[86:87], v[120:121], 0, v[122:123]
    s_waitcnt lgkmcnt(1)
    v_or3_b32 v4, v44, v45, v4
    v_or3_b32 v4, v46, v47, v4
    v_or3_b32 v4, v48, v49, v4
    ds_add_rtn_u64 v[44:45], v20, v[82:83]
    ds_add_rtn_u64 v[46:47], v21, v[84:85]
    ds_add_rtn_u64 v[48:49], v22, v[86:87]
    s_waitcnt lgkmcnt(3)
    v_add3_u32 v55, v55, v2, s37
    v_lshl_add_u32 v51, v51, 8, v55
    v_lshrrev_b32 v55, 8, v55
    v_mad_u32_u24 v51, v55, s23, v51
    buffer_load_dwordx4 v[20:23], v51, s[44:47], s36 idxen
    s_cmp_le_u32 s28, 256
    s_cbranch_scc1 L_p2_kernel_noopt3_9
    v_add3_u32 v63, v63, v2, s39
    v_lshl_add_u32 v62, v62, 8, v63
    v_lshrrev_b32 v63, 8, v63
    v_mad_u32_u24 v62, v63, s23, v62
    buffer_load_dwordx4 v[24:27], v62, s[44:47], s38 idxen
L_p2_kernel_noopt3_9:
    s_add_u32 s14, s22, 80000
    buffer_load_dwordx4 v[88:91], v1, s[8:11], s14 offen
    s_cmp_eq_u32 s24, 7
    s_cbranch_scc1 L_p2_exit
    s_add_u32 s14, s24, 1
    s_min_u32 s14, s14, 7
    s_set_gpr_idx_on s14, gpr_idx(SRC0)
    v_mad_u32_u16 v108, v28, v50, s40 op_sel:[1,0,0,0]
    v_mad_u32_u16 v109, v36, v50, s41 op_sel:[1,0,0,0]
    s_set_gpr_idx_off
    v_sub_u32_sdwa v110, v109, v108 dst_sel:DWORD dst_unused:UNUSED_PAD src0_sel:WORD_1 src1_sel:WORD_1
    s_nop 1
    v_add_u32_dpp v110, v110, v110 row_shr:1 row_mask:0xf bank_mask:0xf bound_ctrl:0
    s_nop 1
    v_add_u32_dpp v110, v110, v110 row_shr:2 row_mask:0xf bank_mask:0xf bound_ctrl:0
    s_nop 1
    v_add_u32_dpp v110, v110, v110 row_shr:4 row_mask:0xf bank_mask:0xf bound_ctrl:0
    s_nop 1
    v_add_u32_dpp v110, v110, v110 row_shr:8 row_mask:0xf bank_mask:0xf bound_ctrl:0
    s_nop 1
    v_add_u32_dpp v110, v110, v110 row_bcast:15 row_mask:0xa bank_mask:0xf
    s_nop 1
    v_add_u32_dpp v110, v110, v110 row_bcast:31 row_mask:0xc bank_mask:0xf
    v_sub_u32_sdwa v109, v109, v110 dst_sel:DWORD dst_unused:UNUSED_PAD src0_sel:WORD_1 src1_sel:DWORD
    v_readlane_b32 s29, v110, 63
    v_add_u32 v110, -1, v110
    ds_write_b16 v126, v109
    v_lshlrev_b32_e64 v111, v110, 1
    v_lshrrev_b32 v110, 5, v110
    s_cmp_gt_u32 s29, 320
    s_cselect_b32 s2, 1, s2
    v_lshl_add_u32 v110, v110, 2, v127
    s_cselect_b64 exec, 0, -1
    ds_or_b32 v110, v111 offset:136
    s_mov_b64 exec, -1
    ds_wrxchg2_rtn_b32 v[108:109], v6, v5, v5 offset0:34 offset1:44
    s_add_u32 s14, s22, 96384
    buffer_load_dwordx4 v[92:95], v1, s[8:11], s14 offen
    s_add_u32 s24, s24, 1
    s_cmp_lt_u32 s24, 8
    s_barrier
    s_cbranch_scc1 L_p2_loop
L_p2_exit:
    s_waitcnt lgkmcnt(0)
    v_or3_b32 v4, v44, v45, v4
    v_or3_b32 v4, v46, v47, v4
    v_or3_b32 v4, v48, v49, v4
    s_mov_b32 s27, s19
    s_waitcnt vmcnt(0)
    v_mov_b64 v[64:65], v[28:29]
    v_mov_b64 v[66:67], v[30:31]
    v_mov_b64 v[68:69], v[36:37]
    v_mov_b64 v[70:71], v[38:39]
    v_mov_b32 v8, 160232
    s_cmp_lg_u32 s13, 0
    s_cselect_b64 exec, 0, 1
    ds_write_b32 v8, v52
    s_mov_b64 exec, -1
    v_subrev_u32 v6, 80000, v124
    s_mul_i32 s24, s12, 19968
    v_subrev_u32 v10, s24, v1
    v_mov_b32 v11, 0x7f000000
    s_waitcnt vmcnt(0) lgkmcnt(0)
    s_barrier
    s_cmp_lt_u32 s13, 12
    s_cbranch_scc1 L_p2_ga
L_p2_ga:
    ds_read_b32 v9, v8
    ds_read_b128 v[88:91], v1 offset:0
    ds_read_b128 v[92:95], v1 offset:16384
    ds_read_b128 v[96:99], v1 offset:32768
    ds_read_b128 v[100:103], v1 offset:49152
    ds_read_b128 v[104:107], v6
    s_mul_i32 s14, s12, 5120000
    s_mul_i32 s15, s3, 80000
    s_add_u32 s25, s14, s15
    s_add_u32 s25, s25, 230838272
    s_cmp_eq_u32 s12, 3
    s_cselect_b32 s15, 128, 0
    s_add_u32 s15, s15, 19968
    s_waitcnt lgkmcnt(5)
    v_readfirstlane_b32 s21, v9
    s_nop 0
    s_bfe_u32 s21, s21, 524296
    s_cmp_lg_u32 s21, 4
    s_cselect_b32 s21, 1, 0
    s_cselect_b32 s24, 0, s15
    v_cmp_le_u32 vcc, s24, v10
    v_add_u32 v10, 16384, v10
    s_add_u32 s14, s25, 0
    v_cndmask_b32 v12, v11, v1, vcc
    s_waitcnt lgkmcnt(4)
    buffer_store_dwordx4 v[88:91], v12, s[4:7], s14 offen sc1
    v_or3_b32 v4, v88, v89, v4
    v_or3_b32 v4, v90, v91, v4
    v_cmp_le_u32 vcc, s24, v10
    v_add_u32 v10, 16384, v10
    s_add_u32 s14, s25, 16384
    v_cndmask_b32 v12, v11, v1, vcc
    s_waitcnt lgkmcnt(3)
    buffer_store_dwordx4 v[92:95], v12, s[4:7], s14 offen sc1
    v_or3_b32 v4, v92, v93, v4
    v_or3_b32 v4, v94, v95, v4
    v_cmp_le_u32 vcc, s24, v10
    v_add_u32 v10, 16384, v10
    s_add_u32 s14, s25, 32768
    v_cndmask_b32 v12, v11, v1, vcc
    s_waitcnt lgkmcnt(2)
    buffer_store_dwordx4 v[96:99], v12, s[4:7], s14 offen sc1
    v_or3_b32 v4, v96, v97, v4
    v_or3_b32 v4, v98, v99, v4
    v_cmp_le_u32 vcc, s24, v10
    v_add_u32 v10, 16384, v10
    s_add_u32 s14, s25, 49152
    v_cndmask_b32 v12, v11, v1, vcc
    s_waitcnt lgkmcnt(1)
    buffer_store_dwordx4 v[100:103], v12, s[4:7], s14 offen sc1
    v_or3_b32 v4, v100, v101, v4
    v_or3_b32 v4, v102, v103, v4
    v_cmp_le_u32 vcc, s24, v10
    v_add_u32 v10, 16384, v10
    s_add_u32 s14, s25, 0
    v_cndmask_b32 v12, v11, v6, vcc
    s_waitcnt lgkmcnt(0)
    buffer_store_dwordx4 v[104:107], v12, s[4:7], s14 offen sc1
    v_or3_b32 v4, v104, v105, v4
    v_or3_b32 v4, v106, v107, v4
    s_load_dwordx2 s[16:17], s[0:1], 88
    s_cmp_ge_u32 s13, 12
    s_cbranch_scc1 L_p2_gb
    v_lshlrev_b32 v30, 16, v60
    v_and_b32 v31, 0xffff0000, v60
    v_lshlrev_b32 v36, 16, v53
    v_and_b32 v37, 0xffff0000, v53
    v_lshlrev_b32 v38, 16, v54
    v_and_b32 v39, 0xffff0000, v54
    v_lshlrev_b32 v40, 16, v56
    v_and_b32 v41, 0xffff0000, v56
    v_lshlrev_b32 v42, 16, v57
    v_and_b32 v43, 0xffff0000, v57
    v_pk_add_f32 v[14:15], v[30:31], v[36:37] op_sel:[0,0] op_sel_hi:[1,0] neg_lo:[0,1] neg_hi:[0,1]
    v_pk_add_f32 v[16:17], v[30:31], v[36:37] op_sel:[0,1] op_sel_hi:[1,1] neg_lo:[0,1] neg_hi:[0,1]
    v_pk_add_f32 v[18:19], v[30:31], v[38:39] op_sel:[0,0] op_sel_hi:[1,0] neg_lo:[0,1] neg_hi:[0,1]
    v_pk_add_f32 v[20:21], v[30:31], v[38:39] op_sel:[0,1] op_sel_hi:[1,1] neg_lo:[0,1] neg_hi:[0,1]
    v_pk_add_f32 v[22:23], v[30:31], v[40:41] op_sel:[0,0] op_sel_hi:[1,0] neg_lo:[0,1] neg_hi:[0,1]
    v_pk_add_f32 v[24:25], v[30:31], v[40:41] op_sel:[0,1] op_sel_hi:[1,1] neg_lo:[0,1] neg_hi:[0,1]
    v_pk_add_f32 v[26:27], v[30:31], v[42:43] op_sel:[0,0] op_sel_hi:[1,0] neg_lo:[0,1] neg_hi:[0,1]
    v_pk_add_f32 v[28:29], v[30:31], v[42:43] op_sel:[0,1] op_sel_hi:[1,1] neg_lo:[0,1] neg_hi:[0,1]
    v_cvt_pk_bf16_f32 v32, v14, v15
    v_lshlrev_b32 v14, 16, v32
    v_and_b32 v15, 0xffff0000, v32
    v_cvt_pk_bf16_f32 v32, v16, v17
    v_lshlrev_b32 v16, 16, v32
    v_and_b32 v17, 0xffff0000, v32
    v_cvt_pk_bf16_f32 v32, v18, v19
    v_lshlrev_b32 v18, 16, v32
    v_and_b32 v19, 0xffff0000, v32
    v_cvt_pk_bf16_f32 v32, v20, v21
    v_lshlrev_b32 v20, 16, v32
    v_and_b32 v21, 0xffff0000, v32
    v_cvt_pk_bf16_f32 v32, v22, v23
    v_lshlrev_b32 v22, 16, v32
    v_and_b32 v23, 0xffff0000, v32
    v_cvt_pk_bf16_f32 v32, v24, v25
    v_lshlrev_b32 v24, 16, v32
    v_and_b32 v25, 0xffff0000, v32
    v_cvt_pk_bf16_f32 v32, v26, v27
    v_lshlrev_b32 v26, 16, v32
    v_and_b32 v27, 0xffff0000, v32
    v_cvt_pk_bf16_f32 v32, v28, v29
    v_lshlrev_b32 v28, 16, v32
    v_and_b32 v29, 0xffff0000, v32
    v_pk_mul_f32 v[14:15], v[14:15], v[14:15]
    v_pk_mul_f32 v[16:17], v[16:17], v[16:17]
    v_pk_mul_f32 v[18:19], v[18:19], v[18:19]
    v_pk_mul_f32 v[20:21], v[20:21], v[20:21]
    v_pk_mul_f32 v[22:23], v[22:23], v[22:23]
    v_pk_mul_f32 v[24:25], v[24:25], v[24:25]
    v_pk_mul_f32 v[26:27], v[26:27], v[26:27]
    v_pk_mul_f32 v[28:29], v[28:29], v[28:29]
    v_cvt_pk_bf16_f32 v32, v14, v15
    v_lshlrev_b32 v14, 16, v32
    v_and_b32 v15, 0xffff0000, v32
    v_cvt_pk_bf16_f32 v32, v16, v17
    v_lshlrev_b32 v16, 16, v32
    v_and_b32 v17, 0xffff0000, v32
    v_cvt_pk_bf16_f32 v32, v18, v19
    v_lshlrev_b32 v18, 16, v32
    v_and_b32 v19, 0xffff0000, v32
    v_cvt_pk_bf16_f32 v32, v20, v21
    v_lshlrev_b32 v20, 16, v32
    v_and_b32 v21, 0xffff0000, v32
    v_cvt_pk_bf16_f32 v32, v22, v23
    v_lshlrev_b32 v22, 16, v32
    v_and_b32 v23, 0xffff0000, v32
    v_cvt_pk_bf16_f32 v32, v24, v25
    v_lshlrev_b32 v24, 16, v32
    v_and_b32 v25, 0xffff0000, v32
    v_cvt_pk_bf16_f32 v32, v26, v27
    v_lshlrev_b32 v26, 16, v32
    v_and_b32 v27, 0xffff0000, v32
    v_cvt_pk_bf16_f32 v32, v28, v29
    v_lshlrev_b32 v28, 16, v32
    v_and_b32 v29, 0xffff0000, v32
    v_mov_b32 v30, 1092616192
    v_mov_b32 v31, 0x3fb8aa3b
    v_pk_mul_f32 v[14:15], v[14:15], v[30:31] op_sel:[0,0] op_sel_hi:[1,0]
    v_pk_mul_f32 v[16:17], v[16:17], v[30:31] op_sel:[0,0] op_sel_hi:[1,0]
    v_pk_mul_f32 v[18:19], v[18:19], v[30:31] op_sel:[0,0] op_sel_hi:[1,0]
    v_pk_mul_f32 v[20:21], v[20:21], v[30:31] op_sel:[0,0] op_sel_hi:[1,0]
    v_pk_mul_f32 v[22:23], v[22:23], v[30:31] op_sel:[0,0] op_sel_hi:[1,0]
    v_pk_mul_f32 v[24:25], v[24:25], v[30:31] op_sel:[0,0] op_sel_hi:[1,0]
    v_pk_mul_f32 v[26:27], v[26:27], v[30:31] op_sel:[0,0] op_sel_hi:[1,0]
    v_pk_mul_f32 v[28:29], v[28:29], v[30:31] op_sel:[0,0] op_sel_hi:[1,0]
    v_cvt_pk_bf16_f32 v32, v14, v15
    v_lshlrev_b32 v14, 16, v32
    v_and_b32 v15, 0xffff0000, v32
    v_cvt_pk_bf16_f32 v32, v16, v17
    v_lshlrev_b32 v16, 16, v32
    v_and_b32 v17, 0xffff0000, v32
    v_cvt_pk_bf16_f32 v32, v18, v19
    v_lshlrev_b32 v18, 16, v32
    v_and_b32 v19, 0xffff0000, v32
    v_cvt_pk_bf16_f32 v32, v20, v21
    v_lshlrev_b32 v20, 16, v32
    v_and_b32 v21, 0xffff0000, v32
    v_cvt_pk_bf16_f32 v32, v22, v23
    v_lshlrev_b32 v22, 16, v32
    v_and_b32 v23, 0xffff0000, v32
    v_cvt_pk_bf16_f32 v32, v24, v25
    v_lshlrev_b32 v24, 16, v32
    v_and_b32 v25, 0xffff0000, v32
    v_cvt_pk_bf16_f32 v32, v26, v27
    v_lshlrev_b32 v26, 16, v32
    v_and_b32 v27, 0xffff0000, v32
    v_cvt_pk_bf16_f32 v32, v28, v29
    v_lshlrev_b32 v28, 16, v32
    v_and_b32 v29, 0xffff0000, v32
    v_pk_mul_f32 v[14:15], v[14:15], v[30:31] op_sel:[0,1] op_sel_hi:[1,1]
    v_pk_mul_f32 v[16:17], v[16:17], v[30:31] op_sel:[0,1] op_sel_hi:[1,1]
    v_pk_mul_f32 v[18:19], v[18:19], v[30:31] op_sel:[0,1] op_sel_hi:[1,1]
    v_pk_mul_f32 v[20:21], v[20:21], v[30:31] op_sel:[0,1] op_sel_hi:[1,1]
    v_pk_mul_f32 v[22:23], v[22:23], v[30:31] op_sel:[0,1] op_sel_hi:[1,1]
    v_pk_mul_f32 v[24:25], v[24:25], v[30:31] op_sel:[0,1] op_sel_hi:[1,1]
    v_pk_mul_f32 v[26:27], v[26:27], v[30:31] op_sel:[0,1] op_sel_hi:[1,1]
    v_pk_mul_f32 v[28:29], v[28:29], v[30:31] op_sel:[0,1] op_sel_hi:[1,1]
    v_exp_f32 v14, -v14
    v_exp_f32 v15, -v15
    v_exp_f32 v16, -v16
    v_exp_f32 v17, -v17
    v_exp_f32 v18, -v18
    v_exp_f32 v19, -v19
    v_exp_f32 v20, -v20
    v_exp_f32 v21, -v21
    v_exp_f32 v22, -v22
    v_exp_f32 v23, -v23
    v_exp_f32 v24, -v24
    v_exp_f32 v25, -v25
    v_exp_f32 v26, -v26
    v_exp_f32 v27, -v27
    v_exp_f32 v28, -v28
    v_exp_f32 v29, -v29
    v_cvt_pk_bf16_f32 v14, v14, v16
    v_cvt_pk_bf16_f32 v15, v15, v17
    v_cvt_pk_bf16_f32 v18, v18, v20
    v_cvt_pk_bf16_f32 v19, v19, v21
    v_cvt_pk_bf16_f32 v22, v22, v24
    v_cvt_pk_bf16_f32 v23, v23, v25
    v_cvt_pk_bf16_f32 v26, v26, v28
    v_cvt_pk_bf16_f32 v27, v27, v29
    v_dot2_f32_bf16 v72, v14, s68, 0
    v_dot2_f32_bf16 v73, v15, s68, 0
    v_dot2_f32_bf16 v74, v14, s69, 0
    v_dot2_f32_bf16 v75, v15, s69, 0
    v_dot2_f32_bf16 v76, v14, s70, 0
    v_dot2_f32_bf16 v77, v15, s70, 0
    v_dot2_f32_bf16 v78, v14, s71, 0
    v_dot2_f32_bf16 v79, v15, s71, 0
    v_dot2_f32_bf16 v80, v14, s52, 0
    v_dot2_f32_bf16 v81, v15, s52, 0
    v_dot2_f32_bf16 v82, v14, s53, 0
    v_dot2_f32_bf16 v83, v15, s53, 0
    v_dot2_f32_bf16 v84, v14, s54, 0
    v_dot2_f32_bf16 v85, v15, s54, 0
    v_dot2_f32_bf16 v86, v14, s55, 0
    v_dot2_f32_bf16 v87, v15, s55, 0
    v_dot2_f32_bf16 v72, v18, s72, v72
    v_dot2_f32_bf16 v73, v19, s72, v73
    v_dot2_f32_bf16 v74, v18, s73, v74
    v_dot2_f32_bf16 v75, v19, s73, v75
    v_dot2_f32_bf16 v76, v18, s74, v76
    v_dot2_f32_bf16 v77, v19, s74, v77
    v_dot2_f32_bf16 v78, v18, s75, v78
    v_dot2_f32_bf16 v79, v19, s75, v79
    v_dot2_f32_bf16 v80, v18, s56, v80
    v_dot2_f32_bf16 v81, v19, s56, v81
    v_dot2_f32_bf16 v82, v18, s57, v82
    v_dot2_f32_bf16 v83, v19, s57, v83
    v_dot2_f32_bf16 v84, v18, s58, v84
    v_dot2_f32_bf16 v85, v19, s58, v85
    v_dot2_f32_bf16 v86, v18, s59, v86
    v_dot2_f32_bf16 v87, v19, s59, v87
    v_dot2_f32_bf16 v72, v22, s76, v72
    v_dot2_f32_bf16 v73, v23, s76, v73
    v_dot2_f32_bf16 v74, v22, s77, v74
    v_dot2_f32_bf16 v75, v23, s77, v75
    v_dot2_f32_bf16 v76, v22, s78, v76
    v_dot2_f32_bf16 v77, v23, s78, v77
    v_dot2_f32_bf16 v78, v22, s79, v78
    v_dot2_f32_bf16 v79, v23, s79, v79
    v_dot2_f32_bf16 v80, v22, s60, v80
    v_dot2_f32_bf16 v81, v23, s60, v81
    v_dot2_f32_bf16 v82, v22, s61, v82
    v_dot2_f32_bf16 v83, v23, s61, v83
    v_dot2_f32_bf16 v84, v22, s62, v84
    v_dot2_f32_bf16 v85, v23, s62, v85
    v_dot2_f32_bf16 v86, v22, s63, v86
    v_dot2_f32_bf16 v87, v23, s63, v87
    v_dot2_f32_bf16 v72, v26, s80, v72
    v_dot2_f32_bf16 v73, v27, s80, v73
    v_dot2_f32_bf16 v74, v26, s81, v74
    v_dot2_f32_bf16 v75, v27, s81, v75
    v_dot2_f32_bf16 v76, v26, s82, v76
    v_dot2_f32_bf16 v77, v27, s82, v77
    v_dot2_f32_bf16 v78, v26, s83, v78
    v_dot2_f32_bf16 v79, v27, s83, v79
    v_dot2_f32_bf16 v80, v26, s64, v80
    v_dot2_f32_bf16 v81, v27, s64, v81
    v_dot2_f32_bf16 v82, v26, s65, v82
    v_dot2_f32_bf16 v83, v27, s65, v83
    v_dot2_f32_bf16 v84, v26, s66, v84
    v_dot2_f32_bf16 v85, v27, s66, v85
    v_dot2_f32_bf16 v86, v26, s67, v86
    v_dot2_f32_bf16 v87, v27, s67, v87
L_p2_gb:
    v_and_b32 v4, 0x80008000, v4
    v_cmp_ne_u32 vcc, 0, v4
    v_mov_b32 v8, s27
    v_and_b32 v10, 15, v0
    v_mul_u32_u24 v10, 240, v10
    v_add_u32 v10, 160000, v10
    s_cmp_lg_u64 vcc, 0
    s_cselect_b32 s2, 1, s2
    v_mov_b32 v9, s2
    s_mov_b64 exec, 1
    ds_write_b32 v8, v9
    s_mov_b64 exec, -1
    s_mov_b32 s49, s12
    s_mov_b32 s51, 0
    s_waitcnt vmcnt(0) lgkmcnt(0)
    s_barrier
    ds_read_b32 v9, v10
    s_mov_b32 s18, 5120000
    s_mov_b32 s19, 0x00020000
    s_waitcnt lgkmcnt(0)
    v_cmp_ne_u32 vcc, 0, v9
    s_nop 1
    s_cmp_lg_u64 vcc, 0
    s_cselect_b32 s2, 1, 0
    s_cbranch_scc1 L_p2_slow
L_p2_signal:
    v_mov_b32 v8, 160228
    s_lshl_b32 s15, s2, 4
    s_or_b32 s15, s15, s21
    s_add_u32 s14, s12, 16
    s_lshl_b32 s20, s15, s14
    s_add_u32 s20, s20, 1
    v_mov_b32 v9, s20
    s_cmp_lg_u32 s13, 15
    s_cbranch_scc1 L_p2_nosig0
    s_lshl_b32 s14, s3, 8
    s_add_u32 s14, s14, 230821888
    s_mov_b64 exec, 1
    buffer_atomic_add v9, off, s[4:7], s14 sc0
    s_mov_b64 exec, -1
L_p2_nosig0:
    s_cmp_eq_u32 s49, 3
    s_cselect_b32 s15, 8, 0
    s_add_u32 s15, s15, 224
    v_add_u32 v2, 16384, v1
    v_cmp_gt_u32 vcc, s15, v0
    s_mul_i32 s14, s3, 80000
    s_mul_i32 s26, s49, 19968
    s_add_u32 s26, s26, s14
    v_cndmask_b32 v2, 0.5, v2, vcc
    s_mov_b32 s10, 5120000
    s_lshl_b32 s28, s92, 16
    s_and_b32 s29, s92, 0xffff0000
    s_lshl_b32 s30, s93, 16
    s_and_b32 s31, s93, 0xffff0000
    s_lshl_b32 s32, s94, 16
    s_and_b32 s33, s94, 0xffff0000
    s_lshl_b32 s34, s95, 16
    s_and_b32 s35, s95, 0xffff0000
    s_lshl_b32 s36, s96, 16
    s_and_b32 s37, s96, 0xffff0000
    s_lshl_b32 s38, s97, 16
    s_and_b32 s39, s97, 0xffff0000
    s_lshl_b32 s40, s98, 16
    s_and_b32 s41, s98, 0xffff0000
    s_lshl_b32 s42, s99, 16
    s_and_b32 s43, s99, 0xffff0000
    s_and_b32 s99, s91, 0xffff0000
    s_lshl_b32 s98, s91, 16
    s_and_b32 s97, s90, 0xffff0000
    s_lshl_b32 s96, s90, 16
    s_and_b32 s95, s89, 0xffff0000
    s_lshl_b32 s94, s89, 16
    s_and_b32 s93, s88, 0xffff0000
    s_lshl_b32 s92, s88, 16
    s_and_b32 s91, s87, 0xffff0000
    s_lshl_b32 s90, s87, 16
    s_and_b32 s89, s86, 0xffff0000
    s_lshl_b32 s88, s86, 16
    s_and_b32 s87, s85, 0xffff0000
    s_lshl_b32 s86, s85, 16
    s_and_b32 s85, s84, 0xffff0000
    s_lshl_b32 s84, s84, 16
    s_mov_b32 s44, s48
    s_add_u32 s45, s48, 2281701376
    s_cmp_eq_u32 s48, 0
    s_cselect_b32 s45, 0, s45
    s_cmp_lt_u32 s13, 12
    s_cbranch_scc1 L_p2_gc
    v_lshlrev_b32 v30, 16, v60
    v_and_b32 v31, 0xffff0000, v60
    v_lshlrev_b32 v36, 16, v53
    v_and_b32 v37, 0xffff0000, v53
    v_lshlrev_b32 v38, 16, v54
    v_and_b32 v39, 0xffff0000, v54
    v_lshlrev_b32 v40, 16, v56
    v_and_b32 v41, 0xffff0000, v56
    v_lshlrev_b32 v42, 16, v57
    v_and_b32 v43, 0xffff0000, v57
    v_pk_add_f32 v[14:15], v[30:31], v[36:37] op_sel:[0,0] op_sel_hi:[1,0] neg_lo:[0,1] neg_hi:[0,1]
    v_pk_add_f32 v[16:17], v[30:31], v[36:37] op_sel:[0,1] op_sel_hi:[1,1] neg_lo:[0,1] neg_hi:[0,1]
    v_pk_add_f32 v[18:19], v[30:31], v[38:39] op_sel:[0,0] op_sel_hi:[1,0] neg_lo:[0,1] neg_hi:[0,1]
    v_pk_add_f32 v[20:21], v[30:31], v[38:39] op_sel:[0,1] op_sel_hi:[1,1] neg_lo:[0,1] neg_hi:[0,1]
    v_pk_add_f32 v[22:23], v[30:31], v[40:41] op_sel:[0,0] op_sel_hi:[1,0] neg_lo:[0,1] neg_hi:[0,1]
    v_pk_add_f32 v[24:25], v[30:31], v[40:41] op_sel:[0,1] op_sel_hi:[1,1] neg_lo:[0,1] neg_hi:[0,1]
    v_pk_add_f32 v[26:27], v[30:31], v[42:43] op_sel:[0,0] op_sel_hi:[1,0] neg_lo:[0,1] neg_hi:[0,1]
    v_pk_add_f32 v[28:29], v[30:31], v[42:43] op_sel:[0,1] op_sel_hi:[1,1] neg_lo:[0,1] neg_hi:[0,1]
    v_cvt_pk_bf16_f32 v32, v14, v15
    v_lshlrev_b32 v14, 16, v32
    v_and_b32 v15, 0xffff0000, v32
    v_cvt_pk_bf16_f32 v32, v16, v17
    v_lshlrev_b32 v16, 16, v32
    v_and_b32 v17, 0xffff0000, v32
    v_cvt_pk_bf16_f32 v32, v18, v19
    v_lshlrev_b32 v18, 16, v32
    v_and_b32 v19, 0xffff0000, v32
    v_cvt_pk_bf16_f32 v32, v20, v21
    v_lshlrev_b32 v20, 16, v32
    v_and_b32 v21, 0xffff0000, v32
    v_cvt_pk_bf16_f32 v32, v22, v23
    v_lshlrev_b32 v22, 16, v32
    v_and_b32 v23, 0xffff0000, v32
    v_cvt_pk_bf16_f32 v32, v24, v25
    v_lshlrev_b32 v24, 16, v32
    v_and_b32 v25, 0xffff0000, v32
    v_cvt_pk_bf16_f32 v32, v26, v27
    v_lshlrev_b32 v26, 16, v32
    v_and_b32 v27, 0xffff0000, v32
    v_cvt_pk_bf16_f32 v32, v28, v29
    v_lshlrev_b32 v28, 16, v32
    v_and_b32 v29, 0xffff0000, v32
    v_pk_mul_f32 v[14:15], v[14:15], v[14:15]
    v_pk_mul_f32 v[16:17], v[16:17], v[16:17]
    v_pk_mul_f32 v[18:19], v[18:19], v[18:19]
    v_pk_mul_f32 v[20:21], v[20:21], v[20:21]
    v_pk_mul_f32 v[22:23], v[22:23], v[22:23]
    v_pk_mul_f32 v[24:25], v[24:25], v[24:25]
    v_pk_mul_f32 v[26:27], v[26:27], v[26:27]
    v_pk_mul_f32 v[28:29], v[28:29], v[28:29]
    v_cvt_pk_bf16_f32 v32, v14, v15
    v_lshlrev_b32 v14, 16, v32
    v_and_b32 v15, 0xffff0000, v32
    v_cvt_pk_bf16_f32 v32, v16, v17
    v_lshlrev_b32 v16, 16, v32
    v_and_b32 v17, 0xffff0000, v32
    v_cvt_pk_bf16_f32 v32, v18, v19
    v_lshlrev_b32 v18, 16, v32
    v_and_b32 v19, 0xffff0000, v32
    v_cvt_pk_bf16_f32 v32, v20, v21
    v_lshlrev_b32 v20, 16, v32
    v_and_b32 v21, 0xffff0000, v32
    v_cvt_pk_bf16_f32 v32, v22, v23
    v_lshlrev_b32 v22, 16, v32
    v_and_b32 v23, 0xffff0000, v32
    v_cvt_pk_bf16_f32 v32, v24, v25
    v_lshlrev_b32 v24, 16, v32
    v_and_b32 v25, 0xffff0000, v32
    v_cvt_pk_bf16_f32 v32, v26, v27
    v_lshlrev_b32 v26, 16, v32
    v_and_b32 v27, 0xffff0000, v32
    v_cvt_pk_bf16_f32 v32, v28, v29
    v_lshlrev_b32 v28, 16, v32
    v_and_b32 v29, 0xffff0000, v32
    v_mov_b32 v30, 1092616192
    v_mov_b32 v31, 0x3fb8aa3b
    v_pk_mul_f32 v[14:15], v[14:15], v[30:31] op_sel:[0,0] op_sel_hi:[1,0]
    v_pk_mul_f32 v[16:17], v[16:17], v[30:31] op_sel:[0,0] op_sel_hi:[1,0]
    v_pk_mul_f32 v[18:19], v[18:19], v[30:31] op_sel:[0,0] op_sel_hi:[1,0]
    v_pk_mul_f32 v[20:21], v[20:21], v[30:31] op_sel:[0,0] op_sel_hi:[1,0]
    v_pk_mul_f32 v[22:23], v[22:23], v[30:31] op_sel:[0,0] op_sel_hi:[1,0]
    v_pk_mul_f32 v[24:25], v[24:25], v[30:31] op_sel:[0,0] op_sel_hi:[1,0]
    v_pk_mul_f32 v[26:27], v[26:27], v[30:31] op_sel:[0,0] op_sel_hi:[1,0]
    v_pk_mul_f32 v[28:29], v[28:29], v[30:31] op_sel:[0,0] op_sel_hi:[1,0]
    v_cvt_pk_bf16_f32 v32, v14, v15
    v_lshlrev_b32 v14, 16, v32
    v_and_b32 v15, 0xffff0000, v32
    v_cvt_pk_bf16_f32 v32, v16, v17
    v_lshlrev_b32 v16, 16, v32
    v_and_b32 v17, 0xffff0000, v32
    v_cvt_pk_bf16_f32 v32, v18, v19
    v_lshlrev_b32 v18, 16, v32
    v_and_b32 v19, 0xffff0000, v32
    v_cvt_pk_bf16_f32 v32, v20, v21
    v_lshlrev_b32 v20, 16, v32
    v_and_b32 v21, 0xffff0000, v32
    v_cvt_pk_bf16_f32 v32, v22, v23
    v_lshlrev_b32 v22, 16, v32
    v_and_b32 v23, 0xffff0000, v32
    v_cvt_pk_bf16_f32 v32, v24, v25
    v_lshlrev_b32 v24, 16, v32
    v_and_b32 v25, 0xffff0000, v32
    v_cvt_pk_bf16_f32 v32, v26, v27
    v_lshlrev_b32 v26, 16, v32
    v_and_b32 v27, 0xffff0000, v32
    v_cvt_pk_bf16_f32 v32, v28, v29
    v_lshlrev_b32 v28, 16, v32
    v_and_b32 v29, 0xffff0000, v32
    v_pk_mul_f32 v[14:15], v[14:15], v[30:31] op_sel:[0,1] op_sel_hi:[1,1]
    v_pk_mul_f32 v[16:17], v[16:17], v[30:31] op_sel:[0,1] op_sel_hi:[1,1]
    v_pk_mul_f32 v[18:19], v[18:19], v[30:31] op_sel:[0,1] op_sel_hi:[1,1]
    v_pk_mul_f32 v[20:21], v[20:21], v[30:31] op_sel:[0,1] op_sel_hi:[1,1]
    v_pk_mul_f32 v[22:23], v[22:23], v[30:31] op_sel:[0,1] op_sel_hi:[1,1]
    v_pk_mul_f32 v[24:25], v[24:25], v[30:31] op_sel:[0,1] op_sel_hi:[1,1]
    v_pk_mul_f32 v[26:27], v[26:27], v[30:31] op_sel:[0,1] op_sel_hi:[1,1]
    v_pk_mul_f32 v[28:29], v[28:29], v[30:31] op_sel:[0,1] op_sel_hi:[1,1]
    v_exp_f32 v14, -v14
    v_exp_f32 v15, -v15
    v_exp_f32 v16, -v16
    v_exp_f32 v17, -v17
    v_exp_f32 v18, -v18
    v_exp_f32 v19, -v19
    v_exp_f32 v20, -v20
    v_exp_f32 v21, -v21
    v_exp_f32 v22, -v22
    v_exp_f32 v23, -v23
    v_exp_f32 v24, -v24
    v_exp_f32 v25, -v25
    v_exp_f32 v26, -v26
    v_exp_f32 v27, -v27
    v_exp_f32 v28, -v28
    v_exp_f32 v29, -v29
    v_cvt_pk_bf16_f32 v14, v14, v16
    v_cvt_pk_bf16_f32 v15, v15, v17
    v_cvt_pk_bf16_f32 v18, v18, v20
    v_cvt_pk_bf16_f32 v19, v19, v21
    v_cvt_pk_bf16_f32 v22, v22, v24
    v_cvt_pk_bf16_f32 v23, v23, v25
    v_cvt_pk_bf16_f32 v26, v26, v28
    v_cvt_pk_bf16_f32 v27, v27, v29
    v_dot2_f32_bf16 v72, v14, s68, 0
    v_dot2_f32_bf16 v73, v15, s68, 0
    v_dot2_f32_bf16 v74, v14, s69, 0
    v_dot2_f32_bf16 v75, v15, s69, 0
    v_dot2_f32_bf16 v76, v14, s70, 0
    v_dot2_f32_bf16 v77, v15, s70, 0
    v_dot2_f32_bf16 v78, v14, s71, 0
    v_dot2_f32_bf16 v79, v15, s71, 0
    v_dot2_f32_bf16 v80, v14, s52, 0
    v_dot2_f32_bf16 v81, v15, s52, 0
    v_dot2_f32_bf16 v82, v14, s53, 0
    v_dot2_f32_bf16 v83, v15, s53, 0
    v_dot2_f32_bf16 v84, v14, s54, 0
    v_dot2_f32_bf16 v85, v15, s54, 0
    v_dot2_f32_bf16 v86, v14, s55, 0
    v_dot2_f32_bf16 v87, v15, s55, 0
    v_dot2_f32_bf16 v72, v18, s72, v72
    v_dot2_f32_bf16 v73, v19, s72, v73
    v_dot2_f32_bf16 v74, v18, s73, v74
    v_dot2_f32_bf16 v75, v19, s73, v75
    v_dot2_f32_bf16 v76, v18, s74, v76
    v_dot2_f32_bf16 v77, v19, s74, v77
    v_dot2_f32_bf16 v78, v18, s75, v78
    v_dot2_f32_bf16 v79, v19, s75, v79
    v_dot2_f32_bf16 v80, v18, s56, v80
    v_dot2_f32_bf16 v81, v19, s56, v81
    v_dot2_f32_bf16 v82, v18, s57, v82
    v_dot2_f32_bf16 v83, v19, s57, v83
    v_dot2_f32_bf16 v84, v18, s58, v84
    v_dot2_f32_bf16 v85, v19, s58, v85
    v_dot2_f32_bf16 v86, v18, s59, v86
    v_dot2_f32_bf16 v87, v19, s59, v87
    v_dot2_f32_bf16 v72, v22, s76, v72
    v_dot2_f32_bf16 v73, v23, s76, v73
    v_dot2_f32_bf16 v74, v22, s77, v74
    v_dot2_f32_bf16 v75, v23, s77, v75
    v_dot2_f32_bf16 v76, v22, s78, v76
    v_dot2_f32_bf16 v77, v23, s78, v77
    v_dot2_f32_bf16 v78, v22, s79, v78
    v_dot2_f32_bf16 v79, v23, s79, v79
    v_dot2_f32_bf16 v80, v22, s60, v80
    v_dot2_f32_bf16 v81, v23, s60, v81
    v_dot2_f32_bf16 v82, v22, s61, v82
    v_dot2_f32_bf16 v83, v23, s61, v83
    v_dot2_f32_bf16 v84, v22, s62, v84
    v_dot2_f32_bf16 v85, v23, s62, v85
    v_dot2_f32_bf16 v86, v22, s63, v86
    v_dot2_f32_bf16 v87, v23, s63, v87
    v_dot2_f32_bf16 v72, v26, s80, v72
    v_dot2_f32_bf16 v73, v27, s80, v73
    v_dot2_f32_bf16 v74, v26, s81, v74
    v_dot2_f32_bf16 v75, v27, s81, v75
    v_dot2_f32_bf16 v76, v26, s82, v76
    v_dot2_f32_bf16 v77, v27, s82, v77
    v_dot2_f32_bf16 v78, v26, s83, v78
    v_dot2_f32_bf16 v79, v27, s83, v79
    v_dot2_f32_bf16 v80, v26, s64, v80
    v_dot2_f32_bf16 v81, v27, s64, v81
    v_dot2_f32_bf16 v82, v26, s65, v82
    v_dot2_f32_bf16 v83, v27, s65, v83
    v_dot2_f32_bf16 v84, v26, s66, v84
    v_dot2_f32_bf16 v85, v27, s66, v85
    v_dot2_f32_bf16 v86, v26, s67, v86
    v_dot2_f32_bf16 v87, v27, s67, v87
L_p2_gc:
    s_cmp_ge_u32 s13, 4
    s_cbranch_scc1 L_p2_gd
    v_lshlrev_b32 v30, 16, v61
    v_and_b32 v31, 0xffff0000, v61
    v_pk_add_f32 v[14:15], v[30:31], v[36:37] op_sel:[0,0] op_sel_hi:[1,0] neg_lo:[0,1] neg_hi:[0,1]
    v_pk_add_f32 v[16:17], v[30:31], v[36:37] op_sel:[0,1] op_sel_hi:[1,1] neg_lo:[0,1] neg_hi:[0,1]
    v_pk_add_f32 v[18:19], v[30:31], v[38:39] op_sel:[0,0] op_sel_hi:[1,0] neg_lo:[0,1] neg_hi:[0,1]
    v_pk_add_f32 v[20:21], v[30:31], v[38:39] op_sel:[0,1] op_sel_hi:[1,1] neg_lo:[0,1] neg_hi:[0,1]
    v_pk_add_f32 v[22:23], v[30:31], v[40:41] op_sel:[0,0] op_sel_hi:[1,0] neg_lo:[0,1] neg_hi:[0,1]
    v_pk_add_f32 v[24:25], v[30:31], v[40:41] op_sel:[0,1] op_sel_hi:[1,1] neg_lo:[0,1] neg_hi:[0,1]
    v_pk_add_f32 v[26:27], v[30:31], v[42:43] op_sel:[0,0] op_sel_hi:[1,0] neg_lo:[0,1] neg_hi:[0,1]
    v_pk_add_f32 v[28:29], v[30:31], v[42:43] op_sel:[0,1] op_sel_hi:[1,1] neg_lo:[0,1] neg_hi:[0,1]
    v_cvt_pk_bf16_f32 v32, v14, v15
    v_lshlrev_b32 v14, 16, v32
    v_and_b32 v15, 0xffff0000, v32
    v_cvt_pk_bf16_f32 v32, v16, v17
    v_lshlrev_b32 v16, 16, v32
    v_and_b32 v17, 0xffff0000, v32
    v_cvt_pk_bf16_f32 v32, v18, v19
    v_lshlrev_b32 v18, 16, v32
    v_and_b32 v19, 0xffff0000, v32
    v_cvt_pk_bf16_f32 v32, v20, v21
    v_lshlrev_b32 v20, 16, v32
    v_and_b32 v21, 0xffff0000, v32
    v_cvt_pk_bf16_f32 v32, v22, v23
    v_lshlrev_b32 v22, 16, v32
    v_and_b32 v23, 0xffff0000, v32
    v_cvt_pk_bf16_f32 v32, v24, v25
    v_lshlrev_b32 v24, 16, v32
    v_and_b32 v25, 0xffff0000, v32
    v_cvt_pk_bf16_f32 v32, v26, v27
    v_lshlrev_b32 v26, 16, v32
    v_and_b32 v27, 0xffff0000, v32
    v_cvt_pk_bf16_f32 v32, v28, v29
    v_lshlrev_b32 v28, 16, v32
    v_and_b32 v29, 0xffff0000, v32
    v_pk_mul_f32 v[14:15], v[14:15], v[14:15]
    v_pk_mul_f32 v[16:17], v[16:17], v[16:17]
    v_pk_mul_f32 v[18:19], v[18:19], v[18:19]
    v_pk_mul_f32 v[20:21], v[20:21], v[20:21]
    v_pk_mul_f32 v[22:23], v[22:23], v[22:23]
    v_pk_mul_f32 v[24:25], v[24:25], v[24:25]
    v_pk_mul_f32 v[26:27], v[26:27], v[26:27]
    v_pk_mul_f32 v[28:29], v[28:29], v[28:29]
    v_cvt_pk_bf16_f32 v32, v14, v15
    v_lshlrev_b32 v14, 16, v32
    v_and_b32 v15, 0xffff0000, v32
    v_cvt_pk_bf16_f32 v32, v16, v17
    v_lshlrev_b32 v16, 16, v32
    v_and_b32 v17, 0xffff0000, v32
    v_cvt_pk_bf16_f32 v32, v18, v19
    v_lshlrev_b32 v18, 16, v32
    v_and_b32 v19, 0xffff0000, v32
    v_cvt_pk_bf16_f32 v32, v20, v21
    v_lshlrev_b32 v20, 16, v32
    v_and_b32 v21, 0xffff0000, v32
    v_cvt_pk_bf16_f32 v32, v22, v23
    v_lshlrev_b32 v22, 16, v32
    v_and_b32 v23, 0xffff0000, v32
    v_cvt_pk_bf16_f32 v32, v24, v25
    v_lshlrev_b32 v24, 16, v32
    v_and_b32 v25, 0xffff0000, v32
    v_cvt_pk_bf16_f32 v32, v26, v27
    v_lshlrev_b32 v26, 16, v32
    v_and_b32 v27, 0xffff0000, v32
    v_cvt_pk_bf16_f32 v32, v28, v29
    v_lshlrev_b32 v28, 16, v32
    v_and_b32 v29, 0xffff0000, v32
    v_mov_b32 v30, 1092616192
    v_mov_b32 v31, 0x3fb8aa3b
    v_pk_mul_f32 v[14:15], v[14:15], v[30:31] op_sel:[0,0] op_sel_hi:[1,0]
    v_pk_mul_f32 v[16:17], v[16:17], v[30:31] op_sel:[0,0] op_sel_hi:[1,0]
    v_pk_mul_f32 v[18:19], v[18:19], v[30:31] op_sel:[0,0] op_sel_hi:[1,0]
    v_pk_mul_f32 v[20:21], v[20:21], v[30:31] op_sel:[0,0] op_sel_hi:[1,0]
    v_pk_mul_f32 v[22:23], v[22:23], v[30:31] op_sel:[0,0] op_sel_hi:[1,0]
    v_pk_mul_f32 v[24:25], v[24:25], v[30:31] op_sel:[0,0] op_sel_hi:[1,0]
    v_pk_mul_f32 v[26:27], v[26:27], v[30:31] op_sel:[0,0] op_sel_hi:[1,0]
    v_pk_mul_f32 v[28:29], v[28:29], v[30:31] op_sel:[0,0] op_sel_hi:[1,0]
    v_cvt_pk_bf16_f32 v32, v14, v15
    v_lshlrev_b32 v14, 16, v32
    v_and_b32 v15, 0xffff0000, v32
    v_cvt_pk_bf16_f32 v32, v16, v17
    v_lshlrev_b32 v16, 16, v32
    v_and_b32 v17, 0xffff0000, v32
    v_cvt_pk_bf16_f32 v32, v18, v19
    v_lshlrev_b32 v18, 16, v32
    v_and_b32 v19, 0xffff0000, v32
    v_cvt_pk_bf16_f32 v32, v20, v21
    v_lshlrev_b32 v20, 16, v32
    v_and_b32 v21, 0xffff0000, v32
    v_cvt_pk_bf16_f32 v32, v22, v23
    v_lshlrev_b32 v22, 16, v32
    v_and_b32 v23, 0xffff0000, v32
    v_cvt_pk_bf16_f32 v32, v24, v25
    v_lshlrev_b32 v24, 16, v32
    v_and_b32 v25, 0xffff0000, v32
    v_cvt_pk_bf16_f32 v32, v26, v27
    v_lshlrev_b32 v26, 16, v32
    v_and_b32 v27, 0xffff0000, v32
    v_cvt_pk_bf16_f32 v32, v28, v29
    v_lshlrev_b32 v28, 16, v32
    v_and_b32 v29, 0xffff0000, v32
    v_pk_mul_f32 v[14:15], v[14:15], v[30:31] op_sel:[0,1] op_sel_hi:[1,1]
    v_pk_mul_f32 v[16:17], v[16:17], v[30:31] op_sel:[0,1] op_sel_hi:[1,1]
    v_pk_mul_f32 v[18:19], v[18:19], v[30:31] op_sel:[0,1] op_sel_hi:[1,1]
    v_pk_mul_f32 v[20:21], v[20:21], v[30:31] op_sel:[0,1] op_sel_hi:[1,1]
    v_pk_mul_f32 v[22:23], v[22:23], v[30:31] op_sel:[0,1] op_sel_hi:[1,1]
    v_pk_mul_f32 v[24:25], v[24:25], v[30:31] op_sel:[0,1] op_sel_hi:[1,1]
    v_pk_mul_f32 v[26:27], v[26:27], v[30:31] op_sel:[0,1] op_sel_hi:[1,1]
    v_pk_mul_f32 v[28:29], v[28:29], v[30:31] op_sel:[0,1] op_sel_hi:[1,1]
    v_exp_f32 v14, -v14
    v_exp_f32 v15, -v15
    v_exp_f32 v16, -v16
    v_exp_f32 v17, -v17
    v_exp_f32 v18, -v18
    v_exp_f32 v19, -v19
    v_exp_f32 v20, -v20
    v_exp_f32 v21, -v21
    v_exp_f32 v22, -v22
    v_exp_f32 v23, -v23
    v_exp_f32 v24, -v24
    v_exp_f32 v25, -v25
    v_exp_f32 v26, -v26
    v_exp_f32 v27, -v27
    v_exp_f32 v28, -v28
    v_exp_f32 v29, -v29
    v_cvt_pk_bf16_f32 v14, v14, v16
    v_cvt_pk_bf16_f32 v15, v15, v17
    v_cvt_pk_bf16_f32 v18, v18, v20
    v_cvt_pk_bf16_f32 v19, v19, v21
    v_cvt_pk_bf16_f32 v22, v22, v24
    v_cvt_pk_bf16_f32 v23, v23, v25
    v_cvt_pk_bf16_f32 v26, v26, v28
    v_cvt_pk_bf16_f32 v27, v27, v29
    v_dot2_f32_bf16 v112, v14, s68, 0
    v_dot2_f32_bf16 v113, v15, s68, 0
    v_dot2_f32_bf16 v114, v14, s69, 0
    v_dot2_f32_bf16 v115, v15, s69, 0
    v_dot2_f32_bf16 v116, v14, s70, 0
    v_dot2_f32_bf16 v117, v15, s70, 0
    v_dot2_f32_bf16 v118, v14, s71, 0
    v_dot2_f32_bf16 v119, v15, s71, 0
    v_dot2_f32_bf16 v120, v14, s52, 0
    v_dot2_f32_bf16 v121, v15, s52, 0
    v_dot2_f32_bf16 v122, v14, s53, 0
    v_dot2_f32_bf16 v123, v15, s53, 0
    v_dot2_f32_bf16 v124, v14, s54, 0
    v_dot2_f32_bf16 v125, v15, s54, 0
    v_dot2_f32_bf16 v126, v14, s55, 0
    v_dot2_f32_bf16 v127, v15, s55, 0
    v_dot2_f32_bf16 v112, v18, s72, v112
    v_dot2_f32_bf16 v113, v19, s72, v113
    v_dot2_f32_bf16 v114, v18, s73, v114
    v_dot2_f32_bf16 v115, v19, s73, v115
    v_dot2_f32_bf16 v116, v18, s74, v116
    v_dot2_f32_bf16 v117, v19, s74, v117
    v_dot2_f32_bf16 v118, v18, s75, v118
    v_dot2_f32_bf16 v119, v19, s75, v119
    v_dot2_f32_bf16 v120, v18, s56, v120
    v_dot2_f32_bf16 v121, v19, s56, v121
    v_dot2_f32_bf16 v122, v18, s57, v122
    v_dot2_f32_bf16 v123, v19, s57, v123
    v_dot2_f32_bf16 v124, v18, s58, v124
    v_dot2_f32_bf16 v125, v19, s58, v125
    v_dot2_f32_bf16 v126, v18, s59, v126
    v_dot2_f32_bf16 v127, v19, s59, v127
    v_dot2_f32_bf16 v112, v22, s76, v112
    v_dot2_f32_bf16 v113, v23, s76, v113
    v_dot2_f32_bf16 v114, v22, s77, v114
    v_dot2_f32_bf16 v115, v23, s77, v115
    v_dot2_f32_bf16 v116, v22, s78, v116
    v_dot2_f32_bf16 v117, v23, s78, v117
    v_dot2_f32_bf16 v118, v22, s79, v118
    v_dot2_f32_bf16 v119, v23, s79, v119
    v_dot2_f32_bf16 v120, v22, s60, v120
    v_dot2_f32_bf16 v121, v23, s60, v121
    v_dot2_f32_bf16 v122, v22, s61, v122
    v_dot2_f32_bf16 v123, v23, s61, v123
    v_dot2_f32_bf16 v124, v22, s62, v124
    v_dot2_f32_bf16 v125, v23, s62, v125
    v_dot2_f32_bf16 v126, v22, s63, v126
    v_dot2_f32_bf16 v127, v23, s63, v127
    v_dot2_f32_bf16 v112, v26, s80, v112
    v_dot2_f32_bf16 v113, v27, s80, v113
    v_dot2_f32_bf16 v114, v26, s81, v114
    v_dot2_f32_bf16 v115, v27, s81, v115
    v_dot2_f32_bf16 v116, v26, s82, v116
    v_dot2_f32_bf16 v117, v27, s82, v117
    v_dot2_f32_bf16 v118, v26, s83, v118
    v_dot2_f32_bf16 v119, v27, s83, v119
    v_dot2_f32_bf16 v120, v26, s64, v120
    v_dot2_f32_bf16 v121, v27, s64, v121
    v_dot2_f32_bf16 v122, v26, s65, v122
    v_dot2_f32_bf16 v123, v27, s65, v123
    v_dot2_f32_bf16 v124, v26, s66, v124
    v_dot2_f32_bf16 v125, v27, s66, v125
    v_dot2_f32_bf16 v126, v26, s67, v126
    v_dot2_f32_bf16 v127, v27, s67, v127
L_p2_gd:
    s_cmp_lg_u32 s13, 15
    s_cbranch_scc1 L_p2_nosig
    s_waitcnt vmcnt(0)
    v_readfirstlane_b32 s15, v9
    s_lshl_b32 s51, 1, s12
    s_add_u32 s20, s20, s15
    s_and_b32 s15, s20, 0xff
    s_cmp_eq_u32 s15, 4
    s_cbranch_scc0 L_p2_notlast
    s_bfe_u32 s15, s20, 262160
    s_or_b32 s51, s51, s15
    s_branch L_p2_pub
L_p2_notlast:
    s_cmp_lg_u32 s21, 0
    s_cselect_b32 s51, 0, s51
    s_cbranch_scc1 L_p2_pub
L_p2_poll:
    v_mov_b32 v9, 0
    s_lshl_b32 s14, s3, 8
    s_add_u32 s14, s14, 230821888
    s_mov_b64 exec, 1
    buffer_atomic_add v9, off, s[4:7], s14 sc0
    s_mov_b64 exec, -1
    s_waitcnt vmcnt(0)
    v_readfirstlane_b32 s20, v9
    s_nop 0
    s_and_b32 s15, s20, 0xff
    s_cmp_lt_u32 s15, 4
    s_cbranch_scc1 L_p2_poll
L_p2_pub:
    s_lshl_b32 s15, s51, 24
    s_or_b32 s15, s15, s20
    v_mov_b32 v9, s15
    s_mov_b64 exec, 1
    ds_write_b32 v8, v9
    s_mov_b64 exec, -1
    s_waitcnt lgkmcnt(0)
L_p2_nosig:
    s_barrier
    ds_read_b32 v9, v8
    s_waitcnt lgkmcnt(0)
    v_readfirstlane_b32 s20, v9
    s_nop 0
    s_lshr_b32 s51, s20, 24
    s_cbranch_scc0 L_p2_end
L_p2_fin:
    s_mul_i32 s24, s49, 19968
    s_add_u32 s14, s12, 1
    s_and_b32 s14, s14, 3
    s_mul_i32 s15, s14, 5120000
    s_add_u32 s15, s15, 230838272
    s_add_u32 s15, s15, s26
    buffer_load_dwordx4 v[12:15], v1, s[4:7], s15 offen sc1
    buffer_load_dwordx4 v[92:95], v2, s[4:7], s15 offen sc1
    s_add_u32 s14, s12, 2
    s_and_b32 s14, s14, 3
    s_mul_i32 s15, s14, 5120000
    s_add_u32 s15, s15, 230838272
    s_add_u32 s15, s15, s26
    buffer_load_dwordx4 v[16:19], v1, s[4:7], s15 offen sc1
    buffer_load_dwordx4 v[96:99], v2, s[4:7], s15 offen sc1
    s_add_u32 s14, s12, 3
    s_and_b32 s14, s14, 3
    s_mul_i32 s15, s14, 5120000
    s_add_u32 s15, s15, 230838272
    s_add_u32 s15, s15, s26
    buffer_load_dwordx4 v[20:23], v1, s[4:7], s15 offen sc1
    buffer_load_dwordx4 v[100:103], v2, s[4:7], s15 offen sc1
    v_add_u32 v24, s24, v1
    ds_read_b128 v[8:11], v24
    v_add_u32 v25, s24, v2
    ds_read_b128 v[88:91], v25
    s_waitcnt vmcnt(0) lgkmcnt(0)
    s_bfe_u32 s14, s20, 262164
    s_cbranch_scc0 L_p2_kernel_nof32a_10
    s_add_u32 s14, s12, 0
    s_and_b32 s14, s14, 3
    s_add_u32 s14, s14, 20
    s_bitcmp1_b32 s20, s14
    s_cbranch_scc0 L_p2_kernel_q_11
    v_mov_b32 v8, 1073758208
    v_mov_b32 v9, 1073758208
    v_mov_b32 v10, 1073758208
    v_mov_b32 v11, 1073758208
L_p2_kernel_q_11:
    s_add_u32 s14, s12, 1
    s_and_b32 s14, s14, 3
    s_add_u32 s14, s14, 20
    s_bitcmp1_b32 s20, s14
    s_cbranch_scc0 L_p2_kernel_q_12
    v_mov_b32 v12, 1073758208
    v_mov_b32 v13, 1073758208
    v_mov_b32 v14, 1073758208
    v_mov_b32 v15, 1073758208
L_p2_kernel_q_12:
    s_add_u32 s14, s12, 2
    s_and_b32 s14, s14, 3
    s_add_u32 s14, s14, 20
    s_bitcmp1_b32 s20, s14
    s_cbranch_scc0 L_p2_kernel_q_13
    v_mov_b32 v16, 1073758208
    v_mov_b32 v17, 1073758208
    v_mov_b32 v18, 1073758208
    v_mov_b32 v19, 1073758208
L_p2_kernel_q_13:
    s_add_u32 s14, s12, 3
    s_and_b32 s14, s14, 3
    s_add_u32 s14, s14, 20
    s_bitcmp1_b32 s20, s14
    s_cbranch_scc0 L_p2_kernel_q_14
    v_mov_b32 v20, 1073758208
    v_mov_b32 v21, 1073758208
    v_mov_b32 v22, 1073758208
    v_mov_b32 v23, 1073758208
L_p2_kernel_q_14:
L_p2_kernel_nof32a_10:
    v_pk_add_u16 v8, v8, v12
    v_pk_add_u16 v16, v16, v20
    v_pk_add_u16 v9, v9, v13
    v_pk_add_u16 v17, v17, v21
    v_pk_add_u16 v10, v10, v14
    v_pk_add_u16 v18, v18, v22
    v_pk_add_u16 v11, v11, v15
    v_pk_add_u16 v19, v19, v23
    v_add_u32_sdwa v24, v8, v16 dst_sel:DWORD dst_unused:UNUSED_PAD src0_sel:WORD_0 src1_sel:WORD_0
    v_add_u32_sdwa v25, v10, v18 dst_sel:DWORD dst_unused:UNUSED_PAD src0_sel:WORD_0 src1_sel:WORD_0
    v_add_u32_sdwa v26, v8, v16 dst_sel:DWORD dst_unused:UNUSED_PAD src0_sel:WORD_1 src1_sel:WORD_1
    v_add_u32_sdwa v27, v10, v18 dst_sel:DWORD dst_unused:UNUSED_PAD src0_sel:WORD_1 src1_sel:WORD_1
    v_add_u32_sdwa v28, v9, v17 dst_sel:DWORD dst_unused:UNUSED_PAD src0_sel:WORD_0 src1_sel:WORD_0
    v_add_u32_sdwa v29, v11, v19 dst_sel:DWORD dst_unused:UNUSED_PAD src0_sel:WORD_0 src1_sel:WORD_0
    v_add_u32_sdwa v30, v9, v17 dst_sel:DWORD dst_unused:UNUSED_PAD src0_sel:WORD_1 src1_sel:WORD_1
    v_add_u32_sdwa v31, v11, v19 dst_sel:DWORD dst_unused:UNUSED_PAD src0_sel:WORD_1 src1_sel:WORD_1
    v_cvt_f32_u32 v24, v24
    v_cvt_f32_u32 v25, v25
    v_cvt_f32_u32 v26, v26
    v_cvt_f32_u32 v27, v27
    v_cvt_f32_u32 v28, v28
    v_cvt_f32_u32 v29, v29
    v_cvt_f32_u32 v30, v30
    v_cvt_f32_u32 v31, v31
    v_pk_fma_f32 v[24:25], v[24:25], s[44:45], s[44:45] op_sel:[0,0,1] op_sel_hi:[1,0,1]
    v_pk_fma_f32 v[26:27], v[26:27], s[44:45], s[44:45] op_sel:[0,0,1] op_sel_hi:[1,0,1]
    v_pk_fma_f32 v[28:29], v[28:29], s[44:45], s[44:45] op_sel:[0,0,1] op_sel_hi:[1,0,1]
    v_pk_fma_f32 v[30:31], v[30:31], s[44:45], s[44:45] op_sel:[0,0,1] op_sel_hi:[1,0,1]
    s_bfe_u32 s14, s20, 262164
    s_cbranch_scc0 L_p2_kernel_nof32b_15
    v_lshlrev_b32 v32, 1, v1
    s_bitcmp1_b32 s20, 20
    s_cbranch_scc0 L_p2_kernel_q_16
    s_lshl_b32 s15, s26, 1
    s_add_u32 s15, s15, 251318272
    buffer_load_dwordx4 v[8:11], v32, s[4:7], s15 offen sc1
    buffer_load_dwordx4 v[12:15], v32, s[4:7], s15 offen offset:16 sc1
    s_waitcnt vmcnt(0)
    v_add_f32 v24, v24, v8
    v_add_f32 v25, v25, v12
    v_add_f32 v26, v26, v9
    v_add_f32 v27, v27, v13
    v_add_f32 v28, v28, v10
    v_add_f32 v29, v29, v14
    v_add_f32 v30, v30, v11
    v_add_f32 v31, v31, v15
L_p2_kernel_q_16:
    s_bitcmp1_b32 s20, 21
    s_cbranch_scc0 L_p2_kernel_q_17
    s_lshl_b32 s15, s26, 1
    s_add_u32 s15, s15, 261558272
    buffer_load_dwordx4 v[8:11], v32, s[4:7], s15 offen sc1
    buffer_load_dwordx4 v[12:15], v32, s[4:7], s15 offen offset:16 sc1
    s_waitcnt vmcnt(0)
    v_add_f32 v24, v24, v8
    v_add_f32 v25, v25, v12
    v_add_f32 v26, v26, v9
    v_add_f32 v27, v27, v13
    v_add_f32 v28, v28, v10
    v_add_f32 v29, v29, v14
    v_add_f32 v30, v30, v11
    v_add_f32 v31, v31, v15
L_p2_kernel_q_17:
    s_bitcmp1_b32 s20, 22
    s_cbranch_scc0 L_p2_kernel_q_18
    s_lshl_b32 s15, s26, 1
    s_add_u32 s15, s15, 271798272
    buffer_load_dwordx4 v[8:11], v32, s[4:7], s15 offen sc1
    buffer_load_dwordx4 v[12:15], v32, s[4:7], s15 offen offset:16 sc1
    s_waitcnt vmcnt(0)
    v_add_f32 v24, v24, v8
    v_add_f32 v25, v25, v12
    v_add_f32 v26, v26, v9
    v_add_f32 v27, v27, v13
    v_add_f32 v28, v28, v10
    v_add_f32 v29, v29, v14
    v_add_f32 v30, v30, v11
    v_add_f32 v31, v31, v15
L_p2_kernel_q_18:
    s_bitcmp1_b32 s20, 23
    s_cbranch_scc0 L_p2_kernel_q_19
    s_lshl_b32 s15, s26, 1
    s_add_u32 s15, s15, 282038272
    buffer_load_dwordx4 v[8:11], v32, s[4:7], s15 offen sc1
    buffer_load_dwordx4 v[12:15], v32, s[4:7], s15 offen offset:16 sc1
    s_waitcnt vmcnt(0)
    v_add_f32 v24, v24, v8
    v_add_f32 v25, v25, v12
    v_add_f32 v26, v26, v9
    v_add_f32 v27, v27, v13
    v_add_f32 v28, v28, v10
    v_add_f32 v29, v29, v14
    v_add_f32 v30, v30, v11
    v_add_f32 v31, v31, v15
L_p2_kernel_q_19:
L_p2_kernel_nof32b_15:
    v_pk_mul_f32 v[8:9], v[24:25], s[84:85] op_sel:[0,0] op_sel_hi:[1,0]
    v_pk_mul_f32 v[10:11], v[24:25], s[84:85] op_sel:[0,1] op_sel_hi:[1,1]
    v_pk_mul_f32 v[12:13], v[24:25], s[86:87] op_sel:[0,0] op_sel_hi:[1,0]
    v_pk_mul_f32 v[14:15], v[24:25], s[86:87] op_sel:[0,1] op_sel_hi:[1,1]
    v_pk_fma_f32 v[8:9], v[26:27], s[88:89], v[8:9] op_sel:[0,0,0] op_sel_hi:[1,0,1]
    v_pk_fma_f32 v[10:11], v[26:27], s[88:89], v[10:11] op_sel:[0,1,0] op_sel_hi:[1,1,1]
    v_pk_fma_f32 v[12:13], v[26:27], s[90:91], v[12:13] op_sel:[0,0,0] op_sel_hi:[1,0,1]
    v_pk_fma_f32 v[14:15], v[26:27], s[90:91], v[14:15] op_sel:[0,1,0] op_sel_hi:[1,1,1]
    v_pk_fma_f32 v[8:9], v[28:29], s[92:93], v[8:9] op_sel:[0,0,0] op_sel_hi:[1,0,1]
    v_pk_fma_f32 v[10:11], v[28:29], s[92:93], v[10:11] op_sel:[0,1,0] op_sel_hi:[1,1,1]
    v_pk_fma_f32 v[12:13], v[28:29], s[94:95], v[12:13] op_sel:[0,0,0] op_sel_hi:[1,0,1]
    v_pk_fma_f32 v[14:15], v[28:29], s[94:95], v[14:15] op_sel:[0,1,0] op_sel_hi:[1,1,1]
    v_pk_fma_f32 v[8:9], v[30:31], s[96:97], v[8:9] op_sel:[0,0,0] op_sel_hi:[1,0,1]
    v_pk_fma_f32 v[10:11], v[30:31], s[96:97], v[10:11] op_sel:[0,1,0] op_sel_hi:[1,1,1]
    v_pk_fma_f32 v[12:13], v[30:31], s[98:99], v[12:13] op_sel:[0,0,0] op_sel_hi:[1,0,1]
    v_pk_fma_f32 v[14:15], v[30:31], s[98:99], v[14:15] op_sel:[0,1,0] op_sel_hi:[1,1,1]
    v_pk_mul_f32 v[8:9], v[8:9], v[72:73]
    v_pk_mul_f32 v[10:11], v[10:11], v[74:75]
    v_pk_mul_f32 v[12:13], v[12:13], v[76:77]
    v_pk_mul_f32 v[14:15], v[14:15], v[78:79]
    v_pk_mul_f32 v[24:25], v[8:9], s[28:29] op_sel:[0,0] op_sel_hi:[1,0]
    v_pk_mul_f32 v[26:27], v[8:9], s[28:29] op_sel:[0,1] op_sel_hi:[1,1]
    v_pk_mul_f32 v[28:29], v[8:9], s[30:31] op_sel:[0,0] op_sel_hi:[1,0]
    v_pk_mul_f32 v[30:31], v[8:9], s[30:31] op_sel:[0,1] op_sel_hi:[1,1]
    v_pk_fma_f32 v[24:25], v[10:11], s[32:33], v[24:25] op_sel:[0,0,0] op_sel_hi:[1,0,1]
    v_pk_fma_f32 v[26:27], v[10:11], s[32:33], v[26:27] op_sel:[0,1,0] op_sel_hi:[1,1,1]
    v_pk_fma_f32 v[28:29], v[10:11], s[34:35], v[28:29] op_sel:[0,0,0] op_sel_hi:[1,0,1]
    v_pk_fma_f32 v[30:31], v[10:11], s[34:35], v[30:31] op_sel:[0,1,0] op_sel_hi:[1,1,1]
    v_pk_fma_f32 v[24:25], v[12:13], s[36:37], v[24:25] op_sel:[0,0,0] op_sel_hi:[1,0,1]
    v_pk_fma_f32 v[26:27], v[12:13], s[36:37], v[26:27] op_sel:[0,1,0] op_sel_hi:[1,1,1]
    v_pk_fma_f32 v[28:29], v[12:13], s[38:39], v[28:29] op_sel:[0,0,0] op_sel_hi:[1,0,1]
    v_pk_fma_f32 v[30:31], v[12:13], s[38:39], v[30:31] op_sel:[0,1,0] op_sel_hi:[1,1,1]
    v_pk_fma_f32 v[24:25], v[14:15], s[40:41], v[24:25] op_sel:[0,0,0] op_sel_hi:[1,0,1]
    v_pk_fma_f32 v[26:27], v[14:15], s[40:41], v[26:27] op_sel:[0,1,0] op_sel_hi:[1,1,1]
    v_pk_fma_f32 v[28:29], v[14:15], s[42:43], v[28:29] op_sel:[0,0,0] op_sel_hi:[1,0,1]
    v_pk_fma_f32 v[30:31], v[14:15], s[42:43], v[30:31] op_sel:[0,1,0] op_sel_hi:[1,1,1]
    v_lshlrev_b32 v8, 16, v64
    v_and_b32 v10, 0xffff0000, v64
    v_lshlrev_b32 v12, 16, v65
    v_and_b32 v14, 0xffff0000, v65
    v_lshlrev_b32 v9, 16, v66
    v_and_b32 v11, 0xffff0000, v66
    v_lshlrev_b32 v13, 16, v67
    v_and_b32 v15, 0xffff0000, v67
    v_pk_fma_f32 v[8:9], v[24:25], v[80:81], v[8:9]
    v_pk_fma_f32 v[10:11], v[26:27], v[82:83], v[10:11]
    v_pk_fma_f32 v[12:13], v[28:29], v[84:85], v[12:13]
    v_pk_fma_f32 v[14:15], v[30:31], v[86:87], v[14:15]
    v_cvt_pk_bf16_f32 v16, v8, v10
    v_cvt_pk_bf16_f32 v17, v12, v14
    v_cvt_pk_bf16_f32 v18, v9, v11
    v_cvt_pk_bf16_f32 v19, v13, v15
    buffer_store_dwordx4 v[16:19], v1, s[16:19], s26 offen
    s_cmp_ge_u32 s13, 4
    s_cbranch_scc1 L_p2_f1
    s_bfe_u32 s14, s20, 262164
    s_cbranch_scc0 L_p2_kernel_nof32a_20
    s_add_u32 s14, s12, 0
    s_and_b32 s14, s14, 3
    s_add_u32 s14, s14, 20
    s_bitcmp1_b32 s20, s14
    s_cbranch_scc0 L_p2_kernel_q_21
    v_mov_b32 v88, 1073758208
    v_mov_b32 v89, 1073758208
    v_mov_b32 v90, 1073758208
    v_mov_b32 v91, 1073758208
L_p2_kernel_q_21:
    s_add_u32 s14, s12, 1
    s_and_b32 s14, s14, 3
    s_add_u32 s14, s14, 20
    s_bitcmp1_b32 s20, s14
    s_cbranch_scc0 L_p2_kernel_q_22
    v_mov_b32 v92, 1073758208
    v_mov_b32 v93, 1073758208
    v_mov_b32 v94, 1073758208
    v_mov_b32 v95, 1073758208
L_p2_kernel_q_22:
    s_add_u32 s14, s12, 2
    s_and_b32 s14, s14, 3
    s_add_u32 s14, s14, 20
    s_bitcmp1_b32 s20, s14
    s_cbranch_scc0 L_p2_kernel_q_23
    v_mov_b32 v96, 1073758208
    v_mov_b32 v97, 1073758208
    v_mov_b32 v98, 1073758208
    v_mov_b32 v99, 1073758208
L_p2_kernel_q_23:
    s_add_u32 s14, s12, 3
    s_and_b32 s14, s14, 3
    s_add_u32 s14, s14, 20
    s_bitcmp1_b32 s20, s14
    s_cbranch_scc0 L_p2_kernel_q_24
    v_mov_b32 v100, 1073758208
    v_mov_b32 v101, 1073758208
    v_mov_b32 v102, 1073758208
    v_mov_b32 v103, 1073758208
L_p2_kernel_q_24:
L_p2_kernel_nof32a_20:
    v_pk_add_u16 v88, v88, v92
    v_pk_add_u16 v96, v96, v100
    v_pk_add_u16 v89, v89, v93
    v_pk_add_u16 v97, v97, v101
    v_pk_add_u16 v90, v90, v94
    v_pk_add_u16 v98, v98, v102
    v_pk_add_u16 v91, v91, v95
    v_pk_add_u16 v99, v99, v103
    v_add_u32_sdwa v24, v88, v96 dst_sel:DWORD dst_unused:UNUSED_PAD src0_sel:WORD_0 src1_sel:WORD_0
    v_add_u32_sdwa v25, v90, v98 dst_sel:DWORD dst_unused:UNUSED_PAD src0_sel:WORD_0 src1_sel:WORD_0
    v_add_u32_sdwa v26, v88, v96 dst_sel:DWORD dst_unused:UNUSED_PAD src0_sel:WORD_1 src1_sel:WORD_1
    v_add_u32_sdwa v27, v90, v98 dst_sel:DWORD dst_unused:UNUSED_PAD src0_sel:WORD_1 src1_sel:WORD_1
    v_add_u32_sdwa v28, v89, v97 dst_sel:DWORD dst_unused:UNUSED_PAD src0_sel:WORD_0 src1_sel:WORD_0
    v_add_u32_sdwa v29, v91, v99 dst_sel:DWORD dst_unused:UNUSED_PAD src0_sel:WORD_0 src1_sel:WORD_0
    v_add_u32_sdwa v30, v89, v97 dst_sel:DWORD dst_unused:UNUSED_PAD src0_sel:WORD_1 src1_sel:WORD_1
    v_add_u32_sdwa v31, v91, v99 dst_sel:DWORD dst_unused:UNUSED_PAD src0_sel:WORD_1 src1_sel:WORD_1
    v_cvt_f32_u32 v24, v24
    v_cvt_f32_u32 v25, v25
    v_cvt_f32_u32 v26, v26
    v_cvt_f32_u32 v27, v27
    v_cvt_f32_u32 v28, v28
    v_cvt_f32_u32 v29, v29
    v_cvt_f32_u32 v30, v30
    v_cvt_f32_u32 v31, v31
    v_pk_fma_f32 v[24:25], v[24:25], s[44:45], s[44:45] op_sel:[0,0,1] op_sel_hi:[1,0,1]
    v_pk_fma_f32 v[26:27], v[26:27], s[44:45], s[44:45] op_sel:[0,0,1] op_sel_hi:[1,0,1]
    v_pk_fma_f32 v[28:29], v[28:29], s[44:45], s[44:45] op_sel:[0,0,1] op_sel_hi:[1,0,1]
    v_pk_fma_f32 v[30:31], v[30:31], s[44:45], s[44:45] op_sel:[0,0,1] op_sel_hi:[1,0,1]
    s_bfe_u32 s14, s20, 262164
    s_cbranch_scc0 L_p2_kernel_nof32b_25
    v_lshlrev_b32 v32, 1, v2
    s_bitcmp1_b32 s20, 20
    s_cbranch_scc0 L_p2_kernel_q_26
    s_lshl_b32 s15, s26, 1
    s_add_u32 s15, s15, 251318272
    buffer_load_dwordx4 v[88:91], v32, s[4:7], s15 offen sc1
    buffer_load_dwordx4 v[92:95], v32, s[4:7], s15 offen offset:16 sc1
    s_waitcnt vmcnt(0)
    v_add_f32 v24, v24, v88
    v_add_f32 v25, v25, v92
    v_add_f32 v26, v26, v89
    v_add_f32 v27, v27, v93
    v_add_f32 v28, v28, v90
    v_add_f32 v29, v29, v94
    v_add_f32 v30, v30, v91
    v_add_f32 v31, v31, v95
L_p2_kernel_q_26:
    s_bitcmp1_b32 s20, 21
    s_cbranch_scc0 L_p2_kernel_q_27
    s_lshl_b32 s15, s26, 1
    s_add_u32 s15, s15, 261558272
    buffer_load_dwordx4 v[88:91], v32, s[4:7], s15 offen sc1
    buffer_load_dwordx4 v[92:95], v32, s[4:7], s15 offen offset:16 sc1
    s_waitcnt vmcnt(0)
    v_add_f32 v24, v24, v88
    v_add_f32 v25, v25, v92
    v_add_f32 v26, v26, v89
    v_add_f32 v27, v27, v93
    v_add_f32 v28, v28, v90
    v_add_f32 v29, v29, v94
    v_add_f32 v30, v30, v91
    v_add_f32 v31, v31, v95
L_p2_kernel_q_27:
    s_bitcmp1_b32 s20, 22
    s_cbranch_scc0 L_p2_kernel_q_28
    s_lshl_b32 s15, s26, 1
    s_add_u32 s15, s15, 271798272
    buffer_load_dwordx4 v[88:91], v32, s[4:7], s15 offen sc1
    buffer_load_dwordx4 v[92:95], v32, s[4:7], s15 offen offset:16 sc1
    s_waitcnt vmcnt(0)
    v_add_f32 v24, v24, v88
    v_add_f32 v25, v25, v92
    v_add_f32 v26, v26, v89
    v_add_f32 v27, v27, v93
    v_add_f32 v28, v28, v90
    v_add_f32 v29, v29, v94
    v_add_f32 v30, v30, v91
    v_add_f32 v31, v31, v95
L_p2_kernel_q_28:
    s_bitcmp1_b32 s20, 23
    s_cbranch_scc0 L_p2_kernel_q_29
    s_lshl_b32 s15, s26, 1
    s_add_u32 s15, s15, 282038272
    buffer_load_dwordx4 v[88:91], v32, s[4:7], s15 offen sc1
    buffer_load_dwordx4 v[92:95], v32, s[4:7], s15 offen offset:16 sc1
    s_waitcnt vmcnt(0)
    v_add_f32 v24, v24, v88
    v_add_f32 v25, v25, v92
    v_add_f32 v26, v26, v89
    v_add_f32 v27, v27, v93
    v_add_f32 v28, v28, v90
    v_add_f32 v29, v29, v94
    v_add_f32 v30, v30, v91
    v_add_f32 v31, v31, v95
L_p2_kernel_q_29:
L_p2_kernel_nof32b_25:
    v_pk_mul_f32 v[88:89], v[24:25], s[84:85] op_sel:[0,0] op_sel_hi:[1,0]
    v_pk_mul_f32 v[90:91], v[24:25], s[84:85] op_sel:[0,1] op_sel_hi:[1,1]
    v_pk_mul_f32 v[92:93], v[24:25], s[86:87] op_sel:[0,0] op_sel_hi:[1,0]
    v_pk_mul_f32 v[94:95], v[24:25], s[86:87] op_sel:[0,1] op_sel_hi:[1,1]
    v_pk_fma_f32 v[88:89], v[26:27], s[88:89], v[88:89] op_sel:[0,0,0] op_sel_hi:[1,0,1]
    v_pk_fma_f32 v[90:91], v[26:27], s[88:89], v[90:91] op_sel:[0,1,0] op_sel_hi:[1,1,1]
    v_pk_fma_f32 v[92:93], v[26:27], s[90:91], v[92:93] op_sel:[0,0,0] op_sel_hi:[1,0,1]
    v_pk_fma_f32 v[94:95], v[26:27], s[90:91], v[94:95] op_sel:[0,1,0] op_sel_hi:[1,1,1]
    v_pk_fma_f32 v[88:89], v[28:29], s[92:93], v[88:89] op_sel:[0,0,0] op_sel_hi:[1,0,1]
    v_pk_fma_f32 v[90:91], v[28:29], s[92:93], v[90:91] op_sel:[0,1,0] op_sel_hi:[1,1,1]
    v_pk_fma_f32 v[92:93], v[28:29], s[94:95], v[92:93] op_sel:[0,0,0] op_sel_hi:[1,0,1]
    v_pk_fma_f32 v[94:95], v[28:29], s[94:95], v[94:95] op_sel:[0,1,0] op_sel_hi:[1,1,1]
    v_pk_fma_f32 v[88:89], v[30:31], s[96:97], v[88:89] op_sel:[0,0,0] op_sel_hi:[1,0,1]
    v_pk_fma_f32 v[90:91], v[30:31], s[96:97], v[90:91] op_sel:[0,1,0] op_sel_hi:[1,1,1]
    v_pk_fma_f32 v[92:93], v[30:31], s[98:99], v[92:93] op_sel:[0,0,0] op_sel_hi:[1,0,1]
    v_pk_fma_f32 v[94:95], v[30:31], s[98:99], v[94:95] op_sel:[0,1,0] op_sel_hi:[1,1,1]
    v_pk_mul_f32 v[88:89], v[88:89], v[112:113]
    v_pk_mul_f32 v[90:91], v[90:91], v[114:115]
    v_pk_mul_f32 v[92:93], v[92:93], v[116:117]
    v_pk_mul_f32 v[94:95], v[94:95], v[118:119]
    v_pk_mul_f32 v[24:25], v[88:89], s[28:29] op_sel:[0,0] op_sel_hi:[1,0]
    v_pk_mul_f32 v[26:27], v[88:89], s[28:29] op_sel:[0,1] op_sel_hi:[1,1]
    v_pk_mul_f32 v[28:29], v[88:89], s[30:31] op_sel:[0,0] op_sel_hi:[1,0]
    v_pk_mul_f32 v[30:31], v[88:89], s[30:31] op_sel:[0,1] op_sel_hi:[1,1]
    v_pk_fma_f32 v[24:25], v[90:91], s[32:33], v[24:25] op_sel:[0,0,0] op_sel_hi:[1,0,1]
    v_pk_fma_f32 v[26:27], v[90:91], s[32:33], v[26:27] op_sel:[0,1,0] op_sel_hi:[1,1,1]
    v_pk_fma_f32 v[28:29], v[90:91], s[34:35], v[28:29] op_sel:[0,0,0] op_sel_hi:[1,0,1]
    v_pk_fma_f32 v[30:31], v[90:91], s[34:35], v[30:31] op_sel:[0,1,0] op_sel_hi:[1,1,1]
    v_pk_fma_f32 v[24:25], v[92:93], s[36:37], v[24:25] op_sel:[0,0,0] op_sel_hi:[1,0,1]
    v_pk_fma_f32 v[26:27], v[92:93], s[36:37], v[26:27] op_sel:[0,1,0] op_sel_hi:[1,1,1]
    v_pk_fma_f32 v[28:29], v[92:93], s[38:39], v[28:29] op_sel:[0,0,0] op_sel_hi:[1,0,1]
    v_pk_fma_f32 v[30:31], v[92:93], s[38:39], v[30:31] op_sel:[0,1,0] op_sel_hi:[1,1,1]
    v_pk_fma_f32 v[24:25], v[94:95], s[40:41], v[24:25] op_sel:[0,0,0] op_sel_hi:[1,0,1]
    v_pk_fma_f32 v[26:27], v[94:95], s[40:41], v[26:27] op_sel:[0,1,0] op_sel_hi:[1,1,1]
    v_pk_fma_f32 v[28:29], v[94:95], s[42:43], v[28:29] op_sel:[0,0,0] op_sel_hi:[1,0,1]
    v_pk_fma_f32 v[30:31], v[94:95], s[42:43], v[30:31] op_sel:[0,1,0] op_sel_hi:[1,1,1]
    v_lshlrev_b32 v88, 16, v68
    v_and_b32 v90, 0xffff0000, v68
    v_lshlrev_b32 v92, 16, v69
    v_and_b32 v94, 0xffff0000, v69
    v_lshlrev_b32 v89, 16, v70
    v_and_b32 v91, 0xffff0000, v70
    v_lshlrev_b32 v93, 16, v71
    v_and_b32 v95, 0xffff0000, v71
    v_pk_fma_f32 v[88:89], v[24:25], v[120:121], v[88:89]
    v_pk_fma_f32 v[90:91], v[26:27], v[122:123], v[90:91]
    v_pk_fma_f32 v[92:93], v[28:29], v[124:125], v[92:93]
    v_pk_fma_f32 v[94:95], v[30:31], v[126:127], v[94:95]
    v_cvt_pk_bf16_f32 v96, v88, v90
    v_cvt_pk_bf16_f32 v97, v92, v94
    v_cvt_pk_bf16_f32 v98, v89, v91
    v_cvt_pk_bf16_f32 v99, v93, v95
    buffer_store_dwordx4 v[96:99], v2, s[16:19], s26 offen
L_p2_f1:
    s_bitset0_b32 s51, s49
    s_cmp_eq_u32 s51, 0
    s_cbranch_scc1 L_p2_done
    s_ff1_i32_b32 s49, s51
    s_mul_i32 s14, s3, 20000
    s_mul_i32 s15, s49, 4992
    s_add_u32 s14, s14, s15
    s_add_u32 s15, s14, 4096
    v_min_u32 v61, 231, v0
    v_lshl_add_u32 v60, v0, 2, s14
    v_lshl_add_u32 v61, v61, 2, s15
    global_load_dword v60, v60, s[100:101] nt
    global_load_dword v61, v61, s[100:101] nt
    s_waitcnt vmcnt(0)
    v_lshlrev_b32 v30, 16, v60
    v_and_b32 v31, 0xffff0000, v60
    v_lshlrev_b32 v36, 16, v53
    v_and_b32 v37, 0xffff0000, v53
    v_lshlrev_b32 v38, 16, v54
    v_and_b32 v39, 0xffff0000, v54
    v_lshlrev_b32 v40, 16, v56
    v_and_b32 v41, 0xffff0000, v56
    v_lshlrev_b32 v42, 16, v57
    v_and_b32 v43, 0xffff0000, v57
    v_pk_add_f32 v[14:15], v[30:31], v[36:37] op_sel:[0,0] op_sel_hi:[1,0] neg_lo:[0,1] neg_hi:[0,1]
    v_pk_add_f32 v[16:17], v[30:31], v[36:37] op_sel:[0,1] op_sel_hi:[1,1] neg_lo:[0,1] neg_hi:[0,1]
    v_pk_add_f32 v[18:19], v[30:31], v[38:39] op_sel:[0,0] op_sel_hi:[1,0] neg_lo:[0,1] neg_hi:[0,1]
    v_pk_add_f32 v[20:21], v[30:31], v[38:39] op_sel:[0,1] op_sel_hi:[1,1] neg_lo:[0,1] neg_hi:[0,1]
    v_pk_add_f32 v[22:23], v[30:31], v[40:41] op_sel:[0,0] op_sel_hi:[1,0] neg_lo:[0,1] neg_hi:[0,1]
    v_pk_add_f32 v[24:25], v[30:31], v[40:41] op_sel:[0,1] op_sel_hi:[1,1] neg_lo:[0,1] neg_hi:[0,1]
    v_pk_add_f32 v[26:27], v[30:31], v[42:43] op_sel:[0,0] op_sel_hi:[1,0] neg_lo:[0,1] neg_hi:[0,1]
    v_pk_add_f32 v[28:29], v[30:31], v[42:43] op_sel:[0,1] op_sel_hi:[1,1] neg_lo:[0,1] neg_hi:[0,1]
    v_cvt_pk_bf16_f32 v32, v14, v15
    v_lshlrev_b32 v14, 16, v32
    v_and_b32 v15, 0xffff0000, v32
    v_cvt_pk_bf16_f32 v32, v16, v17
    v_lshlrev_b32 v16, 16, v32
    v_and_b32 v17, 0xffff0000, v32
    v_cvt_pk_bf16_f32 v32, v18, v19
    v_lshlrev_b32 v18, 16, v32
    v_and_b32 v19, 0xffff0000, v32
    v_cvt_pk_bf16_f32 v32, v20, v21
    v_lshlrev_b32 v20, 16, v32
    v_and_b32 v21, 0xffff0000, v32
    v_cvt_pk_bf16_f32 v32, v22, v23
    v_lshlrev_b32 v22, 16, v32
    v_and_b32 v23, 0xffff0000, v32
    v_cvt_pk_bf16_f32 v32, v24, v25
    v_lshlrev_b32 v24, 16, v32
    v_and_b32 v25, 0xffff0000, v32
    v_cvt_pk_bf16_f32 v32, v26, v27
    v_lshlrev_b32 v26, 16, v32
    v_and_b32 v27, 0xffff0000, v32
    v_cvt_pk_bf16_f32 v32, v28, v29
    v_lshlrev_b32 v28, 16, v32
    v_and_b32 v29, 0xffff0000, v32
    v_pk_mul_f32 v[14:15], v[14:15], v[14:15]
    v_pk_mul_f32 v[16:17], v[16:17], v[16:17]
    v_pk_mul_f32 v[18:19], v[18:19], v[18:19]
    v_pk_mul_f32 v[20:21], v[20:21], v[20:21]
    v_pk_mul_f32 v[22:23], v[22:23], v[22:23]
    v_pk_mul_f32 v[24:25], v[24:25], v[24:25]
    v_pk_mul_f32 v[26:27], v[26:27], v[26:27]
    v_pk_mul_f32 v[28:29], v[28:29], v[28:29]
    v_cvt_pk_bf16_f32 v32, v14, v15
    v_lshlrev_b32 v14, 16, v32
    v_and_b32 v15, 0xffff0000, v32
    v_cvt_pk_bf16_f32 v32, v16, v17
    v_lshlrev_b32 v16, 16, v32
    v_and_b32 v17, 0xffff0000, v32
    v_cvt_pk_bf16_f32 v32, v18, v19
    v_lshlrev_b32 v18, 16, v32
    v_and_b32 v19, 0xffff0000, v32
    v_cvt_pk_bf16_f32 v32, v20, v21
    v_lshlrev_b32 v20, 16, v32
    v_and_b32 v21, 0xffff0000, v32
    v_cvt_pk_bf16_f32 v32, v22, v23
    v_lshlrev_b32 v22, 16, v32
    v_and_b32 v23, 0xffff0000, v32
    v_cvt_pk_bf16_f32 v32, v24, v25
    v_lshlrev_b32 v24, 16, v32
    v_and_b32 v25, 0xffff0000, v32
    v_cvt_pk_bf16_f32 v32, v26, v27
    v_lshlrev_b32 v26, 16, v32
    v_and_b32 v27, 0xffff0000, v32
    v_cvt_pk_bf16_f32 v32, v28, v29
    v_lshlrev_b32 v28, 16, v32
    v_and_b32 v29, 0xffff0000, v32
    v_mov_b32 v30, 1092616192
    v_mov_b32 v31, 0x3fb8aa3b
    v_pk_mul_f32 v[14:15], v[14:15], v[30:31] op_sel:[0,0] op_sel_hi:[1,0]
    v_pk_mul_f32 v[16:17], v[16:17], v[30:31] op_sel:[0,0] op_sel_hi:[1,0]
    v_pk_mul_f32 v[18:19], v[18:19], v[30:31] op_sel:[0,0] op_sel_hi:[1,0]
    v_pk_mul_f32 v[20:21], v[20:21], v[30:31] op_sel:[0,0] op_sel_hi:[1,0]
    v_pk_mul_f32 v[22:23], v[22:23], v[30:31] op_sel:[0,0] op_sel_hi:[1,0]
    v_pk_mul_f32 v[24:25], v[24:25], v[30:31] op_sel:[0,0] op_sel_hi:[1,0]
    v_pk_mul_f32 v[26:27], v[26:27], v[30:31] op_sel:[0,0] op_sel_hi:[1,0]
    v_pk_mul_f32 v[28:29], v[28:29], v[30:31] op_sel:[0,0] op_sel_hi:[1,0]
    v_cvt_pk_bf16_f32 v32, v14, v15
    v_lshlrev_b32 v14, 16, v32
    v_and_b32 v15, 0xffff0000, v32
    v_cvt_pk_bf16_f32 v32, v16, v17
    v_lshlrev_b32 v16, 16, v32
    v_and_b32 v17, 0xffff0000, v32
    v_cvt_pk_bf16_f32 v32, v18, v19
    v_lshlrev_b32 v18, 16, v32
    v_and_b32 v19, 0xffff0000, v32
    v_cvt_pk_bf16_f32 v32, v20, v21
    v_lshlrev_b32 v20, 16, v32
    v_and_b32 v21, 0xffff0000, v32
    v_cvt_pk_bf16_f32 v32, v22, v23
    v_lshlrev_b32 v22, 16, v32
    v_and_b32 v23, 0xffff0000, v32
    v_cvt_pk_bf16_f32 v32, v24, v25
    v_lshlrev_b32 v24, 16, v32
    v_and_b32 v25, 0xffff0000, v32
    v_cvt_pk_bf16_f32 v32, v26, v27
    v_lshlrev_b32 v26, 16, v32
    v_and_b32 v27, 0xffff0000, v32
    v_cvt_pk_bf16_f32 v32, v28, v29
    v_lshlrev_b32 v28, 16, v32
    v_and_b32 v29, 0xffff0000, v32
    v_pk_mul_f32 v[14:15], v[14:15], v[30:31] op_sel:[0,1] op_sel_hi:[1,1]
    v_pk_mul_f32 v[16:17], v[16:17], v[30:31] op_sel:[0,1] op_sel_hi:[1,1]
    v_pk_mul_f32 v[18:19], v[18:19], v[30:31] op_sel:[0,1] op_sel_hi:[1,1]
    v_pk_mul_f32 v[20:21], v[20:21], v[30:31] op_sel:[0,1] op_sel_hi:[1,1]
    v_pk_mul_f32 v[22:23], v[22:23], v[30:31] op_sel:[0,1] op_sel_hi:[1,1]
    v_pk_mul_f32 v[24:25], v[24:25], v[30:31] op_sel:[0,1] op_sel_hi:[1,1]
    v_pk_mul_f32 v[26:27], v[26:27], v[30:31] op_sel:[0,1] op_sel_hi:[1,1]
    v_pk_mul_f32 v[28:29], v[28:29], v[30:31] op_sel:[0,1] op_sel_hi:[1,1]
    v_exp_f32 v14, -v14
    v_exp_f32 v15, -v15
    v_exp_f32 v16, -v16
    v_exp_f32 v17, -v17
    v_exp_f32 v18, -v18
    v_exp_f32 v19, -v19
    v_exp_f32 v20, -v20
    v_exp_f32 v21, -v21
    v_exp_f32 v22, -v22
    v_exp_f32 v23, -v23
    v_exp_f32 v24, -v24
    v_exp_f32 v25, -v25
    v_exp_f32 v26, -v26
    v_exp_f32 v27, -v27
    v_exp_f32 v28, -v28
    v_exp_f32 v29, -v29
    v_cvt_pk_bf16_f32 v14, v14, v16
    v_cvt_pk_bf16_f32 v15, v15, v17
    v_cvt_pk_bf16_f32 v18, v18, v20
    v_cvt_pk_bf16_f32 v19, v19, v21
    v_cvt_pk_bf16_f32 v22, v22, v24
    v_cvt_pk_bf16_f32 v23, v23, v25
    v_cvt_pk_bf16_f32 v26, v26, v28
    v_cvt_pk_bf16_f32 v27, v27, v29
    v_dot2_f32_bf16 v72, v14, s68, 0
    v_dot2_f32_bf16 v73, v15, s68, 0
    v_dot2_f32_bf16 v74, v14, s69, 0
    v_dot2_f32_bf16 v75, v15, s69, 0
    v_dot2_f32_bf16 v76, v14, s70, 0
    v_dot2_f32_bf16 v77, v15, s70, 0
    v_dot2_f32_bf16 v78, v14, s71, 0
    v_dot2_f32_bf16 v79, v15, s71, 0
    v_dot2_f32_bf16 v80, v14, s52, 0
    v_dot2_f32_bf16 v81, v15, s52, 0
    v_dot2_f32_bf16 v82, v14, s53, 0
    v_dot2_f32_bf16 v83, v15, s53, 0
    v_dot2_f32_bf16 v84, v14, s54, 0
    v_dot2_f32_bf16 v85, v15, s54, 0
    v_dot2_f32_bf16 v86, v14, s55, 0
    v_dot2_f32_bf16 v87, v15, s55, 0
    v_dot2_f32_bf16 v72, v18, s72, v72
    v_dot2_f32_bf16 v73, v19, s72, v73
    v_dot2_f32_bf16 v74, v18, s73, v74
    v_dot2_f32_bf16 v75, v19, s73, v75
    v_dot2_f32_bf16 v76, v18, s74, v76
    v_dot2_f32_bf16 v77, v19, s74, v77
    v_dot2_f32_bf16 v78, v18, s75, v78
    v_dot2_f32_bf16 v79, v19, s75, v79
    v_dot2_f32_bf16 v80, v18, s56, v80
    v_dot2_f32_bf16 v81, v19, s56, v81
    v_dot2_f32_bf16 v82, v18, s57, v82
    v_dot2_f32_bf16 v83, v19, s57, v83
    v_dot2_f32_bf16 v84, v18, s58, v84
    v_dot2_f32_bf16 v85, v19, s58, v85
    v_dot2_f32_bf16 v86, v18, s59, v86
    v_dot2_f32_bf16 v87, v19, s59, v87
    v_dot2_f32_bf16 v72, v22, s76, v72
    v_dot2_f32_bf16 v73, v23, s76, v73
    v_dot2_f32_bf16 v74, v22, s77, v74
    v_dot2_f32_bf16 v75, v23, s77, v75
    v_dot2_f32_bf16 v76, v22, s78, v76
    v_dot2_f32_bf16 v77, v23, s78, v77
    v_dot2_f32_bf16 v78, v22, s79, v78
    v_dot2_f32_bf16 v79, v23, s79, v79
    v_dot2_f32_bf16 v80, v22, s60, v80
    v_dot2_f32_bf16 v81, v23, s60, v81
    v_dot2_f32_bf16 v82, v22, s61, v82
    v_dot2_f32_bf16 v83, v23, s61, v83
    v_dot2_f32_bf16 v84, v22, s62, v84
    v_dot2_f32_bf16 v85, v23, s62, v85
    v_dot2_f32_bf16 v86, v22, s63, v86
    v_dot2_f32_bf16 v87, v23, s63, v87
    v_dot2_f32_bf16 v72, v26, s80, v72
    v_dot2_f32_bf16 v73, v27, s80, v73
    v_dot2_f32_bf16 v74, v26, s81, v74
    v_dot2_f32_bf16 v75, v27, s81, v75
    v_dot2_f32_bf16 v76, v26, s82, v76
    v_dot2_f32_bf16 v77, v27, s82, v77
    v_dot2_f32_bf16 v78, v26, s83, v78
    v_dot2_f32_bf16 v79, v27, s83, v79
    v_dot2_f32_bf16 v80, v26, s64, v80
    v_dot2_f32_bf16 v81, v27, s64, v81
    v_dot2_f32_bf16 v82, v26, s65, v82
    v_dot2_f32_bf16 v83, v27, s65, v83
    v_dot2_f32_bf16 v84, v26, s66, v84
    v_dot2_f32_bf16 v85, v27, s66, v85
    v_dot2_f32_bf16 v86, v26, s67, v86
    v_dot2_f32_bf16 v87, v27, s67, v87
    s_cmp_ge_u32 s13, 4
    s_cbranch_scc1 L_p2_kernel_g1_30
    v_lshlrev_b32 v30, 16, v61
    v_and_b32 v31, 0xffff0000, v61
    v_pk_add_f32 v[14:15], v[30:31], v[36:37] op_sel:[0,0] op_sel_hi:[1,0] neg_lo:[0,1] neg_hi:[0,1]
    v_pk_add_f32 v[16:17], v[30:31], v[36:37] op_sel:[0,1] op_sel_hi:[1,1] neg_lo:[0,1] neg_hi:[0,1]
    v_pk_add_f32 v[18:19], v[30:31], v[38:39] op_sel:[0,0] op_sel_hi:[1,0] neg_lo:[0,1] neg_hi:[0,1]
    v_pk_add_f32 v[20:21], v[30:31], v[38:39] op_sel:[0,1] op_sel_hi:[1,1] neg_lo:[0,1] neg_hi:[0,1]
    v_pk_add_f32 v[22:23], v[30:31], v[40:41] op_sel:[0,0] op_sel_hi:[1,0] neg_lo:[0,1] neg_hi:[0,1]
    v_pk_add_f32 v[24:25], v[30:31], v[40:41] op_sel:[0,1] op_sel_hi:[1,1] neg_lo:[0,1] neg_hi:[0,1]
    v_pk_add_f32 v[26:27], v[30:31], v[42:43] op_sel:[0,0] op_sel_hi:[1,0] neg_lo:[0,1] neg_hi:[0,1]
    v_pk_add_f32 v[28:29], v[30:31], v[42:43] op_sel:[0,1] op_sel_hi:[1,1] neg_lo:[0,1] neg_hi:[0,1]
    v_cvt_pk_bf16_f32 v32, v14, v15
    v_lshlrev_b32 v14, 16, v32
    v_and_b32 v15, 0xffff0000, v32
    v_cvt_pk_bf16_f32 v32, v16, v17
    v_lshlrev_b32 v16, 16, v32
    v_and_b32 v17, 0xffff0000, v32
    v_cvt_pk_bf16_f32 v32, v18, v19
    v_lshlrev_b32 v18, 16, v32
    v_and_b32 v19, 0xffff0000, v32
    v_cvt_pk_bf16_f32 v32, v20, v21
    v_lshlrev_b32 v20, 16, v32
    v_and_b32 v21, 0xffff0000, v32
    v_cvt_pk_bf16_f32 v32, v22, v23
    v_lshlrev_b32 v22, 16, v32
    v_and_b32 v23, 0xffff0000, v32
    v_cvt_pk_bf16_f32 v32, v24, v25
    v_lshlrev_b32 v24, 16, v32
    v_and_b32 v25, 0xffff0000, v32
    v_cvt_pk_bf16_f32 v32, v26, v27
    v_lshlrev_b32 v26, 16, v32
    v_and_b32 v27, 0xffff0000, v32
    v_cvt_pk_bf16_f32 v32, v28, v29
    v_lshlrev_b32 v28, 16, v32
    v_and_b32 v29, 0xffff0000, v32
    v_pk_mul_f32 v[14:15], v[14:15], v[14:15]
    v_pk_mul_f32 v[16:17], v[16:17], v[16:17]
    v_pk_mul_f32 v[18:19], v[18:19], v[18:19]
    v_pk_mul_f32 v[20:21], v[20:21], v[20:21]
    v_pk_mul_f32 v[22:23], v[22:23], v[22:23]
    v_pk_mul_f32 v[24:25], v[24:25], v[24:25]
    v_pk_mul_f32 v[26:27], v[26:27], v[26:27]
    v_pk_mul_f32 v[28:29], v[28:29], v[28:29]
    v_cvt_pk_bf16_f32 v32, v14, v15
    v_lshlrev_b32 v14, 16, v32
    v_and_b32 v15, 0xffff0000, v32
    v_cvt_pk_bf16_f32 v32, v16, v17
    v_lshlrev_b32 v16, 16, v32
    v_and_b32 v17, 0xffff0000, v32
    v_cvt_pk_bf16_f32 v32, v18, v19
    v_lshlrev_b32 v18, 16, v32
    v_and_b32 v19, 0xffff0000, v32
    v_cvt_pk_bf16_f32 v32, v20, v21
    v_lshlrev_b32 v20, 16, v32
    v_and_b32 v21, 0xffff0000, v32
    v_cvt_pk_bf16_f32 v32, v22, v23
    v_lshlrev_b32 v22, 16, v32
    v_and_b32 v23, 0xffff0000, v32
    v_cvt_pk_bf16_f32 v32, v24, v25
    v_lshlrev_b32 v24, 16, v32
    v_and_b32 v25, 0xffff0000, v32
    v_cvt_pk_bf16_f32 v32, v26, v27
    v_lshlrev_b32 v26, 16, v32
    v_and_b32 v27, 0xffff0000, v32
    v_cvt_pk_bf16_f32 v32, v28, v29
    v_lshlrev_b32 v28, 16, v32
    v_and_b32 v29, 0xffff0000, v32
    v_mov_b32 v30, 1092616192
    v_mov_b32 v31, 0x3fb8aa3b
    v_pk_mul_f32 v[14:15], v[14:15], v[30:31] op_sel:[0,0] op_sel_hi:[1,0]
    v_pk_mul_f32 v[16:17], v[16:17], v[30:31] op_sel:[0,0] op_sel_hi:[1,0]
    v_pk_mul_f32 v[18:19], v[18:19], v[30:31] op_sel:[0,0] op_sel_hi:[1,0]
    v_pk_mul_f32 v[20:21], v[20:21], v[30:31] op_sel:[0,0] op_sel_hi:[1,0]
    v_pk_mul_f32 v[22:23], v[22:23], v[30:31] op_sel:[0,0] op_sel_hi:[1,0]
    v_pk_mul_f32 v[24:25], v[24:25], v[30:31] op_sel:[0,0] op_sel_hi:[1,0]
    v_pk_mul_f32 v[26:27], v[26:27], v[30:31] op_sel:[0,0] op_sel_hi:[1,0]
    v_pk_mul_f32 v[28:29], v[28:29], v[30:31] op_sel:[0,0] op_sel_hi:[1,0]
    v_cvt_pk_bf16_f32 v32, v14, v15
    v_lshlrev_b32 v14, 16, v32
    v_and_b32 v15, 0xffff0000, v32
    v_cvt_pk_bf16_f32 v32, v16, v17
    v_lshlrev_b32 v16, 16, v32
    v_and_b32 v17, 0xffff0000, v32
    v_cvt_pk_bf16_f32 v32, v18, v19
    v_lshlrev_b32 v18, 16, v32
    v_and_b32 v19, 0xffff0000, v32
    v_cvt_pk_bf16_f32 v32, v20, v21
    v_lshlrev_b32 v20, 16, v32
    v_and_b32 v21, 0xffff0000, v32
    v_cvt_pk_bf16_f32 v32, v22, v23
    v_lshlrev_b32 v22, 16, v32
    v_and_b32 v23, 0xffff0000, v32
    v_cvt_pk_bf16_f32 v32, v24, v25
    v_lshlrev_b32 v24, 16, v32
    v_and_b32 v25, 0xffff0000, v32
    v_cvt_pk_bf16_f32 v32, v26, v27
    v_lshlrev_b32 v26, 16, v32
    v_and_b32 v27, 0xffff0000, v32
    v_cvt_pk_bf16_f32 v32, v28, v29
    v_lshlrev_b32 v28, 16, v32
    v_and_b32 v29, 0xffff0000, v32
    v_pk_mul_f32 v[14:15], v[14:15], v[30:31] op_sel:[0,1] op_sel_hi:[1,1]
    v_pk_mul_f32 v[16:17], v[16:17], v[30:31] op_sel:[0,1] op_sel_hi:[1,1]
    v_pk_mul_f32 v[18:19], v[18:19], v[30:31] op_sel:[0,1] op_sel_hi:[1,1]
    v_pk_mul_f32 v[20:21], v[20:21], v[30:31] op_sel:[0,1] op_sel_hi:[1,1]
    v_pk_mul_f32 v[22:23], v[22:23], v[30:31] op_sel:[0,1] op_sel_hi:[1,1]
    v_pk_mul_f32 v[24:25], v[24:25], v[30:31] op_sel:[0,1] op_sel_hi:[1,1]
    v_pk_mul_f32 v[26:27], v[26:27], v[30:31] op_sel:[0,1] op_sel_hi:[1,1]
    v_pk_mul_f32 v[28:29], v[28:29], v[30:31] op_sel:[0,1] op_sel_hi:[1,1]
    v_exp_f32 v14, -v14
    v_exp_f32 v15, -v15
    v_exp_f32 v16, -v16
    v_exp_f32 v17, -v17
    v_exp_f32 v18, -v18
    v_exp_f32 v19, -v19
    v_exp_f32 v20, -v20
    v_exp_f32 v21, -v21
    v_exp_f32 v22, -v22
    v_exp_f32 v23, -v23
    v_exp_f32 v24, -v24
    v_exp_f32 v25, -v25
    v_exp_f32 v26, -v26
    v_exp_f32 v27, -v27
    v_exp_f32 v28, -v28
    v_exp_f32 v29, -v29
    v_cvt_pk_bf16_f32 v14, v14, v16
    v_cvt_pk_bf16_f32 v15, v15, v17
    v_cvt_pk_bf16_f32 v18, v18, v20
    v_cvt_pk_bf16_f32 v19, v19, v21
    v_cvt_pk_bf16_f32 v22, v22, v24
    v_cvt_pk_bf16_f32 v23, v23, v25
    v_cvt_pk_bf16_f32 v26, v26, v28
    v_cvt_pk_bf16_f32 v27, v27, v29
    v_dot2_f32_bf16 v112, v14, s68, 0
    v_dot2_f32_bf16 v113, v15, s68, 0
    v_dot2_f32_bf16 v114, v14, s69, 0
    v_dot2_f32_bf16 v115, v15, s69, 0
    v_dot2_f32_bf16 v116, v14, s70, 0
    v_dot2_f32_bf16 v117, v15, s70, 0
    v_dot2_f32_bf16 v118, v14, s71, 0
    v_dot2_f32_bf16 v119, v15, s71, 0
    v_dot2_f32_bf16 v120, v14, s52, 0
    v_dot2_f32_bf16 v121, v15, s52, 0
    v_dot2_f32_bf16 v122, v14, s53, 0
    v_dot2_f32_bf16 v123, v15, s53, 0
    v_dot2_f32_bf16 v124, v14, s54, 0
    v_dot2_f32_bf16 v125, v15, s54, 0
    v_dot2_f32_bf16 v126, v14, s55, 0
    v_dot2_f32_bf16 v127, v15, s55, 0
    v_dot2_f32_bf16 v112, v18, s72, v112
    v_dot2_f32_bf16 v113, v19, s72, v113
    v_dot2_f32_bf16 v114, v18, s73, v114
    v_dot2_f32_bf16 v115, v19, s73, v115
    v_dot2_f32_bf16 v116, v18, s74, v116
    v_dot2_f32_bf16 v117, v19, s74, v117
    v_dot2_f32_bf16 v118, v18, s75, v118
    v_dot2_f32_bf16 v119, v19, s75, v119
    v_dot2_f32_bf16 v120, v18, s56, v120
    v_dot2_f32_bf16 v121, v19, s56, v121
    v_dot2_f32_bf16 v122, v18, s57, v122
    v_dot2_f32_bf16 v123, v19, s57, v123
    v_dot2_f32_bf16 v124, v18, s58, v124
    v_dot2_f32_bf16 v125, v19, s58, v125
    v_dot2_f32_bf16 v126, v18, s59, v126
    v_dot2_f32_bf16 v127, v19, s59, v127
    v_dot2_f32_bf16 v112, v22, s76, v112
    v_dot2_f32_bf16 v113, v23, s76, v113
    v_dot2_f32_bf16 v114, v22, s77, v114
    v_dot2_f32_bf16 v115, v23, s77, v115
    v_dot2_f32_bf16 v116, v22, s78, v116
    v_dot2_f32_bf16 v117, v23, s78, v117
    v_dot2_f32_bf16 v118, v22, s79, v118
    v_dot2_f32_bf16 v119, v23, s79, v119
    v_dot2_f32_bf16 v120, v22, s60, v120
    v_dot2_f32_bf16 v121, v23, s60, v121
    v_dot2_f32_bf16 v122, v22, s61, v122
    v_dot2_f32_bf16 v123, v23, s61, v123
    v_dot2_f32_bf16 v124, v22, s62, v124
    v_dot2_f32_bf16 v125, v23, s62, v125
    v_dot2_f32_bf16 v126, v22, s63, v126
    v_dot2_f32_bf16 v127, v23, s63, v127
    v_dot2_f32_bf16 v112, v26, s80, v112
    v_dot2_f32_bf16 v113, v27, s80, v113
    v_dot2_f32_bf16 v114, v26, s81, v114
    v_dot2_f32_bf16 v115, v27, s81, v115
    v_dot2_f32_bf16 v116, v26, s82, v116
    v_dot2_f32_bf16 v117, v27, s82, v117
    v_dot2_f32_bf16 v118, v26, s83, v118
    v_dot2_f32_bf16 v119, v27, s83, v119
    v_dot2_f32_bf16 v120, v26, s64, v120
    v_dot2_f32_bf16 v121, v27, s64, v121
    v_dot2_f32_bf16 v122, v26, s65, v122
    v_dot2_f32_bf16 v123, v27, s65, v123
    v_dot2_f32_bf16 v124, v26, s66, v124
    v_dot2_f32_bf16 v125, v27, s66, v125
    v_dot2_f32_bf16 v126, v26, s67, v126
    v_dot2_f32_bf16 v127, v27, s67, v127
L_p2_kernel_g1_30:
    s_cmp_eq_u32 s49, 3
    s_cselect_b32 s15, 8, 0
    s_add_u32 s15, s15, 224
    v_add_u32 v2, 16384, v1
    v_cmp_gt_u32 vcc, s15, v0
    s_mul_i32 s14, s3, 80000
    s_mul_i32 s26, s49, 19968
    s_add_u32 s26, s26, s14
    v_cndmask_b32 v2, 0.5, v2, vcc
    s_mov_b32 s10, 5120000
    buffer_load_dwordx4 v[64:67], v1, s[8:11], s26 offen
    buffer_load_dwordx4 v[68:71], v2, s[8:11], s26 offen
    s_branch L_p2_fin
L_p2_done:
    s_branch L_p2_end
L_p2_slow:
    s_barrier
    v_mov_b32 v8, 0
    v_mov_b32 v9, 0
    v_mov_b32 v10, 0
    v_mov_b32 v11, 0
    v_mov_b32 v12, v1
    ds_write_b128 v12, v[8:11]
    v_add_u32 v12, 16384, v12
    ds_write_b128 v12, v[8:11]
    v_add_u32 v12, 16384, v12
    ds_write_b128 v12, v[8:11]
    v_add_u32 v12, 16384, v12
    ds_write_b128 v12, v[8:11]
    v_add_u32 v12, 16384, v12
    ds_write_b128 v12, v[8:11]
    v_add_u32 v12, 16384, v12
    ds_write_b128 v12, v[8:11]
    v_add_u32 v12, 16384, v12
    ds_write_b128 v12, v[8:11]
    v_add_u32 v12, 16384, v12
    ds_write_b128 v12, v[8:11]
    v_add_u32 v12, 16384, v12
    ds_write_b128 v12, v[8:11]
    v_add_u32 v12, 16384, v12
    ds_write_b128 v12, v[8:11]
    v_add_u32 v12, 16384, v12
    v_mul_u32_u24 v13, 8320, v0
    v_mov_b32 v29, 0x7fc00000
    v_add_u32 v28, 32, v13
    v_lshlrev_b32 v14, 12, v0
    v_add_u32 v14, 0, v14
    s_mul_i32 s25, s12, 65
    s_add_u32 s25, s25, s3
    s_lshl_b32 s25, s25, 5
    s_add_u32 s25, s25, 222298112
    s_lshl_b32 s50, s50, 1
    s_mul_i32 s22, s12, 1280000
    s_mov_b32 s24, 0
    s_waitcnt lgkmcnt(0)
    s_barrier
L_p2_sstep:
    buffer_load_ushort v15, v13, s[4:7], s25 offen
    buffer_load_ushort v16, v28, s[4:7], s25 offen
    s_waitcnt vmcnt(0)
L_p2_srec:
    v_cmp_lt_u32 vcc, v15, v16
    s_nop 1
    s_and_b64 exec, exec, vcc
    s_cbranch_execz L_p2_sdone
    v_mul_u32_u24 v17, 43691, v15
    v_lshrrev_b32 v17, 17, v17
    v_mad_i32_i24 v18, v17, -3, v15
    v_lshrrev_b32 v19, 8, v17
    v_lshl_add_u32 v19, v19, 22, v14
    v_and_b32 v17, 255, v17
    v_lshl_add_u32 v17, v17, 4, v19
    v_lshl_add_u32 v19, v18, 2, v17
    buffer_load_dword v20, v19, s[4:7], 0 offen
    buffer_load_dword v21, v17, s[4:7], 0 offen offset:12
    v_add_u32 v15, 1, v15
    v_mad_u32_u24 v18, v18, 10, 2
    s_waitcnt vmcnt(0)
    v_and_b32 v19, 0x3fff, v20
    v_lshlrev_b32 v19, 3, v19
    buffer_load_dwordx2 v[22:23], v19, s[8:11], s22 offen
    v_mad_u32_u16 v20, v20, 16, s50 op_sel:[1,0,0,0]
    v_bfe_i32 v21, v21, v18, 10
    v_cmp_eq_i32 vcc, -512, v21
    v_cvt_f32_i32 v21, v21
    v_mul_f32 v21, 989872160, v21
    v_cndmask_b32 v21, v21, v29, vcc
    s_waitcnt vmcnt(0)
    v_lshlrev_b32 v24, 16, v22
    v_and_b32 v25, 0xffff0000, v22
    v_lshlrev_b32 v26, 16, v23
    v_and_b32 v27, 0xffff0000, v23
    v_mul_f32 v24, v21, v24
    v_mul_f32 v25, v21, v25
    v_mul_f32 v26, v21, v26
    v_mul_f32 v27, v21, v27
    ds_add_f32 v20, v24
    ds_add_f32 v20, v25 offset:4
    ds_add_f32 v20, v26 offset:8
    ds_add_f32 v20, v27 offset:12
    s_branch L_p2_srec
L_p2_sdone:
    s_mov_b64 exec, -1
    s_add_u32 s25, s25, 2
    s_add_u32 s22, s22, 80000
    s_add_u32 s24, s24, 1
    s_cmp_lt_u32 s24, 16
    s_cbranch_scc1 L_p2_sstep
    s_waitcnt lgkmcnt(0)
    s_barrier
    s_mul_i32 s14, s12, 10240000
    s_mul_i32 s15, s3, 160000
    s_add_u32 s26, s14, s15
    s_add_u32 s26, s26, 251318272
    v_mov_b32 v12, v1
    s_mov_b32 s24, 0
L_p2_sout:
    v_cmp_gt_u32 vcc, 160000, v12
    ds_read_b128 v[8:11], v12
    s_nop 0
    s_and_b64 exec, exec, vcc
    s_cbranch_execz L_p2_sfin
    s_waitcnt lgkmcnt(0)
    buffer_store_dwordx4 v[8:11], v12, s[4:7], s26 offen sc1
    s_waitcnt vmcnt(0)
    v_add_u32 v12, 16384, v12
    s_branch L_p2_sout
L_p2_sfin:
    s_mov_b64 exec, -1
    s_waitcnt vmcnt(0) lgkmcnt(0)
    s_barrier
    s_branch L_p2_signal
L_p2_end:
    s_endpgm
.section .rodata,"a"
.p2align 6
.amdhsa_kernel p1_kernel
  .amdhsa_next_free_vgpr 128
  .amdhsa_next_free_sgpr 96
  .amdhsa_accum_offset 128
  .amdhsa_group_segment_fixed_size 0
  .amdhsa_kernarg_size 112
  .amdhsa_user_sgpr_count 2
  .amdhsa_user_sgpr_kernarg_segment_ptr 1
  .amdhsa_system_sgpr_workgroup_id_x 1
  .amdhsa_float_denorm_mode_32 0
.end_amdhsa_kernel
.p2align 6
.amdhsa_kernel p2_kernel
  .amdhsa_next_free_vgpr 128
  .amdhsa_next_free_sgpr 102
  .amdhsa_accum_offset 128
  .amdhsa_group_segment_fixed_size 0
  .amdhsa_kernarg_size 112
  .amdhsa_user_sgpr_count 2
  .amdhsa_user_sgpr_kernarg_segment_ptr 1
  .amdhsa_system_sgpr_workgroup_id_x 1
  .amdhsa_float_denorm_mode_32 0
.end_amdhsa_kernel
```

```asm
; @launch kernel=p1_kernel grid=(256,1,1) block=(1024,1,1) lds=163840
; @launch kernel=p2_kernel grid=(256,1,1) block=(1024,1,1) lds=163840
.amdgcn_target "amdgcn-amd-amdhsa--gfx950"
.text
.globl p1_kernel
.p2align 8
.type p1_kernel,@function
p1_kernel:
    s_cmp_ge_u32 s2, 256
    s_cbranch_scc1 L_p1_end
    s_load_dwordx2 s[4:5], s[0:1], 104
    s_load_dwordx2 s[8:9], s[0:1], 8
    s_load_dwordx2 s[12:13], s[0:1], 16
    s_load_dwordx2 s[16:17], s[0:1], 32
    s_load_dwordx2 s[28:29], s[0:1], 0
    s_load_dwordx2 s[6:7], s[0:1], 48
    s_load_dwordx2 s[84:85], s[0:1], 96
    v_cmp_gt_u32 vcc, 256, v0
    s_nop 1
    s_cbranch_vccz L_p1_nopf
    s_getpc_b64 s[72:73]
L_p1_kernel_pc_1:
    s_add_u32 s72, s72, L_p1_nopf-L_p1_kernel_pc_1
    s_addc_u32 s73, s73, 0
    v_lshlrev_b32 v14, 7, v0
    v_min_u32 v14, L_p2_end-L_p1_nopf, v14
    global_load_dword v15, v14, s[72:73]
L_p1_nopf:
    v_lshlrev_b32 v1, 4, v0
    v_lshlrev_b32 v2, 3, v0
    v_lshrrev_b32 v6, 6, v0
    v_and_b32 v3, 1023, v1
    v_mov_b32 v4, 1
    v_mov_b32 v5, 0
    v_readfirstlane_b32 s39, v6
    v_cmp_gt_u32 vcc, 784, v0
    s_and_b32 s51, s2, 7
    s_lshl_b32 s51, s51, 0
    s_bfe_u32 s35, s2, 3
    s_add_u32 s51, s51, s35
    s_and_b32 s35, s2, 248
    s_add_u32 s51, s51, s35
    s_lshr_b32 s35, s39, 4
    s_mul_i32 s36, s35, 4177920
    s_lshl_b32 s33, s51, 14
    s_add_u32 s33, s33, s36
    s_lshr_b32 s34, s33, 1
    s_mul_i32 s48, s51, 3840
    s_cmp_ge_u32 s35, 0
    s_cselect_b32 s48, s48, 0
    s_lshr_b32 s49, s48, 1
    s_mov_b64 s[44:45], vcc
    s_waitcnt lgkmcnt(0)
    s_load_dword s3, s[6:7], 0
    s_mov_b32 s10, 163840000
    s_mov_b32 s11, 0x00020000
    s_mov_b32 s14, 163840000
    s_mov_b32 s15, 0x00020000
    s_mov_b32 s18, 81920000
    s_mov_b32 s19, 0x00020000
    s_mov_b32 s86, 256
    s_mov_b32 s87, 0x00020000
    s_mul_i32 s36, s2, 20000
    s_add_u32 s30, s36, 20000
    s_mov_b32 s31, 0x00020000
    s_add_u32 s35, s36, 16384
    buffer_load_dwordx4 v[48:51], v1, s[28:31], s36 offen
    buffer_load_dwordx4 v[52:55], v1, s[28:31], s35 offen
    s_add_u32 s35, s33, 0
    buffer_load_dwordx4 v[16:19], v1, s[8:11], s35 offen nt
    s_add_u32 s35, s33, 0
    buffer_load_dwordx4 v[20:23], v1, s[12:15], s35 offen nt
    s_add_u32 s35, s33, 4194304
    buffer_load_dwordx4 v[24:27], v1, s[8:11], s35 offen nt
    s_add_u32 s35, s33, 4194304
    buffer_load_dwordx4 v[28:31], v1, s[12:15], s35 offen nt
    s_add_u32 s35, s33, 8388608
    buffer_load_dwordx4 v[32:35], v1, s[8:11], s35 offen nt
    s_add_u32 s35, s33, 8388608
    buffer_load_dwordx4 v[36:39], v1, s[12:15], s35 offen nt
    s_add_u32 s35, s33, 12582912
    buffer_load_dwordx4 v[40:43], v1, s[8:11], s35 offen nt
    s_add_u32 s35, s33, 12582912
    buffer_load_dwordx4 v[44:47], v1, s[12:15], s35 offen nt
    s_add_u32 s35, s33, 16777216
    buffer_load_dwordx4 v[72:75], v1, s[8:11], s35 offen nt
    s_add_u32 s35, s33, 16777216
    buffer_load_dwordx4 v[76:79], v1, s[12:15], s35 offen nt
    s_cmp_lg_u32 s39, 0
    s_cbranch_scc1 L_p1_noprobe
    s_cmp_ge_u32 s2, 64
    s_cbranch_scc1 L_p1_noprobe
    s_mul_i32 s88, s2, 208
    s_lshr_b32 s88, s88, 8
    s_lshl_b32 s88, s88, 22
    s_and_b32 s90, s2, 63
    s_mul_i32 s90, s90, 16384
    s_add_u32 s88, s88, s90
    s_add_u32 s88, s4, s88
    s_addc_u32 s89, s5, 0
    s_load_dword s91, s[88:89], 0x1000
    s_lshl_b32 s90, s2, 10
    s_and_b32 s90, s90, 0x2000
    s_xor_b32 s94, s90, 0x2000
    s_waitcnt lgkmcnt(0)
    s_load_dword s91, s[88:89], s90
    s_load_dwordx2 s[92:93], s[88:89], s94
    s_waitcnt lgkmcnt(2)
    s_getreg_b32 s35, hwreg(HW_REG_IB_STS, 9, 1)
    s_waitcnt lgkmcnt(0)
    s_getreg_b32 s91, hwreg(HW_REG_XCC_ID, 0, 3)
    s_lshr_b32 s90, s2, 3
    s_lshr_b32 s92, s91, 2
    s_xor_b32 s90, s90, s92
    s_xor_b32 s90, s90, s35
    s_and_b32 s90, s90, 1
    s_or_b32 s90, s90, 0x10000
    v_mov_b32 v8, s90
    s_mov_b64 exec, 1
    buffer_atomic_add v8, off, s[84:87], 0 offset:128 sc0
    s_sub_u32 s91, s91, s2
    s_and_b32 s91, s91, 7
    s_or_b32 s92, s91, 8
    s_waitcnt vmcnt(0)
    v_readfirstlane_b32 s93, v8
    s_nop 0
    s_add_u32 s90, s90, s93
    s_cmp_le_u32 s90, 3145746
    s_cselect_b32 s92, s92, 16
    s_cmp_ge_u32 s90, 3145758
    s_cselect_b32 s92, s91, s92
    s_or_b32 s92, s92, 32
    v_mov_b32 v8, s92
    v_mov_b32 v9, 0
    s_lshr_b32 s90, s90, 16
    s_cmp_lg_u32 s90, 48
    s_cbranch_scc1 L_p1_voted
    buffer_atomic_cmpswap v[8:9], off, s[84:87], 0
L_p1_voted:
    s_mov_b64 exec, -1
L_p1_noprobe:
    s_mov_b32 s20, s4
    s_mov_b32 s21, s5
    s_mov_b32 s22, 0
    s_mov_b32 s23, 0x00020000
    s_add_u32 s24, s4, 222298112
    s_addc_u32 s25, s5, 0
    s_mov_b32 s26, 8540160
    s_mov_b32 s27, 0x00020000
    s_mov_b32 s37, 1492179184
    s_mov_b32 s55, 0
    s_mov_b64 s[76:77], 0
    s_mul_i32 s42, s39, 13
    s_mov_b64 s[72:73], s[4:5]
    s_mov_b32 s74, 0
    s_mov_b32 s75, 0x00020000
    s_mov_b32 s50, 21845
    s_mov_b32 s52, 0x8000
    s_mov_b32 s38, 262400
    s_mov_b32 s43, 0x05040100
    s_mov_b32 s40, 0
    v_mov_b32 v8, 0
    v_mov_b32 v9, 0
    v_mov_b32 v10, 0
    v_mov_b32 v11, 0
    ds_write_b128 v1, v[8:11] offset:0
    v_min_u32 v7, 16, v0
    v_lshlrev_b32 v7, 2, v7
    v_add_u32 v7, 160768, v7
    ds_write_b32 v7, v8
    s_waitcnt lgkmcnt(0)
    s_lshl_b32 s3, s3, 16
    v_mov_b32 v12, s3
    v_mul_f32 v12, 0.15915494, v12
    s_nop 0
    v_readfirstlane_b32 s41, v12
    s_waitcnt vmcnt(10)
    v_mov_b32 v12, 0x3f803f80
    v_and_b32 v48, 0x7fff7fff, v48
    v_and_b32 v49, 0x7fff7fff, v49
    v_and_b32 v50, 0x7fff7fff, v50
    v_and_b32 v51, 0x7fff7fff, v51
    v_and_b32 v52, 0x7fff7fff, v52
    v_and_b32 v53, 0x7fff7fff, v53
    v_and_b32 v54, 0x7fff7fff, v54
    v_and_b32 v55, 0x7fff7fff, v55
    v_pk_max_u16 v8, v8, v48
    v_dot2c_f32_bf16 v9, v48, v12
    v_pk_max_u16 v8, v8, v49
    v_dot2c_f32_bf16 v9, v49, v12
    v_pk_max_u16 v8, v8, v50
    v_dot2c_f32_bf16 v9, v50, v12
    v_pk_max_u16 v8, v8, v51
    v_dot2c_f32_bf16 v9, v51, v12
    v_pk_max_u16 v8, v8, v52
    v_dot2c_f32_bf16 v9, v52, v12
    v_pk_max_u16 v8, v8, v53
    v_dot2c_f32_bf16 v9, v53, v12
    v_pk_max_u16 v8, v8, v54
    v_dot2c_f32_bf16 v9, v54, v12
    v_pk_max_u16 v8, v8, v55
    v_dot2c_f32_bf16 v9, v55, v12
    v_lshrrev_b32 v10, 16, v8
    v_and_b32 v8, 0xffff, v8
    v_max_u32 v8, v8, v10
    s_nop 0
    s_nop 1
    v_max_u32_dpp v8, v8, v8 row_shr:1 row_mask:0xf bank_mask:0xf bound_ctrl:0
    s_nop 1
    v_max_u32_dpp v8, v8, v8 row_shr:2 row_mask:0xf bank_mask:0xf bound_ctrl:0
    s_nop 1
    v_max_u32_dpp v8, v8, v8 row_shr:4 row_mask:0xf bank_mask:0xf bound_ctrl:0
    s_nop 1
    v_max_u32_dpp v8, v8, v8 row_shr:8 row_mask:0xf bank_mask:0xf bound_ctrl:0
    s_nop 1
    v_max_u32_dpp v8, v8, v8 row_bcast:15 row_mask:0xa bank_mask:0xf
    s_nop 1
    v_max_u32_dpp v8, v8, v8 row_bcast:31 row_mask:0xc bank_mask:0xf
    s_nop 1
    v_add_f32_dpp v9, v9, v9 row_shr:1 row_mask:0xf bank_mask:0xf bound_ctrl:0
    s_nop 1
    v_add_f32_dpp v9, v9, v9 row_shr:2 row_mask:0xf bank_mask:0xf bound_ctrl:0
    s_nop 1
    v_add_f32_dpp v9, v9, v9 row_shr:4 row_mask:0xf bank_mask:0xf bound_ctrl:0
    s_nop 1
    v_add_f32_dpp v9, v9, v9 row_shr:8 row_mask:0xf bank_mask:0xf bound_ctrl:0
    s_nop 1
    v_add_f32_dpp v9, v9, v9 row_bcast:15 row_mask:0xa bank_mask:0xf
    s_nop 1
    v_add_f32_dpp v9, v9, v9 row_bcast:31 row_mask:0xc bank_mask:0xf
    s_lshl_b32 s35, s39, 4
    s_add_u32 s35, s35, 160320
    v_mov_b32 v10, s35
    s_mov_b32 exec_lo, 0
    s_brev_b32 exec_hi, 1
    ds_write_b64 v10, v[8:9]
    s_mov_b64 exec, -1
    s_waitcnt lgkmcnt(0)
    s_barrier
    s_cmp_lg_u32 s39, 0
    s_cbranch_scc1 L_p1_first
    v_and_b32 v6, 15, v0
    v_lshlrev_b32 v6, 4, v6
    v_add_u32 v6, 160320, v6
    ds_read_b64 v[8:9], v6
    s_waitcnt lgkmcnt(0)
    s_nop 1
    v_max_u32_dpp v8, v8, v8 row_shr:1 row_mask:0xf bank_mask:0xf bound_ctrl:0
    s_nop 1
    v_max_u32_dpp v8, v8, v8 row_shr:2 row_mask:0xf bank_mask:0xf bound_ctrl:0
    s_nop 1
    v_max_u32_dpp v8, v8, v8 row_shr:4 row_mask:0xf bank_mask:0xf bound_ctrl:0
    s_nop 1
    v_max_u32_dpp v8, v8, v8 row_shr:8 row_mask:0xf bank_mask:0xf bound_ctrl:0
    s_nop 1
    v_add_f32_dpp v9, v9, v9 row_shr:1 row_mask:0xf bank_mask:0xf bound_ctrl:0
    s_nop 1
    v_add_f32_dpp v9, v9, v9 row_shr:2 row_mask:0xf bank_mask:0xf bound_ctrl:0
    s_nop 1
    v_add_f32_dpp v9, v9, v9 row_shr:4 row_mask:0xf bank_mask:0xf bound_ctrl:0
    s_nop 1
    v_add_f32_dpp v9, v9, v9 row_shr:8 row_mask:0xf bank_mask:0xf bound_ctrl:0
    s_lshl_b32 s35, s2, 3
    s_add_u32 s35, s35, 8519680
    v_mov_b32 v6, 0
    s_mov_b64 exec, 0x8000
    buffer_store_dwordx2 v[8:9], v6, s[24:27], s35 offen sc1
    s_lshl_b32 s35, s2, 8
    s_add_u32 s35, s35, 8523776
    buffer_store_dword v6, v6, s[24:27], s35 offen sc1
    s_mov_b64 exec, -1
    s_branch L_p1_first
L_p1_loop:
    s_mov_b64 s[72:73], s[20:21]
    s_mov_b32 s74, s22
    s_cmp_lg_u32 s39, 15
    s_cbranch_scc1 L_p1_kernel_nox_2
    s_waitcnt lgkmcnt(13)
    v_lshlrev_b32 v15, 16, v120
    v_and_b32 v120, 0xffff0000, v120
    v_lshlrev_b32 v121, 16, v121
    v_mul_f32 v15, s41, v15
    v_mul_f32 v120, s41, v120
    v_mul_f32 v121, s41, v121
    v_fract_f32 v15, v15
    v_fract_f32 v120, v120
    v_fract_f32 v121, v121
    v_cos_f32 v15, v15
    v_cos_f32 v120, v120
    v_cos_f32 v121, v121
    v_fmaak_f32 v15, v10, v15, 1262486016
    v_fmaak_f32 v120, v10, v120, 1262486016
    v_fmaak_f32 v121, v10, v121, 1262486016
    v_lshlrev_b32 v15, 22, v15
    v_alignbit_b32 v15, v120, v15, 10
    v_alignbit_b32 v15, v121, v15, 10
    v_xor_b32 v15, 0x80200800, v15
    s_add_u32 s36, s42, 13
    s_and_b32 s35, s36, 3
    s_mul_i32 s35, s35, 1047552
    s_lshl_b32 s36, s36, 20
    s_sub_u32 s36, s36, s35
    buffer_store_dwordx4 v[12:15], v3, s[20:23], s36 offen sc1
L_p1_kernel_nox_2:
    s_waitcnt lgkmcnt(12)
    v_lshlrev_b32 v75, 16, v122
    v_and_b32 v122, 0xffff0000, v122
    v_lshlrev_b32 v123, 16, v123
    v_mul_f32 v75, s41, v75
    v_mul_f32 v122, s41, v122
    v_mul_f32 v123, s41, v123
    v_fract_f32 v75, v75
    v_fract_f32 v122, v122
    v_fract_f32 v123, v123
    v_cos_f32 v75, v75
    v_cos_f32 v122, v122
    v_cos_f32 v123, v123
    v_fmaak_f32 v75, v10, v75, 1262486016
    v_fmaak_f32 v122, v10, v122, 1262486016
    v_fmaak_f32 v123, v10, v123, 1262486016
    v_lshlrev_b32 v75, 22, v75
    v_alignbit_b32 v75, v122, v75, 10
    v_alignbit_b32 v75, v123, v75, 10
    v_xor_b32 v75, 0x80200800, v75
    s_add_u32 s36, s42, 0
    s_and_b32 s35, s36, 3
    s_mul_i32 s35, s35, 1047552
    s_lshl_b32 s36, s36, 20
    s_sub_u32 s36, s36, s35
    buffer_store_dwordx4 v[72:75], v3, s[20:23], s36 offen sc1
    s_waitcnt lgkmcnt(11)
    v_lshlrev_b32 v79, 16, v124
    v_and_b32 v124, 0xffff0000, v124
    v_lshlrev_b32 v125, 16, v125
    v_mul_f32 v79, s41, v79
    v_mul_f32 v124, s41, v124
    v_mul_f32 v125, s41, v125
    v_fract_f32 v79, v79
    v_fract_f32 v124, v124
    v_fract_f32 v125, v125
    v_cos_f32 v79, v79
    v_cos_f32 v124, v124
    v_cos_f32 v125, v125
    v_fmaak_f32 v79, v10, v79, 1262486016
    v_fmaak_f32 v124, v10, v124, 1262486016
    v_fmaak_f32 v125, v10, v125, 1262486016
    v_lshlrev_b32 v79, 22, v79
    v_alignbit_b32 v79, v124, v79, 10
    v_alignbit_b32 v79, v125, v79, 10
    v_xor_b32 v79, 0x80200800, v79
    s_add_u32 s36, s42, 1
    s_and_b32 s35, s36, 3
    s_mul_i32 s35, s35, 1047552
    s_lshl_b32 s36, s36, 20
    s_sub_u32 s36, s36, s35
    buffer_store_dwordx4 v[76:79], v3, s[20:23], s36 offen sc1
    s_waitcnt lgkmcnt(0)
    v_lshlrev_b32 v51, 16, v126
    v_and_b32 v126, 0xffff0000, v126
    v_lshlrev_b32 v127, 16, v127
    v_mul_f32 v51, s41, v51
    v_mul_f32 v126, s41, v126
    v_mul_f32 v127, s41, v127
    v_fract_f32 v51, v51
    v_fract_f32 v126, v126
    v_fract_f32 v127, v127
    v_cos_f32 v51, v51
    v_cos_f32 v126, v126
    v_cos_f32 v127, v127
    v_fmaak_f32 v51, v10, v51, 1262486016
    v_fmaak_f32 v126, v10, v126, 1262486016
    v_fmaak_f32 v127, v10, v127, 1262486016
    v_lshlrev_b32 v51, 22, v51
    v_alignbit_b32 v51, v126, v51, 10
    v_alignbit_b32 v51, v127, v51, 10
    v_xor_b32 v51, 0x80200800, v51
    s_add_u32 s36, s42, 2
    s_and_b32 s35, s36, 3
    s_mul_i32 s35, s35, 1047552
    s_lshl_b32 s36, s36, 20
    s_sub_u32 s36, s36, s35
    buffer_store_dwordx4 v[48:51], v3, s[20:23], s36 offen sc1
    s_add_u32 s35, s33, 16777216
    buffer_load_dwordx4 v[72:75], v1, s[8:11], s35 offen nt
    s_add_u32 s35, s33, 16777216
    buffer_load_dwordx4 v[76:79], v1, s[12:15], s35 offen nt
    v_perm_b32 v6, v20, v16, s43
    v_perm_b32 v7, v21, v17, s43
    v_perm_b32 v8, v22, v18, s43
    v_perm_b32 v9, v23, v19, s43
    v_mul_hi_u32_u24 v16, 429497, v16
    v_mul_hi_u32_u24 v20, 429497, v20
    v_mul_hi_u32_u24 v17, 429497, v17
    v_mul_hi_u32_u24 v21, 429497, v21
    v_mul_hi_u32_u24 v18, 429497, v18
    v_mul_hi_u32_u24 v22, 429497, v22
    v_mul_hi_u32_u24 v19, 429497, v19
    v_mul_hi_u32_u24 v23, 429497, v23
    v_lshl_or_b32 v16, v20, 16, v16
    v_lshl_or_b32 v17, v21, 16, v17
    v_lshl_or_b32 v18, v22, 16, v18
    v_lshl_or_b32 v19, v23, 16, v19
    v_dot2_u32_u16 v20, v16, s38, 0
    v_dot2_u32_u16 v21, v17, s38, 0
    v_dot2_u32_u16 v22, v18, s38, 0
    v_dot2_u32_u16 v23, v19, s38, 0
    v_pk_mad_u16 v6, v16, s37, v6
    v_pk_mad_u16 v7, v17, s37, v7
    v_pk_mad_u16 v8, v18, s37, v8
    v_pk_mad_u16 v9, v19, s37, v9
    ds_add_u32 v20, v4 offset:0
    ds_add_u32 v21, v4 offset:0
    ds_add_u32 v22, v4 offset:0
    ds_add_u32 v23, v4 offset:0
    v_pk_mad_u16 v6, v16, s52, v6 op_sel:[1,0,0] op_sel_hi:[1,1,1]
    v_pk_mad_u16 v7, v17, s52, v7 op_sel:[1,0,0] op_sel_hi:[1,1,1]
    v_pk_mad_u16 v8, v18, s52, v8 op_sel:[1,0,0] op_sel_hi:[1,1,1]
    v_pk_mad_u16 v9, v19, s52, v9 op_sel:[1,0,0] op_sel_hi:[1,1,1]
    v_perm_b32 v121, v23, v22, s43
    v_perm_b32 v120, v21, v20, s43
    v_or_b32 v127, 0x40000000, v6
    v_or_b32 v48, 0x40000000, v7
    v_or_b32 v49, 0x40000000, v8
    v_or_b32 v50, 0x40000000, v9
    v_lshlrev_b32 v83, 16, v100
    v_and_b32 v100, 0xffff0000, v100
    v_lshlrev_b32 v101, 16, v101
    v_mul_f32 v83, s41, v83
    v_mul_f32 v100, s41, v100
    v_mul_f32 v101, s41, v101
    v_fract_f32 v83, v83
    v_fract_f32 v100, v100
    v_fract_f32 v101, v101
    v_cos_f32 v83, v83
    v_cos_f32 v100, v100
    v_cos_f32 v101, v101
    v_fmaak_f32 v83, v10, v83, 1262486016
    v_fmaak_f32 v100, v10, v100, 1262486016
    v_fmaak_f32 v101, v10, v101, 1262486016
    v_lshlrev_b32 v83, 22, v83
    v_alignbit_b32 v83, v100, v83, 10
    v_alignbit_b32 v83, v101, v83, 10
    v_xor_b32 v83, 0x80200800, v83
    s_add_u32 s36, s42, 3
    s_and_b32 s35, s36, 3
    s_mul_i32 s35, s35, 1047552
    s_lshl_b32 s36, s36, 20
    s_sub_u32 s36, s36, s35
    buffer_store_dwordx4 v[80:83], v3, s[20:23], s36 offen sc1
    v_lshlrev_b32 v55, 16, v102
    v_and_b32 v102, 0xffff0000, v102
    v_lshlrev_b32 v103, 16, v103
    v_mul_f32 v55, s41, v55
    v_mul_f32 v102, s41, v102
    v_mul_f32 v103, s41, v103
    v_fract_f32 v55, v55
    v_fract_f32 v102, v102
    v_fract_f32 v103, v103
    v_cos_f32 v55, v55
    v_cos_f32 v102, v102
    v_cos_f32 v103, v103
    v_fmaak_f32 v55, v10, v55, 1262486016
    v_fmaak_f32 v102, v10, v102, 1262486016
    v_fmaak_f32 v103, v10, v103, 1262486016
    v_lshlrev_b32 v55, 22, v55
    v_alignbit_b32 v55, v102, v55, 10
    v_alignbit_b32 v55, v103, v55, 10
    v_xor_b32 v55, 0x80200800, v55
    s_cmp_lg_u32 s40, 3
    s_cbranch_scc1 L_p1_kernel_now_3
    v_mov_b64 v[16:17], v[52:53]
    v_mov_b64 v[18:19], v[54:55]
    s_branch L_p1_kernel_held_4
L_p1_kernel_now_3:
    s_add_u32 s36, s42, 4
    s_and_b32 s35, s36, 3
    s_mul_i32 s35, s35, 1047552
    s_lshl_b32 s36, s36, 20
    s_sub_u32 s36, s36, s35
    buffer_store_dwordx4 v[52:55], v3, s[20:23], s36 offen sc1
L_p1_kernel_held_4:
    s_add_u32 s35, s33, 20971520
    buffer_load_dwordx4 v[80:83], v1, s[8:11], s35 offen nt
    s_add_u32 s35, s33, 20971520
    buffer_load_dwordx4 v[100:103], v1, s[12:15], s35 offen nt
    v_lshlrev_b32 v87, 16, v104
    v_and_b32 v104, 0xffff0000, v104
    v_lshlrev_b32 v105, 16, v105
    v_mul_f32 v87, s41, v87
    v_mul_f32 v104, s41, v104
    v_mul_f32 v105, s41, v105
    v_fract_f32 v87, v87
    v_fract_f32 v104, v104
    v_fract_f32 v105, v105
    v_cos_f32 v87, v87
    v_cos_f32 v104, v104
    v_cos_f32 v105, v105
    v_fmaak_f32 v87, v10, v87, 1262486016
    v_fmaak_f32 v104, v10, v104, 1262486016
    v_fmaak_f32 v105, v10, v105, 1262486016
    v_lshlrev_b32 v87, 22, v87
    v_alignbit_b32 v87, v104, v87, 10
    v_alignbit_b32 v87, v105, v87, 10
    v_xor_b32 v87, 0x80200800, v87
    s_add_u32 s36, s42, 5
    s_and_b32 s35, s36, 3
    s_mul_i32 s35, s35, 1047552
    s_lshl_b32 s36, s36, 20
    s_sub_u32 s36, s36, s35
    buffer_store_dwordx4 v[84:87], v3, s[20:23], s36 offen sc1
    v_lshlrev_b32 v59, 16, v106
    v_and_b32 v106, 0xffff0000, v106
    v_lshlrev_b32 v107, 16, v107
    v_mul_f32 v59, s41, v59
    v_mul_f32 v106, s41, v106
    v_mul_f32 v107, s41, v107
    v_fract_f32 v59, v59
    v_fract_f32 v106, v106
    v_fract_f32 v107, v107
    v_cos_f32 v59, v59
    v_cos_f32 v106, v106
    v_cos_f32 v107, v107
    v_fmaak_f32 v59, v10, v59, 1262486016
    v_fmaak_f32 v106, v10, v106, 1262486016
    v_fmaak_f32 v107, v10, v107, 1262486016
    v_lshlrev_b32 v59, 22, v59
    v_alignbit_b32 v59, v106, v59, 10
    v_alignbit_b32 v59, v107, v59, 10
    v_xor_b32 v59, 0x80200800, v59
    s_cmp_lg_u32 s40, 3
    s_cbranch_scc1 L_p1_kernel_now_5
    v_mov_b64 v[20:21], v[56:57]
    v_mov_b64 v[22:23], v[58:59]
    s_branch L_p1_kernel_held_6
L_p1_kernel_now_5:
    s_add_u32 s36, s42, 6
    s_and_b32 s35, s36, 3
    s_mul_i32 s35, s35, 1047552
    s_lshl_b32 s36, s36, 20
    s_sub_u32 s36, s36, s35
    buffer_store_dwordx4 v[56:59], v3, s[20:23], s36 offen sc1
L_p1_kernel_held_6:
    s_add_u32 s35, s33, 25165824
    buffer_load_dwordx4 v[84:87], v1, s[8:11], s35 offen nt
    s_add_u32 s35, s33, 25165824
    buffer_load_dwordx4 v[104:107], v1, s[12:15], s35 offen nt
    v_perm_b32 v6, v28, v24, s43
    v_perm_b32 v7, v29, v25, s43
    v_perm_b32 v8, v30, v26, s43
    v_perm_b32 v9, v31, v27, s43
    v_mul_hi_u32_u24 v24, 429497, v24
    v_mul_hi_u32_u24 v28, 429497, v28
    v_mul_hi_u32_u24 v25, 429497, v25
    v_mul_hi_u32_u24 v29, 429497, v29
    v_mul_hi_u32_u24 v26, 429497, v26
    v_mul_hi_u32_u24 v30, 429497, v30
    v_mul_hi_u32_u24 v27, 429497, v27
    v_mul_hi_u32_u24 v31, 429497, v31
    v_lshl_or_b32 v24, v28, 16, v24
    v_lshl_or_b32 v25, v29, 16, v25
    v_lshl_or_b32 v26, v30, 16, v26
    v_lshl_or_b32 v27, v31, 16, v27
    v_dot2_u32_u16 v28, v24, s38, 0
    v_dot2_u32_u16 v29, v25, s38, 0
    v_dot2_u32_u16 v30, v26, s38, 0
    v_dot2_u32_u16 v31, v27, s38, 0
    v_pk_mad_u16 v6, v24, s37, v6
    v_pk_mad_u16 v7, v25, s37, v7
    v_pk_mad_u16 v8, v26, s37, v8
    v_pk_mad_u16 v9, v27, s37, v9
    ds_add_u32 v28, v4 offset:0
    ds_add_u32 v29, v4 offset:0
    ds_add_u32 v30, v4 offset:0
    ds_add_u32 v31, v4 offset:0
    v_pk_mad_u16 v6, v24, s52, v6 op_sel:[1,0,0] op_sel_hi:[1,1,1]
    v_pk_mad_u16 v7, v25, s52, v7 op_sel:[1,0,0] op_sel_hi:[1,1,1]
    v_pk_mad_u16 v8, v26, s52, v8 op_sel:[1,0,0] op_sel_hi:[1,1,1]
    v_pk_mad_u16 v9, v27, s52, v9 op_sel:[1,0,0] op_sel_hi:[1,1,1]
    v_perm_b32 v123, v31, v30, s43
    v_perm_b32 v122, v29, v28, s43
    v_or_b32 v52, 0x40000000, v6
    v_or_b32 v53, 0x40000000, v7
    v_or_b32 v54, 0x40000000, v8
    v_or_b32 v56, 0x40000000, v9
    v_lshlrev_b32 v91, 16, v108
    v_and_b32 v108, 0xffff0000, v108
    v_lshlrev_b32 v109, 16, v109
    v_mul_f32 v91, s41, v91
    v_mul_f32 v108, s41, v108
    v_mul_f32 v109, s41, v109
    v_fract_f32 v91, v91
    v_fract_f32 v108, v108
    v_fract_f32 v109, v109
    v_cos_f32 v91, v91
    v_cos_f32 v108, v108
    v_cos_f32 v109, v109
    v_fmaak_f32 v91, v10, v91, 1262486016
    v_fmaak_f32 v108, v10, v108, 1262486016
    v_fmaak_f32 v109, v10, v109, 1262486016
    v_lshlrev_b32 v91, 22, v91
    v_alignbit_b32 v91, v108, v91, 10
    v_alignbit_b32 v91, v109, v91, 10
    v_xor_b32 v91, 0x80200800, v91
    s_cmp_lg_u32 s40, 3
    s_cbranch_scc1 L_p1_kernel_now_7
    v_mov_b64 v[24:25], v[88:89]
    v_mov_b64 v[26:27], v[90:91]
    s_branch L_p1_kernel_held_8
L_p1_kernel_now_7:
    s_add_u32 s36, s42, 7
    s_and_b32 s35, s36, 3
    s_mul_i32 s35, s35, 1047552
    s_lshl_b32 s36, s36, 20
    s_sub_u32 s36, s36, s35
    buffer_store_dwordx4 v[88:91], v3, s[20:23], s36 offen sc1
L_p1_kernel_held_8:
    v_lshlrev_b32 v63, 16, v110
    v_and_b32 v110, 0xffff0000, v110
    v_lshlrev_b32 v111, 16, v111
    v_mul_f32 v63, s41, v63
    v_mul_f32 v110, s41, v110
    v_mul_f32 v111, s41, v111
    v_fract_f32 v63, v63
    v_fract_f32 v110, v110
    v_fract_f32 v111, v111
    v_cos_f32 v63, v63
    v_cos_f32 v110, v110
    v_cos_f32 v111, v111
    v_fmaak_f32 v63, v10, v63, 1262486016
    v_fmaak_f32 v110, v10, v110, 1262486016
    v_fmaak_f32 v111, v10, v111, 1262486016
    v_lshlrev_b32 v63, 22, v63
    v_alignbit_b32 v63, v110, v63, 10
    v_alignbit_b32 v63, v111, v63, 10
    v_xor_b32 v63, 0x80200800, v63
    s_cmp_lg_u32 s40, 3
    s_cbranch_scc1 L_p1_kernel_now_9
    v_mov_b64 v[28:29], v[60:61]
    v_mov_b64 v[30:31], v[62:63]
    s_branch L_p1_kernel_held_10
L_p1_kernel_now_9:
    s_add_u32 s36, s42, 8
    s_and_b32 s35, s36, 3
    s_mul_i32 s35, s35, 1047552
    s_lshl_b32 s36, s36, 20
    s_sub_u32 s36, s36, s35
    buffer_store_dwordx4 v[60:63], v3, s[20:23], s36 offen sc1
L_p1_kernel_held_10:
    s_add_u32 s35, s33, 29360128
    buffer_load_dwordx4 v[88:91], v1, s[8:11], s35 offen nt
    s_add_u32 s35, s33, 29360128
    buffer_load_dwordx4 v[108:111], v1, s[12:15], s35 offen nt
    s_waitcnt vmcnt(15)
    v_perm_b32 v6, v36, v32, s43
    v_perm_b32 v7, v37, v33, s43
    v_perm_b32 v8, v38, v34, s43
    v_perm_b32 v9, v39, v35, s43
    v_mul_hi_u32_u24 v32, 429497, v32
    v_mul_hi_u32_u24 v36, 429497, v36
    v_mul_hi_u32_u24 v33, 429497, v33
    v_mul_hi_u32_u24 v37, 429497, v37
    v_mul_hi_u32_u24 v34, 429497, v34
    v_mul_hi_u32_u24 v38, 429497, v38
    v_mul_hi_u32_u24 v35, 429497, v35
    v_mul_hi_u32_u24 v39, 429497, v39
    v_lshl_or_b32 v32, v36, 16, v32
    v_lshl_or_b32 v33, v37, 16, v33
    v_lshl_or_b32 v34, v38, 16, v34
    v_lshl_or_b32 v35, v39, 16, v35
    v_dot2_u32_u16 v36, v32, s38, 0
    v_dot2_u32_u16 v37, v33, s38, 0
    v_dot2_u32_u16 v38, v34, s38, 0
    v_dot2_u32_u16 v39, v35, s38, 0
    v_pk_mad_u16 v6, v32, s37, v6
    v_pk_mad_u16 v7, v33, s37, v7
    v_pk_mad_u16 v8, v34, s37, v8
    v_pk_mad_u16 v9, v35, s37, v9
    ds_add_u32 v36, v4 offset:0
    ds_add_u32 v37, v4 offset:0
    ds_add_u32 v38, v4 offset:0
    ds_add_u32 v39, v4 offset:0
    v_pk_mad_u16 v6, v32, s52, v6 op_sel:[1,0,0] op_sel_hi:[1,1,1]
    v_pk_mad_u16 v7, v33, s52, v7 op_sel:[1,0,0] op_sel_hi:[1,1,1]
    v_pk_mad_u16 v8, v34, s52, v8 op_sel:[1,0,0] op_sel_hi:[1,1,1]
    v_pk_mad_u16 v9, v35, s52, v9 op_sel:[1,0,0] op_sel_hi:[1,1,1]
    v_perm_b32 v125, v39, v38, s43
    v_perm_b32 v124, v37, v36, s43
    v_or_b32 v57, 0x40000000, v6
    v_or_b32 v58, 0x40000000, v7
    v_or_b32 v60, 0x40000000, v8
    v_or_b32 v61, 0x40000000, v9
    v_lshlrev_b32 v95, 16, v112
    v_and_b32 v112, 0xffff0000, v112
    v_lshlrev_b32 v113, 16, v113
    v_mul_f32 v95, s41, v95
    v_mul_f32 v112, s41, v112
    v_mul_f32 v113, s41, v113
    v_fract_f32 v95, v95
    v_fract_f32 v112, v112
    v_fract_f32 v113, v113
    v_cos_f32 v95, v95
    v_cos_f32 v112, v112
    v_cos_f32 v113, v113
    v_fmaak_f32 v95, v10, v95, 1262486016
    v_fmaak_f32 v112, v10, v112, 1262486016
    v_fmaak_f32 v113, v10, v113, 1262486016
    v_lshlrev_b32 v95, 22, v95
    v_alignbit_b32 v95, v112, v95, 10
    v_alignbit_b32 v95, v113, v95, 10
    v_xor_b32 v95, 0x80200800, v95
    s_cmp_lg_u32 s40, 3
    s_cbranch_scc1 L_p1_kernel_now_11
    v_mov_b64 v[32:33], v[92:93]
    v_mov_b64 v[34:35], v[94:95]
    s_branch L_p1_kernel_held_12
L_p1_kernel_now_11:
    s_add_u32 s36, s42, 9
    s_and_b32 s35, s36, 3
    s_mul_i32 s35, s35, 1047552
    s_lshl_b32 s36, s36, 20
    s_sub_u32 s36, s36, s35
    buffer_store_dwordx4 v[92:95], v3, s[20:23], s36 offen sc1
L_p1_kernel_held_12:
    v_lshlrev_b32 v67, 16, v114
    v_and_b32 v114, 0xffff0000, v114
    v_lshlrev_b32 v115, 16, v115
    v_mul_f32 v67, s41, v67
    v_mul_f32 v114, s41, v114
    v_mul_f32 v115, s41, v115
    v_fract_f32 v67, v67
    v_fract_f32 v114, v114
    v_fract_f32 v115, v115
    v_cos_f32 v67, v67
    v_cos_f32 v114, v114
    v_cos_f32 v115, v115
    v_fmaak_f32 v67, v10, v67, 1262486016
    v_fmaak_f32 v114, v10, v114, 1262486016
    v_fmaak_f32 v115, v10, v115, 1262486016
    v_lshlrev_b32 v67, 22, v67
    v_alignbit_b32 v67, v114, v67, 10
    v_alignbit_b32 v67, v115, v67, 10
    v_xor_b32 v67, 0x80200800, v67
    s_cmp_lg_u32 s40, 3
    s_cbranch_scc1 L_p1_kernel_now_13
    v_mov_b64 v[36:37], v[64:65]
    v_mov_b64 v[38:39], v[66:67]
    s_branch L_p1_kernel_held_14
L_p1_kernel_now_13:
    s_add_u32 s36, s42, 10
    s_and_b32 s35, s36, 3
    s_mul_i32 s35, s35, 1047552
    s_lshl_b32 s36, s36, 20
    s_sub_u32 s36, s36, s35
    buffer_store_dwordx4 v[64:67], v3, s[20:23], s36 offen sc1
L_p1_kernel_held_14:
    s_add_u32 s35, s33, 33554432
    buffer_load_dwordx4 v[92:95], v1, s[8:11], s35 offen nt
    s_add_u32 s35, s33, 33554432
    buffer_load_dwordx4 v[112:115], v1, s[12:15], s35 offen nt
    s_waitcnt vmcnt(15)
    v_perm_b32 v6, v44, v40, s43
    v_perm_b32 v7, v45, v41, s43
    v_perm_b32 v8, v46, v42, s43
    v_perm_b32 v9, v47, v43, s43
    v_mul_hi_u32_u24 v40, 429497, v40
    v_mul_hi_u32_u24 v44, 429497, v44
    v_mul_hi_u32_u24 v41, 429497, v41
    v_mul_hi_u32_u24 v45, 429497, v45
    v_mul_hi_u32_u24 v42, 429497, v42
    v_mul_hi_u32_u24 v46, 429497, v46
    v_mul_hi_u32_u24 v43, 429497, v43
    v_mul_hi_u32_u24 v47, 429497, v47
    v_lshl_or_b32 v40, v44, 16, v40
    v_lshl_or_b32 v41, v45, 16, v41
    v_lshl_or_b32 v42, v46, 16, v42
    v_lshl_or_b32 v43, v47, 16, v43
    v_dot2_u32_u16 v44, v40, s38, 0
    v_dot2_u32_u16 v45, v41, s38, 0
    v_dot2_u32_u16 v46, v42, s38, 0
    v_dot2_u32_u16 v47, v43, s38, 0
    v_pk_mad_u16 v6, v40, s37, v6
    v_pk_mad_u16 v7, v41, s37, v7
    v_pk_mad_u16 v8, v42, s37, v8
    v_pk_mad_u16 v9, v43, s37, v9
    ds_add_u32 v44, v4 offset:0
    ds_add_u32 v45, v4 offset:0
    ds_add_u32 v46, v4 offset:0
    ds_add_u32 v47, v4 offset:0
    v_pk_mad_u16 v6, v40, s52, v6 op_sel:[1,0,0] op_sel_hi:[1,1,1]
    v_pk_mad_u16 v7, v41, s52, v7 op_sel:[1,0,0] op_sel_hi:[1,1,1]
    v_pk_mad_u16 v8, v42, s52, v8 op_sel:[1,0,0] op_sel_hi:[1,1,1]
    v_pk_mad_u16 v9, v43, s52, v9 op_sel:[1,0,0] op_sel_hi:[1,1,1]
    v_perm_b32 v51, v47, v46, s43
    v_perm_b32 v126, v45, v44, s43
    v_or_b32 v62, 0x40000000, v6
    v_or_b32 v64, 0x40000000, v7
    v_or_b32 v65, 0x40000000, v8
    v_or_b32 v66, 0x40000000, v9
    v_lshlrev_b32 v99, 16, v116
    v_and_b32 v116, 0xffff0000, v116
    v_lshlrev_b32 v117, 16, v117
    v_mul_f32 v99, s41, v99
    v_mul_f32 v116, s41, v116
    v_mul_f32 v117, s41, v117
    v_fract_f32 v99, v99
    v_fract_f32 v116, v116
    v_fract_f32 v117, v117
    v_cos_f32 v99, v99
    v_cos_f32 v116, v116
    v_cos_f32 v117, v117
    v_fmaak_f32 v99, v10, v99, 1262486016
    v_fmaak_f32 v116, v10, v116, 1262486016
    v_fmaak_f32 v117, v10, v117, 1262486016
    v_lshlrev_b32 v99, 22, v99
    v_alignbit_b32 v99, v116, v99, 10
    v_alignbit_b32 v99, v117, v99, 10
    v_xor_b32 v99, 0x80200800, v99
    s_cmp_lg_u32 s40, 3
    s_cbranch_scc1 L_p1_kernel_now_15
    v_mov_b64 v[40:41], v[96:97]
    v_mov_b64 v[42:43], v[98:99]
    s_branch L_p1_kernel_held_16
L_p1_kernel_now_15:
    s_add_u32 s36, s42, 11
    s_and_b32 s35, s36, 3
    s_mul_i32 s35, s35, 1047552
    s_lshl_b32 s36, s36, 20
    s_sub_u32 s36, s36, s35
    buffer_store_dwordx4 v[96:99], v3, s[20:23], s36 offen sc1
L_p1_kernel_held_16:
    v_lshlrev_b32 v71, 16, v118
    v_and_b32 v118, 0xffff0000, v118
    v_lshlrev_b32 v119, 16, v119
    v_mul_f32 v71, s41, v71
    v_mul_f32 v118, s41, v118
    v_mul_f32 v119, s41, v119
    v_fract_f32 v71, v71
    v_fract_f32 v118, v118
    v_fract_f32 v119, v119
    v_cos_f32 v71, v71
    v_cos_f32 v118, v118
    v_cos_f32 v119, v119
    v_fmaak_f32 v71, v10, v71, 1262486016
    v_fmaak_f32 v118, v10, v118, 1262486016
    v_fmaak_f32 v119, v10, v119, 1262486016
    v_lshlrev_b32 v71, 22, v71
    v_alignbit_b32 v71, v118, v71, 10
    v_alignbit_b32 v71, v119, v71, 10
    v_xor_b32 v71, 0x80200800, v71
    s_cmp_lg_u32 s40, 3
    s_cbranch_scc1 L_p1_kernel_now_17
    v_mov_b64 v[44:45], v[68:69]
    v_mov_b64 v[46:47], v[70:71]
    s_branch L_p1_kernel_held_18
L_p1_kernel_now_17:
    s_add_u32 s36, s42, 12
    s_and_b32 s35, s36, 3
    s_mul_i32 s35, s35, 1047552
    s_lshl_b32 s36, s36, 20
    s_sub_u32 s36, s36, s35
    buffer_store_dwordx4 v[68:71], v3, s[20:23], s36 offen sc1
L_p1_kernel_held_18:
    s_add_u32 s35, s33, 37748736
    s_sub_u32 s35, s35, s48
    v_cndmask_b32 v96, 2.0, v1, s[44:45]
    buffer_load_dwordx4 v[96:99], v96, s[8:11], s35 offen nt
    s_add_u32 s35, s33, 37748736
    s_sub_u32 s35, s35, s48
    v_cndmask_b32 v116, 2.0, v1, s[44:45]
    buffer_load_dwordx4 v[116:119], v116, s[12:15], s35 offen nt
    s_branch L_p1_join
L_p1_first:
    s_add_u32 s35, s33, 20971520
    buffer_load_dwordx4 v[80:83], v1, s[8:11], s35 offen nt
    s_add_u32 s35, s33, 20971520
    buffer_load_dwordx4 v[100:103], v1, s[12:15], s35 offen nt
    s_add_u32 s35, s33, 25165824
    buffer_load_dwordx4 v[84:87], v1, s[8:11], s35 offen nt
    s_add_u32 s35, s33, 25165824
    buffer_load_dwordx4 v[104:107], v1, s[12:15], s35 offen nt
    s_add_u32 s35, s33, 29360128
    buffer_load_dwordx4 v[88:91], v1, s[8:11], s35 offen nt
    s_add_u32 s35, s33, 29360128
    buffer_load_dwordx4 v[108:111], v1, s[12:15], s35 offen nt
    s_add_u32 s35, s33, 33554432
    buffer_load_dwordx4 v[92:95], v1, s[8:11], s35 offen nt
    s_add_u32 s35, s33, 33554432
    buffer_load_dwordx4 v[112:115], v1, s[12:15], s35 offen nt
    s_add_u32 s35, s33, 37748736
    s_sub_u32 s35, s35, s48
    v_cndmask_b32 v96, 2.0, v1, s[44:45]
    buffer_load_dwordx4 v[96:99], v96, s[8:11], s35 offen nt
    s_add_u32 s35, s33, 37748736
    s_sub_u32 s35, s35, s48
    v_cndmask_b32 v116, 2.0, v1, s[44:45]
    buffer_load_dwordx4 v[116:119], v116, s[12:15], s35 offen nt
    s_cmp_lg_u32 s39, 15
    s_cbranch_scc1 L_p1_nofetch
    buffer_load_dword v12, off, s[84:87], 0 sc1
L_p1_nofetch:
    s_waitcnt vmcnt(18)
    v_perm_b32 v6, v20, v16, s43
    v_perm_b32 v7, v21, v17, s43
    v_perm_b32 v8, v22, v18, s43
    v_perm_b32 v9, v23, v19, s43
    v_mul_hi_u32_u24 v16, 429497, v16
    v_mul_hi_u32_u24 v20, 429497, v20
    v_mul_hi_u32_u24 v17, 429497, v17
    v_mul_hi_u32_u24 v21, 429497, v21
    v_mul_hi_u32_u24 v18, 429497, v18
    v_mul_hi_u32_u24 v22, 429497, v22
    v_mul_hi_u32_u24 v19, 429497, v19
    v_mul_hi_u32_u24 v23, 429497, v23
    v_lshl_or_b32 v16, v20, 16, v16
    v_lshl_or_b32 v17, v21, 16, v17
    v_lshl_or_b32 v18, v22, 16, v18
    v_lshl_or_b32 v19, v23, 16, v19
    v_dot2_u32_u16 v20, v16, s38, 0
    v_dot2_u32_u16 v21, v17, s38, 0
    v_dot2_u32_u16 v22, v18, s38, 0
    v_dot2_u32_u16 v23, v19, s38, 0
    v_pk_mad_u16 v6, v16, s37, v6
    v_pk_mad_u16 v7, v17, s37, v7
    v_pk_mad_u16 v8, v18, s37, v8
    v_pk_mad_u16 v9, v19, s37, v9
    ds_add_u32 v20, v4 offset:0
    ds_add_u32 v21, v4 offset:0
    ds_add_u32 v22, v4 offset:0
    ds_add_u32 v23, v4 offset:0
    v_pk_mad_u16 v6, v16, s52, v6 op_sel:[1,0,0] op_sel_hi:[1,1,1]
    v_pk_mad_u16 v7, v17, s52, v7 op_sel:[1,0,0] op_sel_hi:[1,1,1]
    v_pk_mad_u16 v8, v18, s52, v8 op_sel:[1,0,0] op_sel_hi:[1,1,1]
    v_pk_mad_u16 v9, v19, s52, v9 op_sel:[1,0,0] op_sel_hi:[1,1,1]
    v_perm_b32 v121, v23, v22, s43
    v_perm_b32 v120, v21, v20, s43
    v_or_b32 v127, 0x40000000, v6
    v_or_b32 v48, 0x40000000, v7
    v_or_b32 v49, 0x40000000, v8
    v_or_b32 v50, 0x40000000, v9
    s_waitcnt vmcnt(16)
    v_perm_b32 v6, v28, v24, s43
    v_perm_b32 v7, v29, v25, s43
    v_perm_b32 v8, v30, v26, s43
    v_perm_b32 v9, v31, v27, s43
    v_mul_hi_u32_u24 v24, 429497, v24
    v_mul_hi_u32_u24 v28, 429497, v28
    v_mul_hi_u32_u24 v25, 429497, v25
    v_mul_hi_u32_u24 v29, 429497, v29
    v_mul_hi_u32_u24 v26, 429497, v26
    v_mul_hi_u32_u24 v30, 429497, v30
    v_mul_hi_u32_u24 v27, 429497, v27
    v_mul_hi_u32_u24 v31, 429497, v31
    v_lshl_or_b32 v24, v28, 16, v24
    v_lshl_or_b32 v25, v29, 16, v25
    v_lshl_or_b32 v26, v30, 16, v26
    v_lshl_or_b32 v27, v31, 16, v27
    v_dot2_u32_u16 v28, v24, s38, 0
    v_dot2_u32_u16 v29, v25, s38, 0
    v_dot2_u32_u16 v30, v26, s38, 0
    v_dot2_u32_u16 v31, v27, s38, 0
    v_pk_mad_u16 v6, v24, s37, v6
    v_pk_mad_u16 v7, v25, s37, v7
    v_pk_mad_u16 v8, v26, s37, v8
    v_pk_mad_u16 v9, v27, s37, v9
    ds_add_u32 v28, v4 offset:0
    ds_add_u32 v29, v4 offset:0
    ds_add_u32 v30, v4 offset:0
    ds_add_u32 v31, v4 offset:0
    v_pk_mad_u16 v6, v24, s52, v6 op_sel:[1,0,0] op_sel_hi:[1,1,1]
    v_pk_mad_u16 v7, v25, s52, v7 op_sel:[1,0,0] op_sel_hi:[1,1,1]
    v_pk_mad_u16 v8, v26, s52, v8 op_sel:[1,0,0] op_sel_hi:[1,1,1]
    v_pk_mad_u16 v9, v27, s52, v9 op_sel:[1,0,0] op_sel_hi:[1,1,1]
    v_perm_b32 v123, v31, v30, s43
    v_perm_b32 v122, v29, v28, s43
    v_or_b32 v52, 0x40000000, v6
    v_or_b32 v53, 0x40000000, v7
    v_or_b32 v54, 0x40000000, v8
    v_or_b32 v56, 0x40000000, v9
    s_waitcnt vmcnt(14)
    v_perm_b32 v6, v36, v32, s43
    v_perm_b32 v7, v37, v33, s43
    v_perm_b32 v8, v38, v34, s43
    v_perm_b32 v9, v39, v35, s43
    v_mul_hi_u32_u24 v32, 429497, v32
    v_mul_hi_u32_u24 v36, 429497, v36
    v_mul_hi_u32_u24 v33, 429497, v33
    v_mul_hi_u32_u24 v37, 429497, v37
    v_mul_hi_u32_u24 v34, 429497, v34
    v_mul_hi_u32_u24 v38, 429497, v38
    v_mul_hi_u32_u24 v35, 429497, v35
    v_mul_hi_u32_u24 v39, 429497, v39
    v_lshl_or_b32 v32, v36, 16, v32
    v_lshl_or_b32 v33, v37, 16, v33
    v_lshl_or_b32 v34, v38, 16, v34
    v_lshl_or_b32 v35, v39, 16, v35
    v_dot2_u32_u16 v36, v32, s38, 0
    v_dot2_u32_u16 v37, v33, s38, 0
    v_dot2_u32_u16 v38, v34, s38, 0
    v_dot2_u32_u16 v39, v35, s38, 0
    v_pk_mad_u16 v6, v32, s37, v6
    v_pk_mad_u16 v7, v33, s37, v7
    v_pk_mad_u16 v8, v34, s37, v8
    v_pk_mad_u16 v9, v35, s37, v9
    ds_add_u32 v36, v4 offset:0
    ds_add_u32 v37, v4 offset:0
    ds_add_u32 v38, v4 offset:0
    ds_add_u32 v39, v4 offset:0
    v_pk_mad_u16 v6, v32, s52, v6 op_sel:[1,0,0] op_sel_hi:[1,1,1]
    v_pk_mad_u16 v7, v33, s52, v7 op_sel:[1,0,0] op_sel_hi:[1,1,1]
    v_pk_mad_u16 v8, v34, s52, v8 op_sel:[1,0,0] op_sel_hi:[1,1,1]
    v_pk_mad_u16 v9, v35, s52, v9 op_sel:[1,0,0] op_sel_hi:[1,1,1]
    v_perm_b32 v125, v39, v38, s43
    v_perm_b32 v124, v37, v36, s43
    v_or_b32 v57, 0x40000000, v6
    v_or_b32 v58, 0x40000000, v7
    v_or_b32 v60, 0x40000000, v8
    v_or_b32 v61, 0x40000000, v9
    s_waitcnt vmcnt(12)
    v_perm_b32 v6, v44, v40, s43
    v_perm_b32 v7, v45, v41, s43
    v_perm_b32 v8, v46, v42, s43
    v_perm_b32 v9, v47, v43, s43
    v_mul_hi_u32_u24 v40, 429497, v40
    v_mul_hi_u32_u24 v44, 429497, v44
    v_mul_hi_u32_u24 v41, 429497, v41
    v_mul_hi_u32_u24 v45, 429497, v45
    v_mul_hi_u32_u24 v42, 429497, v42
    v_mul_hi_u32_u24 v46, 429497, v46
    v_mul_hi_u32_u24 v43, 429497, v43
    v_mul_hi_u32_u24 v47, 429497, v47
    v_lshl_or_b32 v40, v44, 16, v40
    v_lshl_or_b32 v41, v45, 16, v41
    v_lshl_or_b32 v42, v46, 16, v42
    v_lshl_or_b32 v43, v47, 16, v43
    v_dot2_u32_u16 v44, v40, s38, 0
    v_dot2_u32_u16 v45, v41, s38, 0
    v_dot2_u32_u16 v46, v42, s38, 0
    v_dot2_u32_u16 v47, v43, s38, 0
    v_pk_mad_u16 v6, v40, s37, v6
    v_pk_mad_u16 v7, v41, s37, v7
    v_pk_mad_u16 v8, v42, s37, v8
    v_pk_mad_u16 v9, v43, s37, v9
    ds_add_u32 v44, v4 offset:0
    ds_add_u32 v45, v4 offset:0
    ds_add_u32 v46, v4 offset:0
    ds_add_u32 v47, v4 offset:0
    v_pk_mad_u16 v6, v40, s52, v6 op_sel:[1,0,0] op_sel_hi:[1,1,1]
    v_pk_mad_u16 v7, v41, s52, v7 op_sel:[1,0,0] op_sel_hi:[1,1,1]
    v_pk_mad_u16 v8, v42, s52, v8 op_sel:[1,0,0] op_sel_hi:[1,1,1]
    v_pk_mad_u16 v9, v43, s52, v9 op_sel:[1,0,0] op_sel_hi:[1,1,1]
    v_perm_b32 v51, v47, v46, s43
    v_perm_b32 v126, v45, v44, s43
    v_or_b32 v62, 0x40000000, v6
    v_or_b32 v64, 0x40000000, v7
    v_or_b32 v65, 0x40000000, v8
    v_or_b32 v66, 0x40000000, v9
L_p1_join:
    s_waitcnt vmcnt(10)
    v_perm_b32 v6, v76, v72, s43
    v_perm_b32 v7, v77, v73, s43
    v_perm_b32 v8, v78, v74, s43
    v_perm_b32 v9, v79, v75, s43
    v_mul_hi_u32_u24 v72, 429497, v72
    v_mul_hi_u32_u24 v76, 429497, v76
    v_mul_hi_u32_u24 v73, 429497, v73
    v_mul_hi_u32_u24 v77, 429497, v77
    v_mul_hi_u32_u24 v74, 429497, v74
    v_mul_hi_u32_u24 v78, 429497, v78
    v_mul_hi_u32_u24 v75, 429497, v75
    v_mul_hi_u32_u24 v79, 429497, v79
    v_lshl_or_b32 v72, v76, 16, v72
    v_lshl_or_b32 v73, v77, 16, v73
    v_lshl_or_b32 v74, v78, 16, v74
    v_lshl_or_b32 v75, v79, 16, v75
    v_dot2_u32_u16 v76, v72, s38, 0
    v_dot2_u32_u16 v77, v73, s38, 0
    v_dot2_u32_u16 v78, v74, s38, 0
    v_dot2_u32_u16 v79, v75, s38, 0
    v_pk_mad_u16 v6, v72, s37, v6
    v_pk_mad_u16 v7, v73, s37, v7
    v_pk_mad_u16 v8, v74, s37, v8
    v_pk_mad_u16 v9, v75, s37, v9
    ds_add_u32 v76, v4 offset:0
    ds_add_u32 v77, v4 offset:0
    ds_add_u32 v78, v4 offset:0
    ds_add_u32 v79, v4 offset:0
    v_pk_mad_u16 v6, v72, s52, v6 op_sel:[1,0,0] op_sel_hi:[1,1,1]
    v_pk_mad_u16 v7, v73, s52, v7 op_sel:[1,0,0] op_sel_hi:[1,1,1]
    v_pk_mad_u16 v8, v74, s52, v8 op_sel:[1,0,0] op_sel_hi:[1,1,1]
    v_pk_mad_u16 v9, v75, s52, v9 op_sel:[1,0,0] op_sel_hi:[1,1,1]
    v_perm_b32 v59, v79, v78, s43
    v_perm_b32 v55, v77, v76, s43
    v_or_b32 v68, 0x40000000, v6
    v_or_b32 v69, 0x40000000, v7
    v_or_b32 v70, 0x40000000, v8
    v_or_b32 v72, 0x40000000, v9
    s_waitcnt vmcnt(8)
    v_perm_b32 v6, v100, v80, s43
    v_perm_b32 v7, v101, v81, s43
    v_perm_b32 v8, v102, v82, s43
    v_perm_b32 v9, v103, v83, s43
    v_mul_hi_u32_u24 v80, 429497, v80
    v_mul_hi_u32_u24 v100, 429497, v100
    v_mul_hi_u32_u24 v81, 429497, v81
    v_mul_hi_u32_u24 v101, 429497, v101
    v_mul_hi_u32_u24 v82, 429497, v82
    v_mul_hi_u32_u24 v102, 429497, v102
    v_mul_hi_u32_u24 v83, 429497, v83
    v_mul_hi_u32_u24 v103, 429497, v103
    v_lshl_or_b32 v80, v100, 16, v80
    v_lshl_or_b32 v81, v101, 16, v81
    v_lshl_or_b32 v82, v102, 16, v82
    v_lshl_or_b32 v83, v103, 16, v83
    v_dot2_u32_u16 v100, v80, s38, 0
    v_dot2_u32_u16 v101, v81, s38, 0
    v_dot2_u32_u16 v102, v82, s38, 0
    v_dot2_u32_u16 v103, v83, s38, 0
    v_pk_mad_u16 v6, v80, s37, v6
    v_pk_mad_u16 v7, v81, s37, v7
    v_pk_mad_u16 v8, v82, s37, v8
    v_pk_mad_u16 v9, v83, s37, v9
    ds_add_u32 v100, v4 offset:0
    ds_add_u32 v101, v4 offset:0
    ds_add_u32 v102, v4 offset:0
    ds_add_u32 v103, v4 offset:0
    v_pk_mad_u16 v6, v80, s52, v6 op_sel:[1,0,0] op_sel_hi:[1,1,1]
    v_pk_mad_u16 v7, v81, s52, v7 op_sel:[1,0,0] op_sel_hi:[1,1,1]
    v_pk_mad_u16 v8, v82, s52, v8 op_sel:[1,0,0] op_sel_hi:[1,1,1]
    v_pk_mad_u16 v9, v83, s52, v9 op_sel:[1,0,0] op_sel_hi:[1,1,1]
    v_perm_b32 v67, v103, v102, s43
    v_perm_b32 v63, v101, v100, s43
    v_or_b32 v73, 0x40000000, v6
    v_or_b32 v74, 0x40000000, v7
    v_or_b32 v76, 0x40000000, v8
    v_or_b32 v77, 0x40000000, v9
    s_waitcnt vmcnt(6)
    v_perm_b32 v6, v104, v84, s43
    v_perm_b32 v7, v105, v85, s43
    v_perm_b32 v8, v106, v86, s43
    v_perm_b32 v9, v107, v87, s43
    v_mul_hi_u32_u24 v84, 429497, v84
    v_mul_hi_u32_u24 v104, 429497, v104
    v_mul_hi_u32_u24 v85, 429497, v85
    v_mul_hi_u32_u24 v105, 429497, v105
    v_mul_hi_u32_u24 v86, 429497, v86
    v_mul_hi_u32_u24 v106, 429497, v106
    v_mul_hi_u32_u24 v87, 429497, v87
    v_mul_hi_u32_u24 v107, 429497, v107
    v_lshl_or_b32 v84, v104, 16, v84
    v_lshl_or_b32 v85, v105, 16, v85
    v_lshl_or_b32 v86, v106, 16, v86
    v_lshl_or_b32 v87, v107, 16, v87
    v_dot2_u32_u16 v104, v84, s38, 0
    v_dot2_u32_u16 v105, v85, s38, 0
    v_dot2_u32_u16 v106, v86, s38, 0
    v_dot2_u32_u16 v107, v87, s38, 0
    v_pk_mad_u16 v6, v84, s37, v6
    v_pk_mad_u16 v7, v85, s37, v7
    v_pk_mad_u16 v8, v86, s37, v8
    v_pk_mad_u16 v9, v87, s37, v9
    ds_add_u32 v104, v4 offset:0
    ds_add_u32 v105, v4 offset:0
    ds_add_u32 v106, v4 offset:0
    ds_add_u32 v107, v4 offset:0
    v_pk_mad_u16 v6, v84, s52, v6 op_sel:[1,0,0] op_sel_hi:[1,1,1]
    v_pk_mad_u16 v7, v85, s52, v7 op_sel:[1,0,0] op_sel_hi:[1,1,1]
    v_pk_mad_u16 v8, v86, s52, v8 op_sel:[1,0,0] op_sel_hi:[1,1,1]
    v_pk_mad_u16 v9, v87, s52, v9 op_sel:[1,0,0] op_sel_hi:[1,1,1]
    v_perm_b32 v75, v107, v106, s43
    v_perm_b32 v71, v105, v104, s43
    v_or_b32 v78, 0x40000000, v6
    v_or_b32 v80, 0x40000000, v7
    v_or_b32 v81, 0x40000000, v8
    v_or_b32 v82, 0x40000000, v9
    s_waitcnt vmcnt(4)
    v_perm_b32 v6, v108, v88, s43
    v_perm_b32 v7, v109, v89, s43
    v_perm_b32 v8, v110, v90, s43
    v_perm_b32 v9, v111, v91, s43
    v_mul_hi_u32_u24 v88, 429497, v88
    v_mul_hi_u32_u24 v108, 429497, v108
    v_mul_hi_u32_u24 v89, 429497, v89
    v_mul_hi_u32_u24 v109, 429497, v109
    v_mul_hi_u32_u24 v90, 429497, v90
    v_mul_hi_u32_u24 v110, 429497, v110
    v_mul_hi_u32_u24 v91, 429497, v91
    v_mul_hi_u32_u24 v111, 429497, v111
    v_lshl_or_b32 v88, v108, 16, v88
    v_lshl_or_b32 v89, v109, 16, v89
    v_lshl_or_b32 v90, v110, 16, v90
    v_lshl_or_b32 v91, v111, 16, v91
    v_dot2_u32_u16 v108, v88, s38, 0
    v_dot2_u32_u16 v109, v89, s38, 0
    v_dot2_u32_u16 v110, v90, s38, 0
    v_dot2_u32_u16 v111, v91, s38, 0
    v_pk_mad_u16 v6, v88, s37, v6
    v_pk_mad_u16 v7, v89, s37, v7
    v_pk_mad_u16 v8, v90, s37, v8
    v_pk_mad_u16 v9, v91, s37, v9
    ds_add_u32 v108, v4 offset:0
    ds_add_u32 v109, v4 offset:0
    ds_add_u32 v110, v4 offset:0
    ds_add_u32 v111, v4 offset:0
    v_pk_mad_u16 v6, v88, s52, v6 op_sel:[1,0,0] op_sel_hi:[1,1,1]
    v_pk_mad_u16 v7, v89, s52, v7 op_sel:[1,0,0] op_sel_hi:[1,1,1]
    v_pk_mad_u16 v8, v90, s52, v8 op_sel:[1,0,0] op_sel_hi:[1,1,1]
    v_pk_mad_u16 v9, v91, s52, v9 op_sel:[1,0,0] op_sel_hi:[1,1,1]
    v_perm_b32 v83, v111, v110, s43
    v_perm_b32 v79, v109, v108, s43
    v_or_b32 v84, 0x40000000, v6
    v_or_b32 v85, 0x40000000, v7
    v_or_b32 v86, 0x40000000, v8
    v_or_b32 v88, 0x40000000, v9
    s_waitcnt vmcnt(2)
    v_perm_b32 v6, v112, v92, s43
    v_perm_b32 v7, v113, v93, s43
    v_perm_b32 v8, v114, v94, s43
    v_perm_b32 v9, v115, v95, s43
    v_mul_hi_u32_u24 v92, 429497, v92
    v_mul_hi_u32_u24 v112, 429497, v112
    v_mul_hi_u32_u24 v93, 429497, v93
    v_mul_hi_u32_u24 v113, 429497, v113
    v_mul_hi_u32_u24 v94, 429497, v94
    v_mul_hi_u32_u24 v114, 429497, v114
    v_mul_hi_u32_u24 v95, 429497, v95
    v_mul_hi_u32_u24 v115, 429497, v115
    v_lshl_or_b32 v92, v112, 16, v92
    v_lshl_or_b32 v93, v113, 16, v93
    v_lshl_or_b32 v94, v114, 16, v94
    v_lshl_or_b32 v95, v115, 16, v95
    v_dot2_u32_u16 v112, v92, s38, 0
    v_dot2_u32_u16 v113, v93, s38, 0
    v_dot2_u32_u16 v114, v94, s38, 0
    v_dot2_u32_u16 v115, v95, s38, 0
    v_pk_mad_u16 v6, v92, s37, v6
    v_pk_mad_u16 v7, v93, s37, v7
    v_pk_mad_u16 v8, v94, s37, v8
    v_pk_mad_u16 v9, v95, s37, v9
    ds_add_u32 v112, v4 offset:0
    ds_add_u32 v113, v4 offset:0
    ds_add_u32 v114, v4 offset:0
    ds_add_u32 v115, v4 offset:0
    v_pk_mad_u16 v6, v92, s52, v6 op_sel:[1,0,0] op_sel_hi:[1,1,1]
    v_pk_mad_u16 v7, v93, s52, v7 op_sel:[1,0,0] op_sel_hi:[1,1,1]
    v_pk_mad_u16 v8, v94, s52, v8 op_sel:[1,0,0] op_sel_hi:[1,1,1]
    v_pk_mad_u16 v9, v95, s52, v9 op_sel:[1,0,0] op_sel_hi:[1,1,1]
    v_perm_b32 v91, v115, v114, s43
    v_perm_b32 v87, v113, v112, s43
    v_or_b32 v89, 0x40000000, v6
    v_or_b32 v90, 0x40000000, v7
    v_or_b32 v92, 0x40000000, v8
    v_or_b32 v93, 0x40000000, v9
    s_waitcnt vmcnt(0)
    s_mov_b64 exec, s[44:45]
    v_perm_b32 v6, v116, v96, s43
    v_perm_b32 v7, v117, v97, s43
    v_perm_b32 v8, v118, v98, s43
    v_perm_b32 v9, v119, v99, s43
    v_mul_hi_u32_u24 v96, 429497, v96
    v_mul_hi_u32_u24 v116, 429497, v116
    v_mul_hi_u32_u24 v97, 429497, v97
    v_mul_hi_u32_u24 v117, 429497, v117
    v_mul_hi_u32_u24 v98, 429497, v98
    v_mul_hi_u32_u24 v118, 429497, v118
    v_mul_hi_u32_u24 v99, 429497, v99
    v_mul_hi_u32_u24 v119, 429497, v119
    v_lshl_or_b32 v96, v116, 16, v96
    v_lshl_or_b32 v97, v117, 16, v97
    v_lshl_or_b32 v98, v118, 16, v98
    v_lshl_or_b32 v99, v119, 16, v99
    v_dot2_u32_u16 v116, v96, s38, 0
    v_dot2_u32_u16 v117, v97, s38, 0
    v_dot2_u32_u16 v118, v98, s38, 0
    v_dot2_u32_u16 v119, v99, s38, 0
    v_pk_mad_u16 v6, v96, s37, v6
    v_pk_mad_u16 v7, v97, s37, v7
    v_pk_mad_u16 v8, v98, s37, v8
    v_pk_mad_u16 v9, v99, s37, v9
    ds_add_u32 v116, v4 offset:0
    ds_add_u32 v117, v4 offset:0
    ds_add_u32 v118, v4 offset:0
    ds_add_u32 v119, v4 offset:0
    v_pk_mad_u16 v6, v96, s52, v6 op_sel:[1,0,0] op_sel_hi:[1,1,1]
    v_pk_mad_u16 v7, v97, s52, v7 op_sel:[1,0,0] op_sel_hi:[1,1,1]
    v_pk_mad_u16 v8, v98, s52, v8 op_sel:[1,0,0] op_sel_hi:[1,1,1]
    v_pk_mad_u16 v9, v99, s52, v9 op_sel:[1,0,0] op_sel_hi:[1,1,1]
    v_perm_b32 v99, v119, v118, s43
    v_perm_b32 v95, v117, v116, s43
    v_or_b32 v94, 0x40000000, v6
    v_or_b32 v96, 0x40000000, v7
    v_or_b32 v97, 0x40000000, v8
    v_or_b32 v98, 0x40000000, v9
    s_mov_b64 exec, -1
    s_xor_b32 s35, s39, 15
    s_or_b32 s35, s35, s40
    s_cbranch_scc1 L_p1_nodec
    s_mov_b64 exec, 1
    s_waitcnt vmcnt(0)
    v_cmp_eq_u32 vcc, 0, v12
    v_mov_b32 v6, 160896
    s_nop 0
    s_cbranch_vccz L_p1_dec
    v_mov_b32 v12, 48
    v_mov_b32 v13, 0
    buffer_atomic_cmpswap v[12:13], off, s[84:87], 0 sc0
    s_waitcnt vmcnt(0)
    v_cmp_eq_u32 vcc, 0, v12
    s_nop 1
    v_cndmask_b32 v12, v12, 48, vcc
L_p1_dec:
    ds_write_b32 v6, v12
    s_mov_b64 exec, -1
L_p1_nodec:
    s_lshl2_add_u32 s35, s39, 160768
    v_mov_b32 v13, s35
    v_mov_b32 v7, 2.0
    v_and_b32 v6, 63, v0
    s_mov_b32 s36, 160768
    s_lshl_b32 s35, 0x1fffe, s39
    s_and_b32 s35, s35, 0x1ffff
    s_mov_b32 exec_hi, 0
    s_mov_b32 exec_lo, s35
    v_lshl_add_u32 v7, v6, 2, s36
    s_mov_b64 exec, -1
    v_mov_b32 v14, 160832
    s_mov_b32 s53, 2
    s_waitcnt lgkmcnt(0)
    s_barrier
    ds_read_b128 v[8:11], v1 offset:0
    s_cmp_lg_u32 s40, 3
    s_cbranch_scc1 L_p1_kernel_ld_19
    s_add_u32 s36, s42, 4
    s_and_b32 s35, s36, 3
    s_mul_i32 s35, s35, 1047552
    s_lshl_b32 s36, s36, 20
    s_sub_u32 s36, s36, s35
    buffer_store_dwordx4 v[16:19], v3, s[72:75], s36 offen sc1
    s_branch L_p1_kernel_st_20
L_p1_kernel_ld_19:
    s_add_u32 s35, s33, 40960000
    buffer_load_dwordx4 v[16:19], v1, s[8:11], s35 offen nt
L_p1_kernel_st_20:
L_p1_redo:
    s_waitcnt lgkmcnt(0)
    v_min3_u32 v12, v8, v9, v10
    v_min_u32 v12, v12, v11
    v_cmp_gt_u32 vcc, s53, v12
    s_nop 0
    s_mov_b64 s[46:47], vcc
    s_cbranch_vccz L_p1_kernel_nomask_21
    v_cmp_eq_u32 s[56:57], 0, v8
    v_cmp_ge_u32 s[64:65], 1, v8
    v_max_u32 v8, 2, v8
    v_cmp_eq_u32 s[58:59], 0, v9
    v_cmp_ge_u32 s[66:67], 1, v9
    v_max_u32 v9, 2, v9
    v_cmp_eq_u32 s[60:61], 0, v10
    v_cmp_ge_u32 s[68:69], 1, v10
    v_max_u32 v10, 2, v10
    v_cmp_eq_u32 s[62:63], 0, v11
    v_cmp_ge_u32 s[70:71], 1, v11
    v_max_u32 v11, 2, v11
L_p1_kernel_nomask_21:
    v_add_u32 v9, v8, v9
    v_add_u32 v10, v9, v10
    v_add_u32 v11, v10, v11
    s_nop 1
    v_add_u32_dpp v6, v11, v11 row_shr:1 row_mask:0xf bank_mask:0xf bound_ctrl:0
    s_nop 1
    v_add_u32_dpp v6, v6, v6 row_shr:2 row_mask:0xf bank_mask:0xf bound_ctrl:0
    s_nop 1
    v_add_u32_dpp v6, v6, v6 row_shr:4 row_mask:0xf bank_mask:0xf bound_ctrl:0
    s_nop 1
    v_add_u32_dpp v6, v6, v6 row_shr:8 row_mask:0xf bank_mask:0xf bound_ctrl:0
    s_nop 1
    v_add_u32_dpp v6, v6, v6 row_bcast:15 row_mask:0xa bank_mask:0xf
    s_nop 1
    v_add_u32_dpp v6, v6, v6 row_bcast:31 row_mask:0xc bank_mask:0xf
    s_nop 0
    v_readlane_b32 s35, v6, 63
    v_sub_u32 v6, v6, v11
    v_add_u32 v8, v8, v6
    v_mov_b32 v12, s35
    ds_add_u32 v7, v12
    v_add_u32 v9, v9, v6
    v_add_u32 v10, v10, v6
    s_waitcnt lgkmcnt(0)
    s_barrier
    ds_read_b32 v12, v14
    ds_read_b32 v11, v13
    s_waitcnt lgkmcnt(1)
    v_readfirstlane_b32 s54, v12
    s_waitcnt lgkmcnt(0)
    s_cmp_ge_u32 s54, 40063
    s_cbranch_scc0 L_p1_fits
    s_barrier
    v_mov_b32 v12, 0
    ds_write_b32 v7, v12
    s_mov_b32 s53, 0
    s_mov_b32 s55, 1
    s_waitcnt lgkmcnt(0)
    s_barrier
    ds_read_b128 v[8:11], v1 offset:0
    s_branch L_p1_redo
L_p1_fits:
    s_mov_b64 exec, 1
    v_mov_b32 v7, 24576
    ds_write_b16 v7, v12
    s_mov_b64 exec, -1
    v_add_u32 v12, v11, v6
    v_add_u32 v13, v11, v8
    v_add_u32 v14, v11, v9
    v_add_u32 v15, v11, v10
    ds_write_b128 v1, v[12:15] offset:0
    s_add_u32 s35, s54, 2
    s_mul_hi_u32 s35, s35, 1431655766
    v_perm_b32 v15, v15, v14, s43
    v_perm_b32 v14, v13, v12, s43
    ds_write_b64 v2, v[14:15] offset:16384
    s_lshl_b32 s35, s35, 4
    s_add_u32 s35, s35, 217890943
    s_andn2_b32 s35, s35, 127
    s_min_u32 s22, s35, 218104832
    s_waitcnt lgkmcnt(0)
    s_barrier
    s_cmp_lg_u32 s40, 0
    s_cbranch_scc1 L_p1_slot
    v_mov_b32 v6, 160896
    ds_read_b32 v6, v6
    s_waitcnt lgkmcnt(0)
    v_readfirstlane_b32 s90, v6
    s_lshr_b32 s92, s2, 3
    s_add_u32 s91, s2, s90
    s_and_b32 s35, s91, 3
    s_lshl_b32 s35, s35, 5
    s_or_b32 s35, s35, s92
    s_andn2_b32 s36, s35, 1
    s_add_u32 s76, s35, s36
    s_lshr_b32 s91, s91, 2
    s_lshr_b32 s35, s90, 3
    s_xor_b32 s91, s91, s35
    s_lshr_b32 s35, s90, 4
    s_and_b32 s35, s35, s92
    s_xor_b32 s91, s91, s35
    s_and_b32 s91, s91, 1
    s_lshl1_add_u32 s76, s91, s76
    s_lshr_b32 s77, s90, 3
L_p1_slot:
    s_lshl_b32 s35, s40, 8
    s_lshl_b32 s36, s40, 1
    s_and_b32 s36, s36, s77
    s_xor_b32 s36, s36, s40
    s_and_b32 s36, s36, 2
    s_or_b32 s35, s35, s36
    s_xor_b32 s32, s76, s35
    s_and_b32 s32, s32, 1023
    s_lshl_b32 s35, s32, 12
    s_add_u32 s20, s4, s35
    s_addc_u32 s21, s5, 0
    s_nop 0
    v_and_b32 v6, 0xffff, v120
    v_lshrrev_b32 v7, 16, v120
    v_and_b32 v8, 0xffff, v121
    v_lshrrev_b32 v9, 16, v121
    ds_add_rtn_u32 v6, v6, v4 offset:0
    ds_add_rtn_u32 v7, v7, v4 offset:0
    ds_add_rtn_u32 v8, v8, v4 offset:0
    ds_add_rtn_u32 v9, v9, v4 offset:0
    v_and_b32 v10, 0xffff, v122
    v_lshrrev_b32 v11, 16, v122
    v_and_b32 v12, 0xffff, v123
    v_lshrrev_b32 v13, 16, v123
    ds_add_rtn_u32 v10, v10, v4 offset:0
    ds_add_rtn_u32 v11, v11, v4 offset:0
    ds_add_rtn_u32 v12, v12, v4 offset:0
    ds_add_rtn_u32 v13, v13, v4 offset:0
    s_waitcnt lgkmcnt(4)
    v_perm_b32 v120, v7, v6, s43
    v_perm_b32 v121, v9, v8, s43
    v_and_b32 v6, 0xffff, v124
    v_lshrrev_b32 v7, 16, v124
    v_and_b32 v8, 0xffff, v125
    v_lshrrev_b32 v9, 16, v125
    ds_add_rtn_u32 v6, v6, v4 offset:0
    ds_add_rtn_u32 v7, v7, v4 offset:0
    ds_add_rtn_u32 v8, v8, v4 offset:0
    ds_add_rtn_u32 v9, v9, v4 offset:0
    s_waitcnt lgkmcnt(4)
    v_perm_b32 v122, v11, v10, s43
    v_perm_b32 v123, v13, v12, s43
    s_add_u32 s35, s34, 0
    buffer_load_dwordx2 v[100:101], v2, s[16:19], s35 offen nt
    v_and_b32 v10, 0xffff, v126
    v_lshrrev_b32 v11, 16, v126
    v_and_b32 v12, 0xffff, v51
    v_lshrrev_b32 v13, 16, v51
    ds_add_rtn_u32 v10, v10, v4 offset:0
    ds_add_rtn_u32 v11, v11, v4 offset:0
    ds_add_rtn_u32 v12, v12, v4 offset:0
    ds_add_rtn_u32 v13, v13, v4 offset:0
    s_waitcnt lgkmcnt(4)
    v_perm_b32 v124, v7, v6, s43
    v_perm_b32 v125, v9, v8, s43
    s_add_u32 s35, s34, 2097152
    buffer_load_dwordx2 v[102:103], v2, s[16:19], s35 offen nt
    v_and_b32 v6, 0xffff, v55
    v_lshrrev_b32 v7, 16, v55
    v_and_b32 v8, 0xffff, v59
    v_lshrrev_b32 v9, 16, v59
    ds_add_rtn_u32 v6, v6, v4 offset:0
    ds_add_rtn_u32 v7, v7, v4 offset:0
    ds_add_rtn_u32 v8, v8, v4 offset:0
    ds_add_rtn_u32 v9, v9, v4 offset:0
    s_waitcnt lgkmcnt(4)
    v_perm_b32 v126, v11, v10, s43
    v_perm_b32 v51, v13, v12, s43
    v_and_b32 v10, 0xffff, v63
    v_lshrrev_b32 v11, 16, v63
    v_and_b32 v12, 0xffff, v67
    v_lshrrev_b32 v13, 16, v67
    ds_add_rtn_u32 v10, v10, v4 offset:0
    ds_add_rtn_u32 v11, v11, v4 offset:0
    ds_add_rtn_u32 v12, v12, v4 offset:0
    ds_add_rtn_u32 v13, v13, v4 offset:0
    s_waitcnt lgkmcnt(4)
    v_perm_b32 v55, v7, v6, s43
    v_perm_b32 v59, v9, v8, s43
    s_cmp_lg_u32 s40, 3
    s_cbranch_scc1 L_p1_kernel_ld_22
    s_add_u32 s36, s42, 6
    s_and_b32 s35, s36, 3
    s_mul_i32 s35, s35, 1047552
    s_lshl_b32 s36, s36, 20
    s_sub_u32 s36, s36, s35
    buffer_store_dwordx4 v[20:23], v3, s[72:75], s36 offen sc1
    s_branch L_p1_kernel_st_23
L_p1_kernel_ld_22:
    s_add_u32 s35, s33, 40960000
    buffer_load_dwordx4 v[20:23], v1, s[12:15], s35 offen nt
L_p1_kernel_st_23:
    v_and_b32 v6, 0xffff, v71
    v_lshrrev_b32 v7, 16, v71
    v_and_b32 v8, 0xffff, v75
    v_lshrrev_b32 v9, 16, v75
    ds_add_rtn_u32 v6, v6, v4 offset:0
    ds_add_rtn_u32 v7, v7, v4 offset:0
    ds_add_rtn_u32 v8, v8, v4 offset:0
    ds_add_rtn_u32 v9, v9, v4 offset:0
    s_waitcnt lgkmcnt(4)
    v_perm_b32 v63, v11, v10, s43
    v_perm_b32 v67, v13, v12, s43
    v_and_b32 v10, 0xffff, v79
    v_lshrrev_b32 v11, 16, v79
    v_and_b32 v12, 0xffff, v83
    v_lshrrev_b32 v13, 16, v83
    ds_add_rtn_u32 v10, v10, v4 offset:0
    ds_add_rtn_u32 v11, v11, v4 offset:0
    ds_add_rtn_u32 v12, v12, v4 offset:0
    ds_add_rtn_u32 v13, v13, v4 offset:0
    s_waitcnt lgkmcnt(4)
    v_perm_b32 v71, v7, v6, s43
    v_perm_b32 v75, v9, v8, s43
    v_and_b32 v6, 0xffff, v87
    v_lshrrev_b32 v7, 16, v87
    v_and_b32 v8, 0xffff, v91
    v_lshrrev_b32 v9, 16, v91
    ds_add_rtn_u32 v6, v6, v4 offset:0
    ds_add_rtn_u32 v7, v7, v4 offset:0
    ds_add_rtn_u32 v8, v8, v4 offset:0
    ds_add_rtn_u32 v9, v9, v4 offset:0
    s_waitcnt lgkmcnt(4)
    v_perm_b32 v79, v11, v10, s43
    v_perm_b32 v83, v13, v12, s43
    s_add_u32 s35, s34, 4194304
    buffer_load_dwordx2 v[104:105], v2, s[16:19], s35 offen nt
    s_mov_b64 exec, s[44:45]
    v_and_b32 v10, 0xffff, v95
    v_lshrrev_b32 v11, 16, v95
    v_and_b32 v12, 0xffff, v99
    v_lshrrev_b32 v13, 16, v99
    ds_add_rtn_u32 v10, v10, v4 offset:0
    ds_add_rtn_u32 v11, v11, v4 offset:0
    ds_add_rtn_u32 v12, v12, v4 offset:0
    ds_add_rtn_u32 v13, v13, v4 offset:0
    s_mov_b64 exec, -1
    s_waitcnt lgkmcnt(4)
    v_perm_b32 v87, v7, v6, s43
    v_perm_b32 v91, v9, v8, s43
    s_add_u32 s35, s34, 6291456
    buffer_load_dwordx2 v[106:107], v2, s[16:19], s35 offen nt
    s_waitcnt lgkmcnt(0)
    v_perm_b32 v95, v11, v10, s43
    v_perm_b32 v99, v13, v12, s43
    s_cmp_gt_u32 s39, 8
    s_cbranch_scc1 L_p1_kernel_notab_24
    v_lshrrev_b32 v6, 1, v0
    v_mul_u32_u24 v7, 1009, v6
    v_lshrrev_b32 v7, 16, v7
    v_mul_u32_u24 v7, 959, v7
    v_and_b32 v8, 1, v0
    v_lshl_add_u32 v7, v8, 9, v7
    v_add_lshl_u32 v13, v7, v6, 1
    ds_read_u16 v6, v13 offset:16384
    ds_read_u16 v7, v13 offset:16512
    ds_read_u16 v8, v13 offset:16640
    ds_read_u16 v9, v13 offset:16768
    ds_read_u16 v10, v13 offset:16896
    ds_read_u16 v11, v13 offset:17024
    ds_read_u16 v12, v13 offset:17152
    ds_read_u16 v13, v13 offset:17280
    s_mul_i32 s35, s32, 8320
    s_add_u32 s26, s35, 8320
    s_waitcnt lgkmcnt(6)
    v_perm_b32 v6, v7, v6, s43
    s_waitcnt lgkmcnt(4)
    v_perm_b32 v7, v9, v8, s43
    s_waitcnt lgkmcnt(2)
    v_perm_b32 v8, v11, v10, s43
    s_waitcnt lgkmcnt(0)
    v_perm_b32 v9, v13, v12, s43
    buffer_store_dwordx4 v[6:9], v1, s[24:27], s35 offen sc1
    s_nop 1
L_p1_kernel_notab_24:
    s_barrier
    s_lshl_b32 s35, s54, 2
    v_mov_b32 v6, s35
    v_mov_b32 v7, 0
    v_mov_b32 v12, 1140817920
    s_mov_b64 exec, 1
    ds_write2_b32 v6, v7, v7 offset0:0 offset1:1
    s_cmp_eq_u64 s[46:47], 0
    s_cbranch_scc1 L_p1_kernel_nonull_25
    s_mov_b64 exec, s[64:65]
    v_lshlrev_b32_sdwa v6, 2, v14 dst_sel:DWORD dst_unused:UNUSED_PAD src0_sel:DWORD src1_sel:WORD_0
    ds_write_b32 v6, v7 offset:4
    s_mov_b64 exec, s[56:57]
    ds_write_b32 v6, v7
    s_mov_b64 exec, s[66:67]
    v_lshlrev_b32_sdwa v6, 2, v14 dst_sel:DWORD dst_unused:UNUSED_PAD src0_sel:DWORD src1_sel:WORD_1
    ds_write_b32 v6, v7 offset:4
    s_mov_b64 exec, s[58:59]
    ds_write_b32 v6, v7
    s_mov_b64 exec, s[68:69]
    v_lshlrev_b32_sdwa v6, 2, v15 dst_sel:DWORD dst_unused:UNUSED_PAD src0_sel:DWORD src1_sel:WORD_0
    ds_write_b32 v6, v7 offset:4
    s_mov_b64 exec, s[60:61]
    ds_write_b32 v6, v7
    s_mov_b64 exec, s[70:71]
    v_lshlrev_b32_sdwa v6, 2, v15 dst_sel:DWORD dst_unused:UNUSED_PAD src0_sel:DWORD src1_sel:WORD_1
    ds_write_b32 v6, v7 offset:4
    s_mov_b64 exec, s[62:63]
    ds_write_b32 v6, v7
L_p1_kernel_nonull_25:
    s_mov_b64 exec, -1
    v_lshlrev_b32_sdwa v6, 2, v120 dst_sel:DWORD dst_unused:UNUSED_PAD src0_sel:DWORD src1_sel:WORD_0
    v_lshlrev_b32_sdwa v7, 2, v120 dst_sel:DWORD dst_unused:UNUSED_PAD src0_sel:DWORD src1_sel:WORD_1
    v_lshlrev_b32_sdwa v8, 2, v121 dst_sel:DWORD dst_unused:UNUSED_PAD src0_sel:DWORD src1_sel:WORD_0
    v_lshlrev_b32_sdwa v9, 2, v121 dst_sel:DWORD dst_unused:UNUSED_PAD src0_sel:DWORD src1_sel:WORD_1
    ds_write_b32 v6, v127
    ds_write_b32 v7, v48
    ds_write_b32 v8, v49
    ds_write_b32 v9, v50
    s_cmp_lg_u32 s40, 3
    s_cbranch_scc1 L_p1_kernel_ld_26
    s_add_u32 s36, s42, 7
    s_and_b32 s35, s36, 3
    s_mul_i32 s35, s35, 1047552
    s_lshl_b32 s36, s36, 20
    s_sub_u32 s36, s36, s35
    buffer_store_dwordx4 v[24:27], v3, s[72:75], s36 offen sc1
    s_branch L_p1_kernel_st_27
L_p1_kernel_ld_26:
    s_add_u32 s35, s33, 45154304
    buffer_load_dwordx4 v[24:27], v1, s[8:11], s35 offen nt
L_p1_kernel_st_27:
    v_lshlrev_b32_sdwa v6, 2, v122 dst_sel:DWORD dst_unused:UNUSED_PAD src0_sel:DWORD src1_sel:WORD_0
    v_lshlrev_b32_sdwa v7, 2, v122 dst_sel:DWORD dst_unused:UNUSED_PAD src0_sel:DWORD src1_sel:WORD_1
    v_lshlrev_b32_sdwa v8, 2, v123 dst_sel:DWORD dst_unused:UNUSED_PAD src0_sel:DWORD src1_sel:WORD_0
    v_lshlrev_b32_sdwa v9, 2, v123 dst_sel:DWORD dst_unused:UNUSED_PAD src0_sel:DWORD src1_sel:WORD_1
    ds_write_b32 v6, v52
    ds_write_b32 v7, v53
    ds_write_b32 v8, v54
    ds_write_b32 v9, v56
    v_lshlrev_b32_sdwa v6, 2, v124 dst_sel:DWORD dst_unused:UNUSED_PAD src0_sel:DWORD src1_sel:WORD_0
    v_lshlrev_b32_sdwa v7, 2, v124 dst_sel:DWORD dst_unused:UNUSED_PAD src0_sel:DWORD src1_sel:WORD_1
    v_lshlrev_b32_sdwa v8, 2, v125 dst_sel:DWORD dst_unused:UNUSED_PAD src0_sel:DWORD src1_sel:WORD_0
    v_lshlrev_b32_sdwa v9, 2, v125 dst_sel:DWORD dst_unused:UNUSED_PAD src0_sel:DWORD src1_sel:WORD_1
    ds_write_b32 v6, v57
    ds_write_b32 v7, v58
    ds_write_b32 v8, v60
    ds_write_b32 v9, v61
    v_lshlrev_b32_sdwa v6, 2, v126 dst_sel:DWORD dst_unused:UNUSED_PAD src0_sel:DWORD src1_sel:WORD_0
    v_lshlrev_b32_sdwa v7, 2, v126 dst_sel:DWORD dst_unused:UNUSED_PAD src0_sel:DWORD src1_sel:WORD_1
    v_lshlrev_b32_sdwa v8, 2, v51 dst_sel:DWORD dst_unused:UNUSED_PAD src0_sel:DWORD src1_sel:WORD_0
    v_lshlrev_b32_sdwa v9, 2, v51 dst_sel:DWORD dst_unused:UNUSED_PAD src0_sel:DWORD src1_sel:WORD_1
    ds_write_b32 v6, v62
    ds_write_b32 v7, v64
    ds_write_b32 v8, v65
    ds_write_b32 v9, v66
    s_add_u32 s35, s34, 8388608
    buffer_load_dwordx2 v[108:109], v2, s[16:19], s35 offen nt
    v_lshlrev_b32_sdwa v6, 2, v55 dst_sel:DWORD dst_unused:UNUSED_PAD src0_sel:DWORD src1_sel:WORD_0
    v_lshlrev_b32_sdwa v7, 2, v55 dst_sel:DWORD dst_unused:UNUSED_PAD src0_sel:DWORD src1_sel:WORD_1
    v_lshlrev_b32_sdwa v8, 2, v59 dst_sel:DWORD dst_unused:UNUSED_PAD src0_sel:DWORD src1_sel:WORD_0
    v_lshlrev_b32_sdwa v9, 2, v59 dst_sel:DWORD dst_unused:UNUSED_PAD src0_sel:DWORD src1_sel:WORD_1
    ds_write_b32 v6, v68
    ds_write_b32 v7, v69
    ds_write_b32 v8, v70
    ds_write_b32 v9, v72
    s_add_u32 s35, s34, 10485760
    buffer_load_dwordx2 v[110:111], v2, s[16:19], s35 offen nt
    v_lshlrev_b32_sdwa v6, 2, v63 dst_sel:DWORD dst_unused:UNUSED_PAD src0_sel:DWORD src1_sel:WORD_0
    v_lshlrev_b32_sdwa v7, 2, v63 dst_sel:DWORD dst_unused:UNUSED_PAD src0_sel:DWORD src1_sel:WORD_1
    v_lshlrev_b32_sdwa v8, 2, v67 dst_sel:DWORD dst_unused:UNUSED_PAD src0_sel:DWORD src1_sel:WORD_0
    v_lshlrev_b32_sdwa v9, 2, v67 dst_sel:DWORD dst_unused:UNUSED_PAD src0_sel:DWORD src1_sel:WORD_1
    ds_write_b32 v6, v73
    ds_write_b32 v7, v74
    ds_write_b32 v8, v76
    ds_write_b32 v9, v77
    v_lshlrev_b32_sdwa v6, 2, v71 dst_sel:DWORD dst_unused:UNUSED_PAD src0_sel:DWORD src1_sel:WORD_0
    v_lshlrev_b32_sdwa v7, 2, v71 dst_sel:DWORD dst_unused:UNUSED_PAD src0_sel:DWORD src1_sel:WORD_1
    v_lshlrev_b32_sdwa v8, 2, v75 dst_sel:DWORD dst_unused:UNUSED_PAD src0_sel:DWORD src1_sel:WORD_0
    v_lshlrev_b32_sdwa v9, 2, v75 dst_sel:DWORD dst_unused:UNUSED_PAD src0_sel:DWORD src1_sel:WORD_1
    ds_write_b32 v6, v78
    ds_write_b32 v7, v80
    ds_write_b32 v8, v81
    ds_write_b32 v9, v82
    s_cmp_lg_u32 s40, 3
    s_cbranch_scc1 L_p1_kernel_ld_28
    s_add_u32 s36, s42, 8
    s_and_b32 s35, s36, 3
    s_mul_i32 s35, s35, 1047552
    s_lshl_b32 s36, s36, 20
    s_sub_u32 s36, s36, s35
    buffer_store_dwordx4 v[28:31], v3, s[72:75], s36 offen sc1
    s_branch L_p1_kernel_st_29
L_p1_kernel_ld_28:
    s_add_u32 s35, s33, 45154304
    buffer_load_dwordx4 v[28:31], v1, s[12:15], s35 offen nt
L_p1_kernel_st_29:
    v_lshlrev_b32_sdwa v6, 2, v79 dst_sel:DWORD dst_unused:UNUSED_PAD src0_sel:DWORD src1_sel:WORD_0
    v_lshlrev_b32_sdwa v7, 2, v79 dst_sel:DWORD dst_unused:UNUSED_PAD src0_sel:DWORD src1_sel:WORD_1
    v_lshlrev_b32_sdwa v8, 2, v83 dst_sel:DWORD dst_unused:UNUSED_PAD src0_sel:DWORD src1_sel:WORD_0
    v_lshlrev_b32_sdwa v9, 2, v83 dst_sel:DWORD dst_unused:UNUSED_PAD src0_sel:DWORD src1_sel:WORD_1
    ds_write_b32 v6, v84
    ds_write_b32 v7, v85
    ds_write_b32 v8, v86
    ds_write_b32 v9, v88
    v_lshlrev_b32_sdwa v6, 2, v87 dst_sel:DWORD dst_unused:UNUSED_PAD src0_sel:DWORD src1_sel:WORD_0
    v_lshlrev_b32_sdwa v7, 2, v87 dst_sel:DWORD dst_unused:UNUSED_PAD src0_sel:DWORD src1_sel:WORD_1
    v_lshlrev_b32_sdwa v8, 2, v91 dst_sel:DWORD dst_unused:UNUSED_PAD src0_sel:DWORD src1_sel:WORD_0
    v_lshlrev_b32_sdwa v9, 2, v91 dst_sel:DWORD dst_unused:UNUSED_PAD src0_sel:DWORD src1_sel:WORD_1
    ds_write_b32 v6, v89
    ds_write_b32 v7, v90
    ds_write_b32 v8, v92
    ds_write_b32 v9, v93
    s_add_u32 s35, s34, 12582912
    buffer_load_dwordx2 v[112:113], v2, s[16:19], s35 offen nt
    s_mov_b64 exec, s[44:45]
    v_lshlrev_b32_sdwa v6, 2, v95 dst_sel:DWORD dst_unused:UNUSED_PAD src0_sel:DWORD src1_sel:WORD_0
    v_lshlrev_b32_sdwa v7, 2, v95 dst_sel:DWORD dst_unused:UNUSED_PAD src0_sel:DWORD src1_sel:WORD_1
    v_lshlrev_b32_sdwa v8, 2, v99 dst_sel:DWORD dst_unused:UNUSED_PAD src0_sel:DWORD src1_sel:WORD_0
    v_lshlrev_b32_sdwa v9, 2, v99 dst_sel:DWORD dst_unused:UNUSED_PAD src0_sel:DWORD src1_sel:WORD_1
    ds_write_b32 v6, v94
    ds_write_b32 v7, v96
    ds_write_b32 v8, v97
    ds_write_b32 v9, v98
    s_mov_b64 exec, -1
    s_add_u32 s35, s34, 14680064
    buffer_load_dwordx2 v[114:115], v2, s[16:19], s35 offen nt
    s_mul_i32 s35, s39, 9216
    v_mad_u32_u24 v6, v0, 12, s35
    s_waitcnt lgkmcnt(0)
    s_barrier
    s_cmp_lg_u32 s39, 15
    s_cbranch_scc1 L_p1_kernel_nox_30
    ds_read_b32 v12, v6 offset:9984
    ds_read_b32 v13, v6 offset:9988
    ds_read_b32 v14, v6 offset:9992
L_p1_kernel_nox_30:
    ds_read_b32 v48, v6 offset:1536
    ds_read_b32 v49, v6 offset:1540
    ds_read_b32 v50, v6 offset:1544
    ds_read_b32 v52, v6 offset:3072
    ds_read_b32 v53, v6 offset:3076
    ds_read_b32 v54, v6 offset:3080
    ds_read_b32 v56, v6 offset:4608
    ds_read_b32 v57, v6 offset:4612
    ds_read_b32 v58, v6 offset:4616
    ds_read_b32 v60, v6 offset:6144
    ds_read_b32 v61, v6 offset:6148
    ds_read_b32 v62, v6 offset:6152
    ds_read_b32 v64, v6 offset:7680
    ds_read_b32 v65, v6 offset:7684
    ds_read_b32 v66, v6 offset:7688
    ds_read_b32 v68, v6 offset:9216
    ds_read_b32 v69, v6 offset:9220
    ds_read_b32 v70, v6 offset:9224
    ds_read_b32 v72, v6 offset:0
    ds_read_b32 v73, v6 offset:4
    ds_read_b32 v74, v6 offset:8
    ds_read_b32 v76, v6 offset:768
    ds_read_b32 v77, v6 offset:772
    ds_read_b32 v78, v6 offset:776
    ds_read_b32 v80, v6 offset:2304
    ds_read_b32 v81, v6 offset:2308
    ds_read_b32 v82, v6 offset:2312
    ds_read_b32 v84, v6 offset:3840
    ds_read_b32 v85, v6 offset:3844
    ds_read_b32 v86, v6 offset:3848
    ds_read_b32 v88, v6 offset:5376
    ds_read_b32 v89, v6 offset:5380
    ds_read_b32 v90, v6 offset:5384
    ds_read_b32 v92, v6 offset:6912
    ds_read_b32 v93, v6 offset:6916
    ds_read_b32 v94, v6 offset:6920
    ds_read_b32 v96, v6 offset:8448
    ds_read_b32 v97, v6 offset:8452
    ds_read_b32 v98, v6 offset:8456
    s_cmp_lg_u32 s40, 3
    s_cbranch_scc1 L_p1_kernel_ld_31
    s_add_u32 s36, s42, 9
    s_and_b32 s35, s36, 3
    s_mul_i32 s35, s35, 1047552
    s_lshl_b32 s36, s36, 20
    s_sub_u32 s36, s36, s35
    buffer_store_dwordx4 v[32:35], v3, s[72:75], s36 offen sc1
    s_branch L_p1_kernel_st_32
L_p1_kernel_ld_31:
    s_add_u32 s35, s33, 49348608
    buffer_load_dwordx4 v[32:35], v1, s[8:11], s35 offen nt
L_p1_kernel_st_32:
    v_mov_b32 v8, 0
    v_mov_b32 v9, 0
    v_mov_b32 v10, 0
    v_mov_b32 v11, 0
    v_mov_b32 v15, 16384
    v_min_u32 v7, 16, v0
    v_lshlrev_b32 v7, 2, v7
    v_add_u32 v7, 160768, v7
    s_waitcnt lgkmcnt(0)
    s_barrier
    ds_write_b128 v1, v[8:11] offset:0
    ds_write_b32 v7, v8
    s_nop 1
    v_mov_b32 v6, 1140817920
    s_waitcnt vmcnt(11)
    v_pk_maximum3_f16 v5, v100, v101, v5
    v_mad_u32_u16 v6, v120, s50, v15 op_sel:[0,0,0,0]
    v_mad_u32_u16 v7, v120, s50, v15 op_sel:[1,0,0,0]
    v_mad_u32_u16 v8, v121, s50, v15 op_sel:[0,0,0,0]
    v_mad_u32_u16 v9, v121, s50, v15 op_sel:[1,0,0,0]
    v_add_u32_sdwa v6, v6, v120 dst_sel:DWORD dst_unused:UNUSED_PAD src0_sel:WORD_1 src1_sel:WORD_0
    v_add_u32_sdwa v7, v7, v120 dst_sel:DWORD dst_unused:UNUSED_PAD src0_sel:WORD_1 src1_sel:WORD_1
    v_add_u32_sdwa v8, v8, v121 dst_sel:DWORD dst_unused:UNUSED_PAD src0_sel:WORD_1 src1_sel:WORD_0
    v_add_u32_sdwa v9, v9, v121 dst_sel:DWORD dst_unused:UNUSED_PAD src0_sel:WORD_1 src1_sel:WORD_1
    v_add_u32 v6, v6, v6
    v_add_u32 v7, v7, v7
    v_add_u32 v8, v8, v8
    v_add_u32 v9, v9, v9
    ds_write_b16 v6, v100 offset:16384
    ds_write_b16_d16_hi v7, v100 offset:16384
    ds_write_b16 v8, v101 offset:16384
    ds_write_b16_d16_hi v9, v101 offset:16384
    s_add_u32 s35, s34, 16777216
    buffer_load_dwordx2 v[116:117], v2, s[16:19], s35 offen nt
    v_mov_b32 v6, 1140817920
    s_waitcnt vmcnt(11)
    v_pk_maximum3_f16 v5, v102, v103, v5
    v_mad_u32_u16 v6, v122, s50, v15 op_sel:[0,0,0,0]
    v_mad_u32_u16 v7, v122, s50, v15 op_sel:[1,0,0,0]
    v_mad_u32_u16 v8, v123, s50, v15 op_sel:[0,0,0,0]
    v_mad_u32_u16 v9, v123, s50, v15 op_sel:[1,0,0,0]
    v_add_u32_sdwa v6, v6, v122 dst_sel:DWORD dst_unused:UNUSED_PAD src0_sel:WORD_1 src1_sel:WORD_0
    v_add_u32_sdwa v7, v7, v122 dst_sel:DWORD dst_unused:UNUSED_PAD src0_sel:WORD_1 src1_sel:WORD_1
    v_add_u32_sdwa v8, v8, v123 dst_sel:DWORD dst_unused:UNUSED_PAD src0_sel:WORD_1 src1_sel:WORD_0
    v_add_u32_sdwa v9, v9, v123 dst_sel:DWORD dst_unused:UNUSED_PAD src0_sel:WORD_1 src1_sel:WORD_1
    v_add_u32 v6, v6, v6
    v_add_u32 v7, v7, v7
    v_add_u32 v8, v8, v8
    v_add_u32 v9, v9, v9
    ds_write_b16 v6, v102 offset:16384
    ds_write_b16_d16_hi v7, v102 offset:16384
    ds_write_b16 v8, v103 offset:16384
    ds_write_b16_d16_hi v9, v103 offset:16384
    s_add_u32 s35, s34, 18874368
    s_sub_u32 s35, s35, s49
    v_cndmask_b32 v118, 2.0, v2, s[44:45]
    buffer_load_dwordx2 v[118:119], v118, s[16:19], s35 offen nt
    v_mov_b32 v6, 1140817920
    s_waitcnt vmcnt(10)
    v_pk_maximum3_f16 v5, v104, v105, v5
    v_mad_u32_u16 v6, v124, s50, v15 op_sel:[0,0,0,0]
    v_mad_u32_u16 v7, v124, s50, v15 op_sel:[1,0,0,0]
    v_mad_u32_u16 v8, v125, s50, v15 op_sel:[0,0,0,0]
    v_mad_u32_u16 v9, v125, s50, v15 op_sel:[1,0,0,0]
    v_add_u32_sdwa v6, v6, v124 dst_sel:DWORD dst_unused:UNUSED_PAD src0_sel:WORD_1 src1_sel:WORD_0
    v_add_u32_sdwa v7, v7, v124 dst_sel:DWORD dst_unused:UNUSED_PAD src0_sel:WORD_1 src1_sel:WORD_1
    v_add_u32_sdwa v8, v8, v125 dst_sel:DWORD dst_unused:UNUSED_PAD src0_sel:WORD_1 src1_sel:WORD_0
    v_add_u32_sdwa v9, v9, v125 dst_sel:DWORD dst_unused:UNUSED_PAD src0_sel:WORD_1 src1_sel:WORD_1
    v_add_u32 v6, v6, v6
    v_add_u32 v7, v7, v7
    v_add_u32 v8, v8, v8
    v_add_u32 v9, v9, v9
    ds_write_b16 v6, v104 offset:16384
    ds_write_b16_d16_hi v7, v104 offset:16384
    ds_write_b16 v8, v105 offset:16384
    ds_write_b16_d16_hi v9, v105 offset:16384
    v_mov_b32 v6, 1140817920
    s_waitcnt vmcnt(9)
    v_pk_maximum3_f16 v5, v106, v107, v5
    v_mad_u32_u16 v6, v126, s50, v15 op_sel:[0,0,0,0]
    v_mad_u32_u16 v7, v126, s50, v15 op_sel:[1,0,0,0]
    v_mad_u32_u16 v8, v51, s50, v15 op_sel:[0,0,0,0]
    v_mad_u32_u16 v9, v51, s50, v15 op_sel:[1,0,0,0]
    v_add_u32_sdwa v6, v6, v126 dst_sel:DWORD dst_unused:UNUSED_PAD src0_sel:WORD_1 src1_sel:WORD_0
    v_add_u32_sdwa v7, v7, v126 dst_sel:DWORD dst_unused:UNUSED_PAD src0_sel:WORD_1 src1_sel:WORD_1
    v_add_u32_sdwa v8, v8, v51 dst_sel:DWORD dst_unused:UNUSED_PAD src0_sel:WORD_1 src1_sel:WORD_0
    v_add_u32_sdwa v9, v9, v51 dst_sel:DWORD dst_unused:UNUSED_PAD src0_sel:WORD_1 src1_sel:WORD_1
    v_add_u32 v6, v6, v6
    v_add_u32 v7, v7, v7
    v_add_u32 v8, v8, v8
    v_add_u32 v9, v9, v9
    ds_write_b16 v6, v106 offset:16384
    ds_write_b16_d16_hi v7, v106 offset:16384
    ds_write_b16 v8, v107 offset:16384
    ds_write_b16_d16_hi v9, v107 offset:16384
    s_cmp_lg_u32 s40, 3
    s_cbranch_scc1 L_p1_kernel_ld_33
    s_add_u32 s36, s42, 10
    s_and_b32 s35, s36, 3
    s_mul_i32 s35, s35, 1047552
    s_lshl_b32 s36, s36, 20
    s_sub_u32 s36, s36, s35
    buffer_store_dwordx4 v[36:39], v3, s[72:75], s36 offen sc1
    s_branch L_p1_kernel_st_34
L_p1_kernel_ld_33:
    s_add_u32 s35, s33, 49348608
    buffer_load_dwordx4 v[36:39], v1, s[12:15], s35 offen nt
L_p1_kernel_st_34:
    v_mov_b32 v6, 1140817920
    s_waitcnt vmcnt(8)
    v_pk_maximum3_f16 v5, v108, v109, v5
    v_mad_u32_u16 v6, v55, s50, v15 op_sel:[0,0,0,0]
    v_mad_u32_u16 v7, v55, s50, v15 op_sel:[1,0,0,0]
    v_mad_u32_u16 v8, v59, s50, v15 op_sel:[0,0,0,0]
    v_mad_u32_u16 v9, v59, s50, v15 op_sel:[1,0,0,0]
    v_add_u32_sdwa v6, v6, v55 dst_sel:DWORD dst_unused:UNUSED_PAD src0_sel:WORD_1 src1_sel:WORD_0
    v_add_u32_sdwa v7, v7, v55 dst_sel:DWORD dst_unused:UNUSED_PAD src0_sel:WORD_1 src1_sel:WORD_1
    v_add_u32_sdwa v8, v8, v59 dst_sel:DWORD dst_unused:UNUSED_PAD src0_sel:WORD_1 src1_sel:WORD_0
    v_add_u32_sdwa v9, v9, v59 dst_sel:DWORD dst_unused:UNUSED_PAD src0_sel:WORD_1 src1_sel:WORD_1
    v_add_u32 v6, v6, v6
    v_add_u32 v7, v7, v7
    v_add_u32 v8, v8, v8
    v_add_u32 v9, v9, v9
    ds_write_b16 v6, v108 offset:16384
    ds_write_b16_d16_hi v7, v108 offset:16384
    ds_write_b16 v8, v109 offset:16384
    ds_write_b16_d16_hi v9, v109 offset:16384
    v_mov_b32 v6, 1140817920
    s_waitcnt vmcnt(7)
    v_pk_maximum3_f16 v5, v110, v111, v5
    v_mad_u32_u16 v6, v63, s50, v15 op_sel:[0,0,0,0]
    v_mad_u32_u16 v7, v63, s50, v15 op_sel:[1,0,0,0]
    v_mad_u32_u16 v8, v67, s50, v15 op_sel:[0,0,0,0]
    v_mad_u32_u16 v9, v67, s50, v15 op_sel:[1,0,0,0]
    v_add_u32_sdwa v6, v6, v63 dst_sel:DWORD dst_unused:UNUSED_PAD src0_sel:WORD_1 src1_sel:WORD_0
    v_add_u32_sdwa v7, v7, v63 dst_sel:DWORD dst_unused:UNUSED_PAD src0_sel:WORD_1 src1_sel:WORD_1
    v_add_u32_sdwa v8, v8, v67 dst_sel:DWORD dst_unused:UNUSED_PAD src0_sel:WORD_1 src1_sel:WORD_0
    v_add_u32_sdwa v9, v9, v67 dst_sel:DWORD dst_unused:UNUSED_PAD src0_sel:WORD_1 src1_sel:WORD_1
    v_add_u32 v6, v6, v6
    v_add_u32 v7, v7, v7
    v_add_u32 v8, v8, v8
    v_add_u32 v9, v9, v9
    ds_write_b16 v6, v110 offset:16384
    ds_write_b16_d16_hi v7, v110 offset:16384
    ds_write_b16 v8, v111 offset:16384
    ds_write_b16_d16_hi v9, v111 offset:16384
    v_mov_b32 v6, 1140817920
    s_waitcnt vmcnt(5)
    v_pk_maximum3_f16 v5, v112, v113, v5
    v_mad_u32_u16 v6, v71, s50, v15 op_sel:[0,0,0,0]
    v_mad_u32_u16 v7, v71, s50, v15 op_sel:[1,0,0,0]
    v_mad_u32_u16 v8, v75, s50, v15 op_sel:[0,0,0,0]
    v_mad_u32_u16 v9, v75, s50, v15 op_sel:[1,0,0,0]
    v_add_u32_sdwa v6, v6, v71 dst_sel:DWORD dst_unused:UNUSED_PAD src0_sel:WORD_1 src1_sel:WORD_0
    v_add_u32_sdwa v7, v7, v71 dst_sel:DWORD dst_unused:UNUSED_PAD src0_sel:WORD_1 src1_sel:WORD_1
    v_add_u32_sdwa v8, v8, v75 dst_sel:DWORD dst_unused:UNUSED_PAD src0_sel:WORD_1 src1_sel:WORD_0
    v_add_u32_sdwa v9, v9, v75 dst_sel:DWORD dst_unused:UNUSED_PAD src0_sel:WORD_1 src1_sel:WORD_1
    v_add_u32 v6, v6, v6
    v_add_u32 v7, v7, v7
    v_add_u32 v8, v8, v8
    v_add_u32 v9, v9, v9
    ds_write_b16 v6, v112 offset:16384
    ds_write_b16_d16_hi v7, v112 offset:16384
    ds_write_b16 v8, v113 offset:16384
    ds_write_b16_d16_hi v9, v113 offset:16384
    s_cmp_lg_u32 s40, 3
    s_cbranch_scc1 L_p1_kernel_ld_35
    s_add_u32 s36, s42, 11
    s_and_b32 s35, s36, 3
    s_mul_i32 s35, s35, 1047552
    s_lshl_b32 s36, s36, 20
    s_sub_u32 s36, s36, s35
    buffer_store_dwordx4 v[40:43], v3, s[72:75], s36 offen sc1
    s_branch L_p1_kernel_st_36
L_p1_kernel_ld_35:
    s_add_u32 s35, s33, 53542912
    buffer_load_dwordx4 v[40:43], v1, s[8:11], s35 offen nt
L_p1_kernel_st_36:
    v_mov_b32 v6, 1140817920
    s_waitcnt vmcnt(5)
    v_pk_maximum3_f16 v5, v114, v115, v5
    v_mad_u32_u16 v6, v79, s50, v15 op_sel:[0,0,0,0]
    v_mad_u32_u16 v7, v79, s50, v15 op_sel:[1,0,0,0]
    v_mad_u32_u16 v8, v83, s50, v15 op_sel:[0,0,0,0]
    v_mad_u32_u16 v9, v83, s50, v15 op_sel:[1,0,0,0]
    v_add_u32_sdwa v6, v6, v79 dst_sel:DWORD dst_unused:UNUSED_PAD src0_sel:WORD_1 src1_sel:WORD_0
    v_add_u32_sdwa v7, v7, v79 dst_sel:DWORD dst_unused:UNUSED_PAD src0_sel:WORD_1 src1_sel:WORD_1
    v_add_u32_sdwa v8, v8, v83 dst_sel:DWORD dst_unused:UNUSED_PAD src0_sel:WORD_1 src1_sel:WORD_0
    v_add_u32_sdwa v9, v9, v83 dst_sel:DWORD dst_unused:UNUSED_PAD src0_sel:WORD_1 src1_sel:WORD_1
    v_add_u32 v6, v6, v6
    v_add_u32 v7, v7, v7
    v_add_u32 v8, v8, v8
    v_add_u32 v9, v9, v9
    ds_write_b16 v6, v114 offset:16384
    ds_write_b16_d16_hi v7, v114 offset:16384
    ds_write_b16 v8, v115 offset:16384
    ds_write_b16_d16_hi v9, v115 offset:16384
    v_mov_b32 v6, 1140817920
    s_waitcnt vmcnt(3)
    v_pk_maximum3_f16 v5, v116, v117, v5
    v_mad_u32_u16 v6, v87, s50, v15 op_sel:[0,0,0,0]
    v_mad_u32_u16 v7, v87, s50, v15 op_sel:[1,0,0,0]
    v_mad_u32_u16 v8, v91, s50, v15 op_sel:[0,0,0,0]
    v_mad_u32_u16 v9, v91, s50, v15 op_sel:[1,0,0,0]
    v_add_u32_sdwa v6, v6, v87 dst_sel:DWORD dst_unused:UNUSED_PAD src0_sel:WORD_1 src1_sel:WORD_0
    v_add_u32_sdwa v7, v7, v87 dst_sel:DWORD dst_unused:UNUSED_PAD src0_sel:WORD_1 src1_sel:WORD_1
    v_add_u32_sdwa v8, v8, v91 dst_sel:DWORD dst_unused:UNUSED_PAD src0_sel:WORD_1 src1_sel:WORD_0
    v_add_u32_sdwa v9, v9, v91 dst_sel:DWORD dst_unused:UNUSED_PAD src0_sel:WORD_1 src1_sel:WORD_1
    v_add_u32 v6, v6, v6
    v_add_u32 v7, v7, v7
    v_add_u32 v8, v8, v8
    v_add_u32 v9, v9, v9
    ds_write_b16 v6, v116 offset:16384
    ds_write_b16_d16_hi v7, v116 offset:16384
    ds_write_b16 v8, v117 offset:16384
    ds_write_b16_d16_hi v9, v117 offset:16384
    v_mov_b32 v6, 1140817920
    s_mov_b64 exec, s[44:45]
    s_waitcnt vmcnt(2)
    v_pk_maximum3_f16 v5, v118, v119, v5
    s_mov_b64 exec, -1
    s_mov_b64 exec, s[44:45]
    v_mad_u32_u16 v6, v95, s50, v15 op_sel:[0,0,0,0]
    v_mad_u32_u16 v7, v95, s50, v15 op_sel:[1,0,0,0]
    v_mad_u32_u16 v8, v99, s50, v15 op_sel:[0,0,0,0]
    v_mad_u32_u16 v9, v99, s50, v15 op_sel:[1,0,0,0]
    v_add_u32_sdwa v6, v6, v95 dst_sel:DWORD dst_unused:UNUSED_PAD src0_sel:WORD_1 src1_sel:WORD_0
    v_add_u32_sdwa v7, v7, v95 dst_sel:DWORD dst_unused:UNUSED_PAD src0_sel:WORD_1 src1_sel:WORD_1
    v_add_u32_sdwa v8, v8, v99 dst_sel:DWORD dst_unused:UNUSED_PAD src0_sel:WORD_1 src1_sel:WORD_0
    v_add_u32_sdwa v9, v9, v99 dst_sel:DWORD dst_unused:UNUSED_PAD src0_sel:WORD_1 src1_sel:WORD_1
    v_add_u32 v6, v6, v6
    v_add_u32 v7, v7, v7
    v_add_u32 v8, v8, v8
    v_add_u32 v9, v9, v9
    ds_write_b16 v6, v118 offset:16384
    ds_write_b16_d16_hi v7, v118 offset:16384
    ds_write_b16 v8, v119 offset:16384
    ds_write_b16_d16_hi v9, v119 offset:16384
    s_mov_b64 exec, -1
    s_cmp_lg_u32 s40, 3
    s_cbranch_scc1 L_p1_kernel_ld_37
    s_add_u32 s36, s42, 12
    s_and_b32 s35, s36, 3
    s_mul_i32 s35, s35, 1047552
    s_lshl_b32 s36, s36, 20
    s_sub_u32 s36, s36, s35
    buffer_store_dwordx4 v[44:47], v3, s[72:75], s36 offen sc1
    s_branch L_p1_kernel_st_38
L_p1_kernel_ld_37:
    s_add_u32 s35, s33, 53542912
    buffer_load_dwordx4 v[44:47], v1, s[12:15], s35 offen nt
L_p1_kernel_st_38:
    s_mul_i32 s35, s39, 6144
    v_add_u32 v6, s35, v2
    v_mov_b32 v10, 1140817920
    s_waitcnt lgkmcnt(0)
    s_barrier
    ds_read_b64 v[120:121], v6 offset:23040
    ds_read_b64 v[122:123], v6 offset:16384
    ds_read_b64 v[124:125], v6 offset:16896
    ds_read_b64 v[126:127], v6 offset:17408
    ds_read_b64 v[100:101], v6 offset:17920
    ds_read_b64 v[102:103], v6 offset:18432
    ds_read_b64 v[104:105], v6 offset:18944
    ds_read_b64 v[106:107], v6 offset:19456
    ds_read_b64 v[108:109], v6 offset:19968
    ds_read_b64 v[110:111], v6 offset:20480
    ds_read_b64 v[112:113], v6 offset:20992
    ds_read_b64 v[114:115], v6 offset:21504
    ds_read_b64 v[116:117], v6 offset:22016
    ds_read_b64 v[118:119], v6 offset:22528
    s_add_u32 s33, s33, 40960000
    s_add_u32 s34, s34, 20480000
    s_add_u32 s40, s40, 1
    s_cmp_lt_u32 s40, 4
    s_cbranch_scc1 L_p1_loop
    s_cmp_lg_u32 s39, 15
    s_cbranch_scc1 L_p1_kernel_nox_39
    s_waitcnt lgkmcnt(13)
    v_lshlrev_b32 v15, 16, v120
    v_and_b32 v120, 0xffff0000, v120
    v_lshlrev_b32 v121, 16, v121
    v_mul_f32 v15, s41, v15
    v_mul_f32 v120, s41, v120
    v_mul_f32 v121, s41, v121
    v_fract_f32 v15, v15
    v_fract_f32 v120, v120
    v_fract_f32 v121, v121
    v_cos_f32 v15, v15
    v_cos_f32 v120, v120
    v_cos_f32 v121, v121
    v_fmaak_f32 v15, v10, v15, 1262486016
    v_fmaak_f32 v120, v10, v120, 1262486016
    v_fmaak_f32 v121, v10, v121, 1262486016
    v_lshlrev_b32 v15, 22, v15
    v_alignbit_b32 v15, v120, v15, 10
    v_alignbit_b32 v15, v121, v15, 10
    v_xor_b32 v15, 0x80200800, v15
    s_add_u32 s36, s42, 13
    s_and_b32 s35, s36, 3
    s_mul_i32 s35, s35, 1047552
    s_lshl_b32 s36, s36, 20
    s_sub_u32 s36, s36, s35
    buffer_store_dwordx4 v[12:15], v3, s[20:23], s36 offen sc1
L_p1_kernel_nox_39:
    s_waitcnt lgkmcnt(12)
    v_lshlrev_b32 v75, 16, v122
    v_and_b32 v122, 0xffff0000, v122
    v_lshlrev_b32 v123, 16, v123
    v_mul_f32 v75, s41, v75
    v_mul_f32 v122, s41, v122
    v_mul_f32 v123, s41, v123
    v_fract_f32 v75, v75
    v_fract_f32 v122, v122
    v_fract_f32 v123, v123
    v_cos_f32 v75, v75
    v_cos_f32 v122, v122
    v_cos_f32 v123, v123
    v_fmaak_f32 v75, v10, v75, 1262486016
    v_fmaak_f32 v122, v10, v122, 1262486016
    v_fmaak_f32 v123, v10, v123, 1262486016
    v_lshlrev_b32 v75, 22, v75
    v_alignbit_b32 v75, v122, v75, 10
    v_alignbit_b32 v75, v123, v75, 10
    v_xor_b32 v75, 0x80200800, v75
    s_add_u32 s36, s42, 0
    s_and_b32 s35, s36, 3
    s_mul_i32 s35, s35, 1047552
    s_lshl_b32 s36, s36, 20
    s_sub_u32 s36, s36, s35
    buffer_store_dwordx4 v[72:75], v3, s[20:23], s36 offen sc1
    s_waitcnt lgkmcnt(11)
    v_lshlrev_b32 v79, 16, v124
    v_and_b32 v124, 0xffff0000, v124
    v_lshlrev_b32 v125, 16, v125
    v_mul_f32 v79, s41, v79
    v_mul_f32 v124, s41, v124
    v_mul_f32 v125, s41, v125
    v_fract_f32 v79, v79
    v_fract_f32 v124, v124
    v_fract_f32 v125, v125
    v_cos_f32 v79, v79
    v_cos_f32 v124, v124
    v_cos_f32 v125, v125
    v_fmaak_f32 v79, v10, v79, 1262486016
    v_fmaak_f32 v124, v10, v124, 1262486016
    v_fmaak_f32 v125, v10, v125, 1262486016
    v_lshlrev_b32 v79, 22, v79
    v_alignbit_b32 v79, v124, v79, 10
    v_alignbit_b32 v79, v125, v79, 10
    v_xor_b32 v79, 0x80200800, v79
    s_add_u32 s36, s42, 1
    s_and_b32 s35, s36, 3
    s_mul_i32 s35, s35, 1047552
    s_lshl_b32 s36, s36, 20
    s_sub_u32 s36, s36, s35
    buffer_store_dwordx4 v[76:79], v3, s[20:23], s36 offen sc1
    s_waitcnt lgkmcnt(0)
    v_lshlrev_b32 v51, 16, v126
    v_and_b32 v126, 0xffff0000, v126
    v_lshlrev_b32 v127, 16, v127
    v_mul_f32 v51, s41, v51
    v_mul_f32 v126, s41, v126
    v_mul_f32 v127, s41, v127
    v_fract_f32 v51, v51
    v_fract_f32 v126, v126
    v_fract_f32 v127, v127
    v_cos_f32 v51, v51
    v_cos_f32 v126, v126
    v_cos_f32 v127, v127
    v_fmaak_f32 v51, v10, v51, 1262486016
    v_fmaak_f32 v126, v10, v126, 1262486016
    v_fmaak_f32 v127, v10, v127, 1262486016
    v_lshlrev_b32 v51, 22, v51
    v_alignbit_b32 v51, v126, v51, 10
    v_alignbit_b32 v51, v127, v51, 10
    v_xor_b32 v51, 0x80200800, v51
    s_add_u32 s36, s42, 2
    s_and_b32 s35, s36, 3
    s_mul_i32 s35, s35, 1047552
    s_lshl_b32 s36, s36, 20
    s_sub_u32 s36, s36, s35
    buffer_store_dwordx4 v[48:51], v3, s[20:23], s36 offen sc1
    v_lshlrev_b32 v83, 16, v100
    v_and_b32 v100, 0xffff0000, v100
    v_lshlrev_b32 v101, 16, v101
    v_mul_f32 v83, s41, v83
    v_mul_f32 v100, s41, v100
    v_mul_f32 v101, s41, v101
    v_fract_f32 v83, v83
    v_fract_f32 v100, v100
    v_fract_f32 v101, v101
    v_cos_f32 v83, v83
    v_cos_f32 v100, v100
    v_cos_f32 v101, v101
    v_fmaak_f32 v83, v10, v83, 1262486016
    v_fmaak_f32 v100, v10, v100, 1262486016
    v_fmaak_f32 v101, v10, v101, 1262486016
    v_lshlrev_b32 v83, 22, v83
    v_alignbit_b32 v83, v100, v83, 10
    v_alignbit_b32 v83, v101, v83, 10
    v_xor_b32 v83, 0x80200800, v83
    s_add_u32 s36, s42, 3
    s_and_b32 s35, s36, 3
    s_mul_i32 s35, s35, 1047552
    s_lshl_b32 s36, s36, 20
    s_sub_u32 s36, s36, s35
    buffer_store_dwordx4 v[80:83], v3, s[20:23], s36 offen sc1
    v_lshlrev_b32 v55, 16, v102
    v_and_b32 v102, 0xffff0000, v102
    v_lshlrev_b32 v103, 16, v103
    v_mul_f32 v55, s41, v55
    v_mul_f32 v102, s41, v102
    v_mul_f32 v103, s41, v103
    v_fract_f32 v55, v55
    v_fract_f32 v102, v102
    v_fract_f32 v103, v103
    v_cos_f32 v55, v55
    v_cos_f32 v102, v102
    v_cos_f32 v103, v103
    v_fmaak_f32 v55, v10, v55, 1262486016
    v_fmaak_f32 v102, v10, v102, 1262486016
    v_fmaak_f32 v103, v10, v103, 1262486016
    v_lshlrev_b32 v55, 22, v55
    v_alignbit_b32 v55, v102, v55, 10
    v_alignbit_b32 v55, v103, v55, 10
    v_xor_b32 v55, 0x80200800, v55
    s_add_u32 s36, s42, 4
    s_and_b32 s35, s36, 3
    s_mul_i32 s35, s35, 1047552
    s_lshl_b32 s36, s36, 20
    s_sub_u32 s36, s36, s35
    buffer_store_dwordx4 v[52:55], v3, s[20:23], s36 offen sc1
    v_lshlrev_b32 v87, 16, v104
    v_and_b32 v104, 0xffff0000, v104
    v_lshlrev_b32 v105, 16, v105
    v_mul_f32 v87, s41, v87
    v_mul_f32 v104, s41, v104
    v_mul_f32 v105, s41, v105
    v_fract_f32 v87, v87
    v_fract_f32 v104, v104
    v_fract_f32 v105, v105
    v_cos_f32 v87, v87
    v_cos_f32 v104, v104
    v_cos_f32 v105, v105
    v_fmaak_f32 v87, v10, v87, 1262486016
    v_fmaak_f32 v104, v10, v104, 1262486016
    v_fmaak_f32 v105, v10, v105, 1262486016
    v_lshlrev_b32 v87, 22, v87
    v_alignbit_b32 v87, v104, v87, 10
    v_alignbit_b32 v87, v105, v87, 10
    v_xor_b32 v87, 0x80200800, v87
    s_add_u32 s36, s42, 5
    s_and_b32 s35, s36, 3
    s_mul_i32 s35, s35, 1047552
    s_lshl_b32 s36, s36, 20
    s_sub_u32 s36, s36, s35
    buffer_store_dwordx4 v[84:87], v3, s[20:23], s36 offen sc1
    v_lshlrev_b32 v59, 16, v106
    v_and_b32 v106, 0xffff0000, v106
    v_lshlrev_b32 v107, 16, v107
    v_mul_f32 v59, s41, v59
    v_mul_f32 v106, s41, v106
    v_mul_f32 v107, s41, v107
    v_fract_f32 v59, v59
    v_fract_f32 v106, v106
    v_fract_f32 v107, v107
    v_cos_f32 v59, v59
    v_cos_f32 v106, v106
    v_cos_f32 v107, v107
    v_fmaak_f32 v59, v10, v59, 1262486016
    v_fmaak_f32 v106, v10, v106, 1262486016
    v_fmaak_f32 v107, v10, v107, 1262486016
    v_lshlrev_b32 v59, 22, v59
    v_alignbit_b32 v59, v106, v59, 10
    v_alignbit_b32 v59, v107, v59, 10
    v_xor_b32 v59, 0x80200800, v59
    s_add_u32 s36, s42, 6
    s_and_b32 s35, s36, 3
    s_mul_i32 s35, s35, 1047552
    s_lshl_b32 s36, s36, 20
    s_sub_u32 s36, s36, s35
    buffer_store_dwordx4 v[56:59], v3, s[20:23], s36 offen sc1
    v_lshlrev_b32 v91, 16, v108
    v_and_b32 v108, 0xffff0000, v108
    v_lshlrev_b32 v109, 16, v109
    v_mul_f32 v91, s41, v91
    v_mul_f32 v108, s41, v108
    v_mul_f32 v109, s41, v109
    v_fract_f32 v91, v91
    v_fract_f32 v108, v108
    v_fract_f32 v109, v109
    v_cos_f32 v91, v91
    v_cos_f32 v108, v108
    v_cos_f32 v109, v109
    v_fmaak_f32 v91, v10, v91, 1262486016
    v_fmaak_f32 v108, v10, v108, 1262486016
    v_fmaak_f32 v109, v10, v109, 1262486016
    v_lshlrev_b32 v91, 22, v91
    v_alignbit_b32 v91, v108, v91, 10
    v_alignbit_b32 v91, v109, v91, 10
    v_xor_b32 v91, 0x80200800, v91
    s_add_u32 s36, s42, 7
    s_and_b32 s35, s36, 3
    s_mul_i32 s35, s35, 1047552
    s_lshl_b32 s36, s36, 20
    s_sub_u32 s36, s36, s35
    buffer_store_dwordx4 v[88:91], v3, s[20:23], s36 offen sc1
    v_lshlrev_b32 v63, 16, v110
    v_and_b32 v110, 0xffff0000, v110
    v_lshlrev_b32 v111, 16, v111
    v_mul_f32 v63, s41, v63
    v_mul_f32 v110, s41, v110
    v_mul_f32 v111, s41, v111
    v_fract_f32 v63, v63
    v_fract_f32 v110, v110
    v_fract_f32 v111, v111
    v_cos_f32 v63, v63
    v_cos_f32 v110, v110
    v_cos_f32 v111, v111
    v_fmaak_f32 v63, v10, v63, 1262486016
    v_fmaak_f32 v110, v10, v110, 1262486016
    v_fmaak_f32 v111, v10, v111, 1262486016
    v_lshlrev_b32 v63, 22, v63
    v_alignbit_b32 v63, v110, v63, 10
    v_alignbit_b32 v63, v111, v63, 10
    v_xor_b32 v63, 0x80200800, v63
    s_add_u32 s36, s42, 8
    s_and_b32 s35, s36, 3
    s_mul_i32 s35, s35, 1047552
    s_lshl_b32 s36, s36, 20
    s_sub_u32 s36, s36, s35
    buffer_store_dwordx4 v[60:63], v3, s[20:23], s36 offen sc1
    v_lshlrev_b32 v95, 16, v112
    v_and_b32 v112, 0xffff0000, v112
    v_lshlrev_b32 v113, 16, v113
    v_mul_f32 v95, s41, v95
    v_mul_f32 v112, s41, v112
    v_mul_f32 v113, s41, v113
    v_fract_f32 v95, v95
    v_fract_f32 v112, v112
    v_fract_f32 v113, v113
    v_cos_f32 v95, v95
    v_cos_f32 v112, v112
    v_cos_f32 v113, v113
    v_fmaak_f32 v95, v10, v95, 1262486016
    v_fmaak_f32 v112, v10, v112, 1262486016
    v_fmaak_f32 v113, v10, v113, 1262486016
    v_lshlrev_b32 v95, 22, v95
    v_alignbit_b32 v95, v112, v95, 10
    v_alignbit_b32 v95, v113, v95, 10
    v_xor_b32 v95, 0x80200800, v95
    s_add_u32 s36, s42, 9
    s_and_b32 s35, s36, 3
    s_mul_i32 s35, s35, 1047552
    s_lshl_b32 s36, s36, 20
    s_sub_u32 s36, s36, s35
    buffer_store_dwordx4 v[92:95], v3, s[20:23], s36 offen sc1
    v_lshlrev_b32 v67, 16, v114
    v_and_b32 v114, 0xffff0000, v114
    v_lshlrev_b32 v115, 16, v115
    v_mul_f32 v67, s41, v67
    v_mul_f32 v114, s41, v114
    v_mul_f32 v115, s41, v115
    v_fract_f32 v67, v67
    v_fract_f32 v114, v114
    v_fract_f32 v115, v115
    v_cos_f32 v67, v67
    v_cos_f32 v114, v114
    v_cos_f32 v115, v115
    v_fmaak_f32 v67, v10, v67, 1262486016
    v_fmaak_f32 v114, v10, v114, 1262486016
    v_fmaak_f32 v115, v10, v115, 1262486016
    v_lshlrev_b32 v67, 22, v67
    v_alignbit_b32 v67, v114, v67, 10
    v_alignbit_b32 v67, v115, v67, 10
    v_xor_b32 v67, 0x80200800, v67
    s_add_u32 s36, s42, 10
    s_and_b32 s35, s36, 3
    s_mul_i32 s35, s35, 1047552
    s_lshl_b32 s36, s36, 20
    s_sub_u32 s36, s36, s35
    buffer_store_dwordx4 v[64:67], v3, s[20:23], s36 offen sc1
    v_lshlrev_b32 v99, 16, v116
    v_and_b32 v116, 0xffff0000, v116
    v_lshlrev_b32 v117, 16, v117
    v_mul_f32 v99, s41, v99
    v_mul_f32 v116, s41, v116
    v_mul_f32 v117, s41, v117
    v_fract_f32 v99, v99
    v_fract_f32 v116, v116
    v_fract_f32 v117, v117
    v_cos_f32 v99, v99
    v_cos_f32 v116, v116
    v_cos_f32 v117, v117
    v_fmaak_f32 v99, v10, v99, 1262486016
    v_fmaak_f32 v116, v10, v116, 1262486016
    v_fmaak_f32 v117, v10, v117, 1262486016
    v_lshlrev_b32 v99, 22, v99
    v_alignbit_b32 v99, v116, v99, 10
    v_alignbit_b32 v99, v117, v99, 10
    v_xor_b32 v99, 0x80200800, v99
    s_add_u32 s36, s42, 11
    s_and_b32 s35, s36, 3
    s_mul_i32 s35, s35, 1047552
    s_lshl_b32 s36, s36, 20
    s_sub_u32 s36, s36, s35
    buffer_store_dwordx4 v[96:99], v3, s[20:23], s36 offen sc1
    v_lshlrev_b32 v71, 16, v118
    v_and_b32 v118, 0xffff0000, v118
    v_lshlrev_b32 v119, 16, v119
    v_mul_f32 v71, s41, v71
    v_mul_f32 v118, s41, v118
    v_mul_f32 v119, s41, v119
    v_fract_f32 v71, v71
    v_fract_f32 v118, v118
    v_fract_f32 v119, v119
    v_cos_f32 v71, v71
    v_cos_f32 v118, v118
    v_cos_f32 v119, v119
    v_fmaak_f32 v71, v10, v71, 1262486016
    v_fmaak_f32 v118, v10, v118, 1262486016
    v_fmaak_f32 v119, v10, v119, 1262486016
    v_lshlrev_b32 v71, 22, v71
    v_alignbit_b32 v71, v118, v71, 10
    v_alignbit_b32 v71, v119, v71, 10
    v_xor_b32 v71, 0x80200800, v71
    s_add_u32 s36, s42, 12
    s_and_b32 s35, s36, 3
    s_mul_i32 s35, s35, 1047552
    s_lshl_b32 s36, s36, 20
    s_sub_u32 s36, s36, s35
    buffer_store_dwordx4 v[68:71], v3, s[20:23], s36 offen sc1
    v_and_b32 v6, 0x7c007c00, v5
    v_add_u32 v6, 0x04000400, v6
    v_and_b32 v6, 0x80008000, v6
    v_cmp_ne_u32 vcc, 0, v6
    s_lshl_b32 s35, s2, 3
    s_add_u32 s35, s35, 8519682
    s_mov_b32 s26, 8540160
    s_cmp_lg_u64 vcc, 0
    s_cselect_b32 s55, 1, s55
    s_cmp_eq_u32 s55, 0
    s_cbranch_scc1 L_p1_end
    s_mov_b64 exec, 1
    buffer_store_short v4, off, s[24:27], s35 sc1
L_p1_end:
    s_endpgm
.globl p2_kernel
.p2align 8
.type p2_kernel,@function
p2_kernel:
    s_cmp_ge_u32 s2, 256
    s_cbranch_scc1 L_p2_end
    s_load_dwordx2 s[4:5], s[0:1], 104
    s_load_dwordx2 s[100:101], s[0:1], 24
    s_load_dwordx2 s[8:9], s[0:1], 0
    s_load_dwordx2 s[30:31], s[0:1], 40
    s_load_dwordx4 s[32:35], s[0:1], 56
    s_load_dwordx4 s[36:39], s[0:1], 72
    s_and_b32 s14, s2, 7
    s_lshr_b32 s49, s2, 3
    s_and_b32 s3, s14, 1
    s_lshl_b32 s3, s3, 5
    s_add_u32 s3, s3, s49
    s_lshr_b32 s12, s14, 1
    v_lshrrev_b32 v108, 6, v0
    v_lshlrev_b32 v1, 4, v0
    v_and_b32 v109, 63, v0
    v_readfirstlane_b32 s13, v108
    v_lshlrev_b32 v111, 4, v109
    v_lshrrev_b32 v110, 2, v109
    v_mul_u32_u24 v110, 8256, v110
    v_add_u32 v110, v110, v111
    s_mul_i32 s14, s12, 65
    s_add_u32 s14, s14, s3
    s_lshl_b32 s14, s14, 5
    s_mul_i32 s15, s13, 532480
    s_add_u32 s14, s14, s15
    s_add_u32 s25, s14, 222298112
    s_mul_i32 s22, s12, 1280000
    s_mov_b32 s2, 0
    s_waitcnt lgkmcnt(0)
    s_mov_b32 s6, 655360000
    s_mov_b32 s7, 0x00020000
    s_add_u32 s10, s22, 1280000
    s_mov_b32 s11, 0x00020000
    s_add_u32 s15, s25, 0
    buffer_load_dwordx4 v[28:31], v110, s[4:7], s15 offen
    s_add_u32 s15, s25, 133120
    buffer_load_dwordx4 v[32:35], v110, s[4:7], s15 offen
    s_add_u32 s15, s25, 266240
    buffer_load_dwordx4 v[36:39], v110, s[4:7], s15 offen
    s_add_u32 s15, s25, 399360
    buffer_load_dwordx4 v[40:43], v110, s[4:7], s15 offen
    s_load_dwordx4 s[40:43], s[30:31], 0
    s_load_dwordx16 s[52:67], s[32:33], 0
    s_load_dwordx16 s[68:83], s[34:35], 0
    s_load_dwordx8 s[84:91], s[36:37], 0
    s_load_dwordx8 s[92:99], s[38:39], 0
    v_mov_b32 v52, 0x100
    s_cmp_lg_u32 s13, 0
    s_cbranch_scc1 L_p2_noann
    s_lshl_b32 s14, s3, 8
    s_add_u32 s14, s14, 230821888
    s_mov_b64 exec, 1
    buffer_atomic_add v52, off, s[4:7], s14
    s_mov_b64 exec, -1
L_p2_noann:
    s_add_u32 s14, s22, 0
    buffer_load_dwordx4 v[88:91], v1, s[8:11], s14 offen
    s_add_u32 s14, s22, 16384
    buffer_load_dwordx4 v[92:95], v1, s[8:11], s14 offen
    s_add_u32 s14, s22, 32768
    buffer_load_dwordx4 v[96:99], v1, s[8:11], s14 offen
    s_add_u32 s14, s22, 49152
    buffer_load_dwordx4 v[100:103], v1, s[8:11], s14 offen
    s_add_u32 s14, s22, 65536
    buffer_load_dwordx4 v[104:107], v1, s[8:11], s14 offen
    s_mov_b32 s15, 230817792
    buffer_load_dwordx4 v[80:83], v111, s[4:7], s15 offen offset:0
    buffer_load_dwordx4 v[84:87], v111, s[4:7], s15 offen offset:1024
    v_mov_b32 v2, v109
    v_mov_b32 v50, 21845
    v_add_u32 v3, 80000, v1
    v_add_u32 v124, 145536, v1
    v_add_u32 v113, 65536, v1
    v_mov_b32 v112, 0x7f000000
    v_cmp_gt_u32 vcc, 904, v0
    s_mul_i32 s19, s13, 240
    s_add_u32 s19, s19, 160000
    v_cndmask_b32 v124, v112, v124, vcc
    v_cndmask_b32 v113, v112, v113, vcc
    v_lshl_add_u32 v6, v109, 2, s19
    v_lshl_add_u32 v126, v109, 1, s19
    v_cmp_gt_u32 vcc, 10, v109
    s_lshl_b32 s27, s13, 18
    s_mov_b32 s23, 261888
    v_cndmask_b32 v6, v112, v6, vcc
    s_mov_b32 s44, s4
    s_add_u32 s45, s5, 1048576
    s_mov_b32 s46, 13893632
    s_mov_b32 s47, 0x00020000
    s_mov_b32 s18, 80000
    s_and_b32 s50, s3, 1
    s_lshl_b32 s50, s50, 18
    s_sub_u32 s18, s18, s50
    s_sub_u32 s50, 4294836224, s50
    v_lshlrev_b32 v116, 3, v0
    v_and_b32 v116, 16, v116
    v_and_b32 v117, 1, v0
    v_lshl_or_b32 v116, v117, 5, v116
    v_mov_b32 v58, 0x3f80
    v_mov_b32 v59, 0
    v_lshlrev_b64 v[58:59], v116, v[58:59]
    v_mov_b32 v4, 0
    v_mov_b32 v5, 0
    v_mov_b32 v114, 0xff00
    v_bfe_u32 v127, v0, 0, 1
    v_mul_u32_u24 v127, 40, v127
    v_add_u32 v127, s19, v127
    ds_write2_b32 v6, v5, v5 offset0:34 offset1:44
    ds_write_b16 v126, v114 offset:2
    v_mov_b32 v44, 1073758208
    v_mov_b32 v45, 1073758208
    v_mov_b32 v46, 1073758208
    v_mov_b32 v47, 1073758208
    v_mov_b32 v48, 1073758208
    v_mov_b32 v49, 1073758208
    ds_write_b128 v113, v[44:47]
    v_lshrrev_b32 v115, 4, v109
    v_mul_u32_u24 v115, 15360, v115
    v_lshl_add_u32 v115, v109, 6, v115
    v_lshl_add_u32 v115, v108, 10, v115
    s_waitcnt lgkmcnt(0)
    v_mov_b32 v53, s40
    v_mov_b32 v54, s41
    v_mov_b32 v56, s42
    v_mov_b32 v57, s43
    s_mov_b32 s40, 20987904
    s_mov_b32 s41, 21031594
    s_pack_ll_b32_b16 s14, s52, s54
    s_pack_hh_b32_b16 s15, s52, s54
    s_pack_ll_b32_b16 s54, s53, s55
    s_pack_hh_b32_b16 s55, s53, s55
    s_mov_b32 s52, s14
    s_mov_b32 s53, s15
    s_pack_ll_b32_b16 s14, s56, s58
    s_pack_hh_b32_b16 s15, s56, s58
    s_pack_ll_b32_b16 s58, s57, s59
    s_pack_hh_b32_b16 s59, s57, s59
    s_mov_b32 s56, s14
    s_mov_b32 s57, s15
    s_pack_ll_b32_b16 s14, s60, s62
    s_pack_hh_b32_b16 s15, s60, s62
    s_pack_ll_b32_b16 s62, s61, s63
    s_pack_hh_b32_b16 s63, s61, s63
    s_mov_b32 s60, s14
    s_mov_b32 s61, s15
    s_pack_ll_b32_b16 s14, s64, s66
    s_pack_hh_b32_b16 s15, s64, s66
    s_pack_ll_b32_b16 s66, s65, s67
    s_pack_hh_b32_b16 s67, s65, s67
    s_mov_b32 s64, s14
    s_mov_b32 s65, s15
    s_pack_ll_b32_b16 s14, s68, s70
    s_pack_hh_b32_b16 s15, s68, s70
    s_pack_ll_b32_b16 s70, s69, s71
    s_pack_hh_b32_b16 s71, s69, s71
    s_mov_b32 s68, s14
    s_mov_b32 s69, s15
    s_pack_ll_b32_b16 s14, s72, s74
    s_pack_hh_b32_b16 s15, s72, s74
    s_pack_ll_b32_b16 s74, s73, s75
    s_pack_hh_b32_b16 s75, s73, s75
    s_mov_b32 s72, s14
    s_mov_b32 s73, s15
    s_pack_ll_b32_b16 s14, s76, s78
    s_pack_hh_b32_b16 s15, s76, s78
    s_pack_ll_b32_b16 s78, s77, s79
    s_pack_hh_b32_b16 s79, s77, s79
    s_mov_b32 s76, s14
    s_mov_b32 s77, s15
    s_pack_ll_b32_b16 s14, s80, s82
    s_pack_hh_b32_b16 s15, s80, s82
    s_pack_ll_b32_b16 s82, s81, s83
    s_pack_hh_b32_b16 s83, s81, s83
    s_mov_b32 s80, s14
    s_mov_b32 s81, s15
    s_waitcnt vmcnt(10)
    ds_write_b128 v1, v[28:31] offset:0
    s_waitcnt vmcnt(9)
    ds_write_b128 v1, v[32:35] offset:16384
    s_waitcnt vmcnt(8)
    ds_write_b128 v1, v[36:39] offset:32768
    s_waitcnt vmcnt(7)
    ds_write_b128 v1, v[40:43] offset:49152
    ds_read_b128 v[28:31], v115 offset:0
    ds_read_b128 v[36:39], v115 offset:32
    ds_read_b128 v[32:35], v115 offset:16
    ds_read_b128 v[40:43], v115 offset:48
    ds_write_b128 v1, v[44:47] offset:0
    ds_write_b128 v1, v[44:47] offset:16384
    ds_write_b128 v1, v[44:47] offset:32768
    ds_write_b128 v1, v[44:47] offset:49152
    s_waitcnt lgkmcnt(6)
    v_mad_u32_u16 v108, v28, v50, s40 op_sel:[0,0,0,0]
    v_mad_u32_u16 v109, v36, v50, s41 op_sel:[0,0,0,0]
    v_sub_u32_sdwa v110, v109, v108 dst_sel:DWORD dst_unused:UNUSED_PAD src0_sel:WORD_1 src1_sel:WORD_1
    s_nop 1
    v_add_u32_dpp v110, v110, v110 row_shr:1 row_mask:0xf bank_mask:0xf bound_ctrl:0
    s_nop 1
    v_add_u32_dpp v110, v110, v110 row_shr:2 row_mask:0xf bank_mask:0xf bound_ctrl:0
    s_nop 1
    v_add_u32_dpp v110, v110, v110 row_shr:4 row_mask:0xf bank_mask:0xf bound_ctrl:0
    s_nop 1
    v_add_u32_dpp v110, v110, v110 row_shr:8 row_mask:0xf bank_mask:0xf bound_ctrl:0
    s_nop 1
    v_add_u32_dpp v110, v110, v110 row_bcast:15 row_mask:0xa bank_mask:0xf
    s_nop 1
    v_add_u32_dpp v110, v110, v110 row_bcast:31 row_mask:0xc bank_mask:0xf
    v_sub_u32_sdwa v109, v109, v110 dst_sel:DWORD dst_unused:UNUSED_PAD src0_sel:WORD_1 src1_sel:DWORD
    v_readlane_b32 s29, v110, 63
    v_add_u32 v110, -1, v110
    ds_write_b16 v126, v109
    v_lshlrev_b32_e64 v111, v110, 1
    v_lshrrev_b32 v110, 5, v110
    s_cmp_gt_u32 s29, 320
    s_cselect_b32 s2, 1, s2
    v_lshl_add_u32 v110, v110, 2, v127
    s_cselect_b64 exec, 0, -1
    ds_or_b32 v110, v111 offset:136
    s_mov_b64 exec, -1
    ds_wrxchg2_rtn_b32 v[108:109], v6, v5, v5 offset0:34 offset1:44
    s_waitcnt lgkmcnt(0)
    v_or_b32 v7, v108, v109
    s_nop 0
    v_readlane_b32 s30, v7, 0
    v_readlane_b32 s31, v7, 1
    v_readlane_b32 s32, v7, 2
    v_readlane_b32 s33, v7, 3
    v_readlane_b32 s34, v7, 4
    v_readlane_b32 s35, v7, 5
    v_readlane_b32 s36, v7, 6
    v_readlane_b32 s37, v7, 7
    s_mov_b32 s25, s19
    s_mov_b32 s26, s27
    s_mov_b32 s51, s28
    s_mov_b32 s28, s29
    v_mbcnt_lo_u32_b32 v8, s30, 0
    v_mbcnt_hi_u32_b32 v8, s31, v8
    s_bcnt1_i32_b64 s14, s[30:31]
    v_lshl_add_u32 v9, v8, 1, s25
    ds_read_u16 v9, v9
    s_mov_b32 s30, s26
    s_movk_i32 s31, -320
    s_lshl1_add_u32 s25, s14, s25
    s_lshl_b32 s14, s14, 12
    s_add_u32 s26, s26, s14
    v_mbcnt_lo_u32_b32 v12, s32, 0
    v_mbcnt_hi_u32_b32 v12, s33, v12
    s_bcnt1_i32_b64 s14, s[32:33]
    v_lshl_add_u32 v13, v12, 1, s25
    ds_read_u16 v13, v13
    s_mov_b32 s32, s26
    s_movk_i32 s33, -256
    s_lshl1_add_u32 s25, s14, s25
    s_lshl_b32 s14, s14, 12
    s_add_u32 s26, s26, s14
    v_mbcnt_lo_u32_b32 v16, s34, 0
    v_mbcnt_hi_u32_b32 v16, s35, v16
    s_bcnt1_i32_b64 s14, s[34:35]
    v_lshl_add_u32 v17, v16, 1, s25
    ds_read_u16 v17, v17
    s_mov_b32 s34, s26
    s_movk_i32 s35, -192
    s_lshl1_add_u32 s25, s14, s25
    s_lshl_b32 s14, s14, 12
    s_add_u32 s26, s26, s14
    v_mbcnt_lo_u32_b32 v20, s36, 0
    v_mbcnt_hi_u32_b32 v20, s37, v20
    s_bcnt1_i32_b64 s14, s[36:37]
    v_lshl_add_u32 v21, v20, 1, s25
    ds_read_u16 v21, v21
    s_mov_b32 s36, s26
    s_movk_i32 s37, -128
    s_lshl1_add_u32 s25, s14, s25
    s_lshl_b32 s14, s14, 12
    s_add_u32 s26, s26, s14
    s_waitcnt lgkmcnt(3)
    v_add3_u32 v9, v9, v2, s31
    v_lshl_add_u32 v8, v8, 8, v9
    v_lshrrev_b32 v9, 8, v9
    v_mad_u32_u24 v8, v9, s23, v8
    buffer_load_dwordx4 v[8:11], v8, s[44:47], s30 idxen
    s_waitcnt lgkmcnt(2)
    v_add3_u32 v13, v13, v2, s33
    v_lshl_add_u32 v12, v12, 8, v13
    v_lshrrev_b32 v13, 8, v13
    v_mad_u32_u24 v12, v13, s23, v12
    buffer_load_dwordx4 v[12:15], v12, s[44:47], s32 idxen
    s_waitcnt lgkmcnt(1)
    v_add3_u32 v17, v17, v2, s35
    v_lshl_add_u32 v16, v16, 8, v17
    v_lshrrev_b32 v17, 8, v17
    v_mad_u32_u24 v16, v17, s23, v16
    buffer_load_dwordx4 v[16:19], v16, s[44:47], s34 idxen
    s_waitcnt lgkmcnt(0)
    v_add3_u32 v21, v21, v2, s37
    v_lshl_add_u32 v20, v20, 8, v21
    v_lshrrev_b32 v21, 8, v21
    v_mad_u32_u24 v20, v21, s23, v20
    buffer_load_dwordx4 v[20:23], v20, s[44:47], s36 idxen
    s_cmp_le_u32 s28, 256
    s_cbranch_scc1 L_p2_kernel_noopt_1
    v_readlane_b32 s38, v7, 8
    v_readlane_b32 s39, v7, 9
    s_nop 1
    v_mbcnt_lo_u32_b32 v51, s38, 0
    v_mbcnt_hi_u32_b32 v51, s39, v51
    s_bcnt1_i32_b64 s14, s[38:39]
    v_lshl_add_u32 v55, v51, 1, s25
    ds_read_u16 v55, v55
    s_mov_b32 s38, s26
    s_movk_i32 s39, -64
    s_lshl1_add_u32 s25, s14, s25
    s_lshl_b32 s14, s14, 12
    s_add_u32 s26, s26, s14
    s_waitcnt lgkmcnt(0)
    v_add3_u32 v55, v55, v2, s39
    v_lshl_add_u32 v51, v51, 8, v55
    v_lshrrev_b32 v55, 8, v55
    v_mad_u32_u24 v51, v55, s23, v51
    buffer_load_dwordx4 v[24:27], v51, s[44:47], s38 idxen
L_p2_kernel_noopt_1:
    s_waitcnt vmcnt(6)
    ds_write_b128 v3, v[88:91] offset:0
    ds_write_b128 v3, v[92:95] offset:16384
    ds_write_b128 v3, v[96:99] offset:32768
    ds_write_b128 v3, v[100:103] offset:49152
    ds_write_b128 v124, v[104:107] offset:0
    s_waitcnt vmcnt(4)
    v_max3_u32 v64, v80, v82, v84
    v_add_f32 v65, v81, v83
    v_add_f32 v66, v85, v87
    v_max_u32 v64, v64, v86
    v_add_f32 v65, v65, v66
    v_cmp_lt_u32 vcc, 0xffff, v64
    s_nop 1
    v_max_u32_dpp v64, v64, v64 row_shr:1 row_mask:0xf bank_mask:0xf bound_ctrl:0
    s_nop 1
    v_max_u32_dpp v64, v64, v64 row_shr:2 row_mask:0xf bank_mask:0xf bound_ctrl:0
    s_nop 1
    v_max_u32_dpp v64, v64, v64 row_shr:4 row_mask:0xf bank_mask:0xf bound_ctrl:0
    s_nop 1
    v_max_u32_dpp v64, v64, v64 row_shr:8 row_mask:0xf bank_mask:0xf bound_ctrl:0
    s_nop 1
    v_max_u32_dpp v64, v64, v64 row_bcast:15 row_mask:0xa bank_mask:0xf
    s_nop 1
    v_max_u32_dpp v64, v64, v64 row_bcast:31 row_mask:0xc bank_mask:0xf
    s_nop 1
    v_add_f32_dpp v65, v65, v65 row_shr:1 row_mask:0xf bank_mask:0xf bound_ctrl:0
    s_nop 1
    v_add_f32_dpp v65, v65, v65 row_shr:2 row_mask:0xf bank_mask:0xf bound_ctrl:0
    s_nop 1
    v_add_f32_dpp v65, v65, v65 row_shr:4 row_mask:0xf bank_mask:0xf bound_ctrl:0
    s_nop 1
    v_add_f32_dpp v65, v65, v65 row_shr:8 row_mask:0xf bank_mask:0xf bound_ctrl:0
    s_nop 1
    v_add_f32_dpp v65, v65, v65 row_bcast:15 row_mask:0xa bank_mask:0xf
    s_nop 1
    v_add_f32_dpp v65, v65, v65 row_bcast:31 row_mask:0xc bank_mask:0xf
    s_cmp_lg_u64 vcc, 0
    s_cselect_b32 s2, 1, s2
    v_lshlrev_b32 v64, 16, v64
    v_mul_f32 v66, 936490775, v65
    v_mul_f32 v65, 928531664, v65
    v_cmp_nle_f32 vcc, v64, v66
    v_max_u32 v64, v64, v65
    s_nop 0
    v_readlane_b32 s14, v64, 63
    s_bitcmp1_b32 vcc_hi, 31
    s_cselect_b32 s2, 1, s2
    s_lshr_b32 s14, s14, 23
    s_add_u32 s14, s14, 1
    s_cmp_lt_u32 s14, 40
    s_cselect_b32 s2, 1, s2
    s_cmp_gt_u32 s14, 230
    s_cselect_b32 s2, 1, s2
    s_sub_u32 s48, s14, 14
    s_lshl_b32 s48, s48, 23
    s_add_u32 s16, s48, 272629760
    s_lshr_b32 s15, s16, 16
    s_sub_u32 s15, 0x10000, s15
    s_add_u32 s20, s16, s15
    s_sub_u32 s17, s20, 1
    s_mov_b32 s21, s17
    s_or_b32 s48, s48, 16416
    s_sub_u32 s14, s14, 40
    s_cmp_gt_u32 s14, 190
    s_cselect_b32 s48, 0, s48
    s_waitcnt lgkmcnt(0)
    s_barrier
    s_add_u32 s14, s22, 80000
    buffer_load_dwordx4 v[88:91], v1, s[8:11], s14 offen
    s_add_u32 s14, s22, 96384
    buffer_load_dwordx4 v[92:95], v1, s[8:11], s14 offen
    v_mad_u32_u16 v108, v28, v50, s40 op_sel:[1,0,0,0]
    v_mad_u32_u16 v109, v36, v50, s41 op_sel:[1,0,0,0]
    v_sub_u32_sdwa v110, v109, v108 dst_sel:DWORD dst_unused:UNUSED_PAD src0_sel:WORD_1 src1_sel:WORD_1
    s_nop 1
    v_add_u32_dpp v110, v110, v110 row_shr:1 row_mask:0xf bank_mask:0xf bound_ctrl:0
    s_nop 1
    v_add_u32_dpp v110, v110, v110 row_shr:2 row_mask:0xf bank_mask:0xf bound_ctrl:0
    s_nop 1
    v_add_u32_dpp v110, v110, v110 row_shr:4 row_mask:0xf bank_mask:0xf bound_ctrl:0
    s_nop 1
    v_add_u32_dpp v110, v110, v110 row_shr:8 row_mask:0xf bank_mask:0xf bound_ctrl:0
    s_nop 1
    v_add_u32_dpp v110, v110, v110 row_bcast:15 row_mask:0xa bank_mask:0xf
    s_nop 1
    v_add_u32_dpp v110, v110, v110 row_bcast:31 row_mask:0xc bank_mask:0xf
    v_sub_u32_sdwa v109, v109, v110 dst_sel:DWORD dst_unused:UNUSED_PAD src0_sel:WORD_1 src1_sel:DWORD
    v_readlane_b32 s29, v110, 63
    v_add_u32 v110, -1, v110
    ds_write_b16 v126, v109
    v_lshlrev_b32_e64 v111, v110, 1
    v_lshrrev_b32 v110, 5, v110
    s_cmp_gt_u32 s29, 320
    s_cselect_b32 s2, 1, s2
    v_lshl_add_u32 v110, v110, 2, v127
    s_cselect_b64 exec, 0, -1
    ds_or_b32 v110, v111 offset:136
    s_mov_b64 exec, -1
    ds_wrxchg2_rtn_b32 v[108:109], v6, v5, v5 offset0:34 offset1:44
    s_mov_b32 s24, 0
L_p2_loop:
    s_add_u32 s22, s22, 80000
    s_lshl_b32 s14, s13, 4
    s_or_b32 s14, s14, s24
    s_cmp_lg_u32 s14, 5
    s_cbranch_scc1 L_p2_nost
    v_mov_b32 v52, 0
    s_lshl_b32 s14, s3, 8
    s_add_u32 s14, s14, 230821888
    s_mov_b64 exec, 1
    buffer_atomic_add v52, off, s[4:7], s14 sc0
    s_mov_b64 exec, -1
L_p2_nost:
    s_waitcnt vmcnt(5)
    v_mad_u32_u16 v64, v8, 8, s18
    v_mad_u32_u16 v66, v9, 8, s18
    v_mad_u32_u16 v68, v10, 8, s18
    ds_read_b64 v[64:65], v64
    ds_read_b64 v[66:67], v66
    ds_read_b64 v[68:69], v68
    s_add_u32 s14, s22, 32768
    buffer_load_dwordx4 v[96:99], v1, s[8:11], s14 offen
    s_waitcnt vmcnt(5)
    v_mad_u32_u16 v70, v12, 8, s18
    v_mad_u32_u16 v72, v13, 8, s18
    v_mad_u32_u16 v74, v14, 8, s18
    ds_read_b64 v[70:71], v70
    ds_read_b64 v[72:73], v72
    ds_read_b64 v[74:75], v74
    s_add_u32 s14, s22, 49152
    buffer_load_dwordx4 v[100:103], v1, s[8:11], s14 offen
    s_waitcnt lgkmcnt(6)
    v_or_b32 v7, v108, v109
    s_nop 0
    v_readlane_b32 s30, v7, 0
    v_readlane_b32 s31, v7, 1
    v_readlane_b32 s32, v7, 2
    v_readlane_b32 s33, v7, 3
    v_readlane_b32 s34, v7, 4
    v_readlane_b32 s35, v7, 5
    v_readlane_b32 s36, v7, 6
    v_readlane_b32 s37, v7, 7
    s_mov_b32 s25, s19
    s_mov_b32 s26, s27
    s_mov_b32 s51, s28
    s_mov_b32 s28, s29
    v_mbcnt_lo_u32_b32 v51, s30, 0
    v_mbcnt_hi_u32_b32 v51, s31, v51
    s_bcnt1_i32_b64 s14, s[30:31]
    v_lshl_add_u32 v55, v51, 1, s25
    ds_read_u16 v55, v55
    s_mov_b32 s30, s26
    s_movk_i32 s31, -320
    s_lshl1_add_u32 s25, s14, s25
    s_lshl_b32 s14, s14, 12
    s_add_u32 s26, s26, s14
    v_bfe_i32 v108, v11, 2, 10
    v_bfe_i32 v109, v11, 12, 10
    v_ashrrev_i32 v110, 22, v11
    v_cvt_f32_i32 v108, v108
    v_cvt_f32_i32 v109, v109
    v_cvt_f32_i32 v110, v110
    s_waitcnt lgkmcnt(4)
    v_mfma_f32_4x4x4_16b_bf16 v[112:115], v[58:59], v[64:65], 0
    v_mfma_f32_4x4x4_16b_bf16 v[116:119], v[58:59], v[66:67], 0
    v_mfma_f32_4x4x4_16b_bf16 v[120:123], v[58:59], v[68:69], 0
    v_mad_u32_u16 v8, v8, 8, s50 op_sel:[1,0,0,0]
    v_mad_u32_u16 v9, v9, 8, s50 op_sel:[1,0,0,0]
    v_mad_u32_u16 v10, v10, 8, s50 op_sel:[1,0,0,0]
    v_pk_fma_f32 v[114:115], v[114:115], v[108:109], s[20:21] op_sel:[0,0,0] op_sel_hi:[1,0,1]
    v_pk_fma_f32 v[112:113], v[112:113], v[108:109], s[16:17] op_sel:[0,0,0] op_sel_hi:[1,0,1]
    v_pk_fma_f32 v[118:119], v[118:119], v[108:109], s[20:21] op_sel:[0,1,0] op_sel_hi:[1,1,1]
    v_pk_fma_f32 v[116:117], v[116:117], v[108:109], s[16:17] op_sel:[0,1,0] op_sel_hi:[1,1,1]
    v_pk_fma_f32 v[122:123], v[122:123], v[110:111], s[20:21] op_sel:[0,0,0] op_sel_hi:[1,0,1]
    v_pk_fma_f32 v[120:121], v[120:121], v[110:111], s[16:17] op_sel:[0,0,0] op_sel_hi:[1,0,1]
    v_lshlrev_b64 v[114:115], 16, v[114:115]
    v_lshlrev_b64 v[118:119], 16, v[118:119]
    v_lshlrev_b64 v[122:123], 16, v[122:123]
    v_lshl_add_u64 v[64:65], v[112:113], 0, v[114:115]
    v_lshl_add_u64 v[66:67], v[116:117], 0, v[118:119]
    v_lshl_add_u64 v[68:69], v[120:121], 0, v[122:123]
    v_or3_b32 v4, v44, v45, v4
    v_or3_b32 v4, v46, v47, v4
    v_or3_b32 v4, v48, v49, v4
    ds_add_rtn_u64 v[44:45], v8, v[64:65]
    ds_add_rtn_u64 v[46:47], v9, v[66:67]
    ds_add_rtn_u64 v[48:49], v10, v[68:69]
    s_waitcnt lgkmcnt(3)
    v_add3_u32 v55, v55, v2, s31
    v_lshl_add_u32 v51, v51, 8, v55
    v_lshrrev_b32 v55, 8, v55
    v_mad_u32_u24 v51, v55, s23, v51
    buffer_load_dwordx4 v[8:11], v51, s[44:47], s30 idxen
    s_sub_u32 s14, s22, 80000
    buffer_load_dwordx4 v[104:107], v124, s[8:11], s14 offen
    s_waitcnt vmcnt(7)
    v_mad_u32_u16 v76, v16, 8, s18
    v_mad_u32_u16 v78, v17, 8, s18
    v_mad_u32_u16 v80, v18, 8, s18
    ds_read_b64 v[76:77], v76
    ds_read_b64 v[78:79], v78
    ds_read_b64 v[80:81], v80
    s_waitcnt vmcnt(6)
    v_mad_u32_u16 v82, v20, 8, s18
    v_mad_u32_u16 v84, v21, 8, s18
    v_mad_u32_u16 v86, v22, 8, s18
    ds_read_b64 v[82:83], v82
    ds_read_b64 v[84:85], v84
    ds_read_b64 v[86:87], v86
    s_cmp_le_u32 s51, 256
    s_cbranch_scc1 L_p2_kernel_noopt3_2
    v_mad_u32_u16 v64, v24, 8, s18
    v_mad_u32_u16 v66, v25, 8, s18
    v_mad_u32_u16 v68, v26, 8, s18
    ds_read_b64 v[64:65], v64
    ds_read_b64 v[66:67], v66
    ds_read_b64 v[68:69], v68
L_p2_kernel_noopt3_2:
    v_mbcnt_lo_u32_b32 v51, s32, 0
    v_mbcnt_hi_u32_b32 v51, s33, v51
    s_bcnt1_i32_b64 s14, s[32:33]
    v_lshl_add_u32 v55, v51, 1, s25
    ds_read_u16 v55, v55
    s_mov_b32 s32, s26
    s_movk_i32 s33, -256
    s_lshl1_add_u32 s25, s14, s25
    s_lshl_b32 s14, s14, 12
    s_add_u32 s26, s26, s14
    v_bfe_i32 v108, v15, 2, 10
    v_bfe_i32 v109, v15, 12, 10
    v_ashrrev_i32 v110, 22, v15
    v_cvt_f32_i32 v108, v108
    v_cvt_f32_i32 v109, v109
    v_cvt_f32_i32 v110, v110
    v_mfma_f32_4x4x4_16b_bf16 v[112:115], v[58:59], v[70:71], 0
    v_mfma_f32_4x4x4_16b_bf16 v[116:119], v[58:59], v[72:73], 0
    v_mfma_f32_4x4x4_16b_bf16 v[120:123], v[58:59], v[74:75], 0
    v_mad_u32_u16 v12, v12, 8, s50 op_sel:[1,0,0,0]
    v_mad_u32_u16 v13, v13, 8, s50 op_sel:[1,0,0,0]
    v_mad_u32_u16 v14, v14, 8, s50 op_sel:[1,0,0,0]
    v_pk_fma_f32 v[114:115], v[114:115], v[108:109], s[20:21] op_sel:[0,0,0] op_sel_hi:[1,0,1]
    v_pk_fma_f32 v[112:113], v[112:113], v[108:109], s[16:17] op_sel:[0,0,0] op_sel_hi:[1,0,1]
    v_pk_fma_f32 v[118:119], v[118:119], v[108:109], s[20:21] op_sel:[0,1,0] op_sel_hi:[1,1,1]
    v_pk_fma_f32 v[116:117], v[116:117], v[108:109], s[16:17] op_sel:[0,1,0] op_sel_hi:[1,1,1]
    v_pk_fma_f32 v[122:123], v[122:123], v[110:111], s[20:21] op_sel:[0,0,0] op_sel_hi:[1,0,1]
    v_pk_fma_f32 v[120:121], v[120:121], v[110:111], s[16:17] op_sel:[0,0,0] op_sel_hi:[1,0,1]
    v_lshlrev_b64 v[114:115], 16, v[114:115]
    v_lshlrev_b64 v[118:119], 16, v[118:119]
    v_lshlrev_b64 v[122:123], 16, v[122:123]
    v_lshl_add_u64 v[70:71], v[112:113], 0, v[114:115]
    v_lshl_add_u64 v[72:73], v[116:117], 0, v[118:119]
    v_lshl_add_u64 v[74:75], v[120:121], 0, v[122:123]
    s_waitcnt lgkmcnt(7)
    v_or3_b32 v4, v44, v45, v4
    v_or3_b32 v4, v46, v47, v4
    v_or3_b32 v4, v48, v49, v4
    ds_add_rtn_u64 v[44:45], v12, v[70:71]
    ds_add_rtn_u64 v[46:47], v13, v[72:73]
    ds_add_rtn_u64 v[48:49], v14, v[74:75]
    s_waitcnt lgkmcnt(3)
    v_add3_u32 v55, v55, v2, s33
    v_lshl_add_u32 v51, v51, 8, v55
    v_lshrrev_b32 v55, 8, v55
    v_mad_u32_u24 v51, v55, s23, v51
    buffer_load_dwordx4 v[12:15], v51, s[44:47], s32 idxen
    s_barrier
    s_waitcnt vmcnt(1)
    ds_write_b128 v3, v[88:91] offset:0
    ds_write_b128 v3, v[92:95] offset:16384
    ds_write_b128 v3, v[96:99] offset:32768
    ds_write_b128 v3, v[100:103] offset:49152
    ds_write_b128 v124, v[104:107] offset:0
    s_cmp_lg_u32 s24, 7
    s_cbranch_scc1 L_p2_nofin
    s_mul_i32 s14, s3, 20000
    s_mul_i32 s15, s12, 4992
    s_add_u32 s14, s14, s15
    s_add_u32 s15, s14, 4096
    v_min_u32 v61, 231, v0
    v_lshl_add_u32 v60, v0, 2, s14
    v_lshl_add_u32 v61, v61, 2, s15
    global_load_dword v60, v60, s[100:101] nt
    global_load_dword v61, v61, s[100:101] nt
    s_lshl_b32 s14, s14, 2
    s_lshl_b32 s15, s15, 2
    v_min_u32 v36, 231, v0
    v_add_u32 v28, s14, v1
    v_lshl_add_u32 v36, v36, 4, s15
    global_load_dwordx4 v[28:31], v28, s[8:9]
    global_load_dwordx4 v[36:39], v36, s[8:9]
L_p2_nofin:
    v_mbcnt_lo_u32_b32 v51, s34, 0
    v_mbcnt_hi_u32_b32 v51, s35, v51
    s_bcnt1_i32_b64 s14, s[34:35]
    v_lshl_add_u32 v55, v51, 1, s25
    ds_read_u16 v55, v55
    s_mov_b32 s34, s26
    s_movk_i32 s35, -192
    s_lshl1_add_u32 s25, s14, s25
    s_lshl_b32 s14, s14, 12
    s_add_u32 s26, s26, s14
    v_bfe_i32 v108, v19, 2, 10
    v_bfe_i32 v109, v19, 12, 10
    v_ashrrev_i32 v110, 22, v19
    v_cvt_f32_i32 v108, v108
    v_cvt_f32_i32 v109, v109
    v_cvt_f32_i32 v110, v110
    v_mfma_f32_4x4x4_16b_bf16 v[112:115], v[58:59], v[76:77], 0
    v_mfma_f32_4x4x4_16b_bf16 v[116:119], v[58:59], v[78:79], 0
    v_mfma_f32_4x4x4_16b_bf16 v[120:123], v[58:59], v[80:81], 0
    v_mad_u32_u16 v16, v16, 8, s50 op_sel:[1,0,0,0]
    v_mad_u32_u16 v17, v17, 8, s50 op_sel:[1,0,0,0]
    v_mad_u32_u16 v18, v18, 8, s50 op_sel:[1,0,0,0]
    v_pk_fma_f32 v[114:115], v[114:115], v[108:109], s[20:21] op_sel:[0,0,0] op_sel_hi:[1,0,1]
    v_pk_fma_f32 v[112:113], v[112:113], v[108:109], s[16:17] op_sel:[0,0,0] op_sel_hi:[1,0,1]
    v_pk_fma_f32 v[118:119], v[118:119], v[108:109], s[20:21] op_sel:[0,1,0] op_sel_hi:[1,1,1]
    v_pk_fma_f32 v[116:117], v[116:117], v[108:109], s[16:17] op_sel:[0,1,0] op_sel_hi:[1,1,1]
    v_pk_fma_f32 v[122:123], v[122:123], v[110:111], s[20:21] op_sel:[0,0,0] op_sel_hi:[1,0,1]
    v_pk_fma_f32 v[120:121], v[120:121], v[110:111], s[16:17] op_sel:[0,0,0] op_sel_hi:[1,0,1]
    v_lshlrev_b64 v[114:115], 16, v[114:115]
    v_lshlrev_b64 v[118:119], 16, v[118:119]
    v_lshlrev_b64 v[122:123], 16, v[122:123]
    v_lshl_add_u64 v[76:77], v[112:113], 0, v[114:115]
    v_lshl_add_u64 v[78:79], v[116:117], 0, v[118:119]
    v_lshl_add_u64 v[80:81], v[120:121], 0, v[122:123]
    s_waitcnt lgkmcnt(6)
    v_or3_b32 v4, v44, v45, v4
    v_or3_b32 v4, v46, v47, v4
    v_or3_b32 v4, v48, v49, v4
    ds_add_rtn_u64 v[44:45], v16, v[76:77]
    ds_add_rtn_u64 v[46:47], v17, v[78:79]
    ds_add_rtn_u64 v[48:49], v18, v[80:81]
    s_waitcnt lgkmcnt(3)
    v_add3_u32 v55, v55, v2, s35
    v_lshl_add_u32 v51, v51, 8, v55
    v_lshrrev_b32 v55, 8, v55
    v_mad_u32_u24 v51, v55, s23, v51
    buffer_load_dwordx4 v[16:19], v51, s[44:47], s34 idxen
    s_cmp_le_u32 s51, 256
    s_cbranch_scc1 L_p2_kernel_noopt3_3
    v_bfe_i32 v108, v27, 2, 10
    v_bfe_i32 v109, v27, 12, 10
    v_ashrrev_i32 v110, 22, v27
    v_cvt_f32_i32 v108, v108
    v_cvt_f32_i32 v109, v109
    v_cvt_f32_i32 v110, v110
    v_mfma_f32_4x4x4_16b_bf16 v[112:115], v[58:59], v[64:65], 0
    v_mfma_f32_4x4x4_16b_bf16 v[116:119], v[58:59], v[66:67], 0
    v_mfma_f32_4x4x4_16b_bf16 v[120:123], v[58:59], v[68:69], 0
    v_mad_u32_u16 v24, v24, 8, s50 op_sel:[1,0,0,0]
    v_mad_u32_u16 v25, v25, 8, s50 op_sel:[1,0,0,0]
    v_mad_u32_u16 v26, v26, 8, s50 op_sel:[1,0,0,0]
    v_pk_fma_f32 v[114:115], v[114:115], v[108:109], s[20:21] op_sel:[0,0,0] op_sel_hi:[1,0,1]
    v_pk_fma_f32 v[112:113], v[112:113], v[108:109], s[16:17] op_sel:[0,0,0] op_sel_hi:[1,0,1]
    v_pk_fma_f32 v[118:119], v[118:119], v[108:109], s[20:21] op_sel:[0,1,0] op_sel_hi:[1,1,1]
    v_pk_fma_f32 v[116:117], v[116:117], v[108:109], s[16:17] op_sel:[0,1,0] op_sel_hi:[1,1,1]
    v_pk_fma_f32 v[122:123], v[122:123], v[110:111], s[20:21] op_sel:[0,0,0] op_sel_hi:[1,0,1]
    v_pk_fma_f32 v[120:121], v[120:121], v[110:111], s[16:17] op_sel:[0,0,0] op_sel_hi:[1,0,1]
    v_lshlrev_b64 v[114:115], 16, v[114:115]
    v_lshlrev_b64 v[118:119], 16, v[118:119]
    v_lshlrev_b64 v[122:123], 16, v[122:123]
    v_lshl_add_u64 v[64:65], v[112:113], 0, v[114:115]
    v_lshl_add_u64 v[66:67], v[116:117], 0, v[118:119]
    v_lshl_add_u64 v[68:69], v[120:121], 0, v[122:123]
    s_waitcnt lgkmcnt(0)
    v_or3_b32 v4, v44, v45, v4
    v_or3_b32 v4, v46, v47, v4
    v_or3_b32 v4, v48, v49, v4
    ds_add_rtn_u64 v[44:45], v24, v[64:65]
    ds_add_rtn_u64 v[46:47], v25, v[66:67]
    ds_add_rtn_u64 v[48:49], v26, v[68:69]
L_p2_kernel_noopt3_3:
    v_mbcnt_lo_u32_b32 v51, s36, 0
    v_mbcnt_hi_u32_b32 v51, s37, v51
    s_bcnt1_i32_b64 s14, s[36:37]
    v_lshl_add_u32 v55, v51, 1, s25
    ds_read_u16 v55, v55
    s_mov_b32 s36, s26
    s_movk_i32 s37, -128
    s_lshl1_add_u32 s25, s14, s25
    s_lshl_b32 s14, s14, 12
    s_add_u32 s26, s26, s14
    s_cmp_le_u32 s28, 256
    s_cbranch_scc1 L_p2_kernel_noopt3_4
    v_readlane_b32 s38, v7, 8
    v_readlane_b32 s39, v7, 9
    s_nop 1
    v_mbcnt_lo_u32_b32 v62, s38, 0
    v_mbcnt_hi_u32_b32 v62, s39, v62
    s_bcnt1_i32_b64 s14, s[38:39]
    v_lshl_add_u32 v63, v62, 1, s25
    ds_read_u16 v63, v63
    s_mov_b32 s38, s26
    s_movk_i32 s39, -64
    s_lshl1_add_u32 s25, s14, s25
    s_lshl_b32 s14, s14, 12
    s_add_u32 s26, s26, s14
L_p2_kernel_noopt3_4:
    v_bfe_i32 v108, v23, 2, 10
    v_bfe_i32 v109, v23, 12, 10
    v_ashrrev_i32 v110, 22, v23
    v_cvt_f32_i32 v108, v108
    v_cvt_f32_i32 v109, v109
    v_cvt_f32_i32 v110, v110
    v_mfma_f32_4x4x4_16b_bf16 v[112:115], v[58:59], v[82:83], 0
    v_mfma_f32_4x4x4_16b_bf16 v[116:119], v[58:59], v[84:85], 0
    v_mfma_f32_4x4x4_16b_bf16 v[120:123], v[58:59], v[86:87], 0
    v_mad_u32_u16 v20, v20, 8, s50 op_sel:[1,0,0,0]
    v_mad_u32_u16 v21, v21, 8, s50 op_sel:[1,0,0,0]
    v_mad_u32_u16 v22, v22, 8, s50 op_sel:[1,0,0,0]
    v_pk_fma_f32 v[114:115], v[114:115], v[108:109], s[20:21] op_sel:[0,0,0] op_sel_hi:[1,0,1]
    v_pk_fma_f32 v[112:113], v[112:113], v[108:109], s[16:17] op_sel:[0,0,0] op_sel_hi:[1,0,1]
    v_pk_fma_f32 v[118:119], v[118:119], v[108:109], s[20:21] op_sel:[0,1,0] op_sel_hi:[1,1,1]
    v_pk_fma_f32 v[116:117], v[116:117], v[108:109], s[16:17] op_sel:[0,1,0] op_sel_hi:[1,1,1]
    v_pk_fma_f32 v[122:123], v[122:123], v[110:111], s[20:21] op_sel:[0,0,0] op_sel_hi:[1,0,1]
    v_pk_fma_f32 v[120:121], v[120:121], v[110:111], s[16:17] op_sel:[0,0,0] op_sel_hi:[1,0,1]
    v_lshlrev_b64 v[114:115], 16, v[114:115]
    v_lshlrev_b64 v[118:119], 16, v[118:119]
    v_lshlrev_b64 v[122:123], 16, v[122:123]
    v_lshl_add_u64 v[82:83], v[112:113], 0, v[114:115]
    v_lshl_add_u64 v[84:85], v[116:117], 0, v[118:119]
    v_lshl_add_u64 v[86:87], v[120:121], 0, v[122:123]
    s_waitcnt lgkmcnt(1)
    v_or3_b32 v4, v44, v45, v4
    v_or3_b32 v4, v46, v47, v4
    v_or3_b32 v4, v48, v49, v4
    ds_add_rtn_u64 v[44:45], v20, v[82:83]
    ds_add_rtn_u64 v[46:47], v21, v[84:85]
    ds_add_rtn_u64 v[48:49], v22, v[86:87]
    s_waitcnt lgkmcnt(3)
    v_add3_u32 v55, v55, v2, s37
    v_lshl_add_u32 v51, v51, 8, v55
    v_lshrrev_b32 v55, 8, v55
    v_mad_u32_u24 v51, v55, s23, v51
    buffer_load_dwordx4 v[20:23], v51, s[44:47], s36 idxen
    s_cmp_le_u32 s28, 256
    s_cbranch_scc1 L_p2_kernel_noopt3_5
    v_add3_u32 v63, v63, v2, s39
    v_lshl_add_u32 v62, v62, 8, v63
    v_lshrrev_b32 v63, 8, v63
    v_mad_u32_u24 v62, v63, s23, v62
    buffer_load_dwordx4 v[24:27], v62, s[44:47], s38 idxen
L_p2_kernel_noopt3_5:
    s_add_u32 s14, s22, 80000
    buffer_load_dwordx4 v[88:91], v1, s[8:11], s14 offen
    s_add_u32 s14, s24, 1
    s_min_u32 s14, s14, 7
    s_set_gpr_idx_on s14, gpr_idx(SRC0)
    v_mad_u32_u16 v108, v28, v50, s40 op_sel:[0,0,0,0]
    v_mad_u32_u16 v109, v36, v50, s41 op_sel:[0,0,0,0]
    s_set_gpr_idx_off
    v_sub_u32_sdwa v110, v109, v108 dst_sel:DWORD dst_unused:UNUSED_PAD src0_sel:WORD_1 src1_sel:WORD_1
    s_nop 1
    v_add_u32_dpp v110, v110, v110 row_shr:1 row_mask:0xf bank_mask:0xf bound_ctrl:0
    s_nop 1
    v_add_u32_dpp v110, v110, v110 row_shr:2 row_mask:0xf bank_mask:0xf bound_ctrl:0
    s_nop 1
    v_add_u32_dpp v110, v110, v110 row_shr:4 row_mask:0xf bank_mask:0xf bound_ctrl:0
    s_nop 1
    v_add_u32_dpp v110, v110, v110 row_shr:8 row_mask:0xf bank_mask:0xf bound_ctrl:0
    s_nop 1
    v_add_u32_dpp v110, v110, v110 row_bcast:15 row_mask:0xa bank_mask:0xf
    s_nop 1
    v_add_u32_dpp v110, v110, v110 row_bcast:31 row_mask:0xc bank_mask:0xf
    v_sub_u32_sdwa v109, v109, v110 dst_sel:DWORD dst_unused:UNUSED_PAD src0_sel:WORD_1 src1_sel:DWORD
    v_readlane_b32 s29, v110, 63
    v_add_u32 v110, -1, v110
    ds_write_b16 v126, v109
    v_lshlrev_b32_e64 v111, v110, 1
    v_lshrrev_b32 v110, 5, v110
    s_cmp_gt_u32 s29, 320
    s_cselect_b32 s2, 1, s2
    v_lshl_add_u32 v110, v110, 2, v127
    s_cselect_b64 exec, 0, -1
    ds_or_b32 v110, v111 offset:136
    s_mov_b64 exec, -1
    ds_wrxchg2_rtn_b32 v[108:109], v6, v5, v5 offset0:34 offset1:44
    s_add_u32 s14, s22, 96384
    buffer_load_dwordx4 v[92:95], v1, s[8:11], s14 offen
    s_barrier
    s_add_u32 s22, s22, 80000
    s_cmp_eq_u32 s24, 7
    s_cselect_b32 s46, 0, s46
    v_mad_u32_u16 v64, v8, 8, s18
    v_mad_u32_u16 v66, v9, 8, s18
    v_mad_u32_u16 v68, v10, 8, s18
    ds_read_b64 v[64:65], v64
    ds_read_b64 v[66:67], v66
    ds_read_b64 v[68:69], v68
    s_add_u32 s14, s22, 32768
    buffer_load_dwordx4 v[96:99], v1, s[8:11], s14 offen
    s_waitcnt vmcnt(5)
    v_mad_u32_u16 v70, v12, 8, s18
    v_mad_u32_u16 v72, v13, 8, s18
    v_mad_u32_u16 v74, v14, 8, s18
    ds_read_b64 v[70:71], v70
    ds_read_b64 v[72:73], v72
    ds_read_b64 v[74:75], v74
    s_add_u32 s14, s22, 49152
    buffer_load_dwordx4 v[100:103], v1, s[8:11], s14 offen
    s_waitcnt lgkmcnt(6)
    v_or_b32 v7, v108, v109
    s_nop 0
    v_readlane_b32 s30, v7, 0
    v_readlane_b32 s31, v7, 1
    v_readlane_b32 s32, v7, 2
    v_readlane_b32 s33, v7, 3
    v_readlane_b32 s34, v7, 4
    v_readlane_b32 s35, v7, 5
    v_readlane_b32 s36, v7, 6
    v_readlane_b32 s37, v7, 7
    s_mov_b32 s25, s19
    s_mov_b32 s26, s27
    s_mov_b32 s51, s28
    s_mov_b32 s28, s29
    v_mbcnt_lo_u32_b32 v51, s30, 0
    v_mbcnt_hi_u32_b32 v51, s31, v51
    s_bcnt1_i32_b64 s14, s[30:31]
    v_lshl_add_u32 v55, v51, 1, s25
    ds_read_u16 v55, v55
    s_mov_b32 s30, s26
    s_movk_i32 s31, -320
    s_lshl1_add_u32 s25, s14, s25
    s_lshl_b32 s14, s14, 12
    s_add_u32 s26, s26, s14
    v_bfe_i32 v108, v11, 2, 10
    v_bfe_i32 v109, v11, 12, 10
    v_ashrrev_i32 v110, 22, v11
    v_cvt_f32_i32 v108, v108
    v_cvt_f32_i32 v109, v109
    v_cvt_f32_i32 v110, v110
    s_waitcnt lgkmcnt(4)
    v_mfma_f32_4x4x4_16b_bf16 v[112:115], v[58:59], v[64:65], 0
    v_mfma_f32_4x4x4_16b_bf16 v[116:119], v[58:59], v[66:67], 0
    v_mfma_f32_4x4x4_16b_bf16 v[120:123], v[58:59], v[68:69], 0
    v_mad_u32_u16 v8, v8, 8, s50 op_sel:[1,0,0,0]
    v_mad_u32_u16 v9, v9, 8, s50 op_sel:[1,0,0,0]
    v_mad_u32_u16 v10, v10, 8, s50 op_sel:[1,0,0,0]
    v_pk_fma_f32 v[114:115], v[114:115], v[108:109], s[20:21] op_sel:[0,0,0] op_sel_hi:[1,0,1]
    v_pk_fma_f32 v[112:113], v[112:113], v[108:109], s[16:17] op_sel:[0,0,0] op_sel_hi:[1,0,1]
    v_pk_fma_f32 v[118:119], v[118:119], v[108:109], s[20:21] op_sel:[0,1,0] op_sel_hi:[1,1,1]
    v_pk_fma_f32 v[116:117], v[116:117], v[108:109], s[16:17] op_sel:[0,1,0] op_sel_hi:[1,1,1]
    v_pk_fma_f32 v[122:123], v[122:123], v[110:111], s[20:21] op_sel:[0,0,0] op_sel_hi:[1,0,1]
    v_pk_fma_f32 v[120:121], v[120:121], v[110:111], s[16:17] op_sel:[0,0,0] op_sel_hi:[1,0,1]
    v_lshlrev_b64 v[114:115], 16, v[114:115]
    v_lshlrev_b64 v[118:119], 16, v[118:119]
    v_lshlrev_b64 v[122:123], 16, v[122:123]
    v_lshl_add_u64 v[64:65], v[112:113], 0, v[114:115]
    v_lshl_add_u64 v[66:67], v[116:117], 0, v[118:119]
    v_lshl_add_u64 v[68:69], v[120:121], 0, v[122:123]
    v_or3_b32 v4, v44, v45, v4
    v_or3_b32 v4, v46, v47, v4
    v_or3_b32 v4, v48, v49, v4
    ds_add_rtn_u64 v[44:45], v8, v[64:65]
    ds_add_rtn_u64 v[46:47], v9, v[66:67]
    ds_add_rtn_u64 v[48:49], v10, v[68:69]
    s_waitcnt lgkmcnt(3)
    v_add3_u32 v55, v55, v2, s31
    v_lshl_add_u32 v51, v51, 8, v55
    v_lshrrev_b32 v55, 8, v55
    v_mad_u32_u24 v51, v55, s23, v51
    buffer_load_dwordx4 v[8:11], v51, s[44:47], s30 idxen
    s_sub_u32 s14, s22, 80000
    buffer_load_dwordx4 v[104:107], v124, s[8:11], s14 offen
    s_waitcnt vmcnt(7)
    v_mad_u32_u16 v76, v16, 8, s18
    v_mad_u32_u16 v78, v17, 8, s18
    v_mad_u32_u16 v80, v18, 8, s18
    ds_read_b64 v[76:77], v76
    ds_read_b64 v[78:79], v78
    ds_read_b64 v[80:81], v80
    s_waitcnt vmcnt(6)
    v_mad_u32_u16 v82, v20, 8, s18
    v_mad_u32_u16 v84, v21, 8, s18
    v_mad_u32_u16 v86, v22, 8, s18
    ds_read_b64 v[82:83], v82
    ds_read_b64 v[84:85], v84
    ds_read_b64 v[86:87], v86
    s_cmp_le_u32 s51, 256
    s_cbranch_scc1 L_p2_kernel_noopt3_6
    v_mad_u32_u16 v64, v24, 8, s18
    v_mad_u32_u16 v66, v25, 8, s18
    v_mad_u32_u16 v68, v26, 8, s18
    ds_read_b64 v[64:65], v64
    ds_read_b64 v[66:67], v66
    ds_read_b64 v[68:69], v68
L_p2_kernel_noopt3_6:
    v_mbcnt_lo_u32_b32 v51, s32, 0
    v_mbcnt_hi_u32_b32 v51, s33, v51
    s_bcnt1_i32_b64 s14, s[32:33]
    v_lshl_add_u32 v55, v51, 1, s25
    ds_read_u16 v55, v55
    s_mov_b32 s32, s26
    s_movk_i32 s33, -256
    s_lshl1_add_u32 s25, s14, s25
    s_lshl_b32 s14, s14, 12
    s_add_u32 s26, s26, s14
    v_bfe_i32 v108, v15, 2, 10
    v_bfe_i32 v109, v15, 12, 10
    v_ashrrev_i32 v110, 22, v15
    v_cvt_f32_i32 v108, v108
    v_cvt_f32_i32 v109, v109
    v_cvt_f32_i32 v110, v110
    v_mfma_f32_4x4x4_16b_bf16 v[112:115], v[58:59], v[70:71], 0
    v_mfma_f32_4x4x4_16b_bf16 v[116:119], v[58:59], v[72:73], 0
    v_mfma_f32_4x4x4_16b_bf16 v[120:123], v[58:59], v[74:75], 0
    v_mad_u32_u16 v12, v12, 8, s50 op_sel:[1,0,0,0]
    v_mad_u32_u16 v13, v13, 8, s50 op_sel:[1,0,0,0]
    v_mad_u32_u16 v14, v14, 8, s50 op_sel:[1,0,0,0]
    v_pk_fma_f32 v[114:115], v[114:115], v[108:109], s[20:21] op_sel:[0,0,0] op_sel_hi:[1,0,1]
    v_pk_fma_f32 v[112:113], v[112:113], v[108:109], s[16:17] op_sel:[0,0,0] op_sel_hi:[1,0,1]
    v_pk_fma_f32 v[118:119], v[118:119], v[108:109], s[20:21] op_sel:[0,1,0] op_sel_hi:[1,1,1]
    v_pk_fma_f32 v[116:117], v[116:117], v[108:109], s[16:17] op_sel:[0,1,0] op_sel_hi:[1,1,1]
    v_pk_fma_f32 v[122:123], v[122:123], v[110:111], s[20:21] op_sel:[0,0,0] op_sel_hi:[1,0,1]
    v_pk_fma_f32 v[120:121], v[120:121], v[110:111], s[16:17] op_sel:[0,0,0] op_sel_hi:[1,0,1]
    v_lshlrev_b64 v[114:115], 16, v[114:115]
    v_lshlrev_b64 v[118:119], 16, v[118:119]
    v_lshlrev_b64 v[122:123], 16, v[122:123]
    v_lshl_add_u64 v[70:71], v[112:113], 0, v[114:115]
    v_lshl_add_u64 v[72:73], v[116:117], 0, v[118:119]
    v_lshl_add_u64 v[74:75], v[120:121], 0, v[122:123]
    s_waitcnt lgkmcnt(7)
    v_or3_b32 v4, v44, v45, v4
    v_or3_b32 v4, v46, v47, v4
    v_or3_b32 v4, v48, v49, v4
    ds_add_rtn_u64 v[44:45], v12, v[70:71]
    ds_add_rtn_u64 v[46:47], v13, v[72:73]
    ds_add_rtn_u64 v[48:49], v14, v[74:75]
    s_waitcnt lgkmcnt(3)
    v_add3_u32 v55, v55, v2, s33
    v_lshl_add_u32 v51, v51, 8, v55
    v_lshrrev_b32 v55, 8, v55
    v_mad_u32_u24 v51, v55, s23, v51
    buffer_load_dwordx4 v[12:15], v51, s[44:47], s32 idxen
    s_cmp_lg_u32 s24, 7
    s_cbranch_scc1 L_p2_stage
    s_waitcnt lgkmcnt(0)
    s_branch L_p2_staged
L_p2_stage:
    s_barrier
    s_waitcnt vmcnt(1)
    ds_write_b128 v3, v[88:91] offset:0
    ds_write_b128 v3, v[92:95] offset:16384
    ds_write_b128 v3, v[96:99] offset:32768
    ds_write_b128 v3, v[100:103] offset:49152
    ds_write_b128 v124, v[104:107] offset:0
L_p2_staged:
    v_mbcnt_lo_u32_b32 v51, s34, 0
    v_mbcnt_hi_u32_b32 v51, s35, v51
    s_bcnt1_i32_b64 s14, s[34:35]
    v_lshl_add_u32 v55, v51, 1, s25
    ds_read_u16 v55, v55
    s_mov_b32 s34, s26
    s_movk_i32 s35, -192
    s_lshl1_add_u32 s25, s14, s25
    s_lshl_b32 s14, s14, 12
    s_add_u32 s26, s26, s14
    v_bfe_i32 v108, v19, 2, 10
    v_bfe_i32 v109, v19, 12, 10
    v_ashrrev_i32 v110, 22, v19
    v_cvt_f32_i32 v108, v108
    v_cvt_f32_i32 v109, v109
    v_cvt_f32_i32 v110, v110
    v_mfma_f32_4x4x4_16b_bf16 v[112:115], v[58:59], v[76:77], 0
    v_mfma_f32_4x4x4_16b_bf16 v[116:119], v[58:59], v[78:79], 0
    v_mfma_f32_4x4x4_16b_bf16 v[120:123], v[58:59], v[80:81], 0
    v_mad_u32_u16 v16, v16, 8, s50 op_sel:[1,0,0,0]
    v_mad_u32_u16 v17, v17, 8, s50 op_sel:[1,0,0,0]
    v_mad_u32_u16 v18, v18, 8, s50 op_sel:[1,0,0,0]
    v_pk_fma_f32 v[114:115], v[114:115], v[108:109], s[20:21] op_sel:[0,0,0] op_sel_hi:[1,0,1]
    v_pk_fma_f32 v[112:113], v[112:113], v[108:109], s[16:17] op_sel:[0,0,0] op_sel_hi:[1,0,1]
    v_pk_fma_f32 v[118:119], v[118:119], v[108:109], s[20:21] op_sel:[0,1,0] op_sel_hi:[1,1,1]
    v_pk_fma_f32 v[116:117], v[116:117], v[108:109], s[16:17] op_sel:[0,1,0] op_sel_hi:[1,1,1]
    v_pk_fma_f32 v[122:123], v[122:123], v[110:111], s[20:21] op_sel:[0,0,0] op_sel_hi:[1,0,1]
    v_pk_fma_f32 v[120:121], v[120:121], v[110:111], s[16:17] op_sel:[0,0,0] op_sel_hi:[1,0,1]
    v_lshlrev_b64 v[114:115], 16, v[114:115]
    v_lshlrev_b64 v[118:119], 16, v[118:119]
    v_lshlrev_b64 v[122:123], 16, v[122:123]
    v_lshl_add_u64 v[76:77], v[112:113], 0, v[114:115]
    v_lshl_add_u64 v[78:79], v[116:117], 0, v[118:119]
    v_lshl_add_u64 v[80:81], v[120:121], 0, v[122:123]
    s_waitcnt lgkmcnt(6)
    v_or3_b32 v4, v44, v45, v4
    v_or3_b32 v4, v46, v47, v4
    v_or3_b32 v4, v48, v49, v4
    ds_add_rtn_u64 v[44:45], v16, v[76:77]
    ds_add_rtn_u64 v[46:47], v17, v[78:79]
    ds_add_rtn_u64 v[48:49], v18, v[80:81]
    s_waitcnt lgkmcnt(3)
    v_add3_u32 v55, v55, v2, s35
    v_lshl_add_u32 v51, v51, 8, v55
    v_lshrrev_b32 v55, 8, v55
    v_mad_u32_u24 v51, v55, s23, v51
    buffer_load_dwordx4 v[16:19], v51, s[44:47], s34 idxen
    s_cmp_le_u32 s51, 256
    s_cbranch_scc1 L_p2_kernel_noopt3_7
    v_bfe_i32 v108, v27, 2, 10
    v_bfe_i32 v109, v27, 12, 10
    v_ashrrev_i32 v110, 22, v27
    v_cvt_f32_i32 v108, v108
    v_cvt_f32_i32 v109, v109
    v_cvt_f32_i32 v110, v110
    v_mfma_f32_4x4x4_16b_bf16 v[112:115], v[58:59], v[64:65], 0
    v_mfma_f32_4x4x4_16b_bf16 v[116:119], v[58:59], v[66:67], 0
    v_mfma_f32_4x4x4_16b_bf16 v[120:123], v[58:59], v[68:69], 0
    v_mad_u32_u16 v24, v24, 8, s50 op_sel:[1,0,0,0]
    v_mad_u32_u16 v25, v25, 8, s50 op_sel:[1,0,0,0]
    v_mad_u32_u16 v26, v26, 8, s50 op_sel:[1,0,0,0]
    v_pk_fma_f32 v[114:115], v[114:115], v[108:109], s[20:21] op_sel:[0,0,0] op_sel_hi:[1,0,1]
    v_pk_fma_f32 v[112:113], v[112:113], v[108:109], s[16:17] op_sel:[0,0,0] op_sel_hi:[1,0,1]
    v_pk_fma_f32 v[118:119], v[118:119], v[108:109], s[20:21] op_sel:[0,1,0] op_sel_hi:[1,1,1]
    v_pk_fma_f32 v[116:117], v[116:117], v[108:109], s[16:17] op_sel:[0,1,0] op_sel_hi:[1,1,1]
    v_pk_fma_f32 v[122:123], v[122:123], v[110:111], s[20:21] op_sel:[0,0,0] op_sel_hi:[1,0,1]
    v_pk_fma_f32 v[120:121], v[120:121], v[110:111], s[16:17] op_sel:[0,0,0] op_sel_hi:[1,0,1]
    v_lshlrev_b64 v[114:115], 16, v[114:115]
    v_lshlrev_b64 v[118:119], 16, v[118:119]
    v_lshlrev_b64 v[122:123], 16, v[122:123]
    v_lshl_add_u64 v[64:65], v[112:113], 0, v[114:115]
    v_lshl_add_u64 v[66:67], v[116:117], 0, v[118:119]
    v_lshl_add_u64 v[68:69], v[120:121], 0, v[122:123]
    s_waitcnt lgkmcnt(0)
    v_or3_b32 v4, v44, v45, v4
    v_or3_b32 v4, v46, v47, v4
    v_or3_b32 v4, v48, v49, v4
    ds_add_rtn_u64 v[44:45], v24, v[64:65]
    ds_add_rtn_u64 v[46:47], v25, v[66:67]
    ds_add_rtn_u64 v[48:49], v26, v[68:69]
L_p2_kernel_noopt3_7:
    v_mbcnt_lo_u32_b32 v51, s36, 0
    v_mbcnt_hi_u32_b32 v51, s37, v51
    s_bcnt1_i32_b64 s14, s[36:37]
    v_lshl_add_u32 v55, v51, 1, s25
    ds_read_u16 v55, v55
    s_mov_b32 s36, s26
    s_movk_i32 s37, -128
    s_lshl1_add_u32 s25, s14, s25
    s_lshl_b32 s14, s14, 12
    s_add_u32 s26, s26, s14
    s_cmp_le_u32 s28, 256
    s_cbranch_scc1 L_p2_kernel_noopt3_8
    v_readlane_b32 s38, v7, 8
    v_readlane_b32 s39, v7, 9
    s_nop 1
    v_mbcnt_lo_u32_b32 v62, s38, 0
    v_mbcnt_hi_u32_b32 v62, s39, v62
    s_bcnt1_i32_b64 s14, s[38:39]
    v_lshl_add_u32 v63, v62, 1, s25
    ds_read_u16 v63, v63
    s_mov_b32 s38, s26
    s_movk_i32 s39, -64
    s_lshl1_add_u32 s25, s14, s25
    s_lshl_b32 s14, s14, 12
    s_add_u32 s26, s26, s14
L_p2_kernel_noopt3_8:
    v_bfe_i32 v108, v23, 2, 10
    v_bfe_i32 v109, v23, 12, 10
    v_ashrrev_i32 v110, 22, v23
    v_cvt_f32_i32 v108, v108
    v_cvt_f32_i32 v109, v109
    v_cvt_f32_i32 v110, v110
    v_mfma_f32_4x4x4_16b_bf16 v[112:115], v[58:59], v[82:83], 0
    v_mfma_f32_4x4x4_16b_bf16 v[116:119], v[58:59], v[84:85], 0
    v_mfma_f32_4x4x4_16b_bf16 v[120:123], v[58:59], v[86:87], 0
    v_mad_u32_u16 v20, v20, 8, s50 op_sel:[1,0,0,0]
    v_mad_u32_u16 v21, v21, 8, s50 op_sel:[1,0,0,0]
    v_mad_u32_u16 v22, v22, 8, s50 op_sel:[1,0,0,0]
    v_pk_fma_f32 v[114:115], v[114:115], v[108:109], s[20:21] op_sel:[0,0,0] op_sel_hi:[1,0,1]
    v_pk_fma_f32 v[112:113], v[112:113], v[108:109], s[16:17] op_sel:[0,0,0] op_sel_hi:[1,0,1]
    v_pk_fma_f32 v[118:119], v[118:119], v[108:109], s[20:21] op_sel:[0,1,0] op_sel_hi:[1,1,1]
    v_pk_fma_f32 v[116:117], v[116:117], v[108:109], s[16:17] op_sel:[0,1,0] op_sel_hi:[1,1,1]
    v_pk_fma_f32 v[122:123], v[122:123], v[110:111], s[20:21] op_sel:[0,0,0] op_sel_hi:[1,0,1]
    v_pk_fma_f32 v[120:121], v[120:121], v[110:111], s[16:17] op_sel:[0,0,0] op_sel_hi:[1,0,1]
    v_lshlrev_b64 v[114:115], 16, v[114:115]
    v_lshlrev_b64 v[118:119], 16, v[118:119]
    v_lshlrev_b64 v[122:123], 16, v[122:123]
    v_lshl_add_u64 v[82:83], v[112:113], 0, v[114:115]
    v_lshl_add_u64 v[84:85], v[116:117], 0, v[118:119]
    v_lshl_add_u64 v[86:87], v[120:121], 0, v[122:123]
    s_waitcnt lgkmcnt(1)
    v_or3_b32 v4, v44, v45, v4
    v_or3_b32 v4, v46, v47, v4
    v_or3_b32 v4, v48, v49, v4
    ds_add_rtn_u64 v[44:45], v20, v[82:83]
    ds_add_rtn_u64 v[46:47], v21, v[84:85]
    ds_add_rtn_u64 v[48:49], v22, v[86:87]
    s_waitcnt lgkmcnt(3)
    v_add3_u32 v55, v55, v2, s37
    v_lshl_add_u32 v51, v51, 8, v55
    v_lshrrev_b32 v55, 8, v55
    v_mad_u32_u24 v51, v55, s23, v51
    buffer_load_dwordx4 v[20:23], v51, s[44:47], s36 idxen
    s_cmp_le_u32 s28, 256
    s_cbranch_scc1 L_p2_kernel_noopt3_9
    v_add3_u32 v63, v63, v2, s39
    v_lshl_add_u32 v62, v62, 8, v63
    v_lshrrev_b32 v63, 8, v63
    v_mad_u32_u24 v62, v63, s23, v62
    buffer_load_dwordx4 v[24:27], v62, s[44:47], s38 idxen
L_p2_kernel_noopt3_9:
    s_add_u32 s14, s22, 80000
    buffer_load_dwordx4 v[88:91], v1, s[8:11], s14 offen
    s_cmp_eq_u32 s24, 7
    s_cbranch_scc1 L_p2_exit
    s_add_u32 s14, s24, 1
    s_min_u32 s14, s14, 7
    s_set_gpr_idx_on s14, gpr_idx(SRC0)
    v_mad_u32_u16 v108, v28, v50, s40 op_sel:[1,0,0,0]
    v_mad_u32_u16 v109, v36, v50, s41 op_sel:[1,0,0,0]
    s_set_gpr_idx_off
    v_sub_u32_sdwa v110, v109, v108 dst_sel:DWORD dst_unused:UNUSED_PAD src0_sel:WORD_1 src1_sel:WORD_1
    s_nop 1
    v_add_u32_dpp v110, v110, v110 row_shr:1 row_mask:0xf bank_mask:0xf bound_ctrl:0
    s_nop 1
    v_add_u32_dpp v110, v110, v110 row_shr:2 row_mask:0xf bank_mask:0xf bound_ctrl:0
    s_nop 1
    v_add_u32_dpp v110, v110, v110 row_shr:4 row_mask:0xf bank_mask:0xf bound_ctrl:0
    s_nop 1
    v_add_u32_dpp v110, v110, v110 row_shr:8 row_mask:0xf bank_mask:0xf bound_ctrl:0
    s_nop 1
    v_add_u32_dpp v110, v110, v110 row_bcast:15 row_mask:0xa bank_mask:0xf
    s_nop 1
    v_add_u32_dpp v110, v110, v110 row_bcast:31 row_mask:0xc bank_mask:0xf
    v_sub_u32_sdwa v109, v109, v110 dst_sel:DWORD dst_unused:UNUSED_PAD src0_sel:WORD_1 src1_sel:DWORD
    v_readlane_b32 s29, v110, 63
    v_add_u32 v110, -1, v110
    ds_write_b16 v126, v109
    v_lshlrev_b32_e64 v111, v110, 1
    v_lshrrev_b32 v110, 5, v110
    s_cmp_gt_u32 s29, 320
    s_cselect_b32 s2, 1, s2
    v_lshl_add_u32 v110, v110, 2, v127
    s_cselect_b64 exec, 0, -1
    ds_or_b32 v110, v111 offset:136
    s_mov_b64 exec, -1
    ds_wrxchg2_rtn_b32 v[108:109], v6, v5, v5 offset0:34 offset1:44
    s_add_u32 s14, s22, 96384
    buffer_load_dwordx4 v[92:95], v1, s[8:11], s14 offen
    s_add_u32 s24, s24, 1
    s_cmp_lt_u32 s24, 8
    s_barrier
    s_cbranch_scc1 L_p2_loop
L_p2_exit:
    s_waitcnt lgkmcnt(0)
    v_or3_b32 v4, v44, v45, v4
    v_or3_b32 v4, v46, v47, v4
    v_or3_b32 v4, v48, v49, v4
    s_mov_b32 s27, s19
    s_waitcnt vmcnt(0)
    v_mov_b64 v[64:65], v[28:29]
    v_mov_b64 v[66:67], v[30:31]
    v_mov_b64 v[68:69], v[36:37]
    v_mov_b64 v[70:71], v[38:39]
    v_mov_b32 v8, 160232
    s_cmp_lg_u32 s13, 0
    s_cselect_b64 exec, 0, 1
    ds_write_b32 v8, v52
    s_mov_b64 exec, -1
    v_subrev_u32 v6, 80000, v124
    s_mul_i32 s24, s12, 19968
    v_subrev_u32 v10, s24, v1
    v_mov_b32 v11, 0x7f000000
    s_waitcnt vmcnt(0) lgkmcnt(0)
    s_barrier
    s_cmp_lt_u32 s13, 12
    s_cbranch_scc1 L_p2_ga
L_p2_ga:
    ds_read_b32 v9, v8
    ds_read_b128 v[88:91], v1 offset:0
    ds_read_b128 v[92:95], v1 offset:16384
    ds_read_b128 v[96:99], v1 offset:32768
    ds_read_b128 v[100:103], v1 offset:49152
    ds_read_b128 v[104:107], v6
    s_mul_i32 s14, s12, 5120000
    s_mul_i32 s15, s3, 80000
    s_add_u32 s25, s14, s15
    s_add_u32 s25, s25, 230838272
    s_cmp_eq_u32 s12, 3
    s_cselect_b32 s15, 128, 0
    s_add_u32 s15, s15, 19968
    s_waitcnt lgkmcnt(5)
    v_readfirstlane_b32 s21, v9
    s_nop 0
    s_bfe_u32 s21, s21, 524296
    s_cmp_lg_u32 s21, 4
    s_cselect_b32 s21, 1, 0
    s_cselect_b32 s24, 0, s15
    v_cmp_le_u32 vcc, s24, v10
    v_add_u32 v10, 16384, v10
    s_add_u32 s14, s25, 0
    v_cndmask_b32 v12, v11, v1, vcc
    s_waitcnt lgkmcnt(4)
    buffer_store_dwordx4 v[88:91], v12, s[4:7], s14 offen sc1
    v_or3_b32 v4, v88, v89, v4
    v_or3_b32 v4, v90, v91, v4
    v_cmp_le_u32 vcc, s24, v10
    v_add_u32 v10, 16384, v10
    s_add_u32 s14, s25, 16384
    v_cndmask_b32 v12, v11, v1, vcc
    s_waitcnt lgkmcnt(3)
    buffer_store_dwordx4 v[92:95], v12, s[4:7], s14 offen sc1
    v_or3_b32 v4, v92, v93, v4
    v_or3_b32 v4, v94, v95, v4
    v_cmp_le_u32 vcc, s24, v10
    v_add_u32 v10, 16384, v10
    s_add_u32 s14, s25, 32768
    v_cndmask_b32 v12, v11, v1, vcc
    s_waitcnt lgkmcnt(2)
    buffer_store_dwordx4 v[96:99], v12, s[4:7], s14 offen sc1
    v_or3_b32 v4, v96, v97, v4
    v_or3_b32 v4, v98, v99, v4
    v_cmp_le_u32 vcc, s24, v10
    v_add_u32 v10, 16384, v10
    s_add_u32 s14, s25, 49152
    v_cndmask_b32 v12, v11, v1, vcc
    s_waitcnt lgkmcnt(1)
    buffer_store_dwordx4 v[100:103], v12, s[4:7], s14 offen sc1
    v_or3_b32 v4, v100, v101, v4
    v_or3_b32 v4, v102, v103, v4
    v_cmp_le_u32 vcc, s24, v10
    v_add_u32 v10, 16384, v10
    s_add_u32 s14, s25, 0
    v_cndmask_b32 v12, v11, v6, vcc
    s_waitcnt lgkmcnt(0)
    buffer_store_dwordx4 v[104:107], v12, s[4:7], s14 offen sc1
    v_or3_b32 v4, v104, v105, v4
    v_or3_b32 v4, v106, v107, v4
    s_load_dwordx2 s[16:17], s[0:1], 88
    s_cmp_ge_u32 s13, 12
    s_cbranch_scc1 L_p2_gb
    v_lshlrev_b32 v30, 16, v60
    v_and_b32 v31, 0xffff0000, v60
    v_lshlrev_b32 v36, 16, v53
    v_and_b32 v37, 0xffff0000, v53
    v_lshlrev_b32 v38, 16, v54
    v_and_b32 v39, 0xffff0000, v54
    v_lshlrev_b32 v40, 16, v56
    v_and_b32 v41, 0xffff0000, v56
    v_lshlrev_b32 v42, 16, v57
    v_and_b32 v43, 0xffff0000, v57
    v_pk_add_f32 v[14:15], v[30:31], v[36:37] op_sel:[0,0] op_sel_hi:[1,0] neg_lo:[0,1] neg_hi:[0,1]
    v_pk_add_f32 v[16:17], v[30:31], v[36:37] op_sel:[0,1] op_sel_hi:[1,1] neg_lo:[0,1] neg_hi:[0,1]
    v_pk_add_f32 v[18:19], v[30:31], v[38:39] op_sel:[0,0] op_sel_hi:[1,0] neg_lo:[0,1] neg_hi:[0,1]
    v_pk_add_f32 v[20:21], v[30:31], v[38:39] op_sel:[0,1] op_sel_hi:[1,1] neg_lo:[0,1] neg_hi:[0,1]
    v_pk_add_f32 v[22:23], v[30:31], v[40:41] op_sel:[0,0] op_sel_hi:[1,0] neg_lo:[0,1] neg_hi:[0,1]
    v_pk_add_f32 v[24:25], v[30:31], v[40:41] op_sel:[0,1] op_sel_hi:[1,1] neg_lo:[0,1] neg_hi:[0,1]
    v_pk_add_f32 v[26:27], v[30:31], v[42:43] op_sel:[0,0] op_sel_hi:[1,0] neg_lo:[0,1] neg_hi:[0,1]
    v_pk_add_f32 v[28:29], v[30:31], v[42:43] op_sel:[0,1] op_sel_hi:[1,1] neg_lo:[0,1] neg_hi:[0,1]
    v_cvt_pk_bf16_f32 v32, v14, v15
    v_lshlrev_b32 v14, 16, v32
    v_and_b32 v15, 0xffff0000, v32
    v_cvt_pk_bf16_f32 v32, v16, v17
    v_lshlrev_b32 v16, 16, v32
    v_and_b32 v17, 0xffff0000, v32
    v_cvt_pk_bf16_f32 v32, v18, v19
    v_lshlrev_b32 v18, 16, v32
    v_and_b32 v19, 0xffff0000, v32
    v_cvt_pk_bf16_f32 v32, v20, v21
    v_lshlrev_b32 v20, 16, v32
    v_and_b32 v21, 0xffff0000, v32
    v_cvt_pk_bf16_f32 v32, v22, v23
    v_lshlrev_b32 v22, 16, v32
    v_and_b32 v23, 0xffff0000, v32
    v_cvt_pk_bf16_f32 v32, v24, v25
    v_lshlrev_b32 v24, 16, v32
    v_and_b32 v25, 0xffff0000, v32
    v_cvt_pk_bf16_f32 v32, v26, v27
    v_lshlrev_b32 v26, 16, v32
    v_and_b32 v27, 0xffff0000, v32
    v_cvt_pk_bf16_f32 v32, v28, v29
    v_lshlrev_b32 v28, 16, v32
    v_and_b32 v29, 0xffff0000, v32
    v_pk_mul_f32 v[14:15], v[14:15], v[14:15]
    v_pk_mul_f32 v[16:17], v[16:17], v[16:17]
    v_pk_mul_f32 v[18:19], v[18:19], v[18:19]
    v_pk_mul_f32 v[20:21], v[20:21], v[20:21]
    v_pk_mul_f32 v[22:23], v[22:23], v[22:23]
    v_pk_mul_f32 v[24:25], v[24:25], v[24:25]
    v_pk_mul_f32 v[26:27], v[26:27], v[26:27]
    v_pk_mul_f32 v[28:29], v[28:29], v[28:29]
    v_cvt_pk_bf16_f32 v32, v14, v15
    v_lshlrev_b32 v14, 16, v32
    v_and_b32 v15, 0xffff0000, v32
    v_cvt_pk_bf16_f32 v32, v16, v17
    v_lshlrev_b32 v16, 16, v32
    v_and_b32 v17, 0xffff0000, v32
    v_cvt_pk_bf16_f32 v32, v18, v19
    v_lshlrev_b32 v18, 16, v32
    v_and_b32 v19, 0xffff0000, v32
    v_cvt_pk_bf16_f32 v32, v20, v21
    v_lshlrev_b32 v20, 16, v32
    v_and_b32 v21, 0xffff0000, v32
    v_cvt_pk_bf16_f32 v32, v22, v23
    v_lshlrev_b32 v22, 16, v32
    v_and_b32 v23, 0xffff0000, v32
    v_cvt_pk_bf16_f32 v32, v24, v25
    v_lshlrev_b32 v24, 16, v32
    v_and_b32 v25, 0xffff0000, v32
    v_cvt_pk_bf16_f32 v32, v26, v27
    v_lshlrev_b32 v26, 16, v32
    v_and_b32 v27, 0xffff0000, v32
    v_cvt_pk_bf16_f32 v32, v28, v29
    v_lshlrev_b32 v28, 16, v32
    v_and_b32 v29, 0xffff0000, v32
    v_mov_b32 v30, 1092616192
    v_mov_b32 v31, 0x3fb8aa3b
    v_pk_mul_f32 v[14:15], v[14:15], v[30:31] op_sel:[0,0] op_sel_hi:[1,0]
    v_pk_mul_f32 v[16:17], v[16:17], v[30:31] op_sel:[0,0] op_sel_hi:[1,0]
    v_pk_mul_f32 v[18:19], v[18:19], v[30:31] op_sel:[0,0] op_sel_hi:[1,0]
    v_pk_mul_f32 v[20:21], v[20:21], v[30:31] op_sel:[0,0] op_sel_hi:[1,0]
    v_pk_mul_f32 v[22:23], v[22:23], v[30:31] op_sel:[0,0] op_sel_hi:[1,0]
    v_pk_mul_f32 v[24:25], v[24:25], v[30:31] op_sel:[0,0] op_sel_hi:[1,0]
    v_pk_mul_f32 v[26:27], v[26:27], v[30:31] op_sel:[0,0] op_sel_hi:[1,0]
    v_pk_mul_f32 v[28:29], v[28:29], v[30:31] op_sel:[0,0] op_sel_hi:[1,0]
    v_cvt_pk_bf16_f32 v32, v14, v15
    v_lshlrev_b32 v14, 16, v32
    v_and_b32 v15, 0xffff0000, v32
    v_cvt_pk_bf16_f32 v32, v16, v17
    v_lshlrev_b32 v16, 16, v32
    v_and_b32 v17, 0xffff0000, v32
    v_cvt_pk_bf16_f32 v32, v18, v19
    v_lshlrev_b32 v18, 16, v32
    v_and_b32 v19, 0xffff0000, v32
    v_cvt_pk_bf16_f32 v32, v20, v21
    v_lshlrev_b32 v20, 16, v32
    v_and_b32 v21, 0xffff0000, v32
    v_cvt_pk_bf16_f32 v32, v22, v23
    v_lshlrev_b32 v22, 16, v32
    v_and_b32 v23, 0xffff0000, v32
    v_cvt_pk_bf16_f32 v32, v24, v25
    v_lshlrev_b32 v24, 16, v32
    v_and_b32 v25, 0xffff0000, v32
    v_cvt_pk_bf16_f32 v32, v26, v27
    v_lshlrev_b32 v26, 16, v32
    v_and_b32 v27, 0xffff0000, v32
    v_cvt_pk_bf16_f32 v32, v28, v29
    v_lshlrev_b32 v28, 16, v32
    v_and_b32 v29, 0xffff0000, v32
    v_pk_mul_f32 v[14:15], v[14:15], v[30:31] op_sel:[0,1] op_sel_hi:[1,1]
    v_pk_mul_f32 v[16:17], v[16:17], v[30:31] op_sel:[0,1] op_sel_hi:[1,1]
    v_pk_mul_f32 v[18:19], v[18:19], v[30:31] op_sel:[0,1] op_sel_hi:[1,1]
    v_pk_mul_f32 v[20:21], v[20:21], v[30:31] op_sel:[0,1] op_sel_hi:[1,1]
    v_pk_mul_f32 v[22:23], v[22:23], v[30:31] op_sel:[0,1] op_sel_hi:[1,1]
    v_pk_mul_f32 v[24:25], v[24:25], v[30:31] op_sel:[0,1] op_sel_hi:[1,1]
    v_pk_mul_f32 v[26:27], v[26:27], v[30:31] op_sel:[0,1] op_sel_hi:[1,1]
    v_pk_mul_f32 v[28:29], v[28:29], v[30:31] op_sel:[0,1] op_sel_hi:[1,1]
    v_exp_f32 v14, -v14
    v_exp_f32 v15, -v15
    v_exp_f32 v16, -v16
    v_exp_f32 v17, -v17
    v_exp_f32 v18, -v18
    v_exp_f32 v19, -v19
    v_exp_f32 v20, -v20
    v_exp_f32 v21, -v21
    v_exp_f32 v22, -v22
    v_exp_f32 v23, -v23
    v_exp_f32 v24, -v24
    v_exp_f32 v25, -v25
    v_exp_f32 v26, -v26
    v_exp_f32 v27, -v27
    v_exp_f32 v28, -v28
    v_exp_f32 v29, -v29
    v_cvt_pk_bf16_f32 v14, v14, v16
    v_cvt_pk_bf16_f32 v15, v15, v17
    v_cvt_pk_bf16_f32 v18, v18, v20
    v_cvt_pk_bf16_f32 v19, v19, v21
    v_cvt_pk_bf16_f32 v22, v22, v24
    v_cvt_pk_bf16_f32 v23, v23, v25
    v_cvt_pk_bf16_f32 v26, v26, v28
    v_cvt_pk_bf16_f32 v27, v27, v29
    v_dot2_f32_bf16 v72, v14, s68, 0
    v_dot2_f32_bf16 v73, v15, s68, 0
    v_dot2_f32_bf16 v74, v14, s69, 0
    v_dot2_f32_bf16 v75, v15, s69, 0
    v_dot2_f32_bf16 v76, v14, s70, 0
    v_dot2_f32_bf16 v77, v15, s70, 0
    v_dot2_f32_bf16 v78, v14, s71, 0
    v_dot2_f32_bf16 v79, v15, s71, 0
    v_dot2_f32_bf16 v80, v14, s52, 0
    v_dot2_f32_bf16 v81, v15, s52, 0
    v_dot2_f32_bf16 v82, v14, s53, 0
    v_dot2_f32_bf16 v83, v15, s53, 0
    v_dot2_f32_bf16 v84, v14, s54, 0
    v_dot2_f32_bf16 v85, v15, s54, 0
    v_dot2_f32_bf16 v86, v14, s55, 0
    v_dot2_f32_bf16 v87, v15, s55, 0
    v_dot2_f32_bf16 v72, v18, s72, v72
    v_dot2_f32_bf16 v73, v19, s72, v73
    v_dot2_f32_bf16 v74, v18, s73, v74
    v_dot2_f32_bf16 v75, v19, s73, v75
    v_dot2_f32_bf16 v76, v18, s74, v76
    v_dot2_f32_bf16 v77, v19, s74, v77
    v_dot2_f32_bf16 v78, v18, s75, v78
    v_dot2_f32_bf16 v79, v19, s75, v79
    v_dot2_f32_bf16 v80, v18, s56, v80
    v_dot2_f32_bf16 v81, v19, s56, v81
    v_dot2_f32_bf16 v82, v18, s57, v82
    v_dot2_f32_bf16 v83, v19, s57, v83
    v_dot2_f32_bf16 v84, v18, s58, v84
    v_dot2_f32_bf16 v85, v19, s58, v85
    v_dot2_f32_bf16 v86, v18, s59, v86
    v_dot2_f32_bf16 v87, v19, s59, v87
    v_dot2_f32_bf16 v72, v22, s76, v72
    v_dot2_f32_bf16 v73, v23, s76, v73
    v_dot2_f32_bf16 v74, v22, s77, v74
    v_dot2_f32_bf16 v75, v23, s77, v75
    v_dot2_f32_bf16 v76, v22, s78, v76
    v_dot2_f32_bf16 v77, v23, s78, v77
    v_dot2_f32_bf16 v78, v22, s79, v78
    v_dot2_f32_bf16 v79, v23, s79, v79
    v_dot2_f32_bf16 v80, v22, s60, v80
    v_dot2_f32_bf16 v81, v23, s60, v81
    v_dot2_f32_bf16 v82, v22, s61, v82
    v_dot2_f32_bf16 v83, v23, s61, v83
    v_dot2_f32_bf16 v84, v22, s62, v84
    v_dot2_f32_bf16 v85, v23, s62, v85
    v_dot2_f32_bf16 v86, v22, s63, v86
    v_dot2_f32_bf16 v87, v23, s63, v87
    v_dot2_f32_bf16 v72, v26, s80, v72
    v_dot2_f32_bf16 v73, v27, s80, v73
    v_dot2_f32_bf16 v74, v26, s81, v74
    v_dot2_f32_bf16 v75, v27, s81, v75
    v_dot2_f32_bf16 v76, v26, s82, v76
    v_dot2_f32_bf16 v77, v27, s82, v77
    v_dot2_f32_bf16 v78, v26, s83, v78
    v_dot2_f32_bf16 v79, v27, s83, v79
    v_dot2_f32_bf16 v80, v26, s64, v80
    v_dot2_f32_bf16 v81, v27, s64, v81
    v_dot2_f32_bf16 v82, v26, s65, v82
    v_dot2_f32_bf16 v83, v27, s65, v83
    v_dot2_f32_bf16 v84, v26, s66, v84
    v_dot2_f32_bf16 v85, v27, s66, v85
    v_dot2_f32_bf16 v86, v26, s67, v86
    v_dot2_f32_bf16 v87, v27, s67, v87
L_p2_gb:
    v_and_b32 v4, 0x80008000, v4
    v_cmp_ne_u32 vcc, 0, v4
    v_mov_b32 v8, s27
    v_and_b32 v10, 15, v0
    v_mul_u32_u24 v10, 240, v10
    v_add_u32 v10, 160000, v10
    s_cmp_lg_u64 vcc, 0
    s_cselect_b32 s2, 1, s2
    v_mov_b32 v9, s2
    s_mov_b64 exec, 1
    ds_write_b32 v8, v9
    s_mov_b64 exec, -1
    s_mov_b32 s49, s12
    s_mov_b32 s51, 0
    s_waitcnt vmcnt(0) lgkmcnt(0)
    s_barrier
    ds_read_b32 v9, v10
    s_mov_b32 s18, 5120000
    s_mov_b32 s19, 0x00020000
    s_waitcnt lgkmcnt(0)
    v_cmp_ne_u32 vcc, 0, v9
    s_nop 1
    s_cmp_lg_u64 vcc, 0
    s_cselect_b32 s2, 1, 0
    s_cbranch_scc1 L_p2_slow
L_p2_signal:
    v_mov_b32 v8, 160228
    s_lshl_b32 s15, s2, 4
    s_or_b32 s15, s15, s21
    s_add_u32 s14, s12, 16
    s_lshl_b32 s20, s15, s14
    s_add_u32 s20, s20, 1
    v_mov_b32 v9, s20
    s_cmp_lg_u32 s13, 15
    s_cbranch_scc1 L_p2_nosig0
    s_lshl_b32 s14, s3, 8
    s_add_u32 s14, s14, 230821888
    s_mov_b64 exec, 1
    buffer_atomic_add v9, off, s[4:7], s14 sc0
    s_mov_b64 exec, -1
L_p2_nosig0:
    s_cmp_eq_u32 s49, 3
    s_cselect_b32 s15, 8, 0
    s_add_u32 s15, s15, 224
    v_add_u32 v2, 16384, v1
    v_cmp_gt_u32 vcc, s15, v0
    s_mul_i32 s14, s3, 80000
    s_mul_i32 s26, s49, 19968
    s_add_u32 s26, s26, s14
    v_cndmask_b32 v2, 0.5, v2, vcc
    s_mov_b32 s10, 5120000
    s_lshl_b32 s28, s92, 16
    s_and_b32 s29, s92, 0xffff0000
    s_lshl_b32 s30, s93, 16
    s_and_b32 s31, s93, 0xffff0000
    s_lshl_b32 s32, s94, 16
    s_and_b32 s33, s94, 0xffff0000
    s_lshl_b32 s34, s95, 16
    s_and_b32 s35, s95, 0xffff0000
    s_lshl_b32 s36, s96, 16
    s_and_b32 s37, s96, 0xffff0000
    s_lshl_b32 s38, s97, 16
    s_and_b32 s39, s97, 0xffff0000
    s_lshl_b32 s40, s98, 16
    s_and_b32 s41, s98, 0xffff0000
    s_lshl_b32 s42, s99, 16
    s_and_b32 s43, s99, 0xffff0000
    s_and_b32 s99, s91, 0xffff0000
    s_lshl_b32 s98, s91, 16
    s_and_b32 s97, s90, 0xffff0000
    s_lshl_b32 s96, s90, 16
    s_and_b32 s95, s89, 0xffff0000
    s_lshl_b32 s94, s89, 16
    s_and_b32 s93, s88, 0xffff0000
    s_lshl_b32 s92, s88, 16
    s_and_b32 s91, s87, 0xffff0000
    s_lshl_b32 s90, s87, 16
    s_and_b32 s89, s86, 0xffff0000
    s_lshl_b32 s88, s86, 16
    s_and_b32 s87, s85, 0xffff0000
    s_lshl_b32 s86, s85, 16
    s_and_b32 s85, s84, 0xffff0000
    s_lshl_b32 s84, s84, 16
    s_mov_b32 s44, s48
    s_add_u32 s45, s48, 2281701376
    s_cmp_eq_u32 s48, 0
    s_cselect_b32 s45, 0, s45
    s_cmp_lt_u32 s13, 12
    s_cbranch_scc1 L_p2_gc
    v_lshlrev_b32 v30, 16, v60
    v_and_b32 v31, 0xffff0000, v60
    v_lshlrev_b32 v36, 16, v53
    v_and_b32 v37, 0xffff0000, v53
    v_lshlrev_b32 v38, 16, v54
    v_and_b32 v39, 0xffff0000, v54
    v_lshlrev_b32 v40, 16, v56
    v_and_b32 v41, 0xffff0000, v56
    v_lshlrev_b32 v42, 16, v57
    v_and_b32 v43, 0xffff0000, v57
    v_pk_add_f32 v[14:15], v[30:31], v[36:37] op_sel:[0,0] op_sel_hi:[1,0] neg_lo:[0,1] neg_hi:[0,1]
    v_pk_add_f32 v[16:17], v[30:31], v[36:37] op_sel:[0,1] op_sel_hi:[1,1] neg_lo:[0,1] neg_hi:[0,1]
    v_pk_add_f32 v[18:19], v[30:31], v[38:39] op_sel:[0,0] op_sel_hi:[1,0] neg_lo:[0,1] neg_hi:[0,1]
    v_pk_add_f32 v[20:21], v[30:31], v[38:39] op_sel:[0,1] op_sel_hi:[1,1] neg_lo:[0,1] neg_hi:[0,1]
    v_pk_add_f32 v[22:23], v[30:31], v[40:41] op_sel:[0,0] op_sel_hi:[1,0] neg_lo:[0,1] neg_hi:[0,1]
    v_pk_add_f32 v[24:25], v[30:31], v[40:41] op_sel:[0,1] op_sel_hi:[1,1] neg_lo:[0,1] neg_hi:[0,1]
    v_pk_add_f32 v[26:27], v[30:31], v[42:43] op_sel:[0,0] op_sel_hi:[1,0] neg_lo:[0,1] neg_hi:[0,1]
    v_pk_add_f32 v[28:29], v[30:31], v[42:43] op_sel:[0,1] op_sel_hi:[1,1] neg_lo:[0,1] neg_hi:[0,1]
    v_cvt_pk_bf16_f32 v32, v14, v15
    v_lshlrev_b32 v14, 16, v32
    v_and_b32 v15, 0xffff0000, v32
    v_cvt_pk_bf16_f32 v32, v16, v17
    v_lshlrev_b32 v16, 16, v32
    v_and_b32 v17, 0xffff0000, v32
    v_cvt_pk_bf16_f32 v32, v18, v19
    v_lshlrev_b32 v18, 16, v32
    v_and_b32 v19, 0xffff0000, v32
    v_cvt_pk_bf16_f32 v32, v20, v21
    v_lshlrev_b32 v20, 16, v32
    v_and_b32 v21, 0xffff0000, v32
    v_cvt_pk_bf16_f32 v32, v22, v23
    v_lshlrev_b32 v22, 16, v32
    v_and_b32 v23, 0xffff0000, v32
    v_cvt_pk_bf16_f32 v32, v24, v25
    v_lshlrev_b32 v24, 16, v32
    v_and_b32 v25, 0xffff0000, v32
    v_cvt_pk_bf16_f32 v32, v26, v27
    v_lshlrev_b32 v26, 16, v32
    v_and_b32 v27, 0xffff0000, v32
    v_cvt_pk_bf16_f32 v32, v28, v29
    v_lshlrev_b32 v28, 16, v32
    v_and_b32 v29, 0xffff0000, v32
    v_pk_mul_f32 v[14:15], v[14:15], v[14:15]
    v_pk_mul_f32 v[16:17], v[16:17], v[16:17]
    v_pk_mul_f32 v[18:19], v[18:19], v[18:19]
    v_pk_mul_f32 v[20:21], v[20:21], v[20:21]
    v_pk_mul_f32 v[22:23], v[22:23], v[22:23]
    v_pk_mul_f32 v[24:25], v[24:25], v[24:25]
    v_pk_mul_f32 v[26:27], v[26:27], v[26:27]
    v_pk_mul_f32 v[28:29], v[28:29], v[28:29]
    v_cvt_pk_bf16_f32 v32, v14, v15
    v_lshlrev_b32 v14, 16, v32
    v_and_b32 v15, 0xffff0000, v32
    v_cvt_pk_bf16_f32 v32, v16, v17
    v_lshlrev_b32 v16, 16, v32
    v_and_b32 v17, 0xffff0000, v32
    v_cvt_pk_bf16_f32 v32, v18, v19
    v_lshlrev_b32 v18, 16, v32
    v_and_b32 v19, 0xffff0000, v32
    v_cvt_pk_bf16_f32 v32, v20, v21
    v_lshlrev_b32 v20, 16, v32
    v_and_b32 v21, 0xffff0000, v32
    v_cvt_pk_bf16_f32 v32, v22, v23
    v_lshlrev_b32 v22, 16, v32
    v_and_b32 v23, 0xffff0000, v32
    v_cvt_pk_bf16_f32 v32, v24, v25
    v_lshlrev_b32 v24, 16, v32
    v_and_b32 v25, 0xffff0000, v32
    v_cvt_pk_bf16_f32 v32, v26, v27
    v_lshlrev_b32 v26, 16, v32
    v_and_b32 v27, 0xffff0000, v32
    v_cvt_pk_bf16_f32 v32, v28, v29
    v_lshlrev_b32 v28, 16, v32
    v_and_b32 v29, 0xffff0000, v32
    v_mov_b32 v30, 1092616192
    v_mov_b32 v31, 0x3fb8aa3b
    v_pk_mul_f32 v[14:15], v[14:15], v[30:31] op_sel:[0,0] op_sel_hi:[1,0]
    v_pk_mul_f32 v[16:17], v[16:17], v[30:31] op_sel:[0,0] op_sel_hi:[1,0]
    v_pk_mul_f32 v[18:19], v[18:19], v[30:31] op_sel:[0,0] op_sel_hi:[1,0]
    v_pk_mul_f32 v[20:21], v[20:21], v[30:31] op_sel:[0,0] op_sel_hi:[1,0]
    v_pk_mul_f32 v[22:23], v[22:23], v[30:31] op_sel:[0,0] op_sel_hi:[1,0]
    v_pk_mul_f32 v[24:25], v[24:25], v[30:31] op_sel:[0,0] op_sel_hi:[1,0]
    v_pk_mul_f32 v[26:27], v[26:27], v[30:31] op_sel:[0,0] op_sel_hi:[1,0]
    v_pk_mul_f32 v[28:29], v[28:29], v[30:31] op_sel:[0,0] op_sel_hi:[1,0]
    v_cvt_pk_bf16_f32 v32, v14, v15
    v_lshlrev_b32 v14, 16, v32
    v_and_b32 v15, 0xffff0000, v32
    v_cvt_pk_bf16_f32 v32, v16, v17
    v_lshlrev_b32 v16, 16, v32
    v_and_b32 v17, 0xffff0000, v32
    v_cvt_pk_bf16_f32 v32, v18, v19
    v_lshlrev_b32 v18, 16, v32
    v_and_b32 v19, 0xffff0000, v32
    v_cvt_pk_bf16_f32 v32, v20, v21
    v_lshlrev_b32 v20, 16, v32
    v_and_b32 v21, 0xffff0000, v32
    v_cvt_pk_bf16_f32 v32, v22, v23
    v_lshlrev_b32 v22, 16, v32
    v_and_b32 v23, 0xffff0000, v32
    v_cvt_pk_bf16_f32 v32, v24, v25
    v_lshlrev_b32 v24, 16, v32
    v_and_b32 v25, 0xffff0000, v32
    v_cvt_pk_bf16_f32 v32, v26, v27
    v_lshlrev_b32 v26, 16, v32
    v_and_b32 v27, 0xffff0000, v32
    v_cvt_pk_bf16_f32 v32, v28, v29
    v_lshlrev_b32 v28, 16, v32
    v_and_b32 v29, 0xffff0000, v32
    v_pk_mul_f32 v[14:15], v[14:15], v[30:31] op_sel:[0,1] op_sel_hi:[1,1]
    v_pk_mul_f32 v[16:17], v[16:17], v[30:31] op_sel:[0,1] op_sel_hi:[1,1]
    v_pk_mul_f32 v[18:19], v[18:19], v[30:31] op_sel:[0,1] op_sel_hi:[1,1]
    v_pk_mul_f32 v[20:21], v[20:21], v[30:31] op_sel:[0,1] op_sel_hi:[1,1]
    v_pk_mul_f32 v[22:23], v[22:23], v[30:31] op_sel:[0,1] op_sel_hi:[1,1]
    v_pk_mul_f32 v[24:25], v[24:25], v[30:31] op_sel:[0,1] op_sel_hi:[1,1]
    v_pk_mul_f32 v[26:27], v[26:27], v[30:31] op_sel:[0,1] op_sel_hi:[1,1]
    v_pk_mul_f32 v[28:29], v[28:29], v[30:31] op_sel:[0,1] op_sel_hi:[1,1]
    v_exp_f32 v14, -v14
    v_exp_f32 v15, -v15
    v_exp_f32 v16, -v16
    v_exp_f32 v17, -v17
    v_exp_f32 v18, -v18
    v_exp_f32 v19, -v19
    v_exp_f32 v20, -v20
    v_exp_f32 v21, -v21
    v_exp_f32 v22, -v22
    v_exp_f32 v23, -v23
    v_exp_f32 v24, -v24
    v_exp_f32 v25, -v25
    v_exp_f32 v26, -v26
    v_exp_f32 v27, -v27
    v_exp_f32 v28, -v28
    v_exp_f32 v29, -v29
    v_cvt_pk_bf16_f32 v14, v14, v16
    v_cvt_pk_bf16_f32 v15, v15, v17
    v_cvt_pk_bf16_f32 v18, v18, v20
    v_cvt_pk_bf16_f32 v19, v19, v21
    v_cvt_pk_bf16_f32 v22, v22, v24
    v_cvt_pk_bf16_f32 v23, v23, v25
    v_cvt_pk_bf16_f32 v26, v26, v28
    v_cvt_pk_bf16_f32 v27, v27, v29
    v_dot2_f32_bf16 v72, v14, s68, 0
    v_dot2_f32_bf16 v73, v15, s68, 0
    v_dot2_f32_bf16 v74, v14, s69, 0
    v_dot2_f32_bf16 v75, v15, s69, 0
    v_dot2_f32_bf16 v76, v14, s70, 0
    v_dot2_f32_bf16 v77, v15, s70, 0
    v_dot2_f32_bf16 v78, v14, s71, 0
    v_dot2_f32_bf16 v79, v15, s71, 0
    v_dot2_f32_bf16 v80, v14, s52, 0
    v_dot2_f32_bf16 v81, v15, s52, 0
    v_dot2_f32_bf16 v82, v14, s53, 0
    v_dot2_f32_bf16 v83, v15, s53, 0
    v_dot2_f32_bf16 v84, v14, s54, 0
    v_dot2_f32_bf16 v85, v15, s54, 0
    v_dot2_f32_bf16 v86, v14, s55, 0
    v_dot2_f32_bf16 v87, v15, s55, 0
    v_dot2_f32_bf16 v72, v18, s72, v72
    v_dot2_f32_bf16 v73, v19, s72, v73
    v_dot2_f32_bf16 v74, v18, s73, v74
    v_dot2_f32_bf16 v75, v19, s73, v75
    v_dot2_f32_bf16 v76, v18, s74, v76
    v_dot2_f32_bf16 v77, v19, s74, v77
    v_dot2_f32_bf16 v78, v18, s75, v78
    v_dot2_f32_bf16 v79, v19, s75, v79
    v_dot2_f32_bf16 v80, v18, s56, v80
    v_dot2_f32_bf16 v81, v19, s56, v81
    v_dot2_f32_bf16 v82, v18, s57, v82
    v_dot2_f32_bf16 v83, v19, s57, v83
    v_dot2_f32_bf16 v84, v18, s58, v84
    v_dot2_f32_bf16 v85, v19, s58, v85
    v_dot2_f32_bf16 v86, v18, s59, v86
    v_dot2_f32_bf16 v87, v19, s59, v87
    v_dot2_f32_bf16 v72, v22, s76, v72
    v_dot2_f32_bf16 v73, v23, s76, v73
    v_dot2_f32_bf16 v74, v22, s77, v74
    v_dot2_f32_bf16 v75, v23, s77, v75
    v_dot2_f32_bf16 v76, v22, s78, v76
    v_dot2_f32_bf16 v77, v23, s78, v77
    v_dot2_f32_bf16 v78, v22, s79, v78
    v_dot2_f32_bf16 v79, v23, s79, v79
    v_dot2_f32_bf16 v80, v22, s60, v80
    v_dot2_f32_bf16 v81, v23, s60, v81
    v_dot2_f32_bf16 v82, v22, s61, v82
    v_dot2_f32_bf16 v83, v23, s61, v83
    v_dot2_f32_bf16 v84, v22, s62, v84
    v_dot2_f32_bf16 v85, v23, s62, v85
    v_dot2_f32_bf16 v86, v22, s63, v86
    v_dot2_f32_bf16 v87, v23, s63, v87
    v_dot2_f32_bf16 v72, v26, s80, v72
    v_dot2_f32_bf16 v73, v27, s80, v73
    v_dot2_f32_bf16 v74, v26, s81, v74
    v_dot2_f32_bf16 v75, v27, s81, v75
    v_dot2_f32_bf16 v76, v26, s82, v76
    v_dot2_f32_bf16 v77, v27, s82, v77
    v_dot2_f32_bf16 v78, v26, s83, v78
    v_dot2_f32_bf16 v79, v27, s83, v79
    v_dot2_f32_bf16 v80, v26, s64, v80
    v_dot2_f32_bf16 v81, v27, s64, v81
    v_dot2_f32_bf16 v82, v26, s65, v82
    v_dot2_f32_bf16 v83, v27, s65, v83
    v_dot2_f32_bf16 v84, v26, s66, v84
    v_dot2_f32_bf16 v85, v27, s66, v85
    v_dot2_f32_bf16 v86, v26, s67, v86
    v_dot2_f32_bf16 v87, v27, s67, v87
L_p2_gc:
    s_cmp_ge_u32 s13, 4
    s_cbranch_scc1 L_p2_gd
    v_lshlrev_b32 v30, 16, v61
    v_and_b32 v31, 0xffff0000, v61
    v_pk_add_f32 v[14:15], v[30:31], v[36:37] op_sel:[0,0] op_sel_hi:[1,0] neg_lo:[0,1] neg_hi:[0,1]
    v_pk_add_f32 v[16:17], v[30:31], v[36:37] op_sel:[0,1] op_sel_hi:[1,1] neg_lo:[0,1] neg_hi:[0,1]
    v_pk_add_f32 v[18:19], v[30:31], v[38:39] op_sel:[0,0] op_sel_hi:[1,0] neg_lo:[0,1] neg_hi:[0,1]
    v_pk_add_f32 v[20:21], v[30:31], v[38:39] op_sel:[0,1] op_sel_hi:[1,1] neg_lo:[0,1] neg_hi:[0,1]
    v_pk_add_f32 v[22:23], v[30:31], v[40:41] op_sel:[0,0] op_sel_hi:[1,0] neg_lo:[0,1] neg_hi:[0,1]
    v_pk_add_f32 v[24:25], v[30:31], v[40:41] op_sel:[0,1] op_sel_hi:[1,1] neg_lo:[0,1] neg_hi:[0,1]
    v_pk_add_f32 v[26:27], v[30:31], v[42:43] op_sel:[0,0] op_sel_hi:[1,0] neg_lo:[0,1] neg_hi:[0,1]
    v_pk_add_f32 v[28:29], v[30:31], v[42:43] op_sel:[0,1] op_sel_hi:[1,1] neg_lo:[0,1] neg_hi:[0,1]
    v_cvt_pk_bf16_f32 v32, v14, v15
    v_lshlrev_b32 v14, 16, v32
    v_and_b32 v15, 0xffff0000, v32
    v_cvt_pk_bf16_f32 v32, v16, v17
    v_lshlrev_b32 v16, 16, v32
    v_and_b32 v17, 0xffff0000, v32
    v_cvt_pk_bf16_f32 v32, v18, v19
    v_lshlrev_b32 v18, 16, v32
    v_and_b32 v19, 0xffff0000, v32
    v_cvt_pk_bf16_f32 v32, v20, v21
    v_lshlrev_b32 v20, 16, v32
    v_and_b32 v21, 0xffff0000, v32
    v_cvt_pk_bf16_f32 v32, v22, v23
    v_lshlrev_b32 v22, 16, v32
    v_and_b32 v23, 0xffff0000, v32
    v_cvt_pk_bf16_f32 v32, v24, v25
    v_lshlrev_b32 v24, 16, v32
    v_and_b32 v25, 0xffff0000, v32
    v_cvt_pk_bf16_f32 v32, v26, v27
    v_lshlrev_b32 v26, 16, v32
    v_and_b32 v27, 0xffff0000, v32
    v_cvt_pk_bf16_f32 v32, v28, v29
    v_lshlrev_b32 v28, 16, v32
    v_and_b32 v29, 0xffff0000, v32
    v_pk_mul_f32 v[14:15], v[14:15], v[14:15]
    v_pk_mul_f32 v[16:17], v[16:17], v[16:17]
    v_pk_mul_f32 v[18:19], v[18:19], v[18:19]
    v_pk_mul_f32 v[20:21], v[20:21], v[20:21]
    v_pk_mul_f32 v[22:23], v[22:23], v[22:23]
    v_pk_mul_f32 v[24:25], v[24:25], v[24:25]
    v_pk_mul_f32 v[26:27], v[26:27], v[26:27]
    v_pk_mul_f32 v[28:29], v[28:29], v[28:29]
    v_cvt_pk_bf16_f32 v32, v14, v15
    v_lshlrev_b32 v14, 16, v32
    v_and_b32 v15, 0xffff0000, v32
    v_cvt_pk_bf16_f32 v32, v16, v17
    v_lshlrev_b32 v16, 16, v32
    v_and_b32 v17, 0xffff0000, v32
    v_cvt_pk_bf16_f32 v32, v18, v19
    v_lshlrev_b32 v18, 16, v32
    v_and_b32 v19, 0xffff0000, v32
    v_cvt_pk_bf16_f32 v32, v20, v21
    v_lshlrev_b32 v20, 16, v32
    v_and_b32 v21, 0xffff0000, v32
    v_cvt_pk_bf16_f32 v32, v22, v23
    v_lshlrev_b32 v22, 16, v32
    v_and_b32 v23, 0xffff0000, v32
    v_cvt_pk_bf16_f32 v32, v24, v25
    v_lshlrev_b32 v24, 16, v32
    v_and_b32 v25, 0xffff0000, v32
    v_cvt_pk_bf16_f32 v32, v26, v27
    v_lshlrev_b32 v26, 16, v32
    v_and_b32 v27, 0xffff0000, v32
    v_cvt_pk_bf16_f32 v32, v28, v29
    v_lshlrev_b32 v28, 16, v32
    v_and_b32 v29, 0xffff0000, v32
    v_mov_b32 v30, 1092616192
    v_mov_b32 v31, 0x3fb8aa3b
    v_pk_mul_f32 v[14:15], v[14:15], v[30:31] op_sel:[0,0] op_sel_hi:[1,0]
    v_pk_mul_f32 v[16:17], v[16:17], v[30:31] op_sel:[0,0] op_sel_hi:[1,0]
    v_pk_mul_f32 v[18:19], v[18:19], v[30:31] op_sel:[0,0] op_sel_hi:[1,0]
    v_pk_mul_f32 v[20:21], v[20:21], v[30:31] op_sel:[0,0] op_sel_hi:[1,0]
    v_pk_mul_f32 v[22:23], v[22:23], v[30:31] op_sel:[0,0] op_sel_hi:[1,0]
    v_pk_mul_f32 v[24:25], v[24:25], v[30:31] op_sel:[0,0] op_sel_hi:[1,0]
    v_pk_mul_f32 v[26:27], v[26:27], v[30:31] op_sel:[0,0] op_sel_hi:[1,0]
    v_pk_mul_f32 v[28:29], v[28:29], v[30:31] op_sel:[0,0] op_sel_hi:[1,0]
    v_cvt_pk_bf16_f32 v32, v14, v15
    v_lshlrev_b32 v14, 16, v32
    v_and_b32 v15, 0xffff0000, v32
    v_cvt_pk_bf16_f32 v32, v16, v17
    v_lshlrev_b32 v16, 16, v32
    v_and_b32 v17, 0xffff0000, v32
    v_cvt_pk_bf16_f32 v32, v18, v19
    v_lshlrev_b32 v18, 16, v32
    v_and_b32 v19, 0xffff0000, v32
    v_cvt_pk_bf16_f32 v32, v20, v21
    v_lshlrev_b32 v20, 16, v32
    v_and_b32 v21, 0xffff0000, v32
    v_cvt_pk_bf16_f32 v32, v22, v23
    v_lshlrev_b32 v22, 16, v32
    v_and_b32 v23, 0xffff0000, v32
    v_cvt_pk_bf16_f32 v32, v24, v25
    v_lshlrev_b32 v24, 16, v32
    v_and_b32 v25, 0xffff0000, v32
    v_cvt_pk_bf16_f32 v32, v26, v27
    v_lshlrev_b32 v26, 16, v32
    v_and_b32 v27, 0xffff0000, v32
    v_cvt_pk_bf16_f32 v32, v28, v29
    v_lshlrev_b32 v28, 16, v32
    v_and_b32 v29, 0xffff0000, v32
    v_pk_mul_f32 v[14:15], v[14:15], v[30:31] op_sel:[0,1] op_sel_hi:[1,1]
    v_pk_mul_f32 v[16:17], v[16:17], v[30:31] op_sel:[0,1] op_sel_hi:[1,1]
    v_pk_mul_f32 v[18:19], v[18:19], v[30:31] op_sel:[0,1] op_sel_hi:[1,1]
    v_pk_mul_f32 v[20:21], v[20:21], v[30:31] op_sel:[0,1] op_sel_hi:[1,1]
    v_pk_mul_f32 v[22:23], v[22:23], v[30:31] op_sel:[0,1] op_sel_hi:[1,1]
    v_pk_mul_f32 v[24:25], v[24:25], v[30:31] op_sel:[0,1] op_sel_hi:[1,1]
    v_pk_mul_f32 v[26:27], v[26:27], v[30:31] op_sel:[0,1] op_sel_hi:[1,1]
    v_pk_mul_f32 v[28:29], v[28:29], v[30:31] op_sel:[0,1] op_sel_hi:[1,1]
    v_exp_f32 v14, -v14
    v_exp_f32 v15, -v15
    v_exp_f32 v16, -v16
    v_exp_f32 v17, -v17
    v_exp_f32 v18, -v18
    v_exp_f32 v19, -v19
    v_exp_f32 v20, -v20
    v_exp_f32 v21, -v21
    v_exp_f32 v22, -v22
    v_exp_f32 v23, -v23
    v_exp_f32 v24, -v24
    v_exp_f32 v25, -v25
    v_exp_f32 v26, -v26
    v_exp_f32 v27, -v27
    v_exp_f32 v28, -v28
    v_exp_f32 v29, -v29
    v_cvt_pk_bf16_f32 v14, v14, v16
    v_cvt_pk_bf16_f32 v15, v15, v17
    v_cvt_pk_bf16_f32 v18, v18, v20
    v_cvt_pk_bf16_f32 v19, v19, v21
    v_cvt_pk_bf16_f32 v22, v22, v24
    v_cvt_pk_bf16_f32 v23, v23, v25
    v_cvt_pk_bf16_f32 v26, v26, v28
    v_cvt_pk_bf16_f32 v27, v27, v29
    v_dot2_f32_bf16 v112, v14, s68, 0
    v_dot2_f32_bf16 v113, v15, s68, 0
    v_dot2_f32_bf16 v114, v14, s69, 0
    v_dot2_f32_bf16 v115, v15, s69, 0
    v_dot2_f32_bf16 v116, v14, s70, 0
    v_dot2_f32_bf16 v117, v15, s70, 0
    v_dot2_f32_bf16 v118, v14, s71, 0
    v_dot2_f32_bf16 v119, v15, s71, 0
    v_dot2_f32_bf16 v120, v14, s52, 0
    v_dot2_f32_bf16 v121, v15, s52, 0
    v_dot2_f32_bf16 v122, v14, s53, 0
    v_dot2_f32_bf16 v123, v15, s53, 0
    v_dot2_f32_bf16 v124, v14, s54, 0
    v_dot2_f32_bf16 v125, v15, s54, 0
    v_dot2_f32_bf16 v126, v14, s55, 0
    v_dot2_f32_bf16 v127, v15, s55, 0
    v_dot2_f32_bf16 v112, v18, s72, v112
    v_dot2_f32_bf16 v113, v19, s72, v113
    v_dot2_f32_bf16 v114, v18, s73, v114
    v_dot2_f32_bf16 v115, v19, s73, v115
    v_dot2_f32_bf16 v116, v18, s74, v116
    v_dot2_f32_bf16 v117, v19, s74, v117
    v_dot2_f32_bf16 v118, v18, s75, v118
    v_dot2_f32_bf16 v119, v19, s75, v119
    v_dot2_f32_bf16 v120, v18, s56, v120
    v_dot2_f32_bf16 v121, v19, s56, v121
    v_dot2_f32_bf16 v122, v18, s57, v122
    v_dot2_f32_bf16 v123, v19, s57, v123
    v_dot2_f32_bf16 v124, v18, s58, v124
    v_dot2_f32_bf16 v125, v19, s58, v125
    v_dot2_f32_bf16 v126, v18, s59, v126
    v_dot2_f32_bf16 v127, v19, s59, v127
    v_dot2_f32_bf16 v112, v22, s76, v112
    v_dot2_f32_bf16 v113, v23, s76, v113
    v_dot2_f32_bf16 v114, v22, s77, v114
    v_dot2_f32_bf16 v115, v23, s77, v115
    v_dot2_f32_bf16 v116, v22, s78, v116
    v_dot2_f32_bf16 v117, v23, s78, v117
    v_dot2_f32_bf16 v118, v22, s79, v118
    v_dot2_f32_bf16 v119, v23, s79, v119
    v_dot2_f32_bf16 v120, v22, s60, v120
    v_dot2_f32_bf16 v121, v23, s60, v121
    v_dot2_f32_bf16 v122, v22, s61, v122
    v_dot2_f32_bf16 v123, v23, s61, v123
    v_dot2_f32_bf16 v124, v22, s62, v124
    v_dot2_f32_bf16 v125, v23, s62, v125
    v_dot2_f32_bf16 v126, v22, s63, v126
    v_dot2_f32_bf16 v127, v23, s63, v127
    v_dot2_f32_bf16 v112, v26, s80, v112
    v_dot2_f32_bf16 v113, v27, s80, v113
    v_dot2_f32_bf16 v114, v26, s81, v114
    v_dot2_f32_bf16 v115, v27, s81, v115
    v_dot2_f32_bf16 v116, v26, s82, v116
    v_dot2_f32_bf16 v117, v27, s82, v117
    v_dot2_f32_bf16 v118, v26, s83, v118
    v_dot2_f32_bf16 v119, v27, s83, v119
    v_dot2_f32_bf16 v120, v26, s64, v120
    v_dot2_f32_bf16 v121, v27, s64, v121
    v_dot2_f32_bf16 v122, v26, s65, v122
    v_dot2_f32_bf16 v123, v27, s65, v123
    v_dot2_f32_bf16 v124, v26, s66, v124
    v_dot2_f32_bf16 v125, v27, s66, v125
    v_dot2_f32_bf16 v126, v26, s67, v126
    v_dot2_f32_bf16 v127, v27, s67, v127
L_p2_gd:
    s_cmp_lg_u32 s13, 15
    s_cbranch_scc1 L_p2_nosig
    s_waitcnt vmcnt(0)
    v_readfirstlane_b32 s15, v9
    s_lshl_b32 s51, 1, s12
    s_add_u32 s20, s20, s15
    s_and_b32 s15, s20, 0xff
    s_cmp_eq_u32 s15, 4
    s_cbranch_scc0 L_p2_notlast
    s_bfe_u32 s15, s20, 262160
    s_or_b32 s51, s51, s15
    s_branch L_p2_pub
L_p2_notlast:
    s_cmp_lg_u32 s21, 0
    s_cselect_b32 s51, 0, s51
    s_cbranch_scc1 L_p2_pub
L_p2_poll:
    v_mov_b32 v9, 0
    s_lshl_b32 s14, s3, 8
    s_add_u32 s14, s14, 230821888
    s_mov_b64 exec, 1
    buffer_atomic_add v9, off, s[4:7], s14 sc0
    s_mov_b64 exec, -1
    s_waitcnt vmcnt(0)
    v_readfirstlane_b32 s20, v9
    s_nop 0
    s_and_b32 s15, s20, 0xff
    s_cmp_lt_u32 s15, 4
    s_cbranch_scc1 L_p2_poll
L_p2_pub:
    s_lshl_b32 s15, s51, 24
    s_or_b32 s15, s15, s20
    v_mov_b32 v9, s15
    s_mov_b64 exec, 1
    ds_write_b32 v8, v9
    s_mov_b64 exec, -1
    s_waitcnt lgkmcnt(0)
L_p2_nosig:
    s_barrier
    ds_read_b32 v9, v8
    s_waitcnt lgkmcnt(0)
    v_readfirstlane_b32 s20, v9
    s_nop 0
    s_lshr_b32 s51, s20, 24
    s_cbranch_scc0 L_p2_end
L_p2_fin:
    s_mul_i32 s24, s49, 19968
    s_add_u32 s14, s12, 1
    s_and_b32 s14, s14, 3
    s_mul_i32 s15, s14, 5120000
    s_add_u32 s15, s15, 230838272
    s_add_u32 s15, s15, s26
    buffer_load_dwordx4 v[12:15], v1, s[4:7], s15 offen sc1
    buffer_load_dwordx4 v[92:95], v2, s[4:7], s15 offen sc1
    s_add_u32 s14, s12, 2
    s_and_b32 s14, s14, 3
    s_mul_i32 s15, s14, 5120000
    s_add_u32 s15, s15, 230838272
    s_add_u32 s15, s15, s26
    buffer_load_dwordx4 v[16:19], v1, s[4:7], s15 offen sc1
    buffer_load_dwordx4 v[96:99], v2, s[4:7], s15 offen sc1
    s_add_u32 s14, s12, 3
    s_and_b32 s14, s14, 3
    s_mul_i32 s15, s14, 5120000
    s_add_u32 s15, s15, 230838272
    s_add_u32 s15, s15, s26
    buffer_load_dwordx4 v[20:23], v1, s[4:7], s15 offen sc1
    buffer_load_dwordx4 v[100:103], v2, s[4:7], s15 offen sc1
    v_add_u32 v24, s24, v1
    ds_read_b128 v[8:11], v24
    v_add_u32 v25, s24, v2
    ds_read_b128 v[88:91], v25
    s_waitcnt vmcnt(0) lgkmcnt(0)
    s_bfe_u32 s14, s20, 262164
    s_cbranch_scc0 L_p2_kernel_nof32a_10
    s_add_u32 s14, s12, 0
    s_and_b32 s14, s14, 3
    s_add_u32 s14, s14, 20
    s_bitcmp1_b32 s20, s14
    s_cbranch_scc0 L_p2_kernel_q_11
    v_mov_b32 v8, 1073758208
    v_mov_b32 v9, 1073758208
    v_mov_b32 v10, 1073758208
    v_mov_b32 v11, 1073758208
L_p2_kernel_q_11:
    s_add_u32 s14, s12, 1
    s_and_b32 s14, s14, 3
    s_add_u32 s14, s14, 20
    s_bitcmp1_b32 s20, s14
    s_cbranch_scc0 L_p2_kernel_q_12
    v_mov_b32 v12, 1073758208
    v_mov_b32 v13, 1073758208
    v_mov_b32 v14, 1073758208
    v_mov_b32 v15, 1073758208
L_p2_kernel_q_12:
    s_add_u32 s14, s12, 2
    s_and_b32 s14, s14, 3
    s_add_u32 s14, s14, 20
    s_bitcmp1_b32 s20, s14
    s_cbranch_scc0 L_p2_kernel_q_13
    v_mov_b32 v16, 1073758208
    v_mov_b32 v17, 1073758208
    v_mov_b32 v18, 1073758208
    v_mov_b32 v19, 1073758208
L_p2_kernel_q_13:
    s_add_u32 s14, s12, 3
    s_and_b32 s14, s14, 3
    s_add_u32 s14, s14, 20
    s_bitcmp1_b32 s20, s14
    s_cbranch_scc0 L_p2_kernel_q_14
    v_mov_b32 v20, 1073758208
    v_mov_b32 v21, 1073758208
    v_mov_b32 v22, 1073758208
    v_mov_b32 v23, 1073758208
L_p2_kernel_q_14:
L_p2_kernel_nof32a_10:
    v_pk_add_u16 v8, v8, v12
    v_pk_add_u16 v16, v16, v20
    v_pk_add_u16 v9, v9, v13
    v_pk_add_u16 v17, v17, v21
    v_pk_add_u16 v10, v10, v14
    v_pk_add_u16 v18, v18, v22
    v_pk_add_u16 v11, v11, v15
    v_pk_add_u16 v19, v19, v23
    v_add_u32_sdwa v24, v8, v16 dst_sel:DWORD dst_unused:UNUSED_PAD src0_sel:WORD_0 src1_sel:WORD_0
    v_add_u32_sdwa v25, v10, v18 dst_sel:DWORD dst_unused:UNUSED_PAD src0_sel:WORD_0 src1_sel:WORD_0
    v_add_u32_sdwa v26, v8, v16 dst_sel:DWORD dst_unused:UNUSED_PAD src0_sel:WORD_1 src1_sel:WORD_1
    v_add_u32_sdwa v27, v10, v18 dst_sel:DWORD dst_unused:UNUSED_PAD src0_sel:WORD_1 src1_sel:WORD_1
    v_add_u32_sdwa v28, v9, v17 dst_sel:DWORD dst_unused:UNUSED_PAD src0_sel:WORD_0 src1_sel:WORD_0
    v_add_u32_sdwa v29, v11, v19 dst_sel:DWORD dst_unused:UNUSED_PAD src0_sel:WORD_0 src1_sel:WORD_0
    v_add_u32_sdwa v30, v9, v17 dst_sel:DWORD dst_unused:UNUSED_PAD src0_sel:WORD_1 src1_sel:WORD_1
    v_add_u32_sdwa v31, v11, v19 dst_sel:DWORD dst_unused:UNUSED_PAD src0_sel:WORD_1 src1_sel:WORD_1
    v_cvt_f32_u32 v24, v24
    v_cvt_f32_u32 v25, v25
    v_cvt_f32_u32 v26, v26
    v_cvt_f32_u32 v27, v27
    v_cvt_f32_u32 v28, v28
    v_cvt_f32_u32 v29, v29
    v_cvt_f32_u32 v30, v30
    v_cvt_f32_u32 v31, v31
    v_pk_fma_f32 v[24:25], v[24:25], s[44:45], s[44:45] op_sel:[0,0,1] op_sel_hi:[1,0,1]
    v_pk_fma_f32 v[26:27], v[26:27], s[44:45], s[44:45] op_sel:[0,0,1] op_sel_hi:[1,0,1]
    v_pk_fma_f32 v[28:29], v[28:29], s[44:45], s[44:45] op_sel:[0,0,1] op_sel_hi:[1,0,1]
    v_pk_fma_f32 v[30:31], v[30:31], s[44:45], s[44:45] op_sel:[0,0,1] op_sel_hi:[1,0,1]
    s_bfe_u32 s14, s20, 262164
    s_cbranch_scc0 L_p2_kernel_nof32b_15
    v_lshlrev_b32 v32, 1, v1
    s_bitcmp1_b32 s20, 20
    s_cbranch_scc0 L_p2_kernel_q_16
    s_lshl_b32 s15, s26, 1
    s_add_u32 s15, s15, 251318272
    buffer_load_dwordx4 v[8:11], v32, s[4:7], s15 offen sc1
    buffer_load_dwordx4 v[12:15], v32, s[4:7], s15 offen offset:16 sc1
    s_waitcnt vmcnt(0)
    v_add_f32 v24, v24, v8
    v_add_f32 v25, v25, v12
    v_add_f32 v26, v26, v9
    v_add_f32 v27, v27, v13
    v_add_f32 v28, v28, v10
    v_add_f32 v29, v29, v14
    v_add_f32 v30, v30, v11
    v_add_f32 v31, v31, v15
L_p2_kernel_q_16:
    s_bitcmp1_b32 s20, 21
    s_cbranch_scc0 L_p2_kernel_q_17
    s_lshl_b32 s15, s26, 1
    s_add_u32 s15, s15, 261558272
    buffer_load_dwordx4 v[8:11], v32, s[4:7], s15 offen sc1
    buffer_load_dwordx4 v[12:15], v32, s[4:7], s15 offen offset:16 sc1
    s_waitcnt vmcnt(0)
    v_add_f32 v24, v24, v8
    v_add_f32 v25, v25, v12
    v_add_f32 v26, v26, v9
    v_add_f32 v27, v27, v13
    v_add_f32 v28, v28, v10
    v_add_f32 v29, v29, v14
    v_add_f32 v30, v30, v11
    v_add_f32 v31, v31, v15
L_p2_kernel_q_17:
    s_bitcmp1_b32 s20, 22
    s_cbranch_scc0 L_p2_kernel_q_18
    s_lshl_b32 s15, s26, 1
    s_add_u32 s15, s15, 271798272
    buffer_load_dwordx4 v[8:11], v32, s[4:7], s15 offen sc1
    buffer_load_dwordx4 v[12:15], v32, s[4:7], s15 offen offset:16 sc1
    s_waitcnt vmcnt(0)
    v_add_f32 v24, v24, v8
    v_add_f32 v25, v25, v12
    v_add_f32 v26, v26, v9
    v_add_f32 v27, v27, v13
    v_add_f32 v28, v28, v10
    v_add_f32 v29, v29, v14
    v_add_f32 v30, v30, v11
    v_add_f32 v31, v31, v15
L_p2_kernel_q_18:
    s_bitcmp1_b32 s20, 23
    s_cbranch_scc0 L_p2_kernel_q_19
    s_lshl_b32 s15, s26, 1
    s_add_u32 s15, s15, 282038272
    buffer_load_dwordx4 v[8:11], v32, s[4:7], s15 offen sc1
    buffer_load_dwordx4 v[12:15], v32, s[4:7], s15 offen offset:16 sc1
    s_waitcnt vmcnt(0)
    v_add_f32 v24, v24, v8
    v_add_f32 v25, v25, v12
    v_add_f32 v26, v26, v9
    v_add_f32 v27, v27, v13
    v_add_f32 v28, v28, v10
    v_add_f32 v29, v29, v14
    v_add_f32 v30, v30, v11
    v_add_f32 v31, v31, v15
L_p2_kernel_q_19:
L_p2_kernel_nof32b_15:
    v_pk_mul_f32 v[8:9], v[24:25], s[84:85] op_sel:[0,0] op_sel_hi:[1,0]
    v_pk_mul_f32 v[10:11], v[24:25], s[84:85] op_sel:[0,1] op_sel_hi:[1,1]
    v_pk_mul_f32 v[12:13], v[24:25], s[86:87] op_sel:[0,0] op_sel_hi:[1,0]
    v_pk_mul_f32 v[14:15], v[24:25], s[86:87] op_sel:[0,1] op_sel_hi:[1,1]
    v_pk_fma_f32 v[8:9], v[26:27], s[88:89], v[8:9] op_sel:[0,0,0] op_sel_hi:[1,0,1]
    v_pk_fma_f32 v[10:11], v[26:27], s[88:89], v[10:11] op_sel:[0,1,0] op_sel_hi:[1,1,1]
    v_pk_fma_f32 v[12:13], v[26:27], s[90:91], v[12:13] op_sel:[0,0,0] op_sel_hi:[1,0,1]
    v_pk_fma_f32 v[14:15], v[26:27], s[90:91], v[14:15] op_sel:[0,1,0] op_sel_hi:[1,1,1]
    v_pk_fma_f32 v[8:9], v[28:29], s[92:93], v[8:9] op_sel:[0,0,0] op_sel_hi:[1,0,1]
    v_pk_fma_f32 v[10:11], v[28:29], s[92:93], v[10:11] op_sel:[0,1,0] op_sel_hi:[1,1,1]
    v_pk_fma_f32 v[12:13], v[28:29], s[94:95], v[12:13] op_sel:[0,0,0] op_sel_hi:[1,0,1]
    v_pk_fma_f32 v[14:15], v[28:29], s[94:95], v[14:15] op_sel:[0,1,0] op_sel_hi:[1,1,1]
    v_pk_fma_f32 v[8:9], v[30:31], s[96:97], v[8:9] op_sel:[0,0,0] op_sel_hi:[1,0,1]
    v_pk_fma_f32 v[10:11], v[30:31], s[96:97], v[10:11] op_sel:[0,1,0] op_sel_hi:[1,1,1]
    v_pk_fma_f32 v[12:13], v[30:31], s[98:99], v[12:13] op_sel:[0,0,0] op_sel_hi:[1,0,1]
    v_pk_fma_f32 v[14:15], v[30:31], s[98:99], v[14:15] op_sel:[0,1,0] op_sel_hi:[1,1,1]
    v_pk_mul_f32 v[8:9], v[8:9], v[72:73]
    v_pk_mul_f32 v[10:11], v[10:11], v[74:75]
    v_pk_mul_f32 v[12:13], v[12:13], v[76:77]
    v_pk_mul_f32 v[14:15], v[14:15], v[78:79]
    v_pk_mul_f32 v[24:25], v[8:9], s[28:29] op_sel:[0,0] op_sel_hi:[1,0]
    v_pk_mul_f32 v[26:27], v[8:9], s[28:29] op_sel:[0,1] op_sel_hi:[1,1]
    v_pk_mul_f32 v[28:29], v[8:9], s[30:31] op_sel:[0,0] op_sel_hi:[1,0]
    v_pk_mul_f32 v[30:31], v[8:9], s[30:31] op_sel:[0,1] op_sel_hi:[1,1]
    v_pk_fma_f32 v[24:25], v[10:11], s[32:33], v[24:25] op_sel:[0,0,0] op_sel_hi:[1,0,1]
    v_pk_fma_f32 v[26:27], v[10:11], s[32:33], v[26:27] op_sel:[0,1,0] op_sel_hi:[1,1,1]
    v_pk_fma_f32 v[28:29], v[10:11], s[34:35], v[28:29] op_sel:[0,0,0] op_sel_hi:[1,0,1]
    v_pk_fma_f32 v[30:31], v[10:11], s[34:35], v[30:31] op_sel:[0,1,0] op_sel_hi:[1,1,1]
    v_pk_fma_f32 v[24:25], v[12:13], s[36:37], v[24:25] op_sel:[0,0,0] op_sel_hi:[1,0,1]
    v_pk_fma_f32 v[26:27], v[12:13], s[36:37], v[26:27] op_sel:[0,1,0] op_sel_hi:[1,1,1]
    v_pk_fma_f32 v[28:29], v[12:13], s[38:39], v[28:29] op_sel:[0,0,0] op_sel_hi:[1,0,1]
    v_pk_fma_f32 v[30:31], v[12:13], s[38:39], v[30:31] op_sel:[0,1,0] op_sel_hi:[1,1,1]
    v_pk_fma_f32 v[24:25], v[14:15], s[40:41], v[24:25] op_sel:[0,0,0] op_sel_hi:[1,0,1]
    v_pk_fma_f32 v[26:27], v[14:15], s[40:41], v[26:27] op_sel:[0,1,0] op_sel_hi:[1,1,1]
    v_pk_fma_f32 v[28:29], v[14:15], s[42:43], v[28:29] op_sel:[0,0,0] op_sel_hi:[1,0,1]
    v_pk_fma_f32 v[30:31], v[14:15], s[42:43], v[30:31] op_sel:[0,1,0] op_sel_hi:[1,1,1]
    v_lshlrev_b32 v8, 16, v64
    v_and_b32 v10, 0xffff0000, v64
    v_lshlrev_b32 v12, 16, v65
    v_and_b32 v14, 0xffff0000, v65
    v_lshlrev_b32 v9, 16, v66
    v_and_b32 v11, 0xffff0000, v66
    v_lshlrev_b32 v13, 16, v67
    v_and_b32 v15, 0xffff0000, v67
    v_pk_fma_f32 v[8:9], v[24:25], v[80:81], v[8:9]
    v_pk_fma_f32 v[10:11], v[26:27], v[82:83], v[10:11]
    v_pk_fma_f32 v[12:13], v[28:29], v[84:85], v[12:13]
    v_pk_fma_f32 v[14:15], v[30:31], v[86:87], v[14:15]
    v_cvt_pk_bf16_f32 v16, v8, v10
    v_cvt_pk_bf16_f32 v17, v12, v14
    v_cvt_pk_bf16_f32 v18, v9, v11
    v_cvt_pk_bf16_f32 v19, v13, v15
    buffer_store_dwordx4 v[16:19], v1, s[16:19], s26 offen
    s_cmp_ge_u32 s13, 4
    s_cbranch_scc1 L_p2_f1
    s_bfe_u32 s14, s20, 262164
    s_cbranch_scc0 L_p2_kernel_nof32a_20
    s_add_u32 s14, s12, 0
    s_and_b32 s14, s14, 3
    s_add_u32 s14, s14, 20
    s_bitcmp1_b32 s20, s14
    s_cbranch_scc0 L_p2_kernel_q_21
    v_mov_b32 v88, 1073758208
    v_mov_b32 v89, 1073758208
    v_mov_b32 v90, 1073758208
    v_mov_b32 v91, 1073758208
L_p2_kernel_q_21:
    s_add_u32 s14, s12, 1
    s_and_b32 s14, s14, 3
    s_add_u32 s14, s14, 20
    s_bitcmp1_b32 s20, s14
    s_cbranch_scc0 L_p2_kernel_q_22
    v_mov_b32 v92, 1073758208
    v_mov_b32 v93, 1073758208
    v_mov_b32 v94, 1073758208
    v_mov_b32 v95, 1073758208
L_p2_kernel_q_22:
    s_add_u32 s14, s12, 2
    s_and_b32 s14, s14, 3
    s_add_u32 s14, s14, 20
    s_bitcmp1_b32 s20, s14
    s_cbranch_scc0 L_p2_kernel_q_23
    v_mov_b32 v96, 1073758208
    v_mov_b32 v97, 1073758208
    v_mov_b32 v98, 1073758208
    v_mov_b32 v99, 1073758208
L_p2_kernel_q_23:
    s_add_u32 s14, s12, 3
    s_and_b32 s14, s14, 3
    s_add_u32 s14, s14, 20
    s_bitcmp1_b32 s20, s14
    s_cbranch_scc0 L_p2_kernel_q_24
    v_mov_b32 v100, 1073758208
    v_mov_b32 v101, 1073758208
    v_mov_b32 v102, 1073758208
    v_mov_b32 v103, 1073758208
L_p2_kernel_q_24:
L_p2_kernel_nof32a_20:
    v_pk_add_u16 v88, v88, v92
    v_pk_add_u16 v96, v96, v100
    v_pk_add_u16 v89, v89, v93
    v_pk_add_u16 v97, v97, v101
    v_pk_add_u16 v90, v90, v94
    v_pk_add_u16 v98, v98, v102
    v_pk_add_u16 v91, v91, v95
    v_pk_add_u16 v99, v99, v103
    v_add_u32_sdwa v24, v88, v96 dst_sel:DWORD dst_unused:UNUSED_PAD src0_sel:WORD_0 src1_sel:WORD_0
    v_add_u32_sdwa v25, v90, v98 dst_sel:DWORD dst_unused:UNUSED_PAD src0_sel:WORD_0 src1_sel:WORD_0
    v_add_u32_sdwa v26, v88, v96 dst_sel:DWORD dst_unused:UNUSED_PAD src0_sel:WORD_1 src1_sel:WORD_1
    v_add_u32_sdwa v27, v90, v98 dst_sel:DWORD dst_unused:UNUSED_PAD src0_sel:WORD_1 src1_sel:WORD_1
    v_add_u32_sdwa v28, v89, v97 dst_sel:DWORD dst_unused:UNUSED_PAD src0_sel:WORD_0 src1_sel:WORD_0
    v_add_u32_sdwa v29, v91, v99 dst_sel:DWORD dst_unused:UNUSED_PAD src0_sel:WORD_0 src1_sel:WORD_0
    v_add_u32_sdwa v30, v89, v97 dst_sel:DWORD dst_unused:UNUSED_PAD src0_sel:WORD_1 src1_sel:WORD_1
    v_add_u32_sdwa v31, v91, v99 dst_sel:DWORD dst_unused:UNUSED_PAD src0_sel:WORD_1 src1_sel:WORD_1
    v_cvt_f32_u32 v24, v24
    v_cvt_f32_u32 v25, v25
    v_cvt_f32_u32 v26, v26
    v_cvt_f32_u32 v27, v27
    v_cvt_f32_u32 v28, v28
    v_cvt_f32_u32 v29, v29
    v_cvt_f32_u32 v30, v30
    v_cvt_f32_u32 v31, v31
    v_pk_fma_f32 v[24:25], v[24:25], s[44:45], s[44:45] op_sel:[0,0,1] op_sel_hi:[1,0,1]
    v_pk_fma_f32 v[26:27], v[26:27], s[44:45], s[44:45] op_sel:[0,0,1] op_sel_hi:[1,0,1]
    v_pk_fma_f32 v[28:29], v[28:29], s[44:45], s[44:45] op_sel:[0,0,1] op_sel_hi:[1,0,1]
    v_pk_fma_f32 v[30:31], v[30:31], s[44:45], s[44:45] op_sel:[0,0,1] op_sel_hi:[1,0,1]
    s_bfe_u32 s14, s20, 262164
    s_cbranch_scc0 L_p2_kernel_nof32b_25
    v_lshlrev_b32 v32, 1, v2
    s_bitcmp1_b32 s20, 20
    s_cbranch_scc0 L_p2_kernel_q_26
    s_lshl_b32 s15, s26, 1
    s_add_u32 s15, s15, 251318272
    buffer_load_dwordx4 v[88:91], v32, s[4:7], s15 offen sc1
    buffer_load_dwordx4 v[92:95], v32, s[4:7], s15 offen offset:16 sc1
    s_waitcnt vmcnt(0)
    v_add_f32 v24, v24, v88
    v_add_f32 v25, v25, v92
    v_add_f32 v26, v26, v89
    v_add_f32 v27, v27, v93
    v_add_f32 v28, v28, v90
    v_add_f32 v29, v29, v94
    v_add_f32 v30, v30, v91
    v_add_f32 v31, v31, v95
L_p2_kernel_q_26:
    s_bitcmp1_b32 s20, 21
    s_cbranch_scc0 L_p2_kernel_q_27
    s_lshl_b32 s15, s26, 1
    s_add_u32 s15, s15, 261558272
    buffer_load_dwordx4 v[88:91], v32, s[4:7], s15 offen sc1
    buffer_load_dwordx4 v[92:95], v32, s[4:7], s15 offen offset:16 sc1
    s_waitcnt vmcnt(0)
    v_add_f32 v24, v24, v88
    v_add_f32 v25, v25, v92
    v_add_f32 v26, v26, v89
    v_add_f32 v27, v27, v93
    v_add_f32 v28, v28, v90
    v_add_f32 v29, v29, v94
    v_add_f32 v30, v30, v91
    v_add_f32 v31, v31, v95
L_p2_kernel_q_27:
    s_bitcmp1_b32 s20, 22
    s_cbranch_scc0 L_p2_kernel_q_28
    s_lshl_b32 s15, s26, 1
    s_add_u32 s15, s15, 271798272
    buffer_load_dwordx4 v[88:91], v32, s[4:7], s15 offen sc1
    buffer_load_dwordx4 v[92:95], v32, s[4:7], s15 offen offset:16 sc1
    s_waitcnt vmcnt(0)
    v_add_f32 v24, v24, v88
    v_add_f32 v25, v25, v92
    v_add_f32 v26, v26, v89
    v_add_f32 v27, v27, v93
    v_add_f32 v28, v28, v90
    v_add_f32 v29, v29, v94
    v_add_f32 v30, v30, v91
    v_add_f32 v31, v31, v95
L_p2_kernel_q_28:
    s_bitcmp1_b32 s20, 23
    s_cbranch_scc0 L_p2_kernel_q_29
    s_lshl_b32 s15, s26, 1
    s_add_u32 s15, s15, 282038272
    buffer_load_dwordx4 v[88:91], v32, s[4:7], s15 offen sc1
    buffer_load_dwordx4 v[92:95], v32, s[4:7], s15 offen offset:16 sc1
    s_waitcnt vmcnt(0)
    v_add_f32 v24, v24, v88
    v_add_f32 v25, v25, v92
    v_add_f32 v26, v26, v89
    v_add_f32 v27, v27, v93
    v_add_f32 v28, v28, v90
    v_add_f32 v29, v29, v94
    v_add_f32 v30, v30, v91
    v_add_f32 v31, v31, v95
L_p2_kernel_q_29:
L_p2_kernel_nof32b_25:
    v_pk_mul_f32 v[88:89], v[24:25], s[84:85] op_sel:[0,0] op_sel_hi:[1,0]
    v_pk_mul_f32 v[90:91], v[24:25], s[84:85] op_sel:[0,1] op_sel_hi:[1,1]
    v_pk_mul_f32 v[92:93], v[24:25], s[86:87] op_sel:[0,0] op_sel_hi:[1,0]
    v_pk_mul_f32 v[94:95], v[24:25], s[86:87] op_sel:[0,1] op_sel_hi:[1,1]
    v_pk_fma_f32 v[88:89], v[26:27], s[88:89], v[88:89] op_sel:[0,0,0] op_sel_hi:[1,0,1]
    v_pk_fma_f32 v[90:91], v[26:27], s[88:89], v[90:91] op_sel:[0,1,0] op_sel_hi:[1,1,1]
    v_pk_fma_f32 v[92:93], v[26:27], s[90:91], v[92:93] op_sel:[0,0,0] op_sel_hi:[1,0,1]
    v_pk_fma_f32 v[94:95], v[26:27], s[90:91], v[94:95] op_sel:[0,1,0] op_sel_hi:[1,1,1]
    v_pk_fma_f32 v[88:89], v[28:29], s[92:93], v[88:89] op_sel:[0,0,0] op_sel_hi:[1,0,1]
    v_pk_fma_f32 v[90:91], v[28:29], s[92:93], v[90:91] op_sel:[0,1,0] op_sel_hi:[1,1,1]
    v_pk_fma_f32 v[92:93], v[28:29], s[94:95], v[92:93] op_sel:[0,0,0] op_sel_hi:[1,0,1]
    v_pk_fma_f32 v[94:95], v[28:29], s[94:95], v[94:95] op_sel:[0,1,0] op_sel_hi:[1,1,1]
    v_pk_fma_f32 v[88:89], v[30:31], s[96:97], v[88:89] op_sel:[0,0,0] op_sel_hi:[1,0,1]
    v_pk_fma_f32 v[90:91], v[30:31], s[96:97], v[90:91] op_sel:[0,1,0] op_sel_hi:[1,1,1]
    v_pk_fma_f32 v[92:93], v[30:31], s[98:99], v[92:93] op_sel:[0,0,0] op_sel_hi:[1,0,1]
    v_pk_fma_f32 v[94:95], v[30:31], s[98:99], v[94:95] op_sel:[0,1,0] op_sel_hi:[1,1,1]
    v_pk_mul_f32 v[88:89], v[88:89], v[112:113]
    v_pk_mul_f32 v[90:91], v[90:91], v[114:115]
    v_pk_mul_f32 v[92:93], v[92:93], v[116:117]
    v_pk_mul_f32 v[94:95], v[94:95], v[118:119]
    v_pk_mul_f32 v[24:25], v[88:89], s[28:29] op_sel:[0,0] op_sel_hi:[1,0]
    v_pk_mul_f32 v[26:27], v[88:89], s[28:29] op_sel:[0,1] op_sel_hi:[1,1]
    v_pk_mul_f32 v[28:29], v[88:89], s[30:31] op_sel:[0,0] op_sel_hi:[1,0]
    v_pk_mul_f32 v[30:31], v[88:89], s[30:31] op_sel:[0,1] op_sel_hi:[1,1]
    v_pk_fma_f32 v[24:25], v[90:91], s[32:33], v[24:25] op_sel:[0,0,0] op_sel_hi:[1,0,1]
    v_pk_fma_f32 v[26:27], v[90:91], s[32:33], v[26:27] op_sel:[0,1,0] op_sel_hi:[1,1,1]
    v_pk_fma_f32 v[28:29], v[90:91], s[34:35], v[28:29] op_sel:[0,0,0] op_sel_hi:[1,0,1]
    v_pk_fma_f32 v[30:31], v[90:91], s[34:35], v[30:31] op_sel:[0,1,0] op_sel_hi:[1,1,1]
    v_pk_fma_f32 v[24:25], v[92:93], s[36:37], v[24:25] op_sel:[0,0,0] op_sel_hi:[1,0,1]
    v_pk_fma_f32 v[26:27], v[92:93], s[36:37], v[26:27] op_sel:[0,1,0] op_sel_hi:[1,1,1]
    v_pk_fma_f32 v[28:29], v[92:93], s[38:39], v[28:29] op_sel:[0,0,0] op_sel_hi:[1,0,1]
    v_pk_fma_f32 v[30:31], v[92:93], s[38:39], v[30:31] op_sel:[0,1,0] op_sel_hi:[1,1,1]
    v_pk_fma_f32 v[24:25], v[94:95], s[40:41], v[24:25] op_sel:[0,0,0] op_sel_hi:[1,0,1]
    v_pk_fma_f32 v[26:27], v[94:95], s[40:41], v[26:27] op_sel:[0,1,0] op_sel_hi:[1,1,1]
    v_pk_fma_f32 v[28:29], v[94:95], s[42:43], v[28:29] op_sel:[0,0,0] op_sel_hi:[1,0,1]
    v_pk_fma_f32 v[30:31], v[94:95], s[42:43], v[30:31] op_sel:[0,1,0] op_sel_hi:[1,1,1]
    v_lshlrev_b32 v88, 16, v68
    v_and_b32 v90, 0xffff0000, v68
    v_lshlrev_b32 v92, 16, v69
    v_and_b32 v94, 0xffff0000, v69
    v_lshlrev_b32 v89, 16, v70
    v_and_b32 v91, 0xffff0000, v70
    v_lshlrev_b32 v93, 16, v71
    v_and_b32 v95, 0xffff0000, v71
    v_pk_fma_f32 v[88:89], v[24:25], v[120:121], v[88:89]
    v_pk_fma_f32 v[90:91], v[26:27], v[122:123], v[90:91]
    v_pk_fma_f32 v[92:93], v[28:29], v[124:125], v[92:93]
    v_pk_fma_f32 v[94:95], v[30:31], v[126:127], v[94:95]
    v_cvt_pk_bf16_f32 v96, v88, v90
    v_cvt_pk_bf16_f32 v97, v92, v94
    v_cvt_pk_bf16_f32 v98, v89, v91
    v_cvt_pk_bf16_f32 v99, v93, v95
    buffer_store_dwordx4 v[96:99], v2, s[16:19], s26 offen
L_p2_f1:
    s_bitset0_b32 s51, s49
    s_cmp_eq_u32 s51, 0
    s_cbranch_scc1 L_p2_done
    s_ff1_i32_b32 s49, s51
    s_mul_i32 s14, s3, 20000
    s_mul_i32 s15, s49, 4992
    s_add_u32 s14, s14, s15
    s_add_u32 s15, s14, 4096
    v_min_u32 v61, 231, v0
    v_lshl_add_u32 v60, v0, 2, s14
    v_lshl_add_u32 v61, v61, 2, s15
    global_load_dword v60, v60, s[100:101] nt
    global_load_dword v61, v61, s[100:101] nt
    s_waitcnt vmcnt(0)
    v_lshlrev_b32 v30, 16, v60
    v_and_b32 v31, 0xffff0000, v60
    v_lshlrev_b32 v36, 16, v53
    v_and_b32 v37, 0xffff0000, v53
    v_lshlrev_b32 v38, 16, v54
    v_and_b32 v39, 0xffff0000, v54
    v_lshlrev_b32 v40, 16, v56
    v_and_b32 v41, 0xffff0000, v56
    v_lshlrev_b32 v42, 16, v57
    v_and_b32 v43, 0xffff0000, v57
    v_pk_add_f32 v[14:15], v[30:31], v[36:37] op_sel:[0,0] op_sel_hi:[1,0] neg_lo:[0,1] neg_hi:[0,1]
    v_pk_add_f32 v[16:17], v[30:31], v[36:37] op_sel:[0,1] op_sel_hi:[1,1] neg_lo:[0,1] neg_hi:[0,1]
    v_pk_add_f32 v[18:19], v[30:31], v[38:39] op_sel:[0,0] op_sel_hi:[1,0] neg_lo:[0,1] neg_hi:[0,1]
    v_pk_add_f32 v[20:21], v[30:31], v[38:39] op_sel:[0,1] op_sel_hi:[1,1] neg_lo:[0,1] neg_hi:[0,1]
    v_pk_add_f32 v[22:23], v[30:31], v[40:41] op_sel:[0,0] op_sel_hi:[1,0] neg_lo:[0,1] neg_hi:[0,1]
    v_pk_add_f32 v[24:25], v[30:31], v[40:41] op_sel:[0,1] op_sel_hi:[1,1] neg_lo:[0,1] neg_hi:[0,1]
    v_pk_add_f32 v[26:27], v[30:31], v[42:43] op_sel:[0,0] op_sel_hi:[1,0] neg_lo:[0,1] neg_hi:[0,1]
    v_pk_add_f32 v[28:29], v[30:31], v[42:43] op_sel:[0,1] op_sel_hi:[1,1] neg_lo:[0,1] neg_hi:[0,1]
    v_cvt_pk_bf16_f32 v32, v14, v15
    v_lshlrev_b32 v14, 16, v32
    v_and_b32 v15, 0xffff0000, v32
    v_cvt_pk_bf16_f32 v32, v16, v17
    v_lshlrev_b32 v16, 16, v32
    v_and_b32 v17, 0xffff0000, v32
    v_cvt_pk_bf16_f32 v32, v18, v19
    v_lshlrev_b32 v18, 16, v32
    v_and_b32 v19, 0xffff0000, v32
    v_cvt_pk_bf16_f32 v32, v20, v21
    v_lshlrev_b32 v20, 16, v32
    v_and_b32 v21, 0xffff0000, v32
    v_cvt_pk_bf16_f32 v32, v22, v23
    v_lshlrev_b32 v22, 16, v32
    v_and_b32 v23, 0xffff0000, v32
    v_cvt_pk_bf16_f32 v32, v24, v25
    v_lshlrev_b32 v24, 16, v32
    v_and_b32 v25, 0xffff0000, v32
    v_cvt_pk_bf16_f32 v32, v26, v27
    v_lshlrev_b32 v26, 16, v32
    v_and_b32 v27, 0xffff0000, v32
    v_cvt_pk_bf16_f32 v32, v28, v29
    v_lshlrev_b32 v28, 16, v32
    v_and_b32 v29, 0xffff0000, v32
    v_pk_mul_f32 v[14:15], v[14:15], v[14:15]
    v_pk_mul_f32 v[16:17], v[16:17], v[16:17]
    v_pk_mul_f32 v[18:19], v[18:19], v[18:19]
    v_pk_mul_f32 v[20:21], v[20:21], v[20:21]
    v_pk_mul_f32 v[22:23], v[22:23], v[22:23]
    v_pk_mul_f32 v[24:25], v[24:25], v[24:25]
    v_pk_mul_f32 v[26:27], v[26:27], v[26:27]
    v_pk_mul_f32 v[28:29], v[28:29], v[28:29]
    v_cvt_pk_bf16_f32 v32, v14, v15
    v_lshlrev_b32 v14, 16, v32
    v_and_b32 v15, 0xffff0000, v32
    v_cvt_pk_bf16_f32 v32, v16, v17
    v_lshlrev_b32 v16, 16, v32
    v_and_b32 v17, 0xffff0000, v32
    v_cvt_pk_bf16_f32 v32, v18, v19
    v_lshlrev_b32 v18, 16, v32
    v_and_b32 v19, 0xffff0000, v32
    v_cvt_pk_bf16_f32 v32, v20, v21
    v_lshlrev_b32 v20, 16, v32
    v_and_b32 v21, 0xffff0000, v32
    v_cvt_pk_bf16_f32 v32, v22, v23
    v_lshlrev_b32 v22, 16, v32
    v_and_b32 v23, 0xffff0000, v32
    v_cvt_pk_bf16_f32 v32, v24, v25
    v_lshlrev_b32 v24, 16, v32
    v_and_b32 v25, 0xffff0000, v32
    v_cvt_pk_bf16_f32 v32, v26, v27
    v_lshlrev_b32 v26, 16, v32
    v_and_b32 v27, 0xffff0000, v32
    v_cvt_pk_bf16_f32 v32, v28, v29
    v_lshlrev_b32 v28, 16, v32
    v_and_b32 v29, 0xffff0000, v32
    v_mov_b32 v30, 1092616192
    v_mov_b32 v31, 0x3fb8aa3b
    v_pk_mul_f32 v[14:15], v[14:15], v[30:31] op_sel:[0,0] op_sel_hi:[1,0]
    v_pk_mul_f32 v[16:17], v[16:17], v[30:31] op_sel:[0,0] op_sel_hi:[1,0]
    v_pk_mul_f32 v[18:19], v[18:19], v[30:31] op_sel:[0,0] op_sel_hi:[1,0]
    v_pk_mul_f32 v[20:21], v[20:21], v[30:31] op_sel:[0,0] op_sel_hi:[1,0]
    v_pk_mul_f32 v[22:23], v[22:23], v[30:31] op_sel:[0,0] op_sel_hi:[1,0]
    v_pk_mul_f32 v[24:25], v[24:25], v[30:31] op_sel:[0,0] op_sel_hi:[1,0]
    v_pk_mul_f32 v[26:27], v[26:27], v[30:31] op_sel:[0,0] op_sel_hi:[1,0]
    v_pk_mul_f32 v[28:29], v[28:29], v[30:31] op_sel:[0,0] op_sel_hi:[1,0]
    v_cvt_pk_bf16_f32 v32, v14, v15
    v_lshlrev_b32 v14, 16, v32
    v_and_b32 v15, 0xffff0000, v32
    v_cvt_pk_bf16_f32 v32, v16, v17
    v_lshlrev_b32 v16, 16, v32
    v_and_b32 v17, 0xffff0000, v32
    v_cvt_pk_bf16_f32 v32, v18, v19
    v_lshlrev_b32 v18, 16, v32
    v_and_b32 v19, 0xffff0000, v32
    v_cvt_pk_bf16_f32 v32, v20, v21
    v_lshlrev_b32 v20, 16, v32
    v_and_b32 v21, 0xffff0000, v32
    v_cvt_pk_bf16_f32 v32, v22, v23
    v_lshlrev_b32 v22, 16, v32
    v_and_b32 v23, 0xffff0000, v32
    v_cvt_pk_bf16_f32 v32, v24, v25
    v_lshlrev_b32 v24, 16, v32
    v_and_b32 v25, 0xffff0000, v32
    v_cvt_pk_bf16_f32 v32, v26, v27
    v_lshlrev_b32 v26, 16, v32
    v_and_b32 v27, 0xffff0000, v32
    v_cvt_pk_bf16_f32 v32, v28, v29
    v_lshlrev_b32 v28, 16, v32
    v_and_b32 v29, 0xffff0000, v32
    v_pk_mul_f32 v[14:15], v[14:15], v[30:31] op_sel:[0,1] op_sel_hi:[1,1]
    v_pk_mul_f32 v[16:17], v[16:17], v[30:31] op_sel:[0,1] op_sel_hi:[1,1]
    v_pk_mul_f32 v[18:19], v[18:19], v[30:31] op_sel:[0,1] op_sel_hi:[1,1]
    v_pk_mul_f32 v[20:21], v[20:21], v[30:31] op_sel:[0,1] op_sel_hi:[1,1]
    v_pk_mul_f32 v[22:23], v[22:23], v[30:31] op_sel:[0,1] op_sel_hi:[1,1]
    v_pk_mul_f32 v[24:25], v[24:25], v[30:31] op_sel:[0,1] op_sel_hi:[1,1]
    v_pk_mul_f32 v[26:27], v[26:27], v[30:31] op_sel:[0,1] op_sel_hi:[1,1]
    v_pk_mul_f32 v[28:29], v[28:29], v[30:31] op_sel:[0,1] op_sel_hi:[1,1]
    v_exp_f32 v14, -v14
    v_exp_f32 v15, -v15
    v_exp_f32 v16, -v16
    v_exp_f32 v17, -v17
    v_exp_f32 v18, -v18
    v_exp_f32 v19, -v19
    v_exp_f32 v20, -v20
    v_exp_f32 v21, -v21
    v_exp_f32 v22, -v22
    v_exp_f32 v23, -v23
    v_exp_f32 v24, -v24
    v_exp_f32 v25, -v25
    v_exp_f32 v26, -v26
    v_exp_f32 v27, -v27
    v_exp_f32 v28, -v28
    v_exp_f32 v29, -v29
    v_cvt_pk_bf16_f32 v14, v14, v16
    v_cvt_pk_bf16_f32 v15, v15, v17
    v_cvt_pk_bf16_f32 v18, v18, v20
    v_cvt_pk_bf16_f32 v19, v19, v21
    v_cvt_pk_bf16_f32 v22, v22, v24
    v_cvt_pk_bf16_f32 v23, v23, v25
    v_cvt_pk_bf16_f32 v26, v26, v28
    v_cvt_pk_bf16_f32 v27, v27, v29
    v_dot2_f32_bf16 v72, v14, s68, 0
    v_dot2_f32_bf16 v73, v15, s68, 0
    v_dot2_f32_bf16 v74, v14, s69, 0
    v_dot2_f32_bf16 v75, v15, s69, 0
    v_dot2_f32_bf16 v76, v14, s70, 0
    v_dot2_f32_bf16 v77, v15, s70, 0
    v_dot2_f32_bf16 v78, v14, s71, 0
    v_dot2_f32_bf16 v79, v15, s71, 0
    v_dot2_f32_bf16 v80, v14, s52, 0
    v_dot2_f32_bf16 v81, v15, s52, 0
    v_dot2_f32_bf16 v82, v14, s53, 0
    v_dot2_f32_bf16 v83, v15, s53, 0
    v_dot2_f32_bf16 v84, v14, s54, 0
    v_dot2_f32_bf16 v85, v15, s54, 0
    v_dot2_f32_bf16 v86, v14, s55, 0
    v_dot2_f32_bf16 v87, v15, s55, 0
    v_dot2_f32_bf16 v72, v18, s72, v72
    v_dot2_f32_bf16 v73, v19, s72, v73
    v_dot2_f32_bf16 v74, v18, s73, v74
    v_dot2_f32_bf16 v75, v19, s73, v75
    v_dot2_f32_bf16 v76, v18, s74, v76
    v_dot2_f32_bf16 v77, v19, s74, v77
    v_dot2_f32_bf16 v78, v18, s75, v78
    v_dot2_f32_bf16 v79, v19, s75, v79
    v_dot2_f32_bf16 v80, v18, s56, v80
    v_dot2_f32_bf16 v81, v19, s56, v81
    v_dot2_f32_bf16 v82, v18, s57, v82
    v_dot2_f32_bf16 v83, v19, s57, v83
    v_dot2_f32_bf16 v84, v18, s58, v84
    v_dot2_f32_bf16 v85, v19, s58, v85
    v_dot2_f32_bf16 v86, v18, s59, v86
    v_dot2_f32_bf16 v87, v19, s59, v87
    v_dot2_f32_bf16 v72, v22, s76, v72
    v_dot2_f32_bf16 v73, v23, s76, v73
    v_dot2_f32_bf16 v74, v22, s77, v74
    v_dot2_f32_bf16 v75, v23, s77, v75
    v_dot2_f32_bf16 v76, v22, s78, v76
    v_dot2_f32_bf16 v77, v23, s78, v77
    v_dot2_f32_bf16 v78, v22, s79, v78
    v_dot2_f32_bf16 v79, v23, s79, v79
    v_dot2_f32_bf16 v80, v22, s60, v80
    v_dot2_f32_bf16 v81, v23, s60, v81
    v_dot2_f32_bf16 v82, v22, s61, v82
    v_dot2_f32_bf16 v83, v23, s61, v83
    v_dot2_f32_bf16 v84, v22, s62, v84
    v_dot2_f32_bf16 v85, v23, s62, v85
    v_dot2_f32_bf16 v86, v22, s63, v86
    v_dot2_f32_bf16 v87, v23, s63, v87
    v_dot2_f32_bf16 v72, v26, s80, v72
    v_dot2_f32_bf16 v73, v27, s80, v73
    v_dot2_f32_bf16 v74, v26, s81, v74
    v_dot2_f32_bf16 v75, v27, s81, v75
    v_dot2_f32_bf16 v76, v26, s82, v76
    v_dot2_f32_bf16 v77, v27, s82, v77
    v_dot2_f32_bf16 v78, v26, s83, v78
    v_dot2_f32_bf16 v79, v27, s83, v79
    v_dot2_f32_bf16 v80, v26, s64, v80
    v_dot2_f32_bf16 v81, v27, s64, v81
    v_dot2_f32_bf16 v82, v26, s65, v82
    v_dot2_f32_bf16 v83, v27, s65, v83
    v_dot2_f32_bf16 v84, v26, s66, v84
    v_dot2_f32_bf16 v85, v27, s66, v85
    v_dot2_f32_bf16 v86, v26, s67, v86
    v_dot2_f32_bf16 v87, v27, s67, v87
    s_cmp_ge_u32 s13, 4
    s_cbranch_scc1 L_p2_kernel_g1_30
    v_lshlrev_b32 v30, 16, v61
    v_and_b32 v31, 0xffff0000, v61
    v_pk_add_f32 v[14:15], v[30:31], v[36:37] op_sel:[0,0] op_sel_hi:[1,0] neg_lo:[0,1] neg_hi:[0,1]
    v_pk_add_f32 v[16:17], v[30:31], v[36:37] op_sel:[0,1] op_sel_hi:[1,1] neg_lo:[0,1] neg_hi:[0,1]
    v_pk_add_f32 v[18:19], v[30:31], v[38:39] op_sel:[0,0] op_sel_hi:[1,0] neg_lo:[0,1] neg_hi:[0,1]
    v_pk_add_f32 v[20:21], v[30:31], v[38:39] op_sel:[0,1] op_sel_hi:[1,1] neg_lo:[0,1] neg_hi:[0,1]
    v_pk_add_f32 v[22:23], v[30:31], v[40:41] op_sel:[0,0] op_sel_hi:[1,0] neg_lo:[0,1] neg_hi:[0,1]
    v_pk_add_f32 v[24:25], v[30:31], v[40:41] op_sel:[0,1] op_sel_hi:[1,1] neg_lo:[0,1] neg_hi:[0,1]
    v_pk_add_f32 v[26:27], v[30:31], v[42:43] op_sel:[0,0] op_sel_hi:[1,0] neg_lo:[0,1] neg_hi:[0,1]
    v_pk_add_f32 v[28:29], v[30:31], v[42:43] op_sel:[0,1] op_sel_hi:[1,1] neg_lo:[0,1] neg_hi:[0,1]
    v_cvt_pk_bf16_f32 v32, v14, v15
    v_lshlrev_b32 v14, 16, v32
    v_and_b32 v15, 0xffff0000, v32
    v_cvt_pk_bf16_f32 v32, v16, v17
    v_lshlrev_b32 v16, 16, v32
    v_and_b32 v17, 0xffff0000, v32
    v_cvt_pk_bf16_f32 v32, v18, v19
    v_lshlrev_b32 v18, 16, v32
    v_and_b32 v19, 0xffff0000, v32
    v_cvt_pk_bf16_f32 v32, v20, v21
    v_lshlrev_b32 v20, 16, v32
    v_and_b32 v21, 0xffff0000, v32
    v_cvt_pk_bf16_f32 v32, v22, v23
    v_lshlrev_b32 v22, 16, v32
    v_and_b32 v23, 0xffff0000, v32
    v_cvt_pk_bf16_f32 v32, v24, v25
    v_lshlrev_b32 v24, 16, v32
    v_and_b32 v25, 0xffff0000, v32
    v_cvt_pk_bf16_f32 v32, v26, v27
    v_lshlrev_b32 v26, 16, v32
    v_and_b32 v27, 0xffff0000, v32
    v_cvt_pk_bf16_f32 v32, v28, v29
    v_lshlrev_b32 v28, 16, v32
    v_and_b32 v29, 0xffff0000, v32
    v_pk_mul_f32 v[14:15], v[14:15], v[14:15]
    v_pk_mul_f32 v[16:17], v[16:17], v[16:17]
    v_pk_mul_f32 v[18:19], v[18:19], v[18:19]
    v_pk_mul_f32 v[20:21], v[20:21], v[20:21]
    v_pk_mul_f32 v[22:23], v[22:23], v[22:23]
    v_pk_mul_f32 v[24:25], v[24:25], v[24:25]
    v_pk_mul_f32 v[26:27], v[26:27], v[26:27]
    v_pk_mul_f32 v[28:29], v[28:29], v[28:29]
    v_cvt_pk_bf16_f32 v32, v14, v15
    v_lshlrev_b32 v14, 16, v32
    v_and_b32 v15, 0xffff0000, v32
    v_cvt_pk_bf16_f32 v32, v16, v17
    v_lshlrev_b32 v16, 16, v32
    v_and_b32 v17, 0xffff0000, v32
    v_cvt_pk_bf16_f32 v32, v18, v19
    v_lshlrev_b32 v18, 16, v32
    v_and_b32 v19, 0xffff0000, v32
    v_cvt_pk_bf16_f32 v32, v20, v21
    v_lshlrev_b32 v20, 16, v32
    v_and_b32 v21, 0xffff0000, v32
    v_cvt_pk_bf16_f32 v32, v22, v23
    v_lshlrev_b32 v22, 16, v32
    v_and_b32 v23, 0xffff0000, v32
    v_cvt_pk_bf16_f32 v32, v24, v25
    v_lshlrev_b32 v24, 16, v32
    v_and_b32 v25, 0xffff0000, v32
    v_cvt_pk_bf16_f32 v32, v26, v27
    v_lshlrev_b32 v26, 16, v32
    v_and_b32 v27, 0xffff0000, v32
    v_cvt_pk_bf16_f32 v32, v28, v29
    v_lshlrev_b32 v28, 16, v32
    v_and_b32 v29, 0xffff0000, v32
    v_mov_b32 v30, 1092616192
    v_mov_b32 v31, 0x3fb8aa3b
    v_pk_mul_f32 v[14:15], v[14:15], v[30:31] op_sel:[0,0] op_sel_hi:[1,0]
    v_pk_mul_f32 v[16:17], v[16:17], v[30:31] op_sel:[0,0] op_sel_hi:[1,0]
    v_pk_mul_f32 v[18:19], v[18:19], v[30:31] op_sel:[0,0] op_sel_hi:[1,0]
    v_pk_mul_f32 v[20:21], v[20:21], v[30:31] op_sel:[0,0] op_sel_hi:[1,0]
    v_pk_mul_f32 v[22:23], v[22:23], v[30:31] op_sel:[0,0] op_sel_hi:[1,0]
    v_pk_mul_f32 v[24:25], v[24:25], v[30:31] op_sel:[0,0] op_sel_hi:[1,0]
    v_pk_mul_f32 v[26:27], v[26:27], v[30:31] op_sel:[0,0] op_sel_hi:[1,0]
    v_pk_mul_f32 v[28:29], v[28:29], v[30:31] op_sel:[0,0] op_sel_hi:[1,0]
    v_cvt_pk_bf16_f32 v32, v14, v15
    v_lshlrev_b32 v14, 16, v32
    v_and_b32 v15, 0xffff0000, v32
    v_cvt_pk_bf16_f32 v32, v16, v17
    v_lshlrev_b32 v16, 16, v32
    v_and_b32 v17, 0xffff0000, v32
    v_cvt_pk_bf16_f32 v32, v18, v19
    v_lshlrev_b32 v18, 16, v32
    v_and_b32 v19, 0xffff0000, v32
    v_cvt_pk_bf16_f32 v32, v20, v21
    v_lshlrev_b32 v20, 16, v32
    v_and_b32 v21, 0xffff0000, v32
    v_cvt_pk_bf16_f32 v32, v22, v23
    v_lshlrev_b32 v22, 16, v32
    v_and_b32 v23, 0xffff0000, v32
    v_cvt_pk_bf16_f32 v32, v24, v25
    v_lshlrev_b32 v24, 16, v32
    v_and_b32 v25, 0xffff0000, v32
    v_cvt_pk_bf16_f32 v32, v26, v27
    v_lshlrev_b32 v26, 16, v32
    v_and_b32 v27, 0xffff0000, v32
    v_cvt_pk_bf16_f32 v32, v28, v29
    v_lshlrev_b32 v28, 16, v32
    v_and_b32 v29, 0xffff0000, v32
    v_pk_mul_f32 v[14:15], v[14:15], v[30:31] op_sel:[0,1] op_sel_hi:[1,1]
    v_pk_mul_f32 v[16:17], v[16:17], v[30:31] op_sel:[0,1] op_sel_hi:[1,1]
    v_pk_mul_f32 v[18:19], v[18:19], v[30:31] op_sel:[0,1] op_sel_hi:[1,1]
    v_pk_mul_f32 v[20:21], v[20:21], v[30:31] op_sel:[0,1] op_sel_hi:[1,1]
    v_pk_mul_f32 v[22:23], v[22:23], v[30:31] op_sel:[0,1] op_sel_hi:[1,1]
    v_pk_mul_f32 v[24:25], v[24:25], v[30:31] op_sel:[0,1] op_sel_hi:[1,1]
    v_pk_mul_f32 v[26:27], v[26:27], v[30:31] op_sel:[0,1] op_sel_hi:[1,1]
    v_pk_mul_f32 v[28:29], v[28:29], v[30:31] op_sel:[0,1] op_sel_hi:[1,1]
    v_exp_f32 v14, -v14
    v_exp_f32 v15, -v15
    v_exp_f32 v16, -v16
    v_exp_f32 v17, -v17
    v_exp_f32 v18, -v18
    v_exp_f32 v19, -v19
    v_exp_f32 v20, -v20
    v_exp_f32 v21, -v21
    v_exp_f32 v22, -v22
    v_exp_f32 v23, -v23
    v_exp_f32 v24, -v24
    v_exp_f32 v25, -v25
    v_exp_f32 v26, -v26
    v_exp_f32 v27, -v27
    v_exp_f32 v28, -v28
    v_exp_f32 v29, -v29
    v_cvt_pk_bf16_f32 v14, v14, v16
    v_cvt_pk_bf16_f32 v15, v15, v17
    v_cvt_pk_bf16_f32 v18, v18, v20
    v_cvt_pk_bf16_f32 v19, v19, v21
    v_cvt_pk_bf16_f32 v22, v22, v24
    v_cvt_pk_bf16_f32 v23, v23, v25
    v_cvt_pk_bf16_f32 v26, v26, v28
    v_cvt_pk_bf16_f32 v27, v27, v29
    v_dot2_f32_bf16 v112, v14, s68, 0
    v_dot2_f32_bf16 v113, v15, s68, 0
    v_dot2_f32_bf16 v114, v14, s69, 0
    v_dot2_f32_bf16 v115, v15, s69, 0
    v_dot2_f32_bf16 v116, v14, s70, 0
    v_dot2_f32_bf16 v117, v15, s70, 0
    v_dot2_f32_bf16 v118, v14, s71, 0
    v_dot2_f32_bf16 v119, v15, s71, 0
    v_dot2_f32_bf16 v120, v14, s52, 0
    v_dot2_f32_bf16 v121, v15, s52, 0
    v_dot2_f32_bf16 v122, v14, s53, 0
    v_dot2_f32_bf16 v123, v15, s53, 0
    v_dot2_f32_bf16 v124, v14, s54, 0
    v_dot2_f32_bf16 v125, v15, s54, 0
    v_dot2_f32_bf16 v126, v14, s55, 0
    v_dot2_f32_bf16 v127, v15, s55, 0
    v_dot2_f32_bf16 v112, v18, s72, v112
    v_dot2_f32_bf16 v113, v19, s72, v113
    v_dot2_f32_bf16 v114, v18, s73, v114
    v_dot2_f32_bf16 v115, v19, s73, v115
    v_dot2_f32_bf16 v116, v18, s74, v116
    v_dot2_f32_bf16 v117, v19, s74, v117
    v_dot2_f32_bf16 v118, v18, s75, v118
    v_dot2_f32_bf16 v119, v19, s75, v119
    v_dot2_f32_bf16 v120, v18, s56, v120
    v_dot2_f32_bf16 v121, v19, s56, v121
    v_dot2_f32_bf16 v122, v18, s57, v122
    v_dot2_f32_bf16 v123, v19, s57, v123
    v_dot2_f32_bf16 v124, v18, s58, v124
    v_dot2_f32_bf16 v125, v19, s58, v125
    v_dot2_f32_bf16 v126, v18, s59, v126
    v_dot2_f32_bf16 v127, v19, s59, v127
    v_dot2_f32_bf16 v112, v22, s76, v112
    v_dot2_f32_bf16 v113, v23, s76, v113
    v_dot2_f32_bf16 v114, v22, s77, v114
    v_dot2_f32_bf16 v115, v23, s77, v115
    v_dot2_f32_bf16 v116, v22, s78, v116
    v_dot2_f32_bf16 v117, v23, s78, v117
    v_dot2_f32_bf16 v118, v22, s79, v118
    v_dot2_f32_bf16 v119, v23, s79, v119
    v_dot2_f32_bf16 v120, v22, s60, v120
    v_dot2_f32_bf16 v121, v23, s60, v121
    v_dot2_f32_bf16 v122, v22, s61, v122
    v_dot2_f32_bf16 v123, v23, s61, v123
    v_dot2_f32_bf16 v124, v22, s62, v124
    v_dot2_f32_bf16 v125, v23, s62, v125
    v_dot2_f32_bf16 v126, v22, s63, v126
    v_dot2_f32_bf16 v127, v23, s63, v127
    v_dot2_f32_bf16 v112, v26, s80, v112
    v_dot2_f32_bf16 v113, v27, s80, v113
    v_dot2_f32_bf16 v114, v26, s81, v114
    v_dot2_f32_bf16 v115, v27, s81, v115
    v_dot2_f32_bf16 v116, v26, s82, v116
    v_dot2_f32_bf16 v117, v27, s82, v117
    v_dot2_f32_bf16 v118, v26, s83, v118
    v_dot2_f32_bf16 v119, v27, s83, v119
    v_dot2_f32_bf16 v120, v26, s64, v120
    v_dot2_f32_bf16 v121, v27, s64, v121
    v_dot2_f32_bf16 v122, v26, s65, v122
    v_dot2_f32_bf16 v123, v27, s65, v123
    v_dot2_f32_bf16 v124, v26, s66, v124
    v_dot2_f32_bf16 v125, v27, s66, v125
    v_dot2_f32_bf16 v126, v26, s67, v126
    v_dot2_f32_bf16 v127, v27, s67, v127
L_p2_kernel_g1_30:
    s_cmp_eq_u32 s49, 3
    s_cselect_b32 s15, 8, 0
    s_add_u32 s15, s15, 224
    v_add_u32 v2, 16384, v1
    v_cmp_gt_u32 vcc, s15, v0
    s_mul_i32 s14, s3, 80000
    s_mul_i32 s26, s49, 19968
    s_add_u32 s26, s26, s14
    v_cndmask_b32 v2, 0.5, v2, vcc
    s_mov_b32 s10, 5120000
    buffer_load_dwordx4 v[64:67], v1, s[8:11], s26 offen
    buffer_load_dwordx4 v[68:71], v2, s[8:11], s26 offen
    s_branch L_p2_fin
L_p2_done:
    s_branch L_p2_end
L_p2_slow:
    s_barrier
    v_mov_b32 v8, 0
    v_mov_b32 v9, 0
    v_mov_b32 v10, 0
    v_mov_b32 v11, 0
    v_mov_b32 v12, v1
    ds_write_b128 v12, v[8:11]
    v_add_u32 v12, 16384, v12
    ds_write_b128 v12, v[8:11]
    v_add_u32 v12, 16384, v12
    ds_write_b128 v12, v[8:11]
    v_add_u32 v12, 16384, v12
    ds_write_b128 v12, v[8:11]
    v_add_u32 v12, 16384, v12
    ds_write_b128 v12, v[8:11]
    v_add_u32 v12, 16384, v12
    ds_write_b128 v12, v[8:11]
    v_add_u32 v12, 16384, v12
    ds_write_b128 v12, v[8:11]
    v_add_u32 v12, 16384, v12
    ds_write_b128 v12, v[8:11]
    v_add_u32 v12, 16384, v12
    ds_write_b128 v12, v[8:11]
    v_add_u32 v12, 16384, v12
    ds_write_b128 v12, v[8:11]
    v_add_u32 v12, 16384, v12
    v_mul_u32_u24 v13, 8320, v0
    v_mov_b32 v29, 0x7fc00000
    v_add_u32 v28, 32, v13
    v_lshlrev_b32 v14, 12, v0
    v_add_u32 v14, 0, v14
    s_mul_i32 s25, s12, 65
    s_add_u32 s25, s25, s3
    s_lshl_b32 s25, s25, 5
    s_add_u32 s25, s25, 222298112
    s_lshl_b32 s50, s50, 1
    s_mul_i32 s22, s12, 1280000
    s_mov_b32 s24, 0
    s_waitcnt lgkmcnt(0)
    s_barrier
L_p2_sstep:
    buffer_load_ushort v15, v13, s[4:7], s25 offen
    buffer_load_ushort v16, v28, s[4:7], s25 offen
    s_waitcnt vmcnt(0)
L_p2_srec:
    v_cmp_lt_u32 vcc, v15, v16
    s_nop 1
    s_and_b64 exec, exec, vcc
    s_cbranch_execz L_p2_sdone
    v_mul_u32_u24 v17, 43691, v15
    v_lshrrev_b32 v17, 17, v17
    v_mad_i32_i24 v18, v17, -3, v15
    v_lshrrev_b32 v19, 8, v17
    v_lshl_add_u32 v19, v19, 22, v14
    v_and_b32 v17, 255, v17
    v_lshl_add_u32 v17, v17, 4, v19
    v_lshl_add_u32 v19, v18, 2, v17
    buffer_load_dword v20, v19, s[4:7], 0 offen
    buffer_load_dword v21, v17, s[4:7], 0 offen offset:12
    v_add_u32 v15, 1, v15
    v_mad_u32_u24 v18, v18, 10, 2
    s_waitcnt vmcnt(0)
    v_and_b32 v19, 0x3fff, v20
    v_lshlrev_b32 v19, 3, v19
    buffer_load_dwordx2 v[22:23], v19, s[8:11], s22 offen
    v_mad_u32_u16 v20, v20, 16, s50 op_sel:[1,0,0,0]
    v_bfe_i32 v21, v21, v18, 10
    v_cmp_eq_i32 vcc, -512, v21
    v_cvt_f32_i32 v21, v21
    v_mul_f32 v21, 989872160, v21
    v_cndmask_b32 v21, v21, v29, vcc
    s_waitcnt vmcnt(0)
    v_lshlrev_b32 v24, 16, v22
    v_and_b32 v25, 0xffff0000, v22
    v_lshlrev_b32 v26, 16, v23
    v_and_b32 v27, 0xffff0000, v23
    v_mul_f32 v24, v21, v24
    v_mul_f32 v25, v21, v25
    v_mul_f32 v26, v21, v26
    v_mul_f32 v27, v21, v27
    ds_add_f32 v20, v24
    ds_add_f32 v20, v25 offset:4
    ds_add_f32 v20, v26 offset:8
    ds_add_f32 v20, v27 offset:12
    s_branch L_p2_srec
L_p2_sdone:
    s_mov_b64 exec, -1
    s_add_u32 s25, s25, 2
    s_add_u32 s22, s22, 80000
    s_add_u32 s24, s24, 1
    s_cmp_lt_u32 s24, 16
    s_cbranch_scc1 L_p2_sstep
    s_waitcnt lgkmcnt(0)
    s_barrier
    s_mul_i32 s14, s12, 10240000
    s_mul_i32 s15, s3, 160000
    s_add_u32 s26, s14, s15
    s_add_u32 s26, s26, 251318272
    v_mov_b32 v12, v1
    s_mov_b32 s24, 0
L_p2_sout:
    v_cmp_gt_u32 vcc, 160000, v12
    ds_read_b128 v[8:11], v12
    s_nop 0
    s_and_b64 exec, exec, vcc
    s_cbranch_execz L_p2_sfin
    s_waitcnt lgkmcnt(0)
    buffer_store_dwordx4 v[8:11], v12, s[4:7], s26 offen sc1
    s_waitcnt vmcnt(0)
    v_add_u32 v12, 16384, v12
    s_branch L_p2_sout
L_p2_sfin:
    s_mov_b64 exec, -1
    s_waitcnt vmcnt(0) lgkmcnt(0)
    s_barrier
    s_branch L_p2_signal
L_p2_end:
    s_endpgm
.section .rodata,"a"
.p2align 6
.amdhsa_kernel p1_kernel
  .amdhsa_next_free_vgpr 128
  .amdhsa_next_free_sgpr 96
  .amdhsa_accum_offset 128
  .amdhsa_group_segment_fixed_size 0
  .amdhsa_kernarg_size 112
  .amdhsa_user_sgpr_count 2
  .amdhsa_user_sgpr_kernarg_segment_ptr 1
  .amdhsa_system_sgpr_workgroup_id_x 1
  .amdhsa_float_denorm_mode_32 0
.end_amdhsa_kernel
.p2align 6
.amdhsa_kernel p2_kernel
  .amdhsa_next_free_vgpr 128
  .amdhsa_next_free_sgpr 102
  .amdhsa_accum_offset 128
  .amdhsa_group_segment_fixed_size 0
  .amdhsa_kernarg_size 112
  .amdhsa_user_sgpr_count 2
  .amdhsa_user_sgpr_kernarg_segment_ptr 1
  .amdhsa_system_sgpr_workgroup_id_x 1
  .amdhsa_float_denorm_mode_32 0
.end_amdhsa_kernel
```

```asm
; @launch kernel=p1_kernel grid=(256,1,1) block=(1024,1,1) lds=163840
; @launch kernel=p2_kernel grid=(256,1,1) block=(1024,1,1) lds=163840
.amdgcn_target "amdgcn-amd-amdhsa--gfx950"
.text
.globl p1_kernel
.p2align 8
.type p1_kernel,@function
p1_kernel:
    s_cmp_ge_u32 s2, 256
    s_cbranch_scc1 L_p1_end
    s_load_dwordx2 s[4:5], s[0:1], 104
    s_load_dwordx2 s[8:9], s[0:1], 8
    s_load_dwordx2 s[12:13], s[0:1], 16
    s_load_dwordx2 s[16:17], s[0:1], 32
    s_load_dwordx2 s[28:29], s[0:1], 0
    s_load_dwordx2 s[6:7], s[0:1], 48
    s_load_dwordx2 s[84:85], s[0:1], 96
    v_cmp_gt_u32 vcc, 256, v0
    s_nop 1
    s_cbranch_vccz L_p1_nopf
    s_getpc_b64 s[72:73]
L_p1_kernel_pc_1:
    s_add_u32 s72, s72, L_p1_nopf-L_p1_kernel_pc_1
    s_addc_u32 s73, s73, 0
    v_lshlrev_b32 v14, 7, v0
    v_min_u32 v14, L_p2_end-L_p1_nopf, v14
    global_load_dword v15, v14, s[72:73]
L_p1_nopf:
    v_lshlrev_b32 v1, 4, v0
    v_lshlrev_b32 v2, 3, v0
    v_lshrrev_b32 v6, 6, v0
    v_and_b32 v3, 1023, v1
    v_mov_b32 v4, 1
    v_mov_b32 v5, 0
    v_readfirstlane_b32 s39, v6
    v_cmp_gt_u32 vcc, 784, v0
    s_and_b32 s51, s2, 7
    s_lshl_b32 s51, s51, 0
    s_bfe_u32 s35, s2, 3
    s_add_u32 s51, s51, s35
    s_and_b32 s35, s2, 248
    s_add_u32 s51, s51, s35
    s_lshr_b32 s35, s39, 4
    s_mul_i32 s36, s35, 4177920
    s_lshl_b32 s33, s51, 14
    s_add_u32 s33, s33, s36
    s_lshr_b32 s34, s33, 1
    s_mul_i32 s48, s51, 3840
    s_cmp_ge_u32 s35, 0
    s_cselect_b32 s48, s48, 0
    s_lshr_b32 s49, s48, 1
    s_mov_b64 s[44:45], vcc
    s_waitcnt lgkmcnt(0)
    s_load_dword s3, s[6:7], 0
    s_mov_b32 s10, 163840000
    s_mov_b32 s11, 0x00020000
    s_mov_b32 s14, 163840000
    s_mov_b32 s15, 0x00020000
    s_mov_b32 s18, 81920000
    s_mov_b32 s19, 0x00020000
    s_mov_b32 s86, 256
    s_mov_b32 s87, 0x00020000
    s_mul_i32 s36, s2, 20000
    s_add_u32 s30, s36, 20000
    s_mov_b32 s31, 0x00020000
    s_add_u32 s35, s36, 16384
    buffer_load_dwordx4 v[48:51], v1, s[28:31], s36 offen
    buffer_load_dwordx4 v[52:55], v1, s[28:31], s35 offen
    s_add_u32 s35, s33, 0
    buffer_load_dwordx4 v[16:19], v1, s[8:11], s35 offen nt
    s_add_u32 s35, s33, 0
    buffer_load_dwordx4 v[20:23], v1, s[12:15], s35 offen nt
    s_add_u32 s35, s33, 4194304
    buffer_load_dwordx4 v[24:27], v1, s[8:11], s35 offen nt
    s_add_u32 s35, s33, 4194304
    buffer_load_dwordx4 v[28:31], v1, s[12:15], s35 offen nt
    s_add_u32 s35, s33, 8388608
    buffer_load_dwordx4 v[32:35], v1, s[8:11], s35 offen nt
    s_add_u32 s35, s33, 8388608
    buffer_load_dwordx4 v[36:39], v1, s[12:15], s35 offen nt
    s_add_u32 s35, s33, 12582912
    buffer_load_dwordx4 v[40:43], v1, s[8:11], s35 offen nt
    s_add_u32 s35, s33, 12582912
    buffer_load_dwordx4 v[44:47], v1, s[12:15], s35 offen nt
    s_add_u32 s35, s33, 16777216
    buffer_load_dwordx4 v[72:75], v1, s[8:11], s35 offen nt
    s_add_u32 s35, s33, 16777216
    buffer_load_dwordx4 v[76:79], v1, s[12:15], s35 offen nt
    s_cmp_lg_u32 s39, 0
    s_cbranch_scc1 L_p1_noprobe
    s_cmp_ge_u32 s2, 64
    s_cbranch_scc1 L_p1_noprobe
    s_andn2_b32 s88, s2, 1
    s_mul_i32 s88, s88, 208
    s_lshr_b32 s88, s88, 8
    s_lshl_b32 s88, s88, 22
    s_and_b32 s90, s2, 62
    s_lshl_b32 s90, s90, 14
    s_add_u32 s88, s88, s90
    s_add_u32 s88, s4, s88
    s_addc_u32 s89, s5, 0
    s_and_b32 s95, s2, 1
    s_lshl_b32 s95, s95, 14
    s_xor_b32 s94, s95, 16384
    s_load_dword s91, s[88:89], s94
    s_xor_b32 s94, s94, 8192
    s_load_dword s91, s[88:89], s94
    s_xor_b32 s94, s94, 4352
    s_load_dword s91, s[88:89], s94
    s_xor_b32 s94, s94, 8192
    s_load_dword s91, s[88:89], s94
    s_xor_b32 s94, s94, 4352
    s_getreg_b32 s77, hwreg(HW_REG_XCC_ID, 2, 1)
    s_bfe_u32 s90, s2, 65539
    s_xor_b32 s77, s77, s90
    s_lshl_b32 s90, s90, 13
    s_or_b32 s95, s95, s90
    s_mov_b32 s90, 0x10000
    s_waitcnt lgkmcnt(0)
    s_xor_b32 s94, s95, 0x2000
    s_load_dword s91, s[88:89], s95
    s_load_dwordx2 s[92:93], s[88:89], s94
    s_waitcnt lgkmcnt(2)
    s_getreg_b32 s35, hwreg(HW_REG_IB_STS, 9, 1)
    s_waitcnt lgkmcnt(0)
    s_xor_b32 s35, s35, s77
    s_add_u32 s90, s90, s35
    s_xor_b32 s77, s77, 1
    s_xor_b32 s95, s95, 0x3100
    s_xor_b32 s94, s95, 0x2000
    s_load_dword s91, s[88:89], s95
    s_load_dwordx2 s[92:93], s[88:89], s94
    s_waitcnt lgkmcnt(2)
    s_getreg_b32 s35, hwreg(HW_REG_IB_STS, 9, 1)
    s_waitcnt lgkmcnt(0)
    s_xor_b32 s35, s35, s77
    s_add_u32 s90, s90, s35
    s_xor_b32 s77, s77, 1
    s_xor_b32 s95, s95, 0x3100
    s_getreg_b32 s91, hwreg(HW_REG_XCC_ID, 0, 3)
    v_mov_b32 v8, s90
    s_mov_b64 exec, 1
    buffer_atomic_add v8, off, s[84:87], 0 offset:128 sc0
    s_sub_u32 s91, s91, s2
    s_and_b32 s91, s91, 7
    s_or_b32 s92, s91, 8
    s_waitcnt vmcnt(0)
    v_readfirstlane_b32 s93, v8
    s_nop 0
    s_add_u32 s90, s90, s93
    s_cmp_le_u32 s90, 3145768
    s_cselect_b32 s92, s92, 16
    s_cmp_ge_u32 s90, 3145784
    s_cselect_b32 s92, s91, s92
    s_or_b32 s92, s92, 32
    v_mov_b32 v8, s92
    v_mov_b32 v9, 0
    s_lshr_b32 s90, s90, 16
    s_cmp_lg_u32 s90, 48
    s_cbranch_scc1 L_p1_voted
    buffer_atomic_cmpswap v[8:9], off, s[84:87], 0
L_p1_voted:
    s_mov_b64 exec, -1
L_p1_noprobe:
    s_mov_b32 s20, s4
    s_mov_b32 s21, s5
    s_mov_b32 s22, 0
    s_mov_b32 s23, 0x00020000
    s_add_u32 s24, s4, 222298112
    s_addc_u32 s25, s5, 0
    s_mov_b32 s26, 8540160
    s_mov_b32 s27, 0x00020000
    s_mov_b32 s37, 1492179184
    s_mov_b32 s55, 0
    s_mov_b64 s[76:77], 0
    s_mul_i32 s42, s39, 13
    s_mov_b64 s[72:73], s[4:5]
    s_mov_b32 s74, 0
    s_mov_b32 s75, 0x00020000
    s_mov_b32 s50, 21845
    s_mov_b32 s52, 0x8000
    s_mov_b32 s38, 262400
    s_mov_b32 s43, 0x05040100
    s_mov_b32 s40, 0
    v_mov_b32 v8, 0
    v_mov_b32 v9, 0
    v_mov_b32 v10, 0
    v_mov_b32 v11, 0
    ds_write_b128 v1, v[8:11] offset:0
    v_min_u32 v7, 16, v0
    v_lshlrev_b32 v7, 2, v7
    v_add_u32 v7, 160768, v7
    ds_write_b32 v7, v8
    s_waitcnt lgkmcnt(0)
    s_lshl_b32 s3, s3, 16
    v_mov_b32 v12, s3
    v_mul_f32 v12, 0.15915494, v12
    s_nop 0
    v_readfirstlane_b32 s41, v12
    s_waitcnt vmcnt(10)
    v_mov_b32 v12, 0x3f803f80
    v_and_b32 v48, 0x7fff7fff, v48
    v_and_b32 v49, 0x7fff7fff, v49
    v_and_b32 v50, 0x7fff7fff, v50
    v_and_b32 v51, 0x7fff7fff, v51
    v_and_b32 v52, 0x7fff7fff, v52
    v_and_b32 v53, 0x7fff7fff, v53
    v_and_b32 v54, 0x7fff7fff, v54
    v_and_b32 v55, 0x7fff7fff, v55
    v_pk_max_u16 v8, v8, v48
    v_dot2c_f32_bf16 v9, v48, v12
    v_pk_max_u16 v8, v8, v49
    v_dot2c_f32_bf16 v9, v49, v12
    v_pk_max_u16 v8, v8, v50
    v_dot2c_f32_bf16 v9, v50, v12
    v_pk_max_u16 v8, v8, v51
    v_dot2c_f32_bf16 v9, v51, v12
    v_pk_max_u16 v8, v8, v52
    v_dot2c_f32_bf16 v9, v52, v12
    v_pk_max_u16 v8, v8, v53
    v_dot2c_f32_bf16 v9, v53, v12
    v_pk_max_u16 v8, v8, v54
    v_dot2c_f32_bf16 v9, v54, v12
    v_pk_max_u16 v8, v8, v55
    v_dot2c_f32_bf16 v9, v55, v12
    v_lshrrev_b32 v10, 16, v8
    v_and_b32 v8, 0xffff, v8
    v_max_u32 v8, v8, v10
    s_nop 0
    s_nop 1
    v_max_u32_dpp v8, v8, v8 row_shr:1 row_mask:0xf bank_mask:0xf bound_ctrl:0
    s_nop 1
    v_max_u32_dpp v8, v8, v8 row_shr:2 row_mask:0xf bank_mask:0xf bound_ctrl:0
    s_nop 1
    v_max_u32_dpp v8, v8, v8 row_shr:4 row_mask:0xf bank_mask:0xf bound_ctrl:0
    s_nop 1
    v_max_u32_dpp v8, v8, v8 row_shr:8 row_mask:0xf bank_mask:0xf bound_ctrl:0
    s_nop 1
    v_max_u32_dpp v8, v8, v8 row_bcast:15 row_mask:0xa bank_mask:0xf
    s_nop 1
    v_max_u32_dpp v8, v8, v8 row_bcast:31 row_mask:0xc bank_mask:0xf
    s_nop 1
    v_add_f32_dpp v9, v9, v9 row_shr:1 row_mask:0xf bank_mask:0xf bound_ctrl:0
    s_nop 1
    v_add_f32_dpp v9, v9, v9 row_shr:2 row_mask:0xf bank_mask:0xf bound_ctrl:0
    s_nop 1
    v_add_f32_dpp v9, v9, v9 row_shr:4 row_mask:0xf bank_mask:0xf bound_ctrl:0
    s_nop 1
    v_add_f32_dpp v9, v9, v9 row_shr:8 row_mask:0xf bank_mask:0xf bound_ctrl:0
    s_nop 1
    v_add_f32_dpp v9, v9, v9 row_bcast:15 row_mask:0xa bank_mask:0xf
    s_nop 1
    v_add_f32_dpp v9, v9, v9 row_bcast:31 row_mask:0xc bank_mask:0xf
    s_lshl_b32 s35, s39, 4
    s_add_u32 s35, s35, 160320
    v_mov_b32 v10, s35
    s_mov_b32 exec_lo, 0
    s_brev_b32 exec_hi, 1
    ds_write_b64 v10, v[8:9]
    s_mov_b64 exec, -1
    s_waitcnt lgkmcnt(0)
    s_barrier
    s_cmp_lg_u32 s39, 0
    s_cbranch_scc1 L_p1_first
    v_and_b32 v6, 15, v0
    v_lshlrev_b32 v6, 4, v6
    v_add_u32 v6, 160320, v6
    ds_read_b64 v[8:9], v6
    s_waitcnt lgkmcnt(0)
    s_nop 1
    v_max_u32_dpp v8, v8, v8 row_shr:1 row_mask:0xf bank_mask:0xf bound_ctrl:0
    s_nop 1
    v_max_u32_dpp v8, v8, v8 row_shr:2 row_mask:0xf bank_mask:0xf bound_ctrl:0
    s_nop 1
    v_max_u32_dpp v8, v8, v8 row_shr:4 row_mask:0xf bank_mask:0xf bound_ctrl:0
    s_nop 1
    v_max_u32_dpp v8, v8, v8 row_shr:8 row_mask:0xf bank_mask:0xf bound_ctrl:0
    s_nop 1
    v_add_f32_dpp v9, v9, v9 row_shr:1 row_mask:0xf bank_mask:0xf bound_ctrl:0
    s_nop 1
    v_add_f32_dpp v9, v9, v9 row_shr:2 row_mask:0xf bank_mask:0xf bound_ctrl:0
    s_nop 1
    v_add_f32_dpp v9, v9, v9 row_shr:4 row_mask:0xf bank_mask:0xf bound_ctrl:0
    s_nop 1
    v_add_f32_dpp v9, v9, v9 row_shr:8 row_mask:0xf bank_mask:0xf bound_ctrl:0
    s_lshl_b32 s35, s2, 3
    s_add_u32 s35, s35, 8519680
    v_mov_b32 v6, 0
    s_mov_b64 exec, 0x8000
    buffer_store_dwordx2 v[8:9], v6, s[24:27], s35 offen sc1
    s_lshl_b32 s35, s2, 8
    s_add_u32 s35, s35, 8523776
    buffer_store_dword v6, v6, s[24:27], s35 offen sc1
    s_mov_b64 exec, -1
    s_branch L_p1_first
L_p1_loop:
    s_mov_b64 s[72:73], s[20:21]
    s_mov_b32 s74, s22
    s_cmp_lg_u32 s39, 15
    s_cbranch_scc1 L_p1_kernel_nox_2
    s_waitcnt lgkmcnt(13)
    v_lshlrev_b32 v15, 16, v120
    v_and_b32 v120, 0xffff0000, v120
    v_lshlrev_b32 v121, 16, v121
    v_mul_f32 v15, s41, v15
    v_mul_f32 v120, s41, v120
    v_mul_f32 v121, s41, v121
    v_fract_f32 v15, v15
    v_fract_f32 v120, v120
    v_fract_f32 v121, v121
    v_cos_f32 v15, v15
    v_cos_f32 v120, v120
    v_cos_f32 v121, v121
    v_fmaak_f32 v15, v10, v15, 1262486016
    v_fmaak_f32 v120, v10, v120, 1262486016
    v_fmaak_f32 v121, v10, v121, 1262486016
    v_lshlrev_b32 v15, 22, v15
    v_alignbit_b32 v15, v120, v15, 10
    v_alignbit_b32 v15, v121, v15, 10
    v_xor_b32 v15, 0x80200800, v15
    s_add_u32 s36, s42, 13
    s_and_b32 s35, s36, 3
    s_mul_i32 s35, s35, 1047552
    s_lshl_b32 s36, s36, 20
    s_sub_u32 s36, s36, s35
    buffer_store_dwordx4 v[12:15], v3, s[20:23], s36 offen sc1
L_p1_kernel_nox_2:
    s_waitcnt lgkmcnt(12)
    v_lshlrev_b32 v75, 16, v122
    v_and_b32 v122, 0xffff0000, v122
    v_lshlrev_b32 v123, 16, v123
    v_mul_f32 v75, s41, v75
    v_mul_f32 v122, s41, v122
    v_mul_f32 v123, s41, v123
    v_fract_f32 v75, v75
    v_fract_f32 v122, v122
    v_fract_f32 v123, v123
    v_cos_f32 v75, v75
    v_cos_f32 v122, v122
    v_cos_f32 v123, v123
    v_fmaak_f32 v75, v10, v75, 1262486016
    v_fmaak_f32 v122, v10, v122, 1262486016
    v_fmaak_f32 v123, v10, v123, 1262486016
    v_lshlrev_b32 v75, 22, v75
    v_alignbit_b32 v75, v122, v75, 10
    v_alignbit_b32 v75, v123, v75, 10
    v_xor_b32 v75, 0x80200800, v75
    s_add_u32 s36, s42, 0
    s_and_b32 s35, s36, 3
    s_mul_i32 s35, s35, 1047552
    s_lshl_b32 s36, s36, 20
    s_sub_u32 s36, s36, s35
    buffer_store_dwordx4 v[72:75], v3, s[20:23], s36 offen sc1
    s_waitcnt lgkmcnt(11)
    v_lshlrev_b32 v79, 16, v124
    v_and_b32 v124, 0xffff0000, v124
    v_lshlrev_b32 v125, 16, v125
    v_mul_f32 v79, s41, v79
    v_mul_f32 v124, s41, v124
    v_mul_f32 v125, s41, v125
    v_fract_f32 v79, v79
    v_fract_f32 v124, v124
    v_fract_f32 v125, v125
    v_cos_f32 v79, v79
    v_cos_f32 v124, v124
    v_cos_f32 v125, v125
    v_fmaak_f32 v79, v10, v79, 1262486016
    v_fmaak_f32 v124, v10, v124, 1262486016
    v_fmaak_f32 v125, v10, v125, 1262486016
    v_lshlrev_b32 v79, 22, v79
    v_alignbit_b32 v79, v124, v79, 10
    v_alignbit_b32 v79, v125, v79, 10
    v_xor_b32 v79, 0x80200800, v79
    s_add_u32 s36, s42, 1
    s_and_b32 s35, s36, 3
    s_mul_i32 s35, s35, 1047552
    s_lshl_b32 s36, s36, 20
    s_sub_u32 s36, s36, s35
    buffer_store_dwordx4 v[76:79], v3, s[20:23], s36 offen sc1
    s_waitcnt lgkmcnt(0)
    v_lshlrev_b32 v51, 16, v126
    v_and_b32 v126, 0xffff0000, v126
    v_lshlrev_b32 v127, 16, v127
    v_mul_f32 v51, s41, v51
    v_mul_f32 v126, s41, v126
    v_mul_f32 v127, s41, v127
    v_fract_f32 v51, v51
    v_fract_f32 v126, v126
    v_fract_f32 v127, v127
    v_cos_f32 v51, v51
    v_cos_f32 v126, v126
    v_cos_f32 v127, v127
    v_fmaak_f32 v51, v10, v51, 1262486016
    v_fmaak_f32 v126, v10, v126, 1262486016
    v_fmaak_f32 v127, v10, v127, 1262486016
    v_lshlrev_b32 v51, 22, v51
    v_alignbit_b32 v51, v126, v51, 10
    v_alignbit_b32 v51, v127, v51, 10
    v_xor_b32 v51, 0x80200800, v51
    s_add_u32 s36, s42, 2
    s_and_b32 s35, s36, 3
    s_mul_i32 s35, s35, 1047552
    s_lshl_b32 s36, s36, 20
    s_sub_u32 s36, s36, s35
    buffer_store_dwordx4 v[48:51], v3, s[20:23], s36 offen sc1
    s_add_u32 s35, s33, 16777216
    buffer_load_dwordx4 v[72:75], v1, s[8:11], s35 offen nt
    s_add_u32 s35, s33, 16777216
    buffer_load_dwordx4 v[76:79], v1, s[12:15], s35 offen nt
    v_perm_b32 v6, v20, v16, s43
    v_perm_b32 v7, v21, v17, s43
    v_perm_b32 v8, v22, v18, s43
    v_perm_b32 v9, v23, v19, s43
    v_mul_hi_u32_u24 v16, 429497, v16
    v_mul_hi_u32_u24 v20, 429497, v20
    v_mul_hi_u32_u24 v17, 429497, v17
    v_mul_hi_u32_u24 v21, 429497, v21
    v_mul_hi_u32_u24 v18, 429497, v18
    v_mul_hi_u32_u24 v22, 429497, v22
    v_mul_hi_u32_u24 v19, 429497, v19
    v_mul_hi_u32_u24 v23, 429497, v23
    v_lshl_or_b32 v16, v20, 16, v16
    v_lshl_or_b32 v17, v21, 16, v17
    v_lshl_or_b32 v18, v22, 16, v18
    v_lshl_or_b32 v19, v23, 16, v19
    v_dot2_u32_u16 v20, v16, s38, 0
    v_dot2_u32_u16 v21, v17, s38, 0
    v_dot2_u32_u16 v22, v18, s38, 0
    v_dot2_u32_u16 v23, v19, s38, 0
    v_pk_mad_u16 v6, v16, s37, v6
    v_pk_mad_u16 v7, v17, s37, v7
    v_pk_mad_u16 v8, v18, s37, v8
    v_pk_mad_u16 v9, v19, s37, v9
    ds_add_u32 v20, v4 offset:0
    ds_add_u32 v21, v4 offset:0
    ds_add_u32 v22, v4 offset:0
    ds_add_u32 v23, v4 offset:0
    v_pk_mad_u16 v6, v16, s52, v6 op_sel:[1,0,0] op_sel_hi:[1,1,1]
    v_pk_mad_u16 v7, v17, s52, v7 op_sel:[1,0,0] op_sel_hi:[1,1,1]
    v_pk_mad_u16 v8, v18, s52, v8 op_sel:[1,0,0] op_sel_hi:[1,1,1]
    v_pk_mad_u16 v9, v19, s52, v9 op_sel:[1,0,0] op_sel_hi:[1,1,1]
    v_perm_b32 v121, v23, v22, s43
    v_perm_b32 v120, v21, v20, s43
    v_or_b32 v127, 0x40000000, v6
    v_or_b32 v48, 0x40000000, v7
    v_or_b32 v49, 0x40000000, v8
    v_or_b32 v50, 0x40000000, v9
    v_lshlrev_b32 v83, 16, v100
    v_and_b32 v100, 0xffff0000, v100
    v_lshlrev_b32 v101, 16, v101
    v_mul_f32 v83, s41, v83
    v_mul_f32 v100, s41, v100
    v_mul_f32 v101, s41, v101
    v_fract_f32 v83, v83
    v_fract_f32 v100, v100
    v_fract_f32 v101, v101
    v_cos_f32 v83, v83
    v_cos_f32 v100, v100
    v_cos_f32 v101, v101
    v_fmaak_f32 v83, v10, v83, 1262486016
    v_fmaak_f32 v100, v10, v100, 1262486016
    v_fmaak_f32 v101, v10, v101, 1262486016
    v_lshlrev_b32 v83, 22, v83
    v_alignbit_b32 v83, v100, v83, 10
    v_alignbit_b32 v83, v101, v83, 10
    v_xor_b32 v83, 0x80200800, v83
    s_add_u32 s36, s42, 3
    s_and_b32 s35, s36, 3
    s_mul_i32 s35, s35, 1047552
    s_lshl_b32 s36, s36, 20
    s_sub_u32 s36, s36, s35
    buffer_store_dwordx4 v[80:83], v3, s[20:23], s36 offen sc1
    v_lshlrev_b32 v55, 16, v102
    v_and_b32 v102, 0xffff0000, v102
    v_lshlrev_b32 v103, 16, v103
    v_mul_f32 v55, s41, v55
    v_mul_f32 v102, s41, v102
    v_mul_f32 v103, s41, v103
    v_fract_f32 v55, v55
    v_fract_f32 v102, v102
    v_fract_f32 v103, v103
    v_cos_f32 v55, v55
    v_cos_f32 v102, v102
    v_cos_f32 v103, v103
    v_fmaak_f32 v55, v10, v55, 1262486016
    v_fmaak_f32 v102, v10, v102, 1262486016
    v_fmaak_f32 v103, v10, v103, 1262486016
    v_lshlrev_b32 v55, 22, v55
    v_alignbit_b32 v55, v102, v55, 10
    v_alignbit_b32 v55, v103, v55, 10
    v_xor_b32 v55, 0x80200800, v55
    s_cmp_lg_u32 s40, 3
    s_cbranch_scc1 L_p1_kernel_now_3
    v_mov_b64 v[16:17], v[52:53]
    v_mov_b64 v[18:19], v[54:55]
    s_branch L_p1_kernel_held_4
L_p1_kernel_now_3:
    s_add_u32 s36, s42, 4
    s_and_b32 s35, s36, 3
    s_mul_i32 s35, s35, 1047552
    s_lshl_b32 s36, s36, 20
    s_sub_u32 s36, s36, s35
    buffer_store_dwordx4 v[52:55], v3, s[20:23], s36 offen sc1
L_p1_kernel_held_4:
    s_add_u32 s35, s33, 20971520
    buffer_load_dwordx4 v[80:83], v1, s[8:11], s35 offen nt
    s_add_u32 s35, s33, 20971520
    buffer_load_dwordx4 v[100:103], v1, s[12:15], s35 offen nt
    v_lshlrev_b32 v87, 16, v104
    v_and_b32 v104, 0xffff0000, v104
    v_lshlrev_b32 v105, 16, v105
    v_mul_f32 v87, s41, v87
    v_mul_f32 v104, s41, v104
    v_mul_f32 v105, s41, v105
    v_fract_f32 v87, v87
    v_fract_f32 v104, v104
    v_fract_f32 v105, v105
    v_cos_f32 v87, v87
    v_cos_f32 v104, v104
    v_cos_f32 v105, v105
    v_fmaak_f32 v87, v10, v87, 1262486016
    v_fmaak_f32 v104, v10, v104, 1262486016
    v_fmaak_f32 v105, v10, v105, 1262486016
    v_lshlrev_b32 v87, 22, v87
    v_alignbit_b32 v87, v104, v87, 10
    v_alignbit_b32 v87, v105, v87, 10
    v_xor_b32 v87, 0x80200800, v87
    s_add_u32 s36, s42, 5
    s_and_b32 s35, s36, 3
    s_mul_i32 s35, s35, 1047552
    s_lshl_b32 s36, s36, 20
    s_sub_u32 s36, s36, s35
    buffer_store_dwordx4 v[84:87], v3, s[20:23], s36 offen sc1
    v_lshlrev_b32 v59, 16, v106
    v_and_b32 v106, 0xffff0000, v106
    v_lshlrev_b32 v107, 16, v107
    v_mul_f32 v59, s41, v59
    v_mul_f32 v106, s41, v106
    v_mul_f32 v107, s41, v107
    v_fract_f32 v59, v59
    v_fract_f32 v106, v106
    v_fract_f32 v107, v107
    v_cos_f32 v59, v59
    v_cos_f32 v106, v106
    v_cos_f32 v107, v107
    v_fmaak_f32 v59, v10, v59, 1262486016
    v_fmaak_f32 v106, v10, v106, 1262486016
    v_fmaak_f32 v107, v10, v107, 1262486016
    v_lshlrev_b32 v59, 22, v59
    v_alignbit_b32 v59, v106, v59, 10
    v_alignbit_b32 v59, v107, v59, 10
    v_xor_b32 v59, 0x80200800, v59
    s_cmp_lg_u32 s40, 3
    s_cbranch_scc1 L_p1_kernel_now_5
    v_mov_b64 v[20:21], v[56:57]
    v_mov_b64 v[22:23], v[58:59]
    s_branch L_p1_kernel_held_6
L_p1_kernel_now_5:
    s_add_u32 s36, s42, 6
    s_and_b32 s35, s36, 3
    s_mul_i32 s35, s35, 1047552
    s_lshl_b32 s36, s36, 20
    s_sub_u32 s36, s36, s35
    buffer_store_dwordx4 v[56:59], v3, s[20:23], s36 offen sc1
L_p1_kernel_held_6:
    s_add_u32 s35, s33, 25165824
    buffer_load_dwordx4 v[84:87], v1, s[8:11], s35 offen nt
    s_add_u32 s35, s33, 25165824
    buffer_load_dwordx4 v[104:107], v1, s[12:15], s35 offen nt
    v_perm_b32 v6, v28, v24, s43
    v_perm_b32 v7, v29, v25, s43
    v_perm_b32 v8, v30, v26, s43
    v_perm_b32 v9, v31, v27, s43
    v_mul_hi_u32_u24 v24, 429497, v24
    v_mul_hi_u32_u24 v28, 429497, v28
    v_mul_hi_u32_u24 v25, 429497, v25
    v_mul_hi_u32_u24 v29, 429497, v29
    v_mul_hi_u32_u24 v26, 429497, v26
    v_mul_hi_u32_u24 v30, 429497, v30
    v_mul_hi_u32_u24 v27, 429497, v27
    v_mul_hi_u32_u24 v31, 429497, v31
    v_lshl_or_b32 v24, v28, 16, v24
    v_lshl_or_b32 v25, v29, 16, v25
    v_lshl_or_b32 v26, v30, 16, v26
    v_lshl_or_b32 v27, v31, 16, v27
    v_dot2_u32_u16 v28, v24, s38, 0
    v_dot2_u32_u16 v29, v25, s38, 0
    v_dot2_u32_u16 v30, v26, s38, 0
    v_dot2_u32_u16 v31, v27, s38, 0
    v_pk_mad_u16 v6, v24, s37, v6
    v_pk_mad_u16 v7, v25, s37, v7
    v_pk_mad_u16 v8, v26, s37, v8
    v_pk_mad_u16 v9, v27, s37, v9
    ds_add_u32 v28, v4 offset:0
    ds_add_u32 v29, v4 offset:0
    ds_add_u32 v30, v4 offset:0
    ds_add_u32 v31, v4 offset:0
    v_pk_mad_u16 v6, v24, s52, v6 op_sel:[1,0,0] op_sel_hi:[1,1,1]
    v_pk_mad_u16 v7, v25, s52, v7 op_sel:[1,0,0] op_sel_hi:[1,1,1]
    v_pk_mad_u16 v8, v26, s52, v8 op_sel:[1,0,0] op_sel_hi:[1,1,1]
    v_pk_mad_u16 v9, v27, s52, v9 op_sel:[1,0,0] op_sel_hi:[1,1,1]
    v_perm_b32 v123, v31, v30, s43
    v_perm_b32 v122, v29, v28, s43
    v_or_b32 v52, 0x40000000, v6
    v_or_b32 v53, 0x40000000, v7
    v_or_b32 v54, 0x40000000, v8
    v_or_b32 v56, 0x40000000, v9
    v_lshlrev_b32 v91, 16, v108
    v_and_b32 v108, 0xffff0000, v108
    v_lshlrev_b32 v109, 16, v109
    v_mul_f32 v91, s41, v91
    v_mul_f32 v108, s41, v108
    v_mul_f32 v109, s41, v109
    v_fract_f32 v91, v91
    v_fract_f32 v108, v108
    v_fract_f32 v109, v109
    v_cos_f32 v91, v91
    v_cos_f32 v108, v108
    v_cos_f32 v109, v109
    v_fmaak_f32 v91, v10, v91, 1262486016
    v_fmaak_f32 v108, v10, v108, 1262486016
    v_fmaak_f32 v109, v10, v109, 1262486016
    v_lshlrev_b32 v91, 22, v91
    v_alignbit_b32 v91, v108, v91, 10
    v_alignbit_b32 v91, v109, v91, 10
    v_xor_b32 v91, 0x80200800, v91
    s_cmp_lg_u32 s40, 3
    s_cbranch_scc1 L_p1_kernel_now_7
    v_mov_b64 v[24:25], v[88:89]
    v_mov_b64 v[26:27], v[90:91]
    s_branch L_p1_kernel_held_8
L_p1_kernel_now_7:
    s_add_u32 s36, s42, 7
    s_and_b32 s35, s36, 3
    s_mul_i32 s35, s35, 1047552
    s_lshl_b32 s36, s36, 20
    s_sub_u32 s36, s36, s35
    buffer_store_dwordx4 v[88:91], v3, s[20:23], s36 offen sc1
L_p1_kernel_held_8:
    v_lshlrev_b32 v63, 16, v110
    v_and_b32 v110, 0xffff0000, v110
    v_lshlrev_b32 v111, 16, v111
    v_mul_f32 v63, s41, v63
    v_mul_f32 v110, s41, v110
    v_mul_f32 v111, s41, v111
    v_fract_f32 v63, v63
    v_fract_f32 v110, v110
    v_fract_f32 v111, v111
    v_cos_f32 v63, v63
    v_cos_f32 v110, v110
    v_cos_f32 v111, v111
    v_fmaak_f32 v63, v10, v63, 1262486016
    v_fmaak_f32 v110, v10, v110, 1262486016
    v_fmaak_f32 v111, v10, v111, 1262486016
    v_lshlrev_b32 v63, 22, v63
    v_alignbit_b32 v63, v110, v63, 10
    v_alignbit_b32 v63, v111, v63, 10
    v_xor_b32 v63, 0x80200800, v63
    s_cmp_lg_u32 s40, 3
    s_cbranch_scc1 L_p1_kernel_now_9
    v_mov_b64 v[28:29], v[60:61]
    v_mov_b64 v[30:31], v[62:63]
    s_branch L_p1_kernel_held_10
L_p1_kernel_now_9:
    s_add_u32 s36, s42, 8
    s_and_b32 s35, s36, 3
    s_mul_i32 s35, s35, 1047552
    s_lshl_b32 s36, s36, 20
    s_sub_u32 s36, s36, s35
    buffer_store_dwordx4 v[60:63], v3, s[20:23], s36 offen sc1
L_p1_kernel_held_10:
    s_add_u32 s35, s33, 29360128
    buffer_load_dwordx4 v[88:91], v1, s[8:11], s35 offen nt
    s_add_u32 s35, s33, 29360128
    buffer_load_dwordx4 v[108:111], v1, s[12:15], s35 offen nt
    s_waitcnt vmcnt(15)
    v_perm_b32 v6, v36, v32, s43
    v_perm_b32 v7, v37, v33, s43
    v_perm_b32 v8, v38, v34, s43
    v_perm_b32 v9, v39, v35, s43
    v_mul_hi_u32_u24 v32, 429497, v32
    v_mul_hi_u32_u24 v36, 429497, v36
    v_mul_hi_u32_u24 v33, 429497, v33
    v_mul_hi_u32_u24 v37, 429497, v37
    v_mul_hi_u32_u24 v34, 429497, v34
    v_mul_hi_u32_u24 v38, 429497, v38
    v_mul_hi_u32_u24 v35, 429497, v35
    v_mul_hi_u32_u24 v39, 429497, v39
    v_lshl_or_b32 v32, v36, 16, v32
    v_lshl_or_b32 v33, v37, 16, v33
    v_lshl_or_b32 v34, v38, 16, v34
    v_lshl_or_b32 v35, v39, 16, v35
    v_dot2_u32_u16 v36, v32, s38, 0
    v_dot2_u32_u16 v37, v33, s38, 0
    v_dot2_u32_u16 v38, v34, s38, 0
    v_dot2_u32_u16 v39, v35, s38, 0
    v_pk_mad_u16 v6, v32, s37, v6
    v_pk_mad_u16 v7, v33, s37, v7
    v_pk_mad_u16 v8, v34, s37, v8
    v_pk_mad_u16 v9, v35, s37, v9
    ds_add_u32 v36, v4 offset:0
    ds_add_u32 v37, v4 offset:0
    ds_add_u32 v38, v4 offset:0
    ds_add_u32 v39, v4 offset:0
    v_pk_mad_u16 v6, v32, s52, v6 op_sel:[1,0,0] op_sel_hi:[1,1,1]
    v_pk_mad_u16 v7, v33, s52, v7 op_sel:[1,0,0] op_sel_hi:[1,1,1]
    v_pk_mad_u16 v8, v34, s52, v8 op_sel:[1,0,0] op_sel_hi:[1,1,1]
    v_pk_mad_u16 v9, v35, s52, v9 op_sel:[1,0,0] op_sel_hi:[1,1,1]
    v_perm_b32 v125, v39, v38, s43
    v_perm_b32 v124, v37, v36, s43
    v_or_b32 v57, 0x40000000, v6
    v_or_b32 v58, 0x40000000, v7
    v_or_b32 v60, 0x40000000, v8
    v_or_b32 v61, 0x40000000, v9
    v_lshlrev_b32 v95, 16, v112
    v_and_b32 v112, 0xffff0000, v112
    v_lshlrev_b32 v113, 16, v113
    v_mul_f32 v95, s41, v95
    v_mul_f32 v112, s41, v112
    v_mul_f32 v113, s41, v113
    v_fract_f32 v95, v95
    v_fract_f32 v112, v112
    v_fract_f32 v113, v113
    v_cos_f32 v95, v95
    v_cos_f32 v112, v112
    v_cos_f32 v113, v113
    v_fmaak_f32 v95, v10, v95, 1262486016
    v_fmaak_f32 v112, v10, v112, 1262486016
    v_fmaak_f32 v113, v10, v113, 1262486016
    v_lshlrev_b32 v95, 22, v95
    v_alignbit_b32 v95, v112, v95, 10
    v_alignbit_b32 v95, v113, v95, 10
    v_xor_b32 v95, 0x80200800, v95
    s_cmp_lg_u32 s40, 3
    s_cbranch_scc1 L_p1_kernel_now_11
    v_mov_b64 v[32:33], v[92:93]
    v_mov_b64 v[34:35], v[94:95]
    s_branch L_p1_kernel_held_12
L_p1_kernel_now_11:
    s_add_u32 s36, s42, 9
    s_and_b32 s35, s36, 3
    s_mul_i32 s35, s35, 1047552
    s_lshl_b32 s36, s36, 20
    s_sub_u32 s36, s36, s35
    buffer_store_dwordx4 v[92:95], v3, s[20:23], s36 offen sc1
L_p1_kernel_held_12:
    v_lshlrev_b32 v67, 16, v114
    v_and_b32 v114, 0xffff0000, v114
    v_lshlrev_b32 v115, 16, v115
    v_mul_f32 v67, s41, v67
    v_mul_f32 v114, s41, v114
    v_mul_f32 v115, s41, v115
    v_fract_f32 v67, v67
    v_fract_f32 v114, v114
    v_fract_f32 v115, v115
    v_cos_f32 v67, v67
    v_cos_f32 v114, v114
    v_cos_f32 v115, v115
    v_fmaak_f32 v67, v10, v67, 1262486016
    v_fmaak_f32 v114, v10, v114, 1262486016
    v_fmaak_f32 v115, v10, v115, 1262486016
    v_lshlrev_b32 v67, 22, v67
    v_alignbit_b32 v67, v114, v67, 10
    v_alignbit_b32 v67, v115, v67, 10
    v_xor_b32 v67, 0x80200800, v67
    s_cmp_lg_u32 s40, 3
    s_cbranch_scc1 L_p1_kernel_now_13
    v_mov_b64 v[36:37], v[64:65]
    v_mov_b64 v[38:39], v[66:67]
    s_branch L_p1_kernel_held_14
L_p1_kernel_now_13:
    s_add_u32 s36, s42, 10
    s_and_b32 s35, s36, 3
    s_mul_i32 s35, s35, 1047552
    s_lshl_b32 s36, s36, 20
    s_sub_u32 s36, s36, s35
    buffer_store_dwordx4 v[64:67], v3, s[20:23], s36 offen sc1
L_p1_kernel_held_14:
    s_add_u32 s35, s33, 33554432
    buffer_load_dwordx4 v[92:95], v1, s[8:11], s35 offen nt
    s_add_u32 s35, s33, 33554432
    buffer_load_dwordx4 v[112:115], v1, s[12:15], s35 offen nt
    s_waitcnt vmcnt(15)
    v_perm_b32 v6, v44, v40, s43
    v_perm_b32 v7, v45, v41, s43
    v_perm_b32 v8, v46, v42, s43
    v_perm_b32 v9, v47, v43, s43
    v_mul_hi_u32_u24 v40, 429497, v40
    v_mul_hi_u32_u24 v44, 429497, v44
    v_mul_hi_u32_u24 v41, 429497, v41
    v_mul_hi_u32_u24 v45, 429497, v45
    v_mul_hi_u32_u24 v42, 429497, v42
    v_mul_hi_u32_u24 v46, 429497, v46
    v_mul_hi_u32_u24 v43, 429497, v43
    v_mul_hi_u32_u24 v47, 429497, v47
    v_lshl_or_b32 v40, v44, 16, v40
    v_lshl_or_b32 v41, v45, 16, v41
    v_lshl_or_b32 v42, v46, 16, v42
    v_lshl_or_b32 v43, v47, 16, v43
    v_dot2_u32_u16 v44, v40, s38, 0
    v_dot2_u32_u16 v45, v41, s38, 0
    v_dot2_u32_u16 v46, v42, s38, 0
    v_dot2_u32_u16 v47, v43, s38, 0
    v_pk_mad_u16 v6, v40, s37, v6
    v_pk_mad_u16 v7, v41, s37, v7
    v_pk_mad_u16 v8, v42, s37, v8
    v_pk_mad_u16 v9, v43, s37, v9
    ds_add_u32 v44, v4 offset:0
    ds_add_u32 v45, v4 offset:0
    ds_add_u32 v46, v4 offset:0
    ds_add_u32 v47, v4 offset:0
    v_pk_mad_u16 v6, v40, s52, v6 op_sel:[1,0,0] op_sel_hi:[1,1,1]
    v_pk_mad_u16 v7, v41, s52, v7 op_sel:[1,0,0] op_sel_hi:[1,1,1]
    v_pk_mad_u16 v8, v42, s52, v8 op_sel:[1,0,0] op_sel_hi:[1,1,1]
    v_pk_mad_u16 v9, v43, s52, v9 op_sel:[1,0,0] op_sel_hi:[1,1,1]
    v_perm_b32 v51, v47, v46, s43
    v_perm_b32 v126, v45, v44, s43
    v_or_b32 v62, 0x40000000, v6
    v_or_b32 v64, 0x40000000, v7
    v_or_b32 v65, 0x40000000, v8
    v_or_b32 v66, 0x40000000, v9
    v_lshlrev_b32 v99, 16, v116
    v_and_b32 v116, 0xffff0000, v116
    v_lshlrev_b32 v117, 16, v117
    v_mul_f32 v99, s41, v99
    v_mul_f32 v116, s41, v116
    v_mul_f32 v117, s41, v117
    v_fract_f32 v99, v99
    v_fract_f32 v116, v116
    v_fract_f32 v117, v117
    v_cos_f32 v99, v99
    v_cos_f32 v116, v116
    v_cos_f32 v117, v117
    v_fmaak_f32 v99, v10, v99, 1262486016
    v_fmaak_f32 v116, v10, v116, 1262486016
    v_fmaak_f32 v117, v10, v117, 1262486016
    v_lshlrev_b32 v99, 22, v99
    v_alignbit_b32 v99, v116, v99, 10
    v_alignbit_b32 v99, v117, v99, 10
    v_xor_b32 v99, 0x80200800, v99
    s_cmp_lg_u32 s40, 3
    s_cbranch_scc1 L_p1_kernel_now_15
    v_mov_b64 v[40:41], v[96:97]
    v_mov_b64 v[42:43], v[98:99]
    s_branch L_p1_kernel_held_16
L_p1_kernel_now_15:
    s_add_u32 s36, s42, 11
    s_and_b32 s35, s36, 3
    s_mul_i32 s35, s35, 1047552
    s_lshl_b32 s36, s36, 20
    s_sub_u32 s36, s36, s35
    buffer_store_dwordx4 v[96:99], v3, s[20:23], s36 offen sc1
L_p1_kernel_held_16:
    v_lshlrev_b32 v71, 16, v118
    v_and_b32 v118, 0xffff0000, v118
    v_lshlrev_b32 v119, 16, v119
    v_mul_f32 v71, s41, v71
    v_mul_f32 v118, s41, v118
    v_mul_f32 v119, s41, v119
    v_fract_f32 v71, v71
    v_fract_f32 v118, v118
    v_fract_f32 v119, v119
    v_cos_f32 v71, v71
    v_cos_f32 v118, v118
    v_cos_f32 v119, v119
    v_fmaak_f32 v71, v10, v71, 1262486016
    v_fmaak_f32 v118, v10, v118, 1262486016
    v_fmaak_f32 v119, v10, v119, 1262486016
    v_lshlrev_b32 v71, 22, v71
    v_alignbit_b32 v71, v118, v71, 10
    v_alignbit_b32 v71, v119, v71, 10
    v_xor_b32 v71, 0x80200800, v71
    s_cmp_lg_u32 s40, 3
    s_cbranch_scc1 L_p1_kernel_now_17
    v_mov_b64 v[44:45], v[68:69]
    v_mov_b64 v[46:47], v[70:71]
    s_branch L_p1_kernel_held_18
L_p1_kernel_now_17:
    s_add_u32 s36, s42, 12
    s_and_b32 s35, s36, 3
    s_mul_i32 s35, s35, 1047552
    s_lshl_b32 s36, s36, 20
    s_sub_u32 s36, s36, s35
    buffer_store_dwordx4 v[68:71], v3, s[20:23], s36 offen sc1
L_p1_kernel_held_18:
    s_add_u32 s35, s33, 37748736
    s_sub_u32 s35, s35, s48
    v_cndmask_b32 v96, 2.0, v1, s[44:45]
    buffer_load_dwordx4 v[96:99], v96, s[8:11], s35 offen nt
    s_add_u32 s35, s33, 37748736
    s_sub_u32 s35, s35, s48
    v_cndmask_b32 v116, 2.0, v1, s[44:45]
    buffer_load_dwordx4 v[116:119], v116, s[12:15], s35 offen nt
    s_branch L_p1_join
L_p1_first:
    s_add_u32 s35, s33, 20971520
    buffer_load_dwordx4 v[80:83], v1, s[8:11], s35 offen nt
    s_add_u32 s35, s33, 20971520
    buffer_load_dwordx4 v[100:103], v1, s[12:15], s35 offen nt
    s_add_u32 s35, s33, 25165824
    buffer_load_dwordx4 v[84:87], v1, s[8:11], s35 offen nt
    s_add_u32 s35, s33, 25165824
    buffer_load_dwordx4 v[104:107], v1, s[12:15], s35 offen nt
    s_add_u32 s35, s33, 29360128
    buffer_load_dwordx4 v[88:91], v1, s[8:11], s35 offen nt
    s_add_u32 s35, s33, 29360128
    buffer_load_dwordx4 v[108:111], v1, s[12:15], s35 offen nt
    s_add_u32 s35, s33, 33554432
    buffer_load_dwordx4 v[92:95], v1, s[8:11], s35 offen nt
    s_add_u32 s35, s33, 33554432
    buffer_load_dwordx4 v[112:115], v1, s[12:15], s35 offen nt
    s_add_u32 s35, s33, 37748736
    s_sub_u32 s35, s35, s48
    v_cndmask_b32 v96, 2.0, v1, s[44:45]
    buffer_load_dwordx4 v[96:99], v96, s[8:11], s35 offen nt
    s_add_u32 s35, s33, 37748736
    s_sub_u32 s35, s35, s48
    v_cndmask_b32 v116, 2.0, v1, s[44:45]
    buffer_load_dwordx4 v[116:119], v116, s[12:15], s35 offen nt
    s_cmp_lg_u32 s39, 15
    s_cbranch_scc1 L_p1_nofetch
    buffer_load_dword v12, off, s[84:87], 0 sc1
L_p1_nofetch:
    s_waitcnt vmcnt(18)
    v_perm_b32 v6, v20, v16, s43
    v_perm_b32 v7, v21, v17, s43
    v_perm_b32 v8, v22, v18, s43
    v_perm_b32 v9, v23, v19, s43
    v_mul_hi_u32_u24 v16, 429497, v16
    v_mul_hi_u32_u24 v20, 429497, v20
    v_mul_hi_u32_u24 v17, 429497, v17
    v_mul_hi_u32_u24 v21, 429497, v21
    v_mul_hi_u32_u24 v18, 429497, v18
    v_mul_hi_u32_u24 v22, 429497, v22
    v_mul_hi_u32_u24 v19, 429497, v19
    v_mul_hi_u32_u24 v23, 429497, v23
    v_lshl_or_b32 v16, v20, 16, v16
    v_lshl_or_b32 v17, v21, 16, v17
    v_lshl_or_b32 v18, v22, 16, v18
    v_lshl_or_b32 v19, v23, 16, v19
    v_dot2_u32_u16 v20, v16, s38, 0
    v_dot2_u32_u16 v21, v17, s38, 0
    v_dot2_u32_u16 v22, v18, s38, 0
    v_dot2_u32_u16 v23, v19, s38, 0
    v_pk_mad_u16 v6, v16, s37, v6
    v_pk_mad_u16 v7, v17, s37, v7
    v_pk_mad_u16 v8, v18, s37, v8
    v_pk_mad_u16 v9, v19, s37, v9
    ds_add_u32 v20, v4 offset:0
    ds_add_u32 v21, v4 offset:0
    ds_add_u32 v22, v4 offset:0
    ds_add_u32 v23, v4 offset:0
    v_pk_mad_u16 v6, v16, s52, v6 op_sel:[1,0,0] op_sel_hi:[1,1,1]
    v_pk_mad_u16 v7, v17, s52, v7 op_sel:[1,0,0] op_sel_hi:[1,1,1]
    v_pk_mad_u16 v8, v18, s52, v8 op_sel:[1,0,0] op_sel_hi:[1,1,1]
    v_pk_mad_u16 v9, v19, s52, v9 op_sel:[1,0,0] op_sel_hi:[1,1,1]
    v_perm_b32 v121, v23, v22, s43
    v_perm_b32 v120, v21, v20, s43
    v_or_b32 v127, 0x40000000, v6
    v_or_b32 v48, 0x40000000, v7
    v_or_b32 v49, 0x40000000, v8
    v_or_b32 v50, 0x40000000, v9
    s_waitcnt vmcnt(16)
    v_perm_b32 v6, v28, v24, s43
    v_perm_b32 v7, v29, v25, s43
    v_perm_b32 v8, v30, v26, s43
    v_perm_b32 v9, v31, v27, s43
    v_mul_hi_u32_u24 v24, 429497, v24
    v_mul_hi_u32_u24 v28, 429497, v28
    v_mul_hi_u32_u24 v25, 429497, v25
    v_mul_hi_u32_u24 v29, 429497, v29
    v_mul_hi_u32_u24 v26, 429497, v26
    v_mul_hi_u32_u24 v30, 429497, v30
    v_mul_hi_u32_u24 v27, 429497, v27
    v_mul_hi_u32_u24 v31, 429497, v31
    v_lshl_or_b32 v24, v28, 16, v24
    v_lshl_or_b32 v25, v29, 16, v25
    v_lshl_or_b32 v26, v30, 16, v26
    v_lshl_or_b32 v27, v31, 16, v27
    v_dot2_u32_u16 v28, v24, s38, 0
    v_dot2_u32_u16 v29, v25, s38, 0
    v_dot2_u32_u16 v30, v26, s38, 0
    v_dot2_u32_u16 v31, v27, s38, 0
    v_pk_mad_u16 v6, v24, s37, v6
    v_pk_mad_u16 v7, v25, s37, v7
    v_pk_mad_u16 v8, v26, s37, v8
    v_pk_mad_u16 v9, v27, s37, v9
    ds_add_u32 v28, v4 offset:0
    ds_add_u32 v29, v4 offset:0
    ds_add_u32 v30, v4 offset:0
    ds_add_u32 v31, v4 offset:0
    v_pk_mad_u16 v6, v24, s52, v6 op_sel:[1,0,0] op_sel_hi:[1,1,1]
    v_pk_mad_u16 v7, v25, s52, v7 op_sel:[1,0,0] op_sel_hi:[1,1,1]
    v_pk_mad_u16 v8, v26, s52, v8 op_sel:[1,0,0] op_sel_hi:[1,1,1]
    v_pk_mad_u16 v9, v27, s52, v9 op_sel:[1,0,0] op_sel_hi:[1,1,1]
    v_perm_b32 v123, v31, v30, s43
    v_perm_b32 v122, v29, v28, s43
    v_or_b32 v52, 0x40000000, v6
    v_or_b32 v53, 0x40000000, v7
    v_or_b32 v54, 0x40000000, v8
    v_or_b32 v56, 0x40000000, v9
    s_waitcnt vmcnt(14)
    v_perm_b32 v6, v36, v32, s43
    v_perm_b32 v7, v37, v33, s43
    v_perm_b32 v8, v38, v34, s43
    v_perm_b32 v9, v39, v35, s43
    v_mul_hi_u32_u24 v32, 429497, v32
    v_mul_hi_u32_u24 v36, 429497, v36
    v_mul_hi_u32_u24 v33, 429497, v33
    v_mul_hi_u32_u24 v37, 429497, v37
    v_mul_hi_u32_u24 v34, 429497, v34
    v_mul_hi_u32_u24 v38, 429497, v38
    v_mul_hi_u32_u24 v35, 429497, v35
    v_mul_hi_u32_u24 v39, 429497, v39
    v_lshl_or_b32 v32, v36, 16, v32
    v_lshl_or_b32 v33, v37, 16, v33
    v_lshl_or_b32 v34, v38, 16, v34
    v_lshl_or_b32 v35, v39, 16, v35
    v_dot2_u32_u16 v36, v32, s38, 0
    v_dot2_u32_u16 v37, v33, s38, 0
    v_dot2_u32_u16 v38, v34, s38, 0
    v_dot2_u32_u16 v39, v35, s38, 0
    v_pk_mad_u16 v6, v32, s37, v6
    v_pk_mad_u16 v7, v33, s37, v7
    v_pk_mad_u16 v8, v34, s37, v8
    v_pk_mad_u16 v9, v35, s37, v9
    ds_add_u32 v36, v4 offset:0
    ds_add_u32 v37, v4 offset:0
    ds_add_u32 v38, v4 offset:0
    ds_add_u32 v39, v4 offset:0
    v_pk_mad_u16 v6, v32, s52, v6 op_sel:[1,0,0] op_sel_hi:[1,1,1]
    v_pk_mad_u16 v7, v33, s52, v7 op_sel:[1,0,0] op_sel_hi:[1,1,1]
    v_pk_mad_u16 v8, v34, s52, v8 op_sel:[1,0,0] op_sel_hi:[1,1,1]
    v_pk_mad_u16 v9, v35, s52, v9 op_sel:[1,0,0] op_sel_hi:[1,1,1]
    v_perm_b32 v125, v39, v38, s43
    v_perm_b32 v124, v37, v36, s43
    v_or_b32 v57, 0x40000000, v6
    v_or_b32 v58, 0x40000000, v7
    v_or_b32 v60, 0x40000000, v8
    v_or_b32 v61, 0x40000000, v9
    s_waitcnt vmcnt(12)
    v_perm_b32 v6, v44, v40, s43
    v_perm_b32 v7, v45, v41, s43
    v_perm_b32 v8, v46, v42, s43
    v_perm_b32 v9, v47, v43, s43
    v_mul_hi_u32_u24 v40, 429497, v40
    v_mul_hi_u32_u24 v44, 429497, v44
    v_mul_hi_u32_u24 v41, 429497, v41
    v_mul_hi_u32_u24 v45, 429497, v45
    v_mul_hi_u32_u24 v42, 429497, v42
    v_mul_hi_u32_u24 v46, 429497, v46
    v_mul_hi_u32_u24 v43, 429497, v43
    v_mul_hi_u32_u24 v47, 429497, v47
    v_lshl_or_b32 v40, v44, 16, v40
    v_lshl_or_b32 v41, v45, 16, v41
    v_lshl_or_b32 v42, v46, 16, v42
    v_lshl_or_b32 v43, v47, 16, v43
    v_dot2_u32_u16 v44, v40, s38, 0
    v_dot2_u32_u16 v45, v41, s38, 0
    v_dot2_u32_u16 v46, v42, s38, 0
    v_dot2_u32_u16 v47, v43, s38, 0
    v_pk_mad_u16 v6, v40, s37, v6
    v_pk_mad_u16 v7, v41, s37, v7
    v_pk_mad_u16 v8, v42, s37, v8
    v_pk_mad_u16 v9, v43, s37, v9
    ds_add_u32 v44, v4 offset:0
    ds_add_u32 v45, v4 offset:0
    ds_add_u32 v46, v4 offset:0
    ds_add_u32 v47, v4 offset:0
    v_pk_mad_u16 v6, v40, s52, v6 op_sel:[1,0,0] op_sel_hi:[1,1,1]
    v_pk_mad_u16 v7, v41, s52, v7 op_sel:[1,0,0] op_sel_hi:[1,1,1]
    v_pk_mad_u16 v8, v42, s52, v8 op_sel:[1,0,0] op_sel_hi:[1,1,1]
    v_pk_mad_u16 v9, v43, s52, v9 op_sel:[1,0,0] op_sel_hi:[1,1,1]
    v_perm_b32 v51, v47, v46, s43
    v_perm_b32 v126, v45, v44, s43
    v_or_b32 v62, 0x40000000, v6
    v_or_b32 v64, 0x40000000, v7
    v_or_b32 v65, 0x40000000, v8
    v_or_b32 v66, 0x40000000, v9
L_p1_join:
    s_waitcnt vmcnt(10)
    v_perm_b32 v6, v76, v72, s43
    v_perm_b32 v7, v77, v73, s43
    v_perm_b32 v8, v78, v74, s43
    v_perm_b32 v9, v79, v75, s43
    v_mul_hi_u32_u24 v72, 429497, v72
    v_mul_hi_u32_u24 v76, 429497, v76
    v_mul_hi_u32_u24 v73, 429497, v73
    v_mul_hi_u32_u24 v77, 429497, v77
    v_mul_hi_u32_u24 v74, 429497, v74
    v_mul_hi_u32_u24 v78, 429497, v78
    v_mul_hi_u32_u24 v75, 429497, v75
    v_mul_hi_u32_u24 v79, 429497, v79
    v_lshl_or_b32 v72, v76, 16, v72
    v_lshl_or_b32 v73, v77, 16, v73
    v_lshl_or_b32 v74, v78, 16, v74
    v_lshl_or_b32 v75, v79, 16, v75
    v_dot2_u32_u16 v76, v72, s38, 0
    v_dot2_u32_u16 v77, v73, s38, 0
    v_dot2_u32_u16 v78, v74, s38, 0
    v_dot2_u32_u16 v79, v75, s38, 0
    v_pk_mad_u16 v6, v72, s37, v6
    v_pk_mad_u16 v7, v73, s37, v7
    v_pk_mad_u16 v8, v74, s37, v8
    v_pk_mad_u16 v9, v75, s37, v9
    ds_add_u32 v76, v4 offset:0
    ds_add_u32 v77, v4 offset:0
    ds_add_u32 v78, v4 offset:0
    ds_add_u32 v79, v4 offset:0
    v_pk_mad_u16 v6, v72, s52, v6 op_sel:[1,0,0] op_sel_hi:[1,1,1]
    v_pk_mad_u16 v7, v73, s52, v7 op_sel:[1,0,0] op_sel_hi:[1,1,1]
    v_pk_mad_u16 v8, v74, s52, v8 op_sel:[1,0,0] op_sel_hi:[1,1,1]
    v_pk_mad_u16 v9, v75, s52, v9 op_sel:[1,0,0] op_sel_hi:[1,1,1]
    v_perm_b32 v59, v79, v78, s43
    v_perm_b32 v55, v77, v76, s43
    v_or_b32 v68, 0x40000000, v6
    v_or_b32 v69, 0x40000000, v7
    v_or_b32 v70, 0x40000000, v8
    v_or_b32 v72, 0x40000000, v9
    s_waitcnt vmcnt(8)
    v_perm_b32 v6, v100, v80, s43
    v_perm_b32 v7, v101, v81, s43
    v_perm_b32 v8, v102, v82, s43
    v_perm_b32 v9, v103, v83, s43
    v_mul_hi_u32_u24 v80, 429497, v80
    v_mul_hi_u32_u24 v100, 429497, v100
    v_mul_hi_u32_u24 v81, 429497, v81
    v_mul_hi_u32_u24 v101, 429497, v101
    v_mul_hi_u32_u24 v82, 429497, v82
    v_mul_hi_u32_u24 v102, 429497, v102
    v_mul_hi_u32_u24 v83, 429497, v83
    v_mul_hi_u32_u24 v103, 429497, v103
    v_lshl_or_b32 v80, v100, 16, v80
    v_lshl_or_b32 v81, v101, 16, v81
    v_lshl_or_b32 v82, v102, 16, v82
    v_lshl_or_b32 v83, v103, 16, v83
    v_dot2_u32_u16 v100, v80, s38, 0
    v_dot2_u32_u16 v101, v81, s38, 0
    v_dot2_u32_u16 v102, v82, s38, 0
    v_dot2_u32_u16 v103, v83, s38, 0
    v_pk_mad_u16 v6, v80, s37, v6
    v_pk_mad_u16 v7, v81, s37, v7
    v_pk_mad_u16 v8, v82, s37, v8
    v_pk_mad_u16 v9, v83, s37, v9
    ds_add_u32 v100, v4 offset:0
    ds_add_u32 v101, v4 offset:0
    ds_add_u32 v102, v4 offset:0
    ds_add_u32 v103, v4 offset:0
    v_pk_mad_u16 v6, v80, s52, v6 op_sel:[1,0,0] op_sel_hi:[1,1,1]
    v_pk_mad_u16 v7, v81, s52, v7 op_sel:[1,0,0] op_sel_hi:[1,1,1]
    v_pk_mad_u16 v8, v82, s52, v8 op_sel:[1,0,0] op_sel_hi:[1,1,1]
    v_pk_mad_u16 v9, v83, s52, v9 op_sel:[1,0,0] op_sel_hi:[1,1,1]
    v_perm_b32 v67, v103, v102, s43
    v_perm_b32 v63, v101, v100, s43
    v_or_b32 v73, 0x40000000, v6
    v_or_b32 v74, 0x40000000, v7
    v_or_b32 v76, 0x40000000, v8
    v_or_b32 v77, 0x40000000, v9
    s_waitcnt vmcnt(6)
    v_perm_b32 v6, v104, v84, s43
    v_perm_b32 v7, v105, v85, s43
    v_perm_b32 v8, v106, v86, s43
    v_perm_b32 v9, v107, v87, s43
    v_mul_hi_u32_u24 v84, 429497, v84
    v_mul_hi_u32_u24 v104, 429497, v104
    v_mul_hi_u32_u24 v85, 429497, v85
    v_mul_hi_u32_u24 v105, 429497, v105
    v_mul_hi_u32_u24 v86, 429497, v86
    v_mul_hi_u32_u24 v106, 429497, v106
    v_mul_hi_u32_u24 v87, 429497, v87
    v_mul_hi_u32_u24 v107, 429497, v107
    v_lshl_or_b32 v84, v104, 16, v84
    v_lshl_or_b32 v85, v105, 16, v85
    v_lshl_or_b32 v86, v106, 16, v86
    v_lshl_or_b32 v87, v107, 16, v87
    v_dot2_u32_u16 v104, v84, s38, 0
    v_dot2_u32_u16 v105, v85, s38, 0
    v_dot2_u32_u16 v106, v86, s38, 0
    v_dot2_u32_u16 v107, v87, s38, 0
    v_pk_mad_u16 v6, v84, s37, v6
    v_pk_mad_u16 v7, v85, s37, v7
    v_pk_mad_u16 v8, v86, s37, v8
    v_pk_mad_u16 v9, v87, s37, v9
    ds_add_u32 v104, v4 offset:0
    ds_add_u32 v105, v4 offset:0
    ds_add_u32 v106, v4 offset:0
    ds_add_u32 v107, v4 offset:0
    v_pk_mad_u16 v6, v84, s52, v6 op_sel:[1,0,0] op_sel_hi:[1,1,1]
    v_pk_mad_u16 v7, v85, s52, v7 op_sel:[1,0,0] op_sel_hi:[1,1,1]
    v_pk_mad_u16 v8, v86, s52, v8 op_sel:[1,0,0] op_sel_hi:[1,1,1]
    v_pk_mad_u16 v9, v87, s52, v9 op_sel:[1,0,0] op_sel_hi:[1,1,1]
    v_perm_b32 v75, v107, v106, s43
    v_perm_b32 v71, v105, v104, s43
    v_or_b32 v78, 0x40000000, v6
    v_or_b32 v80, 0x40000000, v7
    v_or_b32 v81, 0x40000000, v8
    v_or_b32 v82, 0x40000000, v9
    s_waitcnt vmcnt(4)
    v_perm_b32 v6, v108, v88, s43
    v_perm_b32 v7, v109, v89, s43
    v_perm_b32 v8, v110, v90, s43
    v_perm_b32 v9, v111, v91, s43
    v_mul_hi_u32_u24 v88, 429497, v88
    v_mul_hi_u32_u24 v108, 429497, v108
    v_mul_hi_u32_u24 v89, 429497, v89
    v_mul_hi_u32_u24 v109, 429497, v109
    v_mul_hi_u32_u24 v90, 429497, v90
    v_mul_hi_u32_u24 v110, 429497, v110
    v_mul_hi_u32_u24 v91, 429497, v91
    v_mul_hi_u32_u24 v111, 429497, v111
    v_lshl_or_b32 v88, v108, 16, v88
    v_lshl_or_b32 v89, v109, 16, v89
    v_lshl_or_b32 v90, v110, 16, v90
    v_lshl_or_b32 v91, v111, 16, v91
    v_dot2_u32_u16 v108, v88, s38, 0
    v_dot2_u32_u16 v109, v89, s38, 0
    v_dot2_u32_u16 v110, v90, s38, 0
    v_dot2_u32_u16 v111, v91, s38, 0
    v_pk_mad_u16 v6, v88, s37, v6
    v_pk_mad_u16 v7, v89, s37, v7
    v_pk_mad_u16 v8, v90, s37, v8
    v_pk_mad_u16 v9, v91, s37, v9
    ds_add_u32 v108, v4 offset:0
    ds_add_u32 v109, v4 offset:0
    ds_add_u32 v110, v4 offset:0
    ds_add_u32 v111, v4 offset:0
    v_pk_mad_u16 v6, v88, s52, v6 op_sel:[1,0,0] op_sel_hi:[1,1,1]
    v_pk_mad_u16 v7, v89, s52, v7 op_sel:[1,0,0] op_sel_hi:[1,1,1]
    v_pk_mad_u16 v8, v90, s52, v8 op_sel:[1,0,0] op_sel_hi:[1,1,1]
    v_pk_mad_u16 v9, v91, s52, v9 op_sel:[1,0,0] op_sel_hi:[1,1,1]
    v_perm_b32 v83, v111, v110, s43
    v_perm_b32 v79, v109, v108, s43
    v_or_b32 v84, 0x40000000, v6
    v_or_b32 v85, 0x40000000, v7
    v_or_b32 v86, 0x40000000, v8
    v_or_b32 v88, 0x40000000, v9
    s_waitcnt vmcnt(2)
    v_perm_b32 v6, v112, v92, s43
    v_perm_b32 v7, v113, v93, s43
    v_perm_b32 v8, v114, v94, s43
    v_perm_b32 v9, v115, v95, s43
    v_mul_hi_u32_u24 v92, 429497, v92
    v_mul_hi_u32_u24 v112, 429497, v112
    v_mul_hi_u32_u24 v93, 429497, v93
    v_mul_hi_u32_u24 v113, 429497, v113
    v_mul_hi_u32_u24 v94, 429497, v94
    v_mul_hi_u32_u24 v114, 429497, v114
    v_mul_hi_u32_u24 v95, 429497, v95
    v_mul_hi_u32_u24 v115, 429497, v115
    v_lshl_or_b32 v92, v112, 16, v92
    v_lshl_or_b32 v93, v113, 16, v93
    v_lshl_or_b32 v94, v114, 16, v94
    v_lshl_or_b32 v95, v115, 16, v95
    v_dot2_u32_u16 v112, v92, s38, 0
    v_dot2_u32_u16 v113, v93, s38, 0
    v_dot2_u32_u16 v114, v94, s38, 0
    v_dot2_u32_u16 v115, v95, s38, 0
    v_pk_mad_u16 v6, v92, s37, v6
    v_pk_mad_u16 v7, v93, s37, v7
    v_pk_mad_u16 v8, v94, s37, v8
    v_pk_mad_u16 v9, v95, s37, v9
    ds_add_u32 v112, v4 offset:0
    ds_add_u32 v113, v4 offset:0
    ds_add_u32 v114, v4 offset:0
    ds_add_u32 v115, v4 offset:0
    v_pk_mad_u16 v6, v92, s52, v6 op_sel:[1,0,0] op_sel_hi:[1,1,1]
    v_pk_mad_u16 v7, v93, s52, v7 op_sel:[1,0,0] op_sel_hi:[1,1,1]
    v_pk_mad_u16 v8, v94, s52, v8 op_sel:[1,0,0] op_sel_hi:[1,1,1]
    v_pk_mad_u16 v9, v95, s52, v9 op_sel:[1,0,0] op_sel_hi:[1,1,1]
    v_perm_b32 v91, v115, v114, s43
    v_perm_b32 v87, v113, v112, s43
    v_or_b32 v89, 0x40000000, v6
    v_or_b32 v90, 0x40000000, v7
    v_or_b32 v92, 0x40000000, v8
    v_or_b32 v93, 0x40000000, v9
    s_waitcnt vmcnt(0)
    s_mov_b64 exec, s[44:45]
    v_perm_b32 v6, v116, v96, s43
    v_perm_b32 v7, v117, v97, s43
    v_perm_b32 v8, v118, v98, s43
    v_perm_b32 v9, v119, v99, s43
    v_mul_hi_u32_u24 v96, 429497, v96
    v_mul_hi_u32_u24 v116, 429497, v116
    v_mul_hi_u32_u24 v97, 429497, v97
    v_mul_hi_u32_u24 v117, 429497, v117
    v_mul_hi_u32_u24 v98, 429497, v98
    v_mul_hi_u32_u24 v118, 429497, v118
    v_mul_hi_u32_u24 v99, 429497, v99
    v_mul_hi_u32_u24 v119, 429497, v119
    v_lshl_or_b32 v96, v116, 16, v96
    v_lshl_or_b32 v97, v117, 16, v97
    v_lshl_or_b32 v98, v118, 16, v98
    v_lshl_or_b32 v99, v119, 16, v99
    v_dot2_u32_u16 v116, v96, s38, 0
    v_dot2_u32_u16 v117, v97, s38, 0
    v_dot2_u32_u16 v118, v98, s38, 0
    v_dot2_u32_u16 v119, v99, s38, 0
    v_pk_mad_u16 v6, v96, s37, v6
    v_pk_mad_u16 v7, v97, s37, v7
    v_pk_mad_u16 v8, v98, s37, v8
    v_pk_mad_u16 v9, v99, s37, v9
    ds_add_u32 v116, v4 offset:0
    ds_add_u32 v117, v4 offset:0
    ds_add_u32 v118, v4 offset:0
    ds_add_u32 v119, v4 offset:0
    v_pk_mad_u16 v6, v96, s52, v6 op_sel:[1,0,0] op_sel_hi:[1,1,1]
    v_pk_mad_u16 v7, v97, s52, v7 op_sel:[1,0,0] op_sel_hi:[1,1,1]
    v_pk_mad_u16 v8, v98, s52, v8 op_sel:[1,0,0] op_sel_hi:[1,1,1]
    v_pk_mad_u16 v9, v99, s52, v9 op_sel:[1,0,0] op_sel_hi:[1,1,1]
    v_perm_b32 v99, v119, v118, s43
    v_perm_b32 v95, v117, v116, s43
    v_or_b32 v94, 0x40000000, v6
    v_or_b32 v96, 0x40000000, v7
    v_or_b32 v97, 0x40000000, v8
    v_or_b32 v98, 0x40000000, v9
    s_mov_b64 exec, -1
    s_xor_b32 s35, s39, 15
    s_or_b32 s35, s35, s40
    s_cbranch_scc1 L_p1_nodec
    s_mov_b64 exec, 1
    s_waitcnt vmcnt(0)
    v_cmp_eq_u32 vcc, 0, v12
    v_mov_b32 v6, 160896
    s_nop 0
    s_cbranch_vccz L_p1_dec
    v_mov_b32 v12, 48
    v_mov_b32 v13, 0
    buffer_atomic_cmpswap v[12:13], off, s[84:87], 0 sc0
    s_waitcnt vmcnt(0)
    v_cmp_eq_u32 vcc, 0, v12
    s_nop 1
    v_cndmask_b32 v12, v12, 48, vcc
L_p1_dec:
    ds_write_b32 v6, v12
    s_mov_b64 exec, -1
L_p1_nodec:
    s_lshl2_add_u32 s35, s39, 160768
    v_mov_b32 v13, s35
    v_mov_b32 v7, 2.0
    v_and_b32 v6, 63, v0
    s_mov_b32 s36, 160768
    s_lshl_b32 s35, 0x1fffe, s39
    s_and_b32 s35, s35, 0x1ffff
    s_mov_b32 exec_hi, 0
    s_mov_b32 exec_lo, s35
    v_lshl_add_u32 v7, v6, 2, s36
    s_mov_b64 exec, -1
    v_mov_b32 v14, 160832
    s_mov_b32 s53, 2
    s_waitcnt lgkmcnt(0)
    s_barrier
    ds_read_b128 v[8:11], v1 offset:0
    s_cmp_lg_u32 s40, 3
    s_cbranch_scc1 L_p1_kernel_ld_19
    s_add_u32 s36, s42, 4
    s_and_b32 s35, s36, 3
    s_mul_i32 s35, s35, 1047552
    s_lshl_b32 s36, s36, 20
    s_sub_u32 s36, s36, s35
    buffer_store_dwordx4 v[16:19], v3, s[72:75], s36 offen sc1
    s_branch L_p1_kernel_st_20
L_p1_kernel_ld_19:
    s_add_u32 s35, s33, 40960000
    buffer_load_dwordx4 v[16:19], v1, s[8:11], s35 offen nt
L_p1_kernel_st_20:
L_p1_redo:
    s_waitcnt lgkmcnt(0)
    v_min3_u32 v12, v8, v9, v10
    v_min_u32 v12, v12, v11
    v_cmp_gt_u32 vcc, s53, v12
    s_nop 0
    s_mov_b64 s[46:47], vcc
    s_cbranch_vccz L_p1_kernel_nomask_21
    v_cmp_eq_u32 s[56:57], 0, v8
    v_cmp_ge_u32 s[64:65], 1, v8
    v_max_u32 v8, 2, v8
    v_cmp_eq_u32 s[58:59], 0, v9
    v_cmp_ge_u32 s[66:67], 1, v9
    v_max_u32 v9, 2, v9
    v_cmp_eq_u32 s[60:61], 0, v10
    v_cmp_ge_u32 s[68:69], 1, v10
    v_max_u32 v10, 2, v10
    v_cmp_eq_u32 s[62:63], 0, v11
    v_cmp_ge_u32 s[70:71], 1, v11
    v_max_u32 v11, 2, v11
L_p1_kernel_nomask_21:
    v_add_u32 v9, v8, v9
    v_add_u32 v10, v9, v10
    v_add_u32 v11, v10, v11
    s_nop 1
    v_add_u32_dpp v6, v11, v11 row_shr:1 row_mask:0xf bank_mask:0xf bound_ctrl:0
    s_nop 1
    v_add_u32_dpp v6, v6, v6 row_shr:2 row_mask:0xf bank_mask:0xf bound_ctrl:0
    s_nop 1
    v_add_u32_dpp v6, v6, v6 row_shr:4 row_mask:0xf bank_mask:0xf bound_ctrl:0
    s_nop 1
    v_add_u32_dpp v6, v6, v6 row_shr:8 row_mask:0xf bank_mask:0xf bound_ctrl:0
    s_nop 1
    v_add_u32_dpp v6, v6, v6 row_bcast:15 row_mask:0xa bank_mask:0xf
    s_nop 1
    v_add_u32_dpp v6, v6, v6 row_bcast:31 row_mask:0xc bank_mask:0xf
    s_nop 0
    v_readlane_b32 s35, v6, 63
    v_sub_u32 v6, v6, v11
    v_add_u32 v8, v8, v6
    v_mov_b32 v12, s35
    ds_add_u32 v7, v12
    v_add_u32 v9, v9, v6
    v_add_u32 v10, v10, v6
    s_waitcnt lgkmcnt(0)
    s_barrier
    ds_read_b32 v12, v14
    ds_read_b32 v11, v13
    s_waitcnt lgkmcnt(1)
    v_readfirstlane_b32 s54, v12
    s_waitcnt lgkmcnt(0)
    s_cmp_ge_u32 s54, 40063
    s_cbranch_scc0 L_p1_fits
    s_barrier
    v_mov_b32 v12, 0
    ds_write_b32 v7, v12
    s_mov_b32 s53, 0
    s_mov_b32 s55, 1
    s_waitcnt lgkmcnt(0)
    s_barrier
    ds_read_b128 v[8:11], v1 offset:0
    s_branch L_p1_redo
L_p1_fits:
    s_mov_b64 exec, 1
    v_mov_b32 v7, 24576
    ds_write_b16 v7, v12
    s_mov_b64 exec, -1
    v_add_u32 v12, v11, v6
    v_add_u32 v13, v11, v8
    v_add_u32 v14, v11, v9
    v_add_u32 v15, v11, v10
    ds_write_b128 v1, v[12:15] offset:0
    s_add_u32 s35, s54, 2
    s_mul_hi_u32 s35, s35, 1431655766
    v_perm_b32 v15, v15, v14, s43
    v_perm_b32 v14, v13, v12, s43
    ds_write_b64 v2, v[14:15] offset:16384
    s_lshl_b32 s35, s35, 4
    s_add_u32 s35, s35, 217890943
    s_andn2_b32 s35, s35, 127
    s_min_u32 s22, s35, 218104832
    s_waitcnt lgkmcnt(0)
    s_barrier
    s_cmp_lg_u32 s40, 0
    s_cbranch_scc1 L_p1_slot
    v_mov_b32 v6, 160896
    ds_read_b32 v6, v6
    s_waitcnt lgkmcnt(0)
    v_readfirstlane_b32 s90, v6
    s_lshr_b32 s92, s2, 3
    s_add_u32 s91, s2, s90
    s_and_b32 s35, s91, 3
    s_lshl_b32 s35, s35, 5
    s_or_b32 s35, s35, s92
    s_andn2_b32 s36, s35, 1
    s_add_u32 s76, s35, s36
    s_lshr_b32 s91, s91, 2
    s_lshr_b32 s35, s90, 3
    s_xor_b32 s91, s91, s35
    s_lshr_b32 s35, s90, 4
    s_and_b32 s35, s35, s92
    s_xor_b32 s91, s91, s35
    s_and_b32 s91, s91, 1
    s_lshl1_add_u32 s76, s91, s76
    s_lshr_b32 s77, s90, 3
L_p1_slot:
    s_lshl_b32 s35, s40, 8
    s_lshl_b32 s36, s40, 1
    s_and_b32 s36, s36, s77
    s_xor_b32 s36, s36, s40
    s_and_b32 s36, s36, 2
    s_or_b32 s35, s35, s36
    s_xor_b32 s32, s76, s35
    s_and_b32 s32, s32, 1023
    s_lshl_b32 s35, s32, 12
    s_add_u32 s20, s4, s35
    s_addc_u32 s21, s5, 0
    s_nop 0
    v_and_b32 v6, 0xffff, v120
    v_lshrrev_b32 v7, 16, v120
    v_and_b32 v8, 0xffff, v121
    v_lshrrev_b32 v9, 16, v121
    ds_add_rtn_u32 v6, v6, v4 offset:0
    ds_add_rtn_u32 v7, v7, v4 offset:0
    ds_add_rtn_u32 v8, v8, v4 offset:0
    ds_add_rtn_u32 v9, v9, v4 offset:0
    v_and_b32 v10, 0xffff, v122
    v_lshrrev_b32 v11, 16, v122
    v_and_b32 v12, 0xffff, v123
    v_lshrrev_b32 v13, 16, v123
    ds_add_rtn_u32 v10, v10, v4 offset:0
    ds_add_rtn_u32 v11, v11, v4 offset:0
    ds_add_rtn_u32 v12, v12, v4 offset:0
    ds_add_rtn_u32 v13, v13, v4 offset:0
    s_waitcnt lgkmcnt(4)
    v_perm_b32 v120, v7, v6, s43
    v_perm_b32 v121, v9, v8, s43
    v_and_b32 v6, 0xffff, v124
    v_lshrrev_b32 v7, 16, v124
    v_and_b32 v8, 0xffff, v125
    v_lshrrev_b32 v9, 16, v125
    ds_add_rtn_u32 v6, v6, v4 offset:0
    ds_add_rtn_u32 v7, v7, v4 offset:0
    ds_add_rtn_u32 v8, v8, v4 offset:0
    ds_add_rtn_u32 v9, v9, v4 offset:0
    s_waitcnt lgkmcnt(4)
    v_perm_b32 v122, v11, v10, s43
    v_perm_b32 v123, v13, v12, s43
    s_add_u32 s35, s34, 0
    buffer_load_dwordx2 v[100:101], v2, s[16:19], s35 offen nt
    v_and_b32 v10, 0xffff, v126
    v_lshrrev_b32 v11, 16, v126
    v_and_b32 v12, 0xffff, v51
    v_lshrrev_b32 v13, 16, v51
    ds_add_rtn_u32 v10, v10, v4 offset:0
    ds_add_rtn_u32 v11, v11, v4 offset:0
    ds_add_rtn_u32 v12, v12, v4 offset:0
    ds_add_rtn_u32 v13, v13, v4 offset:0
    s_waitcnt lgkmcnt(4)
    v_perm_b32 v124, v7, v6, s43
    v_perm_b32 v125, v9, v8, s43
    s_add_u32 s35, s34, 2097152
    buffer_load_dwordx2 v[102:103], v2, s[16:19], s35 offen nt
    v_and_b32 v6, 0xffff, v55
    v_lshrrev_b32 v7, 16, v55
    v_and_b32 v8, 0xffff, v59
    v_lshrrev_b32 v9, 16, v59
    ds_add_rtn_u32 v6, v6, v4 offset:0
    ds_add_rtn_u32 v7, v7, v4 offset:0
    ds_add_rtn_u32 v8, v8, v4 offset:0
    ds_add_rtn_u32 v9, v9, v4 offset:0
    s_waitcnt lgkmcnt(4)
    v_perm_b32 v126, v11, v10, s43
    v_perm_b32 v51, v13, v12, s43
    v_and_b32 v10, 0xffff, v63
    v_lshrrev_b32 v11, 16, v63
    v_and_b32 v12, 0xffff, v67
    v_lshrrev_b32 v13, 16, v67
    ds_add_rtn_u32 v10, v10, v4 offset:0
    ds_add_rtn_u32 v11, v11, v4 offset:0
    ds_add_rtn_u32 v12, v12, v4 offset:0
    ds_add_rtn_u32 v13, v13, v4 offset:0
    s_waitcnt lgkmcnt(4)
    v_perm_b32 v55, v7, v6, s43
    v_perm_b32 v59, v9, v8, s43
    s_cmp_lg_u32 s40, 3
    s_cbranch_scc1 L_p1_kernel_ld_22
    s_add_u32 s36, s42, 6
    s_and_b32 s35, s36, 3
    s_mul_i32 s35, s35, 1047552
    s_lshl_b32 s36, s36, 20
    s_sub_u32 s36, s36, s35
    buffer_store_dwordx4 v[20:23], v3, s[72:75], s36 offen sc1
    s_branch L_p1_kernel_st_23
L_p1_kernel_ld_22:
    s_add_u32 s35, s33, 40960000
    buffer_load_dwordx4 v[20:23], v1, s[12:15], s35 offen nt
L_p1_kernel_st_23:
    v_and_b32 v6, 0xffff, v71
    v_lshrrev_b32 v7, 16, v71
    v_and_b32 v8, 0xffff, v75
    v_lshrrev_b32 v9, 16, v75
    ds_add_rtn_u32 v6, v6, v4 offset:0
    ds_add_rtn_u32 v7, v7, v4 offset:0
    ds_add_rtn_u32 v8, v8, v4 offset:0
    ds_add_rtn_u32 v9, v9, v4 offset:0
    s_waitcnt lgkmcnt(4)
    v_perm_b32 v63, v11, v10, s43
    v_perm_b32 v67, v13, v12, s43
    v_and_b32 v10, 0xffff, v79
    v_lshrrev_b32 v11, 16, v79
    v_and_b32 v12, 0xffff, v83
    v_lshrrev_b32 v13, 16, v83
    ds_add_rtn_u32 v10, v10, v4 offset:0
    ds_add_rtn_u32 v11, v11, v4 offset:0
    ds_add_rtn_u32 v12, v12, v4 offset:0
    ds_add_rtn_u32 v13, v13, v4 offset:0
    s_waitcnt lgkmcnt(4)
    v_perm_b32 v71, v7, v6, s43
    v_perm_b32 v75, v9, v8, s43
    v_and_b32 v6, 0xffff, v87
    v_lshrrev_b32 v7, 16, v87
    v_and_b32 v8, 0xffff, v91
    v_lshrrev_b32 v9, 16, v91
    ds_add_rtn_u32 v6, v6, v4 offset:0
    ds_add_rtn_u32 v7, v7, v4 offset:0
    ds_add_rtn_u32 v8, v8, v4 offset:0
    ds_add_rtn_u32 v9, v9, v4 offset:0
    s_waitcnt lgkmcnt(4)
    v_perm_b32 v79, v11, v10, s43
    v_perm_b32 v83, v13, v12, s43
    s_add_u32 s35, s34, 4194304
    buffer_load_dwordx2 v[104:105], v2, s[16:19], s35 offen nt
    s_mov_b64 exec, s[44:45]
    v_and_b32 v10, 0xffff, v95
    v_lshrrev_b32 v11, 16, v95
    v_and_b32 v12, 0xffff, v99
    v_lshrrev_b32 v13, 16, v99
    ds_add_rtn_u32 v10, v10, v4 offset:0
    ds_add_rtn_u32 v11, v11, v4 offset:0
    ds_add_rtn_u32 v12, v12, v4 offset:0
    ds_add_rtn_u32 v13, v13, v4 offset:0
    s_mov_b64 exec, -1
    s_waitcnt lgkmcnt(4)
    v_perm_b32 v87, v7, v6, s43
    v_perm_b32 v91, v9, v8, s43
    s_add_u32 s35, s34, 6291456
    buffer_load_dwordx2 v[106:107], v2, s[16:19], s35 offen nt
    s_waitcnt lgkmcnt(0)
    v_perm_b32 v95, v11, v10, s43
    v_perm_b32 v99, v13, v12, s43
    s_cmp_gt_u32 s39, 8
    s_cbranch_scc1 L_p1_kernel_notab_24
    v_lshrrev_b32 v6, 1, v0
    v_mul_u32_u24 v7, 1009, v6
    v_lshrrev_b32 v7, 16, v7
    v_mul_u32_u24 v7, 959, v7
    v_and_b32 v8, 1, v0
    v_lshl_add_u32 v7, v8, 9, v7
    v_add_lshl_u32 v13, v7, v6, 1
    ds_read_u16 v6, v13 offset:16384
    ds_read_u16 v7, v13 offset:16512
    ds_read_u16 v8, v13 offset:16640
    ds_read_u16 v9, v13 offset:16768
    ds_read_u16 v10, v13 offset:16896
    ds_read_u16 v11, v13 offset:17024
    ds_read_u16 v12, v13 offset:17152
    ds_read_u16 v13, v13 offset:17280
    s_mul_i32 s35, s32, 8320
    s_add_u32 s26, s35, 8320
    s_waitcnt lgkmcnt(6)
    v_perm_b32 v6, v7, v6, s43
    s_waitcnt lgkmcnt(4)
    v_perm_b32 v7, v9, v8, s43
    s_waitcnt lgkmcnt(2)
    v_perm_b32 v8, v11, v10, s43
    s_waitcnt lgkmcnt(0)
    v_perm_b32 v9, v13, v12, s43
    buffer_store_dwordx4 v[6:9], v1, s[24:27], s35 offen sc1
    s_nop 1
L_p1_kernel_notab_24:
    s_barrier
    s_lshl_b32 s35, s54, 2
    v_mov_b32 v6, s35
    v_mov_b32 v7, 0
    v_mov_b32 v12, 1140817920
    s_mov_b64 exec, 1
    ds_write2_b32 v6, v7, v7 offset0:0 offset1:1
    s_cmp_eq_u64 s[46:47], 0
    s_cbranch_scc1 L_p1_kernel_nonull_25
    s_mov_b64 exec, s[64:65]
    v_lshlrev_b32_sdwa v6, 2, v14 dst_sel:DWORD dst_unused:UNUSED_PAD src0_sel:DWORD src1_sel:WORD_0
    ds_write_b32 v6, v7 offset:4
    s_mov_b64 exec, s[56:57]
    ds_write_b32 v6, v7
    s_mov_b64 exec, s[66:67]
    v_lshlrev_b32_sdwa v6, 2, v14 dst_sel:DWORD dst_unused:UNUSED_PAD src0_sel:DWORD src1_sel:WORD_1
    ds_write_b32 v6, v7 offset:4
    s_mov_b64 exec, s[58:59]
    ds_write_b32 v6, v7
    s_mov_b64 exec, s[68:69]
    v_lshlrev_b32_sdwa v6, 2, v15 dst_sel:DWORD dst_unused:UNUSED_PAD src0_sel:DWORD src1_sel:WORD_0
    ds_write_b32 v6, v7 offset:4
    s_mov_b64 exec, s[60:61]
    ds_write_b32 v6, v7
    s_mov_b64 exec, s[70:71]
    v_lshlrev_b32_sdwa v6, 2, v15 dst_sel:DWORD dst_unused:UNUSED_PAD src0_sel:DWORD src1_sel:WORD_1
    ds_write_b32 v6, v7 offset:4
    s_mov_b64 exec, s[62:63]
    ds_write_b32 v6, v7
L_p1_kernel_nonull_25:
    s_mov_b64 exec, -1
    v_lshlrev_b32_sdwa v6, 2, v120 dst_sel:DWORD dst_unused:UNUSED_PAD src0_sel:DWORD src1_sel:WORD_0
    v_lshlrev_b32_sdwa v7, 2, v120 dst_sel:DWORD dst_unused:UNUSED_PAD src0_sel:DWORD src1_sel:WORD_1
    v_lshlrev_b32_sdwa v8, 2, v121 dst_sel:DWORD dst_unused:UNUSED_PAD src0_sel:DWORD src1_sel:WORD_0
    v_lshlrev_b32_sdwa v9, 2, v121 dst_sel:DWORD dst_unused:UNUSED_PAD src0_sel:DWORD src1_sel:WORD_1
    ds_write_b32 v6, v127
    ds_write_b32 v7, v48
    ds_write_b32 v8, v49
    ds_write_b32 v9, v50
    s_cmp_lg_u32 s40, 3
    s_cbranch_scc1 L_p1_kernel_ld_26
    s_add_u32 s36, s42, 7
    s_and_b32 s35, s36, 3
    s_mul_i32 s35, s35, 1047552
    s_lshl_b32 s36, s36, 20
    s_sub_u32 s36, s36, s35
    buffer_store_dwordx4 v[24:27], v3, s[72:75], s36 offen sc1
    s_branch L_p1_kernel_st_27
L_p1_kernel_ld_26:
    s_add_u32 s35, s33, 45154304
    buffer_load_dwordx4 v[24:27], v1, s[8:11], s35 offen nt
L_p1_kernel_st_27:
    v_lshlrev_b32_sdwa v6, 2, v122 dst_sel:DWORD dst_unused:UNUSED_PAD src0_sel:DWORD src1_sel:WORD_0
    v_lshlrev_b32_sdwa v7, 2, v122 dst_sel:DWORD dst_unused:UNUSED_PAD src0_sel:DWORD src1_sel:WORD_1
    v_lshlrev_b32_sdwa v8, 2, v123 dst_sel:DWORD dst_unused:UNUSED_PAD src0_sel:DWORD src1_sel:WORD_0
    v_lshlrev_b32_sdwa v9, 2, v123 dst_sel:DWORD dst_unused:UNUSED_PAD src0_sel:DWORD src1_sel:WORD_1
    ds_write_b32 v6, v52
    ds_write_b32 v7, v53
    ds_write_b32 v8, v54
    ds_write_b32 v9, v56
    v_lshlrev_b32_sdwa v6, 2, v124 dst_sel:DWORD dst_unused:UNUSED_PAD src0_sel:DWORD src1_sel:WORD_0
    v_lshlrev_b32_sdwa v7, 2, v124 dst_sel:DWORD dst_unused:UNUSED_PAD src0_sel:DWORD src1_sel:WORD_1
    v_lshlrev_b32_sdwa v8, 2, v125 dst_sel:DWORD dst_unused:UNUSED_PAD src0_sel:DWORD src1_sel:WORD_0
    v_lshlrev_b32_sdwa v9, 2, v125 dst_sel:DWORD dst_unused:UNUSED_PAD src0_sel:DWORD src1_sel:WORD_1
    ds_write_b32 v6, v57
    ds_write_b32 v7, v58
    ds_write_b32 v8, v60
    ds_write_b32 v9, v61
    v_lshlrev_b32_sdwa v6, 2, v126 dst_sel:DWORD dst_unused:UNUSED_PAD src0_sel:DWORD src1_sel:WORD_0
    v_lshlrev_b32_sdwa v7, 2, v126 dst_sel:DWORD dst_unused:UNUSED_PAD src0_sel:DWORD src1_sel:WORD_1
    v_lshlrev_b32_sdwa v8, 2, v51 dst_sel:DWORD dst_unused:UNUSED_PAD src0_sel:DWORD src1_sel:WORD_0
    v_lshlrev_b32_sdwa v9, 2, v51 dst_sel:DWORD dst_unused:UNUSED_PAD src0_sel:DWORD src1_sel:WORD_1
    ds_write_b32 v6, v62
    ds_write_b32 v7, v64
    ds_write_b32 v8, v65
    ds_write_b32 v9, v66
    s_add_u32 s35, s34, 8388608
    buffer_load_dwordx2 v[108:109], v2, s[16:19], s35 offen nt
    v_lshlrev_b32_sdwa v6, 2, v55 dst_sel:DWORD dst_unused:UNUSED_PAD src0_sel:DWORD src1_sel:WORD_0
    v_lshlrev_b32_sdwa v7, 2, v55 dst_sel:DWORD dst_unused:UNUSED_PAD src0_sel:DWORD src1_sel:WORD_1
    v_lshlrev_b32_sdwa v8, 2, v59 dst_sel:DWORD dst_unused:UNUSED_PAD src0_sel:DWORD src1_sel:WORD_0
    v_lshlrev_b32_sdwa v9, 2, v59 dst_sel:DWORD dst_unused:UNUSED_PAD src0_sel:DWORD src1_sel:WORD_1
    ds_write_b32 v6, v68
    ds_write_b32 v7, v69
    ds_write_b32 v8, v70
    ds_write_b32 v9, v72
    s_add_u32 s35, s34, 10485760
    buffer_load_dwordx2 v[110:111], v2, s[16:19], s35 offen nt
    v_lshlrev_b32_sdwa v6, 2, v63 dst_sel:DWORD dst_unused:UNUSED_PAD src0_sel:DWORD src1_sel:WORD_0
    v_lshlrev_b32_sdwa v7, 2, v63 dst_sel:DWORD dst_unused:UNUSED_PAD src0_sel:DWORD src1_sel:WORD_1
    v_lshlrev_b32_sdwa v8, 2, v67 dst_sel:DWORD dst_unused:UNUSED_PAD src0_sel:DWORD src1_sel:WORD_0
    v_lshlrev_b32_sdwa v9, 2, v67 dst_sel:DWORD dst_unused:UNUSED_PAD src0_sel:DWORD src1_sel:WORD_1
    ds_write_b32 v6, v73
    ds_write_b32 v7, v74
    ds_write_b32 v8, v76
    ds_write_b32 v9, v77
    v_lshlrev_b32_sdwa v6, 2, v71 dst_sel:DWORD dst_unused:UNUSED_PAD src0_sel:DWORD src1_sel:WORD_0
    v_lshlrev_b32_sdwa v7, 2, v71 dst_sel:DWORD dst_unused:UNUSED_PAD src0_sel:DWORD src1_sel:WORD_1
    v_lshlrev_b32_sdwa v8, 2, v75 dst_sel:DWORD dst_unused:UNUSED_PAD src0_sel:DWORD src1_sel:WORD_0
    v_lshlrev_b32_sdwa v9, 2, v75 dst_sel:DWORD dst_unused:UNUSED_PAD src0_sel:DWORD src1_sel:WORD_1
    ds_write_b32 v6, v78
    ds_write_b32 v7, v80
    ds_write_b32 v8, v81
    ds_write_b32 v9, v82
    s_cmp_lg_u32 s40, 3
    s_cbranch_scc1 L_p1_kernel_ld_28
    s_add_u32 s36, s42, 8
    s_and_b32 s35, s36, 3
    s_mul_i32 s35, s35, 1047552
    s_lshl_b32 s36, s36, 20
    s_sub_u32 s36, s36, s35
    buffer_store_dwordx4 v[28:31], v3, s[72:75], s36 offen sc1
    s_branch L_p1_kernel_st_29
L_p1_kernel_ld_28:
    s_add_u32 s35, s33, 45154304
    buffer_load_dwordx4 v[28:31], v1, s[12:15], s35 offen nt
L_p1_kernel_st_29:
    v_lshlrev_b32_sdwa v6, 2, v79 dst_sel:DWORD dst_unused:UNUSED_PAD src0_sel:DWORD src1_sel:WORD_0
    v_lshlrev_b32_sdwa v7, 2, v79 dst_sel:DWORD dst_unused:UNUSED_PAD src0_sel:DWORD src1_sel:WORD_1
    v_lshlrev_b32_sdwa v8, 2, v83 dst_sel:DWORD dst_unused:UNUSED_PAD src0_sel:DWORD src1_sel:WORD_0
    v_lshlrev_b32_sdwa v9, 2, v83 dst_sel:DWORD dst_unused:UNUSED_PAD src0_sel:DWORD src1_sel:WORD_1
    ds_write_b32 v6, v84
    ds_write_b32 v7, v85
    ds_write_b32 v8, v86
    ds_write_b32 v9, v88
    v_lshlrev_b32_sdwa v6, 2, v87 dst_sel:DWORD dst_unused:UNUSED_PAD src0_sel:DWORD src1_sel:WORD_0
    v_lshlrev_b32_sdwa v7, 2, v87 dst_sel:DWORD dst_unused:UNUSED_PAD src0_sel:DWORD src1_sel:WORD_1
    v_lshlrev_b32_sdwa v8, 2, v91 dst_sel:DWORD dst_unused:UNUSED_PAD src0_sel:DWORD src1_sel:WORD_0
    v_lshlrev_b32_sdwa v9, 2, v91 dst_sel:DWORD dst_unused:UNUSED_PAD src0_sel:DWORD src1_sel:WORD_1
    ds_write_b32 v6, v89
    ds_write_b32 v7, v90
    ds_write_b32 v8, v92
    ds_write_b32 v9, v93
    s_add_u32 s35, s34, 12582912
    buffer_load_dwordx2 v[112:113], v2, s[16:19], s35 offen nt
    s_mov_b64 exec, s[44:45]
    v_lshlrev_b32_sdwa v6, 2, v95 dst_sel:DWORD dst_unused:UNUSED_PAD src0_sel:DWORD src1_sel:WORD_0
    v_lshlrev_b32_sdwa v7, 2, v95 dst_sel:DWORD dst_unused:UNUSED_PAD src0_sel:DWORD src1_sel:WORD_1
    v_lshlrev_b32_sdwa v8, 2, v99 dst_sel:DWORD dst_unused:UNUSED_PAD src0_sel:DWORD src1_sel:WORD_0
    v_lshlrev_b32_sdwa v9, 2, v99 dst_sel:DWORD dst_unused:UNUSED_PAD src0_sel:DWORD src1_sel:WORD_1
    ds_write_b32 v6, v94
    ds_write_b32 v7, v96
    ds_write_b32 v8, v97
    ds_write_b32 v9, v98
    s_mov_b64 exec, -1
    s_add_u32 s35, s34, 14680064
    buffer_load_dwordx2 v[114:115], v2, s[16:19], s35 offen nt
    s_mul_i32 s35, s39, 9216
    v_mad_u32_u24 v6, v0, 12, s35
    s_waitcnt lgkmcnt(0)
    s_barrier
    s_cmp_lg_u32 s39, 15
    s_cbranch_scc1 L_p1_kernel_nox_30
    ds_read_b32 v12, v6 offset:9984
    ds_read_b32 v13, v6 offset:9988
    ds_read_b32 v14, v6 offset:9992
L_p1_kernel_nox_30:
    ds_read_b32 v48, v6 offset:1536
    ds_read_b32 v49, v6 offset:1540
    ds_read_b32 v50, v6 offset:1544
    ds_read_b32 v52, v6 offset:3072
    ds_read_b32 v53, v6 offset:3076
    ds_read_b32 v54, v6 offset:3080
    ds_read_b32 v56, v6 offset:4608
    ds_read_b32 v57, v6 offset:4612
    ds_read_b32 v58, v6 offset:4616
    ds_read_b32 v60, v6 offset:6144
    ds_read_b32 v61, v6 offset:6148
    ds_read_b32 v62, v6 offset:6152
    ds_read_b32 v64, v6 offset:7680
    ds_read_b32 v65, v6 offset:7684
    ds_read_b32 v66, v6 offset:7688
    ds_read_b32 v68, v6 offset:9216
    ds_read_b32 v69, v6 offset:9220
    ds_read_b32 v70, v6 offset:9224
    ds_read_b32 v72, v6 offset:0
    ds_read_b32 v73, v6 offset:4
    ds_read_b32 v74, v6 offset:8
    ds_read_b32 v76, v6 offset:768
    ds_read_b32 v77, v6 offset:772
    ds_read_b32 v78, v6 offset:776
    ds_read_b32 v80, v6 offset:2304
    ds_read_b32 v81, v6 offset:2308
    ds_read_b32 v82, v6 offset:2312
    ds_read_b32 v84, v6 offset:3840
    ds_read_b32 v85, v6 offset:3844
    ds_read_b32 v86, v6 offset:3848
    ds_read_b32 v88, v6 offset:5376
    ds_read_b32 v89, v6 offset:5380
    ds_read_b32 v90, v6 offset:5384
    ds_read_b32 v92, v6 offset:6912
    ds_read_b32 v93, v6 offset:6916
    ds_read_b32 v94, v6 offset:6920
    ds_read_b32 v96, v6 offset:8448
    ds_read_b32 v97, v6 offset:8452
    ds_read_b32 v98, v6 offset:8456
    s_cmp_lg_u32 s40, 3
    s_cbranch_scc1 L_p1_kernel_ld_31
    s_add_u32 s36, s42, 9
    s_and_b32 s35, s36, 3
    s_mul_i32 s35, s35, 1047552
    s_lshl_b32 s36, s36, 20
    s_sub_u32 s36, s36, s35
    buffer_store_dwordx4 v[32:35], v3, s[72:75], s36 offen sc1
    s_branch L_p1_kernel_st_32
L_p1_kernel_ld_31:
    s_add_u32 s35, s33, 49348608
    buffer_load_dwordx4 v[32:35], v1, s[8:11], s35 offen nt
L_p1_kernel_st_32:
    v_mov_b32 v8, 0
    v_mov_b32 v9, 0
    v_mov_b32 v10, 0
    v_mov_b32 v11, 0
    v_mov_b32 v15, 16384
    v_min_u32 v7, 16, v0
    v_lshlrev_b32 v7, 2, v7
    v_add_u32 v7, 160768, v7
    s_waitcnt lgkmcnt(0)
    s_barrier
    ds_write_b128 v1, v[8:11] offset:0
    ds_write_b32 v7, v8
    s_nop 1
    v_mov_b32 v6, 1140817920
    s_waitcnt vmcnt(11)
    v_pk_maximum3_f16 v5, v100, v101, v5
    v_mad_u32_u16 v6, v120, s50, v15 op_sel:[0,0,0,0]
    v_mad_u32_u16 v7, v120, s50, v15 op_sel:[1,0,0,0]
    v_mad_u32_u16 v8, v121, s50, v15 op_sel:[0,0,0,0]
    v_mad_u32_u16 v9, v121, s50, v15 op_sel:[1,0,0,0]
    v_add_u32_sdwa v6, v6, v120 dst_sel:DWORD dst_unused:UNUSED_PAD src0_sel:WORD_1 src1_sel:WORD_0
    v_add_u32_sdwa v7, v7, v120 dst_sel:DWORD dst_unused:UNUSED_PAD src0_sel:WORD_1 src1_sel:WORD_1
    v_add_u32_sdwa v8, v8, v121 dst_sel:DWORD dst_unused:UNUSED_PAD src0_sel:WORD_1 src1_sel:WORD_0
    v_add_u32_sdwa v9, v9, v121 dst_sel:DWORD dst_unused:UNUSED_PAD src0_sel:WORD_1 src1_sel:WORD_1
    v_add_u32 v6, v6, v6
    v_add_u32 v7, v7, v7
    v_add_u32 v8, v8, v8
    v_add_u32 v9, v9, v9
    ds_write_b16 v6, v100 offset:16384
    ds_write_b16_d16_hi v7, v100 offset:16384
    ds_write_b16 v8, v101 offset:16384
    ds_write_b16_d16_hi v9, v101 offset:16384
    s_add_u32 s35, s34, 16777216
    buffer_load_dwordx2 v[116:117], v2, s[16:19], s35 offen nt
    v_mov_b32 v6, 1140817920
    s_waitcnt vmcnt(11)
    v_pk_maximum3_f16 v5, v102, v103, v5
    v_mad_u32_u16 v6, v122, s50, v15 op_sel:[0,0,0,0]
    v_mad_u32_u16 v7, v122, s50, v15 op_sel:[1,0,0,0]
    v_mad_u32_u16 v8, v123, s50, v15 op_sel:[0,0,0,0]
    v_mad_u32_u16 v9, v123, s50, v15 op_sel:[1,0,0,0]
    v_add_u32_sdwa v6, v6, v122 dst_sel:DWORD dst_unused:UNUSED_PAD src0_sel:WORD_1 src1_sel:WORD_0
    v_add_u32_sdwa v7, v7, v122 dst_sel:DWORD dst_unused:UNUSED_PAD src0_sel:WORD_1 src1_sel:WORD_1
    v_add_u32_sdwa v8, v8, v123 dst_sel:DWORD dst_unused:UNUSED_PAD src0_sel:WORD_1 src1_sel:WORD_0
    v_add_u32_sdwa v9, v9, v123 dst_sel:DWORD dst_unused:UNUSED_PAD src0_sel:WORD_1 src1_sel:WORD_1
    v_add_u32 v6, v6, v6
    v_add_u32 v7, v7, v7
    v_add_u32 v8, v8, v8
    v_add_u32 v9, v9, v9
    ds_write_b16 v6, v102 offset:16384
    ds_write_b16_d16_hi v7, v102 offset:16384
    ds_write_b16 v8, v103 offset:16384
    ds_write_b16_d16_hi v9, v103 offset:16384
    s_add_u32 s35, s34, 18874368
    s_sub_u32 s35, s35, s49
    v_cndmask_b32 v118, 2.0, v2, s[44:45]
    buffer_load_dwordx2 v[118:119], v118, s[16:19], s35 offen nt
    v_mov_b32 v6, 1140817920
    s_waitcnt vmcnt(10)
    v_pk_maximum3_f16 v5, v104, v105, v5
    v_mad_u32_u16 v6, v124, s50, v15 op_sel:[0,0,0,0]
    v_mad_u32_u16 v7, v124, s50, v15 op_sel:[1,0,0,0]
    v_mad_u32_u16 v8, v125, s50, v15 op_sel:[0,0,0,0]
    v_mad_u32_u16 v9, v125, s50, v15 op_sel:[1,0,0,0]
    v_add_u32_sdwa v6, v6, v124 dst_sel:DWORD dst_unused:UNUSED_PAD src0_sel:WORD_1 src1_sel:WORD_0
    v_add_u32_sdwa v7, v7, v124 dst_sel:DWORD dst_unused:UNUSED_PAD src0_sel:WORD_1 src1_sel:WORD_1
    v_add_u32_sdwa v8, v8, v125 dst_sel:DWORD dst_unused:UNUSED_PAD src0_sel:WORD_1 src1_sel:WORD_0
    v_add_u32_sdwa v9, v9, v125 dst_sel:DWORD dst_unused:UNUSED_PAD src0_sel:WORD_1 src1_sel:WORD_1
    v_add_u32 v6, v6, v6
    v_add_u32 v7, v7, v7
    v_add_u32 v8, v8, v8
    v_add_u32 v9, v9, v9
    ds_write_b16 v6, v104 offset:16384
    ds_write_b16_d16_hi v7, v104 offset:16384
    ds_write_b16 v8, v105 offset:16384
    ds_write_b16_d16_hi v9, v105 offset:16384
    v_mov_b32 v6, 1140817920
    s_waitcnt vmcnt(9)
    v_pk_maximum3_f16 v5, v106, v107, v5
    v_mad_u32_u16 v6, v126, s50, v15 op_sel:[0,0,0,0]
    v_mad_u32_u16 v7, v126, s50, v15 op_sel:[1,0,0,0]
    v_mad_u32_u16 v8, v51, s50, v15 op_sel:[0,0,0,0]
    v_mad_u32_u16 v9, v51, s50, v15 op_sel:[1,0,0,0]
    v_add_u32_sdwa v6, v6, v126 dst_sel:DWORD dst_unused:UNUSED_PAD src0_sel:WORD_1 src1_sel:WORD_0
    v_add_u32_sdwa v7, v7, v126 dst_sel:DWORD dst_unused:UNUSED_PAD src0_sel:WORD_1 src1_sel:WORD_1
    v_add_u32_sdwa v8, v8, v51 dst_sel:DWORD dst_unused:UNUSED_PAD src0_sel:WORD_1 src1_sel:WORD_0
    v_add_u32_sdwa v9, v9, v51 dst_sel:DWORD dst_unused:UNUSED_PAD src0_sel:WORD_1 src1_sel:WORD_1
    v_add_u32 v6, v6, v6
    v_add_u32 v7, v7, v7
    v_add_u32 v8, v8, v8
    v_add_u32 v9, v9, v9
    ds_write_b16 v6, v106 offset:16384
    ds_write_b16_d16_hi v7, v106 offset:16384
    ds_write_b16 v8, v107 offset:16384
    ds_write_b16_d16_hi v9, v107 offset:16384
    s_cmp_lg_u32 s40, 3
    s_cbranch_scc1 L_p1_kernel_ld_33
    s_add_u32 s36, s42, 10
    s_and_b32 s35, s36, 3
    s_mul_i32 s35, s35, 1047552
    s_lshl_b32 s36, s36, 20
    s_sub_u32 s36, s36, s35
    buffer_store_dwordx4 v[36:39], v3, s[72:75], s36 offen sc1
    s_branch L_p1_kernel_st_34
L_p1_kernel_ld_33:
    s_add_u32 s35, s33, 49348608
    buffer_load_dwordx4 v[36:39], v1, s[12:15], s35 offen nt
L_p1_kernel_st_34:
    v_mov_b32 v6, 1140817920
    s_waitcnt vmcnt(8)
    v_pk_maximum3_f16 v5, v108, v109, v5
    v_mad_u32_u16 v6, v55, s50, v15 op_sel:[0,0,0,0]
    v_mad_u32_u16 v7, v55, s50, v15 op_sel:[1,0,0,0]
    v_mad_u32_u16 v8, v59, s50, v15 op_sel:[0,0,0,0]
    v_mad_u32_u16 v9, v59, s50, v15 op_sel:[1,0,0,0]
    v_add_u32_sdwa v6, v6, v55 dst_sel:DWORD dst_unused:UNUSED_PAD src0_sel:WORD_1 src1_sel:WORD_0
    v_add_u32_sdwa v7, v7, v55 dst_sel:DWORD dst_unused:UNUSED_PAD src0_sel:WORD_1 src1_sel:WORD_1
    v_add_u32_sdwa v8, v8, v59 dst_sel:DWORD dst_unused:UNUSED_PAD src0_sel:WORD_1 src1_sel:WORD_0
    v_add_u32_sdwa v9, v9, v59 dst_sel:DWORD dst_unused:UNUSED_PAD src0_sel:WORD_1 src1_sel:WORD_1
    v_add_u32 v6, v6, v6
    v_add_u32 v7, v7, v7
    v_add_u32 v8, v8, v8
    v_add_u32 v9, v9, v9
    ds_write_b16 v6, v108 offset:16384
    ds_write_b16_d16_hi v7, v108 offset:16384
    ds_write_b16 v8, v109 offset:16384
    ds_write_b16_d16_hi v9, v109 offset:16384
    v_mov_b32 v6, 1140817920
    s_waitcnt vmcnt(7)
    v_pk_maximum3_f16 v5, v110, v111, v5
    v_mad_u32_u16 v6, v63, s50, v15 op_sel:[0,0,0,0]
    v_mad_u32_u16 v7, v63, s50, v15 op_sel:[1,0,0,0]
    v_mad_u32_u16 v8, v67, s50, v15 op_sel:[0,0,0,0]
    v_mad_u32_u16 v9, v67, s50, v15 op_sel:[1,0,0,0]
    v_add_u32_sdwa v6, v6, v63 dst_sel:DWORD dst_unused:UNUSED_PAD src0_sel:WORD_1 src1_sel:WORD_0
    v_add_u32_sdwa v7, v7, v63 dst_sel:DWORD dst_unused:UNUSED_PAD src0_sel:WORD_1 src1_sel:WORD_1
    v_add_u32_sdwa v8, v8, v67 dst_sel:DWORD dst_unused:UNUSED_PAD src0_sel:WORD_1 src1_sel:WORD_0
    v_add_u32_sdwa v9, v9, v67 dst_sel:DWORD dst_unused:UNUSED_PAD src0_sel:WORD_1 src1_sel:WORD_1
    v_add_u32 v6, v6, v6
    v_add_u32 v7, v7, v7
    v_add_u32 v8, v8, v8
    v_add_u32 v9, v9, v9
    ds_write_b16 v6, v110 offset:16384
    ds_write_b16_d16_hi v7, v110 offset:16384
    ds_write_b16 v8, v111 offset:16384
    ds_write_b16_d16_hi v9, v111 offset:16384
    v_mov_b32 v6, 1140817920
    s_waitcnt vmcnt(5)
    v_pk_maximum3_f16 v5, v112, v113, v5
    v_mad_u32_u16 v6, v71, s50, v15 op_sel:[0,0,0,0]
    v_mad_u32_u16 v7, v71, s50, v15 op_sel:[1,0,0,0]
    v_mad_u32_u16 v8, v75, s50, v15 op_sel:[0,0,0,0]
    v_mad_u32_u16 v9, v75, s50, v15 op_sel:[1,0,0,0]
    v_add_u32_sdwa v6, v6, v71 dst_sel:DWORD dst_unused:UNUSED_PAD src0_sel:WORD_1 src1_sel:WORD_0
    v_add_u32_sdwa v7, v7, v71 dst_sel:DWORD dst_unused:UNUSED_PAD src0_sel:WORD_1 src1_sel:WORD_1
    v_add_u32_sdwa v8, v8, v75 dst_sel:DWORD dst_unused:UNUSED_PAD src0_sel:WORD_1 src1_sel:WORD_0
    v_add_u32_sdwa v9, v9, v75 dst_sel:DWORD dst_unused:UNUSED_PAD src0_sel:WORD_1 src1_sel:WORD_1
    v_add_u32 v6, v6, v6
    v_add_u32 v7, v7, v7
    v_add_u32 v8, v8, v8
    v_add_u32 v9, v9, v9
    ds_write_b16 v6, v112 offset:16384
    ds_write_b16_d16_hi v7, v112 offset:16384
    ds_write_b16 v8, v113 offset:16384
    ds_write_b16_d16_hi v9, v113 offset:16384
    s_cmp_lg_u32 s40, 3
    s_cbranch_scc1 L_p1_kernel_ld_35
    s_add_u32 s36, s42, 11
    s_and_b32 s35, s36, 3
    s_mul_i32 s35, s35, 1047552
    s_lshl_b32 s36, s36, 20
    s_sub_u32 s36, s36, s35
    buffer_store_dwordx4 v[40:43], v3, s[72:75], s36 offen sc1
    s_branch L_p1_kernel_st_36
L_p1_kernel_ld_35:
    s_add_u32 s35, s33, 53542912
    buffer_load_dwordx4 v[40:43], v1, s[8:11], s35 offen nt
L_p1_kernel_st_36:
    v_mov_b32 v6, 1140817920
    s_waitcnt vmcnt(5)
    v_pk_maximum3_f16 v5, v114, v115, v5
    v_mad_u32_u16 v6, v79, s50, v15 op_sel:[0,0,0,0]
    v_mad_u32_u16 v7, v79, s50, v15 op_sel:[1,0,0,0]
    v_mad_u32_u16 v8, v83, s50, v15 op_sel:[0,0,0,0]
    v_mad_u32_u16 v9, v83, s50, v15 op_sel:[1,0,0,0]
    v_add_u32_sdwa v6, v6, v79 dst_sel:DWORD dst_unused:UNUSED_PAD src0_sel:WORD_1 src1_sel:WORD_0
    v_add_u32_sdwa v7, v7, v79 dst_sel:DWORD dst_unused:UNUSED_PAD src0_sel:WORD_1 src1_sel:WORD_1
    v_add_u32_sdwa v8, v8, v83 dst_sel:DWORD dst_unused:UNUSED_PAD src0_sel:WORD_1 src1_sel:WORD_0
    v_add_u32_sdwa v9, v9, v83 dst_sel:DWORD dst_unused:UNUSED_PAD src0_sel:WORD_1 src1_sel:WORD_1
    v_add_u32 v6, v6, v6
    v_add_u32 v7, v7, v7
    v_add_u32 v8, v8, v8
    v_add_u32 v9, v9, v9
    ds_write_b16 v6, v114 offset:16384
    ds_write_b16_d16_hi v7, v114 offset:16384
    ds_write_b16 v8, v115 offset:16384
    ds_write_b16_d16_hi v9, v115 offset:16384
    v_mov_b32 v6, 1140817920
    s_waitcnt vmcnt(3)
    v_pk_maximum3_f16 v5, v116, v117, v5
    v_mad_u32_u16 v6, v87, s50, v15 op_sel:[0,0,0,0]
    v_mad_u32_u16 v7, v87, s50, v15 op_sel:[1,0,0,0]
    v_mad_u32_u16 v8, v91, s50, v15 op_sel:[0,0,0,0]
    v_mad_u32_u16 v9, v91, s50, v15 op_sel:[1,0,0,0]
    v_add_u32_sdwa v6, v6, v87 dst_sel:DWORD dst_unused:UNUSED_PAD src0_sel:WORD_1 src1_sel:WORD_0
    v_add_u32_sdwa v7, v7, v87 dst_sel:DWORD dst_unused:UNUSED_PAD src0_sel:WORD_1 src1_sel:WORD_1
    v_add_u32_sdwa v8, v8, v91 dst_sel:DWORD dst_unused:UNUSED_PAD src0_sel:WORD_1 src1_sel:WORD_0
    v_add_u32_sdwa v9, v9, v91 dst_sel:DWORD dst_unused:UNUSED_PAD src0_sel:WORD_1 src1_sel:WORD_1
    v_add_u32 v6, v6, v6
    v_add_u32 v7, v7, v7
    v_add_u32 v8, v8, v8
    v_add_u32 v9, v9, v9
    ds_write_b16 v6, v116 offset:16384
    ds_write_b16_d16_hi v7, v116 offset:16384
    ds_write_b16 v8, v117 offset:16384
    ds_write_b16_d16_hi v9, v117 offset:16384
    v_mov_b32 v6, 1140817920
    s_mov_b64 exec, s[44:45]
    s_waitcnt vmcnt(2)
    v_pk_maximum3_f16 v5, v118, v119, v5
    s_mov_b64 exec, -1
    s_mov_b64 exec, s[44:45]
    v_mad_u32_u16 v6, v95, s50, v15 op_sel:[0,0,0,0]
    v_mad_u32_u16 v7, v95, s50, v15 op_sel:[1,0,0,0]
    v_mad_u32_u16 v8, v99, s50, v15 op_sel:[0,0,0,0]
    v_mad_u32_u16 v9, v99, s50, v15 op_sel:[1,0,0,0]
    v_add_u32_sdwa v6, v6, v95 dst_sel:DWORD dst_unused:UNUSED_PAD src0_sel:WORD_1 src1_sel:WORD_0
    v_add_u32_sdwa v7, v7, v95 dst_sel:DWORD dst_unused:UNUSED_PAD src0_sel:WORD_1 src1_sel:WORD_1
    v_add_u32_sdwa v8, v8, v99 dst_sel:DWORD dst_unused:UNUSED_PAD src0_sel:WORD_1 src1_sel:WORD_0
    v_add_u32_sdwa v9, v9, v99 dst_sel:DWORD dst_unused:UNUSED_PAD src0_sel:WORD_1 src1_sel:WORD_1
    v_add_u32 v6, v6, v6
    v_add_u32 v7, v7, v7
    v_add_u32 v8, v8, v8
    v_add_u32 v9, v9, v9
    ds_write_b16 v6, v118 offset:16384
    ds_write_b16_d16_hi v7, v118 offset:16384
    ds_write_b16 v8, v119 offset:16384
    ds_write_b16_d16_hi v9, v119 offset:16384
    s_mov_b64 exec, -1
    s_cmp_lg_u32 s40, 3
    s_cbranch_scc1 L_p1_kernel_ld_37
    s_add_u32 s36, s42, 12
    s_and_b32 s35, s36, 3
    s_mul_i32 s35, s35, 1047552
    s_lshl_b32 s36, s36, 20
    s_sub_u32 s36, s36, s35
    buffer_store_dwordx4 v[44:47], v3, s[72:75], s36 offen sc1
    s_branch L_p1_kernel_st_38
L_p1_kernel_ld_37:
    s_add_u32 s35, s33, 53542912
    buffer_load_dwordx4 v[44:47], v1, s[12:15], s35 offen nt
L_p1_kernel_st_38:
    s_mul_i32 s35, s39, 6144
    v_add_u32 v6, s35, v2
    v_mov_b32 v10, 1140817920
    s_waitcnt lgkmcnt(0)
    s_barrier
    ds_read_b64 v[120:121], v6 offset:23040
    ds_read_b64 v[122:123], v6 offset:16384
    ds_read_b64 v[124:125], v6 offset:16896
    ds_read_b64 v[126:127], v6 offset:17408
    ds_read_b64 v[100:101], v6 offset:17920
    ds_read_b64 v[102:103], v6 offset:18432
    ds_read_b64 v[104:105], v6 offset:18944
    ds_read_b64 v[106:107], v6 offset:19456
    ds_read_b64 v[108:109], v6 offset:19968
    ds_read_b64 v[110:111], v6 offset:20480
    ds_read_b64 v[112:113], v6 offset:20992
    ds_read_b64 v[114:115], v6 offset:21504
    ds_read_b64 v[116:117], v6 offset:22016
    ds_read_b64 v[118:119], v6 offset:22528
    s_add_u32 s33, s33, 40960000
    s_add_u32 s34, s34, 20480000
    s_add_u32 s40, s40, 1
    s_cmp_lt_u32 s40, 4
    s_cbranch_scc1 L_p1_loop
    s_cmp_lg_u32 s39, 15
    s_cbranch_scc1 L_p1_kernel_nox_39
    s_waitcnt lgkmcnt(13)
    v_lshlrev_b32 v15, 16, v120
    v_and_b32 v120, 0xffff0000, v120
    v_lshlrev_b32 v121, 16, v121
    v_mul_f32 v15, s41, v15
    v_mul_f32 v120, s41, v120
    v_mul_f32 v121, s41, v121
    v_fract_f32 v15, v15
    v_fract_f32 v120, v120
    v_fract_f32 v121, v121
    v_cos_f32 v15, v15
    v_cos_f32 v120, v120
    v_cos_f32 v121, v121
    v_fmaak_f32 v15, v10, v15, 1262486016
    v_fmaak_f32 v120, v10, v120, 1262486016
    v_fmaak_f32 v121, v10, v121, 1262486016
    v_lshlrev_b32 v15, 22, v15
    v_alignbit_b32 v15, v120, v15, 10
    v_alignbit_b32 v15, v121, v15, 10
    v_xor_b32 v15, 0x80200800, v15
    s_add_u32 s36, s42, 13
    s_and_b32 s35, s36, 3
    s_mul_i32 s35, s35, 1047552
    s_lshl_b32 s36, s36, 20
    s_sub_u32 s36, s36, s35
    buffer_store_dwordx4 v[12:15], v3, s[20:23], s36 offen sc1
L_p1_kernel_nox_39:
    s_waitcnt lgkmcnt(12)
    v_lshlrev_b32 v75, 16, v122
    v_and_b32 v122, 0xffff0000, v122
    v_lshlrev_b32 v123, 16, v123
    v_mul_f32 v75, s41, v75
    v_mul_f32 v122, s41, v122
    v_mul_f32 v123, s41, v123
    v_fract_f32 v75, v75
    v_fract_f32 v122, v122
    v_fract_f32 v123, v123
    v_cos_f32 v75, v75
    v_cos_f32 v122, v122
    v_cos_f32 v123, v123
    v_fmaak_f32 v75, v10, v75, 1262486016
    v_fmaak_f32 v122, v10, v122, 1262486016
    v_fmaak_f32 v123, v10, v123, 1262486016
    v_lshlrev_b32 v75, 22, v75
    v_alignbit_b32 v75, v122, v75, 10
    v_alignbit_b32 v75, v123, v75, 10
    v_xor_b32 v75, 0x80200800, v75
    s_add_u32 s36, s42, 0
    s_and_b32 s35, s36, 3
    s_mul_i32 s35, s35, 1047552
    s_lshl_b32 s36, s36, 20
    s_sub_u32 s36, s36, s35
    buffer_store_dwordx4 v[72:75], v3, s[20:23], s36 offen sc1
    s_waitcnt lgkmcnt(11)
    v_lshlrev_b32 v79, 16, v124
    v_and_b32 v124, 0xffff0000, v124
    v_lshlrev_b32 v125, 16, v125
    v_mul_f32 v79, s41, v79
    v_mul_f32 v124, s41, v124
    v_mul_f32 v125, s41, v125
    v_fract_f32 v79, v79
    v_fract_f32 v124, v124
    v_fract_f32 v125, v125
    v_cos_f32 v79, v79
    v_cos_f32 v124, v124
    v_cos_f32 v125, v125
    v_fmaak_f32 v79, v10, v79, 1262486016
    v_fmaak_f32 v124, v10, v124, 1262486016
    v_fmaak_f32 v125, v10, v125, 1262486016
    v_lshlrev_b32 v79, 22, v79
    v_alignbit_b32 v79, v124, v79, 10
    v_alignbit_b32 v79, v125, v79, 10
    v_xor_b32 v79, 0x80200800, v79
    s_add_u32 s36, s42, 1
    s_and_b32 s35, s36, 3
    s_mul_i32 s35, s35, 1047552
    s_lshl_b32 s36, s36, 20
    s_sub_u32 s36, s36, s35
    buffer_store_dwordx4 v[76:79], v3, s[20:23], s36 offen sc1
    s_waitcnt lgkmcnt(0)
    v_lshlrev_b32 v51, 16, v126
    v_and_b32 v126, 0xffff0000, v126
    v_lshlrev_b32 v127, 16, v127
    v_mul_f32 v51, s41, v51
    v_mul_f32 v126, s41, v126
    v_mul_f32 v127, s41, v127
    v_fract_f32 v51, v51
    v_fract_f32 v126, v126
    v_fract_f32 v127, v127
    v_cos_f32 v51, v51
    v_cos_f32 v126, v126
    v_cos_f32 v127, v127
    v_fmaak_f32 v51, v10, v51, 1262486016
    v_fmaak_f32 v126, v10, v126, 1262486016
    v_fmaak_f32 v127, v10, v127, 1262486016
    v_lshlrev_b32 v51, 22, v51
    v_alignbit_b32 v51, v126, v51, 10
    v_alignbit_b32 v51, v127, v51, 10
    v_xor_b32 v51, 0x80200800, v51
    s_add_u32 s36, s42, 2
    s_and_b32 s35, s36, 3
    s_mul_i32 s35, s35, 1047552
    s_lshl_b32 s36, s36, 20
    s_sub_u32 s36, s36, s35
    buffer_store_dwordx4 v[48:51], v3, s[20:23], s36 offen sc1
    v_lshlrev_b32 v83, 16, v100
    v_and_b32 v100, 0xffff0000, v100
    v_lshlrev_b32 v101, 16, v101
    v_mul_f32 v83, s41, v83
    v_mul_f32 v100, s41, v100
    v_mul_f32 v101, s41, v101
    v_fract_f32 v83, v83
    v_fract_f32 v100, v100
    v_fract_f32 v101, v101
    v_cos_f32 v83, v83
    v_cos_f32 v100, v100
    v_cos_f32 v101, v101
    v_fmaak_f32 v83, v10, v83, 1262486016
    v_fmaak_f32 v100, v10, v100, 1262486016
    v_fmaak_f32 v101, v10, v101, 1262486016
    v_lshlrev_b32 v83, 22, v83
    v_alignbit_b32 v83, v100, v83, 10
    v_alignbit_b32 v83, v101, v83, 10
    v_xor_b32 v83, 0x80200800, v83
    s_add_u32 s36, s42, 3
    s_and_b32 s35, s36, 3
    s_mul_i32 s35, s35, 1047552
    s_lshl_b32 s36, s36, 20
    s_sub_u32 s36, s36, s35
    buffer_store_dwordx4 v[80:83], v3, s[20:23], s36 offen sc1
    v_lshlrev_b32 v55, 16, v102
    v_and_b32 v102, 0xffff0000, v102
    v_lshlrev_b32 v103, 16, v103
    v_mul_f32 v55, s41, v55
    v_mul_f32 v102, s41, v102
    v_mul_f32 v103, s41, v103
    v_fract_f32 v55, v55
    v_fract_f32 v102, v102
    v_fract_f32 v103, v103
    v_cos_f32 v55, v55
    v_cos_f32 v102, v102
    v_cos_f32 v103, v103
    v_fmaak_f32 v55, v10, v55, 1262486016
    v_fmaak_f32 v102, v10, v102, 1262486016
    v_fmaak_f32 v103, v10, v103, 1262486016
    v_lshlrev_b32 v55, 22, v55
    v_alignbit_b32 v55, v102, v55, 10
    v_alignbit_b32 v55, v103, v55, 10
    v_xor_b32 v55, 0x80200800, v55
    s_add_u32 s36, s42, 4
    s_and_b32 s35, s36, 3
    s_mul_i32 s35, s35, 1047552
    s_lshl_b32 s36, s36, 20
    s_sub_u32 s36, s36, s35
    buffer_store_dwordx4 v[52:55], v3, s[20:23], s36 offen sc1
    v_lshlrev_b32 v87, 16, v104
    v_and_b32 v104, 0xffff0000, v104
    v_lshlrev_b32 v105, 16, v105
    v_mul_f32 v87, s41, v87
    v_mul_f32 v104, s41, v104
    v_mul_f32 v105, s41, v105
    v_fract_f32 v87, v87
    v_fract_f32 v104, v104
    v_fract_f32 v105, v105
    v_cos_f32 v87, v87
    v_cos_f32 v104, v104
    v_cos_f32 v105, v105
    v_fmaak_f32 v87, v10, v87, 1262486016
    v_fmaak_f32 v104, v10, v104, 1262486016
    v_fmaak_f32 v105, v10, v105, 1262486016
    v_lshlrev_b32 v87, 22, v87
    v_alignbit_b32 v87, v104, v87, 10
    v_alignbit_b32 v87, v105, v87, 10
    v_xor_b32 v87, 0x80200800, v87
    s_add_u32 s36, s42, 5
    s_and_b32 s35, s36, 3
    s_mul_i32 s35, s35, 1047552
    s_lshl_b32 s36, s36, 20
    s_sub_u32 s36, s36, s35
    buffer_store_dwordx4 v[84:87], v3, s[20:23], s36 offen sc1
    v_lshlrev_b32 v59, 16, v106
    v_and_b32 v106, 0xffff0000, v106
    v_lshlrev_b32 v107, 16, v107
    v_mul_f32 v59, s41, v59
    v_mul_f32 v106, s41, v106
    v_mul_f32 v107, s41, v107
    v_fract_f32 v59, v59
    v_fract_f32 v106, v106
    v_fract_f32 v107, v107
    v_cos_f32 v59, v59
    v_cos_f32 v106, v106
    v_cos_f32 v107, v107
    v_fmaak_f32 v59, v10, v59, 1262486016
    v_fmaak_f32 v106, v10, v106, 1262486016
    v_fmaak_f32 v107, v10, v107, 1262486016
    v_lshlrev_b32 v59, 22, v59
    v_alignbit_b32 v59, v106, v59, 10
    v_alignbit_b32 v59, v107, v59, 10
    v_xor_b32 v59, 0x80200800, v59
    s_add_u32 s36, s42, 6
    s_and_b32 s35, s36, 3
    s_mul_i32 s35, s35, 1047552
    s_lshl_b32 s36, s36, 20
    s_sub_u32 s36, s36, s35
    buffer_store_dwordx4 v[56:59], v3, s[20:23], s36 offen sc1
    v_lshlrev_b32 v91, 16, v108
    v_and_b32 v108, 0xffff0000, v108
    v_lshlrev_b32 v109, 16, v109
    v_mul_f32 v91, s41, v91
    v_mul_f32 v108, s41, v108
    v_mul_f32 v109, s41, v109
    v_fract_f32 v91, v91
    v_fract_f32 v108, v108
    v_fract_f32 v109, v109
    v_cos_f32 v91, v91
    v_cos_f32 v108, v108
    v_cos_f32 v109, v109
    v_fmaak_f32 v91, v10, v91, 1262486016
    v_fmaak_f32 v108, v10, v108, 1262486016
    v_fmaak_f32 v109, v10, v109, 1262486016
    v_lshlrev_b32 v91, 22, v91
    v_alignbit_b32 v91, v108, v91, 10
    v_alignbit_b32 v91, v109, v91, 10
    v_xor_b32 v91, 0x80200800, v91
    s_add_u32 s36, s42, 7
    s_and_b32 s35, s36, 3
    s_mul_i32 s35, s35, 1047552
    s_lshl_b32 s36, s36, 20
    s_sub_u32 s36, s36, s35
    buffer_store_dwordx4 v[88:91], v3, s[20:23], s36 offen sc1
    v_lshlrev_b32 v63, 16, v110
    v_and_b32 v110, 0xffff0000, v110
    v_lshlrev_b32 v111, 16, v111
    v_mul_f32 v63, s41, v63
    v_mul_f32 v110, s41, v110
    v_mul_f32 v111, s41, v111
    v_fract_f32 v63, v63
    v_fract_f32 v110, v110
    v_fract_f32 v111, v111
    v_cos_f32 v63, v63
    v_cos_f32 v110, v110
    v_cos_f32 v111, v111
    v_fmaak_f32 v63, v10, v63, 1262486016
    v_fmaak_f32 v110, v10, v110, 1262486016
    v_fmaak_f32 v111, v10, v111, 1262486016
    v_lshlrev_b32 v63, 22, v63
    v_alignbit_b32 v63, v110, v63, 10
    v_alignbit_b32 v63, v111, v63, 10
    v_xor_b32 v63, 0x80200800, v63
    s_add_u32 s36, s42, 8
    s_and_b32 s35, s36, 3
    s_mul_i32 s35, s35, 1047552
    s_lshl_b32 s36, s36, 20
    s_sub_u32 s36, s36, s35
    buffer_store_dwordx4 v[60:63], v3, s[20:23], s36 offen sc1
    v_lshlrev_b32 v95, 16, v112
    v_and_b32 v112, 0xffff0000, v112
    v_lshlrev_b32 v113, 16, v113
    v_mul_f32 v95, s41, v95
    v_mul_f32 v112, s41, v112
    v_mul_f32 v113, s41, v113
    v_fract_f32 v95, v95
    v_fract_f32 v112, v112
    v_fract_f32 v113, v113
    v_cos_f32 v95, v95
    v_cos_f32 v112, v112
    v_cos_f32 v113, v113
    v_fmaak_f32 v95, v10, v95, 1262486016
    v_fmaak_f32 v112, v10, v112, 1262486016
    v_fmaak_f32 v113, v10, v113, 1262486016
    v_lshlrev_b32 v95, 22, v95
    v_alignbit_b32 v95, v112, v95, 10
    v_alignbit_b32 v95, v113, v95, 10
    v_xor_b32 v95, 0x80200800, v95
    s_add_u32 s36, s42, 9
    s_and_b32 s35, s36, 3
    s_mul_i32 s35, s35, 1047552
    s_lshl_b32 s36, s36, 20
    s_sub_u32 s36, s36, s35
    buffer_store_dwordx4 v[92:95], v3, s[20:23], s36 offen sc1
    v_lshlrev_b32 v67, 16, v114
    v_and_b32 v114, 0xffff0000, v114
    v_lshlrev_b32 v115, 16, v115
    v_mul_f32 v67, s41, v67
    v_mul_f32 v114, s41, v114
    v_mul_f32 v115, s41, v115
    v_fract_f32 v67, v67
    v_fract_f32 v114, v114
    v_fract_f32 v115, v115
    v_cos_f32 v67, v67
    v_cos_f32 v114, v114
    v_cos_f32 v115, v115
    v_fmaak_f32 v67, v10, v67, 1262486016
    v_fmaak_f32 v114, v10, v114, 1262486016
    v_fmaak_f32 v115, v10, v115, 1262486016
    v_lshlrev_b32 v67, 22, v67
    v_alignbit_b32 v67, v114, v67, 10
    v_alignbit_b32 v67, v115, v67, 10
    v_xor_b32 v67, 0x80200800, v67
    s_add_u32 s36, s42, 10
    s_and_b32 s35, s36, 3
    s_mul_i32 s35, s35, 1047552
    s_lshl_b32 s36, s36, 20
    s_sub_u32 s36, s36, s35
    buffer_store_dwordx4 v[64:67], v3, s[20:23], s36 offen sc1
    v_lshlrev_b32 v99, 16, v116
    v_and_b32 v116, 0xffff0000, v116
    v_lshlrev_b32 v117, 16, v117
    v_mul_f32 v99, s41, v99
    v_mul_f32 v116, s41, v116
    v_mul_f32 v117, s41, v117
    v_fract_f32 v99, v99
    v_fract_f32 v116, v116
    v_fract_f32 v117, v117
    v_cos_f32 v99, v99
    v_cos_f32 v116, v116
    v_cos_f32 v117, v117
    v_fmaak_f32 v99, v10, v99, 1262486016
    v_fmaak_f32 v116, v10, v116, 1262486016
    v_fmaak_f32 v117, v10, v117, 1262486016
    v_lshlrev_b32 v99, 22, v99
    v_alignbit_b32 v99, v116, v99, 10
    v_alignbit_b32 v99, v117, v99, 10
    v_xor_b32 v99, 0x80200800, v99
    s_add_u32 s36, s42, 11
    s_and_b32 s35, s36, 3
    s_mul_i32 s35, s35, 1047552
    s_lshl_b32 s36, s36, 20
    s_sub_u32 s36, s36, s35
    buffer_store_dwordx4 v[96:99], v3, s[20:23], s36 offen sc1
    v_lshlrev_b32 v71, 16, v118
    v_and_b32 v118, 0xffff0000, v118
    v_lshlrev_b32 v119, 16, v119
    v_mul_f32 v71, s41, v71
    v_mul_f32 v118, s41, v118
    v_mul_f32 v119, s41, v119
    v_fract_f32 v71, v71
    v_fract_f32 v118, v118
    v_fract_f32 v119, v119
    v_cos_f32 v71, v71
    v_cos_f32 v118, v118
    v_cos_f32 v119, v119
    v_fmaak_f32 v71, v10, v71, 1262486016
    v_fmaak_f32 v118, v10, v118, 1262486016
    v_fmaak_f32 v119, v10, v119, 1262486016
    v_lshlrev_b32 v71, 22, v71
    v_alignbit_b32 v71, v118, v71, 10
    v_alignbit_b32 v71, v119, v71, 10
    v_xor_b32 v71, 0x80200800, v71
    s_add_u32 s36, s42, 12
    s_and_b32 s35, s36, 3
    s_mul_i32 s35, s35, 1047552
    s_lshl_b32 s36, s36, 20
    s_sub_u32 s36, s36, s35
    buffer_store_dwordx4 v[68:71], v3, s[20:23], s36 offen sc1
    v_and_b32 v6, 0x7c007c00, v5
    v_add_u32 v6, 0x04000400, v6
    v_and_b32 v6, 0x80008000, v6
    v_cmp_ne_u32 vcc, 0, v6
    s_lshl_b32 s35, s2, 3
    s_add_u32 s35, s35, 8519682
    s_mov_b32 s26, 8540160
    s_cmp_lg_u64 vcc, 0
    s_cselect_b32 s55, 1, s55
    s_cmp_eq_u32 s55, 0
    s_cbranch_scc1 L_p1_end
    s_mov_b64 exec, 1
    buffer_store_short v4, off, s[24:27], s35 sc1
L_p1_end:
    s_endpgm
.globl p2_kernel
.p2align 8
.type p2_kernel,@function
p2_kernel:
    s_cmp_ge_u32 s2, 256
    s_cbranch_scc1 L_p2_end
    s_load_dwordx2 s[4:5], s[0:1], 104
    s_load_dwordx2 s[100:101], s[0:1], 24
    s_load_dwordx2 s[8:9], s[0:1], 0
    s_load_dwordx2 s[30:31], s[0:1], 40
    s_load_dwordx4 s[32:35], s[0:1], 56
    s_load_dwordx4 s[36:39], s[0:1], 72
    s_and_b32 s14, s2, 7
    s_lshr_b32 s49, s2, 3
    s_and_b32 s3, s14, 1
    s_lshl_b32 s3, s3, 5
    s_add_u32 s3, s3, s49
    s_lshr_b32 s12, s14, 1
    v_lshrrev_b32 v108, 6, v0
    v_lshlrev_b32 v1, 4, v0
    v_and_b32 v109, 63, v0
    v_readfirstlane_b32 s13, v108
    v_lshlrev_b32 v111, 4, v109
    v_lshrrev_b32 v110, 2, v109
    v_mul_u32_u24 v110, 8256, v110
    v_add_u32 v110, v110, v111
    s_mul_i32 s14, s12, 65
    s_add_u32 s14, s14, s3
    s_lshl_b32 s14, s14, 5
    s_mul_i32 s15, s13, 532480
    s_add_u32 s14, s14, s15
    s_add_u32 s25, s14, 222298112
    s_mul_i32 s22, s12, 1280000
    s_mov_b32 s2, 0
    s_waitcnt lgkmcnt(0)
    s_mov_b32 s6, 655360000
    s_mov_b32 s7, 0x00020000
    s_add_u32 s10, s22, 1280000
    s_mov_b32 s11, 0x00020000
    s_add_u32 s15, s25, 0
    buffer_load_dwordx4 v[28:31], v110, s[4:7], s15 offen
    s_add_u32 s15, s25, 133120
    buffer_load_dwordx4 v[32:35], v110, s[4:7], s15 offen
    s_add_u32 s15, s25, 266240
    buffer_load_dwordx4 v[36:39], v110, s[4:7], s15 offen
    s_add_u32 s15, s25, 399360
    buffer_load_dwordx4 v[40:43], v110, s[4:7], s15 offen
    s_load_dwordx4 s[40:43], s[30:31], 0
    s_load_dwordx16 s[52:67], s[32:33], 0
    s_load_dwordx16 s[68:83], s[34:35], 0
    s_load_dwordx8 s[84:91], s[36:37], 0
    s_load_dwordx8 s[92:99], s[38:39], 0
    v_mov_b32 v52, 0x100
    s_cmp_lg_u32 s13, 0
    s_cbranch_scc1 L_p2_noann
    s_lshl_b32 s14, s3, 8
    s_add_u32 s14, s14, 230821888
    s_mov_b64 exec, 1
    buffer_atomic_add v52, off, s[4:7], s14
    s_mov_b64 exec, -1
L_p2_noann:
    s_add_u32 s14, s22, 0
    buffer_load_dwordx4 v[88:91], v1, s[8:11], s14 offen
    s_add_u32 s14, s22, 16384
    buffer_load_dwordx4 v[92:95], v1, s[8:11], s14 offen
    s_add_u32 s14, s22, 32768
    buffer_load_dwordx4 v[96:99], v1, s[8:11], s14 offen
    s_add_u32 s14, s22, 49152
    buffer_load_dwordx4 v[100:103], v1, s[8:11], s14 offen
    s_add_u32 s14, s22, 65536
    buffer_load_dwordx4 v[104:107], v1, s[8:11], s14 offen
    s_mov_b32 s15, 230817792
    buffer_load_dwordx4 v[80:83], v111, s[4:7], s15 offen offset:0
    buffer_load_dwordx4 v[84:87], v111, s[4:7], s15 offen offset:1024
    v_mov_b32 v2, v109
    v_mov_b32 v50, 21845
    v_add_u32 v3, 80000, v1
    v_add_u32 v124, 145536, v1
    v_add_u32 v113, 65536, v1
    v_mov_b32 v112, 0x7f000000
    v_cmp_gt_u32 vcc, 904, v0
    s_mul_i32 s19, s13, 240
    s_add_u32 s19, s19, 160000
    v_cndmask_b32 v124, v112, v124, vcc
    v_cndmask_b32 v113, v112, v113, vcc
    v_lshl_add_u32 v6, v109, 2, s19
    v_lshl_add_u32 v126, v109, 1, s19
    v_cmp_gt_u32 vcc, 10, v109
    s_lshl_b32 s27, s13, 18
    s_mov_b32 s23, 261888
    v_cndmask_b32 v6, v112, v6, vcc
    s_mov_b32 s44, s4
    s_add_u32 s45, s5, 1048576
    s_mov_b32 s46, 13893632
    s_mov_b32 s47, 0x00020000
    s_mov_b32 s18, 80000
    s_and_b32 s50, s3, 1
    s_lshl_b32 s50, s50, 18
    s_sub_u32 s18, s18, s50
    s_sub_u32 s50, 4294836224, s50
    v_lshlrev_b32 v116, 3, v0
    v_and_b32 v116, 16, v116
    v_and_b32 v117, 1, v0
    v_lshl_or_b32 v116, v117, 5, v116
    v_mov_b32 v58, 0x3f80
    v_mov_b32 v59, 0
    v_lshlrev_b64 v[58:59], v116, v[58:59]
    v_mov_b32 v4, 0
    v_mov_b32 v5, 0
    v_mov_b32 v114, 0xff00
    v_bfe_u32 v127, v0, 0, 1
    v_mul_u32_u24 v127, 40, v127
    v_add_u32 v127, s19, v127
    ds_write2_b32 v6, v5, v5 offset0:34 offset1:44
    ds_write_b16 v126, v114 offset:2
    v_mov_b32 v44, 1073758208
    v_mov_b32 v45, 1073758208
    v_mov_b32 v46, 1073758208
    v_mov_b32 v47, 1073758208
    v_mov_b32 v48, 1073758208
    v_mov_b32 v49, 1073758208
    ds_write_b128 v113, v[44:47]
    v_lshrrev_b32 v115, 4, v109
    v_mul_u32_u24 v115, 15360, v115
    v_lshl_add_u32 v115, v109, 6, v115
    v_lshl_add_u32 v115, v108, 10, v115
    s_waitcnt lgkmcnt(0)
    v_mov_b32 v53, s40
    v_mov_b32 v54, s41
    v_mov_b32 v56, s42
    v_mov_b32 v57, s43
    s_mov_b32 s40, 20987904
    s_mov_b32 s41, 21031594
    s_pack_ll_b32_b16 s14, s52, s54
    s_pack_hh_b32_b16 s15, s52, s54
    s_pack_ll_b32_b16 s54, s53, s55
    s_pack_hh_b32_b16 s55, s53, s55
    s_mov_b32 s52, s14
    s_mov_b32 s53, s15
    s_pack_ll_b32_b16 s14, s56, s58
    s_pack_hh_b32_b16 s15, s56, s58
    s_pack_ll_b32_b16 s58, s57, s59
    s_pack_hh_b32_b16 s59, s57, s59
    s_mov_b32 s56, s14
    s_mov_b32 s57, s15
    s_pack_ll_b32_b16 s14, s60, s62
    s_pack_hh_b32_b16 s15, s60, s62
    s_pack_ll_b32_b16 s62, s61, s63
    s_pack_hh_b32_b16 s63, s61, s63
    s_mov_b32 s60, s14
    s_mov_b32 s61, s15
    s_pack_ll_b32_b16 s14, s64, s66
    s_pack_hh_b32_b16 s15, s64, s66
    s_pack_ll_b32_b16 s66, s65, s67
    s_pack_hh_b32_b16 s67, s65, s67
    s_mov_b32 s64, s14
    s_mov_b32 s65, s15
    s_pack_ll_b32_b16 s14, s68, s70
    s_pack_hh_b32_b16 s15, s68, s70
    s_pack_ll_b32_b16 s70, s69, s71
    s_pack_hh_b32_b16 s71, s69, s71
    s_mov_b32 s68, s14
    s_mov_b32 s69, s15
    s_pack_ll_b32_b16 s14, s72, s74
    s_pack_hh_b32_b16 s15, s72, s74
    s_pack_ll_b32_b16 s74, s73, s75
    s_pack_hh_b32_b16 s75, s73, s75
    s_mov_b32 s72, s14
    s_mov_b32 s73, s15
    s_pack_ll_b32_b16 s14, s76, s78
    s_pack_hh_b32_b16 s15, s76, s78
    s_pack_ll_b32_b16 s78, s77, s79
    s_pack_hh_b32_b16 s79, s77, s79
    s_mov_b32 s76, s14
    s_mov_b32 s77, s15
    s_pack_ll_b32_b16 s14, s80, s82
    s_pack_hh_b32_b16 s15, s80, s82
    s_pack_ll_b32_b16 s82, s81, s83
    s_pack_hh_b32_b16 s83, s81, s83
    s_mov_b32 s80, s14
    s_mov_b32 s81, s15
    s_waitcnt vmcnt(10)
    ds_write_b128 v1, v[28:31] offset:0
    s_waitcnt vmcnt(9)
    ds_write_b128 v1, v[32:35] offset:16384
    s_waitcnt vmcnt(8)
    ds_write_b128 v1, v[36:39] offset:32768
    s_waitcnt vmcnt(7)
    ds_write_b128 v1, v[40:43] offset:49152
    ds_read_b128 v[28:31], v115 offset:0
    ds_read_b128 v[36:39], v115 offset:32
    ds_read_b128 v[32:35], v115 offset:16
    ds_read_b128 v[40:43], v115 offset:48
    ds_write_b128 v1, v[44:47] offset:0
    ds_write_b128 v1, v[44:47] offset:16384
    ds_write_b128 v1, v[44:47] offset:32768
    ds_write_b128 v1, v[44:47] offset:49152
    s_waitcnt lgkmcnt(6)
    v_mad_u32_u16 v108, v28, v50, s40 op_sel:[0,0,0,0]
    v_mad_u32_u16 v109, v36, v50, s41 op_sel:[0,0,0,0]
    v_sub_u32_sdwa v110, v109, v108 dst_sel:DWORD dst_unused:UNUSED_PAD src0_sel:WORD_1 src1_sel:WORD_1
    s_nop 1
    v_add_u32_dpp v110, v110, v110 row_shr:1 row_mask:0xf bank_mask:0xf bound_ctrl:0
    s_nop 1
    v_add_u32_dpp v110, v110, v110 row_shr:2 row_mask:0xf bank_mask:0xf bound_ctrl:0
    s_nop 1
    v_add_u32_dpp v110, v110, v110 row_shr:4 row_mask:0xf bank_mask:0xf bound_ctrl:0
    s_nop 1
    v_add_u32_dpp v110, v110, v110 row_shr:8 row_mask:0xf bank_mask:0xf bound_ctrl:0
    s_nop 1
    v_add_u32_dpp v110, v110, v110 row_bcast:15 row_mask:0xa bank_mask:0xf
    s_nop 1
    v_add_u32_dpp v110, v110, v110 row_bcast:31 row_mask:0xc bank_mask:0xf
    v_sub_u32_sdwa v109, v109, v110 dst_sel:DWORD dst_unused:UNUSED_PAD src0_sel:WORD_1 src1_sel:DWORD
    v_readlane_b32 s29, v110, 63
    v_add_u32 v110, -1, v110
    ds_write_b16 v126, v109
    v_lshlrev_b32_e64 v111, v110, 1
    v_lshrrev_b32 v110, 5, v110
    s_cmp_gt_u32 s29, 320
    s_cselect_b32 s2, 1, s2
    v_lshl_add_u32 v110, v110, 2, v127
    s_cselect_b64 exec, 0, -1
    ds_or_b32 v110, v111 offset:136
    s_mov_b64 exec, -1
    ds_wrxchg2_rtn_b32 v[108:109], v6, v5, v5 offset0:34 offset1:44
    s_waitcnt lgkmcnt(0)
    v_or_b32 v7, v108, v109
    s_nop 0
    v_readlane_b32 s30, v7, 0
    v_readlane_b32 s31, v7, 1
    v_readlane_b32 s32, v7, 2
    v_readlane_b32 s33, v7, 3
    v_readlane_b32 s34, v7, 4
    v_readlane_b32 s35, v7, 5
    v_readlane_b32 s36, v7, 6
    v_readlane_b32 s37, v7, 7
    s_mov_b32 s25, s19
    s_mov_b32 s26, s27
    s_mov_b32 s51, s28
    s_mov_b32 s28, s29
    v_mbcnt_lo_u32_b32 v8, s30, 0
    v_mbcnt_hi_u32_b32 v8, s31, v8
    s_bcnt1_i32_b64 s14, s[30:31]
    v_lshl_add_u32 v9, v8, 1, s25
    ds_read_u16 v9, v9
    s_mov_b32 s30, s26
    s_movk_i32 s31, -320
    s_lshl1_add_u32 s25, s14, s25
    s_lshl_b32 s14, s14, 12
    s_add_u32 s26, s26, s14
    v_mbcnt_lo_u32_b32 v12, s32, 0
    v_mbcnt_hi_u32_b32 v12, s33, v12
    s_bcnt1_i32_b64 s14, s[32:33]
    v_lshl_add_u32 v13, v12, 1, s25
    ds_read_u16 v13, v13
    s_mov_b32 s32, s26
    s_movk_i32 s33, -256
    s_lshl1_add_u32 s25, s14, s25
    s_lshl_b32 s14, s14, 12
    s_add_u32 s26, s26, s14
    v_mbcnt_lo_u32_b32 v16, s34, 0
    v_mbcnt_hi_u32_b32 v16, s35, v16
    s_bcnt1_i32_b64 s14, s[34:35]
    v_lshl_add_u32 v17, v16, 1, s25
    ds_read_u16 v17, v17
    s_mov_b32 s34, s26
    s_movk_i32 s35, -192
    s_lshl1_add_u32 s25, s14, s25
    s_lshl_b32 s14, s14, 12
    s_add_u32 s26, s26, s14
    v_mbcnt_lo_u32_b32 v20, s36, 0
    v_mbcnt_hi_u32_b32 v20, s37, v20
    s_bcnt1_i32_b64 s14, s[36:37]
    v_lshl_add_u32 v21, v20, 1, s25
    ds_read_u16 v21, v21
    s_mov_b32 s36, s26
    s_movk_i32 s37, -128
    s_lshl1_add_u32 s25, s14, s25
    s_lshl_b32 s14, s14, 12
    s_add_u32 s26, s26, s14
    s_waitcnt lgkmcnt(3)
    v_add3_u32 v9, v9, v2, s31
    v_lshl_add_u32 v8, v8, 8, v9
    v_lshrrev_b32 v9, 8, v9
    v_mad_u32_u24 v8, v9, s23, v8
    buffer_load_dwordx4 v[8:11], v8, s[44:47], s30 idxen
    s_waitcnt lgkmcnt(2)
    v_add3_u32 v13, v13, v2, s33
    v_lshl_add_u32 v12, v12, 8, v13
    v_lshrrev_b32 v13, 8, v13
    v_mad_u32_u24 v12, v13, s23, v12
    buffer_load_dwordx4 v[12:15], v12, s[44:47], s32 idxen
    s_waitcnt lgkmcnt(1)
    v_add3_u32 v17, v17, v2, s35
    v_lshl_add_u32 v16, v16, 8, v17
    v_lshrrev_b32 v17, 8, v17
    v_mad_u32_u24 v16, v17, s23, v16
    buffer_load_dwordx4 v[16:19], v16, s[44:47], s34 idxen
    s_waitcnt lgkmcnt(0)
    v_add3_u32 v21, v21, v2, s37
    v_lshl_add_u32 v20, v20, 8, v21
    v_lshrrev_b32 v21, 8, v21
    v_mad_u32_u24 v20, v21, s23, v20
    buffer_load_dwordx4 v[20:23], v20, s[44:47], s36 idxen
    s_cmp_le_u32 s28, 256
    s_cbranch_scc1 L_p2_kernel_noopt_1
    v_readlane_b32 s38, v7, 8
    v_readlane_b32 s39, v7, 9
    s_nop 1
    v_mbcnt_lo_u32_b32 v51, s38, 0
    v_mbcnt_hi_u32_b32 v51, s39, v51
    s_bcnt1_i32_b64 s14, s[38:39]
    v_lshl_add_u32 v55, v51, 1, s25
    ds_read_u16 v55, v55
    s_mov_b32 s38, s26
    s_movk_i32 s39, -64
    s_lshl1_add_u32 s25, s14, s25
    s_lshl_b32 s14, s14, 12
    s_add_u32 s26, s26, s14
    s_waitcnt lgkmcnt(0)
    v_add3_u32 v55, v55, v2, s39
    v_lshl_add_u32 v51, v51, 8, v55
    v_lshrrev_b32 v55, 8, v55
    v_mad_u32_u24 v51, v55, s23, v51
    buffer_load_dwordx4 v[24:27], v51, s[44:47], s38 idxen
L_p2_kernel_noopt_1:
    s_waitcnt vmcnt(6)
    ds_write_b128 v3, v[88:91] offset:0
    ds_write_b128 v3, v[92:95] offset:16384
    ds_write_b128 v3, v[96:99] offset:32768
    ds_write_b128 v3, v[100:103] offset:49152
    ds_write_b128 v124, v[104:107] offset:0
    s_waitcnt vmcnt(4)
    v_max3_u32 v64, v80, v82, v84
    v_add_f32 v65, v81, v83
    v_add_f32 v66, v85, v87
    v_max_u32 v64, v64, v86
    v_add_f32 v65, v65, v66
    v_cmp_lt_u32 vcc, 0xffff, v64
    s_nop 1
    v_max_u32_dpp v64, v64, v64 row_shr:1 row_mask:0xf bank_mask:0xf bound_ctrl:0
    s_nop 1
    v_max_u32_dpp v64, v64, v64 row_shr:2 row_mask:0xf bank_mask:0xf bound_ctrl:0
    s_nop 1
    v_max_u32_dpp v64, v64, v64 row_shr:4 row_mask:0xf bank_mask:0xf bound_ctrl:0
    s_nop 1
    v_max_u32_dpp v64, v64, v64 row_shr:8 row_mask:0xf bank_mask:0xf bound_ctrl:0
    s_nop 1
    v_max_u32_dpp v64, v64, v64 row_bcast:15 row_mask:0xa bank_mask:0xf
    s_nop 1
    v_max_u32_dpp v64, v64, v64 row_bcast:31 row_mask:0xc bank_mask:0xf
    s_nop 1
    v_add_f32_dpp v65, v65, v65 row_shr:1 row_mask:0xf bank_mask:0xf bound_ctrl:0
    s_nop 1
    v_add_f32_dpp v65, v65, v65 row_shr:2 row_mask:0xf bank_mask:0xf bound_ctrl:0
    s_nop 1
    v_add_f32_dpp v65, v65, v65 row_shr:4 row_mask:0xf bank_mask:0xf bound_ctrl:0
    s_nop 1
    v_add_f32_dpp v65, v65, v65 row_shr:8 row_mask:0xf bank_mask:0xf bound_ctrl:0
    s_nop 1
    v_add_f32_dpp v65, v65, v65 row_bcast:15 row_mask:0xa bank_mask:0xf
    s_nop 1
    v_add_f32_dpp v65, v65, v65 row_bcast:31 row_mask:0xc bank_mask:0xf
    s_cmp_lg_u64 vcc, 0
    s_cselect_b32 s2, 1, s2
    v_lshlrev_b32 v64, 16, v64
    v_mul_f32 v66, 936490775, v65
    v_mul_f32 v65, 928531664, v65
    v_cmp_nle_f32 vcc, v64, v66
    v_max_u32 v64, v64, v65
    s_nop 0
    v_readlane_b32 s14, v64, 63
    s_bitcmp1_b32 vcc_hi, 31
    s_cselect_b32 s2, 1, s2
    s_lshr_b32 s14, s14, 23
    s_add_u32 s14, s14, 1
    s_cmp_lt_u32 s14, 40
    s_cselect_b32 s2, 1, s2
    s_cmp_gt_u32 s14, 230
    s_cselect_b32 s2, 1, s2
    s_sub_u32 s48, s14, 14
    s_lshl_b32 s48, s48, 23
    s_add_u32 s16, s48, 272629760
    s_lshr_b32 s15, s16, 16
    s_sub_u32 s15, 0x10000, s15
    s_add_u32 s20, s16, s15
    s_sub_u32 s17, s20, 1
    s_mov_b32 s21, s17
    s_or_b32 s48, s48, 16416
    s_sub_u32 s14, s14, 40
    s_cmp_gt_u32 s14, 190
    s_cselect_b32 s48, 0, s48
    s_waitcnt lgkmcnt(0)
    s_barrier
    s_add_u32 s14, s22, 80000
    buffer_load_dwordx4 v[88:91], v1, s[8:11], s14 offen
    s_add_u32 s14, s22, 96384
    buffer_load_dwordx4 v[92:95], v1, s[8:11], s14 offen
    v_mad_u32_u16 v108, v28, v50, s40 op_sel:[1,0,0,0]
    v_mad_u32_u16 v109, v36, v50, s41 op_sel:[1,0,0,0]
    v_sub_u32_sdwa v110, v109, v108 dst_sel:DWORD dst_unused:UNUSED_PAD src0_sel:WORD_1 src1_sel:WORD_1
    s_nop 1
    v_add_u32_dpp v110, v110, v110 row_shr:1 row_mask:0xf bank_mask:0xf bound_ctrl:0
    s_nop 1
    v_add_u32_dpp v110, v110, v110 row_shr:2 row_mask:0xf bank_mask:0xf bound_ctrl:0
    s_nop 1
    v_add_u32_dpp v110, v110, v110 row_shr:4 row_mask:0xf bank_mask:0xf bound_ctrl:0
    s_nop 1
    v_add_u32_dpp v110, v110, v110 row_shr:8 row_mask:0xf bank_mask:0xf bound_ctrl:0
    s_nop 1
    v_add_u32_dpp v110, v110, v110 row_bcast:15 row_mask:0xa bank_mask:0xf
    s_nop 1
    v_add_u32_dpp v110, v110, v110 row_bcast:31 row_mask:0xc bank_mask:0xf
    v_sub_u32_sdwa v109, v109, v110 dst_sel:DWORD dst_unused:UNUSED_PAD src0_sel:WORD_1 src1_sel:DWORD
    v_readlane_b32 s29, v110, 63
    v_add_u32 v110, -1, v110
    ds_write_b16 v126, v109
    v_lshlrev_b32_e64 v111, v110, 1
    v_lshrrev_b32 v110, 5, v110
    s_cmp_gt_u32 s29, 320
    s_cselect_b32 s2, 1, s2
    v_lshl_add_u32 v110, v110, 2, v127
    s_cselect_b64 exec, 0, -1
    ds_or_b32 v110, v111 offset:136
    s_mov_b64 exec, -1
    ds_wrxchg2_rtn_b32 v[108:109], v6, v5, v5 offset0:34 offset1:44
    s_mov_b32 s24, 0
L_p2_loop:
    s_add_u32 s22, s22, 80000
    s_lshl_b32 s14, s13, 4
    s_or_b32 s14, s14, s24
    s_cmp_lg_u32 s14, 5
    s_cbranch_scc1 L_p2_nost
    v_mov_b32 v52, 0
    s_lshl_b32 s14, s3, 8
    s_add_u32 s14, s14, 230821888
    s_mov_b64 exec, 1
    buffer_atomic_add v52, off, s[4:7], s14 sc0
    s_mov_b64 exec, -1
L_p2_nost:
    s_waitcnt vmcnt(5)
    v_mad_u32_u16 v64, v8, 8, s18
    v_mad_u32_u16 v66, v9, 8, s18
    v_mad_u32_u16 v68, v10, 8, s18
    ds_read_b64 v[64:65], v64
    ds_read_b64 v[66:67], v66
    ds_read_b64 v[68:69], v68
    s_add_u32 s14, s22, 32768
    buffer_load_dwordx4 v[96:99], v1, s[8:11], s14 offen
    s_waitcnt vmcnt(5)
    v_mad_u32_u16 v70, v12, 8, s18
    v_mad_u32_u16 v72, v13, 8, s18
    v_mad_u32_u16 v74, v14, 8, s18
    ds_read_b64 v[70:71], v70
    ds_read_b64 v[72:73], v72
    ds_read_b64 v[74:75], v74
    s_add_u32 s14, s22, 49152
    buffer_load_dwordx4 v[100:103], v1, s[8:11], s14 offen
    s_waitcnt lgkmcnt(6)
    v_or_b32 v7, v108, v109
    s_nop 0
    v_readlane_b32 s30, v7, 0
    v_readlane_b32 s31, v7, 1
    v_readlane_b32 s32, v7, 2
    v_readlane_b32 s33, v7, 3
    v_readlane_b32 s34, v7, 4
    v_readlane_b32 s35, v7, 5
    v_readlane_b32 s36, v7, 6
    v_readlane_b32 s37, v7, 7
    s_mov_b32 s25, s19
    s_mov_b32 s26, s27
    s_mov_b32 s51, s28
    s_mov_b32 s28, s29
    v_mbcnt_lo_u32_b32 v51, s30, 0
    v_mbcnt_hi_u32_b32 v51, s31, v51
    s_bcnt1_i32_b64 s14, s[30:31]
    v_lshl_add_u32 v55, v51, 1, s25
    ds_read_u16 v55, v55
    s_mov_b32 s30, s26
    s_movk_i32 s31, -320
    s_lshl1_add_u32 s25, s14, s25
    s_lshl_b32 s14, s14, 12
    s_add_u32 s26, s26, s14
    v_bfe_i32 v108, v11, 2, 10
    v_bfe_i32 v109, v11, 12, 10
    v_ashrrev_i32 v110, 22, v11
    v_cvt_f32_i32 v108, v108
    v_cvt_f32_i32 v109, v109
    v_cvt_f32_i32 v110, v110
    s_waitcnt lgkmcnt(4)
    v_mfma_f32_4x4x4_16b_bf16 v[112:115], v[58:59], v[64:65], 0
    v_mfma_f32_4x4x4_16b_bf16 v[116:119], v[58:59], v[66:67], 0
    v_mfma_f32_4x4x4_16b_bf16 v[120:123], v[58:59], v[68:69], 0
    v_mad_u32_u16 v8, v8, 8, s50 op_sel:[1,0,0,0]
    v_mad_u32_u16 v9, v9, 8, s50 op_sel:[1,0,0,0]
    v_mad_u32_u16 v10, v10, 8, s50 op_sel:[1,0,0,0]
    v_pk_fma_f32 v[114:115], v[114:115], v[108:109], s[20:21] op_sel:[0,0,0] op_sel_hi:[1,0,1]
    v_pk_fma_f32 v[112:113], v[112:113], v[108:109], s[16:17] op_sel:[0,0,0] op_sel_hi:[1,0,1]
    v_pk_fma_f32 v[118:119], v[118:119], v[108:109], s[20:21] op_sel:[0,1,0] op_sel_hi:[1,1,1]
    v_pk_fma_f32 v[116:117], v[116:117], v[108:109], s[16:17] op_sel:[0,1,0] op_sel_hi:[1,1,1]
    v_pk_fma_f32 v[122:123], v[122:123], v[110:111], s[20:21] op_sel:[0,0,0] op_sel_hi:[1,0,1]
    v_pk_fma_f32 v[120:121], v[120:121], v[110:111], s[16:17] op_sel:[0,0,0] op_sel_hi:[1,0,1]
    v_lshlrev_b64 v[114:115], 16, v[114:115]
    v_lshlrev_b64 v[118:119], 16, v[118:119]
    v_lshlrev_b64 v[122:123], 16, v[122:123]
    v_lshl_add_u64 v[64:65], v[112:113], 0, v[114:115]
    v_lshl_add_u64 v[66:67], v[116:117], 0, v[118:119]
    v_lshl_add_u64 v[68:69], v[120:121], 0, v[122:123]
    v_or3_b32 v4, v44, v45, v4
    v_or3_b32 v4, v46, v47, v4
    v_or3_b32 v4, v48, v49, v4
    ds_add_rtn_u64 v[44:45], v8, v[64:65]
    ds_add_rtn_u64 v[46:47], v9, v[66:67]
    ds_add_rtn_u64 v[48:49], v10, v[68:69]
    s_waitcnt lgkmcnt(3)
    v_add3_u32 v55, v55, v2, s31
    v_lshl_add_u32 v51, v51, 8, v55
    v_lshrrev_b32 v55, 8, v55
    v_mad_u32_u24 v51, v55, s23, v51
    buffer_load_dwordx4 v[8:11], v51, s[44:47], s30 idxen
    s_sub_u32 s14, s22, 80000
    buffer_load_dwordx4 v[104:107], v124, s[8:11], s14 offen
    s_waitcnt vmcnt(7)
    v_mad_u32_u16 v76, v16, 8, s18
    v_mad_u32_u16 v78, v17, 8, s18
    v_mad_u32_u16 v80, v18, 8, s18
    ds_read_b64 v[76:77], v76
    ds_read_b64 v[78:79], v78
    ds_read_b64 v[80:81], v80
    s_waitcnt vmcnt(6)
    v_mad_u32_u16 v82, v20, 8, s18
    v_mad_u32_u16 v84, v21, 8, s18
    v_mad_u32_u16 v86, v22, 8, s18
    ds_read_b64 v[82:83], v82
    ds_read_b64 v[84:85], v84
    ds_read_b64 v[86:87], v86
    s_cmp_le_u32 s51, 256
    s_cbranch_scc1 L_p2_kernel_noopt3_2
    v_mad_u32_u16 v64, v24, 8, s18
    v_mad_u32_u16 v66, v25, 8, s18
    v_mad_u32_u16 v68, v26, 8, s18
    ds_read_b64 v[64:65], v64
    ds_read_b64 v[66:67], v66
    ds_read_b64 v[68:69], v68
L_p2_kernel_noopt3_2:
    v_mbcnt_lo_u32_b32 v51, s32, 0
    v_mbcnt_hi_u32_b32 v51, s33, v51
    s_bcnt1_i32_b64 s14, s[32:33]
    v_lshl_add_u32 v55, v51, 1, s25
    ds_read_u16 v55, v55
    s_mov_b32 s32, s26
    s_movk_i32 s33, -256
    s_lshl1_add_u32 s25, s14, s25
    s_lshl_b32 s14, s14, 12
    s_add_u32 s26, s26, s14
    v_bfe_i32 v108, v15, 2, 10
    v_bfe_i32 v109, v15, 12, 10
    v_ashrrev_i32 v110, 22, v15
    v_cvt_f32_i32 v108, v108
    v_cvt_f32_i32 v109, v109
    v_cvt_f32_i32 v110, v110
    v_mfma_f32_4x4x4_16b_bf16 v[112:115], v[58:59], v[70:71], 0
    v_mfma_f32_4x4x4_16b_bf16 v[116:119], v[58:59], v[72:73], 0
    v_mfma_f32_4x4x4_16b_bf16 v[120:123], v[58:59], v[74:75], 0
    v_mad_u32_u16 v12, v12, 8, s50 op_sel:[1,0,0,0]
    v_mad_u32_u16 v13, v13, 8, s50 op_sel:[1,0,0,0]
    v_mad_u32_u16 v14, v14, 8, s50 op_sel:[1,0,0,0]
    v_pk_fma_f32 v[114:115], v[114:115], v[108:109], s[20:21] op_sel:[0,0,0] op_sel_hi:[1,0,1]
    v_pk_fma_f32 v[112:113], v[112:113], v[108:109], s[16:17] op_sel:[0,0,0] op_sel_hi:[1,0,1]
    v_pk_fma_f32 v[118:119], v[118:119], v[108:109], s[20:21] op_sel:[0,1,0] op_sel_hi:[1,1,1]
    v_pk_fma_f32 v[116:117], v[116:117], v[108:109], s[16:17] op_sel:[0,1,0] op_sel_hi:[1,1,1]
    v_pk_fma_f32 v[122:123], v[122:123], v[110:111], s[20:21] op_sel:[0,0,0] op_sel_hi:[1,0,1]
    v_pk_fma_f32 v[120:121], v[120:121], v[110:111], s[16:17] op_sel:[0,0,0] op_sel_hi:[1,0,1]
    v_lshlrev_b64 v[114:115], 16, v[114:115]
    v_lshlrev_b64 v[118:119], 16, v[118:119]
    v_lshlrev_b64 v[122:123], 16, v[122:123]
    v_lshl_add_u64 v[70:71], v[112:113], 0, v[114:115]
    v_lshl_add_u64 v[72:73], v[116:117], 0, v[118:119]
    v_lshl_add_u64 v[74:75], v[120:121], 0, v[122:123]
    s_waitcnt lgkmcnt(7)
    v_or3_b32 v4, v44, v45, v4
    v_or3_b32 v4, v46, v47, v4
    v_or3_b32 v4, v48, v49, v4
    ds_add_rtn_u64 v[44:45], v12, v[70:71]
    ds_add_rtn_u64 v[46:47], v13, v[72:73]
    ds_add_rtn_u64 v[48:49], v14, v[74:75]
    s_waitcnt lgkmcnt(3)
    v_add3_u32 v55, v55, v2, s33
    v_lshl_add_u32 v51, v51, 8, v55
    v_lshrrev_b32 v55, 8, v55
    v_mad_u32_u24 v51, v55, s23, v51
    buffer_load_dwordx4 v[12:15], v51, s[44:47], s32 idxen
    s_barrier
    s_waitcnt vmcnt(1)
    ds_write_b128 v3, v[88:91] offset:0
    ds_write_b128 v3, v[92:95] offset:16384
    ds_write_b128 v3, v[96:99] offset:32768
    ds_write_b128 v3, v[100:103] offset:49152
    ds_write_b128 v124, v[104:107] offset:0
    s_cmp_lg_u32 s24, 7
    s_cbranch_scc1 L_p2_nofin
    s_mul_i32 s14, s3, 20000
    s_mul_i32 s15, s12, 4992
    s_add_u32 s14, s14, s15
    s_add_u32 s15, s14, 4096
    v_min_u32 v61, 231, v0
    v_lshl_add_u32 v60, v0, 2, s14
    v_lshl_add_u32 v61, v61, 2, s15
    global_load_dword v60, v60, s[100:101] nt
    global_load_dword v61, v61, s[100:101] nt
    s_lshl_b32 s14, s14, 2
    s_lshl_b32 s15, s15, 2
    v_min_u32 v36, 231, v0
    v_add_u32 v28, s14, v1
    v_lshl_add_u32 v36, v36, 4, s15
    global_load_dwordx4 v[28:31], v28, s[8:9]
    global_load_dwordx4 v[36:39], v36, s[8:9]
L_p2_nofin:
    v_mbcnt_lo_u32_b32 v51, s34, 0
    v_mbcnt_hi_u32_b32 v51, s35, v51
    s_bcnt1_i32_b64 s14, s[34:35]
    v_lshl_add_u32 v55, v51, 1, s25
    ds_read_u16 v55, v55
    s_mov_b32 s34, s26
    s_movk_i32 s35, -192
    s_lshl1_add_u32 s25, s14, s25
    s_lshl_b32 s14, s14, 12
    s_add_u32 s26, s26, s14
    v_bfe_i32 v108, v19, 2, 10
    v_bfe_i32 v109, v19, 12, 10
    v_ashrrev_i32 v110, 22, v19
    v_cvt_f32_i32 v108, v108
    v_cvt_f32_i32 v109, v109
    v_cvt_f32_i32 v110, v110
    v_mfma_f32_4x4x4_16b_bf16 v[112:115], v[58:59], v[76:77], 0
    v_mfma_f32_4x4x4_16b_bf16 v[116:119], v[58:59], v[78:79], 0
    v_mfma_f32_4x4x4_16b_bf16 v[120:123], v[58:59], v[80:81], 0
    v_mad_u32_u16 v16, v16, 8, s50 op_sel:[1,0,0,0]
    v_mad_u32_u16 v17, v17, 8, s50 op_sel:[1,0,0,0]
    v_mad_u32_u16 v18, v18, 8, s50 op_sel:[1,0,0,0]
    v_pk_fma_f32 v[114:115], v[114:115], v[108:109], s[20:21] op_sel:[0,0,0] op_sel_hi:[1,0,1]
    v_pk_fma_f32 v[112:113], v[112:113], v[108:109], s[16:17] op_sel:[0,0,0] op_sel_hi:[1,0,1]
    v_pk_fma_f32 v[118:119], v[118:119], v[108:109], s[20:21] op_sel:[0,1,0] op_sel_hi:[1,1,1]
    v_pk_fma_f32 v[116:117], v[116:117], v[108:109], s[16:17] op_sel:[0,1,0] op_sel_hi:[1,1,1]
    v_pk_fma_f32 v[122:123], v[122:123], v[110:111], s[20:21] op_sel:[0,0,0] op_sel_hi:[1,0,1]
    v_pk_fma_f32 v[120:121], v[120:121], v[110:111], s[16:17] op_sel:[0,0,0] op_sel_hi:[1,0,1]
    v_lshlrev_b64 v[114:115], 16, v[114:115]
    v_lshlrev_b64 v[118:119], 16, v[118:119]
    v_lshlrev_b64 v[122:123], 16, v[122:123]
    v_lshl_add_u64 v[76:77], v[112:113], 0, v[114:115]
    v_lshl_add_u64 v[78:79], v[116:117], 0, v[118:119]
    v_lshl_add_u64 v[80:81], v[120:121], 0, v[122:123]
    s_waitcnt lgkmcnt(6)
    v_or3_b32 v4, v44, v45, v4
    v_or3_b32 v4, v46, v47, v4
    v_or3_b32 v4, v48, v49, v4
    ds_add_rtn_u64 v[44:45], v16, v[76:77]
    ds_add_rtn_u64 v[46:47], v17, v[78:79]
    ds_add_rtn_u64 v[48:49], v18, v[80:81]
    s_waitcnt lgkmcnt(3)
    v_add3_u32 v55, v55, v2, s35
    v_lshl_add_u32 v51, v51, 8, v55
    v_lshrrev_b32 v55, 8, v55
    v_mad_u32_u24 v51, v55, s23, v51
    buffer_load_dwordx4 v[16:19], v51, s[44:47], s34 idxen
    s_cmp_le_u32 s51, 256
    s_cbranch_scc1 L_p2_kernel_noopt3_3
    v_bfe_i32 v108, v27, 2, 10
    v_bfe_i32 v109, v27, 12, 10
    v_ashrrev_i32 v110, 22, v27
    v_cvt_f32_i32 v108, v108
    v_cvt_f32_i32 v109, v109
    v_cvt_f32_i32 v110, v110
    v_mfma_f32_4x4x4_16b_bf16 v[112:115], v[58:59], v[64:65], 0
    v_mfma_f32_4x4x4_16b_bf16 v[116:119], v[58:59], v[66:67], 0
    v_mfma_f32_4x4x4_16b_bf16 v[120:123], v[58:59], v[68:69], 0
    v_mad_u32_u16 v24, v24, 8, s50 op_sel:[1,0,0,0]
    v_mad_u32_u16 v25, v25, 8, s50 op_sel:[1,0,0,0]
    v_mad_u32_u16 v26, v26, 8, s50 op_sel:[1,0,0,0]
    v_pk_fma_f32 v[114:115], v[114:115], v[108:109], s[20:21] op_sel:[0,0,0] op_sel_hi:[1,0,1]
    v_pk_fma_f32 v[112:113], v[112:113], v[108:109], s[16:17] op_sel:[0,0,0] op_sel_hi:[1,0,1]
    v_pk_fma_f32 v[118:119], v[118:119], v[108:109], s[20:21] op_sel:[0,1,0] op_sel_hi:[1,1,1]
    v_pk_fma_f32 v[116:117], v[116:117], v[108:109], s[16:17] op_sel:[0,1,0] op_sel_hi:[1,1,1]
    v_pk_fma_f32 v[122:123], v[122:123], v[110:111], s[20:21] op_sel:[0,0,0] op_sel_hi:[1,0,1]
    v_pk_fma_f32 v[120:121], v[120:121], v[110:111], s[16:17] op_sel:[0,0,0] op_sel_hi:[1,0,1]
    v_lshlrev_b64 v[114:115], 16, v[114:115]
    v_lshlrev_b64 v[118:119], 16, v[118:119]
    v_lshlrev_b64 v[122:123], 16, v[122:123]
    v_lshl_add_u64 v[64:65], v[112:113], 0, v[114:115]
    v_lshl_add_u64 v[66:67], v[116:117], 0, v[118:119]
    v_lshl_add_u64 v[68:69], v[120:121], 0, v[122:123]
    s_waitcnt lgkmcnt(0)
    v_or3_b32 v4, v44, v45, v4
    v_or3_b32 v4, v46, v47, v4
    v_or3_b32 v4, v48, v49, v4
    ds_add_rtn_u64 v[44:45], v24, v[64:65]
    ds_add_rtn_u64 v[46:47], v25, v[66:67]
    ds_add_rtn_u64 v[48:49], v26, v[68:69]
L_p2_kernel_noopt3_3:
    v_mbcnt_lo_u32_b32 v51, s36, 0
    v_mbcnt_hi_u32_b32 v51, s37, v51
    s_bcnt1_i32_b64 s14, s[36:37]
    v_lshl_add_u32 v55, v51, 1, s25
    ds_read_u16 v55, v55
    s_mov_b32 s36, s26
    s_movk_i32 s37, -128
    s_lshl1_add_u32 s25, s14, s25
    s_lshl_b32 s14, s14, 12
    s_add_u32 s26, s26, s14
    s_cmp_le_u32 s28, 256
    s_cbranch_scc1 L_p2_kernel_noopt3_4
    v_readlane_b32 s38, v7, 8
    v_readlane_b32 s39, v7, 9
    s_nop 1
    v_mbcnt_lo_u32_b32 v62, s38, 0
    v_mbcnt_hi_u32_b32 v62, s39, v62
    s_bcnt1_i32_b64 s14, s[38:39]
    v_lshl_add_u32 v63, v62, 1, s25
    ds_read_u16 v63, v63
    s_mov_b32 s38, s26
    s_movk_i32 s39, -64
    s_lshl1_add_u32 s25, s14, s25
    s_lshl_b32 s14, s14, 12
    s_add_u32 s26, s26, s14
L_p2_kernel_noopt3_4:
    v_bfe_i32 v108, v23, 2, 10
    v_bfe_i32 v109, v23, 12, 10
    v_ashrrev_i32 v110, 22, v23
    v_cvt_f32_i32 v108, v108
    v_cvt_f32_i32 v109, v109
    v_cvt_f32_i32 v110, v110
    v_mfma_f32_4x4x4_16b_bf16 v[112:115], v[58:59], v[82:83], 0
    v_mfma_f32_4x4x4_16b_bf16 v[116:119], v[58:59], v[84:85], 0
    v_mfma_f32_4x4x4_16b_bf16 v[120:123], v[58:59], v[86:87], 0
    v_mad_u32_u16 v20, v20, 8, s50 op_sel:[1,0,0,0]
    v_mad_u32_u16 v21, v21, 8, s50 op_sel:[1,0,0,0]
    v_mad_u32_u16 v22, v22, 8, s50 op_sel:[1,0,0,0]
    v_pk_fma_f32 v[114:115], v[114:115], v[108:109], s[20:21] op_sel:[0,0,0] op_sel_hi:[1,0,1]
    v_pk_fma_f32 v[112:113], v[112:113], v[108:109], s[16:17] op_sel:[0,0,0] op_sel_hi:[1,0,1]
    v_pk_fma_f32 v[118:119], v[118:119], v[108:109], s[20:21] op_sel:[0,1,0] op_sel_hi:[1,1,1]
    v_pk_fma_f32 v[116:117], v[116:117], v[108:109], s[16:17] op_sel:[0,1,0] op_sel_hi:[1,1,1]
    v_pk_fma_f32 v[122:123], v[122:123], v[110:111], s[20:21] op_sel:[0,0,0] op_sel_hi:[1,0,1]
    v_pk_fma_f32 v[120:121], v[120:121], v[110:111], s[16:17] op_sel:[0,0,0] op_sel_hi:[1,0,1]
    v_lshlrev_b64 v[114:115], 16, v[114:115]
    v_lshlrev_b64 v[118:119], 16, v[118:119]
    v_lshlrev_b64 v[122:123], 16, v[122:123]
    v_lshl_add_u64 v[82:83], v[112:113], 0, v[114:115]
    v_lshl_add_u64 v[84:85], v[116:117], 0, v[118:119]
    v_lshl_add_u64 v[86:87], v[120:121], 0, v[122:123]
    s_waitcnt lgkmcnt(1)
    v_or3_b32 v4, v44, v45, v4
    v_or3_b32 v4, v46, v47, v4
    v_or3_b32 v4, v48, v49, v4
    ds_add_rtn_u64 v[44:45], v20, v[82:83]
    ds_add_rtn_u64 v[46:47], v21, v[84:85]
    ds_add_rtn_u64 v[48:49], v22, v[86:87]
    s_waitcnt lgkmcnt(3)
    v_add3_u32 v55, v55, v2, s37
    v_lshl_add_u32 v51, v51, 8, v55
    v_lshrrev_b32 v55, 8, v55
    v_mad_u32_u24 v51, v55, s23, v51
    buffer_load_dwordx4 v[20:23], v51, s[44:47], s36 idxen
    s_cmp_le_u32 s28, 256
    s_cbranch_scc1 L_p2_kernel_noopt3_5
    v_add3_u32 v63, v63, v2, s39
    v_lshl_add_u32 v62, v62, 8, v63
    v_lshrrev_b32 v63, 8, v63
    v_mad_u32_u24 v62, v63, s23, v62
    buffer_load_dwordx4 v[24:27], v62, s[44:47], s38 idxen
L_p2_kernel_noopt3_5:
    s_add_u32 s14, s22, 80000
    buffer_load_dwordx4 v[88:91], v1, s[8:11], s14 offen
    s_add_u32 s14, s24, 1
    s_min_u32 s14, s14, 7
    s_set_gpr_idx_on s14, gpr_idx(SRC0)
    v_mad_u32_u16 v108, v28, v50, s40 op_sel:[0,0,0,0]
    v_mad_u32_u16 v109, v36, v50, s41 op_sel:[0,0,0,0]
    s_set_gpr_idx_off
    v_sub_u32_sdwa v110, v109, v108 dst_sel:DWORD dst_unused:UNUSED_PAD src0_sel:WORD_1 src1_sel:WORD_1
    s_nop 1
    v_add_u32_dpp v110, v110, v110 row_shr:1 row_mask:0xf bank_mask:0xf bound_ctrl:0
    s_nop 1
    v_add_u32_dpp v110, v110, v110 row_shr:2 row_mask:0xf bank_mask:0xf bound_ctrl:0
    s_nop 1
    v_add_u32_dpp v110, v110, v110 row_shr:4 row_mask:0xf bank_mask:0xf bound_ctrl:0
    s_nop 1
    v_add_u32_dpp v110, v110, v110 row_shr:8 row_mask:0xf bank_mask:0xf bound_ctrl:0
    s_nop 1
    v_add_u32_dpp v110, v110, v110 row_bcast:15 row_mask:0xa bank_mask:0xf
    s_nop 1
    v_add_u32_dpp v110, v110, v110 row_bcast:31 row_mask:0xc bank_mask:0xf
    v_sub_u32_sdwa v109, v109, v110 dst_sel:DWORD dst_unused:UNUSED_PAD src0_sel:WORD_1 src1_sel:DWORD
    v_readlane_b32 s29, v110, 63
    v_add_u32 v110, -1, v110
    ds_write_b16 v126, v109
    v_lshlrev_b32_e64 v111, v110, 1
    v_lshrrev_b32 v110, 5, v110
    s_cmp_gt_u32 s29, 320
    s_cselect_b32 s2, 1, s2
    v_lshl_add_u32 v110, v110, 2, v127
    s_cselect_b64 exec, 0, -1
    ds_or_b32 v110, v111 offset:136
    s_mov_b64 exec, -1
    ds_wrxchg2_rtn_b32 v[108:109], v6, v5, v5 offset0:34 offset1:44
    s_add_u32 s14, s22, 96384
    buffer_load_dwordx4 v[92:95], v1, s[8:11], s14 offen
    s_barrier
    s_add_u32 s22, s22, 80000
    s_cmp_eq_u32 s24, 7
    s_cselect_b32 s46, 0, s46
    v_mad_u32_u16 v64, v8, 8, s18
    v_mad_u32_u16 v66, v9, 8, s18
    v_mad_u32_u16 v68, v10, 8, s18
    ds_read_b64 v[64:65], v64
    ds_read_b64 v[66:67], v66
    ds_read_b64 v[68:69], v68
    s_add_u32 s14, s22, 32768
    buffer_load_dwordx4 v[96:99], v1, s[8:11], s14 offen
    s_waitcnt vmcnt(5)
    v_mad_u32_u16 v70, v12, 8, s18
    v_mad_u32_u16 v72, v13, 8, s18
    v_mad_u32_u16 v74, v14, 8, s18
    ds_read_b64 v[70:71], v70
    ds_read_b64 v[72:73], v72
    ds_read_b64 v[74:75], v74
    s_add_u32 s14, s22, 49152
    buffer_load_dwordx4 v[100:103], v1, s[8:11], s14 offen
    s_waitcnt lgkmcnt(6)
    v_or_b32 v7, v108, v109
    s_nop 0
    v_readlane_b32 s30, v7, 0
    v_readlane_b32 s31, v7, 1
    v_readlane_b32 s32, v7, 2
    v_readlane_b32 s33, v7, 3
    v_readlane_b32 s34, v7, 4
    v_readlane_b32 s35, v7, 5
    v_readlane_b32 s36, v7, 6
    v_readlane_b32 s37, v7, 7
    s_mov_b32 s25, s19
    s_mov_b32 s26, s27
    s_mov_b32 s51, s28
    s_mov_b32 s28, s29
    v_mbcnt_lo_u32_b32 v51, s30, 0
    v_mbcnt_hi_u32_b32 v51, s31, v51
    s_bcnt1_i32_b64 s14, s[30:31]
    v_lshl_add_u32 v55, v51, 1, s25
    ds_read_u16 v55, v55
    s_mov_b32 s30, s26
    s_movk_i32 s31, -320
    s_lshl1_add_u32 s25, s14, s25
    s_lshl_b32 s14, s14, 12
    s_add_u32 s26, s26, s14
    v_bfe_i32 v108, v11, 2, 10
    v_bfe_i32 v109, v11, 12, 10
    v_ashrrev_i32 v110, 22, v11
    v_cvt_f32_i32 v108, v108
    v_cvt_f32_i32 v109, v109
    v_cvt_f32_i32 v110, v110
    s_waitcnt lgkmcnt(4)
    v_mfma_f32_4x4x4_16b_bf16 v[112:115], v[58:59], v[64:65], 0
    v_mfma_f32_4x4x4_16b_bf16 v[116:119], v[58:59], v[66:67], 0
    v_mfma_f32_4x4x4_16b_bf16 v[120:123], v[58:59], v[68:69], 0
    v_mad_u32_u16 v8, v8, 8, s50 op_sel:[1,0,0,0]
    v_mad_u32_u16 v9, v9, 8, s50 op_sel:[1,0,0,0]
    v_mad_u32_u16 v10, v10, 8, s50 op_sel:[1,0,0,0]
    v_pk_fma_f32 v[114:115], v[114:115], v[108:109], s[20:21] op_sel:[0,0,0] op_sel_hi:[1,0,1]
    v_pk_fma_f32 v[112:113], v[112:113], v[108:109], s[16:17] op_sel:[0,0,0] op_sel_hi:[1,0,1]
    v_pk_fma_f32 v[118:119], v[118:119], v[108:109], s[20:21] op_sel:[0,1,0] op_sel_hi:[1,1,1]
    v_pk_fma_f32 v[116:117], v[116:117], v[108:109], s[16:17] op_sel:[0,1,0] op_sel_hi:[1,1,1]
    v_pk_fma_f32 v[122:123], v[122:123], v[110:111], s[20:21] op_sel:[0,0,0] op_sel_hi:[1,0,1]
    v_pk_fma_f32 v[120:121], v[120:121], v[110:111], s[16:17] op_sel:[0,0,0] op_sel_hi:[1,0,1]
    v_lshlrev_b64 v[114:115], 16, v[114:115]
    v_lshlrev_b64 v[118:119], 16, v[118:119]
    v_lshlrev_b64 v[122:123], 16, v[122:123]
    v_lshl_add_u64 v[64:65], v[112:113], 0, v[114:115]
    v_lshl_add_u64 v[66:67], v[116:117], 0, v[118:119]
    v_lshl_add_u64 v[68:69], v[120:121], 0, v[122:123]
    v_or3_b32 v4, v44, v45, v4
    v_or3_b32 v4, v46, v47, v4
    v_or3_b32 v4, v48, v49, v4
    ds_add_rtn_u64 v[44:45], v8, v[64:65]
    ds_add_rtn_u64 v[46:47], v9, v[66:67]
    ds_add_rtn_u64 v[48:49], v10, v[68:69]
    s_waitcnt lgkmcnt(3)
    v_add3_u32 v55, v55, v2, s31
    v_lshl_add_u32 v51, v51, 8, v55
    v_lshrrev_b32 v55, 8, v55
    v_mad_u32_u24 v51, v55, s23, v51
    buffer_load_dwordx4 v[8:11], v51, s[44:47], s30 idxen
    s_sub_u32 s14, s22, 80000
    buffer_load_dwordx4 v[104:107], v124, s[8:11], s14 offen
    s_waitcnt vmcnt(7)
    v_mad_u32_u16 v76, v16, 8, s18
    v_mad_u32_u16 v78, v17, 8, s18
    v_mad_u32_u16 v80, v18, 8, s18
    ds_read_b64 v[76:77], v76
    ds_read_b64 v[78:79], v78
    ds_read_b64 v[80:81], v80
    s_waitcnt vmcnt(6)
    v_mad_u32_u16 v82, v20, 8, s18
    v_mad_u32_u16 v84, v21, 8, s18
    v_mad_u32_u16 v86, v22, 8, s18
    ds_read_b64 v[82:83], v82
    ds_read_b64 v[84:85], v84
    ds_read_b64 v[86:87], v86
    s_cmp_le_u32 s51, 256
    s_cbranch_scc1 L_p2_kernel_noopt3_6
    v_mad_u32_u16 v64, v24, 8, s18
    v_mad_u32_u16 v66, v25, 8, s18
    v_mad_u32_u16 v68, v26, 8, s18
    ds_read_b64 v[64:65], v64
    ds_read_b64 v[66:67], v66
    ds_read_b64 v[68:69], v68
L_p2_kernel_noopt3_6:
    v_mbcnt_lo_u32_b32 v51, s32, 0
    v_mbcnt_hi_u32_b32 v51, s33, v51
    s_bcnt1_i32_b64 s14, s[32:33]
    v_lshl_add_u32 v55, v51, 1, s25
    ds_read_u16 v55, v55
    s_mov_b32 s32, s26
    s_movk_i32 s33, -256
    s_lshl1_add_u32 s25, s14, s25
    s_lshl_b32 s14, s14, 12
    s_add_u32 s26, s26, s14
    v_bfe_i32 v108, v15, 2, 10
    v_bfe_i32 v109, v15, 12, 10
    v_ashrrev_i32 v110, 22, v15
    v_cvt_f32_i32 v108, v108
    v_cvt_f32_i32 v109, v109
    v_cvt_f32_i32 v110, v110
    v_mfma_f32_4x4x4_16b_bf16 v[112:115], v[58:59], v[70:71], 0
    v_mfma_f32_4x4x4_16b_bf16 v[116:119], v[58:59], v[72:73], 0
    v_mfma_f32_4x4x4_16b_bf16 v[120:123], v[58:59], v[74:75], 0
    v_mad_u32_u16 v12, v12, 8, s50 op_sel:[1,0,0,0]
    v_mad_u32_u16 v13, v13, 8, s50 op_sel:[1,0,0,0]
    v_mad_u32_u16 v14, v14, 8, s50 op_sel:[1,0,0,0]
    v_pk_fma_f32 v[114:115], v[114:115], v[108:109], s[20:21] op_sel:[0,0,0] op_sel_hi:[1,0,1]
    v_pk_fma_f32 v[112:113], v[112:113], v[108:109], s[16:17] op_sel:[0,0,0] op_sel_hi:[1,0,1]
    v_pk_fma_f32 v[118:119], v[118:119], v[108:109], s[20:21] op_sel:[0,1,0] op_sel_hi:[1,1,1]
    v_pk_fma_f32 v[116:117], v[116:117], v[108:109], s[16:17] op_sel:[0,1,0] op_sel_hi:[1,1,1]
    v_pk_fma_f32 v[122:123], v[122:123], v[110:111], s[20:21] op_sel:[0,0,0] op_sel_hi:[1,0,1]
    v_pk_fma_f32 v[120:121], v[120:121], v[110:111], s[16:17] op_sel:[0,0,0] op_sel_hi:[1,0,1]
    v_lshlrev_b64 v[114:115], 16, v[114:115]
    v_lshlrev_b64 v[118:119], 16, v[118:119]
    v_lshlrev_b64 v[122:123], 16, v[122:123]
    v_lshl_add_u64 v[70:71], v[112:113], 0, v[114:115]
    v_lshl_add_u64 v[72:73], v[116:117], 0, v[118:119]
    v_lshl_add_u64 v[74:75], v[120:121], 0, v[122:123]
    s_waitcnt lgkmcnt(7)
    v_or3_b32 v4, v44, v45, v4
    v_or3_b32 v4, v46, v47, v4
    v_or3_b32 v4, v48, v49, v4
    ds_add_rtn_u64 v[44:45], v12, v[70:71]
    ds_add_rtn_u64 v[46:47], v13, v[72:73]
    ds_add_rtn_u64 v[48:49], v14, v[74:75]
    s_waitcnt lgkmcnt(3)
    v_add3_u32 v55, v55, v2, s33
    v_lshl_add_u32 v51, v51, 8, v55
    v_lshrrev_b32 v55, 8, v55
    v_mad_u32_u24 v51, v55, s23, v51
    buffer_load_dwordx4 v[12:15], v51, s[44:47], s32 idxen
    s_cmp_lg_u32 s24, 7
    s_cbranch_scc1 L_p2_stage
    s_waitcnt lgkmcnt(0)
    s_branch L_p2_staged
L_p2_stage:
    s_barrier
    s_waitcnt vmcnt(1)
    ds_write_b128 v3, v[88:91] offset:0
    ds_write_b128 v3, v[92:95] offset:16384
    ds_write_b128 v3, v[96:99] offset:32768
    ds_write_b128 v3, v[100:103] offset:49152
    ds_write_b128 v124, v[104:107] offset:0
L_p2_staged:
    v_mbcnt_lo_u32_b32 v51, s34, 0
    v_mbcnt_hi_u32_b32 v51, s35, v51
    s_bcnt1_i32_b64 s14, s[34:35]
    v_lshl_add_u32 v55, v51, 1, s25
    ds_read_u16 v55, v55
    s_mov_b32 s34, s26
    s_movk_i32 s35, -192
    s_lshl1_add_u32 s25, s14, s25
    s_lshl_b32 s14, s14, 12
    s_add_u32 s26, s26, s14
    v_bfe_i32 v108, v19, 2, 10
    v_bfe_i32 v109, v19, 12, 10
    v_ashrrev_i32 v110, 22, v19
    v_cvt_f32_i32 v108, v108
    v_cvt_f32_i32 v109, v109
    v_cvt_f32_i32 v110, v110
    v_mfma_f32_4x4x4_16b_bf16 v[112:115], v[58:59], v[76:77], 0
    v_mfma_f32_4x4x4_16b_bf16 v[116:119], v[58:59], v[78:79], 0
    v_mfma_f32_4x4x4_16b_bf16 v[120:123], v[58:59], v[80:81], 0
    v_mad_u32_u16 v16, v16, 8, s50 op_sel:[1,0,0,0]
    v_mad_u32_u16 v17, v17, 8, s50 op_sel:[1,0,0,0]
    v_mad_u32_u16 v18, v18, 8, s50 op_sel:[1,0,0,0]
    v_pk_fma_f32 v[114:115], v[114:115], v[108:109], s[20:21] op_sel:[0,0,0] op_sel_hi:[1,0,1]
    v_pk_fma_f32 v[112:113], v[112:113], v[108:109], s[16:17] op_sel:[0,0,0] op_sel_hi:[1,0,1]
    v_pk_fma_f32 v[118:119], v[118:119], v[108:109], s[20:21] op_sel:[0,1,0] op_sel_hi:[1,1,1]
    v_pk_fma_f32 v[116:117], v[116:117], v[108:109], s[16:17] op_sel:[0,1,0] op_sel_hi:[1,1,1]
    v_pk_fma_f32 v[122:123], v[122:123], v[110:111], s[20:21] op_sel:[0,0,0] op_sel_hi:[1,0,1]
    v_pk_fma_f32 v[120:121], v[120:121], v[110:111], s[16:17] op_sel:[0,0,0] op_sel_hi:[1,0,1]
    v_lshlrev_b64 v[114:115], 16, v[114:115]
    v_lshlrev_b64 v[118:119], 16, v[118:119]
    v_lshlrev_b64 v[122:123], 16, v[122:123]
    v_lshl_add_u64 v[76:77], v[112:113], 0, v[114:115]
    v_lshl_add_u64 v[78:79], v[116:117], 0, v[118:119]
    v_lshl_add_u64 v[80:81], v[120:121], 0, v[122:123]
    s_waitcnt lgkmcnt(6)
    v_or3_b32 v4, v44, v45, v4
    v_or3_b32 v4, v46, v47, v4
    v_or3_b32 v4, v48, v49, v4
    ds_add_rtn_u64 v[44:45], v16, v[76:77]
    ds_add_rtn_u64 v[46:47], v17, v[78:79]
    ds_add_rtn_u64 v[48:49], v18, v[80:81]
    s_waitcnt lgkmcnt(3)
    v_add3_u32 v55, v55, v2, s35
    v_lshl_add_u32 v51, v51, 8, v55
    v_lshrrev_b32 v55, 8, v55
    v_mad_u32_u24 v51, v55, s23, v51
    buffer_load_dwordx4 v[16:19], v51, s[44:47], s34 idxen
    s_cmp_le_u32 s51, 256
    s_cbranch_scc1 L_p2_kernel_noopt3_7
    v_bfe_i32 v108, v27, 2, 10
    v_bfe_i32 v109, v27, 12, 10
    v_ashrrev_i32 v110, 22, v27
    v_cvt_f32_i32 v108, v108
    v_cvt_f32_i32 v109, v109
    v_cvt_f32_i32 v110, v110
    v_mfma_f32_4x4x4_16b_bf16 v[112:115], v[58:59], v[64:65], 0
    v_mfma_f32_4x4x4_16b_bf16 v[116:119], v[58:59], v[66:67], 0
    v_mfma_f32_4x4x4_16b_bf16 v[120:123], v[58:59], v[68:69], 0
    v_mad_u32_u16 v24, v24, 8, s50 op_sel:[1,0,0,0]
    v_mad_u32_u16 v25, v25, 8, s50 op_sel:[1,0,0,0]
    v_mad_u32_u16 v26, v26, 8, s50 op_sel:[1,0,0,0]
    v_pk_fma_f32 v[114:115], v[114:115], v[108:109], s[20:21] op_sel:[0,0,0] op_sel_hi:[1,0,1]
    v_pk_fma_f32 v[112:113], v[112:113], v[108:109], s[16:17] op_sel:[0,0,0] op_sel_hi:[1,0,1]
    v_pk_fma_f32 v[118:119], v[118:119], v[108:109], s[20:21] op_sel:[0,1,0] op_sel_hi:[1,1,1]
    v_pk_fma_f32 v[116:117], v[116:117], v[108:109], s[16:17] op_sel:[0,1,0] op_sel_hi:[1,1,1]
    v_pk_fma_f32 v[122:123], v[122:123], v[110:111], s[20:21] op_sel:[0,0,0] op_sel_hi:[1,0,1]
    v_pk_fma_f32 v[120:121], v[120:121], v[110:111], s[16:17] op_sel:[0,0,0] op_sel_hi:[1,0,1]
    v_lshlrev_b64 v[114:115], 16, v[114:115]
    v_lshlrev_b64 v[118:119], 16, v[118:119]
    v_lshlrev_b64 v[122:123], 16, v[122:123]
    v_lshl_add_u64 v[64:65], v[112:113], 0, v[114:115]
    v_lshl_add_u64 v[66:67], v[116:117], 0, v[118:119]
    v_lshl_add_u64 v[68:69], v[120:121], 0, v[122:123]
    s_waitcnt lgkmcnt(0)
    v_or3_b32 v4, v44, v45, v4
    v_or3_b32 v4, v46, v47, v4
    v_or3_b32 v4, v48, v49, v4
    ds_add_rtn_u64 v[44:45], v24, v[64:65]
    ds_add_rtn_u64 v[46:47], v25, v[66:67]
    ds_add_rtn_u64 v[48:49], v26, v[68:69]
L_p2_kernel_noopt3_7:
    v_mbcnt_lo_u32_b32 v51, s36, 0
    v_mbcnt_hi_u32_b32 v51, s37, v51
    s_bcnt1_i32_b64 s14, s[36:37]
    v_lshl_add_u32 v55, v51, 1, s25
    ds_read_u16 v55, v55
    s_mov_b32 s36, s26
    s_movk_i32 s37, -128
    s_lshl1_add_u32 s25, s14, s25
    s_lshl_b32 s14, s14, 12
    s_add_u32 s26, s26, s14
    s_cmp_le_u32 s28, 256
    s_cbranch_scc1 L_p2_kernel_noopt3_8
    v_readlane_b32 s38, v7, 8
    v_readlane_b32 s39, v7, 9
    s_nop 1
    v_mbcnt_lo_u32_b32 v62, s38, 0
    v_mbcnt_hi_u32_b32 v62, s39, v62
    s_bcnt1_i32_b64 s14, s[38:39]
    v_lshl_add_u32 v63, v62, 1, s25
    ds_read_u16 v63, v63
    s_mov_b32 s38, s26
    s_movk_i32 s39, -64
    s_lshl1_add_u32 s25, s14, s25
    s_lshl_b32 s14, s14, 12
    s_add_u32 s26, s26, s14
L_p2_kernel_noopt3_8:
    v_bfe_i32 v108, v23, 2, 10
    v_bfe_i32 v109, v23, 12, 10
    v_ashrrev_i32 v110, 22, v23
    v_cvt_f32_i32 v108, v108
    v_cvt_f32_i32 v109, v109
    v_cvt_f32_i32 v110, v110
    v_mfma_f32_4x4x4_16b_bf16 v[112:115], v[58:59], v[82:83], 0
    v_mfma_f32_4x4x4_16b_bf16 v[116:119], v[58:59], v[84:85], 0
    v_mfma_f32_4x4x4_16b_bf16 v[120:123], v[58:59], v[86:87], 0
    v_mad_u32_u16 v20, v20, 8, s50 op_sel:[1,0,0,0]
    v_mad_u32_u16 v21, v21, 8, s50 op_sel:[1,0,0,0]
    v_mad_u32_u16 v22, v22, 8, s50 op_sel:[1,0,0,0]
    v_pk_fma_f32 v[114:115], v[114:115], v[108:109], s[20:21] op_sel:[0,0,0] op_sel_hi:[1,0,1]
    v_pk_fma_f32 v[112:113], v[112:113], v[108:109], s[16:17] op_sel:[0,0,0] op_sel_hi:[1,0,1]
    v_pk_fma_f32 v[118:119], v[118:119], v[108:109], s[20:21] op_sel:[0,1,0] op_sel_hi:[1,1,1]
    v_pk_fma_f32 v[116:117], v[116:117], v[108:109], s[16:17] op_sel:[0,1,0] op_sel_hi:[1,1,1]
    v_pk_fma_f32 v[122:123], v[122:123], v[110:111], s[20:21] op_sel:[0,0,0] op_sel_hi:[1,0,1]
    v_pk_fma_f32 v[120:121], v[120:121], v[110:111], s[16:17] op_sel:[0,0,0] op_sel_hi:[1,0,1]
    v_lshlrev_b64 v[114:115], 16, v[114:115]
    v_lshlrev_b64 v[118:119], 16, v[118:119]
    v_lshlrev_b64 v[122:123], 16, v[122:123]
    v_lshl_add_u64 v[82:83], v[112:113], 0, v[114:115]
    v_lshl_add_u64 v[84:85], v[116:117], 0, v[118:119]
    v_lshl_add_u64 v[86:87], v[120:121], 0, v[122:123]
    s_waitcnt lgkmcnt(1)
    v_or3_b32 v4, v44, v45, v4
    v_or3_b32 v4, v46, v47, v4
    v_or3_b32 v4, v48, v49, v4
    ds_add_rtn_u64 v[44:45], v20, v[82:83]
    ds_add_rtn_u64 v[46:47], v21, v[84:85]
    ds_add_rtn_u64 v[48:49], v22, v[86:87]
    s_waitcnt lgkmcnt(3)
    v_add3_u32 v55, v55, v2, s37
    v_lshl_add_u32 v51, v51, 8, v55
    v_lshrrev_b32 v55, 8, v55
    v_mad_u32_u24 v51, v55, s23, v51
    buffer_load_dwordx4 v[20:23], v51, s[44:47], s36 idxen
    s_cmp_le_u32 s28, 256
    s_cbranch_scc1 L_p2_kernel_noopt3_9
    v_add3_u32 v63, v63, v2, s39
    v_lshl_add_u32 v62, v62, 8, v63
    v_lshrrev_b32 v63, 8, v63
    v_mad_u32_u24 v62, v63, s23, v62
    buffer_load_dwordx4 v[24:27], v62, s[44:47], s38 idxen
L_p2_kernel_noopt3_9:
    s_add_u32 s14, s22, 80000
    buffer_load_dwordx4 v[88:91], v1, s[8:11], s14 offen
    s_cmp_eq_u32 s24, 7
    s_cbranch_scc1 L_p2_exit
    s_add_u32 s14, s24, 1
    s_min_u32 s14, s14, 7
    s_set_gpr_idx_on s14, gpr_idx(SRC0)
    v_mad_u32_u16 v108, v28, v50, s40 op_sel:[1,0,0,0]
    v_mad_u32_u16 v109, v36, v50, s41 op_sel:[1,0,0,0]
    s_set_gpr_idx_off
    v_sub_u32_sdwa v110, v109, v108 dst_sel:DWORD dst_unused:UNUSED_PAD src0_sel:WORD_1 src1_sel:WORD_1
    s_nop 1
    v_add_u32_dpp v110, v110, v110 row_shr:1 row_mask:0xf bank_mask:0xf bound_ctrl:0
    s_nop 1
    v_add_u32_dpp v110, v110, v110 row_shr:2 row_mask:0xf bank_mask:0xf bound_ctrl:0
    s_nop 1
    v_add_u32_dpp v110, v110, v110 row_shr:4 row_mask:0xf bank_mask:0xf bound_ctrl:0
    s_nop 1
    v_add_u32_dpp v110, v110, v110 row_shr:8 row_mask:0xf bank_mask:0xf bound_ctrl:0
    s_nop 1
    v_add_u32_dpp v110, v110, v110 row_bcast:15 row_mask:0xa bank_mask:0xf
    s_nop 1
    v_add_u32_dpp v110, v110, v110 row_bcast:31 row_mask:0xc bank_mask:0xf
    v_sub_u32_sdwa v109, v109, v110 dst_sel:DWORD dst_unused:UNUSED_PAD src0_sel:WORD_1 src1_sel:DWORD
    v_readlane_b32 s29, v110, 63
    v_add_u32 v110, -1, v110
    ds_write_b16 v126, v109
    v_lshlrev_b32_e64 v111, v110, 1
    v_lshrrev_b32 v110, 5, v110
    s_cmp_gt_u32 s29, 320
    s_cselect_b32 s2, 1, s2
    v_lshl_add_u32 v110, v110, 2, v127
    s_cselect_b64 exec, 0, -1
    ds_or_b32 v110, v111 offset:136
    s_mov_b64 exec, -1
    ds_wrxchg2_rtn_b32 v[108:109], v6, v5, v5 offset0:34 offset1:44
    s_add_u32 s14, s22, 96384
    buffer_load_dwordx4 v[92:95], v1, s[8:11], s14 offen
    s_add_u32 s24, s24, 1
    s_cmp_lt_u32 s24, 8
    s_barrier
    s_cbranch_scc1 L_p2_loop
L_p2_exit:
    s_waitcnt lgkmcnt(0)
    v_or3_b32 v4, v44, v45, v4
    v_or3_b32 v4, v46, v47, v4
    v_or3_b32 v4, v48, v49, v4
    s_mov_b32 s27, s19
    s_waitcnt vmcnt(0)
    v_mov_b64 v[64:65], v[28:29]
    v_mov_b64 v[66:67], v[30:31]
    v_mov_b64 v[68:69], v[36:37]
    v_mov_b64 v[70:71], v[38:39]
    v_mov_b32 v8, 160232
    s_cmp_lg_u32 s13, 0
    s_cselect_b64 exec, 0, 1
    ds_write_b32 v8, v52
    s_mov_b64 exec, -1
    v_subrev_u32 v6, 80000, v124
    s_mul_i32 s24, s12, 19968
    v_subrev_u32 v10, s24, v1
    v_mov_b32 v11, 0x7f000000
    s_waitcnt vmcnt(0) lgkmcnt(0)
    s_barrier
    s_cmp_lt_u32 s13, 12
    s_cbranch_scc1 L_p2_ga
L_p2_ga:
    ds_read_b32 v9, v8
    ds_read_b128 v[88:91], v1 offset:0
    ds_read_b128 v[92:95], v1 offset:16384
    ds_read_b128 v[96:99], v1 offset:32768
    ds_read_b128 v[100:103], v1 offset:49152
    ds_read_b128 v[104:107], v6
    s_mul_i32 s14, s12, 5120000
    s_mul_i32 s15, s3, 80000
    s_add_u32 s25, s14, s15
    s_add_u32 s25, s25, 230838272
    s_cmp_eq_u32 s12, 3
    s_cselect_b32 s15, 128, 0
    s_add_u32 s15, s15, 19968
    s_waitcnt lgkmcnt(5)
    v_readfirstlane_b32 s21, v9
    s_nop 0
    s_bfe_u32 s21, s21, 524296
    s_cmp_lg_u32 s21, 4
    s_cselect_b32 s21, 1, 0
    s_cselect_b32 s24, 0, s15
    v_cmp_le_u32 vcc, s24, v10
    v_add_u32 v10, 16384, v10
    s_add_u32 s14, s25, 0
    v_cndmask_b32 v12, v11, v1, vcc
    s_waitcnt lgkmcnt(4)
    buffer_store_dwordx4 v[88:91], v12, s[4:7], s14 offen sc1
    v_or3_b32 v4, v88, v89, v4
    v_or3_b32 v4, v90, v91, v4
    v_cmp_le_u32 vcc, s24, v10
    v_add_u32 v10, 16384, v10
    s_add_u32 s14, s25, 16384
    v_cndmask_b32 v12, v11, v1, vcc
    s_waitcnt lgkmcnt(3)
    buffer_store_dwordx4 v[92:95], v12, s[4:7], s14 offen sc1
    v_or3_b32 v4, v92, v93, v4
    v_or3_b32 v4, v94, v95, v4
    v_cmp_le_u32 vcc, s24, v10
    v_add_u32 v10, 16384, v10
    s_add_u32 s14, s25, 32768
    v_cndmask_b32 v12, v11, v1, vcc
    s_waitcnt lgkmcnt(2)
    buffer_store_dwordx4 v[96:99], v12, s[4:7], s14 offen sc1
    v_or3_b32 v4, v96, v97, v4
    v_or3_b32 v4, v98, v99, v4
    v_cmp_le_u32 vcc, s24, v10
    v_add_u32 v10, 16384, v10
    s_add_u32 s14, s25, 49152
    v_cndmask_b32 v12, v11, v1, vcc
    s_waitcnt lgkmcnt(1)
    buffer_store_dwordx4 v[100:103], v12, s[4:7], s14 offen sc1
    v_or3_b32 v4, v100, v101, v4
    v_or3_b32 v4, v102, v103, v4
    v_cmp_le_u32 vcc, s24, v10
    v_add_u32 v10, 16384, v10
    s_add_u32 s14, s25, 0
    v_cndmask_b32 v12, v11, v6, vcc
    s_waitcnt lgkmcnt(0)
    buffer_store_dwordx4 v[104:107], v12, s[4:7], s14 offen sc1
    v_or3_b32 v4, v104, v105, v4
    v_or3_b32 v4, v106, v107, v4
    s_load_dwordx2 s[16:17], s[0:1], 88
    s_cmp_ge_u32 s13, 12
    s_cbranch_scc1 L_p2_gb
    v_lshlrev_b32 v30, 16, v60
    v_and_b32 v31, 0xffff0000, v60
    v_lshlrev_b32 v36, 16, v53
    v_and_b32 v37, 0xffff0000, v53
    v_lshlrev_b32 v38, 16, v54
    v_and_b32 v39, 0xffff0000, v54
    v_lshlrev_b32 v40, 16, v56
    v_and_b32 v41, 0xffff0000, v56
    v_lshlrev_b32 v42, 16, v57
    v_and_b32 v43, 0xffff0000, v57
    v_pk_add_f32 v[14:15], v[30:31], v[36:37] op_sel:[0,0] op_sel_hi:[1,0] neg_lo:[0,1] neg_hi:[0,1]
    v_pk_add_f32 v[16:17], v[30:31], v[36:37] op_sel:[0,1] op_sel_hi:[1,1] neg_lo:[0,1] neg_hi:[0,1]
    v_pk_add_f32 v[18:19], v[30:31], v[38:39] op_sel:[0,0] op_sel_hi:[1,0] neg_lo:[0,1] neg_hi:[0,1]
    v_pk_add_f32 v[20:21], v[30:31], v[38:39] op_sel:[0,1] op_sel_hi:[1,1] neg_lo:[0,1] neg_hi:[0,1]
    v_pk_add_f32 v[22:23], v[30:31], v[40:41] op_sel:[0,0] op_sel_hi:[1,0] neg_lo:[0,1] neg_hi:[0,1]
    v_pk_add_f32 v[24:25], v[30:31], v[40:41] op_sel:[0,1] op_sel_hi:[1,1] neg_lo:[0,1] neg_hi:[0,1]
    v_pk_add_f32 v[26:27], v[30:31], v[42:43] op_sel:[0,0] op_sel_hi:[1,0] neg_lo:[0,1] neg_hi:[0,1]
    v_pk_add_f32 v[28:29], v[30:31], v[42:43] op_sel:[0,1] op_sel_hi:[1,1] neg_lo:[0,1] neg_hi:[0,1]
    v_cvt_pk_bf16_f32 v32, v14, v15
    v_lshlrev_b32 v14, 16, v32
    v_and_b32 v15, 0xffff0000, v32
    v_cvt_pk_bf16_f32 v32, v16, v17
    v_lshlrev_b32 v16, 16, v32
    v_and_b32 v17, 0xffff0000, v32
    v_cvt_pk_bf16_f32 v32, v18, v19
    v_lshlrev_b32 v18, 16, v32
    v_and_b32 v19, 0xffff0000, v32
    v_cvt_pk_bf16_f32 v32, v20, v21
    v_lshlrev_b32 v20, 16, v32
    v_and_b32 v21, 0xffff0000, v32
    v_cvt_pk_bf16_f32 v32, v22, v23
    v_lshlrev_b32 v22, 16, v32
    v_and_b32 v23, 0xffff0000, v32
    v_cvt_pk_bf16_f32 v32, v24, v25
    v_lshlrev_b32 v24, 16, v32
    v_and_b32 v25, 0xffff0000, v32
    v_cvt_pk_bf16_f32 v32, v26, v27
    v_lshlrev_b32 v26, 16, v32
    v_and_b32 v27, 0xffff0000, v32
    v_cvt_pk_bf16_f32 v32, v28, v29
    v_lshlrev_b32 v28, 16, v32
    v_and_b32 v29, 0xffff0000, v32
    v_pk_mul_f32 v[14:15], v[14:15], v[14:15]
    v_pk_mul_f32 v[16:17], v[16:17], v[16:17]
    v_pk_mul_f32 v[18:19], v[18:19], v[18:19]
    v_pk_mul_f32 v[20:21], v[20:21], v[20:21]
    v_pk_mul_f32 v[22:23], v[22:23], v[22:23]
    v_pk_mul_f32 v[24:25], v[24:25], v[24:25]
    v_pk_mul_f32 v[26:27], v[26:27], v[26:27]
    v_pk_mul_f32 v[28:29], v[28:29], v[28:29]
    v_cvt_pk_bf16_f32 v32, v14, v15
    v_lshlrev_b32 v14, 16, v32
    v_and_b32 v15, 0xffff0000, v32
    v_cvt_pk_bf16_f32 v32, v16, v17
    v_lshlrev_b32 v16, 16, v32
    v_and_b32 v17, 0xffff0000, v32
    v_cvt_pk_bf16_f32 v32, v18, v19
    v_lshlrev_b32 v18, 16, v32
    v_and_b32 v19, 0xffff0000, v32
    v_cvt_pk_bf16_f32 v32, v20, v21
    v_lshlrev_b32 v20, 16, v32
    v_and_b32 v21, 0xffff0000, v32
    v_cvt_pk_bf16_f32 v32, v22, v23
    v_lshlrev_b32 v22, 16, v32
    v_and_b32 v23, 0xffff0000, v32
    v_cvt_pk_bf16_f32 v32, v24, v25
    v_lshlrev_b32 v24, 16, v32
    v_and_b32 v25, 0xffff0000, v32
    v_cvt_pk_bf16_f32 v32, v26, v27
    v_lshlrev_b32 v26, 16, v32
    v_and_b32 v27, 0xffff0000, v32
    v_cvt_pk_bf16_f32 v32, v28, v29
    v_lshlrev_b32 v28, 16, v32
    v_and_b32 v29, 0xffff0000, v32
    v_mov_b32 v30, 1092616192
    v_mov_b32 v31, 0x3fb8aa3b
    v_pk_mul_f32 v[14:15], v[14:15], v[30:31] op_sel:[0,0] op_sel_hi:[1,0]
    v_pk_mul_f32 v[16:17], v[16:17], v[30:31] op_sel:[0,0] op_sel_hi:[1,0]
    v_pk_mul_f32 v[18:19], v[18:19], v[30:31] op_sel:[0,0] op_sel_hi:[1,0]
    v_pk_mul_f32 v[20:21], v[20:21], v[30:31] op_sel:[0,0] op_sel_hi:[1,0]
    v_pk_mul_f32 v[22:23], v[22:23], v[30:31] op_sel:[0,0] op_sel_hi:[1,0]
    v_pk_mul_f32 v[24:25], v[24:25], v[30:31] op_sel:[0,0] op_sel_hi:[1,0]
    v_pk_mul_f32 v[26:27], v[26:27], v[30:31] op_sel:[0,0] op_sel_hi:[1,0]
    v_pk_mul_f32 v[28:29], v[28:29], v[30:31] op_sel:[0,0] op_sel_hi:[1,0]
    v_cvt_pk_bf16_f32 v32, v14, v15
    v_lshlrev_b32 v14, 16, v32
    v_and_b32 v15, 0xffff0000, v32
    v_cvt_pk_bf16_f32 v32, v16, v17
    v_lshlrev_b32 v16, 16, v32
    v_and_b32 v17, 0xffff0000, v32
    v_cvt_pk_bf16_f32 v32, v18, v19
    v_lshlrev_b32 v18, 16, v32
    v_and_b32 v19, 0xffff0000, v32
    v_cvt_pk_bf16_f32 v32, v20, v21
    v_lshlrev_b32 v20, 16, v32
    v_and_b32 v21, 0xffff0000, v32
    v_cvt_pk_bf16_f32 v32, v22, v23
    v_lshlrev_b32 v22, 16, v32
    v_and_b32 v23, 0xffff0000, v32
    v_cvt_pk_bf16_f32 v32, v24, v25
    v_lshlrev_b32 v24, 16, v32
    v_and_b32 v25, 0xffff0000, v32
    v_cvt_pk_bf16_f32 v32, v26, v27
    v_lshlrev_b32 v26, 16, v32
    v_and_b32 v27, 0xffff0000, v32
    v_cvt_pk_bf16_f32 v32, v28, v29
    v_lshlrev_b32 v28, 16, v32
    v_and_b32 v29, 0xffff0000, v32
    v_pk_mul_f32 v[14:15], v[14:15], v[30:31] op_sel:[0,1] op_sel_hi:[1,1]
    v_pk_mul_f32 v[16:17], v[16:17], v[30:31] op_sel:[0,1] op_sel_hi:[1,1]
    v_pk_mul_f32 v[18:19], v[18:19], v[30:31] op_sel:[0,1] op_sel_hi:[1,1]
    v_pk_mul_f32 v[20:21], v[20:21], v[30:31] op_sel:[0,1] op_sel_hi:[1,1]
    v_pk_mul_f32 v[22:23], v[22:23], v[30:31] op_sel:[0,1] op_sel_hi:[1,1]
    v_pk_mul_f32 v[24:25], v[24:25], v[30:31] op_sel:[0,1] op_sel_hi:[1,1]
    v_pk_mul_f32 v[26:27], v[26:27], v[30:31] op_sel:[0,1] op_sel_hi:[1,1]
    v_pk_mul_f32 v[28:29], v[28:29], v[30:31] op_sel:[0,1] op_sel_hi:[1,1]
    v_exp_f32 v14, -v14
    v_exp_f32 v15, -v15
    v_exp_f32 v16, -v16
    v_exp_f32 v17, -v17
    v_exp_f32 v18, -v18
    v_exp_f32 v19, -v19
    v_exp_f32 v20, -v20
    v_exp_f32 v21, -v21
    v_exp_f32 v22, -v22
    v_exp_f32 v23, -v23
    v_exp_f32 v24, -v24
    v_exp_f32 v25, -v25
    v_exp_f32 v26, -v26
    v_exp_f32 v27, -v27
    v_exp_f32 v28, -v28
    v_exp_f32 v29, -v29
    v_cvt_pk_bf16_f32 v14, v14, v16
    v_cvt_pk_bf16_f32 v15, v15, v17
    v_cvt_pk_bf16_f32 v18, v18, v20
    v_cvt_pk_bf16_f32 v19, v19, v21
    v_cvt_pk_bf16_f32 v22, v22, v24
    v_cvt_pk_bf16_f32 v23, v23, v25
    v_cvt_pk_bf16_f32 v26, v26, v28
    v_cvt_pk_bf16_f32 v27, v27, v29
    v_dot2_f32_bf16 v72, v14, s68, 0
    v_dot2_f32_bf16 v73, v15, s68, 0
    v_dot2_f32_bf16 v74, v14, s69, 0
    v_dot2_f32_bf16 v75, v15, s69, 0
    v_dot2_f32_bf16 v76, v14, s70, 0
    v_dot2_f32_bf16 v77, v15, s70, 0
    v_dot2_f32_bf16 v78, v14, s71, 0
    v_dot2_f32_bf16 v79, v15, s71, 0
    v_dot2_f32_bf16 v80, v14, s52, 0
    v_dot2_f32_bf16 v81, v15, s52, 0
    v_dot2_f32_bf16 v82, v14, s53, 0
    v_dot2_f32_bf16 v83, v15, s53, 0
    v_dot2_f32_bf16 v84, v14, s54, 0
    v_dot2_f32_bf16 v85, v15, s54, 0
    v_dot2_f32_bf16 v86, v14, s55, 0
    v_dot2_f32_bf16 v87, v15, s55, 0
    v_dot2_f32_bf16 v72, v18, s72, v72
    v_dot2_f32_bf16 v73, v19, s72, v73
    v_dot2_f32_bf16 v74, v18, s73, v74
    v_dot2_f32_bf16 v75, v19, s73, v75
    v_dot2_f32_bf16 v76, v18, s74, v76
    v_dot2_f32_bf16 v77, v19, s74, v77
    v_dot2_f32_bf16 v78, v18, s75, v78
    v_dot2_f32_bf16 v79, v19, s75, v79
    v_dot2_f32_bf16 v80, v18, s56, v80
    v_dot2_f32_bf16 v81, v19, s56, v81
    v_dot2_f32_bf16 v82, v18, s57, v82
    v_dot2_f32_bf16 v83, v19, s57, v83
    v_dot2_f32_bf16 v84, v18, s58, v84
    v_dot2_f32_bf16 v85, v19, s58, v85
    v_dot2_f32_bf16 v86, v18, s59, v86
    v_dot2_f32_bf16 v87, v19, s59, v87
    v_dot2_f32_bf16 v72, v22, s76, v72
    v_dot2_f32_bf16 v73, v23, s76, v73
    v_dot2_f32_bf16 v74, v22, s77, v74
    v_dot2_f32_bf16 v75, v23, s77, v75
    v_dot2_f32_bf16 v76, v22, s78, v76
    v_dot2_f32_bf16 v77, v23, s78, v77
    v_dot2_f32_bf16 v78, v22, s79, v78
    v_dot2_f32_bf16 v79, v23, s79, v79
    v_dot2_f32_bf16 v80, v22, s60, v80
    v_dot2_f32_bf16 v81, v23, s60, v81
    v_dot2_f32_bf16 v82, v22, s61, v82
    v_dot2_f32_bf16 v83, v23, s61, v83
    v_dot2_f32_bf16 v84, v22, s62, v84
    v_dot2_f32_bf16 v85, v23, s62, v85
    v_dot2_f32_bf16 v86, v22, s63, v86
    v_dot2_f32_bf16 v87, v23, s63, v87
    v_dot2_f32_bf16 v72, v26, s80, v72
    v_dot2_f32_bf16 v73, v27, s80, v73
    v_dot2_f32_bf16 v74, v26, s81, v74
    v_dot2_f32_bf16 v75, v27, s81, v75
    v_dot2_f32_bf16 v76, v26, s82, v76
    v_dot2_f32_bf16 v77, v27, s82, v77
    v_dot2_f32_bf16 v78, v26, s83, v78
    v_dot2_f32_bf16 v79, v27, s83, v79
    v_dot2_f32_bf16 v80, v26, s64, v80
    v_dot2_f32_bf16 v81, v27, s64, v81
    v_dot2_f32_bf16 v82, v26, s65, v82
    v_dot2_f32_bf16 v83, v27, s65, v83
    v_dot2_f32_bf16 v84, v26, s66, v84
    v_dot2_f32_bf16 v85, v27, s66, v85
    v_dot2_f32_bf16 v86, v26, s67, v86
    v_dot2_f32_bf16 v87, v27, s67, v87
L_p2_gb:
    v_and_b32 v4, 0x80008000, v4
    v_cmp_ne_u32 vcc, 0, v4
    v_mov_b32 v8, s27
    v_and_b32 v10, 15, v0
    v_mul_u32_u24 v10, 240, v10
    v_add_u32 v10, 160000, v10
    s_cmp_lg_u64 vcc, 0
    s_cselect_b32 s2, 1, s2
    v_mov_b32 v9, s2
    s_mov_b64 exec, 1
    ds_write_b32 v8, v9
    s_mov_b64 exec, -1
    s_mov_b32 s49, s12
    s_mov_b32 s51, 0
    s_waitcnt vmcnt(0) lgkmcnt(0)
    s_barrier
    ds_read_b32 v9, v10
    s_mov_b32 s18, 5120000
    s_mov_b32 s19, 0x00020000
    s_waitcnt lgkmcnt(0)
    v_cmp_ne_u32 vcc, 0, v9
    s_nop 1
    s_cmp_lg_u64 vcc, 0
    s_cselect_b32 s2, 1, 0
    s_cbranch_scc1 L_p2_slow
L_p2_signal:
    v_mov_b32 v8, 160228
    s_lshl_b32 s15, s2, 4
    s_or_b32 s15, s15, s21
    s_add_u32 s14, s12, 16
    s_lshl_b32 s20, s15, s14
    s_add_u32 s20, s20, 1
    v_mov_b32 v9, s20
    s_cmp_lg_u32 s13, 15
    s_cbranch_scc1 L_p2_nosig0
    s_lshl_b32 s14, s3, 8
    s_add_u32 s14, s14, 230821888
    s_mov_b64 exec, 1
    buffer_atomic_add v9, off, s[4:7], s14 sc0
    s_mov_b64 exec, -1
L_p2_nosig0:
    s_cmp_eq_u32 s49, 3
    s_cselect_b32 s15, 8, 0
    s_add_u32 s15, s15, 224
    v_add_u32 v2, 16384, v1
    v_cmp_gt_u32 vcc, s15, v0
    s_mul_i32 s14, s3, 80000
    s_mul_i32 s26, s49, 19968
    s_add_u32 s26, s26, s14
    v_cndmask_b32 v2, 0.5, v2, vcc
    s_mov_b32 s10, 5120000
    s_lshl_b32 s28, s92, 16
    s_and_b32 s29, s92, 0xffff0000
    s_lshl_b32 s30, s93, 16
    s_and_b32 s31, s93, 0xffff0000
    s_lshl_b32 s32, s94, 16
    s_and_b32 s33, s94, 0xffff0000
    s_lshl_b32 s34, s95, 16
    s_and_b32 s35, s95, 0xffff0000
    s_lshl_b32 s36, s96, 16
    s_and_b32 s37, s96, 0xffff0000
    s_lshl_b32 s38, s97, 16
    s_and_b32 s39, s97, 0xffff0000
    s_lshl_b32 s40, s98, 16
    s_and_b32 s41, s98, 0xffff0000
    s_lshl_b32 s42, s99, 16
    s_and_b32 s43, s99, 0xffff0000
    s_and_b32 s99, s91, 0xffff0000
    s_lshl_b32 s98, s91, 16
    s_and_b32 s97, s90, 0xffff0000
    s_lshl_b32 s96, s90, 16
    s_and_b32 s95, s89, 0xffff0000
    s_lshl_b32 s94, s89, 16
    s_and_b32 s93, s88, 0xffff0000
    s_lshl_b32 s92, s88, 16
    s_and_b32 s91, s87, 0xffff0000
    s_lshl_b32 s90, s87, 16
    s_and_b32 s89, s86, 0xffff0000
    s_lshl_b32 s88, s86, 16
    s_and_b32 s87, s85, 0xffff0000
    s_lshl_b32 s86, s85, 16
    s_and_b32 s85, s84, 0xffff0000
    s_lshl_b32 s84, s84, 16
    s_mov_b32 s44, s48
    s_add_u32 s45, s48, 2281701376
    s_cmp_eq_u32 s48, 0
    s_cselect_b32 s45, 0, s45
    s_cmp_lt_u32 s13, 12
    s_cbranch_scc1 L_p2_gc
    v_lshlrev_b32 v30, 16, v60
    v_and_b32 v31, 0xffff0000, v60
    v_lshlrev_b32 v36, 16, v53
    v_and_b32 v37, 0xffff0000, v53
    v_lshlrev_b32 v38, 16, v54
    v_and_b32 v39, 0xffff0000, v54
    v_lshlrev_b32 v40, 16, v56
    v_and_b32 v41, 0xffff0000, v56
    v_lshlrev_b32 v42, 16, v57
    v_and_b32 v43, 0xffff0000, v57
    v_pk_add_f32 v[14:15], v[30:31], v[36:37] op_sel:[0,0] op_sel_hi:[1,0] neg_lo:[0,1] neg_hi:[0,1]
    v_pk_add_f32 v[16:17], v[30:31], v[36:37] op_sel:[0,1] op_sel_hi:[1,1] neg_lo:[0,1] neg_hi:[0,1]
    v_pk_add_f32 v[18:19], v[30:31], v[38:39] op_sel:[0,0] op_sel_hi:[1,0] neg_lo:[0,1] neg_hi:[0,1]
    v_pk_add_f32 v[20:21], v[30:31], v[38:39] op_sel:[0,1] op_sel_hi:[1,1] neg_lo:[0,1] neg_hi:[0,1]
    v_pk_add_f32 v[22:23], v[30:31], v[40:41] op_sel:[0,0] op_sel_hi:[1,0] neg_lo:[0,1] neg_hi:[0,1]
    v_pk_add_f32 v[24:25], v[30:31], v[40:41] op_sel:[0,1] op_sel_hi:[1,1] neg_lo:[0,1] neg_hi:[0,1]
    v_pk_add_f32 v[26:27], v[30:31], v[42:43] op_sel:[0,0] op_sel_hi:[1,0] neg_lo:[0,1] neg_hi:[0,1]
    v_pk_add_f32 v[28:29], v[30:31], v[42:43] op_sel:[0,1] op_sel_hi:[1,1] neg_lo:[0,1] neg_hi:[0,1]
    v_cvt_pk_bf16_f32 v32, v14, v15
    v_lshlrev_b32 v14, 16, v32
    v_and_b32 v15, 0xffff0000, v32
    v_cvt_pk_bf16_f32 v32, v16, v17
    v_lshlrev_b32 v16, 16, v32
    v_and_b32 v17, 0xffff0000, v32
    v_cvt_pk_bf16_f32 v32, v18, v19
    v_lshlrev_b32 v18, 16, v32
    v_and_b32 v19, 0xffff0000, v32
    v_cvt_pk_bf16_f32 v32, v20, v21
    v_lshlrev_b32 v20, 16, v32
    v_and_b32 v21, 0xffff0000, v32
    v_cvt_pk_bf16_f32 v32, v22, v23
    v_lshlrev_b32 v22, 16, v32
    v_and_b32 v23, 0xffff0000, v32
    v_cvt_pk_bf16_f32 v32, v24, v25
    v_lshlrev_b32 v24, 16, v32
    v_and_b32 v25, 0xffff0000, v32
    v_cvt_pk_bf16_f32 v32, v26, v27
    v_lshlrev_b32 v26, 16, v32
    v_and_b32 v27, 0xffff0000, v32
    v_cvt_pk_bf16_f32 v32, v28, v29
    v_lshlrev_b32 v28, 16, v32
    v_and_b32 v29, 0xffff0000, v32
    v_pk_mul_f32 v[14:15], v[14:15], v[14:15]
    v_pk_mul_f32 v[16:17], v[16:17], v[16:17]
    v_pk_mul_f32 v[18:19], v[18:19], v[18:19]
    v_pk_mul_f32 v[20:21], v[20:21], v[20:21]
    v_pk_mul_f32 v[22:23], v[22:23], v[22:23]
    v_pk_mul_f32 v[24:25], v[24:25], v[24:25]
    v_pk_mul_f32 v[26:27], v[26:27], v[26:27]
    v_pk_mul_f32 v[28:29], v[28:29], v[28:29]
    v_cvt_pk_bf16_f32 v32, v14, v15
    v_lshlrev_b32 v14, 16, v32
    v_and_b32 v15, 0xffff0000, v32
    v_cvt_pk_bf16_f32 v32, v16, v17
    v_lshlrev_b32 v16, 16, v32
    v_and_b32 v17, 0xffff0000, v32
    v_cvt_pk_bf16_f32 v32, v18, v19
    v_lshlrev_b32 v18, 16, v32
    v_and_b32 v19, 0xffff0000, v32
    v_cvt_pk_bf16_f32 v32, v20, v21
    v_lshlrev_b32 v20, 16, v32
    v_and_b32 v21, 0xffff0000, v32
    v_cvt_pk_bf16_f32 v32, v22, v23
    v_lshlrev_b32 v22, 16, v32
    v_and_b32 v23, 0xffff0000, v32
    v_cvt_pk_bf16_f32 v32, v24, v25
    v_lshlrev_b32 v24, 16, v32
    v_and_b32 v25, 0xffff0000, v32
    v_cvt_pk_bf16_f32 v32, v26, v27
    v_lshlrev_b32 v26, 16, v32
    v_and_b32 v27, 0xffff0000, v32
    v_cvt_pk_bf16_f32 v32, v28, v29
    v_lshlrev_b32 v28, 16, v32
    v_and_b32 v29, 0xffff0000, v32
    v_mov_b32 v30, 1092616192
    v_mov_b32 v31, 0x3fb8aa3b
    v_pk_mul_f32 v[14:15], v[14:15], v[30:31] op_sel:[0,0] op_sel_hi:[1,0]
    v_pk_mul_f32 v[16:17], v[16:17], v[30:31] op_sel:[0,0] op_sel_hi:[1,0]
    v_pk_mul_f32 v[18:19], v[18:19], v[30:31] op_sel:[0,0] op_sel_hi:[1,0]
    v_pk_mul_f32 v[20:21], v[20:21], v[30:31] op_sel:[0,0] op_sel_hi:[1,0]
    v_pk_mul_f32 v[22:23], v[22:23], v[30:31] op_sel:[0,0] op_sel_hi:[1,0]
    v_pk_mul_f32 v[24:25], v[24:25], v[30:31] op_sel:[0,0] op_sel_hi:[1,0]
    v_pk_mul_f32 v[26:27], v[26:27], v[30:31] op_sel:[0,0] op_sel_hi:[1,0]
    v_pk_mul_f32 v[28:29], v[28:29], v[30:31] op_sel:[0,0] op_sel_hi:[1,0]
    v_cvt_pk_bf16_f32 v32, v14, v15
    v_lshlrev_b32 v14, 16, v32
    v_and_b32 v15, 0xffff0000, v32
    v_cvt_pk_bf16_f32 v32, v16, v17
    v_lshlrev_b32 v16, 16, v32
    v_and_b32 v17, 0xffff0000, v32
    v_cvt_pk_bf16_f32 v32, v18, v19
    v_lshlrev_b32 v18, 16, v32
    v_and_b32 v19, 0xffff0000, v32
    v_cvt_pk_bf16_f32 v32, v20, v21
    v_lshlrev_b32 v20, 16, v32
    v_and_b32 v21, 0xffff0000, v32
    v_cvt_pk_bf16_f32 v32, v22, v23
    v_lshlrev_b32 v22, 16, v32
    v_and_b32 v23, 0xffff0000, v32
    v_cvt_pk_bf16_f32 v32, v24, v25
    v_lshlrev_b32 v24, 16, v32
    v_and_b32 v25, 0xffff0000, v32
    v_cvt_pk_bf16_f32 v32, v26, v27
    v_lshlrev_b32 v26, 16, v32
    v_and_b32 v27, 0xffff0000, v32
    v_cvt_pk_bf16_f32 v32, v28, v29
    v_lshlrev_b32 v28, 16, v32
    v_and_b32 v29, 0xffff0000, v32
    v_pk_mul_f32 v[14:15], v[14:15], v[30:31] op_sel:[0,1] op_sel_hi:[1,1]
    v_pk_mul_f32 v[16:17], v[16:17], v[30:31] op_sel:[0,1] op_sel_hi:[1,1]
    v_pk_mul_f32 v[18:19], v[18:19], v[30:31] op_sel:[0,1] op_sel_hi:[1,1]
    v_pk_mul_f32 v[20:21], v[20:21], v[30:31] op_sel:[0,1] op_sel_hi:[1,1]
    v_pk_mul_f32 v[22:23], v[22:23], v[30:31] op_sel:[0,1] op_sel_hi:[1,1]
    v_pk_mul_f32 v[24:25], v[24:25], v[30:31] op_sel:[0,1] op_sel_hi:[1,1]
    v_pk_mul_f32 v[26:27], v[26:27], v[30:31] op_sel:[0,1] op_sel_hi:[1,1]
    v_pk_mul_f32 v[28:29], v[28:29], v[30:31] op_sel:[0,1] op_sel_hi:[1,1]
    v_exp_f32 v14, -v14
    v_exp_f32 v15, -v15
    v_exp_f32 v16, -v16
    v_exp_f32 v17, -v17
    v_exp_f32 v18, -v18
    v_exp_f32 v19, -v19
    v_exp_f32 v20, -v20
    v_exp_f32 v21, -v21
    v_exp_f32 v22, -v22
    v_exp_f32 v23, -v23
    v_exp_f32 v24, -v24
    v_exp_f32 v25, -v25
    v_exp_f32 v26, -v26
    v_exp_f32 v27, -v27
    v_exp_f32 v28, -v28
    v_exp_f32 v29, -v29
    v_cvt_pk_bf16_f32 v14, v14, v16
    v_cvt_pk_bf16_f32 v15, v15, v17
    v_cvt_pk_bf16_f32 v18, v18, v20
    v_cvt_pk_bf16_f32 v19, v19, v21
    v_cvt_pk_bf16_f32 v22, v22, v24
    v_cvt_pk_bf16_f32 v23, v23, v25
    v_cvt_pk_bf16_f32 v26, v26, v28
    v_cvt_pk_bf16_f32 v27, v27, v29
    v_dot2_f32_bf16 v72, v14, s68, 0
    v_dot2_f32_bf16 v73, v15, s68, 0
    v_dot2_f32_bf16 v74, v14, s69, 0
    v_dot2_f32_bf16 v75, v15, s69, 0
    v_dot2_f32_bf16 v76, v14, s70, 0
    v_dot2_f32_bf16 v77, v15, s70, 0
    v_dot2_f32_bf16 v78, v14, s71, 0
    v_dot2_f32_bf16 v79, v15, s71, 0
    v_dot2_f32_bf16 v80, v14, s52, 0
    v_dot2_f32_bf16 v81, v15, s52, 0
    v_dot2_f32_bf16 v82, v14, s53, 0
    v_dot2_f32_bf16 v83, v15, s53, 0
    v_dot2_f32_bf16 v84, v14, s54, 0
    v_dot2_f32_bf16 v85, v15, s54, 0
    v_dot2_f32_bf16 v86, v14, s55, 0
    v_dot2_f32_bf16 v87, v15, s55, 0
    v_dot2_f32_bf16 v72, v18, s72, v72
    v_dot2_f32_bf16 v73, v19, s72, v73
    v_dot2_f32_bf16 v74, v18, s73, v74
    v_dot2_f32_bf16 v75, v19, s73, v75
    v_dot2_f32_bf16 v76, v18, s74, v76
    v_dot2_f32_bf16 v77, v19, s74, v77
    v_dot2_f32_bf16 v78, v18, s75, v78
    v_dot2_f32_bf16 v79, v19, s75, v79
    v_dot2_f32_bf16 v80, v18, s56, v80
    v_dot2_f32_bf16 v81, v19, s56, v81
    v_dot2_f32_bf16 v82, v18, s57, v82
    v_dot2_f32_bf16 v83, v19, s57, v83
    v_dot2_f32_bf16 v84, v18, s58, v84
    v_dot2_f32_bf16 v85, v19, s58, v85
    v_dot2_f32_bf16 v86, v18, s59, v86
    v_dot2_f32_bf16 v87, v19, s59, v87
    v_dot2_f32_bf16 v72, v22, s76, v72
    v_dot2_f32_bf16 v73, v23, s76, v73
    v_dot2_f32_bf16 v74, v22, s77, v74
    v_dot2_f32_bf16 v75, v23, s77, v75
    v_dot2_f32_bf16 v76, v22, s78, v76
    v_dot2_f32_bf16 v77, v23, s78, v77
    v_dot2_f32_bf16 v78, v22, s79, v78
    v_dot2_f32_bf16 v79, v23, s79, v79
    v_dot2_f32_bf16 v80, v22, s60, v80
    v_dot2_f32_bf16 v81, v23, s60, v81
    v_dot2_f32_bf16 v82, v22, s61, v82
    v_dot2_f32_bf16 v83, v23, s61, v83
    v_dot2_f32_bf16 v84, v22, s62, v84
    v_dot2_f32_bf16 v85, v23, s62, v85
    v_dot2_f32_bf16 v86, v22, s63, v86
    v_dot2_f32_bf16 v87, v23, s63, v87
    v_dot2_f32_bf16 v72, v26, s80, v72
    v_dot2_f32_bf16 v73, v27, s80, v73
    v_dot2_f32_bf16 v74, v26, s81, v74
    v_dot2_f32_bf16 v75, v27, s81, v75
    v_dot2_f32_bf16 v76, v26, s82, v76
    v_dot2_f32_bf16 v77, v27, s82, v77
    v_dot2_f32_bf16 v78, v26, s83, v78
    v_dot2_f32_bf16 v79, v27, s83, v79
    v_dot2_f32_bf16 v80, v26, s64, v80
    v_dot2_f32_bf16 v81, v27, s64, v81
    v_dot2_f32_bf16 v82, v26, s65, v82
    v_dot2_f32_bf16 v83, v27, s65, v83
    v_dot2_f32_bf16 v84, v26, s66, v84
    v_dot2_f32_bf16 v85, v27, s66, v85
    v_dot2_f32_bf16 v86, v26, s67, v86
    v_dot2_f32_bf16 v87, v27, s67, v87
L_p2_gc:
    s_cmp_ge_u32 s13, 4
    s_cbranch_scc1 L_p2_gd
    v_lshlrev_b32 v30, 16, v61
    v_and_b32 v31, 0xffff0000, v61
    v_pk_add_f32 v[14:15], v[30:31], v[36:37] op_sel:[0,0] op_sel_hi:[1,0] neg_lo:[0,1] neg_hi:[0,1]
    v_pk_add_f32 v[16:17], v[30:31], v[36:37] op_sel:[0,1] op_sel_hi:[1,1] neg_lo:[0,1] neg_hi:[0,1]
    v_pk_add_f32 v[18:19], v[30:31], v[38:39] op_sel:[0,0] op_sel_hi:[1,0] neg_lo:[0,1] neg_hi:[0,1]
    v_pk_add_f32 v[20:21], v[30:31], v[38:39] op_sel:[0,1] op_sel_hi:[1,1] neg_lo:[0,1] neg_hi:[0,1]
    v_pk_add_f32 v[22:23], v[30:31], v[40:41] op_sel:[0,0] op_sel_hi:[1,0] neg_lo:[0,1] neg_hi:[0,1]
    v_pk_add_f32 v[24:25], v[30:31], v[40:41] op_sel:[0,1] op_sel_hi:[1,1] neg_lo:[0,1] neg_hi:[0,1]
    v_pk_add_f32 v[26:27], v[30:31], v[42:43] op_sel:[0,0] op_sel_hi:[1,0] neg_lo:[0,1] neg_hi:[0,1]
    v_pk_add_f32 v[28:29], v[30:31], v[42:43] op_sel:[0,1] op_sel_hi:[1,1] neg_lo:[0,1] neg_hi:[0,1]
    v_cvt_pk_bf16_f32 v32, v14, v15
    v_lshlrev_b32 v14, 16, v32
    v_and_b32 v15, 0xffff0000, v32
    v_cvt_pk_bf16_f32 v32, v16, v17
    v_lshlrev_b32 v16, 16, v32
    v_and_b32 v17, 0xffff0000, v32
    v_cvt_pk_bf16_f32 v32, v18, v19
    v_lshlrev_b32 v18, 16, v32
    v_and_b32 v19, 0xffff0000, v32
    v_cvt_pk_bf16_f32 v32, v20, v21
    v_lshlrev_b32 v20, 16, v32
    v_and_b32 v21, 0xffff0000, v32
    v_cvt_pk_bf16_f32 v32, v22, v23
    v_lshlrev_b32 v22, 16, v32
    v_and_b32 v23, 0xffff0000, v32
    v_cvt_pk_bf16_f32 v32, v24, v25
    v_lshlrev_b32 v24, 16, v32
    v_and_b32 v25, 0xffff0000, v32
    v_cvt_pk_bf16_f32 v32, v26, v27
    v_lshlrev_b32 v26, 16, v32
    v_and_b32 v27, 0xffff0000, v32
    v_cvt_pk_bf16_f32 v32, v28, v29
    v_lshlrev_b32 v28, 16, v32
    v_and_b32 v29, 0xffff0000, v32
    v_pk_mul_f32 v[14:15], v[14:15], v[14:15]
    v_pk_mul_f32 v[16:17], v[16:17], v[16:17]
    v_pk_mul_f32 v[18:19], v[18:19], v[18:19]
    v_pk_mul_f32 v[20:21], v[20:21], v[20:21]
    v_pk_mul_f32 v[22:23], v[22:23], v[22:23]
    v_pk_mul_f32 v[24:25], v[24:25], v[24:25]
    v_pk_mul_f32 v[26:27], v[26:27], v[26:27]
    v_pk_mul_f32 v[28:29], v[28:29], v[28:29]
    v_cvt_pk_bf16_f32 v32, v14, v15
    v_lshlrev_b32 v14, 16, v32
    v_and_b32 v15, 0xffff0000, v32
    v_cvt_pk_bf16_f32 v32, v16, v17
    v_lshlrev_b32 v16, 16, v32
    v_and_b32 v17, 0xffff0000, v32
    v_cvt_pk_bf16_f32 v32, v18, v19
    v_lshlrev_b32 v18, 16, v32
    v_and_b32 v19, 0xffff0000, v32
    v_cvt_pk_bf16_f32 v32, v20, v21
    v_lshlrev_b32 v20, 16, v32
    v_and_b32 v21, 0xffff0000, v32
    v_cvt_pk_bf16_f32 v32, v22, v23
    v_lshlrev_b32 v22, 16, v32
    v_and_b32 v23, 0xffff0000, v32
    v_cvt_pk_bf16_f32 v32, v24, v25
    v_lshlrev_b32 v24, 16, v32
    v_and_b32 v25, 0xffff0000, v32
    v_cvt_pk_bf16_f32 v32, v26, v27
    v_lshlrev_b32 v26, 16, v32
    v_and_b32 v27, 0xffff0000, v32
    v_cvt_pk_bf16_f32 v32, v28, v29
    v_lshlrev_b32 v28, 16, v32
    v_and_b32 v29, 0xffff0000, v32
    v_mov_b32 v30, 1092616192
    v_mov_b32 v31, 0x3fb8aa3b
    v_pk_mul_f32 v[14:15], v[14:15], v[30:31] op_sel:[0,0] op_sel_hi:[1,0]
    v_pk_mul_f32 v[16:17], v[16:17], v[30:31] op_sel:[0,0] op_sel_hi:[1,0]
    v_pk_mul_f32 v[18:19], v[18:19], v[30:31] op_sel:[0,0] op_sel_hi:[1,0]
    v_pk_mul_f32 v[20:21], v[20:21], v[30:31] op_sel:[0,0] op_sel_hi:[1,0]
    v_pk_mul_f32 v[22:23], v[22:23], v[30:31] op_sel:[0,0] op_sel_hi:[1,0]
    v_pk_mul_f32 v[24:25], v[24:25], v[30:31] op_sel:[0,0] op_sel_hi:[1,0]
    v_pk_mul_f32 v[26:27], v[26:27], v[30:31] op_sel:[0,0] op_sel_hi:[1,0]
    v_pk_mul_f32 v[28:29], v[28:29], v[30:31] op_sel:[0,0] op_sel_hi:[1,0]
    v_cvt_pk_bf16_f32 v32, v14, v15
    v_lshlrev_b32 v14, 16, v32
    v_and_b32 v15, 0xffff0000, v32
    v_cvt_pk_bf16_f32 v32, v16, v17
    v_lshlrev_b32 v16, 16, v32
    v_and_b32 v17, 0xffff0000, v32
    v_cvt_pk_bf16_f32 v32, v18, v19
    v_lshlrev_b32 v18, 16, v32
    v_and_b32 v19, 0xffff0000, v32
    v_cvt_pk_bf16_f32 v32, v20, v21
    v_lshlrev_b32 v20, 16, v32
    v_and_b32 v21, 0xffff0000, v32
    v_cvt_pk_bf16_f32 v32, v22, v23
    v_lshlrev_b32 v22, 16, v32
    v_and_b32 v23, 0xffff0000, v32
    v_cvt_pk_bf16_f32 v32, v24, v25
    v_lshlrev_b32 v24, 16, v32
    v_and_b32 v25, 0xffff0000, v32
    v_cvt_pk_bf16_f32 v32, v26, v27
    v_lshlrev_b32 v26, 16, v32
    v_and_b32 v27, 0xffff0000, v32
    v_cvt_pk_bf16_f32 v32, v28, v29
    v_lshlrev_b32 v28, 16, v32
    v_and_b32 v29, 0xffff0000, v32
    v_pk_mul_f32 v[14:15], v[14:15], v[30:31] op_sel:[0,1] op_sel_hi:[1,1]
    v_pk_mul_f32 v[16:17], v[16:17], v[30:31] op_sel:[0,1] op_sel_hi:[1,1]
    v_pk_mul_f32 v[18:19], v[18:19], v[30:31] op_sel:[0,1] op_sel_hi:[1,1]
    v_pk_mul_f32 v[20:21], v[20:21], v[30:31] op_sel:[0,1] op_sel_hi:[1,1]
    v_pk_mul_f32 v[22:23], v[22:23], v[30:31] op_sel:[0,1] op_sel_hi:[1,1]
    v_pk_mul_f32 v[24:25], v[24:25], v[30:31] op_sel:[0,1] op_sel_hi:[1,1]
    v_pk_mul_f32 v[26:27], v[26:27], v[30:31] op_sel:[0,1] op_sel_hi:[1,1]
    v_pk_mul_f32 v[28:29], v[28:29], v[30:31] op_sel:[0,1] op_sel_hi:[1,1]
    v_exp_f32 v14, -v14
    v_exp_f32 v15, -v15
    v_exp_f32 v16, -v16
    v_exp_f32 v17, -v17
    v_exp_f32 v18, -v18
    v_exp_f32 v19, -v19
    v_exp_f32 v20, -v20
    v_exp_f32 v21, -v21
    v_exp_f32 v22, -v22
    v_exp_f32 v23, -v23
    v_exp_f32 v24, -v24
    v_exp_f32 v25, -v25
    v_exp_f32 v26, -v26
    v_exp_f32 v27, -v27
    v_exp_f32 v28, -v28
    v_exp_f32 v29, -v29
    v_cvt_pk_bf16_f32 v14, v14, v16
    v_cvt_pk_bf16_f32 v15, v15, v17
    v_cvt_pk_bf16_f32 v18, v18, v20
    v_cvt_pk_bf16_f32 v19, v19, v21
    v_cvt_pk_bf16_f32 v22, v22, v24
    v_cvt_pk_bf16_f32 v23, v23, v25
    v_cvt_pk_bf16_f32 v26, v26, v28
    v_cvt_pk_bf16_f32 v27, v27, v29
    v_dot2_f32_bf16 v112, v14, s68, 0
    v_dot2_f32_bf16 v113, v15, s68, 0
    v_dot2_f32_bf16 v114, v14, s69, 0
    v_dot2_f32_bf16 v115, v15, s69, 0
    v_dot2_f32_bf16 v116, v14, s70, 0
    v_dot2_f32_bf16 v117, v15, s70, 0
    v_dot2_f32_bf16 v118, v14, s71, 0
    v_dot2_f32_bf16 v119, v15, s71, 0
    v_dot2_f32_bf16 v120, v14, s52, 0
    v_dot2_f32_bf16 v121, v15, s52, 0
    v_dot2_f32_bf16 v122, v14, s53, 0
    v_dot2_f32_bf16 v123, v15, s53, 0
    v_dot2_f32_bf16 v124, v14, s54, 0
    v_dot2_f32_bf16 v125, v15, s54, 0
    v_dot2_f32_bf16 v126, v14, s55, 0
    v_dot2_f32_bf16 v127, v15, s55, 0
    v_dot2_f32_bf16 v112, v18, s72, v112
    v_dot2_f32_bf16 v113, v19, s72, v113
    v_dot2_f32_bf16 v114, v18, s73, v114
    v_dot2_f32_bf16 v115, v19, s73, v115
    v_dot2_f32_bf16 v116, v18, s74, v116
    v_dot2_f32_bf16 v117, v19, s74, v117
    v_dot2_f32_bf16 v118, v18, s75, v118
    v_dot2_f32_bf16 v119, v19, s75, v119
    v_dot2_f32_bf16 v120, v18, s56, v120
    v_dot2_f32_bf16 v121, v19, s56, v121
    v_dot2_f32_bf16 v122, v18, s57, v122
    v_dot2_f32_bf16 v123, v19, s57, v123
    v_dot2_f32_bf16 v124, v18, s58, v124
    v_dot2_f32_bf16 v125, v19, s58, v125
    v_dot2_f32_bf16 v126, v18, s59, v126
    v_dot2_f32_bf16 v127, v19, s59, v127
    v_dot2_f32_bf16 v112, v22, s76, v112
    v_dot2_f32_bf16 v113, v23, s76, v113
    v_dot2_f32_bf16 v114, v22, s77, v114
    v_dot2_f32_bf16 v115, v23, s77, v115
    v_dot2_f32_bf16 v116, v22, s78, v116
    v_dot2_f32_bf16 v117, v23, s78, v117
    v_dot2_f32_bf16 v118, v22, s79, v118
    v_dot2_f32_bf16 v119, v23, s79, v119
    v_dot2_f32_bf16 v120, v22, s60, v120
    v_dot2_f32_bf16 v121, v23, s60, v121
    v_dot2_f32_bf16 v122, v22, s61, v122
    v_dot2_f32_bf16 v123, v23, s61, v123
    v_dot2_f32_bf16 v124, v22, s62, v124
    v_dot2_f32_bf16 v125, v23, s62, v125
    v_dot2_f32_bf16 v126, v22, s63, v126
    v_dot2_f32_bf16 v127, v23, s63, v127
    v_dot2_f32_bf16 v112, v26, s80, v112
    v_dot2_f32_bf16 v113, v27, s80, v113
    v_dot2_f32_bf16 v114, v26, s81, v114
    v_dot2_f32_bf16 v115, v27, s81, v115
    v_dot2_f32_bf16 v116, v26, s82, v116
    v_dot2_f32_bf16 v117, v27, s82, v117
    v_dot2_f32_bf16 v118, v26, s83, v118
    v_dot2_f32_bf16 v119, v27, s83, v119
    v_dot2_f32_bf16 v120, v26, s64, v120
    v_dot2_f32_bf16 v121, v27, s64, v121
    v_dot2_f32_bf16 v122, v26, s65, v122
    v_dot2_f32_bf16 v123, v27, s65, v123
    v_dot2_f32_bf16 v124, v26, s66, v124
    v_dot2_f32_bf16 v125, v27, s66, v125
    v_dot2_f32_bf16 v126, v26, s67, v126
    v_dot2_f32_bf16 v127, v27, s67, v127
L_p2_gd:
    s_cmp_lg_u32 s13, 15
    s_cbranch_scc1 L_p2_nosig
    s_waitcnt vmcnt(0)
    v_readfirstlane_b32 s15, v9
    s_lshl_b32 s51, 1, s12
    s_add_u32 s20, s20, s15
    s_and_b32 s15, s20, 0xff
    s_cmp_eq_u32 s15, 4
    s_cbranch_scc0 L_p2_notlast
    s_bfe_u32 s15, s20, 262160
    s_or_b32 s51, s51, s15
    s_branch L_p2_pub
L_p2_notlast:
    s_cmp_lg_u32 s21, 0
    s_cselect_b32 s51, 0, s51
    s_cbranch_scc1 L_p2_pub
L_p2_poll:
    v_mov_b32 v9, 0
    s_lshl_b32 s14, s3, 8
    s_add_u32 s14, s14, 230821888
    s_mov_b64 exec, 1
    buffer_atomic_add v9, off, s[4:7], s14 sc0
    s_mov_b64 exec, -1
    s_waitcnt vmcnt(0)
    v_readfirstlane_b32 s20, v9
    s_nop 0
    s_and_b32 s15, s20, 0xff
    s_cmp_lt_u32 s15, 4
    s_cbranch_scc1 L_p2_poll
L_p2_pub:
    s_lshl_b32 s15, s51, 24
    s_or_b32 s15, s15, s20
    v_mov_b32 v9, s15
    s_mov_b64 exec, 1
    ds_write_b32 v8, v9
    s_mov_b64 exec, -1
    s_waitcnt lgkmcnt(0)
L_p2_nosig:
    s_barrier
    ds_read_b32 v9, v8
    s_waitcnt lgkmcnt(0)
    v_readfirstlane_b32 s20, v9
    s_nop 0
    s_lshr_b32 s51, s20, 24
    s_cbranch_scc0 L_p2_end
L_p2_fin:
    s_mul_i32 s24, s49, 19968
    s_add_u32 s14, s12, 1
    s_and_b32 s14, s14, 3
    s_mul_i32 s15, s14, 5120000
    s_add_u32 s15, s15, 230838272
    s_add_u32 s15, s15, s26
    buffer_load_dwordx4 v[12:15], v1, s[4:7], s15 offen sc1
    buffer_load_dwordx4 v[92:95], v2, s[4:7], s15 offen sc1
    s_add_u32 s14, s12, 2
    s_and_b32 s14, s14, 3
    s_mul_i32 s15, s14, 5120000
    s_add_u32 s15, s15, 230838272
    s_add_u32 s15, s15, s26
    buffer_load_dwordx4 v[16:19], v1, s[4:7], s15 offen sc1
    buffer_load_dwordx4 v[96:99], v2, s[4:7], s15 offen sc1
    s_add_u32 s14, s12, 3
    s_and_b32 s14, s14, 3
    s_mul_i32 s15, s14, 5120000
    s_add_u32 s15, s15, 230838272
    s_add_u32 s15, s15, s26
    buffer_load_dwordx4 v[20:23], v1, s[4:7], s15 offen sc1
    buffer_load_dwordx4 v[100:103], v2, s[4:7], s15 offen sc1
    v_add_u32 v24, s24, v1
    ds_read_b128 v[8:11], v24
    v_add_u32 v25, s24, v2
    ds_read_b128 v[88:91], v25
    s_waitcnt vmcnt(0) lgkmcnt(0)
    s_bfe_u32 s14, s20, 262164
    s_cbranch_scc0 L_p2_kernel_nof32a_10
    s_add_u32 s14, s12, 0
    s_and_b32 s14, s14, 3
    s_add_u32 s14, s14, 20
    s_bitcmp1_b32 s20, s14
    s_cbranch_scc0 L_p2_kernel_q_11
    v_mov_b32 v8, 1073758208
    v_mov_b32 v9, 1073758208
    v_mov_b32 v10, 1073758208
    v_mov_b32 v11, 1073758208
L_p2_kernel_q_11:
    s_add_u32 s14, s12, 1
    s_and_b32 s14, s14, 3
    s_add_u32 s14, s14, 20
    s_bitcmp1_b32 s20, s14
    s_cbranch_scc0 L_p2_kernel_q_12
    v_mov_b32 v12, 1073758208
    v_mov_b32 v13, 1073758208
    v_mov_b32 v14, 1073758208
    v_mov_b32 v15, 1073758208
L_p2_kernel_q_12:
    s_add_u32 s14, s12, 2
    s_and_b32 s14, s14, 3
    s_add_u32 s14, s14, 20
    s_bitcmp1_b32 s20, s14
    s_cbranch_scc0 L_p2_kernel_q_13
    v_mov_b32 v16, 1073758208
    v_mov_b32 v17, 1073758208
    v_mov_b32 v18, 1073758208
    v_mov_b32 v19, 1073758208
L_p2_kernel_q_13:
    s_add_u32 s14, s12, 3
    s_and_b32 s14, s14, 3
    s_add_u32 s14, s14, 20
    s_bitcmp1_b32 s20, s14
    s_cbranch_scc0 L_p2_kernel_q_14
    v_mov_b32 v20, 1073758208
    v_mov_b32 v21, 1073758208
    v_mov_b32 v22, 1073758208
    v_mov_b32 v23, 1073758208
L_p2_kernel_q_14:
L_p2_kernel_nof32a_10:
    v_pk_add_u16 v8, v8, v12
    v_pk_add_u16 v16, v16, v20
    v_pk_add_u16 v9, v9, v13
    v_pk_add_u16 v17, v17, v21
    v_pk_add_u16 v10, v10, v14
    v_pk_add_u16 v18, v18, v22
    v_pk_add_u16 v11, v11, v15
    v_pk_add_u16 v19, v19, v23
    v_add_u32_sdwa v24, v8, v16 dst_sel:DWORD dst_unused:UNUSED_PAD src0_sel:WORD_0 src1_sel:WORD_0
    v_add_u32_sdwa v25, v10, v18 dst_sel:DWORD dst_unused:UNUSED_PAD src0_sel:WORD_0 src1_sel:WORD_0
    v_add_u32_sdwa v26, v8, v16 dst_sel:DWORD dst_unused:UNUSED_PAD src0_sel:WORD_1 src1_sel:WORD_1
    v_add_u32_sdwa v27, v10, v18 dst_sel:DWORD dst_unused:UNUSED_PAD src0_sel:WORD_1 src1_sel:WORD_1
    v_add_u32_sdwa v28, v9, v17 dst_sel:DWORD dst_unused:UNUSED_PAD src0_sel:WORD_0 src1_sel:WORD_0
    v_add_u32_sdwa v29, v11, v19 dst_sel:DWORD dst_unused:UNUSED_PAD src0_sel:WORD_0 src1_sel:WORD_0
    v_add_u32_sdwa v30, v9, v17 dst_sel:DWORD dst_unused:UNUSED_PAD src0_sel:WORD_1 src1_sel:WORD_1
    v_add_u32_sdwa v31, v11, v19 dst_sel:DWORD dst_unused:UNUSED_PAD src0_sel:WORD_1 src1_sel:WORD_1
    v_cvt_f32_u32 v24, v24
    v_cvt_f32_u32 v25, v25
    v_cvt_f32_u32 v26, v26
    v_cvt_f32_u32 v27, v27
    v_cvt_f32_u32 v28, v28
    v_cvt_f32_u32 v29, v29
    v_cvt_f32_u32 v30, v30
    v_cvt_f32_u32 v31, v31
    v_pk_fma_f32 v[24:25], v[24:25], s[44:45], s[44:45] op_sel:[0,0,1] op_sel_hi:[1,0,1]
    v_pk_fma_f32 v[26:27], v[26:27], s[44:45], s[44:45] op_sel:[0,0,1] op_sel_hi:[1,0,1]
    v_pk_fma_f32 v[28:29], v[28:29], s[44:45], s[44:45] op_sel:[0,0,1] op_sel_hi:[1,0,1]
    v_pk_fma_f32 v[30:31], v[30:31], s[44:45], s[44:45] op_sel:[0,0,1] op_sel_hi:[1,0,1]
    s_bfe_u32 s14, s20, 262164
    s_cbranch_scc0 L_p2_kernel_nof32b_15
    v_lshlrev_b32 v32, 1, v1
    s_bitcmp1_b32 s20, 20
    s_cbranch_scc0 L_p2_kernel_q_16
    s_lshl_b32 s15, s26, 1
    s_add_u32 s15, s15, 251318272
    buffer_load_dwordx4 v[8:11], v32, s[4:7], s15 offen sc1
    buffer_load_dwordx4 v[12:15], v32, s[4:7], s15 offen offset:16 sc1
    s_waitcnt vmcnt(0)
    v_add_f32 v24, v24, v8
    v_add_f32 v25, v25, v12
    v_add_f32 v26, v26, v9
    v_add_f32 v27, v27, v13
    v_add_f32 v28, v28, v10
    v_add_f32 v29, v29, v14
    v_add_f32 v30, v30, v11
    v_add_f32 v31, v31, v15
L_p2_kernel_q_16:
    s_bitcmp1_b32 s20, 21
    s_cbranch_scc0 L_p2_kernel_q_17
    s_lshl_b32 s15, s26, 1
    s_add_u32 s15, s15, 261558272
    buffer_load_dwordx4 v[8:11], v32, s[4:7], s15 offen sc1
    buffer_load_dwordx4 v[12:15], v32, s[4:7], s15 offen offset:16 sc1
    s_waitcnt vmcnt(0)
    v_add_f32 v24, v24, v8
    v_add_f32 v25, v25, v12
    v_add_f32 v26, v26, v9
    v_add_f32 v27, v27, v13
    v_add_f32 v28, v28, v10
    v_add_f32 v29, v29, v14
    v_add_f32 v30, v30, v11
    v_add_f32 v31, v31, v15
L_p2_kernel_q_17:
    s_bitcmp1_b32 s20, 22
    s_cbranch_scc0 L_p2_kernel_q_18
    s_lshl_b32 s15, s26, 1
    s_add_u32 s15, s15, 271798272
    buffer_load_dwordx4 v[8:11], v32, s[4:7], s15 offen sc1
    buffer_load_dwordx4 v[12:15], v32, s[4:7], s15 offen offset:16 sc1
    s_waitcnt vmcnt(0)
    v_add_f32 v24, v24, v8
    v_add_f32 v25, v25, v12
    v_add_f32 v26, v26, v9
    v_add_f32 v27, v27, v13
    v_add_f32 v28, v28, v10
    v_add_f32 v29, v29, v14
    v_add_f32 v30, v30, v11
    v_add_f32 v31, v31, v15
L_p2_kernel_q_18:
    s_bitcmp1_b32 s20, 23
    s_cbranch_scc0 L_p2_kernel_q_19
    s_lshl_b32 s15, s26, 1
    s_add_u32 s15, s15, 282038272
    buffer_load_dwordx4 v[8:11], v32, s[4:7], s15 offen sc1
    buffer_load_dwordx4 v[12:15], v32, s[4:7], s15 offen offset:16 sc1
    s_waitcnt vmcnt(0)
    v_add_f32 v24, v24, v8
    v_add_f32 v25, v25, v12
    v_add_f32 v26, v26, v9
    v_add_f32 v27, v27, v13
    v_add_f32 v28, v28, v10
    v_add_f32 v29, v29, v14
    v_add_f32 v30, v30, v11
    v_add_f32 v31, v31, v15
L_p2_kernel_q_19:
L_p2_kernel_nof32b_15:
    v_pk_mul_f32 v[8:9], v[24:25], s[84:85] op_sel:[0,0] op_sel_hi:[1,0]
    v_pk_mul_f32 v[10:11], v[24:25], s[84:85] op_sel:[0,1] op_sel_hi:[1,1]
    v_pk_mul_f32 v[12:13], v[24:25], s[86:87] op_sel:[0,0] op_sel_hi:[1,0]
    v_pk_mul_f32 v[14:15], v[24:25], s[86:87] op_sel:[0,1] op_sel_hi:[1,1]
    v_pk_fma_f32 v[8:9], v[26:27], s[88:89], v[8:9] op_sel:[0,0,0] op_sel_hi:[1,0,1]
    v_pk_fma_f32 v[10:11], v[26:27], s[88:89], v[10:11] op_sel:[0,1,0] op_sel_hi:[1,1,1]
    v_pk_fma_f32 v[12:13], v[26:27], s[90:91], v[12:13] op_sel:[0,0,0] op_sel_hi:[1,0,1]
    v_pk_fma_f32 v[14:15], v[26:27], s[90:91], v[14:15] op_sel:[0,1,0] op_sel_hi:[1,1,1]
    v_pk_fma_f32 v[8:9], v[28:29], s[92:93], v[8:9] op_sel:[0,0,0] op_sel_hi:[1,0,1]
    v_pk_fma_f32 v[10:11], v[28:29], s[92:93], v[10:11] op_sel:[0,1,0] op_sel_hi:[1,1,1]
    v_pk_fma_f32 v[12:13], v[28:29], s[94:95], v[12:13] op_sel:[0,0,0] op_sel_hi:[1,0,1]
    v_pk_fma_f32 v[14:15], v[28:29], s[94:95], v[14:15] op_sel:[0,1,0] op_sel_hi:[1,1,1]
    v_pk_fma_f32 v[8:9], v[30:31], s[96:97], v[8:9] op_sel:[0,0,0] op_sel_hi:[1,0,1]
    v_pk_fma_f32 v[10:11], v[30:31], s[96:97], v[10:11] op_sel:[0,1,0] op_sel_hi:[1,1,1]
    v_pk_fma_f32 v[12:13], v[30:31], s[98:99], v[12:13] op_sel:[0,0,0] op_sel_hi:[1,0,1]
    v_pk_fma_f32 v[14:15], v[30:31], s[98:99], v[14:15] op_sel:[0,1,0] op_sel_hi:[1,1,1]
    v_pk_mul_f32 v[8:9], v[8:9], v[72:73]
    v_pk_mul_f32 v[10:11], v[10:11], v[74:75]
    v_pk_mul_f32 v[12:13], v[12:13], v[76:77]
    v_pk_mul_f32 v[14:15], v[14:15], v[78:79]
    v_pk_mul_f32 v[24:25], v[8:9], s[28:29] op_sel:[0,0] op_sel_hi:[1,0]
    v_pk_mul_f32 v[26:27], v[8:9], s[28:29] op_sel:[0,1] op_sel_hi:[1,1]
    v_pk_mul_f32 v[28:29], v[8:9], s[30:31] op_sel:[0,0] op_sel_hi:[1,0]
    v_pk_mul_f32 v[30:31], v[8:9], s[30:31] op_sel:[0,1] op_sel_hi:[1,1]
    v_pk_fma_f32 v[24:25], v[10:11], s[32:33], v[24:25] op_sel:[0,0,0] op_sel_hi:[1,0,1]
    v_pk_fma_f32 v[26:27], v[10:11], s[32:33], v[26:27] op_sel:[0,1,0] op_sel_hi:[1,1,1]
    v_pk_fma_f32 v[28:29], v[10:11], s[34:35], v[28:29] op_sel:[0,0,0] op_sel_hi:[1,0,1]
    v_pk_fma_f32 v[30:31], v[10:11], s[34:35], v[30:31] op_sel:[0,1,0] op_sel_hi:[1,1,1]
    v_pk_fma_f32 v[24:25], v[12:13], s[36:37], v[24:25] op_sel:[0,0,0] op_sel_hi:[1,0,1]
    v_pk_fma_f32 v[26:27], v[12:13], s[36:37], v[26:27] op_sel:[0,1,0] op_sel_hi:[1,1,1]
    v_pk_fma_f32 v[28:29], v[12:13], s[38:39], v[28:29] op_sel:[0,0,0] op_sel_hi:[1,0,1]
    v_pk_fma_f32 v[30:31], v[12:13], s[38:39], v[30:31] op_sel:[0,1,0] op_sel_hi:[1,1,1]
    v_pk_fma_f32 v[24:25], v[14:15], s[40:41], v[24:25] op_sel:[0,0,0] op_sel_hi:[1,0,1]
    v_pk_fma_f32 v[26:27], v[14:15], s[40:41], v[26:27] op_sel:[0,1,0] op_sel_hi:[1,1,1]
    v_pk_fma_f32 v[28:29], v[14:15], s[42:43], v[28:29] op_sel:[0,0,0] op_sel_hi:[1,0,1]
    v_pk_fma_f32 v[30:31], v[14:15], s[42:43], v[30:31] op_sel:[0,1,0] op_sel_hi:[1,1,1]
    v_lshlrev_b32 v8, 16, v64
    v_and_b32 v10, 0xffff0000, v64
    v_lshlrev_b32 v12, 16, v65
    v_and_b32 v14, 0xffff0000, v65
    v_lshlrev_b32 v9, 16, v66
    v_and_b32 v11, 0xffff0000, v66
    v_lshlrev_b32 v13, 16, v67
    v_and_b32 v15, 0xffff0000, v67
    v_pk_fma_f32 v[8:9], v[24:25], v[80:81], v[8:9]
    v_pk_fma_f32 v[10:11], v[26:27], v[82:83], v[10:11]
    v_pk_fma_f32 v[12:13], v[28:29], v[84:85], v[12:13]
    v_pk_fma_f32 v[14:15], v[30:31], v[86:87], v[14:15]
    v_cvt_pk_bf16_f32 v16, v8, v10
    v_cvt_pk_bf16_f32 v17, v12, v14
    v_cvt_pk_bf16_f32 v18, v9, v11
    v_cvt_pk_bf16_f32 v19, v13, v15
    buffer_store_dwordx4 v[16:19], v1, s[16:19], s26 offen
    s_cmp_ge_u32 s13, 4
    s_cbranch_scc1 L_p2_f1
    s_bfe_u32 s14, s20, 262164
    s_cbranch_scc0 L_p2_kernel_nof32a_20
    s_add_u32 s14, s12, 0
    s_and_b32 s14, s14, 3
    s_add_u32 s14, s14, 20
    s_bitcmp1_b32 s20, s14
    s_cbranch_scc0 L_p2_kernel_q_21
    v_mov_b32 v88, 1073758208
    v_mov_b32 v89, 1073758208
    v_mov_b32 v90, 1073758208
    v_mov_b32 v91, 1073758208
L_p2_kernel_q_21:
    s_add_u32 s14, s12, 1
    s_and_b32 s14, s14, 3
    s_add_u32 s14, s14, 20
    s_bitcmp1_b32 s20, s14
    s_cbranch_scc0 L_p2_kernel_q_22
    v_mov_b32 v92, 1073758208
    v_mov_b32 v93, 1073758208
    v_mov_b32 v94, 1073758208
    v_mov_b32 v95, 1073758208
L_p2_kernel_q_22:
    s_add_u32 s14, s12, 2
    s_and_b32 s14, s14, 3
    s_add_u32 s14, s14, 20
    s_bitcmp1_b32 s20, s14
    s_cbranch_scc0 L_p2_kernel_q_23
    v_mov_b32 v96, 1073758208
    v_mov_b32 v97, 1073758208
    v_mov_b32 v98, 1073758208
    v_mov_b32 v99, 1073758208
L_p2_kernel_q_23:
    s_add_u32 s14, s12, 3
    s_and_b32 s14, s14, 3
    s_add_u32 s14, s14, 20
    s_bitcmp1_b32 s20, s14
    s_cbranch_scc0 L_p2_kernel_q_24
    v_mov_b32 v100, 1073758208
    v_mov_b32 v101, 1073758208
    v_mov_b32 v102, 1073758208
    v_mov_b32 v103, 1073758208
L_p2_kernel_q_24:
L_p2_kernel_nof32a_20:
    v_pk_add_u16 v88, v88, v92
    v_pk_add_u16 v96, v96, v100
    v_pk_add_u16 v89, v89, v93
    v_pk_add_u16 v97, v97, v101
    v_pk_add_u16 v90, v90, v94
    v_pk_add_u16 v98, v98, v102
    v_pk_add_u16 v91, v91, v95
    v_pk_add_u16 v99, v99, v103
    v_add_u32_sdwa v24, v88, v96 dst_sel:DWORD dst_unused:UNUSED_PAD src0_sel:WORD_0 src1_sel:WORD_0
    v_add_u32_sdwa v25, v90, v98 dst_sel:DWORD dst_unused:UNUSED_PAD src0_sel:WORD_0 src1_sel:WORD_0
    v_add_u32_sdwa v26, v88, v96 dst_sel:DWORD dst_unused:UNUSED_PAD src0_sel:WORD_1 src1_sel:WORD_1
    v_add_u32_sdwa v27, v90, v98 dst_sel:DWORD dst_unused:UNUSED_PAD src0_sel:WORD_1 src1_sel:WORD_1
    v_add_u32_sdwa v28, v89, v97 dst_sel:DWORD dst_unused:UNUSED_PAD src0_sel:WORD_0 src1_sel:WORD_0
    v_add_u32_sdwa v29, v91, v99 dst_sel:DWORD dst_unused:UNUSED_PAD src0_sel:WORD_0 src1_sel:WORD_0
    v_add_u32_sdwa v30, v89, v97 dst_sel:DWORD dst_unused:UNUSED_PAD src0_sel:WORD_1 src1_sel:WORD_1
    v_add_u32_sdwa v31, v91, v99 dst_sel:DWORD dst_unused:UNUSED_PAD src0_sel:WORD_1 src1_sel:WORD_1
    v_cvt_f32_u32 v24, v24
    v_cvt_f32_u32 v25, v25
    v_cvt_f32_u32 v26, v26
    v_cvt_f32_u32 v27, v27
    v_cvt_f32_u32 v28, v28
    v_cvt_f32_u32 v29, v29
    v_cvt_f32_u32 v30, v30
    v_cvt_f32_u32 v31, v31
    v_pk_fma_f32 v[24:25], v[24:25], s[44:45], s[44:45] op_sel:[0,0,1] op_sel_hi:[1,0,1]
    v_pk_fma_f32 v[26:27], v[26:27], s[44:45], s[44:45] op_sel:[0,0,1] op_sel_hi:[1,0,1]
    v_pk_fma_f32 v[28:29], v[28:29], s[44:45], s[44:45] op_sel:[0,0,1] op_sel_hi:[1,0,1]
    v_pk_fma_f32 v[30:31], v[30:31], s[44:45], s[44:45] op_sel:[0,0,1] op_sel_hi:[1,0,1]
    s_bfe_u32 s14, s20, 262164
    s_cbranch_scc0 L_p2_kernel_nof32b_25
    v_lshlrev_b32 v32, 1, v2
    s_bitcmp1_b32 s20, 20
    s_cbranch_scc0 L_p2_kernel_q_26
    s_lshl_b32 s15, s26, 1
    s_add_u32 s15, s15, 251318272
    buffer_load_dwordx4 v[88:91], v32, s[4:7], s15 offen sc1
    buffer_load_dwordx4 v[92:95], v32, s[4:7], s15 offen offset:16 sc1
    s_waitcnt vmcnt(0)
    v_add_f32 v24, v24, v88
    v_add_f32 v25, v25, v92
    v_add_f32 v26, v26, v89
    v_add_f32 v27, v27, v93
    v_add_f32 v28, v28, v90
    v_add_f32 v29, v29, v94
    v_add_f32 v30, v30, v91
    v_add_f32 v31, v31, v95
L_p2_kernel_q_26:
    s_bitcmp1_b32 s20, 21
    s_cbranch_scc0 L_p2_kernel_q_27
    s_lshl_b32 s15, s26, 1
    s_add_u32 s15, s15, 261558272
    buffer_load_dwordx4 v[88:91], v32, s[4:7], s15 offen sc1
    buffer_load_dwordx4 v[92:95], v32, s[4:7], s15 offen offset:16 sc1
    s_waitcnt vmcnt(0)
    v_add_f32 v24, v24, v88
    v_add_f32 v25, v25, v92
    v_add_f32 v26, v26, v89
    v_add_f32 v27, v27, v93
    v_add_f32 v28, v28, v90
    v_add_f32 v29, v29, v94
    v_add_f32 v30, v30, v91
    v_add_f32 v31, v31, v95
L_p2_kernel_q_27:
    s_bitcmp1_b32 s20, 22
    s_cbranch_scc0 L_p2_kernel_q_28
    s_lshl_b32 s15, s26, 1
    s_add_u32 s15, s15, 271798272
    buffer_load_dwordx4 v[88:91], v32, s[4:7], s15 offen sc1
    buffer_load_dwordx4 v[92:95], v32, s[4:7], s15 offen offset:16 sc1
    s_waitcnt vmcnt(0)
    v_add_f32 v24, v24, v88
    v_add_f32 v25, v25, v92
    v_add_f32 v26, v26, v89
    v_add_f32 v27, v27, v93
    v_add_f32 v28, v28, v90
    v_add_f32 v29, v29, v94
    v_add_f32 v30, v30, v91
    v_add_f32 v31, v31, v95
L_p2_kernel_q_28:
    s_bitcmp1_b32 s20, 23
    s_cbranch_scc0 L_p2_kernel_q_29
    s_lshl_b32 s15, s26, 1
    s_add_u32 s15, s15, 282038272
    buffer_load_dwordx4 v[88:91], v32, s[4:7], s15 offen sc1
    buffer_load_dwordx4 v[92:95], v32, s[4:7], s15 offen offset:16 sc1
    s_waitcnt vmcnt(0)
    v_add_f32 v24, v24, v88
    v_add_f32 v25, v25, v92
    v_add_f32 v26, v26, v89
    v_add_f32 v27, v27, v93
    v_add_f32 v28, v28, v90
    v_add_f32 v29, v29, v94
    v_add_f32 v30, v30, v91
    v_add_f32 v31, v31, v95
L_p2_kernel_q_29:
L_p2_kernel_nof32b_25:
    v_pk_mul_f32 v[88:89], v[24:25], s[84:85] op_sel:[0,0] op_sel_hi:[1,0]
    v_pk_mul_f32 v[90:91], v[24:25], s[84:85] op_sel:[0,1] op_sel_hi:[1,1]
    v_pk_mul_f32 v[92:93], v[24:25], s[86:87] op_sel:[0,0] op_sel_hi:[1,0]
    v_pk_mul_f32 v[94:95], v[24:25], s[86:87] op_sel:[0,1] op_sel_hi:[1,1]
    v_pk_fma_f32 v[88:89], v[26:27], s[88:89], v[88:89] op_sel:[0,0,0] op_sel_hi:[1,0,1]
    v_pk_fma_f32 v[90:91], v[26:27], s[88:89], v[90:91] op_sel:[0,1,0] op_sel_hi:[1,1,1]
    v_pk_fma_f32 v[92:93], v[26:27], s[90:91], v[92:93] op_sel:[0,0,0] op_sel_hi:[1,0,1]
    v_pk_fma_f32 v[94:95], v[26:27], s[90:91], v[94:95] op_sel:[0,1,0] op_sel_hi:[1,1,1]
    v_pk_fma_f32 v[88:89], v[28:29], s[92:93], v[88:89] op_sel:[0,0,0] op_sel_hi:[1,0,1]
    v_pk_fma_f32 v[90:91], v[28:29], s[92:93], v[90:91] op_sel:[0,1,0] op_sel_hi:[1,1,1]
    v_pk_fma_f32 v[92:93], v[28:29], s[94:95], v[92:93] op_sel:[0,0,0] op_sel_hi:[1,0,1]
    v_pk_fma_f32 v[94:95], v[28:29], s[94:95], v[94:95] op_sel:[0,1,0] op_sel_hi:[1,1,1]
    v_pk_fma_f32 v[88:89], v[30:31], s[96:97], v[88:89] op_sel:[0,0,0] op_sel_hi:[1,0,1]
    v_pk_fma_f32 v[90:91], v[30:31], s[96:97], v[90:91] op_sel:[0,1,0] op_sel_hi:[1,1,1]
    v_pk_fma_f32 v[92:93], v[30:31], s[98:99], v[92:93] op_sel:[0,0,0] op_sel_hi:[1,0,1]
    v_pk_fma_f32 v[94:95], v[30:31], s[98:99], v[94:95] op_sel:[0,1,0] op_sel_hi:[1,1,1]
    v_pk_mul_f32 v[88:89], v[88:89], v[112:113]
    v_pk_mul_f32 v[90:91], v[90:91], v[114:115]
    v_pk_mul_f32 v[92:93], v[92:93], v[116:117]
    v_pk_mul_f32 v[94:95], v[94:95], v[118:119]
    v_pk_mul_f32 v[24:25], v[88:89], s[28:29] op_sel:[0,0] op_sel_hi:[1,0]
    v_pk_mul_f32 v[26:27], v[88:89], s[28:29] op_sel:[0,1] op_sel_hi:[1,1]
    v_pk_mul_f32 v[28:29], v[88:89], s[30:31] op_sel:[0,0] op_sel_hi:[1,0]
    v_pk_mul_f32 v[30:31], v[88:89], s[30:31] op_sel:[0,1] op_sel_hi:[1,1]
    v_pk_fma_f32 v[24:25], v[90:91], s[32:33], v[24:25] op_sel:[0,0,0] op_sel_hi:[1,0,1]
    v_pk_fma_f32 v[26:27], v[90:91], s[32:33], v[26:27] op_sel:[0,1,0] op_sel_hi:[1,1,1]
    v_pk_fma_f32 v[28:29], v[90:91], s[34:35], v[28:29] op_sel:[0,0,0] op_sel_hi:[1,0,1]
    v_pk_fma_f32 v[30:31], v[90:91], s[34:35], v[30:31] op_sel:[0,1,0] op_sel_hi:[1,1,1]
    v_pk_fma_f32 v[24:25], v[92:93], s[36:37], v[24:25] op_sel:[0,0,0] op_sel_hi:[1,0,1]
    v_pk_fma_f32 v[26:27], v[92:93], s[36:37], v[26:27] op_sel:[0,1,0] op_sel_hi:[1,1,1]
    v_pk_fma_f32 v[28:29], v[92:93], s[38:39], v[28:29] op_sel:[0,0,0] op_sel_hi:[1,0,1]
    v_pk_fma_f32 v[30:31], v[92:93], s[38:39], v[30:31] op_sel:[0,1,0] op_sel_hi:[1,1,1]
    v_pk_fma_f32 v[24:25], v[94:95], s[40:41], v[24:25] op_sel:[0,0,0] op_sel_hi:[1,0,1]
    v_pk_fma_f32 v[26:27], v[94:95], s[40:41], v[26:27] op_sel:[0,1,0] op_sel_hi:[1,1,1]
    v_pk_fma_f32 v[28:29], v[94:95], s[42:43], v[28:29] op_sel:[0,0,0] op_sel_hi:[1,0,1]
    v_pk_fma_f32 v[30:31], v[94:95], s[42:43], v[30:31] op_sel:[0,1,0] op_sel_hi:[1,1,1]
    v_lshlrev_b32 v88, 16, v68
    v_and_b32 v90, 0xffff0000, v68
    v_lshlrev_b32 v92, 16, v69
    v_and_b32 v94, 0xffff0000, v69
    v_lshlrev_b32 v89, 16, v70
    v_and_b32 v91, 0xffff0000, v70
    v_lshlrev_b32 v93, 16, v71
    v_and_b32 v95, 0xffff0000, v71
    v_pk_fma_f32 v[88:89], v[24:25], v[120:121], v[88:89]
    v_pk_fma_f32 v[90:91], v[26:27], v[122:123], v[90:91]
    v_pk_fma_f32 v[92:93], v[28:29], v[124:125], v[92:93]
    v_pk_fma_f32 v[94:95], v[30:31], v[126:127], v[94:95]
    v_cvt_pk_bf16_f32 v96, v88, v90
    v_cvt_pk_bf16_f32 v97, v92, v94
    v_cvt_pk_bf16_f32 v98, v89, v91
    v_cvt_pk_bf16_f32 v99, v93, v95
    buffer_store_dwordx4 v[96:99], v2, s[16:19], s26 offen
L_p2_f1:
    s_bitset0_b32 s51, s49
    s_cmp_eq_u32 s51, 0
    s_cbranch_scc1 L_p2_done
    s_ff1_i32_b32 s49, s51
    s_mul_i32 s14, s3, 20000
    s_mul_i32 s15, s49, 4992
    s_add_u32 s14, s14, s15
    s_add_u32 s15, s14, 4096
    v_min_u32 v61, 231, v0
    v_lshl_add_u32 v60, v0, 2, s14
    v_lshl_add_u32 v61, v61, 2, s15
    global_load_dword v60, v60, s[100:101] nt
    global_load_dword v61, v61, s[100:101] nt
    s_waitcnt vmcnt(0)
    v_lshlrev_b32 v30, 16, v60
    v_and_b32 v31, 0xffff0000, v60
    v_lshlrev_b32 v36, 16, v53
    v_and_b32 v37, 0xffff0000, v53
    v_lshlrev_b32 v38, 16, v54
    v_and_b32 v39, 0xffff0000, v54
    v_lshlrev_b32 v40, 16, v56
    v_and_b32 v41, 0xffff0000, v56
    v_lshlrev_b32 v42, 16, v57
    v_and_b32 v43, 0xffff0000, v57
    v_pk_add_f32 v[14:15], v[30:31], v[36:37] op_sel:[0,0] op_sel_hi:[1,0] neg_lo:[0,1] neg_hi:[0,1]
    v_pk_add_f32 v[16:17], v[30:31], v[36:37] op_sel:[0,1] op_sel_hi:[1,1] neg_lo:[0,1] neg_hi:[0,1]
    v_pk_add_f32 v[18:19], v[30:31], v[38:39] op_sel:[0,0] op_sel_hi:[1,0] neg_lo:[0,1] neg_hi:[0,1]
    v_pk_add_f32 v[20:21], v[30:31], v[38:39] op_sel:[0,1] op_sel_hi:[1,1] neg_lo:[0,1] neg_hi:[0,1]
    v_pk_add_f32 v[22:23], v[30:31], v[40:41] op_sel:[0,0] op_sel_hi:[1,0] neg_lo:[0,1] neg_hi:[0,1]
    v_pk_add_f32 v[24:25], v[30:31], v[40:41] op_sel:[0,1] op_sel_hi:[1,1] neg_lo:[0,1] neg_hi:[0,1]
    v_pk_add_f32 v[26:27], v[30:31], v[42:43] op_sel:[0,0] op_sel_hi:[1,0] neg_lo:[0,1] neg_hi:[0,1]
    v_pk_add_f32 v[28:29], v[30:31], v[42:43] op_sel:[0,1] op_sel_hi:[1,1] neg_lo:[0,1] neg_hi:[0,1]
    v_cvt_pk_bf16_f32 v32, v14, v15
    v_lshlrev_b32 v14, 16, v32
    v_and_b32 v15, 0xffff0000, v32
    v_cvt_pk_bf16_f32 v32, v16, v17
    v_lshlrev_b32 v16, 16, v32
    v_and_b32 v17, 0xffff0000, v32
    v_cvt_pk_bf16_f32 v32, v18, v19
    v_lshlrev_b32 v18, 16, v32
    v_and_b32 v19, 0xffff0000, v32
    v_cvt_pk_bf16_f32 v32, v20, v21
    v_lshlrev_b32 v20, 16, v32
    v_and_b32 v21, 0xffff0000, v32
    v_cvt_pk_bf16_f32 v32, v22, v23
    v_lshlrev_b32 v22, 16, v32
    v_and_b32 v23, 0xffff0000, v32
    v_cvt_pk_bf16_f32 v32, v24, v25
    v_lshlrev_b32 v24, 16, v32
    v_and_b32 v25, 0xffff0000, v32
    v_cvt_pk_bf16_f32 v32, v26, v27
    v_lshlrev_b32 v26, 16, v32
    v_and_b32 v27, 0xffff0000, v32
    v_cvt_pk_bf16_f32 v32, v28, v29
    v_lshlrev_b32 v28, 16, v32
    v_and_b32 v29, 0xffff0000, v32
    v_pk_mul_f32 v[14:15], v[14:15], v[14:15]
    v_pk_mul_f32 v[16:17], v[16:17], v[16:17]
    v_pk_mul_f32 v[18:19], v[18:19], v[18:19]
    v_pk_mul_f32 v[20:21], v[20:21], v[20:21]
    v_pk_mul_f32 v[22:23], v[22:23], v[22:23]
    v_pk_mul_f32 v[24:25], v[24:25], v[24:25]
    v_pk_mul_f32 v[26:27], v[26:27], v[26:27]
    v_pk_mul_f32 v[28:29], v[28:29], v[28:29]
    v_cvt_pk_bf16_f32 v32, v14, v15
    v_lshlrev_b32 v14, 16, v32
    v_and_b32 v15, 0xffff0000, v32
    v_cvt_pk_bf16_f32 v32, v16, v17
    v_lshlrev_b32 v16, 16, v32
    v_and_b32 v17, 0xffff0000, v32
    v_cvt_pk_bf16_f32 v32, v18, v19
    v_lshlrev_b32 v18, 16, v32
    v_and_b32 v19, 0xffff0000, v32
    v_cvt_pk_bf16_f32 v32, v20, v21
    v_lshlrev_b32 v20, 16, v32
    v_and_b32 v21, 0xffff0000, v32
    v_cvt_pk_bf16_f32 v32, v22, v23
    v_lshlrev_b32 v22, 16, v32
    v_and_b32 v23, 0xffff0000, v32
    v_cvt_pk_bf16_f32 v32, v24, v25
    v_lshlrev_b32 v24, 16, v32
    v_and_b32 v25, 0xffff0000, v32
    v_cvt_pk_bf16_f32 v32, v26, v27
    v_lshlrev_b32 v26, 16, v32
    v_and_b32 v27, 0xffff0000, v32
    v_cvt_pk_bf16_f32 v32, v28, v29
    v_lshlrev_b32 v28, 16, v32
    v_and_b32 v29, 0xffff0000, v32
    v_mov_b32 v30, 1092616192
    v_mov_b32 v31, 0x3fb8aa3b
    v_pk_mul_f32 v[14:15], v[14:15], v[30:31] op_sel:[0,0] op_sel_hi:[1,0]
    v_pk_mul_f32 v[16:17], v[16:17], v[30:31] op_sel:[0,0] op_sel_hi:[1,0]
    v_pk_mul_f32 v[18:19], v[18:19], v[30:31] op_sel:[0,0] op_sel_hi:[1,0]
    v_pk_mul_f32 v[20:21], v[20:21], v[30:31] op_sel:[0,0] op_sel_hi:[1,0]
    v_pk_mul_f32 v[22:23], v[22:23], v[30:31] op_sel:[0,0] op_sel_hi:[1,0]
    v_pk_mul_f32 v[24:25], v[24:25], v[30:31] op_sel:[0,0] op_sel_hi:[1,0]
    v_pk_mul_f32 v[26:27], v[26:27], v[30:31] op_sel:[0,0] op_sel_hi:[1,0]
    v_pk_mul_f32 v[28:29], v[28:29], v[30:31] op_sel:[0,0] op_sel_hi:[1,0]
    v_cvt_pk_bf16_f32 v32, v14, v15
    v_lshlrev_b32 v14, 16, v32
    v_and_b32 v15, 0xffff0000, v32
    v_cvt_pk_bf16_f32 v32, v16, v17
    v_lshlrev_b32 v16, 16, v32
    v_and_b32 v17, 0xffff0000, v32
    v_cvt_pk_bf16_f32 v32, v18, v19
    v_lshlrev_b32 v18, 16, v32
    v_and_b32 v19, 0xffff0000, v32
    v_cvt_pk_bf16_f32 v32, v20, v21
    v_lshlrev_b32 v20, 16, v32
    v_and_b32 v21, 0xffff0000, v32
    v_cvt_pk_bf16_f32 v32, v22, v23
    v_lshlrev_b32 v22, 16, v32
    v_and_b32 v23, 0xffff0000, v32
    v_cvt_pk_bf16_f32 v32, v24, v25
    v_lshlrev_b32 v24, 16, v32
    v_and_b32 v25, 0xffff0000, v32
    v_cvt_pk_bf16_f32 v32, v26, v27
    v_lshlrev_b32 v26, 16, v32
    v_and_b32 v27, 0xffff0000, v32
    v_cvt_pk_bf16_f32 v32, v28, v29
    v_lshlrev_b32 v28, 16, v32
    v_and_b32 v29, 0xffff0000, v32
    v_pk_mul_f32 v[14:15], v[14:15], v[30:31] op_sel:[0,1] op_sel_hi:[1,1]
    v_pk_mul_f32 v[16:17], v[16:17], v[30:31] op_sel:[0,1] op_sel_hi:[1,1]
    v_pk_mul_f32 v[18:19], v[18:19], v[30:31] op_sel:[0,1] op_sel_hi:[1,1]
    v_pk_mul_f32 v[20:21], v[20:21], v[30:31] op_sel:[0,1] op_sel_hi:[1,1]
    v_pk_mul_f32 v[22:23], v[22:23], v[30:31] op_sel:[0,1] op_sel_hi:[1,1]
    v_pk_mul_f32 v[24:25], v[24:25], v[30:31] op_sel:[0,1] op_sel_hi:[1,1]
    v_pk_mul_f32 v[26:27], v[26:27], v[30:31] op_sel:[0,1] op_sel_hi:[1,1]
    v_pk_mul_f32 v[28:29], v[28:29], v[30:31] op_sel:[0,1] op_sel_hi:[1,1]
    v_exp_f32 v14, -v14
    v_exp_f32 v15, -v15
    v_exp_f32 v16, -v16
    v_exp_f32 v17, -v17
    v_exp_f32 v18, -v18
    v_exp_f32 v19, -v19
    v_exp_f32 v20, -v20
    v_exp_f32 v21, -v21
    v_exp_f32 v22, -v22
    v_exp_f32 v23, -v23
    v_exp_f32 v24, -v24
    v_exp_f32 v25, -v25
    v_exp_f32 v26, -v26
    v_exp_f32 v27, -v27
    v_exp_f32 v28, -v28
    v_exp_f32 v29, -v29
    v_cvt_pk_bf16_f32 v14, v14, v16
    v_cvt_pk_bf16_f32 v15, v15, v17
    v_cvt_pk_bf16_f32 v18, v18, v20
    v_cvt_pk_bf16_f32 v19, v19, v21
    v_cvt_pk_bf16_f32 v22, v22, v24
    v_cvt_pk_bf16_f32 v23, v23, v25
    v_cvt_pk_bf16_f32 v26, v26, v28
    v_cvt_pk_bf16_f32 v27, v27, v29
    v_dot2_f32_bf16 v72, v14, s68, 0
    v_dot2_f32_bf16 v73, v15, s68, 0
    v_dot2_f32_bf16 v74, v14, s69, 0
    v_dot2_f32_bf16 v75, v15, s69, 0
    v_dot2_f32_bf16 v76, v14, s70, 0
    v_dot2_f32_bf16 v77, v15, s70, 0
    v_dot2_f32_bf16 v78, v14, s71, 0
    v_dot2_f32_bf16 v79, v15, s71, 0
    v_dot2_f32_bf16 v80, v14, s52, 0
    v_dot2_f32_bf16 v81, v15, s52, 0
    v_dot2_f32_bf16 v82, v14, s53, 0
    v_dot2_f32_bf16 v83, v15, s53, 0
    v_dot2_f32_bf16 v84, v14, s54, 0
    v_dot2_f32_bf16 v85, v15, s54, 0
    v_dot2_f32_bf16 v86, v14, s55, 0
    v_dot2_f32_bf16 v87, v15, s55, 0
    v_dot2_f32_bf16 v72, v18, s72, v72
    v_dot2_f32_bf16 v73, v19, s72, v73
    v_dot2_f32_bf16 v74, v18, s73, v74
    v_dot2_f32_bf16 v75, v19, s73, v75
    v_dot2_f32_bf16 v76, v18, s74, v76
    v_dot2_f32_bf16 v77, v19, s74, v77
    v_dot2_f32_bf16 v78, v18, s75, v78
    v_dot2_f32_bf16 v79, v19, s75, v79
    v_dot2_f32_bf16 v80, v18, s56, v80
    v_dot2_f32_bf16 v81, v19, s56, v81
    v_dot2_f32_bf16 v82, v18, s57, v82
    v_dot2_f32_bf16 v83, v19, s57, v83
    v_dot2_f32_bf16 v84, v18, s58, v84
    v_dot2_f32_bf16 v85, v19, s58, v85
    v_dot2_f32_bf16 v86, v18, s59, v86
    v_dot2_f32_bf16 v87, v19, s59, v87
    v_dot2_f32_bf16 v72, v22, s76, v72
    v_dot2_f32_bf16 v73, v23, s76, v73
    v_dot2_f32_bf16 v74, v22, s77, v74
    v_dot2_f32_bf16 v75, v23, s77, v75
    v_dot2_f32_bf16 v76, v22, s78, v76
    v_dot2_f32_bf16 v77, v23, s78, v77
    v_dot2_f32_bf16 v78, v22, s79, v78
    v_dot2_f32_bf16 v79, v23, s79, v79
    v_dot2_f32_bf16 v80, v22, s60, v80
    v_dot2_f32_bf16 v81, v23, s60, v81
    v_dot2_f32_bf16 v82, v22, s61, v82
    v_dot2_f32_bf16 v83, v23, s61, v83
    v_dot2_f32_bf16 v84, v22, s62, v84
    v_dot2_f32_bf16 v85, v23, s62, v85
    v_dot2_f32_bf16 v86, v22, s63, v86
    v_dot2_f32_bf16 v87, v23, s63, v87
    v_dot2_f32_bf16 v72, v26, s80, v72
    v_dot2_f32_bf16 v73, v27, s80, v73
    v_dot2_f32_bf16 v74, v26, s81, v74
    v_dot2_f32_bf16 v75, v27, s81, v75
    v_dot2_f32_bf16 v76, v26, s82, v76
    v_dot2_f32_bf16 v77, v27, s82, v77
    v_dot2_f32_bf16 v78, v26, s83, v78
    v_dot2_f32_bf16 v79, v27, s83, v79
    v_dot2_f32_bf16 v80, v26, s64, v80
    v_dot2_f32_bf16 v81, v27, s64, v81
    v_dot2_f32_bf16 v82, v26, s65, v82
    v_dot2_f32_bf16 v83, v27, s65, v83
    v_dot2_f32_bf16 v84, v26, s66, v84
    v_dot2_f32_bf16 v85, v27, s66, v85
    v_dot2_f32_bf16 v86, v26, s67, v86
    v_dot2_f32_bf16 v87, v27, s67, v87
    s_cmp_ge_u32 s13, 4
    s_cbranch_scc1 L_p2_kernel_g1_30
    v_lshlrev_b32 v30, 16, v61
    v_and_b32 v31, 0xffff0000, v61
    v_pk_add_f32 v[14:15], v[30:31], v[36:37] op_sel:[0,0] op_sel_hi:[1,0] neg_lo:[0,1] neg_hi:[0,1]
    v_pk_add_f32 v[16:17], v[30:31], v[36:37] op_sel:[0,1] op_sel_hi:[1,1] neg_lo:[0,1] neg_hi:[0,1]
    v_pk_add_f32 v[18:19], v[30:31], v[38:39] op_sel:[0,0] op_sel_hi:[1,0] neg_lo:[0,1] neg_hi:[0,1]
    v_pk_add_f32 v[20:21], v[30:31], v[38:39] op_sel:[0,1] op_sel_hi:[1,1] neg_lo:[0,1] neg_hi:[0,1]
    v_pk_add_f32 v[22:23], v[30:31], v[40:41] op_sel:[0,0] op_sel_hi:[1,0] neg_lo:[0,1] neg_hi:[0,1]
    v_pk_add_f32 v[24:25], v[30:31], v[40:41] op_sel:[0,1] op_sel_hi:[1,1] neg_lo:[0,1] neg_hi:[0,1]
    v_pk_add_f32 v[26:27], v[30:31], v[42:43] op_sel:[0,0] op_sel_hi:[1,0] neg_lo:[0,1] neg_hi:[0,1]
    v_pk_add_f32 v[28:29], v[30:31], v[42:43] op_sel:[0,1] op_sel_hi:[1,1] neg_lo:[0,1] neg_hi:[0,1]
    v_cvt_pk_bf16_f32 v32, v14, v15
    v_lshlrev_b32 v14, 16, v32
    v_and_b32 v15, 0xffff0000, v32
    v_cvt_pk_bf16_f32 v32, v16, v17
    v_lshlrev_b32 v16, 16, v32
    v_and_b32 v17, 0xffff0000, v32
    v_cvt_pk_bf16_f32 v32, v18, v19
    v_lshlrev_b32 v18, 16, v32
    v_and_b32 v19, 0xffff0000, v32
    v_cvt_pk_bf16_f32 v32, v20, v21
    v_lshlrev_b32 v20, 16, v32
    v_and_b32 v21, 0xffff0000, v32
    v_cvt_pk_bf16_f32 v32, v22, v23
    v_lshlrev_b32 v22, 16, v32
    v_and_b32 v23, 0xffff0000, v32
    v_cvt_pk_bf16_f32 v32, v24, v25
    v_lshlrev_b32 v24, 16, v32
    v_and_b32 v25, 0xffff0000, v32
    v_cvt_pk_bf16_f32 v32, v26, v27
    v_lshlrev_b32 v26, 16, v32
    v_and_b32 v27, 0xffff0000, v32
    v_cvt_pk_bf16_f32 v32, v28, v29
    v_lshlrev_b32 v28, 16, v32
    v_and_b32 v29, 0xffff0000, v32
    v_pk_mul_f32 v[14:15], v[14:15], v[14:15]
    v_pk_mul_f32 v[16:17], v[16:17], v[16:17]
    v_pk_mul_f32 v[18:19], v[18:19], v[18:19]
    v_pk_mul_f32 v[20:21], v[20:21], v[20:21]
    v_pk_mul_f32 v[22:23], v[22:23], v[22:23]
    v_pk_mul_f32 v[24:25], v[24:25], v[24:25]
    v_pk_mul_f32 v[26:27], v[26:27], v[26:27]
    v_pk_mul_f32 v[28:29], v[28:29], v[28:29]
    v_cvt_pk_bf16_f32 v32, v14, v15
    v_lshlrev_b32 v14, 16, v32
    v_and_b32 v15, 0xffff0000, v32
    v_cvt_pk_bf16_f32 v32, v16, v17
    v_lshlrev_b32 v16, 16, v32
    v_and_b32 v17, 0xffff0000, v32
    v_cvt_pk_bf16_f32 v32, v18, v19
    v_lshlrev_b32 v18, 16, v32
    v_and_b32 v19, 0xffff0000, v32
    v_cvt_pk_bf16_f32 v32, v20, v21
    v_lshlrev_b32 v20, 16, v32
    v_and_b32 v21, 0xffff0000, v32
    v_cvt_pk_bf16_f32 v32, v22, v23
    v_lshlrev_b32 v22, 16, v32
    v_and_b32 v23, 0xffff0000, v32
    v_cvt_pk_bf16_f32 v32, v24, v25
    v_lshlrev_b32 v24, 16, v32
    v_and_b32 v25, 0xffff0000, v32
    v_cvt_pk_bf16_f32 v32, v26, v27
    v_lshlrev_b32 v26, 16, v32
    v_and_b32 v27, 0xffff0000, v32
    v_cvt_pk_bf16_f32 v32, v28, v29
    v_lshlrev_b32 v28, 16, v32
    v_and_b32 v29, 0xffff0000, v32
    v_mov_b32 v30, 1092616192
    v_mov_b32 v31, 0x3fb8aa3b
    v_pk_mul_f32 v[14:15], v[14:15], v[30:31] op_sel:[0,0] op_sel_hi:[1,0]
    v_pk_mul_f32 v[16:17], v[16:17], v[30:31] op_sel:[0,0] op_sel_hi:[1,0]
    v_pk_mul_f32 v[18:19], v[18:19], v[30:31] op_sel:[0,0] op_sel_hi:[1,0]
    v_pk_mul_f32 v[20:21], v[20:21], v[30:31] op_sel:[0,0] op_sel_hi:[1,0]
    v_pk_mul_f32 v[22:23], v[22:23], v[30:31] op_sel:[0,0] op_sel_hi:[1,0]
    v_pk_mul_f32 v[24:25], v[24:25], v[30:31] op_sel:[0,0] op_sel_hi:[1,0]
    v_pk_mul_f32 v[26:27], v[26:27], v[30:31] op_sel:[0,0] op_sel_hi:[1,0]
    v_pk_mul_f32 v[28:29], v[28:29], v[30:31] op_sel:[0,0] op_sel_hi:[1,0]
    v_cvt_pk_bf16_f32 v32, v14, v15
    v_lshlrev_b32 v14, 16, v32
    v_and_b32 v15, 0xffff0000, v32
    v_cvt_pk_bf16_f32 v32, v16, v17
    v_lshlrev_b32 v16, 16, v32
    v_and_b32 v17, 0xffff0000, v32
    v_cvt_pk_bf16_f32 v32, v18, v19
    v_lshlrev_b32 v18, 16, v32
    v_and_b32 v19, 0xffff0000, v32
    v_cvt_pk_bf16_f32 v32, v20, v21
    v_lshlrev_b32 v20, 16, v32
    v_and_b32 v21, 0xffff0000, v32
    v_cvt_pk_bf16_f32 v32, v22, v23
    v_lshlrev_b32 v22, 16, v32
    v_and_b32 v23, 0xffff0000, v32
    v_cvt_pk_bf16_f32 v32, v24, v25
    v_lshlrev_b32 v24, 16, v32
    v_and_b32 v25, 0xffff0000, v32
    v_cvt_pk_bf16_f32 v32, v26, v27
    v_lshlrev_b32 v26, 16, v32
    v_and_b32 v27, 0xffff0000, v32
    v_cvt_pk_bf16_f32 v32, v28, v29
    v_lshlrev_b32 v28, 16, v32
    v_and_b32 v29, 0xffff0000, v32
    v_pk_mul_f32 v[14:15], v[14:15], v[30:31] op_sel:[0,1] op_sel_hi:[1,1]
    v_pk_mul_f32 v[16:17], v[16:17], v[30:31] op_sel:[0,1] op_sel_hi:[1,1]
    v_pk_mul_f32 v[18:19], v[18:19], v[30:31] op_sel:[0,1] op_sel_hi:[1,1]
    v_pk_mul_f32 v[20:21], v[20:21], v[30:31] op_sel:[0,1] op_sel_hi:[1,1]
    v_pk_mul_f32 v[22:23], v[22:23], v[30:31] op_sel:[0,1] op_sel_hi:[1,1]
    v_pk_mul_f32 v[24:25], v[24:25], v[30:31] op_sel:[0,1] op_sel_hi:[1,1]
    v_pk_mul_f32 v[26:27], v[26:27], v[30:31] op_sel:[0,1] op_sel_hi:[1,1]
    v_pk_mul_f32 v[28:29], v[28:29], v[30:31] op_sel:[0,1] op_sel_hi:[1,1]
    v_exp_f32 v14, -v14
    v_exp_f32 v15, -v15
    v_exp_f32 v16, -v16
    v_exp_f32 v17, -v17
    v_exp_f32 v18, -v18
    v_exp_f32 v19, -v19
    v_exp_f32 v20, -v20
    v_exp_f32 v21, -v21
    v_exp_f32 v22, -v22
    v_exp_f32 v23, -v23
    v_exp_f32 v24, -v24
    v_exp_f32 v25, -v25
    v_exp_f32 v26, -v26
    v_exp_f32 v27, -v27
    v_exp_f32 v28, -v28
    v_exp_f32 v29, -v29
    v_cvt_pk_bf16_f32 v14, v14, v16
    v_cvt_pk_bf16_f32 v15, v15, v17
    v_cvt_pk_bf16_f32 v18, v18, v20
    v_cvt_pk_bf16_f32 v19, v19, v21
    v_cvt_pk_bf16_f32 v22, v22, v24
    v_cvt_pk_bf16_f32 v23, v23, v25
    v_cvt_pk_bf16_f32 v26, v26, v28
    v_cvt_pk_bf16_f32 v27, v27, v29
    v_dot2_f32_bf16 v112, v14, s68, 0
    v_dot2_f32_bf16 v113, v15, s68, 0
    v_dot2_f32_bf16 v114, v14, s69, 0
    v_dot2_f32_bf16 v115, v15, s69, 0
    v_dot2_f32_bf16 v116, v14, s70, 0
    v_dot2_f32_bf16 v117, v15, s70, 0
    v_dot2_f32_bf16 v118, v14, s71, 0
    v_dot2_f32_bf16 v119, v15, s71, 0
    v_dot2_f32_bf16 v120, v14, s52, 0
    v_dot2_f32_bf16 v121, v15, s52, 0
    v_dot2_f32_bf16 v122, v14, s53, 0
    v_dot2_f32_bf16 v123, v15, s53, 0
    v_dot2_f32_bf16 v124, v14, s54, 0
    v_dot2_f32_bf16 v125, v15, s54, 0
    v_dot2_f32_bf16 v126, v14, s55, 0
    v_dot2_f32_bf16 v127, v15, s55, 0
    v_dot2_f32_bf16 v112, v18, s72, v112
    v_dot2_f32_bf16 v113, v19, s72, v113
    v_dot2_f32_bf16 v114, v18, s73, v114
    v_dot2_f32_bf16 v115, v19, s73, v115
    v_dot2_f32_bf16 v116, v18, s74, v116
    v_dot2_f32_bf16 v117, v19, s74, v117
    v_dot2_f32_bf16 v118, v18, s75, v118
    v_dot2_f32_bf16 v119, v19, s75, v119
    v_dot2_f32_bf16 v120, v18, s56, v120
    v_dot2_f32_bf16 v121, v19, s56, v121
    v_dot2_f32_bf16 v122, v18, s57, v122
    v_dot2_f32_bf16 v123, v19, s57, v123
    v_dot2_f32_bf16 v124, v18, s58, v124
    v_dot2_f32_bf16 v125, v19, s58, v125
    v_dot2_f32_bf16 v126, v18, s59, v126
    v_dot2_f32_bf16 v127, v19, s59, v127
    v_dot2_f32_bf16 v112, v22, s76, v112
    v_dot2_f32_bf16 v113, v23, s76, v113
    v_dot2_f32_bf16 v114, v22, s77, v114
    v_dot2_f32_bf16 v115, v23, s77, v115
    v_dot2_f32_bf16 v116, v22, s78, v116
    v_dot2_f32_bf16 v117, v23, s78, v117
    v_dot2_f32_bf16 v118, v22, s79, v118
    v_dot2_f32_bf16 v119, v23, s79, v119
    v_dot2_f32_bf16 v120, v22, s60, v120
    v_dot2_f32_bf16 v121, v23, s60, v121
    v_dot2_f32_bf16 v122, v22, s61, v122
    v_dot2_f32_bf16 v123, v23, s61, v123
    v_dot2_f32_bf16 v124, v22, s62, v124
    v_dot2_f32_bf16 v125, v23, s62, v125
    v_dot2_f32_bf16 v126, v22, s63, v126
    v_dot2_f32_bf16 v127, v23, s63, v127
    v_dot2_f32_bf16 v112, v26, s80, v112
    v_dot2_f32_bf16 v113, v27, s80, v113
    v_dot2_f32_bf16 v114, v26, s81, v114
    v_dot2_f32_bf16 v115, v27, s81, v115
    v_dot2_f32_bf16 v116, v26, s82, v116
    v_dot2_f32_bf16 v117, v27, s82, v117
    v_dot2_f32_bf16 v118, v26, s83, v118
    v_dot2_f32_bf16 v119, v27, s83, v119
    v_dot2_f32_bf16 v120, v26, s64, v120
    v_dot2_f32_bf16 v121, v27, s64, v121
    v_dot2_f32_bf16 v122, v26, s65, v122
    v_dot2_f32_bf16 v123, v27, s65, v123
    v_dot2_f32_bf16 v124, v26, s66, v124
    v_dot2_f32_bf16 v125, v27, s66, v125
    v_dot2_f32_bf16 v126, v26, s67, v126
    v_dot2_f32_bf16 v127, v27, s67, v127
L_p2_kernel_g1_30:
    s_cmp_eq_u32 s49, 3
    s_cselect_b32 s15, 8, 0
    s_add_u32 s15, s15, 224
    v_add_u32 v2, 16384, v1
    v_cmp_gt_u32 vcc, s15, v0
    s_mul_i32 s14, s3, 80000
    s_mul_i32 s26, s49, 19968
    s_add_u32 s26, s26, s14
    v_cndmask_b32 v2, 0.5, v2, vcc
    s_mov_b32 s10, 5120000
    buffer_load_dwordx4 v[64:67], v1, s[8:11], s26 offen
    buffer_load_dwordx4 v[68:71], v2, s[8:11], s26 offen
    s_branch L_p2_fin
L_p2_done:
    s_branch L_p2_end
L_p2_slow:
    s_barrier
    v_mov_b32 v8, 0
    v_mov_b32 v9, 0
    v_mov_b32 v10, 0
    v_mov_b32 v11, 0
    v_mov_b32 v12, v1
    ds_write_b128 v12, v[8:11]
    v_add_u32 v12, 16384, v12
    ds_write_b128 v12, v[8:11]
    v_add_u32 v12, 16384, v12
    ds_write_b128 v12, v[8:11]
    v_add_u32 v12, 16384, v12
    ds_write_b128 v12, v[8:11]
    v_add_u32 v12, 16384, v12
    ds_write_b128 v12, v[8:11]
    v_add_u32 v12, 16384, v12
    ds_write_b128 v12, v[8:11]
    v_add_u32 v12, 16384, v12
    ds_write_b128 v12, v[8:11]
    v_add_u32 v12, 16384, v12
    ds_write_b128 v12, v[8:11]
    v_add_u32 v12, 16384, v12
    ds_write_b128 v12, v[8:11]
    v_add_u32 v12, 16384, v12
    ds_write_b128 v12, v[8:11]
    v_add_u32 v12, 16384, v12
    v_mul_u32_u24 v13, 8320, v0
    v_mov_b32 v29, 0x7fc00000
    v_add_u32 v28, 32, v13
    v_lshlrev_b32 v14, 12, v0
    v_add_u32 v14, 0, v14
    s_mul_i32 s25, s12, 65
    s_add_u32 s25, s25, s3
    s_lshl_b32 s25, s25, 5
    s_add_u32 s25, s25, 222298112
    s_lshl_b32 s50, s50, 1
    s_mul_i32 s22, s12, 1280000
    s_mov_b32 s24, 0
    s_waitcnt lgkmcnt(0)
    s_barrier
L_p2_sstep:
    buffer_load_ushort v15, v13, s[4:7], s25 offen
    buffer_load_ushort v16, v28, s[4:7], s25 offen
    s_waitcnt vmcnt(0)
L_p2_srec:
    v_cmp_lt_u32 vcc, v15, v16
    s_nop 1
    s_and_b64 exec, exec, vcc
    s_cbranch_execz L_p2_sdone
    v_mul_u32_u24 v17, 43691, v15
    v_lshrrev_b32 v17, 17, v17
    v_mad_i32_i24 v18, v17, -3, v15
    v_lshrrev_b32 v19, 8, v17
    v_lshl_add_u32 v19, v19, 22, v14
    v_and_b32 v17, 255, v17
    v_lshl_add_u32 v17, v17, 4, v19
    v_lshl_add_u32 v19, v18, 2, v17
    buffer_load_dword v20, v19, s[4:7], 0 offen
    buffer_load_dword v21, v17, s[4:7], 0 offen offset:12
    v_add_u32 v15, 1, v15
    v_mad_u32_u24 v18, v18, 10, 2
    s_waitcnt vmcnt(0)
    v_and_b32 v19, 0x3fff, v20
    v_lshlrev_b32 v19, 3, v19
    buffer_load_dwordx2 v[22:23], v19, s[8:11], s22 offen
    v_mad_u32_u16 v20, v20, 16, s50 op_sel:[1,0,0,0]
    v_bfe_i32 v21, v21, v18, 10
    v_cmp_eq_i32 vcc, -512, v21
    v_cvt_f32_i32 v21, v21
    v_mul_f32 v21, 989872160, v21
    v_cndmask_b32 v21, v21, v29, vcc
    s_waitcnt vmcnt(0)
    v_lshlrev_b32 v24, 16, v22
    v_and_b32 v25, 0xffff0000, v22
    v_lshlrev_b32 v26, 16, v23
    v_and_b32 v27, 0xffff0000, v23
    v_mul_f32 v24, v21, v24
    v_mul_f32 v25, v21, v25
    v_mul_f32 v26, v21, v26
    v_mul_f32 v27, v21, v27
    ds_add_f32 v20, v24
    ds_add_f32 v20, v25 offset:4
    ds_add_f32 v20, v26 offset:8
    ds_add_f32 v20, v27 offset:12
    s_branch L_p2_srec
L_p2_sdone:
    s_mov_b64 exec, -1
    s_add_u32 s25, s25, 2
    s_add_u32 s22, s22, 80000
    s_add_u32 s24, s24, 1
    s_cmp_lt_u32 s24, 16
    s_cbranch_scc1 L_p2_sstep
    s_waitcnt lgkmcnt(0)
    s_barrier
    s_mul_i32 s14, s12, 10240000
    s_mul_i32 s15, s3, 160000
    s_add_u32 s26, s14, s15
    s_add_u32 s26, s26, 251318272
    v_mov_b32 v12, v1
    s_mov_b32 s24, 0
L_p2_sout:
    v_cmp_gt_u32 vcc, 160000, v12
    ds_read_b128 v[8:11], v12
    s_nop 0
    s_and_b64 exec, exec, vcc
    s_cbranch_execz L_p2_sfin
    s_waitcnt lgkmcnt(0)
    buffer_store_dwordx4 v[8:11], v12, s[4:7], s26 offen sc1
    s_waitcnt vmcnt(0)
    v_add_u32 v12, 16384, v12
    s_branch L_p2_sout
L_p2_sfin:
    s_mov_b64 exec, -1
    s_waitcnt vmcnt(0) lgkmcnt(0)
    s_barrier
    s_branch L_p2_signal
L_p2_end:
    s_endpgm
.section .rodata,"a"
.p2align 6
.amdhsa_kernel p1_kernel
  .amdhsa_next_free_vgpr 128
  .amdhsa_next_free_sgpr 96
  .amdhsa_accum_offset 128
  .amdhsa_group_segment_fixed_size 0
  .amdhsa_kernarg_size 112
  .amdhsa_user_sgpr_count 2
  .amdhsa_user_sgpr_kernarg_segment_ptr 1
  .amdhsa_system_sgpr_workgroup_id_x 1
  .amdhsa_float_denorm_mode_32 0
.end_amdhsa_kernel
.p2align 6
.amdhsa_kernel p2_kernel
  .amdhsa_next_free_vgpr 128
  .amdhsa_next_free_sgpr 102
  .amdhsa_accum_offset 128
  .amdhsa_group_segment_fixed_size 0
  .amdhsa_kernarg_size 112
  .amdhsa_user_sgpr_count 2
  .amdhsa_user_sgpr_kernarg_segment_ptr 1
  .amdhsa_system_sgpr_workgroup_id_x 1
  .amdhsa_float_denorm_mode_32 0
.end_amdhsa_kernel
```

```asm
; @launch kernel=p1_kernel grid=(256,1,1) block=(1024,1,1) lds=163840
; @launch kernel=p2_kernel grid=(256,1,1) block=(1024,1,1) lds=163840
.amdgcn_target "amdgcn-amd-amdhsa--gfx950"
.text
.globl p1_kernel
.p2align 8
.type p1_kernel,@function
p1_kernel:
    s_cmp_ge_u32 s2, 256
    s_cbranch_scc1 L_p1_end
    s_load_dwordx2 s[4:5], s[0:1], 104
    s_load_dwordx2 s[8:9], s[0:1], 8
    s_load_dwordx2 s[12:13], s[0:1], 16
    s_load_dwordx2 s[16:17], s[0:1], 32
    s_load_dwordx2 s[28:29], s[0:1], 0
    s_load_dwordx2 s[6:7], s[0:1], 48
    s_load_dwordx2 s[84:85], s[0:1], 96
    v_cmp_gt_u32 vcc, 256, v0
    s_nop 1
    s_cbranch_vccz L_p1_nopf
    s_getpc_b64 s[72:73]
L_p1_kernel_pc_1:
    s_add_u32 s72, s72, L_p1_nopf-L_p1_kernel_pc_1
    s_addc_u32 s73, s73, 0
    v_lshlrev_b32 v14, 7, v0
    v_min_u32 v14, L_p2_end-L_p1_nopf, v14
    global_load_dword v15, v14, s[72:73]
L_p1_nopf:
    v_lshlrev_b32 v1, 4, v0
    v_lshlrev_b32 v2, 3, v0
    v_lshrrev_b32 v6, 6, v0
    v_and_b32 v3, 1023, v1
    v_mov_b32 v4, 1
    v_mov_b32 v5, 0
    v_readfirstlane_b32 s39, v6
    v_cmp_gt_u32 vcc, 784, v0
    s_and_b32 s51, s2, 7
    s_lshl_b32 s51, s51, 0
    s_bfe_u32 s35, s2, 3
    s_add_u32 s51, s51, s35
    s_and_b32 s35, s2, 248
    s_add_u32 s51, s51, s35
    s_lshr_b32 s35, s39, 4
    s_mul_i32 s36, s35, 4177920
    s_lshl_b32 s33, s51, 14
    s_add_u32 s33, s33, s36
    s_lshr_b32 s34, s33, 1
    s_mul_i32 s48, s51, 3840
    s_cmp_ge_u32 s35, 0
    s_cselect_b32 s48, s48, 0
    s_lshr_b32 s49, s48, 1
    s_mov_b64 s[44:45], vcc
    s_waitcnt lgkmcnt(0)
    s_load_dword s3, s[6:7], 0
    s_mov_b32 s10, 163840000
    s_mov_b32 s11, 0x00020000
    s_mov_b32 s14, 163840000
    s_mov_b32 s15, 0x00020000
    s_mov_b32 s18, 81920000
    s_mov_b32 s19, 0x00020000
    s_mov_b32 s86, 256
    s_mov_b32 s87, 0x00020000
    s_mul_i32 s36, s2, 20000
    s_add_u32 s30, s36, 20000
    s_mov_b32 s31, 0x00020000
    s_add_u32 s35, s36, 16384
    buffer_load_dwordx4 v[48:51], v1, s[28:31], s36 offen
    buffer_load_dwordx4 v[52:55], v1, s[28:31], s35 offen
    s_add_u32 s35, s33, 0
    buffer_load_dwordx4 v[16:19], v1, s[8:11], s35 offen nt
    s_add_u32 s35, s33, 0
    buffer_load_dwordx4 v[20:23], v1, s[12:15], s35 offen nt
    s_add_u32 s35, s33, 4194304
    buffer_load_dwordx4 v[24:27], v1, s[8:11], s35 offen nt
    s_add_u32 s35, s33, 4194304
    buffer_load_dwordx4 v[28:31], v1, s[12:15], s35 offen nt
    s_add_u32 s35, s33, 8388608
    buffer_load_dwordx4 v[32:35], v1, s[8:11], s35 offen nt
    s_add_u32 s35, s33, 8388608
    buffer_load_dwordx4 v[36:39], v1, s[12:15], s35 offen nt
    s_add_u32 s35, s33, 12582912
    buffer_load_dwordx4 v[40:43], v1, s[8:11], s35 offen nt
    s_add_u32 s35, s33, 12582912
    buffer_load_dwordx4 v[44:47], v1, s[12:15], s35 offen nt
    s_add_u32 s35, s33, 16777216
    buffer_load_dwordx4 v[72:75], v1, s[8:11], s35 offen nt
    s_add_u32 s35, s33, 16777216
    buffer_load_dwordx4 v[76:79], v1, s[12:15], s35 offen nt
    s_cmp_lg_u32 s39, 0
    s_cbranch_scc1 L_p1_noprobe
    s_cmp_ge_u32 s2, 64
    s_cbranch_scc1 L_p1_noprobe
    s_andn2_b32 s88, s2, 1
    s_mul_i32 s88, s88, 208
    s_lshr_b32 s88, s88, 8
    s_lshl_b32 s88, s88, 22
    s_and_b32 s90, s2, 62
    s_lshl_b32 s90, s90, 14
    s_add_u32 s88, s88, s90
    s_add_u32 s88, s4, s88
    s_addc_u32 s89, s5, 0
    s_and_b32 s95, s2, 1
    s_lshl_b32 s95, s95, 14
    s_xor_b32 s94, s95, 16384
    s_load_dword s91, s[88:89], s94
    s_xor_b32 s94, s94, 8192
    s_load_dword s91, s[88:89], s94
    s_xor_b32 s94, s94, 4352
    s_load_dword s91, s[88:89], s94
    s_xor_b32 s94, s94, 8192
    s_load_dword s91, s[88:89], s94
    s_xor_b32 s94, s94, 4352
    s_getreg_b32 s77, hwreg(HW_REG_XCC_ID, 2, 1)
    s_bfe_u32 s90, s2, 65539
    s_xor_b32 s77, s77, s90
    s_lshl_b32 s90, s90, 13
    s_or_b32 s95, s95, s90
    s_mov_b32 s90, 0x10000
    s_waitcnt lgkmcnt(0)
    s_xor_b32 s94, s95, 0x2000
    s_load_dword s91, s[88:89], s95
    s_load_dwordx2 s[92:93], s[88:89], s94
    s_waitcnt lgkmcnt(2)
    s_getreg_b32 s35, hwreg(HW_REG_IB_STS, 9, 1)
    s_waitcnt lgkmcnt(0)
    s_xor_b32 s35, s35, s77
    s_add_u32 s90, s90, s35
    s_xor_b32 s77, s77, 1
    s_xor_b32 s95, s95, 0x3100
    s_xor_b32 s94, s95, 0x2000
    s_load_dword s91, s[88:89], s95
    s_load_dwordx2 s[92:93], s[88:89], s94
    s_waitcnt lgkmcnt(2)
    s_getreg_b32 s35, hwreg(HW_REG_IB_STS, 9, 1)
    s_waitcnt lgkmcnt(0)
    s_xor_b32 s35, s35, s77
    s_add_u32 s90, s90, s35
    s_xor_b32 s77, s77, 1
    s_xor_b32 s95, s95, 0x3100
    s_getreg_b32 s91, hwreg(HW_REG_XCC_ID, 0, 3)
    v_mov_b32 v8, s90
    s_mov_b64 exec, 1
    buffer_atomic_add v8, off, s[84:87], 0 offset:128 sc0
    s_sub_u32 s91, s91, s2
    s_and_b32 s91, s91, 7
    s_or_b32 s92, s91, 8
    s_waitcnt vmcnt(0)
    v_readfirstlane_b32 s93, v8
    s_nop 0
    s_add_u32 s90, s90, s93
    s_cmp_le_u32 s90, 3145768
    s_cselect_b32 s92, s92, 16
    s_cmp_ge_u32 s90, 3145784
    s_cselect_b32 s92, s91, s92
    s_or_b32 s92, s92, 32
    v_mov_b32 v8, s92
    v_mov_b32 v9, 0
    s_lshr_b32 s90, s90, 16
    s_cmp_lg_u32 s90, 48
    s_cbranch_scc1 L_p1_voted
    buffer_atomic_cmpswap v[8:9], off, s[84:87], 0
L_p1_voted:
    s_mov_b64 exec, -1
L_p1_noprobe:
    s_mov_b32 s20, s4
    s_mov_b32 s21, s5
    s_mov_b32 s22, 0
    s_mov_b32 s23, 0x00020000
    s_add_u32 s24, s4, 222298112
    s_addc_u32 s25, s5, 0
    s_mov_b32 s26, 8540160
    s_mov_b32 s27, 0x00020000
    s_mov_b32 s37, 1492179184
    s_mov_b32 s55, 0
    s_mov_b64 s[76:77], 0
    s_mul_i32 s42, s39, 13
    s_mov_b64 s[72:73], s[4:5]
    s_mov_b32 s74, 0
    s_mov_b32 s75, 0x00020000
    s_mov_b32 s50, 21845
    s_mov_b32 s52, 0x8000
    s_mov_b32 s38, 262400
    s_mov_b32 s43, 0x05040100
    s_mov_b32 s40, 0
    v_mov_b32 v8, 0
    v_mov_b32 v9, 0
    v_mov_b32 v10, 0
    v_mov_b32 v11, 0
    ds_write_b128 v1, v[8:11] offset:0
    v_min_u32 v7, 16, v0
    v_lshlrev_b32 v7, 2, v7
    v_add_u32 v7, 160768, v7
    ds_write_b32 v7, v8
    s_waitcnt lgkmcnt(0)
    s_lshl_b32 s3, s3, 16
    v_mov_b32 v12, s3
    v_mul_f32 v12, 0.15915494, v12
    s_nop 0
    v_readfirstlane_b32 s41, v12
    s_waitcnt vmcnt(10)
    v_mov_b32 v12, 0x3f803f80
    v_and_b32 v48, 0x7fff7fff, v48
    v_and_b32 v49, 0x7fff7fff, v49
    v_and_b32 v50, 0x7fff7fff, v50
    v_and_b32 v51, 0x7fff7fff, v51
    v_and_b32 v52, 0x7fff7fff, v52
    v_and_b32 v53, 0x7fff7fff, v53
    v_and_b32 v54, 0x7fff7fff, v54
    v_and_b32 v55, 0x7fff7fff, v55
    v_pk_max_u16 v8, v8, v48
    v_dot2c_f32_bf16 v9, v48, v12
    v_pk_max_u16 v8, v8, v49
    v_dot2c_f32_bf16 v9, v49, v12
    v_pk_max_u16 v8, v8, v50
    v_dot2c_f32_bf16 v9, v50, v12
    v_pk_max_u16 v8, v8, v51
    v_dot2c_f32_bf16 v9, v51, v12
    v_pk_max_u16 v8, v8, v52
    v_dot2c_f32_bf16 v9, v52, v12
    v_pk_max_u16 v8, v8, v53
    v_dot2c_f32_bf16 v9, v53, v12
    v_pk_max_u16 v8, v8, v54
    v_dot2c_f32_bf16 v9, v54, v12
    v_pk_max_u16 v8, v8, v55
    v_dot2c_f32_bf16 v9, v55, v12
    v_lshrrev_b32 v10, 16, v8
    v_and_b32 v8, 0xffff, v8
    v_max_u32 v8, v8, v10
    s_nop 0
    s_nop 1
    v_max_u32_dpp v8, v8, v8 row_shr:1 row_mask:0xf bank_mask:0xf bound_ctrl:0
    s_nop 1
    v_max_u32_dpp v8, v8, v8 row_shr:2 row_mask:0xf bank_mask:0xf bound_ctrl:0
    s_nop 1
    v_max_u32_dpp v8, v8, v8 row_shr:4 row_mask:0xf bank_mask:0xf bound_ctrl:0
    s_nop 1
    v_max_u32_dpp v8, v8, v8 row_shr:8 row_mask:0xf bank_mask:0xf bound_ctrl:0
    s_nop 1
    v_max_u32_dpp v8, v8, v8 row_bcast:15 row_mask:0xa bank_mask:0xf
    s_nop 1
    v_max_u32_dpp v8, v8, v8 row_bcast:31 row_mask:0xc bank_mask:0xf
    s_nop 1
    v_add_f32_dpp v9, v9, v9 row_shr:1 row_mask:0xf bank_mask:0xf bound_ctrl:0
    s_nop 1
    v_add_f32_dpp v9, v9, v9 row_shr:2 row_mask:0xf bank_mask:0xf bound_ctrl:0
    s_nop 1
    v_add_f32_dpp v9, v9, v9 row_shr:4 row_mask:0xf bank_mask:0xf bound_ctrl:0
    s_nop 1
    v_add_f32_dpp v9, v9, v9 row_shr:8 row_mask:0xf bank_mask:0xf bound_ctrl:0
    s_nop 1
    v_add_f32_dpp v9, v9, v9 row_bcast:15 row_mask:0xa bank_mask:0xf
    s_nop 1
    v_add_f32_dpp v9, v9, v9 row_bcast:31 row_mask:0xc bank_mask:0xf
    s_lshl_b32 s35, s39, 4
    s_add_u32 s35, s35, 160320
    v_mov_b32 v10, s35
    s_mov_b32 exec_lo, 0
    s_brev_b32 exec_hi, 1
    ds_write_b64 v10, v[8:9]
    s_mov_b64 exec, -1
    s_waitcnt lgkmcnt(0)
    s_barrier
    s_cmp_lg_u32 s39, 0
    s_cbranch_scc1 L_p1_first
    v_and_b32 v6, 15, v0
    v_lshlrev_b32 v6, 4, v6
    v_add_u32 v6, 160320, v6
    ds_read_b64 v[8:9], v6
    s_waitcnt lgkmcnt(0)
    s_nop 1
    v_max_u32_dpp v8, v8, v8 row_shr:1 row_mask:0xf bank_mask:0xf bound_ctrl:0
    s_nop 1
    v_max_u32_dpp v8, v8, v8 row_shr:2 row_mask:0xf bank_mask:0xf bound_ctrl:0
    s_nop 1
    v_max_u32_dpp v8, v8, v8 row_shr:4 row_mask:0xf bank_mask:0xf bound_ctrl:0
    s_nop 1
    v_max_u32_dpp v8, v8, v8 row_shr:8 row_mask:0xf bank_mask:0xf bound_ctrl:0
    s_nop 1
    v_add_f32_dpp v9, v9, v9 row_shr:1 row_mask:0xf bank_mask:0xf bound_ctrl:0
    s_nop 1
    v_add_f32_dpp v9, v9, v9 row_shr:2 row_mask:0xf bank_mask:0xf bound_ctrl:0
    s_nop 1
    v_add_f32_dpp v9, v9, v9 row_shr:4 row_mask:0xf bank_mask:0xf bound_ctrl:0
    s_nop 1
    v_add_f32_dpp v9, v9, v9 row_shr:8 row_mask:0xf bank_mask:0xf bound_ctrl:0
    s_lshl_b32 s35, s2, 3
    s_add_u32 s35, s35, 8519680
    v_mov_b32 v6, 0
    s_mov_b64 exec, 0x8000
    buffer_store_dwordx2 v[8:9], v6, s[24:27], s35 offen sc1
    s_lshl_b32 s35, s2, 8
    s_add_u32 s35, s35, 8523776
    buffer_store_dword v6, v6, s[24:27], s35 offen sc1
    s_mov_b64 exec, -1
    s_branch L_p1_first
L_p1_loop:
    s_mov_b64 s[72:73], s[20:21]
    s_mov_b32 s74, s22
    s_cmp_lg_u32 s39, 15
    s_cbranch_scc1 L_p1_kernel_nox_2
    v_lshlrev_b32 v15, 16, v103
    v_and_b32 v103, 0xffff0000, v103
    v_lshlrev_b32 v9, 16, v119
    v_mul_f32 v15, s41, v15
    v_mul_f32 v103, s41, v103
    v_mul_f32 v9, s41, v9
    v_fract_f32 v15, v15
    v_fract_f32 v103, v103
    v_fract_f32 v9, v9
    v_cos_f32 v15, v15
    v_cos_f32 v103, v103
    v_cos_f32 v9, v9
    v_fmaak_f32 v15, v10, v15, 1262486016
    v_fmaak_f32 v103, v10, v103, 1262486016
    v_fmaak_f32 v9, v10, v9, 1262486016
    v_lshlrev_b32 v15, 22, v15
    v_alignbit_b32 v15, v103, v15, 10
    v_alignbit_b32 v15, v9, v15, 10
    v_xor_b32 v15, 0x80200800, v15
    s_waitcnt lgkmcnt(15)
    s_add_u32 s36, s42, 13
    s_and_b32 s35, s36, 3
    s_mul_i32 s35, s35, 1047552
    s_lshl_b32 s36, s36, 20
    s_sub_u32 s36, s36, s35
    buffer_store_dwordx4 v[12:15], v3, s[20:23], s36 offen sc1
L_p1_kernel_nox_2:
    v_lshlrev_b32 v75, 16, v107
    v_and_b32 v107, 0xffff0000, v107
    v_and_b32 v9, 0xffff0000, v119
    v_mul_f32 v75, s41, v75
    v_mul_f32 v107, s41, v107
    v_mul_f32 v9, s41, v9
    v_fract_f32 v75, v75
    v_fract_f32 v107, v107
    v_fract_f32 v9, v9
    v_cos_f32 v75, v75
    v_cos_f32 v107, v107
    v_cos_f32 v9, v9
    v_fmaak_f32 v75, v10, v75, 1262486016
    v_fmaak_f32 v107, v10, v107, 1262486016
    v_fmaak_f32 v9, v10, v9, 1262486016
    v_lshlrev_b32 v75, 22, v75
    v_alignbit_b32 v75, v107, v75, 10
    v_alignbit_b32 v75, v9, v75, 10
    v_xor_b32 v75, 0x80200800, v75
    s_waitcnt lgkmcnt(15)
    s_add_u32 s36, s42, 0
    s_and_b32 s35, s36, 3
    s_mul_i32 s35, s35, 1047552
    s_lshl_b32 s36, s36, 20
    s_sub_u32 s36, s36, s35
    buffer_store_dwordx4 v[72:75], v3, s[20:23], s36 offen sc1
    v_lshlrev_b32 v79, 16, v111
    v_and_b32 v111, 0xffff0000, v111
    v_lshlrev_b32 v9, 16, v11
    v_mul_f32 v79, s41, v79
    v_mul_f32 v111, s41, v111
    v_mul_f32 v9, s41, v9
    v_fract_f32 v79, v79
    v_fract_f32 v111, v111
    v_fract_f32 v9, v9
    v_cos_f32 v79, v79
    v_cos_f32 v111, v111
    v_cos_f32 v9, v9
    v_fmaak_f32 v79, v10, v79, 1262486016
    v_fmaak_f32 v111, v10, v111, 1262486016
    v_fmaak_f32 v9, v10, v9, 1262486016
    v_lshlrev_b32 v79, 22, v79
    v_alignbit_b32 v79, v111, v79, 10
    v_alignbit_b32 v79, v9, v79, 10
    v_xor_b32 v79, 0x80200800, v79
    s_waitcnt lgkmcnt(15)
    s_add_u32 s36, s42, 1
    s_and_b32 s35, s36, 3
    s_mul_i32 s35, s35, 1047552
    s_lshl_b32 s36, s36, 20
    s_sub_u32 s36, s36, s35
    buffer_store_dwordx4 v[76:79], v3, s[20:23], s36 offen sc1
    v_lshlrev_b32 v51, 16, v115
    v_and_b32 v115, 0xffff0000, v115
    v_and_b32 v9, 0xffff0000, v11
    v_mul_f32 v51, s41, v51
    v_mul_f32 v115, s41, v115
    v_mul_f32 v9, s41, v9
    v_fract_f32 v51, v51
    v_fract_f32 v115, v115
    v_fract_f32 v9, v9
    v_cos_f32 v51, v51
    v_cos_f32 v115, v115
    v_cos_f32 v9, v9
    v_fmaak_f32 v51, v10, v51, 1262486016
    v_fmaak_f32 v115, v10, v115, 1262486016
    v_fmaak_f32 v9, v10, v9, 1262486016
    v_lshlrev_b32 v51, 22, v51
    v_alignbit_b32 v51, v115, v51, 10
    v_alignbit_b32 v51, v9, v51, 10
    v_xor_b32 v51, 0x80200800, v51
    s_waitcnt lgkmcnt(0)
    s_add_u32 s36, s42, 2
    s_and_b32 s35, s36, 3
    s_mul_i32 s35, s35, 1047552
    s_lshl_b32 s36, s36, 20
    s_sub_u32 s36, s36, s35
    buffer_store_dwordx4 v[48:51], v3, s[20:23], s36 offen sc1
    s_add_u32 s35, s33, 16777216
    buffer_load_dwordx4 v[72:75], v1, s[8:11], s35 offen nt
    s_add_u32 s35, s33, 16777216
    buffer_load_dwordx4 v[76:79], v1, s[12:15], s35 offen nt
    s_barrier
    s_waitcnt vmcnt(11)
    v_perm_b32 v6, v20, v16, s43
    v_perm_b32 v7, v21, v17, s43
    v_perm_b32 v8, v22, v18, s43
    v_perm_b32 v9, v23, v19, s43
    v_mul_hi_u32_u24 v16, 429497, v16
    v_mul_hi_u32_u24 v20, 429497, v20
    v_mul_hi_u32_u24 v17, 429497, v17
    v_mul_hi_u32_u24 v21, 429497, v21
    v_mul_hi_u32_u24 v18, 429497, v18
    v_mul_hi_u32_u24 v22, 429497, v22
    v_mul_hi_u32_u24 v19, 429497, v19
    v_mul_hi_u32_u24 v23, 429497, v23
    v_lshl_or_b32 v16, v20, 16, v16
    v_lshl_or_b32 v17, v21, 16, v17
    v_lshl_or_b32 v18, v22, 16, v18
    v_lshl_or_b32 v19, v23, 16, v19
    v_dot2_u32_u16 v20, v16, s38, 0
    v_dot2_u32_u16 v21, v17, s38, 0
    v_dot2_u32_u16 v22, v18, s38, 0
    v_dot2_u32_u16 v23, v19, s38, 0
    v_pk_mad_u16 v6, v16, s37, v6
    v_pk_mad_u16 v7, v17, s37, v7
    v_pk_mad_u16 v8, v18, s37, v8
    v_pk_mad_u16 v9, v19, s37, v9
    ds_add_u32 v20, v4 offset:0
    ds_add_u32 v21, v4 offset:0
    ds_add_u32 v22, v4 offset:0
    ds_add_u32 v23, v4 offset:0
    v_pk_mad_u16 v6, v16, s52, v6 op_sel:[1,0,0] op_sel_hi:[1,1,1]
    v_pk_mad_u16 v7, v17, s52, v7 op_sel:[1,0,0] op_sel_hi:[1,1,1]
    v_pk_mad_u16 v8, v18, s52, v8 op_sel:[1,0,0] op_sel_hi:[1,1,1]
    v_pk_mad_u16 v9, v19, s52, v9 op_sel:[1,0,0] op_sel_hi:[1,1,1]
    v_perm_b32 v121, v23, v22, s43
    v_perm_b32 v120, v21, v20, s43
    v_or_b32 v127, 0x40000000, v6
    v_or_b32 v48, 0x40000000, v7
    v_or_b32 v49, 0x40000000, v8
    v_or_b32 v50, 0x40000000, v9
    v_lshlrev_b32 v83, 16, v100
    v_and_b32 v100, 0xffff0000, v100
    v_lshlrev_b32 v9, 16, v101
    v_mul_f32 v83, s41, v83
    v_mul_f32 v100, s41, v100
    v_mul_f32 v9, s41, v9
    v_fract_f32 v83, v83
    v_fract_f32 v100, v100
    v_fract_f32 v9, v9
    v_cos_f32 v83, v83
    v_cos_f32 v100, v100
    v_cos_f32 v9, v9
    v_fmaak_f32 v83, v10, v83, 1262486016
    v_fmaak_f32 v100, v10, v100, 1262486016
    v_fmaak_f32 v9, v10, v9, 1262486016
    v_lshlrev_b32 v83, 22, v83
    v_alignbit_b32 v83, v100, v83, 10
    v_alignbit_b32 v83, v9, v83, 10
    v_xor_b32 v83, 0x80200800, v83
    s_add_u32 s36, s42, 3
    s_and_b32 s35, s36, 3
    s_mul_i32 s35, s35, 1047552
    s_lshl_b32 s36, s36, 20
    s_sub_u32 s36, s36, s35
    buffer_store_dwordx4 v[80:83], v3, s[20:23], s36 offen sc1
    v_lshlrev_b32 v55, 16, v102
    v_and_b32 v102, 0xffff0000, v102
    v_and_b32 v9, 0xffff0000, v101
    v_mul_f32 v55, s41, v55
    v_mul_f32 v102, s41, v102
    v_mul_f32 v9, s41, v9
    v_fract_f32 v55, v55
    v_fract_f32 v102, v102
    v_fract_f32 v9, v9
    v_cos_f32 v55, v55
    v_cos_f32 v102, v102
    v_cos_f32 v9, v9
    v_fmaak_f32 v55, v10, v55, 1262486016
    v_fmaak_f32 v102, v10, v102, 1262486016
    v_fmaak_f32 v9, v10, v9, 1262486016
    v_lshlrev_b32 v55, 22, v55
    v_alignbit_b32 v55, v102, v55, 10
    v_alignbit_b32 v55, v9, v55, 10
    v_xor_b32 v55, 0x80200800, v55
    s_cmp_lg_u32 s40, 3
    s_cbranch_scc1 L_p1_kernel_now_3
    v_mov_b64 v[16:17], v[52:53]
    v_mov_b64 v[18:19], v[54:55]
    s_branch L_p1_kernel_held_4
L_p1_kernel_now_3:
    s_add_u32 s36, s42, 4
    s_and_b32 s35, s36, 3
    s_mul_i32 s35, s35, 1047552
    s_lshl_b32 s36, s36, 20
    s_sub_u32 s36, s36, s35
    buffer_store_dwordx4 v[52:55], v3, s[20:23], s36 offen sc1
L_p1_kernel_held_4:
    s_add_u32 s35, s33, 20971520
    buffer_load_dwordx4 v[80:83], v1, s[8:11], s35 offen nt
    s_add_u32 s35, s33, 20971520
    buffer_load_dwordx4 v[100:103], v1, s[12:15], s35 offen nt
    v_lshlrev_b32 v87, 16, v104
    v_and_b32 v104, 0xffff0000, v104
    v_lshlrev_b32 v9, 16, v105
    v_mul_f32 v87, s41, v87
    v_mul_f32 v104, s41, v104
    v_mul_f32 v9, s41, v9
    v_fract_f32 v87, v87
    v_fract_f32 v104, v104
    v_fract_f32 v9, v9
    v_cos_f32 v87, v87
    v_cos_f32 v104, v104
    v_cos_f32 v9, v9
    v_fmaak_f32 v87, v10, v87, 1262486016
    v_fmaak_f32 v104, v10, v104, 1262486016
    v_fmaak_f32 v9, v10, v9, 1262486016
    v_lshlrev_b32 v87, 22, v87
    v_alignbit_b32 v87, v104, v87, 10
    v_alignbit_b32 v87, v9, v87, 10
    v_xor_b32 v87, 0x80200800, v87
    s_add_u32 s36, s42, 5
    s_and_b32 s35, s36, 3
    s_mul_i32 s35, s35, 1047552
    s_lshl_b32 s36, s36, 20
    s_sub_u32 s36, s36, s35
    buffer_store_dwordx4 v[84:87], v3, s[20:23], s36 offen sc1
    v_lshlrev_b32 v59, 16, v106
    v_and_b32 v106, 0xffff0000, v106
    v_and_b32 v9, 0xffff0000, v105
    v_mul_f32 v59, s41, v59
    v_mul_f32 v106, s41, v106
    v_mul_f32 v9, s41, v9
    v_fract_f32 v59, v59
    v_fract_f32 v106, v106
    v_fract_f32 v9, v9
    v_cos_f32 v59, v59
    v_cos_f32 v106, v106
    v_cos_f32 v9, v9
    v_fmaak_f32 v59, v10, v59, 1262486016
    v_fmaak_f32 v106, v10, v106, 1262486016
    v_fmaak_f32 v9, v10, v9, 1262486016
    v_lshlrev_b32 v59, 22, v59
    v_alignbit_b32 v59, v106, v59, 10
    v_alignbit_b32 v59, v9, v59, 10
    v_xor_b32 v59, 0x80200800, v59
    s_cmp_lg_u32 s40, 3
    s_cbranch_scc1 L_p1_kernel_now_5
    v_mov_b64 v[20:21], v[56:57]
    v_mov_b64 v[22:23], v[58:59]
    s_branch L_p1_kernel_held_6
L_p1_kernel_now_5:
    s_add_u32 s36, s42, 6
    s_and_b32 s35, s36, 3
    s_mul_i32 s35, s35, 1047552
    s_lshl_b32 s36, s36, 20
    s_sub_u32 s36, s36, s35
    buffer_store_dwordx4 v[56:59], v3, s[20:23], s36 offen sc1
L_p1_kernel_held_6:
    s_add_u32 s35, s33, 25165824
    buffer_load_dwordx4 v[84:87], v1, s[8:11], s35 offen nt
    s_add_u32 s35, s33, 25165824
    buffer_load_dwordx4 v[104:107], v1, s[12:15], s35 offen nt
    s_waitcnt vmcnt(15)
    v_perm_b32 v6, v28, v24, s43
    v_perm_b32 v7, v29, v25, s43
    v_perm_b32 v8, v30, v26, s43
    v_perm_b32 v9, v31, v27, s43
    v_mul_hi_u32_u24 v24, 429497, v24
    v_mul_hi_u32_u24 v28, 429497, v28
    v_mul_hi_u32_u24 v25, 429497, v25
    v_mul_hi_u32_u24 v29, 429497, v29
    v_mul_hi_u32_u24 v26, 429497, v26
    v_mul_hi_u32_u24 v30, 429497, v30
    v_mul_hi_u32_u24 v27, 429497, v27
    v_mul_hi_u32_u24 v31, 429497, v31
    v_lshl_or_b32 v24, v28, 16, v24
    v_lshl_or_b32 v25, v29, 16, v25
    v_lshl_or_b32 v26, v30, 16, v26
    v_lshl_or_b32 v27, v31, 16, v27
    v_dot2_u32_u16 v28, v24, s38, 0
    v_dot2_u32_u16 v29, v25, s38, 0
    v_dot2_u32_u16 v30, v26, s38, 0
    v_dot2_u32_u16 v31, v27, s38, 0
    v_pk_mad_u16 v6, v24, s37, v6
    v_pk_mad_u16 v7, v25, s37, v7
    v_pk_mad_u16 v8, v26, s37, v8
    v_pk_mad_u16 v9, v27, s37, v9
    ds_add_u32 v28, v4 offset:0
    ds_add_u32 v29, v4 offset:0
    ds_add_u32 v30, v4 offset:0
    ds_add_u32 v31, v4 offset:0
    v_pk_mad_u16 v6, v24, s52, v6 op_sel:[1,0,0] op_sel_hi:[1,1,1]
    v_pk_mad_u16 v7, v25, s52, v7 op_sel:[1,0,0] op_sel_hi:[1,1,1]
    v_pk_mad_u16 v8, v26, s52, v8 op_sel:[1,0,0] op_sel_hi:[1,1,1]
    v_pk_mad_u16 v9, v27, s52, v9 op_sel:[1,0,0] op_sel_hi:[1,1,1]
    v_perm_b32 v123, v31, v30, s43
    v_perm_b32 v122, v29, v28, s43
    v_or_b32 v52, 0x40000000, v6
    v_or_b32 v53, 0x40000000, v7
    v_or_b32 v54, 0x40000000, v8
    v_or_b32 v56, 0x40000000, v9
    v_lshlrev_b32 v91, 16, v108
    v_and_b32 v108, 0xffff0000, v108
    v_lshlrev_b32 v9, 16, v109
    v_mul_f32 v91, s41, v91
    v_mul_f32 v108, s41, v108
    v_mul_f32 v9, s41, v9
    v_fract_f32 v91, v91
    v_fract_f32 v108, v108
    v_fract_f32 v9, v9
    v_cos_f32 v91, v91
    v_cos_f32 v108, v108
    v_cos_f32 v9, v9
    v_fmaak_f32 v91, v10, v91, 1262486016
    v_fmaak_f32 v108, v10, v108, 1262486016
    v_fmaak_f32 v9, v10, v9, 1262486016
    v_lshlrev_b32 v91, 22, v91
    v_alignbit_b32 v91, v108, v91, 10
    v_alignbit_b32 v91, v9, v91, 10
    v_xor_b32 v91, 0x80200800, v91
    s_cmp_lg_u32 s40, 3
    s_cbranch_scc1 L_p1_kernel_now_7
    v_mov_b64 v[24:25], v[88:89]
    v_mov_b64 v[26:27], v[90:91]
    s_branch L_p1_kernel_held_8
L_p1_kernel_now_7:
    s_add_u32 s36, s42, 7
    s_and_b32 s35, s36, 3
    s_mul_i32 s35, s35, 1047552
    s_lshl_b32 s36, s36, 20
    s_sub_u32 s36, s36, s35
    buffer_store_dwordx4 v[88:91], v3, s[20:23], s36 offen sc1
L_p1_kernel_held_8:
    v_lshlrev_b32 v63, 16, v110
    v_and_b32 v110, 0xffff0000, v110
    v_and_b32 v9, 0xffff0000, v109
    v_mul_f32 v63, s41, v63
    v_mul_f32 v110, s41, v110
    v_mul_f32 v9, s41, v9
    v_fract_f32 v63, v63
    v_fract_f32 v110, v110
    v_fract_f32 v9, v9
    v_cos_f32 v63, v63
    v_cos_f32 v110, v110
    v_cos_f32 v9, v9
    v_fmaak_f32 v63, v10, v63, 1262486016
    v_fmaak_f32 v110, v10, v110, 1262486016
    v_fmaak_f32 v9, v10, v9, 1262486016
    v_lshlrev_b32 v63, 22, v63
    v_alignbit_b32 v63, v110, v63, 10
    v_alignbit_b32 v63, v9, v63, 10
    v_xor_b32 v63, 0x80200800, v63
    s_cmp_lg_u32 s40, 3
    s_cbranch_scc1 L_p1_kernel_now_9
    v_mov_b64 v[28:29], v[60:61]
    v_mov_b64 v[30:31], v[62:63]
    s_branch L_p1_kernel_held_10
L_p1_kernel_now_9:
    s_add_u32 s36, s42, 8
    s_and_b32 s35, s36, 3
    s_mul_i32 s35, s35, 1047552
    s_lshl_b32 s36, s36, 20
    s_sub_u32 s36, s36, s35
    buffer_store_dwordx4 v[60:63], v3, s[20:23], s36 offen sc1
L_p1_kernel_held_10:
    s_add_u32 s35, s33, 29360128
    buffer_load_dwordx4 v[88:91], v1, s[8:11], s35 offen nt
    s_add_u32 s35, s33, 29360128
    buffer_load_dwordx4 v[108:111], v1, s[12:15], s35 offen nt
    s_waitcnt vmcnt(15)
    v_perm_b32 v6, v36, v32, s43
    v_perm_b32 v7, v37, v33, s43
    v_perm_b32 v8, v38, v34, s43
    v_perm_b32 v9, v39, v35, s43
    v_mul_hi_u32_u24 v32, 429497, v32
    v_mul_hi_u32_u24 v36, 429497, v36
    v_mul_hi_u32_u24 v33, 429497, v33
    v_mul_hi_u32_u24 v37, 429497, v37
    v_mul_hi_u32_u24 v34, 429497, v34
    v_mul_hi_u32_u24 v38, 429497, v38
    v_mul_hi_u32_u24 v35, 429497, v35
    v_mul_hi_u32_u24 v39, 429497, v39
    v_lshl_or_b32 v32, v36, 16, v32
    v_lshl_or_b32 v33, v37, 16, v33
    v_lshl_or_b32 v34, v38, 16, v34
    v_lshl_or_b32 v35, v39, 16, v35
    v_dot2_u32_u16 v36, v32, s38, 0
    v_dot2_u32_u16 v37, v33, s38, 0
    v_dot2_u32_u16 v38, v34, s38, 0
    v_dot2_u32_u16 v39, v35, s38, 0
    v_pk_mad_u16 v6, v32, s37, v6
    v_pk_mad_u16 v7, v33, s37, v7
    v_pk_mad_u16 v8, v34, s37, v8
    v_pk_mad_u16 v9, v35, s37, v9
    ds_add_u32 v36, v4 offset:0
    ds_add_u32 v37, v4 offset:0
    ds_add_u32 v38, v4 offset:0
    ds_add_u32 v39, v4 offset:0
    v_pk_mad_u16 v6, v32, s52, v6 op_sel:[1,0,0] op_sel_hi:[1,1,1]
    v_pk_mad_u16 v7, v33, s52, v7 op_sel:[1,0,0] op_sel_hi:[1,1,1]
    v_pk_mad_u16 v8, v34, s52, v8 op_sel:[1,0,0] op_sel_hi:[1,1,1]
    v_pk_mad_u16 v9, v35, s52, v9 op_sel:[1,0,0] op_sel_hi:[1,1,1]
    v_perm_b32 v125, v39, v38, s43
    v_perm_b32 v124, v37, v36, s43
    v_or_b32 v57, 0x40000000, v6
    v_or_b32 v58, 0x40000000, v7
    v_or_b32 v60, 0x40000000, v8
    v_or_b32 v61, 0x40000000, v9
    v_lshlrev_b32 v95, 16, v112
    v_and_b32 v112, 0xffff0000, v112
    v_lshlrev_b32 v9, 16, v113
    v_mul_f32 v95, s41, v95
    v_mul_f32 v112, s41, v112
    v_mul_f32 v9, s41, v9
    v_fract_f32 v95, v95
    v_fract_f32 v112, v112
    v_fract_f32 v9, v9
    v_cos_f32 v95, v95
    v_cos_f32 v112, v112
    v_cos_f32 v9, v9
    v_fmaak_f32 v95, v10, v95, 1262486016
    v_fmaak_f32 v112, v10, v112, 1262486016
    v_fmaak_f32 v9, v10, v9, 1262486016
    v_lshlrev_b32 v95, 22, v95
    v_alignbit_b32 v95, v112, v95, 10
    v_alignbit_b32 v95, v9, v95, 10
    v_xor_b32 v95, 0x80200800, v95
    s_cmp_lg_u32 s40, 3
    s_cbranch_scc1 L_p1_kernel_now_11
    v_mov_b64 v[32:33], v[92:93]
    v_mov_b64 v[34:35], v[94:95]
    s_branch L_p1_kernel_held_12
L_p1_kernel_now_11:
    s_add_u32 s36, s42, 9
    s_and_b32 s35, s36, 3
    s_mul_i32 s35, s35, 1047552
    s_lshl_b32 s36, s36, 20
    s_sub_u32 s36, s36, s35
    buffer_store_dwordx4 v[92:95], v3, s[20:23], s36 offen sc1
L_p1_kernel_held_12:
    v_lshlrev_b32 v67, 16, v114
    v_and_b32 v114, 0xffff0000, v114
    v_and_b32 v9, 0xffff0000, v113
    v_mul_f32 v67, s41, v67
    v_mul_f32 v114, s41, v114
    v_mul_f32 v9, s41, v9
    v_fract_f32 v67, v67
    v_fract_f32 v114, v114
    v_fract_f32 v9, v9
    v_cos_f32 v67, v67
    v_cos_f32 v114, v114
    v_cos_f32 v9, v9
    v_fmaak_f32 v67, v10, v67, 1262486016
    v_fmaak_f32 v114, v10, v114, 1262486016
    v_fmaak_f32 v9, v10, v9, 1262486016
    v_lshlrev_b32 v67, 22, v67
    v_alignbit_b32 v67, v114, v67, 10
    v_alignbit_b32 v67, v9, v67, 10
    v_xor_b32 v67, 0x80200800, v67
    s_cmp_lg_u32 s40, 3
    s_cbranch_scc1 L_p1_kernel_now_13
    v_mov_b64 v[36:37], v[64:65]
    v_mov_b64 v[38:39], v[66:67]
    s_branch L_p1_kernel_held_14
L_p1_kernel_now_13:
    s_add_u32 s36, s42, 10
    s_and_b32 s35, s36, 3
    s_mul_i32 s35, s35, 1047552
    s_lshl_b32 s36, s36, 20
    s_sub_u32 s36, s36, s35
    buffer_store_dwordx4 v[64:67], v3, s[20:23], s36 offen sc1
L_p1_kernel_held_14:
    s_add_u32 s35, s33, 33554432
    buffer_load_dwordx4 v[92:95], v1, s[8:11], s35 offen nt
    s_add_u32 s35, s33, 33554432
    buffer_load_dwordx4 v[112:115], v1, s[12:15], s35 offen nt
    s_waitcnt vmcnt(15)
    v_perm_b32 v6, v44, v40, s43
    v_perm_b32 v7, v45, v41, s43
    v_perm_b32 v8, v46, v42, s43
    v_perm_b32 v9, v47, v43, s43
    v_mul_hi_u32_u24 v40, 429497, v40
    v_mul_hi_u32_u24 v44, 429497, v44
    v_mul_hi_u32_u24 v41, 429497, v41
    v_mul_hi_u32_u24 v45, 429497, v45
    v_mul_hi_u32_u24 v42, 429497, v42
    v_mul_hi_u32_u24 v46, 429497, v46
    v_mul_hi_u32_u24 v43, 429497, v43
    v_mul_hi_u32_u24 v47, 429497, v47
    v_lshl_or_b32 v40, v44, 16, v40
    v_lshl_or_b32 v41, v45, 16, v41
    v_lshl_or_b32 v42, v46, 16, v42
    v_lshl_or_b32 v43, v47, 16, v43
    v_dot2_u32_u16 v44, v40, s38, 0
    v_dot2_u32_u16 v45, v41, s38, 0
    v_dot2_u32_u16 v46, v42, s38, 0
    v_dot2_u32_u16 v47, v43, s38, 0
    v_pk_mad_u16 v6, v40, s37, v6
    v_pk_mad_u16 v7, v41, s37, v7
    v_pk_mad_u16 v8, v42, s37, v8
    v_pk_mad_u16 v9, v43, s37, v9
    ds_add_u32 v44, v4 offset:0
    ds_add_u32 v45, v4 offset:0
    ds_add_u32 v46, v4 offset:0
    ds_add_u32 v47, v4 offset:0
    v_pk_mad_u16 v6, v40, s52, v6 op_sel:[1,0,0] op_sel_hi:[1,1,1]
    v_pk_mad_u16 v7, v41, s52, v7 op_sel:[1,0,0] op_sel_hi:[1,1,1]
    v_pk_mad_u16 v8, v42, s52, v8 op_sel:[1,0,0] op_sel_hi:[1,1,1]
    v_pk_mad_u16 v9, v43, s52, v9 op_sel:[1,0,0] op_sel_hi:[1,1,1]
    v_perm_b32 v51, v47, v46, s43
    v_perm_b32 v126, v45, v44, s43
    v_or_b32 v62, 0x40000000, v6
    v_or_b32 v64, 0x40000000, v7
    v_or_b32 v65, 0x40000000, v8
    v_or_b32 v66, 0x40000000, v9
    v_lshlrev_b32 v99, 16, v116
    v_and_b32 v116, 0xffff0000, v116
    v_lshlrev_b32 v9, 16, v117
    v_mul_f32 v99, s41, v99
    v_mul_f32 v116, s41, v116
    v_mul_f32 v9, s41, v9
    v_fract_f32 v99, v99
    v_fract_f32 v116, v116
    v_fract_f32 v9, v9
    v_cos_f32 v99, v99
    v_cos_f32 v116, v116
    v_cos_f32 v9, v9
    v_fmaak_f32 v99, v10, v99, 1262486016
    v_fmaak_f32 v116, v10, v116, 1262486016
    v_fmaak_f32 v9, v10, v9, 1262486016
    v_lshlrev_b32 v99, 22, v99
    v_alignbit_b32 v99, v116, v99, 10
    v_alignbit_b32 v99, v9, v99, 10
    v_xor_b32 v99, 0x80200800, v99
    s_cmp_lg_u32 s40, 3
    s_cbranch_scc1 L_p1_kernel_now_15
    v_mov_b64 v[40:41], v[96:97]
    v_mov_b64 v[42:43], v[98:99]
    s_branch L_p1_kernel_held_16
L_p1_kernel_now_15:
    s_add_u32 s36, s42, 11
    s_and_b32 s35, s36, 3
    s_mul_i32 s35, s35, 1047552
    s_lshl_b32 s36, s36, 20
    s_sub_u32 s36, s36, s35
    buffer_store_dwordx4 v[96:99], v3, s[20:23], s36 offen sc1
L_p1_kernel_held_16:
    v_lshlrev_b32 v71, 16, v118
    v_and_b32 v118, 0xffff0000, v118
    v_and_b32 v9, 0xffff0000, v117
    v_mul_f32 v71, s41, v71
    v_mul_f32 v118, s41, v118
    v_mul_f32 v9, s41, v9
    v_fract_f32 v71, v71
    v_fract_f32 v118, v118
    v_fract_f32 v9, v9
    v_cos_f32 v71, v71
    v_cos_f32 v118, v118
    v_cos_f32 v9, v9
    v_fmaak_f32 v71, v10, v71, 1262486016
    v_fmaak_f32 v118, v10, v118, 1262486016
    v_fmaak_f32 v9, v10, v9, 1262486016
    v_lshlrev_b32 v71, 22, v71
    v_alignbit_b32 v71, v118, v71, 10
    v_alignbit_b32 v71, v9, v71, 10
    v_xor_b32 v71, 0x80200800, v71
    s_cmp_lg_u32 s40, 3
    s_cbranch_scc1 L_p1_kernel_now_17
    v_mov_b64 v[44:45], v[68:69]
    v_mov_b64 v[46:47], v[70:71]
    s_branch L_p1_kernel_held_18
L_p1_kernel_now_17:
    s_add_u32 s36, s42, 12
    s_and_b32 s35, s36, 3
    s_mul_i32 s35, s35, 1047552
    s_lshl_b32 s36, s36, 20
    s_sub_u32 s36, s36, s35
    buffer_store_dwordx4 v[68:71], v3, s[20:23], s36 offen sc1
L_p1_kernel_held_18:
    s_add_u32 s35, s33, 37748736
    s_sub_u32 s35, s35, s48
    v_cndmask_b32 v96, 2.0, v1, s[44:45]
    buffer_load_dwordx4 v[96:99], v96, s[8:11], s35 offen nt
    s_add_u32 s35, s33, 37748736
    s_sub_u32 s35, s35, s48
    v_cndmask_b32 v116, 2.0, v1, s[44:45]
    buffer_load_dwordx4 v[116:119], v116, s[12:15], s35 offen nt
    s_branch L_p1_join
L_p1_first:
    s_add_u32 s35, s33, 20971520
    buffer_load_dwordx4 v[80:83], v1, s[8:11], s35 offen nt
    s_add_u32 s35, s33, 20971520
    buffer_load_dwordx4 v[100:103], v1, s[12:15], s35 offen nt
    s_add_u32 s35, s33, 25165824
    buffer_load_dwordx4 v[84:87], v1, s[8:11], s35 offen nt
    s_add_u32 s35, s33, 25165824
    buffer_load_dwordx4 v[104:107], v1, s[12:15], s35 offen nt
    s_add_u32 s35, s33, 29360128
    buffer_load_dwordx4 v[88:91], v1, s[8:11], s35 offen nt
    s_add_u32 s35, s33, 29360128
    buffer_load_dwordx4 v[108:111], v1, s[12:15], s35 offen nt
    s_add_u32 s35, s33, 33554432
    buffer_load_dwordx4 v[92:95], v1, s[8:11], s35 offen nt
    s_add_u32 s35, s33, 33554432
    buffer_load_dwordx4 v[112:115], v1, s[12:15], s35 offen nt
    s_add_u32 s35, s33, 37748736
    s_sub_u32 s35, s35, s48
    v_cndmask_b32 v96, 2.0, v1, s[44:45]
    buffer_load_dwordx4 v[96:99], v96, s[8:11], s35 offen nt
    s_add_u32 s35, s33, 37748736
    s_sub_u32 s35, s35, s48
    v_cndmask_b32 v116, 2.0, v1, s[44:45]
    buffer_load_dwordx4 v[116:119], v116, s[12:15], s35 offen nt
    s_cmp_lg_u32 s39, 15
    s_cbranch_scc1 L_p1_nofetch
    buffer_load_dword v12, off, s[84:87], 0 sc1
L_p1_nofetch:
    s_waitcnt vmcnt(18)
    v_perm_b32 v6, v20, v16, s43
    v_perm_b32 v7, v21, v17, s43
    v_perm_b32 v8, v22, v18, s43
    v_perm_b32 v9, v23, v19, s43
    v_mul_hi_u32_u24 v16, 429497, v16
    v_mul_hi_u32_u24 v20, 429497, v20
    v_mul_hi_u32_u24 v17, 429497, v17
    v_mul_hi_u32_u24 v21, 429497, v21
    v_mul_hi_u32_u24 v18, 429497, v18
    v_mul_hi_u32_u24 v22, 429497, v22
    v_mul_hi_u32_u24 v19, 429497, v19
    v_mul_hi_u32_u24 v23, 429497, v23
    v_lshl_or_b32 v16, v20, 16, v16
    v_lshl_or_b32 v17, v21, 16, v17
    v_lshl_or_b32 v18, v22, 16, v18
    v_lshl_or_b32 v19, v23, 16, v19
    v_dot2_u32_u16 v20, v16, s38, 0
    v_dot2_u32_u16 v21, v17, s38, 0
    v_dot2_u32_u16 v22, v18, s38, 0
    v_dot2_u32_u16 v23, v19, s38, 0
    v_pk_mad_u16 v6, v16, s37, v6
    v_pk_mad_u16 v7, v17, s37, v7
    v_pk_mad_u16 v8, v18, s37, v8
    v_pk_mad_u16 v9, v19, s37, v9
    ds_add_u32 v20, v4 offset:0
    ds_add_u32 v21, v4 offset:0
    ds_add_u32 v22, v4 offset:0
    ds_add_u32 v23, v4 offset:0
    v_pk_mad_u16 v6, v16, s52, v6 op_sel:[1,0,0] op_sel_hi:[1,1,1]
    v_pk_mad_u16 v7, v17, s52, v7 op_sel:[1,0,0] op_sel_hi:[1,1,1]
    v_pk_mad_u16 v8, v18, s52, v8 op_sel:[1,0,0] op_sel_hi:[1,1,1]
    v_pk_mad_u16 v9, v19, s52, v9 op_sel:[1,0,0] op_sel_hi:[1,1,1]
    v_perm_b32 v121, v23, v22, s43
    v_perm_b32 v120, v21, v20, s43
    v_or_b32 v127, 0x40000000, v6
    v_or_b32 v48, 0x40000000, v7
    v_or_b32 v49, 0x40000000, v8
    v_or_b32 v50, 0x40000000, v9
    s_waitcnt vmcnt(16)
    v_perm_b32 v6, v28, v24, s43
    v_perm_b32 v7, v29, v25, s43
    v_perm_b32 v8, v30, v26, s43
    v_perm_b32 v9, v31, v27, s43
    v_mul_hi_u32_u24 v24, 429497, v24
    v_mul_hi_u32_u24 v28, 429497, v28
    v_mul_hi_u32_u24 v25, 429497, v25
    v_mul_hi_u32_u24 v29, 429497, v29
    v_mul_hi_u32_u24 v26, 429497, v26
    v_mul_hi_u32_u24 v30, 429497, v30
    v_mul_hi_u32_u24 v27, 429497, v27
    v_mul_hi_u32_u24 v31, 429497, v31
    v_lshl_or_b32 v24, v28, 16, v24
    v_lshl_or_b32 v25, v29, 16, v25
    v_lshl_or_b32 v26, v30, 16, v26
    v_lshl_or_b32 v27, v31, 16, v27
    v_dot2_u32_u16 v28, v24, s38, 0
    v_dot2_u32_u16 v29, v25, s38, 0
    v_dot2_u32_u16 v30, v26, s38, 0
    v_dot2_u32_u16 v31, v27, s38, 0
    v_pk_mad_u16 v6, v24, s37, v6
    v_pk_mad_u16 v7, v25, s37, v7
    v_pk_mad_u16 v8, v26, s37, v8
    v_pk_mad_u16 v9, v27, s37, v9
    ds_add_u32 v28, v4 offset:0
    ds_add_u32 v29, v4 offset:0
    ds_add_u32 v30, v4 offset:0
    ds_add_u32 v31, v4 offset:0
    v_pk_mad_u16 v6, v24, s52, v6 op_sel:[1,0,0] op_sel_hi:[1,1,1]
    v_pk_mad_u16 v7, v25, s52, v7 op_sel:[1,0,0] op_sel_hi:[1,1,1]
    v_pk_mad_u16 v8, v26, s52, v8 op_sel:[1,0,0] op_sel_hi:[1,1,1]
    v_pk_mad_u16 v9, v27, s52, v9 op_sel:[1,0,0] op_sel_hi:[1,1,1]
    v_perm_b32 v123, v31, v30, s43
    v_perm_b32 v122, v29, v28, s43
    v_or_b32 v52, 0x40000000, v6
    v_or_b32 v53, 0x40000000, v7
    v_or_b32 v54, 0x40000000, v8
    v_or_b32 v56, 0x40000000, v9
    s_waitcnt vmcnt(14)
    v_perm_b32 v6, v36, v32, s43
    v_perm_b32 v7, v37, v33, s43
    v_perm_b32 v8, v38, v34, s43
    v_perm_b32 v9, v39, v35, s43
    v_mul_hi_u32_u24 v32, 429497, v32
    v_mul_hi_u32_u24 v36, 429497, v36
    v_mul_hi_u32_u24 v33, 429497, v33
    v_mul_hi_u32_u24 v37, 429497, v37
    v_mul_hi_u32_u24 v34, 429497, v34
    v_mul_hi_u32_u24 v38, 429497, v38
    v_mul_hi_u32_u24 v35, 429497, v35
    v_mul_hi_u32_u24 v39, 429497, v39
    v_lshl_or_b32 v32, v36, 16, v32
    v_lshl_or_b32 v33, v37, 16, v33
    v_lshl_or_b32 v34, v38, 16, v34
    v_lshl_or_b32 v35, v39, 16, v35
    v_dot2_u32_u16 v36, v32, s38, 0
    v_dot2_u32_u16 v37, v33, s38, 0
    v_dot2_u32_u16 v38, v34, s38, 0
    v_dot2_u32_u16 v39, v35, s38, 0
    v_pk_mad_u16 v6, v32, s37, v6
    v_pk_mad_u16 v7, v33, s37, v7
    v_pk_mad_u16 v8, v34, s37, v8
    v_pk_mad_u16 v9, v35, s37, v9
    ds_add_u32 v36, v4 offset:0
    ds_add_u32 v37, v4 offset:0
    ds_add_u32 v38, v4 offset:0
    ds_add_u32 v39, v4 offset:0
    v_pk_mad_u16 v6, v32, s52, v6 op_sel:[1,0,0] op_sel_hi:[1,1,1]
    v_pk_mad_u16 v7, v33, s52, v7 op_sel:[1,0,0] op_sel_hi:[1,1,1]
    v_pk_mad_u16 v8, v34, s52, v8 op_sel:[1,0,0] op_sel_hi:[1,1,1]
    v_pk_mad_u16 v9, v35, s52, v9 op_sel:[1,0,0] op_sel_hi:[1,1,1]
    v_perm_b32 v125, v39, v38, s43
    v_perm_b32 v124, v37, v36, s43
    v_or_b32 v57, 0x40000000, v6
    v_or_b32 v58, 0x40000000, v7
    v_or_b32 v60, 0x40000000, v8
    v_or_b32 v61, 0x40000000, v9
    s_waitcnt vmcnt(12)
    v_perm_b32 v6, v44, v40, s43
    v_perm_b32 v7, v45, v41, s43
    v_perm_b32 v8, v46, v42, s43
    v_perm_b32 v9, v47, v43, s43
    v_mul_hi_u32_u24 v40, 429497, v40
    v_mul_hi_u32_u24 v44, 429497, v44
    v_mul_hi_u32_u24 v41, 429497, v41
    v_mul_hi_u32_u24 v45, 429497, v45
    v_mul_hi_u32_u24 v42, 429497, v42
    v_mul_hi_u32_u24 v46, 429497, v46
    v_mul_hi_u32_u24 v43, 429497, v43
    v_mul_hi_u32_u24 v47, 429497, v47
    v_lshl_or_b32 v40, v44, 16, v40
    v_lshl_or_b32 v41, v45, 16, v41
    v_lshl_or_b32 v42, v46, 16, v42
    v_lshl_or_b32 v43, v47, 16, v43
    v_dot2_u32_u16 v44, v40, s38, 0
    v_dot2_u32_u16 v45, v41, s38, 0
    v_dot2_u32_u16 v46, v42, s38, 0
    v_dot2_u32_u16 v47, v43, s38, 0
    v_pk_mad_u16 v6, v40, s37, v6
    v_pk_mad_u16 v7, v41, s37, v7
    v_pk_mad_u16 v8, v42, s37, v8
    v_pk_mad_u16 v9, v43, s37, v9
    ds_add_u32 v44, v4 offset:0
    ds_add_u32 v45, v4 offset:0
    ds_add_u32 v46, v4 offset:0
    ds_add_u32 v47, v4 offset:0
    v_pk_mad_u16 v6, v40, s52, v6 op_sel:[1,0,0] op_sel_hi:[1,1,1]
    v_pk_mad_u16 v7, v41, s52, v7 op_sel:[1,0,0] op_sel_hi:[1,1,1]
    v_pk_mad_u16 v8, v42, s52, v8 op_sel:[1,0,0] op_sel_hi:[1,1,1]
    v_pk_mad_u16 v9, v43, s52, v9 op_sel:[1,0,0] op_sel_hi:[1,1,1]
    v_perm_b32 v51, v47, v46, s43
    v_perm_b32 v126, v45, v44, s43
    v_or_b32 v62, 0x40000000, v6
    v_or_b32 v64, 0x40000000, v7
    v_or_b32 v65, 0x40000000, v8
    v_or_b32 v66, 0x40000000, v9
L_p1_join:
    s_waitcnt vmcnt(10)
    v_perm_b32 v6, v76, v72, s43
    v_perm_b32 v7, v77, v73, s43
    v_perm_b32 v8, v78, v74, s43
    v_perm_b32 v9, v79, v75, s43
    v_mul_hi_u32_u24 v72, 429497, v72
    v_mul_hi_u32_u24 v76, 429497, v76
    v_mul_hi_u32_u24 v73, 429497, v73
    v_mul_hi_u32_u24 v77, 429497, v77
    v_mul_hi_u32_u24 v74, 429497, v74
    v_mul_hi_u32_u24 v78, 429497, v78
    v_mul_hi_u32_u24 v75, 429497, v75
    v_mul_hi_u32_u24 v79, 429497, v79
    v_lshl_or_b32 v72, v76, 16, v72
    v_lshl_or_b32 v73, v77, 16, v73
    v_lshl_or_b32 v74, v78, 16, v74
    v_lshl_or_b32 v75, v79, 16, v75
    v_dot2_u32_u16 v76, v72, s38, 0
    v_dot2_u32_u16 v77, v73, s38, 0
    v_dot2_u32_u16 v78, v74, s38, 0
    v_dot2_u32_u16 v79, v75, s38, 0
    v_pk_mad_u16 v6, v72, s37, v6
    v_pk_mad_u16 v7, v73, s37, v7
    v_pk_mad_u16 v8, v74, s37, v8
    v_pk_mad_u16 v9, v75, s37, v9
    ds_add_u32 v76, v4 offset:0
    ds_add_u32 v77, v4 offset:0
    ds_add_u32 v78, v4 offset:0
    ds_add_u32 v79, v4 offset:0
    v_pk_mad_u16 v6, v72, s52, v6 op_sel:[1,0,0] op_sel_hi:[1,1,1]
    v_pk_mad_u16 v7, v73, s52, v7 op_sel:[1,0,0] op_sel_hi:[1,1,1]
    v_pk_mad_u16 v8, v74, s52, v8 op_sel:[1,0,0] op_sel_hi:[1,1,1]
    v_pk_mad_u16 v9, v75, s52, v9 op_sel:[1,0,0] op_sel_hi:[1,1,1]
    v_perm_b32 v59, v79, v78, s43
    v_perm_b32 v55, v77, v76, s43
    v_or_b32 v68, 0x40000000, v6
    v_or_b32 v69, 0x40000000, v7
    v_or_b32 v70, 0x40000000, v8
    v_or_b32 v72, 0x40000000, v9
    s_waitcnt vmcnt(8)
    v_perm_b32 v6, v100, v80, s43
    v_perm_b32 v7, v101, v81, s43
    v_perm_b32 v8, v102, v82, s43
    v_perm_b32 v9, v103, v83, s43
    v_mul_hi_u32_u24 v80, 429497, v80
    v_mul_hi_u32_u24 v100, 429497, v100
    v_mul_hi_u32_u24 v81, 429497, v81
    v_mul_hi_u32_u24 v101, 429497, v101
    v_mul_hi_u32_u24 v82, 429497, v82
    v_mul_hi_u32_u24 v102, 429497, v102
    v_mul_hi_u32_u24 v83, 429497, v83
    v_mul_hi_u32_u24 v103, 429497, v103
    v_lshl_or_b32 v80, v100, 16, v80
    v_lshl_or_b32 v81, v101, 16, v81
    v_lshl_or_b32 v82, v102, 16, v82
    v_lshl_or_b32 v83, v103, 16, v83
    v_dot2_u32_u16 v100, v80, s38, 0
    v_dot2_u32_u16 v101, v81, s38, 0
    v_dot2_u32_u16 v102, v82, s38, 0
    v_dot2_u32_u16 v103, v83, s38, 0
    v_pk_mad_u16 v6, v80, s37, v6
    v_pk_mad_u16 v7, v81, s37, v7
    v_pk_mad_u16 v8, v82, s37, v8
    v_pk_mad_u16 v9, v83, s37, v9
    ds_add_u32 v100, v4 offset:0
    ds_add_u32 v101, v4 offset:0
    ds_add_u32 v102, v4 offset:0
    ds_add_u32 v103, v4 offset:0
    v_pk_mad_u16 v6, v80, s52, v6 op_sel:[1,0,0] op_sel_hi:[1,1,1]
    v_pk_mad_u16 v7, v81, s52, v7 op_sel:[1,0,0] op_sel_hi:[1,1,1]
    v_pk_mad_u16 v8, v82, s52, v8 op_sel:[1,0,0] op_sel_hi:[1,1,1]
    v_pk_mad_u16 v9, v83, s52, v9 op_sel:[1,0,0] op_sel_hi:[1,1,1]
    v_perm_b32 v67, v103, v102, s43
    v_perm_b32 v63, v101, v100, s43
    v_or_b32 v73, 0x40000000, v6
    v_or_b32 v74, 0x40000000, v7
    v_or_b32 v76, 0x40000000, v8
    v_or_b32 v77, 0x40000000, v9
    s_waitcnt vmcnt(6)
    v_perm_b32 v6, v104, v84, s43
    v_perm_b32 v7, v105, v85, s43
    v_perm_b32 v8, v106, v86, s43
    v_perm_b32 v9, v107, v87, s43
    v_mul_hi_u32_u24 v84, 429497, v84
    v_mul_hi_u32_u24 v104, 429497, v104
    v_mul_hi_u32_u24 v85, 429497, v85
    v_mul_hi_u32_u24 v105, 429497, v105
    v_mul_hi_u32_u24 v86, 429497, v86
    v_mul_hi_u32_u24 v106, 429497, v106
    v_mul_hi_u32_u24 v87, 429497, v87
    v_mul_hi_u32_u24 v107, 429497, v107
    v_lshl_or_b32 v84, v104, 16, v84
    v_lshl_or_b32 v85, v105, 16, v85
    v_lshl_or_b32 v86, v106, 16, v86
    v_lshl_or_b32 v87, v107, 16, v87
    v_dot2_u32_u16 v104, v84, s38, 0
    v_dot2_u32_u16 v105, v85, s38, 0
    v_dot2_u32_u16 v106, v86, s38, 0
    v_dot2_u32_u16 v107, v87, s38, 0
    v_pk_mad_u16 v6, v84, s37, v6
    v_pk_mad_u16 v7, v85, s37, v7
    v_pk_mad_u16 v8, v86, s37, v8
    v_pk_mad_u16 v9, v87, s37, v9
    ds_add_u32 v104, v4 offset:0
    ds_add_u32 v105, v4 offset:0
    ds_add_u32 v106, v4 offset:0
    ds_add_u32 v107, v4 offset:0
    v_pk_mad_u16 v6, v84, s52, v6 op_sel:[1,0,0] op_sel_hi:[1,1,1]
    v_pk_mad_u16 v7, v85, s52, v7 op_sel:[1,0,0] op_sel_hi:[1,1,1]
    v_pk_mad_u16 v8, v86, s52, v8 op_sel:[1,0,0] op_sel_hi:[1,1,1]
    v_pk_mad_u16 v9, v87, s52, v9 op_sel:[1,0,0] op_sel_hi:[1,1,1]
    v_perm_b32 v75, v107, v106, s43
    v_perm_b32 v71, v105, v104, s43
    v_or_b32 v78, 0x40000000, v6
    v_or_b32 v80, 0x40000000, v7
    v_or_b32 v81, 0x40000000, v8
    v_or_b32 v82, 0x40000000, v9
    s_waitcnt vmcnt(4)
    v_perm_b32 v6, v108, v88, s43
    v_perm_b32 v7, v109, v89, s43
    v_perm_b32 v8, v110, v90, s43
    v_perm_b32 v9, v111, v91, s43
    v_mul_hi_u32_u24 v88, 429497, v88
    v_mul_hi_u32_u24 v108, 429497, v108
    v_mul_hi_u32_u24 v89, 429497, v89
    v_mul_hi_u32_u24 v109, 429497, v109
    v_mul_hi_u32_u24 v90, 429497, v90
    v_mul_hi_u32_u24 v110, 429497, v110
    v_mul_hi_u32_u24 v91, 429497, v91
    v_mul_hi_u32_u24 v111, 429497, v111
    v_lshl_or_b32 v88, v108, 16, v88
    v_lshl_or_b32 v89, v109, 16, v89
    v_lshl_or_b32 v90, v110, 16, v90
    v_lshl_or_b32 v91, v111, 16, v91
    v_dot2_u32_u16 v108, v88, s38, 0
    v_dot2_u32_u16 v109, v89, s38, 0
    v_dot2_u32_u16 v110, v90, s38, 0
    v_dot2_u32_u16 v111, v91, s38, 0
    v_pk_mad_u16 v6, v88, s37, v6
    v_pk_mad_u16 v7, v89, s37, v7
    v_pk_mad_u16 v8, v90, s37, v8
    v_pk_mad_u16 v9, v91, s37, v9
    ds_add_u32 v108, v4 offset:0
    ds_add_u32 v109, v4 offset:0
    ds_add_u32 v110, v4 offset:0
    ds_add_u32 v111, v4 offset:0
    v_pk_mad_u16 v6, v88, s52, v6 op_sel:[1,0,0] op_sel_hi:[1,1,1]
    v_pk_mad_u16 v7, v89, s52, v7 op_sel:[1,0,0] op_sel_hi:[1,1,1]
    v_pk_mad_u16 v8, v90, s52, v8 op_sel:[1,0,0] op_sel_hi:[1,1,1]
    v_pk_mad_u16 v9, v91, s52, v9 op_sel:[1,0,0] op_sel_hi:[1,1,1]
    v_perm_b32 v83, v111, v110, s43
    v_perm_b32 v79, v109, v108, s43
    v_or_b32 v84, 0x40000000, v6
    v_or_b32 v85, 0x40000000, v7
    v_or_b32 v86, 0x40000000, v8
    v_or_b32 v88, 0x40000000, v9
    s_waitcnt vmcnt(2)
    v_perm_b32 v6, v112, v92, s43
    v_perm_b32 v7, v113, v93, s43
    v_perm_b32 v8, v114, v94, s43
    v_perm_b32 v9, v115, v95, s43
    v_mul_hi_u32_u24 v92, 429497, v92
    v_mul_hi_u32_u24 v112, 429497, v112
    v_mul_hi_u32_u24 v93, 429497, v93
    v_mul_hi_u32_u24 v113, 429497, v113
    v_mul_hi_u32_u24 v94, 429497, v94
    v_mul_hi_u32_u24 v114, 429497, v114
    v_mul_hi_u32_u24 v95, 429497, v95
    v_mul_hi_u32_u24 v115, 429497, v115
    v_lshl_or_b32 v92, v112, 16, v92
    v_lshl_or_b32 v93, v113, 16, v93
    v_lshl_or_b32 v94, v114, 16, v94
    v_lshl_or_b32 v95, v115, 16, v95
    v_dot2_u32_u16 v112, v92, s38, 0
    v_dot2_u32_u16 v113, v93, s38, 0
    v_dot2_u32_u16 v114, v94, s38, 0
    v_dot2_u32_u16 v115, v95, s38, 0
    v_pk_mad_u16 v6, v92, s37, v6
    v_pk_mad_u16 v7, v93, s37, v7
    v_pk_mad_u16 v8, v94, s37, v8
    v_pk_mad_u16 v9, v95, s37, v9
    ds_add_u32 v112, v4 offset:0
    ds_add_u32 v113, v4 offset:0
    ds_add_u32 v114, v4 offset:0
    ds_add_u32 v115, v4 offset:0
    v_pk_mad_u16 v6, v92, s52, v6 op_sel:[1,0,0] op_sel_hi:[1,1,1]
    v_pk_mad_u16 v7, v93, s52, v7 op_sel:[1,0,0] op_sel_hi:[1,1,1]
    v_pk_mad_u16 v8, v94, s52, v8 op_sel:[1,0,0] op_sel_hi:[1,1,1]
    v_pk_mad_u16 v9, v95, s52, v9 op_sel:[1,0,0] op_sel_hi:[1,1,1]
    v_perm_b32 v91, v115, v114, s43
    v_perm_b32 v87, v113, v112, s43
    v_or_b32 v89, 0x40000000, v6
    v_or_b32 v90, 0x40000000, v7
    v_or_b32 v92, 0x40000000, v8
    v_or_b32 v93, 0x40000000, v9
    s_waitcnt vmcnt(0)
    s_mov_b64 exec, s[44:45]
    v_perm_b32 v6, v116, v96, s43
    v_perm_b32 v7, v117, v97, s43
    v_perm_b32 v8, v118, v98, s43
    v_perm_b32 v9, v119, v99, s43
    v_mul_hi_u32_u24 v96, 429497, v96
    v_mul_hi_u32_u24 v116, 429497, v116
    v_mul_hi_u32_u24 v97, 429497, v97
    v_mul_hi_u32_u24 v117, 429497, v117
    v_mul_hi_u32_u24 v98, 429497, v98
    v_mul_hi_u32_u24 v118, 429497, v118
    v_mul_hi_u32_u24 v99, 429497, v99
    v_mul_hi_u32_u24 v119, 429497, v119
    v_lshl_or_b32 v96, v116, 16, v96
    v_lshl_or_b32 v97, v117, 16, v97
    v_lshl_or_b32 v98, v118, 16, v98
    v_lshl_or_b32 v99, v119, 16, v99
    v_dot2_u32_u16 v116, v96, s38, 0
    v_dot2_u32_u16 v117, v97, s38, 0
    v_dot2_u32_u16 v118, v98, s38, 0
    v_dot2_u32_u16 v119, v99, s38, 0
    v_pk_mad_u16 v6, v96, s37, v6
    v_pk_mad_u16 v7, v97, s37, v7
    v_pk_mad_u16 v8, v98, s37, v8
    v_pk_mad_u16 v9, v99, s37, v9
    ds_add_u32 v116, v4 offset:0
    ds_add_u32 v117, v4 offset:0
    ds_add_u32 v118, v4 offset:0
    ds_add_u32 v119, v4 offset:0
    v_pk_mad_u16 v6, v96, s52, v6 op_sel:[1,0,0] op_sel_hi:[1,1,1]
    v_pk_mad_u16 v7, v97, s52, v7 op_sel:[1,0,0] op_sel_hi:[1,1,1]
    v_pk_mad_u16 v8, v98, s52, v8 op_sel:[1,0,0] op_sel_hi:[1,1,1]
    v_pk_mad_u16 v9, v99, s52, v9 op_sel:[1,0,0] op_sel_hi:[1,1,1]
    v_perm_b32 v99, v119, v118, s43
    v_perm_b32 v95, v117, v116, s43
    v_or_b32 v94, 0x40000000, v6
    v_or_b32 v96, 0x40000000, v7
    v_or_b32 v97, 0x40000000, v8
    v_or_b32 v98, 0x40000000, v9
    s_mov_b64 exec, -1
    s_xor_b32 s35, s39, 15
    s_or_b32 s35, s35, s40
    s_cbranch_scc1 L_p1_nodec
    s_mov_b64 exec, 1
    s_waitcnt vmcnt(0)
    v_cmp_eq_u32 vcc, 0, v12
    v_mov_b32 v6, 160896
    s_nop 0
    s_cbranch_vccz L_p1_dec
    v_mov_b32 v12, 48
    v_mov_b32 v13, 0
    buffer_atomic_cmpswap v[12:13], off, s[84:87], 0 sc0
    s_waitcnt vmcnt(0)
    v_cmp_eq_u32 vcc, 0, v12
    s_nop 1
    v_cndmask_b32 v12, v12, 48, vcc
L_p1_dec:
    ds_write_b32 v6, v12
    s_mov_b64 exec, -1
L_p1_nodec:
    s_lshl2_add_u32 s35, s39, 160768
    v_mov_b32 v13, s35
    v_mov_b32 v7, 2.0
    v_and_b32 v6, 63, v0
    s_mov_b32 s36, 160768
    s_lshl_b32 s35, 0x1fffe, s39
    s_and_b32 s35, s35, 0x1ffff
    s_mov_b32 exec_hi, 0
    s_mov_b32 exec_lo, s35
    v_lshl_add_u32 v7, v6, 2, s36
    s_mov_b64 exec, -1
    v_mov_b32 v14, 160832
    s_mov_b32 s53, 2
    s_waitcnt lgkmcnt(0)
    s_barrier
    ds_read_b128 v[8:11], v1 offset:0
    s_cmp_lg_u32 s40, 3
    s_cbranch_scc1 L_p1_kernel_ld_19
    s_add_u32 s36, s42, 4
    s_and_b32 s35, s36, 3
    s_mul_i32 s35, s35, 1047552
    s_lshl_b32 s36, s36, 20
    s_sub_u32 s36, s36, s35
    buffer_store_dwordx4 v[16:19], v3, s[72:75], s36 offen sc1
    s_branch L_p1_kernel_st_20
L_p1_kernel_ld_19:
    s_add_u32 s35, s33, 40960000
    buffer_load_dwordx4 v[16:19], v1, s[8:11], s35 offen nt
L_p1_kernel_st_20:
L_p1_redo:
    s_waitcnt lgkmcnt(0)
    v_min3_u32 v12, v8, v9, v10
    v_min_u32 v12, v12, v11
    v_cmp_gt_u32 vcc, s53, v12
    s_nop 0
    s_mov_b64 s[46:47], vcc
    s_cbranch_vccz L_p1_kernel_nomask_21
    v_cmp_eq_u32 s[56:57], 0, v8
    v_cmp_ge_u32 s[64:65], 1, v8
    v_max_u32 v8, 2, v8
    v_cmp_eq_u32 s[58:59], 0, v9
    v_cmp_ge_u32 s[66:67], 1, v9
    v_max_u32 v9, 2, v9
    v_cmp_eq_u32 s[60:61], 0, v10
    v_cmp_ge_u32 s[68:69], 1, v10
    v_max_u32 v10, 2, v10
    v_cmp_eq_u32 s[62:63], 0, v11
    v_cmp_ge_u32 s[70:71], 1, v11
    v_max_u32 v11, 2, v11
L_p1_kernel_nomask_21:
    v_add_u32 v9, v8, v9
    v_add_u32 v10, v9, v10
    v_add_u32 v11, v10, v11
    s_nop 1
    v_add_u32_dpp v6, v11, v11 row_shr:1 row_mask:0xf bank_mask:0xf bound_ctrl:0
    s_nop 1
    v_add_u32_dpp v6, v6, v6 row_shr:2 row_mask:0xf bank_mask:0xf bound_ctrl:0
    s_nop 1
    v_add_u32_dpp v6, v6, v6 row_shr:4 row_mask:0xf bank_mask:0xf bound_ctrl:0
    s_nop 1
    v_add_u32_dpp v6, v6, v6 row_shr:8 row_mask:0xf bank_mask:0xf bound_ctrl:0
    s_nop 1
    v_add_u32_dpp v6, v6, v6 row_bcast:15 row_mask:0xa bank_mask:0xf
    s_nop 1
    v_add_u32_dpp v6, v6, v6 row_bcast:31 row_mask:0xc bank_mask:0xf
    s_nop 0
    v_readlane_b32 s35, v6, 63
    v_sub_u32 v6, v6, v11
    v_add_u32 v8, v8, v6
    v_mov_b32 v12, s35
    ds_add_u32 v7, v12
    v_add_u32 v9, v9, v6
    v_add_u32 v10, v10, v6
    s_waitcnt lgkmcnt(0)
    s_barrier
    ds_read_b32 v12, v14
    ds_read_b32 v11, v13
    s_waitcnt lgkmcnt(1)
    v_readfirstlane_b32 s54, v12
    s_waitcnt lgkmcnt(0)
    s_cmp_ge_u32 s54, 40063
    s_cbranch_scc0 L_p1_fits
    s_barrier
    v_mov_b32 v12, 0
    ds_write_b32 v7, v12
    s_mov_b32 s53, 0
    s_mov_b32 s55, 1
    s_waitcnt lgkmcnt(0)
    s_barrier
    ds_read_b128 v[8:11], v1 offset:0
    s_branch L_p1_redo
L_p1_fits:
    s_mov_b64 exec, 1
    v_mov_b32 v7, 24576
    ds_write_b16 v7, v12
    s_mov_b64 exec, -1
    v_add_u32 v12, v11, v6
    v_add_u32 v13, v11, v8
    v_add_u32 v14, v11, v9
    v_add_u32 v15, v11, v10
    ds_write_b128 v1, v[12:15] offset:0
    s_add_u32 s35, s54, 2
    s_mul_hi_u32 s35, s35, 1431655766
    v_perm_b32 v15, v15, v14, s43
    v_perm_b32 v14, v13, v12, s43
    ds_write_b64 v2, v[14:15] offset:16384
    s_lshl_b32 s35, s35, 4
    s_add_u32 s35, s35, 217890943
    s_andn2_b32 s35, s35, 127
    s_min_u32 s22, s35, 218104832
    s_waitcnt lgkmcnt(0)
    s_barrier
    s_cmp_lg_u32 s40, 0
    s_cbranch_scc1 L_p1_slot
    v_mov_b32 v6, 160896
    ds_read_b32 v6, v6
    s_waitcnt lgkmcnt(0)
    v_readfirstlane_b32 s90, v6
    s_lshr_b32 s92, s2, 3
    s_add_u32 s91, s2, s90
    s_and_b32 s35, s91, 3
    s_lshl_b32 s35, s35, 5
    s_or_b32 s35, s35, s92
    s_andn2_b32 s36, s35, 1
    s_add_u32 s76, s35, s36
    s_lshr_b32 s91, s91, 2
    s_lshr_b32 s35, s90, 3
    s_xor_b32 s91, s91, s35
    s_lshr_b32 s35, s90, 4
    s_and_b32 s35, s35, s92
    s_xor_b32 s91, s91, s35
    s_and_b32 s91, s91, 1
    s_lshl1_add_u32 s76, s91, s76
    s_lshr_b32 s77, s90, 3
L_p1_slot:
    s_lshl_b32 s35, s40, 8
    s_lshl_b32 s36, s40, 1
    s_and_b32 s36, s36, s77
    s_xor_b32 s36, s36, s40
    s_and_b32 s36, s36, 2
    s_or_b32 s35, s35, s36
    s_xor_b32 s32, s76, s35
    s_and_b32 s32, s32, 1023
    s_lshl_b32 s35, s32, 12
    s_add_u32 s20, s4, s35
    s_addc_u32 s21, s5, 0
    s_nop 0
    v_and_b32 v6, 0xffff, v120
    v_lshrrev_b32 v7, 16, v120
    v_and_b32 v8, 0xffff, v121
    v_lshrrev_b32 v9, 16, v121
    ds_add_rtn_u32 v6, v6, v4 offset:0
    ds_add_rtn_u32 v7, v7, v4 offset:0
    ds_add_rtn_u32 v8, v8, v4 offset:0
    ds_add_rtn_u32 v9, v9, v4 offset:0
    v_and_b32 v10, 0xffff, v122
    v_lshrrev_b32 v11, 16, v122
    v_and_b32 v12, 0xffff, v123
    v_lshrrev_b32 v13, 16, v123
    ds_add_rtn_u32 v10, v10, v4 offset:0
    ds_add_rtn_u32 v11, v11, v4 offset:0
    ds_add_rtn_u32 v12, v12, v4 offset:0
    ds_add_rtn_u32 v13, v13, v4 offset:0
    s_waitcnt lgkmcnt(4)
    v_perm_b32 v120, v7, v6, s43
    v_perm_b32 v121, v9, v8, s43
    v_and_b32 v6, 0xffff, v124
    v_lshrrev_b32 v7, 16, v124
    v_and_b32 v8, 0xffff, v125
    v_lshrrev_b32 v9, 16, v125
    ds_add_rtn_u32 v6, v6, v4 offset:0
    ds_add_rtn_u32 v7, v7, v4 offset:0
    ds_add_rtn_u32 v8, v8, v4 offset:0
    ds_add_rtn_u32 v9, v9, v4 offset:0
    s_waitcnt lgkmcnt(4)
    v_perm_b32 v122, v11, v10, s43
    v_perm_b32 v123, v13, v12, s43
    s_add_u32 s35, s34, 0
    buffer_load_dwordx2 v[100:101], v2, s[16:19], s35 offen nt
    v_and_b32 v10, 0xffff, v126
    v_lshrrev_b32 v11, 16, v126
    v_and_b32 v12, 0xffff, v51
    v_lshrrev_b32 v13, 16, v51
    ds_add_rtn_u32 v10, v10, v4 offset:0
    ds_add_rtn_u32 v11, v11, v4 offset:0
    ds_add_rtn_u32 v12, v12, v4 offset:0
    ds_add_rtn_u32 v13, v13, v4 offset:0
    s_waitcnt lgkmcnt(4)
    v_perm_b32 v124, v7, v6, s43
    v_perm_b32 v125, v9, v8, s43
    s_add_u32 s35, s34, 2097152
    buffer_load_dwordx2 v[102:103], v2, s[16:19], s35 offen nt
    v_and_b32 v6, 0xffff, v55
    v_lshrrev_b32 v7, 16, v55
    v_and_b32 v8, 0xffff, v59
    v_lshrrev_b32 v9, 16, v59
    ds_add_rtn_u32 v6, v6, v4 offset:0
    ds_add_rtn_u32 v7, v7, v4 offset:0
    ds_add_rtn_u32 v8, v8, v4 offset:0
    ds_add_rtn_u32 v9, v9, v4 offset:0
    s_waitcnt lgkmcnt(4)
    v_perm_b32 v126, v11, v10, s43
    v_perm_b32 v51, v13, v12, s43
    s_add_u32 s35, s34, 4194304
    buffer_load_dwordx2 v[104:105], v2, s[16:19], s35 offen nt
    v_and_b32 v10, 0xffff, v63
    v_lshrrev_b32 v11, 16, v63
    v_and_b32 v12, 0xffff, v67
    v_lshrrev_b32 v13, 16, v67
    ds_add_rtn_u32 v10, v10, v4 offset:0
    ds_add_rtn_u32 v11, v11, v4 offset:0
    ds_add_rtn_u32 v12, v12, v4 offset:0
    ds_add_rtn_u32 v13, v13, v4 offset:0
    s_waitcnt lgkmcnt(4)
    v_perm_b32 v55, v7, v6, s43
    v_perm_b32 v59, v9, v8, s43
    v_and_b32 v6, 0xffff, v71
    v_lshrrev_b32 v7, 16, v71
    v_and_b32 v8, 0xffff, v75
    v_lshrrev_b32 v9, 16, v75
    ds_add_rtn_u32 v6, v6, v4 offset:0
    ds_add_rtn_u32 v7, v7, v4 offset:0
    ds_add_rtn_u32 v8, v8, v4 offset:0
    ds_add_rtn_u32 v9, v9, v4 offset:0
    s_waitcnt lgkmcnt(4)
    v_perm_b32 v63, v11, v10, s43
    v_perm_b32 v67, v13, v12, s43
    s_add_u32 s35, s34, 6291456
    buffer_load_dwordx2 v[106:107], v2, s[16:19], s35 offen nt
    v_and_b32 v10, 0xffff, v79
    v_lshrrev_b32 v11, 16, v79
    v_and_b32 v12, 0xffff, v83
    v_lshrrev_b32 v13, 16, v83
    ds_add_rtn_u32 v10, v10, v4 offset:0
    ds_add_rtn_u32 v11, v11, v4 offset:0
    ds_add_rtn_u32 v12, v12, v4 offset:0
    ds_add_rtn_u32 v13, v13, v4 offset:0
    s_waitcnt lgkmcnt(4)
    v_perm_b32 v71, v7, v6, s43
    v_perm_b32 v75, v9, v8, s43
    s_add_u32 s35, s34, 8388608
    buffer_load_dwordx2 v[108:109], v2, s[16:19], s35 offen nt
    v_and_b32 v6, 0xffff, v87
    v_lshrrev_b32 v7, 16, v87
    v_and_b32 v8, 0xffff, v91
    v_lshrrev_b32 v9, 16, v91
    ds_add_rtn_u32 v6, v6, v4 offset:0
    ds_add_rtn_u32 v7, v7, v4 offset:0
    ds_add_rtn_u32 v8, v8, v4 offset:0
    ds_add_rtn_u32 v9, v9, v4 offset:0
    s_waitcnt lgkmcnt(4)
    v_perm_b32 v79, v11, v10, s43
    v_perm_b32 v83, v13, v12, s43
    s_add_u32 s35, s34, 10485760
    buffer_load_dwordx2 v[110:111], v2, s[16:19], s35 offen nt
    s_mov_b64 exec, s[44:45]
    v_and_b32 v10, 0xffff, v95
    v_lshrrev_b32 v11, 16, v95
    v_and_b32 v12, 0xffff, v99
    v_lshrrev_b32 v13, 16, v99
    ds_add_rtn_u32 v10, v10, v4 offset:0
    ds_add_rtn_u32 v11, v11, v4 offset:0
    ds_add_rtn_u32 v12, v12, v4 offset:0
    ds_add_rtn_u32 v13, v13, v4 offset:0
    s_mov_b64 exec, -1
    s_waitcnt lgkmcnt(4)
    v_perm_b32 v87, v7, v6, s43
    v_perm_b32 v91, v9, v8, s43
    s_waitcnt lgkmcnt(0)
    v_perm_b32 v95, v11, v10, s43
    v_perm_b32 v99, v13, v12, s43
    s_add_u32 s35, s34, 12582912
    buffer_load_dwordx2 v[112:113], v2, s[16:19], s35 offen nt
    s_cmp_gt_u32 s39, 8
    s_cbranch_scc1 L_p1_kernel_notab_22
    v_lshrrev_b32 v6, 1, v0
    v_mul_u32_u24 v7, 1009, v6
    v_lshrrev_b32 v7, 16, v7
    v_mul_u32_u24 v7, 959, v7
    v_and_b32 v8, 1, v0
    v_lshl_add_u32 v7, v8, 9, v7
    v_add_lshl_u32 v13, v7, v6, 1
    ds_read_u16 v6, v13 offset:16384
    ds_read_u16 v7, v13 offset:16512
    ds_read_u16 v8, v13 offset:16640
    ds_read_u16 v9, v13 offset:16768
    ds_read_u16 v10, v13 offset:16896
    ds_read_u16 v11, v13 offset:17024
    ds_read_u16 v12, v13 offset:17152
    ds_read_u16 v13, v13 offset:17280
    s_mul_i32 s35, s32, 8320
    s_add_u32 s26, s35, 8320
    s_waitcnt lgkmcnt(6)
    v_perm_b32 v6, v7, v6, s43
    s_waitcnt lgkmcnt(4)
    v_perm_b32 v7, v9, v8, s43
    s_waitcnt lgkmcnt(2)
    v_perm_b32 v8, v11, v10, s43
    s_waitcnt lgkmcnt(0)
    v_perm_b32 v9, v13, v12, s43
    buffer_store_dwordx4 v[6:9], v1, s[24:27], s35 offen sc1
    s_nop 1
L_p1_kernel_notab_22:
    s_barrier
    v_mov_b32 v10, 16384
    v_mad_u32_u16 v6, v120, s50, v10 op_sel:[0,0,0,0]
    v_mad_u32_u16 v7, v120, s50, v10 op_sel:[1,0,0,0]
    v_mad_u32_u16 v8, v121, s50, v10 op_sel:[0,0,0,0]
    v_mad_u32_u16 v9, v121, s50, v10 op_sel:[1,0,0,0]
    v_add_u32_sdwa v6, v6, v120 dst_sel:DWORD dst_unused:UNUSED_PAD src0_sel:WORD_1 src1_sel:WORD_0
    v_add_u32_sdwa v7, v7, v120 dst_sel:DWORD dst_unused:UNUSED_PAD src0_sel:WORD_1 src1_sel:WORD_1
    v_add_u32_sdwa v8, v8, v121 dst_sel:DWORD dst_unused:UNUSED_PAD src0_sel:WORD_1 src1_sel:WORD_0
    v_add_u32_sdwa v9, v9, v121 dst_sel:DWORD dst_unused:UNUSED_PAD src0_sel:WORD_1 src1_sel:WORD_1
    v_add_u32 v6, v6, v6
    v_add_u32 v7, v7, v7
    v_add_u32 v8, v8, v8
    v_add_u32 v9, v9, v9
    s_waitcnt vmcnt(6)
    v_pk_maximum3_f16 v5, v100, v101, v5
    ds_write_b16 v6, v100 offset:24704
    ds_write_b16_d16_hi v7, v100 offset:24704
    ds_write_b16 v8, v101 offset:24704
    ds_write_b16_d16_hi v9, v101 offset:24704
    s_add_u32 s35, s34, 14680064
    buffer_load_dwordx2 v[114:115], v2, s[16:19], s35 offen nt
    v_mad_u32_u16 v6, v122, s50, v10 op_sel:[0,0,0,0]
    v_mad_u32_u16 v7, v122, s50, v10 op_sel:[1,0,0,0]
    v_mad_u32_u16 v8, v123, s50, v10 op_sel:[0,0,0,0]
    v_mad_u32_u16 v9, v123, s50, v10 op_sel:[1,0,0,0]
    v_add_u32_sdwa v6, v6, v122 dst_sel:DWORD dst_unused:UNUSED_PAD src0_sel:WORD_1 src1_sel:WORD_0
    v_add_u32_sdwa v7, v7, v122 dst_sel:DWORD dst_unused:UNUSED_PAD src0_sel:WORD_1 src1_sel:WORD_1
    v_add_u32_sdwa v8, v8, v123 dst_sel:DWORD dst_unused:UNUSED_PAD src0_sel:WORD_1 src1_sel:WORD_0
    v_add_u32_sdwa v9, v9, v123 dst_sel:DWORD dst_unused:UNUSED_PAD src0_sel:WORD_1 src1_sel:WORD_1
    v_add_u32 v6, v6, v6
    v_add_u32 v7, v7, v7
    v_add_u32 v8, v8, v8
    v_add_u32 v9, v9, v9
    s_waitcnt vmcnt(6)
    v_pk_maximum3_f16 v5, v102, v103, v5
    ds_write_b16 v6, v102 offset:24704
    ds_write_b16_d16_hi v7, v102 offset:24704
    ds_write_b16 v8, v103 offset:24704
    ds_write_b16_d16_hi v9, v103 offset:24704
    s_add_u32 s35, s34, 16777216
    buffer_load_dwordx2 v[116:117], v2, s[16:19], s35 offen nt
    v_mad_u32_u16 v6, v124, s50, v10 op_sel:[0,0,0,0]
    v_mad_u32_u16 v7, v124, s50, v10 op_sel:[1,0,0,0]
    v_mad_u32_u16 v8, v125, s50, v10 op_sel:[0,0,0,0]
    v_mad_u32_u16 v9, v125, s50, v10 op_sel:[1,0,0,0]
    v_add_u32_sdwa v6, v6, v124 dst_sel:DWORD dst_unused:UNUSED_PAD src0_sel:WORD_1 src1_sel:WORD_0
    v_add_u32_sdwa v7, v7, v124 dst_sel:DWORD dst_unused:UNUSED_PAD src0_sel:WORD_1 src1_sel:WORD_1
    v_add_u32_sdwa v8, v8, v125 dst_sel:DWORD dst_unused:UNUSED_PAD src0_sel:WORD_1 src1_sel:WORD_0
    v_add_u32_sdwa v9, v9, v125 dst_sel:DWORD dst_unused:UNUSED_PAD src0_sel:WORD_1 src1_sel:WORD_1
    v_add_u32 v6, v6, v6
    v_add_u32 v7, v7, v7
    v_add_u32 v8, v8, v8
    v_add_u32 v9, v9, v9
    s_waitcnt vmcnt(6)
    v_pk_maximum3_f16 v5, v104, v105, v5
    ds_write_b16 v6, v104 offset:24704
    ds_write_b16_d16_hi v7, v104 offset:24704
    ds_write_b16 v8, v105 offset:24704
    ds_write_b16_d16_hi v9, v105 offset:24704
    s_add_u32 s35, s34, 18874368
    s_sub_u32 s35, s35, s49
    v_cndmask_b32 v118, 2.0, v2, s[44:45]
    buffer_load_dwordx2 v[118:119], v118, s[16:19], s35 offen nt
    v_mad_u32_u16 v6, v126, s50, v10 op_sel:[0,0,0,0]
    v_mad_u32_u16 v7, v126, s50, v10 op_sel:[1,0,0,0]
    v_mad_u32_u16 v8, v51, s50, v10 op_sel:[0,0,0,0]
    v_mad_u32_u16 v9, v51, s50, v10 op_sel:[1,0,0,0]
    v_add_u32_sdwa v6, v6, v126 dst_sel:DWORD dst_unused:UNUSED_PAD src0_sel:WORD_1 src1_sel:WORD_0
    v_add_u32_sdwa v7, v7, v126 dst_sel:DWORD dst_unused:UNUSED_PAD src0_sel:WORD_1 src1_sel:WORD_1
    v_add_u32_sdwa v8, v8, v51 dst_sel:DWORD dst_unused:UNUSED_PAD src0_sel:WORD_1 src1_sel:WORD_0
    v_add_u32_sdwa v9, v9, v51 dst_sel:DWORD dst_unused:UNUSED_PAD src0_sel:WORD_1 src1_sel:WORD_1
    v_add_u32 v6, v6, v6
    v_add_u32 v7, v7, v7
    v_add_u32 v8, v8, v8
    v_add_u32 v9, v9, v9
    s_waitcnt vmcnt(6)
    v_pk_maximum3_f16 v5, v106, v107, v5
    ds_write_b16 v6, v106 offset:24704
    ds_write_b16_d16_hi v7, v106 offset:24704
    ds_write_b16 v8, v107 offset:24704
    ds_write_b16_d16_hi v9, v107 offset:24704
    v_mad_u32_u16 v6, v55, s50, v10 op_sel:[0,0,0,0]
    v_mad_u32_u16 v7, v55, s50, v10 op_sel:[1,0,0,0]
    v_mad_u32_u16 v8, v59, s50, v10 op_sel:[0,0,0,0]
    v_mad_u32_u16 v9, v59, s50, v10 op_sel:[1,0,0,0]
    v_add_u32_sdwa v6, v6, v55 dst_sel:DWORD dst_unused:UNUSED_PAD src0_sel:WORD_1 src1_sel:WORD_0
    v_add_u32_sdwa v7, v7, v55 dst_sel:DWORD dst_unused:UNUSED_PAD src0_sel:WORD_1 src1_sel:WORD_1
    v_add_u32_sdwa v8, v8, v59 dst_sel:DWORD dst_unused:UNUSED_PAD src0_sel:WORD_1 src1_sel:WORD_0
    v_add_u32_sdwa v9, v9, v59 dst_sel:DWORD dst_unused:UNUSED_PAD src0_sel:WORD_1 src1_sel:WORD_1
    v_add_u32 v6, v6, v6
    v_add_u32 v7, v7, v7
    v_add_u32 v8, v8, v8
    v_add_u32 v9, v9, v9
    s_waitcnt vmcnt(5)
    v_pk_maximum3_f16 v5, v108, v109, v5
    ds_write_b16 v6, v108 offset:24704
    ds_write_b16_d16_hi v7, v108 offset:24704
    ds_write_b16 v8, v109 offset:24704
    ds_write_b16_d16_hi v9, v109 offset:24704
    s_cmp_lg_u32 s40, 3
    s_cbranch_scc1 L_p1_kernel_ld_23
    s_add_u32 s36, s42, 6
    s_and_b32 s35, s36, 3
    s_mul_i32 s35, s35, 1047552
    s_lshl_b32 s36, s36, 20
    s_sub_u32 s36, s36, s35
    buffer_store_dwordx4 v[20:23], v3, s[72:75], s36 offen sc1
    s_branch L_p1_kernel_st_24
L_p1_kernel_ld_23:
    s_add_u32 s35, s33, 40960000
    buffer_load_dwordx4 v[20:23], v1, s[12:15], s35 offen nt
L_p1_kernel_st_24:
    v_mad_u32_u16 v6, v63, s50, v10 op_sel:[0,0,0,0]
    v_mad_u32_u16 v7, v63, s50, v10 op_sel:[1,0,0,0]
    v_mad_u32_u16 v8, v67, s50, v10 op_sel:[0,0,0,0]
    v_mad_u32_u16 v9, v67, s50, v10 op_sel:[1,0,0,0]
    v_add_u32_sdwa v6, v6, v63 dst_sel:DWORD dst_unused:UNUSED_PAD src0_sel:WORD_1 src1_sel:WORD_0
    v_add_u32_sdwa v7, v7, v63 dst_sel:DWORD dst_unused:UNUSED_PAD src0_sel:WORD_1 src1_sel:WORD_1
    v_add_u32_sdwa v8, v8, v67 dst_sel:DWORD dst_unused:UNUSED_PAD src0_sel:WORD_1 src1_sel:WORD_0
    v_add_u32_sdwa v9, v9, v67 dst_sel:DWORD dst_unused:UNUSED_PAD src0_sel:WORD_1 src1_sel:WORD_1
    v_add_u32 v6, v6, v6
    v_add_u32 v7, v7, v7
    v_add_u32 v8, v8, v8
    v_add_u32 v9, v9, v9
    s_waitcnt vmcnt(5)
    v_pk_maximum3_f16 v5, v110, v111, v5
    ds_write_b16 v6, v110 offset:24704
    ds_write_b16_d16_hi v7, v110 offset:24704
    ds_write_b16 v8, v111 offset:24704
    ds_write_b16_d16_hi v9, v111 offset:24704
    v_mad_u32_u16 v6, v71, s50, v10 op_sel:[0,0,0,0]
    v_mad_u32_u16 v7, v71, s50, v10 op_sel:[1,0,0,0]
    v_mad_u32_u16 v8, v75, s50, v10 op_sel:[0,0,0,0]
    v_mad_u32_u16 v9, v75, s50, v10 op_sel:[1,0,0,0]
    v_add_u32_sdwa v6, v6, v71 dst_sel:DWORD dst_unused:UNUSED_PAD src0_sel:WORD_1 src1_sel:WORD_0
    v_add_u32_sdwa v7, v7, v71 dst_sel:DWORD dst_unused:UNUSED_PAD src0_sel:WORD_1 src1_sel:WORD_1
    v_add_u32_sdwa v8, v8, v75 dst_sel:DWORD dst_unused:UNUSED_PAD src0_sel:WORD_1 src1_sel:WORD_0
    v_add_u32_sdwa v9, v9, v75 dst_sel:DWORD dst_unused:UNUSED_PAD src0_sel:WORD_1 src1_sel:WORD_1
    v_add_u32 v6, v6, v6
    v_add_u32 v7, v7, v7
    v_add_u32 v8, v8, v8
    v_add_u32 v9, v9, v9
    s_waitcnt vmcnt(4)
    v_pk_maximum3_f16 v5, v112, v113, v5
    ds_write_b16 v6, v112 offset:24704
    ds_write_b16_d16_hi v7, v112 offset:24704
    ds_write_b16 v8, v113 offset:24704
    ds_write_b16_d16_hi v9, v113 offset:24704
    v_mad_u32_u16 v6, v79, s50, v10 op_sel:[0,0,0,0]
    v_mad_u32_u16 v7, v79, s50, v10 op_sel:[1,0,0,0]
    v_mad_u32_u16 v8, v83, s50, v10 op_sel:[0,0,0,0]
    v_mad_u32_u16 v9, v83, s50, v10 op_sel:[1,0,0,0]
    v_add_u32_sdwa v6, v6, v79 dst_sel:DWORD dst_unused:UNUSED_PAD src0_sel:WORD_1 src1_sel:WORD_0
    v_add_u32_sdwa v7, v7, v79 dst_sel:DWORD dst_unused:UNUSED_PAD src0_sel:WORD_1 src1_sel:WORD_1
    v_add_u32_sdwa v8, v8, v83 dst_sel:DWORD dst_unused:UNUSED_PAD src0_sel:WORD_1 src1_sel:WORD_0
    v_add_u32_sdwa v9, v9, v83 dst_sel:DWORD dst_unused:UNUSED_PAD src0_sel:WORD_1 src1_sel:WORD_1
    v_add_u32 v6, v6, v6
    v_add_u32 v7, v7, v7
    v_add_u32 v8, v8, v8
    v_add_u32 v9, v9, v9
    s_waitcnt vmcnt(3)
    v_pk_maximum3_f16 v5, v114, v115, v5
    ds_write_b16 v6, v114 offset:24704
    ds_write_b16_d16_hi v7, v114 offset:24704
    ds_write_b16 v8, v115 offset:24704
    ds_write_b16_d16_hi v9, v115 offset:24704
    s_cmp_lg_u32 s40, 3
    s_cbranch_scc1 L_p1_kernel_ld_25
    s_add_u32 s36, s42, 7
    s_and_b32 s35, s36, 3
    s_mul_i32 s35, s35, 1047552
    s_lshl_b32 s36, s36, 20
    s_sub_u32 s36, s36, s35
    buffer_store_dwordx4 v[24:27], v3, s[72:75], s36 offen sc1
    s_branch L_p1_kernel_st_26
L_p1_kernel_ld_25:
    s_add_u32 s35, s33, 45154304
    buffer_load_dwordx4 v[24:27], v1, s[8:11], s35 offen nt
L_p1_kernel_st_26:
    v_mad_u32_u16 v6, v87, s50, v10 op_sel:[0,0,0,0]
    v_mad_u32_u16 v7, v87, s50, v10 op_sel:[1,0,0,0]
    v_mad_u32_u16 v8, v91, s50, v10 op_sel:[0,0,0,0]
    v_mad_u32_u16 v9, v91, s50, v10 op_sel:[1,0,0,0]
    v_add_u32_sdwa v6, v6, v87 dst_sel:DWORD dst_unused:UNUSED_PAD src0_sel:WORD_1 src1_sel:WORD_0
    v_add_u32_sdwa v7, v7, v87 dst_sel:DWORD dst_unused:UNUSED_PAD src0_sel:WORD_1 src1_sel:WORD_1
    v_add_u32_sdwa v8, v8, v91 dst_sel:DWORD dst_unused:UNUSED_PAD src0_sel:WORD_1 src1_sel:WORD_0
    v_add_u32_sdwa v9, v9, v91 dst_sel:DWORD dst_unused:UNUSED_PAD src0_sel:WORD_1 src1_sel:WORD_1
    v_add_u32 v6, v6, v6
    v_add_u32 v7, v7, v7
    v_add_u32 v8, v8, v8
    v_add_u32 v9, v9, v9
    s_waitcnt vmcnt(3)
    v_pk_maximum3_f16 v5, v116, v117, v5
    ds_write_b16 v6, v116 offset:24704
    ds_write_b16_d16_hi v7, v116 offset:24704
    ds_write_b16 v8, v117 offset:24704
    ds_write_b16_d16_hi v9, v117 offset:24704
    s_mov_b64 exec, s[44:45]
    v_mad_u32_u16 v6, v95, s50, v10 op_sel:[0,0,0,0]
    v_mad_u32_u16 v7, v95, s50, v10 op_sel:[1,0,0,0]
    v_mad_u32_u16 v8, v99, s50, v10 op_sel:[0,0,0,0]
    v_mad_u32_u16 v9, v99, s50, v10 op_sel:[1,0,0,0]
    v_add_u32_sdwa v6, v6, v95 dst_sel:DWORD dst_unused:UNUSED_PAD src0_sel:WORD_1 src1_sel:WORD_0
    v_add_u32_sdwa v7, v7, v95 dst_sel:DWORD dst_unused:UNUSED_PAD src0_sel:WORD_1 src1_sel:WORD_1
    v_add_u32_sdwa v8, v8, v99 dst_sel:DWORD dst_unused:UNUSED_PAD src0_sel:WORD_1 src1_sel:WORD_0
    v_add_u32_sdwa v9, v9, v99 dst_sel:DWORD dst_unused:UNUSED_PAD src0_sel:WORD_1 src1_sel:WORD_1
    v_add_u32 v6, v6, v6
    v_add_u32 v7, v7, v7
    v_add_u32 v8, v8, v8
    v_add_u32 v9, v9, v9
    s_waitcnt vmcnt(2)
    v_pk_maximum3_f16 v5, v118, v119, v5
    ds_write_b16 v6, v118 offset:24704
    ds_write_b16_d16_hi v7, v118 offset:24704
    ds_write_b16 v8, v119 offset:24704
    ds_write_b16_d16_hi v9, v119 offset:24704
    s_mov_b64 exec, -1
    s_mul_i32 s35, s39, 6144
    v_add_u32 v12, s35, v2
    s_waitcnt lgkmcnt(0)
    s_barrier
    ds_read_b64 v[100:101], v12 offset:26240
    ds_read_b64 v[102:103], v12 offset:26752
    ds_read_b64 v[104:105], v12 offset:27264
    ds_read_b64 v[106:107], v12 offset:27776
    ds_read_b64 v[108:109], v12 offset:28288
    ds_read_b64 v[110:111], v12 offset:28800
    ds_read_b64 v[112:113], v12 offset:29312
    ds_read_b64 v[114:115], v12 offset:29824
    ds_read_b64 v[116:117], v12 offset:30336
    ds_read_b64 v[118:119], v12 offset:30848
    ds_read_b64 v[6:7], v12 offset:31360
    ds_read_b64 v[8:9], v12 offset:24704
    ds_read_b64 v[10:11], v12 offset:25216
    ds_read_b64 v[12:13], v12 offset:25728
    s_cmp_lg_u32 s40, 3
    s_cbranch_scc1 L_p1_kernel_ld_27
    s_add_u32 s36, s42, 8
    s_and_b32 s35, s36, 3
    s_mul_i32 s35, s35, 1047552
    s_lshl_b32 s36, s36, 20
    s_sub_u32 s36, s36, s35
    buffer_store_dwordx4 v[28:31], v3, s[72:75], s36 offen sc1
    s_branch L_p1_kernel_st_28
L_p1_kernel_ld_27:
    s_add_u32 s35, s33, 45154304
    buffer_load_dwordx4 v[28:31], v1, s[12:15], s35 offen nt
L_p1_kernel_st_28:
    s_waitcnt lgkmcnt(0)
    s_barrier
    v_perm_b32 v101, v103, v101, s43
    v_perm_b32 v105, v107, v105, s43
    v_perm_b32 v109, v111, v109, s43
    v_perm_b32 v113, v115, v113, s43
    v_perm_b32 v117, v119, v117, s43
    v_perm_b32 v119, v9, v7, s43
    v_perm_b32 v11, v13, v11, s43
    v_mov_b32 v103, v6
    v_mov_b32 v107, v8
    v_mov_b32 v111, v10
    v_mov_b32 v115, v12
    s_lshl_b32 s35, s54, 2
    v_mov_b32 v6, s35
    v_mov_b32 v7, 0
    v_mov_b32 v10, 1140817920
    s_mov_b64 exec, 1
    ds_write2_b32 v6, v7, v7 offset0:0 offset1:1
    s_cmp_eq_u64 s[46:47], 0
    s_cbranch_scc1 L_p1_kernel_nonull_29
    s_mov_b64 exec, s[64:65]
    v_lshlrev_b32_sdwa v6, 2, v14 dst_sel:DWORD dst_unused:UNUSED_PAD src0_sel:DWORD src1_sel:WORD_0
    ds_write_b32 v6, v7 offset:4
    s_mov_b64 exec, s[56:57]
    ds_write_b32 v6, v7
    s_mov_b64 exec, s[66:67]
    v_lshlrev_b32_sdwa v6, 2, v14 dst_sel:DWORD dst_unused:UNUSED_PAD src0_sel:DWORD src1_sel:WORD_1
    ds_write_b32 v6, v7 offset:4
    s_mov_b64 exec, s[58:59]
    ds_write_b32 v6, v7
    s_mov_b64 exec, s[68:69]
    v_lshlrev_b32_sdwa v6, 2, v15 dst_sel:DWORD dst_unused:UNUSED_PAD src0_sel:DWORD src1_sel:WORD_0
    ds_write_b32 v6, v7 offset:4
    s_mov_b64 exec, s[60:61]
    ds_write_b32 v6, v7
    s_mov_b64 exec, s[70:71]
    v_lshlrev_b32_sdwa v6, 2, v15 dst_sel:DWORD dst_unused:UNUSED_PAD src0_sel:DWORD src1_sel:WORD_1
    ds_write_b32 v6, v7 offset:4
    s_mov_b64 exec, s[62:63]
    ds_write_b32 v6, v7
L_p1_kernel_nonull_29:
    s_mov_b64 exec, -1
    v_lshlrev_b32_sdwa v6, 2, v120 dst_sel:DWORD dst_unused:UNUSED_PAD src0_sel:DWORD src1_sel:WORD_0
    v_lshlrev_b32_sdwa v7, 2, v120 dst_sel:DWORD dst_unused:UNUSED_PAD src0_sel:DWORD src1_sel:WORD_1
    v_lshlrev_b32_sdwa v8, 2, v121 dst_sel:DWORD dst_unused:UNUSED_PAD src0_sel:DWORD src1_sel:WORD_0
    v_lshlrev_b32_sdwa v9, 2, v121 dst_sel:DWORD dst_unused:UNUSED_PAD src0_sel:DWORD src1_sel:WORD_1
    ds_write_b32 v6, v127
    ds_write_b32 v7, v48
    ds_write_b32 v8, v49
    ds_write_b32 v9, v50
    v_lshlrev_b32_sdwa v6, 2, v122 dst_sel:DWORD dst_unused:UNUSED_PAD src0_sel:DWORD src1_sel:WORD_0
    v_lshlrev_b32_sdwa v7, 2, v122 dst_sel:DWORD dst_unused:UNUSED_PAD src0_sel:DWORD src1_sel:WORD_1
    v_lshlrev_b32_sdwa v8, 2, v123 dst_sel:DWORD dst_unused:UNUSED_PAD src0_sel:DWORD src1_sel:WORD_0
    v_lshlrev_b32_sdwa v9, 2, v123 dst_sel:DWORD dst_unused:UNUSED_PAD src0_sel:DWORD src1_sel:WORD_1
    ds_write_b32 v6, v52
    ds_write_b32 v7, v53
    ds_write_b32 v8, v54
    ds_write_b32 v9, v56
    s_cmp_lg_u32 s40, 3
    s_cbranch_scc1 L_p1_kernel_ld_30
    s_add_u32 s36, s42, 9
    s_and_b32 s35, s36, 3
    s_mul_i32 s35, s35, 1047552
    s_lshl_b32 s36, s36, 20
    s_sub_u32 s36, s36, s35
    buffer_store_dwordx4 v[32:35], v3, s[72:75], s36 offen sc1
    s_branch L_p1_kernel_st_31
L_p1_kernel_ld_30:
    s_add_u32 s35, s33, 49348608
    buffer_load_dwordx4 v[32:35], v1, s[8:11], s35 offen nt
L_p1_kernel_st_31:
    v_lshlrev_b32_sdwa v6, 2, v124 dst_sel:DWORD dst_unused:UNUSED_PAD src0_sel:DWORD src1_sel:WORD_0
    v_lshlrev_b32_sdwa v7, 2, v124 dst_sel:DWORD dst_unused:UNUSED_PAD src0_sel:DWORD src1_sel:WORD_1
    v_lshlrev_b32_sdwa v8, 2, v125 dst_sel:DWORD dst_unused:UNUSED_PAD src0_sel:DWORD src1_sel:WORD_0
    v_lshlrev_b32_sdwa v9, 2, v125 dst_sel:DWORD dst_unused:UNUSED_PAD src0_sel:DWORD src1_sel:WORD_1
    ds_write_b32 v6, v57
    ds_write_b32 v7, v58
    ds_write_b32 v8, v60
    ds_write_b32 v9, v61
    v_lshlrev_b32_sdwa v6, 2, v126 dst_sel:DWORD dst_unused:UNUSED_PAD src0_sel:DWORD src1_sel:WORD_0
    v_lshlrev_b32_sdwa v7, 2, v126 dst_sel:DWORD dst_unused:UNUSED_PAD src0_sel:DWORD src1_sel:WORD_1
    v_lshlrev_b32_sdwa v8, 2, v51 dst_sel:DWORD dst_unused:UNUSED_PAD src0_sel:DWORD src1_sel:WORD_0
    v_lshlrev_b32_sdwa v9, 2, v51 dst_sel:DWORD dst_unused:UNUSED_PAD src0_sel:DWORD src1_sel:WORD_1
    ds_write_b32 v6, v62
    ds_write_b32 v7, v64
    ds_write_b32 v8, v65
    ds_write_b32 v9, v66
    v_lshlrev_b32_sdwa v6, 2, v55 dst_sel:DWORD dst_unused:UNUSED_PAD src0_sel:DWORD src1_sel:WORD_0
    v_lshlrev_b32_sdwa v7, 2, v55 dst_sel:DWORD dst_unused:UNUSED_PAD src0_sel:DWORD src1_sel:WORD_1
    v_lshlrev_b32_sdwa v8, 2, v59 dst_sel:DWORD dst_unused:UNUSED_PAD src0_sel:DWORD src1_sel:WORD_0
    v_lshlrev_b32_sdwa v9, 2, v59 dst_sel:DWORD dst_unused:UNUSED_PAD src0_sel:DWORD src1_sel:WORD_1
    ds_write_b32 v6, v68
    ds_write_b32 v7, v69
    ds_write_b32 v8, v70
    ds_write_b32 v9, v72
    s_cmp_lg_u32 s40, 3
    s_cbranch_scc1 L_p1_kernel_ld_32
    s_add_u32 s36, s42, 10
    s_and_b32 s35, s36, 3
    s_mul_i32 s35, s35, 1047552
    s_lshl_b32 s36, s36, 20
    s_sub_u32 s36, s36, s35
    buffer_store_dwordx4 v[36:39], v3, s[72:75], s36 offen sc1
    s_branch L_p1_kernel_st_33
L_p1_kernel_ld_32:
    s_add_u32 s35, s33, 49348608
    buffer_load_dwordx4 v[36:39], v1, s[12:15], s35 offen nt
L_p1_kernel_st_33:
    v_lshlrev_b32_sdwa v6, 2, v63 dst_sel:DWORD dst_unused:UNUSED_PAD src0_sel:DWORD src1_sel:WORD_0
    v_lshlrev_b32_sdwa v7, 2, v63 dst_sel:DWORD dst_unused:UNUSED_PAD src0_sel:DWORD src1_sel:WORD_1
    v_lshlrev_b32_sdwa v8, 2, v67 dst_sel:DWORD dst_unused:UNUSED_PAD src0_sel:DWORD src1_sel:WORD_0
    v_lshlrev_b32_sdwa v9, 2, v67 dst_sel:DWORD dst_unused:UNUSED_PAD src0_sel:DWORD src1_sel:WORD_1
    ds_write_b32 v6, v73
    ds_write_b32 v7, v74
    ds_write_b32 v8, v76
    ds_write_b32 v9, v77
    v_lshlrev_b32_sdwa v6, 2, v71 dst_sel:DWORD dst_unused:UNUSED_PAD src0_sel:DWORD src1_sel:WORD_0
    v_lshlrev_b32_sdwa v7, 2, v71 dst_sel:DWORD dst_unused:UNUSED_PAD src0_sel:DWORD src1_sel:WORD_1
    v_lshlrev_b32_sdwa v8, 2, v75 dst_sel:DWORD dst_unused:UNUSED_PAD src0_sel:DWORD src1_sel:WORD_0
    v_lshlrev_b32_sdwa v9, 2, v75 dst_sel:DWORD dst_unused:UNUSED_PAD src0_sel:DWORD src1_sel:WORD_1
    ds_write_b32 v6, v78
    ds_write_b32 v7, v80
    ds_write_b32 v8, v81
    ds_write_b32 v9, v82
    v_lshlrev_b32_sdwa v6, 2, v79 dst_sel:DWORD dst_unused:UNUSED_PAD src0_sel:DWORD src1_sel:WORD_0
    v_lshlrev_b32_sdwa v7, 2, v79 dst_sel:DWORD dst_unused:UNUSED_PAD src0_sel:DWORD src1_sel:WORD_1
    v_lshlrev_b32_sdwa v8, 2, v83 dst_sel:DWORD dst_unused:UNUSED_PAD src0_sel:DWORD src1_sel:WORD_0
    v_lshlrev_b32_sdwa v9, 2, v83 dst_sel:DWORD dst_unused:UNUSED_PAD src0_sel:DWORD src1_sel:WORD_1
    ds_write_b32 v6, v84
    ds_write_b32 v7, v85
    ds_write_b32 v8, v86
    ds_write_b32 v9, v88
    s_cmp_lg_u32 s40, 3
    s_cbranch_scc1 L_p1_kernel_ld_34
    s_add_u32 s36, s42, 11
    s_and_b32 s35, s36, 3
    s_mul_i32 s35, s35, 1047552
    s_lshl_b32 s36, s36, 20
    s_sub_u32 s36, s36, s35
    buffer_store_dwordx4 v[40:43], v3, s[72:75], s36 offen sc1
    s_branch L_p1_kernel_st_35
L_p1_kernel_ld_34:
    s_add_u32 s35, s33, 53542912
    buffer_load_dwordx4 v[40:43], v1, s[8:11], s35 offen nt
L_p1_kernel_st_35:
    v_lshlrev_b32_sdwa v6, 2, v87 dst_sel:DWORD dst_unused:UNUSED_PAD src0_sel:DWORD src1_sel:WORD_0
    v_lshlrev_b32_sdwa v7, 2, v87 dst_sel:DWORD dst_unused:UNUSED_PAD src0_sel:DWORD src1_sel:WORD_1
    v_lshlrev_b32_sdwa v8, 2, v91 dst_sel:DWORD dst_unused:UNUSED_PAD src0_sel:DWORD src1_sel:WORD_0
    v_lshlrev_b32_sdwa v9, 2, v91 dst_sel:DWORD dst_unused:UNUSED_PAD src0_sel:DWORD src1_sel:WORD_1
    ds_write_b32 v6, v89
    ds_write_b32 v7, v90
    ds_write_b32 v8, v92
    ds_write_b32 v9, v93
    s_mov_b64 exec, s[44:45]
    v_lshlrev_b32_sdwa v6, 2, v95 dst_sel:DWORD dst_unused:UNUSED_PAD src0_sel:DWORD src1_sel:WORD_0
    v_lshlrev_b32_sdwa v7, 2, v95 dst_sel:DWORD dst_unused:UNUSED_PAD src0_sel:DWORD src1_sel:WORD_1
    v_lshlrev_b32_sdwa v8, 2, v99 dst_sel:DWORD dst_unused:UNUSED_PAD src0_sel:DWORD src1_sel:WORD_0
    v_lshlrev_b32_sdwa v9, 2, v99 dst_sel:DWORD dst_unused:UNUSED_PAD src0_sel:DWORD src1_sel:WORD_1
    ds_write_b32 v6, v94
    ds_write_b32 v7, v96
    ds_write_b32 v8, v97
    ds_write_b32 v9, v98
    s_mov_b64 exec, -1
    s_cmp_lg_u32 s40, 3
    s_cbranch_scc1 L_p1_kernel_ld_36
    s_add_u32 s36, s42, 12
    s_and_b32 s35, s36, 3
    s_mul_i32 s35, s35, 1047552
    s_lshl_b32 s36, s36, 20
    s_sub_u32 s36, s36, s35
    buffer_store_dwordx4 v[44:47], v3, s[72:75], s36 offen sc1
    s_branch L_p1_kernel_st_37
L_p1_kernel_ld_36:
    s_add_u32 s35, s33, 53542912
    buffer_load_dwordx4 v[44:47], v1, s[12:15], s35 offen nt
L_p1_kernel_st_37:
    s_mul_i32 s35, s39, 9216
    v_mad_u32_u24 v6, v0, 12, s35
    s_waitcnt lgkmcnt(0)
    s_barrier
    s_cmp_lg_u32 s39, 15
    s_cbranch_scc1 L_p1_kernel_nox_38
    ds_read_b32 v12, v6 offset:9984
    ds_read_b32 v13, v6 offset:9988
    ds_read_b32 v14, v6 offset:9992
L_p1_kernel_nox_38:
    ds_read_b32 v72, v6 offset:0
    ds_read_b32 v73, v6 offset:4
    ds_read_b32 v74, v6 offset:8
    ds_read_b32 v76, v6 offset:768
    ds_read_b32 v77, v6 offset:772
    ds_read_b32 v78, v6 offset:776
    ds_read_b32 v48, v6 offset:1536
    ds_read_b32 v49, v6 offset:1540
    ds_read_b32 v50, v6 offset:1544
    ds_read_b32 v80, v6 offset:2304
    ds_read_b32 v81, v6 offset:2308
    ds_read_b32 v82, v6 offset:2312
    ds_read_b32 v52, v6 offset:3072
    ds_read_b32 v53, v6 offset:3076
    ds_read_b32 v54, v6 offset:3080
    ds_read_b32 v84, v6 offset:3840
    ds_read_b32 v85, v6 offset:3844
    ds_read_b32 v86, v6 offset:3848
    ds_read_b32 v56, v6 offset:4608
    ds_read_b32 v57, v6 offset:4612
    ds_read_b32 v58, v6 offset:4616
    ds_read_b32 v88, v6 offset:5376
    ds_read_b32 v89, v6 offset:5380
    ds_read_b32 v90, v6 offset:5384
    ds_read_b32 v60, v6 offset:6144
    ds_read_b32 v61, v6 offset:6148
    ds_read_b32 v62, v6 offset:6152
    ds_read_b32 v92, v6 offset:6912
    ds_read_b32 v93, v6 offset:6916
    ds_read_b32 v94, v6 offset:6920
    ds_read_b32 v64, v6 offset:7680
    ds_read_b32 v65, v6 offset:7684
    ds_read_b32 v66, v6 offset:7688
    ds_read_b32 v96, v6 offset:8448
    ds_read_b32 v97, v6 offset:8452
    ds_read_b32 v98, v6 offset:8456
    ds_read_b32 v68, v6 offset:9216
    ds_read_b32 v69, v6 offset:9220
    ds_read_b32 v70, v6 offset:9224
    s_cmp_gt_u32 s39, 1
    s_cbranch_scc1 L_p1_kernel_nozero_39
    s_mul_i32 s35, s39, 9984
    v_add_u32 v7, s35, v3
    v_min_u32 v8, 16, v0
    v_lshlrev_b32 v8, 2, v8
    v_add_u32 v8, 160768, v8
    v_mov_b32 v120, 0
    v_mov_b32 v121, 0
    v_mov_b32 v122, 0
    v_mov_b32 v123, 0
    ds_write_b128 v7, v[120:123] offset:0
    ds_write_b128 v7, v[120:123] offset:1024
    ds_write_b128 v7, v[120:123] offset:2048
    ds_write_b128 v7, v[120:123] offset:3072
    ds_write_b128 v7, v[120:123] offset:4096
    ds_write_b128 v7, v[120:123] offset:5120
    ds_write_b128 v7, v[120:123] offset:6144
    ds_write_b128 v7, v[120:123] offset:7168
    ds_write_b128 v7, v[120:123] offset:8192
    ds_write_b128 v7, v[120:123] offset:8960
    ds_write_b32 v8, v120
L_p1_kernel_nozero_39:
    s_add_u32 s33, s33, 40960000
    s_add_u32 s34, s34, 20480000
    s_add_u32 s40, s40, 1
    s_cmp_lt_u32 s40, 4
    s_cbranch_scc1 L_p1_loop
    s_cmp_lg_u32 s39, 15
    s_cbranch_scc1 L_p1_kernel_nox_40
    v_lshlrev_b32 v15, 16, v103
    v_and_b32 v103, 0xffff0000, v103
    v_lshlrev_b32 v9, 16, v119
    v_mul_f32 v15, s41, v15
    v_mul_f32 v103, s41, v103
    v_mul_f32 v9, s41, v9
    v_fract_f32 v15, v15
    v_fract_f32 v103, v103
    v_fract_f32 v9, v9
    v_cos_f32 v15, v15
    v_cos_f32 v103, v103
    v_cos_f32 v9, v9
    v_fmaak_f32 v15, v10, v15, 1262486016
    v_fmaak_f32 v103, v10, v103, 1262486016
    v_fmaak_f32 v9, v10, v9, 1262486016
    v_lshlrev_b32 v15, 22, v15
    v_alignbit_b32 v15, v103, v15, 10
    v_alignbit_b32 v15, v9, v15, 10
    v_xor_b32 v15, 0x80200800, v15
    s_waitcnt lgkmcnt(15)
    s_add_u32 s36, s42, 13
    s_and_b32 s35, s36, 3
    s_mul_i32 s35, s35, 1047552
    s_lshl_b32 s36, s36, 20
    s_sub_u32 s36, s36, s35
    buffer_store_dwordx4 v[12:15], v3, s[20:23], s36 offen sc1
L_p1_kernel_nox_40:
    v_lshlrev_b32 v75, 16, v107
    v_and_b32 v107, 0xffff0000, v107
    v_and_b32 v9, 0xffff0000, v119
    v_mul_f32 v75, s41, v75
    v_mul_f32 v107, s41, v107
    v_mul_f32 v9, s41, v9
    v_fract_f32 v75, v75
    v_fract_f32 v107, v107
    v_fract_f32 v9, v9
    v_cos_f32 v75, v75
    v_cos_f32 v107, v107
    v_cos_f32 v9, v9
    v_fmaak_f32 v75, v10, v75, 1262486016
    v_fmaak_f32 v107, v10, v107, 1262486016
    v_fmaak_f32 v9, v10, v9, 1262486016
    v_lshlrev_b32 v75, 22, v75
    v_alignbit_b32 v75, v107, v75, 10
    v_alignbit_b32 v75, v9, v75, 10
    v_xor_b32 v75, 0x80200800, v75
    s_waitcnt lgkmcnt(15)
    s_add_u32 s36, s42, 0
    s_and_b32 s35, s36, 3
    s_mul_i32 s35, s35, 1047552
    s_lshl_b32 s36, s36, 20
    s_sub_u32 s36, s36, s35
    buffer_store_dwordx4 v[72:75], v3, s[20:23], s36 offen sc1
    v_lshlrev_b32 v79, 16, v111
    v_and_b32 v111, 0xffff0000, v111
    v_lshlrev_b32 v9, 16, v11
    v_mul_f32 v79, s41, v79
    v_mul_f32 v111, s41, v111
    v_mul_f32 v9, s41, v9
    v_fract_f32 v79, v79
    v_fract_f32 v111, v111
    v_fract_f32 v9, v9
    v_cos_f32 v79, v79
    v_cos_f32 v111, v111
    v_cos_f32 v9, v9
    v_fmaak_f32 v79, v10, v79, 1262486016
    v_fmaak_f32 v111, v10, v111, 1262486016
    v_fmaak_f32 v9, v10, v9, 1262486016
    v_lshlrev_b32 v79, 22, v79
    v_alignbit_b32 v79, v111, v79, 10
    v_alignbit_b32 v79, v9, v79, 10
    v_xor_b32 v79, 0x80200800, v79
    s_waitcnt lgkmcnt(15)
    s_add_u32 s36, s42, 1
    s_and_b32 s35, s36, 3
    s_mul_i32 s35, s35, 1047552
    s_lshl_b32 s36, s36, 20
    s_sub_u32 s36, s36, s35
    buffer_store_dwordx4 v[76:79], v3, s[20:23], s36 offen sc1
    v_lshlrev_b32 v51, 16, v115
    v_and_b32 v115, 0xffff0000, v115
    v_and_b32 v9, 0xffff0000, v11
    v_mul_f32 v51, s41, v51
    v_mul_f32 v115, s41, v115
    v_mul_f32 v9, s41, v9
    v_fract_f32 v51, v51
    v_fract_f32 v115, v115
    v_fract_f32 v9, v9
    v_cos_f32 v51, v51
    v_cos_f32 v115, v115
    v_cos_f32 v9, v9
    v_fmaak_f32 v51, v10, v51, 1262486016
    v_fmaak_f32 v115, v10, v115, 1262486016
    v_fmaak_f32 v9, v10, v9, 1262486016
    v_lshlrev_b32 v51, 22, v51
    v_alignbit_b32 v51, v115, v51, 10
    v_alignbit_b32 v51, v9, v51, 10
    v_xor_b32 v51, 0x80200800, v51
    s_waitcnt lgkmcnt(0)
    s_add_u32 s36, s42, 2
    s_and_b32 s35, s36, 3
    s_mul_i32 s35, s35, 1047552
    s_lshl_b32 s36, s36, 20
    s_sub_u32 s36, s36, s35
    buffer_store_dwordx4 v[48:51], v3, s[20:23], s36 offen sc1
    v_lshlrev_b32 v83, 16, v100
    v_and_b32 v100, 0xffff0000, v100
    v_lshlrev_b32 v9, 16, v101
    v_mul_f32 v83, s41, v83
    v_mul_f32 v100, s41, v100
    v_mul_f32 v9, s41, v9
    v_fract_f32 v83, v83
    v_fract_f32 v100, v100
    v_fract_f32 v9, v9
    v_cos_f32 v83, v83
    v_cos_f32 v100, v100
    v_cos_f32 v9, v9
    v_fmaak_f32 v83, v10, v83, 1262486016
    v_fmaak_f32 v100, v10, v100, 1262486016
    v_fmaak_f32 v9, v10, v9, 1262486016
    v_lshlrev_b32 v83, 22, v83
    v_alignbit_b32 v83, v100, v83, 10
    v_alignbit_b32 v83, v9, v83, 10
    v_xor_b32 v83, 0x80200800, v83
    s_add_u32 s36, s42, 3
    s_and_b32 s35, s36, 3
    s_mul_i32 s35, s35, 1047552
    s_lshl_b32 s36, s36, 20
    s_sub_u32 s36, s36, s35
    buffer_store_dwordx4 v[80:83], v3, s[20:23], s36 offen sc1
    v_lshlrev_b32 v55, 16, v102
    v_and_b32 v102, 0xffff0000, v102
    v_and_b32 v9, 0xffff0000, v101
    v_mul_f32 v55, s41, v55
    v_mul_f32 v102, s41, v102
    v_mul_f32 v9, s41, v9
    v_fract_f32 v55, v55
    v_fract_f32 v102, v102
    v_fract_f32 v9, v9
    v_cos_f32 v55, v55
    v_cos_f32 v102, v102
    v_cos_f32 v9, v9
    v_fmaak_f32 v55, v10, v55, 1262486016
    v_fmaak_f32 v102, v10, v102, 1262486016
    v_fmaak_f32 v9, v10, v9, 1262486016
    v_lshlrev_b32 v55, 22, v55
    v_alignbit_b32 v55, v102, v55, 10
    v_alignbit_b32 v55, v9, v55, 10
    v_xor_b32 v55, 0x80200800, v55
    s_add_u32 s36, s42, 4
    s_and_b32 s35, s36, 3
    s_mul_i32 s35, s35, 1047552
    s_lshl_b32 s36, s36, 20
    s_sub_u32 s36, s36, s35
    buffer_store_dwordx4 v[52:55], v3, s[20:23], s36 offen sc1
    v_lshlrev_b32 v87, 16, v104
    v_and_b32 v104, 0xffff0000, v104
    v_lshlrev_b32 v9, 16, v105
    v_mul_f32 v87, s41, v87
    v_mul_f32 v104, s41, v104
    v_mul_f32 v9, s41, v9
    v_fract_f32 v87, v87
    v_fract_f32 v104, v104
    v_fract_f32 v9, v9
    v_cos_f32 v87, v87
    v_cos_f32 v104, v104
    v_cos_f32 v9, v9
    v_fmaak_f32 v87, v10, v87, 1262486016
    v_fmaak_f32 v104, v10, v104, 1262486016
    v_fmaak_f32 v9, v10, v9, 1262486016
    v_lshlrev_b32 v87, 22, v87
    v_alignbit_b32 v87, v104, v87, 10
    v_alignbit_b32 v87, v9, v87, 10
    v_xor_b32 v87, 0x80200800, v87
    s_add_u32 s36, s42, 5
    s_and_b32 s35, s36, 3
    s_mul_i32 s35, s35, 1047552
    s_lshl_b32 s36, s36, 20
    s_sub_u32 s36, s36, s35
    buffer_store_dwordx4 v[84:87], v3, s[20:23], s36 offen sc1
    v_lshlrev_b32 v59, 16, v106
    v_and_b32 v106, 0xffff0000, v106
    v_and_b32 v9, 0xffff0000, v105
    v_mul_f32 v59, s41, v59
    v_mul_f32 v106, s41, v106
    v_mul_f32 v9, s41, v9
    v_fract_f32 v59, v59
    v_fract_f32 v106, v106
    v_fract_f32 v9, v9
    v_cos_f32 v59, v59
    v_cos_f32 v106, v106
    v_cos_f32 v9, v9
    v_fmaak_f32 v59, v10, v59, 1262486016
    v_fmaak_f32 v106, v10, v106, 1262486016
    v_fmaak_f32 v9, v10, v9, 1262486016
    v_lshlrev_b32 v59, 22, v59
    v_alignbit_b32 v59, v106, v59, 10
    v_alignbit_b32 v59, v9, v59, 10
    v_xor_b32 v59, 0x80200800, v59
    s_add_u32 s36, s42, 6
    s_and_b32 s35, s36, 3
    s_mul_i32 s35, s35, 1047552
    s_lshl_b32 s36, s36, 20
    s_sub_u32 s36, s36, s35
    buffer_store_dwordx4 v[56:59], v3, s[20:23], s36 offen sc1
    v_lshlrev_b32 v91, 16, v108
    v_and_b32 v108, 0xffff0000, v108
    v_lshlrev_b32 v9, 16, v109
    v_mul_f32 v91, s41, v91
    v_mul_f32 v108, s41, v108
    v_mul_f32 v9, s41, v9
    v_fract_f32 v91, v91
    v_fract_f32 v108, v108
    v_fract_f32 v9, v9
    v_cos_f32 v91, v91
    v_cos_f32 v108, v108
    v_cos_f32 v9, v9
    v_fmaak_f32 v91, v10, v91, 1262486016
    v_fmaak_f32 v108, v10, v108, 1262486016
    v_fmaak_f32 v9, v10, v9, 1262486016
    v_lshlrev_b32 v91, 22, v91
    v_alignbit_b32 v91, v108, v91, 10
    v_alignbit_b32 v91, v9, v91, 10
    v_xor_b32 v91, 0x80200800, v91
    s_add_u32 s36, s42, 7
    s_and_b32 s35, s36, 3
    s_mul_i32 s35, s35, 1047552
    s_lshl_b32 s36, s36, 20
    s_sub_u32 s36, s36, s35
    buffer_store_dwordx4 v[88:91], v3, s[20:23], s36 offen sc1
    v_lshlrev_b32 v63, 16, v110
    v_and_b32 v110, 0xffff0000, v110
    v_and_b32 v9, 0xffff0000, v109
    v_mul_f32 v63, s41, v63
    v_mul_f32 v110, s41, v110
    v_mul_f32 v9, s41, v9
    v_fract_f32 v63, v63
    v_fract_f32 v110, v110
    v_fract_f32 v9, v9
    v_cos_f32 v63, v63
    v_cos_f32 v110, v110
    v_cos_f32 v9, v9
    v_fmaak_f32 v63, v10, v63, 1262486016
    v_fmaak_f32 v110, v10, v110, 1262486016
    v_fmaak_f32 v9, v10, v9, 1262486016
    v_lshlrev_b32 v63, 22, v63
    v_alignbit_b32 v63, v110, v63, 10
    v_alignbit_b32 v63, v9, v63, 10
    v_xor_b32 v63, 0x80200800, v63
    s_add_u32 s36, s42, 8
    s_and_b32 s35, s36, 3
    s_mul_i32 s35, s35, 1047552
    s_lshl_b32 s36, s36, 20
    s_sub_u32 s36, s36, s35
    buffer_store_dwordx4 v[60:63], v3, s[20:23], s36 offen sc1
    v_lshlrev_b32 v95, 16, v112
    v_and_b32 v112, 0xffff0000, v112
    v_lshlrev_b32 v9, 16, v113
    v_mul_f32 v95, s41, v95
    v_mul_f32 v112, s41, v112
    v_mul_f32 v9, s41, v9
    v_fract_f32 v95, v95
    v_fract_f32 v112, v112
    v_fract_f32 v9, v9
    v_cos_f32 v95, v95
    v_cos_f32 v112, v112
    v_cos_f32 v9, v9
    v_fmaak_f32 v95, v10, v95, 1262486016
    v_fmaak_f32 v112, v10, v112, 1262486016
    v_fmaak_f32 v9, v10, v9, 1262486016
    v_lshlrev_b32 v95, 22, v95
    v_alignbit_b32 v95, v112, v95, 10
    v_alignbit_b32 v95, v9, v95, 10
    v_xor_b32 v95, 0x80200800, v95
    s_add_u32 s36, s42, 9
    s_and_b32 s35, s36, 3
    s_mul_i32 s35, s35, 1047552
    s_lshl_b32 s36, s36, 20
    s_sub_u32 s36, s36, s35
    buffer_store_dwordx4 v[92:95], v3, s[20:23], s36 offen sc1
    v_lshlrev_b32 v67, 16, v114
    v_and_b32 v114, 0xffff0000, v114
    v_and_b32 v9, 0xffff0000, v113
    v_mul_f32 v67, s41, v67
    v_mul_f32 v114, s41, v114
    v_mul_f32 v9, s41, v9
    v_fract_f32 v67, v67
    v_fract_f32 v114, v114
    v_fract_f32 v9, v9
    v_cos_f32 v67, v67
    v_cos_f32 v114, v114
    v_cos_f32 v9, v9
    v_fmaak_f32 v67, v10, v67, 1262486016
    v_fmaak_f32 v114, v10, v114, 1262486016
    v_fmaak_f32 v9, v10, v9, 1262486016
    v_lshlrev_b32 v67, 22, v67
    v_alignbit_b32 v67, v114, v67, 10
    v_alignbit_b32 v67, v9, v67, 10
    v_xor_b32 v67, 0x80200800, v67
    s_add_u32 s36, s42, 10
    s_and_b32 s35, s36, 3
    s_mul_i32 s35, s35, 1047552
    s_lshl_b32 s36, s36, 20
    s_sub_u32 s36, s36, s35
    buffer_store_dwordx4 v[64:67], v3, s[20:23], s36 offen sc1
    v_lshlrev_b32 v99, 16, v116
    v_and_b32 v116, 0xffff0000, v116
    v_lshlrev_b32 v9, 16, v117
    v_mul_f32 v99, s41, v99
    v_mul_f32 v116, s41, v116
    v_mul_f32 v9, s41, v9
    v_fract_f32 v99, v99
    v_fract_f32 v116, v116
    v_fract_f32 v9, v9
    v_cos_f32 v99, v99
    v_cos_f32 v116, v116
    v_cos_f32 v9, v9
    v_fmaak_f32 v99, v10, v99, 1262486016
    v_fmaak_f32 v116, v10, v116, 1262486016
    v_fmaak_f32 v9, v10, v9, 1262486016
    v_lshlrev_b32 v99, 22, v99
    v_alignbit_b32 v99, v116, v99, 10
    v_alignbit_b32 v99, v9, v99, 10
    v_xor_b32 v99, 0x80200800, v99
    s_add_u32 s36, s42, 11
    s_and_b32 s35, s36, 3
    s_mul_i32 s35, s35, 1047552
    s_lshl_b32 s36, s36, 20
    s_sub_u32 s36, s36, s35
    buffer_store_dwordx4 v[96:99], v3, s[20:23], s36 offen sc1
    v_lshlrev_b32 v71, 16, v118
    v_and_b32 v118, 0xffff0000, v118
    v_and_b32 v9, 0xffff0000, v117
    v_mul_f32 v71, s41, v71
    v_mul_f32 v118, s41, v118
    v_mul_f32 v9, s41, v9
    v_fract_f32 v71, v71
    v_fract_f32 v118, v118
    v_fract_f32 v9, v9
    v_cos_f32 v71, v71
    v_cos_f32 v118, v118
    v_cos_f32 v9, v9
    v_fmaak_f32 v71, v10, v71, 1262486016
    v_fmaak_f32 v118, v10, v118, 1262486016
    v_fmaak_f32 v9, v10, v9, 1262486016
    v_lshlrev_b32 v71, 22, v71
    v_alignbit_b32 v71, v118, v71, 10
    v_alignbit_b32 v71, v9, v71, 10
    v_xor_b32 v71, 0x80200800, v71
    s_add_u32 s36, s42, 12
    s_and_b32 s35, s36, 3
    s_mul_i32 s35, s35, 1047552
    s_lshl_b32 s36, s36, 20
    s_sub_u32 s36, s36, s35
    buffer_store_dwordx4 v[68:71], v3, s[20:23], s36 offen sc1
    v_and_b32 v6, 0x7c007c00, v5
    v_add_u32 v6, 0x04000400, v6
    v_and_b32 v6, 0x80008000, v6
    v_cmp_ne_u32 vcc, 0, v6
    s_lshl_b32 s35, s2, 3
    s_add_u32 s35, s35, 8519682
    s_mov_b32 s26, 8540160
    s_cmp_lg_u64 vcc, 0
    s_cselect_b32 s55, 1, s55
    s_cmp_eq_u32 s55, 0
    s_cbranch_scc1 L_p1_end
    s_mov_b64 exec, 1
    buffer_store_short v4, off, s[24:27], s35 sc1
L_p1_end:
    s_endpgm
.globl p2_kernel
.p2align 8
.type p2_kernel,@function
p2_kernel:
    s_cmp_ge_u32 s2, 256
    s_cbranch_scc1 L_p2_end
    s_load_dwordx2 s[4:5], s[0:1], 104
    s_load_dwordx2 s[100:101], s[0:1], 24
    s_load_dwordx2 s[8:9], s[0:1], 0
    s_load_dwordx2 s[30:31], s[0:1], 40
    s_load_dwordx4 s[32:35], s[0:1], 56
    s_load_dwordx4 s[36:39], s[0:1], 72
    s_and_b32 s14, s2, 7
    s_lshr_b32 s49, s2, 3
    s_and_b32 s3, s14, 1
    s_lshl_b32 s3, s3, 5
    s_add_u32 s3, s3, s49
    s_lshr_b32 s12, s14, 1
    v_lshrrev_b32 v108, 6, v0
    v_lshlrev_b32 v1, 4, v0
    v_and_b32 v109, 63, v0
    v_readfirstlane_b32 s13, v108
    v_lshlrev_b32 v111, 4, v109
    v_lshrrev_b32 v110, 2, v109
    v_mul_u32_u24 v110, 8256, v110
    v_add_u32 v110, v110, v111
    s_mul_i32 s14, s12, 65
    s_add_u32 s14, s14, s3
    s_lshl_b32 s14, s14, 5
    s_mul_i32 s15, s13, 532480
    s_add_u32 s14, s14, s15
    s_add_u32 s25, s14, 222298112
    s_mul_i32 s22, s12, 1280000
    s_mov_b32 s2, 0
    s_waitcnt lgkmcnt(0)
    s_mov_b32 s6, 655360000
    s_mov_b32 s7, 0x00020000
    s_add_u32 s10, s22, 1280000
    s_mov_b32 s11, 0x00020000
    s_add_u32 s15, s25, 0
    buffer_load_dwordx4 v[28:31], v110, s[4:7], s15 offen
    s_add_u32 s15, s25, 133120
    buffer_load_dwordx4 v[32:35], v110, s[4:7], s15 offen
    s_add_u32 s15, s25, 266240
    buffer_load_dwordx4 v[36:39], v110, s[4:7], s15 offen
    s_add_u32 s15, s25, 399360
    buffer_load_dwordx4 v[40:43], v110, s[4:7], s15 offen
    s_load_dwordx4 s[40:43], s[30:31], 0
    s_load_dwordx16 s[52:67], s[32:33], 0
    s_load_dwordx16 s[68:83], s[34:35], 0
    s_load_dwordx8 s[84:91], s[36:37], 0
    s_load_dwordx8 s[92:99], s[38:39], 0
    v_mov_b32 v52, 0x100
    s_cmp_lg_u32 s13, 0
    s_cbranch_scc1 L_p2_noann
    s_lshl_b32 s14, s3, 8
    s_add_u32 s14, s14, 230821888
    s_mov_b64 exec, 1
    buffer_atomic_add v52, off, s[4:7], s14
    s_mov_b64 exec, -1
L_p2_noann:
    s_add_u32 s14, s22, 0
    buffer_load_dwordx4 v[88:91], v1, s[8:11], s14 offen
    s_add_u32 s14, s22, 16384
    buffer_load_dwordx4 v[92:95], v1, s[8:11], s14 offen
    s_add_u32 s14, s22, 32768
    buffer_load_dwordx4 v[96:99], v1, s[8:11], s14 offen
    s_add_u32 s14, s22, 49152
    buffer_load_dwordx4 v[100:103], v1, s[8:11], s14 offen
    s_add_u32 s14, s22, 65536
    buffer_load_dwordx4 v[104:107], v1, s[8:11], s14 offen
    s_mov_b32 s15, 230817792
    buffer_load_dwordx4 v[80:83], v111, s[4:7], s15 offen offset:0
    buffer_load_dwordx4 v[84:87], v111, s[4:7], s15 offen offset:1024
    v_mov_b32 v2, v109
    v_mov_b32 v50, 21845
    v_add_u32 v3, 80000, v1
    v_add_u32 v124, 145536, v1
    v_add_u32 v113, 65536, v1
    v_mov_b32 v112, 0x7f000000
    v_cmp_gt_u32 vcc, 904, v0
    s_mul_i32 s19, s13, 240
    s_add_u32 s19, s19, 160000
    v_cndmask_b32 v124, v112, v124, vcc
    v_cndmask_b32 v113, v112, v113, vcc
    v_lshl_add_u32 v6, v109, 2, s19
    v_lshl_add_u32 v126, v109, 1, s19
    v_cmp_gt_u32 vcc, 10, v109
    s_lshl_b32 s27, s13, 18
    s_mov_b32 s23, 261888
    v_cndmask_b32 v6, v112, v6, vcc
    s_mov_b32 s44, s4
    s_add_u32 s45, s5, 1048576
    s_mov_b32 s46, 13893632
    s_mov_b32 s47, 0x00020000
    s_mov_b32 s18, 80000
    s_and_b32 s50, s3, 1
    s_lshl_b32 s50, s50, 18
    s_sub_u32 s18, s18, s50
    s_sub_u32 s50, 4294836224, s50
    v_lshlrev_b32 v116, 3, v0
    v_and_b32 v116, 16, v116
    v_and_b32 v117, 1, v0
    v_lshl_or_b32 v116, v117, 5, v116
    v_mov_b32 v58, 0x3f80
    v_mov_b32 v59, 0
    v_lshlrev_b64 v[58:59], v116, v[58:59]
    v_mov_b32 v4, 0
    v_mov_b32 v5, 0
    v_mov_b32 v114, 0xff00
    v_bfe_u32 v127, v0, 0, 1
    v_mul_u32_u24 v127, 40, v127
    v_add_u32 v127, s19, v127
    ds_write2_b32 v6, v5, v5 offset0:34 offset1:44
    ds_write_b16 v126, v114 offset:2
    v_mov_b32 v44, 1073758208
    v_mov_b32 v45, 1073758208
    v_mov_b32 v46, 1073758208
    v_mov_b32 v47, 1073758208
    v_mov_b32 v48, 1073758208
    v_mov_b32 v49, 1073758208
    ds_write_b128 v113, v[44:47]
    v_lshrrev_b32 v115, 4, v109
    v_mul_u32_u24 v115, 15360, v115
    v_lshl_add_u32 v115, v109, 6, v115
    v_lshl_add_u32 v115, v108, 10, v115
    s_waitcnt lgkmcnt(0)
    v_mov_b32 v53, s40
    v_mov_b32 v54, s41
    v_mov_b32 v56, s42
    v_mov_b32 v57, s43
    s_mov_b32 s40, 20987904
    s_mov_b32 s41, 21031594
    s_pack_ll_b32_b16 s14, s52, s54
    s_pack_hh_b32_b16 s15, s52, s54
    s_pack_ll_b32_b16 s54, s53, s55
    s_pack_hh_b32_b16 s55, s53, s55
    s_mov_b32 s52, s14
    s_mov_b32 s53, s15
    s_pack_ll_b32_b16 s14, s56, s58
    s_pack_hh_b32_b16 s15, s56, s58
    s_pack_ll_b32_b16 s58, s57, s59
    s_pack_hh_b32_b16 s59, s57, s59
    s_mov_b32 s56, s14
    s_mov_b32 s57, s15
    s_pack_ll_b32_b16 s14, s60, s62
    s_pack_hh_b32_b16 s15, s60, s62
    s_pack_ll_b32_b16 s62, s61, s63
    s_pack_hh_b32_b16 s63, s61, s63
    s_mov_b32 s60, s14
    s_mov_b32 s61, s15
    s_pack_ll_b32_b16 s14, s64, s66
    s_pack_hh_b32_b16 s15, s64, s66
    s_pack_ll_b32_b16 s66, s65, s67
    s_pack_hh_b32_b16 s67, s65, s67
    s_mov_b32 s64, s14
    s_mov_b32 s65, s15
    s_pack_ll_b32_b16 s14, s68, s70
    s_pack_hh_b32_b16 s15, s68, s70
    s_pack_ll_b32_b16 s70, s69, s71
    s_pack_hh_b32_b16 s71, s69, s71
    s_mov_b32 s68, s14
    s_mov_b32 s69, s15
    s_pack_ll_b32_b16 s14, s72, s74
    s_pack_hh_b32_b16 s15, s72, s74
    s_pack_ll_b32_b16 s74, s73, s75
    s_pack_hh_b32_b16 s75, s73, s75
    s_mov_b32 s72, s14
    s_mov_b32 s73, s15
    s_pack_ll_b32_b16 s14, s76, s78
    s_pack_hh_b32_b16 s15, s76, s78
    s_pack_ll_b32_b16 s78, s77, s79
    s_pack_hh_b32_b16 s79, s77, s79
    s_mov_b32 s76, s14
    s_mov_b32 s77, s15
    s_pack_ll_b32_b16 s14, s80, s82
    s_pack_hh_b32_b16 s15, s80, s82
    s_pack_ll_b32_b16 s82, s81, s83
    s_pack_hh_b32_b16 s83, s81, s83
    s_mov_b32 s80, s14
    s_mov_b32 s81, s15
    s_waitcnt vmcnt(10)
    ds_write_b128 v1, v[28:31] offset:0
    s_waitcnt vmcnt(9)
    ds_write_b128 v1, v[32:35] offset:16384
    s_waitcnt vmcnt(8)
    ds_write_b128 v1, v[36:39] offset:32768
    s_waitcnt vmcnt(7)
    ds_write_b128 v1, v[40:43] offset:49152
    ds_read_b128 v[28:31], v115 offset:0
    ds_read_b128 v[36:39], v115 offset:32
    ds_read_b128 v[32:35], v115 offset:16
    ds_read_b128 v[40:43], v115 offset:48
    ds_write_b128 v1, v[44:47] offset:0
    ds_write_b128 v1, v[44:47] offset:16384
    ds_write_b128 v1, v[44:47] offset:32768
    ds_write_b128 v1, v[44:47] offset:49152
    s_waitcnt lgkmcnt(6)
    v_mad_u32_u16 v108, v28, v50, s40 op_sel:[0,0,0,0]
    v_mad_u32_u16 v109, v36, v50, s41 op_sel:[0,0,0,0]
    v_sub_u32_sdwa v110, v109, v108 dst_sel:DWORD dst_unused:UNUSED_PAD src0_sel:WORD_1 src1_sel:WORD_1
    s_nop 1
    v_add_u32_dpp v110, v110, v110 row_shr:1 row_mask:0xf bank_mask:0xf bound_ctrl:0
    s_nop 1
    v_add_u32_dpp v110, v110, v110 row_shr:2 row_mask:0xf bank_mask:0xf bound_ctrl:0
    s_nop 1
    v_add_u32_dpp v110, v110, v110 row_shr:4 row_mask:0xf bank_mask:0xf bound_ctrl:0
    s_nop 1
    v_add_u32_dpp v110, v110, v110 row_shr:8 row_mask:0xf bank_mask:0xf bound_ctrl:0
    s_nop 1
    v_add_u32_dpp v110, v110, v110 row_bcast:15 row_mask:0xa bank_mask:0xf
    s_nop 1
    v_add_u32_dpp v110, v110, v110 row_bcast:31 row_mask:0xc bank_mask:0xf
    v_sub_u32_sdwa v109, v109, v110 dst_sel:DWORD dst_unused:UNUSED_PAD src0_sel:WORD_1 src1_sel:DWORD
    v_readlane_b32 s29, v110, 63
    v_add_u32 v110, -1, v110
    ds_write_b16 v126, v109
    v_lshlrev_b32_e64 v111, v110, 1
    v_lshrrev_b32 v110, 5, v110
    s_cmp_gt_u32 s29, 320
    s_cselect_b32 s2, 1, s2
    v_lshl_add_u32 v110, v110, 2, v127
    s_cselect_b64 exec, 0, -1
    ds_or_b32 v110, v111 offset:136
    s_mov_b64 exec, -1
    ds_wrxchg2_rtn_b32 v[108:109], v6, v5, v5 offset0:34 offset1:44
    s_waitcnt lgkmcnt(0)
    v_or_b32 v7, v108, v109
    s_nop 0
    v_readlane_b32 s30, v7, 0
    v_readlane_b32 s31, v7, 1
    v_readlane_b32 s32, v7, 2
    v_readlane_b32 s33, v7, 3
    v_readlane_b32 s34, v7, 4
    v_readlane_b32 s35, v7, 5
    v_readlane_b32 s36, v7, 6
    v_readlane_b32 s37, v7, 7
    s_mov_b32 s25, s19
    s_mov_b32 s26, s27
    s_mov_b32 s51, s28
    s_mov_b32 s28, s29
    v_mbcnt_lo_u32_b32 v8, s30, 0
    v_mbcnt_hi_u32_b32 v8, s31, v8
    s_bcnt1_i32_b64 s14, s[30:31]
    v_lshl_add_u32 v9, v8, 1, s25
    ds_read_u16 v9, v9
    s_mov_b32 s30, s26
    s_movk_i32 s31, -320
    s_lshl1_add_u32 s25, s14, s25
    s_lshl_b32 s14, s14, 12
    s_add_u32 s26, s26, s14
    v_mbcnt_lo_u32_b32 v12, s32, 0
    v_mbcnt_hi_u32_b32 v12, s33, v12
    s_bcnt1_i32_b64 s14, s[32:33]
    v_lshl_add_u32 v13, v12, 1, s25
    ds_read_u16 v13, v13
    s_mov_b32 s32, s26
    s_movk_i32 s33, -256
    s_lshl1_add_u32 s25, s14, s25
    s_lshl_b32 s14, s14, 12
    s_add_u32 s26, s26, s14
    v_mbcnt_lo_u32_b32 v16, s34, 0
    v_mbcnt_hi_u32_b32 v16, s35, v16
    s_bcnt1_i32_b64 s14, s[34:35]
    v_lshl_add_u32 v17, v16, 1, s25
    ds_read_u16 v17, v17
    s_mov_b32 s34, s26
    s_movk_i32 s35, -192
    s_lshl1_add_u32 s25, s14, s25
    s_lshl_b32 s14, s14, 12
    s_add_u32 s26, s26, s14
    v_mbcnt_lo_u32_b32 v20, s36, 0
    v_mbcnt_hi_u32_b32 v20, s37, v20
    s_bcnt1_i32_b64 s14, s[36:37]
    v_lshl_add_u32 v21, v20, 1, s25
    ds_read_u16 v21, v21
    s_mov_b32 s36, s26
    s_movk_i32 s37, -128
    s_lshl1_add_u32 s25, s14, s25
    s_lshl_b32 s14, s14, 12
    s_add_u32 s26, s26, s14
    s_waitcnt lgkmcnt(3)
    v_add3_u32 v9, v9, v2, s31
    v_lshl_add_u32 v8, v8, 8, v9
    v_lshrrev_b32 v9, 8, v9
    v_mad_u32_u24 v8, v9, s23, v8
    buffer_load_dwordx4 v[8:11], v8, s[44:47], s30 idxen
    s_waitcnt lgkmcnt(2)
    v_add3_u32 v13, v13, v2, s33
    v_lshl_add_u32 v12, v12, 8, v13
    v_lshrrev_b32 v13, 8, v13
    v_mad_u32_u24 v12, v13, s23, v12
    buffer_load_dwordx4 v[12:15], v12, s[44:47], s32 idxen
    s_waitcnt lgkmcnt(1)
    v_add3_u32 v17, v17, v2, s35
    v_lshl_add_u32 v16, v16, 8, v17
    v_lshrrev_b32 v17, 8, v17
    v_mad_u32_u24 v16, v17, s23, v16
    buffer_load_dwordx4 v[16:19], v16, s[44:47], s34 idxen
    s_waitcnt lgkmcnt(0)
    v_add3_u32 v21, v21, v2, s37
    v_lshl_add_u32 v20, v20, 8, v21
    v_lshrrev_b32 v21, 8, v21
    v_mad_u32_u24 v20, v21, s23, v20
    buffer_load_dwordx4 v[20:23], v20, s[44:47], s36 idxen
    s_cmp_le_u32 s28, 256
    s_cbranch_scc1 L_p2_kernel_noopt_1
    v_readlane_b32 s38, v7, 8
    v_readlane_b32 s39, v7, 9
    s_nop 1
    v_mbcnt_lo_u32_b32 v51, s38, 0
    v_mbcnt_hi_u32_b32 v51, s39, v51
    s_bcnt1_i32_b64 s14, s[38:39]
    v_lshl_add_u32 v55, v51, 1, s25
    ds_read_u16 v55, v55
    s_mov_b32 s38, s26
    s_movk_i32 s39, -64
    s_lshl1_add_u32 s25, s14, s25
    s_lshl_b32 s14, s14, 12
    s_add_u32 s26, s26, s14
    s_waitcnt lgkmcnt(0)
    v_add3_u32 v55, v55, v2, s39
    v_lshl_add_u32 v51, v51, 8, v55
    v_lshrrev_b32 v55, 8, v55
    v_mad_u32_u24 v51, v55, s23, v51
    buffer_load_dwordx4 v[24:27], v51, s[44:47], s38 idxen
L_p2_kernel_noopt_1:
    s_waitcnt vmcnt(6)
    ds_write_b128 v3, v[88:91] offset:0
    ds_write_b128 v3, v[92:95] offset:16384
    ds_write_b128 v3, v[96:99] offset:32768
    ds_write_b128 v3, v[100:103] offset:49152
    ds_write_b128 v124, v[104:107] offset:0
    s_waitcnt vmcnt(4)
    v_max3_u32 v64, v80, v82, v84
    v_add_f32 v65, v81, v83
    v_add_f32 v66, v85, v87
    v_max_u32 v64, v64, v86
    v_add_f32 v65, v65, v66
    v_cmp_lt_u32 vcc, 0xffff, v64
    s_nop 1
    v_max_u32_dpp v64, v64, v64 row_shr:1 row_mask:0xf bank_mask:0xf bound_ctrl:0
    s_nop 1
    v_max_u32_dpp v64, v64, v64 row_shr:2 row_mask:0xf bank_mask:0xf bound_ctrl:0
    s_nop 1
    v_max_u32_dpp v64, v64, v64 row_shr:4 row_mask:0xf bank_mask:0xf bound_ctrl:0
    s_nop 1
    v_max_u32_dpp v64, v64, v64 row_shr:8 row_mask:0xf bank_mask:0xf bound_ctrl:0
    s_nop 1
    v_max_u32_dpp v64, v64, v64 row_bcast:15 row_mask:0xa bank_mask:0xf
    s_nop 1
    v_max_u32_dpp v64, v64, v64 row_bcast:31 row_mask:0xc bank_mask:0xf
    s_nop 1
    v_add_f32_dpp v65, v65, v65 row_shr:1 row_mask:0xf bank_mask:0xf bound_ctrl:0
    s_nop 1
    v_add_f32_dpp v65, v65, v65 row_shr:2 row_mask:0xf bank_mask:0xf bound_ctrl:0
    s_nop 1
    v_add_f32_dpp v65, v65, v65 row_shr:4 row_mask:0xf bank_mask:0xf bound_ctrl:0
    s_nop 1
    v_add_f32_dpp v65, v65, v65 row_shr:8 row_mask:0xf bank_mask:0xf bound_ctrl:0
    s_nop 1
    v_add_f32_dpp v65, v65, v65 row_bcast:15 row_mask:0xa bank_mask:0xf
    s_nop 1
    v_add_f32_dpp v65, v65, v65 row_bcast:31 row_mask:0xc bank_mask:0xf
    s_cmp_lg_u64 vcc, 0
    s_cselect_b32 s2, 1, s2
    v_lshlrev_b32 v64, 16, v64
    v_mul_f32 v66, 936490775, v65
    v_mul_f32 v65, 928531664, v65
    v_cmp_nle_f32 vcc, v64, v66
    v_max_u32 v64, v64, v65
    s_nop 0
    v_readlane_b32 s14, v64, 63
    s_bitcmp1_b32 vcc_hi, 31
    s_cselect_b32 s2, 1, s2
    s_lshr_b32 s14, s14, 23
    s_add_u32 s14, s14, 1
    s_cmp_lt_u32 s14, 40
    s_cselect_b32 s2, 1, s2
    s_cmp_gt_u32 s14, 230
    s_cselect_b32 s2, 1, s2
    s_sub_u32 s48, s14, 14
    s_lshl_b32 s48, s48, 23
    s_add_u32 s16, s48, 272629760
    s_lshr_b32 s15, s16, 16
    s_sub_u32 s15, 0x10000, s15
    s_add_u32 s20, s16, s15
    s_sub_u32 s17, s20, 1
    s_mov_b32 s21, s17
    s_or_b32 s48, s48, 16416
    s_sub_u32 s14, s14, 40
    s_cmp_gt_u32 s14, 190
    s_cselect_b32 s48, 0, s48
    s_waitcnt lgkmcnt(0)
    s_barrier
    s_add_u32 s14, s22, 80000
    buffer_load_dwordx4 v[88:91], v1, s[8:11], s14 offen
    s_add_u32 s14, s22, 96384
    buffer_load_dwordx4 v[92:95], v1, s[8:11], s14 offen
    v_mad_u32_u16 v108, v28, v50, s40 op_sel:[1,0,0,0]
    v_mad_u32_u16 v109, v36, v50, s41 op_sel:[1,0,0,0]
    v_sub_u32_sdwa v110, v109, v108 dst_sel:DWORD dst_unused:UNUSED_PAD src0_sel:WORD_1 src1_sel:WORD_1
    s_nop 1
    v_add_u32_dpp v110, v110, v110 row_shr:1 row_mask:0xf bank_mask:0xf bound_ctrl:0
    s_nop 1
    v_add_u32_dpp v110, v110, v110 row_shr:2 row_mask:0xf bank_mask:0xf bound_ctrl:0
    s_nop 1
    v_add_u32_dpp v110, v110, v110 row_shr:4 row_mask:0xf bank_mask:0xf bound_ctrl:0
    s_nop 1
    v_add_u32_dpp v110, v110, v110 row_shr:8 row_mask:0xf bank_mask:0xf bound_ctrl:0
    s_nop 1
    v_add_u32_dpp v110, v110, v110 row_bcast:15 row_mask:0xa bank_mask:0xf
    s_nop 1
    v_add_u32_dpp v110, v110, v110 row_bcast:31 row_mask:0xc bank_mask:0xf
    v_sub_u32_sdwa v109, v109, v110 dst_sel:DWORD dst_unused:UNUSED_PAD src0_sel:WORD_1 src1_sel:DWORD
    v_readlane_b32 s29, v110, 63
    v_add_u32 v110, -1, v110
    ds_write_b16 v126, v109
    v_lshlrev_b32_e64 v111, v110, 1
    v_lshrrev_b32 v110, 5, v110
    s_cmp_gt_u32 s29, 320
    s_cselect_b32 s2, 1, s2
    v_lshl_add_u32 v110, v110, 2, v127
    s_cselect_b64 exec, 0, -1
    ds_or_b32 v110, v111 offset:136
    s_mov_b64 exec, -1
    ds_wrxchg2_rtn_b32 v[108:109], v6, v5, v5 offset0:34 offset1:44
    s_mov_b32 s24, 0
L_p2_loop:
    s_add_u32 s22, s22, 80000
    s_lshl_b32 s14, s13, 4
    s_or_b32 s14, s14, s24
    s_cmp_lg_u32 s14, 5
    s_cbranch_scc1 L_p2_nost
    v_mov_b32 v52, 0
    s_lshl_b32 s14, s3, 8
    s_add_u32 s14, s14, 230821888
    s_mov_b64 exec, 1
    buffer_atomic_add v52, off, s[4:7], s14 sc0
    s_mov_b64 exec, -1
L_p2_nost:
    s_waitcnt vmcnt(5)
    v_mad_u32_u16 v64, v8, 8, s18
    v_mad_u32_u16 v66, v9, 8, s18
    v_mad_u32_u16 v68, v10, 8, s18
    ds_read_b64 v[64:65], v64
    ds_read_b64 v[66:67], v66
    ds_read_b64 v[68:69], v68
    s_add_u32 s14, s22, 32768
    buffer_load_dwordx4 v[96:99], v1, s[8:11], s14 offen
    s_waitcnt vmcnt(5)
    v_mad_u32_u16 v70, v12, 8, s18
    v_mad_u32_u16 v72, v13, 8, s18
    v_mad_u32_u16 v74, v14, 8, s18
    ds_read_b64 v[70:71], v70
    ds_read_b64 v[72:73], v72
    ds_read_b64 v[74:75], v74
    s_add_u32 s14, s22, 49152
    buffer_load_dwordx4 v[100:103], v1, s[8:11], s14 offen
    s_waitcnt lgkmcnt(6)
    v_or_b32 v7, v108, v109
    s_nop 0
    v_readlane_b32 s30, v7, 0
    v_readlane_b32 s31, v7, 1
    v_readlane_b32 s32, v7, 2
    v_readlane_b32 s33, v7, 3
    v_readlane_b32 s34, v7, 4
    v_readlane_b32 s35, v7, 5
    v_readlane_b32 s36, v7, 6
    v_readlane_b32 s37, v7, 7
    s_mov_b32 s25, s19
    s_mov_b32 s26, s27
    s_mov_b32 s51, s28
    s_mov_b32 s28, s29
    v_mbcnt_lo_u32_b32 v51, s30, 0
    v_mbcnt_hi_u32_b32 v51, s31, v51
    s_bcnt1_i32_b64 s14, s[30:31]
    v_lshl_add_u32 v55, v51, 1, s25
    ds_read_u16 v55, v55
    s_mov_b32 s30, s26
    s_movk_i32 s31, -320
    s_lshl1_add_u32 s25, s14, s25
    s_lshl_b32 s14, s14, 12
    s_add_u32 s26, s26, s14
    v_bfe_i32 v108, v11, 2, 10
    v_bfe_i32 v109, v11, 12, 10
    v_ashrrev_i32 v110, 22, v11
    v_cvt_f32_i32 v108, v108
    v_cvt_f32_i32 v109, v109
    v_cvt_f32_i32 v110, v110
    s_waitcnt lgkmcnt(4)
    v_mfma_f32_4x4x4_16b_bf16 v[112:115], v[58:59], v[64:65], 0
    v_mfma_f32_4x4x4_16b_bf16 v[116:119], v[58:59], v[66:67], 0
    v_mfma_f32_4x4x4_16b_bf16 v[120:123], v[58:59], v[68:69], 0
    v_mad_u32_u16 v8, v8, 8, s50 op_sel:[1,0,0,0]
    v_mad_u32_u16 v9, v9, 8, s50 op_sel:[1,0,0,0]
    v_mad_u32_u16 v10, v10, 8, s50 op_sel:[1,0,0,0]
    v_pk_fma_f32 v[114:115], v[114:115], v[108:109], s[20:21] op_sel:[0,0,0] op_sel_hi:[1,0,1]
    v_pk_fma_f32 v[112:113], v[112:113], v[108:109], s[16:17] op_sel:[0,0,0] op_sel_hi:[1,0,1]
    v_pk_fma_f32 v[118:119], v[118:119], v[108:109], s[20:21] op_sel:[0,1,0] op_sel_hi:[1,1,1]
    v_pk_fma_f32 v[116:117], v[116:117], v[108:109], s[16:17] op_sel:[0,1,0] op_sel_hi:[1,1,1]
    v_pk_fma_f32 v[122:123], v[122:123], v[110:111], s[20:21] op_sel:[0,0,0] op_sel_hi:[1,0,1]
    v_pk_fma_f32 v[120:121], v[120:121], v[110:111], s[16:17] op_sel:[0,0,0] op_sel_hi:[1,0,1]
    v_lshlrev_b64 v[114:115], 16, v[114:115]
    v_lshlrev_b64 v[118:119], 16, v[118:119]
    v_lshlrev_b64 v[122:123], 16, v[122:123]
    v_lshl_add_u64 v[64:65], v[112:113], 0, v[114:115]
    v_lshl_add_u64 v[66:67], v[116:117], 0, v[118:119]
    v_lshl_add_u64 v[68:69], v[120:121], 0, v[122:123]
    v_or3_b32 v4, v44, v45, v4
    v_or3_b32 v4, v46, v47, v4
    v_or3_b32 v4, v48, v49, v4
    ds_add_rtn_u64 v[44:45], v8, v[64:65]
    ds_add_rtn_u64 v[46:47], v9, v[66:67]
    ds_add_rtn_u64 v[48:49], v10, v[68:69]
    s_waitcnt lgkmcnt(3)
    v_add3_u32 v55, v55, v2, s31
    v_lshl_add_u32 v51, v51, 8, v55
    v_lshrrev_b32 v55, 8, v55
    v_mad_u32_u24 v51, v55, s23, v51
    buffer_load_dwordx4 v[8:11], v51, s[44:47], s30 idxen
    s_sub_u32 s14, s22, 80000
    buffer_load_dwordx4 v[104:107], v124, s[8:11], s14 offen
    s_waitcnt vmcnt(7)
    v_mad_u32_u16 v76, v16, 8, s18
    v_mad_u32_u16 v78, v17, 8, s18
    v_mad_u32_u16 v80, v18, 8, s18
    ds_read_b64 v[76:77], v76
    ds_read_b64 v[78:79], v78
    ds_read_b64 v[80:81], v80
    s_waitcnt vmcnt(6)
    v_mad_u32_u16 v82, v20, 8, s18
    v_mad_u32_u16 v84, v21, 8, s18
    v_mad_u32_u16 v86, v22, 8, s18
    ds_read_b64 v[82:83], v82
    ds_read_b64 v[84:85], v84
    ds_read_b64 v[86:87], v86
    s_cmp_le_u32 s51, 256
    s_cbranch_scc1 L_p2_kernel_noopt3_2
    v_mad_u32_u16 v64, v24, 8, s18
    v_mad_u32_u16 v66, v25, 8, s18
    v_mad_u32_u16 v68, v26, 8, s18
    ds_read_b64 v[64:65], v64
    ds_read_b64 v[66:67], v66
    ds_read_b64 v[68:69], v68
L_p2_kernel_noopt3_2:
    v_mbcnt_lo_u32_b32 v51, s32, 0
    v_mbcnt_hi_u32_b32 v51, s33, v51
    s_bcnt1_i32_b64 s14, s[32:33]
    v_lshl_add_u32 v55, v51, 1, s25
    ds_read_u16 v55, v55
    s_mov_b32 s32, s26
    s_movk_i32 s33, -256
    s_lshl1_add_u32 s25, s14, s25
    s_lshl_b32 s14, s14, 12
    s_add_u32 s26, s26, s14
    v_bfe_i32 v108, v15, 2, 10
    v_bfe_i32 v109, v15, 12, 10
    v_ashrrev_i32 v110, 22, v15
    v_cvt_f32_i32 v108, v108
    v_cvt_f32_i32 v109, v109
    v_cvt_f32_i32 v110, v110
    v_mfma_f32_4x4x4_16b_bf16 v[112:115], v[58:59], v[70:71], 0
    v_mfma_f32_4x4x4_16b_bf16 v[116:119], v[58:59], v[72:73], 0
    v_mfma_f32_4x4x4_16b_bf16 v[120:123], v[58:59], v[74:75], 0
    v_mad_u32_u16 v12, v12, 8, s50 op_sel:[1,0,0,0]
    v_mad_u32_u16 v13, v13, 8, s50 op_sel:[1,0,0,0]
    v_mad_u32_u16 v14, v14, 8, s50 op_sel:[1,0,0,0]
    v_pk_fma_f32 v[114:115], v[114:115], v[108:109], s[20:21] op_sel:[0,0,0] op_sel_hi:[1,0,1]
    v_pk_fma_f32 v[112:113], v[112:113], v[108:109], s[16:17] op_sel:[0,0,0] op_sel_hi:[1,0,1]
    v_pk_fma_f32 v[118:119], v[118:119], v[108:109], s[20:21] op_sel:[0,1,0] op_sel_hi:[1,1,1]
    v_pk_fma_f32 v[116:117], v[116:117], v[108:109], s[16:17] op_sel:[0,1,0] op_sel_hi:[1,1,1]
    v_pk_fma_f32 v[122:123], v[122:123], v[110:111], s[20:21] op_sel:[0,0,0] op_sel_hi:[1,0,1]
    v_pk_fma_f32 v[120:121], v[120:121], v[110:111], s[16:17] op_sel:[0,0,0] op_sel_hi:[1,0,1]
    v_lshlrev_b64 v[114:115], 16, v[114:115]
    v_lshlrev_b64 v[118:119], 16, v[118:119]
    v_lshlrev_b64 v[122:123], 16, v[122:123]
    v_lshl_add_u64 v[70:71], v[112:113], 0, v[114:115]
    v_lshl_add_u64 v[72:73], v[116:117], 0, v[118:119]
    v_lshl_add_u64 v[74:75], v[120:121], 0, v[122:123]
    s_waitcnt lgkmcnt(7)
    v_or3_b32 v4, v44, v45, v4
    v_or3_b32 v4, v46, v47, v4
    v_or3_b32 v4, v48, v49, v4
    ds_add_rtn_u64 v[44:45], v12, v[70:71]
    ds_add_rtn_u64 v[46:47], v13, v[72:73]
    ds_add_rtn_u64 v[48:49], v14, v[74:75]
    s_waitcnt lgkmcnt(3)
    v_add3_u32 v55, v55, v2, s33
    v_lshl_add_u32 v51, v51, 8, v55
    v_lshrrev_b32 v55, 8, v55
    v_mad_u32_u24 v51, v55, s23, v51
    buffer_load_dwordx4 v[12:15], v51, s[44:47], s32 idxen
    s_barrier
    s_waitcnt vmcnt(1)
    ds_write_b128 v3, v[88:91] offset:0
    ds_write_b128 v3, v[92:95] offset:16384
    ds_write_b128 v3, v[96:99] offset:32768
    ds_write_b128 v3, v[100:103] offset:49152
    ds_write_b128 v124, v[104:107] offset:0
    s_cmp_lg_u32 s24, 7
    s_cbranch_scc1 L_p2_nofin
    s_mul_i32 s14, s3, 20000
    s_mul_i32 s15, s12, 4992
    s_add_u32 s14, s14, s15
    s_add_u32 s15, s14, 4096
    v_min_u32 v61, 231, v0
    v_lshl_add_u32 v60, v0, 2, s14
    v_lshl_add_u32 v61, v61, 2, s15
    global_load_dword v60, v60, s[100:101] nt
    global_load_dword v61, v61, s[100:101] nt
    s_lshl_b32 s14, s14, 2
    s_lshl_b32 s15, s15, 2
    v_min_u32 v36, 231, v0
    v_add_u32 v28, s14, v1
    v_lshl_add_u32 v36, v36, 4, s15
    global_load_dwordx4 v[28:31], v28, s[8:9]
    global_load_dwordx4 v[36:39], v36, s[8:9]
L_p2_nofin:
    v_mbcnt_lo_u32_b32 v51, s34, 0
    v_mbcnt_hi_u32_b32 v51, s35, v51
    s_bcnt1_i32_b64 s14, s[34:35]
    v_lshl_add_u32 v55, v51, 1, s25
    ds_read_u16 v55, v55
    s_mov_b32 s34, s26
    s_movk_i32 s35, -192
    s_lshl1_add_u32 s25, s14, s25
    s_lshl_b32 s14, s14, 12
    s_add_u32 s26, s26, s14
    v_bfe_i32 v108, v19, 2, 10
    v_bfe_i32 v109, v19, 12, 10
    v_ashrrev_i32 v110, 22, v19
    v_cvt_f32_i32 v108, v108
    v_cvt_f32_i32 v109, v109
    v_cvt_f32_i32 v110, v110
    v_mfma_f32_4x4x4_16b_bf16 v[112:115], v[58:59], v[76:77], 0
    v_mfma_f32_4x4x4_16b_bf16 v[116:119], v[58:59], v[78:79], 0
    v_mfma_f32_4x4x4_16b_bf16 v[120:123], v[58:59], v[80:81], 0
    v_mad_u32_u16 v16, v16, 8, s50 op_sel:[1,0,0,0]
    v_mad_u32_u16 v17, v17, 8, s50 op_sel:[1,0,0,0]
    v_mad_u32_u16 v18, v18, 8, s50 op_sel:[1,0,0,0]
    v_pk_fma_f32 v[114:115], v[114:115], v[108:109], s[20:21] op_sel:[0,0,0] op_sel_hi:[1,0,1]
    v_pk_fma_f32 v[112:113], v[112:113], v[108:109], s[16:17] op_sel:[0,0,0] op_sel_hi:[1,0,1]
    v_pk_fma_f32 v[118:119], v[118:119], v[108:109], s[20:21] op_sel:[0,1,0] op_sel_hi:[1,1,1]
    v_pk_fma_f32 v[116:117], v[116:117], v[108:109], s[16:17] op_sel:[0,1,0] op_sel_hi:[1,1,1]
    v_pk_fma_f32 v[122:123], v[122:123], v[110:111], s[20:21] op_sel:[0,0,0] op_sel_hi:[1,0,1]
    v_pk_fma_f32 v[120:121], v[120:121], v[110:111], s[16:17] op_sel:[0,0,0] op_sel_hi:[1,0,1]
    v_lshlrev_b64 v[114:115], 16, v[114:115]
    v_lshlrev_b64 v[118:119], 16, v[118:119]
    v_lshlrev_b64 v[122:123], 16, v[122:123]
    v_lshl_add_u64 v[76:77], v[112:113], 0, v[114:115]
    v_lshl_add_u64 v[78:79], v[116:117], 0, v[118:119]
    v_lshl_add_u64 v[80:81], v[120:121], 0, v[122:123]
    s_waitcnt lgkmcnt(6)
    v_or3_b32 v4, v44, v45, v4
    v_or3_b32 v4, v46, v47, v4
    v_or3_b32 v4, v48, v49, v4
    ds_add_rtn_u64 v[44:45], v16, v[76:77]
    ds_add_rtn_u64 v[46:47], v17, v[78:79]
    ds_add_rtn_u64 v[48:49], v18, v[80:81]
    s_waitcnt lgkmcnt(3)
    v_add3_u32 v55, v55, v2, s35
    v_lshl_add_u32 v51, v51, 8, v55
    v_lshrrev_b32 v55, 8, v55
    v_mad_u32_u24 v51, v55, s23, v51
    buffer_load_dwordx4 v[16:19], v51, s[44:47], s34 idxen
    s_cmp_le_u32 s51, 256
    s_cbranch_scc1 L_p2_kernel_noopt3_3
    v_bfe_i32 v108, v27, 2, 10
    v_bfe_i32 v109, v27, 12, 10
    v_ashrrev_i32 v110, 22, v27
    v_cvt_f32_i32 v108, v108
    v_cvt_f32_i32 v109, v109
    v_cvt_f32_i32 v110, v110
    v_mfma_f32_4x4x4_16b_bf16 v[112:115], v[58:59], v[64:65], 0
    v_mfma_f32_4x4x4_16b_bf16 v[116:119], v[58:59], v[66:67], 0
    v_mfma_f32_4x4x4_16b_bf16 v[120:123], v[58:59], v[68:69], 0
    v_mad_u32_u16 v24, v24, 8, s50 op_sel:[1,0,0,0]
    v_mad_u32_u16 v25, v25, 8, s50 op_sel:[1,0,0,0]
    v_mad_u32_u16 v26, v26, 8, s50 op_sel:[1,0,0,0]
    v_pk_fma_f32 v[114:115], v[114:115], v[108:109], s[20:21] op_sel:[0,0,0] op_sel_hi:[1,0,1]
    v_pk_fma_f32 v[112:113], v[112:113], v[108:109], s[16:17] op_sel:[0,0,0] op_sel_hi:[1,0,1]
    v_pk_fma_f32 v[118:119], v[118:119], v[108:109], s[20:21] op_sel:[0,1,0] op_sel_hi:[1,1,1]
    v_pk_fma_f32 v[116:117], v[116:117], v[108:109], s[16:17] op_sel:[0,1,0] op_sel_hi:[1,1,1]
    v_pk_fma_f32 v[122:123], v[122:123], v[110:111], s[20:21] op_sel:[0,0,0] op_sel_hi:[1,0,1]
    v_pk_fma_f32 v[120:121], v[120:121], v[110:111], s[16:17] op_sel:[0,0,0] op_sel_hi:[1,0,1]
    v_lshlrev_b64 v[114:115], 16, v[114:115]
    v_lshlrev_b64 v[118:119], 16, v[118:119]
    v_lshlrev_b64 v[122:123], 16, v[122:123]
    v_lshl_add_u64 v[64:65], v[112:113], 0, v[114:115]
    v_lshl_add_u64 v[66:67], v[116:117], 0, v[118:119]
    v_lshl_add_u64 v[68:69], v[120:121], 0, v[122:123]
    s_waitcnt lgkmcnt(0)
    v_or3_b32 v4, v44, v45, v4
    v_or3_b32 v4, v46, v47, v4
    v_or3_b32 v4, v48, v49, v4
    ds_add_rtn_u64 v[44:45], v24, v[64:65]
    ds_add_rtn_u64 v[46:47], v25, v[66:67]
    ds_add_rtn_u64 v[48:49], v26, v[68:69]
L_p2_kernel_noopt3_3:
    v_mbcnt_lo_u32_b32 v51, s36, 0
    v_mbcnt_hi_u32_b32 v51, s37, v51
    s_bcnt1_i32_b64 s14, s[36:37]
    v_lshl_add_u32 v55, v51, 1, s25
    ds_read_u16 v55, v55
    s_mov_b32 s36, s26
    s_movk_i32 s37, -128
    s_lshl1_add_u32 s25, s14, s25
    s_lshl_b32 s14, s14, 12
    s_add_u32 s26, s26, s14
    s_cmp_le_u32 s28, 256
    s_cbranch_scc1 L_p2_kernel_noopt3_4
    v_readlane_b32 s38, v7, 8
    v_readlane_b32 s39, v7, 9
    s_nop 1
    v_mbcnt_lo_u32_b32 v62, s38, 0
    v_mbcnt_hi_u32_b32 v62, s39, v62
    s_bcnt1_i32_b64 s14, s[38:39]
    v_lshl_add_u32 v63, v62, 1, s25
    ds_read_u16 v63, v63
    s_mov_b32 s38, s26
    s_movk_i32 s39, -64
    s_lshl1_add_u32 s25, s14, s25
    s_lshl_b32 s14, s14, 12
    s_add_u32 s26, s26, s14
L_p2_kernel_noopt3_4:
    v_bfe_i32 v108, v23, 2, 10
    v_bfe_i32 v109, v23, 12, 10
    v_ashrrev_i32 v110, 22, v23
    v_cvt_f32_i32 v108, v108
    v_cvt_f32_i32 v109, v109
    v_cvt_f32_i32 v110, v110
    v_mfma_f32_4x4x4_16b_bf16 v[112:115], v[58:59], v[82:83], 0
    v_mfma_f32_4x4x4_16b_bf16 v[116:119], v[58:59], v[84:85], 0
    v_mfma_f32_4x4x4_16b_bf16 v[120:123], v[58:59], v[86:87], 0
    v_mad_u32_u16 v20, v20, 8, s50 op_sel:[1,0,0,0]
    v_mad_u32_u16 v21, v21, 8, s50 op_sel:[1,0,0,0]
    v_mad_u32_u16 v22, v22, 8, s50 op_sel:[1,0,0,0]
    v_pk_fma_f32 v[114:115], v[114:115], v[108:109], s[20:21] op_sel:[0,0,0] op_sel_hi:[1,0,1]
    v_pk_fma_f32 v[112:113], v[112:113], v[108:109], s[16:17] op_sel:[0,0,0] op_sel_hi:[1,0,1]
    v_pk_fma_f32 v[118:119], v[118:119], v[108:109], s[20:21] op_sel:[0,1,0] op_sel_hi:[1,1,1]
    v_pk_fma_f32 v[116:117], v[116:117], v[108:109], s[16:17] op_sel:[0,1,0] op_sel_hi:[1,1,1]
    v_pk_fma_f32 v[122:123], v[122:123], v[110:111], s[20:21] op_sel:[0,0,0] op_sel_hi:[1,0,1]
    v_pk_fma_f32 v[120:121], v[120:121], v[110:111], s[16:17] op_sel:[0,0,0] op_sel_hi:[1,0,1]
    v_lshlrev_b64 v[114:115], 16, v[114:115]
    v_lshlrev_b64 v[118:119], 16, v[118:119]
    v_lshlrev_b64 v[122:123], 16, v[122:123]
    v_lshl_add_u64 v[82:83], v[112:113], 0, v[114:115]
    v_lshl_add_u64 v[84:85], v[116:117], 0, v[118:119]
    v_lshl_add_u64 v[86:87], v[120:121], 0, v[122:123]
    s_waitcnt lgkmcnt(1)
    v_or3_b32 v4, v44, v45, v4
    v_or3_b32 v4, v46, v47, v4
    v_or3_b32 v4, v48, v49, v4
    ds_add_rtn_u64 v[44:45], v20, v[82:83]
    ds_add_rtn_u64 v[46:47], v21, v[84:85]
    ds_add_rtn_u64 v[48:49], v22, v[86:87]
    s_waitcnt lgkmcnt(3)
    v_add3_u32 v55, v55, v2, s37
    v_lshl_add_u32 v51, v51, 8, v55
    v_lshrrev_b32 v55, 8, v55
    v_mad_u32_u24 v51, v55, s23, v51
    buffer_load_dwordx4 v[20:23], v51, s[44:47], s36 idxen
    s_cmp_le_u32 s28, 256
    s_cbranch_scc1 L_p2_kernel_noopt3_5
    v_add3_u32 v63, v63, v2, s39
    v_lshl_add_u32 v62, v62, 8, v63
    v_lshrrev_b32 v63, 8, v63
    v_mad_u32_u24 v62, v63, s23, v62
    buffer_load_dwordx4 v[24:27], v62, s[44:47], s38 idxen
L_p2_kernel_noopt3_5:
    s_add_u32 s14, s22, 80000
    buffer_load_dwordx4 v[88:91], v1, s[8:11], s14 offen
    s_add_u32 s14, s24, 1
    s_min_u32 s14, s14, 7
    s_set_gpr_idx_on s14, gpr_idx(SRC0)
    v_mad_u32_u16 v108, v28, v50, s40 op_sel:[0,0,0,0]
    v_mad_u32_u16 v109, v36, v50, s41 op_sel:[0,0,0,0]
    s_set_gpr_idx_off
    v_sub_u32_sdwa v110, v109, v108 dst_sel:DWORD dst_unused:UNUSED_PAD src0_sel:WORD_1 src1_sel:WORD_1
    s_nop 1
    v_add_u32_dpp v110, v110, v110 row_shr:1 row_mask:0xf bank_mask:0xf bound_ctrl:0
    s_nop 1
    v_add_u32_dpp v110, v110, v110 row_shr:2 row_mask:0xf bank_mask:0xf bound_ctrl:0
    s_nop 1
    v_add_u32_dpp v110, v110, v110 row_shr:4 row_mask:0xf bank_mask:0xf bound_ctrl:0
    s_nop 1
    v_add_u32_dpp v110, v110, v110 row_shr:8 row_mask:0xf bank_mask:0xf bound_ctrl:0
    s_nop 1
    v_add_u32_dpp v110, v110, v110 row_bcast:15 row_mask:0xa bank_mask:0xf
    s_nop 1
    v_add_u32_dpp v110, v110, v110 row_bcast:31 row_mask:0xc bank_mask:0xf
    v_sub_u32_sdwa v109, v109, v110 dst_sel:DWORD dst_unused:UNUSED_PAD src0_sel:WORD_1 src1_sel:DWORD
    v_readlane_b32 s29, v110, 63
    v_add_u32 v110, -1, v110
    ds_write_b16 v126, v109
    v_lshlrev_b32_e64 v111, v110, 1
    v_lshrrev_b32 v110, 5, v110
    s_cmp_gt_u32 s29, 320
    s_cselect_b32 s2, 1, s2
    v_lshl_add_u32 v110, v110, 2, v127
    s_cselect_b64 exec, 0, -1
    ds_or_b32 v110, v111 offset:136
    s_mov_b64 exec, -1
    ds_wrxchg2_rtn_b32 v[108:109], v6, v5, v5 offset0:34 offset1:44
    s_add_u32 s14, s22, 96384
    buffer_load_dwordx4 v[92:95], v1, s[8:11], s14 offen
    s_barrier
    s_add_u32 s22, s22, 80000
    s_cmp_eq_u32 s24, 7
    s_cselect_b32 s46, 0, s46
    v_mad_u32_u16 v64, v8, 8, s18
    v_mad_u32_u16 v66, v9, 8, s18
    v_mad_u32_u16 v68, v10, 8, s18
    ds_read_b64 v[64:65], v64
    ds_read_b64 v[66:67], v66
    ds_read_b64 v[68:69], v68
    s_add_u32 s14, s22, 32768
    buffer_load_dwordx4 v[96:99], v1, s[8:11], s14 offen
    s_waitcnt vmcnt(5)
    v_mad_u32_u16 v70, v12, 8, s18
    v_mad_u32_u16 v72, v13, 8, s18
    v_mad_u32_u16 v74, v14, 8, s18
    ds_read_b64 v[70:71], v70
    ds_read_b64 v[72:73], v72
    ds_read_b64 v[74:75], v74
    s_add_u32 s14, s22, 49152
    buffer_load_dwordx4 v[100:103], v1, s[8:11], s14 offen
    s_waitcnt lgkmcnt(6)
    v_or_b32 v7, v108, v109
    s_nop 0
    v_readlane_b32 s30, v7, 0
    v_readlane_b32 s31, v7, 1
    v_readlane_b32 s32, v7, 2
    v_readlane_b32 s33, v7, 3
    v_readlane_b32 s34, v7, 4
    v_readlane_b32 s35, v7, 5
    v_readlane_b32 s36, v7, 6
    v_readlane_b32 s37, v7, 7
    s_mov_b32 s25, s19
    s_mov_b32 s26, s27
    s_mov_b32 s51, s28
    s_mov_b32 s28, s29
    v_mbcnt_lo_u32_b32 v51, s30, 0
    v_mbcnt_hi_u32_b32 v51, s31, v51
    s_bcnt1_i32_b64 s14, s[30:31]
    v_lshl_add_u32 v55, v51, 1, s25
    ds_read_u16 v55, v55
    s_mov_b32 s30, s26
    s_movk_i32 s31, -320
    s_lshl1_add_u32 s25, s14, s25
    s_lshl_b32 s14, s14, 12
    s_add_u32 s26, s26, s14
    v_bfe_i32 v108, v11, 2, 10
    v_bfe_i32 v109, v11, 12, 10
    v_ashrrev_i32 v110, 22, v11
    v_cvt_f32_i32 v108, v108
    v_cvt_f32_i32 v109, v109
    v_cvt_f32_i32 v110, v110
    s_waitcnt lgkmcnt(4)
    v_mfma_f32_4x4x4_16b_bf16 v[112:115], v[58:59], v[64:65], 0
    v_mfma_f32_4x4x4_16b_bf16 v[116:119], v[58:59], v[66:67], 0
    v_mfma_f32_4x4x4_16b_bf16 v[120:123], v[58:59], v[68:69], 0
    v_mad_u32_u16 v8, v8, 8, s50 op_sel:[1,0,0,0]
    v_mad_u32_u16 v9, v9, 8, s50 op_sel:[1,0,0,0]
    v_mad_u32_u16 v10, v10, 8, s50 op_sel:[1,0,0,0]
    v_pk_fma_f32 v[114:115], v[114:115], v[108:109], s[20:21] op_sel:[0,0,0] op_sel_hi:[1,0,1]
    v_pk_fma_f32 v[112:113], v[112:113], v[108:109], s[16:17] op_sel:[0,0,0] op_sel_hi:[1,0,1]
    v_pk_fma_f32 v[118:119], v[118:119], v[108:109], s[20:21] op_sel:[0,1,0] op_sel_hi:[1,1,1]
    v_pk_fma_f32 v[116:117], v[116:117], v[108:109], s[16:17] op_sel:[0,1,0] op_sel_hi:[1,1,1]
    v_pk_fma_f32 v[122:123], v[122:123], v[110:111], s[20:21] op_sel:[0,0,0] op_sel_hi:[1,0,1]
    v_pk_fma_f32 v[120:121], v[120:121], v[110:111], s[16:17] op_sel:[0,0,0] op_sel_hi:[1,0,1]
    v_lshlrev_b64 v[114:115], 16, v[114:115]
    v_lshlrev_b64 v[118:119], 16, v[118:119]
    v_lshlrev_b64 v[122:123], 16, v[122:123]
    v_lshl_add_u64 v[64:65], v[112:113], 0, v[114:115]
    v_lshl_add_u64 v[66:67], v[116:117], 0, v[118:119]
    v_lshl_add_u64 v[68:69], v[120:121], 0, v[122:123]
    v_or3_b32 v4, v44, v45, v4
    v_or3_b32 v4, v46, v47, v4
    v_or3_b32 v4, v48, v49, v4
    ds_add_rtn_u64 v[44:45], v8, v[64:65]
    ds_add_rtn_u64 v[46:47], v9, v[66:67]
    ds_add_rtn_u64 v[48:49], v10, v[68:69]
    s_waitcnt lgkmcnt(3)
    v_add3_u32 v55, v55, v2, s31
    v_lshl_add_u32 v51, v51, 8, v55
    v_lshrrev_b32 v55, 8, v55
    v_mad_u32_u24 v51, v55, s23, v51
    buffer_load_dwordx4 v[8:11], v51, s[44:47], s30 idxen
    s_sub_u32 s14, s22, 80000
    buffer_load_dwordx4 v[104:107], v124, s[8:11], s14 offen
    s_waitcnt vmcnt(7)
    v_mad_u32_u16 v76, v16, 8, s18
    v_mad_u32_u16 v78, v17, 8, s18
    v_mad_u32_u16 v80, v18, 8, s18
    ds_read_b64 v[76:77], v76
    ds_read_b64 v[78:79], v78
    ds_read_b64 v[80:81], v80
    s_waitcnt vmcnt(6)
    v_mad_u32_u16 v82, v20, 8, s18
    v_mad_u32_u16 v84, v21, 8, s18
    v_mad_u32_u16 v86, v22, 8, s18
    ds_read_b64 v[82:83], v82
    ds_read_b64 v[84:85], v84
    ds_read_b64 v[86:87], v86
    s_cmp_le_u32 s51, 256
    s_cbranch_scc1 L_p2_kernel_noopt3_6
    v_mad_u32_u16 v64, v24, 8, s18
    v_mad_u32_u16 v66, v25, 8, s18
    v_mad_u32_u16 v68, v26, 8, s18
    ds_read_b64 v[64:65], v64
    ds_read_b64 v[66:67], v66
    ds_read_b64 v[68:69], v68
L_p2_kernel_noopt3_6:
    v_mbcnt_lo_u32_b32 v51, s32, 0
    v_mbcnt_hi_u32_b32 v51, s33, v51
    s_bcnt1_i32_b64 s14, s[32:33]
    v_lshl_add_u32 v55, v51, 1, s25
    ds_read_u16 v55, v55
    s_mov_b32 s32, s26
    s_movk_i32 s33, -256
    s_lshl1_add_u32 s25, s14, s25
    s_lshl_b32 s14, s14, 12
    s_add_u32 s26, s26, s14
    v_bfe_i32 v108, v15, 2, 10
    v_bfe_i32 v109, v15, 12, 10
    v_ashrrev_i32 v110, 22, v15
    v_cvt_f32_i32 v108, v108
    v_cvt_f32_i32 v109, v109
    v_cvt_f32_i32 v110, v110
    v_mfma_f32_4x4x4_16b_bf16 v[112:115], v[58:59], v[70:71], 0
    v_mfma_f32_4x4x4_16b_bf16 v[116:119], v[58:59], v[72:73], 0
    v_mfma_f32_4x4x4_16b_bf16 v[120:123], v[58:59], v[74:75], 0
    v_mad_u32_u16 v12, v12, 8, s50 op_sel:[1,0,0,0]
    v_mad_u32_u16 v13, v13, 8, s50 op_sel:[1,0,0,0]
    v_mad_u32_u16 v14, v14, 8, s50 op_sel:[1,0,0,0]
    v_pk_fma_f32 v[114:115], v[114:115], v[108:109], s[20:21] op_sel:[0,0,0] op_sel_hi:[1,0,1]
    v_pk_fma_f32 v[112:113], v[112:113], v[108:109], s[16:17] op_sel:[0,0,0] op_sel_hi:[1,0,1]
    v_pk_fma_f32 v[118:119], v[118:119], v[108:109], s[20:21] op_sel:[0,1,0] op_sel_hi:[1,1,1]
    v_pk_fma_f32 v[116:117], v[116:117], v[108:109], s[16:17] op_sel:[0,1,0] op_sel_hi:[1,1,1]
    v_pk_fma_f32 v[122:123], v[122:123], v[110:111], s[20:21] op_sel:[0,0,0] op_sel_hi:[1,0,1]
    v_pk_fma_f32 v[120:121], v[120:121], v[110:111], s[16:17] op_sel:[0,0,0] op_sel_hi:[1,0,1]
    v_lshlrev_b64 v[114:115], 16, v[114:115]
    v_lshlrev_b64 v[118:119], 16, v[118:119]
    v_lshlrev_b64 v[122:123], 16, v[122:123]
    v_lshl_add_u64 v[70:71], v[112:113], 0, v[114:115]
    v_lshl_add_u64 v[72:73], v[116:117], 0, v[118:119]
    v_lshl_add_u64 v[74:75], v[120:121], 0, v[122:123]
    s_waitcnt lgkmcnt(7)
    v_or3_b32 v4, v44, v45, v4
    v_or3_b32 v4, v46, v47, v4
    v_or3_b32 v4, v48, v49, v4
    ds_add_rtn_u64 v[44:45], v12, v[70:71]
    ds_add_rtn_u64 v[46:47], v13, v[72:73]
    ds_add_rtn_u64 v[48:49], v14, v[74:75]
    s_waitcnt lgkmcnt(3)
    v_add3_u32 v55, v55, v2, s33
    v_lshl_add_u32 v51, v51, 8, v55
    v_lshrrev_b32 v55, 8, v55
    v_mad_u32_u24 v51, v55, s23, v51
    buffer_load_dwordx4 v[12:15], v51, s[44:47], s32 idxen
    s_cmp_lg_u32 s24, 7
    s_cbranch_scc1 L_p2_stage
    s_waitcnt lgkmcnt(0)
    s_branch L_p2_staged
L_p2_stage:
    s_barrier
    s_waitcnt vmcnt(1)
    ds_write_b128 v3, v[88:91] offset:0
    ds_write_b128 v3, v[92:95] offset:16384
    ds_write_b128 v3, v[96:99] offset:32768
    ds_write_b128 v3, v[100:103] offset:49152
    ds_write_b128 v124, v[104:107] offset:0
L_p2_staged:
    v_mbcnt_lo_u32_b32 v51, s34, 0
    v_mbcnt_hi_u32_b32 v51, s35, v51
    s_bcnt1_i32_b64 s14, s[34:35]
    v_lshl_add_u32 v55, v51, 1, s25
    ds_read_u16 v55, v55
    s_mov_b32 s34, s26
    s_movk_i32 s35, -192
    s_lshl1_add_u32 s25, s14, s25
    s_lshl_b32 s14, s14, 12
    s_add_u32 s26, s26, s14
    v_bfe_i32 v108, v19, 2, 10
    v_bfe_i32 v109, v19, 12, 10
    v_ashrrev_i32 v110, 22, v19
    v_cvt_f32_i32 v108, v108
    v_cvt_f32_i32 v109, v109
    v_cvt_f32_i32 v110, v110
    v_mfma_f32_4x4x4_16b_bf16 v[112:115], v[58:59], v[76:77], 0
    v_mfma_f32_4x4x4_16b_bf16 v[116:119], v[58:59], v[78:79], 0
    v_mfma_f32_4x4x4_16b_bf16 v[120:123], v[58:59], v[80:81], 0
    v_mad_u32_u16 v16, v16, 8, s50 op_sel:[1,0,0,0]
    v_mad_u32_u16 v17, v17, 8, s50 op_sel:[1,0,0,0]
    v_mad_u32_u16 v18, v18, 8, s50 op_sel:[1,0,0,0]
    v_pk_fma_f32 v[114:115], v[114:115], v[108:109], s[20:21] op_sel:[0,0,0] op_sel_hi:[1,0,1]
    v_pk_fma_f32 v[112:113], v[112:113], v[108:109], s[16:17] op_sel:[0,0,0] op_sel_hi:[1,0,1]
    v_pk_fma_f32 v[118:119], v[118:119], v[108:109], s[20:21] op_sel:[0,1,0] op_sel_hi:[1,1,1]
    v_pk_fma_f32 v[116:117], v[116:117], v[108:109], s[16:17] op_sel:[0,1,0] op_sel_hi:[1,1,1]
    v_pk_fma_f32 v[122:123], v[122:123], v[110:111], s[20:21] op_sel:[0,0,0] op_sel_hi:[1,0,1]
    v_pk_fma_f32 v[120:121], v[120:121], v[110:111], s[16:17] op_sel:[0,0,0] op_sel_hi:[1,0,1]
    v_lshlrev_b64 v[114:115], 16, v[114:115]
    v_lshlrev_b64 v[118:119], 16, v[118:119]
    v_lshlrev_b64 v[122:123], 16, v[122:123]
    v_lshl_add_u64 v[76:77], v[112:113], 0, v[114:115]
    v_lshl_add_u64 v[78:79], v[116:117], 0, v[118:119]
    v_lshl_add_u64 v[80:81], v[120:121], 0, v[122:123]
    s_waitcnt lgkmcnt(6)
    v_or3_b32 v4, v44, v45, v4
    v_or3_b32 v4, v46, v47, v4
    v_or3_b32 v4, v48, v49, v4
    ds_add_rtn_u64 v[44:45], v16, v[76:77]
    ds_add_rtn_u64 v[46:47], v17, v[78:79]
    ds_add_rtn_u64 v[48:49], v18, v[80:81]
    s_waitcnt lgkmcnt(3)
    v_add3_u32 v55, v55, v2, s35
    v_lshl_add_u32 v51, v51, 8, v55
    v_lshrrev_b32 v55, 8, v55
    v_mad_u32_u24 v51, v55, s23, v51
    buffer_load_dwordx4 v[16:19], v51, s[44:47], s34 idxen
    s_cmp_le_u32 s51, 256
    s_cbranch_scc1 L_p2_kernel_noopt3_7
    v_bfe_i32 v108, v27, 2, 10
    v_bfe_i32 v109, v27, 12, 10
    v_ashrrev_i32 v110, 22, v27
    v_cvt_f32_i32 v108, v108
    v_cvt_f32_i32 v109, v109
    v_cvt_f32_i32 v110, v110
    v_mfma_f32_4x4x4_16b_bf16 v[112:115], v[58:59], v[64:65], 0
    v_mfma_f32_4x4x4_16b_bf16 v[116:119], v[58:59], v[66:67], 0
    v_mfma_f32_4x4x4_16b_bf16 v[120:123], v[58:59], v[68:69], 0
    v_mad_u32_u16 v24, v24, 8, s50 op_sel:[1,0,0,0]
    v_mad_u32_u16 v25, v25, 8, s50 op_sel:[1,0,0,0]
    v_mad_u32_u16 v26, v26, 8, s50 op_sel:[1,0,0,0]
    v_pk_fma_f32 v[114:115], v[114:115], v[108:109], s[20:21] op_sel:[0,0,0] op_sel_hi:[1,0,1]
    v_pk_fma_f32 v[112:113], v[112:113], v[108:109], s[16:17] op_sel:[0,0,0] op_sel_hi:[1,0,1]
    v_pk_fma_f32 v[118:119], v[118:119], v[108:109], s[20:21] op_sel:[0,1,0] op_sel_hi:[1,1,1]
    v_pk_fma_f32 v[116:117], v[116:117], v[108:109], s[16:17] op_sel:[0,1,0] op_sel_hi:[1,1,1]
    v_pk_fma_f32 v[122:123], v[122:123], v[110:111], s[20:21] op_sel:[0,0,0] op_sel_hi:[1,0,1]
    v_pk_fma_f32 v[120:121], v[120:121], v[110:111], s[16:17] op_sel:[0,0,0] op_sel_hi:[1,0,1]
    v_lshlrev_b64 v[114:115], 16, v[114:115]
    v_lshlrev_b64 v[118:119], 16, v[118:119]
    v_lshlrev_b64 v[122:123], 16, v[122:123]
    v_lshl_add_u64 v[64:65], v[112:113], 0, v[114:115]
    v_lshl_add_u64 v[66:67], v[116:117], 0, v[118:119]
    v_lshl_add_u64 v[68:69], v[120:121], 0, v[122:123]
    s_waitcnt lgkmcnt(0)
    v_or3_b32 v4, v44, v45, v4
    v_or3_b32 v4, v46, v47, v4
    v_or3_b32 v4, v48, v49, v4
    ds_add_rtn_u64 v[44:45], v24, v[64:65]
    ds_add_rtn_u64 v[46:47], v25, v[66:67]
    ds_add_rtn_u64 v[48:49], v26, v[68:69]
L_p2_kernel_noopt3_7:
    v_mbcnt_lo_u32_b32 v51, s36, 0
    v_mbcnt_hi_u32_b32 v51, s37, v51
    s_bcnt1_i32_b64 s14, s[36:37]
    v_lshl_add_u32 v55, v51, 1, s25
    ds_read_u16 v55, v55
    s_mov_b32 s36, s26
    s_movk_i32 s37, -128
    s_lshl1_add_u32 s25, s14, s25
    s_lshl_b32 s14, s14, 12
    s_add_u32 s26, s26, s14
    s_cmp_le_u32 s28, 256
    s_cbranch_scc1 L_p2_kernel_noopt3_8
    v_readlane_b32 s38, v7, 8
    v_readlane_b32 s39, v7, 9
    s_nop 1
    v_mbcnt_lo_u32_b32 v62, s38, 0
    v_mbcnt_hi_u32_b32 v62, s39, v62
    s_bcnt1_i32_b64 s14, s[38:39]
    v_lshl_add_u32 v63, v62, 1, s25
    ds_read_u16 v63, v63
    s_mov_b32 s38, s26
    s_movk_i32 s39, -64
    s_lshl1_add_u32 s25, s14, s25
    s_lshl_b32 s14, s14, 12
    s_add_u32 s26, s26, s14
L_p2_kernel_noopt3_8:
    v_bfe_i32 v108, v23, 2, 10
    v_bfe_i32 v109, v23, 12, 10
    v_ashrrev_i32 v110, 22, v23
    v_cvt_f32_i32 v108, v108
    v_cvt_f32_i32 v109, v109
    v_cvt_f32_i32 v110, v110
    v_mfma_f32_4x4x4_16b_bf16 v[112:115], v[58:59], v[82:83], 0
    v_mfma_f32_4x4x4_16b_bf16 v[116:119], v[58:59], v[84:85], 0
    v_mfma_f32_4x4x4_16b_bf16 v[120:123], v[58:59], v[86:87], 0
    v_mad_u32_u16 v20, v20, 8, s50 op_sel:[1,0,0,0]
    v_mad_u32_u16 v21, v21, 8, s50 op_sel:[1,0,0,0]
    v_mad_u32_u16 v22, v22, 8, s50 op_sel:[1,0,0,0]
    v_pk_fma_f32 v[114:115], v[114:115], v[108:109], s[20:21] op_sel:[0,0,0] op_sel_hi:[1,0,1]
    v_pk_fma_f32 v[112:113], v[112:113], v[108:109], s[16:17] op_sel:[0,0,0] op_sel_hi:[1,0,1]
    v_pk_fma_f32 v[118:119], v[118:119], v[108:109], s[20:21] op_sel:[0,1,0] op_sel_hi:[1,1,1]
    v_pk_fma_f32 v[116:117], v[116:117], v[108:109], s[16:17] op_sel:[0,1,0] op_sel_hi:[1,1,1]
    v_pk_fma_f32 v[122:123], v[122:123], v[110:111], s[20:21] op_sel:[0,0,0] op_sel_hi:[1,0,1]
    v_pk_fma_f32 v[120:121], v[120:121], v[110:111], s[16:17] op_sel:[0,0,0] op_sel_hi:[1,0,1]
    v_lshlrev_b64 v[114:115], 16, v[114:115]
    v_lshlrev_b64 v[118:119], 16, v[118:119]
    v_lshlrev_b64 v[122:123], 16, v[122:123]
    v_lshl_add_u64 v[82:83], v[112:113], 0, v[114:115]
    v_lshl_add_u64 v[84:85], v[116:117], 0, v[118:119]
    v_lshl_add_u64 v[86:87], v[120:121], 0, v[122:123]
    s_waitcnt lgkmcnt(1)
    v_or3_b32 v4, v44, v45, v4
    v_or3_b32 v4, v46, v47, v4
    v_or3_b32 v4, v48, v49, v4
    ds_add_rtn_u64 v[44:45], v20, v[82:83]
    ds_add_rtn_u64 v[46:47], v21, v[84:85]
    ds_add_rtn_u64 v[48:49], v22, v[86:87]
    s_waitcnt lgkmcnt(3)
    v_add3_u32 v55, v55, v2, s37
    v_lshl_add_u32 v51, v51, 8, v55
    v_lshrrev_b32 v55, 8, v55
    v_mad_u32_u24 v51, v55, s23, v51
    buffer_load_dwordx4 v[20:23], v51, s[44:47], s36 idxen
    s_cmp_le_u32 s28, 256
    s_cbranch_scc1 L_p2_kernel_noopt3_9
    v_add3_u32 v63, v63, v2, s39
    v_lshl_add_u32 v62, v62, 8, v63
    v_lshrrev_b32 v63, 8, v63
    v_mad_u32_u24 v62, v63, s23, v62
    buffer_load_dwordx4 v[24:27], v62, s[44:47], s38 idxen
L_p2_kernel_noopt3_9:
    s_add_u32 s14, s22, 80000
    buffer_load_dwordx4 v[88:91], v1, s[8:11], s14 offen
    s_cmp_eq_u32 s24, 7
    s_cbranch_scc1 L_p2_exit
    s_add_u32 s14, s24, 1
    s_min_u32 s14, s14, 7
    s_set_gpr_idx_on s14, gpr_idx(SRC0)
    v_mad_u32_u16 v108, v28, v50, s40 op_sel:[1,0,0,0]
    v_mad_u32_u16 v109, v36, v50, s41 op_sel:[1,0,0,0]
    s_set_gpr_idx_off
    v_sub_u32_sdwa v110, v109, v108 dst_sel:DWORD dst_unused:UNUSED_PAD src0_sel:WORD_1 src1_sel:WORD_1
    s_nop 1
    v_add_u32_dpp v110, v110, v110 row_shr:1 row_mask:0xf bank_mask:0xf bound_ctrl:0
    s_nop 1
    v_add_u32_dpp v110, v110, v110 row_shr:2 row_mask:0xf bank_mask:0xf bound_ctrl:0
    s_nop 1
    v_add_u32_dpp v110, v110, v110 row_shr:4 row_mask:0xf bank_mask:0xf bound_ctrl:0
    s_nop 1
    v_add_u32_dpp v110, v110, v110 row_shr:8 row_mask:0xf bank_mask:0xf bound_ctrl:0
    s_nop 1
    v_add_u32_dpp v110, v110, v110 row_bcast:15 row_mask:0xa bank_mask:0xf
    s_nop 1
    v_add_u32_dpp v110, v110, v110 row_bcast:31 row_mask:0xc bank_mask:0xf
    v_sub_u32_sdwa v109, v109, v110 dst_sel:DWORD dst_unused:UNUSED_PAD src0_sel:WORD_1 src1_sel:DWORD
    v_readlane_b32 s29, v110, 63
    v_add_u32 v110, -1, v110
    ds_write_b16 v126, v109
    v_lshlrev_b32_e64 v111, v110, 1
    v_lshrrev_b32 v110, 5, v110
    s_cmp_gt_u32 s29, 320
    s_cselect_b32 s2, 1, s2
    v_lshl_add_u32 v110, v110, 2, v127
    s_cselect_b64 exec, 0, -1
    ds_or_b32 v110, v111 offset:136
    s_mov_b64 exec, -1
    ds_wrxchg2_rtn_b32 v[108:109], v6, v5, v5 offset0:34 offset1:44
    s_add_u32 s14, s22, 96384
    buffer_load_dwordx4 v[92:95], v1, s[8:11], s14 offen
    s_add_u32 s24, s24, 1
    s_cmp_lt_u32 s24, 8
    s_barrier
    s_cbranch_scc1 L_p2_loop
L_p2_exit:
    s_waitcnt lgkmcnt(0)
    v_or3_b32 v4, v44, v45, v4
    v_or3_b32 v4, v46, v47, v4
    v_or3_b32 v4, v48, v49, v4
    s_mov_b32 s27, s19
    s_waitcnt vmcnt(0)
    v_mov_b64 v[64:65], v[28:29]
    v_mov_b64 v[66:67], v[30:31]
    v_mov_b64 v[68:69], v[36:37]
    v_mov_b64 v[70:71], v[38:39]
    v_mov_b32 v8, 160232
    s_cmp_lg_u32 s13, 0
    s_cselect_b64 exec, 0, 1
    ds_write_b32 v8, v52
    s_mov_b64 exec, -1
    v_subrev_u32 v6, 80000, v124
    s_mul_i32 s24, s12, 19968
    v_subrev_u32 v10, s24, v1
    v_mov_b32 v11, 0x7f000000
    s_waitcnt vmcnt(0) lgkmcnt(0)
    s_barrier
    s_cmp_lt_u32 s13, 12
    s_cbranch_scc1 L_p2_ga
L_p2_ga:
    ds_read_b32 v9, v8
    ds_read_b128 v[88:91], v1 offset:0
    ds_read_b128 v[92:95], v1 offset:16384
    ds_read_b128 v[96:99], v1 offset:32768
    ds_read_b128 v[100:103], v1 offset:49152
    ds_read_b128 v[104:107], v6
    s_mul_i32 s14, s12, 5120000
    s_mul_i32 s15, s3, 80000
    s_add_u32 s25, s14, s15
    s_add_u32 s25, s25, 230838272
    s_cmp_eq_u32 s12, 3
    s_cselect_b32 s15, 128, 0
    s_add_u32 s15, s15, 19968
    s_waitcnt lgkmcnt(5)
    v_readfirstlane_b32 s21, v9
    s_nop 0
    s_bfe_u32 s21, s21, 524296
    s_cmp_lg_u32 s21, 4
    s_cselect_b32 s21, 1, 0
    s_cselect_b32 s24, 0, s15
    v_cmp_le_u32 vcc, s24, v10
    v_add_u32 v10, 16384, v10
    s_add_u32 s14, s25, 0
    v_cndmask_b32 v12, v11, v1, vcc
    s_waitcnt lgkmcnt(4)
    buffer_store_dwordx4 v[88:91], v12, s[4:7], s14 offen sc1
    v_or3_b32 v4, v88, v89, v4
    v_or3_b32 v4, v90, v91, v4
    v_cmp_le_u32 vcc, s24, v10
    v_add_u32 v10, 16384, v10
    s_add_u32 s14, s25, 16384
    v_cndmask_b32 v12, v11, v1, vcc
    s_waitcnt lgkmcnt(3)
    buffer_store_dwordx4 v[92:95], v12, s[4:7], s14 offen sc1
    v_or3_b32 v4, v92, v93, v4
    v_or3_b32 v4, v94, v95, v4
    v_cmp_le_u32 vcc, s24, v10
    v_add_u32 v10, 16384, v10
    s_add_u32 s14, s25, 32768
    v_cndmask_b32 v12, v11, v1, vcc
    s_waitcnt lgkmcnt(2)
    buffer_store_dwordx4 v[96:99], v12, s[4:7], s14 offen sc1
    v_or3_b32 v4, v96, v97, v4
    v_or3_b32 v4, v98, v99, v4
    v_cmp_le_u32 vcc, s24, v10
    v_add_u32 v10, 16384, v10
    s_add_u32 s14, s25, 49152
    v_cndmask_b32 v12, v11, v1, vcc
    s_waitcnt lgkmcnt(1)
    buffer_store_dwordx4 v[100:103], v12, s[4:7], s14 offen sc1
    v_or3_b32 v4, v100, v101, v4
    v_or3_b32 v4, v102, v103, v4
    v_cmp_le_u32 vcc, s24, v10
    v_add_u32 v10, 16384, v10
    s_add_u32 s14, s25, 0
    v_cndmask_b32 v12, v11, v6, vcc
    s_waitcnt lgkmcnt(0)
    buffer_store_dwordx4 v[104:107], v12, s[4:7], s14 offen sc1
    v_or3_b32 v4, v104, v105, v4
    v_or3_b32 v4, v106, v107, v4
    s_load_dwordx2 s[16:17], s[0:1], 88
    s_cmp_ge_u32 s13, 12
    s_cbranch_scc1 L_p2_gb
    v_lshlrev_b32 v30, 16, v60
    v_and_b32 v31, 0xffff0000, v60
    v_lshlrev_b32 v36, 16, v53
    v_and_b32 v37, 0xffff0000, v53
    v_lshlrev_b32 v38, 16, v54
    v_and_b32 v39, 0xffff0000, v54
    v_lshlrev_b32 v40, 16, v56
    v_and_b32 v41, 0xffff0000, v56
    v_lshlrev_b32 v42, 16, v57
    v_and_b32 v43, 0xffff0000, v57
    v_pk_add_f32 v[14:15], v[30:31], v[36:37] op_sel:[0,0] op_sel_hi:[1,0] neg_lo:[0,1] neg_hi:[0,1]
    v_pk_add_f32 v[16:17], v[30:31], v[36:37] op_sel:[0,1] op_sel_hi:[1,1] neg_lo:[0,1] neg_hi:[0,1]
    v_pk_add_f32 v[18:19], v[30:31], v[38:39] op_sel:[0,0] op_sel_hi:[1,0] neg_lo:[0,1] neg_hi:[0,1]
    v_pk_add_f32 v[20:21], v[30:31], v[38:39] op_sel:[0,1] op_sel_hi:[1,1] neg_lo:[0,1] neg_hi:[0,1]
    v_pk_add_f32 v[22:23], v[30:31], v[40:41] op_sel:[0,0] op_sel_hi:[1,0] neg_lo:[0,1] neg_hi:[0,1]
    v_pk_add_f32 v[24:25], v[30:31], v[40:41] op_sel:[0,1] op_sel_hi:[1,1] neg_lo:[0,1] neg_hi:[0,1]
    v_pk_add_f32 v[26:27], v[30:31], v[42:43] op_sel:[0,0] op_sel_hi:[1,0] neg_lo:[0,1] neg_hi:[0,1]
    v_pk_add_f32 v[28:29], v[30:31], v[42:43] op_sel:[0,1] op_sel_hi:[1,1] neg_lo:[0,1] neg_hi:[0,1]
    v_cvt_pk_bf16_f32 v32, v14, v15
    v_lshlrev_b32 v14, 16, v32
    v_and_b32 v15, 0xffff0000, v32
    v_cvt_pk_bf16_f32 v32, v16, v17
    v_lshlrev_b32 v16, 16, v32
    v_and_b32 v17, 0xffff0000, v32
    v_cvt_pk_bf16_f32 v32, v18, v19
    v_lshlrev_b32 v18, 16, v32
    v_and_b32 v19, 0xffff0000, v32
    v_cvt_pk_bf16_f32 v32, v20, v21
    v_lshlrev_b32 v20, 16, v32
    v_and_b32 v21, 0xffff0000, v32
    v_cvt_pk_bf16_f32 v32, v22, v23
    v_lshlrev_b32 v22, 16, v32
    v_and_b32 v23, 0xffff0000, v32
    v_cvt_pk_bf16_f32 v32, v24, v25
    v_lshlrev_b32 v24, 16, v32
    v_and_b32 v25, 0xffff0000, v32
    v_cvt_pk_bf16_f32 v32, v26, v27
    v_lshlrev_b32 v26, 16, v32
    v_and_b32 v27, 0xffff0000, v32
    v_cvt_pk_bf16_f32 v32, v28, v29
    v_lshlrev_b32 v28, 16, v32
    v_and_b32 v29, 0xffff0000, v32
    v_pk_mul_f32 v[14:15], v[14:15], v[14:15]
    v_pk_mul_f32 v[16:17], v[16:17], v[16:17]
    v_pk_mul_f32 v[18:19], v[18:19], v[18:19]
    v_pk_mul_f32 v[20:21], v[20:21], v[20:21]
    v_pk_mul_f32 v[22:23], v[22:23], v[22:23]
    v_pk_mul_f32 v[24:25], v[24:25], v[24:25]
    v_pk_mul_f32 v[26:27], v[26:27], v[26:27]
    v_pk_mul_f32 v[28:29], v[28:29], v[28:29]
    v_cvt_pk_bf16_f32 v32, v14, v15
    v_lshlrev_b32 v14, 16, v32
    v_and_b32 v15, 0xffff0000, v32
    v_cvt_pk_bf16_f32 v32, v16, v17
    v_lshlrev_b32 v16, 16, v32
    v_and_b32 v17, 0xffff0000, v32
    v_cvt_pk_bf16_f32 v32, v18, v19
    v_lshlrev_b32 v18, 16, v32
    v_and_b32 v19, 0xffff0000, v32
    v_cvt_pk_bf16_f32 v32, v20, v21
    v_lshlrev_b32 v20, 16, v32
    v_and_b32 v21, 0xffff0000, v32
    v_cvt_pk_bf16_f32 v32, v22, v23
    v_lshlrev_b32 v22, 16, v32
    v_and_b32 v23, 0xffff0000, v32
    v_cvt_pk_bf16_f32 v32, v24, v25
    v_lshlrev_b32 v24, 16, v32
    v_and_b32 v25, 0xffff0000, v32
    v_cvt_pk_bf16_f32 v32, v26, v27
    v_lshlrev_b32 v26, 16, v32
    v_and_b32 v27, 0xffff0000, v32
    v_cvt_pk_bf16_f32 v32, v28, v29
    v_lshlrev_b32 v28, 16, v32
    v_and_b32 v29, 0xffff0000, v32
    v_mov_b32 v30, 1092616192
    v_mov_b32 v31, 0x3fb8aa3b
    v_pk_mul_f32 v[14:15], v[14:15], v[30:31] op_sel:[0,0] op_sel_hi:[1,0]
    v_pk_mul_f32 v[16:17], v[16:17], v[30:31] op_sel:[0,0] op_sel_hi:[1,0]
    v_pk_mul_f32 v[18:19], v[18:19], v[30:31] op_sel:[0,0] op_sel_hi:[1,0]
    v_pk_mul_f32 v[20:21], v[20:21], v[30:31] op_sel:[0,0] op_sel_hi:[1,0]
    v_pk_mul_f32 v[22:23], v[22:23], v[30:31] op_sel:[0,0] op_sel_hi:[1,0]
    v_pk_mul_f32 v[24:25], v[24:25], v[30:31] op_sel:[0,0] op_sel_hi:[1,0]
    v_pk_mul_f32 v[26:27], v[26:27], v[30:31] op_sel:[0,0] op_sel_hi:[1,0]
    v_pk_mul_f32 v[28:29], v[28:29], v[30:31] op_sel:[0,0] op_sel_hi:[1,0]
    v_cvt_pk_bf16_f32 v32, v14, v15
    v_lshlrev_b32 v14, 16, v32
    v_and_b32 v15, 0xffff0000, v32
    v_cvt_pk_bf16_f32 v32, v16, v17
    v_lshlrev_b32 v16, 16, v32
    v_and_b32 v17, 0xffff0000, v32
    v_cvt_pk_bf16_f32 v32, v18, v19
    v_lshlrev_b32 v18, 16, v32
    v_and_b32 v19, 0xffff0000, v32
    v_cvt_pk_bf16_f32 v32, v20, v21
    v_lshlrev_b32 v20, 16, v32
    v_and_b32 v21, 0xffff0000, v32
    v_cvt_pk_bf16_f32 v32, v22, v23
    v_lshlrev_b32 v22, 16, v32
    v_and_b32 v23, 0xffff0000, v32
    v_cvt_pk_bf16_f32 v32, v24, v25
    v_lshlrev_b32 v24, 16, v32
    v_and_b32 v25, 0xffff0000, v32
    v_cvt_pk_bf16_f32 v32, v26, v27
    v_lshlrev_b32 v26, 16, v32
    v_and_b32 v27, 0xffff0000, v32
    v_cvt_pk_bf16_f32 v32, v28, v29
    v_lshlrev_b32 v28, 16, v32
    v_and_b32 v29, 0xffff0000, v32
    v_pk_mul_f32 v[14:15], v[14:15], v[30:31] op_sel:[0,1] op_sel_hi:[1,1]
    v_pk_mul_f32 v[16:17], v[16:17], v[30:31] op_sel:[0,1] op_sel_hi:[1,1]
    v_pk_mul_f32 v[18:19], v[18:19], v[30:31] op_sel:[0,1] op_sel_hi:[1,1]
    v_pk_mul_f32 v[20:21], v[20:21], v[30:31] op_sel:[0,1] op_sel_hi:[1,1]
    v_pk_mul_f32 v[22:23], v[22:23], v[30:31] op_sel:[0,1] op_sel_hi:[1,1]
    v_pk_mul_f32 v[24:25], v[24:25], v[30:31] op_sel:[0,1] op_sel_hi:[1,1]
    v_pk_mul_f32 v[26:27], v[26:27], v[30:31] op_sel:[0,1] op_sel_hi:[1,1]
    v_pk_mul_f32 v[28:29], v[28:29], v[30:31] op_sel:[0,1] op_sel_hi:[1,1]
    v_exp_f32 v14, -v14
    v_exp_f32 v15, -v15
    v_exp_f32 v16, -v16
    v_exp_f32 v17, -v17
    v_exp_f32 v18, -v18
    v_exp_f32 v19, -v19
    v_exp_f32 v20, -v20
    v_exp_f32 v21, -v21
    v_exp_f32 v22, -v22
    v_exp_f32 v23, -v23
    v_exp_f32 v24, -v24
    v_exp_f32 v25, -v25
    v_exp_f32 v26, -v26
    v_exp_f32 v27, -v27
    v_exp_f32 v28, -v28
    v_exp_f32 v29, -v29
    v_cvt_pk_bf16_f32 v14, v14, v16
    v_cvt_pk_bf16_f32 v15, v15, v17
    v_cvt_pk_bf16_f32 v18, v18, v20
    v_cvt_pk_bf16_f32 v19, v19, v21
    v_cvt_pk_bf16_f32 v22, v22, v24
    v_cvt_pk_bf16_f32 v23, v23, v25
    v_cvt_pk_bf16_f32 v26, v26, v28
    v_cvt_pk_bf16_f32 v27, v27, v29
    v_dot2_f32_bf16 v72, v14, s68, 0
    v_dot2_f32_bf16 v73, v15, s68, 0
    v_dot2_f32_bf16 v74, v14, s69, 0
    v_dot2_f32_bf16 v75, v15, s69, 0
    v_dot2_f32_bf16 v76, v14, s70, 0
    v_dot2_f32_bf16 v77, v15, s70, 0
    v_dot2_f32_bf16 v78, v14, s71, 0
    v_dot2_f32_bf16 v79, v15, s71, 0
    v_dot2_f32_bf16 v80, v14, s52, 0
    v_dot2_f32_bf16 v81, v15, s52, 0
    v_dot2_f32_bf16 v82, v14, s53, 0
    v_dot2_f32_bf16 v83, v15, s53, 0
    v_dot2_f32_bf16 v84, v14, s54, 0
    v_dot2_f32_bf16 v85, v15, s54, 0
    v_dot2_f32_bf16 v86, v14, s55, 0
    v_dot2_f32_bf16 v87, v15, s55, 0
    v_dot2_f32_bf16 v72, v18, s72, v72
    v_dot2_f32_bf16 v73, v19, s72, v73
    v_dot2_f32_bf16 v74, v18, s73, v74
    v_dot2_f32_bf16 v75, v19, s73, v75
    v_dot2_f32_bf16 v76, v18, s74, v76
    v_dot2_f32_bf16 v77, v19, s74, v77
    v_dot2_f32_bf16 v78, v18, s75, v78
    v_dot2_f32_bf16 v79, v19, s75, v79
    v_dot2_f32_bf16 v80, v18, s56, v80
    v_dot2_f32_bf16 v81, v19, s56, v81
    v_dot2_f32_bf16 v82, v18, s57, v82
    v_dot2_f32_bf16 v83, v19, s57, v83
    v_dot2_f32_bf16 v84, v18, s58, v84
    v_dot2_f32_bf16 v85, v19, s58, v85
    v_dot2_f32_bf16 v86, v18, s59, v86
    v_dot2_f32_bf16 v87, v19, s59, v87
    v_dot2_f32_bf16 v72, v22, s76, v72
    v_dot2_f32_bf16 v73, v23, s76, v73
    v_dot2_f32_bf16 v74, v22, s77, v74
    v_dot2_f32_bf16 v75, v23, s77, v75
    v_dot2_f32_bf16 v76, v22, s78, v76
    v_dot2_f32_bf16 v77, v23, s78, v77
    v_dot2_f32_bf16 v78, v22, s79, v78
    v_dot2_f32_bf16 v79, v23, s79, v79
    v_dot2_f32_bf16 v80, v22, s60, v80
    v_dot2_f32_bf16 v81, v23, s60, v81
    v_dot2_f32_bf16 v82, v22, s61, v82
    v_dot2_f32_bf16 v83, v23, s61, v83
    v_dot2_f32_bf16 v84, v22, s62, v84
    v_dot2_f32_bf16 v85, v23, s62, v85
    v_dot2_f32_bf16 v86, v22, s63, v86
    v_dot2_f32_bf16 v87, v23, s63, v87
    v_dot2_f32_bf16 v72, v26, s80, v72
    v_dot2_f32_bf16 v73, v27, s80, v73
    v_dot2_f32_bf16 v74, v26, s81, v74
    v_dot2_f32_bf16 v75, v27, s81, v75
    v_dot2_f32_bf16 v76, v26, s82, v76
    v_dot2_f32_bf16 v77, v27, s82, v77
    v_dot2_f32_bf16 v78, v26, s83, v78
    v_dot2_f32_bf16 v79, v27, s83, v79
    v_dot2_f32_bf16 v80, v26, s64, v80
    v_dot2_f32_bf16 v81, v27, s64, v81
    v_dot2_f32_bf16 v82, v26, s65, v82
    v_dot2_f32_bf16 v83, v27, s65, v83
    v_dot2_f32_bf16 v84, v26, s66, v84
    v_dot2_f32_bf16 v85, v27, s66, v85
    v_dot2_f32_bf16 v86, v26, s67, v86
    v_dot2_f32_bf16 v87, v27, s67, v87
L_p2_gb:
    v_and_b32 v4, 0x80008000, v4
    v_cmp_ne_u32 vcc, 0, v4
    v_mov_b32 v8, s27
    v_and_b32 v10, 15, v0
    v_mul_u32_u24 v10, 240, v10
    v_add_u32 v10, 160000, v10
    s_cmp_lg_u64 vcc, 0
    s_cselect_b32 s2, 1, s2
    v_mov_b32 v9, s2
    s_mov_b64 exec, 1
    ds_write_b32 v8, v9
    s_mov_b64 exec, -1
    s_mov_b32 s49, s12
    s_mov_b32 s51, 0
    s_waitcnt vmcnt(0) lgkmcnt(0)
    s_barrier
    ds_read_b32 v9, v10
    s_mov_b32 s18, 5120000
    s_mov_b32 s19, 0x00020000
    s_waitcnt lgkmcnt(0)
    v_cmp_ne_u32 vcc, 0, v9
    s_nop 1
    s_cmp_lg_u64 vcc, 0
    s_cselect_b32 s2, 1, 0
    s_cbranch_scc1 L_p2_slow
L_p2_signal:
    v_mov_b32 v8, 160228
    s_lshl_b32 s15, s2, 4
    s_or_b32 s15, s15, s21
    s_add_u32 s14, s12, 16
    s_lshl_b32 s20, s15, s14
    s_add_u32 s20, s20, 1
    v_mov_b32 v9, s20
    s_cmp_lg_u32 s13, 15
    s_cbranch_scc1 L_p2_nosig0
    s_lshl_b32 s14, s3, 8
    s_add_u32 s14, s14, 230821888
    s_mov_b64 exec, 1
    buffer_atomic_add v9, off, s[4:7], s14 sc0
    s_mov_b64 exec, -1
L_p2_nosig0:
    s_cmp_eq_u32 s49, 3
    s_cselect_b32 s15, 8, 0
    s_add_u32 s15, s15, 224
    v_add_u32 v2, 16384, v1
    v_cmp_gt_u32 vcc, s15, v0
    s_mul_i32 s14, s3, 80000
    s_mul_i32 s26, s49, 19968
    s_add_u32 s26, s26, s14
    v_cndmask_b32 v2, 0.5, v2, vcc
    s_mov_b32 s10, 5120000
    s_lshl_b32 s28, s92, 16
    s_and_b32 s29, s92, 0xffff0000
    s_lshl_b32 s30, s93, 16
    s_and_b32 s31, s93, 0xffff0000
    s_lshl_b32 s32, s94, 16
    s_and_b32 s33, s94, 0xffff0000
    s_lshl_b32 s34, s95, 16
    s_and_b32 s35, s95, 0xffff0000
    s_lshl_b32 s36, s96, 16
    s_and_b32 s37, s96, 0xffff0000
    s_lshl_b32 s38, s97, 16
    s_and_b32 s39, s97, 0xffff0000
    s_lshl_b32 s40, s98, 16
    s_and_b32 s41, s98, 0xffff0000
    s_lshl_b32 s42, s99, 16
    s_and_b32 s43, s99, 0xffff0000
    s_and_b32 s99, s91, 0xffff0000
    s_lshl_b32 s98, s91, 16
    s_and_b32 s97, s90, 0xffff0000
    s_lshl_b32 s96, s90, 16
    s_and_b32 s95, s89, 0xffff0000
    s_lshl_b32 s94, s89, 16
    s_and_b32 s93, s88, 0xffff0000
    s_lshl_b32 s92, s88, 16
    s_and_b32 s91, s87, 0xffff0000
    s_lshl_b32 s90, s87, 16
    s_and_b32 s89, s86, 0xffff0000
    s_lshl_b32 s88, s86, 16
    s_and_b32 s87, s85, 0xffff0000
    s_lshl_b32 s86, s85, 16
    s_and_b32 s85, s84, 0xffff0000
    s_lshl_b32 s84, s84, 16
    s_mov_b32 s44, s48
    s_add_u32 s45, s48, 2281701376
    s_cmp_eq_u32 s48, 0
    s_cselect_b32 s45, 0, s45
    s_cmp_lt_u32 s13, 12
    s_cbranch_scc1 L_p2_gc
    v_lshlrev_b32 v30, 16, v60
    v_and_b32 v31, 0xffff0000, v60
    v_lshlrev_b32 v36, 16, v53
    v_and_b32 v37, 0xffff0000, v53
    v_lshlrev_b32 v38, 16, v54
    v_and_b32 v39, 0xffff0000, v54
    v_lshlrev_b32 v40, 16, v56
    v_and_b32 v41, 0xffff0000, v56
    v_lshlrev_b32 v42, 16, v57
    v_and_b32 v43, 0xffff0000, v57
    v_pk_add_f32 v[14:15], v[30:31], v[36:37] op_sel:[0,0] op_sel_hi:[1,0] neg_lo:[0,1] neg_hi:[0,1]
    v_pk_add_f32 v[16:17], v[30:31], v[36:37] op_sel:[0,1] op_sel_hi:[1,1] neg_lo:[0,1] neg_hi:[0,1]
    v_pk_add_f32 v[18:19], v[30:31], v[38:39] op_sel:[0,0] op_sel_hi:[1,0] neg_lo:[0,1] neg_hi:[0,1]
    v_pk_add_f32 v[20:21], v[30:31], v[38:39] op_sel:[0,1] op_sel_hi:[1,1] neg_lo:[0,1] neg_hi:[0,1]
    v_pk_add_f32 v[22:23], v[30:31], v[40:41] op_sel:[0,0] op_sel_hi:[1,0] neg_lo:[0,1] neg_hi:[0,1]
    v_pk_add_f32 v[24:25], v[30:31], v[40:41] op_sel:[0,1] op_sel_hi:[1,1] neg_lo:[0,1] neg_hi:[0,1]
    v_pk_add_f32 v[26:27], v[30:31], v[42:43] op_sel:[0,0] op_sel_hi:[1,0] neg_lo:[0,1] neg_hi:[0,1]
    v_pk_add_f32 v[28:29], v[30:31], v[42:43] op_sel:[0,1] op_sel_hi:[1,1] neg_lo:[0,1] neg_hi:[0,1]
    v_cvt_pk_bf16_f32 v32, v14, v15
    v_lshlrev_b32 v14, 16, v32
    v_and_b32 v15, 0xffff0000, v32
    v_cvt_pk_bf16_f32 v32, v16, v17
    v_lshlrev_b32 v16, 16, v32
    v_and_b32 v17, 0xffff0000, v32
    v_cvt_pk_bf16_f32 v32, v18, v19
    v_lshlrev_b32 v18, 16, v32
    v_and_b32 v19, 0xffff0000, v32
    v_cvt_pk_bf16_f32 v32, v20, v21
    v_lshlrev_b32 v20, 16, v32
    v_and_b32 v21, 0xffff0000, v32
    v_cvt_pk_bf16_f32 v32, v22, v23
    v_lshlrev_b32 v22, 16, v32
    v_and_b32 v23, 0xffff0000, v32
    v_cvt_pk_bf16_f32 v32, v24, v25
    v_lshlrev_b32 v24, 16, v32
    v_and_b32 v25, 0xffff0000, v32
    v_cvt_pk_bf16_f32 v32, v26, v27
    v_lshlrev_b32 v26, 16, v32
    v_and_b32 v27, 0xffff0000, v32
    v_cvt_pk_bf16_f32 v32, v28, v29
    v_lshlrev_b32 v28, 16, v32
    v_and_b32 v29, 0xffff0000, v32
    v_pk_mul_f32 v[14:15], v[14:15], v[14:15]
    v_pk_mul_f32 v[16:17], v[16:17], v[16:17]
    v_pk_mul_f32 v[18:19], v[18:19], v[18:19]
    v_pk_mul_f32 v[20:21], v[20:21], v[20:21]
    v_pk_mul_f32 v[22:23], v[22:23], v[22:23]
    v_pk_mul_f32 v[24:25], v[24:25], v[24:25]
    v_pk_mul_f32 v[26:27], v[26:27], v[26:27]
    v_pk_mul_f32 v[28:29], v[28:29], v[28:29]
    v_cvt_pk_bf16_f32 v32, v14, v15
    v_lshlrev_b32 v14, 16, v32
    v_and_b32 v15, 0xffff0000, v32
    v_cvt_pk_bf16_f32 v32, v16, v17
    v_lshlrev_b32 v16, 16, v32
    v_and_b32 v17, 0xffff0000, v32
    v_cvt_pk_bf16_f32 v32, v18, v19
    v_lshlrev_b32 v18, 16, v32
    v_and_b32 v19, 0xffff0000, v32
    v_cvt_pk_bf16_f32 v32, v20, v21
    v_lshlrev_b32 v20, 16, v32
    v_and_b32 v21, 0xffff0000, v32
    v_cvt_pk_bf16_f32 v32, v22, v23
    v_lshlrev_b32 v22, 16, v32
    v_and_b32 v23, 0xffff0000, v32
    v_cvt_pk_bf16_f32 v32, v24, v25
    v_lshlrev_b32 v24, 16, v32
    v_and_b32 v25, 0xffff0000, v32
    v_cvt_pk_bf16_f32 v32, v26, v27
    v_lshlrev_b32 v26, 16, v32
    v_and_b32 v27, 0xffff0000, v32
    v_cvt_pk_bf16_f32 v32, v28, v29
    v_lshlrev_b32 v28, 16, v32
    v_and_b32 v29, 0xffff0000, v32
    v_mov_b32 v30, 1092616192
    v_mov_b32 v31, 0x3fb8aa3b
    v_pk_mul_f32 v[14:15], v[14:15], v[30:31] op_sel:[0,0] op_sel_hi:[1,0]
    v_pk_mul_f32 v[16:17], v[16:17], v[30:31] op_sel:[0,0] op_sel_hi:[1,0]
    v_pk_mul_f32 v[18:19], v[18:19], v[30:31] op_sel:[0,0] op_sel_hi:[1,0]
    v_pk_mul_f32 v[20:21], v[20:21], v[30:31] op_sel:[0,0] op_sel_hi:[1,0]
    v_pk_mul_f32 v[22:23], v[22:23], v[30:31] op_sel:[0,0] op_sel_hi:[1,0]
    v_pk_mul_f32 v[24:25], v[24:25], v[30:31] op_sel:[0,0] op_sel_hi:[1,0]
    v_pk_mul_f32 v[26:27], v[26:27], v[30:31] op_sel:[0,0] op_sel_hi:[1,0]
    v_pk_mul_f32 v[28:29], v[28:29], v[30:31] op_sel:[0,0] op_sel_hi:[1,0]
    v_cvt_pk_bf16_f32 v32, v14, v15
    v_lshlrev_b32 v14, 16, v32
    v_and_b32 v15, 0xffff0000, v32
    v_cvt_pk_bf16_f32 v32, v16, v17
    v_lshlrev_b32 v16, 16, v32
    v_and_b32 v17, 0xffff0000, v32
    v_cvt_pk_bf16_f32 v32, v18, v19
    v_lshlrev_b32 v18, 16, v32
    v_and_b32 v19, 0xffff0000, v32
    v_cvt_pk_bf16_f32 v32, v20, v21
    v_lshlrev_b32 v20, 16, v32
    v_and_b32 v21, 0xffff0000, v32
    v_cvt_pk_bf16_f32 v32, v22, v23
    v_lshlrev_b32 v22, 16, v32
    v_and_b32 v23, 0xffff0000, v32
    v_cvt_pk_bf16_f32 v32, v24, v25
    v_lshlrev_b32 v24, 16, v32
    v_and_b32 v25, 0xffff0000, v32
    v_cvt_pk_bf16_f32 v32, v26, v27
    v_lshlrev_b32 v26, 16, v32
    v_and_b32 v27, 0xffff0000, v32
    v_cvt_pk_bf16_f32 v32, v28, v29
    v_lshlrev_b32 v28, 16, v32
    v_and_b32 v29, 0xffff0000, v32
    v_pk_mul_f32 v[14:15], v[14:15], v[30:31] op_sel:[0,1] op_sel_hi:[1,1]
    v_pk_mul_f32 v[16:17], v[16:17], v[30:31] op_sel:[0,1] op_sel_hi:[1,1]
    v_pk_mul_f32 v[18:19], v[18:19], v[30:31] op_sel:[0,1] op_sel_hi:[1,1]
    v_pk_mul_f32 v[20:21], v[20:21], v[30:31] op_sel:[0,1] op_sel_hi:[1,1]
    v_pk_mul_f32 v[22:23], v[22:23], v[30:31] op_sel:[0,1] op_sel_hi:[1,1]
    v_pk_mul_f32 v[24:25], v[24:25], v[30:31] op_sel:[0,1] op_sel_hi:[1,1]
    v_pk_mul_f32 v[26:27], v[26:27], v[30:31] op_sel:[0,1] op_sel_hi:[1,1]
    v_pk_mul_f32 v[28:29], v[28:29], v[30:31] op_sel:[0,1] op_sel_hi:[1,1]
    v_exp_f32 v14, -v14
    v_exp_f32 v15, -v15
    v_exp_f32 v16, -v16
    v_exp_f32 v17, -v17
    v_exp_f32 v18, -v18
    v_exp_f32 v19, -v19
    v_exp_f32 v20, -v20
    v_exp_f32 v21, -v21
    v_exp_f32 v22, -v22
    v_exp_f32 v23, -v23
    v_exp_f32 v24, -v24
    v_exp_f32 v25, -v25
    v_exp_f32 v26, -v26
    v_exp_f32 v27, -v27
    v_exp_f32 v28, -v28
    v_exp_f32 v29, -v29
    v_cvt_pk_bf16_f32 v14, v14, v16
    v_cvt_pk_bf16_f32 v15, v15, v17
    v_cvt_pk_bf16_f32 v18, v18, v20
    v_cvt_pk_bf16_f32 v19, v19, v21
    v_cvt_pk_bf16_f32 v22, v22, v24
    v_cvt_pk_bf16_f32 v23, v23, v25
    v_cvt_pk_bf16_f32 v26, v26, v28
    v_cvt_pk_bf16_f32 v27, v27, v29
    v_dot2_f32_bf16 v72, v14, s68, 0
    v_dot2_f32_bf16 v73, v15, s68, 0
    v_dot2_f32_bf16 v74, v14, s69, 0
    v_dot2_f32_bf16 v75, v15, s69, 0
    v_dot2_f32_bf16 v76, v14, s70, 0
    v_dot2_f32_bf16 v77, v15, s70, 0
    v_dot2_f32_bf16 v78, v14, s71, 0
    v_dot2_f32_bf16 v79, v15, s71, 0
    v_dot2_f32_bf16 v80, v14, s52, 0
    v_dot2_f32_bf16 v81, v15, s52, 0
    v_dot2_f32_bf16 v82, v14, s53, 0
    v_dot2_f32_bf16 v83, v15, s53, 0
    v_dot2_f32_bf16 v84, v14, s54, 0
    v_dot2_f32_bf16 v85, v15, s54, 0
    v_dot2_f32_bf16 v86, v14, s55, 0
    v_dot2_f32_bf16 v87, v15, s55, 0
    v_dot2_f32_bf16 v72, v18, s72, v72
    v_dot2_f32_bf16 v73, v19, s72, v73
    v_dot2_f32_bf16 v74, v18, s73, v74
    v_dot2_f32_bf16 v75, v19, s73, v75
    v_dot2_f32_bf16 v76, v18, s74, v76
    v_dot2_f32_bf16 v77, v19, s74, v77
    v_dot2_f32_bf16 v78, v18, s75, v78
    v_dot2_f32_bf16 v79, v19, s75, v79
    v_dot2_f32_bf16 v80, v18, s56, v80
    v_dot2_f32_bf16 v81, v19, s56, v81
    v_dot2_f32_bf16 v82, v18, s57, v82
    v_dot2_f32_bf16 v83, v19, s57, v83
    v_dot2_f32_bf16 v84, v18, s58, v84
    v_dot2_f32_bf16 v85, v19, s58, v85
    v_dot2_f32_bf16 v86, v18, s59, v86
    v_dot2_f32_bf16 v87, v19, s59, v87
    v_dot2_f32_bf16 v72, v22, s76, v72
    v_dot2_f32_bf16 v73, v23, s76, v73
    v_dot2_f32_bf16 v74, v22, s77, v74
    v_dot2_f32_bf16 v75, v23, s77, v75
    v_dot2_f32_bf16 v76, v22, s78, v76
    v_dot2_f32_bf16 v77, v23, s78, v77
    v_dot2_f32_bf16 v78, v22, s79, v78
    v_dot2_f32_bf16 v79, v23, s79, v79
    v_dot2_f32_bf16 v80, v22, s60, v80
    v_dot2_f32_bf16 v81, v23, s60, v81
    v_dot2_f32_bf16 v82, v22, s61, v82
    v_dot2_f32_bf16 v83, v23, s61, v83
    v_dot2_f32_bf16 v84, v22, s62, v84
    v_dot2_f32_bf16 v85, v23, s62, v85
    v_dot2_f32_bf16 v86, v22, s63, v86
    v_dot2_f32_bf16 v87, v23, s63, v87
    v_dot2_f32_bf16 v72, v26, s80, v72
    v_dot2_f32_bf16 v73, v27, s80, v73
    v_dot2_f32_bf16 v74, v26, s81, v74
    v_dot2_f32_bf16 v75, v27, s81, v75
    v_dot2_f32_bf16 v76, v26, s82, v76
    v_dot2_f32_bf16 v77, v27, s82, v77
    v_dot2_f32_bf16 v78, v26, s83, v78
    v_dot2_f32_bf16 v79, v27, s83, v79
    v_dot2_f32_bf16 v80, v26, s64, v80
    v_dot2_f32_bf16 v81, v27, s64, v81
    v_dot2_f32_bf16 v82, v26, s65, v82
    v_dot2_f32_bf16 v83, v27, s65, v83
    v_dot2_f32_bf16 v84, v26, s66, v84
    v_dot2_f32_bf16 v85, v27, s66, v85
    v_dot2_f32_bf16 v86, v26, s67, v86
    v_dot2_f32_bf16 v87, v27, s67, v87
L_p2_gc:
    s_cmp_ge_u32 s13, 4
    s_cbranch_scc1 L_p2_gd
    v_lshlrev_b32 v30, 16, v61
    v_and_b32 v31, 0xffff0000, v61
    v_pk_add_f32 v[14:15], v[30:31], v[36:37] op_sel:[0,0] op_sel_hi:[1,0] neg_lo:[0,1] neg_hi:[0,1]
    v_pk_add_f32 v[16:17], v[30:31], v[36:37] op_sel:[0,1] op_sel_hi:[1,1] neg_lo:[0,1] neg_hi:[0,1]
    v_pk_add_f32 v[18:19], v[30:31], v[38:39] op_sel:[0,0] op_sel_hi:[1,0] neg_lo:[0,1] neg_hi:[0,1]
    v_pk_add_f32 v[20:21], v[30:31], v[38:39] op_sel:[0,1] op_sel_hi:[1,1] neg_lo:[0,1] neg_hi:[0,1]
    v_pk_add_f32 v[22:23], v[30:31], v[40:41] op_sel:[0,0] op_sel_hi:[1,0] neg_lo:[0,1] neg_hi:[0,1]
    v_pk_add_f32 v[24:25], v[30:31], v[40:41] op_sel:[0,1] op_sel_hi:[1,1] neg_lo:[0,1] neg_hi:[0,1]
    v_pk_add_f32 v[26:27], v[30:31], v[42:43] op_sel:[0,0] op_sel_hi:[1,0] neg_lo:[0,1] neg_hi:[0,1]
    v_pk_add_f32 v[28:29], v[30:31], v[42:43] op_sel:[0,1] op_sel_hi:[1,1] neg_lo:[0,1] neg_hi:[0,1]
    v_cvt_pk_bf16_f32 v32, v14, v15
    v_lshlrev_b32 v14, 16, v32
    v_and_b32 v15, 0xffff0000, v32
    v_cvt_pk_bf16_f32 v32, v16, v17
    v_lshlrev_b32 v16, 16, v32
    v_and_b32 v17, 0xffff0000, v32
    v_cvt_pk_bf16_f32 v32, v18, v19
    v_lshlrev_b32 v18, 16, v32
    v_and_b32 v19, 0xffff0000, v32
    v_cvt_pk_bf16_f32 v32, v20, v21
    v_lshlrev_b32 v20, 16, v32
    v_and_b32 v21, 0xffff0000, v32
    v_cvt_pk_bf16_f32 v32, v22, v23
    v_lshlrev_b32 v22, 16, v32
    v_and_b32 v23, 0xffff0000, v32
    v_cvt_pk_bf16_f32 v32, v24, v25
    v_lshlrev_b32 v24, 16, v32
    v_and_b32 v25, 0xffff0000, v32
    v_cvt_pk_bf16_f32 v32, v26, v27
    v_lshlrev_b32 v26, 16, v32
    v_and_b32 v27, 0xffff0000, v32
    v_cvt_pk_bf16_f32 v32, v28, v29
    v_lshlrev_b32 v28, 16, v32
    v_and_b32 v29, 0xffff0000, v32
    v_pk_mul_f32 v[14:15], v[14:15], v[14:15]
    v_pk_mul_f32 v[16:17], v[16:17], v[16:17]
    v_pk_mul_f32 v[18:19], v[18:19], v[18:19]
    v_pk_mul_f32 v[20:21], v[20:21], v[20:21]
    v_pk_mul_f32 v[22:23], v[22:23], v[22:23]
    v_pk_mul_f32 v[24:25], v[24:25], v[24:25]
    v_pk_mul_f32 v[26:27], v[26:27], v[26:27]
    v_pk_mul_f32 v[28:29], v[28:29], v[28:29]
    v_cvt_pk_bf16_f32 v32, v14, v15
    v_lshlrev_b32 v14, 16, v32
    v_and_b32 v15, 0xffff0000, v32
    v_cvt_pk_bf16_f32 v32, v16, v17
    v_lshlrev_b32 v16, 16, v32
    v_and_b32 v17, 0xffff0000, v32
    v_cvt_pk_bf16_f32 v32, v18, v19
    v_lshlrev_b32 v18, 16, v32
    v_and_b32 v19, 0xffff0000, v32
    v_cvt_pk_bf16_f32 v32, v20, v21
    v_lshlrev_b32 v20, 16, v32
    v_and_b32 v21, 0xffff0000, v32
    v_cvt_pk_bf16_f32 v32, v22, v23
    v_lshlrev_b32 v22, 16, v32
    v_and_b32 v23, 0xffff0000, v32
    v_cvt_pk_bf16_f32 v32, v24, v25
    v_lshlrev_b32 v24, 16, v32
    v_and_b32 v25, 0xffff0000, v32
    v_cvt_pk_bf16_f32 v32, v26, v27
    v_lshlrev_b32 v26, 16, v32
    v_and_b32 v27, 0xffff0000, v32
    v_cvt_pk_bf16_f32 v32, v28, v29
    v_lshlrev_b32 v28, 16, v32
    v_and_b32 v29, 0xffff0000, v32
    v_mov_b32 v30, 1092616192
    v_mov_b32 v31, 0x3fb8aa3b
    v_pk_mul_f32 v[14:15], v[14:15], v[30:31] op_sel:[0,0] op_sel_hi:[1,0]
    v_pk_mul_f32 v[16:17], v[16:17], v[30:31] op_sel:[0,0] op_sel_hi:[1,0]
    v_pk_mul_f32 v[18:19], v[18:19], v[30:31] op_sel:[0,0] op_sel_hi:[1,0]
    v_pk_mul_f32 v[20:21], v[20:21], v[30:31] op_sel:[0,0] op_sel_hi:[1,0]
    v_pk_mul_f32 v[22:23], v[22:23], v[30:31] op_sel:[0,0] op_sel_hi:[1,0]
    v_pk_mul_f32 v[24:25], v[24:25], v[30:31] op_sel:[0,0] op_sel_hi:[1,0]
    v_pk_mul_f32 v[26:27], v[26:27], v[30:31] op_sel:[0,0] op_sel_hi:[1,0]
    v_pk_mul_f32 v[28:29], v[28:29], v[30:31] op_sel:[0,0] op_sel_hi:[1,0]
    v_cvt_pk_bf16_f32 v32, v14, v15
    v_lshlrev_b32 v14, 16, v32
    v_and_b32 v15, 0xffff0000, v32
    v_cvt_pk_bf16_f32 v32, v16, v17
    v_lshlrev_b32 v16, 16, v32
    v_and_b32 v17, 0xffff0000, v32
    v_cvt_pk_bf16_f32 v32, v18, v19
    v_lshlrev_b32 v18, 16, v32
    v_and_b32 v19, 0xffff0000, v32
    v_cvt_pk_bf16_f32 v32, v20, v21
    v_lshlrev_b32 v20, 16, v32
    v_and_b32 v21, 0xffff0000, v32
    v_cvt_pk_bf16_f32 v32, v22, v23
    v_lshlrev_b32 v22, 16, v32
    v_and_b32 v23, 0xffff0000, v32
    v_cvt_pk_bf16_f32 v32, v24, v25
    v_lshlrev_b32 v24, 16, v32
    v_and_b32 v25, 0xffff0000, v32
    v_cvt_pk_bf16_f32 v32, v26, v27
    v_lshlrev_b32 v26, 16, v32
    v_and_b32 v27, 0xffff0000, v32
    v_cvt_pk_bf16_f32 v32, v28, v29
    v_lshlrev_b32 v28, 16, v32
    v_and_b32 v29, 0xffff0000, v32
    v_pk_mul_f32 v[14:15], v[14:15], v[30:31] op_sel:[0,1] op_sel_hi:[1,1]
    v_pk_mul_f32 v[16:17], v[16:17], v[30:31] op_sel:[0,1] op_sel_hi:[1,1]
    v_pk_mul_f32 v[18:19], v[18:19], v[30:31] op_sel:[0,1] op_sel_hi:[1,1]
    v_pk_mul_f32 v[20:21], v[20:21], v[30:31] op_sel:[0,1] op_sel_hi:[1,1]
    v_pk_mul_f32 v[22:23], v[22:23], v[30:31] op_sel:[0,1] op_sel_hi:[1,1]
    v_pk_mul_f32 v[24:25], v[24:25], v[30:31] op_sel:[0,1] op_sel_hi:[1,1]
    v_pk_mul_f32 v[26:27], v[26:27], v[30:31] op_sel:[0,1] op_sel_hi:[1,1]
    v_pk_mul_f32 v[28:29], v[28:29], v[30:31] op_sel:[0,1] op_sel_hi:[1,1]
    v_exp_f32 v14, -v14
    v_exp_f32 v15, -v15
    v_exp_f32 v16, -v16
    v_exp_f32 v17, -v17
    v_exp_f32 v18, -v18
    v_exp_f32 v19, -v19
    v_exp_f32 v20, -v20
    v_exp_f32 v21, -v21
    v_exp_f32 v22, -v22
    v_exp_f32 v23, -v23
    v_exp_f32 v24, -v24
    v_exp_f32 v25, -v25
    v_exp_f32 v26, -v26
    v_exp_f32 v27, -v27
    v_exp_f32 v28, -v28
    v_exp_f32 v29, -v29
    v_cvt_pk_bf16_f32 v14, v14, v16
    v_cvt_pk_bf16_f32 v15, v15, v17
    v_cvt_pk_bf16_f32 v18, v18, v20
    v_cvt_pk_bf16_f32 v19, v19, v21
    v_cvt_pk_bf16_f32 v22, v22, v24
    v_cvt_pk_bf16_f32 v23, v23, v25
    v_cvt_pk_bf16_f32 v26, v26, v28
    v_cvt_pk_bf16_f32 v27, v27, v29
    v_dot2_f32_bf16 v112, v14, s68, 0
    v_dot2_f32_bf16 v113, v15, s68, 0
    v_dot2_f32_bf16 v114, v14, s69, 0
    v_dot2_f32_bf16 v115, v15, s69, 0
    v_dot2_f32_bf16 v116, v14, s70, 0
    v_dot2_f32_bf16 v117, v15, s70, 0
    v_dot2_f32_bf16 v118, v14, s71, 0
    v_dot2_f32_bf16 v119, v15, s71, 0
    v_dot2_f32_bf16 v120, v14, s52, 0
    v_dot2_f32_bf16 v121, v15, s52, 0
    v_dot2_f32_bf16 v122, v14, s53, 0
    v_dot2_f32_bf16 v123, v15, s53, 0
    v_dot2_f32_bf16 v124, v14, s54, 0
    v_dot2_f32_bf16 v125, v15, s54, 0
    v_dot2_f32_bf16 v126, v14, s55, 0
    v_dot2_f32_bf16 v127, v15, s55, 0
    v_dot2_f32_bf16 v112, v18, s72, v112
    v_dot2_f32_bf16 v113, v19, s72, v113
    v_dot2_f32_bf16 v114, v18, s73, v114
    v_dot2_f32_bf16 v115, v19, s73, v115
    v_dot2_f32_bf16 v116, v18, s74, v116
    v_dot2_f32_bf16 v117, v19, s74, v117
    v_dot2_f32_bf16 v118, v18, s75, v118
    v_dot2_f32_bf16 v119, v19, s75, v119
    v_dot2_f32_bf16 v120, v18, s56, v120
    v_dot2_f32_bf16 v121, v19, s56, v121
    v_dot2_f32_bf16 v122, v18, s57, v122
    v_dot2_f32_bf16 v123, v19, s57, v123
    v_dot2_f32_bf16 v124, v18, s58, v124
    v_dot2_f32_bf16 v125, v19, s58, v125
    v_dot2_f32_bf16 v126, v18, s59, v126
    v_dot2_f32_bf16 v127, v19, s59, v127
    v_dot2_f32_bf16 v112, v22, s76, v112
    v_dot2_f32_bf16 v113, v23, s76, v113
    v_dot2_f32_bf16 v114, v22, s77, v114
    v_dot2_f32_bf16 v115, v23, s77, v115
    v_dot2_f32_bf16 v116, v22, s78, v116
    v_dot2_f32_bf16 v117, v23, s78, v117
    v_dot2_f32_bf16 v118, v22, s79, v118
    v_dot2_f32_bf16 v119, v23, s79, v119
    v_dot2_f32_bf16 v120, v22, s60, v120
    v_dot2_f32_bf16 v121, v23, s60, v121
    v_dot2_f32_bf16 v122, v22, s61, v122
    v_dot2_f32_bf16 v123, v23, s61, v123
    v_dot2_f32_bf16 v124, v22, s62, v124
    v_dot2_f32_bf16 v125, v23, s62, v125
    v_dot2_f32_bf16 v126, v22, s63, v126
    v_dot2_f32_bf16 v127, v23, s63, v127
    v_dot2_f32_bf16 v112, v26, s80, v112
    v_dot2_f32_bf16 v113, v27, s80, v113
    v_dot2_f32_bf16 v114, v26, s81, v114
    v_dot2_f32_bf16 v115, v27, s81, v115
    v_dot2_f32_bf16 v116, v26, s82, v116
    v_dot2_f32_bf16 v117, v27, s82, v117
    v_dot2_f32_bf16 v118, v26, s83, v118
    v_dot2_f32_bf16 v119, v27, s83, v119
    v_dot2_f32_bf16 v120, v26, s64, v120
    v_dot2_f32_bf16 v121, v27, s64, v121
    v_dot2_f32_bf16 v122, v26, s65, v122
    v_dot2_f32_bf16 v123, v27, s65, v123
    v_dot2_f32_bf16 v124, v26, s66, v124
    v_dot2_f32_bf16 v125, v27, s66, v125
    v_dot2_f32_bf16 v126, v26, s67, v126
    v_dot2_f32_bf16 v127, v27, s67, v127
L_p2_gd:
    s_cmp_lg_u32 s13, 15
    s_cbranch_scc1 L_p2_nosig
    s_waitcnt vmcnt(0)
    v_readfirstlane_b32 s15, v9
    s_lshl_b32 s51, 1, s12
    s_add_u32 s20, s20, s15
    s_and_b32 s15, s20, 0xff
    s_cmp_eq_u32 s15, 4
    s_cbranch_scc0 L_p2_notlast
    s_bfe_u32 s15, s20, 262160
    s_or_b32 s51, s51, s15
    s_branch L_p2_pub
L_p2_notlast:
    s_cmp_lg_u32 s21, 0
    s_cselect_b32 s51, 0, s51
    s_cbranch_scc1 L_p2_pub
L_p2_poll:
    v_mov_b32 v9, 0
    s_lshl_b32 s14, s3, 8
    s_add_u32 s14, s14, 230821888
    s_mov_b64 exec, 1
    buffer_atomic_add v9, off, s[4:7], s14 sc0
    s_mov_b64 exec, -1
    s_waitcnt vmcnt(0)
    v_readfirstlane_b32 s20, v9
    s_nop 0
    s_and_b32 s15, s20, 0xff
    s_cmp_lt_u32 s15, 4
    s_cbranch_scc1 L_p2_poll
L_p2_pub:
    s_lshl_b32 s15, s51, 24
    s_or_b32 s15, s15, s20
    v_mov_b32 v9, s15
    s_mov_b64 exec, 1
    ds_write_b32 v8, v9
    s_mov_b64 exec, -1
    s_waitcnt lgkmcnt(0)
L_p2_nosig:
    s_barrier
    ds_read_b32 v9, v8
    s_waitcnt lgkmcnt(0)
    v_readfirstlane_b32 s20, v9
    s_nop 0
    s_lshr_b32 s51, s20, 24
    s_cbranch_scc0 L_p2_end
L_p2_fin:
    s_mul_i32 s24, s49, 19968
    s_add_u32 s14, s12, 1
    s_and_b32 s14, s14, 3
    s_mul_i32 s15, s14, 5120000
    s_add_u32 s15, s15, 230838272
    s_add_u32 s15, s15, s26
    buffer_load_dwordx4 v[12:15], v1, s[4:7], s15 offen sc1
    buffer_load_dwordx4 v[92:95], v2, s[4:7], s15 offen sc1
    s_add_u32 s14, s12, 2
    s_and_b32 s14, s14, 3
    s_mul_i32 s15, s14, 5120000
    s_add_u32 s15, s15, 230838272
    s_add_u32 s15, s15, s26
    buffer_load_dwordx4 v[16:19], v1, s[4:7], s15 offen sc1
    buffer_load_dwordx4 v[96:99], v2, s[4:7], s15 offen sc1
    s_add_u32 s14, s12, 3
    s_and_b32 s14, s14, 3
    s_mul_i32 s15, s14, 5120000
    s_add_u32 s15, s15, 230838272
    s_add_u32 s15, s15, s26
    buffer_load_dwordx4 v[20:23], v1, s[4:7], s15 offen sc1
    buffer_load_dwordx4 v[100:103], v2, s[4:7], s15 offen sc1
    v_add_u32 v24, s24, v1
    ds_read_b128 v[8:11], v24
    v_add_u32 v25, s24, v2
    ds_read_b128 v[88:91], v25
    s_waitcnt vmcnt(0) lgkmcnt(0)
    s_bfe_u32 s14, s20, 262164
    s_cbranch_scc0 L_p2_kernel_nof32a_10
    s_add_u32 s14, s12, 0
    s_and_b32 s14, s14, 3
    s_add_u32 s14, s14, 20
    s_bitcmp1_b32 s20, s14
    s_cbranch_scc0 L_p2_kernel_q_11
    v_mov_b32 v8, 1073758208
    v_mov_b32 v9, 1073758208
    v_mov_b32 v10, 1073758208
    v_mov_b32 v11, 1073758208
L_p2_kernel_q_11:
    s_add_u32 s14, s12, 1
    s_and_b32 s14, s14, 3
    s_add_u32 s14, s14, 20
    s_bitcmp1_b32 s20, s14
    s_cbranch_scc0 L_p2_kernel_q_12
    v_mov_b32 v12, 1073758208
    v_mov_b32 v13, 1073758208
    v_mov_b32 v14, 1073758208
    v_mov_b32 v15, 1073758208
L_p2_kernel_q_12:
    s_add_u32 s14, s12, 2
    s_and_b32 s14, s14, 3
    s_add_u32 s14, s14, 20
    s_bitcmp1_b32 s20, s14
    s_cbranch_scc0 L_p2_kernel_q_13
    v_mov_b32 v16, 1073758208
    v_mov_b32 v17, 1073758208
    v_mov_b32 v18, 1073758208
    v_mov_b32 v19, 1073758208
L_p2_kernel_q_13:
    s_add_u32 s14, s12, 3
    s_and_b32 s14, s14, 3
    s_add_u32 s14, s14, 20
    s_bitcmp1_b32 s20, s14
    s_cbranch_scc0 L_p2_kernel_q_14
    v_mov_b32 v20, 1073758208
    v_mov_b32 v21, 1073758208
    v_mov_b32 v22, 1073758208
    v_mov_b32 v23, 1073758208
L_p2_kernel_q_14:
L_p2_kernel_nof32a_10:
    v_pk_add_u16 v8, v8, v12
    v_pk_add_u16 v16, v16, v20
    v_pk_add_u16 v9, v9, v13
    v_pk_add_u16 v17, v17, v21
    v_pk_add_u16 v10, v10, v14
    v_pk_add_u16 v18, v18, v22
    v_pk_add_u16 v11, v11, v15
    v_pk_add_u16 v19, v19, v23
    v_add_u32_sdwa v24, v8, v16 dst_sel:DWORD dst_unused:UNUSED_PAD src0_sel:WORD_0 src1_sel:WORD_0
    v_add_u32_sdwa v25, v10, v18 dst_sel:DWORD dst_unused:UNUSED_PAD src0_sel:WORD_0 src1_sel:WORD_0
    v_add_u32_sdwa v26, v8, v16 dst_sel:DWORD dst_unused:UNUSED_PAD src0_sel:WORD_1 src1_sel:WORD_1
    v_add_u32_sdwa v27, v10, v18 dst_sel:DWORD dst_unused:UNUSED_PAD src0_sel:WORD_1 src1_sel:WORD_1
    v_add_u32_sdwa v28, v9, v17 dst_sel:DWORD dst_unused:UNUSED_PAD src0_sel:WORD_0 src1_sel:WORD_0
    v_add_u32_sdwa v29, v11, v19 dst_sel:DWORD dst_unused:UNUSED_PAD src0_sel:WORD_0 src1_sel:WORD_0
    v_add_u32_sdwa v30, v9, v17 dst_sel:DWORD dst_unused:UNUSED_PAD src0_sel:WORD_1 src1_sel:WORD_1
    v_add_u32_sdwa v31, v11, v19 dst_sel:DWORD dst_unused:UNUSED_PAD src0_sel:WORD_1 src1_sel:WORD_1
    v_cvt_f32_u32 v24, v24
    v_cvt_f32_u32 v25, v25
    v_cvt_f32_u32 v26, v26
    v_cvt_f32_u32 v27, v27
    v_cvt_f32_u32 v28, v28
    v_cvt_f32_u32 v29, v29
    v_cvt_f32_u32 v30, v30
    v_cvt_f32_u32 v31, v31
    v_pk_fma_f32 v[24:25], v[24:25], s[44:45], s[44:45] op_sel:[0,0,1] op_sel_hi:[1,0,1]
    v_pk_fma_f32 v[26:27], v[26:27], s[44:45], s[44:45] op_sel:[0,0,1] op_sel_hi:[1,0,1]
    v_pk_fma_f32 v[28:29], v[28:29], s[44:45], s[44:45] op_sel:[0,0,1] op_sel_hi:[1,0,1]
    v_pk_fma_f32 v[30:31], v[30:31], s[44:45], s[44:45] op_sel:[0,0,1] op_sel_hi:[1,0,1]
    s_bfe_u32 s14, s20, 262164
    s_cbranch_scc0 L_p2_kernel_nof32b_15
    v_lshlrev_b32 v32, 1, v1
    s_bitcmp1_b32 s20, 20
    s_cbranch_scc0 L_p2_kernel_q_16
    s_lshl_b32 s15, s26, 1
    s_add_u32 s15, s15, 251318272
    buffer_load_dwordx4 v[8:11], v32, s[4:7], s15 offen sc1
    buffer_load_dwordx4 v[12:15], v32, s[4:7], s15 offen offset:16 sc1
    s_waitcnt vmcnt(0)
    v_add_f32 v24, v24, v8
    v_add_f32 v25, v25, v12
    v_add_f32 v26, v26, v9
    v_add_f32 v27, v27, v13
    v_add_f32 v28, v28, v10
    v_add_f32 v29, v29, v14
    v_add_f32 v30, v30, v11
    v_add_f32 v31, v31, v15
L_p2_kernel_q_16:
    s_bitcmp1_b32 s20, 21
    s_cbranch_scc0 L_p2_kernel_q_17
    s_lshl_b32 s15, s26, 1
    s_add_u32 s15, s15, 261558272
    buffer_load_dwordx4 v[8:11], v32, s[4:7], s15 offen sc1
    buffer_load_dwordx4 v[12:15], v32, s[4:7], s15 offen offset:16 sc1
    s_waitcnt vmcnt(0)
    v_add_f32 v24, v24, v8
    v_add_f32 v25, v25, v12
    v_add_f32 v26, v26, v9
    v_add_f32 v27, v27, v13
    v_add_f32 v28, v28, v10
    v_add_f32 v29, v29, v14
    v_add_f32 v30, v30, v11
    v_add_f32 v31, v31, v15
L_p2_kernel_q_17:
    s_bitcmp1_b32 s20, 22
    s_cbranch_scc0 L_p2_kernel_q_18
    s_lshl_b32 s15, s26, 1
    s_add_u32 s15, s15, 271798272
    buffer_load_dwordx4 v[8:11], v32, s[4:7], s15 offen sc1
    buffer_load_dwordx4 v[12:15], v32, s[4:7], s15 offen offset:16 sc1
    s_waitcnt vmcnt(0)
    v_add_f32 v24, v24, v8
    v_add_f32 v25, v25, v12
    v_add_f32 v26, v26, v9
    v_add_f32 v27, v27, v13
    v_add_f32 v28, v28, v10
    v_add_f32 v29, v29, v14
    v_add_f32 v30, v30, v11
    v_add_f32 v31, v31, v15
L_p2_kernel_q_18:
    s_bitcmp1_b32 s20, 23
    s_cbranch_scc0 L_p2_kernel_q_19
    s_lshl_b32 s15, s26, 1
    s_add_u32 s15, s15, 282038272
    buffer_load_dwordx4 v[8:11], v32, s[4:7], s15 offen sc1
    buffer_load_dwordx4 v[12:15], v32, s[4:7], s15 offen offset:16 sc1
    s_waitcnt vmcnt(0)
    v_add_f32 v24, v24, v8
    v_add_f32 v25, v25, v12
    v_add_f32 v26, v26, v9
    v_add_f32 v27, v27, v13
    v_add_f32 v28, v28, v10
    v_add_f32 v29, v29, v14
    v_add_f32 v30, v30, v11
    v_add_f32 v31, v31, v15
L_p2_kernel_q_19:
L_p2_kernel_nof32b_15:
    v_pk_mul_f32 v[8:9], v[24:25], s[84:85] op_sel:[0,0] op_sel_hi:[1,0]
    v_pk_mul_f32 v[10:11], v[24:25], s[84:85] op_sel:[0,1] op_sel_hi:[1,1]
    v_pk_mul_f32 v[12:13], v[24:25], s[86:87] op_sel:[0,0] op_sel_hi:[1,0]
    v_pk_mul_f32 v[14:15], v[24:25], s[86:87] op_sel:[0,1] op_sel_hi:[1,1]
    v_pk_fma_f32 v[8:9], v[26:27], s[88:89], v[8:9] op_sel:[0,0,0] op_sel_hi:[1,0,1]
    v_pk_fma_f32 v[10:11], v[26:27], s[88:89], v[10:11] op_sel:[0,1,0] op_sel_hi:[1,1,1]
    v_pk_fma_f32 v[12:13], v[26:27], s[90:91], v[12:13] op_sel:[0,0,0] op_sel_hi:[1,0,1]
    v_pk_fma_f32 v[14:15], v[26:27], s[90:91], v[14:15] op_sel:[0,1,0] op_sel_hi:[1,1,1]
    v_pk_fma_f32 v[8:9], v[28:29], s[92:93], v[8:9] op_sel:[0,0,0] op_sel_hi:[1,0,1]
    v_pk_fma_f32 v[10:11], v[28:29], s[92:93], v[10:11] op_sel:[0,1,0] op_sel_hi:[1,1,1]
    v_pk_fma_f32 v[12:13], v[28:29], s[94:95], v[12:13] op_sel:[0,0,0] op_sel_hi:[1,0,1]
    v_pk_fma_f32 v[14:15], v[28:29], s[94:95], v[14:15] op_sel:[0,1,0] op_sel_hi:[1,1,1]
    v_pk_fma_f32 v[8:9], v[30:31], s[96:97], v[8:9] op_sel:[0,0,0] op_sel_hi:[1,0,1]
    v_pk_fma_f32 v[10:11], v[30:31], s[96:97], v[10:11] op_sel:[0,1,0] op_sel_hi:[1,1,1]
    v_pk_fma_f32 v[12:13], v[30:31], s[98:99], v[12:13] op_sel:[0,0,0] op_sel_hi:[1,0,1]
    v_pk_fma_f32 v[14:15], v[30:31], s[98:99], v[14:15] op_sel:[0,1,0] op_sel_hi:[1,1,1]
    v_pk_mul_f32 v[8:9], v[8:9], v[72:73]
    v_pk_mul_f32 v[10:11], v[10:11], v[74:75]
    v_pk_mul_f32 v[12:13], v[12:13], v[76:77]
    v_pk_mul_f32 v[14:15], v[14:15], v[78:79]
    v_pk_mul_f32 v[24:25], v[8:9], s[28:29] op_sel:[0,0] op_sel_hi:[1,0]
    v_pk_mul_f32 v[26:27], v[8:9], s[28:29] op_sel:[0,1] op_sel_hi:[1,1]
    v_pk_mul_f32 v[28:29], v[8:9], s[30:31] op_sel:[0,0] op_sel_hi:[1,0]
    v_pk_mul_f32 v[30:31], v[8:9], s[30:31] op_sel:[0,1] op_sel_hi:[1,1]
    v_pk_fma_f32 v[24:25], v[10:11], s[32:33], v[24:25] op_sel:[0,0,0] op_sel_hi:[1,0,1]
    v_pk_fma_f32 v[26:27], v[10:11], s[32:33], v[26:27] op_sel:[0,1,0] op_sel_hi:[1,1,1]
    v_pk_fma_f32 v[28:29], v[10:11], s[34:35], v[28:29] op_sel:[0,0,0] op_sel_hi:[1,0,1]
    v_pk_fma_f32 v[30:31], v[10:11], s[34:35], v[30:31] op_sel:[0,1,0] op_sel_hi:[1,1,1]
    v_pk_fma_f32 v[24:25], v[12:13], s[36:37], v[24:25] op_sel:[0,0,0] op_sel_hi:[1,0,1]
    v_pk_fma_f32 v[26:27], v[12:13], s[36:37], v[26:27] op_sel:[0,1,0] op_sel_hi:[1,1,1]
    v_pk_fma_f32 v[28:29], v[12:13], s[38:39], v[28:29] op_sel:[0,0,0] op_sel_hi:[1,0,1]
    v_pk_fma_f32 v[30:31], v[12:13], s[38:39], v[30:31] op_sel:[0,1,0] op_sel_hi:[1,1,1]
    v_pk_fma_f32 v[24:25], v[14:15], s[40:41], v[24:25] op_sel:[0,0,0] op_sel_hi:[1,0,1]
    v_pk_fma_f32 v[26:27], v[14:15], s[40:41], v[26:27] op_sel:[0,1,0] op_sel_hi:[1,1,1]
    v_pk_fma_f32 v[28:29], v[14:15], s[42:43], v[28:29] op_sel:[0,0,0] op_sel_hi:[1,0,1]
    v_pk_fma_f32 v[30:31], v[14:15], s[42:43], v[30:31] op_sel:[0,1,0] op_sel_hi:[1,1,1]
    v_lshlrev_b32 v8, 16, v64
    v_and_b32 v10, 0xffff0000, v64
    v_lshlrev_b32 v12, 16, v65
    v_and_b32 v14, 0xffff0000, v65
    v_lshlrev_b32 v9, 16, v66
    v_and_b32 v11, 0xffff0000, v66
    v_lshlrev_b32 v13, 16, v67
    v_and_b32 v15, 0xffff0000, v67
    v_pk_fma_f32 v[8:9], v[24:25], v[80:81], v[8:9]
    v_pk_fma_f32 v[10:11], v[26:27], v[82:83], v[10:11]
    v_pk_fma_f32 v[12:13], v[28:29], v[84:85], v[12:13]
    v_pk_fma_f32 v[14:15], v[30:31], v[86:87], v[14:15]
    v_cvt_pk_bf16_f32 v16, v8, v10
    v_cvt_pk_bf16_f32 v17, v12, v14
    v_cvt_pk_bf16_f32 v18, v9, v11
    v_cvt_pk_bf16_f32 v19, v13, v15
    buffer_store_dwordx4 v[16:19], v1, s[16:19], s26 offen
    s_cmp_ge_u32 s13, 4
    s_cbranch_scc1 L_p2_f1
    s_bfe_u32 s14, s20, 262164
    s_cbranch_scc0 L_p2_kernel_nof32a_20
    s_add_u32 s14, s12, 0
    s_and_b32 s14, s14, 3
    s_add_u32 s14, s14, 20
    s_bitcmp1_b32 s20, s14
    s_cbranch_scc0 L_p2_kernel_q_21
    v_mov_b32 v88, 1073758208
    v_mov_b32 v89, 1073758208
    v_mov_b32 v90, 1073758208
    v_mov_b32 v91, 1073758208
L_p2_kernel_q_21:
    s_add_u32 s14, s12, 1
    s_and_b32 s14, s14, 3
    s_add_u32 s14, s14, 20
    s_bitcmp1_b32 s20, s14
    s_cbranch_scc0 L_p2_kernel_q_22
    v_mov_b32 v92, 1073758208
    v_mov_b32 v93, 1073758208
    v_mov_b32 v94, 1073758208
    v_mov_b32 v95, 1073758208
L_p2_kernel_q_22:
    s_add_u32 s14, s12, 2
    s_and_b32 s14, s14, 3
    s_add_u32 s14, s14, 20
    s_bitcmp1_b32 s20, s14
    s_cbranch_scc0 L_p2_kernel_q_23
    v_mov_b32 v96, 1073758208
    v_mov_b32 v97, 1073758208
    v_mov_b32 v98, 1073758208
    v_mov_b32 v99, 1073758208
L_p2_kernel_q_23:
    s_add_u32 s14, s12, 3
    s_and_b32 s14, s14, 3
    s_add_u32 s14, s14, 20
    s_bitcmp1_b32 s20, s14
    s_cbranch_scc0 L_p2_kernel_q_24
    v_mov_b32 v100, 1073758208
    v_mov_b32 v101, 1073758208
    v_mov_b32 v102, 1073758208
    v_mov_b32 v103, 1073758208
L_p2_kernel_q_24:
L_p2_kernel_nof32a_20:
    v_pk_add_u16 v88, v88, v92
    v_pk_add_u16 v96, v96, v100
    v_pk_add_u16 v89, v89, v93
    v_pk_add_u16 v97, v97, v101
    v_pk_add_u16 v90, v90, v94
    v_pk_add_u16 v98, v98, v102
    v_pk_add_u16 v91, v91, v95
    v_pk_add_u16 v99, v99, v103
    v_add_u32_sdwa v24, v88, v96 dst_sel:DWORD dst_unused:UNUSED_PAD src0_sel:WORD_0 src1_sel:WORD_0
    v_add_u32_sdwa v25, v90, v98 dst_sel:DWORD dst_unused:UNUSED_PAD src0_sel:WORD_0 src1_sel:WORD_0
    v_add_u32_sdwa v26, v88, v96 dst_sel:DWORD dst_unused:UNUSED_PAD src0_sel:WORD_1 src1_sel:WORD_1
    v_add_u32_sdwa v27, v90, v98 dst_sel:DWORD dst_unused:UNUSED_PAD src0_sel:WORD_1 src1_sel:WORD_1
    v_add_u32_sdwa v28, v89, v97 dst_sel:DWORD dst_unused:UNUSED_PAD src0_sel:WORD_0 src1_sel:WORD_0
    v_add_u32_sdwa v29, v91, v99 dst_sel:DWORD dst_unused:UNUSED_PAD src0_sel:WORD_0 src1_sel:WORD_0
    v_add_u32_sdwa v30, v89, v97 dst_sel:DWORD dst_unused:UNUSED_PAD src0_sel:WORD_1 src1_sel:WORD_1
    v_add_u32_sdwa v31, v91, v99 dst_sel:DWORD dst_unused:UNUSED_PAD src0_sel:WORD_1 src1_sel:WORD_1
    v_cvt_f32_u32 v24, v24
    v_cvt_f32_u32 v25, v25
    v_cvt_f32_u32 v26, v26
    v_cvt_f32_u32 v27, v27
    v_cvt_f32_u32 v28, v28
    v_cvt_f32_u32 v29, v29
    v_cvt_f32_u32 v30, v30
    v_cvt_f32_u32 v31, v31
    v_pk_fma_f32 v[24:25], v[24:25], s[44:45], s[44:45] op_sel:[0,0,1] op_sel_hi:[1,0,1]
    v_pk_fma_f32 v[26:27], v[26:27], s[44:45], s[44:45] op_sel:[0,0,1] op_sel_hi:[1,0,1]
    v_pk_fma_f32 v[28:29], v[28:29], s[44:45], s[44:45] op_sel:[0,0,1] op_sel_hi:[1,0,1]
    v_pk_fma_f32 v[30:31], v[30:31], s[44:45], s[44:45] op_sel:[0,0,1] op_sel_hi:[1,0,1]
    s_bfe_u32 s14, s20, 262164
    s_cbranch_scc0 L_p2_kernel_nof32b_25
    v_lshlrev_b32 v32, 1, v2
    s_bitcmp1_b32 s20, 20
    s_cbranch_scc0 L_p2_kernel_q_26
    s_lshl_b32 s15, s26, 1
    s_add_u32 s15, s15, 251318272
    buffer_load_dwordx4 v[88:91], v32, s[4:7], s15 offen sc1
    buffer_load_dwordx4 v[92:95], v32, s[4:7], s15 offen offset:16 sc1
    s_waitcnt vmcnt(0)
    v_add_f32 v24, v24, v88
    v_add_f32 v25, v25, v92
    v_add_f32 v26, v26, v89
    v_add_f32 v27, v27, v93
    v_add_f32 v28, v28, v90
    v_add_f32 v29, v29, v94
    v_add_f32 v30, v30, v91
    v_add_f32 v31, v31, v95
L_p2_kernel_q_26:
    s_bitcmp1_b32 s20, 21
    s_cbranch_scc0 L_p2_kernel_q_27
    s_lshl_b32 s15, s26, 1
    s_add_u32 s15, s15, 261558272
    buffer_load_dwordx4 v[88:91], v32, s[4:7], s15 offen sc1
    buffer_load_dwordx4 v[92:95], v32, s[4:7], s15 offen offset:16 sc1
    s_waitcnt vmcnt(0)
    v_add_f32 v24, v24, v88
    v_add_f32 v25, v25, v92
    v_add_f32 v26, v26, v89
    v_add_f32 v27, v27, v93
    v_add_f32 v28, v28, v90
    v_add_f32 v29, v29, v94
    v_add_f32 v30, v30, v91
    v_add_f32 v31, v31, v95
L_p2_kernel_q_27:
    s_bitcmp1_b32 s20, 22
    s_cbranch_scc0 L_p2_kernel_q_28
    s_lshl_b32 s15, s26, 1
    s_add_u32 s15, s15, 271798272
    buffer_load_dwordx4 v[88:91], v32, s[4:7], s15 offen sc1
    buffer_load_dwordx4 v[92:95], v32, s[4:7], s15 offen offset:16 sc1
    s_waitcnt vmcnt(0)
    v_add_f32 v24, v24, v88
    v_add_f32 v25, v25, v92
    v_add_f32 v26, v26, v89
    v_add_f32 v27, v27, v93
    v_add_f32 v28, v28, v90
    v_add_f32 v29, v29, v94
    v_add_f32 v30, v30, v91
    v_add_f32 v31, v31, v95
L_p2_kernel_q_28:
    s_bitcmp1_b32 s20, 23
    s_cbranch_scc0 L_p2_kernel_q_29
    s_lshl_b32 s15, s26, 1
    s_add_u32 s15, s15, 282038272
    buffer_load_dwordx4 v[88:91], v32, s[4:7], s15 offen sc1
    buffer_load_dwordx4 v[92:95], v32, s[4:7], s15 offen offset:16 sc1
    s_waitcnt vmcnt(0)
    v_add_f32 v24, v24, v88
    v_add_f32 v25, v25, v92
    v_add_f32 v26, v26, v89
    v_add_f32 v27, v27, v93
    v_add_f32 v28, v28, v90
    v_add_f32 v29, v29, v94
    v_add_f32 v30, v30, v91
    v_add_f32 v31, v31, v95
L_p2_kernel_q_29:
L_p2_kernel_nof32b_25:
    v_pk_mul_f32 v[88:89], v[24:25], s[84:85] op_sel:[0,0] op_sel_hi:[1,0]
    v_pk_mul_f32 v[90:91], v[24:25], s[84:85] op_sel:[0,1] op_sel_hi:[1,1]
    v_pk_mul_f32 v[92:93], v[24:25], s[86:87] op_sel:[0,0] op_sel_hi:[1,0]
    v_pk_mul_f32 v[94:95], v[24:25], s[86:87] op_sel:[0,1] op_sel_hi:[1,1]
    v_pk_fma_f32 v[88:89], v[26:27], s[88:89], v[88:89] op_sel:[0,0,0] op_sel_hi:[1,0,1]
    v_pk_fma_f32 v[90:91], v[26:27], s[88:89], v[90:91] op_sel:[0,1,0] op_sel_hi:[1,1,1]
    v_pk_fma_f32 v[92:93], v[26:27], s[90:91], v[92:93] op_sel:[0,0,0] op_sel_hi:[1,0,1]
    v_pk_fma_f32 v[94:95], v[26:27], s[90:91], v[94:95] op_sel:[0,1,0] op_sel_hi:[1,1,1]
    v_pk_fma_f32 v[88:89], v[28:29], s[92:93], v[88:89] op_sel:[0,0,0] op_sel_hi:[1,0,1]
    v_pk_fma_f32 v[90:91], v[28:29], s[92:93], v[90:91] op_sel:[0,1,0] op_sel_hi:[1,1,1]
    v_pk_fma_f32 v[92:93], v[28:29], s[94:95], v[92:93] op_sel:[0,0,0] op_sel_hi:[1,0,1]
    v_pk_fma_f32 v[94:95], v[28:29], s[94:95], v[94:95] op_sel:[0,1,0] op_sel_hi:[1,1,1]
    v_pk_fma_f32 v[88:89], v[30:31], s[96:97], v[88:89] op_sel:[0,0,0] op_sel_hi:[1,0,1]
    v_pk_fma_f32 v[90:91], v[30:31], s[96:97], v[90:91] op_sel:[0,1,0] op_sel_hi:[1,1,1]
    v_pk_fma_f32 v[92:93], v[30:31], s[98:99], v[92:93] op_sel:[0,0,0] op_sel_hi:[1,0,1]
    v_pk_fma_f32 v[94:95], v[30:31], s[98:99], v[94:95] op_sel:[0,1,0] op_sel_hi:[1,1,1]
    v_pk_mul_f32 v[88:89], v[88:89], v[112:113]
    v_pk_mul_f32 v[90:91], v[90:91], v[114:115]
    v_pk_mul_f32 v[92:93], v[92:93], v[116:117]
    v_pk_mul_f32 v[94:95], v[94:95], v[118:119]
    v_pk_mul_f32 v[24:25], v[88:89], s[28:29] op_sel:[0,0] op_sel_hi:[1,0]
    v_pk_mul_f32 v[26:27], v[88:89], s[28:29] op_sel:[0,1] op_sel_hi:[1,1]
    v_pk_mul_f32 v[28:29], v[88:89], s[30:31] op_sel:[0,0] op_sel_hi:[1,0]
    v_pk_mul_f32 v[30:31], v[88:89], s[30:31] op_sel:[0,1] op_sel_hi:[1,1]
    v_pk_fma_f32 v[24:25], v[90:91], s[32:33], v[24:25] op_sel:[0,0,0] op_sel_hi:[1,0,1]
    v_pk_fma_f32 v[26:27], v[90:91], s[32:33], v[26:27] op_sel:[0,1,0] op_sel_hi:[1,1,1]
    v_pk_fma_f32 v[28:29], v[90:91], s[34:35], v[28:29] op_sel:[0,0,0] op_sel_hi:[1,0,1]
    v_pk_fma_f32 v[30:31], v[90:91], s[34:35], v[30:31] op_sel:[0,1,0] op_sel_hi:[1,1,1]
    v_pk_fma_f32 v[24:25], v[92:93], s[36:37], v[24:25] op_sel:[0,0,0] op_sel_hi:[1,0,1]
    v_pk_fma_f32 v[26:27], v[92:93], s[36:37], v[26:27] op_sel:[0,1,0] op_sel_hi:[1,1,1]
    v_pk_fma_f32 v[28:29], v[92:93], s[38:39], v[28:29] op_sel:[0,0,0] op_sel_hi:[1,0,1]
    v_pk_fma_f32 v[30:31], v[92:93], s[38:39], v[30:31] op_sel:[0,1,0] op_sel_hi:[1,1,1]
    v_pk_fma_f32 v[24:25], v[94:95], s[40:41], v[24:25] op_sel:[0,0,0] op_sel_hi:[1,0,1]
    v_pk_fma_f32 v[26:27], v[94:95], s[40:41], v[26:27] op_sel:[0,1,0] op_sel_hi:[1,1,1]
    v_pk_fma_f32 v[28:29], v[94:95], s[42:43], v[28:29] op_sel:[0,0,0] op_sel_hi:[1,0,1]
    v_pk_fma_f32 v[30:31], v[94:95], s[42:43], v[30:31] op_sel:[0,1,0] op_sel_hi:[1,1,1]
    v_lshlrev_b32 v88, 16, v68
    v_and_b32 v90, 0xffff0000, v68
    v_lshlrev_b32 v92, 16, v69
    v_and_b32 v94, 0xffff0000, v69
    v_lshlrev_b32 v89, 16, v70
    v_and_b32 v91, 0xffff0000, v70
    v_lshlrev_b32 v93, 16, v71
    v_and_b32 v95, 0xffff0000, v71
    v_pk_fma_f32 v[88:89], v[24:25], v[120:121], v[88:89]
    v_pk_fma_f32 v[90:91], v[26:27], v[122:123], v[90:91]
    v_pk_fma_f32 v[92:93], v[28:29], v[124:125], v[92:93]
    v_pk_fma_f32 v[94:95], v[30:31], v[126:127], v[94:95]
    v_cvt_pk_bf16_f32 v96, v88, v90
    v_cvt_pk_bf16_f32 v97, v92, v94
    v_cvt_pk_bf16_f32 v98, v89, v91
    v_cvt_pk_bf16_f32 v99, v93, v95
    buffer_store_dwordx4 v[96:99], v2, s[16:19], s26 offen
L_p2_f1:
    s_bitset0_b32 s51, s49
    s_cmp_eq_u32 s51, 0
    s_cbranch_scc1 L_p2_done
    s_ff1_i32_b32 s49, s51
    s_mul_i32 s14, s3, 20000
    s_mul_i32 s15, s49, 4992
    s_add_u32 s14, s14, s15
    s_add_u32 s15, s14, 4096
    v_min_u32 v61, 231, v0
    v_lshl_add_u32 v60, v0, 2, s14
    v_lshl_add_u32 v61, v61, 2, s15
    global_load_dword v60, v60, s[100:101] nt
    global_load_dword v61, v61, s[100:101] nt
    s_waitcnt vmcnt(0)
    v_lshlrev_b32 v30, 16, v60
    v_and_b32 v31, 0xffff0000, v60
    v_lshlrev_b32 v36, 16, v53
    v_and_b32 v37, 0xffff0000, v53
    v_lshlrev_b32 v38, 16, v54
    v_and_b32 v39, 0xffff0000, v54
    v_lshlrev_b32 v40, 16, v56
    v_and_b32 v41, 0xffff0000, v56
    v_lshlrev_b32 v42, 16, v57
    v_and_b32 v43, 0xffff0000, v57
    v_pk_add_f32 v[14:15], v[30:31], v[36:37] op_sel:[0,0] op_sel_hi:[1,0] neg_lo:[0,1] neg_hi:[0,1]
    v_pk_add_f32 v[16:17], v[30:31], v[36:37] op_sel:[0,1] op_sel_hi:[1,1] neg_lo:[0,1] neg_hi:[0,1]
    v_pk_add_f32 v[18:19], v[30:31], v[38:39] op_sel:[0,0] op_sel_hi:[1,0] neg_lo:[0,1] neg_hi:[0,1]
    v_pk_add_f32 v[20:21], v[30:31], v[38:39] op_sel:[0,1] op_sel_hi:[1,1] neg_lo:[0,1] neg_hi:[0,1]
    v_pk_add_f32 v[22:23], v[30:31], v[40:41] op_sel:[0,0] op_sel_hi:[1,0] neg_lo:[0,1] neg_hi:[0,1]
    v_pk_add_f32 v[24:25], v[30:31], v[40:41] op_sel:[0,1] op_sel_hi:[1,1] neg_lo:[0,1] neg_hi:[0,1]
    v_pk_add_f32 v[26:27], v[30:31], v[42:43] op_sel:[0,0] op_sel_hi:[1,0] neg_lo:[0,1] neg_hi:[0,1]
    v_pk_add_f32 v[28:29], v[30:31], v[42:43] op_sel:[0,1] op_sel_hi:[1,1] neg_lo:[0,1] neg_hi:[0,1]
    v_cvt_pk_bf16_f32 v32, v14, v15
    v_lshlrev_b32 v14, 16, v32
    v_and_b32 v15, 0xffff0000, v32
    v_cvt_pk_bf16_f32 v32, v16, v17
    v_lshlrev_b32 v16, 16, v32
    v_and_b32 v17, 0xffff0000, v32
    v_cvt_pk_bf16_f32 v32, v18, v19
    v_lshlrev_b32 v18, 16, v32
    v_and_b32 v19, 0xffff0000, v32
    v_cvt_pk_bf16_f32 v32, v20, v21
    v_lshlrev_b32 v20, 16, v32
    v_and_b32 v21, 0xffff0000, v32
    v_cvt_pk_bf16_f32 v32, v22, v23
    v_lshlrev_b32 v22, 16, v32
    v_and_b32 v23, 0xffff0000, v32
    v_cvt_pk_bf16_f32 v32, v24, v25
    v_lshlrev_b32 v24, 16, v32
    v_and_b32 v25, 0xffff0000, v32
    v_cvt_pk_bf16_f32 v32, v26, v27
    v_lshlrev_b32 v26, 16, v32
    v_and_b32 v27, 0xffff0000, v32
    v_cvt_pk_bf16_f32 v32, v28, v29
    v_lshlrev_b32 v28, 16, v32
    v_and_b32 v29, 0xffff0000, v32
    v_pk_mul_f32 v[14:15], v[14:15], v[14:15]
    v_pk_mul_f32 v[16:17], v[16:17], v[16:17]
    v_pk_mul_f32 v[18:19], v[18:19], v[18:19]
    v_pk_mul_f32 v[20:21], v[20:21], v[20:21]
    v_pk_mul_f32 v[22:23], v[22:23], v[22:23]
    v_pk_mul_f32 v[24:25], v[24:25], v[24:25]
    v_pk_mul_f32 v[26:27], v[26:27], v[26:27]
    v_pk_mul_f32 v[28:29], v[28:29], v[28:29]
    v_cvt_pk_bf16_f32 v32, v14, v15
    v_lshlrev_b32 v14, 16, v32
    v_and_b32 v15, 0xffff0000, v32
    v_cvt_pk_bf16_f32 v32, v16, v17
    v_lshlrev_b32 v16, 16, v32
    v_and_b32 v17, 0xffff0000, v32
    v_cvt_pk_bf16_f32 v32, v18, v19
    v_lshlrev_b32 v18, 16, v32
    v_and_b32 v19, 0xffff0000, v32
    v_cvt_pk_bf16_f32 v32, v20, v21
    v_lshlrev_b32 v20, 16, v32
    v_and_b32 v21, 0xffff0000, v32
    v_cvt_pk_bf16_f32 v32, v22, v23
    v_lshlrev_b32 v22, 16, v32
    v_and_b32 v23, 0xffff0000, v32
    v_cvt_pk_bf16_f32 v32, v24, v25
    v_lshlrev_b32 v24, 16, v32
    v_and_b32 v25, 0xffff0000, v32
    v_cvt_pk_bf16_f32 v32, v26, v27
    v_lshlrev_b32 v26, 16, v32
    v_and_b32 v27, 0xffff0000, v32
    v_cvt_pk_bf16_f32 v32, v28, v29
    v_lshlrev_b32 v28, 16, v32
    v_and_b32 v29, 0xffff0000, v32
    v_mov_b32 v30, 1092616192
    v_mov_b32 v31, 0x3fb8aa3b
    v_pk_mul_f32 v[14:15], v[14:15], v[30:31] op_sel:[0,0] op_sel_hi:[1,0]
    v_pk_mul_f32 v[16:17], v[16:17], v[30:31] op_sel:[0,0] op_sel_hi:[1,0]
    v_pk_mul_f32 v[18:19], v[18:19], v[30:31] op_sel:[0,0] op_sel_hi:[1,0]
    v_pk_mul_f32 v[20:21], v[20:21], v[30:31] op_sel:[0,0] op_sel_hi:[1,0]
    v_pk_mul_f32 v[22:23], v[22:23], v[30:31] op_sel:[0,0] op_sel_hi:[1,0]
    v_pk_mul_f32 v[24:25], v[24:25], v[30:31] op_sel:[0,0] op_sel_hi:[1,0]
    v_pk_mul_f32 v[26:27], v[26:27], v[30:31] op_sel:[0,0] op_sel_hi:[1,0]
    v_pk_mul_f32 v[28:29], v[28:29], v[30:31] op_sel:[0,0] op_sel_hi:[1,0]
    v_cvt_pk_bf16_f32 v32, v14, v15
    v_lshlrev_b32 v14, 16, v32
    v_and_b32 v15, 0xffff0000, v32
    v_cvt_pk_bf16_f32 v32, v16, v17
    v_lshlrev_b32 v16, 16, v32
    v_and_b32 v17, 0xffff0000, v32
    v_cvt_pk_bf16_f32 v32, v18, v19
    v_lshlrev_b32 v18, 16, v32
    v_and_b32 v19, 0xffff0000, v32
    v_cvt_pk_bf16_f32 v32, v20, v21
    v_lshlrev_b32 v20, 16, v32
    v_and_b32 v21, 0xffff0000, v32
    v_cvt_pk_bf16_f32 v32, v22, v23
    v_lshlrev_b32 v22, 16, v32
    v_and_b32 v23, 0xffff0000, v32
    v_cvt_pk_bf16_f32 v32, v24, v25
    v_lshlrev_b32 v24, 16, v32
    v_and_b32 v25, 0xffff0000, v32
    v_cvt_pk_bf16_f32 v32, v26, v27
    v_lshlrev_b32 v26, 16, v32
    v_and_b32 v27, 0xffff0000, v32
    v_cvt_pk_bf16_f32 v32, v28, v29
    v_lshlrev_b32 v28, 16, v32
    v_and_b32 v29, 0xffff0000, v32
    v_pk_mul_f32 v[14:15], v[14:15], v[30:31] op_sel:[0,1] op_sel_hi:[1,1]
    v_pk_mul_f32 v[16:17], v[16:17], v[30:31] op_sel:[0,1] op_sel_hi:[1,1]
    v_pk_mul_f32 v[18:19], v[18:19], v[30:31] op_sel:[0,1] op_sel_hi:[1,1]
    v_pk_mul_f32 v[20:21], v[20:21], v[30:31] op_sel:[0,1] op_sel_hi:[1,1]
    v_pk_mul_f32 v[22:23], v[22:23], v[30:31] op_sel:[0,1] op_sel_hi:[1,1]
    v_pk_mul_f32 v[24:25], v[24:25], v[30:31] op_sel:[0,1] op_sel_hi:[1,1]
    v_pk_mul_f32 v[26:27], v[26:27], v[30:31] op_sel:[0,1] op_sel_hi:[1,1]
    v_pk_mul_f32 v[28:29], v[28:29], v[30:31] op_sel:[0,1] op_sel_hi:[1,1]
    v_exp_f32 v14, -v14
    v_exp_f32 v15, -v15
    v_exp_f32 v16, -v16
    v_exp_f32 v17, -v17
    v_exp_f32 v18, -v18
    v_exp_f32 v19, -v19
    v_exp_f32 v20, -v20
    v_exp_f32 v21, -v21
    v_exp_f32 v22, -v22
    v_exp_f32 v23, -v23
    v_exp_f32 v24, -v24
    v_exp_f32 v25, -v25
    v_exp_f32 v26, -v26
    v_exp_f32 v27, -v27
    v_exp_f32 v28, -v28
    v_exp_f32 v29, -v29
    v_cvt_pk_bf16_f32 v14, v14, v16
    v_cvt_pk_bf16_f32 v15, v15, v17
    v_cvt_pk_bf16_f32 v18, v18, v20
    v_cvt_pk_bf16_f32 v19, v19, v21
    v_cvt_pk_bf16_f32 v22, v22, v24
    v_cvt_pk_bf16_f32 v23, v23, v25
    v_cvt_pk_bf16_f32 v26, v26, v28
    v_cvt_pk_bf16_f32 v27, v27, v29
    v_dot2_f32_bf16 v72, v14, s68, 0
    v_dot2_f32_bf16 v73, v15, s68, 0
    v_dot2_f32_bf16 v74, v14, s69, 0
    v_dot2_f32_bf16 v75, v15, s69, 0
    v_dot2_f32_bf16 v76, v14, s70, 0
    v_dot2_f32_bf16 v77, v15, s70, 0
    v_dot2_f32_bf16 v78, v14, s71, 0
    v_dot2_f32_bf16 v79, v15, s71, 0
    v_dot2_f32_bf16 v80, v14, s52, 0
    v_dot2_f32_bf16 v81, v15, s52, 0
    v_dot2_f32_bf16 v82, v14, s53, 0
    v_dot2_f32_bf16 v83, v15, s53, 0
    v_dot2_f32_bf16 v84, v14, s54, 0
    v_dot2_f32_bf16 v85, v15, s54, 0
    v_dot2_f32_bf16 v86, v14, s55, 0
    v_dot2_f32_bf16 v87, v15, s55, 0
    v_dot2_f32_bf16 v72, v18, s72, v72
    v_dot2_f32_bf16 v73, v19, s72, v73
    v_dot2_f32_bf16 v74, v18, s73, v74
    v_dot2_f32_bf16 v75, v19, s73, v75
    v_dot2_f32_bf16 v76, v18, s74, v76
    v_dot2_f32_bf16 v77, v19, s74, v77
    v_dot2_f32_bf16 v78, v18, s75, v78
    v_dot2_f32_bf16 v79, v19, s75, v79
    v_dot2_f32_bf16 v80, v18, s56, v80
    v_dot2_f32_bf16 v81, v19, s56, v81
    v_dot2_f32_bf16 v82, v18, s57, v82
    v_dot2_f32_bf16 v83, v19, s57, v83
    v_dot2_f32_bf16 v84, v18, s58, v84
    v_dot2_f32_bf16 v85, v19, s58, v85
    v_dot2_f32_bf16 v86, v18, s59, v86
    v_dot2_f32_bf16 v87, v19, s59, v87
    v_dot2_f32_bf16 v72, v22, s76, v72
    v_dot2_f32_bf16 v73, v23, s76, v73
    v_dot2_f32_bf16 v74, v22, s77, v74
    v_dot2_f32_bf16 v75, v23, s77, v75
    v_dot2_f32_bf16 v76, v22, s78, v76
    v_dot2_f32_bf16 v77, v23, s78, v77
    v_dot2_f32_bf16 v78, v22, s79, v78
    v_dot2_f32_bf16 v79, v23, s79, v79
    v_dot2_f32_bf16 v80, v22, s60, v80
    v_dot2_f32_bf16 v81, v23, s60, v81
    v_dot2_f32_bf16 v82, v22, s61, v82
    v_dot2_f32_bf16 v83, v23, s61, v83
    v_dot2_f32_bf16 v84, v22, s62, v84
    v_dot2_f32_bf16 v85, v23, s62, v85
    v_dot2_f32_bf16 v86, v22, s63, v86
    v_dot2_f32_bf16 v87, v23, s63, v87
    v_dot2_f32_bf16 v72, v26, s80, v72
    v_dot2_f32_bf16 v73, v27, s80, v73
    v_dot2_f32_bf16 v74, v26, s81, v74
    v_dot2_f32_bf16 v75, v27, s81, v75
    v_dot2_f32_bf16 v76, v26, s82, v76
    v_dot2_f32_bf16 v77, v27, s82, v77
    v_dot2_f32_bf16 v78, v26, s83, v78
    v_dot2_f32_bf16 v79, v27, s83, v79
    v_dot2_f32_bf16 v80, v26, s64, v80
    v_dot2_f32_bf16 v81, v27, s64, v81
    v_dot2_f32_bf16 v82, v26, s65, v82
    v_dot2_f32_bf16 v83, v27, s65, v83
    v_dot2_f32_bf16 v84, v26, s66, v84
    v_dot2_f32_bf16 v85, v27, s66, v85
    v_dot2_f32_bf16 v86, v26, s67, v86
    v_dot2_f32_bf16 v87, v27, s67, v87
    s_cmp_ge_u32 s13, 4
    s_cbranch_scc1 L_p2_kernel_g1_30
    v_lshlrev_b32 v30, 16, v61
    v_and_b32 v31, 0xffff0000, v61
    v_pk_add_f32 v[14:15], v[30:31], v[36:37] op_sel:[0,0] op_sel_hi:[1,0] neg_lo:[0,1] neg_hi:[0,1]
    v_pk_add_f32 v[16:17], v[30:31], v[36:37] op_sel:[0,1] op_sel_hi:[1,1] neg_lo:[0,1] neg_hi:[0,1]
    v_pk_add_f32 v[18:19], v[30:31], v[38:39] op_sel:[0,0] op_sel_hi:[1,0] neg_lo:[0,1] neg_hi:[0,1]
    v_pk_add_f32 v[20:21], v[30:31], v[38:39] op_sel:[0,1] op_sel_hi:[1,1] neg_lo:[0,1] neg_hi:[0,1]
    v_pk_add_f32 v[22:23], v[30:31], v[40:41] op_sel:[0,0] op_sel_hi:[1,0] neg_lo:[0,1] neg_hi:[0,1]
    v_pk_add_f32 v[24:25], v[30:31], v[40:41] op_sel:[0,1] op_sel_hi:[1,1] neg_lo:[0,1] neg_hi:[0,1]
    v_pk_add_f32 v[26:27], v[30:31], v[42:43] op_sel:[0,0] op_sel_hi:[1,0] neg_lo:[0,1] neg_hi:[0,1]
    v_pk_add_f32 v[28:29], v[30:31], v[42:43] op_sel:[0,1] op_sel_hi:[1,1] neg_lo:[0,1] neg_hi:[0,1]
    v_cvt_pk_bf16_f32 v32, v14, v15
    v_lshlrev_b32 v14, 16, v32
    v_and_b32 v15, 0xffff0000, v32
    v_cvt_pk_bf16_f32 v32, v16, v17
    v_lshlrev_b32 v16, 16, v32
    v_and_b32 v17, 0xffff0000, v32
    v_cvt_pk_bf16_f32 v32, v18, v19
    v_lshlrev_b32 v18, 16, v32
    v_and_b32 v19, 0xffff0000, v32
    v_cvt_pk_bf16_f32 v32, v20, v21
    v_lshlrev_b32 v20, 16, v32
    v_and_b32 v21, 0xffff0000, v32
    v_cvt_pk_bf16_f32 v32, v22, v23
    v_lshlrev_b32 v22, 16, v32
    v_and_b32 v23, 0xffff0000, v32
    v_cvt_pk_bf16_f32 v32, v24, v25
    v_lshlrev_b32 v24, 16, v32
    v_and_b32 v25, 0xffff0000, v32
    v_cvt_pk_bf16_f32 v32, v26, v27
    v_lshlrev_b32 v26, 16, v32
    v_and_b32 v27, 0xffff0000, v32
    v_cvt_pk_bf16_f32 v32, v28, v29
    v_lshlrev_b32 v28, 16, v32
    v_and_b32 v29, 0xffff0000, v32
    v_pk_mul_f32 v[14:15], v[14:15], v[14:15]
    v_pk_mul_f32 v[16:17], v[16:17], v[16:17]
    v_pk_mul_f32 v[18:19], v[18:19], v[18:19]
    v_pk_mul_f32 v[20:21], v[20:21], v[20:21]
    v_pk_mul_f32 v[22:23], v[22:23], v[22:23]
    v_pk_mul_f32 v[24:25], v[24:25], v[24:25]
    v_pk_mul_f32 v[26:27], v[26:27], v[26:27]
    v_pk_mul_f32 v[28:29], v[28:29], v[28:29]
    v_cvt_pk_bf16_f32 v32, v14, v15
    v_lshlrev_b32 v14, 16, v32
    v_and_b32 v15, 0xffff0000, v32
    v_cvt_pk_bf16_f32 v32, v16, v17
    v_lshlrev_b32 v16, 16, v32
    v_and_b32 v17, 0xffff0000, v32
    v_cvt_pk_bf16_f32 v32, v18, v19
    v_lshlrev_b32 v18, 16, v32
    v_and_b32 v19, 0xffff0000, v32
    v_cvt_pk_bf16_f32 v32, v20, v21
    v_lshlrev_b32 v20, 16, v32
    v_and_b32 v21, 0xffff0000, v32
    v_cvt_pk_bf16_f32 v32, v22, v23
    v_lshlrev_b32 v22, 16, v32
    v_and_b32 v23, 0xffff0000, v32
    v_cvt_pk_bf16_f32 v32, v24, v25
    v_lshlrev_b32 v24, 16, v32
    v_and_b32 v25, 0xffff0000, v32
    v_cvt_pk_bf16_f32 v32, v26, v27
    v_lshlrev_b32 v26, 16, v32
    v_and_b32 v27, 0xffff0000, v32
    v_cvt_pk_bf16_f32 v32, v28, v29
    v_lshlrev_b32 v28, 16, v32
    v_and_b32 v29, 0xffff0000, v32
    v_mov_b32 v30, 1092616192
    v_mov_b32 v31, 0x3fb8aa3b
    v_pk_mul_f32 v[14:15], v[14:15], v[30:31] op_sel:[0,0] op_sel_hi:[1,0]
    v_pk_mul_f32 v[16:17], v[16:17], v[30:31] op_sel:[0,0] op_sel_hi:[1,0]
    v_pk_mul_f32 v[18:19], v[18:19], v[30:31] op_sel:[0,0] op_sel_hi:[1,0]
    v_pk_mul_f32 v[20:21], v[20:21], v[30:31] op_sel:[0,0] op_sel_hi:[1,0]
    v_pk_mul_f32 v[22:23], v[22:23], v[30:31] op_sel:[0,0] op_sel_hi:[1,0]
    v_pk_mul_f32 v[24:25], v[24:25], v[30:31] op_sel:[0,0] op_sel_hi:[1,0]
    v_pk_mul_f32 v[26:27], v[26:27], v[30:31] op_sel:[0,0] op_sel_hi:[1,0]
    v_pk_mul_f32 v[28:29], v[28:29], v[30:31] op_sel:[0,0] op_sel_hi:[1,0]
    v_cvt_pk_bf16_f32 v32, v14, v15
    v_lshlrev_b32 v14, 16, v32
    v_and_b32 v15, 0xffff0000, v32
    v_cvt_pk_bf16_f32 v32, v16, v17
    v_lshlrev_b32 v16, 16, v32
    v_and_b32 v17, 0xffff0000, v32
    v_cvt_pk_bf16_f32 v32, v18, v19
    v_lshlrev_b32 v18, 16, v32
    v_and_b32 v19, 0xffff0000, v32
    v_cvt_pk_bf16_f32 v32, v20, v21
    v_lshlrev_b32 v20, 16, v32
    v_and_b32 v21, 0xffff0000, v32
    v_cvt_pk_bf16_f32 v32, v22, v23
    v_lshlrev_b32 v22, 16, v32
    v_and_b32 v23, 0xffff0000, v32
    v_cvt_pk_bf16_f32 v32, v24, v25
    v_lshlrev_b32 v24, 16, v32
    v_and_b32 v25, 0xffff0000, v32
    v_cvt_pk_bf16_f32 v32, v26, v27
    v_lshlrev_b32 v26, 16, v32
    v_and_b32 v27, 0xffff0000, v32
    v_cvt_pk_bf16_f32 v32, v28, v29
    v_lshlrev_b32 v28, 16, v32
    v_and_b32 v29, 0xffff0000, v32
    v_pk_mul_f32 v[14:15], v[14:15], v[30:31] op_sel:[0,1] op_sel_hi:[1,1]
    v_pk_mul_f32 v[16:17], v[16:17], v[30:31] op_sel:[0,1] op_sel_hi:[1,1]
    v_pk_mul_f32 v[18:19], v[18:19], v[30:31] op_sel:[0,1] op_sel_hi:[1,1]
    v_pk_mul_f32 v[20:21], v[20:21], v[30:31] op_sel:[0,1] op_sel_hi:[1,1]
    v_pk_mul_f32 v[22:23], v[22:23], v[30:31] op_sel:[0,1] op_sel_hi:[1,1]
    v_pk_mul_f32 v[24:25], v[24:25], v[30:31] op_sel:[0,1] op_sel_hi:[1,1]
    v_pk_mul_f32 v[26:27], v[26:27], v[30:31] op_sel:[0,1] op_sel_hi:[1,1]
    v_pk_mul_f32 v[28:29], v[28:29], v[30:31] op_sel:[0,1] op_sel_hi:[1,1]
    v_exp_f32 v14, -v14
    v_exp_f32 v15, -v15
    v_exp_f32 v16, -v16
    v_exp_f32 v17, -v17
    v_exp_f32 v18, -v18
    v_exp_f32 v19, -v19
    v_exp_f32 v20, -v20
    v_exp_f32 v21, -v21
    v_exp_f32 v22, -v22
    v_exp_f32 v23, -v23
    v_exp_f32 v24, -v24
    v_exp_f32 v25, -v25
    v_exp_f32 v26, -v26
    v_exp_f32 v27, -v27
    v_exp_f32 v28, -v28
    v_exp_f32 v29, -v29
    v_cvt_pk_bf16_f32 v14, v14, v16
    v_cvt_pk_bf16_f32 v15, v15, v17
    v_cvt_pk_bf16_f32 v18, v18, v20
    v_cvt_pk_bf16_f32 v19, v19, v21
    v_cvt_pk_bf16_f32 v22, v22, v24
    v_cvt_pk_bf16_f32 v23, v23, v25
    v_cvt_pk_bf16_f32 v26, v26, v28
    v_cvt_pk_bf16_f32 v27, v27, v29
    v_dot2_f32_bf16 v112, v14, s68, 0
    v_dot2_f32_bf16 v113, v15, s68, 0
    v_dot2_f32_bf16 v114, v14, s69, 0
    v_dot2_f32_bf16 v115, v15, s69, 0
    v_dot2_f32_bf16 v116, v14, s70, 0
    v_dot2_f32_bf16 v117, v15, s70, 0
    v_dot2_f32_bf16 v118, v14, s71, 0
    v_dot2_f32_bf16 v119, v15, s71, 0
    v_dot2_f32_bf16 v120, v14, s52, 0
    v_dot2_f32_bf16 v121, v15, s52, 0
    v_dot2_f32_bf16 v122, v14, s53, 0
    v_dot2_f32_bf16 v123, v15, s53, 0
    v_dot2_f32_bf16 v124, v14, s54, 0
    v_dot2_f32_bf16 v125, v15, s54, 0
    v_dot2_f32_bf16 v126, v14, s55, 0
    v_dot2_f32_bf16 v127, v15, s55, 0
    v_dot2_f32_bf16 v112, v18, s72, v112
    v_dot2_f32_bf16 v113, v19, s72, v113
    v_dot2_f32_bf16 v114, v18, s73, v114
    v_dot2_f32_bf16 v115, v19, s73, v115
    v_dot2_f32_bf16 v116, v18, s74, v116
    v_dot2_f32_bf16 v117, v19, s74, v117
    v_dot2_f32_bf16 v118, v18, s75, v118
    v_dot2_f32_bf16 v119, v19, s75, v119
    v_dot2_f32_bf16 v120, v18, s56, v120
    v_dot2_f32_bf16 v121, v19, s56, v121
    v_dot2_f32_bf16 v122, v18, s57, v122
    v_dot2_f32_bf16 v123, v19, s57, v123
    v_dot2_f32_bf16 v124, v18, s58, v124
    v_dot2_f32_bf16 v125, v19, s58, v125
    v_dot2_f32_bf16 v126, v18, s59, v126
    v_dot2_f32_bf16 v127, v19, s59, v127
    v_dot2_f32_bf16 v112, v22, s76, v112
    v_dot2_f32_bf16 v113, v23, s76, v113
    v_dot2_f32_bf16 v114, v22, s77, v114
    v_dot2_f32_bf16 v115, v23, s77, v115
    v_dot2_f32_bf16 v116, v22, s78, v116
    v_dot2_f32_bf16 v117, v23, s78, v117
    v_dot2_f32_bf16 v118, v22, s79, v118
    v_dot2_f32_bf16 v119, v23, s79, v119
    v_dot2_f32_bf16 v120, v22, s60, v120
    v_dot2_f32_bf16 v121, v23, s60, v121
    v_dot2_f32_bf16 v122, v22, s61, v122
    v_dot2_f32_bf16 v123, v23, s61, v123
    v_dot2_f32_bf16 v124, v22, s62, v124
    v_dot2_f32_bf16 v125, v23, s62, v125
    v_dot2_f32_bf16 v126, v22, s63, v126
    v_dot2_f32_bf16 v127, v23, s63, v127
    v_dot2_f32_bf16 v112, v26, s80, v112
    v_dot2_f32_bf16 v113, v27, s80, v113
    v_dot2_f32_bf16 v114, v26, s81, v114
    v_dot2_f32_bf16 v115, v27, s81, v115
    v_dot2_f32_bf16 v116, v26, s82, v116
    v_dot2_f32_bf16 v117, v27, s82, v117
    v_dot2_f32_bf16 v118, v26, s83, v118
    v_dot2_f32_bf16 v119, v27, s83, v119
    v_dot2_f32_bf16 v120, v26, s64, v120
    v_dot2_f32_bf16 v121, v27, s64, v121
    v_dot2_f32_bf16 v122, v26, s65, v122
    v_dot2_f32_bf16 v123, v27, s65, v123
    v_dot2_f32_bf16 v124, v26, s66, v124
    v_dot2_f32_bf16 v125, v27, s66, v125
    v_dot2_f32_bf16 v126, v26, s67, v126
    v_dot2_f32_bf16 v127, v27, s67, v127
L_p2_kernel_g1_30:
    s_cmp_eq_u32 s49, 3
    s_cselect_b32 s15, 8, 0
    s_add_u32 s15, s15, 224
    v_add_u32 v2, 16384, v1
    v_cmp_gt_u32 vcc, s15, v0
    s_mul_i32 s14, s3, 80000
    s_mul_i32 s26, s49, 19968
    s_add_u32 s26, s26, s14
    v_cndmask_b32 v2, 0.5, v2, vcc
    s_mov_b32 s10, 5120000
    buffer_load_dwordx4 v[64:67], v1, s[8:11], s26 offen
    buffer_load_dwordx4 v[68:71], v2, s[8:11], s26 offen
    s_branch L_p2_fin
L_p2_done:
    s_branch L_p2_end
L_p2_slow:
    s_barrier
    v_mov_b32 v8, 0
    v_mov_b32 v9, 0
    v_mov_b32 v10, 0
    v_mov_b32 v11, 0
    v_mov_b32 v12, v1
    ds_write_b128 v12, v[8:11]
    v_add_u32 v12, 16384, v12
    ds_write_b128 v12, v[8:11]
    v_add_u32 v12, 16384, v12
    ds_write_b128 v12, v[8:11]
    v_add_u32 v12, 16384, v12
    ds_write_b128 v12, v[8:11]
    v_add_u32 v12, 16384, v12
    ds_write_b128 v12, v[8:11]
    v_add_u32 v12, 16384, v12
    ds_write_b128 v12, v[8:11]
    v_add_u32 v12, 16384, v12
    ds_write_b128 v12, v[8:11]
    v_add_u32 v12, 16384, v12
    ds_write_b128 v12, v[8:11]
    v_add_u32 v12, 16384, v12
    ds_write_b128 v12, v[8:11]
    v_add_u32 v12, 16384, v12
    ds_write_b128 v12, v[8:11]
    v_add_u32 v12, 16384, v12
    v_mul_u32_u24 v13, 8320, v0
    v_mov_b32 v29, 0x7fc00000
    v_add_u32 v28, 32, v13
    v_lshlrev_b32 v14, 12, v0
    v_add_u32 v14, 0, v14
    s_mul_i32 s25, s12, 65
    s_add_u32 s25, s25, s3
    s_lshl_b32 s25, s25, 5
    s_add_u32 s25, s25, 222298112
    s_lshl_b32 s50, s50, 1
    s_mul_i32 s22, s12, 1280000
    s_mov_b32 s24, 0
    s_waitcnt lgkmcnt(0)
    s_barrier
L_p2_sstep:
    buffer_load_ushort v15, v13, s[4:7], s25 offen
    buffer_load_ushort v16, v28, s[4:7], s25 offen
    s_waitcnt vmcnt(0)
L_p2_srec:
    v_cmp_lt_u32 vcc, v15, v16
    s_nop 1
    s_and_b64 exec, exec, vcc
    s_cbranch_execz L_p2_sdone
    v_mul_u32_u24 v17, 43691, v15
    v_lshrrev_b32 v17, 17, v17
    v_mad_i32_i24 v18, v17, -3, v15
    v_lshrrev_b32 v19, 8, v17
    v_lshl_add_u32 v19, v19, 22, v14
    v_and_b32 v17, 255, v17
    v_lshl_add_u32 v17, v17, 4, v19
    v_lshl_add_u32 v19, v18, 2, v17
    buffer_load_dword v20, v19, s[4:7], 0 offen
    buffer_load_dword v21, v17, s[4:7], 0 offen offset:12
    v_add_u32 v15, 1, v15
    v_mad_u32_u24 v18, v18, 10, 2
    s_waitcnt vmcnt(0)
    v_and_b32 v19, 0x3fff, v20
    v_lshlrev_b32 v19, 3, v19
    buffer_load_dwordx2 v[22:23], v19, s[8:11], s22 offen
    v_mad_u32_u16 v20, v20, 16, s50 op_sel:[1,0,0,0]
    v_bfe_i32 v21, v21, v18, 10
    v_cmp_eq_i32 vcc, -512, v21
    v_cvt_f32_i32 v21, v21
    v_mul_f32 v21, 989872160, v21
    v_cndmask_b32 v21, v21, v29, vcc
    s_waitcnt vmcnt(0)
    v_lshlrev_b32 v24, 16, v22
    v_and_b32 v25, 0xffff0000, v22
    v_lshlrev_b32 v26, 16, v23
    v_and_b32 v27, 0xffff0000, v23
    v_mul_f32 v24, v21, v24
    v_mul_f32 v25, v21, v25
    v_mul_f32 v26, v21, v26
    v_mul_f32 v27, v21, v27
    ds_add_f32 v20, v24
    ds_add_f32 v20, v25 offset:4
    ds_add_f32 v20, v26 offset:8
    ds_add_f32 v20, v27 offset:12
    s_branch L_p2_srec
L_p2_sdone:
    s_mov_b64 exec, -1
    s_add_u32 s25, s25, 2
    s_add_u32 s22, s22, 80000
    s_add_u32 s24, s24, 1
    s_cmp_lt_u32 s24, 16
    s_cbranch_scc1 L_p2_sstep
    s_waitcnt lgkmcnt(0)
    s_barrier
    s_mul_i32 s14, s12, 10240000
    s_mul_i32 s15, s3, 160000
    s_add_u32 s26, s14, s15
    s_add_u32 s26, s26, 251318272
    v_mov_b32 v12, v1
    s_mov_b32 s24, 0
L_p2_sout:
    v_cmp_gt_u32 vcc, 160000, v12
    ds_read_b128 v[8:11], v12
    s_nop 0
    s_and_b64 exec, exec, vcc
    s_cbranch_execz L_p2_sfin
    s_waitcnt lgkmcnt(0)
    buffer_store_dwordx4 v[8:11], v12, s[4:7], s26 offen sc1
    s_waitcnt vmcnt(0)
    v_add_u32 v12, 16384, v12
    s_branch L_p2_sout
L_p2_sfin:
    s_mov_b64 exec, -1
    s_waitcnt vmcnt(0) lgkmcnt(0)
    s_barrier
    s_branch L_p2_signal
L_p2_end:
    s_endpgm
.section .rodata,"a"
.p2align 6
.amdhsa_kernel p1_kernel
  .amdhsa_next_free_vgpr 128
  .amdhsa_next_free_sgpr 96
  .amdhsa_accum_offset 128
  .amdhsa_group_segment_fixed_size 0
  .amdhsa_kernarg_size 112
  .amdhsa_user_sgpr_count 2
  .amdhsa_user_sgpr_kernarg_segment_ptr 1
  .amdhsa_system_sgpr_workgroup_id_x 1
  .amdhsa_float_denorm_mode_32 0
.end_amdhsa_kernel
.p2align 6
.amdhsa_kernel p2_kernel
  .amdhsa_next_free_vgpr 128
  .amdhsa_next_free_sgpr 102
  .amdhsa_accum_offset 128
  .amdhsa_group_segment_fixed_size 0
  .amdhsa_kernarg_size 112
  .amdhsa_user_sgpr_count 2
  .amdhsa_user_sgpr_kernarg_segment_ptr 1
  .amdhsa_system_sgpr_workgroup_id_x 1
  .amdhsa_float_denorm_mode_32 0
.end_amdhsa_kernel
```
